```python
import torch

def _softmax(x, axis=-1):
    return torch.softmax(x, dim=axis)
def _gelu(x):
    return torch.nn.functional.gelu(x, approximate="tanh")
def _silu(x):
    return torch.nn.functional.silu(x)
def _sigmoid(x):
    return torch.sigmoid(x)
def _layernorm(x, axis=-1, eps=1e-5):
    m = x.mean(dim=axis, keepdim=True)
    v = x.var(dim=axis, keepdim=True, unbiased=False)
    return (x - m) / torch.sqrt(v + eps)
def _scatter_add(tgt, idx, src, axis=0):
    return tgt.clone().index_add_(axis, idx, src)
def _segment_sum(src, seg, n):
    out = torch.zeros((n,) + src.shape[1:], dtype=src.dtype)
    return out.index_add_(0, seg, src)
def _pad(x, pw):
    flat = tuple(v for pair in reversed(pw) for v in pair)
    return torch.nn.functional.pad(x, flat)

kernel_name = 'concat_heads__ssm_conv_h3__compressed_kv_cla__prompt'

def setup_inputs():

    _w = (lambda a: (lambda t: t.to(torch.bfloat16) if t.is_floating_point() else t)(torch.as_tensor(a)))
    def _A_setup():
        B, S, D = 1, 2048, 448
        ks = 4
        return {
            "q": _w((lambda *s: torch.randn(*s, dtype=torch.bfloat16) * 0.05)(B, S, D)),
            "k": _w((lambda *s: torch.randn(*s, dtype=torch.bfloat16) * 0.1)(B, S, D)),
            "v": _w((lambda *s: torch.randn(*s, dtype=torch.bfloat16) * 0.1)(B, S, D)),
            "shift_k": _w((lambda *s: torch.randn(*s, dtype=torch.bfloat16) * 0.1)(D, ks) * 0.5),
            "ssm_k": _w((lambda *s: torch.randn(*s, dtype=torch.bfloat16) * 0.1)(D, S) * (1.0 / S ** 0.5)),
            "ssm_D": _w((lambda *s: torch.randn(*s, dtype=torch.bfloat16) * 0.1)(D)),
        }
    _A_in = _A_setup()

    def _B_setup():
        B, H, Sq, Sk, D, M = 1, 16, 2048, 2048, 256, 448
        Dc = 4 * D
        return {
            "x": _w((lambda *s: torch.randn(*s, dtype=torch.bfloat16) * 3.2)(B, Sq, M)),
            "c_kv": _w((lambda *s: torch.randn(*s, dtype=torch.bfloat16) * 0.05)(B, Sk, Dc)),
            "w_q": _w((lambda *s: torch.randn(*s, dtype=torch.bfloat16) * 3.2)(M, H, D) * (M ** -0.5)),
            "w_uk": _w((lambda *s: torch.randn(*s, dtype=torch.bfloat16) * 3.2)(Dc, H, D) * (Dc ** -0.5)),
            "w_uv": _w((lambda *s: torch.randn(*s, dtype=torch.bfloat16) * 0.05)(Dc, H, D) * (Dc ** -0.5)),
            "w_o": _w((lambda *s: torch.randn(*s, dtype=torch.bfloat16) * 0.05)(H, D, M) * ((H * D) ** -0.5)),
        }
    _B_in = _B_setup()

    return {
        "A_q": _A_in["q"],
        "A_k": _A_in["k"],
        "A_v": _A_in["v"],
        "A_shift_k": _A_in["shift_k"],
        "A_ssm_k": _A_in["ssm_k"],
        "A_ssm_D": _A_in["ssm_D"],
        "B_x": _B_in["x"],
        "B_c_kv": _B_in["c_kv"],
        "B_w_q": _B_in["w_q"],
        "B_w_uk": _B_in["w_uk"],
        "B_w_uv": _B_in["w_uv"],
        "B_w_o": _B_in["w_o"],
    }

def reference(A_q, A_k, A_v, A_shift_k, A_ssm_k, A_ssm_D, B_x, B_c_kv, B_w_q, B_w_uk, B_w_uv, B_w_o):
    def _A_ref(q, k, v, shift_k, ssm_k, ssm_D):
        B, S, D = q.shape
        ks = shift_k.shape[-1]
        k_pad = _pad(k, ((0, 0), (ks - 1, 0), (0, 0)))
        k_shift = torch.zeros_like(k)
        for t in range(ks):
            k_shift = k_shift + k_pad[:, t:t + S, :] * shift_k[:, ks - 1 - t][None, None, :]
        kv = k_shift * v
        L = 2 * S
        kv_pad = _pad(kv, ((0, 0), (0, S), (0, 0)))
        kf_pad = _pad(ssm_k, ((0, 0), (0, S)))
        kv_f = (lambda x, axes=(-2,-1): torch.fft.rfft2(x.float(), dim=axes))(kv_pad[:, None, :, :], axes=(1, 2))
        kf_f = (lambda x, axes=(-2,-1): torch.fft.rfft2(x.float(), dim=axes))(kf_pad[:, None, :], axes=(1, 2))
        kf_f = (lambda x, *d: x.permute(*d))(kf_f, 1, 2, 0)
        y_f = kv_f * kf_f[None, :, :, :]
        y = (lambda x, s, axes=(-2,-1): torch.fft.irfft2(x, s=s, dim=axes).to(torch.bfloat16))(y_f, (1, L), axes=(1, 2))[:, 0, :S, :]
        y = y + kv * ssm_D[None, None, :]
        return q * y

    def _B_ref(x, c_kv, w_q, w_uk, w_uv, w_o):
        B, Sq, M = x.shape[0], x.shape[1], x.shape[2]
        Sk = c_kv.shape[1]
        H, D = w_q.shape[1], w_q.shape[2]
        q = torch.einsum("bqm,mhd->bhqd", x, w_q)
        k = torch.einsum("bkc,chd->bhkd", c_kv, w_uk)
        v = torch.einsum("bkc,chd->bhkd", c_kv, w_uv)
        scores = torch.einsum("bhqd,bhkd->bhqk", q, k) * (D ** -0.5)
        off = Sk - Sq
        qi = torch.arange(Sq)[:, None]
        kj = torch.arange(Sk)[None, :]
        cmask = kj <= (qi + off)
        scores = torch.where(cmask[None, None], scores, -1e9)
        p = _softmax(scores, axis=-1)
        ctx = torch.einsum("bhqk,bhkd->bhqd", p, v)
        return torch.einsum("bhqd,hdm->bqm", ctx, w_o)

    a = _A_ref(A_q, A_k, A_v, A_shift_k, A_ssm_k, A_ssm_D)
    b = _B_ref(B_x, B_c_kv, B_w_q, B_w_uk, B_w_uv, B_w_o)
    return torch.concatenate([a, b], axis=-1)
```

```asm
; @launch kernel=s1_kernel grid=(224,1,1) block=(256,1,1) lds=8192
; @launch kernel=s2_kernel grid=(224,1,1) block=(256,1,1) lds=51328
; @launch kernel=k1_kernel grid=(256,1,1) block=(256,1,1) lds=131072
; @launch kernel=k2_kernel grid=(256,1,1) block=(256,1,1) lds=131072
; @launch kernel=k3_kernel grid=(224,1,1) block=(256,1,1) lds=139264
.amdgcn_target "amdgcn-amd-amdhsa--gfx950"
.text
.globl s1_kernel
.p2align 8
.type s1_kernel,@function
s1_kernel:
    s_cmp_ge_u32 s2, 224
    s_cbranch_scc1 s1_kernel_end
    s_load_dwordx4 s[20:23], s[0:1], 8
    s_load_dwordx2 s[24:25], s[0:1], 24
    s_load_dwordx2 s[30:31], s[0:1], 112
    s_and_b32 s33, s2, 31
    s_lshr_b32 s34, s2, 5
    v_lshrrev_b32 v1, 3, v0
    v_lshlrev_b32 v4, 8, v1
    v_lshlrev_b32 v1, 1, v1
    s_lshl_b32 s35, s33, 6
    v_add_u32 v1, s35, v1
    v_mul_u32_u24 v1, 896, v1
    v_and_b32 v3, 7, v0
    v_lshl_add_u32 v1, v3, 4, v1
    s_lshl_b32 s35, s34, 7
    v_add_u32 v1, s35, v1
    v_lshl_add_u32 v4, v3, 4, v4
    v_lshlrev_b32 v3, 6, v3
    s_lshl_b32 s35, s34, 9
    v_add_u32 v3, s35, v3
    v_subrev_u32 v5, 2688, v1
    v_subrev_u32 v6, 1792, v1
    v_subrev_u32 v7, 896, v1
    v_lshrrev_b32 v2, 6, v0
    v_and_b32 v0, 63, v0
    v_readfirstlane_b32 s3, v2
    s_waitcnt lgkmcnt(0)
    s_mov_b32 s4, s20
    s_mov_b32 s5, s21
    s_mov_b32 s6, 1835008
    s_mov_b32 s7, 0x20000
    s_mov_b32 s8, s22
    s_mov_b32 s9, s23
    s_mov_b32 s10, 1835008
    s_mov_b32 s11, 0x20000
    s_mov_b32 s16, s24
    s_mov_b32 s17, s25
    s_mov_b32 s18, 3584
    s_mov_b32 s19, 0x20000
    s_mov_b32 s12, s30
    s_mov_b32 s13, s31
    s_mov_b32 s14, 268435456
    s_mov_b32 s15, 0x20000
    buffer_load_dwordx4 v[16:19], v5, s[4:7], 0 offen
    buffer_load_dwordx4 v[20:23], v6, s[4:7], 0 offen
    buffer_load_dwordx4 v[24:27], v7, s[4:7], 0 offen
    buffer_load_dwordx4 v[28:31], v1, s[4:7], 0 offen offset:0
    buffer_load_dwordx4 v[32:35], v1, s[4:7], 0 offen offset:896
    buffer_load_dwordx4 v[36:39], v1, s[8:11], 0 offen offset:0
    buffer_load_dwordx4 v[40:43], v1, s[8:11], 0 offen offset:896
    buffer_load_dwordx4 v[44:47], v3, s[16:19], 0 offen offset:0
    buffer_load_dwordx4 v[48:51], v3, s[16:19], 0 offen offset:16
    buffer_load_dwordx4 v[52:55], v3, s[16:19], 0 offen offset:32
    buffer_load_dwordx4 v[56:59], v3, s[16:19], 0 offen offset:48
    s_mov_b32 s36, 0xffff0000
    s_waitcnt vmcnt(0)
    v_lshlrev_b32 v64, 16, v16
    v_lshlrev_b32 v65, 16, v20
    v_lshlrev_b32 v66, 16, v24
    v_lshlrev_b32 v67, 16, v28
    v_lshlrev_b32 v68, 16, v32
    v_lshlrev_b32 v70, 16, v36
    v_lshlrev_b32 v71, 16, v40
    v_lshlrev_b32 v72, 16, v44
    v_and_b32 v73, s36, v44
    v_lshlrev_b32 v74, 16, v45
    v_and_b32 v75, s36, v45
    v_mul_f32 v80, v64, v75
    v_fmac_f32 v80, v65, v74
    v_fmac_f32 v80, v66, v73
    v_fmac_f32 v80, v67, v72
    v_mul_f32 v80, v80, v70
    v_mul_f32 v88, v65, v75
    v_fmac_f32 v88, v66, v74
    v_fmac_f32 v88, v67, v73
    v_fmac_f32 v88, v68, v72
    v_mul_f32 v88, v88, v71
    v_and_b32 v64, s36, v16
    v_and_b32 v65, s36, v20
    v_and_b32 v66, s36, v24
    v_and_b32 v67, s36, v28
    v_and_b32 v68, s36, v32
    v_and_b32 v70, s36, v36
    v_and_b32 v71, s36, v40
    v_lshlrev_b32 v72, 16, v46
    v_and_b32 v73, s36, v46
    v_lshlrev_b32 v74, 16, v47
    v_and_b32 v75, s36, v47
    v_mul_f32 v81, v64, v75
    v_fmac_f32 v81, v65, v74
    v_fmac_f32 v81, v66, v73
    v_fmac_f32 v81, v67, v72
    v_mul_f32 v81, v81, v70
    v_mul_f32 v89, v65, v75
    v_fmac_f32 v89, v66, v74
    v_fmac_f32 v89, v67, v73
    v_fmac_f32 v89, v68, v72
    v_mul_f32 v89, v89, v71
    v_lshlrev_b32 v64, 16, v17
    v_lshlrev_b32 v65, 16, v21
    v_lshlrev_b32 v66, 16, v25
    v_lshlrev_b32 v67, 16, v29
    v_lshlrev_b32 v68, 16, v33
    v_lshlrev_b32 v70, 16, v37
    v_lshlrev_b32 v71, 16, v41
    v_lshlrev_b32 v72, 16, v48
    v_and_b32 v73, s36, v48
    v_lshlrev_b32 v74, 16, v49
    v_and_b32 v75, s36, v49
    v_mul_f32 v82, v64, v75
    v_fmac_f32 v82, v65, v74
    v_fmac_f32 v82, v66, v73
    v_fmac_f32 v82, v67, v72
    v_mul_f32 v82, v82, v70
    v_mul_f32 v90, v65, v75
    v_fmac_f32 v90, v66, v74
    v_fmac_f32 v90, v67, v73
    v_fmac_f32 v90, v68, v72
    v_mul_f32 v90, v90, v71
    v_and_b32 v64, s36, v17
    v_and_b32 v65, s36, v21
    v_and_b32 v66, s36, v25
    v_and_b32 v67, s36, v29
    v_and_b32 v68, s36, v33
    v_and_b32 v70, s36, v37
    v_and_b32 v71, s36, v41
    v_lshlrev_b32 v72, 16, v50
    v_and_b32 v73, s36, v50
    v_lshlrev_b32 v74, 16, v51
    v_and_b32 v75, s36, v51
    v_mul_f32 v83, v64, v75
    v_fmac_f32 v83, v65, v74
    v_fmac_f32 v83, v66, v73
    v_fmac_f32 v83, v67, v72
    v_mul_f32 v83, v83, v70
    v_mul_f32 v91, v65, v75
    v_fmac_f32 v91, v66, v74
    v_fmac_f32 v91, v67, v73
    v_fmac_f32 v91, v68, v72
    v_mul_f32 v91, v91, v71
    v_lshlrev_b32 v64, 16, v18
    v_lshlrev_b32 v65, 16, v22
    v_lshlrev_b32 v66, 16, v26
    v_lshlrev_b32 v67, 16, v30
    v_lshlrev_b32 v68, 16, v34
    v_lshlrev_b32 v70, 16, v38
    v_lshlrev_b32 v71, 16, v42
    v_lshlrev_b32 v72, 16, v52
    v_and_b32 v73, s36, v52
    v_lshlrev_b32 v74, 16, v53
    v_and_b32 v75, s36, v53
    v_mul_f32 v84, v64, v75
    v_fmac_f32 v84, v65, v74
    v_fmac_f32 v84, v66, v73
    v_fmac_f32 v84, v67, v72
    v_mul_f32 v84, v84, v70
    v_mul_f32 v92, v65, v75
    v_fmac_f32 v92, v66, v74
    v_fmac_f32 v92, v67, v73
    v_fmac_f32 v92, v68, v72
    v_mul_f32 v92, v92, v71
    v_and_b32 v64, s36, v18
    v_and_b32 v65, s36, v22
    v_and_b32 v66, s36, v26
    v_and_b32 v67, s36, v30
    v_and_b32 v68, s36, v34
    v_and_b32 v70, s36, v38
    v_and_b32 v71, s36, v42
    v_lshlrev_b32 v72, 16, v54
    v_and_b32 v73, s36, v54
    v_lshlrev_b32 v74, 16, v55
    v_and_b32 v75, s36, v55
    v_mul_f32 v85, v64, v75
    v_fmac_f32 v85, v65, v74
    v_fmac_f32 v85, v66, v73
    v_fmac_f32 v85, v67, v72
    v_mul_f32 v85, v85, v70
    v_mul_f32 v93, v65, v75
    v_fmac_f32 v93, v66, v74
    v_fmac_f32 v93, v67, v73
    v_fmac_f32 v93, v68, v72
    v_mul_f32 v93, v93, v71
    v_lshlrev_b32 v64, 16, v19
    v_lshlrev_b32 v65, 16, v23
    v_lshlrev_b32 v66, 16, v27
    v_lshlrev_b32 v67, 16, v31
    v_lshlrev_b32 v68, 16, v35
    v_lshlrev_b32 v70, 16, v39
    v_lshlrev_b32 v71, 16, v43
    v_lshlrev_b32 v72, 16, v56
    v_and_b32 v73, s36, v56
    v_lshlrev_b32 v74, 16, v57
    v_and_b32 v75, s36, v57
    v_mul_f32 v86, v64, v75
    v_fmac_f32 v86, v65, v74
    v_fmac_f32 v86, v66, v73
    v_fmac_f32 v86, v67, v72
    v_mul_f32 v86, v86, v70
    v_mul_f32 v94, v65, v75
    v_fmac_f32 v94, v66, v74
    v_fmac_f32 v94, v67, v73
    v_fmac_f32 v94, v68, v72
    v_mul_f32 v94, v94, v71
    v_and_b32 v64, s36, v19
    v_and_b32 v65, s36, v23
    v_and_b32 v66, s36, v27
    v_and_b32 v67, s36, v31
    v_and_b32 v68, s36, v35
    v_and_b32 v70, s36, v39
    v_and_b32 v71, s36, v43
    v_lshlrev_b32 v72, 16, v58
    v_and_b32 v73, s36, v58
    v_lshlrev_b32 v74, 16, v59
    v_and_b32 v75, s36, v59
    v_mul_f32 v87, v64, v75
    v_fmac_f32 v87, v65, v74
    v_fmac_f32 v87, v66, v73
    v_fmac_f32 v87, v67, v72
    v_mul_f32 v87, v87, v70
    v_mul_f32 v95, v65, v75
    v_fmac_f32 v95, v66, v74
    v_fmac_f32 v95, v67, v73
    v_fmac_f32 v95, v68, v72
    v_mul_f32 v95, v95, v71
    v_cvt_pk_bf16_f32 v96, v80, v81
    v_cvt_pk_bf16_f32 v97, v82, v83
    v_cvt_pk_bf16_f32 v98, v84, v85
    v_cvt_pk_bf16_f32 v99, v86, v87
    ds_write_b128 v4, v[96:99] offset:0
    v_cvt_pk_bf16_f32 v100, v88, v89
    v_cvt_pk_bf16_f32 v101, v90, v91
    v_cvt_pk_bf16_f32 v102, v92, v93
    v_cvt_pk_bf16_f32 v103, v94, v95
    ds_write_b128 v4, v[100:103] offset:128
    v_bfe_u32 v5, v0, 2, 2
    v_bfe_u32 v6, v0, 4, 1
    v_lshl_add_u32 v5, v6, 3, v5
    v_lshlrev_b32 v5, 2, v5
    v_lshrrev_b32 v7, 5, v0
    v_add_u32 v5, v5, v7
    v_lshlrev_b32 v5, 7, v5
    v_and_b32 v8, 3, v0
    v_lshl_add_u32 v5, v8, 3, v5
    s_lshl_b32 s35, s3, 5
    v_add_u32 v5, s35, v5
    v_and_b32 v9, 15, v0
    v_lshlrev_b32 v9, 12, v9
    v_lshrrev_b32 v8, 4, v0
    v_lshl_add_u32 v9, v8, 4, v9
    s_lshl_b32 s35, s34, 2
    s_add_u32 s35, s35, s3
    s_lshl_b32 s35, s35, 16
    s_lshl_b32 s37, s33, 7
    s_add_u32 s35, s35, s37
    s_add_u32 s35, s35, 85983232
    s_waitcnt lgkmcnt(0)
    s_barrier
    ds_read_b64_tr_b16 v[16:17], v5 offset:0
    ds_read_b64_tr_b16 v[18:19], v5 offset:2048
    ds_read_b64_tr_b16 v[20:21], v5 offset:256
    ds_read_b64_tr_b16 v[22:23], v5 offset:2304
    s_waitcnt lgkmcnt(0)
    buffer_store_dwordx4 v[16:19], v9, s[12:15], s35 offen offset:0
    buffer_store_dwordx4 v[20:23], v9, s[12:15], s35 offen offset:64
s1_kernel_end:
    s_endpgm
.globl s2_kernel
.p2align 8
.type s2_kernel,@function
s2_kernel:
    s_cmp_ge_u32 s2, 224
    s_cbranch_scc1 s2_kernel_end
    s_load_dwordx4 s[20:23], s[0:1], 32
    s_load_dwordx2 s[30:31], s[0:1], 112
    v_lshrrev_b32 v2, 6, v0
    v_and_b32 v0, 63, v0
    v_readfirstlane_b32 s3, v2
    v_lshlrev_b32 v1, 4, v0
    v_lshrrev_b32 v3, 1, v0
    v_lshlrev_b32 v3, 7, v3
    v_and_b32 v4, 1, v0
    v_lshl_add_u32 v3, v4, 4, v3
    s_lshl_b32 s33, s2, 13
    s_lshl_b32 s34, s3, 10
    s_add_u32 s35, s33, s34
    s_lshl_b32 s36, s3, 5
    s_add_u32 s36, s36, s33
    s_add_u32 s36, s36, 85983232
    s_mul_i32 s37, s3, 1152
    s_lshl_b32 s38, s2, 2
    s_waitcnt lgkmcnt(0)
    s_mov_b32 s4, s20
    s_mov_b32 s5, s21
    s_mov_b32 s6, 1835008
    s_mov_b32 s7, 0x20000
    s_mov_b32 s12, s30
    s_mov_b32 s13, s31
    s_mov_b32 s14, 268435456
    s_mov_b32 s15, 0x20000
    s_load_dword s39, s[22:23], s38
    s_add_u32 m0, s34, 256
    s_nop 0
    buffer_load_dwordx4 v1, s[4:7], s35 offen lds
    s_add_u32 m0, s37, 8832
    s_add_u32 s35, s35, 4096
    buffer_load_dwordx4 v3, s[12:15], s36 offen lds
    s_add_u32 s36, s36, 4096
    s_add_u32 m0, s34, 4608
    s_nop 0
    buffer_load_dwordx4 v1, s[4:7], s35 offen lds
    s_add_u32 m0, s37, 13440
    s_add_u32 s35, s35, 4096
    buffer_load_dwordx4 v3, s[12:15], s36 offen lds
    s_add_u32 s36, s36, 4096
    v_mov_b32 v8, 0
    v_lshlrev_b32 v5, 2, v0
    v_and_b32 v6, 31, v0
    v_lshlrev_b32 v6, 2, v6
    v_add_u32 v6, s37, v6
    s_mul_i32 s40, s3, 8224
    v_and_b32 v7, 3, v0
    v_lshlrev_b32 v7, 2, v7
    v_add_u32 v7, s40, v7
    ds_write_b32 v5, v8 offset:0
    ds_write_b32 v6, v8 offset:8704
    ds_write_b32 v5, v8 offset:4352
    ds_write_b32 v6, v8 offset:13312
    ds_write_b32 v7, v8 offset:18432
    v_and_b32 v14, 15, v0
    v_lshrrev_b32 v15, 4, v0
    v_lshlrev_b32 v9, 3, v14
    v_lshl_add_u32 v9, v15, 4, v9
    s_add_u32 s41, s37, 8712
    v_add_u32 v9, s41, v9
    v_and_b32 v10, 3, v0
    v_bfe_u32 v4, v0, 2, 2
    v_sub_u32 v10, v10, v4
    v_lshlrev_b32 v4, 3, v15
    v_sub_u32 v10, v10, v4
    v_add_u32 v10, 56, v10
    v_lshlrev_b32 v10, 3, v10
    v_lshl_add_u32 v11, v15, 6, v14
    v_add_u32 v11, s3, v11
    v_lshlrev_b32 v11, 2, v11
    v_add_u32 v11, s40, v11
    s_lshl_b32 s41, s3, 11
    v_lshlrev_b32 v12, 5, v0
    v_add_u32 v12, s41, v12
    s_lshl_b32 s41, s3, 8
    v_add_u32 v13, s41, v5
    s_lshl_b32 s42, s2, 13
    s_add_u32 s42, s42, s34
    s_add_u32 s42, s42, 90177536
    s_mov_b32 s45, 0xffff0000
    s_waitcnt vmcnt(0) lgkmcnt(0)
    s_barrier
    s_lshl_b32 s43, s39, 16
    s_and_b32 s44, s39, s45
    ds_read_b64_tr_b16 v[32:33], v10 offset:32
    ds_read_b64_tr_b16 v[34:35], v10 offset:0
    ds_read2_b64 v[96:99], v9 offset0:0 offset1:1
    ds_read_b64_tr_b16 v[36:37], v10 offset:288
    ds_read_b64_tr_b16 v[38:39], v10 offset:256
    ds_read2_b64 v[100:103], v9 offset0:8 offset1:9
    ds_read_b64_tr_b16 v[40:41], v10 offset:544
    ds_read_b64_tr_b16 v[42:43], v10 offset:512
    ds_read2_b64 v[104:107], v9 offset0:16 offset1:17
    ds_read_b64_tr_b16 v[44:45], v10 offset:800
    ds_read_b64_tr_b16 v[46:47], v10 offset:768
    ds_read2_b64 v[108:111], v9 offset0:24 offset1:25
    s_waitcnt lgkmcnt(0)
    ds_read_b64_tr_b16 v[48:49], v10 offset:1056
    ds_read_b64_tr_b16 v[50:51], v10 offset:1024
    ds_read2_b64 v[112:115], v9 offset0:32 offset1:33
    ds_read_b64_tr_b16 v[52:53], v10 offset:1312
    ds_read_b64_tr_b16 v[54:55], v10 offset:1280
    ds_read2_b64 v[116:119], v9 offset0:40 offset1:41
    ds_read_b64_tr_b16 v[56:57], v10 offset:1568
    ds_read_b64_tr_b16 v[58:59], v10 offset:1536
    ds_read2_b64 v[120:123], v9 offset0:48 offset1:49
    ds_read_b64_tr_b16 v[60:61], v10 offset:1824
    ds_read_b64_tr_b16 v[62:63], v10 offset:1792
    ds_read2_b64 v[124:127], v9 offset0:56 offset1:57
    s_waitcnt lgkmcnt(0)
    ds_read_b64_tr_b16 v[64:65], v10 offset:2080
    ds_read_b64_tr_b16 v[66:67], v10 offset:2048
    ds_read2_b64 v[128:131], v9 offset0:64 offset1:65
    ds_read_b64_tr_b16 v[68:69], v10 offset:2336
    ds_read_b64_tr_b16 v[70:71], v10 offset:2304
    ds_read2_b64 v[132:135], v9 offset0:72 offset1:73
    ds_read_b64_tr_b16 v[72:73], v10 offset:2592
    ds_read_b64_tr_b16 v[74:75], v10 offset:2560
    ds_read2_b64 v[136:139], v9 offset0:80 offset1:81
    ds_read_b64_tr_b16 v[76:77], v10 offset:2848
    ds_read_b64_tr_b16 v[78:79], v10 offset:2816
    ds_read2_b64 v[140:143], v9 offset0:88 offset1:89
    s_waitcnt lgkmcnt(0)
    ds_read_b64_tr_b16 v[80:81], v10 offset:3104
    ds_read_b64_tr_b16 v[82:83], v10 offset:3072
    ds_read2_b64 v[144:147], v9 offset0:96 offset1:97
    ds_read_b64_tr_b16 v[84:85], v10 offset:3360
    ds_read_b64_tr_b16 v[86:87], v10 offset:3328
    ds_read2_b64 v[148:151], v9 offset0:104 offset1:105
    ds_read_b64_tr_b16 v[88:89], v10 offset:3616
    ds_read_b64_tr_b16 v[90:91], v10 offset:3584
    ds_read2_b64 v[152:155], v9 offset0:112 offset1:113
    ds_read_b64_tr_b16 v[92:93], v10 offset:3872
    ds_read_b64_tr_b16 v[94:95], v10 offset:3840
    ds_read2_b64 v[156:159], v9 offset0:120 offset1:121
    s_waitcnt lgkmcnt(0)
    v_mfma_f32_16x16x32_bf16 v[160:163], v[100:103], v[32:35], 0
    v_mfma_f32_16x16x32_bf16 v[160:163], v[96:99], v[36:39], v[160:163]
    v_mfma_f32_16x16x32_bf16 v[164:167], v[108:111], v[32:35], 0
    v_mfma_f32_16x16x32_bf16 v[164:167], v[104:107], v[36:39], v[164:167]
    v_mfma_f32_16x16x32_bf16 v[164:167], v[100:103], v[40:43], v[164:167]
    v_mfma_f32_16x16x32_bf16 v[164:167], v[96:99], v[44:47], v[164:167]
    v_mfma_f32_16x16x32_bf16 v[168:171], v[116:119], v[32:35], 0
    v_mfma_f32_16x16x32_bf16 v[168:171], v[112:115], v[36:39], v[168:171]
    v_mfma_f32_16x16x32_bf16 v[168:171], v[108:111], v[40:43], v[168:171]
    v_mfma_f32_16x16x32_bf16 v[168:171], v[104:107], v[44:47], v[168:171]
    v_mfma_f32_16x16x32_bf16 v[168:171], v[100:103], v[48:51], v[168:171]
    v_mfma_f32_16x16x32_bf16 v[168:171], v[96:99], v[52:55], v[168:171]
    v_mfma_f32_16x16x32_bf16 v[172:175], v[124:127], v[32:35], 0
    v_mfma_f32_16x16x32_bf16 v[172:175], v[120:123], v[36:39], v[172:175]
    v_mfma_f32_16x16x32_bf16 v[172:175], v[116:119], v[40:43], v[172:175]
    v_mfma_f32_16x16x32_bf16 v[172:175], v[112:115], v[44:47], v[172:175]
    v_mfma_f32_16x16x32_bf16 v[172:175], v[108:111], v[48:51], v[172:175]
    v_mfma_f32_16x16x32_bf16 v[172:175], v[104:107], v[52:55], v[172:175]
    v_mfma_f32_16x16x32_bf16 v[172:175], v[100:103], v[56:59], v[172:175]
    v_mfma_f32_16x16x32_bf16 v[172:175], v[96:99], v[60:63], v[172:175]
    v_mfma_f32_16x16x32_bf16 v[176:179], v[132:135], v[32:35], 0
    v_mfma_f32_16x16x32_bf16 v[176:179], v[128:131], v[36:39], v[176:179]
    v_mfma_f32_16x16x32_bf16 v[176:179], v[124:127], v[40:43], v[176:179]
    v_mfma_f32_16x16x32_bf16 v[176:179], v[120:123], v[44:47], v[176:179]
    v_mfma_f32_16x16x32_bf16 v[176:179], v[116:119], v[48:51], v[176:179]
    v_mfma_f32_16x16x32_bf16 v[176:179], v[112:115], v[52:55], v[176:179]
    v_mfma_f32_16x16x32_bf16 v[176:179], v[108:111], v[56:59], v[176:179]
    v_mfma_f32_16x16x32_bf16 v[176:179], v[104:107], v[60:63], v[176:179]
    v_mfma_f32_16x16x32_bf16 v[176:179], v[100:103], v[64:67], v[176:179]
    v_mfma_f32_16x16x32_bf16 v[176:179], v[96:99], v[68:71], v[176:179]
    v_mfma_f32_16x16x32_bf16 v[180:183], v[140:143], v[32:35], 0
    v_mfma_f32_16x16x32_bf16 v[180:183], v[136:139], v[36:39], v[180:183]
    v_mfma_f32_16x16x32_bf16 v[180:183], v[132:135], v[40:43], v[180:183]
    v_mfma_f32_16x16x32_bf16 v[180:183], v[128:131], v[44:47], v[180:183]
    v_mfma_f32_16x16x32_bf16 v[180:183], v[124:127], v[48:51], v[180:183]
    v_mfma_f32_16x16x32_bf16 v[180:183], v[120:123], v[52:55], v[180:183]
    v_mfma_f32_16x16x32_bf16 v[180:183], v[116:119], v[56:59], v[180:183]
    v_mfma_f32_16x16x32_bf16 v[180:183], v[112:115], v[60:63], v[180:183]
    v_mfma_f32_16x16x32_bf16 v[180:183], v[108:111], v[64:67], v[180:183]
    v_mfma_f32_16x16x32_bf16 v[180:183], v[104:107], v[68:71], v[180:183]
    v_mfma_f32_16x16x32_bf16 v[180:183], v[100:103], v[72:75], v[180:183]
    v_mfma_f32_16x16x32_bf16 v[180:183], v[96:99], v[76:79], v[180:183]
    v_mfma_f32_16x16x32_bf16 v[184:187], v[148:151], v[32:35], 0
    v_mfma_f32_16x16x32_bf16 v[184:187], v[144:147], v[36:39], v[184:187]
    v_mfma_f32_16x16x32_bf16 v[184:187], v[140:143], v[40:43], v[184:187]
    v_mfma_f32_16x16x32_bf16 v[184:187], v[136:139], v[44:47], v[184:187]
    v_mfma_f32_16x16x32_bf16 v[184:187], v[132:135], v[48:51], v[184:187]
    v_mfma_f32_16x16x32_bf16 v[184:187], v[128:131], v[52:55], v[184:187]
    v_mfma_f32_16x16x32_bf16 v[184:187], v[124:127], v[56:59], v[184:187]
    v_mfma_f32_16x16x32_bf16 v[184:187], v[120:123], v[60:63], v[184:187]
    v_mfma_f32_16x16x32_bf16 v[184:187], v[116:119], v[64:67], v[184:187]
    v_mfma_f32_16x16x32_bf16 v[184:187], v[112:115], v[68:71], v[184:187]
    v_mfma_f32_16x16x32_bf16 v[184:187], v[108:111], v[72:75], v[184:187]
    v_mfma_f32_16x16x32_bf16 v[184:187], v[104:107], v[76:79], v[184:187]
    v_mfma_f32_16x16x32_bf16 v[184:187], v[100:103], v[80:83], v[184:187]
    v_mfma_f32_16x16x32_bf16 v[184:187], v[96:99], v[84:87], v[184:187]
    v_mfma_f32_16x16x32_bf16 v[188:191], v[156:159], v[32:35], 0
    v_mfma_f32_16x16x32_bf16 v[188:191], v[152:155], v[36:39], v[188:191]
    v_mfma_f32_16x16x32_bf16 v[188:191], v[148:151], v[40:43], v[188:191]
    v_mfma_f32_16x16x32_bf16 v[188:191], v[144:147], v[44:47], v[188:191]
    v_mfma_f32_16x16x32_bf16 v[188:191], v[140:143], v[48:51], v[188:191]
    v_mfma_f32_16x16x32_bf16 v[188:191], v[136:139], v[52:55], v[188:191]
    v_mfma_f32_16x16x32_bf16 v[188:191], v[132:135], v[56:59], v[188:191]
    v_mfma_f32_16x16x32_bf16 v[188:191], v[128:131], v[60:63], v[188:191]
    v_mfma_f32_16x16x32_bf16 v[188:191], v[124:127], v[64:67], v[188:191]
    v_mfma_f32_16x16x32_bf16 v[188:191], v[120:123], v[68:71], v[188:191]
    v_mfma_f32_16x16x32_bf16 v[188:191], v[116:119], v[72:75], v[188:191]
    v_mfma_f32_16x16x32_bf16 v[188:191], v[112:115], v[76:79], v[188:191]
    v_mfma_f32_16x16x32_bf16 v[188:191], v[108:111], v[80:83], v[188:191]
    v_mfma_f32_16x16x32_bf16 v[188:191], v[104:107], v[84:87], v[188:191]
    v_mfma_f32_16x16x32_bf16 v[188:191], v[100:103], v[88:91], v[188:191]
    v_mfma_f32_16x16x32_bf16 v[188:191], v[96:99], v[92:95], v[188:191]
    s_nop 7
    ds_write_b32 v11, v160 offset:18432
    ds_write_b32 v11, v161 offset:18496
    ds_write_b32 v11, v162 offset:18560
    ds_write_b32 v11, v163 offset:18624
    ds_write_b32 v11, v164 offset:19456
    ds_write_b32 v11, v165 offset:19520
    ds_write_b32 v11, v166 offset:19584
    ds_write_b32 v11, v167 offset:19648
    ds_write_b32 v11, v168 offset:20480
    ds_write_b32 v11, v169 offset:20544
    ds_write_b32 v11, v170 offset:20608
    ds_write_b32 v11, v171 offset:20672
    ds_write_b32 v11, v172 offset:21504
    ds_write_b32 v11, v173 offset:21568
    ds_write_b32 v11, v174 offset:21632
    ds_write_b32 v11, v175 offset:21696
    ds_write_b32 v11, v176 offset:22528
    ds_write_b32 v11, v177 offset:22592
    ds_write_b32 v11, v178 offset:22656
    ds_write_b32 v11, v179 offset:22720
    ds_write_b32 v11, v180 offset:23552
    ds_write_b32 v11, v181 offset:23616
    ds_write_b32 v11, v182 offset:23680
    ds_write_b32 v11, v183 offset:23744
    ds_write_b32 v11, v184 offset:24576
    ds_write_b32 v11, v185 offset:24640
    ds_write_b32 v11, v186 offset:24704
    ds_write_b32 v11, v187 offset:24768
    ds_write_b32 v11, v188 offset:25600
    ds_write_b32 v11, v189 offset:25664
    ds_write_b32 v11, v190 offset:25728
    ds_write_b32 v11, v191 offset:25792
    s_waitcnt lgkmcnt(0)
    s_barrier
    ds_read_b128 v[192:195], v12 offset:18432
    ds_read_b128 v[196:199], v12 offset:18448
    ds_read_b32 v224, v13 offset:8832
    ds_read_b128 v[200:203], v12 offset:26656
    ds_read_b128 v[204:207], v12 offset:26672
    ds_read_b32 v225, v13 offset:9984
    ds_read_b128 v[208:211], v12 offset:34880
    ds_read_b128 v[212:215], v12 offset:34896
    ds_read_b32 v226, v13 offset:11136
    ds_read_b128 v[216:219], v12 offset:43104
    ds_read_b128 v[220:223], v12 offset:43120
    ds_read_b32 v227, v13 offset:12288
    s_waitcnt lgkmcnt(0)
    v_add_f32 v192, v192, v200
    v_add_f32 v208, v208, v216
    v_add_f32 v192, v192, v208
    v_lshlrev_b32 v228, 16, v224
    v_fmac_f32 v192, s43, v228
    v_add_f32 v193, v193, v201
    v_add_f32 v209, v209, v217
    v_add_f32 v193, v193, v209
    v_lshlrev_b32 v228, 16, v225
    v_fmac_f32 v193, s43, v228
    v_add_f32 v194, v194, v202
    v_add_f32 v210, v210, v218
    v_add_f32 v194, v194, v210
    v_lshlrev_b32 v228, 16, v226
    v_fmac_f32 v194, s43, v228
    v_add_f32 v195, v195, v203
    v_add_f32 v211, v211, v219
    v_add_f32 v195, v195, v211
    v_lshlrev_b32 v228, 16, v227
    v_fmac_f32 v195, s43, v228
    v_add_f32 v196, v196, v204
    v_add_f32 v212, v212, v220
    v_add_f32 v196, v196, v212
    v_and_b32 v228, s45, v224
    v_fmac_f32 v196, s43, v228
    v_add_f32 v197, v197, v205
    v_add_f32 v213, v213, v221
    v_add_f32 v197, v197, v213
    v_and_b32 v228, s45, v225
    v_fmac_f32 v197, s43, v228
    v_add_f32 v198, v198, v206
    v_add_f32 v214, v214, v222
    v_add_f32 v198, v198, v214
    v_and_b32 v228, s45, v226
    v_fmac_f32 v198, s43, v228
    v_add_f32 v199, v199, v207
    v_add_f32 v215, v215, v223
    v_add_f32 v199, v199, v215
    v_and_b32 v228, s45, v227
    v_fmac_f32 v199, s43, v228
    v_cvt_pk_bf16_f32 v232, v192, v193
    v_cvt_pk_bf16_f32 v233, v194, v195
    v_cvt_pk_bf16_f32 v234, v196, v197
    v_cvt_pk_bf16_f32 v235, v198, v199
    buffer_store_dwordx4 v[232:235], v1, s[12:15], s42 offen
    s_add_u32 s42, s42, 4096
    v_add_u32 v9, 4608, v9
    ds_read_b64_tr_b16 v[32:33], v10 offset:4384
    ds_read_b64_tr_b16 v[34:35], v10 offset:4352
    ds_read2_b64 v[96:99], v9 offset0:0 offset1:1
    ds_read_b64_tr_b16 v[36:37], v10 offset:4640
    ds_read_b64_tr_b16 v[38:39], v10 offset:4608
    ds_read2_b64 v[100:103], v9 offset0:8 offset1:9
    ds_read_b64_tr_b16 v[40:41], v10 offset:4896
    ds_read_b64_tr_b16 v[42:43], v10 offset:4864
    ds_read2_b64 v[104:107], v9 offset0:16 offset1:17
    ds_read_b64_tr_b16 v[44:45], v10 offset:5152
    ds_read_b64_tr_b16 v[46:47], v10 offset:5120
    ds_read2_b64 v[108:111], v9 offset0:24 offset1:25
    s_waitcnt lgkmcnt(0)
    ds_read_b64_tr_b16 v[48:49], v10 offset:5408
    ds_read_b64_tr_b16 v[50:51], v10 offset:5376
    ds_read2_b64 v[112:115], v9 offset0:32 offset1:33
    ds_read_b64_tr_b16 v[52:53], v10 offset:5664
    ds_read_b64_tr_b16 v[54:55], v10 offset:5632
    ds_read2_b64 v[116:119], v9 offset0:40 offset1:41
    ds_read_b64_tr_b16 v[56:57], v10 offset:5920
    ds_read_b64_tr_b16 v[58:59], v10 offset:5888
    ds_read2_b64 v[120:123], v9 offset0:48 offset1:49
    ds_read_b64_tr_b16 v[60:61], v10 offset:6176
    ds_read_b64_tr_b16 v[62:63], v10 offset:6144
    ds_read2_b64 v[124:127], v9 offset0:56 offset1:57
    s_waitcnt lgkmcnt(0)
    ds_read_b64_tr_b16 v[64:65], v10 offset:6432
    ds_read_b64_tr_b16 v[66:67], v10 offset:6400
    ds_read2_b64 v[128:131], v9 offset0:64 offset1:65
    ds_read_b64_tr_b16 v[68:69], v10 offset:6688
    ds_read_b64_tr_b16 v[70:71], v10 offset:6656
    ds_read2_b64 v[132:135], v9 offset0:72 offset1:73
    ds_read_b64_tr_b16 v[72:73], v10 offset:6944
    ds_read_b64_tr_b16 v[74:75], v10 offset:6912
    ds_read2_b64 v[136:139], v9 offset0:80 offset1:81
    ds_read_b64_tr_b16 v[76:77], v10 offset:7200
    ds_read_b64_tr_b16 v[78:79], v10 offset:7168
    ds_read2_b64 v[140:143], v9 offset0:88 offset1:89
    s_waitcnt lgkmcnt(0)
    ds_read_b64_tr_b16 v[80:81], v10 offset:7456
    ds_read_b64_tr_b16 v[82:83], v10 offset:7424
    ds_read2_b64 v[144:147], v9 offset0:96 offset1:97
    ds_read_b64_tr_b16 v[84:85], v10 offset:7712
    ds_read_b64_tr_b16 v[86:87], v10 offset:7680
    ds_read2_b64 v[148:151], v9 offset0:104 offset1:105
    ds_read_b64_tr_b16 v[88:89], v10 offset:7968
    ds_read_b64_tr_b16 v[90:91], v10 offset:7936
    ds_read2_b64 v[152:155], v9 offset0:112 offset1:113
    ds_read_b64_tr_b16 v[92:93], v10 offset:8224
    ds_read_b64_tr_b16 v[94:95], v10 offset:8192
    ds_read2_b64 v[156:159], v9 offset0:120 offset1:121
    s_waitcnt lgkmcnt(0)
    v_mfma_f32_16x16x32_bf16 v[160:163], v[100:103], v[32:35], 0
    v_mfma_f32_16x16x32_bf16 v[160:163], v[96:99], v[36:39], v[160:163]
    v_mfma_f32_16x16x32_bf16 v[164:167], v[108:111], v[32:35], 0
    v_mfma_f32_16x16x32_bf16 v[164:167], v[104:107], v[36:39], v[164:167]
    v_mfma_f32_16x16x32_bf16 v[164:167], v[100:103], v[40:43], v[164:167]
    v_mfma_f32_16x16x32_bf16 v[164:167], v[96:99], v[44:47], v[164:167]
    v_mfma_f32_16x16x32_bf16 v[168:171], v[116:119], v[32:35], 0
    v_mfma_f32_16x16x32_bf16 v[168:171], v[112:115], v[36:39], v[168:171]
    v_mfma_f32_16x16x32_bf16 v[168:171], v[108:111], v[40:43], v[168:171]
    v_mfma_f32_16x16x32_bf16 v[168:171], v[104:107], v[44:47], v[168:171]
    v_mfma_f32_16x16x32_bf16 v[168:171], v[100:103], v[48:51], v[168:171]
    v_mfma_f32_16x16x32_bf16 v[168:171], v[96:99], v[52:55], v[168:171]
    v_mfma_f32_16x16x32_bf16 v[172:175], v[124:127], v[32:35], 0
    v_mfma_f32_16x16x32_bf16 v[172:175], v[120:123], v[36:39], v[172:175]
    v_mfma_f32_16x16x32_bf16 v[172:175], v[116:119], v[40:43], v[172:175]
    v_mfma_f32_16x16x32_bf16 v[172:175], v[112:115], v[44:47], v[172:175]
    v_mfma_f32_16x16x32_bf16 v[172:175], v[108:111], v[48:51], v[172:175]
    v_mfma_f32_16x16x32_bf16 v[172:175], v[104:107], v[52:55], v[172:175]
    v_mfma_f32_16x16x32_bf16 v[172:175], v[100:103], v[56:59], v[172:175]
    v_mfma_f32_16x16x32_bf16 v[172:175], v[96:99], v[60:63], v[172:175]
    v_mfma_f32_16x16x32_bf16 v[176:179], v[132:135], v[32:35], 0
    v_mfma_f32_16x16x32_bf16 v[176:179], v[128:131], v[36:39], v[176:179]
    v_mfma_f32_16x16x32_bf16 v[176:179], v[124:127], v[40:43], v[176:179]
    v_mfma_f32_16x16x32_bf16 v[176:179], v[120:123], v[44:47], v[176:179]
    v_mfma_f32_16x16x32_bf16 v[176:179], v[116:119], v[48:51], v[176:179]
    v_mfma_f32_16x16x32_bf16 v[176:179], v[112:115], v[52:55], v[176:179]
    v_mfma_f32_16x16x32_bf16 v[176:179], v[108:111], v[56:59], v[176:179]
    v_mfma_f32_16x16x32_bf16 v[176:179], v[104:107], v[60:63], v[176:179]
    v_mfma_f32_16x16x32_bf16 v[176:179], v[100:103], v[64:67], v[176:179]
    v_mfma_f32_16x16x32_bf16 v[176:179], v[96:99], v[68:71], v[176:179]
    v_mfma_f32_16x16x32_bf16 v[180:183], v[140:143], v[32:35], 0
    v_mfma_f32_16x16x32_bf16 v[180:183], v[136:139], v[36:39], v[180:183]
    v_mfma_f32_16x16x32_bf16 v[180:183], v[132:135], v[40:43], v[180:183]
    v_mfma_f32_16x16x32_bf16 v[180:183], v[128:131], v[44:47], v[180:183]
    v_mfma_f32_16x16x32_bf16 v[180:183], v[124:127], v[48:51], v[180:183]
    v_mfma_f32_16x16x32_bf16 v[180:183], v[120:123], v[52:55], v[180:183]
    v_mfma_f32_16x16x32_bf16 v[180:183], v[116:119], v[56:59], v[180:183]
    v_mfma_f32_16x16x32_bf16 v[180:183], v[112:115], v[60:63], v[180:183]
    v_mfma_f32_16x16x32_bf16 v[180:183], v[108:111], v[64:67], v[180:183]
    v_mfma_f32_16x16x32_bf16 v[180:183], v[104:107], v[68:71], v[180:183]
    v_mfma_f32_16x16x32_bf16 v[180:183], v[100:103], v[72:75], v[180:183]
    v_mfma_f32_16x16x32_bf16 v[180:183], v[96:99], v[76:79], v[180:183]
    v_mfma_f32_16x16x32_bf16 v[184:187], v[148:151], v[32:35], 0
    v_mfma_f32_16x16x32_bf16 v[184:187], v[144:147], v[36:39], v[184:187]
    v_mfma_f32_16x16x32_bf16 v[184:187], v[140:143], v[40:43], v[184:187]
    v_mfma_f32_16x16x32_bf16 v[184:187], v[136:139], v[44:47], v[184:187]
    v_mfma_f32_16x16x32_bf16 v[184:187], v[132:135], v[48:51], v[184:187]
    v_mfma_f32_16x16x32_bf16 v[184:187], v[128:131], v[52:55], v[184:187]
    v_mfma_f32_16x16x32_bf16 v[184:187], v[124:127], v[56:59], v[184:187]
    v_mfma_f32_16x16x32_bf16 v[184:187], v[120:123], v[60:63], v[184:187]
    v_mfma_f32_16x16x32_bf16 v[184:187], v[116:119], v[64:67], v[184:187]
    v_mfma_f32_16x16x32_bf16 v[184:187], v[112:115], v[68:71], v[184:187]
    v_mfma_f32_16x16x32_bf16 v[184:187], v[108:111], v[72:75], v[184:187]
    v_mfma_f32_16x16x32_bf16 v[184:187], v[104:107], v[76:79], v[184:187]
    v_mfma_f32_16x16x32_bf16 v[184:187], v[100:103], v[80:83], v[184:187]
    v_mfma_f32_16x16x32_bf16 v[184:187], v[96:99], v[84:87], v[184:187]
    v_mfma_f32_16x16x32_bf16 v[188:191], v[156:159], v[32:35], 0
    v_mfma_f32_16x16x32_bf16 v[188:191], v[152:155], v[36:39], v[188:191]
    v_mfma_f32_16x16x32_bf16 v[188:191], v[148:151], v[40:43], v[188:191]
    v_mfma_f32_16x16x32_bf16 v[188:191], v[144:147], v[44:47], v[188:191]
    v_mfma_f32_16x16x32_bf16 v[188:191], v[140:143], v[48:51], v[188:191]
    v_mfma_f32_16x16x32_bf16 v[188:191], v[136:139], v[52:55], v[188:191]
    v_mfma_f32_16x16x32_bf16 v[188:191], v[132:135], v[56:59], v[188:191]
    v_mfma_f32_16x16x32_bf16 v[188:191], v[128:131], v[60:63], v[188:191]
    v_mfma_f32_16x16x32_bf16 v[188:191], v[124:127], v[64:67], v[188:191]
    v_mfma_f32_16x16x32_bf16 v[188:191], v[120:123], v[68:71], v[188:191]
    v_mfma_f32_16x16x32_bf16 v[188:191], v[116:119], v[72:75], v[188:191]
    v_mfma_f32_16x16x32_bf16 v[188:191], v[112:115], v[76:79], v[188:191]
    v_mfma_f32_16x16x32_bf16 v[188:191], v[108:111], v[80:83], v[188:191]
    v_mfma_f32_16x16x32_bf16 v[188:191], v[104:107], v[84:87], v[188:191]
    v_mfma_f32_16x16x32_bf16 v[188:191], v[100:103], v[88:91], v[188:191]
    v_mfma_f32_16x16x32_bf16 v[188:191], v[96:99], v[92:95], v[188:191]
    s_barrier
    s_nop 7
    ds_write_b32 v11, v160 offset:18432
    ds_write_b32 v11, v161 offset:18496
    ds_write_b32 v11, v162 offset:18560
    ds_write_b32 v11, v163 offset:18624
    ds_write_b32 v11, v164 offset:19456
    ds_write_b32 v11, v165 offset:19520
    ds_write_b32 v11, v166 offset:19584
    ds_write_b32 v11, v167 offset:19648
    ds_write_b32 v11, v168 offset:20480
    ds_write_b32 v11, v169 offset:20544
    ds_write_b32 v11, v170 offset:20608
    ds_write_b32 v11, v171 offset:20672
    ds_write_b32 v11, v172 offset:21504
    ds_write_b32 v11, v173 offset:21568
    ds_write_b32 v11, v174 offset:21632
    ds_write_b32 v11, v175 offset:21696
    ds_write_b32 v11, v176 offset:22528
    ds_write_b32 v11, v177 offset:22592
    ds_write_b32 v11, v178 offset:22656
    ds_write_b32 v11, v179 offset:22720
    ds_write_b32 v11, v180 offset:23552
    ds_write_b32 v11, v181 offset:23616
    ds_write_b32 v11, v182 offset:23680
    ds_write_b32 v11, v183 offset:23744
    ds_write_b32 v11, v184 offset:24576
    ds_write_b32 v11, v185 offset:24640
    ds_write_b32 v11, v186 offset:24704
    ds_write_b32 v11, v187 offset:24768
    ds_write_b32 v11, v188 offset:25600
    ds_write_b32 v11, v189 offset:25664
    ds_write_b32 v11, v190 offset:25728
    ds_write_b32 v11, v191 offset:25792
    s_waitcnt lgkmcnt(0)
    s_barrier
    ds_read_b128 v[192:195], v12 offset:18432
    ds_read_b128 v[196:199], v12 offset:18448
    ds_read_b32 v224, v13 offset:13440
    ds_read_b128 v[200:203], v12 offset:26656
    ds_read_b128 v[204:207], v12 offset:26672
    ds_read_b32 v225, v13 offset:14592
    ds_read_b128 v[208:211], v12 offset:34880
    ds_read_b128 v[212:215], v12 offset:34896
    ds_read_b32 v226, v13 offset:15744
    ds_read_b128 v[216:219], v12 offset:43104
    ds_read_b128 v[220:223], v12 offset:43120
    ds_read_b32 v227, v13 offset:16896
    s_waitcnt lgkmcnt(0)
    v_add_f32 v192, v192, v200
    v_add_f32 v208, v208, v216
    v_add_f32 v192, v192, v208
    v_lshlrev_b32 v228, 16, v224
    v_fmac_f32 v192, s44, v228
    v_add_f32 v193, v193, v201
    v_add_f32 v209, v209, v217
    v_add_f32 v193, v193, v209
    v_lshlrev_b32 v228, 16, v225
    v_fmac_f32 v193, s44, v228
    v_add_f32 v194, v194, v202
    v_add_f32 v210, v210, v218
    v_add_f32 v194, v194, v210
    v_lshlrev_b32 v228, 16, v226
    v_fmac_f32 v194, s44, v228
    v_add_f32 v195, v195, v203
    v_add_f32 v211, v211, v219
    v_add_f32 v195, v195, v211
    v_lshlrev_b32 v228, 16, v227
    v_fmac_f32 v195, s44, v228
    v_add_f32 v196, v196, v204
    v_add_f32 v212, v212, v220
    v_add_f32 v196, v196, v212
    v_and_b32 v228, s45, v224
    v_fmac_f32 v196, s44, v228
    v_add_f32 v197, v197, v205
    v_add_f32 v213, v213, v221
    v_add_f32 v197, v197, v213
    v_and_b32 v228, s45, v225
    v_fmac_f32 v197, s44, v228
    v_add_f32 v198, v198, v206
    v_add_f32 v214, v214, v222
    v_add_f32 v198, v198, v214
    v_and_b32 v228, s45, v226
    v_fmac_f32 v198, s44, v228
    v_add_f32 v199, v199, v207
    v_add_f32 v215, v215, v223
    v_add_f32 v199, v199, v215
    v_and_b32 v228, s45, v227
    v_fmac_f32 v199, s44, v228
    v_cvt_pk_bf16_f32 v232, v192, v193
    v_cvt_pk_bf16_f32 v233, v194, v195
    v_cvt_pk_bf16_f32 v234, v196, v197
    v_cvt_pk_bf16_f32 v235, v198, v199
    buffer_store_dwordx4 v[232:235], v1, s[12:15], s42 offen
    s_add_u32 s42, s42, 4096
s2_kernel_end:
    s_endpgm
.globl k1_kernel
.p2align 8
.type k1_kernel,@function
k1_kernel:
    s_cmp_ge_u32 s2, 256
    s_cbranch_scc1 k1_kernel_end
    s_load_dwordx4 s[20:23], s[0:1], 48
    s_load_dwordx4 s[24:27], s[0:1], 64
    s_load_dwordx2 s[28:29], s[0:1], 80
    s_load_dwordx2 s[30:31], s[0:1], 112
    v_lshrrev_b32 v1, 6, v0
    v_and_b32 v0, 63, v0
    v_readfirstlane_b32 s3, v1
    s_and_b32 s33, s2, 7
    s_lshr_b32 s34, s2, 3
    s_and_b32 s35, s34, 7
    s_bfe_u32 s36, s34, 0x10003
    s_lshl_b32 s37, s33, 1
    s_add_u32 s36, s36, s37
    s_lshr_b32 s38, s34, 4
    s_and_b32 s39, s3, 1
    s_lshr_b32 s40, s3, 1
    s_mov_b32 s41, 65536
    s_mov_b32 s48, 32768
    s_mov_b32 s42, 131072
    s_mov_b32 s49, 131072
    s_mov_b32 s43, 196608
    s_mov_b32 s50, 163840
    s_mov_b32 s44, 262144
    s_mov_b32 s51, 262144
    s_mov_b32 s45, 327680
    s_mov_b32 s52, 294912
    s_mov_b32 s46, 393216
    s_mov_b32 s53, 393216
    s_mov_b32 s47, 458752
    s_mov_b32 s54, 425984
    s_lshl_b32 s55, s3, 10
    s_lshl_b32 s56, s39, 1
    s_lshl_b32 s57, s40, 3
    s_add_u32 s56, s56, s57
    s_lshl_b32 s57, s56, 9
    s_lshl_b32 s60, s35, 8
    s_lshl_b32 s58, s3, 3
    s_add_u32 s58, s58, s60
    v_lshrrev_b32 v14, 3, v0
    v_add_u32 v14, s58, v14
    v_mul_u32_u24 v14, 2048, v14
    s_lshl_b32 s58, s39, 2
    v_lshrrev_b32 v15, 4, v0
    v_add_u32 v15, s58, v15
    v_xor_b32 v15, v0, v15
    v_and_b32 v15, 7, v15
    v_lshl_add_u32 v1, v15, 4, v14
    v_lshrrev_b32 v14, 5, v0
    s_lshl_b32 s58, s39, 1
    s_lshl_b32 s59, s40, 2
    s_add_u32 s58, s58, s59
    v_add_u32 v15, s58, v14
    v_lshlrev_b32 v15, 1, v15
    v_xor_b32 v15, v0, v15
    v_and_b32 v15, 31, v15
    v_lshlrev_b32 v15, 4, v15
    v_add_u32 v14, s56, v14
    v_lshl_add_u32 v14, v14, 13, v15
    s_lshl_b32 s58, s36, 9
    v_add_u32 v2, s58, v14
    s_waitcnt lgkmcnt(0)
    s_cmp_eq_u32 s38, 0
    s_cselect_b32 s8, s26, s28
    s_cselect_b32 s9, s27, s29
    s_mov_b32 s10, 8388608
    s_mov_b32 s11, 0x20000
    s_mov_b32 s4, s22
    s_mov_b32 s5, s23
    s_mov_b32 s6, 4194304
    s_mov_b32 s7, 0x20000
    s_mov_b32 s12, s30
    s_mov_b32 s13, s31
    s_mov_b32 s14, 268435456
    s_mov_b32 s15, 0x20000
    s_add_u32 m0, s57, 65536
    s_nop 0
    buffer_load_dwordx4 v2, s[8:11], 0 offen lds
    s_add_u32 m0, s55, 0
    s_nop 0
    buffer_load_dwordx4 v1, s[4:7], 0 offen lds
    s_add_u32 m0, s57, 67584
    s_nop 0
    buffer_load_dwordx4 v2, s[8:11], s48 offen lds
    s_add_u32 m0, s55, 4096
    s_nop 0
    buffer_load_dwordx4 v1, s[4:7], s41 offen lds
    s_add_u32 m0, s57, 73728
    s_nop 0
    buffer_load_dwordx4 v2, s[8:11], s49 offen lds
    s_add_u32 m0, s55, 8192
    s_nop 0
    buffer_load_dwordx4 v1, s[4:7], s42 offen lds
    s_add_u32 m0, s57, 75776
    s_nop 0
    buffer_load_dwordx4 v2, s[8:11], s50 offen lds
    s_add_u32 m0, s55, 12288
    s_nop 0
    buffer_load_dwordx4 v1, s[4:7], s43 offen lds
    s_add_u32 m0, s57, 81920
    s_nop 0
    buffer_load_dwordx4 v2, s[8:11], s51 offen lds
    s_add_u32 m0, s55, 16384
    s_nop 0
    buffer_load_dwordx4 v1, s[4:7], s44 offen lds
    s_add_u32 m0, s57, 83968
    s_nop 0
    buffer_load_dwordx4 v2, s[8:11], s52 offen lds
    s_add_u32 m0, s55, 20480
    s_nop 0
    buffer_load_dwordx4 v1, s[4:7], s45 offen lds
    s_add_u32 m0, s57, 90112
    s_nop 0
    buffer_load_dwordx4 v2, s[8:11], s53 offen lds
    s_add_u32 m0, s55, 24576
    s_nop 0
    buffer_load_dwordx4 v1, s[4:7], s46 offen lds
    s_add_u32 m0, s57, 92160
    s_nop 0
    buffer_load_dwordx4 v2, s[8:11], s54 offen lds
    s_add_u32 m0, s55, 28672
    s_nop 0
    buffer_load_dwordx4 v1, s[4:7], s47 offen lds
    v_add_u32 v1, 128, v1
    v_add_u32 v2, 0x80000, v2
    s_add_u32 m0, s57, 98304
    s_nop 0
    buffer_load_dwordx4 v2, s[8:11], 0 offen lds
    s_add_u32 m0, s55, 32768
    s_nop 0
    buffer_load_dwordx4 v1, s[4:7], 0 offen lds
    s_add_u32 m0, s57, 100352
    s_nop 0
    buffer_load_dwordx4 v2, s[8:11], s48 offen lds
    s_add_u32 m0, s55, 36864
    s_nop 0
    buffer_load_dwordx4 v1, s[4:7], s41 offen lds
    s_add_u32 m0, s57, 106496
    s_nop 0
    buffer_load_dwordx4 v2, s[8:11], s49 offen lds
    s_add_u32 m0, s55, 40960
    s_nop 0
    buffer_load_dwordx4 v1, s[4:7], s42 offen lds
    s_add_u32 m0, s57, 108544
    s_nop 0
    buffer_load_dwordx4 v2, s[8:11], s50 offen lds
    s_add_u32 m0, s55, 45056
    s_nop 0
    buffer_load_dwordx4 v1, s[4:7], s43 offen lds
    s_add_u32 m0, s57, 114688
    s_nop 0
    buffer_load_dwordx4 v2, s[8:11], s51 offen lds
    s_add_u32 m0, s55, 49152
    s_nop 0
    buffer_load_dwordx4 v1, s[4:7], s44 offen lds
    s_add_u32 m0, s57, 116736
    s_nop 0
    buffer_load_dwordx4 v2, s[8:11], s52 offen lds
    s_add_u32 m0, s55, 53248
    s_nop 0
    buffer_load_dwordx4 v1, s[4:7], s45 offen lds
    s_add_u32 m0, s57, 122880
    s_nop 0
    buffer_load_dwordx4 v2, s[8:11], s53 offen lds
    s_add_u32 m0, s55, 57344
    s_nop 0
    buffer_load_dwordx4 v1, s[4:7], s46 offen lds
    s_add_u32 m0, s57, 124928
    s_nop 0
    buffer_load_dwordx4 v2, s[8:11], s54 offen lds
    s_add_u32 m0, s55, 61440
    s_nop 0
    buffer_load_dwordx4 v1, s[4:7], s47 offen lds
    v_add_u32 v1, 128, v1
    v_add_u32 v2, 0x80000, v2
    s_lshl_b32 s58, s39, 7
    s_lshl_b32 s59, s40, 3
    v_and_b32 v14, 15, v0
    v_lshrrev_b32 v15, 4, v0
    v_lshrrev_b32 v5, 1, v14
    v_xor_b32 v5, v5, v15
    v_add_u32 v14, s58, v14
    v_lshlrev_b32 v14, 7, v14
    v_lshl_add_u32 v4, v5, 4, v14
    v_xor_b32 v5, 64, v4
    v_bfe_u32 v14, v0, 2, 2
    v_lshl_add_u32 v13, v15, 3, v14
    v_lshlrev_b32 v13, 9, v13
    v_and_b32 v15, 1, v15
    v_lshl_or_b32 v14, v15, 2, v14
    v_xor_b32 v14, s59, v14
    v_lshl_add_u32 v13, v14, 5, v13
    v_and_b32 v14, 3, v0
    v_lshl_add_u32 v13, v14, 3, v13
    v_add_u32 v6, 0x10000, v13
    v_xor_b32 v7, 32, v6
    v_xor_b32 v8, 64, v6
    v_xor_b32 v9, 96, v6
    v_xor_b32 v10, 128, v6
    v_xor_b32 v11, 160, v6
    v_xor_b32 v12, 192, v6
    v_xor_b32 v13, 224, v6
    v_lshlrev_b32 v3, 4, v0
    v_mov_b32 v16, 0
    v_mov_b32 v17, 0
    v_mov_b32 v18, 0
    v_mov_b32 v19, 0
    v_mov_b32 v20, 0
    v_mov_b32 v21, 0
    v_mov_b32 v22, 0
    v_mov_b32 v23, 0
    v_mov_b32 v24, 0
    v_mov_b32 v25, 0
    v_mov_b32 v26, 0
    v_mov_b32 v27, 0
    v_mov_b32 v28, 0
    v_mov_b32 v29, 0
    v_mov_b32 v30, 0
    v_mov_b32 v31, 0
    v_mov_b32 v32, 0
    v_mov_b32 v33, 0
    v_mov_b32 v34, 0
    v_mov_b32 v35, 0
    v_mov_b32 v36, 0
    v_mov_b32 v37, 0
    v_mov_b32 v38, 0
    v_mov_b32 v39, 0
    v_mov_b32 v40, 0
    v_mov_b32 v41, 0
    v_mov_b32 v42, 0
    v_mov_b32 v43, 0
    v_mov_b32 v44, 0
    v_mov_b32 v45, 0
    v_mov_b32 v46, 0
    v_mov_b32 v47, 0
    v_mov_b32 v48, 0
    v_mov_b32 v49, 0
    v_mov_b32 v50, 0
    v_mov_b32 v51, 0
    v_mov_b32 v52, 0
    v_mov_b32 v53, 0
    v_mov_b32 v54, 0
    v_mov_b32 v55, 0
    v_mov_b32 v56, 0
    v_mov_b32 v57, 0
    v_mov_b32 v58, 0
    v_mov_b32 v59, 0
    v_mov_b32 v60, 0
    v_mov_b32 v61, 0
    v_mov_b32 v62, 0
    v_mov_b32 v63, 0
    v_mov_b32 v64, 0
    v_mov_b32 v65, 0
    v_mov_b32 v66, 0
    v_mov_b32 v67, 0
    v_mov_b32 v68, 0
    v_mov_b32 v69, 0
    v_mov_b32 v70, 0
    v_mov_b32 v71, 0
    v_mov_b32 v72, 0
    v_mov_b32 v73, 0
    v_mov_b32 v74, 0
    v_mov_b32 v75, 0
    v_mov_b32 v76, 0
    v_mov_b32 v77, 0
    v_mov_b32 v78, 0
    v_mov_b32 v79, 0
    v_mov_b32 v80, 0
    v_mov_b32 v81, 0
    v_mov_b32 v82, 0
    v_mov_b32 v83, 0
    v_mov_b32 v84, 0
    v_mov_b32 v85, 0
    v_mov_b32 v86, 0
    v_mov_b32 v87, 0
    v_mov_b32 v88, 0
    v_mov_b32 v89, 0
    v_mov_b32 v90, 0
    v_mov_b32 v91, 0
    v_mov_b32 v92, 0
    v_mov_b32 v93, 0
    v_mov_b32 v94, 0
    v_mov_b32 v95, 0
    v_mov_b32 v96, 0
    v_mov_b32 v97, 0
    v_mov_b32 v98, 0
    v_mov_b32 v99, 0
    v_mov_b32 v100, 0
    v_mov_b32 v101, 0
    v_mov_b32 v102, 0
    v_mov_b32 v103, 0
    v_mov_b32 v104, 0
    v_mov_b32 v105, 0
    v_mov_b32 v106, 0
    v_mov_b32 v107, 0
    v_mov_b32 v108, 0
    v_mov_b32 v109, 0
    v_mov_b32 v110, 0
    v_mov_b32 v111, 0
    v_mov_b32 v112, 0
    v_mov_b32 v113, 0
    v_mov_b32 v114, 0
    v_mov_b32 v115, 0
    v_mov_b32 v116, 0
    v_mov_b32 v117, 0
    v_mov_b32 v118, 0
    v_mov_b32 v119, 0
    v_mov_b32 v120, 0
    v_mov_b32 v121, 0
    v_mov_b32 v122, 0
    v_mov_b32 v123, 0
    v_mov_b32 v124, 0
    v_mov_b32 v125, 0
    v_mov_b32 v126, 0
    v_mov_b32 v127, 0
    v_mov_b32 v128, 0
    v_mov_b32 v129, 0
    v_mov_b32 v130, 0
    v_mov_b32 v131, 0
    v_mov_b32 v132, 0
    v_mov_b32 v133, 0
    v_mov_b32 v134, 0
    v_mov_b32 v135, 0
    v_mov_b32 v136, 0
    v_mov_b32 v137, 0
    v_mov_b32 v138, 0
    v_mov_b32 v139, 0
    v_mov_b32 v140, 0
    v_mov_b32 v141, 0
    v_mov_b32 v142, 0
    v_mov_b32 v143, 0
    v_mov_b32 v144, 0
    v_mov_b32 v145, 0
    v_mov_b32 v146, 0
    v_mov_b32 v147, 0
    v_mov_b32 v148, 0
    v_mov_b32 v149, 0
    v_mov_b32 v150, 0
    v_mov_b32 v151, 0
    v_mov_b32 v152, 0
    v_mov_b32 v153, 0
    v_mov_b32 v154, 0
    v_mov_b32 v155, 0
    v_mov_b32 v156, 0
    v_mov_b32 v157, 0
    v_mov_b32 v158, 0
    v_mov_b32 v159, 0
    v_mov_b32 v160, 0
    v_mov_b32 v161, 0
    v_mov_b32 v162, 0
    v_mov_b32 v163, 0
    v_mov_b32 v164, 0
    v_mov_b32 v165, 0
    v_mov_b32 v166, 0
    v_mov_b32 v167, 0
    v_mov_b32 v168, 0
    v_mov_b32 v169, 0
    v_mov_b32 v170, 0
    v_mov_b32 v171, 0
    v_mov_b32 v172, 0
    v_mov_b32 v173, 0
    v_mov_b32 v174, 0
    v_mov_b32 v175, 0
    v_mov_b32 v176, 0
    v_mov_b32 v177, 0
    v_mov_b32 v178, 0
    v_mov_b32 v179, 0
    v_mov_b32 v180, 0
    v_mov_b32 v181, 0
    v_mov_b32 v182, 0
    v_mov_b32 v183, 0
    v_mov_b32 v184, 0
    v_mov_b32 v185, 0
    v_mov_b32 v186, 0
    v_mov_b32 v187, 0
    v_mov_b32 v188, 0
    v_mov_b32 v189, 0
    v_mov_b32 v190, 0
    v_mov_b32 v191, 0
    v_mov_b32 v192, 0
    v_mov_b32 v193, 0
    v_mov_b32 v194, 0
    v_mov_b32 v195, 0
    v_mov_b32 v196, 0
    v_mov_b32 v197, 0
    v_mov_b32 v198, 0
    v_mov_b32 v199, 0
    v_mov_b32 v200, 0
    v_mov_b32 v201, 0
    v_mov_b32 v202, 0
    v_mov_b32 v203, 0
    v_mov_b32 v204, 0
    v_mov_b32 v205, 0
    v_mov_b32 v206, 0
    v_mov_b32 v207, 0
    v_mov_b32 v208, 0
    v_mov_b32 v209, 0
    v_mov_b32 v210, 0
    v_mov_b32 v211, 0
    v_mov_b32 v212, 0
    v_mov_b32 v213, 0
    v_mov_b32 v214, 0
    v_mov_b32 v215, 0
    v_mov_b32 v216, 0
    v_mov_b32 v217, 0
    v_mov_b32 v218, 0
    v_mov_b32 v219, 0
    v_mov_b32 v220, 0
    v_mov_b32 v221, 0
    v_mov_b32 v222, 0
    v_mov_b32 v223, 0
    v_mov_b32 v224, 0
    v_mov_b32 v225, 0
    v_mov_b32 v226, 0
    v_mov_b32 v227, 0
    v_mov_b32 v228, 0
    v_mov_b32 v229, 0
    v_mov_b32 v230, 0
    v_mov_b32 v231, 0
    v_mov_b32 v232, 0
    v_mov_b32 v233, 0
    v_mov_b32 v234, 0
    v_mov_b32 v235, 0
    v_mov_b32 v236, 0
    v_mov_b32 v237, 0
    v_mov_b32 v238, 0
    v_mov_b32 v239, 0
    v_mov_b32 v240, 0
    v_mov_b32 v241, 0
    v_mov_b32 v242, 0
    v_mov_b32 v243, 0
    v_mov_b32 v244, 0
    v_mov_b32 v245, 0
    v_mov_b32 v246, 0
    v_mov_b32 v247, 0
    v_mov_b32 v248, 0
    v_mov_b32 v249, 0
    v_mov_b32 v250, 0
    v_mov_b32 v251, 0
    v_mov_b32 v252, 0
    v_mov_b32 v253, 0
    v_mov_b32 v254, 0
    v_mov_b32 v255, 0
    v_accvgpr_write_b32 a128, 0
    v_accvgpr_write_b32 a129, 0
    v_accvgpr_write_b32 a130, 0
    v_accvgpr_write_b32 a131, 0
    v_accvgpr_write_b32 a132, 0
    v_accvgpr_write_b32 a133, 0
    v_accvgpr_write_b32 a134, 0
    v_accvgpr_write_b32 a135, 0
    v_accvgpr_write_b32 a136, 0
    v_accvgpr_write_b32 a137, 0
    v_accvgpr_write_b32 a138, 0
    v_accvgpr_write_b32 a139, 0
    v_accvgpr_write_b32 a140, 0
    v_accvgpr_write_b32 a141, 0
    v_accvgpr_write_b32 a142, 0
    v_accvgpr_write_b32 a143, 0
    s_mov_b32 s61, 0
    s_waitcnt vmcnt(16)
    s_barrier
    ds_read_b64_tr_b16 a[0:1], v6 offset:0
    ds_read_b64_tr_b16 a[2:3], v6 offset:2048
    ds_read_b128 a[64:67], v4 offset:0
    ds_read_b64_tr_b16 a[4:5], v6 offset:16384
    ds_read_b64_tr_b16 a[6:7], v6 offset:18432
    ds_read_b128 a[68:71], v5 offset:0
    ds_read_b128 a[76:79], v5 offset:2048
    ds_read_b128 a[72:75], v4 offset:2048
    ds_read_b128 a[80:83], v4 offset:4096
    ds_read_b128 a[84:87], v5 offset:4096
    ds_read_b128 a[92:95], v5 offset:6144
    ds_read_b128 a[88:91], v4 offset:6144
    ds_read_b64_tr_b16 a[8:9], v7 offset:0
    ds_read_b64_tr_b16 a[10:11], v7 offset:2048
    ds_read_b64_tr_b16 a[12:13], v7 offset:16384
    ds_read_b64_tr_b16 a[14:15], v7 offset:18432
    ds_read_b64_tr_b16 a[16:17], v8 offset:0
    ds_read_b64_tr_b16 a[18:19], v8 offset:2048
    ds_read_b64_tr_b16 a[20:21], v8 offset:16384
    ds_read_b64_tr_b16 a[22:23], v8 offset:18432
    ds_read_b64_tr_b16 a[24:25], v9 offset:0
    s_cmp_eq_u32 s38, 0
    s_waitcnt lgkmcnt(0)
    s_cbranch_scc0 k1_kernel_vloop
.p2align 6
k1_kernel_kloop:
    v_mfma_f32_16x16x32_bf16 v[16:19], a[0:3], a[64:67], v[16:19]
    ds_read_b64_tr_b16 a[26:27], v9 offset:2048
    v_mfma_f32_16x16x32_bf16 v[16:19], a[4:7], a[68:71], v[16:19]
    s_cmp_eq_u32 s61, 7
    s_cmov_b32 s6, 0
    ds_read_b64_tr_b16 a[28:29], v9 offset:16384
    v_mfma_f32_16x16x32_bf16 v[20:23], a[4:7], a[76:79], v[20:23]
    ds_read_b64_tr_b16 a[30:31], v9 offset:18432
    v_mfma_f32_16x16x32_bf16 v[20:23], a[0:3], a[72:75], v[20:23]
    ds_read_b128 a[96:99], v4 offset:8192
    v_mfma_f32_16x16x32_bf16 v[24:27], a[0:3], a[80:83], v[24:27]
    v_mfma_f32_16x16x32_bf16 v[24:27], a[4:7], a[84:87], v[24:27]
    ds_read_b128 a[100:103], v5 offset:8192
    v_mfma_f32_16x16x32_bf16 v[28:31], a[4:7], a[92:95], v[28:31]
    v_mfma_f32_16x16x32_bf16 v[28:31], a[0:3], a[88:91], v[28:31]
    s_waitcnt lgkmcnt(8)
    ds_read_b128 a[108:111], v5 offset:10240
    v_mfma_f32_16x16x32_bf16 v[48:51], a[8:11], a[64:67], v[48:51]
    v_mfma_f32_16x16x32_bf16 v[48:51], a[12:15], a[68:71], v[48:51]
    ds_read_b128 a[104:107], v4 offset:10240
    v_mfma_f32_16x16x32_bf16 v[52:55], a[12:15], a[76:79], v[52:55]
    v_mfma_f32_16x16x32_bf16 v[52:55], a[8:11], a[72:75], v[52:55]
    ds_read_b128 a[112:115], v4 offset:12288
    v_mfma_f32_16x16x32_bf16 v[56:59], a[8:11], a[80:83], v[56:59]
    v_mfma_f32_16x16x32_bf16 v[56:59], a[12:15], a[84:87], v[56:59]
    ds_read_b128 a[116:119], v5 offset:12288
    v_mfma_f32_16x16x32_bf16 v[60:63], a[12:15], a[92:95], v[60:63]
    v_mfma_f32_16x16x32_bf16 v[60:63], a[8:11], a[88:91], v[60:63]
    ds_read_b128 a[124:127], v5 offset:14336
    v_mfma_f32_16x16x32_bf16 v[80:83], a[16:19], a[64:67], v[80:83]
    s_waitcnt lgkmcnt(8)
    v_mfma_f32_16x16x32_bf16 v[80:83], a[20:23], a[68:71], v[80:83]
    ds_read_b128 a[120:123], v4 offset:14336
    v_mfma_f32_16x16x32_bf16 v[84:87], a[20:23], a[76:79], v[84:87]
    v_mfma_f32_16x16x32_bf16 v[84:87], a[16:19], a[72:75], v[84:87]
    ds_read_b64_tr_b16 a[32:33], v10 offset:0
    v_mfma_f32_16x16x32_bf16 v[88:91], a[16:19], a[80:83], v[88:91]
    ds_read_b64_tr_b16 a[34:35], v10 offset:2048
    v_mfma_f32_16x16x32_bf16 v[88:91], a[20:23], a[84:87], v[88:91]
    ds_read_b64_tr_b16 a[36:37], v10 offset:16384
    v_mfma_f32_16x16x32_bf16 v[92:95], a[20:23], a[92:95], v[92:95]
    ds_read_b64_tr_b16 a[38:39], v10 offset:18432
    v_mfma_f32_16x16x32_bf16 v[92:95], a[16:19], a[88:91], v[92:95]
    ds_read_b64_tr_b16 a[40:41], v11 offset:0
    v_mfma_f32_16x16x32_bf16 v[112:115], a[24:27], a[64:67], v[112:115]
    s_waitcnt lgkmcnt(8)
    ds_read_b64_tr_b16 a[42:43], v11 offset:2048
    v_mfma_f32_16x16x32_bf16 v[112:115], a[28:31], a[68:71], v[112:115]
    ds_read_b64_tr_b16 a[44:45], v11 offset:16384
    v_mfma_f32_16x16x32_bf16 v[116:119], a[28:31], a[76:79], v[116:119]
    ds_read_b64_tr_b16 a[46:47], v11 offset:18432
    v_mfma_f32_16x16x32_bf16 v[116:119], a[24:27], a[72:75], v[116:119]
    ds_read_b64_tr_b16 a[48:49], v12 offset:0
    v_mfma_f32_16x16x32_bf16 v[120:123], a[24:27], a[80:83], v[120:123]
    ds_read_b64_tr_b16 a[50:51], v12 offset:2048
    v_mfma_f32_16x16x32_bf16 v[120:123], a[28:31], a[84:87], v[120:123]
    ds_read_b64_tr_b16 a[52:53], v12 offset:16384
    v_mfma_f32_16x16x32_bf16 v[124:127], a[28:31], a[92:95], v[124:127]
    ds_read_b64_tr_b16 a[54:55], v12 offset:18432
    v_mfma_f32_16x16x32_bf16 v[124:127], a[24:27], a[88:91], v[124:127]
    ds_read_b64_tr_b16 a[56:57], v13 offset:0
    v_mfma_f32_16x16x32_bf16 v[32:35], a[0:3], a[96:99], v[32:35]
    ds_read_b64_tr_b16 a[58:59], v13 offset:2048
    v_mfma_f32_16x16x32_bf16 v[32:35], a[4:7], a[100:103], v[32:35]
    ds_read_b64_tr_b16 a[60:61], v13 offset:16384
    v_mfma_f32_16x16x32_bf16 v[36:39], a[4:7], a[108:111], v[36:39]
    ds_read_b64_tr_b16 a[62:63], v13 offset:18432
    v_mfma_f32_16x16x32_bf16 v[36:39], a[0:3], a[104:107], v[36:39]
    v_mfma_f32_16x16x32_bf16 v[40:43], a[0:3], a[112:115], v[40:43]
    s_waitcnt lgkmcnt(8)
    v_mfma_f32_16x16x32_bf16 v[40:43], a[4:7], a[116:119], v[40:43]
    v_mfma_f32_16x16x32_bf16 v[44:47], a[4:7], a[124:127], v[44:47]
    v_mfma_f32_16x16x32_bf16 v[44:47], a[0:3], a[120:123], v[44:47]
    s_waitcnt lgkmcnt(0)
    v_mfma_f32_16x16x32_bf16 v[64:67], a[8:11], a[96:99], v[64:67]
    s_barrier
    v_mfma_f32_16x16x32_bf16 v[64:67], a[12:15], a[100:103], v[64:67]
    s_add_u32 m0, s57, 65536
    v_mfma_f32_16x16x32_bf16 v[68:71], a[12:15], a[108:111], v[68:71]
    buffer_load_dwordx4 v2, s[8:11], 0 offen lds
    v_mfma_f32_16x16x32_bf16 v[68:71], a[8:11], a[104:107], v[68:71]
    v_mfma_f32_16x16x32_bf16 v[72:75], a[8:11], a[112:115], v[72:75]
    v_mfma_f32_16x16x32_bf16 v[72:75], a[12:15], a[116:119], v[72:75]
    v_mfma_f32_16x16x32_bf16 v[76:79], a[12:15], a[124:127], v[76:79]
    s_add_u32 m0, s55, 0
    v_mfma_f32_16x16x32_bf16 v[76:79], a[8:11], a[120:123], v[76:79]
    buffer_load_dwordx4 v1, s[4:7], 0 offen lds
    v_mfma_f32_16x16x32_bf16 v[96:99], a[16:19], a[96:99], v[96:99]
    v_mfma_f32_16x16x32_bf16 v[96:99], a[20:23], a[100:103], v[96:99]
    v_mfma_f32_16x16x32_bf16 v[100:103], a[20:23], a[108:111], v[100:103]
    v_mfma_f32_16x16x32_bf16 v[100:103], a[16:19], a[104:107], v[100:103]
    s_add_u32 m0, s57, 67584
    v_mfma_f32_16x16x32_bf16 v[104:107], a[16:19], a[112:115], v[104:107]
    buffer_load_dwordx4 v2, s[8:11], s48 offen lds
    v_mfma_f32_16x16x32_bf16 v[104:107], a[20:23], a[116:119], v[104:107]
    v_mfma_f32_16x16x32_bf16 v[108:111], a[20:23], a[124:127], v[108:111]
    v_mfma_f32_16x16x32_bf16 v[108:111], a[16:19], a[120:123], v[108:111]
    v_mfma_f32_16x16x32_bf16 v[128:131], a[24:27], a[96:99], v[128:131]
    s_add_u32 m0, s55, 4096
    v_mfma_f32_16x16x32_bf16 v[128:131], a[28:31], a[100:103], v[128:131]
    buffer_load_dwordx4 v1, s[4:7], s41 offen lds
    v_mfma_f32_16x16x32_bf16 v[132:135], a[28:31], a[108:111], v[132:135]
    v_mfma_f32_16x16x32_bf16 v[132:135], a[24:27], a[104:107], v[132:135]
    v_mfma_f32_16x16x32_bf16 v[136:139], a[24:27], a[112:115], v[136:139]
    v_mfma_f32_16x16x32_bf16 v[136:139], a[28:31], a[116:119], v[136:139]
    s_add_u32 m0, s57, 73728
    v_mfma_f32_16x16x32_bf16 v[140:143], a[28:31], a[124:127], v[140:143]
    buffer_load_dwordx4 v2, s[8:11], s49 offen lds
    v_mfma_f32_16x16x32_bf16 v[140:143], a[24:27], a[120:123], v[140:143]
    v_mfma_f32_16x16x32_bf16 v[160:163], a[32:35], a[96:99], v[160:163]
    v_mfma_f32_16x16x32_bf16 v[160:163], a[36:39], a[100:103], v[160:163]
    v_mfma_f32_16x16x32_bf16 v[164:167], a[36:39], a[108:111], v[164:167]
    s_add_u32 m0, s55, 8192
    v_mfma_f32_16x16x32_bf16 v[164:167], a[32:35], a[104:107], v[164:167]
    buffer_load_dwordx4 v1, s[4:7], s42 offen lds
    v_mfma_f32_16x16x32_bf16 v[168:171], a[32:35], a[112:115], v[168:171]
    v_mfma_f32_16x16x32_bf16 v[168:171], a[36:39], a[116:119], v[168:171]
    v_mfma_f32_16x16x32_bf16 v[172:175], a[36:39], a[124:127], v[172:175]
    v_mfma_f32_16x16x32_bf16 v[172:175], a[32:35], a[120:123], v[172:175]
    s_add_u32 m0, s57, 75776
    v_mfma_f32_16x16x32_bf16 v[192:195], a[40:43], a[96:99], v[192:195]
    buffer_load_dwordx4 v2, s[8:11], s50 offen lds
    v_mfma_f32_16x16x32_bf16 v[192:195], a[44:47], a[100:103], v[192:195]
    v_mfma_f32_16x16x32_bf16 v[196:199], a[44:47], a[108:111], v[196:199]
    v_mfma_f32_16x16x32_bf16 v[196:199], a[40:43], a[104:107], v[196:199]
    v_mfma_f32_16x16x32_bf16 v[200:203], a[40:43], a[112:115], v[200:203]
    s_add_u32 m0, s55, 12288
    v_mfma_f32_16x16x32_bf16 v[200:203], a[44:47], a[116:119], v[200:203]
    buffer_load_dwordx4 v1, s[4:7], s43 offen lds
    v_mfma_f32_16x16x32_bf16 v[204:207], a[44:47], a[124:127], v[204:207]
    v_mfma_f32_16x16x32_bf16 v[204:207], a[40:43], a[120:123], v[204:207]
    v_mfma_f32_16x16x32_bf16 v[224:227], a[48:51], a[96:99], v[224:227]
    v_mfma_f32_16x16x32_bf16 v[224:227], a[52:55], a[100:103], v[224:227]
    s_add_u32 m0, s57, 81920
    v_mfma_f32_16x16x32_bf16 v[228:231], a[52:55], a[108:111], v[228:231]
    buffer_load_dwordx4 v2, s[8:11], s51 offen lds
    v_mfma_f32_16x16x32_bf16 v[228:231], a[48:51], a[104:107], v[228:231]
    v_mfma_f32_16x16x32_bf16 v[232:235], a[48:51], a[112:115], v[232:235]
    v_mfma_f32_16x16x32_bf16 v[232:235], a[52:55], a[116:119], v[232:235]
    v_mfma_f32_16x16x32_bf16 v[236:239], a[52:55], a[124:127], v[236:239]
    s_add_u32 m0, s55, 16384
    v_mfma_f32_16x16x32_bf16 v[236:239], a[48:51], a[120:123], v[236:239]
    buffer_load_dwordx4 v1, s[4:7], s44 offen lds
    v_mfma_f32_16x16x32_bf16 a[128:131], a[56:59], a[96:99], a[128:131]
    v_mfma_f32_16x16x32_bf16 a[128:131], a[60:63], a[100:103], a[128:131]
    v_mfma_f32_16x16x32_bf16 a[132:135], a[60:63], a[108:111], a[132:135]
    v_mfma_f32_16x16x32_bf16 a[132:135], a[56:59], a[104:107], a[132:135]
    s_add_u32 m0, s57, 83968
    v_mfma_f32_16x16x32_bf16 a[136:139], a[56:59], a[112:115], a[136:139]
    s_waitcnt vmcnt(10)
    buffer_load_dwordx4 v2, s[8:11], s52 offen lds
    v_mfma_f32_16x16x32_bf16 a[136:139], a[60:63], a[116:119], a[136:139]
    s_barrier
    ds_read_b64_tr_b16 a[0:1], v6 offset:32768
    v_mfma_f32_16x16x32_bf16 a[140:143], a[60:63], a[124:127], a[140:143]
    ds_read_b64_tr_b16 a[2:3], v6 offset:34816
    v_mfma_f32_16x16x32_bf16 a[140:143], a[56:59], a[120:123], a[140:143]
    ds_read_b128 a[96:99], v4 offset:40960
    v_mfma_f32_16x16x32_bf16 v[144:147], a[32:35], a[64:67], v[144:147]
    s_add_u32 m0, s55, 20480
    v_mfma_f32_16x16x32_bf16 v[144:147], a[36:39], a[68:71], v[144:147]
    buffer_load_dwordx4 v1, s[4:7], s45 offen lds
    v_mfma_f32_16x16x32_bf16 v[148:151], a[36:39], a[76:79], v[148:151]
    ds_read_b64_tr_b16 a[4:5], v6 offset:49152
    v_mfma_f32_16x16x32_bf16 v[148:151], a[32:35], a[72:75], v[148:151]
    ds_read_b64_tr_b16 a[6:7], v6 offset:51200
    v_mfma_f32_16x16x32_bf16 v[152:155], a[32:35], a[80:83], v[152:155]
    ds_read_b128 a[100:103], v5 offset:40960
    v_mfma_f32_16x16x32_bf16 v[152:155], a[36:39], a[84:87], v[152:155]
    s_add_u32 m0, s57, 90112
    v_mfma_f32_16x16x32_bf16 v[156:159], a[36:39], a[92:95], v[156:159]
    buffer_load_dwordx4 v2, s[8:11], s53 offen lds
    v_mfma_f32_16x16x32_bf16 v[156:159], a[32:35], a[88:91], v[156:159]
    ds_read_b128 a[108:111], v5 offset:43008
    v_mfma_f32_16x16x32_bf16 v[176:179], a[40:43], a[64:67], v[176:179]
    v_mfma_f32_16x16x32_bf16 v[176:179], a[44:47], a[68:71], v[176:179]
    ds_read_b128 a[104:107], v4 offset:43008
    v_mfma_f32_16x16x32_bf16 v[180:183], a[44:47], a[76:79], v[180:183]
    s_add_u32 m0, s55, 24576
    v_mfma_f32_16x16x32_bf16 v[180:183], a[40:43], a[72:75], v[180:183]
    buffer_load_dwordx4 v1, s[4:7], s46 offen lds
    v_mfma_f32_16x16x32_bf16 v[184:187], a[40:43], a[80:83], v[184:187]
    ds_read_b128 a[112:115], v4 offset:45056
    v_mfma_f32_16x16x32_bf16 v[184:187], a[44:47], a[84:87], v[184:187]
    v_mfma_f32_16x16x32_bf16 v[188:191], a[44:47], a[92:95], v[188:191]
    ds_read_b128 a[116:119], v5 offset:45056
    v_mfma_f32_16x16x32_bf16 v[188:191], a[40:43], a[88:91], v[188:191]
    s_add_u32 m0, s57, 92160
    v_mfma_f32_16x16x32_bf16 v[208:211], a[48:51], a[64:67], v[208:211]
    buffer_load_dwordx4 v2, s[8:11], s54 offen lds
    v_mfma_f32_16x16x32_bf16 v[208:211], a[52:55], a[68:71], v[208:211]
    ds_read_b128 a[124:127], v5 offset:47104
    v_mfma_f32_16x16x32_bf16 v[212:215], a[52:55], a[76:79], v[212:215]
    v_mfma_f32_16x16x32_bf16 v[212:215], a[48:51], a[72:75], v[212:215]
    ds_read_b128 a[120:123], v4 offset:47104
    v_mfma_f32_16x16x32_bf16 v[216:219], a[48:51], a[80:83], v[216:219]
    s_add_u32 m0, s55, 28672
    v_mfma_f32_16x16x32_bf16 v[216:219], a[52:55], a[84:87], v[216:219]
    buffer_load_dwordx4 v1, s[4:7], s47 offen lds
    v_mfma_f32_16x16x32_bf16 v[220:223], a[52:55], a[92:95], v[220:223]
    v_add_u32 v1, 128, v1
    v_add_u32 v2, 0x80000, v2
    v_mfma_f32_16x16x32_bf16 v[220:223], a[48:51], a[88:91], v[220:223]
    ds_read_b64_tr_b16 a[8:9], v7 offset:32768
    v_mfma_f32_16x16x32_bf16 v[240:243], a[56:59], a[64:67], v[240:243]
    ds_read_b64_tr_b16 a[10:11], v7 offset:34816
    v_mfma_f32_16x16x32_bf16 v[240:243], a[60:63], a[68:71], v[240:243]
    ds_read_b64_tr_b16 a[12:13], v7 offset:49152
    v_mfma_f32_16x16x32_bf16 v[244:247], a[60:63], a[76:79], v[244:247]
    ds_read_b64_tr_b16 a[14:15], v7 offset:51200
    v_mfma_f32_16x16x32_bf16 v[244:247], a[56:59], a[72:75], v[244:247]
    ds_read_b64_tr_b16 a[16:17], v8 offset:32768
    v_mfma_f32_16x16x32_bf16 v[248:251], a[56:59], a[80:83], v[248:251]
    ds_read_b64_tr_b16 a[18:19], v8 offset:34816
    v_mfma_f32_16x16x32_bf16 v[248:251], a[60:63], a[84:87], v[248:251]
    ds_read_b64_tr_b16 a[20:21], v8 offset:49152
    v_mfma_f32_16x16x32_bf16 v[252:255], a[60:63], a[92:95], v[252:255]
    ds_read_b64_tr_b16 a[22:23], v8 offset:51200
    v_mfma_f32_16x16x32_bf16 v[252:255], a[56:59], a[88:91], v[252:255]
    s_waitcnt lgkmcnt(8)
    ds_read_b64_tr_b16 a[24:25], v9 offset:32768
    v_mfma_f32_16x16x32_bf16 v[32:35], a[0:3], a[96:99], v[32:35]
    ds_read_b64_tr_b16 a[26:27], v9 offset:34816
    v_mfma_f32_16x16x32_bf16 v[32:35], a[4:7], a[100:103], v[32:35]
    ds_read_b64_tr_b16 a[28:29], v9 offset:49152
    v_mfma_f32_16x16x32_bf16 v[36:39], a[4:7], a[108:111], v[36:39]
    ds_read_b64_tr_b16 a[30:31], v9 offset:51200
    v_mfma_f32_16x16x32_bf16 v[36:39], a[0:3], a[104:107], v[36:39]
    ds_read_b128 a[64:67], v4 offset:32768
    v_mfma_f32_16x16x32_bf16 v[40:43], a[0:3], a[112:115], v[40:43]
    v_mfma_f32_16x16x32_bf16 v[40:43], a[4:7], a[116:119], v[40:43]
    ds_read_b128 a[68:71], v5 offset:32768
    v_mfma_f32_16x16x32_bf16 v[44:47], a[4:7], a[124:127], v[44:47]
    v_mfma_f32_16x16x32_bf16 v[44:47], a[0:3], a[120:123], v[44:47]
    s_waitcnt lgkmcnt(8)
    ds_read_b128 a[76:79], v5 offset:34816
    v_mfma_f32_16x16x32_bf16 v[64:67], a[8:11], a[96:99], v[64:67]
    v_mfma_f32_16x16x32_bf16 v[64:67], a[12:15], a[100:103], v[64:67]
    ds_read_b128 a[72:75], v4 offset:34816
    v_mfma_f32_16x16x32_bf16 v[68:71], a[12:15], a[108:111], v[68:71]
    v_mfma_f32_16x16x32_bf16 v[68:71], a[8:11], a[104:107], v[68:71]
    ds_read_b128 a[80:83], v4 offset:36864
    v_mfma_f32_16x16x32_bf16 v[72:75], a[8:11], a[112:115], v[72:75]
    v_mfma_f32_16x16x32_bf16 v[72:75], a[12:15], a[116:119], v[72:75]
    ds_read_b128 a[84:87], v5 offset:36864
    v_mfma_f32_16x16x32_bf16 v[76:79], a[12:15], a[124:127], v[76:79]
    v_mfma_f32_16x16x32_bf16 v[76:79], a[8:11], a[120:123], v[76:79]
    ds_read_b128 a[92:95], v5 offset:38912
    v_mfma_f32_16x16x32_bf16 v[96:99], a[16:19], a[96:99], v[96:99]
    s_waitcnt lgkmcnt(8)
    v_mfma_f32_16x16x32_bf16 v[96:99], a[20:23], a[100:103], v[96:99]
    ds_read_b128 a[88:91], v4 offset:38912
    v_mfma_f32_16x16x32_bf16 v[100:103], a[20:23], a[108:111], v[100:103]
    v_mfma_f32_16x16x32_bf16 v[100:103], a[16:19], a[104:107], v[100:103]
    ds_read_b64_tr_b16 a[32:33], v10 offset:32768
    v_mfma_f32_16x16x32_bf16 v[104:107], a[16:19], a[112:115], v[104:107]
    ds_read_b64_tr_b16 a[34:35], v10 offset:34816
    v_mfma_f32_16x16x32_bf16 v[104:107], a[20:23], a[116:119], v[104:107]
    ds_read_b64_tr_b16 a[36:37], v10 offset:49152
    v_mfma_f32_16x16x32_bf16 v[108:111], a[20:23], a[124:127], v[108:111]
    ds_read_b64_tr_b16 a[38:39], v10 offset:51200
    v_mfma_f32_16x16x32_bf16 v[108:111], a[16:19], a[120:123], v[108:111]
    ds_read_b64_tr_b16 a[40:41], v11 offset:32768
    v_mfma_f32_16x16x32_bf16 v[128:131], a[24:27], a[96:99], v[128:131]
    s_waitcnt lgkmcnt(8)
    ds_read_b64_tr_b16 a[42:43], v11 offset:34816
    v_mfma_f32_16x16x32_bf16 v[128:131], a[28:31], a[100:103], v[128:131]
    ds_read_b64_tr_b16 a[44:45], v11 offset:49152
    v_mfma_f32_16x16x32_bf16 v[132:135], a[28:31], a[108:111], v[132:135]
    ds_read_b64_tr_b16 a[46:47], v11 offset:51200
    v_mfma_f32_16x16x32_bf16 v[132:135], a[24:27], a[104:107], v[132:135]
    ds_read_b64_tr_b16 a[48:49], v12 offset:32768
    v_mfma_f32_16x16x32_bf16 v[136:139], a[24:27], a[112:115], v[136:139]
    ds_read_b64_tr_b16 a[50:51], v12 offset:34816
    v_mfma_f32_16x16x32_bf16 v[136:139], a[28:31], a[116:119], v[136:139]
    ds_read_b64_tr_b16 a[52:53], v12 offset:49152
    v_mfma_f32_16x16x32_bf16 v[140:143], a[28:31], a[124:127], v[140:143]
    ds_read_b64_tr_b16 a[54:55], v12 offset:51200
    v_mfma_f32_16x16x32_bf16 v[140:143], a[24:27], a[120:123], v[140:143]
    ds_read_b64_tr_b16 a[56:57], v13 offset:32768
    v_mfma_f32_16x16x32_bf16 v[16:19], a[0:3], a[64:67], v[16:19]
    ds_read_b64_tr_b16 a[58:59], v13 offset:34816
    v_mfma_f32_16x16x32_bf16 v[16:19], a[4:7], a[68:71], v[16:19]
    ds_read_b64_tr_b16 a[60:61], v13 offset:49152
    v_mfma_f32_16x16x32_bf16 v[20:23], a[4:7], a[76:79], v[20:23]
    ds_read_b64_tr_b16 a[62:63], v13 offset:51200
    v_mfma_f32_16x16x32_bf16 v[20:23], a[0:3], a[72:75], v[20:23]
    v_mfma_f32_16x16x32_bf16 v[24:27], a[0:3], a[80:83], v[24:27]
    s_waitcnt lgkmcnt(8)
    v_mfma_f32_16x16x32_bf16 v[24:27], a[4:7], a[84:87], v[24:27]
    v_mfma_f32_16x16x32_bf16 v[28:31], a[4:7], a[92:95], v[28:31]
    v_mfma_f32_16x16x32_bf16 v[28:31], a[0:3], a[88:91], v[28:31]
    s_waitcnt lgkmcnt(0)
    v_mfma_f32_16x16x32_bf16 v[48:51], a[8:11], a[64:67], v[48:51]
    s_barrier
    v_mfma_f32_16x16x32_bf16 v[48:51], a[12:15], a[68:71], v[48:51]
    s_add_u32 m0, s57, 98304
    v_mfma_f32_16x16x32_bf16 v[52:55], a[12:15], a[76:79], v[52:55]
    buffer_load_dwordx4 v2, s[8:11], 0 offen lds
    v_mfma_f32_16x16x32_bf16 v[52:55], a[8:11], a[72:75], v[52:55]
    v_mfma_f32_16x16x32_bf16 v[56:59], a[8:11], a[80:83], v[56:59]
    v_mfma_f32_16x16x32_bf16 v[56:59], a[12:15], a[84:87], v[56:59]
    v_mfma_f32_16x16x32_bf16 v[60:63], a[12:15], a[92:95], v[60:63]
    s_add_u32 m0, s55, 32768
    v_mfma_f32_16x16x32_bf16 v[60:63], a[8:11], a[88:91], v[60:63]
    buffer_load_dwordx4 v1, s[4:7], 0 offen lds
    v_mfma_f32_16x16x32_bf16 v[80:83], a[16:19], a[64:67], v[80:83]
    v_mfma_f32_16x16x32_bf16 v[80:83], a[20:23], a[68:71], v[80:83]
    v_mfma_f32_16x16x32_bf16 v[84:87], a[20:23], a[76:79], v[84:87]
    v_mfma_f32_16x16x32_bf16 v[84:87], a[16:19], a[72:75], v[84:87]
    s_add_u32 m0, s57, 100352
    v_mfma_f32_16x16x32_bf16 v[88:91], a[16:19], a[80:83], v[88:91]
    buffer_load_dwordx4 v2, s[8:11], s48 offen lds
    v_mfma_f32_16x16x32_bf16 v[88:91], a[20:23], a[84:87], v[88:91]
    v_mfma_f32_16x16x32_bf16 v[92:95], a[20:23], a[92:95], v[92:95]
    v_mfma_f32_16x16x32_bf16 v[92:95], a[16:19], a[88:91], v[92:95]
    v_mfma_f32_16x16x32_bf16 v[112:115], a[24:27], a[64:67], v[112:115]
    s_add_u32 m0, s55, 36864
    v_mfma_f32_16x16x32_bf16 v[112:115], a[28:31], a[68:71], v[112:115]
    buffer_load_dwordx4 v1, s[4:7], s41 offen lds
    v_mfma_f32_16x16x32_bf16 v[116:119], a[28:31], a[76:79], v[116:119]
    v_mfma_f32_16x16x32_bf16 v[116:119], a[24:27], a[72:75], v[116:119]
    v_mfma_f32_16x16x32_bf16 v[120:123], a[24:27], a[80:83], v[120:123]
    v_mfma_f32_16x16x32_bf16 v[120:123], a[28:31], a[84:87], v[120:123]
    s_add_u32 m0, s57, 106496
    v_mfma_f32_16x16x32_bf16 v[124:127], a[28:31], a[92:95], v[124:127]
    buffer_load_dwordx4 v2, s[8:11], s49 offen lds
    v_mfma_f32_16x16x32_bf16 v[124:127], a[24:27], a[88:91], v[124:127]
    v_mfma_f32_16x16x32_bf16 v[144:147], a[32:35], a[64:67], v[144:147]
    v_mfma_f32_16x16x32_bf16 v[144:147], a[36:39], a[68:71], v[144:147]
    v_mfma_f32_16x16x32_bf16 v[148:151], a[36:39], a[76:79], v[148:151]
    s_add_u32 m0, s55, 40960
    v_mfma_f32_16x16x32_bf16 v[148:151], a[32:35], a[72:75], v[148:151]
    buffer_load_dwordx4 v1, s[4:7], s42 offen lds
    v_mfma_f32_16x16x32_bf16 v[152:155], a[32:35], a[80:83], v[152:155]
    v_mfma_f32_16x16x32_bf16 v[152:155], a[36:39], a[84:87], v[152:155]
    v_mfma_f32_16x16x32_bf16 v[156:159], a[36:39], a[92:95], v[156:159]
    v_mfma_f32_16x16x32_bf16 v[156:159], a[32:35], a[88:91], v[156:159]
    s_add_u32 m0, s57, 108544
    v_mfma_f32_16x16x32_bf16 v[176:179], a[40:43], a[64:67], v[176:179]
    buffer_load_dwordx4 v2, s[8:11], s50 offen lds
    v_mfma_f32_16x16x32_bf16 v[176:179], a[44:47], a[68:71], v[176:179]
    v_mfma_f32_16x16x32_bf16 v[180:183], a[44:47], a[76:79], v[180:183]
    v_mfma_f32_16x16x32_bf16 v[180:183], a[40:43], a[72:75], v[180:183]
    v_mfma_f32_16x16x32_bf16 v[184:187], a[40:43], a[80:83], v[184:187]
    s_add_u32 m0, s55, 45056
    v_mfma_f32_16x16x32_bf16 v[184:187], a[44:47], a[84:87], v[184:187]
    buffer_load_dwordx4 v1, s[4:7], s43 offen lds
    v_mfma_f32_16x16x32_bf16 v[188:191], a[44:47], a[92:95], v[188:191]
    v_mfma_f32_16x16x32_bf16 v[188:191], a[40:43], a[88:91], v[188:191]
    v_mfma_f32_16x16x32_bf16 v[208:211], a[48:51], a[64:67], v[208:211]
    v_mfma_f32_16x16x32_bf16 v[208:211], a[52:55], a[68:71], v[208:211]
    s_add_u32 m0, s57, 114688
    v_mfma_f32_16x16x32_bf16 v[212:215], a[52:55], a[76:79], v[212:215]
    buffer_load_dwordx4 v2, s[8:11], s51 offen lds
    v_mfma_f32_16x16x32_bf16 v[212:215], a[48:51], a[72:75], v[212:215]
    v_mfma_f32_16x16x32_bf16 v[216:219], a[48:51], a[80:83], v[216:219]
    v_mfma_f32_16x16x32_bf16 v[216:219], a[52:55], a[84:87], v[216:219]
    v_mfma_f32_16x16x32_bf16 v[220:223], a[52:55], a[92:95], v[220:223]
    s_add_u32 m0, s55, 49152
    v_mfma_f32_16x16x32_bf16 v[220:223], a[48:51], a[88:91], v[220:223]
    buffer_load_dwordx4 v1, s[4:7], s44 offen lds
    v_mfma_f32_16x16x32_bf16 v[240:243], a[56:59], a[64:67], v[240:243]
    v_mfma_f32_16x16x32_bf16 v[240:243], a[60:63], a[68:71], v[240:243]
    v_mfma_f32_16x16x32_bf16 v[244:247], a[60:63], a[76:79], v[244:247]
    v_mfma_f32_16x16x32_bf16 v[244:247], a[56:59], a[72:75], v[244:247]
    s_add_u32 m0, s57, 116736
    v_mfma_f32_16x16x32_bf16 v[248:251], a[56:59], a[80:83], v[248:251]
    s_waitcnt vmcnt(10)
    buffer_load_dwordx4 v2, s[8:11], s52 offen lds
    v_mfma_f32_16x16x32_bf16 v[248:251], a[60:63], a[84:87], v[248:251]
    s_barrier
    ds_read_b64_tr_b16 a[0:1], v6 offset:0
    v_mfma_f32_16x16x32_bf16 v[252:255], a[60:63], a[92:95], v[252:255]
    ds_read_b64_tr_b16 a[2:3], v6 offset:2048
    v_mfma_f32_16x16x32_bf16 v[252:255], a[56:59], a[88:91], v[252:255]
    ds_read_b128 a[64:67], v4 offset:0
    v_mfma_f32_16x16x32_bf16 v[160:163], a[32:35], a[96:99], v[160:163]
    s_add_u32 m0, s55, 53248
    v_mfma_f32_16x16x32_bf16 v[160:163], a[36:39], a[100:103], v[160:163]
    buffer_load_dwordx4 v1, s[4:7], s45 offen lds
    v_mfma_f32_16x16x32_bf16 v[164:167], a[36:39], a[108:111], v[164:167]
    ds_read_b64_tr_b16 a[4:5], v6 offset:16384
    v_mfma_f32_16x16x32_bf16 v[164:167], a[32:35], a[104:107], v[164:167]
    ds_read_b64_tr_b16 a[6:7], v6 offset:18432
    v_mfma_f32_16x16x32_bf16 v[168:171], a[32:35], a[112:115], v[168:171]
    ds_read_b128 a[68:71], v5 offset:0
    v_mfma_f32_16x16x32_bf16 v[168:171], a[36:39], a[116:119], v[168:171]
    s_add_u32 m0, s57, 122880
    v_mfma_f32_16x16x32_bf16 v[172:175], a[36:39], a[124:127], v[172:175]
    buffer_load_dwordx4 v2, s[8:11], s53 offen lds
    v_mfma_f32_16x16x32_bf16 v[172:175], a[32:35], a[120:123], v[172:175]
    ds_read_b128 a[76:79], v5 offset:2048
    v_mfma_f32_16x16x32_bf16 v[192:195], a[40:43], a[96:99], v[192:195]
    v_mfma_f32_16x16x32_bf16 v[192:195], a[44:47], a[100:103], v[192:195]
    ds_read_b128 a[72:75], v4 offset:2048
    v_mfma_f32_16x16x32_bf16 v[196:199], a[44:47], a[108:111], v[196:199]
    s_add_u32 m0, s55, 57344
    v_mfma_f32_16x16x32_bf16 v[196:199], a[40:43], a[104:107], v[196:199]
    buffer_load_dwordx4 v1, s[4:7], s46 offen lds
    v_mfma_f32_16x16x32_bf16 v[200:203], a[40:43], a[112:115], v[200:203]
    ds_read_b128 a[80:83], v4 offset:4096
    v_mfma_f32_16x16x32_bf16 v[200:203], a[44:47], a[116:119], v[200:203]
    v_mfma_f32_16x16x32_bf16 v[204:207], a[44:47], a[124:127], v[204:207]
    ds_read_b128 a[84:87], v5 offset:4096
    v_mfma_f32_16x16x32_bf16 v[204:207], a[40:43], a[120:123], v[204:207]
    s_add_u32 m0, s57, 124928
    v_mfma_f32_16x16x32_bf16 v[224:227], a[48:51], a[96:99], v[224:227]
    buffer_load_dwordx4 v2, s[8:11], s54 offen lds
    v_mfma_f32_16x16x32_bf16 v[224:227], a[52:55], a[100:103], v[224:227]
    ds_read_b128 a[92:95], v5 offset:6144
    v_mfma_f32_16x16x32_bf16 v[228:231], a[52:55], a[108:111], v[228:231]
    v_mfma_f32_16x16x32_bf16 v[228:231], a[48:51], a[104:107], v[228:231]
    ds_read_b128 a[88:91], v4 offset:6144
    v_mfma_f32_16x16x32_bf16 v[232:235], a[48:51], a[112:115], v[232:235]
    s_add_u32 m0, s55, 61440
    v_mfma_f32_16x16x32_bf16 v[232:235], a[52:55], a[116:119], v[232:235]
    buffer_load_dwordx4 v1, s[4:7], s47 offen lds
    v_mfma_f32_16x16x32_bf16 v[236:239], a[52:55], a[124:127], v[236:239]
    v_add_u32 v1, 128, v1
    v_add_u32 v2, 0x80000, v2
    v_mfma_f32_16x16x32_bf16 v[236:239], a[48:51], a[120:123], v[236:239]
    ds_read_b64_tr_b16 a[8:9], v7 offset:0
    v_mfma_f32_16x16x32_bf16 a[128:131], a[56:59], a[96:99], a[128:131]
    ds_read_b64_tr_b16 a[10:11], v7 offset:2048
    v_mfma_f32_16x16x32_bf16 a[128:131], a[60:63], a[100:103], a[128:131]
    ds_read_b64_tr_b16 a[12:13], v7 offset:16384
    v_mfma_f32_16x16x32_bf16 a[132:135], a[60:63], a[108:111], a[132:135]
    ds_read_b64_tr_b16 a[14:15], v7 offset:18432
    v_mfma_f32_16x16x32_bf16 a[132:135], a[56:59], a[104:107], a[132:135]
    ds_read_b64_tr_b16 a[16:17], v8 offset:0
    v_mfma_f32_16x16x32_bf16 a[136:139], a[56:59], a[112:115], a[136:139]
    ds_read_b64_tr_b16 a[18:19], v8 offset:2048
    v_mfma_f32_16x16x32_bf16 a[136:139], a[60:63], a[116:119], a[136:139]
    ds_read_b64_tr_b16 a[20:21], v8 offset:16384
    v_mfma_f32_16x16x32_bf16 a[140:143], a[60:63], a[124:127], a[140:143]
    s_add_u32 s61, s61, 1
    ds_read_b64_tr_b16 a[22:23], v8 offset:18432
    v_mfma_f32_16x16x32_bf16 a[140:143], a[56:59], a[120:123], a[140:143]
    s_waitcnt lgkmcnt(8)
    ds_read_b64_tr_b16 a[24:25], v9 offset:0
    s_cmp_lt_u32 s61, 8
    s_cbranch_scc1 k1_kernel_kloop
    s_lshr_b32 s62, s34, 4
    s_add_u32 s62, s62, s37
    s_and_b32 s63, s34, 15
    s_lshl_b32 s60, s63, 7
    s_mov_b32 s41, 28672
    s_mov_b32 s42, 57344
    s_mov_b32 s43, 86016
    s_waitcnt vmcnt(0) lgkmcnt(0)
    s_lshl_b32 s58, s3, 3
    s_add_u32 s58, s58, s60
    v_lshrrev_b32 v14, 3, v0
    v_add_u32 v14, s58, v14
    v_mul_u32_u24 v14, 896, v14
    s_lshl_b32 s58, s39, 2
    v_lshrrev_b32 v15, 4, v0
    v_add_u32 v15, s58, v15
    v_xor_b32 v15, v0, v15
    v_and_b32 v15, 7, v15
    v_lshl_add_u32 v1, v15, 4, v14
    v_lshrrev_b32 v14, 5, v0
    s_lshl_b32 s58, s39, 1
    s_lshl_b32 s59, s40, 2
    s_add_u32 s58, s58, s59
    v_add_u32 v15, s58, v14
    v_lshlrev_b32 v15, 1, v15
    v_xor_b32 v15, v0, v15
    v_and_b32 v15, 31, v15
    v_lshlrev_b32 v15, 4, v15
    v_add_u32 v14, s56, v14
    v_lshl_add_u32 v14, v14, 13, v15
    s_lshl_b32 s58, s62, 9
    v_add_u32 v2, s58, v14
    s_mov_b32 s4, s20
    s_mov_b32 s5, s21
    s_mov_b32 s6, 1835008
    s_mov_b32 s7, 0x20000
    s_mov_b32 s8, s24
    s_mov_b32 s9, s25
    s_mov_b32 s10, 3670016
    s_mov_b32 s11, 0x20000
    s_barrier
    s_add_u32 m0, s57, 98304
    s_nop 0
    buffer_load_dwordx4 v2, s[8:11], 0 offen lds
    s_add_u32 m0, s57, 100352
    s_nop 0
    buffer_load_dwordx4 v2, s[8:11], s48 offen lds
    s_add_u32 m0, s55, 32768
    s_nop 0
    buffer_load_dwordx4 v1, s[4:7], 0 offen lds
    s_add_u32 m0, s57, 106496
    s_nop 0
    buffer_load_dwordx4 v2, s[8:11], s49 offen lds
    s_add_u32 m0, s57, 108544
    s_nop 0
    buffer_load_dwordx4 v2, s[8:11], s50 offen lds
    s_add_u32 m0, s55, 36864
    s_nop 0
    buffer_load_dwordx4 v1, s[4:7], s41 offen lds
    s_add_u32 m0, s57, 114688
    s_nop 0
    buffer_load_dwordx4 v2, s[8:11], s51 offen lds
    s_add_u32 m0, s57, 116736
    s_nop 0
    buffer_load_dwordx4 v2, s[8:11], s52 offen lds
    s_add_u32 m0, s55, 40960
    s_nop 0
    buffer_load_dwordx4 v1, s[4:7], s42 offen lds
    s_add_u32 m0, s57, 122880
    s_nop 0
    buffer_load_dwordx4 v2, s[8:11], s53 offen lds
    s_add_u32 m0, s57, 124928
    s_nop 0
    buffer_load_dwordx4 v2, s[8:11], s54 offen lds
    s_add_u32 m0, s55, 45056
    s_nop 0
    buffer_load_dwordx4 v1, s[4:7], s43 offen lds
    v_add_u32 v1, 128, v1
    v_add_u32 v2, 0x80000, v2
    s_add_u32 m0, s57, 65536
    s_nop 0
    buffer_load_dwordx4 v2, s[8:11], 0 offen lds
    s_add_u32 m0, s57, 67584
    s_nop 0
    buffer_load_dwordx4 v2, s[8:11], s48 offen lds
    s_add_u32 m0, s55, 0
    s_nop 0
    buffer_load_dwordx4 v1, s[4:7], 0 offen lds
    s_add_u32 m0, s57, 73728
    s_nop 0
    buffer_load_dwordx4 v2, s[8:11], s49 offen lds
    s_add_u32 m0, s57, 75776
    s_nop 0
    buffer_load_dwordx4 v2, s[8:11], s50 offen lds
    s_add_u32 m0, s55, 4096
    s_nop 0
    buffer_load_dwordx4 v1, s[4:7], s41 offen lds
    s_add_u32 m0, s57, 81920
    s_nop 0
    buffer_load_dwordx4 v2, s[8:11], s51 offen lds
    s_add_u32 m0, s57, 83968
    s_nop 0
    buffer_load_dwordx4 v2, s[8:11], s52 offen lds
    s_add_u32 m0, s55, 8192
    s_nop 0
    buffer_load_dwordx4 v1, s[4:7], s42 offen lds
    s_add_u32 m0, s57, 90112
    s_nop 0
    buffer_load_dwordx4 v2, s[8:11], s53 offen lds
    s_add_u32 m0, s57, 92160
    s_nop 0
    buffer_load_dwordx4 v2, s[8:11], s54 offen lds
    s_add_u32 m0, s55, 12288
    s_nop 0
    buffer_load_dwordx4 v1, s[4:7], s43 offen lds
    v_add_u32 v1, 128, v1
    v_add_u32 v2, 0x80000, v2
    s_lshl_b32 s58, s36, 20
    s_lshl_b32 s59, s35, 17
    s_add_u32 s58, s58, s59
    s_lshl_b32 s59, s39, 16
    s_add_u32 s58, s58, s59
    s_lshl_b32 s59, s40, 12
    s_add_u32 s58, s58, s59
    v_cvt_pk_bf16_f32 v16, v16, v17
    v_cvt_pk_bf16_f32 v17, v18, v19
    v_cvt_pk_bf16_f32 v18, v48, v49
    v_cvt_pk_bf16_f32 v19, v50, v51
    buffer_store_dwordx4 v[16:19], v3, s[12:15], s58 offen offset:0
    v_cvt_pk_bf16_f32 v80, v80, v81
    v_cvt_pk_bf16_f32 v81, v82, v83
    v_cvt_pk_bf16_f32 v82, v112, v113
    v_cvt_pk_bf16_f32 v83, v114, v115
    buffer_store_dwordx4 v[80:83], v3, s[12:15], s58 offen offset:1024
    v_cvt_pk_bf16_f32 v144, v144, v145
    v_cvt_pk_bf16_f32 v145, v146, v147
    v_cvt_pk_bf16_f32 v146, v176, v177
    v_cvt_pk_bf16_f32 v147, v178, v179
    buffer_store_dwordx4 v[144:147], v3, s[12:15], s58 offen offset:2048
    v_cvt_pk_bf16_f32 v208, v208, v209
    v_cvt_pk_bf16_f32 v209, v210, v211
    v_cvt_pk_bf16_f32 v210, v240, v241
    v_cvt_pk_bf16_f32 v211, v242, v243
    buffer_store_dwordx4 v[208:211], v3, s[12:15], s58 offen offset:3072
    s_add_u32 s58, s58, 8192
    v_cvt_pk_bf16_f32 v20, v20, v21
    v_cvt_pk_bf16_f32 v21, v22, v23
    v_cvt_pk_bf16_f32 v22, v52, v53
    v_cvt_pk_bf16_f32 v23, v54, v55
    buffer_store_dwordx4 v[20:23], v3, s[12:15], s58 offen offset:0
    v_cvt_pk_bf16_f32 v84, v84, v85
    v_cvt_pk_bf16_f32 v85, v86, v87
    v_cvt_pk_bf16_f32 v86, v116, v117
    v_cvt_pk_bf16_f32 v87, v118, v119
    buffer_store_dwordx4 v[84:87], v3, s[12:15], s58 offen offset:1024
    v_cvt_pk_bf16_f32 v148, v148, v149
    v_cvt_pk_bf16_f32 v149, v150, v151
    v_cvt_pk_bf16_f32 v150, v180, v181
    v_cvt_pk_bf16_f32 v151, v182, v183
    buffer_store_dwordx4 v[148:151], v3, s[12:15], s58 offen offset:2048
    v_cvt_pk_bf16_f32 v212, v212, v213
    v_cvt_pk_bf16_f32 v213, v214, v215
    v_cvt_pk_bf16_f32 v214, v244, v245
    v_cvt_pk_bf16_f32 v215, v246, v247
    buffer_store_dwordx4 v[212:215], v3, s[12:15], s58 offen offset:3072
    s_add_u32 s58, s58, 8192
    v_cvt_pk_bf16_f32 v24, v24, v25
    v_cvt_pk_bf16_f32 v25, v26, v27
    v_cvt_pk_bf16_f32 v26, v56, v57
    v_cvt_pk_bf16_f32 v27, v58, v59
    buffer_store_dwordx4 v[24:27], v3, s[12:15], s58 offen offset:0
    v_cvt_pk_bf16_f32 v88, v88, v89
    v_cvt_pk_bf16_f32 v89, v90, v91
    v_cvt_pk_bf16_f32 v90, v120, v121
    v_cvt_pk_bf16_f32 v91, v122, v123
    buffer_store_dwordx4 v[88:91], v3, s[12:15], s58 offen offset:1024
    v_cvt_pk_bf16_f32 v152, v152, v153
    v_cvt_pk_bf16_f32 v153, v154, v155
    v_cvt_pk_bf16_f32 v154, v184, v185
    v_cvt_pk_bf16_f32 v155, v186, v187
    buffer_store_dwordx4 v[152:155], v3, s[12:15], s58 offen offset:2048
    v_cvt_pk_bf16_f32 v216, v216, v217
    v_cvt_pk_bf16_f32 v217, v218, v219
    v_cvt_pk_bf16_f32 v218, v248, v249
    v_cvt_pk_bf16_f32 v219, v250, v251
    buffer_store_dwordx4 v[216:219], v3, s[12:15], s58 offen offset:3072
    s_add_u32 s58, s58, 8192
    v_cvt_pk_bf16_f32 v28, v28, v29
    v_cvt_pk_bf16_f32 v29, v30, v31
    v_cvt_pk_bf16_f32 v30, v60, v61
    v_cvt_pk_bf16_f32 v31, v62, v63
    buffer_store_dwordx4 v[28:31], v3, s[12:15], s58 offen offset:0
    v_cvt_pk_bf16_f32 v92, v92, v93
    v_cvt_pk_bf16_f32 v93, v94, v95
    v_cvt_pk_bf16_f32 v94, v124, v125
    v_cvt_pk_bf16_f32 v95, v126, v127
    buffer_store_dwordx4 v[92:95], v3, s[12:15], s58 offen offset:1024
    v_cvt_pk_bf16_f32 v156, v156, v157
    v_cvt_pk_bf16_f32 v157, v158, v159
    v_cvt_pk_bf16_f32 v158, v188, v189
    v_cvt_pk_bf16_f32 v159, v190, v191
    buffer_store_dwordx4 v[156:159], v3, s[12:15], s58 offen offset:2048
    v_cvt_pk_bf16_f32 v220, v220, v221
    v_cvt_pk_bf16_f32 v221, v222, v223
    v_cvt_pk_bf16_f32 v222, v252, v253
    v_cvt_pk_bf16_f32 v223, v254, v255
    buffer_store_dwordx4 v[220:223], v3, s[12:15], s58 offen offset:3072
    s_add_u32 s58, s58, 8192
    v_cvt_pk_bf16_f32 v32, v32, v33
    v_cvt_pk_bf16_f32 v33, v34, v35
    v_cvt_pk_bf16_f32 v34, v64, v65
    v_cvt_pk_bf16_f32 v35, v66, v67
    buffer_store_dwordx4 v[32:35], v3, s[12:15], s58 offen offset:0
    v_cvt_pk_bf16_f32 v96, v96, v97
    v_cvt_pk_bf16_f32 v97, v98, v99
    v_cvt_pk_bf16_f32 v98, v128, v129
    v_cvt_pk_bf16_f32 v99, v130, v131
    buffer_store_dwordx4 v[96:99], v3, s[12:15], s58 offen offset:1024
    v_cvt_pk_bf16_f32 v160, v160, v161
    v_cvt_pk_bf16_f32 v161, v162, v163
    v_cvt_pk_bf16_f32 v162, v192, v193
    v_cvt_pk_bf16_f32 v163, v194, v195
    buffer_store_dwordx4 v[160:163], v3, s[12:15], s58 offen offset:2048
    v_mov_b32 v16, v224
    v_mov_b32 v17, v225
    v_mov_b32 v18, v226
    v_mov_b32 v19, v227
    v_accvgpr_read_b32 v20, a128
    v_accvgpr_read_b32 v21, a129
    v_accvgpr_read_b32 v22, a130
    v_accvgpr_read_b32 v23, a131
    v_cvt_pk_bf16_f32 v16, v16, v17
    v_cvt_pk_bf16_f32 v17, v18, v19
    v_cvt_pk_bf16_f32 v18, v20, v21
    v_cvt_pk_bf16_f32 v19, v22, v23
    buffer_store_dwordx4 v[16:19], v3, s[12:15], s58 offen offset:3072
    s_add_u32 s58, s58, 8192
    v_cvt_pk_bf16_f32 v36, v36, v37
    v_cvt_pk_bf16_f32 v37, v38, v39
    v_cvt_pk_bf16_f32 v38, v68, v69
    v_cvt_pk_bf16_f32 v39, v70, v71
    buffer_store_dwordx4 v[36:39], v3, s[12:15], s58 offen offset:0
    v_cvt_pk_bf16_f32 v100, v100, v101
    v_cvt_pk_bf16_f32 v101, v102, v103
    v_cvt_pk_bf16_f32 v102, v132, v133
    v_cvt_pk_bf16_f32 v103, v134, v135
    buffer_store_dwordx4 v[100:103], v3, s[12:15], s58 offen offset:1024
    v_cvt_pk_bf16_f32 v164, v164, v165
    v_cvt_pk_bf16_f32 v165, v166, v167
    v_cvt_pk_bf16_f32 v166, v196, v197
    v_cvt_pk_bf16_f32 v167, v198, v199
    buffer_store_dwordx4 v[164:167], v3, s[12:15], s58 offen offset:2048
    v_mov_b32 v16, v228
    v_mov_b32 v17, v229
    v_mov_b32 v18, v230
    v_mov_b32 v19, v231
    v_accvgpr_read_b32 v20, a132
    v_accvgpr_read_b32 v21, a133
    v_accvgpr_read_b32 v22, a134
    v_accvgpr_read_b32 v23, a135
    v_cvt_pk_bf16_f32 v16, v16, v17
    v_cvt_pk_bf16_f32 v17, v18, v19
    v_cvt_pk_bf16_f32 v18, v20, v21
    v_cvt_pk_bf16_f32 v19, v22, v23
    buffer_store_dwordx4 v[16:19], v3, s[12:15], s58 offen offset:3072
    s_add_u32 s58, s58, 8192
    v_cvt_pk_bf16_f32 v40, v40, v41
    v_cvt_pk_bf16_f32 v41, v42, v43
    v_cvt_pk_bf16_f32 v42, v72, v73
    v_cvt_pk_bf16_f32 v43, v74, v75
    buffer_store_dwordx4 v[40:43], v3, s[12:15], s58 offen offset:0
    v_cvt_pk_bf16_f32 v104, v104, v105
    v_cvt_pk_bf16_f32 v105, v106, v107
    v_cvt_pk_bf16_f32 v106, v136, v137
    v_cvt_pk_bf16_f32 v107, v138, v139
    buffer_store_dwordx4 v[104:107], v3, s[12:15], s58 offen offset:1024
    v_cvt_pk_bf16_f32 v168, v168, v169
    v_cvt_pk_bf16_f32 v169, v170, v171
    v_cvt_pk_bf16_f32 v170, v200, v201
    v_cvt_pk_bf16_f32 v171, v202, v203
    buffer_store_dwordx4 v[168:171], v3, s[12:15], s58 offen offset:2048
    v_mov_b32 v16, v232
    v_mov_b32 v17, v233
    v_mov_b32 v18, v234
    v_mov_b32 v19, v235
    v_accvgpr_read_b32 v20, a136
    v_accvgpr_read_b32 v21, a137
    v_accvgpr_read_b32 v22, a138
    v_accvgpr_read_b32 v23, a139
    v_cvt_pk_bf16_f32 v16, v16, v17
    v_cvt_pk_bf16_f32 v17, v18, v19
    v_cvt_pk_bf16_f32 v18, v20, v21
    v_cvt_pk_bf16_f32 v19, v22, v23
    buffer_store_dwordx4 v[16:19], v3, s[12:15], s58 offen offset:3072
    s_add_u32 s58, s58, 8192
    v_cvt_pk_bf16_f32 v44, v44, v45
    v_cvt_pk_bf16_f32 v45, v46, v47
    v_cvt_pk_bf16_f32 v46, v76, v77
    v_cvt_pk_bf16_f32 v47, v78, v79
    buffer_store_dwordx4 v[44:47], v3, s[12:15], s58 offen offset:0
    v_cvt_pk_bf16_f32 v108, v108, v109
    v_cvt_pk_bf16_f32 v109, v110, v111
    v_cvt_pk_bf16_f32 v110, v140, v141
    v_cvt_pk_bf16_f32 v111, v142, v143
    buffer_store_dwordx4 v[108:111], v3, s[12:15], s58 offen offset:1024
    v_cvt_pk_bf16_f32 v172, v172, v173
    v_cvt_pk_bf16_f32 v173, v174, v175
    v_cvt_pk_bf16_f32 v174, v204, v205
    v_cvt_pk_bf16_f32 v175, v206, v207
    buffer_store_dwordx4 v[172:175], v3, s[12:15], s58 offen offset:2048
    v_mov_b32 v16, v236
    v_mov_b32 v17, v237
    v_mov_b32 v18, v238
    v_mov_b32 v19, v239
    v_accvgpr_read_b32 v20, a140
    v_accvgpr_read_b32 v21, a141
    v_accvgpr_read_b32 v22, a142
    v_accvgpr_read_b32 v23, a143
    v_cvt_pk_bf16_f32 v16, v16, v17
    v_cvt_pk_bf16_f32 v17, v18, v19
    v_cvt_pk_bf16_f32 v18, v20, v21
    v_cvt_pk_bf16_f32 v19, v22, v23
    buffer_store_dwordx4 v[16:19], v3, s[12:15], s58 offen offset:3072
    s_add_u32 s58, s58, 8192
    s_branch k1_kernel_q
.p2align 6
k1_kernel_vloop:
    v_mfma_f32_16x16x32_bf16 v[16:19], a[64:67], a[0:3], v[16:19]
    ds_read_b64_tr_b16 a[26:27], v9 offset:2048
    v_mfma_f32_16x16x32_bf16 v[16:19], a[68:71], a[4:7], v[16:19]
    s_cmp_eq_u32 s61, 7
    s_cmov_b32 s6, 0
    ds_read_b64_tr_b16 a[28:29], v9 offset:16384
    v_mfma_f32_16x16x32_bf16 v[20:23], a[76:79], a[4:7], v[20:23]
    ds_read_b64_tr_b16 a[30:31], v9 offset:18432
    v_mfma_f32_16x16x32_bf16 v[20:23], a[72:75], a[0:3], v[20:23]
    ds_read_b128 a[96:99], v4 offset:8192
    v_mfma_f32_16x16x32_bf16 v[24:27], a[80:83], a[0:3], v[24:27]
    v_mfma_f32_16x16x32_bf16 v[24:27], a[84:87], a[4:7], v[24:27]
    ds_read_b128 a[100:103], v5 offset:8192
    v_mfma_f32_16x16x32_bf16 v[28:31], a[92:95], a[4:7], v[28:31]
    v_mfma_f32_16x16x32_bf16 v[28:31], a[88:91], a[0:3], v[28:31]
    s_waitcnt lgkmcnt(8)
    ds_read_b128 a[108:111], v5 offset:10240
    v_mfma_f32_16x16x32_bf16 v[48:51], a[64:67], a[8:11], v[48:51]
    v_mfma_f32_16x16x32_bf16 v[48:51], a[68:71], a[12:15], v[48:51]
    ds_read_b128 a[104:107], v4 offset:10240
    v_mfma_f32_16x16x32_bf16 v[52:55], a[76:79], a[12:15], v[52:55]
    v_mfma_f32_16x16x32_bf16 v[52:55], a[72:75], a[8:11], v[52:55]
    ds_read_b128 a[112:115], v4 offset:12288
    v_mfma_f32_16x16x32_bf16 v[56:59], a[80:83], a[8:11], v[56:59]
    v_mfma_f32_16x16x32_bf16 v[56:59], a[84:87], a[12:15], v[56:59]
    ds_read_b128 a[116:119], v5 offset:12288
    v_mfma_f32_16x16x32_bf16 v[60:63], a[92:95], a[12:15], v[60:63]
    v_mfma_f32_16x16x32_bf16 v[60:63], a[88:91], a[8:11], v[60:63]
    ds_read_b128 a[124:127], v5 offset:14336
    v_mfma_f32_16x16x32_bf16 v[80:83], a[64:67], a[16:19], v[80:83]
    s_waitcnt lgkmcnt(8)
    v_mfma_f32_16x16x32_bf16 v[80:83], a[68:71], a[20:23], v[80:83]
    ds_read_b128 a[120:123], v4 offset:14336
    v_mfma_f32_16x16x32_bf16 v[84:87], a[76:79], a[20:23], v[84:87]
    v_mfma_f32_16x16x32_bf16 v[84:87], a[72:75], a[16:19], v[84:87]
    ds_read_b64_tr_b16 a[32:33], v10 offset:0
    v_mfma_f32_16x16x32_bf16 v[88:91], a[80:83], a[16:19], v[88:91]
    ds_read_b64_tr_b16 a[34:35], v10 offset:2048
    v_mfma_f32_16x16x32_bf16 v[88:91], a[84:87], a[20:23], v[88:91]
    ds_read_b64_tr_b16 a[36:37], v10 offset:16384
    v_mfma_f32_16x16x32_bf16 v[92:95], a[92:95], a[20:23], v[92:95]
    ds_read_b64_tr_b16 a[38:39], v10 offset:18432
    v_mfma_f32_16x16x32_bf16 v[92:95], a[88:91], a[16:19], v[92:95]
    ds_read_b64_tr_b16 a[40:41], v11 offset:0
    v_mfma_f32_16x16x32_bf16 v[112:115], a[64:67], a[24:27], v[112:115]
    s_waitcnt lgkmcnt(8)
    ds_read_b64_tr_b16 a[42:43], v11 offset:2048
    v_mfma_f32_16x16x32_bf16 v[112:115], a[68:71], a[28:31], v[112:115]
    ds_read_b64_tr_b16 a[44:45], v11 offset:16384
    v_mfma_f32_16x16x32_bf16 v[116:119], a[76:79], a[28:31], v[116:119]
    ds_read_b64_tr_b16 a[46:47], v11 offset:18432
    v_mfma_f32_16x16x32_bf16 v[116:119], a[72:75], a[24:27], v[116:119]
    ds_read_b64_tr_b16 a[48:49], v12 offset:0
    v_mfma_f32_16x16x32_bf16 v[120:123], a[80:83], a[24:27], v[120:123]
    ds_read_b64_tr_b16 a[50:51], v12 offset:2048
    v_mfma_f32_16x16x32_bf16 v[120:123], a[84:87], a[28:31], v[120:123]
    ds_read_b64_tr_b16 a[52:53], v12 offset:16384
    v_mfma_f32_16x16x32_bf16 v[124:127], a[92:95], a[28:31], v[124:127]
    ds_read_b64_tr_b16 a[54:55], v12 offset:18432
    v_mfma_f32_16x16x32_bf16 v[124:127], a[88:91], a[24:27], v[124:127]
    ds_read_b64_tr_b16 a[56:57], v13 offset:0
    v_mfma_f32_16x16x32_bf16 v[32:35], a[96:99], a[0:3], v[32:35]
    ds_read_b64_tr_b16 a[58:59], v13 offset:2048
    v_mfma_f32_16x16x32_bf16 v[32:35], a[100:103], a[4:7], v[32:35]
    ds_read_b64_tr_b16 a[60:61], v13 offset:16384
    v_mfma_f32_16x16x32_bf16 v[36:39], a[108:111], a[4:7], v[36:39]
    ds_read_b64_tr_b16 a[62:63], v13 offset:18432
    v_mfma_f32_16x16x32_bf16 v[36:39], a[104:107], a[0:3], v[36:39]
    v_mfma_f32_16x16x32_bf16 v[40:43], a[112:115], a[0:3], v[40:43]
    s_waitcnt lgkmcnt(8)
    v_mfma_f32_16x16x32_bf16 v[40:43], a[116:119], a[4:7], v[40:43]
    v_mfma_f32_16x16x32_bf16 v[44:47], a[124:127], a[4:7], v[44:47]
    v_mfma_f32_16x16x32_bf16 v[44:47], a[120:123], a[0:3], v[44:47]
    s_waitcnt lgkmcnt(0)
    v_mfma_f32_16x16x32_bf16 v[64:67], a[96:99], a[8:11], v[64:67]
    s_barrier
    v_mfma_f32_16x16x32_bf16 v[64:67], a[100:103], a[12:15], v[64:67]
    s_add_u32 m0, s57, 65536
    v_mfma_f32_16x16x32_bf16 v[68:71], a[108:111], a[12:15], v[68:71]
    buffer_load_dwordx4 v2, s[8:11], 0 offen lds
    v_mfma_f32_16x16x32_bf16 v[68:71], a[104:107], a[8:11], v[68:71]
    v_mfma_f32_16x16x32_bf16 v[72:75], a[112:115], a[8:11], v[72:75]
    v_mfma_f32_16x16x32_bf16 v[72:75], a[116:119], a[12:15], v[72:75]
    v_mfma_f32_16x16x32_bf16 v[76:79], a[124:127], a[12:15], v[76:79]
    s_add_u32 m0, s55, 0
    v_mfma_f32_16x16x32_bf16 v[76:79], a[120:123], a[8:11], v[76:79]
    buffer_load_dwordx4 v1, s[4:7], 0 offen lds
    v_mfma_f32_16x16x32_bf16 v[96:99], a[96:99], a[16:19], v[96:99]
    v_mfma_f32_16x16x32_bf16 v[96:99], a[100:103], a[20:23], v[96:99]
    v_mfma_f32_16x16x32_bf16 v[100:103], a[108:111], a[20:23], v[100:103]
    v_mfma_f32_16x16x32_bf16 v[100:103], a[104:107], a[16:19], v[100:103]
    s_add_u32 m0, s57, 67584
    v_mfma_f32_16x16x32_bf16 v[104:107], a[112:115], a[16:19], v[104:107]
    buffer_load_dwordx4 v2, s[8:11], s48 offen lds
    v_mfma_f32_16x16x32_bf16 v[104:107], a[116:119], a[20:23], v[104:107]
    v_mfma_f32_16x16x32_bf16 v[108:111], a[124:127], a[20:23], v[108:111]
    v_mfma_f32_16x16x32_bf16 v[108:111], a[120:123], a[16:19], v[108:111]
    v_mfma_f32_16x16x32_bf16 v[128:131], a[96:99], a[24:27], v[128:131]
    s_add_u32 m0, s55, 4096
    v_mfma_f32_16x16x32_bf16 v[128:131], a[100:103], a[28:31], v[128:131]
    buffer_load_dwordx4 v1, s[4:7], s41 offen lds
    v_mfma_f32_16x16x32_bf16 v[132:135], a[108:111], a[28:31], v[132:135]
    v_mfma_f32_16x16x32_bf16 v[132:135], a[104:107], a[24:27], v[132:135]
    v_mfma_f32_16x16x32_bf16 v[136:139], a[112:115], a[24:27], v[136:139]
    v_mfma_f32_16x16x32_bf16 v[136:139], a[116:119], a[28:31], v[136:139]
    s_add_u32 m0, s57, 73728
    v_mfma_f32_16x16x32_bf16 v[140:143], a[124:127], a[28:31], v[140:143]
    buffer_load_dwordx4 v2, s[8:11], s49 offen lds
    v_mfma_f32_16x16x32_bf16 v[140:143], a[120:123], a[24:27], v[140:143]
    v_mfma_f32_16x16x32_bf16 v[160:163], a[96:99], a[32:35], v[160:163]
    v_mfma_f32_16x16x32_bf16 v[160:163], a[100:103], a[36:39], v[160:163]
    v_mfma_f32_16x16x32_bf16 v[164:167], a[108:111], a[36:39], v[164:167]
    s_add_u32 m0, s55, 8192
    v_mfma_f32_16x16x32_bf16 v[164:167], a[104:107], a[32:35], v[164:167]
    buffer_load_dwordx4 v1, s[4:7], s42 offen lds
    v_mfma_f32_16x16x32_bf16 v[168:171], a[112:115], a[32:35], v[168:171]
    v_mfma_f32_16x16x32_bf16 v[168:171], a[116:119], a[36:39], v[168:171]
    v_mfma_f32_16x16x32_bf16 v[172:175], a[124:127], a[36:39], v[172:175]
    v_mfma_f32_16x16x32_bf16 v[172:175], a[120:123], a[32:35], v[172:175]
    s_add_u32 m0, s57, 75776
    v_mfma_f32_16x16x32_bf16 v[192:195], a[96:99], a[40:43], v[192:195]
    buffer_load_dwordx4 v2, s[8:11], s50 offen lds
    v_mfma_f32_16x16x32_bf16 v[192:195], a[100:103], a[44:47], v[192:195]
    v_mfma_f32_16x16x32_bf16 v[196:199], a[108:111], a[44:47], v[196:199]
    v_mfma_f32_16x16x32_bf16 v[196:199], a[104:107], a[40:43], v[196:199]
    v_mfma_f32_16x16x32_bf16 v[200:203], a[112:115], a[40:43], v[200:203]
    s_add_u32 m0, s55, 12288
    v_mfma_f32_16x16x32_bf16 v[200:203], a[116:119], a[44:47], v[200:203]
    buffer_load_dwordx4 v1, s[4:7], s43 offen lds
    v_mfma_f32_16x16x32_bf16 v[204:207], a[124:127], a[44:47], v[204:207]
    v_mfma_f32_16x16x32_bf16 v[204:207], a[120:123], a[40:43], v[204:207]
    v_mfma_f32_16x16x32_bf16 v[224:227], a[96:99], a[48:51], v[224:227]
    v_mfma_f32_16x16x32_bf16 v[224:227], a[100:103], a[52:55], v[224:227]
    s_add_u32 m0, s57, 81920
    v_mfma_f32_16x16x32_bf16 v[228:231], a[108:111], a[52:55], v[228:231]
    buffer_load_dwordx4 v2, s[8:11], s51 offen lds
    v_mfma_f32_16x16x32_bf16 v[228:231], a[104:107], a[48:51], v[228:231]
    v_mfma_f32_16x16x32_bf16 v[232:235], a[112:115], a[48:51], v[232:235]
    v_mfma_f32_16x16x32_bf16 v[232:235], a[116:119], a[52:55], v[232:235]
    v_mfma_f32_16x16x32_bf16 v[236:239], a[124:127], a[52:55], v[236:239]
    s_add_u32 m0, s55, 16384
    v_mfma_f32_16x16x32_bf16 v[236:239], a[120:123], a[48:51], v[236:239]
    buffer_load_dwordx4 v1, s[4:7], s44 offen lds
    v_mfma_f32_16x16x32_bf16 a[128:131], a[96:99], a[56:59], a[128:131]
    v_mfma_f32_16x16x32_bf16 a[128:131], a[100:103], a[60:63], a[128:131]
    v_mfma_f32_16x16x32_bf16 a[132:135], a[108:111], a[60:63], a[132:135]
    v_mfma_f32_16x16x32_bf16 a[132:135], a[104:107], a[56:59], a[132:135]
    s_add_u32 m0, s57, 83968
    v_mfma_f32_16x16x32_bf16 a[136:139], a[112:115], a[56:59], a[136:139]
    s_waitcnt vmcnt(10)
    buffer_load_dwordx4 v2, s[8:11], s52 offen lds
    v_mfma_f32_16x16x32_bf16 a[136:139], a[116:119], a[60:63], a[136:139]
    s_barrier
    ds_read_b64_tr_b16 a[0:1], v6 offset:32768
    v_mfma_f32_16x16x32_bf16 a[140:143], a[124:127], a[60:63], a[140:143]
    ds_read_b64_tr_b16 a[2:3], v6 offset:34816
    v_mfma_f32_16x16x32_bf16 a[140:143], a[120:123], a[56:59], a[140:143]
    ds_read_b128 a[96:99], v4 offset:40960
    v_mfma_f32_16x16x32_bf16 v[144:147], a[64:67], a[32:35], v[144:147]
    s_add_u32 m0, s55, 20480
    v_mfma_f32_16x16x32_bf16 v[144:147], a[68:71], a[36:39], v[144:147]
    buffer_load_dwordx4 v1, s[4:7], s45 offen lds
    v_mfma_f32_16x16x32_bf16 v[148:151], a[76:79], a[36:39], v[148:151]
    ds_read_b64_tr_b16 a[4:5], v6 offset:49152
    v_mfma_f32_16x16x32_bf16 v[148:151], a[72:75], a[32:35], v[148:151]
    ds_read_b64_tr_b16 a[6:7], v6 offset:51200
    v_mfma_f32_16x16x32_bf16 v[152:155], a[80:83], a[32:35], v[152:155]
    ds_read_b128 a[100:103], v5 offset:40960
    v_mfma_f32_16x16x32_bf16 v[152:155], a[84:87], a[36:39], v[152:155]
    s_add_u32 m0, s57, 90112
    v_mfma_f32_16x16x32_bf16 v[156:159], a[92:95], a[36:39], v[156:159]
    buffer_load_dwordx4 v2, s[8:11], s53 offen lds
    v_mfma_f32_16x16x32_bf16 v[156:159], a[88:91], a[32:35], v[156:159]
    ds_read_b128 a[108:111], v5 offset:43008
    v_mfma_f32_16x16x32_bf16 v[176:179], a[64:67], a[40:43], v[176:179]
    v_mfma_f32_16x16x32_bf16 v[176:179], a[68:71], a[44:47], v[176:179]
    ds_read_b128 a[104:107], v4 offset:43008
    v_mfma_f32_16x16x32_bf16 v[180:183], a[76:79], a[44:47], v[180:183]
    s_add_u32 m0, s55, 24576
    v_mfma_f32_16x16x32_bf16 v[180:183], a[72:75], a[40:43], v[180:183]
    buffer_load_dwordx4 v1, s[4:7], s46 offen lds
    v_mfma_f32_16x16x32_bf16 v[184:187], a[80:83], a[40:43], v[184:187]
    ds_read_b128 a[112:115], v4 offset:45056
    v_mfma_f32_16x16x32_bf16 v[184:187], a[84:87], a[44:47], v[184:187]
    v_mfma_f32_16x16x32_bf16 v[188:191], a[92:95], a[44:47], v[188:191]
    ds_read_b128 a[116:119], v5 offset:45056
    v_mfma_f32_16x16x32_bf16 v[188:191], a[88:91], a[40:43], v[188:191]
    s_add_u32 m0, s57, 92160
    v_mfma_f32_16x16x32_bf16 v[208:211], a[64:67], a[48:51], v[208:211]
    buffer_load_dwordx4 v2, s[8:11], s54 offen lds
    v_mfma_f32_16x16x32_bf16 v[208:211], a[68:71], a[52:55], v[208:211]
    ds_read_b128 a[124:127], v5 offset:47104
    v_mfma_f32_16x16x32_bf16 v[212:215], a[76:79], a[52:55], v[212:215]
    v_mfma_f32_16x16x32_bf16 v[212:215], a[72:75], a[48:51], v[212:215]
    ds_read_b128 a[120:123], v4 offset:47104
    v_mfma_f32_16x16x32_bf16 v[216:219], a[80:83], a[48:51], v[216:219]
    s_add_u32 m0, s55, 28672
    v_mfma_f32_16x16x32_bf16 v[216:219], a[84:87], a[52:55], v[216:219]
    buffer_load_dwordx4 v1, s[4:7], s47 offen lds
    v_mfma_f32_16x16x32_bf16 v[220:223], a[92:95], a[52:55], v[220:223]
    v_add_u32 v1, 128, v1
    v_add_u32 v2, 0x80000, v2
    v_mfma_f32_16x16x32_bf16 v[220:223], a[88:91], a[48:51], v[220:223]
    ds_read_b64_tr_b16 a[8:9], v7 offset:32768
    v_mfma_f32_16x16x32_bf16 v[240:243], a[64:67], a[56:59], v[240:243]
    ds_read_b64_tr_b16 a[10:11], v7 offset:34816
    v_mfma_f32_16x16x32_bf16 v[240:243], a[68:71], a[60:63], v[240:243]
    ds_read_b64_tr_b16 a[12:13], v7 offset:49152
    v_mfma_f32_16x16x32_bf16 v[244:247], a[76:79], a[60:63], v[244:247]
    ds_read_b64_tr_b16 a[14:15], v7 offset:51200
    v_mfma_f32_16x16x32_bf16 v[244:247], a[72:75], a[56:59], v[244:247]
    ds_read_b64_tr_b16 a[16:17], v8 offset:32768
    v_mfma_f32_16x16x32_bf16 v[248:251], a[80:83], a[56:59], v[248:251]
    ds_read_b64_tr_b16 a[18:19], v8 offset:34816
    v_mfma_f32_16x16x32_bf16 v[248:251], a[84:87], a[60:63], v[248:251]
    ds_read_b64_tr_b16 a[20:21], v8 offset:49152
    v_mfma_f32_16x16x32_bf16 v[252:255], a[92:95], a[60:63], v[252:255]
    ds_read_b64_tr_b16 a[22:23], v8 offset:51200
    v_mfma_f32_16x16x32_bf16 v[252:255], a[88:91], a[56:59], v[252:255]
    s_waitcnt lgkmcnt(8)
    ds_read_b64_tr_b16 a[24:25], v9 offset:32768
    v_mfma_f32_16x16x32_bf16 v[32:35], a[96:99], a[0:3], v[32:35]
    ds_read_b64_tr_b16 a[26:27], v9 offset:34816
    v_mfma_f32_16x16x32_bf16 v[32:35], a[100:103], a[4:7], v[32:35]
    ds_read_b64_tr_b16 a[28:29], v9 offset:49152
    v_mfma_f32_16x16x32_bf16 v[36:39], a[108:111], a[4:7], v[36:39]
    ds_read_b64_tr_b16 a[30:31], v9 offset:51200
    v_mfma_f32_16x16x32_bf16 v[36:39], a[104:107], a[0:3], v[36:39]
    ds_read_b128 a[64:67], v4 offset:32768
    v_mfma_f32_16x16x32_bf16 v[40:43], a[112:115], a[0:3], v[40:43]
    v_mfma_f32_16x16x32_bf16 v[40:43], a[116:119], a[4:7], v[40:43]
    ds_read_b128 a[68:71], v5 offset:32768
    v_mfma_f32_16x16x32_bf16 v[44:47], a[124:127], a[4:7], v[44:47]
    v_mfma_f32_16x16x32_bf16 v[44:47], a[120:123], a[0:3], v[44:47]
    s_waitcnt lgkmcnt(8)
    ds_read_b128 a[76:79], v5 offset:34816
    v_mfma_f32_16x16x32_bf16 v[64:67], a[96:99], a[8:11], v[64:67]
    v_mfma_f32_16x16x32_bf16 v[64:67], a[100:103], a[12:15], v[64:67]
    ds_read_b128 a[72:75], v4 offset:34816
    v_mfma_f32_16x16x32_bf16 v[68:71], a[108:111], a[12:15], v[68:71]
    v_mfma_f32_16x16x32_bf16 v[68:71], a[104:107], a[8:11], v[68:71]
    ds_read_b128 a[80:83], v4 offset:36864
    v_mfma_f32_16x16x32_bf16 v[72:75], a[112:115], a[8:11], v[72:75]
    v_mfma_f32_16x16x32_bf16 v[72:75], a[116:119], a[12:15], v[72:75]
    ds_read_b128 a[84:87], v5 offset:36864
    v_mfma_f32_16x16x32_bf16 v[76:79], a[124:127], a[12:15], v[76:79]
    v_mfma_f32_16x16x32_bf16 v[76:79], a[120:123], a[8:11], v[76:79]
    ds_read_b128 a[92:95], v5 offset:38912
    v_mfma_f32_16x16x32_bf16 v[96:99], a[96:99], a[16:19], v[96:99]
    s_waitcnt lgkmcnt(8)
    v_mfma_f32_16x16x32_bf16 v[96:99], a[100:103], a[20:23], v[96:99]
    ds_read_b128 a[88:91], v4 offset:38912
    v_mfma_f32_16x16x32_bf16 v[100:103], a[108:111], a[20:23], v[100:103]
    v_mfma_f32_16x16x32_bf16 v[100:103], a[104:107], a[16:19], v[100:103]
    ds_read_b64_tr_b16 a[32:33], v10 offset:32768
    v_mfma_f32_16x16x32_bf16 v[104:107], a[112:115], a[16:19], v[104:107]
    ds_read_b64_tr_b16 a[34:35], v10 offset:34816
    v_mfma_f32_16x16x32_bf16 v[104:107], a[116:119], a[20:23], v[104:107]
    ds_read_b64_tr_b16 a[36:37], v10 offset:49152
    v_mfma_f32_16x16x32_bf16 v[108:111], a[124:127], a[20:23], v[108:111]
    ds_read_b64_tr_b16 a[38:39], v10 offset:51200
    v_mfma_f32_16x16x32_bf16 v[108:111], a[120:123], a[16:19], v[108:111]
    ds_read_b64_tr_b16 a[40:41], v11 offset:32768
    v_mfma_f32_16x16x32_bf16 v[128:131], a[96:99], a[24:27], v[128:131]
    s_waitcnt lgkmcnt(8)
    ds_read_b64_tr_b16 a[42:43], v11 offset:34816
    v_mfma_f32_16x16x32_bf16 v[128:131], a[100:103], a[28:31], v[128:131]
    ds_read_b64_tr_b16 a[44:45], v11 offset:49152
    v_mfma_f32_16x16x32_bf16 v[132:135], a[108:111], a[28:31], v[132:135]
    ds_read_b64_tr_b16 a[46:47], v11 offset:51200
    v_mfma_f32_16x16x32_bf16 v[132:135], a[104:107], a[24:27], v[132:135]
    ds_read_b64_tr_b16 a[48:49], v12 offset:32768
    v_mfma_f32_16x16x32_bf16 v[136:139], a[112:115], a[24:27], v[136:139]
    ds_read_b64_tr_b16 a[50:51], v12 offset:34816
    v_mfma_f32_16x16x32_bf16 v[136:139], a[116:119], a[28:31], v[136:139]
    ds_read_b64_tr_b16 a[52:53], v12 offset:49152
    v_mfma_f32_16x16x32_bf16 v[140:143], a[124:127], a[28:31], v[140:143]
    ds_read_b64_tr_b16 a[54:55], v12 offset:51200
    v_mfma_f32_16x16x32_bf16 v[140:143], a[120:123], a[24:27], v[140:143]
    ds_read_b64_tr_b16 a[56:57], v13 offset:32768
    v_mfma_f32_16x16x32_bf16 v[16:19], a[64:67], a[0:3], v[16:19]
    ds_read_b64_tr_b16 a[58:59], v13 offset:34816
    v_mfma_f32_16x16x32_bf16 v[16:19], a[68:71], a[4:7], v[16:19]
    ds_read_b64_tr_b16 a[60:61], v13 offset:49152
    v_mfma_f32_16x16x32_bf16 v[20:23], a[76:79], a[4:7], v[20:23]
    ds_read_b64_tr_b16 a[62:63], v13 offset:51200
    v_mfma_f32_16x16x32_bf16 v[20:23], a[72:75], a[0:3], v[20:23]
    v_mfma_f32_16x16x32_bf16 v[24:27], a[80:83], a[0:3], v[24:27]
    s_waitcnt lgkmcnt(8)
    v_mfma_f32_16x16x32_bf16 v[24:27], a[84:87], a[4:7], v[24:27]
    v_mfma_f32_16x16x32_bf16 v[28:31], a[92:95], a[4:7], v[28:31]
    v_mfma_f32_16x16x32_bf16 v[28:31], a[88:91], a[0:3], v[28:31]
    s_waitcnt lgkmcnt(0)
    v_mfma_f32_16x16x32_bf16 v[48:51], a[64:67], a[8:11], v[48:51]
    s_barrier
    v_mfma_f32_16x16x32_bf16 v[48:51], a[68:71], a[12:15], v[48:51]
    s_add_u32 m0, s57, 98304
    v_mfma_f32_16x16x32_bf16 v[52:55], a[76:79], a[12:15], v[52:55]
    buffer_load_dwordx4 v2, s[8:11], 0 offen lds
    v_mfma_f32_16x16x32_bf16 v[52:55], a[72:75], a[8:11], v[52:55]
    v_mfma_f32_16x16x32_bf16 v[56:59], a[80:83], a[8:11], v[56:59]
    v_mfma_f32_16x16x32_bf16 v[56:59], a[84:87], a[12:15], v[56:59]
    v_mfma_f32_16x16x32_bf16 v[60:63], a[92:95], a[12:15], v[60:63]
    s_add_u32 m0, s55, 32768
    v_mfma_f32_16x16x32_bf16 v[60:63], a[88:91], a[8:11], v[60:63]
    buffer_load_dwordx4 v1, s[4:7], 0 offen lds
    v_mfma_f32_16x16x32_bf16 v[80:83], a[64:67], a[16:19], v[80:83]
    v_mfma_f32_16x16x32_bf16 v[80:83], a[68:71], a[20:23], v[80:83]
    v_mfma_f32_16x16x32_bf16 v[84:87], a[76:79], a[20:23], v[84:87]
    v_mfma_f32_16x16x32_bf16 v[84:87], a[72:75], a[16:19], v[84:87]
    s_add_u32 m0, s57, 100352
    v_mfma_f32_16x16x32_bf16 v[88:91], a[80:83], a[16:19], v[88:91]
    buffer_load_dwordx4 v2, s[8:11], s48 offen lds
    v_mfma_f32_16x16x32_bf16 v[88:91], a[84:87], a[20:23], v[88:91]
    v_mfma_f32_16x16x32_bf16 v[92:95], a[92:95], a[20:23], v[92:95]
    v_mfma_f32_16x16x32_bf16 v[92:95], a[88:91], a[16:19], v[92:95]
    v_mfma_f32_16x16x32_bf16 v[112:115], a[64:67], a[24:27], v[112:115]
    s_add_u32 m0, s55, 36864
    v_mfma_f32_16x16x32_bf16 v[112:115], a[68:71], a[28:31], v[112:115]
    buffer_load_dwordx4 v1, s[4:7], s41 offen lds
    v_mfma_f32_16x16x32_bf16 v[116:119], a[76:79], a[28:31], v[116:119]
    v_mfma_f32_16x16x32_bf16 v[116:119], a[72:75], a[24:27], v[116:119]
    v_mfma_f32_16x16x32_bf16 v[120:123], a[80:83], a[24:27], v[120:123]
    v_mfma_f32_16x16x32_bf16 v[120:123], a[84:87], a[28:31], v[120:123]
    s_add_u32 m0, s57, 106496
    v_mfma_f32_16x16x32_bf16 v[124:127], a[92:95], a[28:31], v[124:127]
    buffer_load_dwordx4 v2, s[8:11], s49 offen lds
    v_mfma_f32_16x16x32_bf16 v[124:127], a[88:91], a[24:27], v[124:127]
    v_mfma_f32_16x16x32_bf16 v[144:147], a[64:67], a[32:35], v[144:147]
    v_mfma_f32_16x16x32_bf16 v[144:147], a[68:71], a[36:39], v[144:147]
    v_mfma_f32_16x16x32_bf16 v[148:151], a[76:79], a[36:39], v[148:151]
    s_add_u32 m0, s55, 40960
    v_mfma_f32_16x16x32_bf16 v[148:151], a[72:75], a[32:35], v[148:151]
    buffer_load_dwordx4 v1, s[4:7], s42 offen lds
    v_mfma_f32_16x16x32_bf16 v[152:155], a[80:83], a[32:35], v[152:155]
    v_mfma_f32_16x16x32_bf16 v[152:155], a[84:87], a[36:39], v[152:155]
    v_mfma_f32_16x16x32_bf16 v[156:159], a[92:95], a[36:39], v[156:159]
    v_mfma_f32_16x16x32_bf16 v[156:159], a[88:91], a[32:35], v[156:159]
    s_add_u32 m0, s57, 108544
    v_mfma_f32_16x16x32_bf16 v[176:179], a[64:67], a[40:43], v[176:179]
    buffer_load_dwordx4 v2, s[8:11], s50 offen lds
    v_mfma_f32_16x16x32_bf16 v[176:179], a[68:71], a[44:47], v[176:179]
    v_mfma_f32_16x16x32_bf16 v[180:183], a[76:79], a[44:47], v[180:183]
    v_mfma_f32_16x16x32_bf16 v[180:183], a[72:75], a[40:43], v[180:183]
    v_mfma_f32_16x16x32_bf16 v[184:187], a[80:83], a[40:43], v[184:187]
    s_add_u32 m0, s55, 45056
    v_mfma_f32_16x16x32_bf16 v[184:187], a[84:87], a[44:47], v[184:187]
    buffer_load_dwordx4 v1, s[4:7], s43 offen lds
    v_mfma_f32_16x16x32_bf16 v[188:191], a[92:95], a[44:47], v[188:191]
    v_mfma_f32_16x16x32_bf16 v[188:191], a[88:91], a[40:43], v[188:191]
    v_mfma_f32_16x16x32_bf16 v[208:211], a[64:67], a[48:51], v[208:211]
    v_mfma_f32_16x16x32_bf16 v[208:211], a[68:71], a[52:55], v[208:211]
    s_add_u32 m0, s57, 114688
    v_mfma_f32_16x16x32_bf16 v[212:215], a[76:79], a[52:55], v[212:215]
    buffer_load_dwordx4 v2, s[8:11], s51 offen lds
    v_mfma_f32_16x16x32_bf16 v[212:215], a[72:75], a[48:51], v[212:215]
    v_mfma_f32_16x16x32_bf16 v[216:219], a[80:83], a[48:51], v[216:219]
    v_mfma_f32_16x16x32_bf16 v[216:219], a[84:87], a[52:55], v[216:219]
    v_mfma_f32_16x16x32_bf16 v[220:223], a[92:95], a[52:55], v[220:223]
    s_add_u32 m0, s55, 49152
    v_mfma_f32_16x16x32_bf16 v[220:223], a[88:91], a[48:51], v[220:223]
    buffer_load_dwordx4 v1, s[4:7], s44 offen lds
    v_mfma_f32_16x16x32_bf16 v[240:243], a[64:67], a[56:59], v[240:243]
    v_mfma_f32_16x16x32_bf16 v[240:243], a[68:71], a[60:63], v[240:243]
    v_mfma_f32_16x16x32_bf16 v[244:247], a[76:79], a[60:63], v[244:247]
    v_mfma_f32_16x16x32_bf16 v[244:247], a[72:75], a[56:59], v[244:247]
    s_add_u32 m0, s57, 116736
    v_mfma_f32_16x16x32_bf16 v[248:251], a[80:83], a[56:59], v[248:251]
    s_waitcnt vmcnt(10)
    buffer_load_dwordx4 v2, s[8:11], s52 offen lds
    v_mfma_f32_16x16x32_bf16 v[248:251], a[84:87], a[60:63], v[248:251]
    s_barrier
    ds_read_b64_tr_b16 a[0:1], v6 offset:0
    v_mfma_f32_16x16x32_bf16 v[252:255], a[92:95], a[60:63], v[252:255]
    ds_read_b64_tr_b16 a[2:3], v6 offset:2048
    v_mfma_f32_16x16x32_bf16 v[252:255], a[88:91], a[56:59], v[252:255]
    ds_read_b128 a[64:67], v4 offset:0
    v_mfma_f32_16x16x32_bf16 v[160:163], a[96:99], a[32:35], v[160:163]
    s_add_u32 m0, s55, 53248
    v_mfma_f32_16x16x32_bf16 v[160:163], a[100:103], a[36:39], v[160:163]
    buffer_load_dwordx4 v1, s[4:7], s45 offen lds
    v_mfma_f32_16x16x32_bf16 v[164:167], a[108:111], a[36:39], v[164:167]
    ds_read_b64_tr_b16 a[4:5], v6 offset:16384
    v_mfma_f32_16x16x32_bf16 v[164:167], a[104:107], a[32:35], v[164:167]
    ds_read_b64_tr_b16 a[6:7], v6 offset:18432
    v_mfma_f32_16x16x32_bf16 v[168:171], a[112:115], a[32:35], v[168:171]
    ds_read_b128 a[68:71], v5 offset:0
    v_mfma_f32_16x16x32_bf16 v[168:171], a[116:119], a[36:39], v[168:171]
    s_add_u32 m0, s57, 122880
    v_mfma_f32_16x16x32_bf16 v[172:175], a[124:127], a[36:39], v[172:175]
    buffer_load_dwordx4 v2, s[8:11], s53 offen lds
    v_mfma_f32_16x16x32_bf16 v[172:175], a[120:123], a[32:35], v[172:175]
    ds_read_b128 a[76:79], v5 offset:2048
    v_mfma_f32_16x16x32_bf16 v[192:195], a[96:99], a[40:43], v[192:195]
    v_mfma_f32_16x16x32_bf16 v[192:195], a[100:103], a[44:47], v[192:195]
    ds_read_b128 a[72:75], v4 offset:2048
    v_mfma_f32_16x16x32_bf16 v[196:199], a[108:111], a[44:47], v[196:199]
    s_add_u32 m0, s55, 57344
    v_mfma_f32_16x16x32_bf16 v[196:199], a[104:107], a[40:43], v[196:199]
    buffer_load_dwordx4 v1, s[4:7], s46 offen lds
    v_mfma_f32_16x16x32_bf16 v[200:203], a[112:115], a[40:43], v[200:203]
    ds_read_b128 a[80:83], v4 offset:4096
    v_mfma_f32_16x16x32_bf16 v[200:203], a[116:119], a[44:47], v[200:203]
    v_mfma_f32_16x16x32_bf16 v[204:207], a[124:127], a[44:47], v[204:207]
    ds_read_b128 a[84:87], v5 offset:4096
    v_mfma_f32_16x16x32_bf16 v[204:207], a[120:123], a[40:43], v[204:207]
    s_add_u32 m0, s57, 124928
    v_mfma_f32_16x16x32_bf16 v[224:227], a[96:99], a[48:51], v[224:227]
    buffer_load_dwordx4 v2, s[8:11], s54 offen lds
    v_mfma_f32_16x16x32_bf16 v[224:227], a[100:103], a[52:55], v[224:227]
    ds_read_b128 a[92:95], v5 offset:6144
    v_mfma_f32_16x16x32_bf16 v[228:231], a[108:111], a[52:55], v[228:231]
    v_mfma_f32_16x16x32_bf16 v[228:231], a[104:107], a[48:51], v[228:231]
    ds_read_b128 a[88:91], v4 offset:6144
    v_mfma_f32_16x16x32_bf16 v[232:235], a[112:115], a[48:51], v[232:235]
    s_add_u32 m0, s55, 61440
    v_mfma_f32_16x16x32_bf16 v[232:235], a[116:119], a[52:55], v[232:235]
    buffer_load_dwordx4 v1, s[4:7], s47 offen lds
    v_mfma_f32_16x16x32_bf16 v[236:239], a[124:127], a[52:55], v[236:239]
    v_add_u32 v1, 128, v1
    v_add_u32 v2, 0x80000, v2
    v_mfma_f32_16x16x32_bf16 v[236:239], a[120:123], a[48:51], v[236:239]
    ds_read_b64_tr_b16 a[8:9], v7 offset:0
    v_mfma_f32_16x16x32_bf16 a[128:131], a[96:99], a[56:59], a[128:131]
    ds_read_b64_tr_b16 a[10:11], v7 offset:2048
    v_mfma_f32_16x16x32_bf16 a[128:131], a[100:103], a[60:63], a[128:131]
    ds_read_b64_tr_b16 a[12:13], v7 offset:16384
    v_mfma_f32_16x16x32_bf16 a[132:135], a[108:111], a[60:63], a[132:135]
    ds_read_b64_tr_b16 a[14:15], v7 offset:18432
    v_mfma_f32_16x16x32_bf16 a[132:135], a[104:107], a[56:59], a[132:135]
    ds_read_b64_tr_b16 a[16:17], v8 offset:0
    v_mfma_f32_16x16x32_bf16 a[136:139], a[112:115], a[56:59], a[136:139]
    ds_read_b64_tr_b16 a[18:19], v8 offset:2048
    v_mfma_f32_16x16x32_bf16 a[136:139], a[116:119], a[60:63], a[136:139]
    ds_read_b64_tr_b16 a[20:21], v8 offset:16384
    v_mfma_f32_16x16x32_bf16 a[140:143], a[124:127], a[60:63], a[140:143]
    s_add_u32 s61, s61, 1
    ds_read_b64_tr_b16 a[22:23], v8 offset:18432
    v_mfma_f32_16x16x32_bf16 a[140:143], a[120:123], a[56:59], a[140:143]
    s_waitcnt lgkmcnt(8)
    ds_read_b64_tr_b16 a[24:25], v9 offset:0
    s_cmp_lt_u32 s61, 8
    s_cbranch_scc1 k1_kernel_vloop
    s_lshr_b32 s62, s34, 4
    s_add_u32 s62, s62, s37
    s_and_b32 s63, s34, 15
    s_lshl_b32 s60, s63, 7
    s_mov_b32 s41, 28672
    s_mov_b32 s42, 57344
    s_mov_b32 s43, 86016
    s_waitcnt vmcnt(0) lgkmcnt(0)
    s_lshl_b32 s58, s3, 3
    s_add_u32 s58, s58, s60
    v_lshrrev_b32 v14, 3, v0
    v_add_u32 v14, s58, v14
    v_mul_u32_u24 v14, 896, v14
    s_lshl_b32 s58, s39, 2
    v_lshrrev_b32 v15, 4, v0
    v_add_u32 v15, s58, v15
    v_xor_b32 v15, v0, v15
    v_and_b32 v15, 7, v15
    v_lshl_add_u32 v1, v15, 4, v14
    v_lshrrev_b32 v14, 5, v0
    s_lshl_b32 s58, s39, 1
    s_lshl_b32 s59, s40, 2
    s_add_u32 s58, s58, s59
    v_add_u32 v15, s58, v14
    v_lshlrev_b32 v15, 1, v15
    v_xor_b32 v15, v0, v15
    v_and_b32 v15, 31, v15
    v_lshlrev_b32 v15, 4, v15
    v_add_u32 v14, s56, v14
    v_lshl_add_u32 v14, v14, 13, v15
    s_lshl_b32 s58, s62, 9
    v_add_u32 v2, s58, v14
    s_mov_b32 s4, s20
    s_mov_b32 s5, s21
    s_mov_b32 s6, 1835008
    s_mov_b32 s7, 0x20000
    s_mov_b32 s8, s24
    s_mov_b32 s9, s25
    s_mov_b32 s10, 3670016
    s_mov_b32 s11, 0x20000
    s_barrier
    s_add_u32 m0, s57, 98304
    s_nop 0
    buffer_load_dwordx4 v2, s[8:11], 0 offen lds
    s_add_u32 m0, s57, 100352
    s_nop 0
    buffer_load_dwordx4 v2, s[8:11], s48 offen lds
    s_add_u32 m0, s55, 32768
    s_nop 0
    buffer_load_dwordx4 v1, s[4:7], 0 offen lds
    s_add_u32 m0, s57, 106496
    s_nop 0
    buffer_load_dwordx4 v2, s[8:11], s49 offen lds
    s_add_u32 m0, s57, 108544
    s_nop 0
    buffer_load_dwordx4 v2, s[8:11], s50 offen lds
    s_add_u32 m0, s55, 36864
    s_nop 0
    buffer_load_dwordx4 v1, s[4:7], s41 offen lds
    s_add_u32 m0, s57, 114688
    s_nop 0
    buffer_load_dwordx4 v2, s[8:11], s51 offen lds
    s_add_u32 m0, s57, 116736
    s_nop 0
    buffer_load_dwordx4 v2, s[8:11], s52 offen lds
    s_add_u32 m0, s55, 40960
    s_nop 0
    buffer_load_dwordx4 v1, s[4:7], s42 offen lds
    s_add_u32 m0, s57, 122880
    s_nop 0
    buffer_load_dwordx4 v2, s[8:11], s53 offen lds
    s_add_u32 m0, s57, 124928
    s_nop 0
    buffer_load_dwordx4 v2, s[8:11], s54 offen lds
    s_add_u32 m0, s55, 45056
    s_nop 0
    buffer_load_dwordx4 v1, s[4:7], s43 offen lds
    v_add_u32 v1, 128, v1
    v_add_u32 v2, 0x80000, v2
    s_add_u32 m0, s57, 65536
    s_nop 0
    buffer_load_dwordx4 v2, s[8:11], 0 offen lds
    s_add_u32 m0, s57, 67584
    s_nop 0
    buffer_load_dwordx4 v2, s[8:11], s48 offen lds
    s_add_u32 m0, s55, 0
    s_nop 0
    buffer_load_dwordx4 v1, s[4:7], 0 offen lds
    s_add_u32 m0, s57, 73728
    s_nop 0
    buffer_load_dwordx4 v2, s[8:11], s49 offen lds
    s_add_u32 m0, s57, 75776
    s_nop 0
    buffer_load_dwordx4 v2, s[8:11], s50 offen lds
    s_add_u32 m0, s55, 4096
    s_nop 0
    buffer_load_dwordx4 v1, s[4:7], s41 offen lds
    s_add_u32 m0, s57, 81920
    s_nop 0
    buffer_load_dwordx4 v2, s[8:11], s51 offen lds
    s_add_u32 m0, s57, 83968
    s_nop 0
    buffer_load_dwordx4 v2, s[8:11], s52 offen lds
    s_add_u32 m0, s55, 8192
    s_nop 0
    buffer_load_dwordx4 v1, s[4:7], s42 offen lds
    s_add_u32 m0, s57, 90112
    s_nop 0
    buffer_load_dwordx4 v2, s[8:11], s53 offen lds
    s_add_u32 m0, s57, 92160
    s_nop 0
    buffer_load_dwordx4 v2, s[8:11], s54 offen lds
    s_add_u32 m0, s55, 12288
    s_nop 0
    buffer_load_dwordx4 v1, s[4:7], s43 offen lds
    v_add_u32 v1, 128, v1
    v_add_u32 v2, 0x80000, v2
    s_lshl_b32 s58, s36, 20
    s_lshl_b32 s59, s35, 17
    s_add_u32 s58, s58, s59
    s_lshl_b32 s59, s39, 16
    s_add_u32 s58, s58, s59
    s_lshl_b32 s59, s40, 13
    s_add_u32 s58, s58, s59
    s_add_u32 s58, s58, 16777216
    v_cvt_pk_bf16_f32 v16, v16, v17
    v_cvt_pk_bf16_f32 v17, v18, v19
    v_cvt_pk_bf16_f32 v18, v20, v21
    v_cvt_pk_bf16_f32 v19, v22, v23
    buffer_store_dwordx4 v[16:19], v3, s[12:15], s58 offen offset:0
    v_cvt_pk_bf16_f32 v48, v48, v49
    v_cvt_pk_bf16_f32 v49, v50, v51
    v_cvt_pk_bf16_f32 v50, v52, v53
    v_cvt_pk_bf16_f32 v51, v54, v55
    buffer_store_dwordx4 v[48:51], v3, s[12:15], s58 offen offset:1024
    v_cvt_pk_bf16_f32 v80, v80, v81
    v_cvt_pk_bf16_f32 v81, v82, v83
    v_cvt_pk_bf16_f32 v82, v84, v85
    v_cvt_pk_bf16_f32 v83, v86, v87
    buffer_store_dwordx4 v[80:83], v3, s[12:15], s58 offen offset:2048
    v_cvt_pk_bf16_f32 v112, v112, v113
    v_cvt_pk_bf16_f32 v113, v114, v115
    v_cvt_pk_bf16_f32 v114, v116, v117
    v_cvt_pk_bf16_f32 v115, v118, v119
    buffer_store_dwordx4 v[112:115], v3, s[12:15], s58 offen offset:3072
    s_add_u32 s58, s58, 4096
    v_cvt_pk_bf16_f32 v144, v144, v145
    v_cvt_pk_bf16_f32 v145, v146, v147
    v_cvt_pk_bf16_f32 v146, v148, v149
    v_cvt_pk_bf16_f32 v147, v150, v151
    buffer_store_dwordx4 v[144:147], v3, s[12:15], s58 offen offset:0
    v_cvt_pk_bf16_f32 v176, v176, v177
    v_cvt_pk_bf16_f32 v177, v178, v179
    v_cvt_pk_bf16_f32 v178, v180, v181
    v_cvt_pk_bf16_f32 v179, v182, v183
    buffer_store_dwordx4 v[176:179], v3, s[12:15], s58 offen offset:1024
    v_cvt_pk_bf16_f32 v208, v208, v209
    v_cvt_pk_bf16_f32 v209, v210, v211
    v_cvt_pk_bf16_f32 v210, v212, v213
    v_cvt_pk_bf16_f32 v211, v214, v215
    buffer_store_dwordx4 v[208:211], v3, s[12:15], s58 offen offset:2048
    v_cvt_pk_bf16_f32 v240, v240, v241
    v_cvt_pk_bf16_f32 v241, v242, v243
    v_cvt_pk_bf16_f32 v242, v244, v245
    v_cvt_pk_bf16_f32 v243, v246, v247
    buffer_store_dwordx4 v[240:243], v3, s[12:15], s58 offen offset:3072
    s_add_u32 s58, s58, 12288
    v_cvt_pk_bf16_f32 v24, v24, v25
    v_cvt_pk_bf16_f32 v25, v26, v27
    v_cvt_pk_bf16_f32 v26, v28, v29
    v_cvt_pk_bf16_f32 v27, v30, v31
    buffer_store_dwordx4 v[24:27], v3, s[12:15], s58 offen offset:0
    v_cvt_pk_bf16_f32 v56, v56, v57
    v_cvt_pk_bf16_f32 v57, v58, v59
    v_cvt_pk_bf16_f32 v58, v60, v61
    v_cvt_pk_bf16_f32 v59, v62, v63
    buffer_store_dwordx4 v[56:59], v3, s[12:15], s58 offen offset:1024
    v_cvt_pk_bf16_f32 v88, v88, v89
    v_cvt_pk_bf16_f32 v89, v90, v91
    v_cvt_pk_bf16_f32 v90, v92, v93
    v_cvt_pk_bf16_f32 v91, v94, v95
    buffer_store_dwordx4 v[88:91], v3, s[12:15], s58 offen offset:2048
    v_cvt_pk_bf16_f32 v120, v120, v121
    v_cvt_pk_bf16_f32 v121, v122, v123
    v_cvt_pk_bf16_f32 v122, v124, v125
    v_cvt_pk_bf16_f32 v123, v126, v127
    buffer_store_dwordx4 v[120:123], v3, s[12:15], s58 offen offset:3072
    s_add_u32 s58, s58, 4096
    v_cvt_pk_bf16_f32 v152, v152, v153
    v_cvt_pk_bf16_f32 v153, v154, v155
    v_cvt_pk_bf16_f32 v154, v156, v157
    v_cvt_pk_bf16_f32 v155, v158, v159
    buffer_store_dwordx4 v[152:155], v3, s[12:15], s58 offen offset:0
    v_cvt_pk_bf16_f32 v184, v184, v185
    v_cvt_pk_bf16_f32 v185, v186, v187
    v_cvt_pk_bf16_f32 v186, v188, v189
    v_cvt_pk_bf16_f32 v187, v190, v191
    buffer_store_dwordx4 v[184:187], v3, s[12:15], s58 offen offset:1024
    v_cvt_pk_bf16_f32 v216, v216, v217
    v_cvt_pk_bf16_f32 v217, v218, v219
    v_cvt_pk_bf16_f32 v218, v220, v221
    v_cvt_pk_bf16_f32 v219, v222, v223
    buffer_store_dwordx4 v[216:219], v3, s[12:15], s58 offen offset:2048
    v_cvt_pk_bf16_f32 v248, v248, v249
    v_cvt_pk_bf16_f32 v249, v250, v251
    v_cvt_pk_bf16_f32 v250, v252, v253
    v_cvt_pk_bf16_f32 v251, v254, v255
    buffer_store_dwordx4 v[248:251], v3, s[12:15], s58 offen offset:3072
    s_add_u32 s58, s58, 12288
    v_cvt_pk_bf16_f32 v32, v32, v33
    v_cvt_pk_bf16_f32 v33, v34, v35
    v_cvt_pk_bf16_f32 v34, v36, v37
    v_cvt_pk_bf16_f32 v35, v38, v39
    buffer_store_dwordx4 v[32:35], v3, s[12:15], s58 offen offset:0
    v_cvt_pk_bf16_f32 v64, v64, v65
    v_cvt_pk_bf16_f32 v65, v66, v67
    v_cvt_pk_bf16_f32 v66, v68, v69
    v_cvt_pk_bf16_f32 v67, v70, v71
    buffer_store_dwordx4 v[64:67], v3, s[12:15], s58 offen offset:1024
    v_cvt_pk_bf16_f32 v96, v96, v97
    v_cvt_pk_bf16_f32 v97, v98, v99
    v_cvt_pk_bf16_f32 v98, v100, v101
    v_cvt_pk_bf16_f32 v99, v102, v103
    buffer_store_dwordx4 v[96:99], v3, s[12:15], s58 offen offset:2048
    v_cvt_pk_bf16_f32 v128, v128, v129
    v_cvt_pk_bf16_f32 v129, v130, v131
    v_cvt_pk_bf16_f32 v130, v132, v133
    v_cvt_pk_bf16_f32 v131, v134, v135
    buffer_store_dwordx4 v[128:131], v3, s[12:15], s58 offen offset:3072
    s_add_u32 s58, s58, 4096
    v_cvt_pk_bf16_f32 v160, v160, v161
    v_cvt_pk_bf16_f32 v161, v162, v163
    v_cvt_pk_bf16_f32 v162, v164, v165
    v_cvt_pk_bf16_f32 v163, v166, v167
    buffer_store_dwordx4 v[160:163], v3, s[12:15], s58 offen offset:0
    v_cvt_pk_bf16_f32 v192, v192, v193
    v_cvt_pk_bf16_f32 v193, v194, v195
    v_cvt_pk_bf16_f32 v194, v196, v197
    v_cvt_pk_bf16_f32 v195, v198, v199
    buffer_store_dwordx4 v[192:195], v3, s[12:15], s58 offen offset:1024
    v_cvt_pk_bf16_f32 v224, v224, v225
    v_cvt_pk_bf16_f32 v225, v226, v227
    v_cvt_pk_bf16_f32 v226, v228, v229
    v_cvt_pk_bf16_f32 v227, v230, v231
    buffer_store_dwordx4 v[224:227], v3, s[12:15], s58 offen offset:2048
    v_accvgpr_read_b32 v16, a128
    v_accvgpr_read_b32 v17, a129
    v_accvgpr_read_b32 v18, a130
    v_accvgpr_read_b32 v19, a131
    v_accvgpr_read_b32 v20, a132
    v_accvgpr_read_b32 v21, a133
    v_accvgpr_read_b32 v22, a134
    v_accvgpr_read_b32 v23, a135
    v_cvt_pk_bf16_f32 v16, v16, v17
    v_cvt_pk_bf16_f32 v17, v18, v19
    v_cvt_pk_bf16_f32 v18, v20, v21
    v_cvt_pk_bf16_f32 v19, v22, v23
    buffer_store_dwordx4 v[16:19], v3, s[12:15], s58 offen offset:3072
    s_add_u32 s58, s58, 12288
    v_cvt_pk_bf16_f32 v40, v40, v41
    v_cvt_pk_bf16_f32 v41, v42, v43
    v_cvt_pk_bf16_f32 v42, v44, v45
    v_cvt_pk_bf16_f32 v43, v46, v47
    buffer_store_dwordx4 v[40:43], v3, s[12:15], s58 offen offset:0
    v_cvt_pk_bf16_f32 v72, v72, v73
    v_cvt_pk_bf16_f32 v73, v74, v75
    v_cvt_pk_bf16_f32 v74, v76, v77
    v_cvt_pk_bf16_f32 v75, v78, v79
    buffer_store_dwordx4 v[72:75], v3, s[12:15], s58 offen offset:1024
    v_cvt_pk_bf16_f32 v104, v104, v105
    v_cvt_pk_bf16_f32 v105, v106, v107
    v_cvt_pk_bf16_f32 v106, v108, v109
    v_cvt_pk_bf16_f32 v107, v110, v111
    buffer_store_dwordx4 v[104:107], v3, s[12:15], s58 offen offset:2048
    v_cvt_pk_bf16_f32 v136, v136, v137
    v_cvt_pk_bf16_f32 v137, v138, v139
    v_cvt_pk_bf16_f32 v138, v140, v141
    v_cvt_pk_bf16_f32 v139, v142, v143
    buffer_store_dwordx4 v[136:139], v3, s[12:15], s58 offen offset:3072
    s_add_u32 s58, s58, 4096
    v_cvt_pk_bf16_f32 v168, v168, v169
    v_cvt_pk_bf16_f32 v169, v170, v171
    v_cvt_pk_bf16_f32 v170, v172, v173
    v_cvt_pk_bf16_f32 v171, v174, v175
    buffer_store_dwordx4 v[168:171], v3, s[12:15], s58 offen offset:0
    v_cvt_pk_bf16_f32 v200, v200, v201
    v_cvt_pk_bf16_f32 v201, v202, v203
    v_cvt_pk_bf16_f32 v202, v204, v205
    v_cvt_pk_bf16_f32 v203, v206, v207
    buffer_store_dwordx4 v[200:203], v3, s[12:15], s58 offen offset:1024
    v_cvt_pk_bf16_f32 v232, v232, v233
    v_cvt_pk_bf16_f32 v233, v234, v235
    v_cvt_pk_bf16_f32 v234, v236, v237
    v_cvt_pk_bf16_f32 v235, v238, v239
    buffer_store_dwordx4 v[232:235], v3, s[12:15], s58 offen offset:2048
    v_accvgpr_read_b32 v16, a136
    v_accvgpr_read_b32 v17, a137
    v_accvgpr_read_b32 v18, a138
    v_accvgpr_read_b32 v19, a139
    v_accvgpr_read_b32 v20, a140
    v_accvgpr_read_b32 v21, a141
    v_accvgpr_read_b32 v22, a142
    v_accvgpr_read_b32 v23, a143
    v_cvt_pk_bf16_f32 v16, v16, v17
    v_cvt_pk_bf16_f32 v17, v18, v19
    v_cvt_pk_bf16_f32 v18, v20, v21
    v_cvt_pk_bf16_f32 v19, v22, v23
    buffer_store_dwordx4 v[16:19], v3, s[12:15], s58 offen offset:3072
    s_add_u32 s58, s58, 12288
k1_kernel_q:
    s_lshl_b32 s59, s3, 2
    v_and_b32 v14, 15, v0
    v_lshrrev_b32 v15, 4, v0
    v_lshrrev_b32 v5, 1, v14
    v_xor_b32 v5, v5, v15
    v_add_u32 v14, 0, v14
    v_lshlrev_b32 v14, 7, v14
    v_lshl_add_u32 v4, v5, 4, v14
    v_xor_b32 v5, 64, v4
    v_bfe_u32 v14, v0, 2, 2
    v_lshl_add_u32 v13, v15, 3, v14
    v_lshlrev_b32 v13, 9, v13
    v_and_b32 v15, 1, v15
    v_lshl_or_b32 v14, v15, 2, v14
    v_xor_b32 v14, s59, v14
    v_lshl_add_u32 v13, v14, 5, v13
    v_and_b32 v14, 3, v0
    v_lshl_add_u32 v13, v14, 3, v13
    v_add_u32 v6, 0x10000, v13
    v_xor_b32 v7, 32, v6
    v_xor_b32 v8, 64, v6
    v_xor_b32 v9, 96, v6
    s_nop 1
    v_mov_b32 v128, 0
    v_mov_b32 v129, 0
    v_mov_b32 v130, 0
    v_mov_b32 v131, 0
    v_mov_b32 v132, 0
    v_mov_b32 v133, 0
    v_mov_b32 v134, 0
    v_mov_b32 v135, 0
    v_mov_b32 v136, 0
    v_mov_b32 v137, 0
    v_mov_b32 v138, 0
    v_mov_b32 v139, 0
    v_mov_b32 v140, 0
    v_mov_b32 v141, 0
    v_mov_b32 v142, 0
    v_mov_b32 v143, 0
    v_mov_b32 v144, 0
    v_mov_b32 v145, 0
    v_mov_b32 v146, 0
    v_mov_b32 v147, 0
    v_mov_b32 v148, 0
    v_mov_b32 v149, 0
    v_mov_b32 v150, 0
    v_mov_b32 v151, 0
    v_mov_b32 v152, 0
    v_mov_b32 v153, 0
    v_mov_b32 v154, 0
    v_mov_b32 v155, 0
    v_mov_b32 v156, 0
    v_mov_b32 v157, 0
    v_mov_b32 v158, 0
    v_mov_b32 v159, 0
    v_mov_b32 v160, 0
    v_mov_b32 v161, 0
    v_mov_b32 v162, 0
    v_mov_b32 v163, 0
    v_mov_b32 v164, 0
    v_mov_b32 v165, 0
    v_mov_b32 v166, 0
    v_mov_b32 v167, 0
    v_mov_b32 v168, 0
    v_mov_b32 v169, 0
    v_mov_b32 v170, 0
    v_mov_b32 v171, 0
    v_mov_b32 v172, 0
    v_mov_b32 v173, 0
    v_mov_b32 v174, 0
    v_mov_b32 v175, 0
    v_mov_b32 v176, 0
    v_mov_b32 v177, 0
    v_mov_b32 v178, 0
    v_mov_b32 v179, 0
    v_mov_b32 v180, 0
    v_mov_b32 v181, 0
    v_mov_b32 v182, 0
    v_mov_b32 v183, 0
    v_mov_b32 v184, 0
    v_mov_b32 v185, 0
    v_mov_b32 v186, 0
    v_mov_b32 v187, 0
    v_mov_b32 v188, 0
    v_mov_b32 v189, 0
    v_mov_b32 v190, 0
    v_mov_b32 v191, 0
    v_mov_b32 v192, 0
    v_mov_b32 v193, 0
    v_mov_b32 v194, 0
    v_mov_b32 v195, 0
    v_mov_b32 v196, 0
    v_mov_b32 v197, 0
    v_mov_b32 v198, 0
    v_mov_b32 v199, 0
    v_mov_b32 v200, 0
    v_mov_b32 v201, 0
    v_mov_b32 v202, 0
    v_mov_b32 v203, 0
    v_mov_b32 v204, 0
    v_mov_b32 v205, 0
    v_mov_b32 v206, 0
    v_mov_b32 v207, 0
    v_mov_b32 v208, 0
    v_mov_b32 v209, 0
    v_mov_b32 v210, 0
    v_mov_b32 v211, 0
    v_mov_b32 v212, 0
    v_mov_b32 v213, 0
    v_mov_b32 v214, 0
    v_mov_b32 v215, 0
    v_mov_b32 v216, 0
    v_mov_b32 v217, 0
    v_mov_b32 v218, 0
    v_mov_b32 v219, 0
    v_mov_b32 v220, 0
    v_mov_b32 v221, 0
    v_mov_b32 v222, 0
    v_mov_b32 v223, 0
    v_mov_b32 v224, 0
    v_mov_b32 v225, 0
    v_mov_b32 v226, 0
    v_mov_b32 v227, 0
    v_mov_b32 v228, 0
    v_mov_b32 v229, 0
    v_mov_b32 v230, 0
    v_mov_b32 v231, 0
    v_mov_b32 v232, 0
    v_mov_b32 v233, 0
    v_mov_b32 v234, 0
    v_mov_b32 v235, 0
    v_mov_b32 v236, 0
    v_mov_b32 v237, 0
    v_mov_b32 v238, 0
    v_mov_b32 v239, 0
    v_mov_b32 v240, 0
    v_mov_b32 v241, 0
    v_mov_b32 v242, 0
    v_mov_b32 v243, 0
    v_mov_b32 v244, 0
    v_mov_b32 v245, 0
    v_mov_b32 v246, 0
    v_mov_b32 v247, 0
    v_mov_b32 v248, 0
    v_mov_b32 v249, 0
    v_mov_b32 v250, 0
    v_mov_b32 v251, 0
    v_mov_b32 v252, 0
    v_mov_b32 v253, 0
    v_mov_b32 v254, 0
    v_mov_b32 v255, 0
    s_mov_b32 s61, 0
    s_waitcnt vmcnt(44)
    s_barrier
    ds_read_b64_tr_b16 a[32:33], v6 offset:32768
    ds_read_b64_tr_b16 a[34:35], v6 offset:34816
    ds_read_b128 a[160:163], v4 offset:40960
    ds_read_b64_tr_b16 a[36:37], v6 offset:49152
    ds_read_b64_tr_b16 a[38:39], v6 offset:51200
    ds_read_b128 a[164:167], v5 offset:40960
    ds_read_b128 a[172:175], v5 offset:43008
    ds_read_b128 a[168:171], v4 offset:43008
    ds_read_b128 a[176:179], v4 offset:45056
    ds_read_b128 a[180:183], v5 offset:45056
    ds_read_b128 a[188:191], v5 offset:47104
    ds_read_b128 a[184:187], v4 offset:47104
    ds_read_b64_tr_b16 a[40:41], v7 offset:32768
    ds_read_b64_tr_b16 a[42:43], v7 offset:34816
    ds_read_b64_tr_b16 a[44:45], v7 offset:49152
    ds_read_b64_tr_b16 a[46:47], v7 offset:51200
    ds_read_b128 a[128:131], v4 offset:32768
    ds_read_b128 a[132:135], v5 offset:32768
    ds_read_b128 a[140:143], v5 offset:34816
    ds_read_b128 a[136:139], v4 offset:34816
    s_waitcnt lgkmcnt(0)
    s_branch k1_kernel_qentry
.p2align 6
k1_kernel_qloop:
    v_mfma_f32_16x16x32_bf16 v[128:131], a[0:3], a[64:67], v[128:131]
    v_mfma_f32_16x16x32_bf16 v[128:131], a[4:7], a[68:71], v[128:131]
    s_cmp_eq_u32 s61, 3
    s_cmov_b32 s6, 0
    ds_read_b128 a[112:115], v4 offset:12288
    v_mfma_f32_16x16x32_bf16 v[132:135], a[4:7], a[76:79], v[132:135]
    v_mfma_f32_16x16x32_bf16 v[132:135], a[0:3], a[72:75], v[132:135]
    ds_read_b128 a[116:119], v5 offset:12288
    v_mfma_f32_16x16x32_bf16 v[136:139], a[0:3], a[80:83], v[136:139]
    v_mfma_f32_16x16x32_bf16 v[136:139], a[4:7], a[84:87], v[136:139]
    ds_read_b128 a[124:127], v5 offset:14336
    v_mfma_f32_16x16x32_bf16 v[140:143], a[4:7], a[92:95], v[140:143]
    s_waitcnt lgkmcnt(8)
    v_mfma_f32_16x16x32_bf16 v[140:143], a[0:3], a[88:91], v[140:143]
    ds_read_b128 a[120:123], v4 offset:14336
    v_mfma_f32_16x16x32_bf16 v[160:163], a[8:11], a[64:67], v[160:163]
    s_waitcnt lgkmcnt(8)
    v_mfma_f32_16x16x32_bf16 v[160:163], a[12:15], a[68:71], v[160:163]
    ds_read_b64_tr_b16 a[16:17], v8 offset:0
    v_mfma_f32_16x16x32_bf16 v[164:167], a[12:15], a[76:79], v[164:167]
    ds_read_b64_tr_b16 a[18:19], v8 offset:2048
    v_mfma_f32_16x16x32_bf16 v[164:167], a[8:11], a[72:75], v[164:167]
    ds_read_b64_tr_b16 a[20:21], v8 offset:16384
    v_mfma_f32_16x16x32_bf16 v[168:171], a[8:11], a[80:83], v[168:171]
    ds_read_b64_tr_b16 a[22:23], v8 offset:18432
    v_mfma_f32_16x16x32_bf16 v[168:171], a[12:15], a[84:87], v[168:171]
    ds_read_b64_tr_b16 a[24:25], v9 offset:0
    v_mfma_f32_16x16x32_bf16 v[172:175], a[12:15], a[92:95], v[172:175]
    ds_read_b64_tr_b16 a[26:27], v9 offset:2048
    v_mfma_f32_16x16x32_bf16 v[172:175], a[8:11], a[88:91], v[172:175]
    s_waitcnt lgkmcnt(8)
    ds_read_b64_tr_b16 a[28:29], v9 offset:16384
    v_mfma_f32_16x16x32_bf16 v[144:147], a[0:3], a[96:99], v[144:147]
    ds_read_b64_tr_b16 a[30:31], v9 offset:18432
    v_mfma_f32_16x16x32_bf16 v[144:147], a[4:7], a[100:103], v[144:147]
    v_mfma_f32_16x16x32_bf16 v[148:151], a[4:7], a[108:111], v[148:151]
    v_mfma_f32_16x16x32_bf16 v[148:151], a[0:3], a[104:107], v[148:151]
    s_waitcnt vmcnt(0) lgkmcnt(0)
    v_mfma_f32_16x16x32_bf16 v[152:155], a[0:3], a[112:115], v[152:155]
    s_barrier
    ds_read_b64_tr_b16 a[32:33], v6 offset:32768
    v_mfma_f32_16x16x32_bf16 v[152:155], a[4:7], a[116:119], v[152:155]
    s_add_u32 m0, s57, 65536
    ds_read_b64_tr_b16 a[34:35], v6 offset:34816
    v_mfma_f32_16x16x32_bf16 v[156:159], a[4:7], a[124:127], v[156:159]
    buffer_load_dwordx4 v2, s[8:11], 0 offen lds
    v_mfma_f32_16x16x32_bf16 v[156:159], a[0:3], a[120:123], v[156:159]
    ds_read_b128 a[160:163], v4 offset:40960
    v_mfma_f32_16x16x32_bf16 v[176:179], a[8:11], a[96:99], v[176:179]
    s_add_u32 m0, s57, 67584
    v_mfma_f32_16x16x32_bf16 v[176:179], a[12:15], a[100:103], v[176:179]
    buffer_load_dwordx4 v2, s[8:11], s48 offen lds
    v_mfma_f32_16x16x32_bf16 v[180:183], a[12:15], a[108:111], v[180:183]
    ds_read_b64_tr_b16 a[36:37], v6 offset:49152
    v_mfma_f32_16x16x32_bf16 v[180:183], a[8:11], a[104:107], v[180:183]
    s_add_u32 m0, s55, 0
    ds_read_b64_tr_b16 a[38:39], v6 offset:51200
    v_mfma_f32_16x16x32_bf16 v[184:187], a[8:11], a[112:115], v[184:187]
    buffer_load_dwordx4 v1, s[4:7], 0 offen lds
    v_mfma_f32_16x16x32_bf16 v[184:187], a[12:15], a[116:119], v[184:187]
    ds_read_b128 a[164:167], v5 offset:40960
    v_mfma_f32_16x16x32_bf16 v[188:191], a[12:15], a[124:127], v[188:191]
    s_add_u32 m0, s57, 73728
    v_mfma_f32_16x16x32_bf16 v[188:191], a[8:11], a[120:123], v[188:191]
    buffer_load_dwordx4 v2, s[8:11], s49 offen lds
    v_mfma_f32_16x16x32_bf16 v[208:211], a[16:19], a[96:99], v[208:211]
    ds_read_b128 a[172:175], v5 offset:43008
    v_mfma_f32_16x16x32_bf16 v[208:211], a[20:23], a[100:103], v[208:211]
    s_add_u32 m0, s57, 75776
    v_mfma_f32_16x16x32_bf16 v[212:215], a[20:23], a[108:111], v[212:215]
    buffer_load_dwordx4 v2, s[8:11], s50 offen lds
    v_mfma_f32_16x16x32_bf16 v[212:215], a[16:19], a[104:107], v[212:215]
    ds_read_b128 a[168:171], v4 offset:43008
    v_mfma_f32_16x16x32_bf16 v[216:219], a[16:19], a[112:115], v[216:219]
    s_add_u32 m0, s55, 4096
    v_mfma_f32_16x16x32_bf16 v[216:219], a[20:23], a[116:119], v[216:219]
    buffer_load_dwordx4 v1, s[4:7], s41 offen lds
    v_mfma_f32_16x16x32_bf16 v[220:223], a[20:23], a[124:127], v[220:223]
    ds_read_b128 a[176:179], v4 offset:45056
    v_mfma_f32_16x16x32_bf16 v[220:223], a[16:19], a[120:123], v[220:223]
    s_add_u32 m0, s57, 81920
    v_mfma_f32_16x16x32_bf16 v[240:243], a[24:27], a[96:99], v[240:243]
    buffer_load_dwordx4 v2, s[8:11], s51 offen lds
    v_mfma_f32_16x16x32_bf16 v[240:243], a[28:31], a[100:103], v[240:243]
    ds_read_b128 a[180:183], v5 offset:45056
    v_mfma_f32_16x16x32_bf16 v[244:247], a[28:31], a[108:111], v[244:247]
    s_add_u32 m0, s57, 83968
    v_mfma_f32_16x16x32_bf16 v[244:247], a[24:27], a[104:107], v[244:247]
    buffer_load_dwordx4 v2, s[8:11], s52 offen lds
    v_mfma_f32_16x16x32_bf16 v[248:251], a[24:27], a[112:115], v[248:251]
    ds_read_b128 a[188:191], v5 offset:47104
    v_mfma_f32_16x16x32_bf16 v[248:251], a[28:31], a[116:119], v[248:251]
    s_add_u32 m0, s55, 8192
    v_mfma_f32_16x16x32_bf16 v[252:255], a[28:31], a[124:127], v[252:255]
    buffer_load_dwordx4 v1, s[4:7], s42 offen lds
    v_mfma_f32_16x16x32_bf16 v[252:255], a[24:27], a[120:123], v[252:255]
    ds_read_b128 a[184:187], v4 offset:47104
    v_mfma_f32_16x16x32_bf16 v[192:195], a[16:19], a[64:67], v[192:195]
    s_add_u32 m0, s57, 90112
    v_mfma_f32_16x16x32_bf16 v[192:195], a[20:23], a[68:71], v[192:195]
    buffer_load_dwordx4 v2, s[8:11], s53 offen lds
    v_mfma_f32_16x16x32_bf16 v[196:199], a[20:23], a[76:79], v[196:199]
    ds_read_b64_tr_b16 a[40:41], v7 offset:32768
    v_mfma_f32_16x16x32_bf16 v[196:199], a[16:19], a[72:75], v[196:199]
    s_add_u32 m0, s57, 92160
    ds_read_b64_tr_b16 a[42:43], v7 offset:34816
    v_mfma_f32_16x16x32_bf16 v[200:203], a[16:19], a[80:83], v[200:203]
    buffer_load_dwordx4 v2, s[8:11], s54 offen lds
    v_mfma_f32_16x16x32_bf16 v[200:203], a[20:23], a[84:87], v[200:203]
    ds_read_b64_tr_b16 a[44:45], v7 offset:49152
    v_mfma_f32_16x16x32_bf16 v[204:207], a[20:23], a[92:95], v[204:207]
    s_add_u32 m0, s55, 12288
    ds_read_b64_tr_b16 a[46:47], v7 offset:51200
    v_mfma_f32_16x16x32_bf16 v[204:207], a[16:19], a[88:91], v[204:207]
    buffer_load_dwordx4 v1, s[4:7], s43 offen lds
    v_mfma_f32_16x16x32_bf16 v[224:227], a[24:27], a[64:67], v[224:227]
    v_add_u32 v1, 128, v1
    v_add_u32 v2, 0x80000, v2
    v_mfma_f32_16x16x32_bf16 v[224:227], a[28:31], a[68:71], v[224:227]
    ds_read_b128 a[128:131], v4 offset:32768
    v_mfma_f32_16x16x32_bf16 v[228:231], a[28:31], a[76:79], v[228:231]
    v_mfma_f32_16x16x32_bf16 v[228:231], a[24:27], a[72:75], v[228:231]
    ds_read_b128 a[132:135], v5 offset:32768
    v_mfma_f32_16x16x32_bf16 v[232:235], a[24:27], a[80:83], v[232:235]
    v_mfma_f32_16x16x32_bf16 v[232:235], a[28:31], a[84:87], v[232:235]
    ds_read_b128 a[140:143], v5 offset:34816
    v_mfma_f32_16x16x32_bf16 v[236:239], a[28:31], a[92:95], v[236:239]
    v_mfma_f32_16x16x32_bf16 v[236:239], a[24:27], a[88:91], v[236:239]
    s_waitcnt lgkmcnt(8)
    ds_read_b128 a[136:139], v4 offset:34816
k1_kernel_qentry:
    v_mfma_f32_16x16x32_bf16 v[144:147], a[32:35], a[160:163], v[144:147]
    v_mfma_f32_16x16x32_bf16 v[144:147], a[36:39], a[164:167], v[144:147]
    ds_read_b128 a[144:147], v4 offset:36864
    v_mfma_f32_16x16x32_bf16 v[148:151], a[36:39], a[172:175], v[148:151]
    v_mfma_f32_16x16x32_bf16 v[148:151], a[32:35], a[168:171], v[148:151]
    ds_read_b128 a[148:151], v5 offset:36864
    v_mfma_f32_16x16x32_bf16 v[152:155], a[32:35], a[176:179], v[152:155]
    v_mfma_f32_16x16x32_bf16 v[152:155], a[36:39], a[180:183], v[152:155]
    ds_read_b128 a[156:159], v5 offset:38912
    v_mfma_f32_16x16x32_bf16 v[156:159], a[36:39], a[188:191], v[156:159]
    s_waitcnt lgkmcnt(8)
    v_mfma_f32_16x16x32_bf16 v[156:159], a[32:35], a[184:187], v[156:159]
    ds_read_b128 a[152:155], v4 offset:38912
    v_mfma_f32_16x16x32_bf16 v[176:179], a[40:43], a[160:163], v[176:179]
    s_waitcnt lgkmcnt(8)
    v_mfma_f32_16x16x32_bf16 v[176:179], a[44:47], a[164:167], v[176:179]
    ds_read_b64_tr_b16 a[48:49], v8 offset:32768
    v_mfma_f32_16x16x32_bf16 v[180:183], a[44:47], a[172:175], v[180:183]
    ds_read_b64_tr_b16 a[50:51], v8 offset:34816
    v_mfma_f32_16x16x32_bf16 v[180:183], a[40:43], a[168:171], v[180:183]
    ds_read_b64_tr_b16 a[52:53], v8 offset:49152
    v_mfma_f32_16x16x32_bf16 v[184:187], a[40:43], a[176:179], v[184:187]
    ds_read_b64_tr_b16 a[54:55], v8 offset:51200
    v_mfma_f32_16x16x32_bf16 v[184:187], a[44:47], a[180:183], v[184:187]
    ds_read_b64_tr_b16 a[56:57], v9 offset:32768
    v_mfma_f32_16x16x32_bf16 v[188:191], a[44:47], a[188:191], v[188:191]
    ds_read_b64_tr_b16 a[58:59], v9 offset:34816
    v_mfma_f32_16x16x32_bf16 v[188:191], a[40:43], a[184:187], v[188:191]
    s_waitcnt lgkmcnt(8)
    ds_read_b64_tr_b16 a[60:61], v9 offset:49152
    v_mfma_f32_16x16x32_bf16 v[128:131], a[32:35], a[128:131], v[128:131]
    ds_read_b64_tr_b16 a[62:63], v9 offset:51200
    v_mfma_f32_16x16x32_bf16 v[128:131], a[36:39], a[132:135], v[128:131]
    v_mfma_f32_16x16x32_bf16 v[132:135], a[36:39], a[140:143], v[132:135]
    v_mfma_f32_16x16x32_bf16 v[132:135], a[32:35], a[136:139], v[132:135]
    s_waitcnt vmcnt(0) lgkmcnt(0)
    v_mfma_f32_16x16x32_bf16 v[136:139], a[32:35], a[144:147], v[136:139]
    s_barrier
    ds_read_b64_tr_b16 a[0:1], v6 offset:0
    v_mfma_f32_16x16x32_bf16 v[136:139], a[36:39], a[148:151], v[136:139]
    s_add_u32 m0, s57, 98304
    ds_read_b64_tr_b16 a[2:3], v6 offset:2048
    v_mfma_f32_16x16x32_bf16 v[140:143], a[36:39], a[156:159], v[140:143]
    buffer_load_dwordx4 v2, s[8:11], 0 offen lds
    v_mfma_f32_16x16x32_bf16 v[140:143], a[32:35], a[152:155], v[140:143]
    ds_read_b128 a[64:67], v4 offset:0
    v_mfma_f32_16x16x32_bf16 v[160:163], a[40:43], a[128:131], v[160:163]
    s_add_u32 m0, s57, 100352
    v_mfma_f32_16x16x32_bf16 v[160:163], a[44:47], a[132:135], v[160:163]
    buffer_load_dwordx4 v2, s[8:11], s48 offen lds
    v_mfma_f32_16x16x32_bf16 v[164:167], a[44:47], a[140:143], v[164:167]
    ds_read_b64_tr_b16 a[4:5], v6 offset:16384
    v_mfma_f32_16x16x32_bf16 v[164:167], a[40:43], a[136:139], v[164:167]
    s_add_u32 m0, s55, 32768
    ds_read_b64_tr_b16 a[6:7], v6 offset:18432
    v_mfma_f32_16x16x32_bf16 v[168:171], a[40:43], a[144:147], v[168:171]
    buffer_load_dwordx4 v1, s[4:7], 0 offen lds
    v_mfma_f32_16x16x32_bf16 v[168:171], a[44:47], a[148:151], v[168:171]
    ds_read_b128 a[68:71], v5 offset:0
    v_mfma_f32_16x16x32_bf16 v[172:175], a[44:47], a[156:159], v[172:175]
    s_add_u32 m0, s57, 106496
    v_mfma_f32_16x16x32_bf16 v[172:175], a[40:43], a[152:155], v[172:175]
    buffer_load_dwordx4 v2, s[8:11], s49 offen lds
    v_mfma_f32_16x16x32_bf16 v[192:195], a[48:51], a[128:131], v[192:195]
    ds_read_b128 a[76:79], v5 offset:2048
    v_mfma_f32_16x16x32_bf16 v[192:195], a[52:55], a[132:135], v[192:195]
    s_add_u32 m0, s57, 108544
    v_mfma_f32_16x16x32_bf16 v[196:199], a[52:55], a[140:143], v[196:199]
    buffer_load_dwordx4 v2, s[8:11], s50 offen lds
    v_mfma_f32_16x16x32_bf16 v[196:199], a[48:51], a[136:139], v[196:199]
    ds_read_b128 a[72:75], v4 offset:2048
    v_mfma_f32_16x16x32_bf16 v[200:203], a[48:51], a[144:147], v[200:203]
    s_add_u32 m0, s55, 36864
    v_mfma_f32_16x16x32_bf16 v[200:203], a[52:55], a[148:151], v[200:203]
    buffer_load_dwordx4 v1, s[4:7], s41 offen lds
    v_mfma_f32_16x16x32_bf16 v[204:207], a[52:55], a[156:159], v[204:207]
    ds_read_b128 a[80:83], v4 offset:4096
    v_mfma_f32_16x16x32_bf16 v[204:207], a[48:51], a[152:155], v[204:207]
    s_add_u32 m0, s57, 114688
    v_mfma_f32_16x16x32_bf16 v[224:227], a[56:59], a[128:131], v[224:227]
    buffer_load_dwordx4 v2, s[8:11], s51 offen lds
    v_mfma_f32_16x16x32_bf16 v[224:227], a[60:63], a[132:135], v[224:227]
    ds_read_b128 a[84:87], v5 offset:4096
    v_mfma_f32_16x16x32_bf16 v[228:231], a[60:63], a[140:143], v[228:231]
    s_add_u32 m0, s57, 116736
    v_mfma_f32_16x16x32_bf16 v[228:231], a[56:59], a[136:139], v[228:231]
    buffer_load_dwordx4 v2, s[8:11], s52 offen lds
    v_mfma_f32_16x16x32_bf16 v[232:235], a[56:59], a[144:147], v[232:235]
    ds_read_b128 a[92:95], v5 offset:6144
    v_mfma_f32_16x16x32_bf16 v[232:235], a[60:63], a[148:151], v[232:235]
    s_add_u32 m0, s55, 40960
    v_mfma_f32_16x16x32_bf16 v[236:239], a[60:63], a[156:159], v[236:239]
    buffer_load_dwordx4 v1, s[4:7], s42 offen lds
    v_mfma_f32_16x16x32_bf16 v[236:239], a[56:59], a[152:155], v[236:239]
    ds_read_b128 a[88:91], v4 offset:6144
    v_mfma_f32_16x16x32_bf16 v[208:211], a[48:51], a[160:163], v[208:211]
    s_add_u32 m0, s57, 122880
    v_mfma_f32_16x16x32_bf16 v[208:211], a[52:55], a[164:167], v[208:211]
    buffer_load_dwordx4 v2, s[8:11], s53 offen lds
    v_mfma_f32_16x16x32_bf16 v[212:215], a[52:55], a[172:175], v[212:215]
    ds_read_b64_tr_b16 a[8:9], v7 offset:0
    v_mfma_f32_16x16x32_bf16 v[212:215], a[48:51], a[168:171], v[212:215]
    s_add_u32 m0, s57, 124928
    ds_read_b64_tr_b16 a[10:11], v7 offset:2048
    v_mfma_f32_16x16x32_bf16 v[216:219], a[48:51], a[176:179], v[216:219]
    buffer_load_dwordx4 v2, s[8:11], s54 offen lds
    v_mfma_f32_16x16x32_bf16 v[216:219], a[52:55], a[180:183], v[216:219]
    ds_read_b64_tr_b16 a[12:13], v7 offset:16384
    v_mfma_f32_16x16x32_bf16 v[220:223], a[52:55], a[188:191], v[220:223]
    s_add_u32 m0, s55, 45056
    ds_read_b64_tr_b16 a[14:15], v7 offset:18432
    v_mfma_f32_16x16x32_bf16 v[220:223], a[48:51], a[184:187], v[220:223]
    buffer_load_dwordx4 v1, s[4:7], s43 offen lds
    v_mfma_f32_16x16x32_bf16 v[240:243], a[56:59], a[160:163], v[240:243]
    v_add_u32 v1, 128, v1
    v_add_u32 v2, 0x80000, v2
    v_mfma_f32_16x16x32_bf16 v[240:243], a[60:63], a[164:167], v[240:243]
    ds_read_b128 a[96:99], v4 offset:8192
    v_mfma_f32_16x16x32_bf16 v[244:247], a[60:63], a[172:175], v[244:247]
    v_mfma_f32_16x16x32_bf16 v[244:247], a[56:59], a[168:171], v[244:247]
    ds_read_b128 a[100:103], v5 offset:8192
    v_mfma_f32_16x16x32_bf16 v[248:251], a[56:59], a[176:179], v[248:251]
    v_mfma_f32_16x16x32_bf16 v[248:251], a[60:63], a[180:183], v[248:251]
    ds_read_b128 a[108:111], v5 offset:10240
    v_mfma_f32_16x16x32_bf16 v[252:255], a[60:63], a[188:191], v[252:255]
    s_add_u32 s61, s61, 1
    v_mfma_f32_16x16x32_bf16 v[252:255], a[56:59], a[184:187], v[252:255]
    s_waitcnt lgkmcnt(8)
    ds_read_b128 a[104:107], v4 offset:10240
    s_cmp_lt_u32 s61, 4
    s_cbranch_scc1 k1_kernel_qloop
    s_mov_b32 s59, 0x3db8aa3b
    s_lshl_b32 s58, s62, 20
    s_lshl_b32 s60, s63, 16
    s_add_u32 s58, s58, s60
    s_lshl_b32 s60, s3, 11
    s_add_u32 s58, s58, s60
    s_add_u32 s58, s58, 33554432
    s_nop 3
    v_mul_f32 v128, s59, v128
    v_mul_f32 v129, s59, v129
    v_mul_f32 v130, s59, v130
    v_mul_f32 v131, s59, v131
    v_mul_f32 v160, s59, v160
    v_mul_f32 v161, s59, v161
    v_mul_f32 v162, s59, v162
    v_mul_f32 v163, s59, v163
    v_cvt_pk_bf16_f32 v128, v128, v129
    v_cvt_pk_bf16_f32 v129, v130, v131
    v_cvt_pk_bf16_f32 v130, v160, v161
    v_cvt_pk_bf16_f32 v131, v162, v163
    buffer_store_dwordx4 v[128:131], v3, s[12:15], s58 offen offset:0
    v_mul_f32 v192, s59, v192
    v_mul_f32 v193, s59, v193
    v_mul_f32 v194, s59, v194
    v_mul_f32 v195, s59, v195
    v_mul_f32 v224, s59, v224
    v_mul_f32 v225, s59, v225
    v_mul_f32 v226, s59, v226
    v_mul_f32 v227, s59, v227
    v_cvt_pk_bf16_f32 v192, v192, v193
    v_cvt_pk_bf16_f32 v193, v194, v195
    v_cvt_pk_bf16_f32 v194, v224, v225
    v_cvt_pk_bf16_f32 v195, v226, v227
    buffer_store_dwordx4 v[192:195], v3, s[12:15], s58 offen offset:1024
    s_add_u32 s58, s58, 8192
    v_mul_f32 v132, s59, v132
    v_mul_f32 v133, s59, v133
    v_mul_f32 v134, s59, v134
    v_mul_f32 v135, s59, v135
    v_mul_f32 v164, s59, v164
    v_mul_f32 v165, s59, v165
    v_mul_f32 v166, s59, v166
    v_mul_f32 v167, s59, v167
    v_cvt_pk_bf16_f32 v132, v132, v133
    v_cvt_pk_bf16_f32 v133, v134, v135
    v_cvt_pk_bf16_f32 v134, v164, v165
    v_cvt_pk_bf16_f32 v135, v166, v167
    buffer_store_dwordx4 v[132:135], v3, s[12:15], s58 offen offset:0
    v_mul_f32 v196, s59, v196
    v_mul_f32 v197, s59, v197
    v_mul_f32 v198, s59, v198
    v_mul_f32 v199, s59, v199
    v_mul_f32 v228, s59, v228
    v_mul_f32 v229, s59, v229
    v_mul_f32 v230, s59, v230
    v_mul_f32 v231, s59, v231
    v_cvt_pk_bf16_f32 v196, v196, v197
    v_cvt_pk_bf16_f32 v197, v198, v199
    v_cvt_pk_bf16_f32 v198, v228, v229
    v_cvt_pk_bf16_f32 v199, v230, v231
    buffer_store_dwordx4 v[196:199], v3, s[12:15], s58 offen offset:1024
    s_add_u32 s58, s58, 8192
    v_mul_f32 v136, s59, v136
    v_mul_f32 v137, s59, v137
    v_mul_f32 v138, s59, v138
    v_mul_f32 v139, s59, v139
    v_mul_f32 v168, s59, v168
    v_mul_f32 v169, s59, v169
    v_mul_f32 v170, s59, v170
    v_mul_f32 v171, s59, v171
    v_cvt_pk_bf16_f32 v136, v136, v137
    v_cvt_pk_bf16_f32 v137, v138, v139
    v_cvt_pk_bf16_f32 v138, v168, v169
    v_cvt_pk_bf16_f32 v139, v170, v171
    buffer_store_dwordx4 v[136:139], v3, s[12:15], s58 offen offset:0
    v_mul_f32 v200, s59, v200
    v_mul_f32 v201, s59, v201
    v_mul_f32 v202, s59, v202
    v_mul_f32 v203, s59, v203
    v_mul_f32 v232, s59, v232
    v_mul_f32 v233, s59, v233
    v_mul_f32 v234, s59, v234
    v_mul_f32 v235, s59, v235
    v_cvt_pk_bf16_f32 v200, v200, v201
    v_cvt_pk_bf16_f32 v201, v202, v203
    v_cvt_pk_bf16_f32 v202, v232, v233
    v_cvt_pk_bf16_f32 v203, v234, v235
    buffer_store_dwordx4 v[200:203], v3, s[12:15], s58 offen offset:1024
    s_add_u32 s58, s58, 8192
    v_mul_f32 v140, s59, v140
    v_mul_f32 v141, s59, v141
    v_mul_f32 v142, s59, v142
    v_mul_f32 v143, s59, v143
    v_mul_f32 v172, s59, v172
    v_mul_f32 v173, s59, v173
    v_mul_f32 v174, s59, v174
    v_mul_f32 v175, s59, v175
    v_cvt_pk_bf16_f32 v140, v140, v141
    v_cvt_pk_bf16_f32 v141, v142, v143
    v_cvt_pk_bf16_f32 v142, v172, v173
    v_cvt_pk_bf16_f32 v143, v174, v175
    buffer_store_dwordx4 v[140:143], v3, s[12:15], s58 offen offset:0
    v_mul_f32 v204, s59, v204
    v_mul_f32 v205, s59, v205
    v_mul_f32 v206, s59, v206
    v_mul_f32 v207, s59, v207
    v_mul_f32 v236, s59, v236
    v_mul_f32 v237, s59, v237
    v_mul_f32 v238, s59, v238
    v_mul_f32 v239, s59, v239
    v_cvt_pk_bf16_f32 v204, v204, v205
    v_cvt_pk_bf16_f32 v205, v206, v207
    v_cvt_pk_bf16_f32 v206, v236, v237
    v_cvt_pk_bf16_f32 v207, v238, v239
    buffer_store_dwordx4 v[204:207], v3, s[12:15], s58 offen offset:1024
    s_add_u32 s58, s58, 8192
    v_mul_f32 v144, s59, v144
    v_mul_f32 v145, s59, v145
    v_mul_f32 v146, s59, v146
    v_mul_f32 v147, s59, v147
    v_mul_f32 v176, s59, v176
    v_mul_f32 v177, s59, v177
    v_mul_f32 v178, s59, v178
    v_mul_f32 v179, s59, v179
    v_cvt_pk_bf16_f32 v144, v144, v145
    v_cvt_pk_bf16_f32 v145, v146, v147
    v_cvt_pk_bf16_f32 v146, v176, v177
    v_cvt_pk_bf16_f32 v147, v178, v179
    buffer_store_dwordx4 v[144:147], v3, s[12:15], s58 offen offset:0
    v_mul_f32 v208, s59, v208
    v_mul_f32 v209, s59, v209
    v_mul_f32 v210, s59, v210
    v_mul_f32 v211, s59, v211
    v_mul_f32 v240, s59, v240
    v_mul_f32 v241, s59, v241
    v_mul_f32 v242, s59, v242
    v_mul_f32 v243, s59, v243
    v_cvt_pk_bf16_f32 v208, v208, v209
    v_cvt_pk_bf16_f32 v209, v210, v211
    v_cvt_pk_bf16_f32 v210, v240, v241
    v_cvt_pk_bf16_f32 v211, v242, v243
    buffer_store_dwordx4 v[208:211], v3, s[12:15], s58 offen offset:1024
    s_add_u32 s58, s58, 8192
    v_mul_f32 v148, s59, v148
    v_mul_f32 v149, s59, v149
    v_mul_f32 v150, s59, v150
    v_mul_f32 v151, s59, v151
    v_mul_f32 v180, s59, v180
    v_mul_f32 v181, s59, v181
    v_mul_f32 v182, s59, v182
    v_mul_f32 v183, s59, v183
    v_cvt_pk_bf16_f32 v148, v148, v149
    v_cvt_pk_bf16_f32 v149, v150, v151
    v_cvt_pk_bf16_f32 v150, v180, v181
    v_cvt_pk_bf16_f32 v151, v182, v183
    buffer_store_dwordx4 v[148:151], v3, s[12:15], s58 offen offset:0
    v_mul_f32 v212, s59, v212
    v_mul_f32 v213, s59, v213
    v_mul_f32 v214, s59, v214
    v_mul_f32 v215, s59, v215
    v_mul_f32 v244, s59, v244
    v_mul_f32 v245, s59, v245
    v_mul_f32 v246, s59, v246
    v_mul_f32 v247, s59, v247
    v_cvt_pk_bf16_f32 v212, v212, v213
    v_cvt_pk_bf16_f32 v213, v214, v215
    v_cvt_pk_bf16_f32 v214, v244, v245
    v_cvt_pk_bf16_f32 v215, v246, v247
    buffer_store_dwordx4 v[212:215], v3, s[12:15], s58 offen offset:1024
    s_add_u32 s58, s58, 8192
    v_mul_f32 v152, s59, v152
    v_mul_f32 v153, s59, v153
    v_mul_f32 v154, s59, v154
    v_mul_f32 v155, s59, v155
    v_mul_f32 v184, s59, v184
    v_mul_f32 v185, s59, v185
    v_mul_f32 v186, s59, v186
    v_mul_f32 v187, s59, v187
    v_cvt_pk_bf16_f32 v152, v152, v153
    v_cvt_pk_bf16_f32 v153, v154, v155
    v_cvt_pk_bf16_f32 v154, v184, v185
    v_cvt_pk_bf16_f32 v155, v186, v187
    buffer_store_dwordx4 v[152:155], v3, s[12:15], s58 offen offset:0
    v_mul_f32 v216, s59, v216
    v_mul_f32 v217, s59, v217
    v_mul_f32 v218, s59, v218
    v_mul_f32 v219, s59, v219
    v_mul_f32 v248, s59, v248
    v_mul_f32 v249, s59, v249
    v_mul_f32 v250, s59, v250
    v_mul_f32 v251, s59, v251
    v_cvt_pk_bf16_f32 v216, v216, v217
    v_cvt_pk_bf16_f32 v217, v218, v219
    v_cvt_pk_bf16_f32 v218, v248, v249
    v_cvt_pk_bf16_f32 v219, v250, v251
    buffer_store_dwordx4 v[216:219], v3, s[12:15], s58 offen offset:1024
    s_add_u32 s58, s58, 8192
    v_mul_f32 v156, s59, v156
    v_mul_f32 v157, s59, v157
    v_mul_f32 v158, s59, v158
    v_mul_f32 v159, s59, v159
    v_mul_f32 v188, s59, v188
    v_mul_f32 v189, s59, v189
    v_mul_f32 v190, s59, v190
    v_mul_f32 v191, s59, v191
    v_cvt_pk_bf16_f32 v156, v156, v157
    v_cvt_pk_bf16_f32 v157, v158, v159
    v_cvt_pk_bf16_f32 v158, v188, v189
    v_cvt_pk_bf16_f32 v159, v190, v191
    buffer_store_dwordx4 v[156:159], v3, s[12:15], s58 offen offset:0
    v_mul_f32 v220, s59, v220
    v_mul_f32 v221, s59, v221
    v_mul_f32 v222, s59, v222
    v_mul_f32 v223, s59, v223
    v_mul_f32 v252, s59, v252
    v_mul_f32 v253, s59, v253
    v_mul_f32 v254, s59, v254
    v_mul_f32 v255, s59, v255
    v_cvt_pk_bf16_f32 v220, v220, v221
    v_cvt_pk_bf16_f32 v221, v222, v223
    v_cvt_pk_bf16_f32 v222, v252, v253
    v_cvt_pk_bf16_f32 v223, v254, v255
    buffer_store_dwordx4 v[220:223], v3, s[12:15], s58 offen offset:1024
    s_add_u32 s58, s58, 8192
    s_cmp_lg_u32 s2, 0
    s_cbranch_scc1 k1_kernel_noflag
    v_mov_b32 v4, 0
    v_mov_b32 v5, 0
    v_mov_b32 v6, 0
    v_mov_b32 v7, 0
    s_add_u32 s58, s55, 84934656
    buffer_store_dwordx4 v[4:7], v3, s[12:15], s58 offen
    s_add_u32 s58, s58, 4096
    buffer_store_dwordx4 v[4:7], v3, s[12:15], s58 offen
    s_add_u32 s58, s58, 4096
    buffer_store_dwordx4 v[4:7], v3, s[12:15], s58 offen
    s_add_u32 s58, s58, 4096
    buffer_store_dwordx4 v[4:7], v3, s[12:15], s58 offen
    s_add_u32 s58, s58, 4096
k1_kernel_noflag:
k1_kernel_end:
    s_endpgm
.globl k2_kernel
.p2align 8
.type k2_kernel,@function
k2_kernel:
    s_cmp_ge_u32 s2, 256
    s_cbranch_scc1 k2_kernel_end
    s_load_dwordx2 s[30:31], s[0:1], 112
    v_lshrrev_b32 v2, 6, v0
    v_and_b32 v0, 63, v0
    v_readfirstlane_b32 s3, v2
    s_and_b32 s33, s2, 7
    s_bfe_u32 s34, s2, 0x30003
    s_bfe_u32 s35, s2, 0x10006
    s_lshl_b32 s33, s33, 1
    s_add_u32 s35, s35, s33
    s_lshr_b32 s36, s2, 7
    s_lshl_b32 s37, s34, 1
    s_sub_u32 s38, 14, s37
    s_and_b32 s39, s2, 127
    s_mov_b32 s47, 0x4b800000
    v_lshlrev_b32 v1, 4, v0
    v_add_u32 v4, 4096, v1
    v_and_b32 v14, 15, v0
    v_lshrrev_b32 v11, 4, v0
    v_lshlrev_b32 v11, 2, v11
    v_sub_u32 v14, v14, v11
    s_lshl_b32 s48, s3, 4
    v_add_u32 v14, s48, v14
    s_lshl_b32 s49, s35, 20
    s_lshl_b32 s50, s3, 13
    s_waitcnt lgkmcnt(0)
    s_mov_b32 s12, s30
    s_mov_b32 s13, s31
    s_mov_b32 s14, 268435456
    s_mov_b32 s15, 0x20000
    s_sub_u32 s51, 15, s34
    s_cmp_eq_u32 s36, 0
    s_cbranch_scc1 k2_kernel_roleB
    s_mov_b32 s52, s38
    s_mov_b32 s53, 18
    s_cmp_eq_u32 s38, 0
    s_cselect_b32 s54, 1, 2
    s_branch k2_kernel_seg
k2_kernel_roleB:
    s_mov_b32 s52, 0
    s_mov_b32 s53, s38
    s_mov_b32 s54, 0
    s_cmp_lg_u32 s38, 0
    s_cbranch_scc1 k2_kernel_seg
k2_kernel_seg2:
    s_mov_b32 s51, s34
    s_mov_b32 s52, 0
    s_add_u32 s53, s37, 2
    s_mov_b32 s54, 1
k2_kernel_seg:
    s_lshl_b32 s55, s52, 15
    s_add_u32 s55, s55, s49
    s_add_u32 s42, s55, s50
    s_add_u32 s43, s42, 16777216
    s_mov_b32 s40, s50
    s_add_u32 s41, s50, 0x10000
    s_lshl_b32 s55, s51, 16
    s_add_u32 s55, s55, s49
    s_add_u32 s55, s55, s50
    s_add_u32 s55, s55, 33554432
    s_add_u32 s56, s55, 0x8000
    s_mov_b32 m0, s40
    s_nop 0
    buffer_load_dwordx4 v1, s[12:15], s42 offen offset:0 lds
    buffer_load_dwordx4 v1, s[12:15], s42 offen offset:1024 lds
    buffer_load_dwordx4 v1, s[12:15], s42 offen offset:2048 lds
    buffer_load_dwordx4 v1, s[12:15], s42 offen offset:3072 lds
    s_bitset1_b32 m0, 12
    s_nop 0
    buffer_load_dwordx4 v4, s[12:15], s42 offen offset:0 lds
    buffer_load_dwordx4 v4, s[12:15], s42 offen offset:1024 lds
    buffer_load_dwordx4 v4, s[12:15], s42 offen offset:2048 lds
    buffer_load_dwordx4 v4, s[12:15], s42 offen offset:3072 lds
    s_add_u32 s42, s42, 0x8000
    s_xor_b32 s40, s40, 0x8000
    buffer_load_dwordx4 a[0:3], v1, s[12:15], s55 offen offset:0
    buffer_load_dwordx4 a[4:7], v1, s[12:15], s55 offen offset:1024
    buffer_load_dwordx4 a[8:11], v1, s[12:15], s55 offen offset:2048
    buffer_load_dwordx4 a[12:15], v1, s[12:15], s55 offen offset:3072
    buffer_load_dwordx4 a[16:19], v4, s[12:15], s55 offen offset:0
    buffer_load_dwordx4 a[20:23], v4, s[12:15], s55 offen offset:1024
    buffer_load_dwordx4 a[24:27], v4, s[12:15], s55 offen offset:2048
    buffer_load_dwordx4 a[28:31], v4, s[12:15], s55 offen offset:3072
    buffer_load_dwordx4 a[32:35], v1, s[12:15], s56 offen offset:0
    buffer_load_dwordx4 a[36:39], v1, s[12:15], s56 offen offset:1024
    buffer_load_dwordx4 a[40:43], v1, s[12:15], s56 offen offset:2048
    buffer_load_dwordx4 a[44:47], v1, s[12:15], s56 offen offset:3072
    buffer_load_dwordx4 a[48:51], v4, s[12:15], s56 offen offset:0
    buffer_load_dwordx4 a[52:55], v4, s[12:15], s56 offen offset:1024
    buffer_load_dwordx4 a[56:59], v4, s[12:15], s56 offen offset:2048
    buffer_load_dwordx4 a[60:63], v4, s[12:15], s56 offen offset:3072
    s_mov_b32 m0, s40
    s_nop 0
    buffer_load_dwordx4 v1, s[12:15], s42 offen offset:0 lds
    buffer_load_dwordx4 v1, s[12:15], s42 offen offset:1024 lds
    buffer_load_dwordx4 v1, s[12:15], s42 offen offset:2048 lds
    buffer_load_dwordx4 v1, s[12:15], s42 offen offset:3072 lds
    s_bitset1_b32 m0, 12
    s_nop 0
    buffer_load_dwordx4 v4, s[12:15], s42 offen offset:0 lds
    buffer_load_dwordx4 v4, s[12:15], s42 offen offset:1024 lds
    buffer_load_dwordx4 v4, s[12:15], s42 offen offset:2048 lds
    buffer_load_dwordx4 v4, s[12:15], s42 offen offset:3072 lds
    s_add_u32 s42, s42, 0x8000
    s_xor_b32 s40, s40, 0x8000
    s_mov_b32 m0, s41
    s_nop 0
    buffer_load_dwordx4 v1, s[12:15], s43 offen offset:0 lds
    buffer_load_dwordx4 v1, s[12:15], s43 offen offset:1024 lds
    buffer_load_dwordx4 v1, s[12:15], s43 offen offset:2048 lds
    buffer_load_dwordx4 v1, s[12:15], s43 offen offset:3072 lds
    s_bitset1_b32 m0, 12
    s_nop 0
    buffer_load_dwordx4 v4, s[12:15], s43 offen offset:0 lds
    buffer_load_dwordx4 v4, s[12:15], s43 offen offset:1024 lds
    buffer_load_dwordx4 v4, s[12:15], s43 offen offset:2048 lds
    buffer_load_dwordx4 v4, s[12:15], s43 offen offset:3072 lds
    s_add_u32 s43, s43, 0x8000
    s_xor_b32 s41, s41, 0x8000
    v_mov_b32 v2, v1
    v_add_u32 v3, 0x10000, v1
    v_mov_b32 v96, 0
    v_mov_b32 v97, 0
    v_mov_b32 v98, 0
    v_mov_b32 v99, 0
    v_mov_b32 v100, 0
    v_mov_b32 v101, 0
    v_mov_b32 v102, 0
    v_mov_b32 v103, 0
    v_mov_b32 v104, 0
    v_mov_b32 v105, 0
    v_mov_b32 v106, 0
    v_mov_b32 v107, 0
    v_mov_b32 v108, 0
    v_mov_b32 v109, 0
    v_mov_b32 v110, 0
    v_mov_b32 v111, 0
    v_mov_b32 v112, 0
    v_mov_b32 v113, 0
    v_mov_b32 v114, 0
    v_mov_b32 v115, 0
    v_mov_b32 v116, 0
    v_mov_b32 v117, 0
    v_mov_b32 v118, 0
    v_mov_b32 v119, 0
    v_mov_b32 v120, 0
    v_mov_b32 v121, 0
    v_mov_b32 v122, 0
    v_mov_b32 v123, 0
    v_mov_b32 v124, 0
    v_mov_b32 v125, 0
    v_mov_b32 v126, 0
    v_mov_b32 v127, 0
    v_mov_b32 v128, 0
    v_mov_b32 v129, 0
    v_mov_b32 v130, 0
    v_mov_b32 v131, 0
    v_mov_b32 v132, 0
    v_mov_b32 v133, 0
    v_mov_b32 v134, 0
    v_mov_b32 v135, 0
    v_mov_b32 v136, 0
    v_mov_b32 v137, 0
    v_mov_b32 v138, 0
    v_mov_b32 v139, 0
    v_mov_b32 v140, 0
    v_mov_b32 v141, 0
    v_mov_b32 v142, 0
    v_mov_b32 v143, 0
    v_mov_b32 v144, 0
    v_mov_b32 v145, 0
    v_mov_b32 v146, 0
    v_mov_b32 v147, 0
    v_mov_b32 v148, 0
    v_mov_b32 v149, 0
    v_mov_b32 v150, 0
    v_mov_b32 v151, 0
    v_mov_b32 v152, 0
    v_mov_b32 v153, 0
    v_mov_b32 v154, 0
    v_mov_b32 v155, 0
    v_mov_b32 v156, 0
    v_mov_b32 v157, 0
    v_mov_b32 v158, 0
    v_mov_b32 v159, 0
    v_mov_b32 v160, 0
    v_mov_b32 v161, 0
    v_mov_b32 v162, 0
    v_mov_b32 v163, 0
    v_mov_b32 v164, 0
    v_mov_b32 v165, 0
    v_mov_b32 v166, 0
    v_mov_b32 v167, 0
    v_mov_b32 v168, 0
    v_mov_b32 v169, 0
    v_mov_b32 v170, 0
    v_mov_b32 v171, 0
    v_mov_b32 v172, 0
    v_mov_b32 v173, 0
    v_mov_b32 v174, 0
    v_mov_b32 v175, 0
    v_mov_b32 v176, 0
    v_mov_b32 v177, 0
    v_mov_b32 v178, 0
    v_mov_b32 v179, 0
    v_mov_b32 v180, 0
    v_mov_b32 v181, 0
    v_mov_b32 v182, 0
    v_mov_b32 v183, 0
    v_mov_b32 v184, 0
    v_mov_b32 v185, 0
    v_mov_b32 v186, 0
    v_mov_b32 v187, 0
    v_mov_b32 v188, 0
    v_mov_b32 v189, 0
    v_mov_b32 v190, 0
    v_mov_b32 v191, 0
    v_mov_b32 v192, 0
    v_mov_b32 v193, 0
    v_mov_b32 v194, 0
    v_mov_b32 v195, 0
    v_mov_b32 v196, 0
    v_mov_b32 v197, 0
    v_mov_b32 v198, 0
    v_mov_b32 v199, 0
    v_mov_b32 v200, 0
    v_mov_b32 v201, 0
    v_mov_b32 v202, 0
    v_mov_b32 v203, 0
    v_mov_b32 v204, 0
    v_mov_b32 v205, 0
    v_mov_b32 v206, 0
    v_mov_b32 v207, 0
    v_mov_b32 v208, 0
    v_mov_b32 v209, 0
    v_mov_b32 v210, 0
    v_mov_b32 v211, 0
    v_mov_b32 v212, 0
    v_mov_b32 v213, 0
    v_mov_b32 v214, 0
    v_mov_b32 v215, 0
    v_mov_b32 v216, 0
    v_mov_b32 v217, 0
    v_mov_b32 v218, 0
    v_mov_b32 v219, 0
    v_mov_b32 v220, 0
    v_mov_b32 v221, 0
    v_mov_b32 v222, 0
    v_mov_b32 v223, 0
    v_mov_b32 v224, 0
    v_mov_b32 v225, 0
    v_mov_b32 v226, 0
    v_mov_b32 v227, 0
    v_mov_b32 v228, 0
    v_mov_b32 v229, 0
    v_mov_b32 v230, 0
    v_mov_b32 v231, 0
    v_mov_b32 v232, 0
    v_mov_b32 v233, 0
    v_mov_b32 v234, 0
    v_mov_b32 v235, 0
    v_mov_b32 v236, 0
    v_mov_b32 v237, 0
    v_mov_b32 v238, 0
    v_mov_b32 v239, 0
    v_mov_b32 v240, 0
    v_mov_b32 v241, 0
    v_mov_b32 v242, 0
    v_mov_b32 v243, 0
    v_mov_b32 v244, 0
    v_mov_b32 v245, 0
    v_mov_b32 v246, 0
    v_mov_b32 v247, 0
    v_mov_b32 v248, 0
    v_mov_b32 v249, 0
    v_mov_b32 v250, 0
    v_mov_b32 v251, 0
    v_mov_b32 v252, 0
    v_mov_b32 v253, 0
    v_mov_b32 v254, 0
    v_mov_b32 v255, 0
    v_mov_b32 v7, 0
    v_mov_b32 v8, 0
    v_mov_b32 v9, 0
    v_mov_b32 v10, 0
    s_mov_b32 s46, 0xff800000
    s_cmp_eq_u32 s54, 0
    s_cselect_b32 s45, 0, 2
    s_sub_u32 s44, s53, 1
    s_cmp_ge_u32 s44, s45
    s_cbranch_scc1 k2_kernel_nomask0
    v_mov_b32 v11, 0xf149f2ca
    v_cmp_gt_i32 s[16:17], 0, v14
    v_cmp_gt_i32 s[18:19], 1, v14
    v_cmp_gt_i32 s[20:21], 2, v14
    v_cmp_gt_i32 s[22:23], 3, v14
    v_cndmask_b32 v96, v9, v11, s[16:17]
    v_cndmask_b32 v97, v9, v11, s[18:19]
    v_cndmask_b32 v98, v9, v11, s[20:21]
    v_cndmask_b32 v99, v9, v11, s[22:23]
    v_cmp_gt_i32 s[16:17], 16, v14
    v_cmp_gt_i32 s[18:19], 17, v14
    v_cmp_gt_i32 s[20:21], 18, v14
    v_cmp_gt_i32 s[22:23], 19, v14
    v_cndmask_b32 v104, v9, v11, s[16:17]
    v_cndmask_b32 v105, v9, v11, s[18:19]
    v_cndmask_b32 v106, v9, v11, s[20:21]
    v_cndmask_b32 v107, v9, v11, s[22:23]
    v_cmp_gt_i32 s[16:17], 32, v14
    v_cmp_gt_i32 s[18:19], 33, v14
    v_cmp_gt_i32 s[20:21], 34, v14
    v_cmp_gt_i32 s[22:23], 35, v14
    v_cndmask_b32 v112, v9, v11, s[16:17]
    v_cndmask_b32 v113, v9, v11, s[18:19]
    v_cndmask_b32 v114, v9, v11, s[20:21]
    v_cndmask_b32 v115, v9, v11, s[22:23]
    v_cmp_gt_i32 s[16:17], 48, v14
    v_cmp_gt_i32 s[18:19], 49, v14
    v_cmp_gt_i32 s[20:21], 50, v14
    v_cmp_gt_i32 s[22:23], 51, v14
    v_cndmask_b32 v120, v9, v11, s[16:17]
    v_cndmask_b32 v121, v9, v11, s[18:19]
    v_cndmask_b32 v122, v9, v11, s[20:21]
    v_cndmask_b32 v123, v9, v11, s[22:23]
k2_kernel_nomask0:
    s_waitcnt vmcnt(16)
    s_barrier
    ds_read_b128 a[64:67], v2 offset:0
    ds_read_b128 a[68:71], v2 offset:1024
    ds_read_b128 a[72:75], v2 offset:2048
    ds_read_b128 a[76:79], v2 offset:3072
    ds_read_b128 a[80:83], v2 offset:4096
    ds_read_b128 a[84:87], v2 offset:5120
    ds_read_b128 a[88:91], v2 offset:6144
    ds_read_b128 a[92:95], v2 offset:7168
    s_waitcnt lgkmcnt(0)
    v_mfma_f32_16x16x32_bf16 v[32:35], a[64:67], a[0:3], v[96:99]
    ds_read_b128 a[96:99], v2 offset:8192
    v_mfma_f32_16x16x32_bf16 v[32:35], a[68:71], a[4:7], v[32:35]
    v_mfma_f32_16x16x32_bf16 v[32:35], a[72:75], a[8:11], v[32:35]
    ds_read_b128 a[100:103], v2 offset:9216
    v_mfma_f32_16x16x32_bf16 v[32:35], a[76:79], a[12:15], v[32:35]
    v_mfma_f32_16x16x32_bf16 v[32:35], a[80:83], a[16:19], v[32:35]
    ds_read_b128 a[104:107], v2 offset:10240
    v_mfma_f32_16x16x32_bf16 v[32:35], a[84:87], a[20:23], v[32:35]
    v_mfma_f32_16x16x32_bf16 v[32:35], a[88:91], a[24:27], v[32:35]
    ds_read_b128 a[108:111], v2 offset:11264
    v_mfma_f32_16x16x32_bf16 v[32:35], a[92:95], a[28:31], v[32:35]
    v_mfma_f32_16x16x32_bf16 v[36:39], a[64:67], a[32:35], v[100:103]
    ds_read_b128 a[112:115], v2 offset:12288
    v_mfma_f32_16x16x32_bf16 v[36:39], a[68:71], a[36:39], v[36:39]
    v_mfma_f32_16x16x32_bf16 v[36:39], a[72:75], a[40:43], v[36:39]
    ds_read_b128 a[116:119], v2 offset:13312
    v_mfma_f32_16x16x32_bf16 v[36:39], a[76:79], a[44:47], v[36:39]
    v_mfma_f32_16x16x32_bf16 v[36:39], a[80:83], a[48:51], v[36:39]
    ds_read_b128 a[120:123], v2 offset:14336
    v_mfma_f32_16x16x32_bf16 v[36:39], a[84:87], a[52:55], v[36:39]
    v_mfma_f32_16x16x32_bf16 v[36:39], a[88:91], a[56:59], v[36:39]
    ds_read_b128 a[124:127], v2 offset:15360
    v_mfma_f32_16x16x32_bf16 v[36:39], a[92:95], a[60:63], v[36:39]
    s_waitcnt lgkmcnt(6)
    v_mfma_f32_16x16x32_bf16 v[40:43], a[96:99], a[0:3], v[104:107]
    ds_read_b128 a[64:67], v2 offset:16384
    v_mfma_f32_16x16x32_bf16 v[40:43], a[100:103], a[4:7], v[40:43]
    s_waitcnt lgkmcnt(5)
    v_mfma_f32_16x16x32_bf16 v[40:43], a[104:107], a[8:11], v[40:43]
    ds_read_b128 a[68:71], v2 offset:17408
    v_mfma_f32_16x16x32_bf16 v[40:43], a[108:111], a[12:15], v[40:43]
    s_waitcnt lgkmcnt(4)
    v_mfma_f32_16x16x32_bf16 v[40:43], a[112:115], a[16:19], v[40:43]
    ds_read_b128 a[72:75], v2 offset:18432
    v_mfma_f32_16x16x32_bf16 v[40:43], a[116:119], a[20:23], v[40:43]
    s_waitcnt lgkmcnt(3)
    v_mfma_f32_16x16x32_bf16 v[40:43], a[120:123], a[24:27], v[40:43]
    ds_read_b128 a[76:79], v2 offset:19456
    v_mfma_f32_16x16x32_bf16 v[40:43], a[124:127], a[28:31], v[40:43]
    v_mfma_f32_16x16x32_bf16 v[44:47], a[96:99], a[32:35], v[108:111]
    ds_read_b128 a[80:83], v2 offset:20480
    v_mfma_f32_16x16x32_bf16 v[44:47], a[100:103], a[36:39], v[44:47]
    v_mfma_f32_16x16x32_bf16 v[44:47], a[104:107], a[40:43], v[44:47]
    ds_read_b128 a[84:87], v2 offset:21504
    v_mfma_f32_16x16x32_bf16 v[44:47], a[108:111], a[44:47], v[44:47]
    v_mfma_f32_16x16x32_bf16 v[44:47], a[112:115], a[48:51], v[44:47]
    ds_read_b128 a[88:91], v2 offset:22528
    v_mfma_f32_16x16x32_bf16 v[44:47], a[116:119], a[52:55], v[44:47]
    v_mfma_f32_16x16x32_bf16 v[44:47], a[120:123], a[56:59], v[44:47]
    ds_read_b128 a[92:95], v2 offset:23552
    v_mfma_f32_16x16x32_bf16 v[44:47], a[124:127], a[60:63], v[44:47]
    s_waitcnt lgkmcnt(6)
    v_mfma_f32_16x16x32_bf16 v[48:51], a[64:67], a[0:3], v[112:115]
    ds_read_b128 a[96:99], v2 offset:24576
    v_mfma_f32_16x16x32_bf16 v[48:51], a[68:71], a[4:7], v[48:51]
    s_waitcnt lgkmcnt(5)
    v_mfma_f32_16x16x32_bf16 v[48:51], a[72:75], a[8:11], v[48:51]
    ds_read_b128 a[100:103], v2 offset:25600
    v_mfma_f32_16x16x32_bf16 v[48:51], a[76:79], a[12:15], v[48:51]
    s_waitcnt lgkmcnt(4)
    v_mfma_f32_16x16x32_bf16 v[48:51], a[80:83], a[16:19], v[48:51]
    ds_read_b128 a[104:107], v2 offset:26624
    v_mfma_f32_16x16x32_bf16 v[48:51], a[84:87], a[20:23], v[48:51]
    s_waitcnt lgkmcnt(3)
    v_mfma_f32_16x16x32_bf16 v[48:51], a[88:91], a[24:27], v[48:51]
    ds_read_b128 a[108:111], v2 offset:27648
    v_mfma_f32_16x16x32_bf16 v[48:51], a[92:95], a[28:31], v[48:51]
    v_mfma_f32_16x16x32_bf16 v[52:55], a[64:67], a[32:35], v[116:119]
    ds_read_b128 a[112:115], v2 offset:28672
    v_mfma_f32_16x16x32_bf16 v[52:55], a[68:71], a[36:39], v[52:55]
    v_mfma_f32_16x16x32_bf16 v[52:55], a[72:75], a[40:43], v[52:55]
    ds_read_b128 a[116:119], v2 offset:29696
    v_mfma_f32_16x16x32_bf16 v[52:55], a[76:79], a[44:47], v[52:55]
    v_mfma_f32_16x16x32_bf16 v[52:55], a[80:83], a[48:51], v[52:55]
    ds_read_b128 a[120:123], v2 offset:30720
    v_mfma_f32_16x16x32_bf16 v[52:55], a[84:87], a[52:55], v[52:55]
    v_mfma_f32_16x16x32_bf16 v[52:55], a[88:91], a[56:59], v[52:55]
    ds_read_b128 a[124:127], v2 offset:31744
    v_mfma_f32_16x16x32_bf16 v[52:55], a[92:95], a[60:63], v[52:55]
    s_waitcnt lgkmcnt(6)
    v_mfma_f32_16x16x32_bf16 v[56:59], a[96:99], a[0:3], v[120:123]
    v_mfma_f32_16x16x32_bf16 v[56:59], a[100:103], a[4:7], v[56:59]
    s_waitcnt lgkmcnt(4)
    v_mfma_f32_16x16x32_bf16 v[56:59], a[104:107], a[8:11], v[56:59]
    v_mfma_f32_16x16x32_bf16 v[56:59], a[108:111], a[12:15], v[56:59]
    s_waitcnt lgkmcnt(2)
    v_mfma_f32_16x16x32_bf16 v[56:59], a[112:115], a[16:19], v[56:59]
    v_mfma_f32_16x16x32_bf16 v[56:59], a[116:119], a[20:23], v[56:59]
    s_waitcnt lgkmcnt(0)
    v_mfma_f32_16x16x32_bf16 v[56:59], a[120:123], a[24:27], v[56:59]
    v_mfma_f32_16x16x32_bf16 v[56:59], a[124:127], a[28:31], v[56:59]
    v_mfma_f32_16x16x32_bf16 v[60:63], a[96:99], a[32:35], v[124:127]
    v_mfma_f32_16x16x32_bf16 v[60:63], a[100:103], a[36:39], v[60:63]
    v_mfma_f32_16x16x32_bf16 v[60:63], a[104:107], a[40:43], v[60:63]
    v_mfma_f32_16x16x32_bf16 v[60:63], a[108:111], a[44:47], v[60:63]
    v_mfma_f32_16x16x32_bf16 v[60:63], a[112:115], a[48:51], v[60:63]
    v_mfma_f32_16x16x32_bf16 v[60:63], a[116:119], a[52:55], v[60:63]
    v_mfma_f32_16x16x32_bf16 v[60:63], a[120:123], a[56:59], v[60:63]
    v_mfma_f32_16x16x32_bf16 v[60:63], a[124:127], a[60:63], v[60:63]
    v_xor_b32 v2, 0x8000, v2
    s_waitcnt vmcnt(8)
    s_barrier
    ds_read_b128 a[64:67], v2 offset:0
    ds_read_b128 a[68:71], v2 offset:1024
    ds_read_b128 a[72:75], v2 offset:2048
    ds_read_b128 a[76:79], v2 offset:3072
    ds_read_b128 a[80:83], v2 offset:4096
    ds_read_b128 a[84:87], v2 offset:5120
    ds_read_b128 a[88:91], v2 offset:6144
    ds_read_b128 a[92:95], v2 offset:7168
k2_kernel_slow:
    s_nop 7
    v_max3_f32 v11, v32, v33, v34
    v_max3_f32 v11, v11, v35, v40
    v_max3_f32 v11, v11, v41, v42
    v_max3_f32 v11, v11, v43, v48
    v_max3_f32 v11, v11, v49, v50
    v_max3_f32 v11, v11, v51, v56
    v_max3_f32 v11, v11, v57, v58
    v_max_f32 v11, v11, v59
    v_mov_b32 v13, v11
    s_nop 1
    v_permlane32_swap_b32 v11, v13
    s_nop 1
    v_max_f32 v11, v11, v13
    v_mov_b32 v13, v11
    s_nop 1
    v_permlane16_swap_b32 v11, v13
    s_nop 1
    v_max_f32 v11, v11, v13
    v_max_f32 v11, s46, v11
    v_sub_f32 v9, v9, v11
    v_sub_f32 v32, v32, v11
    v_sub_f32 v33, v33, v11
    v_sub_f32 v34, v34, v11
    v_sub_f32 v35, v35, v11
    v_sub_f32 v40, v40, v11
    v_sub_f32 v41, v41, v11
    v_sub_f32 v42, v42, v11
    v_sub_f32 v43, v43, v11
    v_sub_f32 v48, v48, v11
    v_sub_f32 v49, v49, v11
    v_sub_f32 v50, v50, v11
    v_sub_f32 v51, v51, v11
    v_sub_f32 v56, v56, v11
    v_sub_f32 v57, v57, v11
    v_sub_f32 v58, v58, v11
    v_sub_f32 v59, v59, v11
    v_exp_f32 v64, v32
    v_mov_b32 v96, v9
    v_exp_f32 v65, v33
    v_mov_b32 v97, v9
    v_exp_f32 v66, v34
    v_mov_b32 v98, v9
    v_exp_f32 v67, v35
    v_mov_b32 v99, v9
    v_exp_f32 v72, v40
    v_mov_b32 v104, v9
    v_exp_f32 v73, v41
    v_mov_b32 v105, v9
    v_exp_f32 v74, v42
    v_mov_b32 v106, v9
    v_exp_f32 v75, v43
    v_mov_b32 v107, v9
    v_exp_f32 v80, v48
    v_mov_b32 v112, v9
    v_exp_f32 v81, v49
    v_mov_b32 v113, v9
    v_exp_f32 v82, v50
    v_mov_b32 v114, v9
    v_exp_f32 v83, v51
    v_mov_b32 v115, v9
    v_exp_f32 v88, v56
    v_mov_b32 v120, v9
    v_exp_f32 v89, v57
    v_mov_b32 v121, v9
    v_exp_f32 v90, v58
    v_mov_b32 v122, v9
    v_exp_f32 v91, v59
    v_mov_b32 v123, v9
    v_add_f32 v5, v64, v65
    v_add_f32 v5, v5, v66
    v_add_f32 v5, v5, v67
    v_add_f32 v5, v5, v72
    v_add_f32 v5, v5, v73
    v_add_f32 v5, v5, v74
    v_add_f32 v5, v5, v75
    v_add_f32 v5, v5, v80
    v_add_f32 v5, v5, v81
    v_add_f32 v5, v5, v82
    v_add_f32 v5, v5, v83
    v_add_f32 v5, v5, v88
    v_add_f32 v5, v5, v89
    v_add_f32 v5, v5, v90
    v_add_f32 v5, v5, v91
    v_max3_f32 v12, v36, v37, v38
    v_max3_f32 v12, v12, v39, v44
    v_max3_f32 v12, v12, v45, v46
    v_max3_f32 v12, v12, v47, v52
    v_max3_f32 v12, v12, v53, v54
    v_max3_f32 v12, v12, v55, v60
    v_max3_f32 v12, v12, v61, v62
    v_max_f32 v12, v12, v63
    v_mov_b32 v13, v12
    s_nop 1
    v_permlane32_swap_b32 v12, v13
    s_nop 1
    v_max_f32 v12, v12, v13
    v_mov_b32 v13, v12
    s_nop 1
    v_permlane16_swap_b32 v12, v13
    s_nop 1
    v_max_f32 v12, v12, v13
    v_max_f32 v12, s46, v12
    v_sub_f32 v10, v10, v12
    v_sub_f32 v36, v36, v12
    v_sub_f32 v37, v37, v12
    v_sub_f32 v38, v38, v12
    v_sub_f32 v39, v39, v12
    v_sub_f32 v44, v44, v12
    v_sub_f32 v45, v45, v12
    v_sub_f32 v46, v46, v12
    v_sub_f32 v47, v47, v12
    v_sub_f32 v52, v52, v12
    v_sub_f32 v53, v53, v12
    v_sub_f32 v54, v54, v12
    v_sub_f32 v55, v55, v12
    v_sub_f32 v60, v60, v12
    v_sub_f32 v61, v61, v12
    v_sub_f32 v62, v62, v12
    v_sub_f32 v63, v63, v12
    v_exp_f32 v68, v36
    v_mov_b32 v100, v10
    v_exp_f32 v69, v37
    v_mov_b32 v101, v10
    v_exp_f32 v70, v38
    v_mov_b32 v102, v10
    v_exp_f32 v71, v39
    v_mov_b32 v103, v10
    v_exp_f32 v76, v44
    v_mov_b32 v108, v10
    v_exp_f32 v77, v45
    v_mov_b32 v109, v10
    v_exp_f32 v78, v46
    v_mov_b32 v110, v10
    v_exp_f32 v79, v47
    v_mov_b32 v111, v10
    v_exp_f32 v84, v52
    v_mov_b32 v116, v10
    v_exp_f32 v85, v53
    v_mov_b32 v117, v10
    v_exp_f32 v86, v54
    v_mov_b32 v118, v10
    v_exp_f32 v87, v55
    v_mov_b32 v119, v10
    v_exp_f32 v92, v60
    v_mov_b32 v124, v10
    v_exp_f32 v93, v61
    v_mov_b32 v125, v10
    v_exp_f32 v94, v62
    v_mov_b32 v126, v10
    v_exp_f32 v95, v63
    v_mov_b32 v127, v10
    v_add_f32 v6, v68, v69
    v_add_f32 v6, v6, v70
    v_add_f32 v6, v6, v71
    v_add_f32 v6, v6, v76
    v_add_f32 v6, v6, v77
    v_add_f32 v6, v6, v78
    v_add_f32 v6, v6, v79
    v_add_f32 v6, v6, v84
    v_add_f32 v6, v6, v85
    v_add_f32 v6, v6, v86
    v_add_f32 v6, v6, v87
    v_add_f32 v6, v6, v92
    v_add_f32 v6, v6, v93
    v_add_f32 v6, v6, v94
    v_add_f32 v6, v6, v95
    s_waitcnt lgkmcnt(0)
    s_cmp_lg_u32 s46, 0
    s_mov_b32 s46, 0
    s_cbranch_scc1 k2_kernel_ret
    v_exp_f32 v11, -v11
    s_nop 0
    v_mul_f32 v7, v7, v11
    v_mul_f32 v128, v128, v11
    v_mul_f32 v129, v129, v11
    v_mul_f32 v130, v130, v11
    v_mul_f32 v131, v131, v11
    v_mul_f32 v132, v132, v11
    v_mul_f32 v133, v133, v11
    v_mul_f32 v134, v134, v11
    v_mul_f32 v135, v135, v11
    v_mul_f32 v136, v136, v11
    v_mul_f32 v137, v137, v11
    v_mul_f32 v138, v138, v11
    v_mul_f32 v139, v139, v11
    v_mul_f32 v140, v140, v11
    v_mul_f32 v141, v141, v11
    v_mul_f32 v142, v142, v11
    v_mul_f32 v143, v143, v11
    v_mul_f32 v144, v144, v11
    v_mul_f32 v145, v145, v11
    v_mul_f32 v146, v146, v11
    v_mul_f32 v147, v147, v11
    v_mul_f32 v148, v148, v11
    v_mul_f32 v149, v149, v11
    v_mul_f32 v150, v150, v11
    v_mul_f32 v151, v151, v11
    v_mul_f32 v152, v152, v11
    v_mul_f32 v153, v153, v11
    v_mul_f32 v154, v154, v11
    v_mul_f32 v155, v155, v11
    v_mul_f32 v156, v156, v11
    v_mul_f32 v157, v157, v11
    v_mul_f32 v158, v158, v11
    v_mul_f32 v159, v159, v11
    v_mul_f32 v160, v160, v11
    v_mul_f32 v161, v161, v11
    v_mul_f32 v162, v162, v11
    v_mul_f32 v163, v163, v11
    v_mul_f32 v164, v164, v11
    v_mul_f32 v165, v165, v11
    v_mul_f32 v166, v166, v11
    v_mul_f32 v167, v167, v11
    v_mul_f32 v168, v168, v11
    v_mul_f32 v169, v169, v11
    v_mul_f32 v170, v170, v11
    v_mul_f32 v171, v171, v11
    v_mul_f32 v172, v172, v11
    v_mul_f32 v173, v173, v11
    v_mul_f32 v174, v174, v11
    v_mul_f32 v175, v175, v11
    v_mul_f32 v176, v176, v11
    v_mul_f32 v177, v177, v11
    v_mul_f32 v178, v178, v11
    v_mul_f32 v179, v179, v11
    v_mul_f32 v180, v180, v11
    v_mul_f32 v181, v181, v11
    v_mul_f32 v182, v182, v11
    v_mul_f32 v183, v183, v11
    v_mul_f32 v184, v184, v11
    v_mul_f32 v185, v185, v11
    v_mul_f32 v186, v186, v11
    v_mul_f32 v187, v187, v11
    v_mul_f32 v188, v188, v11
    v_mul_f32 v189, v189, v11
    v_mul_f32 v190, v190, v11
    v_mul_f32 v191, v191, v11
    v_exp_f32 v12, -v12
    s_nop 0
    v_mul_f32 v8, v8, v12
    v_mul_f32 v192, v192, v12
    v_mul_f32 v193, v193, v12
    v_mul_f32 v194, v194, v12
    v_mul_f32 v195, v195, v12
    v_mul_f32 v196, v196, v12
    v_mul_f32 v197, v197, v12
    v_mul_f32 v198, v198, v12
    v_mul_f32 v199, v199, v12
    v_mul_f32 v200, v200, v12
    v_mul_f32 v201, v201, v12
    v_mul_f32 v202, v202, v12
    v_mul_f32 v203, v203, v12
    v_mul_f32 v204, v204, v12
    v_mul_f32 v205, v205, v12
    v_mul_f32 v206, v206, v12
    v_mul_f32 v207, v207, v12
    v_mul_f32 v208, v208, v12
    v_mul_f32 v209, v209, v12
    v_mul_f32 v210, v210, v12
    v_mul_f32 v211, v211, v12
    v_mul_f32 v212, v212, v12
    v_mul_f32 v213, v213, v12
    v_mul_f32 v214, v214, v12
    v_mul_f32 v215, v215, v12
    v_mul_f32 v216, v216, v12
    v_mul_f32 v217, v217, v12
    v_mul_f32 v218, v218, v12
    v_mul_f32 v219, v219, v12
    v_mul_f32 v220, v220, v12
    v_mul_f32 v221, v221, v12
    v_mul_f32 v222, v222, v12
    v_mul_f32 v223, v223, v12
    v_mul_f32 v224, v224, v12
    v_mul_f32 v225, v225, v12
    v_mul_f32 v226, v226, v12
    v_mul_f32 v227, v227, v12
    v_mul_f32 v228, v228, v12
    v_mul_f32 v229, v229, v12
    v_mul_f32 v230, v230, v12
    v_mul_f32 v231, v231, v12
    v_mul_f32 v232, v232, v12
    v_mul_f32 v233, v233, v12
    v_mul_f32 v234, v234, v12
    v_mul_f32 v235, v235, v12
    v_mul_f32 v236, v236, v12
    v_mul_f32 v237, v237, v12
    v_mul_f32 v238, v238, v12
    v_mul_f32 v239, v239, v12
    v_mul_f32 v240, v240, v12
    v_mul_f32 v241, v241, v12
    v_mul_f32 v242, v242, v12
    v_mul_f32 v243, v243, v12
    v_mul_f32 v244, v244, v12
    v_mul_f32 v245, v245, v12
    v_mul_f32 v246, v246, v12
    v_mul_f32 v247, v247, v12
    v_mul_f32 v248, v248, v12
    v_mul_f32 v249, v249, v12
    v_mul_f32 v250, v250, v12
    v_mul_f32 v251, v251, v12
    v_mul_f32 v252, v252, v12
    v_mul_f32 v253, v253, v12
    v_mul_f32 v254, v254, v12
    v_mul_f32 v255, v255, v12
    s_branch k2_kernel_ret
.p2align 6
k2_kernel_loop:
    v_mfma_f32_16x16x32_bf16 v[32:35], a[64:67], a[0:3], v[96:99]
    s_mov_b32 m0, s40
    ds_read_b128 a[96:99], v2 offset:8192
    v_cvt_pk_bf16_f32 v16, v64, v65
    v_mfma_f32_16x16x32_bf16 v[32:35], a[68:71], a[4:7], v[32:35]
    s_waitcnt lgkmcnt(5)
    buffer_load_dwordx4 v1, s[12:15], s42 offen offset:0 lds
    v_mfma_f32_16x16x32_bf16 v[32:35], a[72:75], a[8:11], v[32:35]
    ds_read_b128 a[100:103], v2 offset:9216
    v_cvt_pk_bf16_f32 v17, v66, v67
    v_mfma_f32_16x16x32_bf16 v[32:35], a[76:79], a[12:15], v[32:35]
    s_waitcnt lgkmcnt(4)
    v_cvt_pk_bf16_f32 v20, v68, v69
    v_cvt_pk_bf16_f32 v21, v70, v71
    v_mfma_f32_16x16x32_bf16 v[32:35], a[80:83], a[16:19], v[32:35]
    ds_read_b128 a[104:107], v2 offset:10240
    v_add_f32 v7, v7, v5
    v_mfma_f32_16x16x32_bf16 v[32:35], a[84:87], a[20:23], v[32:35]
    s_waitcnt lgkmcnt(3)
    v_add_f32 v8, v8, v6
    v_cvt_pk_bf16_f32 v18, v72, v73
    v_mfma_f32_16x16x32_bf16 v[32:35], a[88:91], a[24:27], v[32:35]
    ds_read_b128 a[108:111], v2 offset:11264
    v_cvt_pk_bf16_f32 v19, v74, v75
    v_mfma_f32_16x16x32_bf16 v[32:35], a[92:95], a[28:31], v[32:35]
    buffer_load_dwordx4 v1, s[12:15], s42 offen offset:1024 lds
    v_mfma_f32_16x16x32_bf16 v[36:39], a[64:67], a[32:35], v[100:103]
    ds_read_b128 a[112:115], v2 offset:12288
    v_cvt_pk_bf16_f32 v22, v76, v77
    v_mfma_f32_16x16x32_bf16 v[36:39], a[68:71], a[36:39], v[36:39]
    v_cvt_pk_bf16_f32 v23, v78, v79
    v_cvt_pk_bf16_f32 v24, v80, v81
    v_mfma_f32_16x16x32_bf16 v[36:39], a[72:75], a[40:43], v[36:39]
    ds_read_b128 a[116:119], v2 offset:13312
    v_cvt_pk_bf16_f32 v25, v82, v83
    v_mfma_f32_16x16x32_bf16 v[36:39], a[76:79], a[44:47], v[36:39]
    v_cvt_pk_bf16_f32 v28, v84, v85
    v_cvt_pk_bf16_f32 v29, v86, v87
    v_mfma_f32_16x16x32_bf16 v[36:39], a[80:83], a[48:51], v[36:39]
    ds_read_b128 a[120:123], v2 offset:14336
    v_cvt_pk_bf16_f32 v26, v88, v89
    v_mfma_f32_16x16x32_bf16 v[36:39], a[84:87], a[52:55], v[36:39]
    buffer_load_dwordx4 v1, s[12:15], s42 offen offset:2048 lds
    v_mfma_f32_16x16x32_bf16 v[36:39], a[88:91], a[56:59], v[36:39]
    ds_read_b128 a[124:127], v2 offset:15360
    v_cvt_pk_bf16_f32 v27, v90, v91
    v_mfma_f32_16x16x32_bf16 v[36:39], a[92:95], a[60:63], v[36:39]
    s_waitcnt lgkmcnt(6)
    v_exp_f32 v64, v32
    v_mfma_f32_16x16x32_bf16 v[40:43], a[96:99], a[0:3], v[104:107]
    ds_read_b128 a[64:67], v2 offset:16384
    v_cvt_pk_bf16_f32 v30, v92, v93
    v_mfma_f32_16x16x32_bf16 v[40:43], a[100:103], a[4:7], v[40:43]
    s_waitcnt lgkmcnt(5)
    v_exp_f32 v65, v33
    v_mfma_f32_16x16x32_bf16 v[40:43], a[104:107], a[8:11], v[40:43]
    ds_read_b128 a[68:71], v2 offset:17408
    v_cvt_pk_bf16_f32 v31, v94, v95
    v_mfma_f32_16x16x32_bf16 v[40:43], a[108:111], a[12:15], v[40:43]
    s_waitcnt lgkmcnt(4)
    buffer_load_dwordx4 v1, s[12:15], s42 offen offset:3072 lds
    v_mfma_f32_16x16x32_bf16 v[40:43], a[112:115], a[16:19], v[40:43]
    ds_read_b128 a[72:75], v2 offset:18432
    v_add_f32 v5, v64, v65
    v_mfma_f32_16x16x32_bf16 v[40:43], a[116:119], a[20:23], v[40:43]
    s_waitcnt lgkmcnt(3)
    v_exp_f32 v66, v34
    v_mfma_f32_16x16x32_bf16 v[40:43], a[120:123], a[24:27], v[40:43]
    ds_read_b128 a[76:79], v2 offset:19456
    v_add_f32 v5, v5, v66
    v_mfma_f32_16x16x32_bf16 v[40:43], a[124:127], a[28:31], v[40:43]
    v_exp_f32 v67, v35
    v_mfma_f32_16x16x32_bf16 v[44:47], a[96:99], a[32:35], v[108:111]
    s_bitset1_b32 m0, 12
    ds_read_b128 a[80:83], v2 offset:20480
    v_add_f32 v5, v5, v67
    v_mfma_f32_16x16x32_bf16 v[44:47], a[100:103], a[36:39], v[44:47]
    buffer_load_dwordx4 v4, s[12:15], s42 offen offset:0 lds
    v_mfma_f32_16x16x32_bf16 v[44:47], a[104:107], a[40:43], v[44:47]
    ds_read_b128 a[84:87], v2 offset:21504
    v_mfma_f32_16x16x32_bf16 v[44:47], a[108:111], a[44:47], v[44:47]
    v_exp_f32 v68, v36
    v_mfma_f32_16x16x32_bf16 v[44:47], a[112:115], a[48:51], v[44:47]
    ds_read_b128 a[88:91], v2 offset:22528
    v_mfma_f32_16x16x32_bf16 v[44:47], a[116:119], a[52:55], v[44:47]
    v_exp_f32 v69, v37
    v_mfma_f32_16x16x32_bf16 v[44:47], a[120:123], a[56:59], v[44:47]
    ds_read_b128 a[92:95], v2 offset:23552
    v_add_f32 v6, v68, v69
    v_mfma_f32_16x16x32_bf16 v[44:47], a[124:127], a[60:63], v[44:47]
    s_waitcnt lgkmcnt(6)
    buffer_load_dwordx4 v4, s[12:15], s42 offen offset:1024 lds
    v_mfma_f32_16x16x32_bf16 v[48:51], a[64:67], a[0:3], v[112:115]
    ds_read_b128 a[96:99], v2 offset:24576
    v_mfma_f32_16x16x32_bf16 v[48:51], a[68:71], a[4:7], v[48:51]
    s_waitcnt lgkmcnt(5)
    v_exp_f32 v70, v38
    v_mfma_f32_16x16x32_bf16 v[48:51], a[72:75], a[8:11], v[48:51]
    ds_read_b128 a[100:103], v2 offset:25600
    v_add_f32 v6, v6, v70
    v_mfma_f32_16x16x32_bf16 v[48:51], a[76:79], a[12:15], v[48:51]
    s_waitcnt lgkmcnt(4)
    v_exp_f32 v71, v39
    v_mfma_f32_16x16x32_bf16 v[48:51], a[80:83], a[16:19], v[48:51]
    ds_read_b128 a[104:107], v2 offset:26624
    v_add_f32 v6, v6, v71
    v_mfma_f32_16x16x32_bf16 v[48:51], a[84:87], a[20:23], v[48:51]
    s_waitcnt lgkmcnt(3)
    buffer_load_dwordx4 v4, s[12:15], s42 offen offset:2048 lds
    v_mfma_f32_16x16x32_bf16 v[48:51], a[88:91], a[24:27], v[48:51]
    ds_read_b128 a[108:111], v2 offset:27648
    v_mfma_f32_16x16x32_bf16 v[48:51], a[92:95], a[28:31], v[48:51]
    v_exp_f32 v72, v40
    v_mfma_f32_16x16x32_bf16 v[52:55], a[64:67], a[32:35], v[116:119]
    ds_read_b128 a[112:115], v2 offset:28672
    v_add_f32 v5, v5, v72
    v_mfma_f32_16x16x32_bf16 v[52:55], a[68:71], a[36:39], v[52:55]
    v_exp_f32 v73, v41
    v_mfma_f32_16x16x32_bf16 v[52:55], a[72:75], a[40:43], v[52:55]
    ds_read_b128 a[116:119], v2 offset:29696
    v_add_f32 v5, v5, v73
    v_mfma_f32_16x16x32_bf16 v[52:55], a[76:79], a[44:47], v[52:55]
    buffer_load_dwordx4 v4, s[12:15], s42 offen offset:3072 lds
    v_mfma_f32_16x16x32_bf16 v[52:55], a[80:83], a[48:51], v[52:55]
    s_add_u32 s42, s42, 0x8000
    ds_read_b128 a[120:123], v2 offset:30720
    v_mfma_f32_16x16x32_bf16 v[52:55], a[84:87], a[52:55], v[52:55]
    s_xor_b32 s40, s40, 0x8000
    v_exp_f32 v74, v42
    v_mfma_f32_16x16x32_bf16 v[52:55], a[88:91], a[56:59], v[52:55]
    s_waitcnt vmcnt(8)
    ds_read_b128 a[124:127], v2 offset:31744
    v_add_f32 v5, v5, v74
    v_mfma_f32_16x16x32_bf16 v[52:55], a[92:95], a[60:63], v[52:55]
    s_waitcnt lgkmcnt(6)
    s_barrier
    v_mfma_f32_16x16x32_bf16 v[56:59], a[96:99], a[0:3], v[120:123]
    s_mov_b32 m0, s41
    ds_read_b128 a[64:67], v3 offset:0
    v_xor_b32 v2, 0x8000, v2
    v_mfma_f32_16x16x32_bf16 v[56:59], a[100:103], a[4:7], v[56:59]
    s_waitcnt lgkmcnt(5)
    buffer_load_dwordx4 v1, s[12:15], s43 offen offset:0 lds
    v_mfma_f32_16x16x32_bf16 v[56:59], a[104:107], a[8:11], v[56:59]
    ds_read_b128 a[68:71], v3 offset:16384
    v_mfma_f32_16x16x32_bf16 v[56:59], a[108:111], a[12:15], v[56:59]
    s_waitcnt lgkmcnt(4)
    v_exp_f32 v75, v43
    v_mfma_f32_16x16x32_bf16 v[56:59], a[112:115], a[16:19], v[56:59]
    ds_read_b128 a[72:75], v3 offset:1024
    v_add_f32 v5, v5, v75
    v_mfma_f32_16x16x32_bf16 v[56:59], a[116:119], a[20:23], v[56:59]
    s_waitcnt lgkmcnt(3)
    v_exp_f32 v76, v44
    v_mfma_f32_16x16x32_bf16 v[56:59], a[120:123], a[24:27], v[56:59]
    ds_read_b128 a[76:79], v3 offset:17408
    v_add_f32 v6, v6, v76
    v_mfma_f32_16x16x32_bf16 v[56:59], a[124:127], a[28:31], v[56:59]
    buffer_load_dwordx4 v1, s[12:15], s43 offen offset:1024 lds
    v_mfma_f32_16x16x32_bf16 v[60:63], a[96:99], a[32:35], v[124:127]
    ds_read_b128 a[80:83], v3 offset:2048
    v_mfma_f32_16x16x32_bf16 v[60:63], a[100:103], a[36:39], v[60:63]
    v_exp_f32 v77, v45
    v_mfma_f32_16x16x32_bf16 v[60:63], a[104:107], a[40:43], v[60:63]
    ds_read_b128 a[84:87], v3 offset:18432
    v_add_f32 v6, v6, v77
    v_mfma_f32_16x16x32_bf16 v[60:63], a[108:111], a[44:47], v[60:63]
    v_exp_f32 v78, v46
    v_mfma_f32_16x16x32_bf16 v[60:63], a[112:115], a[48:51], v[60:63]
    ds_read_b128 a[88:91], v3 offset:3072
    v_add_f32 v6, v6, v78
    v_mfma_f32_16x16x32_bf16 v[60:63], a[116:119], a[52:55], v[60:63]
    buffer_load_dwordx4 v1, s[12:15], s43 offen offset:2048 lds
    v_mfma_f32_16x16x32_bf16 v[60:63], a[120:123], a[56:59], v[60:63]
    ds_read_b128 a[92:95], v3 offset:19456
    v_mfma_f32_16x16x32_bf16 v[60:63], a[124:127], a[60:63], v[60:63]
    s_waitcnt lgkmcnt(6)
    v_exp_f32 v79, v47
    v_mfma_f32_16x16x32_bf16 v[128:131], a[64:67], v[16:19], v[128:131]
    ds_read_b128 a[96:99], v3 offset:4096
    v_add_f32 v6, v6, v79
    v_mfma_f32_16x16x32_bf16 v[128:131], a[68:71], v[24:27], v[128:131]
    v_exp_f32 v80, v48
    v_mfma_f32_16x16x32_bf16 v[192:195], a[68:71], v[28:31], v[192:195]
    ds_read_b128 a[100:103], v3 offset:20480
    v_add_f32 v5, v5, v80
    v_mfma_f32_16x16x32_bf16 v[192:195], a[64:67], v[20:23], v[192:195]
    s_waitcnt lgkmcnt(6)
    buffer_load_dwordx4 v1, s[12:15], s43 offen offset:3072 lds
    v_mfma_f32_16x16x32_bf16 v[132:135], a[72:75], v[16:19], v[132:135]
    ds_read_b128 a[104:107], v3 offset:5120
    v_mfma_f32_16x16x32_bf16 v[132:135], a[76:79], v[24:27], v[132:135]
    v_exp_f32 v81, v49
    v_mfma_f32_16x16x32_bf16 v[196:199], a[76:79], v[28:31], v[196:199]
    ds_read_b128 a[108:111], v3 offset:21504
    v_add_f32 v5, v5, v81
    v_mfma_f32_16x16x32_bf16 v[196:199], a[72:75], v[20:23], v[196:199]
    s_waitcnt lgkmcnt(6)
    v_exp_f32 v82, v50
    v_mfma_f32_16x16x32_bf16 v[136:139], a[80:83], v[16:19], v[136:139]
    s_bitset1_b32 m0, 12
    ds_read_b128 a[112:115], v3 offset:6144
    v_add_f32 v5, v5, v82
    v_mfma_f32_16x16x32_bf16 v[136:139], a[84:87], v[24:27], v[136:139]
    buffer_load_dwordx4 v4, s[12:15], s43 offen offset:0 lds
    v_mfma_f32_16x16x32_bf16 v[200:203], a[84:87], v[28:31], v[200:203]
    ds_read_b128 a[116:119], v3 offset:22528
    v_mfma_f32_16x16x32_bf16 v[200:203], a[80:83], v[20:23], v[200:203]
    s_waitcnt lgkmcnt(6)
    v_exp_f32 v83, v51
    v_mfma_f32_16x16x32_bf16 v[140:143], a[88:91], v[16:19], v[140:143]
    ds_read_b128 a[120:123], v3 offset:7168
    v_add_f32 v5, v5, v83
    v_mfma_f32_16x16x32_bf16 v[140:143], a[92:95], v[24:27], v[140:143]
    v_exp_f32 v84, v52
    v_mfma_f32_16x16x32_bf16 v[204:207], a[92:95], v[28:31], v[204:207]
    ds_read_b128 a[124:127], v3 offset:23552
    v_add_f32 v6, v6, v84
    v_mfma_f32_16x16x32_bf16 v[204:207], a[88:91], v[20:23], v[204:207]
    s_waitcnt lgkmcnt(6)
    buffer_load_dwordx4 v4, s[12:15], s43 offen offset:1024 lds
    v_mfma_f32_16x16x32_bf16 v[144:147], a[96:99], v[16:19], v[144:147]
    ds_read_b128 a[64:67], v3 offset:8192
    v_mfma_f32_16x16x32_bf16 v[144:147], a[100:103], v[24:27], v[144:147]
    v_exp_f32 v85, v53
    v_mfma_f32_16x16x32_bf16 v[208:211], a[100:103], v[28:31], v[208:211]
    ds_read_b128 a[68:71], v3 offset:24576
    v_add_f32 v6, v6, v85
    v_mfma_f32_16x16x32_bf16 v[208:211], a[96:99], v[20:23], v[208:211]
    s_waitcnt lgkmcnt(6)
    v_exp_f32 v86, v54
    v_mfma_f32_16x16x32_bf16 v[148:151], a[104:107], v[16:19], v[148:151]
    ds_read_b128 a[72:75], v3 offset:9216
    v_add_f32 v6, v6, v86
    v_mfma_f32_16x16x32_bf16 v[148:151], a[108:111], v[24:27], v[148:151]
    buffer_load_dwordx4 v4, s[12:15], s43 offen offset:2048 lds
    v_mfma_f32_16x16x32_bf16 v[212:215], a[108:111], v[28:31], v[212:215]
    ds_read_b128 a[76:79], v3 offset:25600
    v_mfma_f32_16x16x32_bf16 v[212:215], a[104:107], v[20:23], v[212:215]
    s_waitcnt lgkmcnt(6)
    v_exp_f32 v87, v55
    v_mfma_f32_16x16x32_bf16 v[152:155], a[112:115], v[16:19], v[152:155]
    ds_read_b128 a[80:83], v3 offset:10240
    v_add_f32 v6, v6, v87
    v_mfma_f32_16x16x32_bf16 v[152:155], a[116:119], v[24:27], v[152:155]
    v_exp_f32 v88, v56
    v_mfma_f32_16x16x32_bf16 v[216:219], a[116:119], v[28:31], v[216:219]
    ds_read_b128 a[84:87], v3 offset:26624
    v_add_f32 v5, v5, v88
    v_mfma_f32_16x16x32_bf16 v[216:219], a[112:115], v[20:23], v[216:219]
    s_waitcnt lgkmcnt(6)
    buffer_load_dwordx4 v4, s[12:15], s43 offen offset:3072 lds
    v_mfma_f32_16x16x32_bf16 v[156:159], a[120:123], v[16:19], v[156:159]
    s_add_u32 s43, s43, 0x8000
    ds_read_b128 a[88:91], v3 offset:11264
    v_mfma_f32_16x16x32_bf16 v[156:159], a[124:127], v[24:27], v[156:159]
    s_xor_b32 s41, s41, 0x8000
    v_exp_f32 v89, v57
    v_mfma_f32_16x16x32_bf16 v[220:223], a[124:127], v[28:31], v[220:223]
    ds_read_b128 a[92:95], v3 offset:27648
    v_add_f32 v5, v5, v89
    v_mfma_f32_16x16x32_bf16 v[220:223], a[120:123], v[20:23], v[220:223]
    s_waitcnt lgkmcnt(6)
    v_exp_f32 v90, v58
    v_mfma_f32_16x16x32_bf16 v[160:163], a[64:67], v[16:19], v[160:163]
    ds_read_b128 a[96:99], v3 offset:12288
    v_add_f32 v5, v5, v90
    v_mfma_f32_16x16x32_bf16 v[160:163], a[68:71], v[24:27], v[160:163]
    v_exp_f32 v91, v59
    v_mfma_f32_16x16x32_bf16 v[224:227], a[68:71], v[28:31], v[224:227]
    ds_read_b128 a[100:103], v3 offset:28672
    v_add_f32 v5, v5, v91
    v_mfma_f32_16x16x32_bf16 v[224:227], a[64:67], v[20:23], v[224:227]
    s_waitcnt lgkmcnt(6)
    v_exp_f32 v92, v60
    v_mfma_f32_16x16x32_bf16 v[164:167], a[72:75], v[16:19], v[164:167]
    ds_read_b128 a[104:107], v3 offset:13312
    v_add_f32 v6, v6, v92
    v_mfma_f32_16x16x32_bf16 v[164:167], a[76:79], v[24:27], v[164:167]
    v_exp_f32 v93, v61
    v_mfma_f32_16x16x32_bf16 v[228:231], a[76:79], v[28:31], v[228:231]
    ds_read_b128 a[108:111], v3 offset:29696
    v_add_f32 v6, v6, v93
    v_mfma_f32_16x16x32_bf16 v[228:231], a[72:75], v[20:23], v[228:231]
    s_waitcnt lgkmcnt(6)
    v_exp_f32 v94, v62
    v_mfma_f32_16x16x32_bf16 v[168:171], a[80:83], v[16:19], v[168:171]
    ds_read_b128 a[112:115], v3 offset:14336
    v_add_f32 v6, v6, v94
    v_mfma_f32_16x16x32_bf16 v[168:171], a[84:87], v[24:27], v[168:171]
    v_exp_f32 v95, v63
    v_mfma_f32_16x16x32_bf16 v[232:235], a[84:87], v[28:31], v[232:235]
    ds_read_b128 a[116:119], v3 offset:30720
    v_add_f32 v6, v6, v95
    v_mfma_f32_16x16x32_bf16 v[232:235], a[80:83], v[20:23], v[232:235]
    s_waitcnt lgkmcnt(6)
    v_add_f32 v11, v5, v6
    v_mfma_f32_16x16x32_bf16 v[172:175], a[88:91], v[16:19], v[172:175]
    ds_read_b128 a[120:123], v3 offset:15360
    v_cmp_nge_f32 vcc, s47, v11
    v_mfma_f32_16x16x32_bf16 v[172:175], a[92:95], v[24:27], v[172:175]
    v_mfma_f32_16x16x32_bf16 v[236:239], a[92:95], v[28:31], v[236:239]
    s_waitcnt vmcnt(8)
    ds_read_b128 a[124:127], v3 offset:31744
    v_mfma_f32_16x16x32_bf16 v[236:239], a[88:91], v[20:23], v[236:239]
    s_waitcnt lgkmcnt(6)
    s_barrier
    v_mfma_f32_16x16x32_bf16 v[176:179], a[96:99], v[16:19], v[176:179]
    ds_read_b128 a[64:67], v2 offset:0
    v_xor_b32 v3, 0x8000, v3
    v_mfma_f32_16x16x32_bf16 v[176:179], a[100:103], v[24:27], v[176:179]
    v_mfma_f32_16x16x32_bf16 v[240:243], a[100:103], v[28:31], v[240:243]
    ds_read_b128 a[68:71], v2 offset:1024
    v_mfma_f32_16x16x32_bf16 v[240:243], a[96:99], v[20:23], v[240:243]
    s_waitcnt lgkmcnt(6)
    v_mfma_f32_16x16x32_bf16 v[180:183], a[104:107], v[16:19], v[180:183]
    ds_read_b128 a[72:75], v2 offset:2048
    v_mfma_f32_16x16x32_bf16 v[180:183], a[108:111], v[24:27], v[180:183]
    v_mfma_f32_16x16x32_bf16 v[244:247], a[108:111], v[28:31], v[244:247]
    ds_read_b128 a[76:79], v2 offset:3072
    v_mfma_f32_16x16x32_bf16 v[244:247], a[104:107], v[20:23], v[244:247]
    s_waitcnt lgkmcnt(6)
    v_mfma_f32_16x16x32_bf16 v[184:187], a[112:115], v[16:19], v[184:187]
    s_sub_u32 s44, s44, 1
    ds_read_b128 a[80:83], v2 offset:4096
    v_mfma_f32_16x16x32_bf16 v[184:187], a[116:119], v[24:27], v[184:187]
    v_mfma_f32_16x16x32_bf16 v[248:251], a[116:119], v[28:31], v[248:251]
    ds_read_b128 a[84:87], v2 offset:5120
    v_mfma_f32_16x16x32_bf16 v[248:251], a[112:115], v[20:23], v[248:251]
    s_waitcnt lgkmcnt(6)
    v_mfma_f32_16x16x32_bf16 v[188:191], a[120:123], v[16:19], v[188:191]
    ds_read_b128 a[88:91], v2 offset:6144
    v_mfma_f32_16x16x32_bf16 v[188:191], a[124:127], v[24:27], v[188:191]
    v_mfma_f32_16x16x32_bf16 v[252:255], a[124:127], v[28:31], v[252:255]
    ds_read_b128 a[92:95], v2 offset:7168
    v_mfma_f32_16x16x32_bf16 v[252:255], a[120:123], v[20:23], v[252:255]
    s_waitcnt lgkmcnt(6)
    s_cbranch_vccnz k2_kernel_slow
k2_kernel_ret:
    s_cmp_gt_u32 s44, s45
    s_cbranch_scc1 k2_kernel_loop
    s_cmp_eq_u32 s44, 0
    s_cbranch_scc1 k2_kernel_tail
    s_cmp_eq_u32 s44, 1
    s_cbranch_scc1 k2_kernel_d1
    v_mov_b32 v11, 0xf149f2ca
    v_cmp_gt_i32 s[16:17], 0, v14
    v_cmp_gt_i32 s[18:19], 1, v14
    v_cmp_gt_i32 s[20:21], 2, v14
    v_cmp_gt_i32 s[22:23], 3, v14
    v_cndmask_b32 v96, v9, v11, s[16:17]
    v_cndmask_b32 v97, v9, v11, s[18:19]
    v_cndmask_b32 v98, v9, v11, s[20:21]
    v_cndmask_b32 v99, v9, v11, s[22:23]
    v_cmp_gt_i32 s[16:17], 16, v14
    v_cmp_gt_i32 s[18:19], 17, v14
    v_cmp_gt_i32 s[20:21], 18, v14
    v_cmp_gt_i32 s[22:23], 19, v14
    v_cndmask_b32 v104, v9, v11, s[16:17]
    v_cndmask_b32 v105, v9, v11, s[18:19]
    v_cndmask_b32 v106, v9, v11, s[20:21]
    v_cndmask_b32 v107, v9, v11, s[22:23]
    v_cmp_gt_i32 s[16:17], 32, v14
    v_cmp_gt_i32 s[18:19], 33, v14
    v_cmp_gt_i32 s[20:21], 34, v14
    v_cmp_gt_i32 s[22:23], 35, v14
    v_cndmask_b32 v112, v9, v11, s[16:17]
    v_cndmask_b32 v113, v9, v11, s[18:19]
    v_cndmask_b32 v114, v9, v11, s[20:21]
    v_cndmask_b32 v115, v9, v11, s[22:23]
    v_cmp_gt_i32 s[16:17], 48, v14
    v_cmp_gt_i32 s[18:19], 49, v14
    v_cmp_gt_i32 s[20:21], 50, v14
    v_cmp_gt_i32 s[22:23], 51, v14
    v_cndmask_b32 v120, v9, v11, s[16:17]
    v_cndmask_b32 v121, v9, v11, s[18:19]
    v_cndmask_b32 v122, v9, v11, s[20:21]
    v_cndmask_b32 v123, v9, v11, s[22:23]
    s_nop 0
    s_branch k2_kernel_loop
k2_kernel_d1:
    v_mov_b32 v11, 0xf149f2ca
    v_cmp_gt_i32 s[16:17], 0, v14
    v_cmp_gt_i32 s[18:19], 1, v14
    v_cmp_gt_i32 s[20:21], 2, v14
    v_cmp_gt_i32 s[22:23], 3, v14
    v_cndmask_b32 v100, v10, v11, s[16:17]
    v_cndmask_b32 v101, v10, v11, s[18:19]
    v_cndmask_b32 v102, v10, v11, s[20:21]
    v_cndmask_b32 v103, v10, v11, s[22:23]
    v_cmp_gt_i32 s[16:17], 16, v14
    v_cmp_gt_i32 s[18:19], 17, v14
    v_cmp_gt_i32 s[20:21], 18, v14
    v_cmp_gt_i32 s[22:23], 19, v14
    v_cndmask_b32 v108, v10, v11, s[16:17]
    v_cndmask_b32 v109, v10, v11, s[18:19]
    v_cndmask_b32 v110, v10, v11, s[20:21]
    v_cndmask_b32 v111, v10, v11, s[22:23]
    v_cmp_gt_i32 s[16:17], 32, v14
    v_cmp_gt_i32 s[18:19], 33, v14
    v_cmp_gt_i32 s[20:21], 34, v14
    v_cmp_gt_i32 s[22:23], 35, v14
    v_cndmask_b32 v116, v10, v11, s[16:17]
    v_cndmask_b32 v117, v10, v11, s[18:19]
    v_cndmask_b32 v118, v10, v11, s[20:21]
    v_cndmask_b32 v119, v10, v11, s[22:23]
    v_cmp_gt_i32 s[16:17], 48, v14
    v_cmp_gt_i32 s[18:19], 49, v14
    v_cmp_gt_i32 s[20:21], 50, v14
    v_cmp_gt_i32 s[22:23], 51, v14
    v_cndmask_b32 v124, v10, v11, s[16:17]
    v_cndmask_b32 v125, v10, v11, s[18:19]
    v_cndmask_b32 v126, v10, v11, s[20:21]
    v_cndmask_b32 v127, v10, v11, s[22:23]
    v_mov_b32 v96, v11
    v_mov_b32 v97, v11
    v_mov_b32 v98, v11
    v_mov_b32 v99, v11
    v_mov_b32 v104, v11
    v_mov_b32 v105, v11
    v_mov_b32 v106, v11
    v_mov_b32 v107, v11
    v_mov_b32 v112, v11
    v_mov_b32 v113, v11
    v_mov_b32 v114, v11
    v_mov_b32 v115, v11
    v_mov_b32 v120, v11
    v_mov_b32 v121, v11
    v_mov_b32 v122, v11
    v_mov_b32 v123, v11
    s_nop 0
    s_branch k2_kernel_loop
k2_kernel_tail:
    s_waitcnt vmcnt(0) lgkmcnt(0)
    s_barrier
    ds_read_b128 a[64:67], v3 offset:0
    ds_read_b128 a[68:71], v3 offset:16384
    ds_read_b128 a[72:75], v3 offset:1024
    ds_read_b128 a[76:79], v3 offset:17408
    ds_read_b128 a[80:83], v3 offset:2048
    ds_read_b128 a[84:87], v3 offset:18432
    ds_read_b128 a[88:91], v3 offset:3072
    ds_read_b128 a[92:95], v3 offset:19456
    v_cvt_pk_bf16_f32 v16, v64, v65
    v_cvt_pk_bf16_f32 v17, v66, v67
    v_cvt_pk_bf16_f32 v20, v68, v69
    v_cvt_pk_bf16_f32 v21, v70, v71
    v_cvt_pk_bf16_f32 v18, v72, v73
    v_cvt_pk_bf16_f32 v19, v74, v75
    v_cvt_pk_bf16_f32 v22, v76, v77
    v_cvt_pk_bf16_f32 v23, v78, v79
    v_cvt_pk_bf16_f32 v24, v80, v81
    v_cvt_pk_bf16_f32 v25, v82, v83
    v_cvt_pk_bf16_f32 v28, v84, v85
    v_cvt_pk_bf16_f32 v29, v86, v87
    v_cvt_pk_bf16_f32 v26, v88, v89
    v_cvt_pk_bf16_f32 v27, v90, v91
    v_cvt_pk_bf16_f32 v30, v92, v93
    v_cvt_pk_bf16_f32 v31, v94, v95
    v_add_f32 v7, v7, v5
    v_add_f32 v8, v8, v6
    s_waitcnt lgkmcnt(0)
    v_mfma_f32_16x16x32_bf16 v[128:131], a[64:67], v[16:19], v[128:131]
    ds_read_b128 a[96:99], v3 offset:4096
    v_mfma_f32_16x16x32_bf16 v[128:131], a[68:71], v[24:27], v[128:131]
    v_mfma_f32_16x16x32_bf16 v[192:195], a[68:71], v[28:31], v[192:195]
    ds_read_b128 a[100:103], v3 offset:20480
    v_mfma_f32_16x16x32_bf16 v[192:195], a[64:67], v[20:23], v[192:195]
    v_mfma_f32_16x16x32_bf16 v[132:135], a[72:75], v[16:19], v[132:135]
    ds_read_b128 a[104:107], v3 offset:5120
    v_mfma_f32_16x16x32_bf16 v[132:135], a[76:79], v[24:27], v[132:135]
    v_mfma_f32_16x16x32_bf16 v[196:199], a[76:79], v[28:31], v[196:199]
    ds_read_b128 a[108:111], v3 offset:21504
    v_mfma_f32_16x16x32_bf16 v[196:199], a[72:75], v[20:23], v[196:199]
    v_mfma_f32_16x16x32_bf16 v[136:139], a[80:83], v[16:19], v[136:139]
    ds_read_b128 a[112:115], v3 offset:6144
    v_mfma_f32_16x16x32_bf16 v[136:139], a[84:87], v[24:27], v[136:139]
    v_mfma_f32_16x16x32_bf16 v[200:203], a[84:87], v[28:31], v[200:203]
    ds_read_b128 a[116:119], v3 offset:22528
    v_mfma_f32_16x16x32_bf16 v[200:203], a[80:83], v[20:23], v[200:203]
    v_mfma_f32_16x16x32_bf16 v[140:143], a[88:91], v[16:19], v[140:143]
    ds_read_b128 a[120:123], v3 offset:7168
    v_mfma_f32_16x16x32_bf16 v[140:143], a[92:95], v[24:27], v[140:143]
    v_mfma_f32_16x16x32_bf16 v[204:207], a[92:95], v[28:31], v[204:207]
    ds_read_b128 a[124:127], v3 offset:23552
    v_mfma_f32_16x16x32_bf16 v[204:207], a[88:91], v[20:23], v[204:207]
    s_waitcnt lgkmcnt(6)
    v_mfma_f32_16x16x32_bf16 v[144:147], a[96:99], v[16:19], v[144:147]
    ds_read_b128 a[64:67], v3 offset:8192
    v_mfma_f32_16x16x32_bf16 v[144:147], a[100:103], v[24:27], v[144:147]
    v_mfma_f32_16x16x32_bf16 v[208:211], a[100:103], v[28:31], v[208:211]
    ds_read_b128 a[68:71], v3 offset:24576
    v_mfma_f32_16x16x32_bf16 v[208:211], a[96:99], v[20:23], v[208:211]
    s_waitcnt lgkmcnt(6)
    v_mfma_f32_16x16x32_bf16 v[148:151], a[104:107], v[16:19], v[148:151]
    ds_read_b128 a[72:75], v3 offset:9216
    v_mfma_f32_16x16x32_bf16 v[148:151], a[108:111], v[24:27], v[148:151]
    v_mfma_f32_16x16x32_bf16 v[212:215], a[108:111], v[28:31], v[212:215]
    ds_read_b128 a[76:79], v3 offset:25600
    v_mfma_f32_16x16x32_bf16 v[212:215], a[104:107], v[20:23], v[212:215]
    s_waitcnt lgkmcnt(6)
    v_mfma_f32_16x16x32_bf16 v[152:155], a[112:115], v[16:19], v[152:155]
    ds_read_b128 a[80:83], v3 offset:10240
    v_mfma_f32_16x16x32_bf16 v[152:155], a[116:119], v[24:27], v[152:155]
    v_mfma_f32_16x16x32_bf16 v[216:219], a[116:119], v[28:31], v[216:219]
    ds_read_b128 a[84:87], v3 offset:26624
    v_mfma_f32_16x16x32_bf16 v[216:219], a[112:115], v[20:23], v[216:219]
    s_waitcnt lgkmcnt(6)
    v_mfma_f32_16x16x32_bf16 v[156:159], a[120:123], v[16:19], v[156:159]
    ds_read_b128 a[88:91], v3 offset:11264
    v_mfma_f32_16x16x32_bf16 v[156:159], a[124:127], v[24:27], v[156:159]
    v_mfma_f32_16x16x32_bf16 v[220:223], a[124:127], v[28:31], v[220:223]
    ds_read_b128 a[92:95], v3 offset:27648
    v_mfma_f32_16x16x32_bf16 v[220:223], a[120:123], v[20:23], v[220:223]
    s_waitcnt lgkmcnt(6)
    v_mfma_f32_16x16x32_bf16 v[160:163], a[64:67], v[16:19], v[160:163]
    ds_read_b128 a[96:99], v3 offset:12288
    v_mfma_f32_16x16x32_bf16 v[160:163], a[68:71], v[24:27], v[160:163]
    v_mfma_f32_16x16x32_bf16 v[224:227], a[68:71], v[28:31], v[224:227]
    ds_read_b128 a[100:103], v3 offset:28672
    v_mfma_f32_16x16x32_bf16 v[224:227], a[64:67], v[20:23], v[224:227]
    s_waitcnt lgkmcnt(6)
    v_mfma_f32_16x16x32_bf16 v[164:167], a[72:75], v[16:19], v[164:167]
    ds_read_b128 a[104:107], v3 offset:13312
    v_mfma_f32_16x16x32_bf16 v[164:167], a[76:79], v[24:27], v[164:167]
    v_mfma_f32_16x16x32_bf16 v[228:231], a[76:79], v[28:31], v[228:231]
    ds_read_b128 a[108:111], v3 offset:29696
    v_mfma_f32_16x16x32_bf16 v[228:231], a[72:75], v[20:23], v[228:231]
    s_waitcnt lgkmcnt(6)
    v_mfma_f32_16x16x32_bf16 v[168:171], a[80:83], v[16:19], v[168:171]
    ds_read_b128 a[112:115], v3 offset:14336
    v_mfma_f32_16x16x32_bf16 v[168:171], a[84:87], v[24:27], v[168:171]
    v_mfma_f32_16x16x32_bf16 v[232:235], a[84:87], v[28:31], v[232:235]
    ds_read_b128 a[116:119], v3 offset:30720
    v_mfma_f32_16x16x32_bf16 v[232:235], a[80:83], v[20:23], v[232:235]
    s_waitcnt lgkmcnt(6)
    v_mfma_f32_16x16x32_bf16 v[172:175], a[88:91], v[16:19], v[172:175]
    ds_read_b128 a[120:123], v3 offset:15360
    v_mfma_f32_16x16x32_bf16 v[172:175], a[92:95], v[24:27], v[172:175]
    v_mfma_f32_16x16x32_bf16 v[236:239], a[92:95], v[28:31], v[236:239]
    ds_read_b128 a[124:127], v3 offset:31744
    v_mfma_f32_16x16x32_bf16 v[236:239], a[88:91], v[20:23], v[236:239]
    s_waitcnt lgkmcnt(6)
    v_mfma_f32_16x16x32_bf16 v[176:179], a[96:99], v[16:19], v[176:179]
    v_mfma_f32_16x16x32_bf16 v[176:179], a[100:103], v[24:27], v[176:179]
    v_mfma_f32_16x16x32_bf16 v[240:243], a[100:103], v[28:31], v[240:243]
    v_mfma_f32_16x16x32_bf16 v[240:243], a[96:99], v[20:23], v[240:243]
    s_waitcnt lgkmcnt(4)
    v_mfma_f32_16x16x32_bf16 v[180:183], a[104:107], v[16:19], v[180:183]
    v_mfma_f32_16x16x32_bf16 v[180:183], a[108:111], v[24:27], v[180:183]
    v_mfma_f32_16x16x32_bf16 v[244:247], a[108:111], v[28:31], v[244:247]
    v_mfma_f32_16x16x32_bf16 v[244:247], a[104:107], v[20:23], v[244:247]
    s_waitcnt lgkmcnt(2)
    v_mfma_f32_16x16x32_bf16 v[184:187], a[112:115], v[16:19], v[184:187]
    v_mfma_f32_16x16x32_bf16 v[184:187], a[116:119], v[24:27], v[184:187]
    v_mfma_f32_16x16x32_bf16 v[248:251], a[116:119], v[28:31], v[248:251]
    v_mfma_f32_16x16x32_bf16 v[248:251], a[112:115], v[20:23], v[248:251]
    s_waitcnt lgkmcnt(0)
    v_mfma_f32_16x16x32_bf16 v[188:191], a[120:123], v[16:19], v[188:191]
    v_mfma_f32_16x16x32_bf16 v[188:191], a[124:127], v[24:27], v[188:191]
    v_mfma_f32_16x16x32_bf16 v[252:255], a[124:127], v[28:31], v[252:255]
    v_mfma_f32_16x16x32_bf16 v[252:255], a[120:123], v[20:23], v[252:255]
    v_mov_b32 v13, v7
    s_nop 1
    v_permlane32_swap_b32 v7, v13
    s_nop 1
    v_add_f32 v7, v7, v13
    v_mov_b32 v13, v7
    s_nop 1
    v_permlane16_swap_b32 v7, v13
    s_nop 1
    v_add_f32 v7, v7, v13
    v_mov_b32 v13, v8
    s_nop 1
    v_permlane32_swap_b32 v8, v13
    s_nop 1
    v_add_f32 v8, v8, v13
    v_mov_b32 v13, v8
    s_nop 1
    v_permlane16_swap_b32 v8, v13
    s_nop 1
    v_add_f32 v8, v8, v13
    v_log_f32 v5, v7
    v_rcp_f32 v11, v7
    v_log_f32 v6, v8
    v_rcp_f32 v12, v8
    v_sub_f32 v5, v5, v9
    v_sub_f32 v6, v6, v10
    s_lshl_b32 s55, s39, 16
    s_lshl_b32 s57, s3, 14
    s_add_u32 s55, s55, s57
    s_add_u32 s55, s55, 67108864
    s_add_u32 s56, s55, 0x2000
    s_lshl_b32 s57, s39, 2
    s_add_u32 s57, s57, s3
    s_lshl_b32 s57, s57, 9
    s_add_u32 s57, s57, 83886080
    s_lshl_b32 s58, s39, 7
    s_add_u32 s58, s58, 84934656
    v_lshrrev_b32 v15, 2, v1
    s_cmp_lg_u32 s54, 0
    s_cbranch_scc1 k2_kernel_final
    buffer_store_dword v5, v15, s[12:15], s57 offen offset:0 sc1
    buffer_store_dword v6, v15, s[12:15], s57 offen offset:256 sc1
    v_mul_f32 v128, v128, v11
    v_mul_f32 v129, v129, v11
    v_mul_f32 v130, v130, v11
    v_mul_f32 v131, v131, v11
    v_mul_f32 v132, v132, v11
    v_mul_f32 v133, v133, v11
    v_mul_f32 v134, v134, v11
    v_mul_f32 v135, v135, v11
    v_cvt_pk_bf16_f32 v128, v128, v129
    v_cvt_pk_bf16_f32 v129, v130, v131
    v_cvt_pk_bf16_f32 v130, v132, v133
    v_cvt_pk_bf16_f32 v131, v134, v135
    buffer_store_dwordx4 v[128:131], v1, s[12:15], s55 offen offset:0 sc1
    v_mul_f32 v136, v136, v11
    v_mul_f32 v137, v137, v11
    v_mul_f32 v138, v138, v11
    v_mul_f32 v139, v139, v11
    v_mul_f32 v140, v140, v11
    v_mul_f32 v141, v141, v11
    v_mul_f32 v142, v142, v11
    v_mul_f32 v143, v143, v11
    v_cvt_pk_bf16_f32 v136, v136, v137
    v_cvt_pk_bf16_f32 v137, v138, v139
    v_cvt_pk_bf16_f32 v138, v140, v141
    v_cvt_pk_bf16_f32 v139, v142, v143
    buffer_store_dwordx4 v[136:139], v1, s[12:15], s55 offen offset:1024 sc1
    v_mul_f32 v144, v144, v11
    v_mul_f32 v145, v145, v11
    v_mul_f32 v146, v146, v11
    v_mul_f32 v147, v147, v11
    v_mul_f32 v148, v148, v11
    v_mul_f32 v149, v149, v11
    v_mul_f32 v150, v150, v11
    v_mul_f32 v151, v151, v11
    v_cvt_pk_bf16_f32 v144, v144, v145
    v_cvt_pk_bf16_f32 v145, v146, v147
    v_cvt_pk_bf16_f32 v146, v148, v149
    v_cvt_pk_bf16_f32 v147, v150, v151
    buffer_store_dwordx4 v[144:147], v1, s[12:15], s55 offen offset:2048 sc1
    v_mul_f32 v152, v152, v11
    v_mul_f32 v153, v153, v11
    v_mul_f32 v154, v154, v11
    v_mul_f32 v155, v155, v11
    v_mul_f32 v156, v156, v11
    v_mul_f32 v157, v157, v11
    v_mul_f32 v158, v158, v11
    v_mul_f32 v159, v159, v11
    v_cvt_pk_bf16_f32 v152, v152, v153
    v_cvt_pk_bf16_f32 v153, v154, v155
    v_cvt_pk_bf16_f32 v154, v156, v157
    v_cvt_pk_bf16_f32 v155, v158, v159
    buffer_store_dwordx4 v[152:155], v1, s[12:15], s55 offen offset:3072 sc1
    v_mul_f32 v160, v160, v11
    v_mul_f32 v161, v161, v11
    v_mul_f32 v162, v162, v11
    v_mul_f32 v163, v163, v11
    v_mul_f32 v164, v164, v11
    v_mul_f32 v165, v165, v11
    v_mul_f32 v166, v166, v11
    v_mul_f32 v167, v167, v11
    v_cvt_pk_bf16_f32 v160, v160, v161
    v_cvt_pk_bf16_f32 v161, v162, v163
    v_cvt_pk_bf16_f32 v162, v164, v165
    v_cvt_pk_bf16_f32 v163, v166, v167
    buffer_store_dwordx4 v[160:163], v4, s[12:15], s55 offen offset:0 sc1
    v_mul_f32 v168, v168, v11
    v_mul_f32 v169, v169, v11
    v_mul_f32 v170, v170, v11
    v_mul_f32 v171, v171, v11
    v_mul_f32 v172, v172, v11
    v_mul_f32 v173, v173, v11
    v_mul_f32 v174, v174, v11
    v_mul_f32 v175, v175, v11
    v_cvt_pk_bf16_f32 v168, v168, v169
    v_cvt_pk_bf16_f32 v169, v170, v171
    v_cvt_pk_bf16_f32 v170, v172, v173
    v_cvt_pk_bf16_f32 v171, v174, v175
    buffer_store_dwordx4 v[168:171], v4, s[12:15], s55 offen offset:1024 sc1
    v_mul_f32 v176, v176, v11
    v_mul_f32 v177, v177, v11
    v_mul_f32 v178, v178, v11
    v_mul_f32 v179, v179, v11
    v_mul_f32 v180, v180, v11
    v_mul_f32 v181, v181, v11
    v_mul_f32 v182, v182, v11
    v_mul_f32 v183, v183, v11
    v_cvt_pk_bf16_f32 v176, v176, v177
    v_cvt_pk_bf16_f32 v177, v178, v179
    v_cvt_pk_bf16_f32 v178, v180, v181
    v_cvt_pk_bf16_f32 v179, v182, v183
    buffer_store_dwordx4 v[176:179], v4, s[12:15], s55 offen offset:2048 sc1
    v_mul_f32 v184, v184, v11
    v_mul_f32 v185, v185, v11
    v_mul_f32 v186, v186, v11
    v_mul_f32 v187, v187, v11
    v_mul_f32 v188, v188, v11
    v_mul_f32 v189, v189, v11
    v_mul_f32 v190, v190, v11
    v_mul_f32 v191, v191, v11
    v_cvt_pk_bf16_f32 v184, v184, v185
    v_cvt_pk_bf16_f32 v185, v186, v187
    v_cvt_pk_bf16_f32 v186, v188, v189
    v_cvt_pk_bf16_f32 v187, v190, v191
    buffer_store_dwordx4 v[184:187], v4, s[12:15], s55 offen offset:3072 sc1
    v_mul_f32 v192, v192, v12
    v_mul_f32 v193, v193, v12
    v_mul_f32 v194, v194, v12
    v_mul_f32 v195, v195, v12
    v_mul_f32 v196, v196, v12
    v_mul_f32 v197, v197, v12
    v_mul_f32 v198, v198, v12
    v_mul_f32 v199, v199, v12
    v_cvt_pk_bf16_f32 v192, v192, v193
    v_cvt_pk_bf16_f32 v193, v194, v195
    v_cvt_pk_bf16_f32 v194, v196, v197
    v_cvt_pk_bf16_f32 v195, v198, v199
    buffer_store_dwordx4 v[192:195], v1, s[12:15], s56 offen offset:0 sc1
    v_mul_f32 v200, v200, v12
    v_mul_f32 v201, v201, v12
    v_mul_f32 v202, v202, v12
    v_mul_f32 v203, v203, v12
    v_mul_f32 v204, v204, v12
    v_mul_f32 v205, v205, v12
    v_mul_f32 v206, v206, v12
    v_mul_f32 v207, v207, v12
    v_cvt_pk_bf16_f32 v200, v200, v201
    v_cvt_pk_bf16_f32 v201, v202, v203
    v_cvt_pk_bf16_f32 v202, v204, v205
    v_cvt_pk_bf16_f32 v203, v206, v207
    buffer_store_dwordx4 v[200:203], v1, s[12:15], s56 offen offset:1024 sc1
    v_mul_f32 v208, v208, v12
    v_mul_f32 v209, v209, v12
    v_mul_f32 v210, v210, v12
    v_mul_f32 v211, v211, v12
    v_mul_f32 v212, v212, v12
    v_mul_f32 v213, v213, v12
    v_mul_f32 v214, v214, v12
    v_mul_f32 v215, v215, v12
    v_cvt_pk_bf16_f32 v208, v208, v209
    v_cvt_pk_bf16_f32 v209, v210, v211
    v_cvt_pk_bf16_f32 v210, v212, v213
    v_cvt_pk_bf16_f32 v211, v214, v215
    buffer_store_dwordx4 v[208:211], v1, s[12:15], s56 offen offset:2048 sc1
    v_mul_f32 v216, v216, v12
    v_mul_f32 v217, v217, v12
    v_mul_f32 v218, v218, v12
    v_mul_f32 v219, v219, v12
    v_mul_f32 v220, v220, v12
    v_mul_f32 v221, v221, v12
    v_mul_f32 v222, v222, v12
    v_mul_f32 v223, v223, v12
    v_cvt_pk_bf16_f32 v216, v216, v217
    v_cvt_pk_bf16_f32 v217, v218, v219
    v_cvt_pk_bf16_f32 v218, v220, v221
    v_cvt_pk_bf16_f32 v219, v222, v223
    buffer_store_dwordx4 v[216:219], v1, s[12:15], s56 offen offset:3072 sc1
    v_mul_f32 v224, v224, v12
    v_mul_f32 v225, v225, v12
    v_mul_f32 v226, v226, v12
    v_mul_f32 v227, v227, v12
    v_mul_f32 v228, v228, v12
    v_mul_f32 v229, v229, v12
    v_mul_f32 v230, v230, v12
    v_mul_f32 v231, v231, v12
    v_cvt_pk_bf16_f32 v224, v224, v225
    v_cvt_pk_bf16_f32 v225, v226, v227
    v_cvt_pk_bf16_f32 v226, v228, v229
    v_cvt_pk_bf16_f32 v227, v230, v231
    buffer_store_dwordx4 v[224:227], v4, s[12:15], s56 offen offset:0 sc1
    v_mul_f32 v232, v232, v12
    v_mul_f32 v233, v233, v12
    v_mul_f32 v234, v234, v12
    v_mul_f32 v235, v235, v12
    v_mul_f32 v236, v236, v12
    v_mul_f32 v237, v237, v12
    v_mul_f32 v238, v238, v12
    v_mul_f32 v239, v239, v12
    v_cvt_pk_bf16_f32 v232, v232, v233
    v_cvt_pk_bf16_f32 v233, v234, v235
    v_cvt_pk_bf16_f32 v234, v236, v237
    v_cvt_pk_bf16_f32 v235, v238, v239
    buffer_store_dwordx4 v[232:235], v4, s[12:15], s56 offen offset:1024 sc1
    v_mul_f32 v240, v240, v12
    v_mul_f32 v241, v241, v12
    v_mul_f32 v242, v242, v12
    v_mul_f32 v243, v243, v12
    v_mul_f32 v244, v244, v12
    v_mul_f32 v245, v245, v12
    v_mul_f32 v246, v246, v12
    v_mul_f32 v247, v247, v12
    v_cvt_pk_bf16_f32 v240, v240, v241
    v_cvt_pk_bf16_f32 v241, v242, v243
    v_cvt_pk_bf16_f32 v242, v244, v245
    v_cvt_pk_bf16_f32 v243, v246, v247
    buffer_store_dwordx4 v[240:243], v4, s[12:15], s56 offen offset:2048 sc1
    v_mul_f32 v248, v248, v12
    v_mul_f32 v249, v249, v12
    v_mul_f32 v250, v250, v12
    v_mul_f32 v251, v251, v12
    v_mul_f32 v252, v252, v12
    v_mul_f32 v253, v253, v12
    v_mul_f32 v254, v254, v12
    v_mul_f32 v255, v255, v12
    v_cvt_pk_bf16_f32 v248, v248, v249
    v_cvt_pk_bf16_f32 v249, v250, v251
    v_cvt_pk_bf16_f32 v250, v252, v253
    v_cvt_pk_bf16_f32 v251, v254, v255
    buffer_store_dwordx4 v[248:251], v4, s[12:15], s56 offen offset:3072 sc1
    s_waitcnt vmcnt(0)
    s_barrier
    s_cmp_lg_u32 s3, 0
    s_cbranch_scc1 k2_kernel_seg2
    v_mov_b32 v11, 1
    v_mov_b32 v12, 0
    s_mov_b64 s[60:61], exec
    s_mov_b64 exec, 1
    buffer_store_dword v11, v12, s[12:15], s58 offen sc1
    s_mov_b64 exec, s[60:61]
    s_branch k2_kernel_seg2
k2_kernel_final:
    s_cmp_eq_u32 s54, 1
    s_cbranch_scc1 k2_kernel_store
    v_mov_b32 v13, 0
k2_kernel_poll:
    buffer_load_dword v16, v13, s[12:15], s58 offen sc1
    s_waitcnt vmcnt(0)
    v_readfirstlane_b32 s59, v16
    s_cmp_eq_u32 s59, 1
    s_cbranch_scc1 k2_kernel_got
    s_sleep 4
    s_branch k2_kernel_poll
k2_kernel_got:
    buffer_load_dword v16, v15, s[12:15], s57 offen offset:0 sc1
    buffer_load_dword v17, v15, s[12:15], s57 offen offset:256 sc1
    buffer_load_dwordx4 v[32:35], v1, s[12:15], s55 offen offset:0 sc1
    buffer_load_dwordx4 v[36:39], v1, s[12:15], s55 offen offset:1024 sc1
    buffer_load_dwordx4 v[40:43], v1, s[12:15], s55 offen offset:2048 sc1
    buffer_load_dwordx4 v[44:47], v1, s[12:15], s55 offen offset:3072 sc1
    buffer_load_dwordx4 v[48:51], v4, s[12:15], s55 offen offset:0 sc1
    buffer_load_dwordx4 v[52:55], v4, s[12:15], s55 offen offset:1024 sc1
    buffer_load_dwordx4 v[56:59], v4, s[12:15], s55 offen offset:2048 sc1
    buffer_load_dwordx4 v[60:63], v4, s[12:15], s55 offen offset:3072 sc1
    buffer_load_dwordx4 v[64:67], v1, s[12:15], s56 offen offset:0 sc1
    buffer_load_dwordx4 v[68:71], v1, s[12:15], s56 offen offset:1024 sc1
    buffer_load_dwordx4 v[72:75], v1, s[12:15], s56 offen offset:2048 sc1
    buffer_load_dwordx4 v[76:79], v1, s[12:15], s56 offen offset:3072 sc1
    buffer_load_dwordx4 v[80:83], v4, s[12:15], s56 offen offset:0 sc1
    buffer_load_dwordx4 v[84:87], v4, s[12:15], s56 offen offset:1024 sc1
    buffer_load_dwordx4 v[88:91], v4, s[12:15], s56 offen offset:2048 sc1
    buffer_load_dwordx4 v[92:95], v4, s[12:15], s56 offen offset:3072 sc1
    s_waitcnt vmcnt(16)
    v_max_f32 v18, v16, v5
    v_sub_f32 v19, v5, v18
    v_sub_f32 v20, v16, v18
    v_exp_f32 v19, v19
    v_exp_f32 v20, v20
    s_nop 0
    v_add_f32 v18, v19, v20
    v_rcp_f32 v18, v18
    s_nop 0
    v_mul_f32 v19, v19, v18
    v_mul_f32 v22, v20, v18
    v_mul_f32 v11, v11, v19
    v_max_f32 v18, v17, v6
    v_sub_f32 v19, v6, v18
    v_sub_f32 v20, v17, v18
    v_exp_f32 v19, v19
    v_exp_f32 v20, v20
    s_nop 0
    v_add_f32 v18, v19, v20
    v_rcp_f32 v18, v18
    s_nop 0
    v_mul_f32 v19, v19, v18
    v_mul_f32 v23, v20, v18
    v_mul_f32 v12, v12, v19
    s_lshl_b32 s55, s51, 20
    s_lshl_b32 s57, s3, 17
    s_add_u32 s55, s55, s57
    s_lshl_b32 s57, s35, 13
    s_add_u32 s55, s55, s57
    s_add_u32 s55, s55, 50331648
    s_add_u32 s56, s55, 0x80000
    s_mov_b32 s59, 0xffff0000
    s_waitcnt vmcnt(15)
    v_lshlrev_b32 v24, 16, v32
    v_mul_f32 v24, v24, v22
    v_fma_f32 v128, v128, v11, v24
    v_and_b32 v24, s59, v32
    v_mul_f32 v24, v24, v22
    v_fma_f32 v129, v129, v11, v24
    v_lshlrev_b32 v24, 16, v33
    v_mul_f32 v24, v24, v22
    v_fma_f32 v130, v130, v11, v24
    v_and_b32 v24, s59, v33
    v_mul_f32 v24, v24, v22
    v_fma_f32 v131, v131, v11, v24
    v_lshlrev_b32 v24, 16, v34
    v_mul_f32 v24, v24, v22
    v_fma_f32 v132, v132, v11, v24
    v_and_b32 v24, s59, v34
    v_mul_f32 v24, v24, v22
    v_fma_f32 v133, v133, v11, v24
    v_lshlrev_b32 v24, 16, v35
    v_mul_f32 v24, v24, v22
    v_fma_f32 v134, v134, v11, v24
    v_and_b32 v24, s59, v35
    v_mul_f32 v24, v24, v22
    v_fma_f32 v135, v135, v11, v24
    v_cvt_pk_bf16_f32 v128, v128, v129
    v_cvt_pk_bf16_f32 v129, v130, v131
    v_cvt_pk_bf16_f32 v130, v132, v133
    v_cvt_pk_bf16_f32 v131, v134, v135
    buffer_store_dwordx4 v[128:131], v1, s[12:15], s55 offen offset:0
    s_waitcnt vmcnt(15)
    v_lshlrev_b32 v24, 16, v36
    v_mul_f32 v24, v24, v22
    v_fma_f32 v136, v136, v11, v24
    v_and_b32 v24, s59, v36
    v_mul_f32 v24, v24, v22
    v_fma_f32 v137, v137, v11, v24
    v_lshlrev_b32 v24, 16, v37
    v_mul_f32 v24, v24, v22
    v_fma_f32 v138, v138, v11, v24
    v_and_b32 v24, s59, v37
    v_mul_f32 v24, v24, v22
    v_fma_f32 v139, v139, v11, v24
    v_lshlrev_b32 v24, 16, v38
    v_mul_f32 v24, v24, v22
    v_fma_f32 v140, v140, v11, v24
    v_and_b32 v24, s59, v38
    v_mul_f32 v24, v24, v22
    v_fma_f32 v141, v141, v11, v24
    v_lshlrev_b32 v24, 16, v39
    v_mul_f32 v24, v24, v22
    v_fma_f32 v142, v142, v11, v24
    v_and_b32 v24, s59, v39
    v_mul_f32 v24, v24, v22
    v_fma_f32 v143, v143, v11, v24
    v_cvt_pk_bf16_f32 v136, v136, v137
    v_cvt_pk_bf16_f32 v137, v138, v139
    v_cvt_pk_bf16_f32 v138, v140, v141
    v_cvt_pk_bf16_f32 v139, v142, v143
    buffer_store_dwordx4 v[136:139], v1, s[12:15], s55 offen offset:1024
    s_waitcnt vmcnt(15)
    v_lshlrev_b32 v24, 16, v40
    v_mul_f32 v24, v24, v22
    v_fma_f32 v144, v144, v11, v24
    v_and_b32 v24, s59, v40
    v_mul_f32 v24, v24, v22
    v_fma_f32 v145, v145, v11, v24
    v_lshlrev_b32 v24, 16, v41
    v_mul_f32 v24, v24, v22
    v_fma_f32 v146, v146, v11, v24
    v_and_b32 v24, s59, v41
    v_mul_f32 v24, v24, v22
    v_fma_f32 v147, v147, v11, v24
    v_lshlrev_b32 v24, 16, v42
    v_mul_f32 v24, v24, v22
    v_fma_f32 v148, v148, v11, v24
    v_and_b32 v24, s59, v42
    v_mul_f32 v24, v24, v22
    v_fma_f32 v149, v149, v11, v24
    v_lshlrev_b32 v24, 16, v43
    v_mul_f32 v24, v24, v22
    v_fma_f32 v150, v150, v11, v24
    v_and_b32 v24, s59, v43
    v_mul_f32 v24, v24, v22
    v_fma_f32 v151, v151, v11, v24
    v_cvt_pk_bf16_f32 v144, v144, v145
    v_cvt_pk_bf16_f32 v145, v146, v147
    v_cvt_pk_bf16_f32 v146, v148, v149
    v_cvt_pk_bf16_f32 v147, v150, v151
    buffer_store_dwordx4 v[144:147], v1, s[12:15], s55 offen offset:2048
    s_waitcnt vmcnt(15)
    v_lshlrev_b32 v24, 16, v44
    v_mul_f32 v24, v24, v22
    v_fma_f32 v152, v152, v11, v24
    v_and_b32 v24, s59, v44
    v_mul_f32 v24, v24, v22
    v_fma_f32 v153, v153, v11, v24
    v_lshlrev_b32 v24, 16, v45
    v_mul_f32 v24, v24, v22
    v_fma_f32 v154, v154, v11, v24
    v_and_b32 v24, s59, v45
    v_mul_f32 v24, v24, v22
    v_fma_f32 v155, v155, v11, v24
    v_lshlrev_b32 v24, 16, v46
    v_mul_f32 v24, v24, v22
    v_fma_f32 v156, v156, v11, v24
    v_and_b32 v24, s59, v46
    v_mul_f32 v24, v24, v22
    v_fma_f32 v157, v157, v11, v24
    v_lshlrev_b32 v24, 16, v47
    v_mul_f32 v24, v24, v22
    v_fma_f32 v158, v158, v11, v24
    v_and_b32 v24, s59, v47
    v_mul_f32 v24, v24, v22
    v_fma_f32 v159, v159, v11, v24
    v_cvt_pk_bf16_f32 v152, v152, v153
    v_cvt_pk_bf16_f32 v153, v154, v155
    v_cvt_pk_bf16_f32 v154, v156, v157
    v_cvt_pk_bf16_f32 v155, v158, v159
    buffer_store_dwordx4 v[152:155], v1, s[12:15], s55 offen offset:3072
    s_waitcnt vmcnt(15)
    v_lshlrev_b32 v24, 16, v48
    v_mul_f32 v24, v24, v22
    v_fma_f32 v160, v160, v11, v24
    v_and_b32 v24, s59, v48
    v_mul_f32 v24, v24, v22
    v_fma_f32 v161, v161, v11, v24
    v_lshlrev_b32 v24, 16, v49
    v_mul_f32 v24, v24, v22
    v_fma_f32 v162, v162, v11, v24
    v_and_b32 v24, s59, v49
    v_mul_f32 v24, v24, v22
    v_fma_f32 v163, v163, v11, v24
    v_lshlrev_b32 v24, 16, v50
    v_mul_f32 v24, v24, v22
    v_fma_f32 v164, v164, v11, v24
    v_and_b32 v24, s59, v50
    v_mul_f32 v24, v24, v22
    v_fma_f32 v165, v165, v11, v24
    v_lshlrev_b32 v24, 16, v51
    v_mul_f32 v24, v24, v22
    v_fma_f32 v166, v166, v11, v24
    v_and_b32 v24, s59, v51
    v_mul_f32 v24, v24, v22
    v_fma_f32 v167, v167, v11, v24
    v_cvt_pk_bf16_f32 v160, v160, v161
    v_cvt_pk_bf16_f32 v161, v162, v163
    v_cvt_pk_bf16_f32 v162, v164, v165
    v_cvt_pk_bf16_f32 v163, v166, v167
    buffer_store_dwordx4 v[160:163], v4, s[12:15], s55 offen offset:0
    s_waitcnt vmcnt(15)
    v_lshlrev_b32 v24, 16, v52
    v_mul_f32 v24, v24, v22
    v_fma_f32 v168, v168, v11, v24
    v_and_b32 v24, s59, v52
    v_mul_f32 v24, v24, v22
    v_fma_f32 v169, v169, v11, v24
    v_lshlrev_b32 v24, 16, v53
    v_mul_f32 v24, v24, v22
    v_fma_f32 v170, v170, v11, v24
    v_and_b32 v24, s59, v53
    v_mul_f32 v24, v24, v22
    v_fma_f32 v171, v171, v11, v24
    v_lshlrev_b32 v24, 16, v54
    v_mul_f32 v24, v24, v22
    v_fma_f32 v172, v172, v11, v24
    v_and_b32 v24, s59, v54
    v_mul_f32 v24, v24, v22
    v_fma_f32 v173, v173, v11, v24
    v_lshlrev_b32 v24, 16, v55
    v_mul_f32 v24, v24, v22
    v_fma_f32 v174, v174, v11, v24
    v_and_b32 v24, s59, v55
    v_mul_f32 v24, v24, v22
    v_fma_f32 v175, v175, v11, v24
    v_cvt_pk_bf16_f32 v168, v168, v169
    v_cvt_pk_bf16_f32 v169, v170, v171
    v_cvt_pk_bf16_f32 v170, v172, v173
    v_cvt_pk_bf16_f32 v171, v174, v175
    buffer_store_dwordx4 v[168:171], v4, s[12:15], s55 offen offset:1024
    s_waitcnt vmcnt(15)
    v_lshlrev_b32 v24, 16, v56
    v_mul_f32 v24, v24, v22
    v_fma_f32 v176, v176, v11, v24
    v_and_b32 v24, s59, v56
    v_mul_f32 v24, v24, v22
    v_fma_f32 v177, v177, v11, v24
    v_lshlrev_b32 v24, 16, v57
    v_mul_f32 v24, v24, v22
    v_fma_f32 v178, v178, v11, v24
    v_and_b32 v24, s59, v57
    v_mul_f32 v24, v24, v22
    v_fma_f32 v179, v179, v11, v24
    v_lshlrev_b32 v24, 16, v58
    v_mul_f32 v24, v24, v22
    v_fma_f32 v180, v180, v11, v24
    v_and_b32 v24, s59, v58
    v_mul_f32 v24, v24, v22
    v_fma_f32 v181, v181, v11, v24
    v_lshlrev_b32 v24, 16, v59
    v_mul_f32 v24, v24, v22
    v_fma_f32 v182, v182, v11, v24
    v_and_b32 v24, s59, v59
    v_mul_f32 v24, v24, v22
    v_fma_f32 v183, v183, v11, v24
    v_cvt_pk_bf16_f32 v176, v176, v177
    v_cvt_pk_bf16_f32 v177, v178, v179
    v_cvt_pk_bf16_f32 v178, v180, v181
    v_cvt_pk_bf16_f32 v179, v182, v183
    buffer_store_dwordx4 v[176:179], v4, s[12:15], s55 offen offset:2048
    s_waitcnt vmcnt(15)
    v_lshlrev_b32 v24, 16, v60
    v_mul_f32 v24, v24, v22
    v_fma_f32 v184, v184, v11, v24
    v_and_b32 v24, s59, v60
    v_mul_f32 v24, v24, v22
    v_fma_f32 v185, v185, v11, v24
    v_lshlrev_b32 v24, 16, v61
    v_mul_f32 v24, v24, v22
    v_fma_f32 v186, v186, v11, v24
    v_and_b32 v24, s59, v61
    v_mul_f32 v24, v24, v22
    v_fma_f32 v187, v187, v11, v24
    v_lshlrev_b32 v24, 16, v62
    v_mul_f32 v24, v24, v22
    v_fma_f32 v188, v188, v11, v24
    v_and_b32 v24, s59, v62
    v_mul_f32 v24, v24, v22
    v_fma_f32 v189, v189, v11, v24
    v_lshlrev_b32 v24, 16, v63
    v_mul_f32 v24, v24, v22
    v_fma_f32 v190, v190, v11, v24
    v_and_b32 v24, s59, v63
    v_mul_f32 v24, v24, v22
    v_fma_f32 v191, v191, v11, v24
    v_cvt_pk_bf16_f32 v184, v184, v185
    v_cvt_pk_bf16_f32 v185, v186, v187
    v_cvt_pk_bf16_f32 v186, v188, v189
    v_cvt_pk_bf16_f32 v187, v190, v191
    buffer_store_dwordx4 v[184:187], v4, s[12:15], s55 offen offset:3072
    s_waitcnt vmcnt(15)
    v_lshlrev_b32 v24, 16, v64
    v_mul_f32 v24, v24, v23
    v_fma_f32 v192, v192, v12, v24
    v_and_b32 v24, s59, v64
    v_mul_f32 v24, v24, v23
    v_fma_f32 v193, v193, v12, v24
    v_lshlrev_b32 v24, 16, v65
    v_mul_f32 v24, v24, v23
    v_fma_f32 v194, v194, v12, v24
    v_and_b32 v24, s59, v65
    v_mul_f32 v24, v24, v23
    v_fma_f32 v195, v195, v12, v24
    v_lshlrev_b32 v24, 16, v66
    v_mul_f32 v24, v24, v23
    v_fma_f32 v196, v196, v12, v24
    v_and_b32 v24, s59, v66
    v_mul_f32 v24, v24, v23
    v_fma_f32 v197, v197, v12, v24
    v_lshlrev_b32 v24, 16, v67
    v_mul_f32 v24, v24, v23
    v_fma_f32 v198, v198, v12, v24
    v_and_b32 v24, s59, v67
    v_mul_f32 v24, v24, v23
    v_fma_f32 v199, v199, v12, v24
    v_cvt_pk_bf16_f32 v192, v192, v193
    v_cvt_pk_bf16_f32 v193, v194, v195
    v_cvt_pk_bf16_f32 v194, v196, v197
    v_cvt_pk_bf16_f32 v195, v198, v199
    buffer_store_dwordx4 v[192:195], v1, s[12:15], s56 offen offset:0
    s_waitcnt vmcnt(15)
    v_lshlrev_b32 v24, 16, v68
    v_mul_f32 v24, v24, v23
    v_fma_f32 v200, v200, v12, v24
    v_and_b32 v24, s59, v68
    v_mul_f32 v24, v24, v23
    v_fma_f32 v201, v201, v12, v24
    v_lshlrev_b32 v24, 16, v69
    v_mul_f32 v24, v24, v23
    v_fma_f32 v202, v202, v12, v24
    v_and_b32 v24, s59, v69
    v_mul_f32 v24, v24, v23
    v_fma_f32 v203, v203, v12, v24
    v_lshlrev_b32 v24, 16, v70
    v_mul_f32 v24, v24, v23
    v_fma_f32 v204, v204, v12, v24
    v_and_b32 v24, s59, v70
    v_mul_f32 v24, v24, v23
    v_fma_f32 v205, v205, v12, v24
    v_lshlrev_b32 v24, 16, v71
    v_mul_f32 v24, v24, v23
    v_fma_f32 v206, v206, v12, v24
    v_and_b32 v24, s59, v71
    v_mul_f32 v24, v24, v23
    v_fma_f32 v207, v207, v12, v24
    v_cvt_pk_bf16_f32 v200, v200, v201
    v_cvt_pk_bf16_f32 v201, v202, v203
    v_cvt_pk_bf16_f32 v202, v204, v205
    v_cvt_pk_bf16_f32 v203, v206, v207
    buffer_store_dwordx4 v[200:203], v1, s[12:15], s56 offen offset:1024
    s_waitcnt vmcnt(15)
    v_lshlrev_b32 v24, 16, v72
    v_mul_f32 v24, v24, v23
    v_fma_f32 v208, v208, v12, v24
    v_and_b32 v24, s59, v72
    v_mul_f32 v24, v24, v23
    v_fma_f32 v209, v209, v12, v24
    v_lshlrev_b32 v24, 16, v73
    v_mul_f32 v24, v24, v23
    v_fma_f32 v210, v210, v12, v24
    v_and_b32 v24, s59, v73
    v_mul_f32 v24, v24, v23
    v_fma_f32 v211, v211, v12, v24
    v_lshlrev_b32 v24, 16, v74
    v_mul_f32 v24, v24, v23
    v_fma_f32 v212, v212, v12, v24
    v_and_b32 v24, s59, v74
    v_mul_f32 v24, v24, v23
    v_fma_f32 v213, v213, v12, v24
    v_lshlrev_b32 v24, 16, v75
    v_mul_f32 v24, v24, v23
    v_fma_f32 v214, v214, v12, v24
    v_and_b32 v24, s59, v75
    v_mul_f32 v24, v24, v23
    v_fma_f32 v215, v215, v12, v24
    v_cvt_pk_bf16_f32 v208, v208, v209
    v_cvt_pk_bf16_f32 v209, v210, v211
    v_cvt_pk_bf16_f32 v210, v212, v213
    v_cvt_pk_bf16_f32 v211, v214, v215
    buffer_store_dwordx4 v[208:211], v1, s[12:15], s56 offen offset:2048
    s_waitcnt vmcnt(15)
    v_lshlrev_b32 v24, 16, v76
    v_mul_f32 v24, v24, v23
    v_fma_f32 v216, v216, v12, v24
    v_and_b32 v24, s59, v76
    v_mul_f32 v24, v24, v23
    v_fma_f32 v217, v217, v12, v24
    v_lshlrev_b32 v24, 16, v77
    v_mul_f32 v24, v24, v23
    v_fma_f32 v218, v218, v12, v24
    v_and_b32 v24, s59, v77
    v_mul_f32 v24, v24, v23
    v_fma_f32 v219, v219, v12, v24
    v_lshlrev_b32 v24, 16, v78
    v_mul_f32 v24, v24, v23
    v_fma_f32 v220, v220, v12, v24
    v_and_b32 v24, s59, v78
    v_mul_f32 v24, v24, v23
    v_fma_f32 v221, v221, v12, v24
    v_lshlrev_b32 v24, 16, v79
    v_mul_f32 v24, v24, v23
    v_fma_f32 v222, v222, v12, v24
    v_and_b32 v24, s59, v79
    v_mul_f32 v24, v24, v23
    v_fma_f32 v223, v223, v12, v24
    v_cvt_pk_bf16_f32 v216, v216, v217
    v_cvt_pk_bf16_f32 v217, v218, v219
    v_cvt_pk_bf16_f32 v218, v220, v221
    v_cvt_pk_bf16_f32 v219, v222, v223
    buffer_store_dwordx4 v[216:219], v1, s[12:15], s56 offen offset:3072
    s_waitcnt vmcnt(15)
    v_lshlrev_b32 v24, 16, v80
    v_mul_f32 v24, v24, v23
    v_fma_f32 v224, v224, v12, v24
    v_and_b32 v24, s59, v80
    v_mul_f32 v24, v24, v23
    v_fma_f32 v225, v225, v12, v24
    v_lshlrev_b32 v24, 16, v81
    v_mul_f32 v24, v24, v23
    v_fma_f32 v226, v226, v12, v24
    v_and_b32 v24, s59, v81
    v_mul_f32 v24, v24, v23
    v_fma_f32 v227, v227, v12, v24
    v_lshlrev_b32 v24, 16, v82
    v_mul_f32 v24, v24, v23
    v_fma_f32 v228, v228, v12, v24
    v_and_b32 v24, s59, v82
    v_mul_f32 v24, v24, v23
    v_fma_f32 v229, v229, v12, v24
    v_lshlrev_b32 v24, 16, v83
    v_mul_f32 v24, v24, v23
    v_fma_f32 v230, v230, v12, v24
    v_and_b32 v24, s59, v83
    v_mul_f32 v24, v24, v23
    v_fma_f32 v231, v231, v12, v24
    v_cvt_pk_bf16_f32 v224, v224, v225
    v_cvt_pk_bf16_f32 v225, v226, v227
    v_cvt_pk_bf16_f32 v226, v228, v229
    v_cvt_pk_bf16_f32 v227, v230, v231
    buffer_store_dwordx4 v[224:227], v4, s[12:15], s56 offen offset:0
    s_waitcnt vmcnt(15)
    v_lshlrev_b32 v24, 16, v84
    v_mul_f32 v24, v24, v23
    v_fma_f32 v232, v232, v12, v24
    v_and_b32 v24, s59, v84
    v_mul_f32 v24, v24, v23
    v_fma_f32 v233, v233, v12, v24
    v_lshlrev_b32 v24, 16, v85
    v_mul_f32 v24, v24, v23
    v_fma_f32 v234, v234, v12, v24
    v_and_b32 v24, s59, v85
    v_mul_f32 v24, v24, v23
    v_fma_f32 v235, v235, v12, v24
    v_lshlrev_b32 v24, 16, v86
    v_mul_f32 v24, v24, v23
    v_fma_f32 v236, v236, v12, v24
    v_and_b32 v24, s59, v86
    v_mul_f32 v24, v24, v23
    v_fma_f32 v237, v237, v12, v24
    v_lshlrev_b32 v24, 16, v87
    v_mul_f32 v24, v24, v23
    v_fma_f32 v238, v238, v12, v24
    v_and_b32 v24, s59, v87
    v_mul_f32 v24, v24, v23
    v_fma_f32 v239, v239, v12, v24
    v_cvt_pk_bf16_f32 v232, v232, v233
    v_cvt_pk_bf16_f32 v233, v234, v235
    v_cvt_pk_bf16_f32 v234, v236, v237
    v_cvt_pk_bf16_f32 v235, v238, v239
    buffer_store_dwordx4 v[232:235], v4, s[12:15], s56 offen offset:1024
    s_waitcnt vmcnt(15)
    v_lshlrev_b32 v24, 16, v88
    v_mul_f32 v24, v24, v23
    v_fma_f32 v240, v240, v12, v24
    v_and_b32 v24, s59, v88
    v_mul_f32 v24, v24, v23
    v_fma_f32 v241, v241, v12, v24
    v_lshlrev_b32 v24, 16, v89
    v_mul_f32 v24, v24, v23
    v_fma_f32 v242, v242, v12, v24
    v_and_b32 v24, s59, v89
    v_mul_f32 v24, v24, v23
    v_fma_f32 v243, v243, v12, v24
    v_lshlrev_b32 v24, 16, v90
    v_mul_f32 v24, v24, v23
    v_fma_f32 v244, v244, v12, v24
    v_and_b32 v24, s59, v90
    v_mul_f32 v24, v24, v23
    v_fma_f32 v245, v245, v12, v24
    v_lshlrev_b32 v24, 16, v91
    v_mul_f32 v24, v24, v23
    v_fma_f32 v246, v246, v12, v24
    v_and_b32 v24, s59, v91
    v_mul_f32 v24, v24, v23
    v_fma_f32 v247, v247, v12, v24
    v_cvt_pk_bf16_f32 v240, v240, v241
    v_cvt_pk_bf16_f32 v241, v242, v243
    v_cvt_pk_bf16_f32 v242, v244, v245
    v_cvt_pk_bf16_f32 v243, v246, v247
    buffer_store_dwordx4 v[240:243], v4, s[12:15], s56 offen offset:2048
    s_waitcnt vmcnt(15)
    v_lshlrev_b32 v24, 16, v92
    v_mul_f32 v24, v24, v23
    v_fma_f32 v248, v248, v12, v24
    v_and_b32 v24, s59, v92
    v_mul_f32 v24, v24, v23
    v_fma_f32 v249, v249, v12, v24
    v_lshlrev_b32 v24, 16, v93
    v_mul_f32 v24, v24, v23
    v_fma_f32 v250, v250, v12, v24
    v_and_b32 v24, s59, v93
    v_mul_f32 v24, v24, v23
    v_fma_f32 v251, v251, v12, v24
    v_lshlrev_b32 v24, 16, v94
    v_mul_f32 v24, v24, v23
    v_fma_f32 v252, v252, v12, v24
    v_and_b32 v24, s59, v94
    v_mul_f32 v24, v24, v23
    v_fma_f32 v253, v253, v12, v24
    v_lshlrev_b32 v24, 16, v95
    v_mul_f32 v24, v24, v23
    v_fma_f32 v254, v254, v12, v24
    v_and_b32 v24, s59, v95
    v_mul_f32 v24, v24, v23
    v_fma_f32 v255, v255, v12, v24
    v_cvt_pk_bf16_f32 v248, v248, v249
    v_cvt_pk_bf16_f32 v249, v250, v251
    v_cvt_pk_bf16_f32 v250, v252, v253
    v_cvt_pk_bf16_f32 v251, v254, v255
    buffer_store_dwordx4 v[248:251], v4, s[12:15], s56 offen offset:3072
    s_branch k2_kernel_done
k2_kernel_store:
    s_lshl_b32 s55, s51, 20
    s_lshl_b32 s57, s3, 17
    s_add_u32 s55, s55, s57
    s_lshl_b32 s57, s35, 13
    s_add_u32 s55, s55, s57
    s_add_u32 s55, s55, 50331648
    s_add_u32 s56, s55, 0x80000
    v_mul_f32 v128, v128, v11
    v_mul_f32 v129, v129, v11
    v_mul_f32 v130, v130, v11
    v_mul_f32 v131, v131, v11
    v_mul_f32 v132, v132, v11
    v_mul_f32 v133, v133, v11
    v_mul_f32 v134, v134, v11
    v_mul_f32 v135, v135, v11
    v_cvt_pk_bf16_f32 v128, v128, v129
    v_cvt_pk_bf16_f32 v129, v130, v131
    v_cvt_pk_bf16_f32 v130, v132, v133
    v_cvt_pk_bf16_f32 v131, v134, v135
    buffer_store_dwordx4 v[128:131], v1, s[12:15], s55 offen offset:0
    v_mul_f32 v136, v136, v11
    v_mul_f32 v137, v137, v11
    v_mul_f32 v138, v138, v11
    v_mul_f32 v139, v139, v11
    v_mul_f32 v140, v140, v11
    v_mul_f32 v141, v141, v11
    v_mul_f32 v142, v142, v11
    v_mul_f32 v143, v143, v11
    v_cvt_pk_bf16_f32 v136, v136, v137
    v_cvt_pk_bf16_f32 v137, v138, v139
    v_cvt_pk_bf16_f32 v138, v140, v141
    v_cvt_pk_bf16_f32 v139, v142, v143
    buffer_store_dwordx4 v[136:139], v1, s[12:15], s55 offen offset:1024
    v_mul_f32 v144, v144, v11
    v_mul_f32 v145, v145, v11
    v_mul_f32 v146, v146, v11
    v_mul_f32 v147, v147, v11
    v_mul_f32 v148, v148, v11
    v_mul_f32 v149, v149, v11
    v_mul_f32 v150, v150, v11
    v_mul_f32 v151, v151, v11
    v_cvt_pk_bf16_f32 v144, v144, v145
    v_cvt_pk_bf16_f32 v145, v146, v147
    v_cvt_pk_bf16_f32 v146, v148, v149
    v_cvt_pk_bf16_f32 v147, v150, v151
    buffer_store_dwordx4 v[144:147], v1, s[12:15], s55 offen offset:2048
    v_mul_f32 v152, v152, v11
    v_mul_f32 v153, v153, v11
    v_mul_f32 v154, v154, v11
    v_mul_f32 v155, v155, v11
    v_mul_f32 v156, v156, v11
    v_mul_f32 v157, v157, v11
    v_mul_f32 v158, v158, v11
    v_mul_f32 v159, v159, v11
    v_cvt_pk_bf16_f32 v152, v152, v153
    v_cvt_pk_bf16_f32 v153, v154, v155
    v_cvt_pk_bf16_f32 v154, v156, v157
    v_cvt_pk_bf16_f32 v155, v158, v159
    buffer_store_dwordx4 v[152:155], v1, s[12:15], s55 offen offset:3072
    v_mul_f32 v160, v160, v11
    v_mul_f32 v161, v161, v11
    v_mul_f32 v162, v162, v11
    v_mul_f32 v163, v163, v11
    v_mul_f32 v164, v164, v11
    v_mul_f32 v165, v165, v11
    v_mul_f32 v166, v166, v11
    v_mul_f32 v167, v167, v11
    v_cvt_pk_bf16_f32 v160, v160, v161
    v_cvt_pk_bf16_f32 v161, v162, v163
    v_cvt_pk_bf16_f32 v162, v164, v165
    v_cvt_pk_bf16_f32 v163, v166, v167
    buffer_store_dwordx4 v[160:163], v4, s[12:15], s55 offen offset:0
    v_mul_f32 v168, v168, v11
    v_mul_f32 v169, v169, v11
    v_mul_f32 v170, v170, v11
    v_mul_f32 v171, v171, v11
    v_mul_f32 v172, v172, v11
    v_mul_f32 v173, v173, v11
    v_mul_f32 v174, v174, v11
    v_mul_f32 v175, v175, v11
    v_cvt_pk_bf16_f32 v168, v168, v169
    v_cvt_pk_bf16_f32 v169, v170, v171
    v_cvt_pk_bf16_f32 v170, v172, v173
    v_cvt_pk_bf16_f32 v171, v174, v175
    buffer_store_dwordx4 v[168:171], v4, s[12:15], s55 offen offset:1024
    v_mul_f32 v176, v176, v11
    v_mul_f32 v177, v177, v11
    v_mul_f32 v178, v178, v11
    v_mul_f32 v179, v179, v11
    v_mul_f32 v180, v180, v11
    v_mul_f32 v181, v181, v11
    v_mul_f32 v182, v182, v11
    v_mul_f32 v183, v183, v11
    v_cvt_pk_bf16_f32 v176, v176, v177
    v_cvt_pk_bf16_f32 v177, v178, v179
    v_cvt_pk_bf16_f32 v178, v180, v181
    v_cvt_pk_bf16_f32 v179, v182, v183
    buffer_store_dwordx4 v[176:179], v4, s[12:15], s55 offen offset:2048
    v_mul_f32 v184, v184, v11
    v_mul_f32 v185, v185, v11
    v_mul_f32 v186, v186, v11
    v_mul_f32 v187, v187, v11
    v_mul_f32 v188, v188, v11
    v_mul_f32 v189, v189, v11
    v_mul_f32 v190, v190, v11
    v_mul_f32 v191, v191, v11
    v_cvt_pk_bf16_f32 v184, v184, v185
    v_cvt_pk_bf16_f32 v185, v186, v187
    v_cvt_pk_bf16_f32 v186, v188, v189
    v_cvt_pk_bf16_f32 v187, v190, v191
    buffer_store_dwordx4 v[184:187], v4, s[12:15], s55 offen offset:3072
    v_mul_f32 v192, v192, v12
    v_mul_f32 v193, v193, v12
    v_mul_f32 v194, v194, v12
    v_mul_f32 v195, v195, v12
    v_mul_f32 v196, v196, v12
    v_mul_f32 v197, v197, v12
    v_mul_f32 v198, v198, v12
    v_mul_f32 v199, v199, v12
    v_cvt_pk_bf16_f32 v192, v192, v193
    v_cvt_pk_bf16_f32 v193, v194, v195
    v_cvt_pk_bf16_f32 v194, v196, v197
    v_cvt_pk_bf16_f32 v195, v198, v199
    buffer_store_dwordx4 v[192:195], v1, s[12:15], s56 offen offset:0
    v_mul_f32 v200, v200, v12
    v_mul_f32 v201, v201, v12
    v_mul_f32 v202, v202, v12
    v_mul_f32 v203, v203, v12
    v_mul_f32 v204, v204, v12
    v_mul_f32 v205, v205, v12
    v_mul_f32 v206, v206, v12
    v_mul_f32 v207, v207, v12
    v_cvt_pk_bf16_f32 v200, v200, v201
    v_cvt_pk_bf16_f32 v201, v202, v203
    v_cvt_pk_bf16_f32 v202, v204, v205
    v_cvt_pk_bf16_f32 v203, v206, v207
    buffer_store_dwordx4 v[200:203], v1, s[12:15], s56 offen offset:1024
    v_mul_f32 v208, v208, v12
    v_mul_f32 v209, v209, v12
    v_mul_f32 v210, v210, v12
    v_mul_f32 v211, v211, v12
    v_mul_f32 v212, v212, v12
    v_mul_f32 v213, v213, v12
    v_mul_f32 v214, v214, v12
    v_mul_f32 v215, v215, v12
    v_cvt_pk_bf16_f32 v208, v208, v209
    v_cvt_pk_bf16_f32 v209, v210, v211
    v_cvt_pk_bf16_f32 v210, v212, v213
    v_cvt_pk_bf16_f32 v211, v214, v215
    buffer_store_dwordx4 v[208:211], v1, s[12:15], s56 offen offset:2048
    v_mul_f32 v216, v216, v12
    v_mul_f32 v217, v217, v12
    v_mul_f32 v218, v218, v12
    v_mul_f32 v219, v219, v12
    v_mul_f32 v220, v220, v12
    v_mul_f32 v221, v221, v12
    v_mul_f32 v222, v222, v12
    v_mul_f32 v223, v223, v12
    v_cvt_pk_bf16_f32 v216, v216, v217
    v_cvt_pk_bf16_f32 v217, v218, v219
    v_cvt_pk_bf16_f32 v218, v220, v221
    v_cvt_pk_bf16_f32 v219, v222, v223
    buffer_store_dwordx4 v[216:219], v1, s[12:15], s56 offen offset:3072
    v_mul_f32 v224, v224, v12
    v_mul_f32 v225, v225, v12
    v_mul_f32 v226, v226, v12
    v_mul_f32 v227, v227, v12
    v_mul_f32 v228, v228, v12
    v_mul_f32 v229, v229, v12
    v_mul_f32 v230, v230, v12
    v_mul_f32 v231, v231, v12
    v_cvt_pk_bf16_f32 v224, v224, v225
    v_cvt_pk_bf16_f32 v225, v226, v227
    v_cvt_pk_bf16_f32 v226, v228, v229
    v_cvt_pk_bf16_f32 v227, v230, v231
    buffer_store_dwordx4 v[224:227], v4, s[12:15], s56 offen offset:0
    v_mul_f32 v232, v232, v12
    v_mul_f32 v233, v233, v12
    v_mul_f32 v234, v234, v12
    v_mul_f32 v235, v235, v12
    v_mul_f32 v236, v236, v12
    v_mul_f32 v237, v237, v12
    v_mul_f32 v238, v238, v12
    v_mul_f32 v239, v239, v12
    v_cvt_pk_bf16_f32 v232, v232, v233
    v_cvt_pk_bf16_f32 v233, v234, v235
    v_cvt_pk_bf16_f32 v234, v236, v237
    v_cvt_pk_bf16_f32 v235, v238, v239
    buffer_store_dwordx4 v[232:235], v4, s[12:15], s56 offen offset:1024
    v_mul_f32 v240, v240, v12
    v_mul_f32 v241, v241, v12
    v_mul_f32 v242, v242, v12
    v_mul_f32 v243, v243, v12
    v_mul_f32 v244, v244, v12
    v_mul_f32 v245, v245, v12
    v_mul_f32 v246, v246, v12
    v_mul_f32 v247, v247, v12
    v_cvt_pk_bf16_f32 v240, v240, v241
    v_cvt_pk_bf16_f32 v241, v242, v243
    v_cvt_pk_bf16_f32 v242, v244, v245
    v_cvt_pk_bf16_f32 v243, v246, v247
    buffer_store_dwordx4 v[240:243], v4, s[12:15], s56 offen offset:2048
    v_mul_f32 v248, v248, v12
    v_mul_f32 v249, v249, v12
    v_mul_f32 v250, v250, v12
    v_mul_f32 v251, v251, v12
    v_mul_f32 v252, v252, v12
    v_mul_f32 v253, v253, v12
    v_mul_f32 v254, v254, v12
    v_mul_f32 v255, v255, v12
    v_cvt_pk_bf16_f32 v248, v248, v249
    v_cvt_pk_bf16_f32 v249, v250, v251
    v_cvt_pk_bf16_f32 v250, v252, v253
    v_cvt_pk_bf16_f32 v251, v254, v255
    buffer_store_dwordx4 v[248:251], v4, s[12:15], s56 offen offset:3072
k2_kernel_done:
k2_kernel_end:
    s_endpgm
.globl k3_kernel
.p2align 8
.type k3_kernel,@function
k3_kernel:
    s_cmp_ge_u32 s2, 224
    s_cbranch_scc1 k3_kernel_end
    s_load_dwordx2 s[20:21], s[0:1], 0
    s_load_dwordx4 s[24:27], s[0:1], 88
    s_load_dwordx2 s[30:31], s[0:1], 112
    v_lshrrev_b32 v2, 6, v0
    v_and_b32 v0, 63, v0
    v_readfirstlane_b32 s3, v2
    s_and_b32 s33, s2, 7
    s_lshl_b32 s33, s33, 2
    s_bfe_u32 s34, s2, 0x20003
    s_add_u32 s33, s33, s34
    s_lshr_b32 s34, s2, 5
    v_lshlrev_b32 v1, 4, v0
    v_lshrrev_b32 v3, 3, v0
    v_mul_u32_u24 v4, 896, v3
    v_and_b32 v3, 6, v3
    v_xor_b32 v3, v3, v0
    v_and_b32 v3, 7, v3
    v_lshl_add_u32 v3, v3, 4, v4
    v_lshrrev_b32 v8, 2, v0
    v_lshlrev_b32 v4, 7, v8
    v_bfe_u32 v8, v8, 1, 2
    v_lshl_add_u32 v4, v8, 5, v4
    v_and_b32 v8, 3, v0
    v_lshl_add_u32 v4, v8, 3, v4
    s_lshl_b32 s35, s3, 15
    v_add_u32 v4, s35, v4
    v_xor_b32 v5, 32, v4
    v_xor_b32 v6, 64, v4
    v_xor_b32 v7, 96, v4
    s_mul_i32 s36, s3, 917504
    s_lshl_b32 s41, s34, 7
    s_add_u32 s36, s36, s41
    s_lshl_b32 s37, s33, 19
    s_add_u32 s37, s37, s35
    s_add_u32 s37, s37, 50331648
    v_add_u32 v9, 131072, v1
    v_add_u32 v13, 7168, v3
    v_add_u32 v10, 262144, v1
    v_add_u32 v14, 14336, v3
    v_add_u32 v11, 393216, v1
    v_add_u32 v15, 21504, v3
    s_waitcnt lgkmcnt(0)
    s_mov_b32 s4, s24
    s_mov_b32 s5, s25
    s_mov_b32 s6, 3670016
    s_mov_b32 s7, 0x20000
    s_mov_b32 s8, s26
    s_mov_b32 s9, s27
    s_mov_b32 s10, 3670016
    s_mov_b32 s11, 0x20000
    s_mov_b32 s12, s30
    s_mov_b32 s13, s31
    s_mov_b32 s14, 268435456
    s_mov_b32 s15, 0x20000
    s_mov_b32 s16, s20
    s_mov_b32 s17, s21
    s_mov_b32 s18, 1835008
    s_mov_b32 s19, 0x20000
    s_add_u32 m0, s35, 0
    s_nop 0
    buffer_load_dwordx4 v3, s[4:7], s36 offen lds
    buffer_load_dwordx4 a[0:3], v1, s[12:15], s37 offen
    s_add_u32 m0, s35, 1024
    s_nop 0
    buffer_load_dwordx4 v13, s[4:7], s36 offen lds
    buffer_load_dwordx4 a[4:7], v9, s[12:15], s37 offen
    s_add_u32 m0, s35, 2048
    s_nop 0
    buffer_load_dwordx4 v14, s[4:7], s36 offen lds
    buffer_load_dwordx4 a[8:11], v10, s[12:15], s37 offen
    s_add_u32 m0, s35, 3072
    s_nop 0
    buffer_load_dwordx4 v15, s[4:7], s36 offen lds
    buffer_load_dwordx4 a[12:15], v11, s[12:15], s37 offen
    s_add_u32 s36, s36, 28672
    s_add_u32 s37, s37, 1024
    s_add_u32 m0, s35, 4096
    s_nop 0
    buffer_load_dwordx4 v3, s[4:7], s36 offen lds
    buffer_load_dwordx4 a[16:19], v1, s[12:15], s37 offen
    s_add_u32 m0, s35, 5120
    s_nop 0
    buffer_load_dwordx4 v13, s[4:7], s36 offen lds
    buffer_load_dwordx4 a[20:23], v9, s[12:15], s37 offen
    s_add_u32 m0, s35, 6144
    s_nop 0
    buffer_load_dwordx4 v14, s[4:7], s36 offen lds
    buffer_load_dwordx4 a[24:27], v10, s[12:15], s37 offen
    s_add_u32 m0, s35, 7168
    s_nop 0
    buffer_load_dwordx4 v15, s[4:7], s36 offen lds
    buffer_load_dwordx4 a[28:31], v11, s[12:15], s37 offen
    s_add_u32 s36, s36, 28672
    s_add_u32 s37, s37, 1024
    s_add_u32 m0, s35, 8192
    s_nop 0
    buffer_load_dwordx4 v3, s[4:7], s36 offen lds
    buffer_load_dwordx4 a[32:35], v1, s[12:15], s37 offen
    s_add_u32 m0, s35, 9216
    s_nop 0
    buffer_load_dwordx4 v13, s[4:7], s36 offen lds
    buffer_load_dwordx4 a[36:39], v9, s[12:15], s37 offen
    s_add_u32 m0, s35, 10240
    s_nop 0
    buffer_load_dwordx4 v14, s[4:7], s36 offen lds
    buffer_load_dwordx4 a[40:43], v10, s[12:15], s37 offen
    s_add_u32 m0, s35, 11264
    s_nop 0
    buffer_load_dwordx4 v15, s[4:7], s36 offen lds
    buffer_load_dwordx4 a[44:47], v11, s[12:15], s37 offen
    s_add_u32 s36, s36, 28672
    s_add_u32 s37, s37, 1024
    s_add_u32 m0, s35, 12288
    s_nop 0
    buffer_load_dwordx4 v3, s[4:7], s36 offen lds
    buffer_load_dwordx4 a[48:51], v1, s[12:15], s37 offen
    s_add_u32 m0, s35, 13312
    s_nop 0
    buffer_load_dwordx4 v13, s[4:7], s36 offen lds
    buffer_load_dwordx4 a[52:55], v9, s[12:15], s37 offen
    s_add_u32 m0, s35, 14336
    s_nop 0
    buffer_load_dwordx4 v14, s[4:7], s36 offen lds
    buffer_load_dwordx4 a[56:59], v10, s[12:15], s37 offen
    s_add_u32 m0, s35, 15360
    s_nop 0
    buffer_load_dwordx4 v15, s[4:7], s36 offen lds
    buffer_load_dwordx4 a[60:63], v11, s[12:15], s37 offen
    s_add_u32 s36, s36, 28672
    s_add_u32 s37, s37, 1024
    s_add_u32 m0, s35, 16384
    s_nop 0
    buffer_load_dwordx4 v3, s[4:7], s36 offen lds
    buffer_load_dwordx4 a[64:67], v1, s[12:15], s37 offen
    s_add_u32 m0, s35, 17408
    s_nop 0
    buffer_load_dwordx4 v13, s[4:7], s36 offen lds
    buffer_load_dwordx4 a[68:71], v9, s[12:15], s37 offen
    s_add_u32 m0, s35, 18432
    s_nop 0
    buffer_load_dwordx4 v14, s[4:7], s36 offen lds
    buffer_load_dwordx4 a[72:75], v10, s[12:15], s37 offen
    s_add_u32 m0, s35, 19456
    s_nop 0
    buffer_load_dwordx4 v15, s[4:7], s36 offen lds
    buffer_load_dwordx4 a[76:79], v11, s[12:15], s37 offen
    s_add_u32 s36, s36, 28672
    s_add_u32 s37, s37, 1024
    s_add_u32 m0, s35, 20480
    s_nop 0
    buffer_load_dwordx4 v3, s[4:7], s36 offen lds
    buffer_load_dwordx4 a[80:83], v1, s[12:15], s37 offen
    s_add_u32 m0, s35, 21504
    s_nop 0
    buffer_load_dwordx4 v13, s[4:7], s36 offen lds
    buffer_load_dwordx4 a[84:87], v9, s[12:15], s37 offen
    s_add_u32 m0, s35, 22528
    s_nop 0
    buffer_load_dwordx4 v14, s[4:7], s36 offen lds
    buffer_load_dwordx4 a[88:91], v10, s[12:15], s37 offen
    s_add_u32 m0, s35, 23552
    s_nop 0
    buffer_load_dwordx4 v15, s[4:7], s36 offen lds
    buffer_load_dwordx4 a[92:95], v11, s[12:15], s37 offen
    s_add_u32 s36, s36, 28672
    s_add_u32 s37, s37, 1024
    v_mov_b32 v64, 0
    v_mov_b32 v65, 0
    v_mov_b32 v66, 0
    v_mov_b32 v67, 0
    v_mov_b32 v68, 0
    v_mov_b32 v69, 0
    v_mov_b32 v70, 0
    v_mov_b32 v71, 0
    v_mov_b32 v72, 0
    v_mov_b32 v73, 0
    v_mov_b32 v74, 0
    v_mov_b32 v75, 0
    v_mov_b32 v76, 0
    v_mov_b32 v77, 0
    v_mov_b32 v78, 0
    v_mov_b32 v79, 0
    v_mov_b32 v80, 0
    v_mov_b32 v81, 0
    v_mov_b32 v82, 0
    v_mov_b32 v83, 0
    v_mov_b32 v84, 0
    v_mov_b32 v85, 0
    v_mov_b32 v86, 0
    v_mov_b32 v87, 0
    v_mov_b32 v88, 0
    v_mov_b32 v89, 0
    v_mov_b32 v90, 0
    v_mov_b32 v91, 0
    v_mov_b32 v92, 0
    v_mov_b32 v93, 0
    v_mov_b32 v94, 0
    v_mov_b32 v95, 0
    v_mov_b32 v96, 0
    v_mov_b32 v97, 0
    v_mov_b32 v98, 0
    v_mov_b32 v99, 0
    v_mov_b32 v100, 0
    v_mov_b32 v101, 0
    v_mov_b32 v102, 0
    v_mov_b32 v103, 0
    v_mov_b32 v104, 0
    v_mov_b32 v105, 0
    v_mov_b32 v106, 0
    v_mov_b32 v107, 0
    v_mov_b32 v108, 0
    v_mov_b32 v109, 0
    v_mov_b32 v110, 0
    v_mov_b32 v111, 0
    v_mov_b32 v112, 0
    v_mov_b32 v113, 0
    v_mov_b32 v114, 0
    v_mov_b32 v115, 0
    v_mov_b32 v116, 0
    v_mov_b32 v117, 0
    v_mov_b32 v118, 0
    v_mov_b32 v119, 0
    v_mov_b32 v120, 0
    v_mov_b32 v121, 0
    v_mov_b32 v122, 0
    v_mov_b32 v123, 0
    v_mov_b32 v124, 0
    v_mov_b32 v125, 0
    v_mov_b32 v126, 0
    v_mov_b32 v127, 0
    s_waitcnt vmcnt(40)
    ds_read_b64_tr_b16 v[32:33], v4 offset:0
    ds_read_b64_tr_b16 v[34:35], v4 offset:2048
    ds_read_b64_tr_b16 v[36:37], v5 offset:0
    ds_read_b64_tr_b16 v[38:39], v5 offset:2048
    ds_read_b64_tr_b16 v[40:41], v6 offset:0
    ds_read_b64_tr_b16 v[42:43], v6 offset:2048
    ds_read_b64_tr_b16 v[44:45], v7 offset:0
    ds_read_b64_tr_b16 v[46:47], v7 offset:2048
    s_mov_b32 s42, 0
    s_mov_b32 s43, 0xf0000000
.p2align 6
k3_kernel_loop:
    s_waitcnt vmcnt(32) lgkmcnt(0)
    v_mfma_f32_16x16x32_bf16 v[64:67], v[32:35], a[0:3], v[64:67]
    s_add_u32 m0, s35, 24576
    ds_read_b64_tr_b16 v[48:49], v4 offset:4096
    v_mfma_f32_16x16x32_bf16 v[68:71], v[32:35], a[4:7], v[68:71]
    buffer_load_dwordx4 v3, s[4:7], s36 offen lds
    v_mfma_f32_16x16x32_bf16 v[72:75], v[32:35], a[8:11], v[72:75]
    ds_read_b64_tr_b16 v[50:51], v4 offset:6144
    v_mfma_f32_16x16x32_bf16 v[76:79], v[32:35], a[12:15], v[76:79]
    buffer_load_dwordx4 a[96:99], v1, s[12:15], s37 offen
    v_mfma_f32_16x16x32_bf16 v[80:83], v[36:39], a[0:3], v[80:83]
    s_add_u32 m0, s35, 25600
    ds_read_b64_tr_b16 v[52:53], v5 offset:4096
    v_mfma_f32_16x16x32_bf16 v[84:87], v[36:39], a[4:7], v[84:87]
    buffer_load_dwordx4 v13, s[4:7], s36 offen lds
    v_mfma_f32_16x16x32_bf16 v[88:91], v[36:39], a[8:11], v[88:91]
    ds_read_b64_tr_b16 v[54:55], v5 offset:6144
    v_mfma_f32_16x16x32_bf16 v[92:95], v[36:39], a[12:15], v[92:95]
    buffer_load_dwordx4 a[100:103], v9, s[12:15], s37 offen
    v_mfma_f32_16x16x32_bf16 v[96:99], v[40:43], a[0:3], v[96:99]
    s_add_u32 m0, s35, 26624
    ds_read_b64_tr_b16 v[56:57], v6 offset:4096
    v_mfma_f32_16x16x32_bf16 v[100:103], v[40:43], a[4:7], v[100:103]
    buffer_load_dwordx4 v14, s[4:7], s36 offen lds
    v_mfma_f32_16x16x32_bf16 v[104:107], v[40:43], a[8:11], v[104:107]
    ds_read_b64_tr_b16 v[58:59], v6 offset:6144
    v_mfma_f32_16x16x32_bf16 v[108:111], v[40:43], a[12:15], v[108:111]
    buffer_load_dwordx4 a[104:107], v10, s[12:15], s37 offen
    v_mfma_f32_16x16x32_bf16 v[112:115], v[44:47], a[0:3], v[112:115]
    s_add_u32 m0, s35, 27648
    ds_read_b64_tr_b16 v[60:61], v7 offset:4096
    v_mfma_f32_16x16x32_bf16 v[116:119], v[44:47], a[4:7], v[116:119]
    buffer_load_dwordx4 v15, s[4:7], s36 offen lds
    v_mfma_f32_16x16x32_bf16 v[120:123], v[44:47], a[8:11], v[120:123]
    ds_read_b64_tr_b16 v[62:63], v7 offset:6144
    v_mfma_f32_16x16x32_bf16 v[124:127], v[44:47], a[12:15], v[124:127]
    buffer_load_dwordx4 a[108:111], v11, s[12:15], s37 offen
    s_add_u32 s36, s36, 28672
    s_add_u32 s37, s37, 1024
    s_waitcnt vmcnt(32) lgkmcnt(0)
    v_mfma_f32_16x16x32_bf16 v[64:67], v[48:51], a[16:19], v[64:67]
    s_add_u32 m0, s35, 28672
    ds_read_b64_tr_b16 v[32:33], v4 offset:8192
    v_mfma_f32_16x16x32_bf16 v[68:71], v[48:51], a[20:23], v[68:71]
    buffer_load_dwordx4 v3, s[4:7], s36 offen lds
    v_mfma_f32_16x16x32_bf16 v[72:75], v[48:51], a[24:27], v[72:75]
    ds_read_b64_tr_b16 v[34:35], v4 offset:10240
    v_mfma_f32_16x16x32_bf16 v[76:79], v[48:51], a[28:31], v[76:79]
    buffer_load_dwordx4 a[112:115], v1, s[12:15], s37 offen
    v_mfma_f32_16x16x32_bf16 v[80:83], v[52:55], a[16:19], v[80:83]
    s_add_u32 m0, s35, 29696
    ds_read_b64_tr_b16 v[36:37], v5 offset:8192
    v_mfma_f32_16x16x32_bf16 v[84:87], v[52:55], a[20:23], v[84:87]
    buffer_load_dwordx4 v13, s[4:7], s36 offen lds
    v_mfma_f32_16x16x32_bf16 v[88:91], v[52:55], a[24:27], v[88:91]
    ds_read_b64_tr_b16 v[38:39], v5 offset:10240
    v_mfma_f32_16x16x32_bf16 v[92:95], v[52:55], a[28:31], v[92:95]
    buffer_load_dwordx4 a[116:119], v9, s[12:15], s37 offen
    v_mfma_f32_16x16x32_bf16 v[96:99], v[56:59], a[16:19], v[96:99]
    s_add_u32 m0, s35, 30720
    ds_read_b64_tr_b16 v[40:41], v6 offset:8192
    v_mfma_f32_16x16x32_bf16 v[100:103], v[56:59], a[20:23], v[100:103]
    buffer_load_dwordx4 v14, s[4:7], s36 offen lds
    v_mfma_f32_16x16x32_bf16 v[104:107], v[56:59], a[24:27], v[104:107]
    ds_read_b64_tr_b16 v[42:43], v6 offset:10240
    v_mfma_f32_16x16x32_bf16 v[108:111], v[56:59], a[28:31], v[108:111]
    buffer_load_dwordx4 a[120:123], v10, s[12:15], s37 offen
    v_mfma_f32_16x16x32_bf16 v[112:115], v[60:63], a[16:19], v[112:115]
    s_add_u32 m0, s35, 31744
    ds_read_b64_tr_b16 v[44:45], v7 offset:8192
    v_mfma_f32_16x16x32_bf16 v[116:119], v[60:63], a[20:23], v[116:119]
    buffer_load_dwordx4 v15, s[4:7], s36 offen lds
    v_mfma_f32_16x16x32_bf16 v[120:123], v[60:63], a[24:27], v[120:123]
    ds_read_b64_tr_b16 v[46:47], v7 offset:10240
    v_mfma_f32_16x16x32_bf16 v[124:127], v[60:63], a[28:31], v[124:127]
    buffer_load_dwordx4 a[124:127], v11, s[12:15], s37 offen
    s_add_u32 s36, s36, 28672
    s_add_u32 s37, s37, 1024
    s_cmp_eq_u32 s42, 3
    s_cmov_b32 s36, s43
    s_cmov_b32 s37, s43
    s_waitcnt vmcnt(32) lgkmcnt(0)
    v_mfma_f32_16x16x32_bf16 v[64:67], v[32:35], a[32:35], v[64:67]
    s_add_u32 m0, s35, 0
    ds_read_b64_tr_b16 v[48:49], v4 offset:12288
    v_mfma_f32_16x16x32_bf16 v[68:71], v[32:35], a[36:39], v[68:71]
    buffer_load_dwordx4 v3, s[4:7], s36 offen lds
    v_mfma_f32_16x16x32_bf16 v[72:75], v[32:35], a[40:43], v[72:75]
    ds_read_b64_tr_b16 v[50:51], v4 offset:14336
    v_mfma_f32_16x16x32_bf16 v[76:79], v[32:35], a[44:47], v[76:79]
    buffer_load_dwordx4 a[0:3], v1, s[12:15], s37 offen
    v_mfma_f32_16x16x32_bf16 v[80:83], v[36:39], a[32:35], v[80:83]
    s_add_u32 m0, s35, 1024
    ds_read_b64_tr_b16 v[52:53], v5 offset:12288
    v_mfma_f32_16x16x32_bf16 v[84:87], v[36:39], a[36:39], v[84:87]
    buffer_load_dwordx4 v13, s[4:7], s36 offen lds
    v_mfma_f32_16x16x32_bf16 v[88:91], v[36:39], a[40:43], v[88:91]
    ds_read_b64_tr_b16 v[54:55], v5 offset:14336
    v_mfma_f32_16x16x32_bf16 v[92:95], v[36:39], a[44:47], v[92:95]
    buffer_load_dwordx4 a[4:7], v9, s[12:15], s37 offen
    v_mfma_f32_16x16x32_bf16 v[96:99], v[40:43], a[32:35], v[96:99]
    s_add_u32 m0, s35, 2048
    ds_read_b64_tr_b16 v[56:57], v6 offset:12288
    v_mfma_f32_16x16x32_bf16 v[100:103], v[40:43], a[36:39], v[100:103]
    buffer_load_dwordx4 v14, s[4:7], s36 offen lds
    v_mfma_f32_16x16x32_bf16 v[104:107], v[40:43], a[40:43], v[104:107]
    ds_read_b64_tr_b16 v[58:59], v6 offset:14336
    v_mfma_f32_16x16x32_bf16 v[108:111], v[40:43], a[44:47], v[108:111]
    buffer_load_dwordx4 a[8:11], v10, s[12:15], s37 offen
    v_mfma_f32_16x16x32_bf16 v[112:115], v[44:47], a[32:35], v[112:115]
    s_add_u32 m0, s35, 3072
    ds_read_b64_tr_b16 v[60:61], v7 offset:12288
    v_mfma_f32_16x16x32_bf16 v[116:119], v[44:47], a[36:39], v[116:119]
    buffer_load_dwordx4 v15, s[4:7], s36 offen lds
    v_mfma_f32_16x16x32_bf16 v[120:123], v[44:47], a[40:43], v[120:123]
    ds_read_b64_tr_b16 v[62:63], v7 offset:14336
    v_mfma_f32_16x16x32_bf16 v[124:127], v[44:47], a[44:47], v[124:127]
    buffer_load_dwordx4 a[12:15], v11, s[12:15], s37 offen
    s_add_u32 s36, s36, 28672
    s_add_u32 s37, s37, 1024
    s_waitcnt vmcnt(32) lgkmcnt(0)
    v_mfma_f32_16x16x32_bf16 v[64:67], v[48:51], a[48:51], v[64:67]
    s_add_u32 m0, s35, 4096
    ds_read_b64_tr_b16 v[32:33], v4 offset:16384
    v_mfma_f32_16x16x32_bf16 v[68:71], v[48:51], a[52:55], v[68:71]
    buffer_load_dwordx4 v3, s[4:7], s36 offen lds
    v_mfma_f32_16x16x32_bf16 v[72:75], v[48:51], a[56:59], v[72:75]
    ds_read_b64_tr_b16 v[34:35], v4 offset:18432
    v_mfma_f32_16x16x32_bf16 v[76:79], v[48:51], a[60:63], v[76:79]
    buffer_load_dwordx4 a[16:19], v1, s[12:15], s37 offen
    v_mfma_f32_16x16x32_bf16 v[80:83], v[52:55], a[48:51], v[80:83]
    s_add_u32 m0, s35, 5120
    ds_read_b64_tr_b16 v[36:37], v5 offset:16384
    v_mfma_f32_16x16x32_bf16 v[84:87], v[52:55], a[52:55], v[84:87]
    buffer_load_dwordx4 v13, s[4:7], s36 offen lds
    v_mfma_f32_16x16x32_bf16 v[88:91], v[52:55], a[56:59], v[88:91]
    ds_read_b64_tr_b16 v[38:39], v5 offset:18432
    v_mfma_f32_16x16x32_bf16 v[92:95], v[52:55], a[60:63], v[92:95]
    buffer_load_dwordx4 a[20:23], v9, s[12:15], s37 offen
    v_mfma_f32_16x16x32_bf16 v[96:99], v[56:59], a[48:51], v[96:99]
    s_add_u32 m0, s35, 6144
    ds_read_b64_tr_b16 v[40:41], v6 offset:16384
    v_mfma_f32_16x16x32_bf16 v[100:103], v[56:59], a[52:55], v[100:103]
    buffer_load_dwordx4 v14, s[4:7], s36 offen lds
    v_mfma_f32_16x16x32_bf16 v[104:107], v[56:59], a[56:59], v[104:107]
    ds_read_b64_tr_b16 v[42:43], v6 offset:18432
    v_mfma_f32_16x16x32_bf16 v[108:111], v[56:59], a[60:63], v[108:111]
    buffer_load_dwordx4 a[24:27], v10, s[12:15], s37 offen
    v_mfma_f32_16x16x32_bf16 v[112:115], v[60:63], a[48:51], v[112:115]
    s_add_u32 m0, s35, 7168
    ds_read_b64_tr_b16 v[44:45], v7 offset:16384
    v_mfma_f32_16x16x32_bf16 v[116:119], v[60:63], a[52:55], v[116:119]
    buffer_load_dwordx4 v15, s[4:7], s36 offen lds
    v_mfma_f32_16x16x32_bf16 v[120:123], v[60:63], a[56:59], v[120:123]
    ds_read_b64_tr_b16 v[46:47], v7 offset:18432
    v_mfma_f32_16x16x32_bf16 v[124:127], v[60:63], a[60:63], v[124:127]
    buffer_load_dwordx4 a[28:31], v11, s[12:15], s37 offen
    s_add_u32 s36, s36, 28672
    s_add_u32 s37, s37, 1024
    s_waitcnt vmcnt(32) lgkmcnt(0)
    v_mfma_f32_16x16x32_bf16 v[64:67], v[32:35], a[64:67], v[64:67]
    s_add_u32 m0, s35, 8192
    ds_read_b64_tr_b16 v[48:49], v4 offset:20480
    v_mfma_f32_16x16x32_bf16 v[68:71], v[32:35], a[68:71], v[68:71]
    buffer_load_dwordx4 v3, s[4:7], s36 offen lds
    v_mfma_f32_16x16x32_bf16 v[72:75], v[32:35], a[72:75], v[72:75]
    ds_read_b64_tr_b16 v[50:51], v4 offset:22528
    v_mfma_f32_16x16x32_bf16 v[76:79], v[32:35], a[76:79], v[76:79]
    buffer_load_dwordx4 a[32:35], v1, s[12:15], s37 offen
    v_mfma_f32_16x16x32_bf16 v[80:83], v[36:39], a[64:67], v[80:83]
    s_add_u32 m0, s35, 9216
    ds_read_b64_tr_b16 v[52:53], v5 offset:20480
    v_mfma_f32_16x16x32_bf16 v[84:87], v[36:39], a[68:71], v[84:87]
    buffer_load_dwordx4 v13, s[4:7], s36 offen lds
    v_mfma_f32_16x16x32_bf16 v[88:91], v[36:39], a[72:75], v[88:91]
    ds_read_b64_tr_b16 v[54:55], v5 offset:22528
    v_mfma_f32_16x16x32_bf16 v[92:95], v[36:39], a[76:79], v[92:95]
    buffer_load_dwordx4 a[36:39], v9, s[12:15], s37 offen
    v_mfma_f32_16x16x32_bf16 v[96:99], v[40:43], a[64:67], v[96:99]
    s_add_u32 m0, s35, 10240
    ds_read_b64_tr_b16 v[56:57], v6 offset:20480
    v_mfma_f32_16x16x32_bf16 v[100:103], v[40:43], a[68:71], v[100:103]
    buffer_load_dwordx4 v14, s[4:7], s36 offen lds
    v_mfma_f32_16x16x32_bf16 v[104:107], v[40:43], a[72:75], v[104:107]
    ds_read_b64_tr_b16 v[58:59], v6 offset:22528
    v_mfma_f32_16x16x32_bf16 v[108:111], v[40:43], a[76:79], v[108:111]
    buffer_load_dwordx4 a[40:43], v10, s[12:15], s37 offen
    v_mfma_f32_16x16x32_bf16 v[112:115], v[44:47], a[64:67], v[112:115]
    s_add_u32 m0, s35, 11264
    ds_read_b64_tr_b16 v[60:61], v7 offset:20480
    v_mfma_f32_16x16x32_bf16 v[116:119], v[44:47], a[68:71], v[116:119]
    buffer_load_dwordx4 v15, s[4:7], s36 offen lds
    v_mfma_f32_16x16x32_bf16 v[120:123], v[44:47], a[72:75], v[120:123]
    ds_read_b64_tr_b16 v[62:63], v7 offset:22528
    v_mfma_f32_16x16x32_bf16 v[124:127], v[44:47], a[76:79], v[124:127]
    buffer_load_dwordx4 a[44:47], v11, s[12:15], s37 offen
    s_add_u32 s36, s36, 28672
    s_add_u32 s37, s37, 1024
    s_waitcnt vmcnt(32) lgkmcnt(0)
    v_mfma_f32_16x16x32_bf16 v[64:67], v[48:51], a[80:83], v[64:67]
    s_add_u32 m0, s35, 12288
    ds_read_b64_tr_b16 v[32:33], v4 offset:24576
    v_mfma_f32_16x16x32_bf16 v[68:71], v[48:51], a[84:87], v[68:71]
    buffer_load_dwordx4 v3, s[4:7], s36 offen lds
    v_mfma_f32_16x16x32_bf16 v[72:75], v[48:51], a[88:91], v[72:75]
    ds_read_b64_tr_b16 v[34:35], v4 offset:26624
    v_mfma_f32_16x16x32_bf16 v[76:79], v[48:51], a[92:95], v[76:79]
    buffer_load_dwordx4 a[48:51], v1, s[12:15], s37 offen
    v_mfma_f32_16x16x32_bf16 v[80:83], v[52:55], a[80:83], v[80:83]
    s_add_u32 m0, s35, 13312
    ds_read_b64_tr_b16 v[36:37], v5 offset:24576
    v_mfma_f32_16x16x32_bf16 v[84:87], v[52:55], a[84:87], v[84:87]
    buffer_load_dwordx4 v13, s[4:7], s36 offen lds
    v_mfma_f32_16x16x32_bf16 v[88:91], v[52:55], a[88:91], v[88:91]
    ds_read_b64_tr_b16 v[38:39], v5 offset:26624
    v_mfma_f32_16x16x32_bf16 v[92:95], v[52:55], a[92:95], v[92:95]
    buffer_load_dwordx4 a[52:55], v9, s[12:15], s37 offen
    v_mfma_f32_16x16x32_bf16 v[96:99], v[56:59], a[80:83], v[96:99]
    s_add_u32 m0, s35, 14336
    ds_read_b64_tr_b16 v[40:41], v6 offset:24576
    v_mfma_f32_16x16x32_bf16 v[100:103], v[56:59], a[84:87], v[100:103]
    buffer_load_dwordx4 v14, s[4:7], s36 offen lds
    v_mfma_f32_16x16x32_bf16 v[104:107], v[56:59], a[88:91], v[104:107]
    ds_read_b64_tr_b16 v[42:43], v6 offset:26624
    v_mfma_f32_16x16x32_bf16 v[108:111], v[56:59], a[92:95], v[108:111]
    buffer_load_dwordx4 a[56:59], v10, s[12:15], s37 offen
    v_mfma_f32_16x16x32_bf16 v[112:115], v[60:63], a[80:83], v[112:115]
    s_add_u32 m0, s35, 15360
    ds_read_b64_tr_b16 v[44:45], v7 offset:24576
    v_mfma_f32_16x16x32_bf16 v[116:119], v[60:63], a[84:87], v[116:119]
    buffer_load_dwordx4 v15, s[4:7], s36 offen lds
    v_mfma_f32_16x16x32_bf16 v[120:123], v[60:63], a[88:91], v[120:123]
    ds_read_b64_tr_b16 v[46:47], v7 offset:26624
    v_mfma_f32_16x16x32_bf16 v[124:127], v[60:63], a[92:95], v[124:127]
    buffer_load_dwordx4 a[60:63], v11, s[12:15], s37 offen
    s_add_u32 s36, s36, 28672
    s_add_u32 s37, s37, 1024
    s_waitcnt vmcnt(32) lgkmcnt(0)
    v_mfma_f32_16x16x32_bf16 v[64:67], v[32:35], a[96:99], v[64:67]
    s_add_u32 m0, s35, 16384
    ds_read_b64_tr_b16 v[48:49], v4 offset:28672
    v_mfma_f32_16x16x32_bf16 v[68:71], v[32:35], a[100:103], v[68:71]
    buffer_load_dwordx4 v3, s[4:7], s36 offen lds
    v_mfma_f32_16x16x32_bf16 v[72:75], v[32:35], a[104:107], v[72:75]
    ds_read_b64_tr_b16 v[50:51], v4 offset:30720
    v_mfma_f32_16x16x32_bf16 v[76:79], v[32:35], a[108:111], v[76:79]
    buffer_load_dwordx4 a[64:67], v1, s[12:15], s37 offen
    v_mfma_f32_16x16x32_bf16 v[80:83], v[36:39], a[96:99], v[80:83]
    s_add_u32 m0, s35, 17408
    ds_read_b64_tr_b16 v[52:53], v5 offset:28672
    v_mfma_f32_16x16x32_bf16 v[84:87], v[36:39], a[100:103], v[84:87]
    buffer_load_dwordx4 v13, s[4:7], s36 offen lds
    v_mfma_f32_16x16x32_bf16 v[88:91], v[36:39], a[104:107], v[88:91]
    ds_read_b64_tr_b16 v[54:55], v5 offset:30720
    v_mfma_f32_16x16x32_bf16 v[92:95], v[36:39], a[108:111], v[92:95]
    buffer_load_dwordx4 a[68:71], v9, s[12:15], s37 offen
    v_mfma_f32_16x16x32_bf16 v[96:99], v[40:43], a[96:99], v[96:99]
    s_add_u32 m0, s35, 18432
    ds_read_b64_tr_b16 v[56:57], v6 offset:28672
    v_mfma_f32_16x16x32_bf16 v[100:103], v[40:43], a[100:103], v[100:103]
    buffer_load_dwordx4 v14, s[4:7], s36 offen lds
    v_mfma_f32_16x16x32_bf16 v[104:107], v[40:43], a[104:107], v[104:107]
    ds_read_b64_tr_b16 v[58:59], v6 offset:30720
    v_mfma_f32_16x16x32_bf16 v[108:111], v[40:43], a[108:111], v[108:111]
    buffer_load_dwordx4 a[72:75], v10, s[12:15], s37 offen
    v_mfma_f32_16x16x32_bf16 v[112:115], v[44:47], a[96:99], v[112:115]
    s_add_u32 m0, s35, 19456
    ds_read_b64_tr_b16 v[60:61], v7 offset:28672
    v_mfma_f32_16x16x32_bf16 v[116:119], v[44:47], a[100:103], v[116:119]
    buffer_load_dwordx4 v15, s[4:7], s36 offen lds
    v_mfma_f32_16x16x32_bf16 v[120:123], v[44:47], a[104:107], v[120:123]
    ds_read_b64_tr_b16 v[62:63], v7 offset:30720
    v_mfma_f32_16x16x32_bf16 v[124:127], v[44:47], a[108:111], v[124:127]
    buffer_load_dwordx4 a[76:79], v11, s[12:15], s37 offen
    s_add_u32 s36, s36, 28672
    s_add_u32 s37, s37, 1024
    s_waitcnt vmcnt(32) lgkmcnt(0)
    v_mfma_f32_16x16x32_bf16 v[64:67], v[48:51], a[112:115], v[64:67]
    s_add_u32 m0, s35, 20480
    ds_read_b64_tr_b16 v[32:33], v4 offset:0
    v_mfma_f32_16x16x32_bf16 v[68:71], v[48:51], a[116:119], v[68:71]
    buffer_load_dwordx4 v3, s[4:7], s36 offen lds
    v_mfma_f32_16x16x32_bf16 v[72:75], v[48:51], a[120:123], v[72:75]
    ds_read_b64_tr_b16 v[34:35], v4 offset:2048
    v_mfma_f32_16x16x32_bf16 v[76:79], v[48:51], a[124:127], v[76:79]
    buffer_load_dwordx4 a[80:83], v1, s[12:15], s37 offen
    v_mfma_f32_16x16x32_bf16 v[80:83], v[52:55], a[112:115], v[80:83]
    s_add_u32 m0, s35, 21504
    ds_read_b64_tr_b16 v[36:37], v5 offset:0
    v_mfma_f32_16x16x32_bf16 v[84:87], v[52:55], a[116:119], v[84:87]
    buffer_load_dwordx4 v13, s[4:7], s36 offen lds
    v_mfma_f32_16x16x32_bf16 v[88:91], v[52:55], a[120:123], v[88:91]
    ds_read_b64_tr_b16 v[38:39], v5 offset:2048
    v_mfma_f32_16x16x32_bf16 v[92:95], v[52:55], a[124:127], v[92:95]
    buffer_load_dwordx4 a[84:87], v9, s[12:15], s37 offen
    v_mfma_f32_16x16x32_bf16 v[96:99], v[56:59], a[112:115], v[96:99]
    s_add_u32 m0, s35, 22528
    ds_read_b64_tr_b16 v[40:41], v6 offset:0
    v_mfma_f32_16x16x32_bf16 v[100:103], v[56:59], a[116:119], v[100:103]
    buffer_load_dwordx4 v14, s[4:7], s36 offen lds
    v_mfma_f32_16x16x32_bf16 v[104:107], v[56:59], a[120:123], v[104:107]
    ds_read_b64_tr_b16 v[42:43], v6 offset:2048
    v_mfma_f32_16x16x32_bf16 v[108:111], v[56:59], a[124:127], v[108:111]
    buffer_load_dwordx4 a[88:91], v10, s[12:15], s37 offen
    v_mfma_f32_16x16x32_bf16 v[112:115], v[60:63], a[112:115], v[112:115]
    s_add_u32 m0, s35, 23552
    ds_read_b64_tr_b16 v[44:45], v7 offset:0
    v_mfma_f32_16x16x32_bf16 v[116:119], v[60:63], a[116:119], v[116:119]
    buffer_load_dwordx4 v15, s[4:7], s36 offen lds
    v_mfma_f32_16x16x32_bf16 v[120:123], v[60:63], a[120:123], v[120:123]
    ds_read_b64_tr_b16 v[46:47], v7 offset:2048
    v_mfma_f32_16x16x32_bf16 v[124:127], v[60:63], a[124:127], v[124:127]
    buffer_load_dwordx4 a[92:95], v11, s[12:15], s37 offen
    s_add_u32 s36, s36, 28672
    s_add_u32 s37, s37, 1024
    s_add_u32 s42, s42, 1
    s_cmp_lt_u32 s42, 4
    s_cbranch_scc1 k3_kernel_loop
    s_waitcnt vmcnt(0) lgkmcnt(0)
    v_lshrrev_b32 v8, 3, v0
    v_lshlrev_b32 v8, 12, v8
    v_and_b32 v9, 7, v0
    v_lshl_add_u32 v8, v9, 4, v8
    s_lshl_b32 s44, s34, 2
    s_add_u32 s44, s44, s3
    s_lshl_b32 s44, s44, 16
    s_lshl_b32 s45, s33, 7
    s_add_u32 s44, s44, s45
    s_add_u32 s44, s44, 90177536
    s_lshl_b32 s45, s3, 11
    s_add_u32 m0, s45, 0x20000
    s_nop 0
    buffer_load_dwordx4 v8, s[12:15], s44 offen lds
    s_add_u32 m0, s45, 0x20400
    s_add_u32 s44, s44, 0x8000
    buffer_load_dwordx4 v8, s[12:15], s44 offen lds
    s_lshl_b32 s44, s33, 6
    s_lshl_b32 s45, s3, 4
    s_add_u32 s44, s44, s45
    v_and_b32 v9, 15, v0
    v_add_u32 v9, s44, v9
    v_mul_u32_u24 v9, 896, v9
    v_lshrrev_b32 v10, 4, v0
    v_lshlrev_b32 v10, 4, v10
    v_add_u32 v10, s41, v10
    v_add_u32 v11, v9, v10
    v_lshl_add_u32 v12, v9, 1, v10
    buffer_load_dwordx4 v[16:19], v11, s[16:19], 0 offen offset:0
    buffer_load_dwordx4 v[20:23], v11, s[16:19], 0 offen offset:64
    v_and_b32 v9, 15, v0
    v_mul_u32_u24 v9, 272, v9
    v_lshrrev_b32 v10, 4, v0
    v_lshl_add_u32 v9, v10, 4, v9
    v_add_u32 v9, s35, v9
    ds_write_b128 v9, v[64:67] offset:0
    ds_write_b128 v9, v[68:71] offset:4352
    ds_write_b128 v9, v[72:75] offset:8704
    ds_write_b128 v9, v[76:79] offset:13056
    ds_write_b128 v9, v[80:83] offset:64
    ds_write_b128 v9, v[84:87] offset:4416
    ds_write_b128 v9, v[88:91] offset:8768
    ds_write_b128 v9, v[92:95] offset:13120
    ds_write_b128 v9, v[96:99] offset:128
    ds_write_b128 v9, v[100:103] offset:4480
    ds_write_b128 v9, v[104:107] offset:8832
    ds_write_b128 v9, v[108:111] offset:13184
    ds_write_b128 v9, v[112:115] offset:192
    ds_write_b128 v9, v[116:119] offset:4544
    ds_write_b128 v9, v[120:123] offset:8896
    ds_write_b128 v9, v[124:127] offset:13248
    v_lshrrev_b32 v9, 3, v0
    v_add_u32 v9, s45, v9
    v_mul_u32_u24 v13, 272, v9
    v_and_b32 v10, 7, v0
    v_lshl_add_u32 v13, v10, 5, v13
    v_add_u32 v14, 0x10000, v13
    s_lshl_b32 s44, s33, 6
    v_add_u32 v9, s44, v9
    v_mul_u32_u24 v9, 1792, v9
    v_lshl_add_u32 v9, v10, 4, v9
    s_add_u32 s46, s41, 896
    s_add_u32 s47, s46, 14336
    v_lshrrev_b32 v10, 4, v0
    v_lshlrev_b32 v10, 3, v10
    v_bfe_u32 v15, v0, 2, 2
    v_add_u32 v10, v10, v15
    v_lshlrev_b32 v10, 7, v10
    v_and_b32 v15, 3, v0
    v_lshl_add_u32 v10, v15, 3, v10
    s_lshl_b32 s48, s3, 5
    s_add_u32 s48, s48, 0x20000
    v_add_u32 v10, s48, v10
    s_mov_b32 s49, 0xffff0000
    s_waitcnt vmcnt(0) lgkmcnt(0)
    s_barrier
    ds_read_b64_tr_b16 v[24:25], v10 offset:0
    ds_read_b64_tr_b16 v[26:27], v10 offset:512
    ds_read_b64_tr_b16 v[28:29], v10 offset:4096
    ds_read_b64_tr_b16 v[30:31], v10 offset:4608
    ds_read_b128 v[64:67], v13 offset:0
    ds_read_b128 v[68:71], v13 offset:16
    ds_read_b128 v[72:75], v13 offset:32768
    ds_read_b128 v[76:79], v13 offset:32784
    ds_read_b128 v[80:83], v14 offset:0
    ds_read_b128 v[84:87], v14 offset:16
    ds_read_b128 v[88:91], v14 offset:32768
    ds_read_b128 v[92:95], v14 offset:32784
    s_waitcnt lgkmcnt(8)
    ds_read_b128 v[96:99], v13 offset:2176
    ds_read_b128 v[100:103], v13 offset:2192
    ds_read_b128 v[104:107], v13 offset:34944
    ds_read_b128 v[108:111], v13 offset:34960
    ds_read_b128 v[112:115], v14 offset:2176
    ds_read_b128 v[116:119], v14 offset:2192
    ds_read_b128 v[120:123], v14 offset:34944
    ds_read_b128 v[124:127], v14 offset:34960
    v_lshlrev_b32 v32, 16, v16
    v_lshlrev_b32 v33, 16, v24
    v_and_b32 v34, s49, v16
    v_and_b32 v35, s49, v24
    v_mul_f32 v32, v32, v33
    v_mul_f32 v34, v34, v35
    v_cvt_pk_bf16_f32 v40, v32, v34
    v_lshlrev_b32 v32, 16, v17
    v_lshlrev_b32 v33, 16, v25
    v_and_b32 v34, s49, v17
    v_and_b32 v35, s49, v25
    v_mul_f32 v32, v32, v33
    v_mul_f32 v34, v34, v35
    v_cvt_pk_bf16_f32 v41, v32, v34
    v_lshlrev_b32 v32, 16, v18
    v_lshlrev_b32 v33, 16, v26
    v_and_b32 v34, s49, v18
    v_and_b32 v35, s49, v26
    v_mul_f32 v32, v32, v33
    v_mul_f32 v34, v34, v35
    v_cvt_pk_bf16_f32 v42, v32, v34
    v_lshlrev_b32 v32, 16, v19
    v_lshlrev_b32 v33, 16, v27
    v_and_b32 v34, s49, v19
    v_and_b32 v35, s49, v27
    v_mul_f32 v32, v32, v33
    v_mul_f32 v34, v34, v35
    v_cvt_pk_bf16_f32 v43, v32, v34
    buffer_store_dwordx4 v[40:43], v12, s[8:11], 0 offen offset:0
    v_lshlrev_b32 v32, 16, v20
    v_lshlrev_b32 v33, 16, v28
    v_and_b32 v34, s49, v20
    v_and_b32 v35, s49, v28
    v_mul_f32 v32, v32, v33
    v_mul_f32 v34, v34, v35
    v_cvt_pk_bf16_f32 v44, v32, v34
    v_lshlrev_b32 v32, 16, v21
    v_lshlrev_b32 v33, 16, v29
    v_and_b32 v34, s49, v21
    v_and_b32 v35, s49, v29
    v_mul_f32 v32, v32, v33
    v_mul_f32 v34, v34, v35
    v_cvt_pk_bf16_f32 v45, v32, v34
    v_lshlrev_b32 v32, 16, v22
    v_lshlrev_b32 v33, 16, v30
    v_and_b32 v34, s49, v22
    v_and_b32 v35, s49, v30
    v_mul_f32 v32, v32, v33
    v_mul_f32 v34, v34, v35
    v_cvt_pk_bf16_f32 v46, v32, v34
    v_lshlrev_b32 v32, 16, v23
    v_lshlrev_b32 v33, 16, v31
    v_and_b32 v34, s49, v23
    v_and_b32 v35, s49, v31
    v_mul_f32 v32, v32, v33
    v_mul_f32 v34, v34, v35
    v_cvt_pk_bf16_f32 v47, v32, v34
    buffer_store_dwordx4 v[44:47], v12, s[8:11], 0 offen offset:64
    s_waitcnt lgkmcnt(0)
    v_add_f32 v64, v64, v72
    v_add_f32 v80, v80, v88
    v_add_f32 v64, v64, v80
    v_add_f32 v65, v65, v73
    v_add_f32 v81, v81, v89
    v_add_f32 v65, v65, v81
    v_add_f32 v66, v66, v74
    v_add_f32 v82, v82, v90
    v_add_f32 v66, v66, v82
    v_add_f32 v67, v67, v75
    v_add_f32 v83, v83, v91
    v_add_f32 v67, v67, v83
    v_add_f32 v68, v68, v76
    v_add_f32 v84, v84, v92
    v_add_f32 v68, v68, v84
    v_add_f32 v69, v69, v77
    v_add_f32 v85, v85, v93
    v_add_f32 v69, v69, v85
    v_add_f32 v70, v70, v78
    v_add_f32 v86, v86, v94
    v_add_f32 v70, v70, v86
    v_add_f32 v71, v71, v79
    v_add_f32 v87, v87, v95
    v_add_f32 v71, v71, v87
    v_cvt_pk_bf16_f32 v48, v64, v65
    v_cvt_pk_bf16_f32 v49, v66, v67
    v_cvt_pk_bf16_f32 v50, v68, v69
    v_cvt_pk_bf16_f32 v51, v70, v71
    buffer_store_dwordx4 v[48:51], v9, s[8:11], s46 offen
    v_add_f32 v96, v96, v104
    v_add_f32 v112, v112, v120
    v_add_f32 v96, v96, v112
    v_add_f32 v97, v97, v105
    v_add_f32 v113, v113, v121
    v_add_f32 v97, v97, v113
    v_add_f32 v98, v98, v106
    v_add_f32 v114, v114, v122
    v_add_f32 v98, v98, v114
    v_add_f32 v99, v99, v107
    v_add_f32 v115, v115, v123
    v_add_f32 v99, v99, v115
    v_add_f32 v100, v100, v108
    v_add_f32 v116, v116, v124
    v_add_f32 v100, v100, v116
    v_add_f32 v101, v101, v109
    v_add_f32 v117, v117, v125
    v_add_f32 v101, v101, v117
    v_add_f32 v102, v102, v110
    v_add_f32 v118, v118, v126
    v_add_f32 v102, v102, v118
    v_add_f32 v103, v103, v111
    v_add_f32 v119, v119, v127
    v_add_f32 v103, v103, v119
    v_cvt_pk_bf16_f32 v52, v96, v97
    v_cvt_pk_bf16_f32 v53, v98, v99
    v_cvt_pk_bf16_f32 v54, v100, v101
    v_cvt_pk_bf16_f32 v55, v102, v103
    buffer_store_dwordx4 v[52:55], v9, s[8:11], s47 offen
k3_kernel_end:
    s_endpgm
.section .rodata,"a"
.p2align 6
.amdhsa_kernel s1_kernel
  .amdhsa_next_free_vgpr 128
  .amdhsa_next_free_sgpr 102
  .amdhsa_accum_offset 128
  .amdhsa_group_segment_fixed_size 0
  .amdhsa_kernarg_size 120
  .amdhsa_user_sgpr_count 2
  .amdhsa_user_sgpr_kernarg_segment_ptr 1
  .amdhsa_system_sgpr_workgroup_id_x 1
.end_amdhsa_kernel
.p2align 6
.amdhsa_kernel s2_kernel
  .amdhsa_next_free_vgpr 256
  .amdhsa_next_free_sgpr 102
  .amdhsa_accum_offset 256
  .amdhsa_group_segment_fixed_size 0
  .amdhsa_kernarg_size 120
  .amdhsa_user_sgpr_count 2
  .amdhsa_user_sgpr_kernarg_segment_ptr 1
  .amdhsa_system_sgpr_workgroup_id_x 1
.end_amdhsa_kernel
.p2align 6
.amdhsa_kernel k1_kernel
  .amdhsa_next_free_vgpr 512
  .amdhsa_next_free_sgpr 102
  .amdhsa_accum_offset 256
  .amdhsa_group_segment_fixed_size 0
  .amdhsa_kernarg_size 120
  .amdhsa_user_sgpr_count 2
  .amdhsa_user_sgpr_kernarg_segment_ptr 1
  .amdhsa_system_sgpr_workgroup_id_x 1
.end_amdhsa_kernel
.p2align 6
.amdhsa_kernel k2_kernel
  .amdhsa_next_free_vgpr 512
  .amdhsa_next_free_sgpr 102
  .amdhsa_accum_offset 256
  .amdhsa_group_segment_fixed_size 0
  .amdhsa_kernarg_size 120
  .amdhsa_user_sgpr_count 2
  .amdhsa_user_sgpr_kernarg_segment_ptr 1
  .amdhsa_system_sgpr_workgroup_id_x 1
.end_amdhsa_kernel
.p2align 6
.amdhsa_kernel k3_kernel
  .amdhsa_next_free_vgpr 256
  .amdhsa_next_free_sgpr 102
  .amdhsa_accum_offset 128
  .amdhsa_group_segment_fixed_size 0
  .amdhsa_kernarg_size 120
  .amdhsa_user_sgpr_count 2
  .amdhsa_user_sgpr_kernarg_segment_ptr 1
  .amdhsa_system_sgpr_workgroup_id_x 1
.end_amdhsa_kernel
```

```asm
; @launch grid=(256,1,1) block=(256,1,1) lds=163840
.amdgcn_target "amdgcn-amd-amdhsa--gfx950"
.text
.globl concat_heads__ssm_conv_h3__compressed_kv_cla__prompt_kernel
.p2align 8
.type concat_heads__ssm_conv_h3__compressed_kv_cla__prompt_kernel,@function
concat_heads__ssm_conv_h3__compressed_kv_cla__prompt_kernel:
    s_cmp_lt_u32 s2, 256
    s_cbranch_scc1 L_go
    s_endpgm
L_go:
    s_load_dwordx16 s[64:79], s[0:1], 0
    s_load_dwordx8 s[80:87], s[0:1], 64
    s_load_dwordx4 s[88:91], s[0:1], 96
    s_load_dwordx2 s[12:13], s[0:1], 112
    v_lshrrev_b32 v1, 6, v0
    v_and_b32 v0, 63, v0
    v_readfirstlane_b32 s3, v1
    s_and_b32 s24, s2, 7
    s_bfe_u32 s25, s2, 0x30003
    s_bfe_u32 s26, s2, 0x10006
    s_lshl_b32 s37, s24, 1
    s_add_u32 s26, s26, s37
    s_lshr_b32 s27, s2, 7
    s_bfe_u32 s28, s2, 0x40003
    s_lshl_b32 s29, s3, 10
    s_and_b32 s39, s3, 1
    s_lshr_b32 s40, s3, 1
    s_mov_b32 s41, 65536
    s_mov_b32 s48, 32768
    s_mov_b32 s42, 131072
    s_mov_b32 s49, 131072
    s_mov_b32 s43, 196608
    s_mov_b32 s50, 163840
    s_mov_b32 s44, 262144
    s_mov_b32 s51, 262144
    s_mov_b32 s45, 327680
    s_mov_b32 s52, 294912
    s_mov_b32 s46, 393216
    s_mov_b32 s53, 393216
    s_mov_b32 s47, 458752
    s_mov_b32 s54, 425984
    s_lshl_b32 s56, s39, 1
    s_lshl_b32 s57, s40, 3
    s_add_u32 s56, s56, s57
    s_lshl_b32 s60, s25, 8
    s_lshl_b32 s58, s3, 3
    s_add_u32 s58, s58, s60
    v_lshrrev_b32 v14, 3, v0
    v_add_u32 v14, s58, v14
    v_mul_u32_u24 v14, 2048, v14
    s_lshl_b32 s58, s39, 2
    v_lshrrev_b32 v15, 4, v0
    v_add_u32 v15, s58, v15
    v_xor_b32 v15, v0, v15
    v_and_b32 v15, 7, v15
    v_lshl_add_u32 v1, v15, 4, v14
    v_lshrrev_b32 v14, 5, v0
    s_lshl_b32 s58, s3, 1
    v_add_u32 v15, s58, v14
    v_lshlrev_b32 v15, 1, v15
    v_xor_b32 v15, v0, v15
    v_and_b32 v15, 31, v15
    v_lshlrev_b32 v15, 4, v15
    v_add_u32 v14, s56, v14
    v_lshl_add_u32 v14, v14, 13, v15
    s_lshl_b32 s58, s26, 9
    v_add_u32 v2, s58, v14
    s_waitcnt lgkmcnt(0)
    s_cmp_eq_u32 s27, 0
    s_cselect_b32 s8, s82, s84
    s_cselect_b32 s9, s83, s85
    s_mov_b32 s10, 8388608
    s_mov_b32 s11, 0x20000
    s_mov_b32 s4, s78
    s_mov_b32 s5, s79
    s_mov_b32 s6, 4194304
    s_mov_b32 s7, 0x20000
    s_mov_b32 s14, 268435456
    s_mov_b32 s15, 0x20000
    s_add_u32 m0, s29, 65536
    s_nop 0
    buffer_load_dwordx4 v2, s[8:11], 0 offen lds
    s_add_u32 m0, s29, 0
    s_nop 0
    buffer_load_dwordx4 v1, s[4:7], 0 offen lds
    s_add_u32 m0, s29, 69632
    s_nop 0
    buffer_load_dwordx4 v2, s[8:11], s48 offen lds
    s_add_u32 m0, s29, 4096
    s_nop 0
    buffer_load_dwordx4 v1, s[4:7], s41 offen lds
    s_add_u32 m0, s29, 73728
    s_nop 0
    buffer_load_dwordx4 v2, s[8:11], s49 offen lds
    s_add_u32 m0, s29, 8192
    s_nop 0
    buffer_load_dwordx4 v1, s[4:7], s42 offen lds
    s_add_u32 m0, s29, 77824
    s_nop 0
    buffer_load_dwordx4 v2, s[8:11], s50 offen lds
    s_add_u32 m0, s29, 12288
    s_nop 0
    buffer_load_dwordx4 v1, s[4:7], s43 offen lds
    s_add_u32 m0, s29, 81920
    s_nop 0
    buffer_load_dwordx4 v2, s[8:11], s51 offen lds
    s_add_u32 m0, s29, 16384
    s_nop 0
    buffer_load_dwordx4 v1, s[4:7], s44 offen lds
    s_add_u32 m0, s29, 86016
    s_nop 0
    buffer_load_dwordx4 v2, s[8:11], s52 offen lds
    s_add_u32 m0, s29, 20480
    s_nop 0
    buffer_load_dwordx4 v1, s[4:7], s45 offen lds
    s_add_u32 m0, s29, 90112
    s_nop 0
    buffer_load_dwordx4 v2, s[8:11], s53 offen lds
    s_add_u32 m0, s29, 24576
    s_nop 0
    buffer_load_dwordx4 v1, s[4:7], s46 offen lds
    s_add_u32 m0, s29, 94208
    s_nop 0
    buffer_load_dwordx4 v2, s[8:11], s54 offen lds
    s_add_u32 m0, s29, 28672
    s_nop 0
    buffer_load_dwordx4 v1, s[4:7], s47 offen lds
    v_add_u32 v1, 128, v1
    v_add_u32 v2, 0x80000, v2
    s_lshl_b32 s58, s27, 3
    s_add_u32 s59, s58, s25
    s_lshl_b32 s59, s59, 2
    s_lshl_b32 s92, s26, 7
    s_add_u32 s92, s92, s59
    s_add_u32 s92, s92, 84934656
    s_add_u32 s58, s58, s24
    s_mul_i32 s95, s58, 14
    s_add_u32 s95, s95, s28
    s_sub_u32 s63, 15, s25
    s_cmp_eq_u32 s27, 0
    s_cselect_b32 s63, s25, s63
    s_lshl_b32 s93, s63, 7
    s_lshl_b32 s59, s26, 2
    s_add_u32 s93, s93, s59
    s_add_u32 s93, s93, 84938752
    s_and_b32 s94, s2, 127
    s_lshl_b32 s94, s94, 7
    s_add_u32 s94, s94, 84942848
    s_cmp_lg_u32 s3, 0
    s_cbranch_scc1 L_noclr
    s_lshl_b32 s58, s95, 2
    s_add_u32 s59, s58, 84963328
    s_add_u32 s58, s58, 84959232
    s_lshl_b32 s61, s27, 2
    s_add_u32 s61, s61, s94
    s_cmp_lt_u32 s28, 14
    s_cselect_b32 s58, s58, s92
    s_cselect_b32 s59, s59, s92
    v_mov_b32 v14, s92
    v_writelane_b32 v14, s93, 1
    v_writelane_b32 v14, s61, 2
    v_writelane_b32 v14, s58, 3
    v_writelane_b32 v14, s59, 4
    v_mov_b32 v15, 0
    s_mov_b64 exec, 31
    buffer_store_dword v15, v14, s[12:15], 0 offen sc1
    s_mov_b64 exec, -1
L_noclr:
    s_add_u32 m0, s29, 98304
    s_nop 0
    buffer_load_dwordx4 v2, s[8:11], 0 offen lds
    s_add_u32 m0, s29, 32768
    s_nop 0
    buffer_load_dwordx4 v1, s[4:7], 0 offen lds
    s_add_u32 m0, s29, 102400
    s_nop 0
    buffer_load_dwordx4 v2, s[8:11], s48 offen lds
    s_add_u32 m0, s29, 36864
    s_nop 0
    buffer_load_dwordx4 v1, s[4:7], s41 offen lds
    s_add_u32 m0, s29, 106496
    s_nop 0
    buffer_load_dwordx4 v2, s[8:11], s49 offen lds
    s_add_u32 m0, s29, 40960
    s_nop 0
    buffer_load_dwordx4 v1, s[4:7], s42 offen lds
    s_add_u32 m0, s29, 110592
    s_nop 0
    buffer_load_dwordx4 v2, s[8:11], s50 offen lds
    s_add_u32 m0, s29, 45056
    s_nop 0
    buffer_load_dwordx4 v1, s[4:7], s43 offen lds
    s_add_u32 m0, s29, 114688
    s_nop 0
    buffer_load_dwordx4 v2, s[8:11], s51 offen lds
    s_add_u32 m0, s29, 49152
    s_nop 0
    buffer_load_dwordx4 v1, s[4:7], s44 offen lds
    s_add_u32 m0, s29, 118784
    s_nop 0
    buffer_load_dwordx4 v2, s[8:11], s52 offen lds
    s_add_u32 m0, s29, 53248
    s_nop 0
    buffer_load_dwordx4 v1, s[4:7], s45 offen lds
    s_add_u32 m0, s29, 122880
    s_nop 0
    buffer_load_dwordx4 v2, s[8:11], s53 offen lds
    s_add_u32 m0, s29, 57344
    s_nop 0
    buffer_load_dwordx4 v1, s[4:7], s46 offen lds
    s_add_u32 m0, s29, 126976
    s_nop 0
    buffer_load_dwordx4 v2, s[8:11], s54 offen lds
    s_add_u32 m0, s29, 61440
    s_nop 0
    buffer_load_dwordx4 v1, s[4:7], s47 offen lds
    v_add_u32 v1, 128, v1
    v_add_u32 v2, 0x80000, v2
    s_lshl_b32 s58, s39, 7
    s_lshl_b32 s59, s40, 3
    v_and_b32 v14, 15, v0
    v_lshrrev_b32 v15, 4, v0
    v_lshrrev_b32 v5, 1, v14
    v_xor_b32 v5, v5, v15
    v_add_u32 v14, s58, v14
    v_lshlrev_b32 v14, 7, v14
    v_lshl_add_u32 v4, v5, 4, v14
    v_xor_b32 v5, 64, v4
    v_bfe_u32 v14, v0, 2, 3
    v_lshrrev_b32 v15, 5, v0
    v_lshl_add_u32 v13, v15, 4, v14
    v_lshlrev_b32 v13, 9, v13
    v_xor_b32 v14, s59, v14
    v_lshl_add_u32 v13, v14, 5, v13
    v_and_b32 v14, 3, v0
    v_lshl_add_u32 v13, v14, 3, v13
    v_add_u32 v6, 0x10000, v13
    v_xor_b32 v7, 32, v6
    v_xor_b32 v8, 64, v6
    v_xor_b32 v9, 96, v6
    v_xor_b32 v10, 128, v6
    v_xor_b32 v11, 160, v6
    v_xor_b32 v12, 192, v6
    v_xor_b32 v13, 224, v6
    v_lshlrev_b32 v3, 4, v0
    v_mov_b64 v[16:17], 0
    v_mov_b64 v[18:19], 0
    v_mov_b64 v[20:21], 0
    v_mov_b64 v[22:23], 0
    v_mov_b64 v[24:25], 0
    v_mov_b64 v[26:27], 0
    v_mov_b64 v[28:29], 0
    v_mov_b64 v[30:31], 0
    v_mov_b64 v[32:33], 0
    v_mov_b64 v[34:35], 0
    v_mov_b64 v[36:37], 0
    v_mov_b64 v[38:39], 0
    v_mov_b64 v[40:41], 0
    v_mov_b64 v[42:43], 0
    v_mov_b64 v[44:45], 0
    v_mov_b64 v[46:47], 0
    v_mov_b64 v[48:49], 0
    v_mov_b64 v[50:51], 0
    v_mov_b64 v[52:53], 0
    v_mov_b64 v[54:55], 0
    v_mov_b64 v[56:57], 0
    v_mov_b64 v[58:59], 0
    v_mov_b64 v[60:61], 0
    v_mov_b64 v[62:63], 0
    v_mov_b64 v[64:65], 0
    v_mov_b64 v[66:67], 0
    v_mov_b64 v[68:69], 0
    v_mov_b64 v[70:71], 0
    v_mov_b64 v[72:73], 0
    v_mov_b64 v[74:75], 0
    v_mov_b64 v[76:77], 0
    v_mov_b64 v[78:79], 0
    v_mov_b64 v[80:81], 0
    v_mov_b64 v[82:83], 0
    v_mov_b64 v[84:85], 0
    v_mov_b64 v[86:87], 0
    v_mov_b64 v[88:89], 0
    v_mov_b64 v[90:91], 0
    v_mov_b64 v[92:93], 0
    v_mov_b64 v[94:95], 0
    v_mov_b64 v[96:97], 0
    v_mov_b64 v[98:99], 0
    v_mov_b64 v[100:101], 0
    v_mov_b64 v[102:103], 0
    v_mov_b64 v[104:105], 0
    v_mov_b64 v[106:107], 0
    v_mov_b64 v[108:109], 0
    v_mov_b64 v[110:111], 0
    v_mov_b64 v[112:113], 0
    v_mov_b64 v[114:115], 0
    v_mov_b64 v[116:117], 0
    v_mov_b64 v[118:119], 0
    v_mov_b64 v[120:121], 0
    v_mov_b64 v[122:123], 0
    v_mov_b64 v[124:125], 0
    v_mov_b64 v[126:127], 0
    v_mov_b64 v[128:129], 0
    v_mov_b64 v[130:131], 0
    v_mov_b64 v[132:133], 0
    v_mov_b64 v[134:135], 0
    v_mov_b64 v[136:137], 0
    v_mov_b64 v[138:139], 0
    v_mov_b64 v[140:141], 0
    v_mov_b64 v[142:143], 0
    v_mov_b64 v[144:145], 0
    v_mov_b64 v[146:147], 0
    v_mov_b64 v[148:149], 0
    v_mov_b64 v[150:151], 0
    v_mov_b64 v[152:153], 0
    v_mov_b64 v[154:155], 0
    v_mov_b64 v[156:157], 0
    v_mov_b64 v[158:159], 0
    v_mov_b64 v[160:161], 0
    v_mov_b64 v[162:163], 0
    v_mov_b64 v[164:165], 0
    v_mov_b64 v[166:167], 0
    v_mov_b64 v[168:169], 0
    v_mov_b64 v[170:171], 0
    v_mov_b64 v[172:173], 0
    v_mov_b64 v[174:175], 0
    v_mov_b64 v[176:177], 0
    v_mov_b64 v[178:179], 0
    v_mov_b64 v[180:181], 0
    v_mov_b64 v[182:183], 0
    v_mov_b64 v[184:185], 0
    v_mov_b64 v[186:187], 0
    v_mov_b64 v[188:189], 0
    v_mov_b64 v[190:191], 0
    v_mov_b64 v[192:193], 0
    v_mov_b64 v[194:195], 0
    v_mov_b64 v[196:197], 0
    v_mov_b64 v[198:199], 0
    v_mov_b64 v[200:201], 0
    v_mov_b64 v[202:203], 0
    v_mov_b64 v[204:205], 0
    v_mov_b64 v[206:207], 0
    v_mov_b64 v[208:209], 0
    v_mov_b64 v[210:211], 0
    v_mov_b64 v[212:213], 0
    v_mov_b64 v[214:215], 0
    v_mov_b64 v[216:217], 0
    v_mov_b64 v[218:219], 0
    v_mov_b64 v[220:221], 0
    v_mov_b64 v[222:223], 0
    v_mov_b64 v[224:225], 0
    v_mov_b64 v[226:227], 0
    v_mov_b64 v[228:229], 0
    v_mov_b64 v[230:231], 0
    v_mov_b64 v[232:233], 0
    v_mov_b64 v[234:235], 0
    v_mov_b64 v[236:237], 0
    v_mov_b64 v[238:239], 0
    v_mov_b64 v[240:241], 0
    v_mov_b64 v[242:243], 0
    v_mov_b64 v[244:245], 0
    v_mov_b64 v[246:247], 0
    v_mov_b64 v[248:249], 0
    v_mov_b64 v[250:251], 0
    v_mov_b64 v[252:253], 0
    v_mov_b64 v[254:255], 0
    v_accvgpr_write_b32 a224, 0
    v_accvgpr_write_b32 a225, 0
    v_accvgpr_write_b32 a226, 0
    v_accvgpr_write_b32 a227, 0
    v_accvgpr_write_b32 a228, 0
    v_accvgpr_write_b32 a229, 0
    v_accvgpr_write_b32 a230, 0
    v_accvgpr_write_b32 a231, 0
    v_accvgpr_write_b32 a232, 0
    v_accvgpr_write_b32 a233, 0
    v_accvgpr_write_b32 a234, 0
    v_accvgpr_write_b32 a235, 0
    v_accvgpr_write_b32 a236, 0
    v_accvgpr_write_b32 a237, 0
    v_accvgpr_write_b32 a238, 0
    v_accvgpr_write_b32 a239, 0
    s_mov_b32 s61, 0
    s_waitcnt vmcnt(16)
    s_barrier
    ds_read_b64_tr_b16 a[0:1], v6 offset:0
    ds_read_b64_tr_b16 a[2:3], v6 offset:4096
    ds_read_b128 a[64:67], v4 offset:0
    ds_read_b64_tr_b16 a[4:5], v6 offset:16384
    ds_read_b64_tr_b16 a[6:7], v6 offset:20480
    ds_read_b128 a[68:71], v5 offset:0
    ds_read_b128 a[76:79], v5 offset:2048
    ds_read_b128 a[72:75], v4 offset:2048
    ds_read_b128 a[80:83], v4 offset:4096
    ds_read_b128 a[84:87], v5 offset:4096
    ds_read_b128 a[92:95], v5 offset:6144
    ds_read_b128 a[88:91], v4 offset:6144
    ds_read_b64_tr_b16 a[8:9], v7 offset:0
    ds_read_b64_tr_b16 a[10:11], v7 offset:4096
    ds_read_b64_tr_b16 a[12:13], v7 offset:16384
    ds_read_b64_tr_b16 a[14:15], v7 offset:20480
    ds_read_b64_tr_b16 a[16:17], v8 offset:0
    ds_read_b64_tr_b16 a[18:19], v8 offset:4096
    ds_read_b64_tr_b16 a[20:21], v8 offset:16384
    ds_read_b64_tr_b16 a[22:23], v8 offset:20480
    ds_read_b64_tr_b16 a[24:25], v9 offset:0
    s_mul_i32 s55, s25, 6
    s_lshr_b32 s55, s55, 3
    s_cmp_lg_u32 s3, 0
    s_cmov_b32 s55, 64
    s_getreg_b32 s58, hwreg(HW_REG_XCC_ID, 0, 3)
    s_and_b32 s59, s58, 3
    s_lshl_b32 s59, s59, 3
    s_lshl_b32 s59, 1, s59
    s_and_b32 s58, s58, 4
    s_lshl_b32 s62, s24, 3
    s_add_u32 s58, s58, s62
    v_mov_b32 v14, 128
    v_mov_b32 v15, 1
    v_writelane_b32 v14, s58, 0
    v_writelane_b32 v15, s59, 0
    s_cmp_eq_u32 s27, 0
    s_waitcnt lgkmcnt(0)
    s_cbranch_scc0 L_vloop
.p2align 6
L_kloop:
    v_mfma_f32_16x16x32_bf16 v[16:19], a[0:3], a[64:67], v[16:19]
    ds_read_b64_tr_b16 a[26:27], v9 offset:4096
    v_mfma_f32_16x16x32_bf16 v[16:19], a[4:7], a[68:71], v[16:19]
    s_cmp_eq_u32 s61, 7
    s_cmov_b32 s6, 0
    ds_read_b64_tr_b16 a[28:29], v9 offset:16384
    v_mfma_f32_16x16x32_bf16 v[48:51], a[4:7], a[76:79], v[48:51]
    ds_read_b64_tr_b16 a[30:31], v9 offset:20480
    v_mfma_f32_16x16x32_bf16 v[48:51], a[0:3], a[72:75], v[48:51]
    ds_read_b128 a[96:99], v4 offset:8192
    v_mfma_f32_16x16x32_bf16 v[80:83], a[0:3], a[80:83], v[80:83]
    s_cmp_eq_u32 s61, s55
    s_cbranch_scc1 L_kloop_side
L_kloop_back:
    v_mfma_f32_16x16x32_bf16 v[80:83], a[4:7], a[84:87], v[80:83]
    ds_read_b128 a[100:103], v5 offset:8192
    v_mfma_f32_16x16x32_bf16 v[112:115], a[4:7], a[92:95], v[112:115]
    v_mfma_f32_16x16x32_bf16 v[112:115], a[0:3], a[88:91], v[112:115]
    s_waitcnt lgkmcnt(8)
    ds_read_b128 a[108:111], v5 offset:10240
    v_mfma_f32_16x16x32_bf16 v[116:119], a[8:11], a[88:91], v[116:119]
    v_mfma_f32_16x16x32_bf16 v[116:119], a[12:15], a[92:95], v[116:119]
    ds_read_b128 a[104:107], v4 offset:10240
    v_mfma_f32_16x16x32_bf16 v[84:87], a[12:15], a[84:87], v[84:87]
    v_mfma_f32_16x16x32_bf16 v[84:87], a[8:11], a[80:83], v[84:87]
    ds_read_b128 a[112:115], v4 offset:12288
    v_mfma_f32_16x16x32_bf16 v[52:55], a[8:11], a[72:75], v[52:55]
    v_mfma_f32_16x16x32_bf16 v[52:55], a[12:15], a[76:79], v[52:55]
    ds_read_b128 a[116:119], v5 offset:12288
    v_mfma_f32_16x16x32_bf16 v[20:23], a[12:15], a[68:71], v[20:23]
    v_mfma_f32_16x16x32_bf16 v[20:23], a[8:11], a[64:67], v[20:23]
    ds_read_b128 a[124:127], v5 offset:14336
    v_mfma_f32_16x16x32_bf16 v[24:27], a[16:19], a[64:67], v[24:27]
    s_waitcnt lgkmcnt(8)
    v_mfma_f32_16x16x32_bf16 v[24:27], a[20:23], a[68:71], v[24:27]
    ds_read_b128 a[120:123], v4 offset:14336
    v_mfma_f32_16x16x32_bf16 v[56:59], a[20:23], a[76:79], v[56:59]
    v_mfma_f32_16x16x32_bf16 v[56:59], a[16:19], a[72:75], v[56:59]
    ds_read_b64_tr_b16 a[32:33], v10 offset:0
    v_mfma_f32_16x16x32_bf16 v[88:91], a[16:19], a[80:83], v[88:91]
    ds_read_b64_tr_b16 a[34:35], v10 offset:4096
    v_mfma_f32_16x16x32_bf16 v[88:91], a[20:23], a[84:87], v[88:91]
    ds_read_b64_tr_b16 a[36:37], v10 offset:16384
    v_mfma_f32_16x16x32_bf16 v[120:123], a[20:23], a[92:95], v[120:123]
    ds_read_b64_tr_b16 a[38:39], v10 offset:20480
    v_mfma_f32_16x16x32_bf16 v[120:123], a[16:19], a[88:91], v[120:123]
    ds_read_b64_tr_b16 a[40:41], v11 offset:0
    v_mfma_f32_16x16x32_bf16 v[124:127], a[24:27], a[88:91], v[124:127]
    s_waitcnt lgkmcnt(8)
    ds_read_b64_tr_b16 a[42:43], v11 offset:4096
    v_mfma_f32_16x16x32_bf16 v[124:127], a[28:31], a[92:95], v[124:127]
    ds_read_b64_tr_b16 a[44:45], v11 offset:16384
    v_mfma_f32_16x16x32_bf16 v[92:95], a[28:31], a[84:87], v[92:95]
    ds_read_b64_tr_b16 a[46:47], v11 offset:20480
    v_mfma_f32_16x16x32_bf16 v[92:95], a[24:27], a[80:83], v[92:95]
    ds_read_b64_tr_b16 a[48:49], v12 offset:0
    v_mfma_f32_16x16x32_bf16 v[60:63], a[24:27], a[72:75], v[60:63]
    ds_read_b64_tr_b16 a[50:51], v12 offset:4096
    v_mfma_f32_16x16x32_bf16 v[60:63], a[28:31], a[76:79], v[60:63]
    ds_read_b64_tr_b16 a[52:53], v12 offset:16384
    v_mfma_f32_16x16x32_bf16 v[28:31], a[28:31], a[68:71], v[28:31]
    ds_read_b64_tr_b16 a[54:55], v12 offset:20480
    v_mfma_f32_16x16x32_bf16 v[28:31], a[24:27], a[64:67], v[28:31]
    ds_read_b64_tr_b16 a[56:57], v13 offset:0
    v_mfma_f32_16x16x32_bf16 v[144:147], a[0:3], a[96:99], v[144:147]
    ds_read_b64_tr_b16 a[58:59], v13 offset:4096
    v_mfma_f32_16x16x32_bf16 v[144:147], a[4:7], a[100:103], v[144:147]
    ds_read_b64_tr_b16 a[60:61], v13 offset:16384
    v_mfma_f32_16x16x32_bf16 v[176:179], a[4:7], a[108:111], v[176:179]
    ds_read_b64_tr_b16 a[62:63], v13 offset:20480
    v_mfma_f32_16x16x32_bf16 v[176:179], a[0:3], a[104:107], v[176:179]
    v_mfma_f32_16x16x32_bf16 v[208:211], a[0:3], a[112:115], v[208:211]
    s_waitcnt lgkmcnt(8)
    v_mfma_f32_16x16x32_bf16 v[208:211], a[4:7], a[116:119], v[208:211]
    v_mfma_f32_16x16x32_bf16 v[240:243], a[4:7], a[124:127], v[240:243]
    v_mfma_f32_16x16x32_bf16 v[240:243], a[0:3], a[120:123], v[240:243]
    s_waitcnt lgkmcnt(0)
    v_mfma_f32_16x16x32_bf16 v[244:247], a[8:11], a[120:123], v[244:247]
    s_barrier
    v_mfma_f32_16x16x32_bf16 v[244:247], a[12:15], a[124:127], v[244:247]
    s_add_u32 m0, s29, 65536
    v_mfma_f32_16x16x32_bf16 v[212:215], a[12:15], a[116:119], v[212:215]
    buffer_load_dwordx4 v2, s[8:11], 0 offen lds
    v_mfma_f32_16x16x32_bf16 v[212:215], a[8:11], a[112:115], v[212:215]
    v_mfma_f32_16x16x32_bf16 v[180:183], a[8:11], a[104:107], v[180:183]
    v_mfma_f32_16x16x32_bf16 v[180:183], a[12:15], a[108:111], v[180:183]
    v_mfma_f32_16x16x32_bf16 v[148:151], a[12:15], a[100:103], v[148:151]
    s_add_u32 m0, s29, 0
    v_mfma_f32_16x16x32_bf16 v[148:151], a[8:11], a[96:99], v[148:151]
    buffer_load_dwordx4 v1, s[4:7], 0 offen lds
    v_mfma_f32_16x16x32_bf16 v[152:155], a[16:19], a[96:99], v[152:155]
    v_mfma_f32_16x16x32_bf16 v[152:155], a[20:23], a[100:103], v[152:155]
    v_mfma_f32_16x16x32_bf16 v[184:187], a[20:23], a[108:111], v[184:187]
    v_mfma_f32_16x16x32_bf16 v[184:187], a[16:19], a[104:107], v[184:187]
    s_add_u32 m0, s29, 69632
    v_mfma_f32_16x16x32_bf16 v[216:219], a[16:19], a[112:115], v[216:219]
    buffer_load_dwordx4 v2, s[8:11], s48 offen lds
    v_mfma_f32_16x16x32_bf16 v[216:219], a[20:23], a[116:119], v[216:219]
    v_mfma_f32_16x16x32_bf16 v[248:251], a[20:23], a[124:127], v[248:251]
    v_mfma_f32_16x16x32_bf16 v[248:251], a[16:19], a[120:123], v[248:251]
    v_mfma_f32_16x16x32_bf16 v[252:255], a[24:27], a[120:123], v[252:255]
    s_add_u32 m0, s29, 4096
    v_mfma_f32_16x16x32_bf16 v[252:255], a[28:31], a[124:127], v[252:255]
    buffer_load_dwordx4 v1, s[4:7], s41 offen lds
    v_mfma_f32_16x16x32_bf16 v[220:223], a[28:31], a[116:119], v[220:223]
    v_mfma_f32_16x16x32_bf16 v[220:223], a[24:27], a[112:115], v[220:223]
    v_mfma_f32_16x16x32_bf16 v[188:191], a[24:27], a[104:107], v[188:191]
    v_mfma_f32_16x16x32_bf16 v[188:191], a[28:31], a[108:111], v[188:191]
    s_add_u32 m0, s29, 73728
    v_mfma_f32_16x16x32_bf16 v[156:159], a[28:31], a[100:103], v[156:159]
    buffer_load_dwordx4 v2, s[8:11], s49 offen lds
    v_mfma_f32_16x16x32_bf16 v[156:159], a[24:27], a[96:99], v[156:159]
    v_mfma_f32_16x16x32_bf16 v[160:163], a[32:35], a[96:99], v[160:163]
    v_mfma_f32_16x16x32_bf16 v[160:163], a[36:39], a[100:103], v[160:163]
    v_mfma_f32_16x16x32_bf16 v[192:195], a[36:39], a[108:111], v[192:195]
    s_add_u32 m0, s29, 8192
    v_mfma_f32_16x16x32_bf16 v[192:195], a[32:35], a[104:107], v[192:195]
    buffer_load_dwordx4 v1, s[4:7], s42 offen lds
    v_mfma_f32_16x16x32_bf16 v[224:227], a[32:35], a[112:115], v[224:227]
    v_mfma_f32_16x16x32_bf16 v[224:227], a[36:39], a[116:119], v[224:227]
    v_mfma_f32_16x16x32_bf16 a[224:227], a[36:39], a[124:127], a[224:227]
    v_mfma_f32_16x16x32_bf16 a[224:227], a[32:35], a[120:123], a[224:227]
    s_add_u32 m0, s29, 77824
    v_mfma_f32_16x16x32_bf16 a[228:231], a[40:43], a[120:123], a[228:231]
    buffer_load_dwordx4 v2, s[8:11], s50 offen lds
    v_mfma_f32_16x16x32_bf16 a[228:231], a[44:47], a[124:127], a[228:231]
    v_mfma_f32_16x16x32_bf16 v[228:231], a[44:47], a[116:119], v[228:231]
    v_mfma_f32_16x16x32_bf16 v[228:231], a[40:43], a[112:115], v[228:231]
    v_mfma_f32_16x16x32_bf16 v[196:199], a[40:43], a[104:107], v[196:199]
    s_add_u32 m0, s29, 12288
    v_mfma_f32_16x16x32_bf16 v[196:199], a[44:47], a[108:111], v[196:199]
    buffer_load_dwordx4 v1, s[4:7], s43 offen lds
    v_mfma_f32_16x16x32_bf16 v[164:167], a[44:47], a[100:103], v[164:167]
    v_mfma_f32_16x16x32_bf16 v[164:167], a[40:43], a[96:99], v[164:167]
    v_mfma_f32_16x16x32_bf16 v[168:171], a[48:51], a[96:99], v[168:171]
    v_mfma_f32_16x16x32_bf16 v[168:171], a[52:55], a[100:103], v[168:171]
    s_add_u32 m0, s29, 81920
    v_mfma_f32_16x16x32_bf16 v[200:203], a[52:55], a[108:111], v[200:203]
    buffer_load_dwordx4 v2, s[8:11], s51 offen lds
    v_mfma_f32_16x16x32_bf16 v[200:203], a[48:51], a[104:107], v[200:203]
    v_mfma_f32_16x16x32_bf16 v[232:235], a[48:51], a[112:115], v[232:235]
    v_mfma_f32_16x16x32_bf16 v[232:235], a[52:55], a[116:119], v[232:235]
    v_mfma_f32_16x16x32_bf16 a[232:235], a[52:55], a[124:127], a[232:235]
    s_add_u32 m0, s29, 16384
    v_mfma_f32_16x16x32_bf16 a[232:235], a[48:51], a[120:123], a[232:235]
    buffer_load_dwordx4 v1, s[4:7], s44 offen lds
    v_mfma_f32_16x16x32_bf16 a[236:239], a[56:59], a[120:123], a[236:239]
    v_mfma_f32_16x16x32_bf16 a[236:239], a[60:63], a[124:127], a[236:239]
    v_mfma_f32_16x16x32_bf16 v[236:239], a[60:63], a[116:119], v[236:239]
    v_mfma_f32_16x16x32_bf16 v[236:239], a[56:59], a[112:115], v[236:239]
    s_add_u32 m0, s29, 86016
    v_mfma_f32_16x16x32_bf16 v[204:207], a[56:59], a[104:107], v[204:207]
    s_waitcnt vmcnt(10)
    buffer_load_dwordx4 v2, s[8:11], s52 offen lds
    v_mfma_f32_16x16x32_bf16 v[204:207], a[60:63], a[108:111], v[204:207]
    s_barrier
    ds_read_b64_tr_b16 a[0:1], v6 offset:32768
    v_mfma_f32_16x16x32_bf16 v[172:175], a[60:63], a[100:103], v[172:175]
    ds_read_b64_tr_b16 a[2:3], v6 offset:36864
    v_mfma_f32_16x16x32_bf16 v[172:175], a[56:59], a[96:99], v[172:175]
    ds_read_b128 a[96:99], v4 offset:40960
    v_mfma_f32_16x16x32_bf16 v[32:35], a[32:35], a[64:67], v[32:35]
    s_add_u32 m0, s29, 20480
    v_mfma_f32_16x16x32_bf16 v[32:35], a[36:39], a[68:71], v[32:35]
    buffer_load_dwordx4 v1, s[4:7], s45 offen lds
    v_mfma_f32_16x16x32_bf16 v[64:67], a[36:39], a[76:79], v[64:67]
    ds_read_b64_tr_b16 a[4:5], v6 offset:49152
    v_mfma_f32_16x16x32_bf16 v[64:67], a[32:35], a[72:75], v[64:67]
    ds_read_b64_tr_b16 a[6:7], v6 offset:53248
    v_mfma_f32_16x16x32_bf16 v[96:99], a[32:35], a[80:83], v[96:99]
    ds_read_b128 a[100:103], v5 offset:40960
    v_mfma_f32_16x16x32_bf16 v[96:99], a[36:39], a[84:87], v[96:99]
    s_add_u32 m0, s29, 90112
    v_mfma_f32_16x16x32_bf16 v[128:131], a[36:39], a[92:95], v[128:131]
    buffer_load_dwordx4 v2, s[8:11], s53 offen lds
    v_mfma_f32_16x16x32_bf16 v[128:131], a[32:35], a[88:91], v[128:131]
    ds_read_b128 a[108:111], v5 offset:43008
    v_mfma_f32_16x16x32_bf16 v[132:135], a[40:43], a[88:91], v[132:135]
    v_mfma_f32_16x16x32_bf16 v[132:135], a[44:47], a[92:95], v[132:135]
    ds_read_b128 a[104:107], v4 offset:43008
    v_mfma_f32_16x16x32_bf16 v[100:103], a[44:47], a[84:87], v[100:103]
    s_add_u32 m0, s29, 24576
    v_mfma_f32_16x16x32_bf16 v[100:103], a[40:43], a[80:83], v[100:103]
    buffer_load_dwordx4 v1, s[4:7], s46 offen lds
    v_mfma_f32_16x16x32_bf16 v[68:71], a[40:43], a[72:75], v[68:71]
    ds_read_b128 a[112:115], v4 offset:45056
    v_mfma_f32_16x16x32_bf16 v[68:71], a[44:47], a[76:79], v[68:71]
    v_mfma_f32_16x16x32_bf16 v[36:39], a[44:47], a[68:71], v[36:39]
    ds_read_b128 a[116:119], v5 offset:45056
    v_mfma_f32_16x16x32_bf16 v[36:39], a[40:43], a[64:67], v[36:39]
    s_add_u32 m0, s29, 94208
    v_mfma_f32_16x16x32_bf16 v[40:43], a[48:51], a[64:67], v[40:43]
    buffer_load_dwordx4 v2, s[8:11], s54 offen lds
    v_mfma_f32_16x16x32_bf16 v[40:43], a[52:55], a[68:71], v[40:43]
    ds_read_b128 a[124:127], v5 offset:47104
    v_mfma_f32_16x16x32_bf16 v[72:75], a[52:55], a[76:79], v[72:75]
    v_mfma_f32_16x16x32_bf16 v[72:75], a[48:51], a[72:75], v[72:75]
    ds_read_b128 a[120:123], v4 offset:47104
    v_mfma_f32_16x16x32_bf16 v[104:107], a[48:51], a[80:83], v[104:107]
    s_add_u32 m0, s29, 28672
    v_mfma_f32_16x16x32_bf16 v[104:107], a[52:55], a[84:87], v[104:107]
    buffer_load_dwordx4 v1, s[4:7], s47 offen lds
    v_mfma_f32_16x16x32_bf16 v[136:139], a[52:55], a[92:95], v[136:139]
    v_add_u32 v1, 128, v1
    v_add_u32 v2, 0x80000, v2
    v_mfma_f32_16x16x32_bf16 v[136:139], a[48:51], a[88:91], v[136:139]
    ds_read_b64_tr_b16 a[8:9], v7 offset:32768
    v_mfma_f32_16x16x32_bf16 v[140:143], a[56:59], a[88:91], v[140:143]
    ds_read_b64_tr_b16 a[10:11], v7 offset:36864
    v_mfma_f32_16x16x32_bf16 v[140:143], a[60:63], a[92:95], v[140:143]
    ds_read_b64_tr_b16 a[12:13], v7 offset:49152
    v_mfma_f32_16x16x32_bf16 v[108:111], a[60:63], a[84:87], v[108:111]
    ds_read_b64_tr_b16 a[14:15], v7 offset:53248
    v_mfma_f32_16x16x32_bf16 v[108:111], a[56:59], a[80:83], v[108:111]
    ds_read_b64_tr_b16 a[16:17], v8 offset:32768
    v_mfma_f32_16x16x32_bf16 v[76:79], a[56:59], a[72:75], v[76:79]
    ds_read_b64_tr_b16 a[18:19], v8 offset:36864
    v_mfma_f32_16x16x32_bf16 v[76:79], a[60:63], a[76:79], v[76:79]
    ds_read_b64_tr_b16 a[20:21], v8 offset:49152
    v_mfma_f32_16x16x32_bf16 v[44:47], a[60:63], a[68:71], v[44:47]
    ds_read_b64_tr_b16 a[22:23], v8 offset:53248
    v_mfma_f32_16x16x32_bf16 v[44:47], a[56:59], a[64:67], v[44:47]
    s_waitcnt lgkmcnt(8)
    ds_read_b64_tr_b16 a[24:25], v9 offset:32768
    v_mfma_f32_16x16x32_bf16 v[144:147], a[0:3], a[96:99], v[144:147]
    ds_read_b64_tr_b16 a[26:27], v9 offset:36864
    v_mfma_f32_16x16x32_bf16 v[144:147], a[4:7], a[100:103], v[144:147]
    ds_read_b64_tr_b16 a[28:29], v9 offset:49152
    v_mfma_f32_16x16x32_bf16 v[176:179], a[4:7], a[108:111], v[176:179]
    ds_read_b64_tr_b16 a[30:31], v9 offset:53248
    v_mfma_f32_16x16x32_bf16 v[176:179], a[0:3], a[104:107], v[176:179]
    ds_read_b128 a[64:67], v4 offset:32768
    v_mfma_f32_16x16x32_bf16 v[208:211], a[0:3], a[112:115], v[208:211]
    v_mfma_f32_16x16x32_bf16 v[208:211], a[4:7], a[116:119], v[208:211]
    ds_read_b128 a[68:71], v5 offset:32768
    v_mfma_f32_16x16x32_bf16 v[240:243], a[4:7], a[124:127], v[240:243]
    v_mfma_f32_16x16x32_bf16 v[240:243], a[0:3], a[120:123], v[240:243]
    s_waitcnt lgkmcnt(8)
    ds_read_b128 a[76:79], v5 offset:34816
    v_mfma_f32_16x16x32_bf16 v[244:247], a[8:11], a[120:123], v[244:247]
    v_mfma_f32_16x16x32_bf16 v[244:247], a[12:15], a[124:127], v[244:247]
    ds_read_b128 a[72:75], v4 offset:34816
    v_mfma_f32_16x16x32_bf16 v[212:215], a[12:15], a[116:119], v[212:215]
    v_mfma_f32_16x16x32_bf16 v[212:215], a[8:11], a[112:115], v[212:215]
    ds_read_b128 a[80:83], v4 offset:36864
    v_mfma_f32_16x16x32_bf16 v[180:183], a[8:11], a[104:107], v[180:183]
    v_mfma_f32_16x16x32_bf16 v[180:183], a[12:15], a[108:111], v[180:183]
    ds_read_b128 a[84:87], v5 offset:36864
    v_mfma_f32_16x16x32_bf16 v[148:151], a[12:15], a[100:103], v[148:151]
    v_mfma_f32_16x16x32_bf16 v[148:151], a[8:11], a[96:99], v[148:151]
    ds_read_b128 a[92:95], v5 offset:38912
    v_mfma_f32_16x16x32_bf16 v[152:155], a[16:19], a[96:99], v[152:155]
    s_waitcnt lgkmcnt(8)
    v_mfma_f32_16x16x32_bf16 v[152:155], a[20:23], a[100:103], v[152:155]
    ds_read_b128 a[88:91], v4 offset:38912
    v_mfma_f32_16x16x32_bf16 v[184:187], a[20:23], a[108:111], v[184:187]
    v_mfma_f32_16x16x32_bf16 v[184:187], a[16:19], a[104:107], v[184:187]
    ds_read_b64_tr_b16 a[32:33], v10 offset:32768
    v_mfma_f32_16x16x32_bf16 v[216:219], a[16:19], a[112:115], v[216:219]
    ds_read_b64_tr_b16 a[34:35], v10 offset:36864
    v_mfma_f32_16x16x32_bf16 v[216:219], a[20:23], a[116:119], v[216:219]
    ds_read_b64_tr_b16 a[36:37], v10 offset:49152
    v_mfma_f32_16x16x32_bf16 v[248:251], a[20:23], a[124:127], v[248:251]
    ds_read_b64_tr_b16 a[38:39], v10 offset:53248
    v_mfma_f32_16x16x32_bf16 v[248:251], a[16:19], a[120:123], v[248:251]
    ds_read_b64_tr_b16 a[40:41], v11 offset:32768
    v_mfma_f32_16x16x32_bf16 v[252:255], a[24:27], a[120:123], v[252:255]
    s_waitcnt lgkmcnt(8)
    ds_read_b64_tr_b16 a[42:43], v11 offset:36864
    v_mfma_f32_16x16x32_bf16 v[252:255], a[28:31], a[124:127], v[252:255]
    ds_read_b64_tr_b16 a[44:45], v11 offset:49152
    v_mfma_f32_16x16x32_bf16 v[220:223], a[28:31], a[116:119], v[220:223]
    ds_read_b64_tr_b16 a[46:47], v11 offset:53248
    v_mfma_f32_16x16x32_bf16 v[220:223], a[24:27], a[112:115], v[220:223]
    ds_read_b64_tr_b16 a[48:49], v12 offset:32768
    v_mfma_f32_16x16x32_bf16 v[188:191], a[24:27], a[104:107], v[188:191]
    ds_read_b64_tr_b16 a[50:51], v12 offset:36864
    v_mfma_f32_16x16x32_bf16 v[188:191], a[28:31], a[108:111], v[188:191]
    ds_read_b64_tr_b16 a[52:53], v12 offset:49152
    v_mfma_f32_16x16x32_bf16 v[156:159], a[28:31], a[100:103], v[156:159]
    ds_read_b64_tr_b16 a[54:55], v12 offset:53248
    v_mfma_f32_16x16x32_bf16 v[156:159], a[24:27], a[96:99], v[156:159]
    ds_read_b64_tr_b16 a[56:57], v13 offset:32768
    v_mfma_f32_16x16x32_bf16 v[16:19], a[0:3], a[64:67], v[16:19]
    ds_read_b64_tr_b16 a[58:59], v13 offset:36864
    v_mfma_f32_16x16x32_bf16 v[16:19], a[4:7], a[68:71], v[16:19]
    ds_read_b64_tr_b16 a[60:61], v13 offset:49152
    v_mfma_f32_16x16x32_bf16 v[48:51], a[4:7], a[76:79], v[48:51]
    ds_read_b64_tr_b16 a[62:63], v13 offset:53248
    v_mfma_f32_16x16x32_bf16 v[48:51], a[0:3], a[72:75], v[48:51]
    v_mfma_f32_16x16x32_bf16 v[80:83], a[0:3], a[80:83], v[80:83]
    s_waitcnt lgkmcnt(8)
    v_mfma_f32_16x16x32_bf16 v[80:83], a[4:7], a[84:87], v[80:83]
    v_mfma_f32_16x16x32_bf16 v[112:115], a[4:7], a[92:95], v[112:115]
    v_mfma_f32_16x16x32_bf16 v[112:115], a[0:3], a[88:91], v[112:115]
    s_waitcnt lgkmcnt(0)
    v_mfma_f32_16x16x32_bf16 v[116:119], a[8:11], a[88:91], v[116:119]
    s_barrier
    v_mfma_f32_16x16x32_bf16 v[116:119], a[12:15], a[92:95], v[116:119]
    s_add_u32 m0, s29, 98304
    v_mfma_f32_16x16x32_bf16 v[84:87], a[12:15], a[84:87], v[84:87]
    buffer_load_dwordx4 v2, s[8:11], 0 offen lds
    v_mfma_f32_16x16x32_bf16 v[84:87], a[8:11], a[80:83], v[84:87]
    v_mfma_f32_16x16x32_bf16 v[52:55], a[8:11], a[72:75], v[52:55]
    v_mfma_f32_16x16x32_bf16 v[52:55], a[12:15], a[76:79], v[52:55]
    v_mfma_f32_16x16x32_bf16 v[20:23], a[12:15], a[68:71], v[20:23]
    s_add_u32 m0, s29, 32768
    v_mfma_f32_16x16x32_bf16 v[20:23], a[8:11], a[64:67], v[20:23]
    buffer_load_dwordx4 v1, s[4:7], 0 offen lds
    v_mfma_f32_16x16x32_bf16 v[24:27], a[16:19], a[64:67], v[24:27]
    v_mfma_f32_16x16x32_bf16 v[24:27], a[20:23], a[68:71], v[24:27]
    v_mfma_f32_16x16x32_bf16 v[56:59], a[20:23], a[76:79], v[56:59]
    v_mfma_f32_16x16x32_bf16 v[56:59], a[16:19], a[72:75], v[56:59]
    s_add_u32 m0, s29, 102400
    v_mfma_f32_16x16x32_bf16 v[88:91], a[16:19], a[80:83], v[88:91]
    buffer_load_dwordx4 v2, s[8:11], s48 offen lds
    v_mfma_f32_16x16x32_bf16 v[88:91], a[20:23], a[84:87], v[88:91]
    v_mfma_f32_16x16x32_bf16 v[120:123], a[20:23], a[92:95], v[120:123]
    v_mfma_f32_16x16x32_bf16 v[120:123], a[16:19], a[88:91], v[120:123]
    v_mfma_f32_16x16x32_bf16 v[124:127], a[24:27], a[88:91], v[124:127]
    s_add_u32 m0, s29, 36864
    v_mfma_f32_16x16x32_bf16 v[124:127], a[28:31], a[92:95], v[124:127]
    buffer_load_dwordx4 v1, s[4:7], s41 offen lds
    v_mfma_f32_16x16x32_bf16 v[92:95], a[28:31], a[84:87], v[92:95]
    v_mfma_f32_16x16x32_bf16 v[92:95], a[24:27], a[80:83], v[92:95]
    v_mfma_f32_16x16x32_bf16 v[60:63], a[24:27], a[72:75], v[60:63]
    v_mfma_f32_16x16x32_bf16 v[60:63], a[28:31], a[76:79], v[60:63]
    s_add_u32 m0, s29, 106496
    v_mfma_f32_16x16x32_bf16 v[28:31], a[28:31], a[68:71], v[28:31]
    buffer_load_dwordx4 v2, s[8:11], s49 offen lds
    v_mfma_f32_16x16x32_bf16 v[28:31], a[24:27], a[64:67], v[28:31]
    v_mfma_f32_16x16x32_bf16 v[32:35], a[32:35], a[64:67], v[32:35]
    v_mfma_f32_16x16x32_bf16 v[32:35], a[36:39], a[68:71], v[32:35]
    v_mfma_f32_16x16x32_bf16 v[64:67], a[36:39], a[76:79], v[64:67]
    s_add_u32 m0, s29, 40960
    v_mfma_f32_16x16x32_bf16 v[64:67], a[32:35], a[72:75], v[64:67]
    buffer_load_dwordx4 v1, s[4:7], s42 offen lds
    v_mfma_f32_16x16x32_bf16 v[96:99], a[32:35], a[80:83], v[96:99]
    v_mfma_f32_16x16x32_bf16 v[96:99], a[36:39], a[84:87], v[96:99]
    v_mfma_f32_16x16x32_bf16 v[128:131], a[36:39], a[92:95], v[128:131]
    v_mfma_f32_16x16x32_bf16 v[128:131], a[32:35], a[88:91], v[128:131]
    s_add_u32 m0, s29, 110592
    v_mfma_f32_16x16x32_bf16 v[132:135], a[40:43], a[88:91], v[132:135]
    buffer_load_dwordx4 v2, s[8:11], s50 offen lds
    v_mfma_f32_16x16x32_bf16 v[132:135], a[44:47], a[92:95], v[132:135]
    v_mfma_f32_16x16x32_bf16 v[100:103], a[44:47], a[84:87], v[100:103]
    v_mfma_f32_16x16x32_bf16 v[100:103], a[40:43], a[80:83], v[100:103]
    v_mfma_f32_16x16x32_bf16 v[68:71], a[40:43], a[72:75], v[68:71]
    s_add_u32 m0, s29, 45056
    v_mfma_f32_16x16x32_bf16 v[68:71], a[44:47], a[76:79], v[68:71]
    buffer_load_dwordx4 v1, s[4:7], s43 offen lds
    v_mfma_f32_16x16x32_bf16 v[36:39], a[44:47], a[68:71], v[36:39]
    v_mfma_f32_16x16x32_bf16 v[36:39], a[40:43], a[64:67], v[36:39]
    v_mfma_f32_16x16x32_bf16 v[40:43], a[48:51], a[64:67], v[40:43]
    v_mfma_f32_16x16x32_bf16 v[40:43], a[52:55], a[68:71], v[40:43]
    s_add_u32 m0, s29, 114688
    v_mfma_f32_16x16x32_bf16 v[72:75], a[52:55], a[76:79], v[72:75]
    buffer_load_dwordx4 v2, s[8:11], s51 offen lds
    v_mfma_f32_16x16x32_bf16 v[72:75], a[48:51], a[72:75], v[72:75]
    v_mfma_f32_16x16x32_bf16 v[104:107], a[48:51], a[80:83], v[104:107]
    v_mfma_f32_16x16x32_bf16 v[104:107], a[52:55], a[84:87], v[104:107]
    v_mfma_f32_16x16x32_bf16 v[136:139], a[52:55], a[92:95], v[136:139]
    s_add_u32 m0, s29, 49152
    v_mfma_f32_16x16x32_bf16 v[136:139], a[48:51], a[88:91], v[136:139]
    buffer_load_dwordx4 v1, s[4:7], s44 offen lds
    v_mfma_f32_16x16x32_bf16 v[140:143], a[56:59], a[88:91], v[140:143]
    v_mfma_f32_16x16x32_bf16 v[140:143], a[60:63], a[92:95], v[140:143]
    v_mfma_f32_16x16x32_bf16 v[108:111], a[60:63], a[84:87], v[108:111]
    v_mfma_f32_16x16x32_bf16 v[108:111], a[56:59], a[80:83], v[108:111]
    s_add_u32 m0, s29, 118784
    v_mfma_f32_16x16x32_bf16 v[76:79], a[56:59], a[72:75], v[76:79]
    s_waitcnt vmcnt(10)
    buffer_load_dwordx4 v2, s[8:11], s52 offen lds
    v_mfma_f32_16x16x32_bf16 v[76:79], a[60:63], a[76:79], v[76:79]
    s_barrier
    ds_read_b64_tr_b16 a[0:1], v6 offset:0
    v_mfma_f32_16x16x32_bf16 v[44:47], a[60:63], a[68:71], v[44:47]
    ds_read_b64_tr_b16 a[2:3], v6 offset:4096
    v_mfma_f32_16x16x32_bf16 v[44:47], a[56:59], a[64:67], v[44:47]
    ds_read_b128 a[64:67], v4 offset:0
    v_mfma_f32_16x16x32_bf16 v[160:163], a[32:35], a[96:99], v[160:163]
    s_add_u32 m0, s29, 53248
    v_mfma_f32_16x16x32_bf16 v[160:163], a[36:39], a[100:103], v[160:163]
    buffer_load_dwordx4 v1, s[4:7], s45 offen lds
    v_mfma_f32_16x16x32_bf16 v[192:195], a[36:39], a[108:111], v[192:195]
    ds_read_b64_tr_b16 a[4:5], v6 offset:16384
    v_mfma_f32_16x16x32_bf16 v[192:195], a[32:35], a[104:107], v[192:195]
    ds_read_b64_tr_b16 a[6:7], v6 offset:20480
    v_mfma_f32_16x16x32_bf16 v[224:227], a[32:35], a[112:115], v[224:227]
    ds_read_b128 a[68:71], v5 offset:0
    v_mfma_f32_16x16x32_bf16 v[224:227], a[36:39], a[116:119], v[224:227]
    s_add_u32 m0, s29, 122880
    v_mfma_f32_16x16x32_bf16 a[224:227], a[36:39], a[124:127], a[224:227]
    buffer_load_dwordx4 v2, s[8:11], s53 offen lds
    v_mfma_f32_16x16x32_bf16 a[224:227], a[32:35], a[120:123], a[224:227]
    ds_read_b128 a[76:79], v5 offset:2048
    v_mfma_f32_16x16x32_bf16 a[228:231], a[40:43], a[120:123], a[228:231]
    v_mfma_f32_16x16x32_bf16 a[228:231], a[44:47], a[124:127], a[228:231]
    ds_read_b128 a[72:75], v4 offset:2048
    v_mfma_f32_16x16x32_bf16 v[228:231], a[44:47], a[116:119], v[228:231]
    s_add_u32 m0, s29, 57344
    v_mfma_f32_16x16x32_bf16 v[228:231], a[40:43], a[112:115], v[228:231]
    buffer_load_dwordx4 v1, s[4:7], s46 offen lds
    v_mfma_f32_16x16x32_bf16 v[196:199], a[40:43], a[104:107], v[196:199]
    ds_read_b128 a[80:83], v4 offset:4096
    v_mfma_f32_16x16x32_bf16 v[196:199], a[44:47], a[108:111], v[196:199]
    v_mfma_f32_16x16x32_bf16 v[164:167], a[44:47], a[100:103], v[164:167]
    ds_read_b128 a[84:87], v5 offset:4096
    v_mfma_f32_16x16x32_bf16 v[164:167], a[40:43], a[96:99], v[164:167]
    s_add_u32 m0, s29, 126976
    v_mfma_f32_16x16x32_bf16 v[168:171], a[48:51], a[96:99], v[168:171]
    buffer_load_dwordx4 v2, s[8:11], s54 offen lds
    v_mfma_f32_16x16x32_bf16 v[168:171], a[52:55], a[100:103], v[168:171]
    ds_read_b128 a[92:95], v5 offset:6144
    v_mfma_f32_16x16x32_bf16 v[200:203], a[52:55], a[108:111], v[200:203]
    v_mfma_f32_16x16x32_bf16 v[200:203], a[48:51], a[104:107], v[200:203]
    ds_read_b128 a[88:91], v4 offset:6144
    v_mfma_f32_16x16x32_bf16 v[232:235], a[48:51], a[112:115], v[232:235]
    s_add_u32 m0, s29, 61440
    v_mfma_f32_16x16x32_bf16 v[232:235], a[52:55], a[116:119], v[232:235]
    buffer_load_dwordx4 v1, s[4:7], s47 offen lds
    v_mfma_f32_16x16x32_bf16 a[232:235], a[52:55], a[124:127], a[232:235]
    v_add_u32 v1, 128, v1
    v_add_u32 v2, 0x80000, v2
    v_mfma_f32_16x16x32_bf16 a[232:235], a[48:51], a[120:123], a[232:235]
    ds_read_b64_tr_b16 a[8:9], v7 offset:0
    v_mfma_f32_16x16x32_bf16 a[236:239], a[56:59], a[120:123], a[236:239]
    ds_read_b64_tr_b16 a[10:11], v7 offset:4096
    v_mfma_f32_16x16x32_bf16 a[236:239], a[60:63], a[124:127], a[236:239]
    ds_read_b64_tr_b16 a[12:13], v7 offset:16384
    v_mfma_f32_16x16x32_bf16 v[236:239], a[60:63], a[116:119], v[236:239]
    ds_read_b64_tr_b16 a[14:15], v7 offset:20480
    v_mfma_f32_16x16x32_bf16 v[236:239], a[56:59], a[112:115], v[236:239]
    ds_read_b64_tr_b16 a[16:17], v8 offset:0
    v_mfma_f32_16x16x32_bf16 v[204:207], a[56:59], a[104:107], v[204:207]
    ds_read_b64_tr_b16 a[18:19], v8 offset:4096
    v_mfma_f32_16x16x32_bf16 v[204:207], a[60:63], a[108:111], v[204:207]
    ds_read_b64_tr_b16 a[20:21], v8 offset:16384
    v_mfma_f32_16x16x32_bf16 v[172:175], a[60:63], a[100:103], v[172:175]
    s_add_u32 s61, s61, 1
    ds_read_b64_tr_b16 a[22:23], v8 offset:20480
    v_mfma_f32_16x16x32_bf16 v[172:175], a[56:59], a[96:99], v[172:175]
    s_waitcnt lgkmcnt(8)
    ds_read_b64_tr_b16 a[24:25], v9 offset:0
    s_cmp_lt_u32 s61, 8
    s_cbranch_scc1 L_kloop
    s_branch L_kvdone
L_kloop_side:
    s_mov_b64 exec, 3
    global_atomic_add v14, v15, s[90:91] sc1
    s_mov_b64 exec, -1
    s_branch L_kloop_back
L_vloop_side:
    s_mov_b64 exec, 3
    global_atomic_add v14, v15, s[90:91] sc1
    s_mov_b64 exec, -1
    s_branch L_vloop_back
.p2align 6
L_vloop:
    v_mfma_f32_16x16x32_bf16 v[16:19], a[64:67], a[0:3], v[16:19]
    ds_read_b64_tr_b16 a[26:27], v9 offset:4096
    v_mfma_f32_16x16x32_bf16 v[16:19], a[68:71], a[4:7], v[16:19]
    s_cmp_eq_u32 s61, 7
    s_cmov_b32 s6, 0
    ds_read_b64_tr_b16 a[28:29], v9 offset:16384
    v_mfma_f32_16x16x32_bf16 v[20:23], a[76:79], a[4:7], v[20:23]
    ds_read_b64_tr_b16 a[30:31], v9 offset:20480
    v_mfma_f32_16x16x32_bf16 v[20:23], a[72:75], a[0:3], v[20:23]
    ds_read_b128 a[96:99], v4 offset:8192
    v_mfma_f32_16x16x32_bf16 v[80:83], a[80:83], a[0:3], v[80:83]
    s_cmp_eq_u32 s61, s55
    s_cbranch_scc1 L_vloop_side
L_vloop_back:
    v_mfma_f32_16x16x32_bf16 v[80:83], a[84:87], a[4:7], v[80:83]
    ds_read_b128 a[100:103], v5 offset:8192
    v_mfma_f32_16x16x32_bf16 v[84:87], a[92:95], a[4:7], v[84:87]
    v_mfma_f32_16x16x32_bf16 v[84:87], a[88:91], a[0:3], v[84:87]
    s_waitcnt lgkmcnt(8)
    ds_read_b128 a[108:111], v5 offset:10240
    v_mfma_f32_16x16x32_bf16 v[92:95], a[88:91], a[8:11], v[92:95]
    v_mfma_f32_16x16x32_bf16 v[92:95], a[92:95], a[12:15], v[92:95]
    ds_read_b128 a[104:107], v4 offset:10240
    v_mfma_f32_16x16x32_bf16 v[88:91], a[84:87], a[12:15], v[88:91]
    v_mfma_f32_16x16x32_bf16 v[88:91], a[80:83], a[8:11], v[88:91]
    ds_read_b128 a[112:115], v4 offset:12288
    v_mfma_f32_16x16x32_bf16 v[28:31], a[72:75], a[8:11], v[28:31]
    v_mfma_f32_16x16x32_bf16 v[28:31], a[76:79], a[12:15], v[28:31]
    ds_read_b128 a[116:119], v5 offset:12288
    v_mfma_f32_16x16x32_bf16 v[24:27], a[68:71], a[12:15], v[24:27]
    v_mfma_f32_16x16x32_bf16 v[24:27], a[64:67], a[8:11], v[24:27]
    ds_read_b128 a[124:127], v5 offset:14336
    v_mfma_f32_16x16x32_bf16 v[32:35], a[64:67], a[16:19], v[32:35]
    s_waitcnt lgkmcnt(8)
    v_mfma_f32_16x16x32_bf16 v[32:35], a[68:71], a[20:23], v[32:35]
    ds_read_b128 a[120:123], v4 offset:14336
    v_mfma_f32_16x16x32_bf16 v[36:39], a[76:79], a[20:23], v[36:39]
    v_mfma_f32_16x16x32_bf16 v[36:39], a[72:75], a[16:19], v[36:39]
    ds_read_b64_tr_b16 a[32:33], v10 offset:0
    v_mfma_f32_16x16x32_bf16 v[96:99], a[80:83], a[16:19], v[96:99]
    ds_read_b64_tr_b16 a[34:35], v10 offset:4096
    v_mfma_f32_16x16x32_bf16 v[96:99], a[84:87], a[20:23], v[96:99]
    ds_read_b64_tr_b16 a[36:37], v10 offset:16384
    v_mfma_f32_16x16x32_bf16 v[100:103], a[92:95], a[20:23], v[100:103]
    ds_read_b64_tr_b16 a[38:39], v10 offset:20480
    v_mfma_f32_16x16x32_bf16 v[100:103], a[88:91], a[16:19], v[100:103]
    ds_read_b64_tr_b16 a[40:41], v11 offset:0
    v_mfma_f32_16x16x32_bf16 v[108:111], a[88:91], a[24:27], v[108:111]
    s_waitcnt lgkmcnt(8)
    ds_read_b64_tr_b16 a[42:43], v11 offset:4096
    v_mfma_f32_16x16x32_bf16 v[108:111], a[92:95], a[28:31], v[108:111]
    ds_read_b64_tr_b16 a[44:45], v11 offset:16384
    v_mfma_f32_16x16x32_bf16 v[104:107], a[84:87], a[28:31], v[104:107]
    ds_read_b64_tr_b16 a[46:47], v11 offset:20480
    v_mfma_f32_16x16x32_bf16 v[104:107], a[80:83], a[24:27], v[104:107]
    ds_read_b64_tr_b16 a[48:49], v12 offset:0
    v_mfma_f32_16x16x32_bf16 v[44:47], a[72:75], a[24:27], v[44:47]
    ds_read_b64_tr_b16 a[50:51], v12 offset:4096
    v_mfma_f32_16x16x32_bf16 v[44:47], a[76:79], a[28:31], v[44:47]
    ds_read_b64_tr_b16 a[52:53], v12 offset:16384
    v_mfma_f32_16x16x32_bf16 v[40:43], a[68:71], a[28:31], v[40:43]
    ds_read_b64_tr_b16 a[54:55], v12 offset:20480
    v_mfma_f32_16x16x32_bf16 v[40:43], a[64:67], a[24:27], v[40:43]
    ds_read_b64_tr_b16 a[56:57], v13 offset:0
    v_mfma_f32_16x16x32_bf16 v[144:147], a[96:99], a[0:3], v[144:147]
    ds_read_b64_tr_b16 a[58:59], v13 offset:4096
    v_mfma_f32_16x16x32_bf16 v[144:147], a[100:103], a[4:7], v[144:147]
    ds_read_b64_tr_b16 a[60:61], v13 offset:16384
    v_mfma_f32_16x16x32_bf16 v[148:151], a[108:111], a[4:7], v[148:151]
    ds_read_b64_tr_b16 a[62:63], v13 offset:20480
    v_mfma_f32_16x16x32_bf16 v[148:151], a[104:107], a[0:3], v[148:151]
    v_mfma_f32_16x16x32_bf16 v[208:211], a[112:115], a[0:3], v[208:211]
    s_waitcnt lgkmcnt(8)
    v_mfma_f32_16x16x32_bf16 v[208:211], a[116:119], a[4:7], v[208:211]
    v_mfma_f32_16x16x32_bf16 v[212:215], a[124:127], a[4:7], v[212:215]
    v_mfma_f32_16x16x32_bf16 v[212:215], a[120:123], a[0:3], v[212:215]
    s_waitcnt lgkmcnt(0)
    v_mfma_f32_16x16x32_bf16 v[220:223], a[120:123], a[8:11], v[220:223]
    s_barrier
    v_mfma_f32_16x16x32_bf16 v[220:223], a[124:127], a[12:15], v[220:223]
    s_add_u32 m0, s29, 65536
    v_mfma_f32_16x16x32_bf16 v[216:219], a[116:119], a[12:15], v[216:219]
    buffer_load_dwordx4 v2, s[8:11], 0 offen lds
    v_mfma_f32_16x16x32_bf16 v[216:219], a[112:115], a[8:11], v[216:219]
    v_mfma_f32_16x16x32_bf16 v[156:159], a[104:107], a[8:11], v[156:159]
    v_mfma_f32_16x16x32_bf16 v[156:159], a[108:111], a[12:15], v[156:159]
    v_mfma_f32_16x16x32_bf16 v[152:155], a[100:103], a[12:15], v[152:155]
    s_add_u32 m0, s29, 0
    v_mfma_f32_16x16x32_bf16 v[152:155], a[96:99], a[8:11], v[152:155]
    buffer_load_dwordx4 v1, s[4:7], 0 offen lds
    v_mfma_f32_16x16x32_bf16 v[160:163], a[96:99], a[16:19], v[160:163]
    v_mfma_f32_16x16x32_bf16 v[160:163], a[100:103], a[20:23], v[160:163]
    v_mfma_f32_16x16x32_bf16 v[164:167], a[108:111], a[20:23], v[164:167]
    v_mfma_f32_16x16x32_bf16 v[164:167], a[104:107], a[16:19], v[164:167]
    s_add_u32 m0, s29, 69632
    v_mfma_f32_16x16x32_bf16 v[224:227], a[112:115], a[16:19], v[224:227]
    buffer_load_dwordx4 v2, s[8:11], s48 offen lds
    v_mfma_f32_16x16x32_bf16 v[224:227], a[116:119], a[20:23], v[224:227]
    v_mfma_f32_16x16x32_bf16 v[228:231], a[124:127], a[20:23], v[228:231]
    v_mfma_f32_16x16x32_bf16 v[228:231], a[120:123], a[16:19], v[228:231]
    v_mfma_f32_16x16x32_bf16 v[236:239], a[120:123], a[24:27], v[236:239]
    s_add_u32 m0, s29, 4096
    v_mfma_f32_16x16x32_bf16 v[236:239], a[124:127], a[28:31], v[236:239]
    buffer_load_dwordx4 v1, s[4:7], s41 offen lds
    v_mfma_f32_16x16x32_bf16 v[232:235], a[116:119], a[28:31], v[232:235]
    v_mfma_f32_16x16x32_bf16 v[232:235], a[112:115], a[24:27], v[232:235]
    v_mfma_f32_16x16x32_bf16 v[172:175], a[104:107], a[24:27], v[172:175]
    v_mfma_f32_16x16x32_bf16 v[172:175], a[108:111], a[28:31], v[172:175]
    s_add_u32 m0, s29, 73728
    v_mfma_f32_16x16x32_bf16 v[168:171], a[100:103], a[28:31], v[168:171]
    buffer_load_dwordx4 v2, s[8:11], s49 offen lds
    v_mfma_f32_16x16x32_bf16 v[168:171], a[96:99], a[24:27], v[168:171]
    v_mfma_f32_16x16x32_bf16 v[176:179], a[96:99], a[32:35], v[176:179]
    v_mfma_f32_16x16x32_bf16 v[176:179], a[100:103], a[36:39], v[176:179]
    v_mfma_f32_16x16x32_bf16 v[180:183], a[108:111], a[36:39], v[180:183]
    s_add_u32 m0, s29, 8192
    v_mfma_f32_16x16x32_bf16 v[180:183], a[104:107], a[32:35], v[180:183]
    buffer_load_dwordx4 v1, s[4:7], s42 offen lds
    v_mfma_f32_16x16x32_bf16 v[240:243], a[112:115], a[32:35], v[240:243]
    v_mfma_f32_16x16x32_bf16 v[240:243], a[116:119], a[36:39], v[240:243]
    v_mfma_f32_16x16x32_bf16 v[244:247], a[124:127], a[36:39], v[244:247]
    v_mfma_f32_16x16x32_bf16 v[244:247], a[120:123], a[32:35], v[244:247]
    s_add_u32 m0, s29, 77824
    v_mfma_f32_16x16x32_bf16 v[252:255], a[120:123], a[40:43], v[252:255]
    buffer_load_dwordx4 v2, s[8:11], s50 offen lds
    v_mfma_f32_16x16x32_bf16 v[252:255], a[124:127], a[44:47], v[252:255]
    v_mfma_f32_16x16x32_bf16 v[248:251], a[116:119], a[44:47], v[248:251]
    v_mfma_f32_16x16x32_bf16 v[248:251], a[112:115], a[40:43], v[248:251]
    v_mfma_f32_16x16x32_bf16 v[188:191], a[104:107], a[40:43], v[188:191]
    s_add_u32 m0, s29, 12288
    v_mfma_f32_16x16x32_bf16 v[188:191], a[108:111], a[44:47], v[188:191]
    buffer_load_dwordx4 v1, s[4:7], s43 offen lds
    v_mfma_f32_16x16x32_bf16 v[184:187], a[100:103], a[44:47], v[184:187]
    v_mfma_f32_16x16x32_bf16 v[184:187], a[96:99], a[40:43], v[184:187]
    v_mfma_f32_16x16x32_bf16 v[192:195], a[96:99], a[48:51], v[192:195]
    v_mfma_f32_16x16x32_bf16 v[192:195], a[100:103], a[52:55], v[192:195]
    s_add_u32 m0, s29, 81920
    v_mfma_f32_16x16x32_bf16 v[196:199], a[108:111], a[52:55], v[196:199]
    buffer_load_dwordx4 v2, s[8:11], s51 offen lds
    v_mfma_f32_16x16x32_bf16 v[196:199], a[104:107], a[48:51], v[196:199]
    v_mfma_f32_16x16x32_bf16 a[224:227], a[112:115], a[48:51], a[224:227]
    v_mfma_f32_16x16x32_bf16 a[224:227], a[116:119], a[52:55], a[224:227]
    v_mfma_f32_16x16x32_bf16 a[228:231], a[124:127], a[52:55], a[228:231]
    s_add_u32 m0, s29, 16384
    v_mfma_f32_16x16x32_bf16 a[228:231], a[120:123], a[48:51], a[228:231]
    buffer_load_dwordx4 v1, s[4:7], s44 offen lds
    v_mfma_f32_16x16x32_bf16 a[236:239], a[120:123], a[56:59], a[236:239]
    v_mfma_f32_16x16x32_bf16 a[236:239], a[124:127], a[60:63], a[236:239]
    v_mfma_f32_16x16x32_bf16 a[232:235], a[116:119], a[60:63], a[232:235]
    v_mfma_f32_16x16x32_bf16 a[232:235], a[112:115], a[56:59], a[232:235]
    s_add_u32 m0, s29, 86016
    v_mfma_f32_16x16x32_bf16 v[204:207], a[104:107], a[56:59], v[204:207]
    s_waitcnt vmcnt(10)
    buffer_load_dwordx4 v2, s[8:11], s52 offen lds
    v_mfma_f32_16x16x32_bf16 v[204:207], a[108:111], a[60:63], v[204:207]
    s_barrier
    ds_read_b64_tr_b16 a[0:1], v6 offset:32768
    v_mfma_f32_16x16x32_bf16 v[200:203], a[100:103], a[60:63], v[200:203]
    ds_read_b64_tr_b16 a[2:3], v6 offset:36864
    v_mfma_f32_16x16x32_bf16 v[200:203], a[96:99], a[56:59], v[200:203]
    ds_read_b128 a[96:99], v4 offset:40960
    v_mfma_f32_16x16x32_bf16 v[48:51], a[64:67], a[32:35], v[48:51]
    s_add_u32 m0, s29, 20480
    v_mfma_f32_16x16x32_bf16 v[48:51], a[68:71], a[36:39], v[48:51]
    buffer_load_dwordx4 v1, s[4:7], s45 offen lds
    v_mfma_f32_16x16x32_bf16 v[52:55], a[76:79], a[36:39], v[52:55]
    ds_read_b64_tr_b16 a[4:5], v6 offset:49152
    v_mfma_f32_16x16x32_bf16 v[52:55], a[72:75], a[32:35], v[52:55]
    ds_read_b64_tr_b16 a[6:7], v6 offset:53248
    v_mfma_f32_16x16x32_bf16 v[112:115], a[80:83], a[32:35], v[112:115]
    ds_read_b128 a[100:103], v5 offset:40960
    v_mfma_f32_16x16x32_bf16 v[112:115], a[84:87], a[36:39], v[112:115]
    s_add_u32 m0, s29, 90112
    v_mfma_f32_16x16x32_bf16 v[116:119], a[92:95], a[36:39], v[116:119]
    buffer_load_dwordx4 v2, s[8:11], s53 offen lds
    v_mfma_f32_16x16x32_bf16 v[116:119], a[88:91], a[32:35], v[116:119]
    ds_read_b128 a[108:111], v5 offset:43008
    v_mfma_f32_16x16x32_bf16 v[124:127], a[88:91], a[40:43], v[124:127]
    v_mfma_f32_16x16x32_bf16 v[124:127], a[92:95], a[44:47], v[124:127]
    ds_read_b128 a[104:107], v4 offset:43008
    v_mfma_f32_16x16x32_bf16 v[120:123], a[84:87], a[44:47], v[120:123]
    s_add_u32 m0, s29, 24576
    v_mfma_f32_16x16x32_bf16 v[120:123], a[80:83], a[40:43], v[120:123]
    buffer_load_dwordx4 v1, s[4:7], s46 offen lds
    v_mfma_f32_16x16x32_bf16 v[60:63], a[72:75], a[40:43], v[60:63]
    ds_read_b128 a[112:115], v4 offset:45056
    v_mfma_f32_16x16x32_bf16 v[60:63], a[76:79], a[44:47], v[60:63]
    v_mfma_f32_16x16x32_bf16 v[56:59], a[68:71], a[44:47], v[56:59]
    ds_read_b128 a[116:119], v5 offset:45056
    v_mfma_f32_16x16x32_bf16 v[56:59], a[64:67], a[40:43], v[56:59]
    s_add_u32 m0, s29, 94208
    v_mfma_f32_16x16x32_bf16 v[64:67], a[64:67], a[48:51], v[64:67]
    buffer_load_dwordx4 v2, s[8:11], s54 offen lds
    v_mfma_f32_16x16x32_bf16 v[64:67], a[68:71], a[52:55], v[64:67]
    ds_read_b128 a[124:127], v5 offset:47104
    v_mfma_f32_16x16x32_bf16 v[68:71], a[76:79], a[52:55], v[68:71]
    v_mfma_f32_16x16x32_bf16 v[68:71], a[72:75], a[48:51], v[68:71]
    ds_read_b128 a[120:123], v4 offset:47104
    v_mfma_f32_16x16x32_bf16 v[128:131], a[80:83], a[48:51], v[128:131]
    s_add_u32 m0, s29, 28672
    v_mfma_f32_16x16x32_bf16 v[128:131], a[84:87], a[52:55], v[128:131]
    buffer_load_dwordx4 v1, s[4:7], s47 offen lds
    v_mfma_f32_16x16x32_bf16 v[132:135], a[92:95], a[52:55], v[132:135]
    v_add_u32 v1, 128, v1
    v_add_u32 v2, 0x80000, v2
    v_mfma_f32_16x16x32_bf16 v[132:135], a[88:91], a[48:51], v[132:135]
    ds_read_b64_tr_b16 a[8:9], v7 offset:32768
    v_mfma_f32_16x16x32_bf16 v[140:143], a[88:91], a[56:59], v[140:143]
    ds_read_b64_tr_b16 a[10:11], v7 offset:36864
    v_mfma_f32_16x16x32_bf16 v[140:143], a[92:95], a[60:63], v[140:143]
    ds_read_b64_tr_b16 a[12:13], v7 offset:49152
    v_mfma_f32_16x16x32_bf16 v[136:139], a[84:87], a[60:63], v[136:139]
    ds_read_b64_tr_b16 a[14:15], v7 offset:53248
    v_mfma_f32_16x16x32_bf16 v[136:139], a[80:83], a[56:59], v[136:139]
    ds_read_b64_tr_b16 a[16:17], v8 offset:32768
    v_mfma_f32_16x16x32_bf16 v[76:79], a[72:75], a[56:59], v[76:79]
    ds_read_b64_tr_b16 a[18:19], v8 offset:36864
    v_mfma_f32_16x16x32_bf16 v[76:79], a[76:79], a[60:63], v[76:79]
    ds_read_b64_tr_b16 a[20:21], v8 offset:49152
    v_mfma_f32_16x16x32_bf16 v[72:75], a[68:71], a[60:63], v[72:75]
    ds_read_b64_tr_b16 a[22:23], v8 offset:53248
    v_mfma_f32_16x16x32_bf16 v[72:75], a[64:67], a[56:59], v[72:75]
    s_waitcnt lgkmcnt(8)
    ds_read_b64_tr_b16 a[24:25], v9 offset:32768
    v_mfma_f32_16x16x32_bf16 v[144:147], a[96:99], a[0:3], v[144:147]
    ds_read_b64_tr_b16 a[26:27], v9 offset:36864
    v_mfma_f32_16x16x32_bf16 v[144:147], a[100:103], a[4:7], v[144:147]
    ds_read_b64_tr_b16 a[28:29], v9 offset:49152
    v_mfma_f32_16x16x32_bf16 v[148:151], a[108:111], a[4:7], v[148:151]
    ds_read_b64_tr_b16 a[30:31], v9 offset:53248
    v_mfma_f32_16x16x32_bf16 v[148:151], a[104:107], a[0:3], v[148:151]
    ds_read_b128 a[64:67], v4 offset:32768
    v_mfma_f32_16x16x32_bf16 v[208:211], a[112:115], a[0:3], v[208:211]
    v_mfma_f32_16x16x32_bf16 v[208:211], a[116:119], a[4:7], v[208:211]
    ds_read_b128 a[68:71], v5 offset:32768
    v_mfma_f32_16x16x32_bf16 v[212:215], a[124:127], a[4:7], v[212:215]
    v_mfma_f32_16x16x32_bf16 v[212:215], a[120:123], a[0:3], v[212:215]
    s_waitcnt lgkmcnt(8)
    ds_read_b128 a[76:79], v5 offset:34816
    v_mfma_f32_16x16x32_bf16 v[220:223], a[120:123], a[8:11], v[220:223]
    v_mfma_f32_16x16x32_bf16 v[220:223], a[124:127], a[12:15], v[220:223]
    ds_read_b128 a[72:75], v4 offset:34816
    v_mfma_f32_16x16x32_bf16 v[216:219], a[116:119], a[12:15], v[216:219]
    v_mfma_f32_16x16x32_bf16 v[216:219], a[112:115], a[8:11], v[216:219]
    ds_read_b128 a[80:83], v4 offset:36864
    v_mfma_f32_16x16x32_bf16 v[156:159], a[104:107], a[8:11], v[156:159]
    v_mfma_f32_16x16x32_bf16 v[156:159], a[108:111], a[12:15], v[156:159]
    ds_read_b128 a[84:87], v5 offset:36864
    v_mfma_f32_16x16x32_bf16 v[152:155], a[100:103], a[12:15], v[152:155]
    v_mfma_f32_16x16x32_bf16 v[152:155], a[96:99], a[8:11], v[152:155]
    ds_read_b128 a[92:95], v5 offset:38912
    v_mfma_f32_16x16x32_bf16 v[160:163], a[96:99], a[16:19], v[160:163]
    s_waitcnt lgkmcnt(8)
    v_mfma_f32_16x16x32_bf16 v[160:163], a[100:103], a[20:23], v[160:163]
    ds_read_b128 a[88:91], v4 offset:38912
    v_mfma_f32_16x16x32_bf16 v[164:167], a[108:111], a[20:23], v[164:167]
    v_mfma_f32_16x16x32_bf16 v[164:167], a[104:107], a[16:19], v[164:167]
    ds_read_b64_tr_b16 a[32:33], v10 offset:32768
    v_mfma_f32_16x16x32_bf16 v[224:227], a[112:115], a[16:19], v[224:227]
    ds_read_b64_tr_b16 a[34:35], v10 offset:36864
    v_mfma_f32_16x16x32_bf16 v[224:227], a[116:119], a[20:23], v[224:227]
    ds_read_b64_tr_b16 a[36:37], v10 offset:49152
    v_mfma_f32_16x16x32_bf16 v[228:231], a[124:127], a[20:23], v[228:231]
    ds_read_b64_tr_b16 a[38:39], v10 offset:53248
    v_mfma_f32_16x16x32_bf16 v[228:231], a[120:123], a[16:19], v[228:231]
    ds_read_b64_tr_b16 a[40:41], v11 offset:32768
    v_mfma_f32_16x16x32_bf16 v[236:239], a[120:123], a[24:27], v[236:239]
    s_waitcnt lgkmcnt(8)
    ds_read_b64_tr_b16 a[42:43], v11 offset:36864
    v_mfma_f32_16x16x32_bf16 v[236:239], a[124:127], a[28:31], v[236:239]
    ds_read_b64_tr_b16 a[44:45], v11 offset:49152
    v_mfma_f32_16x16x32_bf16 v[232:235], a[116:119], a[28:31], v[232:235]
    ds_read_b64_tr_b16 a[46:47], v11 offset:53248
    v_mfma_f32_16x16x32_bf16 v[232:235], a[112:115], a[24:27], v[232:235]
    ds_read_b64_tr_b16 a[48:49], v12 offset:32768
    v_mfma_f32_16x16x32_bf16 v[172:175], a[104:107], a[24:27], v[172:175]
    ds_read_b64_tr_b16 a[50:51], v12 offset:36864
    v_mfma_f32_16x16x32_bf16 v[172:175], a[108:111], a[28:31], v[172:175]
    ds_read_b64_tr_b16 a[52:53], v12 offset:49152
    v_mfma_f32_16x16x32_bf16 v[168:171], a[100:103], a[28:31], v[168:171]
    ds_read_b64_tr_b16 a[54:55], v12 offset:53248
    v_mfma_f32_16x16x32_bf16 v[168:171], a[96:99], a[24:27], v[168:171]
    ds_read_b64_tr_b16 a[56:57], v13 offset:32768
    v_mfma_f32_16x16x32_bf16 v[16:19], a[64:67], a[0:3], v[16:19]
    ds_read_b64_tr_b16 a[58:59], v13 offset:36864
    v_mfma_f32_16x16x32_bf16 v[16:19], a[68:71], a[4:7], v[16:19]
    ds_read_b64_tr_b16 a[60:61], v13 offset:49152
    v_mfma_f32_16x16x32_bf16 v[20:23], a[76:79], a[4:7], v[20:23]
    ds_read_b64_tr_b16 a[62:63], v13 offset:53248
    v_mfma_f32_16x16x32_bf16 v[20:23], a[72:75], a[0:3], v[20:23]
    v_mfma_f32_16x16x32_bf16 v[80:83], a[80:83], a[0:3], v[80:83]
    s_waitcnt lgkmcnt(8)
    v_mfma_f32_16x16x32_bf16 v[80:83], a[84:87], a[4:7], v[80:83]
    v_mfma_f32_16x16x32_bf16 v[84:87], a[92:95], a[4:7], v[84:87]
    v_mfma_f32_16x16x32_bf16 v[84:87], a[88:91], a[0:3], v[84:87]
    s_waitcnt lgkmcnt(0)
    v_mfma_f32_16x16x32_bf16 v[92:95], a[88:91], a[8:11], v[92:95]
    s_barrier
    v_mfma_f32_16x16x32_bf16 v[92:95], a[92:95], a[12:15], v[92:95]
    s_add_u32 m0, s29, 98304
    v_mfma_f32_16x16x32_bf16 v[88:91], a[84:87], a[12:15], v[88:91]
    buffer_load_dwordx4 v2, s[8:11], 0 offen lds
    v_mfma_f32_16x16x32_bf16 v[88:91], a[80:83], a[8:11], v[88:91]
    v_mfma_f32_16x16x32_bf16 v[28:31], a[72:75], a[8:11], v[28:31]
    v_mfma_f32_16x16x32_bf16 v[28:31], a[76:79], a[12:15], v[28:31]
    v_mfma_f32_16x16x32_bf16 v[24:27], a[68:71], a[12:15], v[24:27]
    s_add_u32 m0, s29, 32768
    v_mfma_f32_16x16x32_bf16 v[24:27], a[64:67], a[8:11], v[24:27]
    buffer_load_dwordx4 v1, s[4:7], 0 offen lds
    v_mfma_f32_16x16x32_bf16 v[32:35], a[64:67], a[16:19], v[32:35]
    v_mfma_f32_16x16x32_bf16 v[32:35], a[68:71], a[20:23], v[32:35]
    v_mfma_f32_16x16x32_bf16 v[36:39], a[76:79], a[20:23], v[36:39]
    v_mfma_f32_16x16x32_bf16 v[36:39], a[72:75], a[16:19], v[36:39]
    s_add_u32 m0, s29, 102400
    v_mfma_f32_16x16x32_bf16 v[96:99], a[80:83], a[16:19], v[96:99]
    buffer_load_dwordx4 v2, s[8:11], s48 offen lds
    v_mfma_f32_16x16x32_bf16 v[96:99], a[84:87], a[20:23], v[96:99]
    v_mfma_f32_16x16x32_bf16 v[100:103], a[92:95], a[20:23], v[100:103]
    v_mfma_f32_16x16x32_bf16 v[100:103], a[88:91], a[16:19], v[100:103]
    v_mfma_f32_16x16x32_bf16 v[108:111], a[88:91], a[24:27], v[108:111]
    s_add_u32 m0, s29, 36864
    v_mfma_f32_16x16x32_bf16 v[108:111], a[92:95], a[28:31], v[108:111]
    buffer_load_dwordx4 v1, s[4:7], s41 offen lds
    v_mfma_f32_16x16x32_bf16 v[104:107], a[84:87], a[28:31], v[104:107]
    v_mfma_f32_16x16x32_bf16 v[104:107], a[80:83], a[24:27], v[104:107]
    v_mfma_f32_16x16x32_bf16 v[44:47], a[72:75], a[24:27], v[44:47]
    v_mfma_f32_16x16x32_bf16 v[44:47], a[76:79], a[28:31], v[44:47]
    s_add_u32 m0, s29, 106496
    v_mfma_f32_16x16x32_bf16 v[40:43], a[68:71], a[28:31], v[40:43]
    buffer_load_dwordx4 v2, s[8:11], s49 offen lds
    v_mfma_f32_16x16x32_bf16 v[40:43], a[64:67], a[24:27], v[40:43]
    v_mfma_f32_16x16x32_bf16 v[48:51], a[64:67], a[32:35], v[48:51]
    v_mfma_f32_16x16x32_bf16 v[48:51], a[68:71], a[36:39], v[48:51]
    v_mfma_f32_16x16x32_bf16 v[52:55], a[76:79], a[36:39], v[52:55]
    s_add_u32 m0, s29, 40960
    v_mfma_f32_16x16x32_bf16 v[52:55], a[72:75], a[32:35], v[52:55]
    buffer_load_dwordx4 v1, s[4:7], s42 offen lds
    v_mfma_f32_16x16x32_bf16 v[112:115], a[80:83], a[32:35], v[112:115]
    v_mfma_f32_16x16x32_bf16 v[112:115], a[84:87], a[36:39], v[112:115]
    v_mfma_f32_16x16x32_bf16 v[116:119], a[92:95], a[36:39], v[116:119]
    v_mfma_f32_16x16x32_bf16 v[116:119], a[88:91], a[32:35], v[116:119]
    s_add_u32 m0, s29, 110592
    v_mfma_f32_16x16x32_bf16 v[124:127], a[88:91], a[40:43], v[124:127]
    buffer_load_dwordx4 v2, s[8:11], s50 offen lds
    v_mfma_f32_16x16x32_bf16 v[124:127], a[92:95], a[44:47], v[124:127]
    v_mfma_f32_16x16x32_bf16 v[120:123], a[84:87], a[44:47], v[120:123]
    v_mfma_f32_16x16x32_bf16 v[120:123], a[80:83], a[40:43], v[120:123]
    v_mfma_f32_16x16x32_bf16 v[60:63], a[72:75], a[40:43], v[60:63]
    s_add_u32 m0, s29, 45056
    v_mfma_f32_16x16x32_bf16 v[60:63], a[76:79], a[44:47], v[60:63]
    buffer_load_dwordx4 v1, s[4:7], s43 offen lds
    v_mfma_f32_16x16x32_bf16 v[56:59], a[68:71], a[44:47], v[56:59]
    v_mfma_f32_16x16x32_bf16 v[56:59], a[64:67], a[40:43], v[56:59]
    v_mfma_f32_16x16x32_bf16 v[64:67], a[64:67], a[48:51], v[64:67]
    v_mfma_f32_16x16x32_bf16 v[64:67], a[68:71], a[52:55], v[64:67]
    s_add_u32 m0, s29, 114688
    v_mfma_f32_16x16x32_bf16 v[68:71], a[76:79], a[52:55], v[68:71]
    buffer_load_dwordx4 v2, s[8:11], s51 offen lds
    v_mfma_f32_16x16x32_bf16 v[68:71], a[72:75], a[48:51], v[68:71]
    v_mfma_f32_16x16x32_bf16 v[128:131], a[80:83], a[48:51], v[128:131]
    v_mfma_f32_16x16x32_bf16 v[128:131], a[84:87], a[52:55], v[128:131]
    v_mfma_f32_16x16x32_bf16 v[132:135], a[92:95], a[52:55], v[132:135]
    s_add_u32 m0, s29, 49152
    v_mfma_f32_16x16x32_bf16 v[132:135], a[88:91], a[48:51], v[132:135]
    buffer_load_dwordx4 v1, s[4:7], s44 offen lds
    v_mfma_f32_16x16x32_bf16 v[140:143], a[88:91], a[56:59], v[140:143]
    v_mfma_f32_16x16x32_bf16 v[140:143], a[92:95], a[60:63], v[140:143]
    v_mfma_f32_16x16x32_bf16 v[136:139], a[84:87], a[60:63], v[136:139]
    v_mfma_f32_16x16x32_bf16 v[136:139], a[80:83], a[56:59], v[136:139]
    s_add_u32 m0, s29, 118784
    v_mfma_f32_16x16x32_bf16 v[76:79], a[72:75], a[56:59], v[76:79]
    s_waitcnt vmcnt(10)
    buffer_load_dwordx4 v2, s[8:11], s52 offen lds
    v_mfma_f32_16x16x32_bf16 v[76:79], a[76:79], a[60:63], v[76:79]
    s_barrier
    ds_read_b64_tr_b16 a[0:1], v6 offset:0
    v_mfma_f32_16x16x32_bf16 v[72:75], a[68:71], a[60:63], v[72:75]
    ds_read_b64_tr_b16 a[2:3], v6 offset:4096
    v_mfma_f32_16x16x32_bf16 v[72:75], a[64:67], a[56:59], v[72:75]
    ds_read_b128 a[64:67], v4 offset:0
    v_mfma_f32_16x16x32_bf16 v[176:179], a[96:99], a[32:35], v[176:179]
    s_add_u32 m0, s29, 53248
    v_mfma_f32_16x16x32_bf16 v[176:179], a[100:103], a[36:39], v[176:179]
    buffer_load_dwordx4 v1, s[4:7], s45 offen lds
    v_mfma_f32_16x16x32_bf16 v[180:183], a[108:111], a[36:39], v[180:183]
    ds_read_b64_tr_b16 a[4:5], v6 offset:16384
    v_mfma_f32_16x16x32_bf16 v[180:183], a[104:107], a[32:35], v[180:183]
    ds_read_b64_tr_b16 a[6:7], v6 offset:20480
    v_mfma_f32_16x16x32_bf16 v[240:243], a[112:115], a[32:35], v[240:243]
    ds_read_b128 a[68:71], v5 offset:0
    v_mfma_f32_16x16x32_bf16 v[240:243], a[116:119], a[36:39], v[240:243]
    s_add_u32 m0, s29, 122880
    v_mfma_f32_16x16x32_bf16 v[244:247], a[124:127], a[36:39], v[244:247]
    buffer_load_dwordx4 v2, s[8:11], s53 offen lds
    v_mfma_f32_16x16x32_bf16 v[244:247], a[120:123], a[32:35], v[244:247]
    ds_read_b128 a[76:79], v5 offset:2048
    v_mfma_f32_16x16x32_bf16 v[252:255], a[120:123], a[40:43], v[252:255]
    v_mfma_f32_16x16x32_bf16 v[252:255], a[124:127], a[44:47], v[252:255]
    ds_read_b128 a[72:75], v4 offset:2048
    v_mfma_f32_16x16x32_bf16 v[248:251], a[116:119], a[44:47], v[248:251]
    s_add_u32 m0, s29, 57344
    v_mfma_f32_16x16x32_bf16 v[248:251], a[112:115], a[40:43], v[248:251]
    buffer_load_dwordx4 v1, s[4:7], s46 offen lds
    v_mfma_f32_16x16x32_bf16 v[188:191], a[104:107], a[40:43], v[188:191]
    ds_read_b128 a[80:83], v4 offset:4096
    v_mfma_f32_16x16x32_bf16 v[188:191], a[108:111], a[44:47], v[188:191]
    v_mfma_f32_16x16x32_bf16 v[184:187], a[100:103], a[44:47], v[184:187]
    ds_read_b128 a[84:87], v5 offset:4096
    v_mfma_f32_16x16x32_bf16 v[184:187], a[96:99], a[40:43], v[184:187]
    s_add_u32 m0, s29, 126976
    v_mfma_f32_16x16x32_bf16 v[192:195], a[96:99], a[48:51], v[192:195]
    buffer_load_dwordx4 v2, s[8:11], s54 offen lds
    v_mfma_f32_16x16x32_bf16 v[192:195], a[100:103], a[52:55], v[192:195]
    ds_read_b128 a[92:95], v5 offset:6144
    v_mfma_f32_16x16x32_bf16 v[196:199], a[108:111], a[52:55], v[196:199]
    v_mfma_f32_16x16x32_bf16 v[196:199], a[104:107], a[48:51], v[196:199]
    ds_read_b128 a[88:91], v4 offset:6144
    v_mfma_f32_16x16x32_bf16 a[224:227], a[112:115], a[48:51], a[224:227]
    s_add_u32 m0, s29, 61440
    v_mfma_f32_16x16x32_bf16 a[224:227], a[116:119], a[52:55], a[224:227]
    buffer_load_dwordx4 v1, s[4:7], s47 offen lds
    v_mfma_f32_16x16x32_bf16 a[228:231], a[124:127], a[52:55], a[228:231]
    v_add_u32 v1, 128, v1
    v_add_u32 v2, 0x80000, v2
    v_mfma_f32_16x16x32_bf16 a[228:231], a[120:123], a[48:51], a[228:231]
    ds_read_b64_tr_b16 a[8:9], v7 offset:0
    v_mfma_f32_16x16x32_bf16 a[236:239], a[120:123], a[56:59], a[236:239]
    ds_read_b64_tr_b16 a[10:11], v7 offset:4096
    v_mfma_f32_16x16x32_bf16 a[236:239], a[124:127], a[60:63], a[236:239]
    ds_read_b64_tr_b16 a[12:13], v7 offset:16384
    v_mfma_f32_16x16x32_bf16 a[232:235], a[116:119], a[60:63], a[232:235]
    ds_read_b64_tr_b16 a[14:15], v7 offset:20480
    v_mfma_f32_16x16x32_bf16 a[232:235], a[112:115], a[56:59], a[232:235]
    ds_read_b64_tr_b16 a[16:17], v8 offset:0
    v_mfma_f32_16x16x32_bf16 v[204:207], a[104:107], a[56:59], v[204:207]
    ds_read_b64_tr_b16 a[18:19], v8 offset:4096
    v_mfma_f32_16x16x32_bf16 v[204:207], a[108:111], a[60:63], v[204:207]
    ds_read_b64_tr_b16 a[20:21], v8 offset:16384
    v_mfma_f32_16x16x32_bf16 v[200:203], a[100:103], a[60:63], v[200:203]
    s_add_u32 s61, s61, 1
    ds_read_b64_tr_b16 a[22:23], v8 offset:20480
    v_mfma_f32_16x16x32_bf16 v[200:203], a[96:99], a[56:59], v[200:203]
    s_waitcnt lgkmcnt(8)
    ds_read_b64_tr_b16 a[24:25], v9 offset:0
    s_cmp_lt_u32 s61, 8
    s_cbranch_scc1 L_vloop
L_kvdone:
    s_lshl_b32 s60, s63, 7
    s_mov_b32 s41, 28672
    s_mov_b32 s42, 57344
    s_mov_b32 s43, 86016
    s_waitcnt vmcnt(0) lgkmcnt(0)
    s_lshl_b32 s58, s3, 3
    s_add_u32 s58, s58, s60
    v_lshrrev_b32 v14, 3, v0
    v_add_u32 v14, s58, v14
    v_mul_u32_u24 v14, 896, v14
    s_lshl_b32 s58, s39, 2
    v_lshrrev_b32 v15, 4, v0
    v_add_u32 v15, s58, v15
    v_xor_b32 v15, v0, v15
    v_and_b32 v15, 7, v15
    v_lshl_add_u32 v1, v15, 4, v14
    v_lshrrev_b32 v14, 5, v0
    s_lshl_b32 s58, s3, 1
    v_add_u32 v15, s58, v14
    v_lshlrev_b32 v15, 1, v15
    v_xor_b32 v15, v0, v15
    v_and_b32 v15, 31, v15
    v_lshlrev_b32 v15, 4, v15
    v_add_u32 v14, s56, v14
    v_lshl_add_u32 v14, v14, 13, v15
    s_lshl_b32 s58, s26, 9
    v_add_u32 v2, s58, v14
    s_mov_b32 s4, s76
    s_mov_b32 s5, s77
    s_mov_b32 s6, 1835008
    s_mov_b32 s7, 0x20000
    s_mov_b32 s8, s80
    s_mov_b32 s9, s81
    s_mov_b32 s10, 3670016
    s_mov_b32 s11, 0x20000
    s_barrier
    s_add_u32 m0, s29, 98304
    s_nop 0
    buffer_load_dwordx4 v2, s[8:11], 0 offen lds
    s_add_u32 m0, s29, 102400
    s_nop 0
    buffer_load_dwordx4 v2, s[8:11], s48 offen lds
    s_add_u32 m0, s29, 32768
    s_nop 0
    buffer_load_dwordx4 v1, s[4:7], 0 offen lds
    s_add_u32 m0, s29, 106496
    s_nop 0
    buffer_load_dwordx4 v2, s[8:11], s49 offen lds
    s_add_u32 m0, s29, 110592
    s_nop 0
    buffer_load_dwordx4 v2, s[8:11], s50 offen lds
    s_add_u32 m0, s29, 36864
    s_nop 0
    buffer_load_dwordx4 v1, s[4:7], s41 offen lds
    s_add_u32 m0, s29, 114688
    s_nop 0
    buffer_load_dwordx4 v2, s[8:11], s51 offen lds
    s_add_u32 m0, s29, 118784
    s_nop 0
    buffer_load_dwordx4 v2, s[8:11], s52 offen lds
    s_add_u32 m0, s29, 40960
    s_nop 0
    buffer_load_dwordx4 v1, s[4:7], s42 offen lds
    s_add_u32 m0, s29, 122880
    s_nop 0
    buffer_load_dwordx4 v2, s[8:11], s53 offen lds
    s_add_u32 m0, s29, 126976
    s_nop 0
    buffer_load_dwordx4 v2, s[8:11], s54 offen lds
    s_add_u32 m0, s29, 45056
    s_nop 0
    buffer_load_dwordx4 v1, s[4:7], s43 offen lds
    v_add_u32 v1, 128, v1
    v_add_u32 v2, 0x80000, v2
    s_add_u32 m0, s29, 65536
    s_nop 0
    buffer_load_dwordx4 v2, s[8:11], 0 offen lds
    s_add_u32 m0, s29, 69632
    s_nop 0
    buffer_load_dwordx4 v2, s[8:11], s48 offen lds
    s_add_u32 m0, s29, 0
    s_nop 0
    buffer_load_dwordx4 v1, s[4:7], 0 offen lds
    s_add_u32 m0, s29, 73728
    s_nop 0
    buffer_load_dwordx4 v2, s[8:11], s49 offen lds
    s_add_u32 m0, s29, 77824
    s_nop 0
    buffer_load_dwordx4 v2, s[8:11], s50 offen lds
    s_add_u32 m0, s29, 4096
    s_nop 0
    buffer_load_dwordx4 v1, s[4:7], s41 offen lds
    s_add_u32 m0, s29, 81920
    s_nop 0
    buffer_load_dwordx4 v2, s[8:11], s51 offen lds
    s_add_u32 m0, s29, 86016
    s_nop 0
    buffer_load_dwordx4 v2, s[8:11], s52 offen lds
    s_add_u32 m0, s29, 8192
    s_nop 0
    buffer_load_dwordx4 v1, s[4:7], s42 offen lds
    s_add_u32 m0, s29, 90112
    s_nop 0
    buffer_load_dwordx4 v2, s[8:11], s53 offen lds
    s_add_u32 m0, s29, 94208
    s_nop 0
    buffer_load_dwordx4 v2, s[8:11], s54 offen lds
    s_add_u32 m0, s29, 12288
    s_nop 0
    buffer_load_dwordx4 v1, s[4:7], s43 offen lds
    v_add_u32 v1, 128, v1
    v_add_u32 v2, 0x80000, v2
    s_lshl_b32 s58, s24, 3
    v_mov_b32 v13, s58
    global_load_dwordx2 v[14:15], v13, s[90:91] sc1
    s_lshl_b32 s58, s26, 20
    s_lshl_b32 s59, s25, 17
    s_add_u32 s58, s58, s59
    s_lshl_b32 s59, s39, 16
    s_add_u32 s58, s58, s59
    s_lshl_b32 s59, s40, 12
    s_lshl_b32 s59, s59, s27
    s_add_u32 s58, s58, s59
    s_lshl_b32 s59, s27, 24
    s_add_u32 s58, s58, s59
    s_cmp_eq_u32 s27, 0
    s_movk_i32 s44, 0x2000
    s_cselect_b32 s45, s44, 0x3000
    s_cselect_b32 s44, s44, 0x1000
    v_cvt_pk_bf16_f32 v16, v16, v17
    v_cvt_pk_bf16_f32 v17, v18, v19
    v_cvt_pk_bf16_f32 v18, v20, v21
    v_cvt_pk_bf16_f32 v19, v22, v23
    buffer_store_dwordx4 v[16:19], v3, s[12:15], s58 offen offset:0
    v_cvt_pk_bf16_f32 v24, v24, v25
    v_cvt_pk_bf16_f32 v25, v26, v27
    v_cvt_pk_bf16_f32 v26, v28, v29
    v_cvt_pk_bf16_f32 v27, v30, v31
    buffer_store_dwordx4 v[24:27], v3, s[12:15], s58 offen offset:1024
    v_cvt_pk_bf16_f32 v32, v32, v33
    v_cvt_pk_bf16_f32 v33, v34, v35
    v_cvt_pk_bf16_f32 v34, v36, v37
    v_cvt_pk_bf16_f32 v35, v38, v39
    buffer_store_dwordx4 v[32:35], v3, s[12:15], s58 offen offset:2048
    v_cvt_pk_bf16_f32 v40, v40, v41
    v_cvt_pk_bf16_f32 v41, v42, v43
    v_cvt_pk_bf16_f32 v42, v44, v45
    v_cvt_pk_bf16_f32 v43, v46, v47
    buffer_store_dwordx4 v[40:43], v3, s[12:15], s58 offen offset:3072
    s_add_u32 s58, s58, s44
    v_cvt_pk_bf16_f32 v48, v48, v49
    v_cvt_pk_bf16_f32 v49, v50, v51
    v_cvt_pk_bf16_f32 v50, v52, v53
    v_cvt_pk_bf16_f32 v51, v54, v55
    buffer_store_dwordx4 v[48:51], v3, s[12:15], s58 offen offset:0
    v_cvt_pk_bf16_f32 v56, v56, v57
    v_cvt_pk_bf16_f32 v57, v58, v59
    v_cvt_pk_bf16_f32 v58, v60, v61
    v_cvt_pk_bf16_f32 v59, v62, v63
    buffer_store_dwordx4 v[56:59], v3, s[12:15], s58 offen offset:1024
    v_cvt_pk_bf16_f32 v64, v64, v65
    v_cvt_pk_bf16_f32 v65, v66, v67
    v_cvt_pk_bf16_f32 v66, v68, v69
    v_cvt_pk_bf16_f32 v67, v70, v71
    buffer_store_dwordx4 v[64:67], v3, s[12:15], s58 offen offset:2048
    v_cvt_pk_bf16_f32 v72, v72, v73
    v_cvt_pk_bf16_f32 v73, v74, v75
    v_cvt_pk_bf16_f32 v74, v76, v77
    v_cvt_pk_bf16_f32 v75, v78, v79
    buffer_store_dwordx4 v[72:75], v3, s[12:15], s58 offen offset:3072
    s_add_u32 s58, s58, s45
    v_cvt_pk_bf16_f32 v80, v80, v81
    v_cvt_pk_bf16_f32 v81, v82, v83
    v_cvt_pk_bf16_f32 v82, v84, v85
    v_cvt_pk_bf16_f32 v83, v86, v87
    buffer_store_dwordx4 v[80:83], v3, s[12:15], s58 offen offset:0
    v_cvt_pk_bf16_f32 v88, v88, v89
    v_cvt_pk_bf16_f32 v89, v90, v91
    v_cvt_pk_bf16_f32 v90, v92, v93
    v_cvt_pk_bf16_f32 v91, v94, v95
    buffer_store_dwordx4 v[88:91], v3, s[12:15], s58 offen offset:1024
    v_cvt_pk_bf16_f32 v96, v96, v97
    v_cvt_pk_bf16_f32 v97, v98, v99
    v_cvt_pk_bf16_f32 v98, v100, v101
    v_cvt_pk_bf16_f32 v99, v102, v103
    buffer_store_dwordx4 v[96:99], v3, s[12:15], s58 offen offset:2048
    v_cvt_pk_bf16_f32 v104, v104, v105
    v_cvt_pk_bf16_f32 v105, v106, v107
    v_cvt_pk_bf16_f32 v106, v108, v109
    v_cvt_pk_bf16_f32 v107, v110, v111
    buffer_store_dwordx4 v[104:107], v3, s[12:15], s58 offen offset:3072
    s_add_u32 s58, s58, s44
    v_cvt_pk_bf16_f32 v112, v112, v113
    v_cvt_pk_bf16_f32 v113, v114, v115
    v_cvt_pk_bf16_f32 v114, v116, v117
    v_cvt_pk_bf16_f32 v115, v118, v119
    buffer_store_dwordx4 v[112:115], v3, s[12:15], s58 offen offset:0
    v_cvt_pk_bf16_f32 v120, v120, v121
    v_cvt_pk_bf16_f32 v121, v122, v123
    v_cvt_pk_bf16_f32 v122, v124, v125
    v_cvt_pk_bf16_f32 v123, v126, v127
    buffer_store_dwordx4 v[120:123], v3, s[12:15], s58 offen offset:1024
    v_cvt_pk_bf16_f32 v128, v128, v129
    v_cvt_pk_bf16_f32 v129, v130, v131
    v_cvt_pk_bf16_f32 v130, v132, v133
    v_cvt_pk_bf16_f32 v131, v134, v135
    buffer_store_dwordx4 v[128:131], v3, s[12:15], s58 offen offset:2048
    v_cvt_pk_bf16_f32 v136, v136, v137
    v_cvt_pk_bf16_f32 v137, v138, v139
    v_cvt_pk_bf16_f32 v138, v140, v141
    v_cvt_pk_bf16_f32 v139, v142, v143
    buffer_store_dwordx4 v[136:139], v3, s[12:15], s58 offen offset:3072
    s_add_u32 s58, s58, s45
    v_cvt_pk_bf16_f32 v144, v144, v145
    v_cvt_pk_bf16_f32 v145, v146, v147
    v_cvt_pk_bf16_f32 v146, v148, v149
    v_cvt_pk_bf16_f32 v147, v150, v151
    buffer_store_dwordx4 v[144:147], v3, s[12:15], s58 offen offset:0
    v_cvt_pk_bf16_f32 v152, v152, v153
    v_cvt_pk_bf16_f32 v153, v154, v155
    v_cvt_pk_bf16_f32 v154, v156, v157
    v_cvt_pk_bf16_f32 v155, v158, v159
    buffer_store_dwordx4 v[152:155], v3, s[12:15], s58 offen offset:1024
    v_cvt_pk_bf16_f32 v160, v160, v161
    v_cvt_pk_bf16_f32 v161, v162, v163
    v_cvt_pk_bf16_f32 v162, v164, v165
    v_cvt_pk_bf16_f32 v163, v166, v167
    buffer_store_dwordx4 v[160:163], v3, s[12:15], s58 offen offset:2048
    v_cvt_pk_bf16_f32 v168, v168, v169
    v_cvt_pk_bf16_f32 v169, v170, v171
    v_cvt_pk_bf16_f32 v170, v172, v173
    v_cvt_pk_bf16_f32 v171, v174, v175
    buffer_store_dwordx4 v[168:171], v3, s[12:15], s58 offen offset:3072
    s_add_u32 s58, s58, s44
    v_cvt_pk_bf16_f32 v176, v176, v177
    v_cvt_pk_bf16_f32 v177, v178, v179
    v_cvt_pk_bf16_f32 v178, v180, v181
    v_cvt_pk_bf16_f32 v179, v182, v183
    buffer_store_dwordx4 v[176:179], v3, s[12:15], s58 offen offset:0
    v_cvt_pk_bf16_f32 v184, v184, v185
    v_cvt_pk_bf16_f32 v185, v186, v187
    v_cvt_pk_bf16_f32 v186, v188, v189
    v_cvt_pk_bf16_f32 v187, v190, v191
    buffer_store_dwordx4 v[184:187], v3, s[12:15], s58 offen offset:1024
    v_cvt_pk_bf16_f32 v192, v192, v193
    v_cvt_pk_bf16_f32 v193, v194, v195
    v_cvt_pk_bf16_f32 v194, v196, v197
    v_cvt_pk_bf16_f32 v195, v198, v199
    buffer_store_dwordx4 v[192:195], v3, s[12:15], s58 offen offset:2048
    v_cvt_pk_bf16_f32 v200, v200, v201
    v_cvt_pk_bf16_f32 v201, v202, v203
    v_cvt_pk_bf16_f32 v202, v204, v205
    v_cvt_pk_bf16_f32 v203, v206, v207
    buffer_store_dwordx4 v[200:203], v3, s[12:15], s58 offen offset:3072
    s_add_u32 s58, s58, s45
    v_cvt_pk_bf16_f32 v208, v208, v209
    v_cvt_pk_bf16_f32 v209, v210, v211
    v_cvt_pk_bf16_f32 v210, v212, v213
    v_cvt_pk_bf16_f32 v211, v214, v215
    buffer_store_dwordx4 v[208:211], v3, s[12:15], s58 offen offset:0
    v_cvt_pk_bf16_f32 v216, v216, v217
    v_cvt_pk_bf16_f32 v217, v218, v219
    v_cvt_pk_bf16_f32 v218, v220, v221
    v_cvt_pk_bf16_f32 v219, v222, v223
    buffer_store_dwordx4 v[216:219], v3, s[12:15], s58 offen offset:1024
    v_cvt_pk_bf16_f32 v224, v224, v225
    v_cvt_pk_bf16_f32 v225, v226, v227
    v_cvt_pk_bf16_f32 v226, v228, v229
    v_cvt_pk_bf16_f32 v227, v230, v231
    buffer_store_dwordx4 v[224:227], v3, s[12:15], s58 offen offset:2048
    v_cvt_pk_bf16_f32 v232, v232, v233
    v_cvt_pk_bf16_f32 v233, v234, v235
    v_cvt_pk_bf16_f32 v234, v236, v237
    v_cvt_pk_bf16_f32 v235, v238, v239
    buffer_store_dwordx4 v[232:235], v3, s[12:15], s58 offen offset:3072
    s_add_u32 s58, s58, s44
    v_cvt_pk_bf16_f32 v240, v240, v241
    v_cvt_pk_bf16_f32 v241, v242, v243
    v_cvt_pk_bf16_f32 v242, v244, v245
    v_cvt_pk_bf16_f32 v243, v246, v247
    buffer_store_dwordx4 v[240:243], v3, s[12:15], s58 offen offset:0
    v_cvt_pk_bf16_f32 v248, v248, v249
    v_cvt_pk_bf16_f32 v249, v250, v251
    v_cvt_pk_bf16_f32 v250, v252, v253
    v_cvt_pk_bf16_f32 v251, v254, v255
    buffer_store_dwordx4 v[248:251], v3, s[12:15], s58 offen offset:1024
    v_accvgpr_read_b32 v16, a224
    v_accvgpr_read_b32 v17, a225
    v_accvgpr_read_b32 v18, a226
    v_accvgpr_read_b32 v19, a227
    v_accvgpr_read_b32 v20, a228
    v_accvgpr_read_b32 v21, a229
    v_accvgpr_read_b32 v22, a230
    v_accvgpr_read_b32 v23, a231
    v_cvt_pk_bf16_f32 v16, v16, v17
    v_cvt_pk_bf16_f32 v17, v18, v19
    v_cvt_pk_bf16_f32 v18, v20, v21
    v_cvt_pk_bf16_f32 v19, v22, v23
    buffer_store_dwordx4 v[16:19], v3, s[12:15], s58 offen offset:2048
    v_accvgpr_read_b32 v24, a232
    v_accvgpr_read_b32 v25, a233
    v_accvgpr_read_b32 v26, a234
    v_accvgpr_read_b32 v27, a235
    v_accvgpr_read_b32 v28, a236
    v_accvgpr_read_b32 v29, a237
    v_accvgpr_read_b32 v30, a238
    v_accvgpr_read_b32 v31, a239
    v_cvt_pk_bf16_f32 v24, v24, v25
    v_cvt_pk_bf16_f32 v25, v26, v27
    v_cvt_pk_bf16_f32 v26, v28, v29
    v_cvt_pk_bf16_f32 v27, v30, v31
    buffer_store_dwordx4 v[24:27], v3, s[12:15], s58 offen offset:3072
    s_add_u32 s58, s58, s45
    s_waitcnt vmcnt(32)
    v_or_b32 v14, v14, v15
    v_and_b32 v14, 0x20202020, v14
    s_nop 0
    v_readfirstlane_b32 s30, v14
    s_lshl_b32 s59, s3, 2
    v_and_b32 v14, 15, v0
    v_lshrrev_b32 v15, 4, v0
    v_lshrrev_b32 v5, 1, v14
    v_xor_b32 v5, v5, v15
    v_add_u32 v14, 0, v14
    v_lshlrev_b32 v14, 7, v14
    v_lshl_add_u32 v4, v5, 4, v14
    v_xor_b32 v5, 64, v4
    v_bfe_u32 v14, v0, 2, 3
    v_lshrrev_b32 v15, 5, v0
    v_lshl_add_u32 v13, v15, 4, v14
    v_lshlrev_b32 v13, 9, v13
    v_xor_b32 v14, s59, v14
    v_lshl_add_u32 v13, v14, 5, v13
    v_and_b32 v14, 3, v0
    v_lshl_add_u32 v13, v14, 3, v13
    v_add_u32 v6, 0x10000, v13
    v_xor_b32 v7, 32, v6
    v_xor_b32 v8, 64, v6
    v_xor_b32 v9, 96, v6
    v_mov_b64 v[128:129], 0
    v_mov_b64 v[130:131], 0
    v_mov_b64 v[132:133], 0
    v_mov_b64 v[134:135], 0
    v_mov_b64 v[136:137], 0
    v_mov_b64 v[138:139], 0
    v_mov_b64 v[140:141], 0
    v_mov_b64 v[142:143], 0
    v_mov_b64 v[144:145], 0
    v_mov_b64 v[146:147], 0
    v_mov_b64 v[148:149], 0
    v_mov_b64 v[150:151], 0
    v_mov_b64 v[152:153], 0
    v_mov_b64 v[154:155], 0
    v_mov_b64 v[156:157], 0
    v_mov_b64 v[158:159], 0
    v_mov_b64 v[160:161], 0
    v_mov_b64 v[162:163], 0
    v_mov_b64 v[164:165], 0
    v_mov_b64 v[166:167], 0
    v_mov_b64 v[168:169], 0
    v_mov_b64 v[170:171], 0
    v_mov_b64 v[172:173], 0
    v_mov_b64 v[174:175], 0
    v_mov_b64 v[176:177], 0
    v_mov_b64 v[178:179], 0
    v_mov_b64 v[180:181], 0
    v_mov_b64 v[182:183], 0
    v_mov_b64 v[184:185], 0
    v_mov_b64 v[186:187], 0
    v_mov_b64 v[188:189], 0
    v_mov_b64 v[190:191], 0
    v_mov_b64 v[192:193], 0
    v_mov_b64 v[194:195], 0
    v_mov_b64 v[196:197], 0
    v_mov_b64 v[198:199], 0
    v_mov_b64 v[200:201], 0
    v_mov_b64 v[202:203], 0
    v_mov_b64 v[204:205], 0
    v_mov_b64 v[206:207], 0
    v_mov_b64 v[208:209], 0
    v_mov_b64 v[210:211], 0
    v_mov_b64 v[212:213], 0
    v_mov_b64 v[214:215], 0
    v_mov_b64 v[216:217], 0
    v_mov_b64 v[218:219], 0
    v_mov_b64 v[220:221], 0
    v_mov_b64 v[222:223], 0
    v_mov_b64 v[224:225], 0
    v_mov_b64 v[226:227], 0
    v_mov_b64 v[228:229], 0
    v_mov_b64 v[230:231], 0
    v_mov_b64 v[232:233], 0
    v_mov_b64 v[234:235], 0
    v_mov_b64 v[236:237], 0
    v_mov_b64 v[238:239], 0
    v_mov_b64 v[240:241], 0
    v_mov_b64 v[242:243], 0
    v_mov_b64 v[244:245], 0
    v_mov_b64 v[246:247], 0
    v_mov_b64 v[248:249], 0
    v_mov_b64 v[250:251], 0
    v_mov_b64 v[252:253], 0
    v_mov_b64 v[254:255], 0
    s_mov_b32 s61, 0
    s_barrier
    ds_read_b64_tr_b16 a[32:33], v6 offset:32768
    ds_read_b64_tr_b16 a[34:35], v6 offset:36864
    ds_read_b128 a[160:163], v4 offset:40960
    ds_read_b64_tr_b16 a[36:37], v6 offset:49152
    ds_read_b64_tr_b16 a[38:39], v6 offset:53248
    ds_read_b128 a[164:167], v5 offset:40960
    ds_read_b128 a[172:175], v5 offset:43008
    ds_read_b128 a[168:171], v4 offset:43008
    ds_read_b128 a[176:179], v4 offset:45056
    ds_read_b128 a[180:183], v5 offset:45056
    ds_read_b128 a[188:191], v5 offset:47104
    ds_read_b128 a[184:187], v4 offset:47104
    ds_read_b64_tr_b16 a[40:41], v7 offset:32768
    ds_read_b64_tr_b16 a[42:43], v7 offset:36864
    ds_read_b64_tr_b16 a[44:45], v7 offset:49152
    ds_read_b64_tr_b16 a[46:47], v7 offset:53248
    ds_read_b128 a[128:131], v4 offset:32768
    ds_read_b128 a[132:135], v5 offset:32768
    ds_read_b128 a[140:143], v5 offset:34816
    s_waitcnt lgkmcnt(0)
    s_branch L_qentry
.p2align 6
L_qloop:
    v_mfma_f32_16x16x32_bf16 v[128:131], a[0:3], a[64:67], v[128:131]
    v_mfma_f32_16x16x32_bf16 v[128:131], a[4:7], a[68:71], v[128:131]
    s_cmp_eq_u32 s61, 3
    s_cmov_b32 s6, 0
    ds_read_b128 a[104:107], v4 offset:10240
    v_mfma_f32_16x16x32_bf16 v[144:147], a[4:7], a[76:79], v[144:147]
    v_mfma_f32_16x16x32_bf16 v[144:147], a[0:3], a[72:75], v[144:147]
    ds_read_b128 a[112:115], v4 offset:12288
    v_mfma_f32_16x16x32_bf16 v[160:163], a[0:3], a[80:83], v[160:163]
    v_mfma_f32_16x16x32_bf16 v[160:163], a[4:7], a[84:87], v[160:163]
    s_waitcnt lgkmcnt(8)
    ds_read_b128 a[116:119], v5 offset:12288
    v_mfma_f32_16x16x32_bf16 v[176:179], a[4:7], a[92:95], v[176:179]
    v_mfma_f32_16x16x32_bf16 v[176:179], a[0:3], a[88:91], v[176:179]
    s_waitcnt lgkmcnt(6)
    ds_read_b128 a[124:127], v5 offset:14336
    v_mfma_f32_16x16x32_bf16 v[180:183], a[8:11], a[88:91], v[180:183]
    v_mfma_f32_16x16x32_bf16 v[180:183], a[12:15], a[92:95], v[180:183]
    ds_read_b128 a[120:123], v4 offset:14336
    v_mfma_f32_16x16x32_bf16 v[164:167], a[12:15], a[84:87], v[164:167]
    v_mfma_f32_16x16x32_bf16 v[164:167], a[8:11], a[80:83], v[164:167]
    ds_read_b64_tr_b16 a[16:17], v8 offset:0
    v_mfma_f32_16x16x32_bf16 v[148:151], a[8:11], a[72:75], v[148:151]
    ds_read_b64_tr_b16 a[18:19], v8 offset:4096
    v_mfma_f32_16x16x32_bf16 v[148:151], a[12:15], a[76:79], v[148:151]
    ds_read_b64_tr_b16 a[20:21], v8 offset:16384
    v_mfma_f32_16x16x32_bf16 v[132:135], a[12:15], a[68:71], v[132:135]
    ds_read_b64_tr_b16 a[22:23], v8 offset:20480
    v_mfma_f32_16x16x32_bf16 v[132:135], a[8:11], a[64:67], v[132:135]
    s_waitcnt lgkmcnt(8)
    ds_read_b64_tr_b16 a[24:25], v9 offset:0
    v_mfma_f32_16x16x32_bf16 v[192:195], a[0:3], a[96:99], v[192:195]
    ds_read_b64_tr_b16 a[26:27], v9 offset:4096
    v_mfma_f32_16x16x32_bf16 v[192:195], a[4:7], a[100:103], v[192:195]
    ds_read_b64_tr_b16 a[28:29], v9 offset:16384
    v_mfma_f32_16x16x32_bf16 v[208:211], a[4:7], a[108:111], v[208:211]
    ds_read_b64_tr_b16 a[30:31], v9 offset:20480
    v_mfma_f32_16x16x32_bf16 v[208:211], a[0:3], a[104:107], v[208:211]
    s_waitcnt lgkmcnt(8)
    v_mfma_f32_16x16x32_bf16 v[224:227], a[0:3], a[112:115], v[224:227]
    v_mfma_f32_16x16x32_bf16 v[224:227], a[4:7], a[116:119], v[224:227]
    s_waitcnt vmcnt(0) lgkmcnt(0)
    v_mfma_f32_16x16x32_bf16 v[240:243], a[4:7], a[124:127], v[240:243]
    s_barrier
    ds_read_b64_tr_b16 a[32:33], v6 offset:32768
    v_mfma_f32_16x16x32_bf16 v[240:243], a[0:3], a[120:123], v[240:243]
    s_add_u32 m0, s29, 65536
    ds_read_b64_tr_b16 a[34:35], v6 offset:36864
    v_mfma_f32_16x16x32_bf16 v[244:247], a[8:11], a[120:123], v[244:247]
    buffer_load_dwordx4 v2, s[8:11], 0 offen lds
    v_mfma_f32_16x16x32_bf16 v[244:247], a[12:15], a[124:127], v[244:247]
    ds_read_b128 a[160:163], v4 offset:40960
    v_mfma_f32_16x16x32_bf16 v[228:231], a[12:15], a[116:119], v[228:231]
    s_add_u32 m0, s29, 69632
    v_mfma_f32_16x16x32_bf16 v[228:231], a[8:11], a[112:115], v[228:231]
    buffer_load_dwordx4 v2, s[8:11], s48 offen lds
    v_mfma_f32_16x16x32_bf16 v[212:215], a[8:11], a[104:107], v[212:215]
    ds_read_b64_tr_b16 a[36:37], v6 offset:49152
    v_mfma_f32_16x16x32_bf16 v[212:215], a[12:15], a[108:111], v[212:215]
    s_add_u32 m0, s29, 0
    ds_read_b64_tr_b16 a[38:39], v6 offset:53248
    v_mfma_f32_16x16x32_bf16 v[196:199], a[12:15], a[100:103], v[196:199]
    buffer_load_dwordx4 v1, s[4:7], 0 offen lds
    v_mfma_f32_16x16x32_bf16 v[196:199], a[8:11], a[96:99], v[196:199]
    ds_read_b128 a[164:167], v5 offset:40960
    v_mfma_f32_16x16x32_bf16 v[200:203], a[16:19], a[96:99], v[200:203]
    s_add_u32 m0, s29, 73728
    v_mfma_f32_16x16x32_bf16 v[200:203], a[20:23], a[100:103], v[200:203]
    buffer_load_dwordx4 v2, s[8:11], s49 offen lds
    v_mfma_f32_16x16x32_bf16 v[216:219], a[20:23], a[108:111], v[216:219]
    ds_read_b128 a[172:175], v5 offset:43008
    v_mfma_f32_16x16x32_bf16 v[216:219], a[16:19], a[104:107], v[216:219]
    s_add_u32 m0, s29, 77824
    v_mfma_f32_16x16x32_bf16 v[232:235], a[16:19], a[112:115], v[232:235]
    buffer_load_dwordx4 v2, s[8:11], s50 offen lds
    v_mfma_f32_16x16x32_bf16 v[232:235], a[20:23], a[116:119], v[232:235]
    ds_read_b128 a[168:171], v4 offset:43008
    v_mfma_f32_16x16x32_bf16 v[248:251], a[20:23], a[124:127], v[248:251]
    s_add_u32 m0, s29, 4096
    v_mfma_f32_16x16x32_bf16 v[248:251], a[16:19], a[120:123], v[248:251]
    buffer_load_dwordx4 v1, s[4:7], s41 offen lds
    v_mfma_f32_16x16x32_bf16 v[252:255], a[24:27], a[120:123], v[252:255]
    ds_read_b128 a[176:179], v4 offset:45056
    v_mfma_f32_16x16x32_bf16 v[252:255], a[28:31], a[124:127], v[252:255]
    s_add_u32 m0, s29, 81920
    v_mfma_f32_16x16x32_bf16 v[236:239], a[28:31], a[116:119], v[236:239]
    buffer_load_dwordx4 v2, s[8:11], s51 offen lds
    v_mfma_f32_16x16x32_bf16 v[236:239], a[24:27], a[112:115], v[236:239]
    ds_read_b128 a[180:183], v5 offset:45056
    v_mfma_f32_16x16x32_bf16 v[220:223], a[24:27], a[104:107], v[220:223]
    s_add_u32 m0, s29, 86016
    v_mfma_f32_16x16x32_bf16 v[220:223], a[28:31], a[108:111], v[220:223]
    buffer_load_dwordx4 v2, s[8:11], s52 offen lds
    v_mfma_f32_16x16x32_bf16 v[204:207], a[28:31], a[100:103], v[204:207]
    ds_read_b128 a[188:191], v5 offset:47104
    v_mfma_f32_16x16x32_bf16 v[204:207], a[24:27], a[96:99], v[204:207]
    s_add_u32 m0, s29, 8192
    v_mfma_f32_16x16x32_bf16 v[136:139], a[16:19], a[64:67], v[136:139]
    buffer_load_dwordx4 v1, s[4:7], s42 offen lds
    v_mfma_f32_16x16x32_bf16 v[136:139], a[20:23], a[68:71], v[136:139]
    ds_read_b128 a[184:187], v4 offset:47104
    v_mfma_f32_16x16x32_bf16 v[152:155], a[20:23], a[76:79], v[152:155]
    s_add_u32 m0, s29, 90112
    v_mfma_f32_16x16x32_bf16 v[152:155], a[16:19], a[72:75], v[152:155]
    buffer_load_dwordx4 v2, s[8:11], s53 offen lds
    v_mfma_f32_16x16x32_bf16 v[168:171], a[16:19], a[80:83], v[168:171]
    ds_read_b64_tr_b16 a[40:41], v7 offset:32768
    v_mfma_f32_16x16x32_bf16 v[168:171], a[20:23], a[84:87], v[168:171]
    s_add_u32 m0, s29, 94208
    ds_read_b64_tr_b16 a[42:43], v7 offset:36864
    v_mfma_f32_16x16x32_bf16 v[184:187], a[20:23], a[92:95], v[184:187]
    buffer_load_dwordx4 v2, s[8:11], s54 offen lds
    v_mfma_f32_16x16x32_bf16 v[184:187], a[16:19], a[88:91], v[184:187]
    ds_read_b64_tr_b16 a[44:45], v7 offset:49152
    v_mfma_f32_16x16x32_bf16 v[188:191], a[24:27], a[88:91], v[188:191]
    s_add_u32 m0, s29, 12288
    ds_read_b64_tr_b16 a[46:47], v7 offset:53248
    v_mfma_f32_16x16x32_bf16 v[188:191], a[28:31], a[92:95], v[188:191]
    buffer_load_dwordx4 v1, s[4:7], s43 offen lds
    v_mfma_f32_16x16x32_bf16 v[172:175], a[28:31], a[84:87], v[172:175]
    v_add_u32 v1, 128, v1
    v_add_u32 v2, 0x80000, v2
    v_mfma_f32_16x16x32_bf16 v[172:175], a[24:27], a[80:83], v[172:175]
    ds_read_b128 a[128:131], v4 offset:32768
    v_mfma_f32_16x16x32_bf16 v[156:159], a[24:27], a[72:75], v[156:159]
    v_mfma_f32_16x16x32_bf16 v[156:159], a[28:31], a[76:79], v[156:159]
    ds_read_b128 a[132:135], v5 offset:32768
    v_mfma_f32_16x16x32_bf16 v[140:143], a[28:31], a[68:71], v[140:143]
    v_mfma_f32_16x16x32_bf16 v[140:143], a[24:27], a[64:67], v[140:143]
    s_waitcnt lgkmcnt(8)
    ds_read_b128 a[140:143], v5 offset:34816
L_qentry:
    v_mfma_f32_16x16x32_bf16 v[192:195], a[32:35], a[160:163], v[192:195]
    v_mfma_f32_16x16x32_bf16 v[192:195], a[36:39], a[164:167], v[192:195]
    ds_read_b128 a[136:139], v4 offset:34816
    v_mfma_f32_16x16x32_bf16 v[208:211], a[36:39], a[172:175], v[208:211]
    v_mfma_f32_16x16x32_bf16 v[208:211], a[32:35], a[168:171], v[208:211]
    ds_read_b128 a[144:147], v4 offset:36864
    v_mfma_f32_16x16x32_bf16 v[224:227], a[32:35], a[176:179], v[224:227]
    v_mfma_f32_16x16x32_bf16 v[224:227], a[36:39], a[180:183], v[224:227]
    s_waitcnt lgkmcnt(8)
    ds_read_b128 a[148:151], v5 offset:36864
    v_mfma_f32_16x16x32_bf16 v[240:243], a[36:39], a[188:191], v[240:243]
    v_mfma_f32_16x16x32_bf16 v[240:243], a[32:35], a[184:187], v[240:243]
    s_waitcnt lgkmcnt(6)
    ds_read_b128 a[156:159], v5 offset:38912
    v_mfma_f32_16x16x32_bf16 v[244:247], a[40:43], a[184:187], v[244:247]
    v_mfma_f32_16x16x32_bf16 v[244:247], a[44:47], a[188:191], v[244:247]
    ds_read_b128 a[152:155], v4 offset:38912
    v_mfma_f32_16x16x32_bf16 v[228:231], a[44:47], a[180:183], v[228:231]
    v_mfma_f32_16x16x32_bf16 v[228:231], a[40:43], a[176:179], v[228:231]
    ds_read_b64_tr_b16 a[48:49], v8 offset:32768
    v_mfma_f32_16x16x32_bf16 v[212:215], a[40:43], a[168:171], v[212:215]
    ds_read_b64_tr_b16 a[50:51], v8 offset:36864
    v_mfma_f32_16x16x32_bf16 v[212:215], a[44:47], a[172:175], v[212:215]
    ds_read_b64_tr_b16 a[52:53], v8 offset:49152
    v_mfma_f32_16x16x32_bf16 v[196:199], a[44:47], a[164:167], v[196:199]
    ds_read_b64_tr_b16 a[54:55], v8 offset:53248
    v_mfma_f32_16x16x32_bf16 v[196:199], a[40:43], a[160:163], v[196:199]
    s_waitcnt lgkmcnt(8)
    ds_read_b64_tr_b16 a[56:57], v9 offset:32768
    v_mfma_f32_16x16x32_bf16 v[128:131], a[32:35], a[128:131], v[128:131]
    ds_read_b64_tr_b16 a[58:59], v9 offset:36864
    v_mfma_f32_16x16x32_bf16 v[128:131], a[36:39], a[132:135], v[128:131]
    ds_read_b64_tr_b16 a[60:61], v9 offset:49152
    v_mfma_f32_16x16x32_bf16 v[144:147], a[36:39], a[140:143], v[144:147]
    ds_read_b64_tr_b16 a[62:63], v9 offset:53248
    v_mfma_f32_16x16x32_bf16 v[144:147], a[32:35], a[136:139], v[144:147]
    s_waitcnt lgkmcnt(8)
    v_mfma_f32_16x16x32_bf16 v[160:163], a[32:35], a[144:147], v[160:163]
    v_mfma_f32_16x16x32_bf16 v[160:163], a[36:39], a[148:151], v[160:163]
    s_waitcnt vmcnt(0) lgkmcnt(0)
    v_mfma_f32_16x16x32_bf16 v[176:179], a[36:39], a[156:159], v[176:179]
    s_barrier
    ds_read_b64_tr_b16 a[0:1], v6 offset:0
    v_mfma_f32_16x16x32_bf16 v[176:179], a[32:35], a[152:155], v[176:179]
    s_add_u32 m0, s29, 98304
    ds_read_b64_tr_b16 a[2:3], v6 offset:4096
    v_mfma_f32_16x16x32_bf16 v[180:183], a[40:43], a[152:155], v[180:183]
    buffer_load_dwordx4 v2, s[8:11], 0 offen lds
    v_mfma_f32_16x16x32_bf16 v[180:183], a[44:47], a[156:159], v[180:183]
    ds_read_b128 a[64:67], v4 offset:0
    v_mfma_f32_16x16x32_bf16 v[164:167], a[44:47], a[148:151], v[164:167]
    s_add_u32 m0, s29, 102400
    v_mfma_f32_16x16x32_bf16 v[164:167], a[40:43], a[144:147], v[164:167]
    buffer_load_dwordx4 v2, s[8:11], s48 offen lds
    v_mfma_f32_16x16x32_bf16 v[148:151], a[40:43], a[136:139], v[148:151]
    ds_read_b64_tr_b16 a[4:5], v6 offset:16384
    v_mfma_f32_16x16x32_bf16 v[148:151], a[44:47], a[140:143], v[148:151]
    s_add_u32 m0, s29, 32768
    ds_read_b64_tr_b16 a[6:7], v6 offset:20480
    v_mfma_f32_16x16x32_bf16 v[132:135], a[44:47], a[132:135], v[132:135]
    buffer_load_dwordx4 v1, s[4:7], 0 offen lds
    v_mfma_f32_16x16x32_bf16 v[132:135], a[40:43], a[128:131], v[132:135]
    ds_read_b128 a[68:71], v5 offset:0
    v_mfma_f32_16x16x32_bf16 v[136:139], a[48:51], a[128:131], v[136:139]
    s_add_u32 m0, s29, 106496
    v_mfma_f32_16x16x32_bf16 v[136:139], a[52:55], a[132:135], v[136:139]
    buffer_load_dwordx4 v2, s[8:11], s49 offen lds
    v_mfma_f32_16x16x32_bf16 v[152:155], a[52:55], a[140:143], v[152:155]
    ds_read_b128 a[76:79], v5 offset:2048
    v_mfma_f32_16x16x32_bf16 v[152:155], a[48:51], a[136:139], v[152:155]
    s_add_u32 m0, s29, 110592
    v_mfma_f32_16x16x32_bf16 v[168:171], a[48:51], a[144:147], v[168:171]
    buffer_load_dwordx4 v2, s[8:11], s50 offen lds
    v_mfma_f32_16x16x32_bf16 v[168:171], a[52:55], a[148:151], v[168:171]
    ds_read_b128 a[72:75], v4 offset:2048
    v_mfma_f32_16x16x32_bf16 v[184:187], a[52:55], a[156:159], v[184:187]
    s_add_u32 m0, s29, 36864
    v_mfma_f32_16x16x32_bf16 v[184:187], a[48:51], a[152:155], v[184:187]
    buffer_load_dwordx4 v1, s[4:7], s41 offen lds
    v_mfma_f32_16x16x32_bf16 v[188:191], a[56:59], a[152:155], v[188:191]
    ds_read_b128 a[80:83], v4 offset:4096
    v_mfma_f32_16x16x32_bf16 v[188:191], a[60:63], a[156:159], v[188:191]
    s_add_u32 m0, s29, 114688
    v_mfma_f32_16x16x32_bf16 v[172:175], a[60:63], a[148:151], v[172:175]
    buffer_load_dwordx4 v2, s[8:11], s51 offen lds
    v_mfma_f32_16x16x32_bf16 v[172:175], a[56:59], a[144:147], v[172:175]
    ds_read_b128 a[84:87], v5 offset:4096
    v_mfma_f32_16x16x32_bf16 v[156:159], a[56:59], a[136:139], v[156:159]
    s_add_u32 m0, s29, 118784
    v_mfma_f32_16x16x32_bf16 v[156:159], a[60:63], a[140:143], v[156:159]
    buffer_load_dwordx4 v2, s[8:11], s52 offen lds
    v_mfma_f32_16x16x32_bf16 v[140:143], a[60:63], a[132:135], v[140:143]
    ds_read_b128 a[92:95], v5 offset:6144
    v_mfma_f32_16x16x32_bf16 v[140:143], a[56:59], a[128:131], v[140:143]
    s_add_u32 m0, s29, 40960
    v_mfma_f32_16x16x32_bf16 v[200:203], a[48:51], a[160:163], v[200:203]
    buffer_load_dwordx4 v1, s[4:7], s42 offen lds
    v_mfma_f32_16x16x32_bf16 v[200:203], a[52:55], a[164:167], v[200:203]
    ds_read_b128 a[88:91], v4 offset:6144
    v_mfma_f32_16x16x32_bf16 v[216:219], a[52:55], a[172:175], v[216:219]
    s_add_u32 m0, s29, 122880
    v_mfma_f32_16x16x32_bf16 v[216:219], a[48:51], a[168:171], v[216:219]
    buffer_load_dwordx4 v2, s[8:11], s53 offen lds
    v_mfma_f32_16x16x32_bf16 v[232:235], a[48:51], a[176:179], v[232:235]
    ds_read_b64_tr_b16 a[8:9], v7 offset:0
    v_mfma_f32_16x16x32_bf16 v[232:235], a[52:55], a[180:183], v[232:235]
    s_add_u32 m0, s29, 126976
    ds_read_b64_tr_b16 a[10:11], v7 offset:4096
    v_mfma_f32_16x16x32_bf16 v[248:251], a[52:55], a[188:191], v[248:251]
    buffer_load_dwordx4 v2, s[8:11], s54 offen lds
    v_mfma_f32_16x16x32_bf16 v[248:251], a[48:51], a[184:187], v[248:251]
    ds_read_b64_tr_b16 a[12:13], v7 offset:16384
    v_mfma_f32_16x16x32_bf16 v[252:255], a[56:59], a[184:187], v[252:255]
    s_add_u32 m0, s29, 45056
    ds_read_b64_tr_b16 a[14:15], v7 offset:20480
    v_mfma_f32_16x16x32_bf16 v[252:255], a[60:63], a[188:191], v[252:255]
    buffer_load_dwordx4 v1, s[4:7], s43 offen lds
    v_mfma_f32_16x16x32_bf16 v[236:239], a[60:63], a[180:183], v[236:239]
    v_add_u32 v1, 128, v1
    v_add_u32 v2, 0x80000, v2
    v_mfma_f32_16x16x32_bf16 v[236:239], a[56:59], a[176:179], v[236:239]
    ds_read_b128 a[96:99], v4 offset:8192
    v_mfma_f32_16x16x32_bf16 v[220:223], a[56:59], a[168:171], v[220:223]
    v_mfma_f32_16x16x32_bf16 v[220:223], a[60:63], a[172:175], v[220:223]
    ds_read_b128 a[100:103], v5 offset:8192
    v_mfma_f32_16x16x32_bf16 v[204:207], a[60:63], a[164:167], v[204:207]
    s_add_u32 s61, s61, 1
    v_mfma_f32_16x16x32_bf16 v[204:207], a[56:59], a[160:163], v[204:207]
    s_waitcnt lgkmcnt(8)
    ds_read_b128 a[108:111], v5 offset:10240
    s_cmp_lt_u32 s61, 4
    s_cbranch_scc1 L_qloop
    s_mov_b32 s44, 0x3db8aa3b
    s_mov_b32 s45, 0x3db8aa3b
    s_lshl_b32 s58, s26, 20
    s_lshl_b32 s60, s63, 16
    s_add_u32 s58, s58, s60
    s_lshl_b32 s60, s3, 11
    s_add_u32 s58, s58, s60
    s_add_u32 s58, s58, 33554432
    s_nop 3
    v_pk_mul_f32 v[128:129], v[128:129], s[44:45]
    v_pk_mul_f32 v[130:131], v[130:131], s[44:45]
    v_pk_mul_f32 v[132:133], v[132:133], s[44:45]
    v_pk_mul_f32 v[134:135], v[134:135], s[44:45]
    v_cvt_pk_bf16_f32 v128, v128, v129
    v_cvt_pk_bf16_f32 v129, v130, v131
    v_cvt_pk_bf16_f32 v130, v132, v133
    v_cvt_pk_bf16_f32 v131, v134, v135
    buffer_store_dwordx4 v[128:131], v3, s[12:15], s58 offen offset:0
    v_pk_mul_f32 v[136:137], v[136:137], s[44:45]
    v_pk_mul_f32 v[138:139], v[138:139], s[44:45]
    v_pk_mul_f32 v[140:141], v[140:141], s[44:45]
    v_pk_mul_f32 v[142:143], v[142:143], s[44:45]
    v_cvt_pk_bf16_f32 v136, v136, v137
    v_cvt_pk_bf16_f32 v137, v138, v139
    v_cvt_pk_bf16_f32 v138, v140, v141
    v_cvt_pk_bf16_f32 v139, v142, v143
    buffer_store_dwordx4 v[136:139], v3, s[12:15], s58 offen offset:1024
    s_add_u32 s58, s58, 8192
    v_pk_mul_f32 v[144:145], v[144:145], s[44:45]
    v_pk_mul_f32 v[146:147], v[146:147], s[44:45]
    v_pk_mul_f32 v[148:149], v[148:149], s[44:45]
    v_pk_mul_f32 v[150:151], v[150:151], s[44:45]
    v_cvt_pk_bf16_f32 v144, v144, v145
    v_cvt_pk_bf16_f32 v145, v146, v147
    v_cvt_pk_bf16_f32 v146, v148, v149
    v_cvt_pk_bf16_f32 v147, v150, v151
    buffer_store_dwordx4 v[144:147], v3, s[12:15], s58 offen offset:0
    v_pk_mul_f32 v[152:153], v[152:153], s[44:45]
    v_pk_mul_f32 v[154:155], v[154:155], s[44:45]
    v_pk_mul_f32 v[156:157], v[156:157], s[44:45]
    v_pk_mul_f32 v[158:159], v[158:159], s[44:45]
    v_cvt_pk_bf16_f32 v152, v152, v153
    v_cvt_pk_bf16_f32 v153, v154, v155
    v_cvt_pk_bf16_f32 v154, v156, v157
    v_cvt_pk_bf16_f32 v155, v158, v159
    buffer_store_dwordx4 v[152:155], v3, s[12:15], s58 offen offset:1024
    s_add_u32 s58, s58, 8192
    v_pk_mul_f32 v[160:161], v[160:161], s[44:45]
    v_pk_mul_f32 v[162:163], v[162:163], s[44:45]
    v_pk_mul_f32 v[164:165], v[164:165], s[44:45]
    v_pk_mul_f32 v[166:167], v[166:167], s[44:45]
    v_cvt_pk_bf16_f32 v160, v160, v161
    v_cvt_pk_bf16_f32 v161, v162, v163
    v_cvt_pk_bf16_f32 v162, v164, v165
    v_cvt_pk_bf16_f32 v163, v166, v167
    buffer_store_dwordx4 v[160:163], v3, s[12:15], s58 offen offset:0
    v_pk_mul_f32 v[168:169], v[168:169], s[44:45]
    v_pk_mul_f32 v[170:171], v[170:171], s[44:45]
    v_pk_mul_f32 v[172:173], v[172:173], s[44:45]
    v_pk_mul_f32 v[174:175], v[174:175], s[44:45]
    v_cvt_pk_bf16_f32 v168, v168, v169
    v_cvt_pk_bf16_f32 v169, v170, v171
    v_cvt_pk_bf16_f32 v170, v172, v173
    v_cvt_pk_bf16_f32 v171, v174, v175
    buffer_store_dwordx4 v[168:171], v3, s[12:15], s58 offen offset:1024
    s_add_u32 s58, s58, 8192
    v_pk_mul_f32 v[176:177], v[176:177], s[44:45]
    v_pk_mul_f32 v[178:179], v[178:179], s[44:45]
    v_pk_mul_f32 v[180:181], v[180:181], s[44:45]
    v_pk_mul_f32 v[182:183], v[182:183], s[44:45]
    v_cvt_pk_bf16_f32 v176, v176, v177
    v_cvt_pk_bf16_f32 v177, v178, v179
    v_cvt_pk_bf16_f32 v178, v180, v181
    v_cvt_pk_bf16_f32 v179, v182, v183
    buffer_store_dwordx4 v[176:179], v3, s[12:15], s58 offen offset:0
    v_pk_mul_f32 v[184:185], v[184:185], s[44:45]
    v_pk_mul_f32 v[186:187], v[186:187], s[44:45]
    v_pk_mul_f32 v[188:189], v[188:189], s[44:45]
    v_pk_mul_f32 v[190:191], v[190:191], s[44:45]
    v_cvt_pk_bf16_f32 v184, v184, v185
    v_cvt_pk_bf16_f32 v185, v186, v187
    v_cvt_pk_bf16_f32 v186, v188, v189
    v_cvt_pk_bf16_f32 v187, v190, v191
    buffer_store_dwordx4 v[184:187], v3, s[12:15], s58 offen offset:1024
    s_add_u32 s58, s58, 8192
    v_pk_mul_f32 v[192:193], v[192:193], s[44:45]
    v_pk_mul_f32 v[194:195], v[194:195], s[44:45]
    v_pk_mul_f32 v[196:197], v[196:197], s[44:45]
    v_pk_mul_f32 v[198:199], v[198:199], s[44:45]
    v_cvt_pk_bf16_f32 v192, v192, v193
    v_cvt_pk_bf16_f32 v193, v194, v195
    v_cvt_pk_bf16_f32 v194, v196, v197
    v_cvt_pk_bf16_f32 v195, v198, v199
    buffer_store_dwordx4 v[192:195], v3, s[12:15], s58 offen offset:0
    v_pk_mul_f32 v[200:201], v[200:201], s[44:45]
    v_pk_mul_f32 v[202:203], v[202:203], s[44:45]
    v_pk_mul_f32 v[204:205], v[204:205], s[44:45]
    v_pk_mul_f32 v[206:207], v[206:207], s[44:45]
    v_cvt_pk_bf16_f32 v200, v200, v201
    v_cvt_pk_bf16_f32 v201, v202, v203
    v_cvt_pk_bf16_f32 v202, v204, v205
    v_cvt_pk_bf16_f32 v203, v206, v207
    buffer_store_dwordx4 v[200:203], v3, s[12:15], s58 offen offset:1024
    s_add_u32 s58, s58, 8192
    v_pk_mul_f32 v[208:209], v[208:209], s[44:45]
    v_pk_mul_f32 v[210:211], v[210:211], s[44:45]
    v_pk_mul_f32 v[212:213], v[212:213], s[44:45]
    v_pk_mul_f32 v[214:215], v[214:215], s[44:45]
    v_cvt_pk_bf16_f32 v208, v208, v209
    v_cvt_pk_bf16_f32 v209, v210, v211
    v_cvt_pk_bf16_f32 v210, v212, v213
    v_cvt_pk_bf16_f32 v211, v214, v215
    buffer_store_dwordx4 v[208:211], v3, s[12:15], s58 offen offset:0
    v_pk_mul_f32 v[216:217], v[216:217], s[44:45]
    v_pk_mul_f32 v[218:219], v[218:219], s[44:45]
    v_pk_mul_f32 v[220:221], v[220:221], s[44:45]
    v_pk_mul_f32 v[222:223], v[222:223], s[44:45]
    v_cvt_pk_bf16_f32 v216, v216, v217
    v_cvt_pk_bf16_f32 v217, v218, v219
    v_cvt_pk_bf16_f32 v218, v220, v221
    v_cvt_pk_bf16_f32 v219, v222, v223
    buffer_store_dwordx4 v[216:219], v3, s[12:15], s58 offen offset:1024
    s_add_u32 s58, s58, 8192
    v_pk_mul_f32 v[224:225], v[224:225], s[44:45]
    v_pk_mul_f32 v[226:227], v[226:227], s[44:45]
    v_pk_mul_f32 v[228:229], v[228:229], s[44:45]
    v_pk_mul_f32 v[230:231], v[230:231], s[44:45]
    v_cvt_pk_bf16_f32 v224, v224, v225
    v_cvt_pk_bf16_f32 v225, v226, v227
    v_cvt_pk_bf16_f32 v226, v228, v229
    v_cvt_pk_bf16_f32 v227, v230, v231
    buffer_store_dwordx4 v[224:227], v3, s[12:15], s58 offen offset:0
    v_pk_mul_f32 v[232:233], v[232:233], s[44:45]
    v_pk_mul_f32 v[234:235], v[234:235], s[44:45]
    v_pk_mul_f32 v[236:237], v[236:237], s[44:45]
    v_pk_mul_f32 v[238:239], v[238:239], s[44:45]
    v_cvt_pk_bf16_f32 v232, v232, v233
    v_cvt_pk_bf16_f32 v233, v234, v235
    v_cvt_pk_bf16_f32 v234, v236, v237
    v_cvt_pk_bf16_f32 v235, v238, v239
    buffer_store_dwordx4 v[232:235], v3, s[12:15], s58 offen offset:1024
    s_add_u32 s58, s58, 8192
    v_pk_mul_f32 v[240:241], v[240:241], s[44:45]
    v_pk_mul_f32 v[242:243], v[242:243], s[44:45]
    v_pk_mul_f32 v[244:245], v[244:245], s[44:45]
    v_pk_mul_f32 v[246:247], v[246:247], s[44:45]
    v_cvt_pk_bf16_f32 v240, v240, v241
    v_cvt_pk_bf16_f32 v241, v242, v243
    v_cvt_pk_bf16_f32 v242, v244, v245
    v_cvt_pk_bf16_f32 v243, v246, v247
    buffer_store_dwordx4 v[240:243], v3, s[12:15], s58 offen offset:0
    v_pk_mul_f32 v[248:249], v[248:249], s[44:45]
    v_pk_mul_f32 v[250:251], v[250:251], s[44:45]
    v_pk_mul_f32 v[252:253], v[252:253], s[44:45]
    v_pk_mul_f32 v[254:255], v[254:255], s[44:45]
    v_cvt_pk_bf16_f32 v248, v248, v249
    v_cvt_pk_bf16_f32 v249, v250, v251
    v_cvt_pk_bf16_f32 v250, v252, v253
    v_cvt_pk_bf16_f32 v251, v254, v255
    buffer_store_dwordx4 v[248:251], v3, s[12:15], s58 offen offset:1024
    s_add_u32 s58, s58, 8192
    s_waitcnt vmcnt(0)
    s_barrier
    s_cmp_lg_u32 s3, 0
    s_cbranch_scc1 L_pub0
    s_cmp_lg_u32 s30, 0
    s_cbranch_scc1 L_pub0_x
    buffer_wbl2 sc1
    s_waitcnt vmcnt(0)
L_pub0_x:
    v_mov_b32 v14, 0
    v_mov_b32 v15, 1
    s_mov_b64 exec, 1
    buffer_store_dword v15, v14, s[12:15], s92 offen sc1
    s_mov_b64 exec, -1
L_pub0:
    s_cmp_ge_u32 s28, 14
    s_cbranch_scc1 L_s1end
    s_and_b32 s33, s95, 31
    s_lshr_b32 s34, s95, 5
    v_lshrrev_b32 v1, 3, v0
    s_lshl_b32 s35, s3, 3
    v_add_u32 v1, s35, v1
    v_lshlrev_b32 v4, 8, v1
    v_lshlrev_b32 v1, 1, v1
    s_lshl_b32 s35, s33, 6
    v_add_u32 v1, s35, v1
    v_mul_u32_u24 v1, 896, v1
    v_and_b32 v3, 7, v0
    v_lshl_add_u32 v1, v3, 4, v1
    s_lshl_b32 s35, s34, 7
    v_add_u32 v1, s35, v1
    v_lshl_add_u32 v4, v3, 4, v4
    v_add_u32 v4, 0x20000, v4
    v_lshlrev_b32 v3, 6, v3
    s_lshl_b32 s35, s34, 9
    v_add_u32 v3, s35, v3
    v_subrev_u32 v5, 2688, v1
    v_subrev_u32 v6, 1792, v1
    v_subrev_u32 v7, 896, v1
    s_mov_b32 s4, s66
    s_mov_b32 s5, s67
    s_mov_b32 s6, 1835008
    s_mov_b32 s7, 0x20000
    s_mov_b32 s8, s68
    s_mov_b32 s9, s69
    s_mov_b32 s10, 1835008
    s_mov_b32 s11, 0x20000
    s_mov_b32 s16, s70
    s_mov_b32 s17, s71
    s_mov_b32 s18, 3584
    s_mov_b32 s19, 0x20000
    buffer_load_dwordx4 v[16:19], v5, s[4:7], 0 offen
    buffer_load_dwordx4 v[20:23], v6, s[4:7], 0 offen
    buffer_load_dwordx4 v[24:27], v7, s[4:7], 0 offen
    buffer_load_dwordx4 v[28:31], v1, s[4:7], 0 offen offset:0
    buffer_load_dwordx4 v[32:35], v1, s[4:7], 0 offen offset:896
    buffer_load_dwordx4 v[36:39], v1, s[8:11], 0 offen offset:0
    buffer_load_dwordx4 v[40:43], v1, s[8:11], 0 offen offset:896
    buffer_load_dwordx4 v[44:47], v3, s[16:19], 0 offen offset:0
    buffer_load_dwordx4 v[48:51], v3, s[16:19], 0 offen offset:16
    buffer_load_dwordx4 v[52:55], v3, s[16:19], 0 offen offset:32
    buffer_load_dwordx4 v[56:59], v3, s[16:19], 0 offen offset:48
    s_mov_b32 s36, 0xffff0000
    s_waitcnt vmcnt(0)
    v_lshlrev_b32 v64, 16, v16
    v_lshlrev_b32 v65, 16, v20
    v_lshlrev_b32 v66, 16, v24
    v_lshlrev_b32 v67, 16, v28
    v_lshlrev_b32 v68, 16, v32
    v_lshlrev_b32 v70, 16, v36
    v_lshlrev_b32 v71, 16, v40
    v_lshlrev_b32 v72, 16, v44
    v_and_b32 v73, s36, v44
    v_lshlrev_b32 v74, 16, v45
    v_and_b32 v75, s36, v45
    v_mul_f32 v80, v64, v75
    v_fmac_f32 v80, v65, v74
    v_fmac_f32 v80, v66, v73
    v_fmac_f32 v80, v67, v72
    v_mul_f32 v80, v80, v70
    v_mul_f32 v88, v65, v75
    v_fmac_f32 v88, v66, v74
    v_fmac_f32 v88, v67, v73
    v_fmac_f32 v88, v68, v72
    v_mul_f32 v88, v88, v71
    v_and_b32 v64, s36, v16
    v_and_b32 v65, s36, v20
    v_and_b32 v66, s36, v24
    v_and_b32 v67, s36, v28
    v_and_b32 v68, s36, v32
    v_and_b32 v70, s36, v36
    v_and_b32 v71, s36, v40
    v_lshlrev_b32 v72, 16, v46
    v_and_b32 v73, s36, v46
    v_lshlrev_b32 v74, 16, v47
    v_and_b32 v75, s36, v47
    v_mul_f32 v81, v64, v75
    v_fmac_f32 v81, v65, v74
    v_fmac_f32 v81, v66, v73
    v_fmac_f32 v81, v67, v72
    v_mul_f32 v81, v81, v70
    v_mul_f32 v89, v65, v75
    v_fmac_f32 v89, v66, v74
    v_fmac_f32 v89, v67, v73
    v_fmac_f32 v89, v68, v72
    v_mul_f32 v89, v89, v71
    v_lshlrev_b32 v64, 16, v17
    v_lshlrev_b32 v65, 16, v21
    v_lshlrev_b32 v66, 16, v25
    v_lshlrev_b32 v67, 16, v29
    v_lshlrev_b32 v68, 16, v33
    v_lshlrev_b32 v70, 16, v37
    v_lshlrev_b32 v71, 16, v41
    v_lshlrev_b32 v72, 16, v48
    v_and_b32 v73, s36, v48
    v_lshlrev_b32 v74, 16, v49
    v_and_b32 v75, s36, v49
    v_mul_f32 v82, v64, v75
    v_fmac_f32 v82, v65, v74
    v_fmac_f32 v82, v66, v73
    v_fmac_f32 v82, v67, v72
    v_mul_f32 v82, v82, v70
    v_mul_f32 v90, v65, v75
    v_fmac_f32 v90, v66, v74
    v_fmac_f32 v90, v67, v73
    v_fmac_f32 v90, v68, v72
    v_mul_f32 v90, v90, v71
    v_and_b32 v64, s36, v17
    v_and_b32 v65, s36, v21
    v_and_b32 v66, s36, v25
    v_and_b32 v67, s36, v29
    v_and_b32 v68, s36, v33
    v_and_b32 v70, s36, v37
    v_and_b32 v71, s36, v41
    v_lshlrev_b32 v72, 16, v50
    v_and_b32 v73, s36, v50
    v_lshlrev_b32 v74, 16, v51
    v_and_b32 v75, s36, v51
    v_mul_f32 v83, v64, v75
    v_fmac_f32 v83, v65, v74
    v_fmac_f32 v83, v66, v73
    v_fmac_f32 v83, v67, v72
    v_mul_f32 v83, v83, v70
    v_mul_f32 v91, v65, v75
    v_fmac_f32 v91, v66, v74
    v_fmac_f32 v91, v67, v73
    v_fmac_f32 v91, v68, v72
    v_mul_f32 v91, v91, v71
    v_lshlrev_b32 v64, 16, v18
    v_lshlrev_b32 v65, 16, v22
    v_lshlrev_b32 v66, 16, v26
    v_lshlrev_b32 v67, 16, v30
    v_lshlrev_b32 v68, 16, v34
    v_lshlrev_b32 v70, 16, v38
    v_lshlrev_b32 v71, 16, v42
    v_lshlrev_b32 v72, 16, v52
    v_and_b32 v73, s36, v52
    v_lshlrev_b32 v74, 16, v53
    v_and_b32 v75, s36, v53
    v_mul_f32 v84, v64, v75
    v_fmac_f32 v84, v65, v74
    v_fmac_f32 v84, v66, v73
    v_fmac_f32 v84, v67, v72
    v_mul_f32 v84, v84, v70
    v_mul_f32 v92, v65, v75
    v_fmac_f32 v92, v66, v74
    v_fmac_f32 v92, v67, v73
    v_fmac_f32 v92, v68, v72
    v_mul_f32 v92, v92, v71
    v_and_b32 v64, s36, v18
    v_and_b32 v65, s36, v22
    v_and_b32 v66, s36, v26
    v_and_b32 v67, s36, v30
    v_and_b32 v68, s36, v34
    v_and_b32 v70, s36, v38
    v_and_b32 v71, s36, v42
    v_lshlrev_b32 v72, 16, v54
    v_and_b32 v73, s36, v54
    v_lshlrev_b32 v74, 16, v55
    v_and_b32 v75, s36, v55
    v_mul_f32 v85, v64, v75
    v_fmac_f32 v85, v65, v74
    v_fmac_f32 v85, v66, v73
    v_fmac_f32 v85, v67, v72
    v_mul_f32 v85, v85, v70
    v_mul_f32 v93, v65, v75
    v_fmac_f32 v93, v66, v74
    v_fmac_f32 v93, v67, v73
    v_fmac_f32 v93, v68, v72
    v_mul_f32 v93, v93, v71
    v_lshlrev_b32 v64, 16, v19
    v_lshlrev_b32 v65, 16, v23
    v_lshlrev_b32 v66, 16, v27
    v_lshlrev_b32 v67, 16, v31
    v_lshlrev_b32 v68, 16, v35
    v_lshlrev_b32 v70, 16, v39
    v_lshlrev_b32 v71, 16, v43
    v_lshlrev_b32 v72, 16, v56
    v_and_b32 v73, s36, v56
    v_lshlrev_b32 v74, 16, v57
    v_and_b32 v75, s36, v57
    v_mul_f32 v86, v64, v75
    v_fmac_f32 v86, v65, v74
    v_fmac_f32 v86, v66, v73
    v_fmac_f32 v86, v67, v72
    v_mul_f32 v86, v86, v70
    v_mul_f32 v94, v65, v75
    v_fmac_f32 v94, v66, v74
    v_fmac_f32 v94, v67, v73
    v_fmac_f32 v94, v68, v72
    v_mul_f32 v94, v94, v71
    v_and_b32 v64, s36, v19
    v_and_b32 v65, s36, v23
    v_and_b32 v66, s36, v27
    v_and_b32 v67, s36, v31
    v_and_b32 v68, s36, v35
    v_and_b32 v70, s36, v39
    v_and_b32 v71, s36, v43
    v_lshlrev_b32 v72, 16, v58
    v_and_b32 v73, s36, v58
    v_lshlrev_b32 v74, 16, v59
    v_and_b32 v75, s36, v59
    v_mul_f32 v87, v64, v75
    v_fmac_f32 v87, v65, v74
    v_fmac_f32 v87, v66, v73
    v_fmac_f32 v87, v67, v72
    v_mul_f32 v87, v87, v70
    v_mul_f32 v95, v65, v75
    v_fmac_f32 v95, v66, v74
    v_fmac_f32 v95, v67, v73
    v_fmac_f32 v95, v68, v72
    v_mul_f32 v95, v95, v71
    v_cvt_pk_bf16_f32 v96, v80, v81
    v_cvt_pk_bf16_f32 v97, v82, v83
    v_cvt_pk_bf16_f32 v98, v84, v85
    v_cvt_pk_bf16_f32 v99, v86, v87
    ds_write_b128 v4, v[96:99] offset:0
    v_cvt_pk_bf16_f32 v100, v88, v89
    v_cvt_pk_bf16_f32 v101, v90, v91
    v_cvt_pk_bf16_f32 v102, v92, v93
    v_cvt_pk_bf16_f32 v103, v94, v95
    ds_write_b128 v4, v[100:103] offset:128
    v_bfe_u32 v5, v0, 2, 2
    v_bfe_u32 v6, v0, 4, 1
    v_lshl_add_u32 v5, v6, 3, v5
    v_lshlrev_b32 v5, 2, v5
    v_lshrrev_b32 v7, 5, v0
    v_add_u32 v5, v5, v7
    v_lshlrev_b32 v5, 7, v5
    v_and_b32 v8, 3, v0
    v_lshl_add_u32 v5, v8, 3, v5
    s_lshl_b32 s35, s3, 5
    s_add_u32 s35, s35, 0x20000
    v_add_u32 v5, s35, v5
    v_and_b32 v9, 15, v0
    v_lshlrev_b32 v9, 12, v9
    v_lshrrev_b32 v8, 4, v0
    v_lshl_add_u32 v9, v8, 4, v9
    s_lshl_b32 s35, s34, 2
    s_add_u32 s35, s35, s3
    s_lshl_b32 s35, s35, 16
    s_lshl_b32 s37, s33, 7
    s_add_u32 s35, s35, s37
    s_add_u32 s35, s35, 85983232
    s_waitcnt lgkmcnt(0)
    s_barrier
    ds_read_b64_tr_b16 v[16:17], v5 offset:0
    ds_read_b64_tr_b16 v[18:19], v5 offset:2048
    ds_read_b64_tr_b16 v[20:21], v5 offset:256
    ds_read_b64_tr_b16 v[22:23], v5 offset:2304
    s_waitcnt lgkmcnt(0)
    buffer_store_dwordx4 v[16:19], v9, s[12:15], s35 offen offset:0 sc1
    buffer_store_dwordx4 v[20:23], v9, s[12:15], s35 offen offset:64 sc1
    s_lshl_b32 s35, s95, 2
    s_add_u32 s35, s35, 84959232
    s_waitcnt vmcnt(0)
    s_barrier
    s_cmp_lg_u32 s3, 0
    s_cbranch_scc1 L_pub1
    v_mov_b32 v14, 0
    v_mov_b32 v15, 1
    s_mov_b64 exec, 1
    buffer_store_dword v15, v14, s[12:15], s35 offen sc1
    s_mov_b64 exec, -1
L_pub1:
L_s1end:
    v_and_b32 v14, 0, v0
    v_lshlrev_b32 v14, 2, v14
    s_mov_b32 s100, 0
L_poll2:
    global_load_dword v15, v14, s[90:91] offset:128 sc1
    s_waitcnt vmcnt(0)
    v_cmp_ne_u32 vcc, 256, v15
    s_cbranch_vccz L_poll2_ok
    s_sleep 2
    s_add_u32 s100, s100, 1
    s_cmp_lt_u32 s100, 0x80000
    s_cbranch_scc1 L_poll2
L_poll2_ok:
    s_lshl_b32 s33, s26, 7
    s_add_u32 s33, s33, 84934656
    v_and_b32 v14, 15, v0
    v_lshlrev_b32 v14, 2, v14
    s_mov_b32 s100, 0
L_poll3:
    buffer_load_dword v15, v14, s[12:15], s33 offen sc1
    s_waitcnt vmcnt(0)
    v_cmp_ne_u32 vcc, 1, v15
    s_cbranch_vccz L_poll3_ok
    s_sleep 2
    s_add_u32 s100, s100, 1
    s_cmp_lt_u32 s100, 0x80000
    s_cbranch_scc1 L_poll3
L_poll3_ok:
    s_lshl_b32 s37, s25, 1
    s_sub_i32 s38, 14, s37
    s_max_i32 s38, s38, 0
    s_lshl_b32 s49, s26, 20
    s_lshl_b32 s50, s3, 13
    s_add_u32 s49, s49, s50
    s_mov_b32 s51, s63
    s_add_u32 s53, s37, 2
    s_sub_u32 s55, 32, s37
    s_sub_u32 s55, s55, s38
    s_cmp_eq_u32 s27, 0
    s_cselect_b32 s53, s53, s55
    s_cselect_b32 s52, 0, s38
    s_cselect_b32 s54, 0, 2
    v_lshlrev_b32 v1, 4, v0
    v_add_u32 v4, 4096, v1
    s_lshl_b32 s55, s52, 15
    s_add_u32 s42, s55, s49
    s_add_u32 s43, s42, 16777216
    s_mov_b32 s40, s50
    s_add_u32 s41, s50, 0x10000
    s_mov_b32 m0, s40
    s_nop 0
    buffer_load_dwordx4 v1, s[12:15], s42 offen offset:0 sc1 lds
    buffer_load_dwordx4 v1, s[12:15], s42 offen offset:1024 sc1 lds
    buffer_load_dwordx4 v1, s[12:15], s42 offen offset:2048 sc1 lds
    buffer_load_dwordx4 v1, s[12:15], s42 offen offset:3072 sc1 lds
    s_bitset1_b32 m0, 12
    s_nop 0
    buffer_load_dwordx4 v4, s[12:15], s42 offen offset:0 sc1 lds
    buffer_load_dwordx4 v4, s[12:15], s42 offen offset:1024 sc1 lds
    buffer_load_dwordx4 v4, s[12:15], s42 offen offset:2048 sc1 lds
    buffer_load_dwordx4 v4, s[12:15], s42 offen offset:3072 sc1 lds
    s_add_u32 s42, s42, 0x8000
    s_xor_b32 s40, s40, 0x8000
    s_lshl_b32 s55, s51, 16
    s_add_u32 s55, s55, s49
    s_add_u32 s55, s55, 33554432
    s_add_u32 s56, s55, 0x8000
    buffer_load_dwordx4 a[0:3], v1, s[12:15], s55 offen offset:0 sc1
    buffer_load_dwordx4 a[4:7], v1, s[12:15], s55 offen offset:1024 sc1
    buffer_load_dwordx4 a[8:11], v1, s[12:15], s55 offen offset:2048 sc1
    buffer_load_dwordx4 a[12:15], v1, s[12:15], s55 offen offset:3072 sc1
    buffer_load_dwordx4 a[16:19], v4, s[12:15], s55 offen offset:0 sc1
    buffer_load_dwordx4 a[20:23], v4, s[12:15], s55 offen offset:1024 sc1
    buffer_load_dwordx4 a[24:27], v4, s[12:15], s55 offen offset:2048 sc1
    buffer_load_dwordx4 a[28:31], v4, s[12:15], s55 offen offset:3072 sc1
    buffer_load_dwordx4 a[32:35], v1, s[12:15], s56 offen offset:0 sc1
    buffer_load_dwordx4 a[36:39], v1, s[12:15], s56 offen offset:1024 sc1
    buffer_load_dwordx4 a[40:43], v1, s[12:15], s56 offen offset:2048 sc1
    buffer_load_dwordx4 a[44:47], v1, s[12:15], s56 offen offset:3072 sc1
    buffer_load_dwordx4 a[48:51], v4, s[12:15], s56 offen offset:0 sc1
    buffer_load_dwordx4 a[52:55], v4, s[12:15], s56 offen offset:1024 sc1
    buffer_load_dwordx4 a[56:59], v4, s[12:15], s56 offen offset:2048 sc1
    buffer_load_dwordx4 a[60:63], v4, s[12:15], s56 offen offset:3072 sc1
    s_mov_b32 m0, s40
    s_nop 0
    buffer_load_dwordx4 v1, s[12:15], s42 offen offset:0 sc1 lds
    buffer_load_dwordx4 v1, s[12:15], s42 offen offset:1024 sc1 lds
    buffer_load_dwordx4 v1, s[12:15], s42 offen offset:2048 sc1 lds
    buffer_load_dwordx4 v1, s[12:15], s42 offen offset:3072 sc1 lds
    s_bitset1_b32 m0, 12
    s_nop 0
    buffer_load_dwordx4 v4, s[12:15], s42 offen offset:0 sc1 lds
    buffer_load_dwordx4 v4, s[12:15], s42 offen offset:1024 sc1 lds
    buffer_load_dwordx4 v4, s[12:15], s42 offen offset:2048 sc1 lds
    buffer_load_dwordx4 v4, s[12:15], s42 offen offset:3072 sc1 lds
    s_add_u32 s42, s42, 0x8000
    s_xor_b32 s40, s40, 0x8000
    s_mov_b32 m0, s41
    s_nop 0
    buffer_load_dwordx4 v1, s[12:15], s43 offen offset:0 sc1 lds
    buffer_load_dwordx4 v1, s[12:15], s43 offen offset:1024 sc1 lds
    buffer_load_dwordx4 v1, s[12:15], s43 offen offset:2048 sc1 lds
    buffer_load_dwordx4 v1, s[12:15], s43 offen offset:3072 sc1 lds
    s_bitset1_b32 m0, 12
    s_nop 0
    buffer_load_dwordx4 v4, s[12:15], s43 offen offset:0 sc1 lds
    buffer_load_dwordx4 v4, s[12:15], s43 offen offset:1024 sc1 lds
    buffer_load_dwordx4 v4, s[12:15], s43 offen offset:2048 sc1 lds
    buffer_load_dwordx4 v4, s[12:15], s43 offen offset:3072 sc1 lds
    s_add_u32 s43, s43, 0x8000
    s_xor_b32 s41, s41, 0x8000
    v_and_b32 v14, 15, v0
    v_lshrrev_b32 v11, 4, v0
    v_lshlrev_b32 v11, 2, v11
    v_sub_u32 v14, v14, v11
    s_lshl_b32 s48, s3, 4
    v_add_u32 v14, s48, v14
    v_mov_b32 v2, v1
    v_add_u32 v3, 0x10000, v1
    v_mov_b64 v[96:97], 0
    v_mov_b64 v[98:99], 0
    v_mov_b64 v[100:101], 0
    v_mov_b64 v[102:103], 0
    v_mov_b64 v[104:105], 0
    v_mov_b64 v[106:107], 0
    v_mov_b64 v[108:109], 0
    v_mov_b64 v[110:111], 0
    v_mov_b64 v[112:113], 0
    v_mov_b64 v[114:115], 0
    v_mov_b64 v[116:117], 0
    v_mov_b64 v[118:119], 0
    v_mov_b64 v[120:121], 0
    v_mov_b64 v[122:123], 0
    v_mov_b64 v[124:125], 0
    v_mov_b64 v[126:127], 0
    v_mov_b64 v[128:129], 0
    v_mov_b64 v[130:131], 0
    v_mov_b64 v[132:133], 0
    v_mov_b64 v[134:135], 0
    v_mov_b64 v[136:137], 0
    v_mov_b64 v[138:139], 0
    v_mov_b64 v[140:141], 0
    v_mov_b64 v[142:143], 0
    v_mov_b64 v[144:145], 0
    v_mov_b64 v[146:147], 0
    v_mov_b64 v[148:149], 0
    v_mov_b64 v[150:151], 0
    v_mov_b64 v[152:153], 0
    v_mov_b64 v[154:155], 0
    v_mov_b64 v[156:157], 0
    v_mov_b64 v[158:159], 0
    v_mov_b64 v[160:161], 0
    v_mov_b64 v[162:163], 0
    v_mov_b64 v[164:165], 0
    v_mov_b64 v[166:167], 0
    v_mov_b64 v[168:169], 0
    v_mov_b64 v[170:171], 0
    v_mov_b64 v[172:173], 0
    v_mov_b64 v[174:175], 0
    v_mov_b64 v[176:177], 0
    v_mov_b64 v[178:179], 0
    v_mov_b64 v[180:181], 0
    v_mov_b64 v[182:183], 0
    v_mov_b64 v[184:185], 0
    v_mov_b64 v[186:187], 0
    v_mov_b64 v[188:189], 0
    v_mov_b64 v[190:191], 0
    v_mov_b64 v[192:193], 0
    v_mov_b64 v[194:195], 0
    v_mov_b64 v[196:197], 0
    v_mov_b64 v[198:199], 0
    v_mov_b64 v[200:201], 0
    v_mov_b64 v[202:203], 0
    v_mov_b64 v[204:205], 0
    v_mov_b64 v[206:207], 0
    v_mov_b64 v[208:209], 0
    v_mov_b64 v[210:211], 0
    v_mov_b64 v[212:213], 0
    v_mov_b64 v[214:215], 0
    v_mov_b64 v[216:217], 0
    v_mov_b64 v[218:219], 0
    v_mov_b64 v[220:221], 0
    v_mov_b64 v[222:223], 0
    v_mov_b64 v[224:225], 0
    v_mov_b64 v[226:227], 0
    v_mov_b64 v[228:229], 0
    v_mov_b64 v[230:231], 0
    v_mov_b64 v[232:233], 0
    v_mov_b64 v[234:235], 0
    v_mov_b64 v[236:237], 0
    v_mov_b64 v[238:239], 0
    v_mov_b64 v[240:241], 0
    v_mov_b64 v[242:243], 0
    v_mov_b64 v[244:245], 0
    v_mov_b64 v[246:247], 0
    v_mov_b64 v[248:249], 0
    v_mov_b64 v[250:251], 0
    v_mov_b64 v[252:253], 0
    v_mov_b64 v[254:255], 0
    v_mov_b32 v7, 0
    v_mov_b32 v8, 0
    v_mov_b32 v9, 0
    v_mov_b32 v10, 0
    s_mov_b32 s47, 0x4b800000
    s_mov_b32 s45, 2
    s_sub_u32 s44, s53, 1
    s_cmp_ge_u32 s44, 2
    s_cbranch_scc1 L_nomask0
    v_mov_b32 v11, 0xf149f2ca
    v_cmp_gt_i32 s[16:17], 0, v14
    v_cmp_gt_i32 s[18:19], 1, v14
    v_cmp_gt_i32 s[20:21], 2, v14
    v_cmp_gt_i32 s[22:23], 3, v14
    v_cndmask_b32 v96, v9, v11, s[16:17]
    v_cndmask_b32 v97, v9, v11, s[18:19]
    v_cndmask_b32 v98, v9, v11, s[20:21]
    v_cndmask_b32 v99, v9, v11, s[22:23]
    v_cmp_gt_i32 s[16:17], 16, v14
    v_cmp_gt_i32 s[18:19], 17, v14
    v_cmp_gt_i32 s[20:21], 18, v14
    v_cmp_gt_i32 s[22:23], 19, v14
    v_cndmask_b32 v104, v9, v11, s[16:17]
    v_cndmask_b32 v105, v9, v11, s[18:19]
    v_cndmask_b32 v106, v9, v11, s[20:21]
    v_cndmask_b32 v107, v9, v11, s[22:23]
    v_cmp_gt_i32 s[16:17], 32, v14
    v_cmp_gt_i32 s[18:19], 33, v14
    v_cmp_gt_i32 s[20:21], 34, v14
    v_cmp_gt_i32 s[22:23], 35, v14
    v_cndmask_b32 v112, v9, v11, s[16:17]
    v_cndmask_b32 v113, v9, v11, s[18:19]
    v_cndmask_b32 v114, v9, v11, s[20:21]
    v_cndmask_b32 v115, v9, v11, s[22:23]
    v_cmp_gt_i32 s[16:17], 48, v14
    v_cmp_gt_i32 s[18:19], 49, v14
    v_cmp_gt_i32 s[20:21], 50, v14
    v_cmp_gt_i32 s[22:23], 51, v14
    v_cndmask_b32 v120, v9, v11, s[16:17]
    v_cndmask_b32 v121, v9, v11, s[18:19]
    v_cndmask_b32 v122, v9, v11, s[20:21]
    v_cndmask_b32 v123, v9, v11, s[22:23]
L_nomask0:
    s_waitcnt vmcnt(16)
    s_barrier
    ds_read_b128 a[64:67], v2 offset:0
    ds_read_b128 a[68:71], v2 offset:1024
    ds_read_b128 a[72:75], v2 offset:2048
    ds_read_b128 a[76:79], v2 offset:3072
    ds_read_b128 a[80:83], v2 offset:4096
    ds_read_b128 a[84:87], v2 offset:5120
    ds_read_b128 a[88:91], v2 offset:6144
    ds_read_b128 a[92:95], v2 offset:7168
    s_waitcnt lgkmcnt(0)
    v_mfma_f32_16x16x32_bf16 v[32:35], a[64:67], a[0:3], v[96:99]
    ds_read_b128 a[96:99], v2 offset:8192
    v_mfma_f32_16x16x32_bf16 v[32:35], a[68:71], a[4:7], v[32:35]
    v_mfma_f32_16x16x32_bf16 v[32:35], a[72:75], a[8:11], v[32:35]
    ds_read_b128 a[100:103], v2 offset:9216
    v_mfma_f32_16x16x32_bf16 v[32:35], a[76:79], a[12:15], v[32:35]
    v_mfma_f32_16x16x32_bf16 v[32:35], a[80:83], a[16:19], v[32:35]
    ds_read_b128 a[104:107], v2 offset:10240
    v_mfma_f32_16x16x32_bf16 v[32:35], a[84:87], a[20:23], v[32:35]
    v_mfma_f32_16x16x32_bf16 v[32:35], a[88:91], a[24:27], v[32:35]
    ds_read_b128 a[108:111], v2 offset:11264
    v_mfma_f32_16x16x32_bf16 v[32:35], a[92:95], a[28:31], v[32:35]
    v_mfma_f32_16x16x32_bf16 v[36:39], a[64:67], a[32:35], v[100:103]
    ds_read_b128 a[112:115], v2 offset:12288
    v_mfma_f32_16x16x32_bf16 v[36:39], a[68:71], a[36:39], v[36:39]
    v_mfma_f32_16x16x32_bf16 v[36:39], a[72:75], a[40:43], v[36:39]
    ds_read_b128 a[116:119], v2 offset:13312
    v_mfma_f32_16x16x32_bf16 v[36:39], a[76:79], a[44:47], v[36:39]
    v_mfma_f32_16x16x32_bf16 v[36:39], a[80:83], a[48:51], v[36:39]
    ds_read_b128 a[120:123], v2 offset:14336
    v_mfma_f32_16x16x32_bf16 v[36:39], a[84:87], a[52:55], v[36:39]
    v_exp_f32 v64, v32
    v_mfma_f32_16x16x32_bf16 v[36:39], a[88:91], a[56:59], v[36:39]
    ds_read_b128 a[124:127], v2 offset:15360
    v_mfma_f32_16x16x32_bf16 v[36:39], a[92:95], a[60:63], v[36:39]
    s_waitcnt lgkmcnt(6)
    v_exp_f32 v65, v33
    v_mfma_f32_16x16x32_bf16 v[40:43], a[96:99], a[0:3], v[104:107]
    ds_read_b128 a[64:67], v2 offset:16384
    v_add_f32 v5, v64, v65
    v_mfma_f32_16x16x32_bf16 v[40:43], a[100:103], a[4:7], v[40:43]
    s_waitcnt lgkmcnt(5)
    v_exp_f32 v66, v34
    v_mfma_f32_16x16x32_bf16 v[40:43], a[104:107], a[8:11], v[40:43]
    ds_read_b128 a[68:71], v2 offset:17408
    v_add_f32 v5, v5, v66
    v_mfma_f32_16x16x32_bf16 v[40:43], a[108:111], a[12:15], v[40:43]
    s_waitcnt lgkmcnt(4)
    v_exp_f32 v67, v35
    v_mfma_f32_16x16x32_bf16 v[40:43], a[112:115], a[16:19], v[40:43]
    ds_read_b128 a[72:75], v2 offset:18432
    v_add_f32 v5, v5, v67
    v_mfma_f32_16x16x32_bf16 v[40:43], a[116:119], a[20:23], v[40:43]
    s_waitcnt lgkmcnt(3)
    v_exp_f32 v68, v36
    v_mfma_f32_16x16x32_bf16 v[40:43], a[120:123], a[24:27], v[40:43]
    ds_read_b128 a[76:79], v2 offset:19456
    v_mfma_f32_16x16x32_bf16 v[40:43], a[124:127], a[28:31], v[40:43]
    v_exp_f32 v69, v37
    v_mfma_f32_16x16x32_bf16 v[44:47], a[96:99], a[32:35], v[108:111]
    ds_read_b128 a[80:83], v2 offset:20480
    v_add_f32 v6, v68, v69
    v_mfma_f32_16x16x32_bf16 v[44:47], a[100:103], a[36:39], v[44:47]
    v_exp_f32 v70, v38
    v_mfma_f32_16x16x32_bf16 v[44:47], a[104:107], a[40:43], v[44:47]
    ds_read_b128 a[84:87], v2 offset:21504
    v_add_f32 v6, v6, v70
    v_mfma_f32_16x16x32_bf16 v[44:47], a[108:111], a[44:47], v[44:47]
    v_exp_f32 v71, v39
    v_mfma_f32_16x16x32_bf16 v[44:47], a[112:115], a[48:51], v[44:47]
    ds_read_b128 a[88:91], v2 offset:22528
    v_add_f32 v6, v6, v71
    v_mfma_f32_16x16x32_bf16 v[44:47], a[116:119], a[52:55], v[44:47]
    v_exp_f32 v72, v40
    v_mfma_f32_16x16x32_bf16 v[44:47], a[120:123], a[56:59], v[44:47]
    ds_read_b128 a[92:95], v2 offset:23552
    v_add_f32 v5, v5, v72
    v_mfma_f32_16x16x32_bf16 v[44:47], a[124:127], a[60:63], v[44:47]
    s_waitcnt lgkmcnt(6)
    v_exp_f32 v73, v41
    v_mfma_f32_16x16x32_bf16 v[48:51], a[64:67], a[0:3], v[112:115]
    ds_read_b128 a[96:99], v2 offset:24576
    v_add_f32 v5, v5, v73
    v_mfma_f32_16x16x32_bf16 v[48:51], a[68:71], a[4:7], v[48:51]
    s_waitcnt lgkmcnt(5)
    v_exp_f32 v74, v42
    v_mfma_f32_16x16x32_bf16 v[48:51], a[72:75], a[8:11], v[48:51]
    ds_read_b128 a[100:103], v2 offset:25600
    v_add_f32 v5, v5, v74
    v_mfma_f32_16x16x32_bf16 v[48:51], a[76:79], a[12:15], v[48:51]
    s_waitcnt lgkmcnt(4)
    v_exp_f32 v75, v43
    v_mfma_f32_16x16x32_bf16 v[48:51], a[80:83], a[16:19], v[48:51]
    ds_read_b128 a[104:107], v2 offset:26624
    v_add_f32 v5, v5, v75
    v_mfma_f32_16x16x32_bf16 v[48:51], a[84:87], a[20:23], v[48:51]
    s_waitcnt lgkmcnt(3)
    v_exp_f32 v76, v44
    v_mfma_f32_16x16x32_bf16 v[48:51], a[88:91], a[24:27], v[48:51]
    ds_read_b128 a[108:111], v2 offset:27648
    v_add_f32 v6, v6, v76
    v_mfma_f32_16x16x32_bf16 v[48:51], a[92:95], a[28:31], v[48:51]
    v_exp_f32 v77, v45
    v_mfma_f32_16x16x32_bf16 v[52:55], a[64:67], a[32:35], v[116:119]
    ds_read_b128 a[112:115], v2 offset:28672
    v_add_f32 v6, v6, v77
    v_mfma_f32_16x16x32_bf16 v[52:55], a[68:71], a[36:39], v[52:55]
    v_exp_f32 v78, v46
    v_mfma_f32_16x16x32_bf16 v[52:55], a[72:75], a[40:43], v[52:55]
    ds_read_b128 a[116:119], v2 offset:29696
    v_add_f32 v6, v6, v78
    v_mfma_f32_16x16x32_bf16 v[52:55], a[76:79], a[44:47], v[52:55]
    v_exp_f32 v79, v47
    v_mfma_f32_16x16x32_bf16 v[52:55], a[80:83], a[48:51], v[52:55]
    ds_read_b128 a[120:123], v2 offset:30720
    v_add_f32 v6, v6, v79
    v_mfma_f32_16x16x32_bf16 v[52:55], a[84:87], a[52:55], v[52:55]
    v_exp_f32 v80, v48
    v_mfma_f32_16x16x32_bf16 v[52:55], a[88:91], a[56:59], v[52:55]
    ds_read_b128 a[124:127], v2 offset:31744
    v_add_f32 v5, v5, v80
    v_mfma_f32_16x16x32_bf16 v[52:55], a[92:95], a[60:63], v[52:55]
    s_waitcnt lgkmcnt(6)
    v_exp_f32 v81, v49
    v_mfma_f32_16x16x32_bf16 v[56:59], a[96:99], a[0:3], v[120:123]
    v_exp_f32 v82, v50
    v_mfma_f32_16x16x32_bf16 v[56:59], a[100:103], a[4:7], v[56:59]
    s_waitcnt lgkmcnt(4)
    v_exp_f32 v83, v51
    v_mfma_f32_16x16x32_bf16 v[56:59], a[104:107], a[8:11], v[56:59]
    v_add_f32 v5, v5, v81
    v_mfma_f32_16x16x32_bf16 v[56:59], a[108:111], a[12:15], v[56:59]
    s_waitcnt lgkmcnt(2)
    v_add_f32 v5, v5, v82
    v_mfma_f32_16x16x32_bf16 v[56:59], a[112:115], a[16:19], v[56:59]
    v_add_f32 v5, v5, v83
    v_mfma_f32_16x16x32_bf16 v[56:59], a[116:119], a[20:23], v[56:59]
    s_waitcnt lgkmcnt(0)
    v_exp_f32 v84, v52
    v_mfma_f32_16x16x32_bf16 v[56:59], a[120:123], a[24:27], v[56:59]
    v_exp_f32 v85, v53
    v_mfma_f32_16x16x32_bf16 v[56:59], a[124:127], a[28:31], v[56:59]
    v_exp_f32 v86, v54
    v_mfma_f32_16x16x32_bf16 v[60:63], a[96:99], a[32:35], v[124:127]
    v_exp_f32 v87, v55
    v_mfma_f32_16x16x32_bf16 v[60:63], a[100:103], a[36:39], v[60:63]
    v_add_f32 v6, v6, v84
    v_mfma_f32_16x16x32_bf16 v[60:63], a[104:107], a[40:43], v[60:63]
    v_add_f32 v6, v6, v85
    v_mfma_f32_16x16x32_bf16 v[60:63], a[108:111], a[44:47], v[60:63]
    v_add_f32 v6, v6, v86
    v_mfma_f32_16x16x32_bf16 v[60:63], a[112:115], a[48:51], v[60:63]
    v_add_f32 v6, v6, v87
    v_mfma_f32_16x16x32_bf16 v[60:63], a[116:119], a[52:55], v[60:63]
    v_exp_f32 v88, v56
    v_mfma_f32_16x16x32_bf16 v[60:63], a[120:123], a[56:59], v[60:63]
    v_exp_f32 v89, v57
    v_mfma_f32_16x16x32_bf16 v[60:63], a[124:127], a[60:63], v[60:63]
    v_exp_f32 v90, v58
    v_xor_b32 v2, 0x8000, v2
    s_waitcnt vmcnt(8)
    s_barrier
    ds_read_b128 a[64:67], v2 offset:0
    ds_read_b128 a[68:71], v2 offset:1024
    ds_read_b128 a[72:75], v2 offset:2048
    ds_read_b128 a[76:79], v2 offset:3072
    ds_read_b128 a[80:83], v2 offset:4096
    ds_read_b128 a[84:87], v2 offset:5120
    ds_read_b128 a[88:91], v2 offset:6144
    ds_read_b128 a[92:95], v2 offset:7168
    v_exp_f32 v91, v59
    v_exp_f32 v92, v60
    v_exp_f32 v93, v61
    v_exp_f32 v94, v62
    v_exp_f32 v95, v63
    v_add_f32 v5, v5, v88
    v_add_f32 v5, v5, v89
    v_add_f32 v5, v5, v90
    v_add_f32 v5, v5, v91
    v_add_f32 v6, v6, v92
    v_add_f32 v6, v6, v93
    v_add_f32 v6, v6, v94
    v_add_f32 v6, v6, v95
L_first:
    v_add_f32 v11, v5, v6
    v_min_f32 v12, v5, v6
    v_cmp_nge_f32 vcc, s47, v11
    s_mov_b32 s46, 0xff800000
    s_cbranch_vccnz L_slow2
    v_cmp_gt_f32 vcc, 0x33800000, v12
    s_cbranch_vccnz L_slow2
    s_mov_b32 s46, 0
    s_waitcnt lgkmcnt(0)
    s_branch L_ret
L_slow:
    s_cmp_lg_u32 s47, 0x4b800000
    s_cbranch_scc1 L_switched
    s_nop 5
L_slow2:
    v_max3_f32 v11, v32, v33, v34
    v_max3_f32 v11, v11, v35, v40
    v_max3_f32 v11, v11, v41, v42
    v_max3_f32 v11, v11, v43, v48
    v_max3_f32 v11, v11, v49, v50
    v_max3_f32 v11, v11, v51, v56
    v_max3_f32 v11, v11, v57, v58
    v_max_f32 v11, v11, v59
    v_mov_b32 v13, v11
    s_nop 1
    v_permlane32_swap_b32 v11, v13
    s_nop 1
    v_max_f32 v11, v11, v13
    v_mov_b32 v13, v11
    s_nop 1
    v_permlane16_swap_b32 v11, v13
    s_nop 1
    v_max_f32 v11, v11, v13
    v_max_f32 v11, s46, v11
    v_sub_f32 v9, v9, v11
    v_sub_f32 v32, v32, v11
    v_sub_f32 v33, v33, v11
    v_sub_f32 v34, v34, v11
    v_sub_f32 v35, v35, v11
    v_sub_f32 v40, v40, v11
    v_sub_f32 v41, v41, v11
    v_sub_f32 v42, v42, v11
    v_sub_f32 v43, v43, v11
    v_sub_f32 v48, v48, v11
    v_sub_f32 v49, v49, v11
    v_sub_f32 v50, v50, v11
    v_sub_f32 v51, v51, v11
    v_sub_f32 v56, v56, v11
    v_sub_f32 v57, v57, v11
    v_sub_f32 v58, v58, v11
    v_sub_f32 v59, v59, v11
    v_exp_f32 v64, v32
    v_mov_b32 v96, v9
    v_exp_f32 v65, v33
    v_mov_b32 v97, v9
    v_exp_f32 v66, v34
    v_mov_b32 v98, v9
    v_exp_f32 v67, v35
    v_mov_b32 v99, v9
    v_exp_f32 v72, v40
    v_mov_b32 v104, v9
    v_exp_f32 v73, v41
    v_mov_b32 v105, v9
    v_exp_f32 v74, v42
    v_mov_b32 v106, v9
    v_exp_f32 v75, v43
    v_mov_b32 v107, v9
    v_exp_f32 v80, v48
    v_mov_b32 v112, v9
    v_exp_f32 v81, v49
    v_mov_b32 v113, v9
    v_exp_f32 v82, v50
    v_mov_b32 v114, v9
    v_exp_f32 v83, v51
    v_mov_b32 v115, v9
    v_exp_f32 v88, v56
    v_mov_b32 v120, v9
    v_exp_f32 v89, v57
    v_mov_b32 v121, v9
    v_exp_f32 v90, v58
    v_mov_b32 v122, v9
    v_exp_f32 v91, v59
    v_mov_b32 v123, v9
    v_add_f32 v5, v64, v65
    v_add_f32 v5, v5, v66
    v_add_f32 v5, v5, v67
    v_add_f32 v5, v5, v72
    v_add_f32 v5, v5, v73
    v_add_f32 v5, v5, v74
    v_add_f32 v5, v5, v75
    v_add_f32 v5, v5, v80
    v_add_f32 v5, v5, v81
    v_add_f32 v5, v5, v82
    v_add_f32 v5, v5, v83
    v_add_f32 v5, v5, v88
    v_add_f32 v5, v5, v89
    v_add_f32 v5, v5, v90
    v_add_f32 v5, v5, v91
    v_max3_f32 v12, v36, v37, v38
    v_max3_f32 v12, v12, v39, v44
    v_max3_f32 v12, v12, v45, v46
    v_max3_f32 v12, v12, v47, v52
    v_max3_f32 v12, v12, v53, v54
    v_max3_f32 v12, v12, v55, v60
    v_max3_f32 v12, v12, v61, v62
    v_max_f32 v12, v12, v63
    v_mov_b32 v13, v12
    s_nop 1
    v_permlane32_swap_b32 v12, v13
    s_nop 1
    v_max_f32 v12, v12, v13
    v_mov_b32 v13, v12
    s_nop 1
    v_permlane16_swap_b32 v12, v13
    s_nop 1
    v_max_f32 v12, v12, v13
    v_max_f32 v12, s46, v12
    v_sub_f32 v10, v10, v12
    v_sub_f32 v36, v36, v12
    v_sub_f32 v37, v37, v12
    v_sub_f32 v38, v38, v12
    v_sub_f32 v39, v39, v12
    v_sub_f32 v44, v44, v12
    v_sub_f32 v45, v45, v12
    v_sub_f32 v46, v46, v12
    v_sub_f32 v47, v47, v12
    v_sub_f32 v52, v52, v12
    v_sub_f32 v53, v53, v12
    v_sub_f32 v54, v54, v12
    v_sub_f32 v55, v55, v12
    v_sub_f32 v60, v60, v12
    v_sub_f32 v61, v61, v12
    v_sub_f32 v62, v62, v12
    v_sub_f32 v63, v63, v12
    v_exp_f32 v68, v36
    v_mov_b32 v100, v10
    v_exp_f32 v69, v37
    v_mov_b32 v101, v10
    v_exp_f32 v70, v38
    v_mov_b32 v102, v10
    v_exp_f32 v71, v39
    v_mov_b32 v103, v10
    v_exp_f32 v76, v44
    v_mov_b32 v108, v10
    v_exp_f32 v77, v45
    v_mov_b32 v109, v10
    v_exp_f32 v78, v46
    v_mov_b32 v110, v10
    v_exp_f32 v79, v47
    v_mov_b32 v111, v10
    v_exp_f32 v84, v52
    v_mov_b32 v116, v10
    v_exp_f32 v85, v53
    v_mov_b32 v117, v10
    v_exp_f32 v86, v54
    v_mov_b32 v118, v10
    v_exp_f32 v87, v55
    v_mov_b32 v119, v10
    v_exp_f32 v92, v60
    v_mov_b32 v124, v10
    v_exp_f32 v93, v61
    v_mov_b32 v125, v10
    v_exp_f32 v94, v62
    v_mov_b32 v126, v10
    v_exp_f32 v95, v63
    v_mov_b32 v127, v10
    v_add_f32 v6, v68, v69
    v_add_f32 v6, v6, v70
    v_add_f32 v6, v6, v71
    v_add_f32 v6, v6, v76
    v_add_f32 v6, v6, v77
    v_add_f32 v6, v6, v78
    v_add_f32 v6, v6, v79
    v_add_f32 v6, v6, v84
    v_add_f32 v6, v6, v85
    v_add_f32 v6, v6, v86
    v_add_f32 v6, v6, v87
    v_add_f32 v6, v6, v92
    v_add_f32 v6, v6, v93
    v_add_f32 v6, v6, v94
    v_add_f32 v6, v6, v95
    s_waitcnt lgkmcnt(0)
    s_cmp_lg_u32 s46, 0
    s_mov_b32 s46, 0
    s_cbranch_scc1 L_ret
    v_exp_f32 v11, -v11
    s_nop 0
    v_mul_f32 v7, v7, v11
    v_mul_f32 v128, v128, v11
    v_mul_f32 v129, v129, v11
    v_mul_f32 v130, v130, v11
    v_mul_f32 v131, v131, v11
    v_mul_f32 v132, v132, v11
    v_mul_f32 v133, v133, v11
    v_mul_f32 v134, v134, v11
    v_mul_f32 v135, v135, v11
    v_mul_f32 v136, v136, v11
    v_mul_f32 v137, v137, v11
    v_mul_f32 v138, v138, v11
    v_mul_f32 v139, v139, v11
    v_mul_f32 v140, v140, v11
    v_mul_f32 v141, v141, v11
    v_mul_f32 v142, v142, v11
    v_mul_f32 v143, v143, v11
    v_mul_f32 v144, v144, v11
    v_mul_f32 v145, v145, v11
    v_mul_f32 v146, v146, v11
    v_mul_f32 v147, v147, v11
    v_mul_f32 v148, v148, v11
    v_mul_f32 v149, v149, v11
    v_mul_f32 v150, v150, v11
    v_mul_f32 v151, v151, v11
    v_mul_f32 v152, v152, v11
    v_mul_f32 v153, v153, v11
    v_mul_f32 v154, v154, v11
    v_mul_f32 v155, v155, v11
    v_mul_f32 v156, v156, v11
    v_mul_f32 v157, v157, v11
    v_mul_f32 v158, v158, v11
    v_mul_f32 v159, v159, v11
    v_mul_f32 v160, v160, v11
    v_mul_f32 v161, v161, v11
    v_mul_f32 v162, v162, v11
    v_mul_f32 v163, v163, v11
    v_mul_f32 v164, v164, v11
    v_mul_f32 v165, v165, v11
    v_mul_f32 v166, v166, v11
    v_mul_f32 v167, v167, v11
    v_mul_f32 v168, v168, v11
    v_mul_f32 v169, v169, v11
    v_mul_f32 v170, v170, v11
    v_mul_f32 v171, v171, v11
    v_mul_f32 v172, v172, v11
    v_mul_f32 v173, v173, v11
    v_mul_f32 v174, v174, v11
    v_mul_f32 v175, v175, v11
    v_mul_f32 v176, v176, v11
    v_mul_f32 v177, v177, v11
    v_mul_f32 v178, v178, v11
    v_mul_f32 v179, v179, v11
    v_mul_f32 v180, v180, v11
    v_mul_f32 v181, v181, v11
    v_mul_f32 v182, v182, v11
    v_mul_f32 v183, v183, v11
    v_mul_f32 v184, v184, v11
    v_mul_f32 v185, v185, v11
    v_mul_f32 v186, v186, v11
    v_mul_f32 v187, v187, v11
    v_mul_f32 v188, v188, v11
    v_mul_f32 v189, v189, v11
    v_mul_f32 v190, v190, v11
    v_mul_f32 v191, v191, v11
    v_exp_f32 v12, -v12
    s_nop 0
    v_mul_f32 v8, v8, v12
    v_mul_f32 v192, v192, v12
    v_mul_f32 v193, v193, v12
    v_mul_f32 v194, v194, v12
    v_mul_f32 v195, v195, v12
    v_mul_f32 v196, v196, v12
    v_mul_f32 v197, v197, v12
    v_mul_f32 v198, v198, v12
    v_mul_f32 v199, v199, v12
    v_mul_f32 v200, v200, v12
    v_mul_f32 v201, v201, v12
    v_mul_f32 v202, v202, v12
    v_mul_f32 v203, v203, v12
    v_mul_f32 v204, v204, v12
    v_mul_f32 v205, v205, v12
    v_mul_f32 v206, v206, v12
    v_mul_f32 v207, v207, v12
    v_mul_f32 v208, v208, v12
    v_mul_f32 v209, v209, v12
    v_mul_f32 v210, v210, v12
    v_mul_f32 v211, v211, v12
    v_mul_f32 v212, v212, v12
    v_mul_f32 v213, v213, v12
    v_mul_f32 v214, v214, v12
    v_mul_f32 v215, v215, v12
    v_mul_f32 v216, v216, v12
    v_mul_f32 v217, v217, v12
    v_mul_f32 v218, v218, v12
    v_mul_f32 v219, v219, v12
    v_mul_f32 v220, v220, v12
    v_mul_f32 v221, v221, v12
    v_mul_f32 v222, v222, v12
    v_mul_f32 v223, v223, v12
    v_mul_f32 v224, v224, v12
    v_mul_f32 v225, v225, v12
    v_mul_f32 v226, v226, v12
    v_mul_f32 v227, v227, v12
    v_mul_f32 v228, v228, v12
    v_mul_f32 v229, v229, v12
    v_mul_f32 v230, v230, v12
    v_mul_f32 v231, v231, v12
    v_mul_f32 v232, v232, v12
    v_mul_f32 v233, v233, v12
    v_mul_f32 v234, v234, v12
    v_mul_f32 v235, v235, v12
    v_mul_f32 v236, v236, v12
    v_mul_f32 v237, v237, v12
    v_mul_f32 v238, v238, v12
    v_mul_f32 v239, v239, v12
    v_mul_f32 v240, v240, v12
    v_mul_f32 v241, v241, v12
    v_mul_f32 v242, v242, v12
    v_mul_f32 v243, v243, v12
    v_mul_f32 v244, v244, v12
    v_mul_f32 v245, v245, v12
    v_mul_f32 v246, v246, v12
    v_mul_f32 v247, v247, v12
    v_mul_f32 v248, v248, v12
    v_mul_f32 v249, v249, v12
    v_mul_f32 v250, v250, v12
    v_mul_f32 v251, v251, v12
    v_mul_f32 v252, v252, v12
    v_mul_f32 v253, v253, v12
    v_mul_f32 v254, v254, v12
    v_mul_f32 v255, v255, v12
    s_branch L_ret
.p2align 6
L_loop:
    v_mfma_f32_16x16x32_bf16 v[32:35], a[64:67], a[0:3], v[96:99]
    s_mov_b32 m0, s40
    ds_read_b128 a[96:99], v2 offset:8192
    v_cvt_pk_bf16_f32 v16, v64, v65
    v_mfma_f32_16x16x32_bf16 v[32:35], a[68:71], a[4:7], v[32:35]
    s_waitcnt lgkmcnt(5)
    buffer_load_dwordx4 v1, s[12:15], s42 offen offset:0 sc1 lds
    v_mfma_f32_16x16x32_bf16 v[32:35], a[72:75], a[8:11], v[32:35]
    ds_read_b128 a[100:103], v2 offset:9216
    v_cvt_pk_bf16_f32 v17, v66, v67
    v_mfma_f32_16x16x32_bf16 v[32:35], a[76:79], a[12:15], v[32:35]
    s_waitcnt lgkmcnt(4)
    v_cvt_pk_bf16_f32 v20, v68, v69
    v_cvt_pk_bf16_f32 v21, v70, v71
    v_mfma_f32_16x16x32_bf16 v[32:35], a[80:83], a[16:19], v[32:35]
    ds_read_b128 a[104:107], v2 offset:10240
    v_add_f32 v7, v7, v5
    v_mfma_f32_16x16x32_bf16 v[32:35], a[84:87], a[20:23], v[32:35]
    s_waitcnt lgkmcnt(3)
    v_add_f32 v8, v8, v6
    v_cvt_pk_bf16_f32 v18, v72, v73
    v_mfma_f32_16x16x32_bf16 v[32:35], a[88:91], a[24:27], v[32:35]
    ds_read_b128 a[108:111], v2 offset:11264
    v_cvt_pk_bf16_f32 v19, v74, v75
    v_mfma_f32_16x16x32_bf16 v[32:35], a[92:95], a[28:31], v[32:35]
    buffer_load_dwordx4 v1, s[12:15], s42 offen offset:1024 sc1 lds
    v_mfma_f32_16x16x32_bf16 v[36:39], a[64:67], a[32:35], v[100:103]
    ds_read_b128 a[112:115], v2 offset:12288
    v_cvt_pk_bf16_f32 v22, v76, v77
    v_mfma_f32_16x16x32_bf16 v[36:39], a[68:71], a[36:39], v[36:39]
    v_cvt_pk_bf16_f32 v23, v78, v79
    v_cvt_pk_bf16_f32 v24, v80, v81
    v_mfma_f32_16x16x32_bf16 v[36:39], a[72:75], a[40:43], v[36:39]
    ds_read_b128 a[116:119], v2 offset:13312
    v_cvt_pk_bf16_f32 v25, v82, v83
    v_mfma_f32_16x16x32_bf16 v[36:39], a[76:79], a[44:47], v[36:39]
    v_cvt_pk_bf16_f32 v28, v84, v85
    v_cvt_pk_bf16_f32 v29, v86, v87
    v_mfma_f32_16x16x32_bf16 v[36:39], a[80:83], a[48:51], v[36:39]
    ds_read_b128 a[120:123], v2 offset:14336
    v_cvt_pk_bf16_f32 v26, v88, v89
    v_mfma_f32_16x16x32_bf16 v[36:39], a[84:87], a[52:55], v[36:39]
    buffer_load_dwordx4 v1, s[12:15], s42 offen offset:2048 sc1 lds
    v_mfma_f32_16x16x32_bf16 v[36:39], a[88:91], a[56:59], v[36:39]
    ds_read_b128 a[124:127], v2 offset:15360
    v_cvt_pk_bf16_f32 v27, v90, v91
    v_mfma_f32_16x16x32_bf16 v[36:39], a[92:95], a[60:63], v[36:39]
    s_waitcnt lgkmcnt(6)
    v_exp_f32 v64, v32
    v_mfma_f32_16x16x32_bf16 v[40:43], a[96:99], a[0:3], v[104:107]
    ds_read_b128 a[64:67], v2 offset:16384
    v_cvt_pk_bf16_f32 v30, v92, v93
    v_mfma_f32_16x16x32_bf16 v[40:43], a[100:103], a[4:7], v[40:43]
    s_waitcnt lgkmcnt(5)
    v_exp_f32 v65, v33
    v_mfma_f32_16x16x32_bf16 v[40:43], a[104:107], a[8:11], v[40:43]
    ds_read_b128 a[68:71], v2 offset:17408
    v_cvt_pk_bf16_f32 v31, v94, v95
    v_mfma_f32_16x16x32_bf16 v[40:43], a[108:111], a[12:15], v[40:43]
    s_waitcnt lgkmcnt(4)
    buffer_load_dwordx4 v1, s[12:15], s42 offen offset:3072 sc1 lds
    v_mfma_f32_16x16x32_bf16 v[40:43], a[112:115], a[16:19], v[40:43]
    ds_read_b128 a[72:75], v2 offset:18432
    v_add_f32 v5, v64, v65
    v_mfma_f32_16x16x32_bf16 v[40:43], a[116:119], a[20:23], v[40:43]
    s_waitcnt lgkmcnt(3)
    v_exp_f32 v66, v34
    v_mfma_f32_16x16x32_bf16 v[40:43], a[120:123], a[24:27], v[40:43]
    ds_read_b128 a[76:79], v2 offset:19456
    v_add_f32 v5, v5, v66
    v_mfma_f32_16x16x32_bf16 v[40:43], a[124:127], a[28:31], v[40:43]
    v_exp_f32 v67, v35
    v_mfma_f32_16x16x32_bf16 v[44:47], a[96:99], a[32:35], v[108:111]
    s_bitset1_b32 m0, 12
    ds_read_b128 a[80:83], v2 offset:20480
    v_add_f32 v5, v5, v67
    v_mfma_f32_16x16x32_bf16 v[44:47], a[100:103], a[36:39], v[44:47]
    buffer_load_dwordx4 v4, s[12:15], s42 offen offset:0 sc1 lds
    v_mfma_f32_16x16x32_bf16 v[44:47], a[104:107], a[40:43], v[44:47]
    ds_read_b128 a[84:87], v2 offset:21504
    v_mfma_f32_16x16x32_bf16 v[44:47], a[108:111], a[44:47], v[44:47]
    v_exp_f32 v68, v36
    v_mfma_f32_16x16x32_bf16 v[44:47], a[112:115], a[48:51], v[44:47]
    ds_read_b128 a[88:91], v2 offset:22528
    v_mfma_f32_16x16x32_bf16 v[44:47], a[116:119], a[52:55], v[44:47]
    v_exp_f32 v69, v37
    v_mfma_f32_16x16x32_bf16 v[44:47], a[120:123], a[56:59], v[44:47]
    ds_read_b128 a[92:95], v2 offset:23552
    v_add_f32 v6, v68, v69
    v_mfma_f32_16x16x32_bf16 v[44:47], a[124:127], a[60:63], v[44:47]
    s_waitcnt lgkmcnt(6)
    buffer_load_dwordx4 v4, s[12:15], s42 offen offset:1024 sc1 lds
    v_mfma_f32_16x16x32_bf16 v[48:51], a[64:67], a[0:3], v[112:115]
    ds_read_b128 a[96:99], v2 offset:24576
    v_mfma_f32_16x16x32_bf16 v[48:51], a[68:71], a[4:7], v[48:51]
    s_waitcnt lgkmcnt(5)
    v_exp_f32 v70, v38
    v_mfma_f32_16x16x32_bf16 v[48:51], a[72:75], a[8:11], v[48:51]
    ds_read_b128 a[100:103], v2 offset:25600
    v_add_f32 v6, v6, v70
    v_mfma_f32_16x16x32_bf16 v[48:51], a[76:79], a[12:15], v[48:51]
    s_waitcnt lgkmcnt(4)
    v_exp_f32 v71, v39
    v_mfma_f32_16x16x32_bf16 v[48:51], a[80:83], a[16:19], v[48:51]
    ds_read_b128 a[104:107], v2 offset:26624
    v_add_f32 v6, v6, v71
    v_mfma_f32_16x16x32_bf16 v[48:51], a[84:87], a[20:23], v[48:51]
    s_waitcnt lgkmcnt(3)
    buffer_load_dwordx4 v4, s[12:15], s42 offen offset:2048 sc1 lds
    v_mfma_f32_16x16x32_bf16 v[48:51], a[88:91], a[24:27], v[48:51]
    ds_read_b128 a[108:111], v2 offset:27648
    v_mfma_f32_16x16x32_bf16 v[48:51], a[92:95], a[28:31], v[48:51]
    v_exp_f32 v72, v40
    v_mfma_f32_16x16x32_bf16 v[52:55], a[64:67], a[32:35], v[116:119]
    ds_read_b128 a[112:115], v2 offset:28672
    v_add_f32 v5, v5, v72
    v_mfma_f32_16x16x32_bf16 v[52:55], a[68:71], a[36:39], v[52:55]
    v_exp_f32 v73, v41
    v_mfma_f32_16x16x32_bf16 v[52:55], a[72:75], a[40:43], v[52:55]
    ds_read_b128 a[116:119], v2 offset:29696
    v_add_f32 v5, v5, v73
    v_mfma_f32_16x16x32_bf16 v[52:55], a[76:79], a[44:47], v[52:55]
    buffer_load_dwordx4 v4, s[12:15], s42 offen offset:3072 sc1 lds
    v_mfma_f32_16x16x32_bf16 v[52:55], a[80:83], a[48:51], v[52:55]
    s_add_u32 s42, s42, 0x8000
    ds_read_b128 a[120:123], v2 offset:30720
    v_mfma_f32_16x16x32_bf16 v[52:55], a[84:87], a[52:55], v[52:55]
    s_xor_b32 s40, s40, 0x8000
    v_exp_f32 v74, v42
    v_mfma_f32_16x16x32_bf16 v[52:55], a[88:91], a[56:59], v[52:55]
    s_waitcnt vmcnt(8)
    ds_read_b128 a[124:127], v2 offset:31744
    v_add_f32 v5, v5, v74
    v_mfma_f32_16x16x32_bf16 v[52:55], a[92:95], a[60:63], v[52:55]
    s_waitcnt lgkmcnt(6)
    s_barrier
    v_mfma_f32_16x16x32_bf16 v[56:59], a[96:99], a[0:3], v[120:123]
    s_mov_b32 m0, s41
    ds_read_b128 a[64:67], v3 offset:0
    v_xor_b32 v2, 0x8000, v2
    v_mfma_f32_16x16x32_bf16 v[56:59], a[100:103], a[4:7], v[56:59]
    s_waitcnt lgkmcnt(5)
    buffer_load_dwordx4 v1, s[12:15], s43 offen offset:0 sc1 lds
    v_mfma_f32_16x16x32_bf16 v[56:59], a[104:107], a[8:11], v[56:59]
    ds_read_b128 a[68:71], v3 offset:16384
    v_mfma_f32_16x16x32_bf16 v[56:59], a[108:111], a[12:15], v[56:59]
    s_waitcnt lgkmcnt(4)
    v_exp_f32 v75, v43
    v_mfma_f32_16x16x32_bf16 v[56:59], a[112:115], a[16:19], v[56:59]
    ds_read_b128 a[72:75], v3 offset:1024
    v_add_f32 v5, v5, v75
    v_mfma_f32_16x16x32_bf16 v[56:59], a[116:119], a[20:23], v[56:59]
    s_waitcnt lgkmcnt(3)
    v_exp_f32 v76, v44
    v_mfma_f32_16x16x32_bf16 v[56:59], a[120:123], a[24:27], v[56:59]
    ds_read_b128 a[76:79], v3 offset:17408
    v_add_f32 v6, v6, v76
    v_mfma_f32_16x16x32_bf16 v[56:59], a[124:127], a[28:31], v[56:59]
    buffer_load_dwordx4 v1, s[12:15], s43 offen offset:1024 sc1 lds
    v_mfma_f32_16x16x32_bf16 v[60:63], a[96:99], a[32:35], v[124:127]
    ds_read_b128 a[80:83], v3 offset:2048
    v_mfma_f32_16x16x32_bf16 v[60:63], a[100:103], a[36:39], v[60:63]
    v_exp_f32 v77, v45
    v_mfma_f32_16x16x32_bf16 v[60:63], a[104:107], a[40:43], v[60:63]
    ds_read_b128 a[84:87], v3 offset:18432
    v_add_f32 v6, v6, v77
    v_mfma_f32_16x16x32_bf16 v[60:63], a[108:111], a[44:47], v[60:63]
    v_exp_f32 v78, v46
    v_mfma_f32_16x16x32_bf16 v[60:63], a[112:115], a[48:51], v[60:63]
    ds_read_b128 a[88:91], v3 offset:3072
    v_add_f32 v6, v6, v78
    v_mfma_f32_16x16x32_bf16 v[60:63], a[116:119], a[52:55], v[60:63]
    buffer_load_dwordx4 v1, s[12:15], s43 offen offset:2048 sc1 lds
    v_mfma_f32_16x16x32_bf16 v[60:63], a[120:123], a[56:59], v[60:63]
    ds_read_b128 a[92:95], v3 offset:19456
    v_mfma_f32_16x16x32_bf16 v[60:63], a[124:127], a[60:63], v[60:63]
    s_waitcnt lgkmcnt(6)
    v_exp_f32 v79, v47
    v_mfma_f32_16x16x32_bf16 v[128:131], a[64:67], v[16:19], v[128:131]
    ds_read_b128 a[96:99], v3 offset:4096
    v_add_f32 v6, v6, v79
    v_mfma_f32_16x16x32_bf16 v[128:131], a[68:71], v[24:27], v[128:131]
    v_exp_f32 v80, v48
    v_mfma_f32_16x16x32_bf16 v[192:195], a[68:71], v[28:31], v[192:195]
    ds_read_b128 a[100:103], v3 offset:20480
    v_add_f32 v5, v5, v80
    v_mfma_f32_16x16x32_bf16 v[192:195], a[64:67], v[20:23], v[192:195]
    s_waitcnt lgkmcnt(6)
    buffer_load_dwordx4 v1, s[12:15], s43 offen offset:3072 sc1 lds
    v_mfma_f32_16x16x32_bf16 v[132:135], a[72:75], v[16:19], v[132:135]
    ds_read_b128 a[104:107], v3 offset:5120
    v_mfma_f32_16x16x32_bf16 v[132:135], a[76:79], v[24:27], v[132:135]
    v_exp_f32 v81, v49
    v_mfma_f32_16x16x32_bf16 v[196:199], a[76:79], v[28:31], v[196:199]
    ds_read_b128 a[108:111], v3 offset:21504
    v_add_f32 v5, v5, v81
    v_mfma_f32_16x16x32_bf16 v[196:199], a[72:75], v[20:23], v[196:199]
    s_waitcnt lgkmcnt(6)
    v_exp_f32 v82, v50
    v_mfma_f32_16x16x32_bf16 v[136:139], a[80:83], v[16:19], v[136:139]
    s_bitset1_b32 m0, 12
    ds_read_b128 a[112:115], v3 offset:6144
    v_add_f32 v5, v5, v82
    v_mfma_f32_16x16x32_bf16 v[136:139], a[84:87], v[24:27], v[136:139]
    buffer_load_dwordx4 v4, s[12:15], s43 offen offset:0 sc1 lds
    v_mfma_f32_16x16x32_bf16 v[200:203], a[84:87], v[28:31], v[200:203]
    ds_read_b128 a[116:119], v3 offset:22528
    v_mfma_f32_16x16x32_bf16 v[200:203], a[80:83], v[20:23], v[200:203]
    s_waitcnt lgkmcnt(6)
    v_exp_f32 v83, v51
    v_mfma_f32_16x16x32_bf16 v[140:143], a[88:91], v[16:19], v[140:143]
    ds_read_b128 a[120:123], v3 offset:7168
    v_add_f32 v5, v5, v83
    v_mfma_f32_16x16x32_bf16 v[140:143], a[92:95], v[24:27], v[140:143]
    v_exp_f32 v84, v52
    v_mfma_f32_16x16x32_bf16 v[204:207], a[92:95], v[28:31], v[204:207]
    ds_read_b128 a[124:127], v3 offset:23552
    v_add_f32 v6, v6, v84
    v_mfma_f32_16x16x32_bf16 v[204:207], a[88:91], v[20:23], v[204:207]
    s_waitcnt lgkmcnt(6)
    buffer_load_dwordx4 v4, s[12:15], s43 offen offset:1024 sc1 lds
    v_mfma_f32_16x16x32_bf16 v[144:147], a[96:99], v[16:19], v[144:147]
    ds_read_b128 a[64:67], v3 offset:8192
    v_mfma_f32_16x16x32_bf16 v[144:147], a[100:103], v[24:27], v[144:147]
    v_exp_f32 v85, v53
    v_mfma_f32_16x16x32_bf16 v[208:211], a[100:103], v[28:31], v[208:211]
    ds_read_b128 a[68:71], v3 offset:24576
    v_add_f32 v6, v6, v85
    v_mfma_f32_16x16x32_bf16 v[208:211], a[96:99], v[20:23], v[208:211]
    s_waitcnt lgkmcnt(6)
    v_exp_f32 v86, v54
    v_mfma_f32_16x16x32_bf16 v[148:151], a[104:107], v[16:19], v[148:151]
    ds_read_b128 a[72:75], v3 offset:9216
    v_add_f32 v6, v6, v86
    v_mfma_f32_16x16x32_bf16 v[148:151], a[108:111], v[24:27], v[148:151]
    buffer_load_dwordx4 v4, s[12:15], s43 offen offset:2048 sc1 lds
    v_mfma_f32_16x16x32_bf16 v[212:215], a[108:111], v[28:31], v[212:215]
    ds_read_b128 a[76:79], v3 offset:25600
    v_mfma_f32_16x16x32_bf16 v[212:215], a[104:107], v[20:23], v[212:215]
    s_waitcnt lgkmcnt(6)
    v_exp_f32 v87, v55
    v_mfma_f32_16x16x32_bf16 v[152:155], a[112:115], v[16:19], v[152:155]
    ds_read_b128 a[80:83], v3 offset:10240
    v_add_f32 v6, v6, v87
    v_mfma_f32_16x16x32_bf16 v[152:155], a[116:119], v[24:27], v[152:155]
    v_exp_f32 v88, v56
    v_mfma_f32_16x16x32_bf16 v[216:219], a[116:119], v[28:31], v[216:219]
    ds_read_b128 a[84:87], v3 offset:26624
    v_add_f32 v5, v5, v88
    v_mfma_f32_16x16x32_bf16 v[216:219], a[112:115], v[20:23], v[216:219]
    s_waitcnt lgkmcnt(6)
    buffer_load_dwordx4 v4, s[12:15], s43 offen offset:3072 sc1 lds
    v_mfma_f32_16x16x32_bf16 v[156:159], a[120:123], v[16:19], v[156:159]
    s_add_u32 s43, s43, 0x8000
    ds_read_b128 a[88:91], v3 offset:11264
    v_mfma_f32_16x16x32_bf16 v[156:159], a[124:127], v[24:27], v[156:159]
    s_xor_b32 s41, s41, 0x8000
    v_exp_f32 v89, v57
    v_mfma_f32_16x16x32_bf16 v[220:223], a[124:127], v[28:31], v[220:223]
    ds_read_b128 a[92:95], v3 offset:27648
    v_add_f32 v5, v5, v89
    v_mfma_f32_16x16x32_bf16 v[220:223], a[120:123], v[20:23], v[220:223]
    s_waitcnt lgkmcnt(6)
    v_exp_f32 v90, v58
    v_mfma_f32_16x16x32_bf16 v[160:163], a[64:67], v[16:19], v[160:163]
    ds_read_b128 a[96:99], v3 offset:12288
    v_add_f32 v5, v5, v90
    v_mfma_f32_16x16x32_bf16 v[160:163], a[68:71], v[24:27], v[160:163]
    v_exp_f32 v91, v59
    v_mfma_f32_16x16x32_bf16 v[224:227], a[68:71], v[28:31], v[224:227]
    ds_read_b128 a[100:103], v3 offset:28672
    v_add_f32 v5, v5, v91
    v_mfma_f32_16x16x32_bf16 v[224:227], a[64:67], v[20:23], v[224:227]
    s_waitcnt lgkmcnt(6)
    v_exp_f32 v92, v60
    v_mfma_f32_16x16x32_bf16 v[164:167], a[72:75], v[16:19], v[164:167]
    ds_read_b128 a[104:107], v3 offset:13312
    v_add_f32 v6, v6, v92
    v_mfma_f32_16x16x32_bf16 v[164:167], a[76:79], v[24:27], v[164:167]
    v_exp_f32 v93, v61
    v_mfma_f32_16x16x32_bf16 v[228:231], a[76:79], v[28:31], v[228:231]
    ds_read_b128 a[108:111], v3 offset:29696
    v_add_f32 v6, v6, v93
    v_mfma_f32_16x16x32_bf16 v[228:231], a[72:75], v[20:23], v[228:231]
    s_waitcnt lgkmcnt(6)
    v_exp_f32 v94, v62
    v_mfma_f32_16x16x32_bf16 v[168:171], a[80:83], v[16:19], v[168:171]
    ds_read_b128 a[112:115], v3 offset:14336
    v_add_f32 v6, v6, v94
    v_mfma_f32_16x16x32_bf16 v[168:171], a[84:87], v[24:27], v[168:171]
    v_exp_f32 v95, v63
    v_mfma_f32_16x16x32_bf16 v[232:235], a[84:87], v[28:31], v[232:235]
    ds_read_b128 a[116:119], v3 offset:30720
    v_add_f32 v6, v6, v95
    v_mfma_f32_16x16x32_bf16 v[232:235], a[80:83], v[20:23], v[232:235]
    s_waitcnt lgkmcnt(6)
    v_add_f32 v11, v5, v6
    v_mfma_f32_16x16x32_bf16 v[172:175], a[88:91], v[16:19], v[172:175]
    ds_read_b128 a[120:123], v3 offset:15360
    v_cmp_nge_f32 vcc, s47, v11
    v_mfma_f32_16x16x32_bf16 v[172:175], a[92:95], v[24:27], v[172:175]
    v_mfma_f32_16x16x32_bf16 v[236:239], a[92:95], v[28:31], v[236:239]
    s_waitcnt vmcnt(8)
    ds_read_b128 a[124:127], v3 offset:31744
    v_mfma_f32_16x16x32_bf16 v[236:239], a[88:91], v[20:23], v[236:239]
    s_waitcnt lgkmcnt(6)
    s_barrier
    v_mfma_f32_16x16x32_bf16 v[176:179], a[96:99], v[16:19], v[176:179]
    ds_read_b128 a[64:67], v2 offset:0
    v_xor_b32 v3, 0x8000, v3
    v_mfma_f32_16x16x32_bf16 v[176:179], a[100:103], v[24:27], v[176:179]
    v_mfma_f32_16x16x32_bf16 v[240:243], a[100:103], v[28:31], v[240:243]
    ds_read_b128 a[68:71], v2 offset:1024
    v_mfma_f32_16x16x32_bf16 v[240:243], a[96:99], v[20:23], v[240:243]
    s_waitcnt lgkmcnt(6)
    v_mfma_f32_16x16x32_bf16 v[180:183], a[104:107], v[16:19], v[180:183]
    ds_read_b128 a[72:75], v2 offset:2048
    v_mfma_f32_16x16x32_bf16 v[180:183], a[108:111], v[24:27], v[180:183]
    v_mfma_f32_16x16x32_bf16 v[244:247], a[108:111], v[28:31], v[244:247]
    ds_read_b128 a[76:79], v2 offset:3072
    v_mfma_f32_16x16x32_bf16 v[244:247], a[104:107], v[20:23], v[244:247]
    s_waitcnt lgkmcnt(6)
    v_mfma_f32_16x16x32_bf16 v[184:187], a[112:115], v[16:19], v[184:187]
    s_sub_u32 s44, s44, 1
    ds_read_b128 a[80:83], v2 offset:4096
    v_mfma_f32_16x16x32_bf16 v[184:187], a[116:119], v[24:27], v[184:187]
    v_mfma_f32_16x16x32_bf16 v[248:251], a[116:119], v[28:31], v[248:251]
    ds_read_b128 a[84:87], v2 offset:5120
    v_mfma_f32_16x16x32_bf16 v[248:251], a[112:115], v[20:23], v[248:251]
    s_waitcnt lgkmcnt(6)
    v_mfma_f32_16x16x32_bf16 v[188:191], a[120:123], v[16:19], v[188:191]
    ds_read_b128 a[88:91], v2 offset:6144
    v_mfma_f32_16x16x32_bf16 v[188:191], a[124:127], v[24:27], v[188:191]
    v_mfma_f32_16x16x32_bf16 v[252:255], a[124:127], v[28:31], v[252:255]
    ds_read_b128 a[92:95], v2 offset:7168
    v_mfma_f32_16x16x32_bf16 v[252:255], a[120:123], v[20:23], v[252:255]
    s_waitcnt lgkmcnt(6)
    s_cbranch_vccnz L_slow
L_ret:
    s_cmp_gt_u32 s44, s45
    s_cbranch_scc1 L_loop
    s_cmp_eq_u32 s44, 0
    s_cbranch_scc1 L_segend
    s_cmp_eq_u32 s44, 1
    s_cbranch_scc1 L_d1
    v_mov_b32 v11, 0xf149f2ca
    v_cmp_gt_i32 s[16:17], 0, v14
    v_cmp_gt_i32 s[18:19], 1, v14
    v_cmp_gt_i32 s[20:21], 2, v14
    v_cmp_gt_i32 s[22:23], 3, v14
    v_cndmask_b32 v96, v9, v11, s[16:17]
    v_cndmask_b32 v97, v9, v11, s[18:19]
    v_cndmask_b32 v98, v9, v11, s[20:21]
    v_cndmask_b32 v99, v9, v11, s[22:23]
    v_cmp_gt_i32 s[16:17], 16, v14
    v_cmp_gt_i32 s[18:19], 17, v14
    v_cmp_gt_i32 s[20:21], 18, v14
    v_cmp_gt_i32 s[22:23], 19, v14
    v_cndmask_b32 v104, v9, v11, s[16:17]
    v_cndmask_b32 v105, v9, v11, s[18:19]
    v_cndmask_b32 v106, v9, v11, s[20:21]
    v_cndmask_b32 v107, v9, v11, s[22:23]
    v_cmp_gt_i32 s[16:17], 32, v14
    v_cmp_gt_i32 s[18:19], 33, v14
    v_cmp_gt_i32 s[20:21], 34, v14
    v_cmp_gt_i32 s[22:23], 35, v14
    v_cndmask_b32 v112, v9, v11, s[16:17]
    v_cndmask_b32 v113, v9, v11, s[18:19]
    v_cndmask_b32 v114, v9, v11, s[20:21]
    v_cndmask_b32 v115, v9, v11, s[22:23]
    v_cmp_gt_i32 s[16:17], 48, v14
    v_cmp_gt_i32 s[18:19], 49, v14
    v_cmp_gt_i32 s[20:21], 50, v14
    v_cmp_gt_i32 s[22:23], 51, v14
    v_cndmask_b32 v120, v9, v11, s[16:17]
    v_cndmask_b32 v121, v9, v11, s[18:19]
    v_cndmask_b32 v122, v9, v11, s[20:21]
    v_cndmask_b32 v123, v9, v11, s[22:23]
    s_nop 0
    s_branch L_loop
L_d1:
    s_cmp_eq_u32 s54, 0
    s_cselect_b32 s57, s38, 0
    s_cmp_lg_u32 s57, 0
    s_cselect_b32 s42, s49, 0xf0000000
    s_cbranch_scc0 L_d1b
    s_sub_u32 s58, 15, s25
    s_lshl_b32 s55, s58, 16
    s_add_u32 s55, s55, s49
    s_add_u32 s55, s55, 33554432
    s_add_u32 s56, s55, 0x8000
    buffer_load_dwordx4 a[128:131], v1, s[12:15], s55 offen offset:0 sc1
    buffer_load_dwordx4 a[132:135], v1, s[12:15], s55 offen offset:1024 sc1
    buffer_load_dwordx4 a[136:139], v1, s[12:15], s55 offen offset:2048 sc1
    buffer_load_dwordx4 a[140:143], v1, s[12:15], s55 offen offset:3072 sc1
    buffer_load_dwordx4 a[144:147], v4, s[12:15], s55 offen offset:0 sc1
    buffer_load_dwordx4 a[148:151], v4, s[12:15], s55 offen offset:1024 sc1
    buffer_load_dwordx4 a[152:155], v4, s[12:15], s55 offen offset:2048 sc1
    buffer_load_dwordx4 a[156:159], v4, s[12:15], s55 offen offset:3072 sc1
    buffer_load_dwordx4 a[160:163], v1, s[12:15], s56 offen offset:0 sc1
    buffer_load_dwordx4 a[164:167], v1, s[12:15], s56 offen offset:1024 sc1
    buffer_load_dwordx4 a[168:171], v1, s[12:15], s56 offen offset:2048 sc1
    buffer_load_dwordx4 a[172:175], v1, s[12:15], s56 offen offset:3072 sc1
    buffer_load_dwordx4 a[176:179], v4, s[12:15], s56 offen offset:0 sc1
    buffer_load_dwordx4 a[180:183], v4, s[12:15], s56 offen offset:1024 sc1
    buffer_load_dwordx4 a[184:187], v4, s[12:15], s56 offen offset:2048 sc1
    buffer_load_dwordx4 a[188:191], v4, s[12:15], s56 offen offset:3072 sc1
L_d1b:
    v_mov_b32 v11, 0xf149f2ca
    v_cmp_gt_i32 s[16:17], 0, v14
    v_cmp_gt_i32 s[18:19], 1, v14
    v_cmp_gt_i32 s[20:21], 2, v14
    v_cmp_gt_i32 s[22:23], 3, v14
    v_cndmask_b32 v100, v10, v11, s[16:17]
    v_cndmask_b32 v101, v10, v11, s[18:19]
    v_cndmask_b32 v102, v10, v11, s[20:21]
    v_cndmask_b32 v103, v10, v11, s[22:23]
    v_cmp_gt_i32 s[16:17], 16, v14
    v_cmp_gt_i32 s[18:19], 17, v14
    v_cmp_gt_i32 s[20:21], 18, v14
    v_cmp_gt_i32 s[22:23], 19, v14
    v_cndmask_b32 v108, v10, v11, s[16:17]
    v_cndmask_b32 v109, v10, v11, s[18:19]
    v_cndmask_b32 v110, v10, v11, s[20:21]
    v_cndmask_b32 v111, v10, v11, s[22:23]
    v_cmp_gt_i32 s[16:17], 32, v14
    v_cmp_gt_i32 s[18:19], 33, v14
    v_cmp_gt_i32 s[20:21], 34, v14
    v_cmp_gt_i32 s[22:23], 35, v14
    v_cndmask_b32 v116, v10, v11, s[16:17]
    v_cndmask_b32 v117, v10, v11, s[18:19]
    v_cndmask_b32 v118, v10, v11, s[20:21]
    v_cndmask_b32 v119, v10, v11, s[22:23]
    v_cmp_gt_i32 s[16:17], 48, v14
    v_cmp_gt_i32 s[18:19], 49, v14
    v_cmp_gt_i32 s[20:21], 50, v14
    v_cmp_gt_i32 s[22:23], 51, v14
    v_cndmask_b32 v124, v10, v11, s[16:17]
    v_cndmask_b32 v125, v10, v11, s[18:19]
    v_cndmask_b32 v126, v10, v11, s[20:21]
    v_cndmask_b32 v127, v10, v11, s[22:23]
    v_mov_b32 v96, v11
    v_mov_b32 v97, v11
    v_mov_b32 v98, v11
    v_mov_b32 v99, v11
    v_mov_b32 v104, v11
    v_mov_b32 v105, v11
    v_mov_b32 v106, v11
    v_mov_b32 v107, v11
    v_mov_b32 v112, v11
    v_mov_b32 v113, v11
    v_mov_b32 v114, v11
    v_mov_b32 v115, v11
    v_mov_b32 v120, v11
    v_mov_b32 v121, v11
    v_mov_b32 v122, v11
    v_mov_b32 v123, v11
    s_nop 0
    s_branch L_loop
L_segend:
    s_cmp_eq_u32 s54, 0
    s_cselect_b32 s57, s38, 0
    s_cmp_eq_u32 s57, 0
    s_cbranch_scc1 L_tail
    v_accvgpr_mov_b32 a0, a128
    v_accvgpr_mov_b32 a1, a129
    v_accvgpr_mov_b32 a2, a130
    v_accvgpr_mov_b32 a3, a131
    v_accvgpr_mov_b32 a4, a132
    v_accvgpr_mov_b32 a5, a133
    v_accvgpr_mov_b32 a6, a134
    v_accvgpr_mov_b32 a7, a135
    v_accvgpr_mov_b32 a8, a136
    v_accvgpr_mov_b32 a9, a137
    v_accvgpr_mov_b32 a10, a138
    v_accvgpr_mov_b32 a11, a139
    v_accvgpr_mov_b32 a12, a140
    v_accvgpr_mov_b32 a13, a141
    v_accvgpr_mov_b32 a14, a142
    v_accvgpr_mov_b32 a15, a143
    v_accvgpr_mov_b32 a16, a144
    v_accvgpr_mov_b32 a17, a145
    v_accvgpr_mov_b32 a18, a146
    v_accvgpr_mov_b32 a19, a147
    v_accvgpr_mov_b32 a20, a148
    v_accvgpr_mov_b32 a21, a149
    v_accvgpr_mov_b32 a22, a150
    v_accvgpr_mov_b32 a23, a151
    v_accvgpr_mov_b32 a24, a152
    v_accvgpr_mov_b32 a25, a153
    v_accvgpr_mov_b32 a26, a154
    v_accvgpr_mov_b32 a27, a155
    v_accvgpr_mov_b32 a28, a156
    v_accvgpr_mov_b32 a29, a157
    v_accvgpr_mov_b32 a30, a158
    v_accvgpr_mov_b32 a31, a159
    v_accvgpr_mov_b32 a32, a160
    v_accvgpr_mov_b32 a33, a161
    v_accvgpr_mov_b32 a34, a162
    v_accvgpr_mov_b32 a35, a163
    v_accvgpr_mov_b32 a36, a164
    v_accvgpr_mov_b32 a37, a165
    v_accvgpr_mov_b32 a38, a166
    v_accvgpr_mov_b32 a39, a167
    v_accvgpr_mov_b32 a40, a168
    v_accvgpr_mov_b32 a41, a169
    v_accvgpr_mov_b32 a42, a170
    v_accvgpr_mov_b32 a43, a171
    v_accvgpr_mov_b32 a44, a172
    v_accvgpr_mov_b32 a45, a173
    v_accvgpr_mov_b32 a46, a174
    v_accvgpr_mov_b32 a47, a175
    v_accvgpr_mov_b32 a48, a176
    v_accvgpr_mov_b32 a49, a177
    v_accvgpr_mov_b32 a50, a178
    v_accvgpr_mov_b32 a51, a179
    v_accvgpr_mov_b32 a52, a180
    v_accvgpr_mov_b32 a53, a181
    v_accvgpr_mov_b32 a54, a182
    v_accvgpr_mov_b32 a55, a183
    v_accvgpr_mov_b32 a56, a184
    v_accvgpr_mov_b32 a57, a185
    v_accvgpr_mov_b32 a58, a186
    v_accvgpr_mov_b32 a59, a187
    v_accvgpr_mov_b32 a60, a188
    v_accvgpr_mov_b32 a61, a189
    v_accvgpr_mov_b32 a62, a190
    v_accvgpr_mov_b32 a63, a191
    v_mov_b64 v[96:97], 0
    v_mov_b64 v[98:99], 0
    v_mov_b64 v[100:101], 0
    v_mov_b64 v[102:103], 0
    v_mov_b64 v[104:105], 0
    v_mov_b64 v[106:107], 0
    v_mov_b64 v[108:109], 0
    v_mov_b64 v[110:111], 0
    v_mov_b64 v[112:113], 0
    v_mov_b64 v[114:115], 0
    v_mov_b64 v[116:117], 0
    v_mov_b64 v[118:119], 0
    v_mov_b64 v[120:121], 0
    v_mov_b64 v[122:123], 0
    v_mov_b64 v[124:125], 0
    v_mov_b64 v[126:127], 0
    s_add_u32 s43, s49, 16777216
    s_mov_b32 s44, s38
    s_mov_b32 s45, 0
    s_mov_b32 s47, -1.0
    s_branch L_loop
L_switched:
    v_mov_b32 v13, v7
    s_nop 1
    v_permlane32_swap_b32 v7, v13
    s_nop 1
    v_add_f32 v7, v7, v13
    v_mov_b32 v13, v7
    s_nop 1
    v_permlane16_swap_b32 v7, v13
    s_nop 1
    v_add_f32 v7, v7, v13
    v_mov_b32 v13, v8
    s_nop 1
    v_permlane32_swap_b32 v8, v13
    s_nop 1
    v_add_f32 v8, v8, v13
    v_mov_b32 v13, v8
    s_nop 1
    v_permlane16_swap_b32 v8, v13
    s_nop 1
    v_add_f32 v8, v8, v13
    v_rcp_f32 v16, v7
    v_rcp_f32 v17, v8
    s_lshl_b32 s55, s51, 20
    s_lshl_b32 s57, s3, 17
    s_add_u32 s55, s55, s57
    s_lshl_b32 s57, s26, 13
    s_add_u32 s55, s55, s57
    s_add_u32 s55, s55, 50331648
    s_add_u32 s56, s55, 0x80000
    v_pk_mul_f32 v[128:129], v[128:129], v[16:17] op_sel:[0,0] op_sel_hi:[1,0]
    v_pk_mul_f32 v[130:131], v[130:131], v[16:17] op_sel:[0,0] op_sel_hi:[1,0]
    v_pk_mul_f32 v[132:133], v[132:133], v[16:17] op_sel:[0,0] op_sel_hi:[1,0]
    v_pk_mul_f32 v[134:135], v[134:135], v[16:17] op_sel:[0,0] op_sel_hi:[1,0]
    v_cvt_pk_bf16_f32 v128, v128, v129
    v_cvt_pk_bf16_f32 v129, v130, v131
    v_cvt_pk_bf16_f32 v130, v132, v133
    v_cvt_pk_bf16_f32 v131, v134, v135
    buffer_store_dwordx4 v[128:131], v1, s[12:15], s55 offen offset:0 sc1
    v_pk_mul_f32 v[136:137], v[136:137], v[16:17] op_sel:[0,0] op_sel_hi:[1,0]
    v_pk_mul_f32 v[138:139], v[138:139], v[16:17] op_sel:[0,0] op_sel_hi:[1,0]
    v_pk_mul_f32 v[140:141], v[140:141], v[16:17] op_sel:[0,0] op_sel_hi:[1,0]
    v_pk_mul_f32 v[142:143], v[142:143], v[16:17] op_sel:[0,0] op_sel_hi:[1,0]
    v_cvt_pk_bf16_f32 v136, v136, v137
    v_cvt_pk_bf16_f32 v137, v138, v139
    v_cvt_pk_bf16_f32 v138, v140, v141
    v_cvt_pk_bf16_f32 v139, v142, v143
    buffer_store_dwordx4 v[136:139], v1, s[12:15], s55 offen offset:1024 sc1
    v_pk_mul_f32 v[144:145], v[144:145], v[16:17] op_sel:[0,0] op_sel_hi:[1,0]
    v_pk_mul_f32 v[146:147], v[146:147], v[16:17] op_sel:[0,0] op_sel_hi:[1,0]
    v_pk_mul_f32 v[148:149], v[148:149], v[16:17] op_sel:[0,0] op_sel_hi:[1,0]
    v_pk_mul_f32 v[150:151], v[150:151], v[16:17] op_sel:[0,0] op_sel_hi:[1,0]
    v_cvt_pk_bf16_f32 v144, v144, v145
    v_cvt_pk_bf16_f32 v145, v146, v147
    v_cvt_pk_bf16_f32 v146, v148, v149
    v_cvt_pk_bf16_f32 v147, v150, v151
    buffer_store_dwordx4 v[144:147], v1, s[12:15], s55 offen offset:2048 sc1
    v_pk_mul_f32 v[152:153], v[152:153], v[16:17] op_sel:[0,0] op_sel_hi:[1,0]
    v_pk_mul_f32 v[154:155], v[154:155], v[16:17] op_sel:[0,0] op_sel_hi:[1,0]
    v_pk_mul_f32 v[156:157], v[156:157], v[16:17] op_sel:[0,0] op_sel_hi:[1,0]
    v_pk_mul_f32 v[158:159], v[158:159], v[16:17] op_sel:[0,0] op_sel_hi:[1,0]
    v_cvt_pk_bf16_f32 v152, v152, v153
    v_cvt_pk_bf16_f32 v153, v154, v155
    v_cvt_pk_bf16_f32 v154, v156, v157
    v_cvt_pk_bf16_f32 v155, v158, v159
    buffer_store_dwordx4 v[152:155], v1, s[12:15], s55 offen offset:3072 sc1
    v_pk_mul_f32 v[160:161], v[160:161], v[16:17] op_sel:[0,0] op_sel_hi:[1,0]
    v_pk_mul_f32 v[162:163], v[162:163], v[16:17] op_sel:[0,0] op_sel_hi:[1,0]
    v_pk_mul_f32 v[164:165], v[164:165], v[16:17] op_sel:[0,0] op_sel_hi:[1,0]
    v_pk_mul_f32 v[166:167], v[166:167], v[16:17] op_sel:[0,0] op_sel_hi:[1,0]
    v_cvt_pk_bf16_f32 v160, v160, v161
    v_cvt_pk_bf16_f32 v161, v162, v163
    v_cvt_pk_bf16_f32 v162, v164, v165
    v_cvt_pk_bf16_f32 v163, v166, v167
    buffer_store_dwordx4 v[160:163], v4, s[12:15], s55 offen offset:0 sc1
    v_pk_mul_f32 v[168:169], v[168:169], v[16:17] op_sel:[0,0] op_sel_hi:[1,0]
    v_pk_mul_f32 v[170:171], v[170:171], v[16:17] op_sel:[0,0] op_sel_hi:[1,0]
    v_pk_mul_f32 v[172:173], v[172:173], v[16:17] op_sel:[0,0] op_sel_hi:[1,0]
    v_pk_mul_f32 v[174:175], v[174:175], v[16:17] op_sel:[0,0] op_sel_hi:[1,0]
    v_cvt_pk_bf16_f32 v168, v168, v169
    v_cvt_pk_bf16_f32 v169, v170, v171
    v_cvt_pk_bf16_f32 v170, v172, v173
    v_cvt_pk_bf16_f32 v171, v174, v175
    buffer_store_dwordx4 v[168:171], v4, s[12:15], s55 offen offset:1024 sc1
    v_pk_mul_f32 v[176:177], v[176:177], v[16:17] op_sel:[0,0] op_sel_hi:[1,0]
    v_pk_mul_f32 v[178:179], v[178:179], v[16:17] op_sel:[0,0] op_sel_hi:[1,0]
    v_pk_mul_f32 v[180:181], v[180:181], v[16:17] op_sel:[0,0] op_sel_hi:[1,0]
    v_pk_mul_f32 v[182:183], v[182:183], v[16:17] op_sel:[0,0] op_sel_hi:[1,0]
    v_cvt_pk_bf16_f32 v176, v176, v177
    v_cvt_pk_bf16_f32 v177, v178, v179
    v_cvt_pk_bf16_f32 v178, v180, v181
    v_cvt_pk_bf16_f32 v179, v182, v183
    buffer_store_dwordx4 v[176:179], v4, s[12:15], s55 offen offset:2048 sc1
    v_pk_mul_f32 v[184:185], v[184:185], v[16:17] op_sel:[0,0] op_sel_hi:[1,0]
    v_pk_mul_f32 v[186:187], v[186:187], v[16:17] op_sel:[0,0] op_sel_hi:[1,0]
    v_pk_mul_f32 v[188:189], v[188:189], v[16:17] op_sel:[0,0] op_sel_hi:[1,0]
    v_pk_mul_f32 v[190:191], v[190:191], v[16:17] op_sel:[0,0] op_sel_hi:[1,0]
    v_cvt_pk_bf16_f32 v184, v184, v185
    v_cvt_pk_bf16_f32 v185, v186, v187
    v_cvt_pk_bf16_f32 v186, v188, v189
    v_cvt_pk_bf16_f32 v187, v190, v191
    buffer_store_dwordx4 v[184:187], v4, s[12:15], s55 offen offset:3072 sc1
    v_pk_mul_f32 v[192:193], v[192:193], v[16:17] op_sel:[0,1] op_sel_hi:[1,1]
    v_pk_mul_f32 v[194:195], v[194:195], v[16:17] op_sel:[0,1] op_sel_hi:[1,1]
    v_pk_mul_f32 v[196:197], v[196:197], v[16:17] op_sel:[0,1] op_sel_hi:[1,1]
    v_pk_mul_f32 v[198:199], v[198:199], v[16:17] op_sel:[0,1] op_sel_hi:[1,1]
    v_cvt_pk_bf16_f32 v192, v192, v193
    v_cvt_pk_bf16_f32 v193, v194, v195
    v_cvt_pk_bf16_f32 v194, v196, v197
    v_cvt_pk_bf16_f32 v195, v198, v199
    buffer_store_dwordx4 v[192:195], v1, s[12:15], s56 offen offset:0 sc1
    v_pk_mul_f32 v[200:201], v[200:201], v[16:17] op_sel:[0,1] op_sel_hi:[1,1]
    v_pk_mul_f32 v[202:203], v[202:203], v[16:17] op_sel:[0,1] op_sel_hi:[1,1]
    v_pk_mul_f32 v[204:205], v[204:205], v[16:17] op_sel:[0,1] op_sel_hi:[1,1]
    v_pk_mul_f32 v[206:207], v[206:207], v[16:17] op_sel:[0,1] op_sel_hi:[1,1]
    v_cvt_pk_bf16_f32 v200, v200, v201
    v_cvt_pk_bf16_f32 v201, v202, v203
    v_cvt_pk_bf16_f32 v202, v204, v205
    v_cvt_pk_bf16_f32 v203, v206, v207
    buffer_store_dwordx4 v[200:203], v1, s[12:15], s56 offen offset:1024 sc1
    v_pk_mul_f32 v[208:209], v[208:209], v[16:17] op_sel:[0,1] op_sel_hi:[1,1]
    v_pk_mul_f32 v[210:211], v[210:211], v[16:17] op_sel:[0,1] op_sel_hi:[1,1]
    v_pk_mul_f32 v[212:213], v[212:213], v[16:17] op_sel:[0,1] op_sel_hi:[1,1]
    v_pk_mul_f32 v[214:215], v[214:215], v[16:17] op_sel:[0,1] op_sel_hi:[1,1]
    v_cvt_pk_bf16_f32 v208, v208, v209
    v_cvt_pk_bf16_f32 v209, v210, v211
    v_cvt_pk_bf16_f32 v210, v212, v213
    v_cvt_pk_bf16_f32 v211, v214, v215
    buffer_store_dwordx4 v[208:211], v1, s[12:15], s56 offen offset:2048 sc1
    v_pk_mul_f32 v[216:217], v[216:217], v[16:17] op_sel:[0,1] op_sel_hi:[1,1]
    v_pk_mul_f32 v[218:219], v[218:219], v[16:17] op_sel:[0,1] op_sel_hi:[1,1]
    v_pk_mul_f32 v[220:221], v[220:221], v[16:17] op_sel:[0,1] op_sel_hi:[1,1]
    v_pk_mul_f32 v[222:223], v[222:223], v[16:17] op_sel:[0,1] op_sel_hi:[1,1]
    v_cvt_pk_bf16_f32 v216, v216, v217
    v_cvt_pk_bf16_f32 v217, v218, v219
    v_cvt_pk_bf16_f32 v218, v220, v221
    v_cvt_pk_bf16_f32 v219, v222, v223
    buffer_store_dwordx4 v[216:219], v1, s[12:15], s56 offen offset:3072 sc1
    v_pk_mul_f32 v[224:225], v[224:225], v[16:17] op_sel:[0,1] op_sel_hi:[1,1]
    v_pk_mul_f32 v[226:227], v[226:227], v[16:17] op_sel:[0,1] op_sel_hi:[1,1]
    v_pk_mul_f32 v[228:229], v[228:229], v[16:17] op_sel:[0,1] op_sel_hi:[1,1]
    v_pk_mul_f32 v[230:231], v[230:231], v[16:17] op_sel:[0,1] op_sel_hi:[1,1]
    v_cvt_pk_bf16_f32 v224, v224, v225
    v_cvt_pk_bf16_f32 v225, v226, v227
    v_cvt_pk_bf16_f32 v226, v228, v229
    v_cvt_pk_bf16_f32 v227, v230, v231
    buffer_store_dwordx4 v[224:227], v4, s[12:15], s56 offen offset:0 sc1
    v_pk_mul_f32 v[232:233], v[232:233], v[16:17] op_sel:[0,1] op_sel_hi:[1,1]
    v_pk_mul_f32 v[234:235], v[234:235], v[16:17] op_sel:[0,1] op_sel_hi:[1,1]
    v_pk_mul_f32 v[236:237], v[236:237], v[16:17] op_sel:[0,1] op_sel_hi:[1,1]
    v_pk_mul_f32 v[238:239], v[238:239], v[16:17] op_sel:[0,1] op_sel_hi:[1,1]
    v_cvt_pk_bf16_f32 v232, v232, v233
    v_cvt_pk_bf16_f32 v233, v234, v235
    v_cvt_pk_bf16_f32 v234, v236, v237
    v_cvt_pk_bf16_f32 v235, v238, v239
    buffer_store_dwordx4 v[232:235], v4, s[12:15], s56 offen offset:1024 sc1
    v_pk_mul_f32 v[240:241], v[240:241], v[16:17] op_sel:[0,1] op_sel_hi:[1,1]
    v_pk_mul_f32 v[242:243], v[242:243], v[16:17] op_sel:[0,1] op_sel_hi:[1,1]
    v_pk_mul_f32 v[244:245], v[244:245], v[16:17] op_sel:[0,1] op_sel_hi:[1,1]
    v_pk_mul_f32 v[246:247], v[246:247], v[16:17] op_sel:[0,1] op_sel_hi:[1,1]
    v_cvt_pk_bf16_f32 v240, v240, v241
    v_cvt_pk_bf16_f32 v241, v242, v243
    v_cvt_pk_bf16_f32 v242, v244, v245
    v_cvt_pk_bf16_f32 v243, v246, v247
    buffer_store_dwordx4 v[240:243], v4, s[12:15], s56 offen offset:2048 sc1
    v_pk_mul_f32 v[248:249], v[248:249], v[16:17] op_sel:[0,1] op_sel_hi:[1,1]
    v_pk_mul_f32 v[250:251], v[250:251], v[16:17] op_sel:[0,1] op_sel_hi:[1,1]
    v_pk_mul_f32 v[252:253], v[252:253], v[16:17] op_sel:[0,1] op_sel_hi:[1,1]
    v_pk_mul_f32 v[254:255], v[254:255], v[16:17] op_sel:[0,1] op_sel_hi:[1,1]
    v_cvt_pk_bf16_f32 v248, v248, v249
    v_cvt_pk_bf16_f32 v249, v250, v251
    v_cvt_pk_bf16_f32 v250, v252, v253
    v_cvt_pk_bf16_f32 v251, v254, v255
    buffer_store_dwordx4 v[248:251], v4, s[12:15], s56 offen offset:3072 sc1
    s_nop 0
    v_mov_b64 v[128:129], 0
    v_mov_b64 v[130:131], 0
    v_mov_b64 v[132:133], 0
    v_mov_b64 v[134:135], 0
    v_mov_b64 v[136:137], 0
    v_mov_b64 v[138:139], 0
    v_mov_b64 v[140:141], 0
    v_mov_b64 v[142:143], 0
    v_mov_b64 v[144:145], 0
    v_mov_b64 v[146:147], 0
    v_mov_b64 v[148:149], 0
    v_mov_b64 v[150:151], 0
    v_mov_b64 v[152:153], 0
    v_mov_b64 v[154:155], 0
    v_mov_b64 v[156:157], 0
    v_mov_b64 v[158:159], 0
    v_mov_b64 v[160:161], 0
    v_mov_b64 v[162:163], 0
    v_mov_b64 v[164:165], 0
    v_mov_b64 v[166:167], 0
    v_mov_b64 v[168:169], 0
    v_mov_b64 v[170:171], 0
    v_mov_b64 v[172:173], 0
    v_mov_b64 v[174:175], 0
    v_mov_b64 v[176:177], 0
    v_mov_b64 v[178:179], 0
    v_mov_b64 v[180:181], 0
    v_mov_b64 v[182:183], 0
    v_mov_b64 v[184:185], 0
    v_mov_b64 v[186:187], 0
    v_mov_b64 v[188:189], 0
    v_mov_b64 v[190:191], 0
    v_mov_b64 v[192:193], 0
    v_mov_b64 v[194:195], 0
    v_mov_b64 v[196:197], 0
    v_mov_b64 v[198:199], 0
    v_mov_b64 v[200:201], 0
    v_mov_b64 v[202:203], 0
    v_mov_b64 v[204:205], 0
    v_mov_b64 v[206:207], 0
    v_mov_b64 v[208:209], 0
    v_mov_b64 v[210:211], 0
    v_mov_b64 v[212:213], 0
    v_mov_b64 v[214:215], 0
    v_mov_b64 v[216:217], 0
    v_mov_b64 v[218:219], 0
    v_mov_b64 v[220:221], 0
    v_mov_b64 v[222:223], 0
    v_mov_b64 v[224:225], 0
    v_mov_b64 v[226:227], 0
    v_mov_b64 v[228:229], 0
    v_mov_b64 v[230:231], 0
    v_mov_b64 v[232:233], 0
    v_mov_b64 v[234:235], 0
    v_mov_b64 v[236:237], 0
    v_mov_b64 v[238:239], 0
    v_mov_b64 v[240:241], 0
    v_mov_b64 v[242:243], 0
    v_mov_b64 v[244:245], 0
    v_mov_b64 v[246:247], 0
    v_mov_b64 v[248:249], 0
    v_mov_b64 v[250:251], 0
    v_mov_b64 v[252:253], 0
    v_mov_b64 v[254:255], 0
    v_mov_b32 v7, 0
    v_mov_b32 v8, 0
    v_mov_b32 v9, 0
    v_mov_b32 v10, 0
    s_mov_b32 s47, 0x4b800000
    s_mov_b32 s54, 1
    s_waitcnt vmcnt(0)
    s_barrier
    s_cmp_lg_u32 s3, 0
    s_cbranch_scc1 L_pub4
    v_mov_b32 v11, 0
    v_mov_b32 v12, 1
    s_mov_b64 exec, 1
    buffer_store_dword v12, v11, s[12:15], s93 offen sc1
    s_mov_b64 exec, -1
L_pub4:
    s_branch L_first
L_tail:
    s_waitcnt vmcnt(0) lgkmcnt(0)
    s_barrier
    ds_read_b128 a[64:67], v3 offset:0
    ds_read_b128 a[68:71], v3 offset:16384
    ds_read_b128 a[72:75], v3 offset:1024
    ds_read_b128 a[76:79], v3 offset:17408
    ds_read_b128 a[80:83], v3 offset:2048
    ds_read_b128 a[84:87], v3 offset:18432
    ds_read_b128 a[88:91], v3 offset:3072
    ds_read_b128 a[92:95], v3 offset:19456
    v_cvt_pk_bf16_f32 v16, v64, v65
    v_cvt_pk_bf16_f32 v17, v66, v67
    v_cvt_pk_bf16_f32 v20, v68, v69
    v_cvt_pk_bf16_f32 v21, v70, v71
    v_cvt_pk_bf16_f32 v18, v72, v73
    v_cvt_pk_bf16_f32 v19, v74, v75
    v_cvt_pk_bf16_f32 v22, v76, v77
    v_cvt_pk_bf16_f32 v23, v78, v79
    v_cvt_pk_bf16_f32 v24, v80, v81
    v_cvt_pk_bf16_f32 v25, v82, v83
    v_cvt_pk_bf16_f32 v28, v84, v85
    v_cvt_pk_bf16_f32 v29, v86, v87
    v_cvt_pk_bf16_f32 v26, v88, v89
    v_cvt_pk_bf16_f32 v27, v90, v91
    v_cvt_pk_bf16_f32 v30, v92, v93
    v_cvt_pk_bf16_f32 v31, v94, v95
    v_add_f32 v7, v7, v5
    v_add_f32 v8, v8, v6
    s_waitcnt lgkmcnt(0)
    v_mfma_f32_16x16x32_bf16 v[128:131], a[64:67], v[16:19], v[128:131]
    ds_read_b128 a[96:99], v3 offset:4096
    v_mfma_f32_16x16x32_bf16 v[128:131], a[68:71], v[24:27], v[128:131]
    v_mfma_f32_16x16x32_bf16 v[192:195], a[68:71], v[28:31], v[192:195]
    ds_read_b128 a[100:103], v3 offset:20480
    v_mfma_f32_16x16x32_bf16 v[192:195], a[64:67], v[20:23], v[192:195]
    v_mfma_f32_16x16x32_bf16 v[132:135], a[72:75], v[16:19], v[132:135]
    ds_read_b128 a[104:107], v3 offset:5120
    v_mfma_f32_16x16x32_bf16 v[132:135], a[76:79], v[24:27], v[132:135]
    v_mfma_f32_16x16x32_bf16 v[196:199], a[76:79], v[28:31], v[196:199]
    ds_read_b128 a[108:111], v3 offset:21504
    v_mfma_f32_16x16x32_bf16 v[196:199], a[72:75], v[20:23], v[196:199]
    v_mfma_f32_16x16x32_bf16 v[136:139], a[80:83], v[16:19], v[136:139]
    ds_read_b128 a[112:115], v3 offset:6144
    v_mfma_f32_16x16x32_bf16 v[136:139], a[84:87], v[24:27], v[136:139]
    v_mfma_f32_16x16x32_bf16 v[200:203], a[84:87], v[28:31], v[200:203]
    ds_read_b128 a[116:119], v3 offset:22528
    v_mfma_f32_16x16x32_bf16 v[200:203], a[80:83], v[20:23], v[200:203]
    v_mfma_f32_16x16x32_bf16 v[140:143], a[88:91], v[16:19], v[140:143]
    ds_read_b128 a[120:123], v3 offset:7168
    v_mfma_f32_16x16x32_bf16 v[140:143], a[92:95], v[24:27], v[140:143]
    v_mfma_f32_16x16x32_bf16 v[204:207], a[92:95], v[28:31], v[204:207]
    ds_read_b128 a[124:127], v3 offset:23552
    v_mfma_f32_16x16x32_bf16 v[204:207], a[88:91], v[20:23], v[204:207]
    s_waitcnt lgkmcnt(6)
    v_mfma_f32_16x16x32_bf16 v[144:147], a[96:99], v[16:19], v[144:147]
    ds_read_b128 a[64:67], v3 offset:8192
    v_mfma_f32_16x16x32_bf16 v[144:147], a[100:103], v[24:27], v[144:147]
    v_mfma_f32_16x16x32_bf16 v[208:211], a[100:103], v[28:31], v[208:211]
    ds_read_b128 a[68:71], v3 offset:24576
    v_mfma_f32_16x16x32_bf16 v[208:211], a[96:99], v[20:23], v[208:211]
    s_waitcnt lgkmcnt(6)
    v_mfma_f32_16x16x32_bf16 v[148:151], a[104:107], v[16:19], v[148:151]
    ds_read_b128 a[72:75], v3 offset:9216
    v_mfma_f32_16x16x32_bf16 v[148:151], a[108:111], v[24:27], v[148:151]
    v_mfma_f32_16x16x32_bf16 v[212:215], a[108:111], v[28:31], v[212:215]
    ds_read_b128 a[76:79], v3 offset:25600
    v_mfma_f32_16x16x32_bf16 v[212:215], a[104:107], v[20:23], v[212:215]
    s_waitcnt lgkmcnt(6)
    v_mfma_f32_16x16x32_bf16 v[152:155], a[112:115], v[16:19], v[152:155]
    ds_read_b128 a[80:83], v3 offset:10240
    v_mfma_f32_16x16x32_bf16 v[152:155], a[116:119], v[24:27], v[152:155]
    v_mfma_f32_16x16x32_bf16 v[216:219], a[116:119], v[28:31], v[216:219]
    ds_read_b128 a[84:87], v3 offset:26624
    v_mfma_f32_16x16x32_bf16 v[216:219], a[112:115], v[20:23], v[216:219]
    s_waitcnt lgkmcnt(6)
    v_mfma_f32_16x16x32_bf16 v[156:159], a[120:123], v[16:19], v[156:159]
    ds_read_b128 a[88:91], v3 offset:11264
    v_mfma_f32_16x16x32_bf16 v[156:159], a[124:127], v[24:27], v[156:159]
    v_mfma_f32_16x16x32_bf16 v[220:223], a[124:127], v[28:31], v[220:223]
    ds_read_b128 a[92:95], v3 offset:27648
    v_mfma_f32_16x16x32_bf16 v[220:223], a[120:123], v[20:23], v[220:223]
    s_waitcnt lgkmcnt(6)
    v_mfma_f32_16x16x32_bf16 v[160:163], a[64:67], v[16:19], v[160:163]
    ds_read_b128 a[96:99], v3 offset:12288
    v_mfma_f32_16x16x32_bf16 v[160:163], a[68:71], v[24:27], v[160:163]
    v_mfma_f32_16x16x32_bf16 v[224:227], a[68:71], v[28:31], v[224:227]
    ds_read_b128 a[100:103], v3 offset:28672
    v_mfma_f32_16x16x32_bf16 v[224:227], a[64:67], v[20:23], v[224:227]
    s_waitcnt lgkmcnt(6)
    v_mfma_f32_16x16x32_bf16 v[164:167], a[72:75], v[16:19], v[164:167]
    ds_read_b128 a[104:107], v3 offset:13312
    v_mfma_f32_16x16x32_bf16 v[164:167], a[76:79], v[24:27], v[164:167]
    v_mfma_f32_16x16x32_bf16 v[228:231], a[76:79], v[28:31], v[228:231]
    ds_read_b128 a[108:111], v3 offset:29696
    v_mfma_f32_16x16x32_bf16 v[228:231], a[72:75], v[20:23], v[228:231]
    s_waitcnt lgkmcnt(6)
    v_mfma_f32_16x16x32_bf16 v[168:171], a[80:83], v[16:19], v[168:171]
    ds_read_b128 a[112:115], v3 offset:14336
    v_mfma_f32_16x16x32_bf16 v[168:171], a[84:87], v[24:27], v[168:171]
    v_mfma_f32_16x16x32_bf16 v[232:235], a[84:87], v[28:31], v[232:235]
    ds_read_b128 a[116:119], v3 offset:30720
    v_mfma_f32_16x16x32_bf16 v[232:235], a[80:83], v[20:23], v[232:235]
    s_waitcnt lgkmcnt(6)
    v_mfma_f32_16x16x32_bf16 v[172:175], a[88:91], v[16:19], v[172:175]
    ds_read_b128 a[120:123], v3 offset:15360
    v_mfma_f32_16x16x32_bf16 v[172:175], a[92:95], v[24:27], v[172:175]
    v_mfma_f32_16x16x32_bf16 v[236:239], a[92:95], v[28:31], v[236:239]
    ds_read_b128 a[124:127], v3 offset:31744
    v_mfma_f32_16x16x32_bf16 v[236:239], a[88:91], v[20:23], v[236:239]
    s_waitcnt lgkmcnt(6)
    v_mfma_f32_16x16x32_bf16 v[176:179], a[96:99], v[16:19], v[176:179]
    v_mfma_f32_16x16x32_bf16 v[176:179], a[100:103], v[24:27], v[176:179]
    v_mfma_f32_16x16x32_bf16 v[240:243], a[100:103], v[28:31], v[240:243]
    v_mfma_f32_16x16x32_bf16 v[240:243], a[96:99], v[20:23], v[240:243]
    s_waitcnt lgkmcnt(4)
    v_mfma_f32_16x16x32_bf16 v[180:183], a[104:107], v[16:19], v[180:183]
    v_mfma_f32_16x16x32_bf16 v[180:183], a[108:111], v[24:27], v[180:183]
    v_mfma_f32_16x16x32_bf16 v[244:247], a[108:111], v[28:31], v[244:247]
    v_mfma_f32_16x16x32_bf16 v[244:247], a[104:107], v[20:23], v[244:247]
    s_waitcnt lgkmcnt(2)
    v_mfma_f32_16x16x32_bf16 v[184:187], a[112:115], v[16:19], v[184:187]
    v_mfma_f32_16x16x32_bf16 v[184:187], a[116:119], v[24:27], v[184:187]
    v_mfma_f32_16x16x32_bf16 v[248:251], a[116:119], v[28:31], v[248:251]
    v_mfma_f32_16x16x32_bf16 v[248:251], a[112:115], v[20:23], v[248:251]
    s_waitcnt lgkmcnt(0)
    v_mfma_f32_16x16x32_bf16 v[188:191], a[120:123], v[16:19], v[188:191]
    v_mfma_f32_16x16x32_bf16 v[188:191], a[124:127], v[24:27], v[188:191]
    v_mfma_f32_16x16x32_bf16 v[252:255], a[124:127], v[28:31], v[252:255]
    v_mfma_f32_16x16x32_bf16 v[252:255], a[120:123], v[20:23], v[252:255]
    v_mov_b32 v13, v7
    s_nop 1
    v_permlane32_swap_b32 v7, v13
    s_nop 1
    v_add_f32 v7, v7, v13
    v_mov_b32 v13, v7
    s_nop 1
    v_permlane16_swap_b32 v7, v13
    s_nop 1
    v_add_f32 v7, v7, v13
    v_mov_b32 v13, v8
    s_nop 1
    v_permlane32_swap_b32 v8, v13
    s_nop 1
    v_add_f32 v8, v8, v13
    v_mov_b32 v13, v8
    s_nop 1
    v_permlane16_swap_b32 v8, v13
    s_nop 1
    v_add_f32 v8, v8, v13
    v_log_f32 v5, v7
    v_rcp_f32 v16, v7
    v_log_f32 v6, v8
    v_rcp_f32 v17, v8
    v_sub_f32 v5, v5, v9
    v_sub_f32 v6, v6, v10
    s_cmp_eq_u32 s38, 0
    s_cbranch_scc1 L_store
    s_and_b32 s39, s2, 127
    s_lshl_b32 s55, s39, 16
    s_lshl_b32 s57, s3, 14
    s_add_u32 s55, s55, s57
    s_add_u32 s55, s55, 67108864
    s_add_u32 s56, s55, 0x2000
    s_lshl_b32 s57, s39, 2
    s_add_u32 s57, s57, s3
    s_lshl_b32 s57, s57, 9
    s_add_u32 s57, s57, 83886080
    v_lshrrev_b32 v15, 2, v1
    s_cmp_eq_u32 s54, 2
    s_cbranch_scc1 L_merge
    buffer_store_dword v5, v15, s[12:15], s57 offen offset:0
    buffer_store_dword v6, v15, s[12:15], s57 offen offset:256
    v_pk_mul_f32 v[128:129], v[128:129], v[16:17] op_sel:[0,0] op_sel_hi:[1,0]
    v_pk_mul_f32 v[130:131], v[130:131], v[16:17] op_sel:[0,0] op_sel_hi:[1,0]
    v_pk_mul_f32 v[132:133], v[132:133], v[16:17] op_sel:[0,0] op_sel_hi:[1,0]
    v_pk_mul_f32 v[134:135], v[134:135], v[16:17] op_sel:[0,0] op_sel_hi:[1,0]
    v_cvt_pk_bf16_f32 v128, v128, v129
    v_cvt_pk_bf16_f32 v129, v130, v131
    v_cvt_pk_bf16_f32 v130, v132, v133
    v_cvt_pk_bf16_f32 v131, v134, v135
    buffer_store_dwordx4 v[128:131], v1, s[12:15], s55 offen offset:0
    v_pk_mul_f32 v[136:137], v[136:137], v[16:17] op_sel:[0,0] op_sel_hi:[1,0]
    v_pk_mul_f32 v[138:139], v[138:139], v[16:17] op_sel:[0,0] op_sel_hi:[1,0]
    v_pk_mul_f32 v[140:141], v[140:141], v[16:17] op_sel:[0,0] op_sel_hi:[1,0]
    v_pk_mul_f32 v[142:143], v[142:143], v[16:17] op_sel:[0,0] op_sel_hi:[1,0]
    v_cvt_pk_bf16_f32 v136, v136, v137
    v_cvt_pk_bf16_f32 v137, v138, v139
    v_cvt_pk_bf16_f32 v138, v140, v141
    v_cvt_pk_bf16_f32 v139, v142, v143
    buffer_store_dwordx4 v[136:139], v1, s[12:15], s55 offen offset:1024
    v_pk_mul_f32 v[144:145], v[144:145], v[16:17] op_sel:[0,0] op_sel_hi:[1,0]
    v_pk_mul_f32 v[146:147], v[146:147], v[16:17] op_sel:[0,0] op_sel_hi:[1,0]
    v_pk_mul_f32 v[148:149], v[148:149], v[16:17] op_sel:[0,0] op_sel_hi:[1,0]
    v_pk_mul_f32 v[150:151], v[150:151], v[16:17] op_sel:[0,0] op_sel_hi:[1,0]
    v_cvt_pk_bf16_f32 v144, v144, v145
    v_cvt_pk_bf16_f32 v145, v146, v147
    v_cvt_pk_bf16_f32 v146, v148, v149
    v_cvt_pk_bf16_f32 v147, v150, v151
    buffer_store_dwordx4 v[144:147], v1, s[12:15], s55 offen offset:2048
    v_pk_mul_f32 v[152:153], v[152:153], v[16:17] op_sel:[0,0] op_sel_hi:[1,0]
    v_pk_mul_f32 v[154:155], v[154:155], v[16:17] op_sel:[0,0] op_sel_hi:[1,0]
    v_pk_mul_f32 v[156:157], v[156:157], v[16:17] op_sel:[0,0] op_sel_hi:[1,0]
    v_pk_mul_f32 v[158:159], v[158:159], v[16:17] op_sel:[0,0] op_sel_hi:[1,0]
    v_cvt_pk_bf16_f32 v152, v152, v153
    v_cvt_pk_bf16_f32 v153, v154, v155
    v_cvt_pk_bf16_f32 v154, v156, v157
    v_cvt_pk_bf16_f32 v155, v158, v159
    buffer_store_dwordx4 v[152:155], v1, s[12:15], s55 offen offset:3072
    v_pk_mul_f32 v[160:161], v[160:161], v[16:17] op_sel:[0,0] op_sel_hi:[1,0]
    v_pk_mul_f32 v[162:163], v[162:163], v[16:17] op_sel:[0,0] op_sel_hi:[1,0]
    v_pk_mul_f32 v[164:165], v[164:165], v[16:17] op_sel:[0,0] op_sel_hi:[1,0]
    v_pk_mul_f32 v[166:167], v[166:167], v[16:17] op_sel:[0,0] op_sel_hi:[1,0]
    v_cvt_pk_bf16_f32 v160, v160, v161
    v_cvt_pk_bf16_f32 v161, v162, v163
    v_cvt_pk_bf16_f32 v162, v164, v165
    v_cvt_pk_bf16_f32 v163, v166, v167
    buffer_store_dwordx4 v[160:163], v4, s[12:15], s55 offen offset:0
    v_pk_mul_f32 v[168:169], v[168:169], v[16:17] op_sel:[0,0] op_sel_hi:[1,0]
    v_pk_mul_f32 v[170:171], v[170:171], v[16:17] op_sel:[0,0] op_sel_hi:[1,0]
    v_pk_mul_f32 v[172:173], v[172:173], v[16:17] op_sel:[0,0] op_sel_hi:[1,0]
    v_pk_mul_f32 v[174:175], v[174:175], v[16:17] op_sel:[0,0] op_sel_hi:[1,0]
    v_cvt_pk_bf16_f32 v168, v168, v169
    v_cvt_pk_bf16_f32 v169, v170, v171
    v_cvt_pk_bf16_f32 v170, v172, v173
    v_cvt_pk_bf16_f32 v171, v174, v175
    buffer_store_dwordx4 v[168:171], v4, s[12:15], s55 offen offset:1024
    v_pk_mul_f32 v[176:177], v[176:177], v[16:17] op_sel:[0,0] op_sel_hi:[1,0]
    v_pk_mul_f32 v[178:179], v[178:179], v[16:17] op_sel:[0,0] op_sel_hi:[1,0]
    v_pk_mul_f32 v[180:181], v[180:181], v[16:17] op_sel:[0,0] op_sel_hi:[1,0]
    v_pk_mul_f32 v[182:183], v[182:183], v[16:17] op_sel:[0,0] op_sel_hi:[1,0]
    v_cvt_pk_bf16_f32 v176, v176, v177
    v_cvt_pk_bf16_f32 v177, v178, v179
    v_cvt_pk_bf16_f32 v178, v180, v181
    v_cvt_pk_bf16_f32 v179, v182, v183
    buffer_store_dwordx4 v[176:179], v4, s[12:15], s55 offen offset:2048
    v_pk_mul_f32 v[184:185], v[184:185], v[16:17] op_sel:[0,0] op_sel_hi:[1,0]
    v_pk_mul_f32 v[186:187], v[186:187], v[16:17] op_sel:[0,0] op_sel_hi:[1,0]
    v_pk_mul_f32 v[188:189], v[188:189], v[16:17] op_sel:[0,0] op_sel_hi:[1,0]
    v_pk_mul_f32 v[190:191], v[190:191], v[16:17] op_sel:[0,0] op_sel_hi:[1,0]
    v_cvt_pk_bf16_f32 v184, v184, v185
    v_cvt_pk_bf16_f32 v185, v186, v187
    v_cvt_pk_bf16_f32 v186, v188, v189
    v_cvt_pk_bf16_f32 v187, v190, v191
    buffer_store_dwordx4 v[184:187], v4, s[12:15], s55 offen offset:3072
    v_pk_mul_f32 v[192:193], v[192:193], v[16:17] op_sel:[0,1] op_sel_hi:[1,1]
    v_pk_mul_f32 v[194:195], v[194:195], v[16:17] op_sel:[0,1] op_sel_hi:[1,1]
    v_pk_mul_f32 v[196:197], v[196:197], v[16:17] op_sel:[0,1] op_sel_hi:[1,1]
    v_pk_mul_f32 v[198:199], v[198:199], v[16:17] op_sel:[0,1] op_sel_hi:[1,1]
    v_cvt_pk_bf16_f32 v192, v192, v193
    v_cvt_pk_bf16_f32 v193, v194, v195
    v_cvt_pk_bf16_f32 v194, v196, v197
    v_cvt_pk_bf16_f32 v195, v198, v199
    buffer_store_dwordx4 v[192:195], v1, s[12:15], s56 offen offset:0
    v_pk_mul_f32 v[200:201], v[200:201], v[16:17] op_sel:[0,1] op_sel_hi:[1,1]
    v_pk_mul_f32 v[202:203], v[202:203], v[16:17] op_sel:[0,1] op_sel_hi:[1,1]
    v_pk_mul_f32 v[204:205], v[204:205], v[16:17] op_sel:[0,1] op_sel_hi:[1,1]
    v_pk_mul_f32 v[206:207], v[206:207], v[16:17] op_sel:[0,1] op_sel_hi:[1,1]
    v_cvt_pk_bf16_f32 v200, v200, v201
    v_cvt_pk_bf16_f32 v201, v202, v203
    v_cvt_pk_bf16_f32 v202, v204, v205
    v_cvt_pk_bf16_f32 v203, v206, v207
    buffer_store_dwordx4 v[200:203], v1, s[12:15], s56 offen offset:1024
    v_pk_mul_f32 v[208:209], v[208:209], v[16:17] op_sel:[0,1] op_sel_hi:[1,1]
    v_pk_mul_f32 v[210:211], v[210:211], v[16:17] op_sel:[0,1] op_sel_hi:[1,1]
    v_pk_mul_f32 v[212:213], v[212:213], v[16:17] op_sel:[0,1] op_sel_hi:[1,1]
    v_pk_mul_f32 v[214:215], v[214:215], v[16:17] op_sel:[0,1] op_sel_hi:[1,1]
    v_cvt_pk_bf16_f32 v208, v208, v209
    v_cvt_pk_bf16_f32 v209, v210, v211
    v_cvt_pk_bf16_f32 v210, v212, v213
    v_cvt_pk_bf16_f32 v211, v214, v215
    buffer_store_dwordx4 v[208:211], v1, s[12:15], s56 offen offset:2048
    v_pk_mul_f32 v[216:217], v[216:217], v[16:17] op_sel:[0,1] op_sel_hi:[1,1]
    v_pk_mul_f32 v[218:219], v[218:219], v[16:17] op_sel:[0,1] op_sel_hi:[1,1]
    v_pk_mul_f32 v[220:221], v[220:221], v[16:17] op_sel:[0,1] op_sel_hi:[1,1]
    v_pk_mul_f32 v[222:223], v[222:223], v[16:17] op_sel:[0,1] op_sel_hi:[1,1]
    v_cvt_pk_bf16_f32 v216, v216, v217
    v_cvt_pk_bf16_f32 v217, v218, v219
    v_cvt_pk_bf16_f32 v218, v220, v221
    v_cvt_pk_bf16_f32 v219, v222, v223
    buffer_store_dwordx4 v[216:219], v1, s[12:15], s56 offen offset:3072
    v_pk_mul_f32 v[224:225], v[224:225], v[16:17] op_sel:[0,1] op_sel_hi:[1,1]
    v_pk_mul_f32 v[226:227], v[226:227], v[16:17] op_sel:[0,1] op_sel_hi:[1,1]
    v_pk_mul_f32 v[228:229], v[228:229], v[16:17] op_sel:[0,1] op_sel_hi:[1,1]
    v_pk_mul_f32 v[230:231], v[230:231], v[16:17] op_sel:[0,1] op_sel_hi:[1,1]
    v_cvt_pk_bf16_f32 v224, v224, v225
    v_cvt_pk_bf16_f32 v225, v226, v227
    v_cvt_pk_bf16_f32 v226, v228, v229
    v_cvt_pk_bf16_f32 v227, v230, v231
    buffer_store_dwordx4 v[224:227], v4, s[12:15], s56 offen offset:0
    v_pk_mul_f32 v[232:233], v[232:233], v[16:17] op_sel:[0,1] op_sel_hi:[1,1]
    v_pk_mul_f32 v[234:235], v[234:235], v[16:17] op_sel:[0,1] op_sel_hi:[1,1]
    v_pk_mul_f32 v[236:237], v[236:237], v[16:17] op_sel:[0,1] op_sel_hi:[1,1]
    v_pk_mul_f32 v[238:239], v[238:239], v[16:17] op_sel:[0,1] op_sel_hi:[1,1]
    v_cvt_pk_bf16_f32 v232, v232, v233
    v_cvt_pk_bf16_f32 v233, v234, v235
    v_cvt_pk_bf16_f32 v234, v236, v237
    v_cvt_pk_bf16_f32 v235, v238, v239
    buffer_store_dwordx4 v[232:235], v4, s[12:15], s56 offen offset:1024
    v_pk_mul_f32 v[240:241], v[240:241], v[16:17] op_sel:[0,1] op_sel_hi:[1,1]
    v_pk_mul_f32 v[242:243], v[242:243], v[16:17] op_sel:[0,1] op_sel_hi:[1,1]
    v_pk_mul_f32 v[244:245], v[244:245], v[16:17] op_sel:[0,1] op_sel_hi:[1,1]
    v_pk_mul_f32 v[246:247], v[246:247], v[16:17] op_sel:[0,1] op_sel_hi:[1,1]
    v_cvt_pk_bf16_f32 v240, v240, v241
    v_cvt_pk_bf16_f32 v241, v242, v243
    v_cvt_pk_bf16_f32 v242, v244, v245
    v_cvt_pk_bf16_f32 v243, v246, v247
    buffer_store_dwordx4 v[240:243], v4, s[12:15], s56 offen offset:2048
    v_pk_mul_f32 v[248:249], v[248:249], v[16:17] op_sel:[0,1] op_sel_hi:[1,1]
    v_pk_mul_f32 v[250:251], v[250:251], v[16:17] op_sel:[0,1] op_sel_hi:[1,1]
    v_pk_mul_f32 v[252:253], v[252:253], v[16:17] op_sel:[0,1] op_sel_hi:[1,1]
    v_pk_mul_f32 v[254:255], v[254:255], v[16:17] op_sel:[0,1] op_sel_hi:[1,1]
    v_cvt_pk_bf16_f32 v248, v248, v249
    v_cvt_pk_bf16_f32 v249, v250, v251
    v_cvt_pk_bf16_f32 v250, v252, v253
    v_cvt_pk_bf16_f32 v251, v254, v255
    buffer_store_dwordx4 v[248:251], v4, s[12:15], s56 offen offset:3072
    s_waitcnt vmcnt(0)
    s_barrier
    s_cmp_lg_u32 s3, 0
    s_cbranch_scc1 L_pub5
    s_cmp_lg_u32 s30, 0
    s_cbranch_scc1 L_pub5_x
    buffer_wbl2 sc1
    s_waitcnt vmcnt(0)
L_pub5_x:
    v_mov_b32 v11, 0
    v_mov_b32 v12, 1
    s_mov_b64 exec, 1
    buffer_store_dword v12, v11, s[12:15], s94 offen sc1
    s_mov_b64 exec, -1
L_pub5:
    s_branch L_attdone
L_merge:
    v_and_b32 v11, 0, v0
    v_lshlrev_b32 v11, 2, v11
    s_mov_b32 s100, 0
L_poll6:
    buffer_load_dword v12, v11, s[12:15], s94 offen sc1
    s_waitcnt vmcnt(0)
    v_cmp_ne_u32 vcc, 1, v12
    s_cbranch_vccz L_poll6_ok
    s_sleep 2
    s_add_u32 s100, s100, 1
    s_cmp_lt_u32 s100, 0x80000
    s_cbranch_scc1 L_poll6
L_poll6_ok:
    buffer_load_dword v18, v15, s[12:15], s57 offen offset:0 sc1
    buffer_load_dword v19, v15, s[12:15], s57 offen offset:256 sc1
    buffer_load_dwordx4 v[32:35], v1, s[12:15], s55 offen offset:0 sc1
    buffer_load_dwordx4 v[36:39], v1, s[12:15], s55 offen offset:1024 sc1
    buffer_load_dwordx4 v[40:43], v1, s[12:15], s55 offen offset:2048 sc1
    buffer_load_dwordx4 v[44:47], v1, s[12:15], s55 offen offset:3072 sc1
    buffer_load_dwordx4 v[48:51], v4, s[12:15], s55 offen offset:0 sc1
    buffer_load_dwordx4 v[52:55], v4, s[12:15], s55 offen offset:1024 sc1
    buffer_load_dwordx4 v[56:59], v4, s[12:15], s55 offen offset:2048 sc1
    buffer_load_dwordx4 v[60:63], v4, s[12:15], s55 offen offset:3072 sc1
    buffer_load_dwordx4 v[64:67], v1, s[12:15], s56 offen offset:0 sc1
    buffer_load_dwordx4 v[68:71], v1, s[12:15], s56 offen offset:1024 sc1
    buffer_load_dwordx4 v[72:75], v1, s[12:15], s56 offen offset:2048 sc1
    buffer_load_dwordx4 v[76:79], v1, s[12:15], s56 offen offset:3072 sc1
    buffer_load_dwordx4 v[80:83], v4, s[12:15], s56 offen offset:0 sc1
    buffer_load_dwordx4 v[84:87], v4, s[12:15], s56 offen offset:1024 sc1
    buffer_load_dwordx4 v[88:91], v4, s[12:15], s56 offen offset:2048 sc1
    buffer_load_dwordx4 v[92:95], v4, s[12:15], s56 offen offset:3072 sc1
    s_waitcnt vmcnt(16)
    v_max_f32 v20, v18, v5
    v_sub_f32 v21, v5, v20
    v_sub_f32 v22, v18, v20
    v_exp_f32 v21, v21
    v_exp_f32 v22, v22
    s_nop 0
    v_add_f32 v20, v21, v22
    v_rcp_f32 v20, v20
    s_nop 0
    v_mul_f32 v21, v21, v20
    v_mul_f32 v18, v22, v20
    v_mul_f32 v16, v16, v21
    v_max_f32 v20, v19, v6
    v_sub_f32 v21, v6, v20
    v_sub_f32 v22, v19, v20
    v_exp_f32 v21, v21
    v_exp_f32 v22, v22
    s_nop 0
    v_add_f32 v20, v21, v22
    v_rcp_f32 v20, v20
    s_nop 0
    v_mul_f32 v21, v21, v20
    v_mul_f32 v19, v22, v20
    v_mul_f32 v17, v17, v21
    s_lshl_b32 s55, s51, 20
    s_lshl_b32 s57, s3, 17
    s_add_u32 s55, s55, s57
    s_lshl_b32 s57, s26, 13
    s_add_u32 s55, s55, s57
    s_add_u32 s55, s55, 50331648
    s_add_u32 s56, s55, 0x80000
    s_mov_b32 s59, 0xffff0000
    s_waitcnt vmcnt(15)
    v_lshlrev_b32 v24, 16, v32
    v_and_b32 v25, s59, v32
    v_pk_mul_f32 v[24:25], v[24:25], v[18:19] op_sel:[0,0] op_sel_hi:[1,0]
    v_pk_fma_f32 v[128:129], v[128:129], v[16:17], v[24:25] op_sel:[0,0,0] op_sel_hi:[1,0,1]
    v_lshlrev_b32 v26, 16, v33
    v_and_b32 v27, s59, v33
    v_pk_mul_f32 v[26:27], v[26:27], v[18:19] op_sel:[0,0] op_sel_hi:[1,0]
    v_pk_fma_f32 v[130:131], v[130:131], v[16:17], v[26:27] op_sel:[0,0,0] op_sel_hi:[1,0,1]
    v_lshlrev_b32 v28, 16, v34
    v_and_b32 v29, s59, v34
    v_pk_mul_f32 v[28:29], v[28:29], v[18:19] op_sel:[0,0] op_sel_hi:[1,0]
    v_pk_fma_f32 v[132:133], v[132:133], v[16:17], v[28:29] op_sel:[0,0,0] op_sel_hi:[1,0,1]
    v_lshlrev_b32 v30, 16, v35
    v_and_b32 v31, s59, v35
    v_pk_mul_f32 v[30:31], v[30:31], v[18:19] op_sel:[0,0] op_sel_hi:[1,0]
    v_pk_fma_f32 v[134:135], v[134:135], v[16:17], v[30:31] op_sel:[0,0,0] op_sel_hi:[1,0,1]
    v_cvt_pk_bf16_f32 v128, v128, v129
    v_cvt_pk_bf16_f32 v129, v130, v131
    v_cvt_pk_bf16_f32 v130, v132, v133
    v_cvt_pk_bf16_f32 v131, v134, v135
    buffer_store_dwordx4 v[128:131], v1, s[12:15], s55 offen offset:0 sc1
    s_waitcnt vmcnt(15)
    v_lshlrev_b32 v24, 16, v36
    v_and_b32 v25, s59, v36
    v_pk_mul_f32 v[24:25], v[24:25], v[18:19] op_sel:[0,0] op_sel_hi:[1,0]
    v_pk_fma_f32 v[136:137], v[136:137], v[16:17], v[24:25] op_sel:[0,0,0] op_sel_hi:[1,0,1]
    v_lshlrev_b32 v26, 16, v37
    v_and_b32 v27, s59, v37
    v_pk_mul_f32 v[26:27], v[26:27], v[18:19] op_sel:[0,0] op_sel_hi:[1,0]
    v_pk_fma_f32 v[138:139], v[138:139], v[16:17], v[26:27] op_sel:[0,0,0] op_sel_hi:[1,0,1]
    v_lshlrev_b32 v28, 16, v38
    v_and_b32 v29, s59, v38
    v_pk_mul_f32 v[28:29], v[28:29], v[18:19] op_sel:[0,0] op_sel_hi:[1,0]
    v_pk_fma_f32 v[140:141], v[140:141], v[16:17], v[28:29] op_sel:[0,0,0] op_sel_hi:[1,0,1]
    v_lshlrev_b32 v30, 16, v39
    v_and_b32 v31, s59, v39
    v_pk_mul_f32 v[30:31], v[30:31], v[18:19] op_sel:[0,0] op_sel_hi:[1,0]
    v_pk_fma_f32 v[142:143], v[142:143], v[16:17], v[30:31] op_sel:[0,0,0] op_sel_hi:[1,0,1]
    v_cvt_pk_bf16_f32 v136, v136, v137
    v_cvt_pk_bf16_f32 v137, v138, v139
    v_cvt_pk_bf16_f32 v138, v140, v141
    v_cvt_pk_bf16_f32 v139, v142, v143
    buffer_store_dwordx4 v[136:139], v1, s[12:15], s55 offen offset:1024 sc1
    s_waitcnt vmcnt(15)
    v_lshlrev_b32 v24, 16, v40
    v_and_b32 v25, s59, v40
    v_pk_mul_f32 v[24:25], v[24:25], v[18:19] op_sel:[0,0] op_sel_hi:[1,0]
    v_pk_fma_f32 v[144:145], v[144:145], v[16:17], v[24:25] op_sel:[0,0,0] op_sel_hi:[1,0,1]
    v_lshlrev_b32 v26, 16, v41
    v_and_b32 v27, s59, v41
    v_pk_mul_f32 v[26:27], v[26:27], v[18:19] op_sel:[0,0] op_sel_hi:[1,0]
    v_pk_fma_f32 v[146:147], v[146:147], v[16:17], v[26:27] op_sel:[0,0,0] op_sel_hi:[1,0,1]
    v_lshlrev_b32 v28, 16, v42
    v_and_b32 v29, s59, v42
    v_pk_mul_f32 v[28:29], v[28:29], v[18:19] op_sel:[0,0] op_sel_hi:[1,0]
    v_pk_fma_f32 v[148:149], v[148:149], v[16:17], v[28:29] op_sel:[0,0,0] op_sel_hi:[1,0,1]
    v_lshlrev_b32 v30, 16, v43
    v_and_b32 v31, s59, v43
    v_pk_mul_f32 v[30:31], v[30:31], v[18:19] op_sel:[0,0] op_sel_hi:[1,0]
    v_pk_fma_f32 v[150:151], v[150:151], v[16:17], v[30:31] op_sel:[0,0,0] op_sel_hi:[1,0,1]
    v_cvt_pk_bf16_f32 v144, v144, v145
    v_cvt_pk_bf16_f32 v145, v146, v147
    v_cvt_pk_bf16_f32 v146, v148, v149
    v_cvt_pk_bf16_f32 v147, v150, v151
    buffer_store_dwordx4 v[144:147], v1, s[12:15], s55 offen offset:2048 sc1
    s_waitcnt vmcnt(15)
    v_lshlrev_b32 v24, 16, v44
    v_and_b32 v25, s59, v44
    v_pk_mul_f32 v[24:25], v[24:25], v[18:19] op_sel:[0,0] op_sel_hi:[1,0]
    v_pk_fma_f32 v[152:153], v[152:153], v[16:17], v[24:25] op_sel:[0,0,0] op_sel_hi:[1,0,1]
    v_lshlrev_b32 v26, 16, v45
    v_and_b32 v27, s59, v45
    v_pk_mul_f32 v[26:27], v[26:27], v[18:19] op_sel:[0,0] op_sel_hi:[1,0]
    v_pk_fma_f32 v[154:155], v[154:155], v[16:17], v[26:27] op_sel:[0,0,0] op_sel_hi:[1,0,1]
    v_lshlrev_b32 v28, 16, v46
    v_and_b32 v29, s59, v46
    v_pk_mul_f32 v[28:29], v[28:29], v[18:19] op_sel:[0,0] op_sel_hi:[1,0]
    v_pk_fma_f32 v[156:157], v[156:157], v[16:17], v[28:29] op_sel:[0,0,0] op_sel_hi:[1,0,1]
    v_lshlrev_b32 v30, 16, v47
    v_and_b32 v31, s59, v47
    v_pk_mul_f32 v[30:31], v[30:31], v[18:19] op_sel:[0,0] op_sel_hi:[1,0]
    v_pk_fma_f32 v[158:159], v[158:159], v[16:17], v[30:31] op_sel:[0,0,0] op_sel_hi:[1,0,1]
    v_cvt_pk_bf16_f32 v152, v152, v153
    v_cvt_pk_bf16_f32 v153, v154, v155
    v_cvt_pk_bf16_f32 v154, v156, v157
    v_cvt_pk_bf16_f32 v155, v158, v159
    buffer_store_dwordx4 v[152:155], v1, s[12:15], s55 offen offset:3072 sc1
    s_waitcnt vmcnt(15)
    v_lshlrev_b32 v24, 16, v48
    v_and_b32 v25, s59, v48
    v_pk_mul_f32 v[24:25], v[24:25], v[18:19] op_sel:[0,0] op_sel_hi:[1,0]
    v_pk_fma_f32 v[160:161], v[160:161], v[16:17], v[24:25] op_sel:[0,0,0] op_sel_hi:[1,0,1]
    v_lshlrev_b32 v26, 16, v49
    v_and_b32 v27, s59, v49
    v_pk_mul_f32 v[26:27], v[26:27], v[18:19] op_sel:[0,0] op_sel_hi:[1,0]
    v_pk_fma_f32 v[162:163], v[162:163], v[16:17], v[26:27] op_sel:[0,0,0] op_sel_hi:[1,0,1]
    v_lshlrev_b32 v28, 16, v50
    v_and_b32 v29, s59, v50
    v_pk_mul_f32 v[28:29], v[28:29], v[18:19] op_sel:[0,0] op_sel_hi:[1,0]
    v_pk_fma_f32 v[164:165], v[164:165], v[16:17], v[28:29] op_sel:[0,0,0] op_sel_hi:[1,0,1]
    v_lshlrev_b32 v30, 16, v51
    v_and_b32 v31, s59, v51
    v_pk_mul_f32 v[30:31], v[30:31], v[18:19] op_sel:[0,0] op_sel_hi:[1,0]
    v_pk_fma_f32 v[166:167], v[166:167], v[16:17], v[30:31] op_sel:[0,0,0] op_sel_hi:[1,0,1]
    v_cvt_pk_bf16_f32 v160, v160, v161
    v_cvt_pk_bf16_f32 v161, v162, v163
    v_cvt_pk_bf16_f32 v162, v164, v165
    v_cvt_pk_bf16_f32 v163, v166, v167
    buffer_store_dwordx4 v[160:163], v4, s[12:15], s55 offen offset:0 sc1
    s_waitcnt vmcnt(15)
    v_lshlrev_b32 v24, 16, v52
    v_and_b32 v25, s59, v52
    v_pk_mul_f32 v[24:25], v[24:25], v[18:19] op_sel:[0,0] op_sel_hi:[1,0]
    v_pk_fma_f32 v[168:169], v[168:169], v[16:17], v[24:25] op_sel:[0,0,0] op_sel_hi:[1,0,1]
    v_lshlrev_b32 v26, 16, v53
    v_and_b32 v27, s59, v53
    v_pk_mul_f32 v[26:27], v[26:27], v[18:19] op_sel:[0,0] op_sel_hi:[1,0]
    v_pk_fma_f32 v[170:171], v[170:171], v[16:17], v[26:27] op_sel:[0,0,0] op_sel_hi:[1,0,1]
    v_lshlrev_b32 v28, 16, v54
    v_and_b32 v29, s59, v54
    v_pk_mul_f32 v[28:29], v[28:29], v[18:19] op_sel:[0,0] op_sel_hi:[1,0]
    v_pk_fma_f32 v[172:173], v[172:173], v[16:17], v[28:29] op_sel:[0,0,0] op_sel_hi:[1,0,1]
    v_lshlrev_b32 v30, 16, v55
    v_and_b32 v31, s59, v55
    v_pk_mul_f32 v[30:31], v[30:31], v[18:19] op_sel:[0,0] op_sel_hi:[1,0]
    v_pk_fma_f32 v[174:175], v[174:175], v[16:17], v[30:31] op_sel:[0,0,0] op_sel_hi:[1,0,1]
    v_cvt_pk_bf16_f32 v168, v168, v169
    v_cvt_pk_bf16_f32 v169, v170, v171
    v_cvt_pk_bf16_f32 v170, v172, v173
    v_cvt_pk_bf16_f32 v171, v174, v175
    buffer_store_dwordx4 v[168:171], v4, s[12:15], s55 offen offset:1024 sc1
    s_waitcnt vmcnt(15)
    v_lshlrev_b32 v24, 16, v56
    v_and_b32 v25, s59, v56
    v_pk_mul_f32 v[24:25], v[24:25], v[18:19] op_sel:[0,0] op_sel_hi:[1,0]
    v_pk_fma_f32 v[176:177], v[176:177], v[16:17], v[24:25] op_sel:[0,0,0] op_sel_hi:[1,0,1]
    v_lshlrev_b32 v26, 16, v57
    v_and_b32 v27, s59, v57
    v_pk_mul_f32 v[26:27], v[26:27], v[18:19] op_sel:[0,0] op_sel_hi:[1,0]
    v_pk_fma_f32 v[178:179], v[178:179], v[16:17], v[26:27] op_sel:[0,0,0] op_sel_hi:[1,0,1]
    v_lshlrev_b32 v28, 16, v58
    v_and_b32 v29, s59, v58
    v_pk_mul_f32 v[28:29], v[28:29], v[18:19] op_sel:[0,0] op_sel_hi:[1,0]
    v_pk_fma_f32 v[180:181], v[180:181], v[16:17], v[28:29] op_sel:[0,0,0] op_sel_hi:[1,0,1]
    v_lshlrev_b32 v30, 16, v59
    v_and_b32 v31, s59, v59
    v_pk_mul_f32 v[30:31], v[30:31], v[18:19] op_sel:[0,0] op_sel_hi:[1,0]
    v_pk_fma_f32 v[182:183], v[182:183], v[16:17], v[30:31] op_sel:[0,0,0] op_sel_hi:[1,0,1]
    v_cvt_pk_bf16_f32 v176, v176, v177
    v_cvt_pk_bf16_f32 v177, v178, v179
    v_cvt_pk_bf16_f32 v178, v180, v181
    v_cvt_pk_bf16_f32 v179, v182, v183
    buffer_store_dwordx4 v[176:179], v4, s[12:15], s55 offen offset:2048 sc1
    s_waitcnt vmcnt(15)
    v_lshlrev_b32 v24, 16, v60
    v_and_b32 v25, s59, v60
    v_pk_mul_f32 v[24:25], v[24:25], v[18:19] op_sel:[0,0] op_sel_hi:[1,0]
    v_pk_fma_f32 v[184:185], v[184:185], v[16:17], v[24:25] op_sel:[0,0,0] op_sel_hi:[1,0,1]
    v_lshlrev_b32 v26, 16, v61
    v_and_b32 v27, s59, v61
    v_pk_mul_f32 v[26:27], v[26:27], v[18:19] op_sel:[0,0] op_sel_hi:[1,0]
    v_pk_fma_f32 v[186:187], v[186:187], v[16:17], v[26:27] op_sel:[0,0,0] op_sel_hi:[1,0,1]
    v_lshlrev_b32 v28, 16, v62
    v_and_b32 v29, s59, v62
    v_pk_mul_f32 v[28:29], v[28:29], v[18:19] op_sel:[0,0] op_sel_hi:[1,0]
    v_pk_fma_f32 v[188:189], v[188:189], v[16:17], v[28:29] op_sel:[0,0,0] op_sel_hi:[1,0,1]
    v_lshlrev_b32 v30, 16, v63
    v_and_b32 v31, s59, v63
    v_pk_mul_f32 v[30:31], v[30:31], v[18:19] op_sel:[0,0] op_sel_hi:[1,0]
    v_pk_fma_f32 v[190:191], v[190:191], v[16:17], v[30:31] op_sel:[0,0,0] op_sel_hi:[1,0,1]
    v_cvt_pk_bf16_f32 v184, v184, v185
    v_cvt_pk_bf16_f32 v185, v186, v187
    v_cvt_pk_bf16_f32 v186, v188, v189
    v_cvt_pk_bf16_f32 v187, v190, v191
    buffer_store_dwordx4 v[184:187], v4, s[12:15], s55 offen offset:3072 sc1
    s_waitcnt vmcnt(15)
    v_lshlrev_b32 v24, 16, v64
    v_and_b32 v25, s59, v64
    v_pk_mul_f32 v[24:25], v[24:25], v[18:19] op_sel:[0,1] op_sel_hi:[1,1]
    v_pk_fma_f32 v[192:193], v[192:193], v[16:17], v[24:25] op_sel:[0,1,0] op_sel_hi:[1,1,1]
    v_lshlrev_b32 v26, 16, v65
    v_and_b32 v27, s59, v65
    v_pk_mul_f32 v[26:27], v[26:27], v[18:19] op_sel:[0,1] op_sel_hi:[1,1]
    v_pk_fma_f32 v[194:195], v[194:195], v[16:17], v[26:27] op_sel:[0,1,0] op_sel_hi:[1,1,1]
    v_lshlrev_b32 v28, 16, v66
    v_and_b32 v29, s59, v66
    v_pk_mul_f32 v[28:29], v[28:29], v[18:19] op_sel:[0,1] op_sel_hi:[1,1]
    v_pk_fma_f32 v[196:197], v[196:197], v[16:17], v[28:29] op_sel:[0,1,0] op_sel_hi:[1,1,1]
    v_lshlrev_b32 v30, 16, v67
    v_and_b32 v31, s59, v67
    v_pk_mul_f32 v[30:31], v[30:31], v[18:19] op_sel:[0,1] op_sel_hi:[1,1]
    v_pk_fma_f32 v[198:199], v[198:199], v[16:17], v[30:31] op_sel:[0,1,0] op_sel_hi:[1,1,1]
    v_cvt_pk_bf16_f32 v192, v192, v193
    v_cvt_pk_bf16_f32 v193, v194, v195
    v_cvt_pk_bf16_f32 v194, v196, v197
    v_cvt_pk_bf16_f32 v195, v198, v199
    buffer_store_dwordx4 v[192:195], v1, s[12:15], s56 offen offset:0 sc1
    s_waitcnt vmcnt(15)
    v_lshlrev_b32 v24, 16, v68
    v_and_b32 v25, s59, v68
    v_pk_mul_f32 v[24:25], v[24:25], v[18:19] op_sel:[0,1] op_sel_hi:[1,1]
    v_pk_fma_f32 v[200:201], v[200:201], v[16:17], v[24:25] op_sel:[0,1,0] op_sel_hi:[1,1,1]
    v_lshlrev_b32 v26, 16, v69
    v_and_b32 v27, s59, v69
    v_pk_mul_f32 v[26:27], v[26:27], v[18:19] op_sel:[0,1] op_sel_hi:[1,1]
    v_pk_fma_f32 v[202:203], v[202:203], v[16:17], v[26:27] op_sel:[0,1,0] op_sel_hi:[1,1,1]
    v_lshlrev_b32 v28, 16, v70
    v_and_b32 v29, s59, v70
    v_pk_mul_f32 v[28:29], v[28:29], v[18:19] op_sel:[0,1] op_sel_hi:[1,1]
    v_pk_fma_f32 v[204:205], v[204:205], v[16:17], v[28:29] op_sel:[0,1,0] op_sel_hi:[1,1,1]
    v_lshlrev_b32 v30, 16, v71
    v_and_b32 v31, s59, v71
    v_pk_mul_f32 v[30:31], v[30:31], v[18:19] op_sel:[0,1] op_sel_hi:[1,1]
    v_pk_fma_f32 v[206:207], v[206:207], v[16:17], v[30:31] op_sel:[0,1,0] op_sel_hi:[1,1,1]
    v_cvt_pk_bf16_f32 v200, v200, v201
    v_cvt_pk_bf16_f32 v201, v202, v203
    v_cvt_pk_bf16_f32 v202, v204, v205
    v_cvt_pk_bf16_f32 v203, v206, v207
    buffer_store_dwordx4 v[200:203], v1, s[12:15], s56 offen offset:1024 sc1
    s_waitcnt vmcnt(15)
    v_lshlrev_b32 v24, 16, v72
    v_and_b32 v25, s59, v72
    v_pk_mul_f32 v[24:25], v[24:25], v[18:19] op_sel:[0,1] op_sel_hi:[1,1]
    v_pk_fma_f32 v[208:209], v[208:209], v[16:17], v[24:25] op_sel:[0,1,0] op_sel_hi:[1,1,1]
    v_lshlrev_b32 v26, 16, v73
    v_and_b32 v27, s59, v73
    v_pk_mul_f32 v[26:27], v[26:27], v[18:19] op_sel:[0,1] op_sel_hi:[1,1]
    v_pk_fma_f32 v[210:211], v[210:211], v[16:17], v[26:27] op_sel:[0,1,0] op_sel_hi:[1,1,1]
    v_lshlrev_b32 v28, 16, v74
    v_and_b32 v29, s59, v74
    v_pk_mul_f32 v[28:29], v[28:29], v[18:19] op_sel:[0,1] op_sel_hi:[1,1]
    v_pk_fma_f32 v[212:213], v[212:213], v[16:17], v[28:29] op_sel:[0,1,0] op_sel_hi:[1,1,1]
    v_lshlrev_b32 v30, 16, v75
    v_and_b32 v31, s59, v75
    v_pk_mul_f32 v[30:31], v[30:31], v[18:19] op_sel:[0,1] op_sel_hi:[1,1]
    v_pk_fma_f32 v[214:215], v[214:215], v[16:17], v[30:31] op_sel:[0,1,0] op_sel_hi:[1,1,1]
    v_cvt_pk_bf16_f32 v208, v208, v209
    v_cvt_pk_bf16_f32 v209, v210, v211
    v_cvt_pk_bf16_f32 v210, v212, v213
    v_cvt_pk_bf16_f32 v211, v214, v215
    buffer_store_dwordx4 v[208:211], v1, s[12:15], s56 offen offset:2048 sc1
    s_waitcnt vmcnt(15)
    v_lshlrev_b32 v24, 16, v76
    v_and_b32 v25, s59, v76
    v_pk_mul_f32 v[24:25], v[24:25], v[18:19] op_sel:[0,1] op_sel_hi:[1,1]
    v_pk_fma_f32 v[216:217], v[216:217], v[16:17], v[24:25] op_sel:[0,1,0] op_sel_hi:[1,1,1]
    v_lshlrev_b32 v26, 16, v77
    v_and_b32 v27, s59, v77
    v_pk_mul_f32 v[26:27], v[26:27], v[18:19] op_sel:[0,1] op_sel_hi:[1,1]
    v_pk_fma_f32 v[218:219], v[218:219], v[16:17], v[26:27] op_sel:[0,1,0] op_sel_hi:[1,1,1]
    v_lshlrev_b32 v28, 16, v78
    v_and_b32 v29, s59, v78
    v_pk_mul_f32 v[28:29], v[28:29], v[18:19] op_sel:[0,1] op_sel_hi:[1,1]
    v_pk_fma_f32 v[220:221], v[220:221], v[16:17], v[28:29] op_sel:[0,1,0] op_sel_hi:[1,1,1]
    v_lshlrev_b32 v30, 16, v79
    v_and_b32 v31, s59, v79
    v_pk_mul_f32 v[30:31], v[30:31], v[18:19] op_sel:[0,1] op_sel_hi:[1,1]
    v_pk_fma_f32 v[222:223], v[222:223], v[16:17], v[30:31] op_sel:[0,1,0] op_sel_hi:[1,1,1]
    v_cvt_pk_bf16_f32 v216, v216, v217
    v_cvt_pk_bf16_f32 v217, v218, v219
    v_cvt_pk_bf16_f32 v218, v220, v221
    v_cvt_pk_bf16_f32 v219, v222, v223
    buffer_store_dwordx4 v[216:219], v1, s[12:15], s56 offen offset:3072 sc1
    s_waitcnt vmcnt(15)
    v_lshlrev_b32 v24, 16, v80
    v_and_b32 v25, s59, v80
    v_pk_mul_f32 v[24:25], v[24:25], v[18:19] op_sel:[0,1] op_sel_hi:[1,1]
    v_pk_fma_f32 v[224:225], v[224:225], v[16:17], v[24:25] op_sel:[0,1,0] op_sel_hi:[1,1,1]
    v_lshlrev_b32 v26, 16, v81
    v_and_b32 v27, s59, v81
    v_pk_mul_f32 v[26:27], v[26:27], v[18:19] op_sel:[0,1] op_sel_hi:[1,1]
    v_pk_fma_f32 v[226:227], v[226:227], v[16:17], v[26:27] op_sel:[0,1,0] op_sel_hi:[1,1,1]
    v_lshlrev_b32 v28, 16, v82
    v_and_b32 v29, s59, v82
    v_pk_mul_f32 v[28:29], v[28:29], v[18:19] op_sel:[0,1] op_sel_hi:[1,1]
    v_pk_fma_f32 v[228:229], v[228:229], v[16:17], v[28:29] op_sel:[0,1,0] op_sel_hi:[1,1,1]
    v_lshlrev_b32 v30, 16, v83
    v_and_b32 v31, s59, v83
    v_pk_mul_f32 v[30:31], v[30:31], v[18:19] op_sel:[0,1] op_sel_hi:[1,1]
    v_pk_fma_f32 v[230:231], v[230:231], v[16:17], v[30:31] op_sel:[0,1,0] op_sel_hi:[1,1,1]
    v_cvt_pk_bf16_f32 v224, v224, v225
    v_cvt_pk_bf16_f32 v225, v226, v227
    v_cvt_pk_bf16_f32 v226, v228, v229
    v_cvt_pk_bf16_f32 v227, v230, v231
    buffer_store_dwordx4 v[224:227], v4, s[12:15], s56 offen offset:0 sc1
    s_waitcnt vmcnt(15)
    v_lshlrev_b32 v24, 16, v84
    v_and_b32 v25, s59, v84
    v_pk_mul_f32 v[24:25], v[24:25], v[18:19] op_sel:[0,1] op_sel_hi:[1,1]
    v_pk_fma_f32 v[232:233], v[232:233], v[16:17], v[24:25] op_sel:[0,1,0] op_sel_hi:[1,1,1]
    v_lshlrev_b32 v26, 16, v85
    v_and_b32 v27, s59, v85
    v_pk_mul_f32 v[26:27], v[26:27], v[18:19] op_sel:[0,1] op_sel_hi:[1,1]
    v_pk_fma_f32 v[234:235], v[234:235], v[16:17], v[26:27] op_sel:[0,1,0] op_sel_hi:[1,1,1]
    v_lshlrev_b32 v28, 16, v86
    v_and_b32 v29, s59, v86
    v_pk_mul_f32 v[28:29], v[28:29], v[18:19] op_sel:[0,1] op_sel_hi:[1,1]
    v_pk_fma_f32 v[236:237], v[236:237], v[16:17], v[28:29] op_sel:[0,1,0] op_sel_hi:[1,1,1]
    v_lshlrev_b32 v30, 16, v87
    v_and_b32 v31, s59, v87
    v_pk_mul_f32 v[30:31], v[30:31], v[18:19] op_sel:[0,1] op_sel_hi:[1,1]
    v_pk_fma_f32 v[238:239], v[238:239], v[16:17], v[30:31] op_sel:[0,1,0] op_sel_hi:[1,1,1]
    v_cvt_pk_bf16_f32 v232, v232, v233
    v_cvt_pk_bf16_f32 v233, v234, v235
    v_cvt_pk_bf16_f32 v234, v236, v237
    v_cvt_pk_bf16_f32 v235, v238, v239
    buffer_store_dwordx4 v[232:235], v4, s[12:15], s56 offen offset:1024 sc1
    s_waitcnt vmcnt(15)
    v_lshlrev_b32 v24, 16, v88
    v_and_b32 v25, s59, v88
    v_pk_mul_f32 v[24:25], v[24:25], v[18:19] op_sel:[0,1] op_sel_hi:[1,1]
    v_pk_fma_f32 v[240:241], v[240:241], v[16:17], v[24:25] op_sel:[0,1,0] op_sel_hi:[1,1,1]
    v_lshlrev_b32 v26, 16, v89
    v_and_b32 v27, s59, v89
    v_pk_mul_f32 v[26:27], v[26:27], v[18:19] op_sel:[0,1] op_sel_hi:[1,1]
    v_pk_fma_f32 v[242:243], v[242:243], v[16:17], v[26:27] op_sel:[0,1,0] op_sel_hi:[1,1,1]
    v_lshlrev_b32 v28, 16, v90
    v_and_b32 v29, s59, v90
    v_pk_mul_f32 v[28:29], v[28:29], v[18:19] op_sel:[0,1] op_sel_hi:[1,1]
    v_pk_fma_f32 v[244:245], v[244:245], v[16:17], v[28:29] op_sel:[0,1,0] op_sel_hi:[1,1,1]
    v_lshlrev_b32 v30, 16, v91
    v_and_b32 v31, s59, v91
    v_pk_mul_f32 v[30:31], v[30:31], v[18:19] op_sel:[0,1] op_sel_hi:[1,1]
    v_pk_fma_f32 v[246:247], v[246:247], v[16:17], v[30:31] op_sel:[0,1,0] op_sel_hi:[1,1,1]
    v_cvt_pk_bf16_f32 v240, v240, v241
    v_cvt_pk_bf16_f32 v241, v242, v243
    v_cvt_pk_bf16_f32 v242, v244, v245
    v_cvt_pk_bf16_f32 v243, v246, v247
    buffer_store_dwordx4 v[240:243], v4, s[12:15], s56 offen offset:2048 sc1
    s_waitcnt vmcnt(15)
    v_lshlrev_b32 v24, 16, v92
    v_and_b32 v25, s59, v92
    v_pk_mul_f32 v[24:25], v[24:25], v[18:19] op_sel:[0,1] op_sel_hi:[1,1]
    v_pk_fma_f32 v[248:249], v[248:249], v[16:17], v[24:25] op_sel:[0,1,0] op_sel_hi:[1,1,1]
    v_lshlrev_b32 v26, 16, v93
    v_and_b32 v27, s59, v93
    v_pk_mul_f32 v[26:27], v[26:27], v[18:19] op_sel:[0,1] op_sel_hi:[1,1]
    v_pk_fma_f32 v[250:251], v[250:251], v[16:17], v[26:27] op_sel:[0,1,0] op_sel_hi:[1,1,1]
    v_lshlrev_b32 v28, 16, v94
    v_and_b32 v29, s59, v94
    v_pk_mul_f32 v[28:29], v[28:29], v[18:19] op_sel:[0,1] op_sel_hi:[1,1]
    v_pk_fma_f32 v[252:253], v[252:253], v[16:17], v[28:29] op_sel:[0,1,0] op_sel_hi:[1,1,1]
    v_lshlrev_b32 v30, 16, v95
    v_and_b32 v31, s59, v95
    v_pk_mul_f32 v[30:31], v[30:31], v[18:19] op_sel:[0,1] op_sel_hi:[1,1]
    v_pk_fma_f32 v[254:255], v[254:255], v[16:17], v[30:31] op_sel:[0,1,0] op_sel_hi:[1,1,1]
    v_cvt_pk_bf16_f32 v248, v248, v249
    v_cvt_pk_bf16_f32 v249, v250, v251
    v_cvt_pk_bf16_f32 v250, v252, v253
    v_cvt_pk_bf16_f32 v251, v254, v255
    buffer_store_dwordx4 v[248:251], v4, s[12:15], s56 offen offset:3072 sc1
    s_branch L_pubctx
L_store:
    s_lshl_b32 s55, s51, 20
    s_lshl_b32 s57, s3, 17
    s_add_u32 s55, s55, s57
    s_lshl_b32 s57, s26, 13
    s_add_u32 s55, s55, s57
    s_add_u32 s55, s55, 50331648
    s_add_u32 s56, s55, 0x80000
    v_pk_mul_f32 v[128:129], v[128:129], v[16:17] op_sel:[0,0] op_sel_hi:[1,0]
    v_pk_mul_f32 v[130:131], v[130:131], v[16:17] op_sel:[0,0] op_sel_hi:[1,0]
    v_pk_mul_f32 v[132:133], v[132:133], v[16:17] op_sel:[0,0] op_sel_hi:[1,0]
    v_pk_mul_f32 v[134:135], v[134:135], v[16:17] op_sel:[0,0] op_sel_hi:[1,0]
    v_cvt_pk_bf16_f32 v128, v128, v129
    v_cvt_pk_bf16_f32 v129, v130, v131
    v_cvt_pk_bf16_f32 v130, v132, v133
    v_cvt_pk_bf16_f32 v131, v134, v135
    buffer_store_dwordx4 v[128:131], v1, s[12:15], s55 offen offset:0 sc1
    v_pk_mul_f32 v[136:137], v[136:137], v[16:17] op_sel:[0,0] op_sel_hi:[1,0]
    v_pk_mul_f32 v[138:139], v[138:139], v[16:17] op_sel:[0,0] op_sel_hi:[1,0]
    v_pk_mul_f32 v[140:141], v[140:141], v[16:17] op_sel:[0,0] op_sel_hi:[1,0]
    v_pk_mul_f32 v[142:143], v[142:143], v[16:17] op_sel:[0,0] op_sel_hi:[1,0]
    v_cvt_pk_bf16_f32 v136, v136, v137
    v_cvt_pk_bf16_f32 v137, v138, v139
    v_cvt_pk_bf16_f32 v138, v140, v141
    v_cvt_pk_bf16_f32 v139, v142, v143
    buffer_store_dwordx4 v[136:139], v1, s[12:15], s55 offen offset:1024 sc1
    v_pk_mul_f32 v[144:145], v[144:145], v[16:17] op_sel:[0,0] op_sel_hi:[1,0]
    v_pk_mul_f32 v[146:147], v[146:147], v[16:17] op_sel:[0,0] op_sel_hi:[1,0]
    v_pk_mul_f32 v[148:149], v[148:149], v[16:17] op_sel:[0,0] op_sel_hi:[1,0]
    v_pk_mul_f32 v[150:151], v[150:151], v[16:17] op_sel:[0,0] op_sel_hi:[1,0]
    v_cvt_pk_bf16_f32 v144, v144, v145
    v_cvt_pk_bf16_f32 v145, v146, v147
    v_cvt_pk_bf16_f32 v146, v148, v149
    v_cvt_pk_bf16_f32 v147, v150, v151
    buffer_store_dwordx4 v[144:147], v1, s[12:15], s55 offen offset:2048 sc1
    v_pk_mul_f32 v[152:153], v[152:153], v[16:17] op_sel:[0,0] op_sel_hi:[1,0]
    v_pk_mul_f32 v[154:155], v[154:155], v[16:17] op_sel:[0,0] op_sel_hi:[1,0]
    v_pk_mul_f32 v[156:157], v[156:157], v[16:17] op_sel:[0,0] op_sel_hi:[1,0]
    v_pk_mul_f32 v[158:159], v[158:159], v[16:17] op_sel:[0,0] op_sel_hi:[1,0]
    v_cvt_pk_bf16_f32 v152, v152, v153
    v_cvt_pk_bf16_f32 v153, v154, v155
    v_cvt_pk_bf16_f32 v154, v156, v157
    v_cvt_pk_bf16_f32 v155, v158, v159
    buffer_store_dwordx4 v[152:155], v1, s[12:15], s55 offen offset:3072 sc1
    v_pk_mul_f32 v[160:161], v[160:161], v[16:17] op_sel:[0,0] op_sel_hi:[1,0]
    v_pk_mul_f32 v[162:163], v[162:163], v[16:17] op_sel:[0,0] op_sel_hi:[1,0]
    v_pk_mul_f32 v[164:165], v[164:165], v[16:17] op_sel:[0,0] op_sel_hi:[1,0]
    v_pk_mul_f32 v[166:167], v[166:167], v[16:17] op_sel:[0,0] op_sel_hi:[1,0]
    v_cvt_pk_bf16_f32 v160, v160, v161
    v_cvt_pk_bf16_f32 v161, v162, v163
    v_cvt_pk_bf16_f32 v162, v164, v165
    v_cvt_pk_bf16_f32 v163, v166, v167
    buffer_store_dwordx4 v[160:163], v4, s[12:15], s55 offen offset:0 sc1
    v_pk_mul_f32 v[168:169], v[168:169], v[16:17] op_sel:[0,0] op_sel_hi:[1,0]
    v_pk_mul_f32 v[170:171], v[170:171], v[16:17] op_sel:[0,0] op_sel_hi:[1,0]
    v_pk_mul_f32 v[172:173], v[172:173], v[16:17] op_sel:[0,0] op_sel_hi:[1,0]
    v_pk_mul_f32 v[174:175], v[174:175], v[16:17] op_sel:[0,0] op_sel_hi:[1,0]
    v_cvt_pk_bf16_f32 v168, v168, v169
    v_cvt_pk_bf16_f32 v169, v170, v171
    v_cvt_pk_bf16_f32 v170, v172, v173
    v_cvt_pk_bf16_f32 v171, v174, v175
    buffer_store_dwordx4 v[168:171], v4, s[12:15], s55 offen offset:1024 sc1
    v_pk_mul_f32 v[176:177], v[176:177], v[16:17] op_sel:[0,0] op_sel_hi:[1,0]
    v_pk_mul_f32 v[178:179], v[178:179], v[16:17] op_sel:[0,0] op_sel_hi:[1,0]
    v_pk_mul_f32 v[180:181], v[180:181], v[16:17] op_sel:[0,0] op_sel_hi:[1,0]
    v_pk_mul_f32 v[182:183], v[182:183], v[16:17] op_sel:[0,0] op_sel_hi:[1,0]
    v_cvt_pk_bf16_f32 v176, v176, v177
    v_cvt_pk_bf16_f32 v177, v178, v179
    v_cvt_pk_bf16_f32 v178, v180, v181
    v_cvt_pk_bf16_f32 v179, v182, v183
    buffer_store_dwordx4 v[176:179], v4, s[12:15], s55 offen offset:2048 sc1
    v_pk_mul_f32 v[184:185], v[184:185], v[16:17] op_sel:[0,0] op_sel_hi:[1,0]
    v_pk_mul_f32 v[186:187], v[186:187], v[16:17] op_sel:[0,0] op_sel_hi:[1,0]
    v_pk_mul_f32 v[188:189], v[188:189], v[16:17] op_sel:[0,0] op_sel_hi:[1,0]
    v_pk_mul_f32 v[190:191], v[190:191], v[16:17] op_sel:[0,0] op_sel_hi:[1,0]
    v_cvt_pk_bf16_f32 v184, v184, v185
    v_cvt_pk_bf16_f32 v185, v186, v187
    v_cvt_pk_bf16_f32 v186, v188, v189
    v_cvt_pk_bf16_f32 v187, v190, v191
    buffer_store_dwordx4 v[184:187], v4, s[12:15], s55 offen offset:3072 sc1
    v_pk_mul_f32 v[192:193], v[192:193], v[16:17] op_sel:[0,1] op_sel_hi:[1,1]
    v_pk_mul_f32 v[194:195], v[194:195], v[16:17] op_sel:[0,1] op_sel_hi:[1,1]
    v_pk_mul_f32 v[196:197], v[196:197], v[16:17] op_sel:[0,1] op_sel_hi:[1,1]
    v_pk_mul_f32 v[198:199], v[198:199], v[16:17] op_sel:[0,1] op_sel_hi:[1,1]
    v_cvt_pk_bf16_f32 v192, v192, v193
    v_cvt_pk_bf16_f32 v193, v194, v195
    v_cvt_pk_bf16_f32 v194, v196, v197
    v_cvt_pk_bf16_f32 v195, v198, v199
    buffer_store_dwordx4 v[192:195], v1, s[12:15], s56 offen offset:0 sc1
    v_pk_mul_f32 v[200:201], v[200:201], v[16:17] op_sel:[0,1] op_sel_hi:[1,1]
    v_pk_mul_f32 v[202:203], v[202:203], v[16:17] op_sel:[0,1] op_sel_hi:[1,1]
    v_pk_mul_f32 v[204:205], v[204:205], v[16:17] op_sel:[0,1] op_sel_hi:[1,1]
    v_pk_mul_f32 v[206:207], v[206:207], v[16:17] op_sel:[0,1] op_sel_hi:[1,1]
    v_cvt_pk_bf16_f32 v200, v200, v201
    v_cvt_pk_bf16_f32 v201, v202, v203
    v_cvt_pk_bf16_f32 v202, v204, v205
    v_cvt_pk_bf16_f32 v203, v206, v207
    buffer_store_dwordx4 v[200:203], v1, s[12:15], s56 offen offset:1024 sc1
    v_pk_mul_f32 v[208:209], v[208:209], v[16:17] op_sel:[0,1] op_sel_hi:[1,1]
    v_pk_mul_f32 v[210:211], v[210:211], v[16:17] op_sel:[0,1] op_sel_hi:[1,1]
    v_pk_mul_f32 v[212:213], v[212:213], v[16:17] op_sel:[0,1] op_sel_hi:[1,1]
    v_pk_mul_f32 v[214:215], v[214:215], v[16:17] op_sel:[0,1] op_sel_hi:[1,1]
    v_cvt_pk_bf16_f32 v208, v208, v209
    v_cvt_pk_bf16_f32 v209, v210, v211
    v_cvt_pk_bf16_f32 v210, v212, v213
    v_cvt_pk_bf16_f32 v211, v214, v215
    buffer_store_dwordx4 v[208:211], v1, s[12:15], s56 offen offset:2048 sc1
    v_pk_mul_f32 v[216:217], v[216:217], v[16:17] op_sel:[0,1] op_sel_hi:[1,1]
    v_pk_mul_f32 v[218:219], v[218:219], v[16:17] op_sel:[0,1] op_sel_hi:[1,1]
    v_pk_mul_f32 v[220:221], v[220:221], v[16:17] op_sel:[0,1] op_sel_hi:[1,1]
    v_pk_mul_f32 v[222:223], v[222:223], v[16:17] op_sel:[0,1] op_sel_hi:[1,1]
    v_cvt_pk_bf16_f32 v216, v216, v217
    v_cvt_pk_bf16_f32 v217, v218, v219
    v_cvt_pk_bf16_f32 v218, v220, v221
    v_cvt_pk_bf16_f32 v219, v222, v223
    buffer_store_dwordx4 v[216:219], v1, s[12:15], s56 offen offset:3072 sc1
    v_pk_mul_f32 v[224:225], v[224:225], v[16:17] op_sel:[0,1] op_sel_hi:[1,1]
    v_pk_mul_f32 v[226:227], v[226:227], v[16:17] op_sel:[0,1] op_sel_hi:[1,1]
    v_pk_mul_f32 v[228:229], v[228:229], v[16:17] op_sel:[0,1] op_sel_hi:[1,1]
    v_pk_mul_f32 v[230:231], v[230:231], v[16:17] op_sel:[0,1] op_sel_hi:[1,1]
    v_cvt_pk_bf16_f32 v224, v224, v225
    v_cvt_pk_bf16_f32 v225, v226, v227
    v_cvt_pk_bf16_f32 v226, v228, v229
    v_cvt_pk_bf16_f32 v227, v230, v231
    buffer_store_dwordx4 v[224:227], v4, s[12:15], s56 offen offset:0 sc1
    v_pk_mul_f32 v[232:233], v[232:233], v[16:17] op_sel:[0,1] op_sel_hi:[1,1]
    v_pk_mul_f32 v[234:235], v[234:235], v[16:17] op_sel:[0,1] op_sel_hi:[1,1]
    v_pk_mul_f32 v[236:237], v[236:237], v[16:17] op_sel:[0,1] op_sel_hi:[1,1]
    v_pk_mul_f32 v[238:239], v[238:239], v[16:17] op_sel:[0,1] op_sel_hi:[1,1]
    v_cvt_pk_bf16_f32 v232, v232, v233
    v_cvt_pk_bf16_f32 v233, v234, v235
    v_cvt_pk_bf16_f32 v234, v236, v237
    v_cvt_pk_bf16_f32 v235, v238, v239
    buffer_store_dwordx4 v[232:235], v4, s[12:15], s56 offen offset:1024 sc1
    v_pk_mul_f32 v[240:241], v[240:241], v[16:17] op_sel:[0,1] op_sel_hi:[1,1]
    v_pk_mul_f32 v[242:243], v[242:243], v[16:17] op_sel:[0,1] op_sel_hi:[1,1]
    v_pk_mul_f32 v[244:245], v[244:245], v[16:17] op_sel:[0,1] op_sel_hi:[1,1]
    v_pk_mul_f32 v[246:247], v[246:247], v[16:17] op_sel:[0,1] op_sel_hi:[1,1]
    v_cvt_pk_bf16_f32 v240, v240, v241
    v_cvt_pk_bf16_f32 v241, v242, v243
    v_cvt_pk_bf16_f32 v242, v244, v245
    v_cvt_pk_bf16_f32 v243, v246, v247
    buffer_store_dwordx4 v[240:243], v4, s[12:15], s56 offen offset:2048 sc1
    v_pk_mul_f32 v[248:249], v[248:249], v[16:17] op_sel:[0,1] op_sel_hi:[1,1]
    v_pk_mul_f32 v[250:251], v[250:251], v[16:17] op_sel:[0,1] op_sel_hi:[1,1]
    v_pk_mul_f32 v[252:253], v[252:253], v[16:17] op_sel:[0,1] op_sel_hi:[1,1]
    v_pk_mul_f32 v[254:255], v[254:255], v[16:17] op_sel:[0,1] op_sel_hi:[1,1]
    v_cvt_pk_bf16_f32 v248, v248, v249
    v_cvt_pk_bf16_f32 v249, v250, v251
    v_cvt_pk_bf16_f32 v250, v252, v253
    v_cvt_pk_bf16_f32 v251, v254, v255
    buffer_store_dwordx4 v[248:251], v4, s[12:15], s56 offen offset:3072 sc1
L_pubctx:
    s_waitcnt vmcnt(0)
    s_barrier
    s_cmp_lg_u32 s3, 0
    s_cbranch_scc1 L_pub7
    v_mov_b32 v11, 0
    v_mov_b32 v12, 1
    s_mov_b64 exec, 1
    buffer_store_dword v12, v11, s[12:15], s93 offen sc1
    s_mov_b64 exec, -1
L_pub7:
L_attdone:
    s_cmp_ge_u32 s28, 14
    s_cbranch_scc1 L_fin
    s_cmp_lg_u32 s27, 0
    s_cbranch_scc1 L_s2end
    s_lshr_b32 s33, s95, 4
    s_lshl_b32 s33, s33, 7
    s_add_u32 s33, s33, 84959232
    v_and_b32 v14, 31, v0
    v_lshlrev_b32 v14, 2, v14
    s_mov_b32 s100, 0
L_poll8:
    buffer_load_dword v15, v14, s[12:15], s33 offen sc1
    s_waitcnt vmcnt(0)
    v_cmp_ne_u32 vcc, 1, v15
    s_cbranch_vccz L_poll8_ok
    s_sleep 2
    s_add_u32 s100, s100, 1
    s_cmp_lt_u32 s100, 0x80000
    s_cbranch_scc1 L_poll8
L_poll8_ok:
    s_lshl_b32 s34, s95, 2
    s_add_u32 s34, s34, s3
    s_lshl_b32 s35, s34, 12
    s_add_u32 s36, s35, 85983232
    s_mul_i32 s37, s3, 38912
    s_lshr_b32 s38, s34, 1
    s_lshl_b32 s38, s38, 2
    s_load_dword s39, s[74:75], s38
    s_mov_b32 s4, s72
    s_mov_b32 s5, s73
    s_mov_b32 s6, 1835008
    s_mov_b32 s7, 0x20000
    v_lshlrev_b32 v1, 4, v0
    v_lshrrev_b32 v3, 1, v0
    v_lshlrev_b32 v3, 7, v3
    v_and_b32 v4, 1, v0
    v_lshl_add_u32 v3, v4, 4, v3
    s_add_u32 m0, s37, 29536
    s_nop 0
    buffer_load_dwordx4 v1, s[4:7], s35 offen offset:0 lds
    buffer_load_dwordx4 v1, s[4:7], s35 offen offset:1024 lds
    buffer_load_dwordx4 v1, s[4:7], s35 offen offset:2048 lds
    buffer_load_dwordx4 v1, s[4:7], s35 offen offset:3072 lds
    s_add_u32 m0, s37, 128
    s_nop 0
    buffer_load_dwordx4 v3, s[12:15], s36 offen offset:0 sc1 lds
    s_add_u32 m0, s37, 1248
    s_nop 0
    buffer_load_dwordx4 v3, s[12:15], s36 offen offset:32 sc1 lds
    s_add_u32 m0, s37, 2368
    s_nop 0
    buffer_load_dwordx4 v3, s[12:15], s36 offen offset:64 sc1 lds
    s_add_u32 m0, s37, 3488
    s_nop 0
    buffer_load_dwordx4 v3, s[12:15], s36 offen offset:96 sc1 lds
    v_mov_b32 v8, 0
    v_lshlrev_b32 v5, 2, v0
    v_add_u32 v5, s37, v5
    v_and_b32 v6, 31, v0
    v_lshlrev_b32 v6, 2, v6
    v_add_u32 v6, s37, v6
    ds_write_b32 v5, v8 offset:29280
    ds_write_b32 v6, v8 offset:0
    ds_write_b32 v6, v8 offset:1152
    ds_write_b32 v6, v8 offset:2304
    ds_write_b32 v6, v8 offset:3456
    ds_write_b32 v6, v8 offset:12832
    ds_write_b32 v6, v8 offset:21056
    v_and_b32 v14, 15, v0
    v_lshrrev_b32 v15, 4, v0
    v_lshlrev_b32 v9, 3, v14
    v_lshl_add_u32 v9, v15, 4, v9
    v_add_u32 v9, s37, v9
    v_and_b32 v10, 3, v0
    v_bfe_u32 v4, v0, 2, 2
    v_sub_u32 v10, v10, v4
    v_lshlrev_b32 v4, 3, v15
    v_sub_u32 v10, v10, v4
    v_add_u32 v10, 56, v10
    v_lshlrev_b32 v10, 3, v10
    v_add_u32 v10, s37, v10
    v_lshl_add_u32 v11, v15, 6, v14
    v_lshlrev_b32 v11, 2, v11
    v_add_u32 v11, s37, v11
    v_lshlrev_b32 v12, 5, v0
    v_add_u32 v12, s37, v12
    s_add_u32 s42, s35, 90177536
    s_mov_b32 s45, 0xffff0000
    s_waitcnt vmcnt(0) lgkmcnt(0)
    s_lshl_b32 s43, s39, 16
    s_and_b32 s44, s39, s45
    s_bitcmp1_b32 s3, 0
    s_cselect_b32 s43, s44, s43
    ds_read_b64_tr_b16 a[0:1], v10 offset:29312
    ds_read_b64_tr_b16 a[2:3], v10 offset:29280
    ds_read_b64 a[64:65], v9 offset:8
    ds_read_b64 a[66:67], v9 offset:16
    ds_read_b64_tr_b16 a[4:5], v10 offset:29568
    ds_read_b64_tr_b16 a[6:7], v10 offset:29536
    ds_read_b64 a[68:69], v9 offset:72
    ds_read_b64 a[70:71], v9 offset:80
    ds_read_b64_tr_b16 a[8:9], v10 offset:29824
    ds_read_b64_tr_b16 a[10:11], v10 offset:29792
    ds_read_b64 a[72:73], v9 offset:136
    ds_read_b64 a[74:75], v9 offset:144
    s_waitcnt lgkmcnt(4)
    ds_read_b64_tr_b16 a[12:13], v10 offset:30080
    ds_read_b64_tr_b16 a[14:15], v10 offset:30048
    ds_read_b64 a[76:77], v9 offset:200
    ds_read_b64 a[78:79], v9 offset:208
    ds_read_b64_tr_b16 a[16:17], v10 offset:30336
    ds_read_b64_tr_b16 a[18:19], v10 offset:30304
    ds_read_b64 a[80:81], v9 offset:264
    ds_read_b64 a[82:83], v9 offset:272
    ds_read_b64_tr_b16 a[20:21], v10 offset:30592
    ds_read_b64_tr_b16 a[22:23], v10 offset:30560
    ds_read_b64 a[84:85], v9 offset:328
    ds_read_b64 a[86:87], v9 offset:336
    s_waitcnt lgkmcnt(4)
    ds_read_b64_tr_b16 a[24:25], v10 offset:30848
    ds_read_b64_tr_b16 a[26:27], v10 offset:30816
    ds_read_b64 a[88:89], v9 offset:392
    ds_read_b64 a[90:91], v9 offset:400
    ds_read_b64_tr_b16 a[28:29], v10 offset:31104
    ds_read_b64_tr_b16 a[30:31], v10 offset:31072
    ds_read_b64 a[92:93], v9 offset:456
    ds_read_b64 a[94:95], v9 offset:464
    s_waitcnt lgkmcnt(0)
    v_mfma_f32_16x16x32_bf16 v[32:35], a[68:71], a[0:3], 0
    ds_read_b64_tr_b16 a[32:33], v10 offset:31360
    v_mfma_f32_16x16x32_bf16 v[32:35], a[64:67], a[4:7], v[32:35]
    ds_read_b64_tr_b16 a[34:35], v10 offset:31328
    v_mfma_f32_16x16x32_bf16 v[36:39], a[76:79], a[0:3], 0
    ds_read_b64 a[96:97], v9 offset:520
    v_mfma_f32_16x16x32_bf16 v[36:39], a[72:75], a[4:7], v[36:39]
    ds_read_b64 a[98:99], v9 offset:528
    v_mfma_f32_16x16x32_bf16 v[36:39], a[68:71], a[8:11], v[36:39]
    ds_read_b64_tr_b16 a[36:37], v10 offset:31616
    v_mfma_f32_16x16x32_bf16 v[36:39], a[64:67], a[12:15], v[36:39]
    ds_read_b64_tr_b16 a[38:39], v10 offset:31584
    v_mfma_f32_16x16x32_bf16 v[40:43], a[84:87], a[0:3], 0
    ds_read_b64 a[100:101], v9 offset:584
    v_mfma_f32_16x16x32_bf16 v[40:43], a[80:83], a[4:7], v[40:43]
    ds_read_b64 a[102:103], v9 offset:592
    v_mfma_f32_16x16x32_bf16 v[40:43], a[76:79], a[8:11], v[40:43]
    ds_read_b64_tr_b16 a[40:41], v10 offset:31872
    v_mfma_f32_16x16x32_bf16 v[40:43], a[72:75], a[12:15], v[40:43]
    ds_read_b64_tr_b16 a[42:43], v10 offset:31840
    v_mfma_f32_16x16x32_bf16 v[40:43], a[68:71], a[16:19], v[40:43]
    ds_read_b64 a[104:105], v9 offset:648
    v_mfma_f32_16x16x32_bf16 v[40:43], a[64:67], a[20:23], v[40:43]
    ds_read_b64 a[106:107], v9 offset:656
    v_mfma_f32_16x16x32_bf16 v[44:47], a[92:95], a[0:3], 0
    ds_read_b64_tr_b16 a[44:45], v10 offset:32128
    v_mfma_f32_16x16x32_bf16 v[44:47], a[88:91], a[4:7], v[44:47]
    ds_read_b64_tr_b16 a[46:47], v10 offset:32096
    v_mfma_f32_16x16x32_bf16 v[44:47], a[84:87], a[8:11], v[44:47]
    ds_read_b64 a[108:109], v9 offset:712
    v_mfma_f32_16x16x32_bf16 v[44:47], a[80:83], a[12:15], v[44:47]
    ds_read_b64 a[110:111], v9 offset:720
    v_mfma_f32_16x16x32_bf16 v[44:47], a[76:79], a[16:19], v[44:47]
    ds_read_b64_tr_b16 a[48:49], v10 offset:32384
    v_mfma_f32_16x16x32_bf16 v[44:47], a[72:75], a[20:23], v[44:47]
    ds_read_b64_tr_b16 a[50:51], v10 offset:32352
    v_mfma_f32_16x16x32_bf16 v[44:47], a[68:71], a[24:27], v[44:47]
    ds_read_b64 a[112:113], v9 offset:776
    v_mfma_f32_16x16x32_bf16 v[44:47], a[64:67], a[28:31], v[44:47]
    s_waitcnt lgkmcnt(11)
    ds_read_b64 a[114:115], v9 offset:784
    v_mfma_f32_16x16x32_bf16 v[48:51], a[100:103], a[0:3], 0
    ds_read_b64_tr_b16 a[52:53], v10 offset:32640
    v_mfma_f32_16x16x32_bf16 v[48:51], a[96:99], a[4:7], v[48:51]
    ds_read_b64_tr_b16 a[54:55], v10 offset:32608
    v_mfma_f32_16x16x32_bf16 v[48:51], a[92:95], a[8:11], v[48:51]
    ds_read_b64 a[116:117], v9 offset:840
    v_mfma_f32_16x16x32_bf16 v[48:51], a[88:91], a[12:15], v[48:51]
    ds_read_b64 a[118:119], v9 offset:848
    v_mfma_f32_16x16x32_bf16 v[48:51], a[84:87], a[16:19], v[48:51]
    ds_read_b64_tr_b16 a[56:57], v10 offset:32896
    v_mfma_f32_16x16x32_bf16 v[48:51], a[80:83], a[20:23], v[48:51]
    ds_read_b64_tr_b16 a[58:59], v10 offset:32864
    v_mfma_f32_16x16x32_bf16 v[48:51], a[76:79], a[24:27], v[48:51]
    ds_read_b64 a[120:121], v9 offset:904
    v_mfma_f32_16x16x32_bf16 v[48:51], a[72:75], a[28:31], v[48:51]
    ds_read_b64 a[122:123], v9 offset:912
    v_mfma_f32_16x16x32_bf16 v[48:51], a[68:71], a[32:35], v[48:51]
    ds_read_b64_tr_b16 a[60:61], v10 offset:33152
    v_mfma_f32_16x16x32_bf16 v[48:51], a[64:67], a[36:39], v[48:51]
    s_waitcnt lgkmcnt(13)
    ds_read_b64_tr_b16 a[62:63], v10 offset:33120
    v_mfma_f32_16x16x32_bf16 v[52:55], a[108:111], a[0:3], 0
    ds_read_b64 a[124:125], v9 offset:968
    v_mfma_f32_16x16x32_bf16 v[52:55], a[104:107], a[4:7], v[52:55]
    ds_read_b64 a[126:127], v9 offset:976
    v_mfma_f32_16x16x32_bf16 v[52:55], a[100:103], a[8:11], v[52:55]
    ds_read_b64 a[128:129], v9 offset:1160
    v_mfma_f32_16x16x32_bf16 v[52:55], a[96:99], a[12:15], v[52:55]
    ds_read_b64 a[130:131], v9 offset:1168
    v_mfma_f32_16x16x32_bf16 v[52:55], a[92:95], a[16:19], v[52:55]
    ds_read_b64 a[132:133], v9 offset:1224
    v_mfma_f32_16x16x32_bf16 v[52:55], a[88:91], a[20:23], v[52:55]
    ds_read_b64 a[134:135], v9 offset:1232
    v_mfma_f32_16x16x32_bf16 v[52:55], a[84:87], a[24:27], v[52:55]
    ds_read_b64 a[136:137], v9 offset:1288
    v_mfma_f32_16x16x32_bf16 v[52:55], a[80:83], a[28:31], v[52:55]
    ds_read_b64 a[138:139], v9 offset:1296
    v_mfma_f32_16x16x32_bf16 v[52:55], a[76:79], a[32:35], v[52:55]
    ds_read_b64 a[140:141], v9 offset:1352
    v_mfma_f32_16x16x32_bf16 v[52:55], a[72:75], a[36:39], v[52:55]
    ds_read_b64 a[142:143], v9 offset:1360
    v_mfma_f32_16x16x32_bf16 v[52:55], a[68:71], a[40:43], v[52:55]
    ds_read_b64 a[144:145], v9 offset:1416
    v_mfma_f32_16x16x32_bf16 v[52:55], a[64:67], a[44:47], v[52:55]
    s_waitcnt lgkmcnt(15)
    ds_read_b64 a[146:147], v9 offset:1424
    v_mfma_f32_16x16x32_bf16 v[56:59], a[116:119], a[0:3], 0
    ds_read_b64 a[148:149], v9 offset:1480
    v_mfma_f32_16x16x32_bf16 v[56:59], a[112:115], a[4:7], v[56:59]
    ds_read_b64 a[150:151], v9 offset:1488
    v_mfma_f32_16x16x32_bf16 v[56:59], a[108:111], a[8:11], v[56:59]
    ds_read_b64 a[152:153], v9 offset:1544
    v_mfma_f32_16x16x32_bf16 v[56:59], a[104:107], a[12:15], v[56:59]
    ds_read_b64 a[154:155], v9 offset:1552
    v_mfma_f32_16x16x32_bf16 v[56:59], a[100:103], a[16:19], v[56:59]
    ds_read_b64 a[156:157], v9 offset:1608
    v_mfma_f32_16x16x32_bf16 v[56:59], a[96:99], a[20:23], v[56:59]
    ds_read_b64 a[158:159], v9 offset:1616
    v_mfma_f32_16x16x32_bf16 v[56:59], a[92:95], a[24:27], v[56:59]
    ds_read_b64 a[160:161], v9 offset:1672
    v_mfma_f32_16x16x32_bf16 v[56:59], a[88:91], a[28:31], v[56:59]
    ds_read_b64 a[162:163], v9 offset:1680
    v_mfma_f32_16x16x32_bf16 v[56:59], a[84:87], a[32:35], v[56:59]
    ds_read_b64 a[164:165], v9 offset:1736
    v_mfma_f32_16x16x32_bf16 v[56:59], a[80:83], a[36:39], v[56:59]
    ds_read_b64 a[166:167], v9 offset:1744
    v_mfma_f32_16x16x32_bf16 v[56:59], a[76:79], a[40:43], v[56:59]
    ds_read_b64 a[168:169], v9 offset:1800
    v_mfma_f32_16x16x32_bf16 v[56:59], a[72:75], a[44:47], v[56:59]
    ds_read_b64 a[170:171], v9 offset:1808
    v_mfma_f32_16x16x32_bf16 v[56:59], a[68:71], a[48:51], v[56:59]
    ds_read_b64 a[172:173], v9 offset:1864
    v_mfma_f32_16x16x32_bf16 v[56:59], a[64:67], a[52:55], v[56:59]
    s_waitcnt lgkmcnt(15)
    ds_read_b64 a[174:175], v9 offset:1872
    v_mfma_f32_16x16x32_bf16 v[60:63], a[124:127], a[0:3], 0
    ds_read_b64 a[176:177], v9 offset:1928
    v_mfma_f32_16x16x32_bf16 v[60:63], a[120:123], a[4:7], v[60:63]
    ds_read_b64 a[178:179], v9 offset:1936
    v_mfma_f32_16x16x32_bf16 v[60:63], a[116:119], a[8:11], v[60:63]
    ds_read_b64 a[180:181], v9 offset:1992
    v_mfma_f32_16x16x32_bf16 v[60:63], a[112:115], a[12:15], v[60:63]
    ds_read_b64 a[182:183], v9 offset:2000
    v_mfma_f32_16x16x32_bf16 v[60:63], a[108:111], a[16:19], v[60:63]
    ds_read_b64 a[184:185], v9 offset:2056
    v_mfma_f32_16x16x32_bf16 v[60:63], a[104:107], a[20:23], v[60:63]
    ds_read_b64 a[186:187], v9 offset:2064
    v_mfma_f32_16x16x32_bf16 v[60:63], a[100:103], a[24:27], v[60:63]
    ds_read_b64 a[188:189], v9 offset:2120
    v_mfma_f32_16x16x32_bf16 v[60:63], a[96:99], a[28:31], v[60:63]
    ds_read_b64 a[190:191], v9 offset:2128
    v_mfma_f32_16x16x32_bf16 v[60:63], a[92:95], a[32:35], v[60:63]
    v_mfma_f32_16x16x32_bf16 v[60:63], a[88:91], a[36:39], v[60:63]
    ds_write_b32 v11, v32 offset:4608
    v_mfma_f32_16x16x32_bf16 v[60:63], a[84:87], a[40:43], v[60:63]
    ds_write_b32 v11, v33 offset:4672
    v_mfma_f32_16x16x32_bf16 v[60:63], a[80:83], a[44:47], v[60:63]
    ds_write_b32 v11, v34 offset:4736
    v_mfma_f32_16x16x32_bf16 v[60:63], a[76:79], a[48:51], v[60:63]
    ds_write_b32 v11, v35 offset:4800
    v_mfma_f32_16x16x32_bf16 v[60:63], a[72:75], a[52:55], v[60:63]
    ds_write_b32 v11, v36 offset:5632
    v_mfma_f32_16x16x32_bf16 v[60:63], a[68:71], a[56:59], v[60:63]
    ds_write_b32 v11, v37 offset:5696
    v_mfma_f32_16x16x32_bf16 v[60:63], a[64:67], a[60:63], v[60:63]
    ds_write_b32 v11, v38 offset:5760
    v_mfma_f32_16x16x32_bf16 v[64:67], a[132:135], a[0:3], 0
    ds_write_b32 v11, v39 offset:5824
    v_mfma_f32_16x16x32_bf16 v[64:67], a[128:131], a[4:7], v[64:67]
    ds_write_b32 v11, v40 offset:6656
    v_mfma_f32_16x16x32_bf16 v[68:71], a[140:143], a[0:3], 0
    ds_write_b32 v11, v41 offset:6720
    v_mfma_f32_16x16x32_bf16 v[68:71], a[136:139], a[4:7], v[68:71]
    ds_write_b32 v11, v42 offset:6784
    v_mfma_f32_16x16x32_bf16 v[68:71], a[132:135], a[8:11], v[68:71]
    ds_write_b32 v11, v43 offset:6848
    v_mfma_f32_16x16x32_bf16 v[68:71], a[128:131], a[12:15], v[68:71]
    s_waitcnt lgkmcnt(15)
    ds_write_b32 v11, v44 offset:7680
    v_mfma_f32_16x16x32_bf16 v[72:75], a[148:151], a[0:3], 0
    ds_write_b32 v11, v45 offset:7744
    v_mfma_f32_16x16x32_bf16 v[72:75], a[144:147], a[4:7], v[72:75]
    ds_write_b32 v11, v46 offset:7808
    v_mfma_f32_16x16x32_bf16 v[72:75], a[140:143], a[8:11], v[72:75]
    ds_write_b32 v11, v47 offset:7872
    v_mfma_f32_16x16x32_bf16 v[72:75], a[136:139], a[12:15], v[72:75]
    ds_write_b32 v11, v48 offset:8704
    v_mfma_f32_16x16x32_bf16 v[72:75], a[132:135], a[16:19], v[72:75]
    ds_write_b32 v11, v49 offset:8768
    v_mfma_f32_16x16x32_bf16 v[72:75], a[128:131], a[20:23], v[72:75]
    ds_write_b32 v11, v50 offset:8832
    v_mfma_f32_16x16x32_bf16 v[76:79], a[156:159], a[0:3], 0
    ds_write_b32 v11, v51 offset:8896
    v_mfma_f32_16x16x32_bf16 v[76:79], a[152:155], a[4:7], v[76:79]
    ds_write_b32 v11, v52 offset:9728
    v_mfma_f32_16x16x32_bf16 v[76:79], a[148:151], a[8:11], v[76:79]
    ds_write_b32 v11, v53 offset:9792
    v_mfma_f32_16x16x32_bf16 v[76:79], a[144:147], a[12:15], v[76:79]
    ds_write_b32 v11, v54 offset:9856
    v_mfma_f32_16x16x32_bf16 v[76:79], a[140:143], a[16:19], v[76:79]
    ds_write_b32 v11, v55 offset:9920
    v_mfma_f32_16x16x32_bf16 v[76:79], a[136:139], a[20:23], v[76:79]
    ds_write_b32 v11, v56 offset:10752
    v_mfma_f32_16x16x32_bf16 v[76:79], a[132:135], a[24:27], v[76:79]
    ds_write_b32 v11, v57 offset:10816
    v_mfma_f32_16x16x32_bf16 v[76:79], a[128:131], a[28:31], v[76:79]
    ds_write_b32 v11, v58 offset:10880
    v_mfma_f32_16x16x32_bf16 v[80:83], a[164:167], a[0:3], 0
    ds_write_b32 v11, v59 offset:10944
    v_mfma_f32_16x16x32_bf16 v[80:83], a[160:163], a[4:7], v[80:83]
    ds_write_b32 v11, v60 offset:11776
    v_mfma_f32_16x16x32_bf16 v[80:83], a[156:159], a[8:11], v[80:83]
    ds_write_b32 v11, v61 offset:11840
    v_mfma_f32_16x16x32_bf16 v[80:83], a[152:155], a[12:15], v[80:83]
    ds_write_b32 v11, v62 offset:11904
    v_mfma_f32_16x16x32_bf16 v[80:83], a[148:151], a[16:19], v[80:83]
    ds_write_b32 v11, v63 offset:11968
    v_mfma_f32_16x16x32_bf16 v[80:83], a[144:147], a[20:23], v[80:83]
    ds_write_b32 v11, v64 offset:12836
    v_mfma_f32_16x16x32_bf16 v[80:83], a[140:143], a[24:27], v[80:83]
    ds_write_b32 v11, v65 offset:12900
    v_mfma_f32_16x16x32_bf16 v[80:83], a[136:139], a[28:31], v[80:83]
    ds_write_b32 v11, v66 offset:12964
    v_mfma_f32_16x16x32_bf16 v[80:83], a[132:135], a[32:35], v[80:83]
    ds_write_b32 v11, v67 offset:13028
    v_mfma_f32_16x16x32_bf16 v[80:83], a[128:131], a[36:39], v[80:83]
    ds_write_b32 v11, v68 offset:13860
    v_mfma_f32_16x16x32_bf16 v[84:87], a[172:175], a[0:3], 0
    ds_write_b32 v11, v69 offset:13924
    v_mfma_f32_16x16x32_bf16 v[84:87], a[168:171], a[4:7], v[84:87]
    ds_read_b64 a[64:65], v9 offset:2312
    v_mfma_f32_16x16x32_bf16 v[84:87], a[164:167], a[8:11], v[84:87]
    ds_read_b64 a[66:67], v9 offset:2320
    v_mfma_f32_16x16x32_bf16 v[84:87], a[160:163], a[12:15], v[84:87]
    ds_read_b64 a[68:69], v9 offset:2376
    v_mfma_f32_16x16x32_bf16 v[84:87], a[156:159], a[16:19], v[84:87]
    ds_read_b64 a[70:71], v9 offset:2384
    v_mfma_f32_16x16x32_bf16 v[84:87], a[152:155], a[20:23], v[84:87]
    ds_read_b64 a[72:73], v9 offset:2440
    v_mfma_f32_16x16x32_bf16 v[84:87], a[148:151], a[24:27], v[84:87]
    ds_read_b64 a[74:75], v9 offset:2448
    v_mfma_f32_16x16x32_bf16 v[84:87], a[144:147], a[28:31], v[84:87]
    ds_read_b64 a[76:77], v9 offset:2504
    v_mfma_f32_16x16x32_bf16 v[84:87], a[140:143], a[32:35], v[84:87]
    ds_read_b64 a[78:79], v9 offset:2512
    v_mfma_f32_16x16x32_bf16 v[84:87], a[136:139], a[36:39], v[84:87]
    ds_read_b64 a[80:81], v9 offset:2568
    v_mfma_f32_16x16x32_bf16 v[84:87], a[132:135], a[40:43], v[84:87]
    ds_read_b64 a[82:83], v9 offset:2576
    v_mfma_f32_16x16x32_bf16 v[84:87], a[128:131], a[44:47], v[84:87]
    ds_read_b64 a[84:85], v9 offset:2632
    v_mfma_f32_16x16x32_bf16 v[88:91], a[180:183], a[0:3], 0
    ds_read_b64 a[86:87], v9 offset:2640
    v_mfma_f32_16x16x32_bf16 v[88:91], a[176:179], a[4:7], v[88:91]
    ds_read_b64 a[88:89], v9 offset:2696
    v_mfma_f32_16x16x32_bf16 v[88:91], a[172:175], a[8:11], v[88:91]
    ds_read_b64 a[90:91], v9 offset:2704
    v_mfma_f32_16x16x32_bf16 v[88:91], a[168:171], a[12:15], v[88:91]
    ds_read_b64 a[92:93], v9 offset:2760
    v_mfma_f32_16x16x32_bf16 v[88:91], a[164:167], a[16:19], v[88:91]
    ds_read_b64 a[94:95], v9 offset:2768
    v_mfma_f32_16x16x32_bf16 v[88:91], a[160:163], a[20:23], v[88:91]
    ds_read_b64 a[96:97], v9 offset:2824
    v_mfma_f32_16x16x32_bf16 v[88:91], a[156:159], a[24:27], v[88:91]
    ds_read_b64 a[98:99], v9 offset:2832
    v_mfma_f32_16x16x32_bf16 v[88:91], a[152:155], a[28:31], v[88:91]
    ds_read_b64 a[100:101], v9 offset:2888
    v_mfma_f32_16x16x32_bf16 v[88:91], a[148:151], a[32:35], v[88:91]
    ds_read_b64 a[102:103], v9 offset:2896
    v_mfma_f32_16x16x32_bf16 v[88:91], a[144:147], a[36:39], v[88:91]
    ds_read_b64 a[104:105], v9 offset:2952
    v_mfma_f32_16x16x32_bf16 v[88:91], a[140:143], a[40:43], v[88:91]
    ds_read_b64 a[106:107], v9 offset:2960
    v_mfma_f32_16x16x32_bf16 v[88:91], a[136:139], a[44:47], v[88:91]
    ds_read_b64 a[108:109], v9 offset:3016
    v_mfma_f32_16x16x32_bf16 v[88:91], a[132:135], a[48:51], v[88:91]
    ds_read_b64 a[110:111], v9 offset:3024
    v_mfma_f32_16x16x32_bf16 v[88:91], a[128:131], a[52:55], v[88:91]
    s_waitcnt lgkmcnt(15)
    ds_read_b64 a[112:113], v9 offset:3080
    v_mfma_f32_16x16x32_bf16 v[92:95], a[188:191], a[0:3], 0
    ds_read_b64 a[114:115], v9 offset:3088
    v_mfma_f32_16x16x32_bf16 v[92:95], a[184:187], a[4:7], v[92:95]
    ds_read_b64 a[116:117], v9 offset:3144
    v_mfma_f32_16x16x32_bf16 v[92:95], a[180:183], a[8:11], v[92:95]
    ds_read_b64 a[118:119], v9 offset:3152
    v_mfma_f32_16x16x32_bf16 v[92:95], a[176:179], a[12:15], v[92:95]
    ds_read_b64 a[120:121], v9 offset:3208
    v_mfma_f32_16x16x32_bf16 v[92:95], a[172:175], a[16:19], v[92:95]
    ds_read_b64 a[122:123], v9 offset:3216
    v_mfma_f32_16x16x32_bf16 v[92:95], a[168:171], a[20:23], v[92:95]
    ds_read_b64 a[124:125], v9 offset:3272
    v_mfma_f32_16x16x32_bf16 v[92:95], a[164:167], a[24:27], v[92:95]
    ds_read_b64 a[126:127], v9 offset:3280
    v_mfma_f32_16x16x32_bf16 v[92:95], a[160:163], a[28:31], v[92:95]
    ds_write_b32 v11, v70 offset:13988
    v_mfma_f32_16x16x32_bf16 v[92:95], a[156:159], a[32:35], v[92:95]
    ds_write_b32 v11, v71 offset:14052
    v_mfma_f32_16x16x32_bf16 v[92:95], a[152:155], a[36:39], v[92:95]
    ds_write_b32 v11, v72 offset:14884
    v_mfma_f32_16x16x32_bf16 v[92:95], a[148:151], a[40:43], v[92:95]
    ds_write_b32 v11, v73 offset:14948
    v_mfma_f32_16x16x32_bf16 v[92:95], a[144:147], a[44:47], v[92:95]
    ds_write_b32 v11, v74 offset:15012
    v_mfma_f32_16x16x32_bf16 v[92:95], a[140:143], a[48:51], v[92:95]
    ds_write_b32 v11, v75 offset:15076
    v_mfma_f32_16x16x32_bf16 v[92:95], a[136:139], a[52:55], v[92:95]
    ds_write_b32 v11, v76 offset:15908
    v_mfma_f32_16x16x32_bf16 v[92:95], a[132:135], a[56:59], v[92:95]
    ds_write_b32 v11, v77 offset:15972
    v_mfma_f32_16x16x32_bf16 v[92:95], a[128:131], a[60:63], v[92:95]
    ds_write_b32 v11, v78 offset:16036
    v_mfma_f32_16x16x32_bf16 v[32:35], a[68:71], a[0:3], 0
    ds_write_b32 v11, v79 offset:16100
    v_mfma_f32_16x16x32_bf16 v[32:35], a[64:67], a[4:7], v[32:35]
    ds_write_b32 v11, v80 offset:16932
    v_mfma_f32_16x16x32_bf16 v[36:39], a[76:79], a[0:3], 0
    ds_write_b32 v11, v81 offset:16996
    v_mfma_f32_16x16x32_bf16 v[36:39], a[72:75], a[4:7], v[36:39]
    ds_write_b32 v11, v82 offset:17060
    v_mfma_f32_16x16x32_bf16 v[36:39], a[68:71], a[8:11], v[36:39]
    ds_write_b32 v11, v83 offset:17124
    v_mfma_f32_16x16x32_bf16 v[36:39], a[64:67], a[12:15], v[36:39]
    s_waitcnt lgkmcnt(15)
    ds_write_b32 v11, v84 offset:17956
    v_mfma_f32_16x16x32_bf16 v[40:43], a[84:87], a[0:3], 0
    ds_write_b32 v11, v85 offset:18020
    v_mfma_f32_16x16x32_bf16 v[40:43], a[80:83], a[4:7], v[40:43]
    ds_write_b32 v11, v86 offset:18084
    v_mfma_f32_16x16x32_bf16 v[40:43], a[76:79], a[8:11], v[40:43]
    ds_write_b32 v11, v87 offset:18148
    v_mfma_f32_16x16x32_bf16 v[40:43], a[72:75], a[12:15], v[40:43]
    ds_write_b32 v11, v88 offset:18980
    v_mfma_f32_16x16x32_bf16 v[40:43], a[68:71], a[16:19], v[40:43]
    ds_write_b32 v11, v89 offset:19044
    v_mfma_f32_16x16x32_bf16 v[40:43], a[64:67], a[20:23], v[40:43]
    ds_write_b32 v11, v90 offset:19108
    v_mfma_f32_16x16x32_bf16 v[44:47], a[92:95], a[0:3], 0
    ds_write_b32 v11, v91 offset:19172
    v_mfma_f32_16x16x32_bf16 v[44:47], a[88:91], a[4:7], v[44:47]
    ds_write_b32 v11, v92 offset:20004
    v_mfma_f32_16x16x32_bf16 v[44:47], a[84:87], a[8:11], v[44:47]
    ds_write_b32 v11, v93 offset:20068
    v_mfma_f32_16x16x32_bf16 v[44:47], a[80:83], a[12:15], v[44:47]
    ds_write_b32 v11, v94 offset:20132
    v_mfma_f32_16x16x32_bf16 v[44:47], a[76:79], a[16:19], v[44:47]
    ds_write_b32 v11, v95 offset:20196
    v_mfma_f32_16x16x32_bf16 v[44:47], a[72:75], a[20:23], v[44:47]
    ds_write_b32 v11, v32 offset:21064
    v_mfma_f32_16x16x32_bf16 v[44:47], a[68:71], a[24:27], v[44:47]
    ds_write_b32 v11, v33 offset:21128
    v_mfma_f32_16x16x32_bf16 v[44:47], a[64:67], a[28:31], v[44:47]
    ds_write_b32 v11, v34 offset:21192
    v_mfma_f32_16x16x32_bf16 v[48:51], a[100:103], a[0:3], 0
    ds_write_b32 v11, v35 offset:21256
    v_mfma_f32_16x16x32_bf16 v[48:51], a[96:99], a[4:7], v[48:51]
    ds_write_b32 v11, v36 offset:22088
    v_mfma_f32_16x16x32_bf16 v[48:51], a[92:95], a[8:11], v[48:51]
    ds_write_b32 v11, v37 offset:22152
    v_mfma_f32_16x16x32_bf16 v[48:51], a[88:91], a[12:15], v[48:51]
    ds_write_b32 v11, v38 offset:22216
    v_mfma_f32_16x16x32_bf16 v[48:51], a[84:87], a[16:19], v[48:51]
    ds_write_b32 v11, v39 offset:22280
    v_mfma_f32_16x16x32_bf16 v[48:51], a[80:83], a[20:23], v[48:51]
    ds_write_b32 v11, v40 offset:23112
    v_mfma_f32_16x16x32_bf16 v[48:51], a[76:79], a[24:27], v[48:51]
    ds_write_b32 v11, v41 offset:23176
    v_mfma_f32_16x16x32_bf16 v[48:51], a[72:75], a[28:31], v[48:51]
    ds_write_b32 v11, v42 offset:23240
    v_mfma_f32_16x16x32_bf16 v[48:51], a[68:71], a[32:35], v[48:51]
    ds_write_b32 v11, v43 offset:23304
    v_mfma_f32_16x16x32_bf16 v[48:51], a[64:67], a[36:39], v[48:51]
    ds_write_b32 v11, v44 offset:24136
    v_mfma_f32_16x16x32_bf16 v[52:55], a[108:111], a[0:3], 0
    ds_write_b32 v11, v45 offset:24200
    v_mfma_f32_16x16x32_bf16 v[52:55], a[104:107], a[4:7], v[52:55]
    ds_read_b64 a[128:129], v9 offset:3464
    v_mfma_f32_16x16x32_bf16 v[52:55], a[100:103], a[8:11], v[52:55]
    ds_read_b64 a[130:131], v9 offset:3472
    v_mfma_f32_16x16x32_bf16 v[52:55], a[96:99], a[12:15], v[52:55]
    ds_read_b64 a[132:133], v9 offset:3528
    v_mfma_f32_16x16x32_bf16 v[52:55], a[92:95], a[16:19], v[52:55]
    ds_read_b64 a[134:135], v9 offset:3536
    v_mfma_f32_16x16x32_bf16 v[52:55], a[88:91], a[20:23], v[52:55]
    ds_read_b64 a[136:137], v9 offset:3592
    v_mfma_f32_16x16x32_bf16 v[52:55], a[84:87], a[24:27], v[52:55]
    ds_read_b64 a[138:139], v9 offset:3600
    v_mfma_f32_16x16x32_bf16 v[52:55], a[80:83], a[28:31], v[52:55]
    ds_read_b64 a[140:141], v9 offset:3656
    v_mfma_f32_16x16x32_bf16 v[52:55], a[76:79], a[32:35], v[52:55]
    ds_read_b64 a[142:143], v9 offset:3664
    v_mfma_f32_16x16x32_bf16 v[52:55], a[72:75], a[36:39], v[52:55]
    ds_read_b64 a[144:145], v9 offset:3720
    v_mfma_f32_16x16x32_bf16 v[52:55], a[68:71], a[40:43], v[52:55]
    ds_read_b64 a[146:147], v9 offset:3728
    v_mfma_f32_16x16x32_bf16 v[52:55], a[64:67], a[44:47], v[52:55]
    ds_read_b64 a[148:149], v9 offset:3784
    v_mfma_f32_16x16x32_bf16 v[56:59], a[116:119], a[0:3], 0
    ds_read_b64 a[150:151], v9 offset:3792
    v_mfma_f32_16x16x32_bf16 v[56:59], a[112:115], a[4:7], v[56:59]
    ds_read_b64 a[152:153], v9 offset:3848
    v_mfma_f32_16x16x32_bf16 v[56:59], a[108:111], a[8:11], v[56:59]
    ds_read_b64 a[154:155], v9 offset:3856
    v_mfma_f32_16x16x32_bf16 v[56:59], a[104:107], a[12:15], v[56:59]
    ds_read_b64 a[156:157], v9 offset:3912
    v_mfma_f32_16x16x32_bf16 v[56:59], a[100:103], a[16:19], v[56:59]
    ds_read_b64 a[158:159], v9 offset:3920
    v_mfma_f32_16x16x32_bf16 v[56:59], a[96:99], a[20:23], v[56:59]
    ds_read_b64 a[160:161], v9 offset:3976
    v_mfma_f32_16x16x32_bf16 v[56:59], a[92:95], a[24:27], v[56:59]
    ds_read_b64 a[162:163], v9 offset:3984
    v_mfma_f32_16x16x32_bf16 v[56:59], a[88:91], a[28:31], v[56:59]
    ds_read_b64 a[164:165], v9 offset:4040
    v_mfma_f32_16x16x32_bf16 v[56:59], a[84:87], a[32:35], v[56:59]
    ds_read_b64 a[166:167], v9 offset:4048
    v_mfma_f32_16x16x32_bf16 v[56:59], a[80:83], a[36:39], v[56:59]
    ds_read_b64 a[168:169], v9 offset:4104
    v_mfma_f32_16x16x32_bf16 v[56:59], a[76:79], a[40:43], v[56:59]
    ds_read_b64 a[170:171], v9 offset:4112
    v_mfma_f32_16x16x32_bf16 v[56:59], a[72:75], a[44:47], v[56:59]
    ds_read_b64 a[172:173], v9 offset:4168
    v_mfma_f32_16x16x32_bf16 v[56:59], a[68:71], a[48:51], v[56:59]
    ds_read_b64 a[174:175], v9 offset:4176
    v_mfma_f32_16x16x32_bf16 v[56:59], a[64:67], a[52:55], v[56:59]
    s_waitcnt lgkmcnt(15)
    ds_read_b64 a[176:177], v9 offset:4232
    v_mfma_f32_16x16x32_bf16 v[60:63], a[124:127], a[0:3], 0
    ds_read_b64 a[178:179], v9 offset:4240
    v_mfma_f32_16x16x32_bf16 v[60:63], a[120:123], a[4:7], v[60:63]
    ds_read_b64 a[180:181], v9 offset:4296
    v_mfma_f32_16x16x32_bf16 v[60:63], a[116:119], a[8:11], v[60:63]
    ds_read_b64 a[182:183], v9 offset:4304
    v_mfma_f32_16x16x32_bf16 v[60:63], a[112:115], a[12:15], v[60:63]
    ds_read_b64 a[184:185], v9 offset:4360
    v_mfma_f32_16x16x32_bf16 v[60:63], a[108:111], a[16:19], v[60:63]
    ds_read_b64 a[186:187], v9 offset:4368
    v_mfma_f32_16x16x32_bf16 v[60:63], a[104:107], a[20:23], v[60:63]
    ds_read_b64 a[188:189], v9 offset:4424
    v_mfma_f32_16x16x32_bf16 v[60:63], a[100:103], a[24:27], v[60:63]
    ds_read_b64 a[190:191], v9 offset:4432
    v_mfma_f32_16x16x32_bf16 v[60:63], a[96:99], a[28:31], v[60:63]
    ds_write_b32 v11, v46 offset:24264
    v_mfma_f32_16x16x32_bf16 v[60:63], a[92:95], a[32:35], v[60:63]
    ds_write_b32 v11, v47 offset:24328
    v_mfma_f32_16x16x32_bf16 v[60:63], a[88:91], a[36:39], v[60:63]
    ds_write_b32 v11, v48 offset:25160
    v_mfma_f32_16x16x32_bf16 v[60:63], a[84:87], a[40:43], v[60:63]
    ds_write_b32 v11, v49 offset:25224
    v_mfma_f32_16x16x32_bf16 v[60:63], a[80:83], a[44:47], v[60:63]
    ds_write_b32 v11, v50 offset:25288
    v_mfma_f32_16x16x32_bf16 v[60:63], a[76:79], a[48:51], v[60:63]
    ds_write_b32 v11, v51 offset:25352
    v_mfma_f32_16x16x32_bf16 v[60:63], a[72:75], a[52:55], v[60:63]
    ds_write_b32 v11, v52 offset:26184
    v_mfma_f32_16x16x32_bf16 v[60:63], a[68:71], a[56:59], v[60:63]
    ds_write_b32 v11, v53 offset:26248
    v_mfma_f32_16x16x32_bf16 v[60:63], a[64:67], a[60:63], v[60:63]
    ds_write_b32 v11, v54 offset:26312
    v_mfma_f32_16x16x32_bf16 v[64:67], a[132:135], a[0:3], 0
    ds_write_b32 v11, v55 offset:26376
    v_mfma_f32_16x16x32_bf16 v[64:67], a[128:131], a[4:7], v[64:67]
    ds_write_b32 v11, v56 offset:27208
    v_mfma_f32_16x16x32_bf16 v[68:71], a[140:143], a[0:3], 0
    ds_write_b32 v11, v57 offset:27272
    v_mfma_f32_16x16x32_bf16 v[68:71], a[136:139], a[4:7], v[68:71]
    ds_write_b32 v11, v58 offset:27336
    v_mfma_f32_16x16x32_bf16 v[68:71], a[132:135], a[8:11], v[68:71]
    ds_write_b32 v11, v59 offset:27400
    v_mfma_f32_16x16x32_bf16 v[68:71], a[128:131], a[12:15], v[68:71]
    s_waitcnt lgkmcnt(15)
    v_mfma_f32_16x16x32_bf16 v[72:75], a[148:151], a[0:3], 0
    v_mfma_f32_16x16x32_bf16 v[72:75], a[144:147], a[4:7], v[72:75]
    v_mfma_f32_16x16x32_bf16 v[72:75], a[140:143], a[8:11], v[72:75]
    ds_write_b32 v11, v60 offset:28232
    v_mfma_f32_16x16x32_bf16 v[72:75], a[136:139], a[12:15], v[72:75]
    ds_write_b32 v11, v61 offset:28296
    v_mfma_f32_16x16x32_bf16 v[72:75], a[132:135], a[16:19], v[72:75]
    ds_write_b32 v11, v62 offset:28360
    v_mfma_f32_16x16x32_bf16 v[72:75], a[128:131], a[20:23], v[72:75]
    ds_write_b32 v11, v63 offset:28424
    v_mfma_f32_16x16x32_bf16 v[76:79], a[156:159], a[0:3], 0
    ds_write_b32 v11, v64 offset:29292
    v_mfma_f32_16x16x32_bf16 v[76:79], a[152:155], a[4:7], v[76:79]
    ds_write_b32 v11, v65 offset:29356
    v_mfma_f32_16x16x32_bf16 v[76:79], a[148:151], a[8:11], v[76:79]
    ds_write_b32 v11, v66 offset:29420
    v_mfma_f32_16x16x32_bf16 v[76:79], a[144:147], a[12:15], v[76:79]
    ds_write_b32 v11, v67 offset:29484
    v_mfma_f32_16x16x32_bf16 v[76:79], a[140:143], a[16:19], v[76:79]
    ds_write_b32 v11, v68 offset:30316
    v_mfma_f32_16x16x32_bf16 v[76:79], a[136:139], a[20:23], v[76:79]
    ds_write_b32 v11, v69 offset:30380
    v_mfma_f32_16x16x32_bf16 v[76:79], a[132:135], a[24:27], v[76:79]
    ds_write_b32 v11, v70 offset:30444
    v_mfma_f32_16x16x32_bf16 v[76:79], a[128:131], a[28:31], v[76:79]
    ds_write_b32 v11, v71 offset:30508
    v_mfma_f32_16x16x32_bf16 v[80:83], a[164:167], a[0:3], 0
    ds_write_b32 v11, v72 offset:31340
    v_mfma_f32_16x16x32_bf16 v[80:83], a[160:163], a[4:7], v[80:83]
    ds_write_b32 v11, v73 offset:31404
    v_mfma_f32_16x16x32_bf16 v[80:83], a[156:159], a[8:11], v[80:83]
    ds_write_b32 v11, v74 offset:31468
    v_mfma_f32_16x16x32_bf16 v[80:83], a[152:155], a[12:15], v[80:83]
    ds_write_b32 v11, v75 offset:31532
    v_mfma_f32_16x16x32_bf16 v[80:83], a[148:151], a[16:19], v[80:83]
    v_mfma_f32_16x16x32_bf16 v[80:83], a[144:147], a[20:23], v[80:83]
    v_mfma_f32_16x16x32_bf16 v[80:83], a[140:143], a[24:27], v[80:83]
    v_mfma_f32_16x16x32_bf16 v[80:83], a[136:139], a[28:31], v[80:83]
    v_mfma_f32_16x16x32_bf16 v[80:83], a[132:135], a[32:35], v[80:83]
    ds_write_b32 v11, v76 offset:32364
    v_mfma_f32_16x16x32_bf16 v[80:83], a[128:131], a[36:39], v[80:83]
    ds_write_b32 v11, v77 offset:32428
    v_mfma_f32_16x16x32_bf16 v[84:87], a[172:175], a[0:3], 0
    ds_write_b32 v11, v78 offset:32492
    v_mfma_f32_16x16x32_bf16 v[84:87], a[168:171], a[4:7], v[84:87]
    ds_write_b32 v11, v79 offset:32556
    v_mfma_f32_16x16x32_bf16 v[84:87], a[164:167], a[8:11], v[84:87]
    v_mfma_f32_16x16x32_bf16 v[84:87], a[160:163], a[12:15], v[84:87]
    v_mfma_f32_16x16x32_bf16 v[84:87], a[156:159], a[16:19], v[84:87]
    v_mfma_f32_16x16x32_bf16 v[84:87], a[152:155], a[20:23], v[84:87]
    v_mfma_f32_16x16x32_bf16 v[84:87], a[148:151], a[24:27], v[84:87]
    v_mfma_f32_16x16x32_bf16 v[84:87], a[144:147], a[28:31], v[84:87]
    v_mfma_f32_16x16x32_bf16 v[84:87], a[140:143], a[32:35], v[84:87]
    ds_write_b32 v11, v80 offset:33388
    v_mfma_f32_16x16x32_bf16 v[84:87], a[136:139], a[36:39], v[84:87]
    ds_write_b32 v11, v81 offset:33452
    v_mfma_f32_16x16x32_bf16 v[84:87], a[132:135], a[40:43], v[84:87]
    ds_write_b32 v11, v82 offset:33516
    v_mfma_f32_16x16x32_bf16 v[84:87], a[128:131], a[44:47], v[84:87]
    ds_write_b32 v11, v83 offset:33580
    v_mfma_f32_16x16x32_bf16 v[88:91], a[180:183], a[0:3], 0
    v_mfma_f32_16x16x32_bf16 v[88:91], a[176:179], a[4:7], v[88:91]
    v_mfma_f32_16x16x32_bf16 v[88:91], a[172:175], a[8:11], v[88:91]
    v_mfma_f32_16x16x32_bf16 v[88:91], a[168:171], a[12:15], v[88:91]
    v_mfma_f32_16x16x32_bf16 v[88:91], a[164:167], a[16:19], v[88:91]
    v_mfma_f32_16x16x32_bf16 v[88:91], a[160:163], a[20:23], v[88:91]
    v_mfma_f32_16x16x32_bf16 v[88:91], a[156:159], a[24:27], v[88:91]
    v_mfma_f32_16x16x32_bf16 v[88:91], a[152:155], a[28:31], v[88:91]
    v_mfma_f32_16x16x32_bf16 v[88:91], a[148:151], a[32:35], v[88:91]
    ds_write_b32 v11, v84 offset:34412
    v_mfma_f32_16x16x32_bf16 v[88:91], a[144:147], a[36:39], v[88:91]
    ds_write_b32 v11, v85 offset:34476
    v_mfma_f32_16x16x32_bf16 v[88:91], a[140:143], a[40:43], v[88:91]
    ds_write_b32 v11, v86 offset:34540
    v_mfma_f32_16x16x32_bf16 v[88:91], a[136:139], a[44:47], v[88:91]
    ds_write_b32 v11, v87 offset:34604
    v_mfma_f32_16x16x32_bf16 v[88:91], a[132:135], a[48:51], v[88:91]
    v_mfma_f32_16x16x32_bf16 v[88:91], a[128:131], a[52:55], v[88:91]
    s_waitcnt lgkmcnt(15)
    v_mfma_f32_16x16x32_bf16 v[92:95], a[188:191], a[0:3], 0
    v_mfma_f32_16x16x32_bf16 v[92:95], a[184:187], a[4:7], v[92:95]
    v_mfma_f32_16x16x32_bf16 v[92:95], a[180:183], a[8:11], v[92:95]
    v_mfma_f32_16x16x32_bf16 v[92:95], a[176:179], a[12:15], v[92:95]
    v_mfma_f32_16x16x32_bf16 v[92:95], a[172:175], a[16:19], v[92:95]
    v_mfma_f32_16x16x32_bf16 v[92:95], a[168:171], a[20:23], v[92:95]
    v_mfma_f32_16x16x32_bf16 v[92:95], a[164:167], a[24:27], v[92:95]
    v_mfma_f32_16x16x32_bf16 v[92:95], a[160:163], a[28:31], v[92:95]
    v_mfma_f32_16x16x32_bf16 v[92:95], a[156:159], a[32:35], v[92:95]
    ds_write_b32 v11, v88 offset:35436
    v_mfma_f32_16x16x32_bf16 v[92:95], a[152:155], a[36:39], v[92:95]
    ds_write_b32 v11, v89 offset:35500
    v_mfma_f32_16x16x32_bf16 v[92:95], a[148:151], a[40:43], v[92:95]
    ds_write_b32 v11, v90 offset:35564
    v_mfma_f32_16x16x32_bf16 v[92:95], a[144:147], a[44:47], v[92:95]
    ds_write_b32 v11, v91 offset:35628
    v_mfma_f32_16x16x32_bf16 v[92:95], a[140:143], a[48:51], v[92:95]
    v_mfma_f32_16x16x32_bf16 v[92:95], a[136:139], a[52:55], v[92:95]
    v_mfma_f32_16x16x32_bf16 v[92:95], a[132:135], a[56:59], v[92:95]
    v_mfma_f32_16x16x32_bf16 v[92:95], a[128:131], a[60:63], v[92:95]
    s_nop 7
    ds_write_b32 v11, v92 offset:36460
    ds_write_b32 v11, v93 offset:36524
    ds_write_b32 v11, v94 offset:36588
    ds_write_b32 v11, v95 offset:36652
    s_waitcnt lgkmcnt(0)
    ds_read_b128 v[96:99], v12 offset:4608
    ds_read_b128 v[100:103], v12 offset:4624
    ds_read_b32 v128, v5 offset:128
    ds_read_b128 v[104:107], v12 offset:12832
    ds_read_b128 v[108:111], v12 offset:12848
    ds_read_b32 v129, v5 offset:1280
    ds_read_b128 v[112:115], v12 offset:21056
    ds_read_b128 v[116:119], v12 offset:21072
    ds_read_b32 v130, v5 offset:2432
    ds_read_b128 v[120:123], v12 offset:29280
    ds_read_b128 v[124:127], v12 offset:29296
    ds_read_b32 v131, v5 offset:3584
    s_waitcnt lgkmcnt(0)
    v_pk_add_f32 v[96:97], v[96:97], v[104:105]
    v_pk_add_f32 v[112:113], v[112:113], v[120:121]
    v_pk_add_f32 v[96:97], v[96:97], v[112:113]
    v_pk_add_f32 v[98:99], v[98:99], v[106:107]
    v_pk_add_f32 v[114:115], v[114:115], v[122:123]
    v_pk_add_f32 v[98:99], v[98:99], v[114:115]
    v_pk_add_f32 v[100:101], v[100:101], v[108:109]
    v_pk_add_f32 v[116:117], v[116:117], v[124:125]
    v_pk_add_f32 v[100:101], v[100:101], v[116:117]
    v_pk_add_f32 v[102:103], v[102:103], v[110:111]
    v_pk_add_f32 v[118:119], v[118:119], v[126:127]
    v_pk_add_f32 v[102:103], v[102:103], v[118:119]
    v_lshlrev_b32 v16, 16, v128
    v_fmac_f32 v96, s43, v16
    v_lshlrev_b32 v16, 16, v129
    v_fmac_f32 v97, s43, v16
    v_lshlrev_b32 v16, 16, v130
    v_fmac_f32 v98, s43, v16
    v_lshlrev_b32 v16, 16, v131
    v_fmac_f32 v99, s43, v16
    v_and_b32 v16, s45, v128
    v_fmac_f32 v100, s43, v16
    v_and_b32 v16, s45, v129
    v_fmac_f32 v101, s43, v16
    v_and_b32 v16, s45, v130
    v_fmac_f32 v102, s43, v16
    v_and_b32 v16, s45, v131
    v_fmac_f32 v103, s43, v16
    v_cvt_pk_bf16_f32 v132, v96, v97
    v_cvt_pk_bf16_f32 v133, v98, v99
    v_cvt_pk_bf16_f32 v134, v100, v101
    v_cvt_pk_bf16_f32 v135, v102, v103
    buffer_store_dwordx4 v[132:135], v1, s[12:15], s42 offen offset:0 sc1
    ds_read_b128 v[136:139], v12 offset:6656
    ds_read_b128 v[140:143], v12 offset:6672
    ds_read_b32 v168, v5 offset:384
    ds_read_b128 v[144:147], v12 offset:14880
    ds_read_b128 v[148:151], v12 offset:14896
    ds_read_b32 v169, v5 offset:1536
    ds_read_b128 v[152:155], v12 offset:23104
    ds_read_b128 v[156:159], v12 offset:23120
    ds_read_b32 v170, v5 offset:2688
    ds_read_b128 v[160:163], v12 offset:31328
    ds_read_b128 v[164:167], v12 offset:31344
    ds_read_b32 v171, v5 offset:3840
    s_waitcnt lgkmcnt(0)
    v_pk_add_f32 v[136:137], v[136:137], v[144:145]
    v_pk_add_f32 v[152:153], v[152:153], v[160:161]
    v_pk_add_f32 v[136:137], v[136:137], v[152:153]
    v_pk_add_f32 v[138:139], v[138:139], v[146:147]
    v_pk_add_f32 v[154:155], v[154:155], v[162:163]
    v_pk_add_f32 v[138:139], v[138:139], v[154:155]
    v_pk_add_f32 v[140:141], v[140:141], v[148:149]
    v_pk_add_f32 v[156:157], v[156:157], v[164:165]
    v_pk_add_f32 v[140:141], v[140:141], v[156:157]
    v_pk_add_f32 v[142:143], v[142:143], v[150:151]
    v_pk_add_f32 v[158:159], v[158:159], v[166:167]
    v_pk_add_f32 v[142:143], v[142:143], v[158:159]
    v_lshlrev_b32 v16, 16, v168
    v_fmac_f32 v136, s43, v16
    v_lshlrev_b32 v16, 16, v169
    v_fmac_f32 v137, s43, v16
    v_lshlrev_b32 v16, 16, v170
    v_fmac_f32 v138, s43, v16
    v_lshlrev_b32 v16, 16, v171
    v_fmac_f32 v139, s43, v16
    v_and_b32 v16, s45, v168
    v_fmac_f32 v140, s43, v16
    v_and_b32 v16, s45, v169
    v_fmac_f32 v141, s43, v16
    v_and_b32 v16, s45, v170
    v_fmac_f32 v142, s43, v16
    v_and_b32 v16, s45, v171
    v_fmac_f32 v143, s43, v16
    v_cvt_pk_bf16_f32 v172, v136, v137
    v_cvt_pk_bf16_f32 v173, v138, v139
    v_cvt_pk_bf16_f32 v174, v140, v141
    v_cvt_pk_bf16_f32 v175, v142, v143
    buffer_store_dwordx4 v[172:175], v1, s[12:15], s42 offen offset:1024 sc1
    ds_read_b128 v[96:99], v12 offset:8704
    ds_read_b128 v[100:103], v12 offset:8720
    ds_read_b32 v128, v5 offset:640
    ds_read_b128 v[104:107], v12 offset:16928
    ds_read_b128 v[108:111], v12 offset:16944
    ds_read_b32 v129, v5 offset:1792
    ds_read_b128 v[112:115], v12 offset:25152
    ds_read_b128 v[116:119], v12 offset:25168
    ds_read_b32 v130, v5 offset:2944
    ds_read_b128 v[120:123], v12 offset:33376
    ds_read_b128 v[124:127], v12 offset:33392
    ds_read_b32 v131, v5 offset:4096
    s_waitcnt lgkmcnt(0)
    v_pk_add_f32 v[96:97], v[96:97], v[104:105]
    v_pk_add_f32 v[112:113], v[112:113], v[120:121]
    v_pk_add_f32 v[96:97], v[96:97], v[112:113]
    v_pk_add_f32 v[98:99], v[98:99], v[106:107]
    v_pk_add_f32 v[114:115], v[114:115], v[122:123]
    v_pk_add_f32 v[98:99], v[98:99], v[114:115]
    v_pk_add_f32 v[100:101], v[100:101], v[108:109]
    v_pk_add_f32 v[116:117], v[116:117], v[124:125]
    v_pk_add_f32 v[100:101], v[100:101], v[116:117]
    v_pk_add_f32 v[102:103], v[102:103], v[110:111]
    v_pk_add_f32 v[118:119], v[118:119], v[126:127]
    v_pk_add_f32 v[102:103], v[102:103], v[118:119]
    v_lshlrev_b32 v16, 16, v128
    v_fmac_f32 v96, s43, v16
    v_lshlrev_b32 v16, 16, v129
    v_fmac_f32 v97, s43, v16
    v_lshlrev_b32 v16, 16, v130
    v_fmac_f32 v98, s43, v16
    v_lshlrev_b32 v16, 16, v131
    v_fmac_f32 v99, s43, v16
    v_and_b32 v16, s45, v128
    v_fmac_f32 v100, s43, v16
    v_and_b32 v16, s45, v129
    v_fmac_f32 v101, s43, v16
    v_and_b32 v16, s45, v130
    v_fmac_f32 v102, s43, v16
    v_and_b32 v16, s45, v131
    v_fmac_f32 v103, s43, v16
    v_cvt_pk_bf16_f32 v132, v96, v97
    v_cvt_pk_bf16_f32 v133, v98, v99
    v_cvt_pk_bf16_f32 v134, v100, v101
    v_cvt_pk_bf16_f32 v135, v102, v103
    buffer_store_dwordx4 v[132:135], v1, s[12:15], s42 offen offset:2048 sc1
    ds_read_b128 v[136:139], v12 offset:10752
    ds_read_b128 v[140:143], v12 offset:10768
    ds_read_b32 v168, v5 offset:896
    ds_read_b128 v[144:147], v12 offset:18976
    ds_read_b128 v[148:151], v12 offset:18992
    ds_read_b32 v169, v5 offset:2048
    ds_read_b128 v[152:155], v12 offset:27200
    ds_read_b128 v[156:159], v12 offset:27216
    ds_read_b32 v170, v5 offset:3200
    ds_read_b128 v[160:163], v12 offset:35424
    ds_read_b128 v[164:167], v12 offset:35440
    ds_read_b32 v171, v5 offset:4352
    s_waitcnt lgkmcnt(0)
    v_pk_add_f32 v[136:137], v[136:137], v[144:145]
    v_pk_add_f32 v[152:153], v[152:153], v[160:161]
    v_pk_add_f32 v[136:137], v[136:137], v[152:153]
    v_pk_add_f32 v[138:139], v[138:139], v[146:147]
    v_pk_add_f32 v[154:155], v[154:155], v[162:163]
    v_pk_add_f32 v[138:139], v[138:139], v[154:155]
    v_pk_add_f32 v[140:141], v[140:141], v[148:149]
    v_pk_add_f32 v[156:157], v[156:157], v[164:165]
    v_pk_add_f32 v[140:141], v[140:141], v[156:157]
    v_pk_add_f32 v[142:143], v[142:143], v[150:151]
    v_pk_add_f32 v[158:159], v[158:159], v[166:167]
    v_pk_add_f32 v[142:143], v[142:143], v[158:159]
    v_lshlrev_b32 v16, 16, v168
    v_fmac_f32 v136, s43, v16
    v_lshlrev_b32 v16, 16, v169
    v_fmac_f32 v137, s43, v16
    v_lshlrev_b32 v16, 16, v170
    v_fmac_f32 v138, s43, v16
    v_lshlrev_b32 v16, 16, v171
    v_fmac_f32 v139, s43, v16
    v_and_b32 v16, s45, v168
    v_fmac_f32 v140, s43, v16
    v_and_b32 v16, s45, v169
    v_fmac_f32 v141, s43, v16
    v_and_b32 v16, s45, v170
    v_fmac_f32 v142, s43, v16
    v_and_b32 v16, s45, v171
    v_fmac_f32 v143, s43, v16
    v_cvt_pk_bf16_f32 v172, v136, v137
    v_cvt_pk_bf16_f32 v173, v138, v139
    v_cvt_pk_bf16_f32 v174, v140, v141
    v_cvt_pk_bf16_f32 v175, v142, v143
    buffer_store_dwordx4 v[172:175], v1, s[12:15], s42 offen offset:3072 sc1
    s_lshl_b32 s35, s95, 2
    s_add_u32 s35, s35, 84963328
    s_waitcnt vmcnt(0)
    s_barrier
    s_cmp_lg_u32 s3, 0
    s_cbranch_scc1 L_pub9
    v_mov_b32 v14, 0
    v_mov_b32 v15, 1
    s_mov_b64 exec, 1
    buffer_store_dword v15, v14, s[12:15], s35 offen sc1
    s_mov_b64 exec, -1
L_pub9:
L_s2end:
    s_lshl_b32 s33, s24, 1
    s_and_b32 s34, s28, 1
    s_add_u32 s33, s33, s34
    s_xor_b32 s34, s27, 1
    s_lshl_b32 s34, s34, 4
    s_add_u32 s33, s33, s34
    s_lshr_b32 s34, s28, 1
    v_lshlrev_b32 v1, 4, v0
    v_lshrrev_b32 v3, 3, v0
    v_mul_u32_u24 v4, 896, v3
    v_and_b32 v3, 6, v3
    v_xor_b32 v3, v3, v0
    v_and_b32 v3, 7, v3
    v_lshl_add_u32 v3, v3, 4, v4
    v_lshrrev_b32 v8, 2, v0
    v_lshlrev_b32 v4, 7, v8
    v_bfe_u32 v8, v8, 1, 2
    v_lshl_add_u32 v4, v8, 5, v4
    v_and_b32 v8, 3, v0
    v_lshl_add_u32 v4, v8, 3, v4
    s_lshl_b32 s35, s3, 15
    v_add_u32 v4, s35, v4
    v_xor_b32 v5, 32, v4
    v_xor_b32 v6, 64, v4
    v_xor_b32 v7, 96, v4
    s_mul_i32 s36, s3, 917504
    s_lshl_b32 s41, s34, 7
    s_add_u32 s36, s36, s41
    s_lshl_b32 s37, s33, 19
    s_add_u32 s37, s37, s35
    s_add_u32 s37, s37, 50331648
    v_add_u32 v9, 131072, v1
    v_add_u32 v13, 7168, v3
    v_add_u32 v10, 262144, v1
    v_add_u32 v14, 14336, v3
    v_add_u32 v11, 393216, v1
    v_add_u32 v15, 21504, v3
    s_mov_b32 s4, s86
    s_mov_b32 s5, s87
    s_mov_b32 s6, 3670016
    s_mov_b32 s7, 0x20000
    s_mov_b32 s8, s88
    s_mov_b32 s9, s89
    s_mov_b32 s10, 3670016
    s_mov_b32 s11, 0x20000
    s_mov_b32 s16, s64
    s_mov_b32 s17, s65
    s_mov_b32 s18, 1835008
    s_mov_b32 s19, 0x20000
    s_add_u32 m0, s35, 0
    s_nop 0
    buffer_load_dwordx4 v3, s[4:7], s36 offen lds
    s_add_u32 m0, s35, 1024
    s_nop 0
    buffer_load_dwordx4 v13, s[4:7], s36 offen lds
    s_add_u32 m0, s35, 2048
    s_nop 0
    buffer_load_dwordx4 v14, s[4:7], s36 offen lds
    s_add_u32 m0, s35, 3072
    s_nop 0
    buffer_load_dwordx4 v15, s[4:7], s36 offen lds
    s_add_u32 s36, s36, 28672
    s_add_u32 m0, s35, 4096
    s_nop 0
    buffer_load_dwordx4 v3, s[4:7], s36 offen lds
    s_add_u32 m0, s35, 5120
    s_nop 0
    buffer_load_dwordx4 v13, s[4:7], s36 offen lds
    s_add_u32 m0, s35, 6144
    s_nop 0
    buffer_load_dwordx4 v14, s[4:7], s36 offen lds
    s_add_u32 m0, s35, 7168
    s_nop 0
    buffer_load_dwordx4 v15, s[4:7], s36 offen lds
    s_add_u32 s36, s36, 28672
    s_add_u32 m0, s35, 8192
    s_nop 0
    buffer_load_dwordx4 v3, s[4:7], s36 offen lds
    s_add_u32 m0, s35, 9216
    s_nop 0
    buffer_load_dwordx4 v13, s[4:7], s36 offen lds
    s_add_u32 m0, s35, 10240
    s_nop 0
    buffer_load_dwordx4 v14, s[4:7], s36 offen lds
    s_add_u32 m0, s35, 11264
    s_nop 0
    buffer_load_dwordx4 v15, s[4:7], s36 offen lds
    s_add_u32 s36, s36, 28672
    s_add_u32 m0, s35, 12288
    s_nop 0
    buffer_load_dwordx4 v3, s[4:7], s36 offen lds
    s_add_u32 m0, s35, 13312
    s_nop 0
    buffer_load_dwordx4 v13, s[4:7], s36 offen lds
    s_add_u32 m0, s35, 14336
    s_nop 0
    buffer_load_dwordx4 v14, s[4:7], s36 offen lds
    s_add_u32 m0, s35, 15360
    s_nop 0
    buffer_load_dwordx4 v15, s[4:7], s36 offen lds
    s_add_u32 s36, s36, 28672
    s_add_u32 m0, s35, 16384
    s_nop 0
    buffer_load_dwordx4 v3, s[4:7], s36 offen lds
    s_add_u32 m0, s35, 17408
    s_nop 0
    buffer_load_dwordx4 v13, s[4:7], s36 offen lds
    s_add_u32 m0, s35, 18432
    s_nop 0
    buffer_load_dwordx4 v14, s[4:7], s36 offen lds
    s_add_u32 m0, s35, 19456
    s_nop 0
    buffer_load_dwordx4 v15, s[4:7], s36 offen lds
    s_add_u32 s36, s36, 28672
    s_add_u32 m0, s35, 20480
    s_nop 0
    buffer_load_dwordx4 v3, s[4:7], s36 offen lds
    s_add_u32 m0, s35, 21504
    s_nop 0
    buffer_load_dwordx4 v13, s[4:7], s36 offen lds
    s_add_u32 m0, s35, 22528
    s_nop 0
    buffer_load_dwordx4 v14, s[4:7], s36 offen lds
    s_add_u32 m0, s35, 23552
    s_nop 0
    buffer_load_dwordx4 v15, s[4:7], s36 offen lds
    s_add_u32 s36, s36, 28672
    v_mov_b64 v[64:65], 0
    v_mov_b64 v[66:67], 0
    v_mov_b64 v[68:69], 0
    v_mov_b64 v[70:71], 0
    v_mov_b64 v[72:73], 0
    v_mov_b64 v[74:75], 0
    v_mov_b64 v[76:77], 0
    v_mov_b64 v[78:79], 0
    v_mov_b64 v[80:81], 0
    v_mov_b64 v[82:83], 0
    v_mov_b64 v[84:85], 0
    v_mov_b64 v[86:87], 0
    v_mov_b64 v[88:89], 0
    v_mov_b64 v[90:91], 0
    v_mov_b64 v[92:93], 0
    v_mov_b64 v[94:95], 0
    v_mov_b64 v[96:97], 0
    v_mov_b64 v[98:99], 0
    v_mov_b64 v[100:101], 0
    v_mov_b64 v[102:103], 0
    v_mov_b64 v[104:105], 0
    v_mov_b64 v[106:107], 0
    v_mov_b64 v[108:109], 0
    v_mov_b64 v[110:111], 0
    v_mov_b64 v[112:113], 0
    v_mov_b64 v[114:115], 0
    v_mov_b64 v[116:117], 0
    v_mov_b64 v[118:119], 0
    v_mov_b64 v[120:121], 0
    v_mov_b64 v[122:123], 0
    v_mov_b64 v[124:125], 0
    v_mov_b64 v[126:127], 0
    s_lshr_b32 s44, s33, 1
    s_lshl_b32 s44, s44, 7
    s_add_u32 s44, s44, 84938752
    v_and_b32 v16, 15, v0
    v_lshlrev_b32 v16, 2, v16
    s_mov_b32 s100, 0
L_poll10:
    buffer_load_dword v17, v16, s[12:15], s44 offen sc1
    s_waitcnt vmcnt(0)
    v_cmp_ne_u32 vcc, 1, v17
    s_cbranch_vccz L_poll10_ok
    s_sleep 2
    s_add_u32 s100, s100, 1
    s_cmp_lt_u32 s100, 0x80000
    s_cbranch_scc1 L_poll10
L_poll10_ok:
    buffer_load_dwordx4 a[0:3], v1, s[12:15], s37 offen sc1
    buffer_load_dwordx4 a[4:7], v9, s[12:15], s37 offen sc1
    buffer_load_dwordx4 a[8:11], v10, s[12:15], s37 offen sc1
    buffer_load_dwordx4 a[12:15], v11, s[12:15], s37 offen sc1
    s_add_u32 s37, s37, 1024
    buffer_load_dwordx4 a[16:19], v1, s[12:15], s37 offen sc1
    buffer_load_dwordx4 a[20:23], v9, s[12:15], s37 offen sc1
    buffer_load_dwordx4 a[24:27], v10, s[12:15], s37 offen sc1
    buffer_load_dwordx4 a[28:31], v11, s[12:15], s37 offen sc1
    s_add_u32 s37, s37, 1024
    buffer_load_dwordx4 a[32:35], v1, s[12:15], s37 offen sc1
    buffer_load_dwordx4 a[36:39], v9, s[12:15], s37 offen sc1
    buffer_load_dwordx4 a[40:43], v10, s[12:15], s37 offen sc1
    buffer_load_dwordx4 a[44:47], v11, s[12:15], s37 offen sc1
    s_add_u32 s37, s37, 1024
    buffer_load_dwordx4 a[48:51], v1, s[12:15], s37 offen sc1
    buffer_load_dwordx4 a[52:55], v9, s[12:15], s37 offen sc1
    buffer_load_dwordx4 a[56:59], v10, s[12:15], s37 offen sc1
    buffer_load_dwordx4 a[60:63], v11, s[12:15], s37 offen sc1
    s_add_u32 s37, s37, 1024
    buffer_load_dwordx4 a[64:67], v1, s[12:15], s37 offen sc1
    buffer_load_dwordx4 a[68:71], v9, s[12:15], s37 offen sc1
    buffer_load_dwordx4 a[72:75], v10, s[12:15], s37 offen sc1
    buffer_load_dwordx4 a[76:79], v11, s[12:15], s37 offen sc1
    s_add_u32 s37, s37, 1024
    buffer_load_dwordx4 a[80:83], v1, s[12:15], s37 offen sc1
    buffer_load_dwordx4 a[84:87], v9, s[12:15], s37 offen sc1
    buffer_load_dwordx4 a[88:91], v10, s[12:15], s37 offen sc1
    buffer_load_dwordx4 a[92:95], v11, s[12:15], s37 offen sc1
    s_add_u32 s37, s37, 1024
    ds_read_b64_tr_b16 v[32:33], v4 offset:0
    ds_read_b64_tr_b16 v[34:35], v4 offset:2048
    ds_read_b64_tr_b16 v[36:37], v5 offset:0
    ds_read_b64_tr_b16 v[38:39], v5 offset:2048
    ds_read_b64_tr_b16 v[40:41], v6 offset:0
    ds_read_b64_tr_b16 v[42:43], v6 offset:2048
    ds_read_b64_tr_b16 v[44:45], v7 offset:0
    ds_read_b64_tr_b16 v[46:47], v7 offset:2048
    s_waitcnt vmcnt(0)
    s_mov_b32 s42, 0
    s_mov_b32 s43, 0xf0000000
.p2align 6
L_oloop:
    s_waitcnt vmcnt(32) lgkmcnt(0)
    v_mfma_f32_16x16x32_bf16 v[64:67], v[32:35], a[0:3], v[64:67]
    s_add_u32 m0, s35, 24576
    ds_read_b64_tr_b16 v[48:49], v4 offset:4096
    v_mfma_f32_16x16x32_bf16 v[68:71], v[32:35], a[4:7], v[68:71]
    buffer_load_dwordx4 v3, s[4:7], s36 offen lds
    v_mfma_f32_16x16x32_bf16 v[72:75], v[32:35], a[8:11], v[72:75]
    ds_read_b64_tr_b16 v[50:51], v4 offset:6144
    v_mfma_f32_16x16x32_bf16 v[76:79], v[32:35], a[12:15], v[76:79]
    buffer_load_dwordx4 a[96:99], v1, s[12:15], s37 offen sc1
    v_mfma_f32_16x16x32_bf16 v[80:83], v[36:39], a[0:3], v[80:83]
    s_add_u32 m0, s35, 25600
    ds_read_b64_tr_b16 v[52:53], v5 offset:4096
    v_mfma_f32_16x16x32_bf16 v[84:87], v[36:39], a[4:7], v[84:87]
    buffer_load_dwordx4 v13, s[4:7], s36 offen lds
    v_mfma_f32_16x16x32_bf16 v[88:91], v[36:39], a[8:11], v[88:91]
    ds_read_b64_tr_b16 v[54:55], v5 offset:6144
    v_mfma_f32_16x16x32_bf16 v[92:95], v[36:39], a[12:15], v[92:95]
    buffer_load_dwordx4 a[100:103], v9, s[12:15], s37 offen sc1
    v_mfma_f32_16x16x32_bf16 v[96:99], v[40:43], a[0:3], v[96:99]
    s_add_u32 m0, s35, 26624
    ds_read_b64_tr_b16 v[56:57], v6 offset:4096
    v_mfma_f32_16x16x32_bf16 v[100:103], v[40:43], a[4:7], v[100:103]
    buffer_load_dwordx4 v14, s[4:7], s36 offen lds
    v_mfma_f32_16x16x32_bf16 v[104:107], v[40:43], a[8:11], v[104:107]
    ds_read_b64_tr_b16 v[58:59], v6 offset:6144
    v_mfma_f32_16x16x32_bf16 v[108:111], v[40:43], a[12:15], v[108:111]
    buffer_load_dwordx4 a[104:107], v10, s[12:15], s37 offen sc1
    v_mfma_f32_16x16x32_bf16 v[112:115], v[44:47], a[0:3], v[112:115]
    s_add_u32 m0, s35, 27648
    ds_read_b64_tr_b16 v[60:61], v7 offset:4096
    v_mfma_f32_16x16x32_bf16 v[116:119], v[44:47], a[4:7], v[116:119]
    buffer_load_dwordx4 v15, s[4:7], s36 offen lds
    v_mfma_f32_16x16x32_bf16 v[120:123], v[44:47], a[8:11], v[120:123]
    ds_read_b64_tr_b16 v[62:63], v7 offset:6144
    v_mfma_f32_16x16x32_bf16 v[124:127], v[44:47], a[12:15], v[124:127]
    buffer_load_dwordx4 a[108:111], v11, s[12:15], s37 offen sc1
    s_add_u32 s36, s36, 28672
    s_add_u32 s37, s37, 1024
    s_waitcnt vmcnt(32) lgkmcnt(0)
    v_mfma_f32_16x16x32_bf16 v[64:67], v[48:51], a[16:19], v[64:67]
    s_add_u32 m0, s35, 28672
    ds_read_b64_tr_b16 v[32:33], v4 offset:8192
    v_mfma_f32_16x16x32_bf16 v[68:71], v[48:51], a[20:23], v[68:71]
    buffer_load_dwordx4 v3, s[4:7], s36 offen lds
    v_mfma_f32_16x16x32_bf16 v[72:75], v[48:51], a[24:27], v[72:75]
    ds_read_b64_tr_b16 v[34:35], v4 offset:10240
    v_mfma_f32_16x16x32_bf16 v[76:79], v[48:51], a[28:31], v[76:79]
    buffer_load_dwordx4 a[112:115], v1, s[12:15], s37 offen sc1
    v_mfma_f32_16x16x32_bf16 v[80:83], v[52:55], a[16:19], v[80:83]
    s_add_u32 m0, s35, 29696
    ds_read_b64_tr_b16 v[36:37], v5 offset:8192
    v_mfma_f32_16x16x32_bf16 v[84:87], v[52:55], a[20:23], v[84:87]
    buffer_load_dwordx4 v13, s[4:7], s36 offen lds
    v_mfma_f32_16x16x32_bf16 v[88:91], v[52:55], a[24:27], v[88:91]
    ds_read_b64_tr_b16 v[38:39], v5 offset:10240
    v_mfma_f32_16x16x32_bf16 v[92:95], v[52:55], a[28:31], v[92:95]
    buffer_load_dwordx4 a[116:119], v9, s[12:15], s37 offen sc1
    v_mfma_f32_16x16x32_bf16 v[96:99], v[56:59], a[16:19], v[96:99]
    s_add_u32 m0, s35, 30720
    ds_read_b64_tr_b16 v[40:41], v6 offset:8192
    v_mfma_f32_16x16x32_bf16 v[100:103], v[56:59], a[20:23], v[100:103]
    buffer_load_dwordx4 v14, s[4:7], s36 offen lds
    v_mfma_f32_16x16x32_bf16 v[104:107], v[56:59], a[24:27], v[104:107]
    ds_read_b64_tr_b16 v[42:43], v6 offset:10240
    v_mfma_f32_16x16x32_bf16 v[108:111], v[56:59], a[28:31], v[108:111]
    buffer_load_dwordx4 a[120:123], v10, s[12:15], s37 offen sc1
    v_mfma_f32_16x16x32_bf16 v[112:115], v[60:63], a[16:19], v[112:115]
    s_add_u32 m0, s35, 31744
    ds_read_b64_tr_b16 v[44:45], v7 offset:8192
    v_mfma_f32_16x16x32_bf16 v[116:119], v[60:63], a[20:23], v[116:119]
    buffer_load_dwordx4 v15, s[4:7], s36 offen lds
    v_mfma_f32_16x16x32_bf16 v[120:123], v[60:63], a[24:27], v[120:123]
    ds_read_b64_tr_b16 v[46:47], v7 offset:10240
    v_mfma_f32_16x16x32_bf16 v[124:127], v[60:63], a[28:31], v[124:127]
    buffer_load_dwordx4 a[124:127], v11, s[12:15], s37 offen sc1
    s_add_u32 s36, s36, 28672
    s_add_u32 s37, s37, 1024
    s_cmp_eq_u32 s42, 3
    s_cmov_b32 s36, s43
    s_cmov_b32 s37, s43
    s_waitcnt vmcnt(32) lgkmcnt(0)
    v_mfma_f32_16x16x32_bf16 v[64:67], v[32:35], a[32:35], v[64:67]
    s_add_u32 m0, s35, 0
    ds_read_b64_tr_b16 v[48:49], v4 offset:12288
    v_mfma_f32_16x16x32_bf16 v[68:71], v[32:35], a[36:39], v[68:71]
    buffer_load_dwordx4 v3, s[4:7], s36 offen lds
    v_mfma_f32_16x16x32_bf16 v[72:75], v[32:35], a[40:43], v[72:75]
    ds_read_b64_tr_b16 v[50:51], v4 offset:14336
    v_mfma_f32_16x16x32_bf16 v[76:79], v[32:35], a[44:47], v[76:79]
    buffer_load_dwordx4 a[0:3], v1, s[12:15], s37 offen sc1
    v_mfma_f32_16x16x32_bf16 v[80:83], v[36:39], a[32:35], v[80:83]
    s_add_u32 m0, s35, 1024
    ds_read_b64_tr_b16 v[52:53], v5 offset:12288
    v_mfma_f32_16x16x32_bf16 v[84:87], v[36:39], a[36:39], v[84:87]
    buffer_load_dwordx4 v13, s[4:7], s36 offen lds
    v_mfma_f32_16x16x32_bf16 v[88:91], v[36:39], a[40:43], v[88:91]
    ds_read_b64_tr_b16 v[54:55], v5 offset:14336
    v_mfma_f32_16x16x32_bf16 v[92:95], v[36:39], a[44:47], v[92:95]
    buffer_load_dwordx4 a[4:7], v9, s[12:15], s37 offen sc1
    v_mfma_f32_16x16x32_bf16 v[96:99], v[40:43], a[32:35], v[96:99]
    s_add_u32 m0, s35, 2048
    ds_read_b64_tr_b16 v[56:57], v6 offset:12288
    v_mfma_f32_16x16x32_bf16 v[100:103], v[40:43], a[36:39], v[100:103]
    buffer_load_dwordx4 v14, s[4:7], s36 offen lds
    v_mfma_f32_16x16x32_bf16 v[104:107], v[40:43], a[40:43], v[104:107]
    ds_read_b64_tr_b16 v[58:59], v6 offset:14336
    v_mfma_f32_16x16x32_bf16 v[108:111], v[40:43], a[44:47], v[108:111]
    buffer_load_dwordx4 a[8:11], v10, s[12:15], s37 offen sc1
    v_mfma_f32_16x16x32_bf16 v[112:115], v[44:47], a[32:35], v[112:115]
    s_add_u32 m0, s35, 3072
    ds_read_b64_tr_b16 v[60:61], v7 offset:12288
    v_mfma_f32_16x16x32_bf16 v[116:119], v[44:47], a[36:39], v[116:119]
    buffer_load_dwordx4 v15, s[4:7], s36 offen lds
    v_mfma_f32_16x16x32_bf16 v[120:123], v[44:47], a[40:43], v[120:123]
    ds_read_b64_tr_b16 v[62:63], v7 offset:14336
    v_mfma_f32_16x16x32_bf16 v[124:127], v[44:47], a[44:47], v[124:127]
    buffer_load_dwordx4 a[12:15], v11, s[12:15], s37 offen sc1
    s_add_u32 s36, s36, 28672
    s_add_u32 s37, s37, 1024
    s_waitcnt vmcnt(32) lgkmcnt(0)
    v_mfma_f32_16x16x32_bf16 v[64:67], v[48:51], a[48:51], v[64:67]
    s_add_u32 m0, s35, 4096
    ds_read_b64_tr_b16 v[32:33], v4 offset:16384
    v_mfma_f32_16x16x32_bf16 v[68:71], v[48:51], a[52:55], v[68:71]
    buffer_load_dwordx4 v3, s[4:7], s36 offen lds
    v_mfma_f32_16x16x32_bf16 v[72:75], v[48:51], a[56:59], v[72:75]
    ds_read_b64_tr_b16 v[34:35], v4 offset:18432
    v_mfma_f32_16x16x32_bf16 v[76:79], v[48:51], a[60:63], v[76:79]
    buffer_load_dwordx4 a[16:19], v1, s[12:15], s37 offen sc1
    v_mfma_f32_16x16x32_bf16 v[80:83], v[52:55], a[48:51], v[80:83]
    s_add_u32 m0, s35, 5120
    ds_read_b64_tr_b16 v[36:37], v5 offset:16384
    v_mfma_f32_16x16x32_bf16 v[84:87], v[52:55], a[52:55], v[84:87]
    buffer_load_dwordx4 v13, s[4:7], s36 offen lds
    v_mfma_f32_16x16x32_bf16 v[88:91], v[52:55], a[56:59], v[88:91]
    ds_read_b64_tr_b16 v[38:39], v5 offset:18432
    v_mfma_f32_16x16x32_bf16 v[92:95], v[52:55], a[60:63], v[92:95]
    buffer_load_dwordx4 a[20:23], v9, s[12:15], s37 offen sc1
    v_mfma_f32_16x16x32_bf16 v[96:99], v[56:59], a[48:51], v[96:99]
    s_add_u32 m0, s35, 6144
    ds_read_b64_tr_b16 v[40:41], v6 offset:16384
    v_mfma_f32_16x16x32_bf16 v[100:103], v[56:59], a[52:55], v[100:103]
    buffer_load_dwordx4 v14, s[4:7], s36 offen lds
    v_mfma_f32_16x16x32_bf16 v[104:107], v[56:59], a[56:59], v[104:107]
    ds_read_b64_tr_b16 v[42:43], v6 offset:18432
    v_mfma_f32_16x16x32_bf16 v[108:111], v[56:59], a[60:63], v[108:111]
    buffer_load_dwordx4 a[24:27], v10, s[12:15], s37 offen sc1
    v_mfma_f32_16x16x32_bf16 v[112:115], v[60:63], a[48:51], v[112:115]
    s_add_u32 m0, s35, 7168
    ds_read_b64_tr_b16 v[44:45], v7 offset:16384
    v_mfma_f32_16x16x32_bf16 v[116:119], v[60:63], a[52:55], v[116:119]
    buffer_load_dwordx4 v15, s[4:7], s36 offen lds
    v_mfma_f32_16x16x32_bf16 v[120:123], v[60:63], a[56:59], v[120:123]
    ds_read_b64_tr_b16 v[46:47], v7 offset:18432
    v_mfma_f32_16x16x32_bf16 v[124:127], v[60:63], a[60:63], v[124:127]
    buffer_load_dwordx4 a[28:31], v11, s[12:15], s37 offen sc1
    s_add_u32 s36, s36, 28672
    s_add_u32 s37, s37, 1024
    s_waitcnt vmcnt(32) lgkmcnt(0)
    v_mfma_f32_16x16x32_bf16 v[64:67], v[32:35], a[64:67], v[64:67]
    s_add_u32 m0, s35, 8192
    ds_read_b64_tr_b16 v[48:49], v4 offset:20480
    v_mfma_f32_16x16x32_bf16 v[68:71], v[32:35], a[68:71], v[68:71]
    buffer_load_dwordx4 v3, s[4:7], s36 offen lds
    v_mfma_f32_16x16x32_bf16 v[72:75], v[32:35], a[72:75], v[72:75]
    ds_read_b64_tr_b16 v[50:51], v4 offset:22528
    v_mfma_f32_16x16x32_bf16 v[76:79], v[32:35], a[76:79], v[76:79]
    buffer_load_dwordx4 a[32:35], v1, s[12:15], s37 offen sc1
    v_mfma_f32_16x16x32_bf16 v[80:83], v[36:39], a[64:67], v[80:83]
    s_add_u32 m0, s35, 9216
    ds_read_b64_tr_b16 v[52:53], v5 offset:20480
    v_mfma_f32_16x16x32_bf16 v[84:87], v[36:39], a[68:71], v[84:87]
    buffer_load_dwordx4 v13, s[4:7], s36 offen lds
    v_mfma_f32_16x16x32_bf16 v[88:91], v[36:39], a[72:75], v[88:91]
    ds_read_b64_tr_b16 v[54:55], v5 offset:22528
    v_mfma_f32_16x16x32_bf16 v[92:95], v[36:39], a[76:79], v[92:95]
    buffer_load_dwordx4 a[36:39], v9, s[12:15], s37 offen sc1
    v_mfma_f32_16x16x32_bf16 v[96:99], v[40:43], a[64:67], v[96:99]
    s_add_u32 m0, s35, 10240
    ds_read_b64_tr_b16 v[56:57], v6 offset:20480
    v_mfma_f32_16x16x32_bf16 v[100:103], v[40:43], a[68:71], v[100:103]
    buffer_load_dwordx4 v14, s[4:7], s36 offen lds
    v_mfma_f32_16x16x32_bf16 v[104:107], v[40:43], a[72:75], v[104:107]
    ds_read_b64_tr_b16 v[58:59], v6 offset:22528
    v_mfma_f32_16x16x32_bf16 v[108:111], v[40:43], a[76:79], v[108:111]
    buffer_load_dwordx4 a[40:43], v10, s[12:15], s37 offen sc1
    v_mfma_f32_16x16x32_bf16 v[112:115], v[44:47], a[64:67], v[112:115]
    s_add_u32 m0, s35, 11264
    ds_read_b64_tr_b16 v[60:61], v7 offset:20480
    v_mfma_f32_16x16x32_bf16 v[116:119], v[44:47], a[68:71], v[116:119]
    buffer_load_dwordx4 v15, s[4:7], s36 offen lds
    v_mfma_f32_16x16x32_bf16 v[120:123], v[44:47], a[72:75], v[120:123]
    ds_read_b64_tr_b16 v[62:63], v7 offset:22528
    v_mfma_f32_16x16x32_bf16 v[124:127], v[44:47], a[76:79], v[124:127]
    buffer_load_dwordx4 a[44:47], v11, s[12:15], s37 offen sc1
    s_add_u32 s36, s36, 28672
    s_add_u32 s37, s37, 1024
    s_waitcnt vmcnt(32) lgkmcnt(0)
    v_mfma_f32_16x16x32_bf16 v[64:67], v[48:51], a[80:83], v[64:67]
    s_add_u32 m0, s35, 12288
    ds_read_b64_tr_b16 v[32:33], v4 offset:24576
    v_mfma_f32_16x16x32_bf16 v[68:71], v[48:51], a[84:87], v[68:71]
    buffer_load_dwordx4 v3, s[4:7], s36 offen lds
    v_mfma_f32_16x16x32_bf16 v[72:75], v[48:51], a[88:91], v[72:75]
    ds_read_b64_tr_b16 v[34:35], v4 offset:26624
    v_mfma_f32_16x16x32_bf16 v[76:79], v[48:51], a[92:95], v[76:79]
    buffer_load_dwordx4 a[48:51], v1, s[12:15], s37 offen sc1
    v_mfma_f32_16x16x32_bf16 v[80:83], v[52:55], a[80:83], v[80:83]
    s_add_u32 m0, s35, 13312
    ds_read_b64_tr_b16 v[36:37], v5 offset:24576
    v_mfma_f32_16x16x32_bf16 v[84:87], v[52:55], a[84:87], v[84:87]
    buffer_load_dwordx4 v13, s[4:7], s36 offen lds
    v_mfma_f32_16x16x32_bf16 v[88:91], v[52:55], a[88:91], v[88:91]
    ds_read_b64_tr_b16 v[38:39], v5 offset:26624
    v_mfma_f32_16x16x32_bf16 v[92:95], v[52:55], a[92:95], v[92:95]
    buffer_load_dwordx4 a[52:55], v9, s[12:15], s37 offen sc1
    v_mfma_f32_16x16x32_bf16 v[96:99], v[56:59], a[80:83], v[96:99]
    s_add_u32 m0, s35, 14336
    ds_read_b64_tr_b16 v[40:41], v6 offset:24576
    v_mfma_f32_16x16x32_bf16 v[100:103], v[56:59], a[84:87], v[100:103]
    buffer_load_dwordx4 v14, s[4:7], s36 offen lds
    v_mfma_f32_16x16x32_bf16 v[104:107], v[56:59], a[88:91], v[104:107]
    ds_read_b64_tr_b16 v[42:43], v6 offset:26624
    v_mfma_f32_16x16x32_bf16 v[108:111], v[56:59], a[92:95], v[108:111]
    buffer_load_dwordx4 a[56:59], v10, s[12:15], s37 offen sc1
    v_mfma_f32_16x16x32_bf16 v[112:115], v[60:63], a[80:83], v[112:115]
    s_add_u32 m0, s35, 15360
    ds_read_b64_tr_b16 v[44:45], v7 offset:24576
    v_mfma_f32_16x16x32_bf16 v[116:119], v[60:63], a[84:87], v[116:119]
    buffer_load_dwordx4 v15, s[4:7], s36 offen lds
    v_mfma_f32_16x16x32_bf16 v[120:123], v[60:63], a[88:91], v[120:123]
    ds_read_b64_tr_b16 v[46:47], v7 offset:26624
    v_mfma_f32_16x16x32_bf16 v[124:127], v[60:63], a[92:95], v[124:127]
    buffer_load_dwordx4 a[60:63], v11, s[12:15], s37 offen sc1
    s_add_u32 s36, s36, 28672
    s_add_u32 s37, s37, 1024
    s_waitcnt vmcnt(32) lgkmcnt(0)
    v_mfma_f32_16x16x32_bf16 v[64:67], v[32:35], a[96:99], v[64:67]
    s_add_u32 m0, s35, 16384
    ds_read_b64_tr_b16 v[48:49], v4 offset:28672
    v_mfma_f32_16x16x32_bf16 v[68:71], v[32:35], a[100:103], v[68:71]
    buffer_load_dwordx4 v3, s[4:7], s36 offen lds
    v_mfma_f32_16x16x32_bf16 v[72:75], v[32:35], a[104:107], v[72:75]
    ds_read_b64_tr_b16 v[50:51], v4 offset:30720
    v_mfma_f32_16x16x32_bf16 v[76:79], v[32:35], a[108:111], v[76:79]
    buffer_load_dwordx4 a[64:67], v1, s[12:15], s37 offen sc1
    v_mfma_f32_16x16x32_bf16 v[80:83], v[36:39], a[96:99], v[80:83]
    s_add_u32 m0, s35, 17408
    ds_read_b64_tr_b16 v[52:53], v5 offset:28672
    v_mfma_f32_16x16x32_bf16 v[84:87], v[36:39], a[100:103], v[84:87]
    buffer_load_dwordx4 v13, s[4:7], s36 offen lds
    v_mfma_f32_16x16x32_bf16 v[88:91], v[36:39], a[104:107], v[88:91]
    ds_read_b64_tr_b16 v[54:55], v5 offset:30720
    v_mfma_f32_16x16x32_bf16 v[92:95], v[36:39], a[108:111], v[92:95]
    buffer_load_dwordx4 a[68:71], v9, s[12:15], s37 offen sc1
    v_mfma_f32_16x16x32_bf16 v[96:99], v[40:43], a[96:99], v[96:99]
    s_add_u32 m0, s35, 18432
    ds_read_b64_tr_b16 v[56:57], v6 offset:28672
    v_mfma_f32_16x16x32_bf16 v[100:103], v[40:43], a[100:103], v[100:103]
    buffer_load_dwordx4 v14, s[4:7], s36 offen lds
    v_mfma_f32_16x16x32_bf16 v[104:107], v[40:43], a[104:107], v[104:107]
    ds_read_b64_tr_b16 v[58:59], v6 offset:30720
    v_mfma_f32_16x16x32_bf16 v[108:111], v[40:43], a[108:111], v[108:111]
    buffer_load_dwordx4 a[72:75], v10, s[12:15], s37 offen sc1
    v_mfma_f32_16x16x32_bf16 v[112:115], v[44:47], a[96:99], v[112:115]
    s_add_u32 m0, s35, 19456
    ds_read_b64_tr_b16 v[60:61], v7 offset:28672
    v_mfma_f32_16x16x32_bf16 v[116:119], v[44:47], a[100:103], v[116:119]
    buffer_load_dwordx4 v15, s[4:7], s36 offen lds
    v_mfma_f32_16x16x32_bf16 v[120:123], v[44:47], a[104:107], v[120:123]
    ds_read_b64_tr_b16 v[62:63], v7 offset:30720
    v_mfma_f32_16x16x32_bf16 v[124:127], v[44:47], a[108:111], v[124:127]
    buffer_load_dwordx4 a[76:79], v11, s[12:15], s37 offen sc1
    s_add_u32 s36, s36, 28672
    s_add_u32 s37, s37, 1024
    s_waitcnt vmcnt(32) lgkmcnt(0)
    v_mfma_f32_16x16x32_bf16 v[64:67], v[48:51], a[112:115], v[64:67]
    s_add_u32 m0, s35, 20480
    ds_read_b64_tr_b16 v[32:33], v4 offset:0
    v_mfma_f32_16x16x32_bf16 v[68:71], v[48:51], a[116:119], v[68:71]
    buffer_load_dwordx4 v3, s[4:7], s36 offen lds
    v_mfma_f32_16x16x32_bf16 v[72:75], v[48:51], a[120:123], v[72:75]
    ds_read_b64_tr_b16 v[34:35], v4 offset:2048
    v_mfma_f32_16x16x32_bf16 v[76:79], v[48:51], a[124:127], v[76:79]
    buffer_load_dwordx4 a[80:83], v1, s[12:15], s37 offen sc1
    v_mfma_f32_16x16x32_bf16 v[80:83], v[52:55], a[112:115], v[80:83]
    s_add_u32 m0, s35, 21504
    ds_read_b64_tr_b16 v[36:37], v5 offset:0
    v_mfma_f32_16x16x32_bf16 v[84:87], v[52:55], a[116:119], v[84:87]
    buffer_load_dwordx4 v13, s[4:7], s36 offen lds
    v_mfma_f32_16x16x32_bf16 v[88:91], v[52:55], a[120:123], v[88:91]
    ds_read_b64_tr_b16 v[38:39], v5 offset:2048
    v_mfma_f32_16x16x32_bf16 v[92:95], v[52:55], a[124:127], v[92:95]
    buffer_load_dwordx4 a[84:87], v9, s[12:15], s37 offen sc1
    v_mfma_f32_16x16x32_bf16 v[96:99], v[56:59], a[112:115], v[96:99]
    s_add_u32 m0, s35, 22528
    ds_read_b64_tr_b16 v[40:41], v6 offset:0
    v_mfma_f32_16x16x32_bf16 v[100:103], v[56:59], a[116:119], v[100:103]
    buffer_load_dwordx4 v14, s[4:7], s36 offen lds
    v_mfma_f32_16x16x32_bf16 v[104:107], v[56:59], a[120:123], v[104:107]
    ds_read_b64_tr_b16 v[42:43], v6 offset:2048
    v_mfma_f32_16x16x32_bf16 v[108:111], v[56:59], a[124:127], v[108:111]
    buffer_load_dwordx4 a[88:91], v10, s[12:15], s37 offen sc1
    v_mfma_f32_16x16x32_bf16 v[112:115], v[60:63], a[112:115], v[112:115]
    s_add_u32 m0, s35, 23552
    ds_read_b64_tr_b16 v[44:45], v7 offset:0
    v_mfma_f32_16x16x32_bf16 v[116:119], v[60:63], a[116:119], v[116:119]
    buffer_load_dwordx4 v15, s[4:7], s36 offen lds
    v_mfma_f32_16x16x32_bf16 v[120:123], v[60:63], a[120:123], v[120:123]
    ds_read_b64_tr_b16 v[46:47], v7 offset:2048
    v_mfma_f32_16x16x32_bf16 v[124:127], v[60:63], a[124:127], v[124:127]
    buffer_load_dwordx4 a[92:95], v11, s[12:15], s37 offen sc1
    s_add_u32 s36, s36, 28672
    s_add_u32 s37, s37, 1024
    s_add_u32 s42, s42, 1
    s_cmp_lt_u32 s42, 4
    s_cbranch_scc1 L_oloop
    s_lshl_b32 s44, s34, 6
    s_add_u32 s44, s44, 84963328
    s_waitcnt lgkmcnt(0)
    v_and_b32 v16, 15, v0
    v_lshlrev_b32 v16, 2, v16
    s_mov_b32 s100, 0
L_poll11:
    buffer_load_dword v17, v16, s[12:15], s44 offen sc1
    s_waitcnt vmcnt(0)
    v_cmp_ne_u32 vcc, 1, v17
    s_cbranch_vccz L_poll11_ok
    s_sleep 2
    s_add_u32 s100, s100, 1
    s_cmp_lt_u32 s100, 0x80000
    s_cbranch_scc1 L_poll11
L_poll11_ok:
    v_lshrrev_b32 v8, 3, v0
    v_lshlrev_b32 v8, 12, v8
    v_and_b32 v9, 7, v0
    v_lshl_add_u32 v8, v9, 4, v8
    s_lshl_b32 s44, s34, 2
    s_add_u32 s44, s44, s3
    s_lshl_b32 s44, s44, 16
    s_lshl_b32 s45, s33, 7
    s_add_u32 s44, s44, s45
    s_add_u32 s44, s44, 90177536
    s_lshl_b32 s45, s3, 11
    s_add_u32 m0, s45, 0x20000
    s_nop 0
    buffer_load_dwordx4 v8, s[12:15], s44 offen sc1 lds
    s_add_u32 m0, s45, 0x20400
    s_add_u32 s44, s44, 0x8000
    buffer_load_dwordx4 v8, s[12:15], s44 offen sc1 lds
    s_lshl_b32 s44, s33, 6
    s_lshl_b32 s45, s3, 4
    s_add_u32 s44, s44, s45
    v_and_b32 v9, 15, v0
    v_add_u32 v9, s44, v9
    v_mul_u32_u24 v9, 896, v9
    v_lshrrev_b32 v10, 4, v0
    v_lshlrev_b32 v10, 4, v10
    v_add_u32 v10, s41, v10
    v_add_u32 v11, v9, v10
    v_lshl_add_u32 v12, v9, 1, v10
    buffer_load_dwordx4 v[16:19], v11, s[16:19], 0 offen offset:0
    buffer_load_dwordx4 v[20:23], v11, s[16:19], 0 offen offset:64
    v_and_b32 v9, 15, v0
    v_mul_u32_u24 v9, 272, v9
    v_lshrrev_b32 v10, 4, v0
    v_lshl_add_u32 v9, v10, 4, v9
    v_add_u32 v9, s35, v9
    ds_write_b128 v9, v[64:67] offset:0
    ds_write_b128 v9, v[68:71] offset:4352
    ds_write_b128 v9, v[72:75] offset:8704
    ds_write_b128 v9, v[76:79] offset:13056
    ds_write_b128 v9, v[80:83] offset:64
    ds_write_b128 v9, v[84:87] offset:4416
    ds_write_b128 v9, v[88:91] offset:8768
    ds_write_b128 v9, v[92:95] offset:13120
    ds_write_b128 v9, v[96:99] offset:128
    ds_write_b128 v9, v[100:103] offset:4480
    ds_write_b128 v9, v[104:107] offset:8832
    ds_write_b128 v9, v[108:111] offset:13184
    ds_write_b128 v9, v[112:115] offset:192
    ds_write_b128 v9, v[116:119] offset:4544
    ds_write_b128 v9, v[120:123] offset:8896
    ds_write_b128 v9, v[124:127] offset:13248
    v_lshrrev_b32 v9, 3, v0
    v_add_u32 v9, s45, v9
    v_mul_u32_u24 v13, 272, v9
    v_and_b32 v10, 7, v0
    v_lshl_add_u32 v13, v10, 5, v13
    v_add_u32 v14, 0x10000, v13
    s_lshl_b32 s44, s33, 6
    v_add_u32 v9, s44, v9
    v_mul_u32_u24 v9, 1792, v9
    v_lshl_add_u32 v9, v10, 4, v9
    s_add_u32 s46, s41, 896
    s_add_u32 s47, s46, 14336
    v_lshrrev_b32 v10, 4, v0
    v_lshlrev_b32 v10, 3, v10
    v_bfe_u32 v15, v0, 2, 2
    v_add_u32 v10, v10, v15
    v_lshlrev_b32 v10, 7, v10
    v_and_b32 v15, 3, v0
    v_lshl_add_u32 v10, v15, 3, v10
    s_lshl_b32 s48, s3, 5
    s_add_u32 s48, s48, 0x20000
    v_add_u32 v10, s48, v10
    s_mov_b32 s49, 0xffff0000
    s_waitcnt vmcnt(0) lgkmcnt(0)
    s_barrier
    ds_read_b64_tr_b16 v[24:25], v10 offset:0
    ds_read_b64_tr_b16 v[26:27], v10 offset:512
    ds_read_b64_tr_b16 v[28:29], v10 offset:4096
    ds_read_b64_tr_b16 v[30:31], v10 offset:4608
    ds_read_b128 v[64:67], v13 offset:0
    ds_read_b128 v[68:71], v13 offset:16
    ds_read_b128 v[72:75], v13 offset:32768
    ds_read_b128 v[76:79], v13 offset:32784
    ds_read_b128 v[80:83], v14 offset:0
    ds_read_b128 v[84:87], v14 offset:16
    ds_read_b128 v[88:91], v14 offset:32768
    ds_read_b128 v[92:95], v14 offset:32784
    s_waitcnt lgkmcnt(8)
    ds_read_b128 v[96:99], v13 offset:2176
    ds_read_b128 v[100:103], v13 offset:2192
    ds_read_b128 v[104:107], v13 offset:34944
    ds_read_b128 v[108:111], v13 offset:34960
    ds_read_b128 v[112:115], v14 offset:2176
    ds_read_b128 v[116:119], v14 offset:2192
    ds_read_b128 v[120:123], v14 offset:34944
    ds_read_b128 v[124:127], v14 offset:34960
    v_lshlrev_b32 v32, 16, v16
    v_lshlrev_b32 v33, 16, v24
    v_and_b32 v34, s49, v16
    v_and_b32 v35, s49, v24
    v_mul_f32 v32, v32, v33
    v_mul_f32 v34, v34, v35
    v_cvt_pk_bf16_f32 v40, v32, v34
    v_lshlrev_b32 v32, 16, v17
    v_lshlrev_b32 v33, 16, v25
    v_and_b32 v34, s49, v17
    v_and_b32 v35, s49, v25
    v_mul_f32 v32, v32, v33
    v_mul_f32 v34, v34, v35
    v_cvt_pk_bf16_f32 v41, v32, v34
    v_lshlrev_b32 v32, 16, v18
    v_lshlrev_b32 v33, 16, v26
    v_and_b32 v34, s49, v18
    v_and_b32 v35, s49, v26
    v_mul_f32 v32, v32, v33
    v_mul_f32 v34, v34, v35
    v_cvt_pk_bf16_f32 v42, v32, v34
    v_lshlrev_b32 v32, 16, v19
    v_lshlrev_b32 v33, 16, v27
    v_and_b32 v34, s49, v19
    v_and_b32 v35, s49, v27
    v_mul_f32 v32, v32, v33
    v_mul_f32 v34, v34, v35
    v_cvt_pk_bf16_f32 v43, v32, v34
    buffer_store_dwordx4 v[40:43], v12, s[8:11], 0 offen offset:0
    v_lshlrev_b32 v32, 16, v20
    v_lshlrev_b32 v33, 16, v28
    v_and_b32 v34, s49, v20
    v_and_b32 v35, s49, v28
    v_mul_f32 v32, v32, v33
    v_mul_f32 v34, v34, v35
    v_cvt_pk_bf16_f32 v44, v32, v34
    v_lshlrev_b32 v32, 16, v21
    v_lshlrev_b32 v33, 16, v29
    v_and_b32 v34, s49, v21
    v_and_b32 v35, s49, v29
    v_mul_f32 v32, v32, v33
    v_mul_f32 v34, v34, v35
    v_cvt_pk_bf16_f32 v45, v32, v34
    v_lshlrev_b32 v32, 16, v22
    v_lshlrev_b32 v33, 16, v30
    v_and_b32 v34, s49, v22
    v_and_b32 v35, s49, v30
    v_mul_f32 v32, v32, v33
    v_mul_f32 v34, v34, v35
    v_cvt_pk_bf16_f32 v46, v32, v34
    v_lshlrev_b32 v32, 16, v23
    v_lshlrev_b32 v33, 16, v31
    v_and_b32 v34, s49, v23
    v_and_b32 v35, s49, v31
    v_mul_f32 v32, v32, v33
    v_mul_f32 v34, v34, v35
    v_cvt_pk_bf16_f32 v47, v32, v34
    buffer_store_dwordx4 v[44:47], v12, s[8:11], 0 offen offset:64
    s_waitcnt lgkmcnt(0)
    v_pk_add_f32 v[64:65], v[64:65], v[72:73]
    v_pk_add_f32 v[80:81], v[80:81], v[88:89]
    v_pk_add_f32 v[64:65], v[64:65], v[80:81]
    v_pk_add_f32 v[66:67], v[66:67], v[74:75]
    v_pk_add_f32 v[82:83], v[82:83], v[90:91]
    v_pk_add_f32 v[66:67], v[66:67], v[82:83]
    v_pk_add_f32 v[68:69], v[68:69], v[76:77]
    v_pk_add_f32 v[84:85], v[84:85], v[92:93]
    v_pk_add_f32 v[68:69], v[68:69], v[84:85]
    v_pk_add_f32 v[70:71], v[70:71], v[78:79]
    v_pk_add_f32 v[86:87], v[86:87], v[94:95]
    v_pk_add_f32 v[70:71], v[70:71], v[86:87]
    v_cvt_pk_bf16_f32 v48, v64, v65
    v_cvt_pk_bf16_f32 v49, v66, v67
    v_cvt_pk_bf16_f32 v50, v68, v69
    v_cvt_pk_bf16_f32 v51, v70, v71
    buffer_store_dwordx4 v[48:51], v9, s[8:11], s46 offen
    v_pk_add_f32 v[96:97], v[96:97], v[104:105]
    v_pk_add_f32 v[112:113], v[112:113], v[120:121]
    v_pk_add_f32 v[96:97], v[96:97], v[112:113]
    v_pk_add_f32 v[98:99], v[98:99], v[106:107]
    v_pk_add_f32 v[114:115], v[114:115], v[122:123]
    v_pk_add_f32 v[98:99], v[98:99], v[114:115]
    v_pk_add_f32 v[100:101], v[100:101], v[108:109]
    v_pk_add_f32 v[116:117], v[116:117], v[124:125]
    v_pk_add_f32 v[100:101], v[100:101], v[116:117]
    v_pk_add_f32 v[102:103], v[102:103], v[110:111]
    v_pk_add_f32 v[118:119], v[118:119], v[126:127]
    v_pk_add_f32 v[102:103], v[102:103], v[118:119]
    v_cvt_pk_bf16_f32 v52, v96, v97
    v_cvt_pk_bf16_f32 v53, v98, v99
    v_cvt_pk_bf16_f32 v54, v100, v101
    v_cvt_pk_bf16_f32 v55, v102, v103
    buffer_store_dwordx4 v[52:55], v9, s[8:11], s47 offen
L_fin:
    s_endpgm
.section .rodata,"a"
.p2align 6
.amdhsa_kernel concat_heads__ssm_conv_h3__compressed_kv_cla__prompt_kernel
  .amdhsa_next_free_vgpr 512
  .amdhsa_next_free_sgpr 102
  .amdhsa_accum_offset 256
  .amdhsa_group_segment_fixed_size 0
  .amdhsa_kernarg_size 120
  .amdhsa_user_sgpr_count 2
  .amdhsa_user_sgpr_kernarg_segment_ptr 1
  .amdhsa_system_sgpr_workgroup_id_x 1
.end_amdhsa_kernel
```

```asm
; @launch grid=(256,1,1) block=(256,1,1) lds=163840
.amdgcn_target "amdgcn-amd-amdhsa--gfx950"
.text
.globl concat_heads__ssm_conv_h3__compressed_kv_cla__prompt_kernel
.p2align 8
.type concat_heads__ssm_conv_h3__compressed_kv_cla__prompt_kernel,@function
concat_heads__ssm_conv_h3__compressed_kv_cla__prompt_kernel:
    s_cmp_lt_u32 s2, 256
    s_cbranch_scc1 L_go
    s_endpgm
L_go:
    s_load_dwordx16 s[64:79], s[0:1], 0
    s_load_dwordx8 s[80:87], s[0:1], 64
    s_load_dwordx4 s[88:91], s[0:1], 96
    s_load_dwordx2 s[12:13], s[0:1], 112
    v_lshrrev_b32 v1, 6, v0
    v_and_b32 v0, 63, v0
    v_readfirstlane_b32 s3, v1
    s_and_b32 s24, s2, 7
    s_bfe_u32 s25, s2, 0x30003
    s_bfe_u32 s26, s2, 0x10006
    s_lshl_b32 s37, s24, 1
    s_add_u32 s26, s26, s37
    s_lshr_b32 s27, s2, 7
    s_bfe_u32 s28, s2, 0x40003
    s_lshl_b32 s29, s3, 10
    s_and_b32 s39, s3, 1
    s_lshr_b32 s40, s3, 1
    s_mov_b32 s41, 65536
    s_mov_b32 s48, 32768
    s_mov_b32 s42, 131072
    s_mov_b32 s49, 131072
    s_mov_b32 s43, 196608
    s_mov_b32 s50, 163840
    s_mov_b32 s44, 262144
    s_mov_b32 s51, 262144
    s_mov_b32 s45, 327680
    s_mov_b32 s52, 294912
    s_mov_b32 s46, 393216
    s_mov_b32 s53, 393216
    s_mov_b32 s47, 458752
    s_mov_b32 s54, 425984
    s_lshl_b32 s56, s39, 1
    s_lshl_b32 s57, s40, 3
    s_add_u32 s56, s56, s57
    s_lshl_b32 s60, s25, 8
    s_lshl_b32 s58, s3, 3
    s_add_u32 s58, s58, s60
    v_lshrrev_b32 v14, 3, v0
    v_add_u32 v14, s58, v14
    v_lshlrev_b32 v14, 11, v14
    s_lshl_b32 s58, s39, 2
    v_lshrrev_b32 v15, 4, v0
    v_add_u32 v15, s58, v15
    v_xor_b32 v15, v0, v15
    v_and_b32 v15, 7, v15
    v_lshl_add_u32 v1, v15, 4, v14
    v_lshrrev_b32 v14, 5, v0
    s_lshl_b32 s58, s3, 1
    v_add_u32 v15, s58, v14
    v_lshlrev_b32 v15, 1, v15
    v_xor_b32 v15, v0, v15
    v_and_b32 v15, 31, v15
    v_lshlrev_b32 v15, 4, v15
    v_add_u32 v14, s56, v14
    v_lshl_add_u32 v14, v14, 13, v15
    s_lshl_b32 s58, s26, 9
    v_add_u32 v2, s58, v14
    s_waitcnt lgkmcnt(0)
    s_cmp_eq_u32 s27, 0
    s_cselect_b32 s8, s82, s84
    s_cselect_b32 s9, s83, s85
    s_mov_b32 s10, 8388608
    s_mov_b32 s11, 0x20000
    s_mov_b32 s4, s78
    s_mov_b32 s5, s79
    s_mov_b32 s6, 4194304
    s_mov_b32 s7, 0x20000
    s_mov_b32 s14, 268435456
    s_mov_b32 s15, 0x20000
    s_add_u32 m0, s29, 65536
    s_nop 0
    buffer_load_dwordx4 v2, s[8:11], 0 offen lds
    s_add_u32 m0, s29, 0
    s_nop 0
    buffer_load_dwordx4 v1, s[4:7], 0 offen lds
    s_add_u32 m0, s29, 69632
    s_nop 0
    buffer_load_dwordx4 v2, s[8:11], s48 offen lds
    s_add_u32 m0, s29, 4096
    s_nop 0
    buffer_load_dwordx4 v1, s[4:7], s41 offen lds
    s_add_u32 m0, s29, 73728
    s_nop 0
    buffer_load_dwordx4 v2, s[8:11], s49 offen lds
    s_add_u32 m0, s29, 8192
    s_nop 0
    buffer_load_dwordx4 v1, s[4:7], s42 offen lds
    s_add_u32 m0, s29, 77824
    s_nop 0
    buffer_load_dwordx4 v2, s[8:11], s50 offen lds
    s_add_u32 m0, s29, 12288
    s_nop 0
    buffer_load_dwordx4 v1, s[4:7], s43 offen lds
    s_add_u32 m0, s29, 81920
    s_nop 0
    buffer_load_dwordx4 v2, s[8:11], s51 offen lds
    s_add_u32 m0, s29, 16384
    s_nop 0
    buffer_load_dwordx4 v1, s[4:7], s44 offen lds
    s_add_u32 m0, s29, 86016
    s_nop 0
    buffer_load_dwordx4 v2, s[8:11], s52 offen lds
    s_add_u32 m0, s29, 20480
    s_nop 0
    buffer_load_dwordx4 v1, s[4:7], s45 offen lds
    s_add_u32 m0, s29, 90112
    s_nop 0
    buffer_load_dwordx4 v2, s[8:11], s53 offen lds
    s_add_u32 m0, s29, 24576
    s_nop 0
    buffer_load_dwordx4 v1, s[4:7], s46 offen lds
    s_add_u32 m0, s29, 94208
    s_nop 0
    buffer_load_dwordx4 v2, s[8:11], s54 offen lds
    s_add_u32 m0, s29, 28672
    s_nop 0
    buffer_load_dwordx4 v1, s[4:7], s47 offen lds
    v_add_u32 v1, 128, v1
    v_add_u32 v2, 0x80000, v2
    s_getpc_b64 s[100:101]
L_pc:
    s_sub_u32 s100, s100, L_pc-L_go
    s_subb_u32 s101, s101, 0
    s_lshr_b32 s32, s2, 1
    s_and_b32 s32, s32, 12
    s_add_u32 s32, s32, s3
    s_lshl_b32 s32, s32, 13
    v_lshlrev_b32 v14, 7, v0
    v_add_u32 v14, s32, v14
    v_min_u32 v14, L_codeend-L_go-4, v14
    v_accvgpr_write_b32 a244, v14
    global_load_dword a243, v14, s[100:101]
    s_lshl_b32 s58, s27, 3
    s_add_u32 s59, s58, s25
    s_lshl_b32 s59, s59, 2
    s_lshl_b32 s92, s26, 7
    s_add_u32 s92, s92, s59
    s_add_u32 s92, s92, 84934656
    s_add_u32 s58, s58, s24
    s_mul_i32 s95, s58, 14
    s_add_u32 s95, s95, s28
    s_sub_u32 s63, 15, s25
    s_cmp_eq_u32 s27, 0
    s_cselect_b32 s63, s25, s63
    s_lshl_b32 s93, s63, 7
    s_lshl_b32 s59, s26, 2
    s_add_u32 s93, s93, s59
    s_add_u32 s93, s93, 84938752
    s_and_b32 s94, s2, 127
    s_lshl_b32 s94, s94, 7
    s_add_u32 s94, s94, 84942848
    s_cmp_lg_u32 s3, 0
    s_cbranch_scc1 L_noclr
    s_lshl_b32 s58, s95, 2
    s_add_u32 s59, s58, 84963328
    s_add_u32 s58, s58, 84959232
    s_lshl_b32 s61, s27, 2
    s_add_u32 s61, s61, s94
    s_cmp_lt_u32 s28, 14
    s_cselect_b32 s58, s58, s92
    s_cselect_b32 s59, s59, s92
    v_mov_b32 v14, s92
    v_writelane_b32 v14, s93, 1
    v_writelane_b32 v14, s61, 2
    v_writelane_b32 v14, s58, 3
    v_writelane_b32 v14, s59, 4
    v_mov_b32 v15, 0
    s_mov_b64 exec, 31
    buffer_store_dword v15, v14, s[12:15], 0 offen sc1
    s_mov_b64 exec, -1
L_noclr:
    s_add_u32 m0, s29, 98304
    s_nop 0
    buffer_load_dwordx4 v2, s[8:11], 0 offen lds
    s_add_u32 m0, s29, 32768
    s_nop 0
    buffer_load_dwordx4 v1, s[4:7], 0 offen lds
    s_add_u32 m0, s29, 102400
    s_nop 0
    buffer_load_dwordx4 v2, s[8:11], s48 offen lds
    s_add_u32 m0, s29, 36864
    s_nop 0
    buffer_load_dwordx4 v1, s[4:7], s41 offen lds
    s_add_u32 m0, s29, 106496
    s_nop 0
    buffer_load_dwordx4 v2, s[8:11], s49 offen lds
    s_add_u32 m0, s29, 40960
    s_nop 0
    buffer_load_dwordx4 v1, s[4:7], s42 offen lds
    s_add_u32 m0, s29, 110592
    s_nop 0
    buffer_load_dwordx4 v2, s[8:11], s50 offen lds
    s_add_u32 m0, s29, 45056
    s_nop 0
    buffer_load_dwordx4 v1, s[4:7], s43 offen lds
    s_add_u32 m0, s29, 114688
    s_nop 0
    buffer_load_dwordx4 v2, s[8:11], s51 offen lds
    s_add_u32 m0, s29, 49152
    s_nop 0
    buffer_load_dwordx4 v1, s[4:7], s44 offen lds
    s_add_u32 m0, s29, 118784
    s_nop 0
    buffer_load_dwordx4 v2, s[8:11], s52 offen lds
    s_add_u32 m0, s29, 53248
    s_nop 0
    buffer_load_dwordx4 v1, s[4:7], s45 offen lds
    s_add_u32 m0, s29, 122880
    s_nop 0
    buffer_load_dwordx4 v2, s[8:11], s53 offen lds
    s_add_u32 m0, s29, 57344
    s_nop 0
    buffer_load_dwordx4 v1, s[4:7], s46 offen lds
    s_add_u32 m0, s29, 126976
    s_nop 0
    buffer_load_dwordx4 v2, s[8:11], s54 offen lds
    s_add_u32 m0, s29, 61440
    s_nop 0
    buffer_load_dwordx4 v1, s[4:7], s47 offen lds
    v_add_u32 v1, 128, v1
    v_add_u32 v2, 0x80000, v2
    s_lshl_b32 s58, s39, 7
    s_lshl_b32 s59, s40, 3
    v_and_b32 v14, 15, v0
    v_lshrrev_b32 v15, 4, v0
    s_lshl_b32 s60, s63, 7
    s_lshl_b32 s62, s3, 4
    s_add_u32 s60, s60, s62
    v_lshrrev_b32 v13, 3, v0
    v_lshlrev_b32 v13, 1, v13
    v_add_u32 v12, s60, v13
    v_mul_u32_u24 v12, 896, v12
    v_lshrrev_b32 v13, 1, v13
    v_xor_b32 v13, v0, v13
    v_and_b32 v13, 7, v13
    v_lshl_add_u32 v13, v13, 4, v12
    v_accvgpr_write_b32 a240, v13
    v_lshrrev_b32 v13, 1, v14
    v_xor_b32 v12, v13, v15
    v_lshlrev_b32 v12, 4, v12
    v_lshl_add_u32 v12, v13, 7, v12
    v_and_b32 v13, 1, v14
    v_lshl_add_u32 v12, v13, 10, v12
    s_lshl_b32 s33, s3, 13
    s_add_u32 s33, s33, 0x20000
    v_add_u32 v12, s33, v12
    v_accvgpr_write_b32 a242, v12
    v_lshrrev_b32 v5, 1, v14
    v_xor_b32 v5, v5, v15
    v_add_u32 v14, s58, v14
    v_lshlrev_b32 v14, 7, v14
    v_lshl_add_u32 v4, v5, 4, v14
    v_xor_b32 v5, 64, v4
    v_bfe_u32 v14, v0, 2, 3
    v_lshrrev_b32 v15, 5, v0
    v_lshl_add_u32 v13, v15, 4, v14
    v_lshlrev_b32 v13, 9, v13
    v_xor_b32 v14, s59, v14
    v_lshl_add_u32 v13, v14, 5, v13
    v_and_b32 v14, 3, v0
    v_lshl_add_u32 v13, v14, 3, v13
    v_add_u32 v6, 0x10000, v13
    v_xor_b32 v7, 32, v6
    v_xor_b32 v8, 64, v6
    v_xor_b32 v9, 96, v6
    v_xor_b32 v10, 128, v6
    v_xor_b32 v11, 160, v6
    v_xor_b32 v12, 192, v6
    v_xor_b32 v13, 224, v6
    v_mov_b64 v[16:17], 0
    v_mov_b64 v[18:19], 0
    v_mov_b64 v[20:21], 0
    v_mov_b64 v[22:23], 0
    v_mov_b64 v[24:25], 0
    v_mov_b64 v[26:27], 0
    v_mov_b64 v[28:29], 0
    v_mov_b64 v[30:31], 0
    v_mov_b64 v[32:33], 0
    v_mov_b64 v[34:35], 0
    v_mov_b64 v[36:37], 0
    v_mov_b64 v[38:39], 0
    v_mov_b64 v[40:41], 0
    v_mov_b64 v[42:43], 0
    v_mov_b64 v[44:45], 0
    v_mov_b64 v[46:47], 0
    v_mov_b64 v[48:49], 0
    v_mov_b64 v[50:51], 0
    v_mov_b64 v[52:53], 0
    v_mov_b64 v[54:55], 0
    v_mov_b64 v[56:57], 0
    v_mov_b64 v[58:59], 0
    v_mov_b64 v[60:61], 0
    v_mov_b64 v[62:63], 0
    v_mov_b64 v[64:65], 0
    v_mov_b64 v[66:67], 0
    v_mov_b64 v[68:69], 0
    v_mov_b64 v[70:71], 0
    v_mov_b64 v[72:73], 0
    v_mov_b64 v[74:75], 0
    v_mov_b64 v[76:77], 0
    v_mov_b64 v[78:79], 0
    v_mov_b64 v[80:81], 0
    v_mov_b64 v[82:83], 0
    v_mov_b64 v[84:85], 0
    v_mov_b64 v[86:87], 0
    v_mov_b64 v[88:89], 0
    v_mov_b64 v[90:91], 0
    v_mov_b64 v[92:93], 0
    v_mov_b64 v[94:95], 0
    v_mov_b64 v[96:97], 0
    v_mov_b64 v[98:99], 0
    v_mov_b64 v[100:101], 0
    v_mov_b64 v[102:103], 0
    v_mov_b64 v[104:105], 0
    v_mov_b64 v[106:107], 0
    v_mov_b64 v[108:109], 0
    v_mov_b64 v[110:111], 0
    v_mov_b64 v[112:113], 0
    v_mov_b64 v[114:115], 0
    v_mov_b64 v[116:117], 0
    v_mov_b64 v[118:119], 0
    v_mov_b64 v[120:121], 0
    v_mov_b64 v[122:123], 0
    v_mov_b64 v[124:125], 0
    v_mov_b64 v[126:127], 0
    v_mov_b64 v[128:129], 0
    v_mov_b64 v[130:131], 0
    v_mov_b64 v[132:133], 0
    v_mov_b64 v[134:135], 0
    v_mov_b64 v[136:137], 0
    v_mov_b64 v[138:139], 0
    v_mov_b64 v[140:141], 0
    v_mov_b64 v[142:143], 0
    v_mov_b64 v[144:145], 0
    v_mov_b64 v[146:147], 0
    v_mov_b64 v[148:149], 0
    v_mov_b64 v[150:151], 0
    v_mov_b64 v[152:153], 0
    v_mov_b64 v[154:155], 0
    v_mov_b64 v[156:157], 0
    v_mov_b64 v[158:159], 0
    v_mov_b64 v[160:161], 0
    v_mov_b64 v[162:163], 0
    v_mov_b64 v[164:165], 0
    v_mov_b64 v[166:167], 0
    v_mov_b64 v[168:169], 0
    v_mov_b64 v[170:171], 0
    v_mov_b64 v[172:173], 0
    v_mov_b64 v[174:175], 0
    v_mov_b64 v[176:177], 0
    v_mov_b64 v[178:179], 0
    v_mov_b64 v[180:181], 0
    v_mov_b64 v[182:183], 0
    v_mov_b64 v[184:185], 0
    v_mov_b64 v[186:187], 0
    v_mov_b64 v[188:189], 0
    v_mov_b64 v[190:191], 0
    v_mov_b64 v[192:193], 0
    v_mov_b64 v[194:195], 0
    v_mov_b64 v[196:197], 0
    v_mov_b64 v[198:199], 0
    v_mov_b64 v[200:201], 0
    v_mov_b64 v[202:203], 0
    v_mov_b64 v[204:205], 0
    v_mov_b64 v[206:207], 0
    v_mov_b64 v[208:209], 0
    v_mov_b64 v[210:211], 0
    v_mov_b64 v[212:213], 0
    v_mov_b64 v[214:215], 0
    v_mov_b64 v[216:217], 0
    v_mov_b64 v[218:219], 0
    v_mov_b64 v[220:221], 0
    v_mov_b64 v[222:223], 0
    v_mov_b64 v[224:225], 0
    v_mov_b64 v[226:227], 0
    v_mov_b64 v[228:229], 0
    v_mov_b64 v[230:231], 0
    v_mov_b64 v[232:233], 0
    v_mov_b64 v[234:235], 0
    v_mov_b64 v[236:237], 0
    v_mov_b64 v[238:239], 0
    v_mov_b64 v[240:241], 0
    v_mov_b64 v[242:243], 0
    v_mov_b64 v[244:245], 0
    v_mov_b64 v[246:247], 0
    v_mov_b64 v[248:249], 0
    v_mov_b64 v[250:251], 0
    v_mov_b64 v[252:253], 0
    v_mov_b64 v[254:255], 0
    v_accvgpr_write_b32 a224, 0
    v_accvgpr_write_b32 a225, 0
    v_accvgpr_write_b32 a226, 0
    v_accvgpr_write_b32 a227, 0
    v_accvgpr_write_b32 a228, 0
    v_accvgpr_write_b32 a229, 0
    v_accvgpr_write_b32 a230, 0
    v_accvgpr_write_b32 a231, 0
    v_accvgpr_write_b32 a232, 0
    v_accvgpr_write_b32 a233, 0
    v_accvgpr_write_b32 a234, 0
    v_accvgpr_write_b32 a235, 0
    v_accvgpr_write_b32 a236, 0
    v_accvgpr_write_b32 a237, 0
    v_accvgpr_write_b32 a238, 0
    v_accvgpr_write_b32 a239, 0
    s_mov_b32 s16, s80
    s_mov_b32 s17, s81
    s_mov_b32 s18, 3670016
    s_mov_b32 s19, 0x20000
    s_mov_b32 s20, s76
    s_mov_b32 s21, s77
    s_mov_b32 s22, 1835008
    s_mov_b32 s23, 0x20000
    s_lshl_b32 s58, s26, 20
    s_lshl_b32 s62, s63, 16
    s_add_u32 s62, s62, s58
    s_lshl_b32 s59, s3, 13
    s_add_u32 s62, s62, s59
    s_add_u32 s62, s62, 33554432
    s_lshl_b32 s59, s25, 17
    s_add_u32 s58, s58, s59
    s_lshl_b32 s59, s39, 16
    s_add_u32 s58, s58, s59
    s_lshl_b32 s59, s40, 12
    s_lshl_b32 s59, s59, s27
    s_add_u32 s58, s58, s59
    s_lshl_b32 s59, s27, 24
    s_add_u32 s58, s58, s59
    s_mov_b32 s57, 57344
    s_lshl_b32 s60, s40, 8
    s_add_u32 s60, s60, 0x10000
    s_mov_b32 s34, 0x3db8aa3b
    s_mov_b32 s35, 0x3db8aa3b
    s_mul_i32 s55, s25, 6
    s_lshr_b32 s55, s55, 3
    s_cmp_lg_u32 s3, 0
    s_cmov_b32 s55, 64
    v_mov_b32 v15, 1
    s_mul_i32 s36, s2, 7282
    s_lshr_b32 s36, s36, 16
    s_mul_i32 s37, s36, 9
    s_sub_u32 s37, s2, s37
    s_lshl_b32 s38, s36, 16
    s_mov_b64 s[30:31], s[80:81]
    s_cmp_eq_u32 s37, 2
    s_cmov_b64 s[30:31], s[76:77]
    s_cmp_eq_u32 s37, 3
    s_cmov_b64 s[30:31], s[66:67]
    s_cmp_eq_u32 s37, 4
    s_cmov_b64 s[30:31], s[68:69]
    s_cmp_eq_u32 s37, 5
    s_cmov_b64 s[30:31], s[86:87]
    s_cmp_eq_u32 s37, 6
    s_cmov_b64 s[30:31], s[86:87]
    s_cmp_eq_u32 s37, 7
    s_cmov_b64 s[30:31], s[72:73]
    s_cmp_eq_u32 s37, 8
    s_cmov_b64 s[30:31], s[64:65]
    s_add_u32 s32, s38, 1835008
    s_cmp_eq_u32 s37, 1
    s_cmov_b32 s38, s32
    s_cmp_eq_u32 s37, 6
    s_cmov_b32 s38, s32
    s_lshl_b32 s32, s39, 15
    s_add_u32 s38, s38, s32
    s_cmp_ge_u32 s37, 9
    s_cmov_b32 s36, 28
    s_cmp_lt_u32 s36, 28
    s_cselect_b32 s32, 0x8000, 0
    s_cselect_b32 s38, s38, 0
    s_add_u32 s36, s30, s38
    s_addc_u32 s37, s31, 0
    s_mov_b32 s38, s32
    s_mov_b32 s39, 0x20000
    v_lshlrev_b32 v14, 6, v0
    s_mov_b32 s56, 0xffffd000
    s_movk_i32 s30, 0x1000
    s_cmp_ge_u32 s3, 2
    s_cbranch_scc1 L_pfset
    s_mov_b32 s38, 0
    s_cmp_eq_u32 s3, 1
    s_cbranch_scc1 L_pfc
    s_mov_b64 s[36:37], s[8:9]
    s_mov_b32 s38, s10
    s_mov_b32 s30, 0x80000
    s_mov_b32 s56, 0x100000
    s_lshl_b32 s31, s25, 16
    s_lshl_b32 s32, s26, 9
    s_add_u32 s31, s31, s32
    v_lshrrev_b32 v15, 3, v0
    v_lshlrev_b32 v15, 13, v15
    v_and_b32 v14, 0x1c0, v14
    v_add3_u32 v14, v14, v15, s31
    s_branch L_pfset
L_pfc:
    s_mov_b64 s[36:37], s[4:5]
    s_mov_b32 s38, s6
    s_movk_i32 s30, 128
    s_movk_i32 s56, 256
    s_lshl_b32 s31, s25, 2
    s_lshr_b32 s32, s2, 6
    s_add_u32 s31, s31, s32
    s_lshl_b32 s31, s31, 17
    v_lshlrev_b32 v14, 11, v0
    v_add_u32 v14, s31, v14
L_pfset:
    v_mov_b32 v15, 1
    v_mov_b32 v3, 0
    buffer_load_dword a243, v14, s[36:39], s56 offen
    s_add_u32 s56, s56, s30
    buffer_load_dword a243, v14, s[36:39], s56 offen
    s_add_u32 s56, s56, s30
    s_mov_b32 s61, 0
    s_waitcnt vmcnt(18)
    s_barrier
    ds_read_b64_tr_b16 a[0:1], v6 offset:0
    ds_read_b64_tr_b16 a[2:3], v6 offset:4096
    ds_read_b128 a[64:67], v4 offset:0
    ds_read_b64_tr_b16 a[4:5], v6 offset:16384
    ds_read_b64_tr_b16 a[6:7], v6 offset:20480
    ds_read_b128 a[68:71], v5 offset:0
    ds_read_b128 a[76:79], v5 offset:2048
    ds_read_b128 a[72:75], v4 offset:2048
    ds_read_b128 a[80:83], v4 offset:4096
    ds_read_b128 a[84:87], v5 offset:4096
    ds_read_b128 a[92:95], v5 offset:6144
    ds_read_b128 a[88:91], v4 offset:6144
    ds_read_b64_tr_b16 a[8:9], v7 offset:0
    ds_read_b64_tr_b16 a[10:11], v7 offset:4096
    ds_read_b64_tr_b16 a[12:13], v7 offset:16384
    ds_read_b64_tr_b16 a[14:15], v7 offset:20480
    ds_read_b64_tr_b16 a[16:17], v8 offset:0
    ds_read_b64_tr_b16 a[18:19], v8 offset:4096
    ds_read_b64_tr_b16 a[20:21], v8 offset:16384
    ds_read_b64_tr_b16 a[22:23], v8 offset:20480
    s_cmp_eq_u32 s27, 0
    s_waitcnt lgkmcnt(0)
    s_cbranch_scc0 L_vloop
.p2align 6
L_kloop:
    v_mfma_f32_16x16x32_bf16 v[88:91], a[0:3], a[64:67], v[88:91]
    ds_read_b64_tr_b16 a[24:25], v9 offset:0
    v_mfma_f32_16x16x32_bf16 v[88:91], a[4:7], a[68:71], v[88:91]
    ds_read_b64_tr_b16 a[26:27], v9 offset:4096
    v_mfma_f32_16x16x32_bf16 v[80:83], a[4:7], a[76:79], v[80:83]
    ds_read_b64_tr_b16 a[28:29], v9 offset:16384
    v_mfma_f32_16x16x32_bf16 v[80:83], a[0:3], a[72:75], v[80:83]
    ds_read_b64_tr_b16 a[30:31], v9 offset:20480
    v_mfma_f32_16x16x32_bf16 v[72:75], a[0:3], a[80:83], v[72:75]
    ds_read_b128 a[96:99], v4 offset:8192
    v_mfma_f32_16x16x32_bf16 v[72:75], a[4:7], a[84:87], v[72:75]
    s_cmp_eq_u32 s61, s55
    s_cbranch_scc1 L_kloop_side
L_kloop_back:
    v_mfma_f32_16x16x32_bf16 v[64:67], a[4:7], a[92:95], v[64:67]
    s_waitcnt lgkmcnt(8)
    ds_read_b128 a[100:103], v5 offset:8192
    v_mfma_f32_16x16x32_bf16 v[64:67], a[0:3], a[88:91], v[64:67]
    v_mfma_f32_16x16x32_bf16 v[68:71], a[8:11], a[88:91], v[68:71]
    ds_read_b128 a[108:111], v5 offset:10240
    v_mfma_f32_16x16x32_bf16 v[68:71], a[12:15], a[92:95], v[68:71]
    v_mfma_f32_16x16x32_bf16 v[76:79], a[12:15], a[84:87], v[76:79]
    ds_read_b128 a[104:107], v4 offset:10240
    v_mfma_f32_16x16x32_bf16 v[76:79], a[8:11], a[80:83], v[76:79]
    v_mfma_f32_16x16x32_bf16 v[84:87], a[8:11], a[72:75], v[84:87]
    ds_read_b128 a[112:115], v4 offset:12288
    v_mfma_f32_16x16x32_bf16 v[84:87], a[12:15], a[76:79], v[84:87]
    v_mfma_f32_16x16x32_bf16 v[92:95], a[12:15], a[68:71], v[92:95]
    ds_read_b128 a[116:119], v5 offset:12288
    v_mfma_f32_16x16x32_bf16 v[92:95], a[8:11], a[64:67], v[92:95]
    s_waitcnt lgkmcnt(8)
    v_mfma_f32_16x16x32_bf16 v[120:123], a[16:19], a[64:67], v[120:123]
    ds_read_b128 a[124:127], v5 offset:14336
    v_mfma_f32_16x16x32_bf16 v[120:123], a[20:23], a[68:71], v[120:123]
    v_mfma_f32_16x16x32_bf16 v[112:115], a[20:23], a[76:79], v[112:115]
    ds_read_b128 a[120:123], v4 offset:14336
    v_mfma_f32_16x16x32_bf16 v[112:115], a[16:19], a[72:75], v[112:115]
    v_mfma_f32_16x16x32_bf16 v[104:107], a[16:19], a[80:83], v[104:107]
    ds_read_b64_tr_b16 a[32:33], v10 offset:0
    v_mfma_f32_16x16x32_bf16 v[104:107], a[20:23], a[84:87], v[104:107]
    ds_read_b64_tr_b16 a[34:35], v10 offset:4096
    v_mfma_f32_16x16x32_bf16 v[96:99], a[20:23], a[92:95], v[96:99]
    ds_read_b64_tr_b16 a[36:37], v10 offset:16384
    v_mfma_f32_16x16x32_bf16 v[96:99], a[16:19], a[88:91], v[96:99]
    ds_read_b64_tr_b16 a[38:39], v10 offset:20480
    v_mfma_f32_16x16x32_bf16 v[100:103], a[24:27], a[88:91], v[100:103]
    s_waitcnt lgkmcnt(8)
    ds_read_b64_tr_b16 a[40:41], v11 offset:0
    v_mfma_f32_16x16x32_bf16 v[100:103], a[28:31], a[92:95], v[100:103]
    ds_read_b64_tr_b16 a[42:43], v11 offset:4096
    v_mfma_f32_16x16x32_bf16 v[108:111], a[28:31], a[84:87], v[108:111]
    ds_read_b64_tr_b16 a[44:45], v11 offset:16384
    v_mfma_f32_16x16x32_bf16 v[108:111], a[24:27], a[80:83], v[108:111]
    ds_read_b64_tr_b16 a[46:47], v11 offset:20480
    v_mfma_f32_16x16x32_bf16 v[116:119], a[24:27], a[72:75], v[116:119]
    ds_read_b64_tr_b16 a[48:49], v12 offset:0
    v_mfma_f32_16x16x32_bf16 v[116:119], a[28:31], a[76:79], v[116:119]
    ds_read_b64_tr_b16 a[50:51], v12 offset:4096
    v_mfma_f32_16x16x32_bf16 v[124:127], a[28:31], a[68:71], v[124:127]
    ds_read_b64_tr_b16 a[52:53], v12 offset:16384
    v_mfma_f32_16x16x32_bf16 v[124:127], a[24:27], a[64:67], v[124:127]
    ds_read_b64_tr_b16 a[54:55], v12 offset:20480
    v_mfma_f32_16x16x32_bf16 a[232:235], a[0:3], a[96:99], a[232:235]
    ds_read_b64_tr_b16 a[56:57], v13 offset:0
    v_mfma_f32_16x16x32_bf16 a[232:235], a[4:7], a[100:103], a[232:235]
    ds_read_b64_tr_b16 a[58:59], v13 offset:4096
    v_mfma_f32_16x16x32_bf16 a[224:227], a[4:7], a[108:111], a[224:227]
    ds_read_b64_tr_b16 a[60:61], v13 offset:16384
    v_mfma_f32_16x16x32_bf16 a[224:227], a[0:3], a[104:107], a[224:227]
    s_waitcnt lgkmcnt(8)
    ds_read_b64_tr_b16 a[62:63], v13 offset:20480
    v_mfma_f32_16x16x32_bf16 v[24:27], a[0:3], a[112:115], v[24:27]
    v_mfma_f32_16x16x32_bf16 v[24:27], a[4:7], a[116:119], v[24:27]
    v_mfma_f32_16x16x32_bf16 v[16:19], a[4:7], a[124:127], v[16:19]
    v_mfma_f32_16x16x32_bf16 v[16:19], a[0:3], a[120:123], v[16:19]
    s_waitcnt lgkmcnt(0)
    v_mfma_f32_16x16x32_bf16 v[20:23], a[8:11], a[120:123], v[20:23]
    s_barrier
    v_mfma_f32_16x16x32_bf16 v[20:23], a[12:15], a[124:127], v[20:23]
    s_add_u32 m0, s29, 65536
    v_mfma_f32_16x16x32_bf16 v[28:31], a[12:15], a[116:119], v[28:31]
    buffer_load_dwordx4 v2, s[8:11], 0 offen lds
    v_mfma_f32_16x16x32_bf16 v[28:31], a[8:11], a[112:115], v[28:31]
    v_mfma_f32_16x16x32_bf16 a[228:231], a[8:11], a[104:107], a[228:231]
    v_mfma_f32_16x16x32_bf16 a[228:231], a[12:15], a[108:111], a[228:231]
    v_mfma_f32_16x16x32_bf16 a[236:239], a[12:15], a[100:103], a[236:239]
    s_add_u32 m0, s29, 0
    v_mfma_f32_16x16x32_bf16 a[236:239], a[8:11], a[96:99], a[236:239]
    buffer_load_dwordx4 v1, s[4:7], 0 offen lds
    v_mfma_f32_16x16x32_bf16 v[56:59], a[16:19], a[96:99], v[56:59]
    v_mfma_f32_16x16x32_bf16 v[56:59], a[20:23], a[100:103], v[56:59]
    v_mfma_f32_16x16x32_bf16 v[48:51], a[20:23], a[108:111], v[48:51]
    v_mfma_f32_16x16x32_bf16 v[48:51], a[16:19], a[104:107], v[48:51]
    s_add_u32 m0, s29, 69632
    v_mfma_f32_16x16x32_bf16 v[40:43], a[16:19], a[112:115], v[40:43]
    buffer_load_dwordx4 v2, s[8:11], s48 offen lds
    v_mfma_f32_16x16x32_bf16 v[40:43], a[20:23], a[116:119], v[40:43]
    v_mfma_f32_16x16x32_bf16 v[32:35], a[20:23], a[124:127], v[32:35]
    v_mfma_f32_16x16x32_bf16 v[32:35], a[16:19], a[120:123], v[32:35]
    v_mfma_f32_16x16x32_bf16 v[36:39], a[24:27], a[120:123], v[36:39]
    s_add_u32 m0, s29, 4096
    v_mfma_f32_16x16x32_bf16 v[36:39], a[28:31], a[124:127], v[36:39]
    buffer_load_dwordx4 v1, s[4:7], s41 offen lds
    v_mfma_f32_16x16x32_bf16 v[44:47], a[28:31], a[116:119], v[44:47]
    v_mfma_f32_16x16x32_bf16 v[44:47], a[24:27], a[112:115], v[44:47]
    v_mfma_f32_16x16x32_bf16 v[52:55], a[24:27], a[104:107], v[52:55]
    v_mfma_f32_16x16x32_bf16 v[52:55], a[28:31], a[108:111], v[52:55]
    s_add_u32 m0, s29, 73728
    v_mfma_f32_16x16x32_bf16 v[60:63], a[28:31], a[100:103], v[60:63]
    buffer_load_dwordx4 v2, s[8:11], s49 offen lds
    v_mfma_f32_16x16x32_bf16 v[60:63], a[24:27], a[96:99], v[60:63]
    v_mfma_f32_16x16x32_bf16 v[216:219], a[32:35], a[96:99], v[216:219]
    v_mfma_f32_16x16x32_bf16 v[216:219], a[36:39], a[100:103], v[216:219]
    v_mfma_f32_16x16x32_bf16 v[208:211], a[36:39], a[108:111], v[208:211]
    s_add_u32 m0, s29, 8192
    v_mfma_f32_16x16x32_bf16 v[208:211], a[32:35], a[104:107], v[208:211]
    buffer_load_dwordx4 v1, s[4:7], s42 offen lds
    v_mfma_f32_16x16x32_bf16 v[200:203], a[32:35], a[112:115], v[200:203]
    v_mfma_f32_16x16x32_bf16 v[200:203], a[36:39], a[116:119], v[200:203]
    v_mfma_f32_16x16x32_bf16 v[192:195], a[36:39], a[124:127], v[192:195]
    v_mfma_f32_16x16x32_bf16 v[192:195], a[32:35], a[120:123], v[192:195]
    s_add_u32 m0, s29, 77824
    v_mfma_f32_16x16x32_bf16 v[196:199], a[40:43], a[120:123], v[196:199]
    buffer_load_dwordx4 v2, s[8:11], s50 offen lds
    v_mfma_f32_16x16x32_bf16 v[196:199], a[44:47], a[124:127], v[196:199]
    v_mfma_f32_16x16x32_bf16 v[204:207], a[44:47], a[116:119], v[204:207]
    v_mfma_f32_16x16x32_bf16 v[204:207], a[40:43], a[112:115], v[204:207]
    v_mfma_f32_16x16x32_bf16 v[212:215], a[40:43], a[104:107], v[212:215]
    s_add_u32 m0, s29, 12288
    v_mfma_f32_16x16x32_bf16 v[212:215], a[44:47], a[108:111], v[212:215]
    buffer_load_dwordx4 v1, s[4:7], s43 offen lds
    v_mfma_f32_16x16x32_bf16 v[220:223], a[44:47], a[100:103], v[220:223]
    v_mfma_f32_16x16x32_bf16 v[220:223], a[40:43], a[96:99], v[220:223]
    v_mfma_f32_16x16x32_bf16 v[248:251], a[48:51], a[96:99], v[248:251]
    v_mfma_f32_16x16x32_bf16 v[248:251], a[52:55], a[100:103], v[248:251]
    s_add_u32 m0, s29, 81920
    v_mfma_f32_16x16x32_bf16 v[240:243], a[52:55], a[108:111], v[240:243]
    buffer_load_dwordx4 v2, s[8:11], s51 offen lds
    v_mfma_f32_16x16x32_bf16 v[240:243], a[48:51], a[104:107], v[240:243]
    v_mfma_f32_16x16x32_bf16 v[232:235], a[48:51], a[112:115], v[232:235]
    v_mfma_f32_16x16x32_bf16 v[232:235], a[52:55], a[116:119], v[232:235]
    v_mfma_f32_16x16x32_bf16 v[224:227], a[52:55], a[124:127], v[224:227]
    s_add_u32 m0, s29, 16384
    v_mfma_f32_16x16x32_bf16 v[224:227], a[48:51], a[120:123], v[224:227]
    buffer_load_dwordx4 v1, s[4:7], s44 offen lds
    v_mfma_f32_16x16x32_bf16 v[228:231], a[56:59], a[120:123], v[228:231]
    v_mfma_f32_16x16x32_bf16 v[228:231], a[60:63], a[124:127], v[228:231]
    v_mfma_f32_16x16x32_bf16 v[236:239], a[60:63], a[116:119], v[236:239]
    v_mfma_f32_16x16x32_bf16 v[236:239], a[56:59], a[112:115], v[236:239]
    s_add_u32 m0, s29, 86016
    v_mfma_f32_16x16x32_bf16 v[244:247], a[56:59], a[104:107], v[244:247]
    s_waitcnt vmcnt(11)
    buffer_load_dwordx4 v2, s[8:11], s52 offen lds
    v_mfma_f32_16x16x32_bf16 v[244:247], a[60:63], a[108:111], v[244:247]
    s_barrier
    ds_read_b64_tr_b16 a[0:1], v6 offset:32768
    v_mfma_f32_16x16x32_bf16 v[252:255], a[60:63], a[100:103], v[252:255]
    ds_read_b64_tr_b16 a[2:3], v6 offset:36864
    v_mfma_f32_16x16x32_bf16 v[252:255], a[56:59], a[96:99], v[252:255]
    ds_read_b128 a[96:99], v4 offset:40960
    v_mfma_f32_16x16x32_bf16 v[152:155], a[32:35], a[64:67], v[152:155]
    s_add_u32 m0, s29, 20480
    v_mfma_f32_16x16x32_bf16 v[152:155], a[36:39], a[68:71], v[152:155]
    buffer_load_dwordx4 v1, s[4:7], s45 offen lds
    v_mfma_f32_16x16x32_bf16 v[144:147], a[36:39], a[76:79], v[144:147]
    ds_read_b64_tr_b16 a[4:5], v6 offset:49152
    v_mfma_f32_16x16x32_bf16 v[144:147], a[32:35], a[72:75], v[144:147]
    ds_read_b64_tr_b16 a[6:7], v6 offset:53248
    v_mfma_f32_16x16x32_bf16 v[136:139], a[32:35], a[80:83], v[136:139]
    ds_read_b128 a[100:103], v5 offset:40960
    v_mfma_f32_16x16x32_bf16 v[136:139], a[36:39], a[84:87], v[136:139]
    s_add_u32 m0, s29, 90112
    v_mfma_f32_16x16x32_bf16 v[128:131], a[36:39], a[92:95], v[128:131]
    buffer_load_dwordx4 v2, s[8:11], s53 offen lds
    v_mfma_f32_16x16x32_bf16 v[128:131], a[32:35], a[88:91], v[128:131]
    ds_read_b128 a[108:111], v5 offset:43008
    v_mfma_f32_16x16x32_bf16 v[132:135], a[40:43], a[88:91], v[132:135]
    v_mfma_f32_16x16x32_bf16 v[132:135], a[44:47], a[92:95], v[132:135]
    ds_read_b128 a[104:107], v4 offset:43008
    v_mfma_f32_16x16x32_bf16 v[140:143], a[44:47], a[84:87], v[140:143]
    s_add_u32 m0, s29, 24576
    v_mfma_f32_16x16x32_bf16 v[140:143], a[40:43], a[80:83], v[140:143]
    buffer_load_dwordx4 v1, s[4:7], s46 offen lds
    v_mfma_f32_16x16x32_bf16 v[148:151], a[40:43], a[72:75], v[148:151]
    ds_read_b128 a[112:115], v4 offset:45056
    v_mfma_f32_16x16x32_bf16 v[148:151], a[44:47], a[76:79], v[148:151]
    v_mfma_f32_16x16x32_bf16 v[156:159], a[44:47], a[68:71], v[156:159]
    ds_read_b128 a[116:119], v5 offset:45056
    v_mfma_f32_16x16x32_bf16 v[156:159], a[40:43], a[64:67], v[156:159]
    s_add_u32 m0, s29, 94208
    v_mfma_f32_16x16x32_bf16 v[184:187], a[48:51], a[64:67], v[184:187]
    buffer_load_dwordx4 v2, s[8:11], s54 offen lds
    v_mfma_f32_16x16x32_bf16 v[184:187], a[52:55], a[68:71], v[184:187]
    ds_read_b128 a[124:127], v5 offset:47104
    v_mfma_f32_16x16x32_bf16 v[176:179], a[52:55], a[76:79], v[176:179]
    v_mfma_f32_16x16x32_bf16 v[176:179], a[48:51], a[72:75], v[176:179]
    ds_read_b128 a[120:123], v4 offset:47104
    v_mfma_f32_16x16x32_bf16 v[168:171], a[48:51], a[80:83], v[168:171]
    s_add_u32 m0, s29, 28672
    v_mfma_f32_16x16x32_bf16 v[168:171], a[52:55], a[84:87], v[168:171]
    buffer_load_dwordx4 v1, s[4:7], s47 offen lds
    v_mfma_f32_16x16x32_bf16 v[160:163], a[52:55], a[92:95], v[160:163]
    v_add_u32 v1, 128, v1
    v_add_u32 v2, 0x80000, v2
    v_mfma_f32_16x16x32_bf16 v[160:163], a[48:51], a[88:91], v[160:163]
    ds_read_b64_tr_b16 a[8:9], v7 offset:32768
    v_mfma_f32_16x16x32_bf16 v[164:167], a[56:59], a[88:91], v[164:167]
    buffer_load_dword a243, v14, s[36:39], s56 offen
    v_mfma_f32_16x16x32_bf16 v[164:167], a[60:63], a[92:95], v[164:167]
    s_add_u32 s56, s56, s30
    ds_read_b64_tr_b16 a[10:11], v7 offset:36864
    v_mfma_f32_16x16x32_bf16 v[172:175], a[60:63], a[84:87], v[172:175]
    ds_read_b64_tr_b16 a[12:13], v7 offset:49152
    v_mfma_f32_16x16x32_bf16 v[172:175], a[56:59], a[80:83], v[172:175]
    ds_read_b64_tr_b16 a[14:15], v7 offset:53248
    v_mfma_f32_16x16x32_bf16 v[180:183], a[56:59], a[72:75], v[180:183]
    ds_read_b64_tr_b16 a[16:17], v8 offset:32768
    v_mfma_f32_16x16x32_bf16 v[180:183], a[60:63], a[76:79], v[180:183]
    ds_read_b64_tr_b16 a[18:19], v8 offset:36864
    v_mfma_f32_16x16x32_bf16 v[188:191], a[60:63], a[68:71], v[188:191]
    ds_read_b64_tr_b16 a[20:21], v8 offset:49152
    v_mfma_f32_16x16x32_bf16 v[188:191], a[56:59], a[64:67], v[188:191]
    s_waitcnt lgkmcnt(8)
    ds_read_b64_tr_b16 a[22:23], v8 offset:53248
    v_mfma_f32_16x16x32_bf16 a[232:235], a[0:3], a[96:99], a[232:235]
    ds_read_b64_tr_b16 a[24:25], v9 offset:32768
    v_mfma_f32_16x16x32_bf16 a[232:235], a[4:7], a[100:103], a[232:235]
    ds_read_b64_tr_b16 a[26:27], v9 offset:36864
    v_mfma_f32_16x16x32_bf16 a[224:227], a[4:7], a[108:111], a[224:227]
    ds_read_b64_tr_b16 a[28:29], v9 offset:49152
    v_mfma_f32_16x16x32_bf16 a[224:227], a[0:3], a[104:107], a[224:227]
    ds_read_b64_tr_b16 a[30:31], v9 offset:53248
    v_mfma_f32_16x16x32_bf16 v[24:27], a[0:3], a[112:115], v[24:27]
    ds_read_b128 a[64:67], v4 offset:32768
    v_mfma_f32_16x16x32_bf16 v[24:27], a[4:7], a[116:119], v[24:27]
    v_mfma_f32_16x16x32_bf16 v[16:19], a[4:7], a[124:127], v[16:19]
    s_waitcnt lgkmcnt(8)
    ds_read_b128 a[68:71], v5 offset:32768
    v_mfma_f32_16x16x32_bf16 v[16:19], a[0:3], a[120:123], v[16:19]
    v_mfma_f32_16x16x32_bf16 v[20:23], a[8:11], a[120:123], v[20:23]
    ds_read_b128 a[76:79], v5 offset:34816
    v_mfma_f32_16x16x32_bf16 v[20:23], a[12:15], a[124:127], v[20:23]
    v_mfma_f32_16x16x32_bf16 v[28:31], a[12:15], a[116:119], v[28:31]
    ds_read_b128 a[72:75], v4 offset:34816
    v_mfma_f32_16x16x32_bf16 v[28:31], a[8:11], a[112:115], v[28:31]
    v_mfma_f32_16x16x32_bf16 a[228:231], a[8:11], a[104:107], a[228:231]
    ds_read_b128 a[80:83], v4 offset:36864
    v_mfma_f32_16x16x32_bf16 a[228:231], a[12:15], a[108:111], a[228:231]
    v_mfma_f32_16x16x32_bf16 a[236:239], a[12:15], a[100:103], a[236:239]
    ds_read_b128 a[84:87], v5 offset:36864
    v_mfma_f32_16x16x32_bf16 a[236:239], a[8:11], a[96:99], a[236:239]
    s_waitcnt lgkmcnt(8)
    v_mfma_f32_16x16x32_bf16 v[56:59], a[16:19], a[96:99], v[56:59]
    ds_read_b128 a[92:95], v5 offset:38912
    v_mfma_f32_16x16x32_bf16 v[56:59], a[20:23], a[100:103], v[56:59]
    v_mfma_f32_16x16x32_bf16 v[48:51], a[20:23], a[108:111], v[48:51]
    ds_read_b128 a[88:91], v4 offset:38912
    v_mfma_f32_16x16x32_bf16 v[48:51], a[16:19], a[104:107], v[48:51]
    v_mfma_f32_16x16x32_bf16 v[40:43], a[16:19], a[112:115], v[40:43]
    ds_read_b64_tr_b16 a[32:33], v10 offset:32768
    v_mfma_f32_16x16x32_bf16 v[40:43], a[20:23], a[116:119], v[40:43]
    ds_read_b64_tr_b16 a[34:35], v10 offset:36864
    v_mfma_f32_16x16x32_bf16 v[32:35], a[20:23], a[124:127], v[32:35]
    ds_read_b64_tr_b16 a[36:37], v10 offset:49152
    v_mfma_f32_16x16x32_bf16 v[32:35], a[16:19], a[120:123], v[32:35]
    ds_read_b64_tr_b16 a[38:39], v10 offset:53248
    v_mfma_f32_16x16x32_bf16 v[36:39], a[24:27], a[120:123], v[36:39]
    s_waitcnt lgkmcnt(8)
    ds_read_b64_tr_b16 a[40:41], v11 offset:32768
    v_mfma_f32_16x16x32_bf16 v[36:39], a[28:31], a[124:127], v[36:39]
    ds_read_b64_tr_b16 a[42:43], v11 offset:36864
    v_mfma_f32_16x16x32_bf16 v[44:47], a[28:31], a[116:119], v[44:47]
    ds_read_b64_tr_b16 a[44:45], v11 offset:49152
    v_mfma_f32_16x16x32_bf16 v[44:47], a[24:27], a[112:115], v[44:47]
    ds_read_b64_tr_b16 a[46:47], v11 offset:53248
    v_mfma_f32_16x16x32_bf16 v[52:55], a[24:27], a[104:107], v[52:55]
    ds_read_b64_tr_b16 a[48:49], v12 offset:32768
    v_mfma_f32_16x16x32_bf16 v[52:55], a[28:31], a[108:111], v[52:55]
    ds_read_b64_tr_b16 a[50:51], v12 offset:36864
    v_mfma_f32_16x16x32_bf16 v[60:63], a[28:31], a[100:103], v[60:63]
    ds_read_b64_tr_b16 a[52:53], v12 offset:49152
    v_mfma_f32_16x16x32_bf16 v[60:63], a[24:27], a[96:99], v[60:63]
    ds_read_b64_tr_b16 a[54:55], v12 offset:53248
    v_mfma_f32_16x16x32_bf16 v[88:91], a[0:3], a[64:67], v[88:91]
    ds_read_b64_tr_b16 a[56:57], v13 offset:32768
    v_mfma_f32_16x16x32_bf16 v[88:91], a[4:7], a[68:71], v[88:91]
    ds_read_b64_tr_b16 a[58:59], v13 offset:36864
    v_mfma_f32_16x16x32_bf16 v[80:83], a[4:7], a[76:79], v[80:83]
    ds_read_b64_tr_b16 a[60:61], v13 offset:49152
    v_mfma_f32_16x16x32_bf16 v[80:83], a[0:3], a[72:75], v[80:83]
    s_waitcnt lgkmcnt(8)
    ds_read_b64_tr_b16 a[62:63], v13 offset:53248
    v_mfma_f32_16x16x32_bf16 v[72:75], a[0:3], a[80:83], v[72:75]
    v_mfma_f32_16x16x32_bf16 v[72:75], a[4:7], a[84:87], v[72:75]
    v_mfma_f32_16x16x32_bf16 v[64:67], a[4:7], a[92:95], v[64:67]
    v_mfma_f32_16x16x32_bf16 v[64:67], a[0:3], a[88:91], v[64:67]
    s_waitcnt lgkmcnt(0)
    v_mfma_f32_16x16x32_bf16 v[68:71], a[8:11], a[88:91], v[68:71]
    s_barrier
    v_mfma_f32_16x16x32_bf16 v[68:71], a[12:15], a[92:95], v[68:71]
    s_add_u32 m0, s29, 98304
    v_mfma_f32_16x16x32_bf16 v[76:79], a[12:15], a[84:87], v[76:79]
    buffer_load_dwordx4 v2, s[8:11], 0 offen lds
    v_mfma_f32_16x16x32_bf16 v[76:79], a[8:11], a[80:83], v[76:79]
    v_mfma_f32_16x16x32_bf16 v[84:87], a[8:11], a[72:75], v[84:87]
    v_mfma_f32_16x16x32_bf16 v[84:87], a[12:15], a[76:79], v[84:87]
    v_mfma_f32_16x16x32_bf16 v[92:95], a[12:15], a[68:71], v[92:95]
    s_add_u32 m0, s29, 32768
    v_mfma_f32_16x16x32_bf16 v[92:95], a[8:11], a[64:67], v[92:95]
    buffer_load_dwordx4 v1, s[4:7], 0 offen lds
    v_mfma_f32_16x16x32_bf16 v[120:123], a[16:19], a[64:67], v[120:123]
    v_mfma_f32_16x16x32_bf16 v[120:123], a[20:23], a[68:71], v[120:123]
    v_mfma_f32_16x16x32_bf16 v[112:115], a[20:23], a[76:79], v[112:115]
    v_mfma_f32_16x16x32_bf16 v[112:115], a[16:19], a[72:75], v[112:115]
    s_add_u32 m0, s29, 102400
    v_mfma_f32_16x16x32_bf16 v[104:107], a[16:19], a[80:83], v[104:107]
    buffer_load_dwordx4 v2, s[8:11], s48 offen lds
    v_mfma_f32_16x16x32_bf16 v[104:107], a[20:23], a[84:87], v[104:107]
    v_mfma_f32_16x16x32_bf16 v[96:99], a[20:23], a[92:95], v[96:99]
    v_mfma_f32_16x16x32_bf16 v[96:99], a[16:19], a[88:91], v[96:99]
    v_mfma_f32_16x16x32_bf16 v[100:103], a[24:27], a[88:91], v[100:103]
    s_add_u32 m0, s29, 36864
    v_mfma_f32_16x16x32_bf16 v[100:103], a[28:31], a[92:95], v[100:103]
    buffer_load_dwordx4 v1, s[4:7], s41 offen lds
    v_mfma_f32_16x16x32_bf16 v[108:111], a[28:31], a[84:87], v[108:111]
    v_mfma_f32_16x16x32_bf16 v[108:111], a[24:27], a[80:83], v[108:111]
    v_mfma_f32_16x16x32_bf16 v[116:119], a[24:27], a[72:75], v[116:119]
    v_mfma_f32_16x16x32_bf16 v[116:119], a[28:31], a[76:79], v[116:119]
    s_add_u32 m0, s29, 106496
    v_mfma_f32_16x16x32_bf16 v[124:127], a[28:31], a[68:71], v[124:127]
    buffer_load_dwordx4 v2, s[8:11], s49 offen lds
    v_mfma_f32_16x16x32_bf16 v[124:127], a[24:27], a[64:67], v[124:127]
    v_mfma_f32_16x16x32_bf16 v[152:155], a[32:35], a[64:67], v[152:155]
    v_mfma_f32_16x16x32_bf16 v[152:155], a[36:39], a[68:71], v[152:155]
    v_mfma_f32_16x16x32_bf16 v[144:147], a[36:39], a[76:79], v[144:147]
    s_add_u32 m0, s29, 40960
    v_mfma_f32_16x16x32_bf16 v[144:147], a[32:35], a[72:75], v[144:147]
    buffer_load_dwordx4 v1, s[4:7], s42 offen lds
    v_mfma_f32_16x16x32_bf16 v[136:139], a[32:35], a[80:83], v[136:139]
    v_mfma_f32_16x16x32_bf16 v[136:139], a[36:39], a[84:87], v[136:139]
    v_mfma_f32_16x16x32_bf16 v[128:131], a[36:39], a[92:95], v[128:131]
    v_mfma_f32_16x16x32_bf16 v[128:131], a[32:35], a[88:91], v[128:131]
    s_add_u32 m0, s29, 110592
    v_mfma_f32_16x16x32_bf16 v[132:135], a[40:43], a[88:91], v[132:135]
    buffer_load_dwordx4 v2, s[8:11], s50 offen lds
    v_mfma_f32_16x16x32_bf16 v[132:135], a[44:47], a[92:95], v[132:135]
    v_mfma_f32_16x16x32_bf16 v[140:143], a[44:47], a[84:87], v[140:143]
    v_mfma_f32_16x16x32_bf16 v[140:143], a[40:43], a[80:83], v[140:143]
    v_mfma_f32_16x16x32_bf16 v[148:151], a[40:43], a[72:75], v[148:151]
    s_add_u32 m0, s29, 45056
    v_mfma_f32_16x16x32_bf16 v[148:151], a[44:47], a[76:79], v[148:151]
    buffer_load_dwordx4 v1, s[4:7], s43 offen lds
    v_mfma_f32_16x16x32_bf16 v[156:159], a[44:47], a[68:71], v[156:159]
    v_mfma_f32_16x16x32_bf16 v[156:159], a[40:43], a[64:67], v[156:159]
    v_mfma_f32_16x16x32_bf16 v[184:187], a[48:51], a[64:67], v[184:187]
    v_mfma_f32_16x16x32_bf16 v[184:187], a[52:55], a[68:71], v[184:187]
    s_add_u32 m0, s29, 114688
    v_mfma_f32_16x16x32_bf16 v[176:179], a[52:55], a[76:79], v[176:179]
    buffer_load_dwordx4 v2, s[8:11], s51 offen lds
    v_mfma_f32_16x16x32_bf16 v[176:179], a[48:51], a[72:75], v[176:179]
    v_mfma_f32_16x16x32_bf16 v[168:171], a[48:51], a[80:83], v[168:171]
    v_mfma_f32_16x16x32_bf16 v[168:171], a[52:55], a[84:87], v[168:171]
    v_mfma_f32_16x16x32_bf16 v[160:163], a[52:55], a[92:95], v[160:163]
    s_add_u32 m0, s29, 49152
    v_mfma_f32_16x16x32_bf16 v[160:163], a[48:51], a[88:91], v[160:163]
    buffer_load_dwordx4 v1, s[4:7], s44 offen lds
    v_mfma_f32_16x16x32_bf16 v[164:167], a[56:59], a[88:91], v[164:167]
    v_mfma_f32_16x16x32_bf16 v[164:167], a[60:63], a[92:95], v[164:167]
    v_mfma_f32_16x16x32_bf16 v[172:175], a[60:63], a[84:87], v[172:175]
    v_mfma_f32_16x16x32_bf16 v[172:175], a[56:59], a[80:83], v[172:175]
    s_add_u32 m0, s29, 118784
    v_mfma_f32_16x16x32_bf16 v[180:183], a[56:59], a[72:75], v[180:183]
    s_waitcnt vmcnt(11)
    buffer_load_dwordx4 v2, s[8:11], s52 offen lds
    v_mfma_f32_16x16x32_bf16 v[180:183], a[60:63], a[76:79], v[180:183]
    s_barrier
    ds_read_b64_tr_b16 a[0:1], v6 offset:0
    v_mfma_f32_16x16x32_bf16 v[188:191], a[60:63], a[68:71], v[188:191]
    ds_read_b64_tr_b16 a[2:3], v6 offset:4096
    v_mfma_f32_16x16x32_bf16 v[188:191], a[56:59], a[64:67], v[188:191]
    ds_read_b128 a[64:67], v4 offset:0
    v_mfma_f32_16x16x32_bf16 v[216:219], a[32:35], a[96:99], v[216:219]
    s_add_u32 m0, s29, 53248
    v_mfma_f32_16x16x32_bf16 v[216:219], a[36:39], a[100:103], v[216:219]
    buffer_load_dwordx4 v1, s[4:7], s45 offen lds
    v_mfma_f32_16x16x32_bf16 v[208:211], a[36:39], a[108:111], v[208:211]
    ds_read_b64_tr_b16 a[4:5], v6 offset:16384
    v_mfma_f32_16x16x32_bf16 v[208:211], a[32:35], a[104:107], v[208:211]
    ds_read_b64_tr_b16 a[6:7], v6 offset:20480
    v_mfma_f32_16x16x32_bf16 v[200:203], a[32:35], a[112:115], v[200:203]
    ds_read_b128 a[68:71], v5 offset:0
    v_mfma_f32_16x16x32_bf16 v[200:203], a[36:39], a[116:119], v[200:203]
    s_add_u32 m0, s29, 122880
    v_mfma_f32_16x16x32_bf16 v[192:195], a[36:39], a[124:127], v[192:195]
    buffer_load_dwordx4 v2, s[8:11], s53 offen lds
    v_mfma_f32_16x16x32_bf16 v[192:195], a[32:35], a[120:123], v[192:195]
    ds_read_b128 a[76:79], v5 offset:2048
    v_mfma_f32_16x16x32_bf16 v[196:199], a[40:43], a[120:123], v[196:199]
    v_mfma_f32_16x16x32_bf16 v[196:199], a[44:47], a[124:127], v[196:199]
    ds_read_b128 a[72:75], v4 offset:2048
    v_mfma_f32_16x16x32_bf16 v[204:207], a[44:47], a[116:119], v[204:207]
    s_add_u32 m0, s29, 57344
    v_mfma_f32_16x16x32_bf16 v[204:207], a[40:43], a[112:115], v[204:207]
    buffer_load_dwordx4 v1, s[4:7], s46 offen lds
    v_mfma_f32_16x16x32_bf16 v[212:215], a[40:43], a[104:107], v[212:215]
    ds_read_b128 a[80:83], v4 offset:4096
    v_mfma_f32_16x16x32_bf16 v[212:215], a[44:47], a[108:111], v[212:215]
    v_mfma_f32_16x16x32_bf16 v[220:223], a[44:47], a[100:103], v[220:223]
    ds_read_b128 a[84:87], v5 offset:4096
    v_mfma_f32_16x16x32_bf16 v[220:223], a[40:43], a[96:99], v[220:223]
    s_add_u32 m0, s29, 126976
    v_mfma_f32_16x16x32_bf16 v[248:251], a[48:51], a[96:99], v[248:251]
    buffer_load_dwordx4 v2, s[8:11], s54 offen lds
    v_mfma_f32_16x16x32_bf16 v[248:251], a[52:55], a[100:103], v[248:251]
    ds_read_b128 a[92:95], v5 offset:6144
    v_mfma_f32_16x16x32_bf16 v[240:243], a[52:55], a[108:111], v[240:243]
    v_mfma_f32_16x16x32_bf16 v[240:243], a[48:51], a[104:107], v[240:243]
    ds_read_b128 a[88:91], v4 offset:6144
    v_mfma_f32_16x16x32_bf16 v[232:235], a[48:51], a[112:115], v[232:235]
    s_add_u32 m0, s29, 61440
    v_mfma_f32_16x16x32_bf16 v[232:235], a[52:55], a[116:119], v[232:235]
    buffer_load_dwordx4 v1, s[4:7], s47 offen lds
    v_mfma_f32_16x16x32_bf16 v[224:227], a[52:55], a[124:127], v[224:227]
    v_add_u32 v1, 128, v1
    v_add_u32 v2, 0x80000, v2
    v_mfma_f32_16x16x32_bf16 v[224:227], a[48:51], a[120:123], v[224:227]
    ds_read_b64_tr_b16 a[8:9], v7 offset:0
    v_mfma_f32_16x16x32_bf16 v[228:231], a[56:59], a[120:123], v[228:231]
    buffer_load_dword a243, v14, s[36:39], s56 offen
    v_mfma_f32_16x16x32_bf16 v[228:231], a[60:63], a[124:127], v[228:231]
    s_add_u32 s56, s56, s30
    ds_read_b64_tr_b16 a[10:11], v7 offset:4096
    v_mfma_f32_16x16x32_bf16 v[236:239], a[60:63], a[116:119], v[236:239]
    ds_read_b64_tr_b16 a[12:13], v7 offset:16384
    v_mfma_f32_16x16x32_bf16 v[236:239], a[56:59], a[112:115], v[236:239]
    ds_read_b64_tr_b16 a[14:15], v7 offset:20480
    v_mfma_f32_16x16x32_bf16 v[244:247], a[56:59], a[104:107], v[244:247]
    ds_read_b64_tr_b16 a[16:17], v8 offset:0
    v_mfma_f32_16x16x32_bf16 v[244:247], a[60:63], a[108:111], v[244:247]
    ds_read_b64_tr_b16 a[18:19], v8 offset:4096
    v_mfma_f32_16x16x32_bf16 v[252:255], a[60:63], a[100:103], v[252:255]
    s_add_u32 s61, s61, 1
    ds_read_b64_tr_b16 a[20:21], v8 offset:16384
    v_mfma_f32_16x16x32_bf16 v[252:255], a[56:59], a[96:99], v[252:255]
    s_waitcnt lgkmcnt(8)
    ds_read_b64_tr_b16 a[22:23], v8 offset:20480
    s_cmp_lt_u32 s61, 6
    s_cbranch_scc1 L_kloop
    v_mfma_f32_16x16x32_bf16 v[88:91], a[0:3], a[64:67], v[88:91]
    ds_read_b64_tr_b16 a[24:25], v9 offset:0
    v_accvgpr_read_b32 v15, a240
    v_mfma_f32_16x16x32_bf16 v[88:91], a[4:7], a[68:71], v[88:91]
    ds_read_b64_tr_b16 a[26:27], v9 offset:4096
    v_accvgpr_read_b32 v14, a244
    v_mfma_f32_16x16x32_bf16 v[80:83], a[4:7], a[76:79], v[80:83]
    s_waitcnt lgkmcnt(12)
    ds_read_b64_tr_b16 a[28:29], v9 offset:16384
    global_load_dword a243, v14, s[100:101]
    v_mfma_f32_16x16x32_bf16 v[80:83], a[0:3], a[72:75], v[80:83]
    ds_read_b64_tr_b16 a[30:31], v9 offset:20480
    v_accvgpr_read_b32 v14, a242
    v_mfma_f32_16x16x32_bf16 v[72:75], a[0:3], a[80:83], v[72:75]
    s_add_u32 m0, s33, 0x0
    ds_read_b128 a[96:99], v4 offset:8192
    v_xor_b32 v3, 64, v14
    v_mfma_f32_16x16x32_bf16 v[72:75], a[4:7], a[84:87], v[72:75]
    s_waitcnt lgkmcnt(11)
    v_mfma_f32_16x16x32_bf16 v[64:67], a[4:7], a[92:95], v[64:67]
    ds_read_b128 a[100:103], v5 offset:8192
    buffer_load_dwordx4 v15, s[20:23], 0 offen offset:0 lds
    v_mfma_f32_16x16x32_bf16 v[64:67], a[0:3], a[88:91], v[64:67]
    v_mfma_f32_16x16x32_bf16 v[68:71], a[8:11], a[88:91], v[68:71]
    s_waitcnt lgkmcnt(10)
    ds_read_b128 a[108:111], v5 offset:10240
    v_mfma_f32_16x16x32_bf16 v[68:71], a[12:15], a[92:95], v[68:71]
    s_add_u32 m0, s33, 0x80
    v_mfma_f32_16x16x32_bf16 v[76:79], a[12:15], a[84:87], v[76:79]
    ds_read_b128 a[104:107], v4 offset:10240
    buffer_load_dwordx4 v15, s[20:23], 0 offen offset:896 lds
    v_mfma_f32_16x16x32_bf16 v[76:79], a[8:11], a[80:83], v[76:79]
    v_mfma_f32_16x16x32_bf16 v[84:87], a[8:11], a[72:75], v[84:87]
    ds_read_b128 a[112:115], v4 offset:12288
    v_mfma_f32_16x16x32_bf16 v[84:87], a[12:15], a[76:79], v[84:87]
    s_add_u32 m0, s33, 0x800
    v_mfma_f32_16x16x32_bf16 v[92:95], a[12:15], a[68:71], v[92:95]
    ds_read_b128 a[116:119], v5 offset:12288
    buffer_load_dwordx4 v15, s[20:23], s57 offen offset:0 lds
    v_mfma_f32_16x16x32_bf16 v[92:95], a[8:11], a[64:67], v[92:95]
    s_waitcnt lgkmcnt(10)
    v_mfma_f32_16x16x32_bf16 v[120:123], a[16:19], a[64:67], v[120:123]
    ds_read_b128 a[124:127], v5 offset:14336
    v_mfma_f32_16x16x32_bf16 v[120:123], a[20:23], a[68:71], v[120:123]
    s_add_u32 m0, s33, 0x880
    v_mfma_f32_16x16x32_bf16 v[112:115], a[20:23], a[76:79], v[112:115]
    ds_read_b128 a[120:123], v4 offset:14336
    buffer_load_dwordx4 v15, s[20:23], s57 offen offset:896 lds
    v_mfma_f32_16x16x32_bf16 v[112:115], a[16:19], a[72:75], v[112:115]
    v_mfma_f32_16x16x32_bf16 v[104:107], a[16:19], a[80:83], v[104:107]
    ds_read_b64_tr_b16 a[32:33], v10 offset:0
    v_mfma_f32_16x16x32_bf16 v[104:107], a[20:23], a[84:87], v[104:107]
    s_add_u32 m0, s33, 0xf80
    ds_read_b64_tr_b16 a[34:35], v10 offset:4096
    v_mfma_f32_16x16x32_bf16 v[96:99], a[20:23], a[92:95], v[96:99]
    ds_read_b64_tr_b16 a[36:37], v10 offset:16384
    buffer_load_dwordx4 v15, s[20:23], 0 offen offset:128 lds
    v_mfma_f32_16x16x32_bf16 v[96:99], a[16:19], a[88:91], v[96:99]
    s_waitcnt lgkmcnt(11)
    ds_read_b64_tr_b16 a[38:39], v10 offset:20480
    v_mfma_f32_16x16x32_bf16 v[100:103], a[24:27], a[88:91], v[100:103]
    ds_read_b64_tr_b16 a[40:41], v11 offset:0
    v_mfma_f32_16x16x32_bf16 v[100:103], a[28:31], a[92:95], v[100:103]
    s_add_u32 m0, s33, 0x1000
    ds_read_b64_tr_b16 a[42:43], v11 offset:4096
    v_mfma_f32_16x16x32_bf16 v[108:111], a[28:31], a[84:87], v[108:111]
    ds_read_b64_tr_b16 a[44:45], v11 offset:16384
    buffer_load_dwordx4 v15, s[20:23], 0 offen offset:1024 lds
    v_mfma_f32_16x16x32_bf16 v[108:111], a[24:27], a[80:83], v[108:111]
    ds_read_b64_tr_b16 a[46:47], v11 offset:20480
    v_mfma_f32_16x16x32_bf16 v[116:119], a[24:27], a[72:75], v[116:119]
    ds_read_b64_tr_b16 a[48:49], v12 offset:0
    v_mfma_f32_16x16x32_bf16 v[116:119], a[28:31], a[76:79], v[116:119]
    s_add_u32 m0, s33, 0x1780
    ds_read_b64_tr_b16 a[50:51], v12 offset:4096
    v_mfma_f32_16x16x32_bf16 v[124:127], a[28:31], a[68:71], v[124:127]
    ds_read_b64_tr_b16 a[52:53], v12 offset:16384
    buffer_load_dwordx4 v15, s[20:23], s57 offen offset:128 lds
    v_mfma_f32_16x16x32_bf16 v[124:127], a[24:27], a[64:67], v[124:127]
    s_waitcnt lgkmcnt(15)
    ds_read_b64_tr_b16 a[54:55], v12 offset:20480
    v_mfma_f32_16x16x32_bf16 a[232:235], a[0:3], a[96:99], a[232:235]
    ds_read_b64_tr_b16 a[56:57], v13 offset:0
    v_mfma_f32_16x16x32_bf16 a[232:235], a[4:7], a[100:103], a[232:235]
    s_add_u32 m0, s33, 0x1800
    ds_read_b64_tr_b16 a[58:59], v13 offset:4096
    v_mfma_f32_16x16x32_bf16 a[224:227], a[4:7], a[108:111], a[224:227]
    ds_read_b64_tr_b16 a[60:61], v13 offset:16384
    buffer_load_dwordx4 v15, s[20:23], s57 offen offset:1024 lds
    v_mfma_f32_16x16x32_bf16 a[224:227], a[0:3], a[104:107], a[224:227]
    s_waitcnt lgkmcnt(15)
    ds_read_b64_tr_b16 a[62:63], v13 offset:20480
    v_mfma_f32_16x16x32_bf16 v[24:27], a[0:3], a[112:115], v[24:27]
    v_mfma_f32_16x16x32_bf16 v[24:27], a[4:7], a[116:119], v[24:27]
    v_mfma_f32_16x16x32_bf16 v[16:19], a[4:7], a[124:127], v[16:19]
    v_mfma_f32_16x16x32_bf16 v[16:19], a[0:3], a[120:123], v[16:19]
    s_waitcnt lgkmcnt(0)
    v_mfma_f32_16x16x32_bf16 v[20:23], a[8:11], a[120:123], v[20:23]
    s_barrier
    v_mfma_f32_16x16x32_bf16 v[20:23], a[12:15], a[124:127], v[20:23]
    s_add_u32 m0, s29, 65536
    v_mfma_f32_16x16x32_bf16 v[28:31], a[12:15], a[116:119], v[28:31]
    buffer_load_dwordx4 v2, s[8:11], 0 offen lds
    v_mfma_f32_16x16x32_bf16 v[28:31], a[8:11], a[112:115], v[28:31]
    v_mfma_f32_16x16x32_bf16 a[228:231], a[8:11], a[104:107], a[228:231]
    v_mfma_f32_16x16x32_bf16 a[228:231], a[12:15], a[108:111], a[228:231]
    v_mfma_f32_16x16x32_bf16 a[236:239], a[12:15], a[100:103], a[236:239]
    s_add_u32 m0, s29, 0
    v_mfma_f32_16x16x32_bf16 a[236:239], a[8:11], a[96:99], a[236:239]
    buffer_load_dwordx4 v1, s[4:7], 0 offen lds
    v_mfma_f32_16x16x32_bf16 v[56:59], a[16:19], a[96:99], v[56:59]
    v_mfma_f32_16x16x32_bf16 v[56:59], a[20:23], a[100:103], v[56:59]
    v_mfma_f32_16x16x32_bf16 v[48:51], a[20:23], a[108:111], v[48:51]
    v_mfma_f32_16x16x32_bf16 v[48:51], a[16:19], a[104:107], v[48:51]
    s_add_u32 m0, s29, 69632
    v_mfma_f32_16x16x32_bf16 v[40:43], a[16:19], a[112:115], v[40:43]
    buffer_load_dwordx4 v2, s[8:11], s48 offen lds
    v_mfma_f32_16x16x32_bf16 v[40:43], a[20:23], a[116:119], v[40:43]
    v_mfma_f32_16x16x32_bf16 v[32:35], a[20:23], a[124:127], v[32:35]
    v_mfma_f32_16x16x32_bf16 v[32:35], a[16:19], a[120:123], v[32:35]
    v_mfma_f32_16x16x32_bf16 v[36:39], a[24:27], a[120:123], v[36:39]
    s_add_u32 m0, s29, 4096
    v_mfma_f32_16x16x32_bf16 v[36:39], a[28:31], a[124:127], v[36:39]
    buffer_load_dwordx4 v1, s[4:7], s41 offen lds
    v_mfma_f32_16x16x32_bf16 v[44:47], a[28:31], a[116:119], v[44:47]
    v_mfma_f32_16x16x32_bf16 v[44:47], a[24:27], a[112:115], v[44:47]
    v_mfma_f32_16x16x32_bf16 v[52:55], a[24:27], a[104:107], v[52:55]
    v_mfma_f32_16x16x32_bf16 v[52:55], a[28:31], a[108:111], v[52:55]
    s_add_u32 m0, s29, 73728
    v_mfma_f32_16x16x32_bf16 v[60:63], a[28:31], a[100:103], v[60:63]
    buffer_load_dwordx4 v2, s[8:11], s49 offen lds
    v_mfma_f32_16x16x32_bf16 v[60:63], a[24:27], a[96:99], v[60:63]
    v_mfma_f32_16x16x32_bf16 v[216:219], a[32:35], a[96:99], v[216:219]
    v_mfma_f32_16x16x32_bf16 v[216:219], a[36:39], a[100:103], v[216:219]
    v_mfma_f32_16x16x32_bf16 v[208:211], a[36:39], a[108:111], v[208:211]
    s_add_u32 m0, s29, 8192
    v_mfma_f32_16x16x32_bf16 v[208:211], a[32:35], a[104:107], v[208:211]
    buffer_load_dwordx4 v1, s[4:7], s42 offen lds
    v_mfma_f32_16x16x32_bf16 v[200:203], a[32:35], a[112:115], v[200:203]
    v_mfma_f32_16x16x32_bf16 v[200:203], a[36:39], a[116:119], v[200:203]
    v_mfma_f32_16x16x32_bf16 v[192:195], a[36:39], a[124:127], v[192:195]
    v_mfma_f32_16x16x32_bf16 v[192:195], a[32:35], a[120:123], v[192:195]
    s_add_u32 m0, s29, 77824
    v_mfma_f32_16x16x32_bf16 v[196:199], a[40:43], a[120:123], v[196:199]
    buffer_load_dwordx4 v2, s[8:11], s50 offen lds
    v_mfma_f32_16x16x32_bf16 v[196:199], a[44:47], a[124:127], v[196:199]
    v_mfma_f32_16x16x32_bf16 v[204:207], a[44:47], a[116:119], v[204:207]
    v_mfma_f32_16x16x32_bf16 v[204:207], a[40:43], a[112:115], v[204:207]
    v_mfma_f32_16x16x32_bf16 v[212:215], a[40:43], a[104:107], v[212:215]
    s_add_u32 m0, s29, 12288
    v_mfma_f32_16x16x32_bf16 v[212:215], a[44:47], a[108:111], v[212:215]
    buffer_load_dwordx4 v1, s[4:7], s43 offen lds
    v_mfma_f32_16x16x32_bf16 v[220:223], a[44:47], a[100:103], v[220:223]
    v_mfma_f32_16x16x32_bf16 v[220:223], a[40:43], a[96:99], v[220:223]
    v_mfma_f32_16x16x32_bf16 v[248:251], a[48:51], a[96:99], v[248:251]
    v_mfma_f32_16x16x32_bf16 v[248:251], a[52:55], a[100:103], v[248:251]
    s_add_u32 m0, s29, 81920
    v_mfma_f32_16x16x32_bf16 v[240:243], a[52:55], a[108:111], v[240:243]
    buffer_load_dwordx4 v2, s[8:11], s51 offen lds
    v_mfma_f32_16x16x32_bf16 v[240:243], a[48:51], a[104:107], v[240:243]
    v_mfma_f32_16x16x32_bf16 v[232:235], a[48:51], a[112:115], v[232:235]
    v_mfma_f32_16x16x32_bf16 v[232:235], a[52:55], a[116:119], v[232:235]
    v_mfma_f32_16x16x32_bf16 v[224:227], a[52:55], a[124:127], v[224:227]
    s_add_u32 m0, s29, 16384
    v_mfma_f32_16x16x32_bf16 v[224:227], a[48:51], a[120:123], v[224:227]
    buffer_load_dwordx4 v1, s[4:7], s44 offen lds
    v_mfma_f32_16x16x32_bf16 v[228:231], a[56:59], a[120:123], v[228:231]
    v_mfma_f32_16x16x32_bf16 v[228:231], a[60:63], a[124:127], v[228:231]
    v_mfma_f32_16x16x32_bf16 v[236:239], a[60:63], a[116:119], v[236:239]
    v_mfma_f32_16x16x32_bf16 v[236:239], a[56:59], a[112:115], v[236:239]
    s_add_u32 m0, s29, 86016
    v_mfma_f32_16x16x32_bf16 v[244:247], a[56:59], a[104:107], v[244:247]
    s_waitcnt vmcnt(10)
    buffer_load_dwordx4 v2, s[8:11], s52 offen lds
    v_mfma_f32_16x16x32_bf16 v[244:247], a[60:63], a[108:111], v[244:247]
    s_barrier
    ds_read_b64_tr_b16 a[0:1], v6 offset:32768
    v_mfma_f32_16x16x32_bf16 v[252:255], a[60:63], a[100:103], v[252:255]
    ds_read_b64_tr_b16 a[2:3], v6 offset:36864
    v_mfma_f32_16x16x32_bf16 v[252:255], a[56:59], a[96:99], v[252:255]
    ds_read_b128 a[96:99], v4 offset:40960
    v_mfma_f32_16x16x32_bf16 v[152:155], a[32:35], a[64:67], v[152:155]
    s_add_u32 m0, s29, 20480
    ds_read_b128 a[128:131], v14 offset:0
    v_mfma_f32_16x16x32_bf16 v[152:155], a[36:39], a[68:71], v[152:155]
    buffer_load_dwordx4 v1, s[4:7], s45 offen lds
    v_mfma_f32_16x16x32_bf16 v[144:147], a[36:39], a[76:79], v[144:147]
    ds_read_b64_tr_b16 a[4:5], v6 offset:49152
    v_mfma_f32_16x16x32_bf16 v[144:147], a[32:35], a[72:75], v[144:147]
    ds_read_b64_tr_b16 a[6:7], v6 offset:53248
    v_mfma_f32_16x16x32_bf16 v[136:139], a[32:35], a[80:83], v[136:139]
    ds_read_b128 a[100:103], v5 offset:40960
    v_mfma_f32_16x16x32_bf16 v[136:139], a[36:39], a[84:87], v[136:139]
    s_add_u32 m0, s29, 90112
    ds_read_b128 a[136:139], v3 offset:0
    v_mfma_f32_16x16x32_bf16 v[128:131], a[36:39], a[92:95], v[128:131]
    buffer_load_dwordx4 v2, s[8:11], s53 offen lds
    v_mfma_f32_16x16x32_bf16 v[128:131], a[32:35], a[88:91], v[128:131]
    ds_read_b128 a[108:111], v5 offset:43008
    v_mfma_f32_16x16x32_bf16 v[132:135], a[40:43], a[88:91], v[132:135]
    ds_read_b128 a[132:135], v14 offset:2048
    v_mfma_f32_16x16x32_bf16 v[132:135], a[44:47], a[92:95], v[132:135]
    ds_read_b128 a[104:107], v4 offset:43008
    v_mfma_f32_16x16x32_bf16 v[140:143], a[44:47], a[84:87], v[140:143]
    s_add_u32 m0, s29, 24576
    ds_read_b128 a[140:143], v3 offset:2048
    v_mfma_f32_16x16x32_bf16 v[140:143], a[40:43], a[80:83], v[140:143]
    buffer_load_dwordx4 v1, s[4:7], s46 offen lds
    v_mfma_f32_16x16x32_bf16 v[148:151], a[40:43], a[72:75], v[148:151]
    ds_read_b128 a[112:115], v4 offset:45056
    v_mfma_f32_16x16x32_bf16 v[148:151], a[44:47], a[76:79], v[148:151]
    ds_read_b128 a[144:147], v14 offset:4096
    v_mfma_f32_16x16x32_bf16 v[156:159], a[44:47], a[68:71], v[156:159]
    ds_read_b128 a[116:119], v5 offset:45056
    v_mfma_f32_16x16x32_bf16 v[156:159], a[40:43], a[64:67], v[156:159]
    s_add_u32 m0, s29, 94208
    ds_read_b128 a[152:155], v3 offset:4096
    v_mfma_f32_16x16x32_bf16 v[184:187], a[48:51], a[64:67], v[184:187]
    buffer_load_dwordx4 v2, s[8:11], s54 offen lds
    v_mfma_f32_16x16x32_bf16 v[184:187], a[52:55], a[68:71], v[184:187]
    ds_read_b128 a[124:127], v5 offset:47104
    v_mfma_f32_16x16x32_bf16 v[176:179], a[52:55], a[76:79], v[176:179]
    ds_read_b128 a[148:151], v14 offset:6144
    v_mfma_f32_16x16x32_bf16 v[176:179], a[48:51], a[72:75], v[176:179]
    ds_read_b128 a[120:123], v4 offset:47104
    v_mfma_f32_16x16x32_bf16 v[168:171], a[48:51], a[80:83], v[168:171]
    s_add_u32 m0, s29, 28672
    ds_read_b128 a[156:159], v3 offset:6144
    v_mfma_f32_16x16x32_bf16 v[168:171], a[52:55], a[84:87], v[168:171]
    buffer_load_dwordx4 v1, s[4:7], s47 offen lds
    v_mfma_f32_16x16x32_bf16 v[160:163], a[52:55], a[92:95], v[160:163]
    v_add_u32 v1, 128, v1
    v_add_u32 v2, 0x80000, v2
    v_mfma_f32_16x16x32_bf16 v[160:163], a[48:51], a[88:91], v[160:163]
    ds_read_b64_tr_b16 a[8:9], v7 offset:32768
    v_mfma_f32_16x16x32_bf16 v[164:167], a[56:59], a[88:91], v[164:167]
    v_mfma_f32_16x16x32_bf16 v[164:167], a[60:63], a[92:95], v[164:167]
    ds_read_b64_tr_b16 a[10:11], v7 offset:36864
    v_mfma_f32_16x16x32_bf16 v[172:175], a[60:63], a[84:87], v[172:175]
    ds_read_b64_tr_b16 a[12:13], v7 offset:49152
    v_mfma_f32_16x16x32_bf16 v[172:175], a[56:59], a[80:83], v[172:175]
    ds_read_b64_tr_b16 a[14:15], v7 offset:53248
    v_mfma_f32_16x16x32_bf16 v[180:183], a[56:59], a[72:75], v[180:183]
    ds_read_b64_tr_b16 a[16:17], v8 offset:32768
    v_mfma_f32_16x16x32_bf16 v[180:183], a[60:63], a[76:79], v[180:183]
    ds_read_b64_tr_b16 a[18:19], v8 offset:36864
    v_mfma_f32_16x16x32_bf16 v[188:191], a[60:63], a[68:71], v[188:191]
    ds_read_b64_tr_b16 a[20:21], v8 offset:49152
    v_mfma_f32_16x16x32_bf16 v[188:191], a[56:59], a[64:67], v[188:191]
    s_waitcnt lgkmcnt(15)
    ds_read_b64_tr_b16 a[22:23], v8 offset:53248
    v_mfma_f32_16x16x32_bf16 a[232:235], a[0:3], a[96:99], a[232:235]
    ds_read_b64_tr_b16 a[24:25], v9 offset:32768
    v_mfma_f32_16x16x32_bf16 a[232:235], a[4:7], a[100:103], a[232:235]
    s_add_u32 m0, s33, 0xffffff00
    ds_read_b64_tr_b16 a[26:27], v9 offset:36864
    v_mfma_f32_16x16x32_bf16 a[224:227], a[4:7], a[108:111], a[224:227]
    s_waitcnt lgkmcnt(10)
    ds_read_b64_tr_b16 a[28:29], v9 offset:49152
    v_mfma_f32_16x16x32_bf16 a[224:227], a[0:3], a[104:107], a[224:227]
    ds_read_b64_tr_b16 a[30:31], v9 offset:53248
    buffer_load_dwordx4 v15, s[20:23], 0 offen offset:256 lds
    v_mfma_f32_16x16x32_bf16 v[24:27], a[0:3], a[112:115], v[24:27]
    ds_read_b128 a[64:67], v4 offset:32768
    v_mfma_f32_16x16x32_bf16 v[24:27], a[4:7], a[116:119], v[24:27]
    v_mfma_f32_16x16x32_bf16 v[16:19], a[4:7], a[124:127], v[16:19]
    s_add_u32 m0, s33, 0xffffff80
    ds_read_b128 a[68:71], v5 offset:32768
    v_mfma_f32_16x16x32_bf16 v[16:19], a[0:3], a[120:123], v[16:19]
    s_waitcnt lgkmcnt(10)
    buffer_load_dwordx4 v15, s[20:23], 0 offen offset:1152 lds
    v_mfma_f32_16x16x32_bf16 v[20:23], a[8:11], a[120:123], v[20:23]
    ds_read_b128 a[76:79], v5 offset:34816
    v_mfma_f32_16x16x32_bf16 v[20:23], a[12:15], a[124:127], v[20:23]
    v_mfma_f32_16x16x32_bf16 v[28:31], a[12:15], a[116:119], v[28:31]
    s_add_u32 m0, s33, 0x700
    ds_read_b128 a[72:75], v4 offset:34816
    v_mfma_f32_16x16x32_bf16 v[28:31], a[8:11], a[112:115], v[28:31]
    buffer_load_dwordx4 v15, s[20:23], s57 offen offset:256 lds
    v_mfma_f32_16x16x32_bf16 a[228:231], a[8:11], a[104:107], a[228:231]
    ds_read_b128 a[80:83], v4 offset:36864
    v_mfma_f32_16x16x32_bf16 a[228:231], a[12:15], a[108:111], a[228:231]
    v_mfma_f32_16x16x32_bf16 a[236:239], a[12:15], a[100:103], a[236:239]
    s_add_u32 m0, s33, 0x780
    ds_read_b128 a[84:87], v5 offset:36864
    v_mfma_f32_16x16x32_bf16 a[236:239], a[8:11], a[96:99], a[236:239]
    s_waitcnt lgkmcnt(10)
    buffer_load_dwordx4 v15, s[20:23], s57 offen offset:1152 lds
    v_mfma_f32_16x16x32_bf16 v[56:59], a[16:19], a[96:99], v[56:59]
    ds_read_b128 a[92:95], v5 offset:38912
    v_mfma_f32_16x16x32_bf16 v[56:59], a[20:23], a[100:103], v[56:59]
    v_mfma_f32_16x16x32_bf16 v[48:51], a[20:23], a[108:111], v[48:51]
    s_add_u32 m0, s33, 0xe80
    ds_read_b128 a[88:91], v4 offset:38912
    v_mfma_f32_16x16x32_bf16 v[48:51], a[16:19], a[104:107], v[48:51]
    buffer_load_dwordx4 v15, s[20:23], 0 offen offset:384 lds
    v_mfma_f32_16x16x32_bf16 v[40:43], a[16:19], a[112:115], v[40:43]
    ds_read_b64_tr_b16 a[32:33], v10 offset:32768
    v_mfma_f32_16x16x32_bf16 v[40:43], a[20:23], a[116:119], v[40:43]
    ds_read_b64_tr_b16 a[34:35], v10 offset:36864
    v_mfma_f32_16x16x32_bf16 v[32:35], a[20:23], a[124:127], v[32:35]
    s_add_u32 m0, s33, 0xf00
    ds_read_b64_tr_b16 a[36:37], v10 offset:49152
    v_mfma_f32_16x16x32_bf16 v[32:35], a[16:19], a[120:123], v[32:35]
    s_waitcnt lgkmcnt(11)
    ds_read_b64_tr_b16 a[38:39], v10 offset:53248
    buffer_load_dwordx4 v15, s[20:23], 0 offen offset:1280 lds
    v_mfma_f32_16x16x32_bf16 v[36:39], a[24:27], a[120:123], v[36:39]
    ds_read_b64_tr_b16 a[40:41], v11 offset:32768
    v_mfma_f32_16x16x32_bf16 v[36:39], a[28:31], a[124:127], v[36:39]
    ds_read_b64_tr_b16 a[42:43], v11 offset:36864
    v_mfma_f32_16x16x32_bf16 v[44:47], a[28:31], a[116:119], v[44:47]
    s_add_u32 m0, s33, 0x1680
    ds_read_b64_tr_b16 a[44:45], v11 offset:49152
    v_mfma_f32_16x16x32_bf16 v[44:47], a[24:27], a[112:115], v[44:47]
    ds_read_b64_tr_b16 a[46:47], v11 offset:53248
    buffer_load_dwordx4 v15, s[20:23], s57 offen offset:384 lds
    v_mfma_f32_16x16x32_bf16 v[52:55], a[24:27], a[104:107], v[52:55]
    ds_read_b64_tr_b16 a[48:49], v12 offset:32768
    v_mfma_f32_16x16x32_bf16 v[52:55], a[28:31], a[108:111], v[52:55]
    ds_read_b64_tr_b16 a[50:51], v12 offset:36864
    v_mfma_f32_16x16x32_bf16 v[60:63], a[28:31], a[100:103], v[60:63]
    s_add_u32 m0, s33, 0x1700
    ds_read_b64_tr_b16 a[52:53], v12 offset:49152
    v_mfma_f32_16x16x32_bf16 v[60:63], a[24:27], a[96:99], v[60:63]
    s_waitcnt lgkmcnt(15)
    ds_read_b64_tr_b16 a[54:55], v12 offset:53248
    buffer_load_dwordx4 v15, s[20:23], s57 offen offset:1280 lds
    v_mfma_f32_16x16x32_bf16 v[88:91], a[0:3], a[64:67], v[88:91]
    ds_read_b64_tr_b16 a[56:57], v13 offset:32768
    v_mfma_f32_16x16x32_bf16 v[88:91], a[4:7], a[68:71], v[88:91]
    ds_read_b64_tr_b16 a[58:59], v13 offset:36864
    v_mfma_f32_16x16x32_bf16 v[80:83], a[4:7], a[76:79], v[80:83]
    ds_read_b64_tr_b16 a[60:61], v13 offset:49152
    v_mfma_f32_16x16x32_bf16 v[80:83], a[0:3], a[72:75], v[80:83]
    s_waitcnt lgkmcnt(15)
    ds_read_b64_tr_b16 a[62:63], v13 offset:53248
    v_mfma_f32_16x16x32_bf16 v[72:75], a[0:3], a[80:83], v[72:75]
    v_mfma_f32_16x16x32_bf16 v[72:75], a[4:7], a[84:87], v[72:75]
    v_mfma_f32_16x16x32_bf16 v[64:67], a[4:7], a[92:95], v[64:67]
    v_mfma_f32_16x16x32_bf16 v[64:67], a[0:3], a[88:91], v[64:67]
    s_waitcnt lgkmcnt(0)
    v_mfma_f32_16x16x32_bf16 v[68:71], a[8:11], a[88:91], v[68:71]
    s_barrier
    v_mfma_f32_16x16x32_bf16 v[68:71], a[12:15], a[92:95], v[68:71]
    s_add_u32 m0, s29, 98304
    v_mfma_f32_16x16x32_bf16 v[76:79], a[12:15], a[84:87], v[76:79]
    buffer_load_dwordx4 v2, s[8:11], 0 offen lds
    v_mfma_f32_16x16x32_bf16 v[76:79], a[8:11], a[80:83], v[76:79]
    v_mfma_f32_16x16x32_bf16 v[84:87], a[8:11], a[72:75], v[84:87]
    v_mfma_f32_16x16x32_bf16 v[84:87], a[12:15], a[76:79], v[84:87]
    v_mfma_f32_16x16x32_bf16 v[92:95], a[12:15], a[68:71], v[92:95]
    s_add_u32 m0, s29, 32768
    v_mfma_f32_16x16x32_bf16 v[92:95], a[8:11], a[64:67], v[92:95]
    buffer_load_dwordx4 v1, s[4:7], 0 offen lds
    v_mfma_f32_16x16x32_bf16 v[120:123], a[16:19], a[64:67], v[120:123]
    v_mfma_f32_16x16x32_bf16 v[120:123], a[20:23], a[68:71], v[120:123]
    v_mfma_f32_16x16x32_bf16 v[112:115], a[20:23], a[76:79], v[112:115]
    v_mfma_f32_16x16x32_bf16 v[112:115], a[16:19], a[72:75], v[112:115]
    s_add_u32 m0, s29, 102400
    v_mfma_f32_16x16x32_bf16 v[104:107], a[16:19], a[80:83], v[104:107]
    buffer_load_dwordx4 v2, s[8:11], s48 offen lds
    v_mfma_f32_16x16x32_bf16 v[104:107], a[20:23], a[84:87], v[104:107]
    v_mfma_f32_16x16x32_bf16 v[96:99], a[20:23], a[92:95], v[96:99]
    v_mfma_f32_16x16x32_bf16 v[96:99], a[16:19], a[88:91], v[96:99]
    v_mfma_f32_16x16x32_bf16 v[100:103], a[24:27], a[88:91], v[100:103]
    s_add_u32 m0, s29, 36864
    v_mfma_f32_16x16x32_bf16 v[100:103], a[28:31], a[92:95], v[100:103]
    buffer_load_dwordx4 v1, s[4:7], s41 offen lds
    v_mfma_f32_16x16x32_bf16 v[108:111], a[28:31], a[84:87], v[108:111]
    v_mfma_f32_16x16x32_bf16 v[108:111], a[24:27], a[80:83], v[108:111]
    v_mfma_f32_16x16x32_bf16 v[116:119], a[24:27], a[72:75], v[116:119]
    v_mfma_f32_16x16x32_bf16 v[116:119], a[28:31], a[76:79], v[116:119]
    s_add_u32 m0, s29, 106496
    v_mfma_f32_16x16x32_bf16 v[124:127], a[28:31], a[68:71], v[124:127]
    buffer_load_dwordx4 v2, s[8:11], s49 offen lds
    v_mfma_f32_16x16x32_bf16 v[124:127], a[24:27], a[64:67], v[124:127]
    v_mfma_f32_16x16x32_bf16 v[152:155], a[32:35], a[64:67], v[152:155]
    v_mfma_f32_16x16x32_bf16 v[152:155], a[36:39], a[68:71], v[152:155]
    v_mfma_f32_16x16x32_bf16 v[144:147], a[36:39], a[76:79], v[144:147]
    s_add_u32 m0, s29, 40960
    v_mfma_f32_16x16x32_bf16 v[144:147], a[32:35], a[72:75], v[144:147]
    buffer_load_dwordx4 v1, s[4:7], s42 offen lds
    v_mfma_f32_16x16x32_bf16 v[136:139], a[32:35], a[80:83], v[136:139]
    v_mfma_f32_16x16x32_bf16 v[136:139], a[36:39], a[84:87], v[136:139]
    v_mfma_f32_16x16x32_bf16 v[128:131], a[36:39], a[92:95], v[128:131]
    v_mfma_f32_16x16x32_bf16 v[128:131], a[32:35], a[88:91], v[128:131]
    s_add_u32 m0, s29, 110592
    v_mfma_f32_16x16x32_bf16 v[132:135], a[40:43], a[88:91], v[132:135]
    buffer_load_dwordx4 v2, s[8:11], s50 offen lds
    v_mfma_f32_16x16x32_bf16 v[132:135], a[44:47], a[92:95], v[132:135]
    v_mfma_f32_16x16x32_bf16 v[140:143], a[44:47], a[84:87], v[140:143]
    v_mfma_f32_16x16x32_bf16 v[140:143], a[40:43], a[80:83], v[140:143]
    v_mfma_f32_16x16x32_bf16 v[148:151], a[40:43], a[72:75], v[148:151]
    s_add_u32 m0, s29, 45056
    v_mfma_f32_16x16x32_bf16 v[148:151], a[44:47], a[76:79], v[148:151]
    buffer_load_dwordx4 v1, s[4:7], s43 offen lds
    v_mfma_f32_16x16x32_bf16 v[156:159], a[44:47], a[68:71], v[156:159]
    v_mfma_f32_16x16x32_bf16 v[156:159], a[40:43], a[64:67], v[156:159]
    v_mfma_f32_16x16x32_bf16 v[184:187], a[48:51], a[64:67], v[184:187]
    v_mfma_f32_16x16x32_bf16 v[184:187], a[52:55], a[68:71], v[184:187]
    s_add_u32 m0, s29, 114688
    v_mfma_f32_16x16x32_bf16 v[176:179], a[52:55], a[76:79], v[176:179]
    buffer_load_dwordx4 v2, s[8:11], s51 offen lds
    v_mfma_f32_16x16x32_bf16 v[176:179], a[48:51], a[72:75], v[176:179]
    v_mfma_f32_16x16x32_bf16 v[168:171], a[48:51], a[80:83], v[168:171]
    v_mfma_f32_16x16x32_bf16 v[168:171], a[52:55], a[84:87], v[168:171]
    v_mfma_f32_16x16x32_bf16 v[160:163], a[52:55], a[92:95], v[160:163]
    s_add_u32 m0, s29, 49152
    v_mfma_f32_16x16x32_bf16 v[160:163], a[48:51], a[88:91], v[160:163]
    buffer_load_dwordx4 v1, s[4:7], s44 offen lds
    v_mfma_f32_16x16x32_bf16 v[164:167], a[56:59], a[88:91], v[164:167]
    v_mfma_f32_16x16x32_bf16 v[164:167], a[60:63], a[92:95], v[164:167]
    v_mfma_f32_16x16x32_bf16 v[172:175], a[60:63], a[84:87], v[172:175]
    v_mfma_f32_16x16x32_bf16 v[172:175], a[56:59], a[80:83], v[172:175]
    s_add_u32 m0, s29, 118784
    v_mfma_f32_16x16x32_bf16 v[180:183], a[56:59], a[72:75], v[180:183]
    s_waitcnt vmcnt(10)
    buffer_load_dwordx4 v2, s[8:11], s52 offen lds
    v_mfma_f32_16x16x32_bf16 v[180:183], a[60:63], a[76:79], v[180:183]
    s_barrier
    ds_read_b64_tr_b16 a[0:1], v6 offset:0
    v_mfma_f32_16x16x32_bf16 v[188:191], a[60:63], a[68:71], v[188:191]
    ds_read_b64_tr_b16 a[2:3], v6 offset:4096
    v_mfma_f32_16x16x32_bf16 v[188:191], a[56:59], a[64:67], v[188:191]
    ds_read_b128 a[64:67], v4 offset:0
    v_mfma_f32_16x16x32_bf16 v[216:219], a[32:35], a[96:99], v[216:219]
    s_add_u32 m0, s29, 53248
    ds_read_b128 a[160:163], v14 offset:0
    v_mfma_f32_16x16x32_bf16 v[216:219], a[36:39], a[100:103], v[216:219]
    buffer_load_dwordx4 v1, s[4:7], s45 offen lds
    v_mfma_f32_16x16x32_bf16 v[208:211], a[36:39], a[108:111], v[208:211]
    ds_read_b64_tr_b16 a[4:5], v6 offset:16384
    v_mfma_f32_16x16x32_bf16 v[208:211], a[32:35], a[104:107], v[208:211]
    ds_read_b64_tr_b16 a[6:7], v6 offset:20480
    v_mfma_f32_16x16x32_bf16 v[200:203], a[32:35], a[112:115], v[200:203]
    ds_read_b128 a[68:71], v5 offset:0
    v_mfma_f32_16x16x32_bf16 v[200:203], a[36:39], a[116:119], v[200:203]
    s_add_u32 m0, s29, 122880
    ds_read_b128 a[168:171], v3 offset:0
    v_mfma_f32_16x16x32_bf16 v[192:195], a[36:39], a[124:127], v[192:195]
    buffer_load_dwordx4 v2, s[8:11], s53 offen lds
    v_mfma_f32_16x16x32_bf16 v[192:195], a[32:35], a[120:123], v[192:195]
    ds_read_b128 a[76:79], v5 offset:2048
    v_mfma_f32_16x16x32_bf16 v[196:199], a[40:43], a[120:123], v[196:199]
    ds_read_b128 a[164:167], v14 offset:2048
    v_mfma_f32_16x16x32_bf16 v[196:199], a[44:47], a[124:127], v[196:199]
    ds_read_b128 a[72:75], v4 offset:2048
    v_mfma_f32_16x16x32_bf16 v[204:207], a[44:47], a[116:119], v[204:207]
    s_add_u32 m0, s29, 57344
    ds_read_b128 a[172:175], v3 offset:2048
    v_mfma_f32_16x16x32_bf16 v[204:207], a[40:43], a[112:115], v[204:207]
    buffer_load_dwordx4 v1, s[4:7], s46 offen lds
    v_mfma_f32_16x16x32_bf16 v[212:215], a[40:43], a[104:107], v[212:215]
    ds_read_b128 a[80:83], v4 offset:4096
    v_mfma_f32_16x16x32_bf16 v[212:215], a[44:47], a[108:111], v[212:215]
    ds_read_b128 a[176:179], v14 offset:4096
    v_mfma_f32_16x16x32_bf16 v[220:223], a[44:47], a[100:103], v[220:223]
    ds_read_b128 a[84:87], v5 offset:4096
    v_mfma_f32_16x16x32_bf16 v[220:223], a[40:43], a[96:99], v[220:223]
    s_add_u32 m0, s29, 126976
    ds_read_b128 a[184:187], v3 offset:4096
    v_mfma_f32_16x16x32_bf16 v[248:251], a[48:51], a[96:99], v[248:251]
    buffer_load_dwordx4 v2, s[8:11], s54 offen lds
    v_mfma_f32_16x16x32_bf16 v[248:251], a[52:55], a[100:103], v[248:251]
    ds_read_b128 a[92:95], v5 offset:6144
    v_mfma_f32_16x16x32_bf16 v[240:243], a[52:55], a[108:111], v[240:243]
    ds_read_b128 a[180:183], v14 offset:6144
    v_mfma_f32_16x16x32_bf16 v[240:243], a[48:51], a[104:107], v[240:243]
    ds_read_b128 a[88:91], v4 offset:6144
    v_mfma_f32_16x16x32_bf16 v[232:235], a[48:51], a[112:115], v[232:235]
    s_add_u32 m0, s29, 61440
    ds_read_b128 a[188:191], v3 offset:6144
    v_mfma_f32_16x16x32_bf16 v[232:235], a[52:55], a[116:119], v[232:235]
    buffer_load_dwordx4 v1, s[4:7], s47 offen lds
    v_mfma_f32_16x16x32_bf16 v[224:227], a[52:55], a[124:127], v[224:227]
    v_add_u32 v1, 128, v1
    v_add_u32 v2, 0x80000, v2
    v_mfma_f32_16x16x32_bf16 v[224:227], a[48:51], a[120:123], v[224:227]
    ds_read_b64_tr_b16 a[8:9], v7 offset:0
    v_mfma_f32_16x16x32_bf16 v[228:231], a[56:59], a[120:123], v[228:231]
    v_mfma_f32_16x16x32_bf16 v[228:231], a[60:63], a[124:127], v[228:231]
    ds_read_b64_tr_b16 a[10:11], v7 offset:4096
    v_mfma_f32_16x16x32_bf16 v[236:239], a[60:63], a[116:119], v[236:239]
    ds_read_b64_tr_b16 a[12:13], v7 offset:16384
    v_mfma_f32_16x16x32_bf16 v[236:239], a[56:59], a[112:115], v[236:239]
    ds_read_b64_tr_b16 a[14:15], v7 offset:20480
    v_mfma_f32_16x16x32_bf16 v[244:247], a[56:59], a[104:107], v[244:247]
    ds_read_b64_tr_b16 a[16:17], v8 offset:0
    v_mfma_f32_16x16x32_bf16 v[244:247], a[60:63], a[108:111], v[244:247]
    ds_read_b64_tr_b16 a[18:19], v8 offset:4096
    v_mfma_f32_16x16x32_bf16 v[252:255], a[60:63], a[100:103], v[252:255]
    ds_read_b64_tr_b16 a[20:21], v8 offset:16384
    v_mfma_f32_16x16x32_bf16 v[252:255], a[56:59], a[96:99], v[252:255]
    s_waitcnt lgkmcnt(15)
    ds_read_b64_tr_b16 a[22:23], v8 offset:20480
    v_mfma_f32_16x16x32_bf16 v[88:91], a[0:3], a[64:67], v[88:91]
    ds_read_b64_tr_b16 a[24:25], v9 offset:0
    v_lshlrev_b32 v1, 4, v0
    v_mfma_f32_16x16x32_bf16 v[88:91], a[4:7], a[68:71], v[88:91]
    s_add_u32 m0, s33, 0xfffffe00
    ds_read_b64_tr_b16 a[26:27], v9 offset:4096
    v_mfma_f32_16x16x32_bf16 v[80:83], a[4:7], a[76:79], v[80:83]
    s_waitcnt lgkmcnt(10)
    ds_read_b64_tr_b16 a[28:29], v9 offset:16384
    v_mfma_f32_16x16x32_bf16 v[80:83], a[0:3], a[72:75], v[80:83]
    ds_read_b64_tr_b16 a[30:31], v9 offset:20480
    buffer_load_dwordx4 v15, s[20:23], 0 offen offset:512 lds
    v_mfma_f32_16x16x32_bf16 v[72:75], a[0:3], a[80:83], v[72:75]
    ds_read_b128 a[96:99], v4 offset:8192
    v_mfma_f32_16x16x32_bf16 v[72:75], a[4:7], a[84:87], v[72:75]
    v_mfma_f32_16x16x32_bf16 v[64:67], a[4:7], a[92:95], v[64:67]
    s_add_u32 m0, s33, 0xfffffe80
    ds_read_b128 a[100:103], v5 offset:8192
    v_mfma_f32_16x16x32_bf16 v[64:67], a[0:3], a[88:91], v[64:67]
    s_waitcnt lgkmcnt(10)
    buffer_load_dwordx4 v15, s[20:23], 0 offen offset:1408 lds
    v_mfma_f32_16x16x32_bf16 v[68:71], a[8:11], a[88:91], v[68:71]
    ds_read_b128 a[108:111], v5 offset:10240
    v_mfma_f32_16x16x32_bf16 v[68:71], a[12:15], a[92:95], v[68:71]
    v_mfma_f32_16x16x32_bf16 v[76:79], a[12:15], a[84:87], v[76:79]
    s_add_u32 m0, s33, 0x600
    ds_read_b128 a[104:107], v4 offset:10240
    v_mfma_f32_16x16x32_bf16 v[76:79], a[8:11], a[80:83], v[76:79]
    buffer_load_dwordx4 v15, s[20:23], s57 offen offset:512 lds
    v_mfma_f32_16x16x32_bf16 v[84:87], a[8:11], a[72:75], v[84:87]
    ds_read_b128 a[112:115], v4 offset:12288
    v_mfma_f32_16x16x32_bf16 v[84:87], a[12:15], a[76:79], v[84:87]
    v_mfma_f32_16x16x32_bf16 v[92:95], a[12:15], a[68:71], v[92:95]
    s_add_u32 m0, s33, 0x680
    ds_read_b128 a[116:119], v5 offset:12288
    v_mfma_f32_16x16x32_bf16 v[92:95], a[8:11], a[64:67], v[92:95]
    s_waitcnt lgkmcnt(10)
    buffer_load_dwordx4 v15, s[20:23], s57 offen offset:1408 lds
    v_mfma_f32_16x16x32_bf16 v[120:123], a[16:19], a[64:67], v[120:123]
    ds_read_b128 a[124:127], v5 offset:14336
    v_mfma_f32_16x16x32_bf16 v[120:123], a[20:23], a[68:71], v[120:123]
    v_mfma_f32_16x16x32_bf16 v[112:115], a[20:23], a[76:79], v[112:115]
    s_add_u32 m0, s33, 0xd80
    ds_read_b128 a[120:123], v4 offset:14336
    v_mfma_f32_16x16x32_bf16 v[112:115], a[16:19], a[72:75], v[112:115]
    buffer_load_dwordx4 v15, s[20:23], 0 offen offset:640 lds
    v_mfma_f32_16x16x32_bf16 v[104:107], a[16:19], a[80:83], v[104:107]
    ds_read_b64_tr_b16 a[32:33], v10 offset:0
    v_mfma_f32_16x16x32_bf16 v[104:107], a[20:23], a[84:87], v[104:107]
    ds_read_b64_tr_b16 a[34:35], v10 offset:4096
    v_mfma_f32_16x16x32_bf16 v[96:99], a[20:23], a[92:95], v[96:99]
    s_add_u32 m0, s33, 0xe00
    ds_read_b64_tr_b16 a[36:37], v10 offset:16384
    v_mfma_f32_16x16x32_bf16 v[96:99], a[16:19], a[88:91], v[96:99]
    s_waitcnt lgkmcnt(11)
    ds_read_b64_tr_b16 a[38:39], v10 offset:20480
    buffer_load_dwordx4 v15, s[20:23], 0 offen offset:1536 lds
    v_mfma_f32_16x16x32_bf16 v[100:103], a[24:27], a[88:91], v[100:103]
    ds_read_b64_tr_b16 a[40:41], v11 offset:0
    v_mfma_f32_16x16x32_bf16 v[100:103], a[28:31], a[92:95], v[100:103]
    ds_read_b64_tr_b16 a[42:43], v11 offset:4096
    v_mfma_f32_16x16x32_bf16 v[108:111], a[28:31], a[84:87], v[108:111]
    s_add_u32 m0, s33, 0x1580
    ds_read_b64_tr_b16 a[44:45], v11 offset:16384
    v_mfma_f32_16x16x32_bf16 v[108:111], a[24:27], a[80:83], v[108:111]
    ds_read_b64_tr_b16 a[46:47], v11 offset:20480
    buffer_load_dwordx4 v15, s[20:23], s57 offen offset:640 lds
    v_mfma_f32_16x16x32_bf16 v[116:119], a[24:27], a[72:75], v[116:119]
    ds_read_b64_tr_b16 a[48:49], v12 offset:0
    v_mfma_f32_16x16x32_bf16 v[116:119], a[28:31], a[76:79], v[116:119]
    ds_read_b64_tr_b16 a[50:51], v12 offset:4096
    v_mfma_f32_16x16x32_bf16 v[124:127], a[28:31], a[68:71], v[124:127]
    s_add_u32 m0, s33, 0x1600
    ds_read_b64_tr_b16 a[52:53], v12 offset:16384
    v_mfma_f32_16x16x32_bf16 v[124:127], a[24:27], a[64:67], v[124:127]
    s_waitcnt lgkmcnt(15)
    ds_read_b64_tr_b16 a[54:55], v12 offset:20480
    buffer_load_dwordx4 v15, s[20:23], s57 offen offset:1536 lds
    v_mfma_f32_16x16x32_bf16 a[232:235], a[0:3], a[96:99], a[232:235]
    ds_read_b64_tr_b16 a[56:57], v13 offset:0
    v_mfma_f32_16x16x32_bf16 a[232:235], a[4:7], a[100:103], a[232:235]
    ds_read_b64_tr_b16 a[58:59], v13 offset:4096
    v_mfma_f32_16x16x32_bf16 a[224:227], a[4:7], a[108:111], a[224:227]
    ds_read_b64_tr_b16 a[60:61], v13 offset:16384
    v_mfma_f32_16x16x32_bf16 a[224:227], a[0:3], a[104:107], a[224:227]
    s_waitcnt lgkmcnt(15)
    ds_read_b64_tr_b16 a[62:63], v13 offset:20480
    v_mfma_f32_16x16x32_bf16 v[24:27], a[0:3], a[112:115], v[24:27]
    v_mfma_f32_16x16x32_bf16 v[24:27], a[4:7], a[116:119], v[24:27]
    v_mfma_f32_16x16x32_bf16 v[16:19], a[4:7], a[124:127], v[16:19]
    v_mfma_f32_16x16x32_bf16 v[16:19], a[0:3], a[120:123], v[16:19]
    s_waitcnt lgkmcnt(0)
    v_mfma_f32_16x16x32_bf16 v[20:23], a[8:11], a[120:123], v[20:23]
    s_barrier
    v_mfma_f32_16x16x32_bf16 v[20:23], a[12:15], a[124:127], v[20:23]
    s_add_u32 m0, s29, 0
    v_add_u32 v2, 0xff800000, v2
    v_mfma_f32_16x16x32_bf16 v[28:31], a[12:15], a[116:119], v[28:31]
    buffer_load_dwordx4 v2, s[16:19], 0 offen lds
    v_mfma_f32_16x16x32_bf16 v[28:31], a[8:11], a[112:115], v[28:31]
    v_mfma_f32_16x16x32_bf16 a[228:231], a[8:11], a[104:107], a[228:231]
    v_mfma_f32_16x16x32_bf16 a[228:231], a[12:15], a[108:111], a[228:231]
    v_mfma_f32_16x16x32_bf16 a[236:239], a[12:15], a[100:103], a[236:239]
    s_add_u32 m0, s29, 4096
    v_mfma_f32_16x16x32_bf16 a[236:239], a[8:11], a[96:99], a[236:239]
    buffer_load_dwordx4 v2, s[16:19], s48 offen lds
    v_mfma_f32_16x16x32_bf16 v[56:59], a[16:19], a[96:99], v[56:59]
    v_mfma_f32_16x16x32_bf16 v[56:59], a[20:23], a[100:103], v[56:59]
    v_mfma_f32_16x16x32_bf16 v[48:51], a[20:23], a[108:111], v[48:51]
    v_mfma_f32_16x16x32_bf16 v[48:51], a[16:19], a[104:107], v[48:51]
    s_add_u32 m0, s29, 8192
    v_mfma_f32_16x16x32_bf16 v[40:43], a[16:19], a[112:115], v[40:43]
    buffer_load_dwordx4 v2, s[16:19], s49 offen lds
    v_mfma_f32_16x16x32_bf16 v[40:43], a[20:23], a[116:119], v[40:43]
    v_mfma_f32_16x16x32_bf16 v[32:35], a[20:23], a[124:127], v[32:35]
    v_mfma_f32_16x16x32_bf16 v[32:35], a[16:19], a[120:123], v[32:35]
    v_mfma_f32_16x16x32_bf16 v[36:39], a[24:27], a[120:123], v[36:39]
    s_add_u32 m0, s29, 12288
    v_mfma_f32_16x16x32_bf16 v[36:39], a[28:31], a[124:127], v[36:39]
    buffer_load_dwordx4 v2, s[16:19], s50 offen lds
    v_mfma_f32_16x16x32_bf16 v[44:47], a[28:31], a[116:119], v[44:47]
    v_mfma_f32_16x16x32_bf16 v[44:47], a[24:27], a[112:115], v[44:47]
    v_mfma_f32_16x16x32_bf16 v[52:55], a[24:27], a[104:107], v[52:55]
    v_mfma_f32_16x16x32_bf16 v[52:55], a[28:31], a[108:111], v[52:55]
    s_add_u32 m0, s29, 16384
    v_mfma_f32_16x16x32_bf16 v[60:63], a[28:31], a[100:103], v[60:63]
    buffer_load_dwordx4 v2, s[16:19], s51 offen lds
    v_mfma_f32_16x16x32_bf16 v[60:63], a[24:27], a[96:99], v[60:63]
    v_mfma_f32_16x16x32_bf16 v[216:219], a[32:35], a[96:99], v[216:219]
    v_mfma_f32_16x16x32_bf16 v[216:219], a[36:39], a[100:103], v[216:219]
    v_mfma_f32_16x16x32_bf16 v[208:211], a[36:39], a[108:111], v[208:211]
    s_add_u32 m0, s29, 20480
    v_mfma_f32_16x16x32_bf16 v[208:211], a[32:35], a[104:107], v[208:211]
    buffer_load_dwordx4 v2, s[16:19], s52 offen lds
    v_mfma_f32_16x16x32_bf16 v[200:203], a[32:35], a[112:115], v[200:203]
    v_mfma_f32_16x16x32_bf16 v[200:203], a[36:39], a[116:119], v[200:203]
    v_mfma_f32_16x16x32_bf16 v[192:195], a[36:39], a[124:127], v[192:195]
    v_mfma_f32_16x16x32_bf16 v[192:195], a[32:35], a[120:123], v[192:195]
    s_add_u32 m0, s29, 24576
    v_mfma_f32_16x16x32_bf16 v[196:199], a[40:43], a[120:123], v[196:199]
    buffer_load_dwordx4 v2, s[16:19], s53 offen lds
    v_mfma_f32_16x16x32_bf16 v[196:199], a[44:47], a[124:127], v[196:199]
    v_mfma_f32_16x16x32_bf16 v[204:207], a[44:47], a[116:119], v[204:207]
    v_mfma_f32_16x16x32_bf16 v[204:207], a[40:43], a[112:115], v[204:207]
    v_mfma_f32_16x16x32_bf16 v[212:215], a[40:43], a[104:107], v[212:215]
    s_add_u32 m0, s29, 28672
    v_mfma_f32_16x16x32_bf16 v[212:215], a[44:47], a[108:111], v[212:215]
    buffer_load_dwordx4 v2, s[16:19], s54 offen lds
    v_mfma_f32_16x16x32_bf16 v[220:223], a[44:47], a[100:103], v[220:223]
    v_mfma_f32_16x16x32_bf16 v[220:223], a[40:43], a[96:99], v[220:223]
    v_mfma_f32_16x16x32_bf16 v[248:251], a[48:51], a[96:99], v[248:251]
    s_add_u32 m0, s29, 65536
    v_add_u32 v2, 0x80000, v2
    v_mfma_f32_16x16x32_bf16 v[248:251], a[52:55], a[100:103], v[248:251]
    buffer_load_dwordx4 v2, s[16:19], 0 offen lds
    v_mfma_f32_16x16x32_bf16 v[240:243], a[52:55], a[108:111], v[240:243]
    v_mfma_f32_16x16x32_bf16 v[240:243], a[48:51], a[104:107], v[240:243]
    v_mfma_f32_16x16x32_bf16 v[232:235], a[48:51], a[112:115], v[232:235]
    v_mfma_f32_16x16x32_bf16 v[232:235], a[52:55], a[116:119], v[232:235]
    s_add_u32 m0, s29, 69632
    v_mfma_f32_16x16x32_bf16 v[224:227], a[52:55], a[124:127], v[224:227]
    buffer_load_dwordx4 v2, s[16:19], s48 offen lds
    v_mfma_f32_16x16x32_bf16 v[224:227], a[48:51], a[120:123], v[224:227]
    v_mfma_f32_16x16x32_bf16 v[228:231], a[56:59], a[120:123], v[228:231]
    v_mfma_f32_16x16x32_bf16 v[228:231], a[60:63], a[124:127], v[228:231]
    v_mfma_f32_16x16x32_bf16 v[236:239], a[60:63], a[116:119], v[236:239]
    s_add_u32 m0, s29, 73728
    v_mfma_f32_16x16x32_bf16 v[236:239], a[56:59], a[112:115], v[236:239]
    buffer_load_dwordx4 v2, s[16:19], s49 offen lds
    v_mfma_f32_16x16x32_bf16 v[244:247], a[56:59], a[104:107], v[244:247]
    s_waitcnt vmcnt(11)
    v_mfma_f32_16x16x32_bf16 v[244:247], a[60:63], a[108:111], v[244:247]
    s_barrier
    ds_read_b64_tr_b16 a[0:1], v6 offset:32768
    v_mfma_f32_16x16x32_bf16 v[252:255], a[60:63], a[100:103], v[252:255]
    ds_read_b64_tr_b16 a[2:3], v6 offset:36864
    v_mfma_f32_16x16x32_bf16 v[252:255], a[56:59], a[96:99], v[252:255]
    s_add_u32 m0, s29, 77824
    ds_read_b128 a[96:99], v4 offset:40960
    v_mfma_f32_16x16x32_bf16 v[152:155], a[32:35], a[64:67], v[152:155]
    ds_read_b128 a[192:195], v14 offset:0
    buffer_load_dwordx4 v2, s[16:19], s50 offen lds
    v_mfma_f32_16x16x32_bf16 v[152:155], a[36:39], a[68:71], v[152:155]
    ds_read_b128 a[200:203], v3 offset:0
    v_mfma_f32_16x16x32_bf16 v[144:147], a[36:39], a[76:79], v[144:147]
    ds_read_b64_tr_b16 a[4:5], v6 offset:49152
    v_mfma_f32_16x16x32_bf16 v[144:147], a[32:35], a[72:75], v[144:147]
    ds_read_b64_tr_b16 a[6:7], v6 offset:53248
    v_mfma_f32_16x16x32_bf16 v[136:139], a[32:35], a[80:83], v[136:139]
    s_add_u32 m0, s29, 81920
    ds_read_b128 a[100:103], v5 offset:40960
    v_mfma_f32_16x16x32_bf16 v[136:139], a[36:39], a[84:87], v[136:139]
    ds_read_b128 a[196:199], v14 offset:2048
    buffer_load_dwordx4 v2, s[16:19], s51 offen lds
    v_mfma_f32_16x16x32_bf16 v[128:131], a[36:39], a[92:95], v[128:131]
    ds_read_b128 a[204:207], v3 offset:2048
    v_mfma_f32_16x16x32_bf16 v[128:131], a[32:35], a[88:91], v[128:131]
    ds_read_b128 a[108:111], v5 offset:43008
    v_mfma_f32_16x16x32_bf16 v[132:135], a[40:43], a[88:91], v[132:135]
    ds_read_b128 a[208:211], v14 offset:4096
    v_mfma_f32_16x16x32_bf16 v[132:135], a[44:47], a[92:95], v[132:135]
    s_add_u32 m0, s29, 86016
    ds_read_b128 a[104:107], v4 offset:43008
    v_mfma_f32_16x16x32_bf16 v[140:143], a[44:47], a[84:87], v[140:143]
    ds_read_b128 a[216:219], v3 offset:4096
    buffer_load_dwordx4 v2, s[16:19], s52 offen lds
    v_mfma_f32_16x16x32_bf16 v[140:143], a[40:43], a[80:83], v[140:143]
    ds_read_b128 a[212:215], v14 offset:6144
    v_mfma_f32_16x16x32_bf16 v[148:151], a[40:43], a[72:75], v[148:151]
    ds_read_b128 a[112:115], v4 offset:45056
    v_mfma_f32_16x16x32_bf16 v[148:151], a[44:47], a[76:79], v[148:151]
    ds_read_b128 a[220:223], v3 offset:6144
    v_mfma_f32_16x16x32_bf16 v[156:159], a[44:47], a[68:71], v[156:159]
    s_add_u32 m0, s29, 90112
    ds_read_b128 a[116:119], v5 offset:45056
    v_mfma_f32_16x16x32_bf16 v[156:159], a[40:43], a[64:67], v[156:159]
    buffer_load_dwordx4 v2, s[16:19], s53 offen lds
    v_mfma_f32_16x16x32_bf16 v[184:187], a[48:51], a[64:67], v[184:187]
    v_mfma_f32_16x16x32_bf16 v[184:187], a[52:55], a[68:71], v[184:187]
    ds_read_b128 a[124:127], v5 offset:47104
    v_mfma_f32_16x16x32_bf16 v[176:179], a[52:55], a[76:79], v[176:179]
    v_mfma_f32_16x16x32_bf16 v[176:179], a[48:51], a[72:75], v[176:179]
    s_add_u32 m0, s29, 94208
    ds_read_b128 a[120:123], v4 offset:47104
    v_mfma_f32_16x16x32_bf16 v[168:171], a[48:51], a[80:83], v[168:171]
    buffer_load_dwordx4 v2, s[16:19], s54 offen lds
    v_mfma_f32_16x16x32_bf16 v[168:171], a[52:55], a[84:87], v[168:171]
    v_mfma_f32_16x16x32_bf16 v[160:163], a[52:55], a[92:95], v[160:163]
    v_mfma_f32_16x16x32_bf16 v[160:163], a[48:51], a[88:91], v[160:163]
    ds_read_b64_tr_b16 a[8:9], v7 offset:32768
    v_mfma_f32_16x16x32_bf16 v[164:167], a[56:59], a[88:91], v[164:167]
    v_mfma_f32_16x16x32_bf16 v[164:167], a[60:63], a[92:95], v[164:167]
    ds_read_b64_tr_b16 a[10:11], v7 offset:36864
    v_mfma_f32_16x16x32_bf16 v[172:175], a[60:63], a[84:87], v[172:175]
    ds_read_b64_tr_b16 a[12:13], v7 offset:49152
    v_mfma_f32_16x16x32_bf16 v[172:175], a[56:59], a[80:83], v[172:175]
    ds_read_b64_tr_b16 a[14:15], v7 offset:53248
    v_mfma_f32_16x16x32_bf16 v[180:183], a[56:59], a[72:75], v[180:183]
    ds_read_b64_tr_b16 a[16:17], v8 offset:32768
    v_mfma_f32_16x16x32_bf16 v[180:183], a[60:63], a[76:79], v[180:183]
    ds_read_b64_tr_b16 a[18:19], v8 offset:36864
    v_mfma_f32_16x16x32_bf16 v[188:191], a[60:63], a[68:71], v[188:191]
    ds_read_b64_tr_b16 a[20:21], v8 offset:49152
    v_mfma_f32_16x16x32_bf16 v[188:191], a[56:59], a[64:67], v[188:191]
    s_waitcnt lgkmcnt(15)
    ds_read_b64_tr_b16 a[22:23], v8 offset:53248
    v_mfma_f32_16x16x32_bf16 a[232:235], a[0:3], a[96:99], a[232:235]
    ds_read_b64_tr_b16 a[24:25], v9 offset:32768
    v_mfma_f32_16x16x32_bf16 a[232:235], a[4:7], a[100:103], a[232:235]
    s_add_u32 m0, s33, 0xfffffd00
    ds_read_b64_tr_b16 a[26:27], v9 offset:36864
    v_mfma_f32_16x16x32_bf16 a[224:227], a[4:7], a[108:111], a[224:227]
    s_waitcnt lgkmcnt(13)
    ds_read_b64_tr_b16 a[28:29], v9 offset:49152
    v_mfma_f32_16x16x32_bf16 a[224:227], a[0:3], a[104:107], a[224:227]
    ds_read_b64_tr_b16 a[30:31], v9 offset:53248
    buffer_load_dwordx4 v15, s[20:23], 0 offen offset:768 lds
    v_mfma_f32_16x16x32_bf16 v[24:27], a[0:3], a[112:115], v[24:27]
    s_waitcnt lgkmcnt(12)
    ds_read_b128 a[64:67], v4 offset:32768
    v_mfma_f32_16x16x32_bf16 v[24:27], a[4:7], a[116:119], v[24:27]
    v_mfma_f32_16x16x32_bf16 v[16:19], a[4:7], a[124:127], v[16:19]
    s_add_u32 m0, s33, 0xfffffd80
    ds_read_b128 a[68:71], v5 offset:32768
    v_mfma_f32_16x16x32_bf16 v[16:19], a[0:3], a[120:123], v[16:19]
    s_waitcnt lgkmcnt(10)
    buffer_load_dwordx4 v15, s[20:23], 0 offen offset:1664 lds
    v_mfma_f32_16x16x32_bf16 v[20:23], a[8:11], a[120:123], v[20:23]
    ds_read_b128 a[76:79], v5 offset:34816
    v_mfma_f32_16x16x32_bf16 v[20:23], a[12:15], a[124:127], v[20:23]
    v_mfma_f32_16x16x32_bf16 v[28:31], a[12:15], a[116:119], v[28:31]
    s_add_u32 m0, s33, 0x500
    ds_read_b128 a[72:75], v4 offset:34816
    v_mfma_f32_16x16x32_bf16 v[28:31], a[8:11], a[112:115], v[28:31]
    buffer_load_dwordx4 v15, s[20:23], s57 offen offset:768 lds
    v_mfma_f32_16x16x32_bf16 a[228:231], a[8:11], a[104:107], a[228:231]
    ds_read_b128 a[80:83], v4 offset:36864
    v_mfma_f32_16x16x32_bf16 a[228:231], a[12:15], a[108:111], a[228:231]
    v_mfma_f32_16x16x32_bf16 a[236:239], a[12:15], a[100:103], a[236:239]
    s_add_u32 m0, s33, 0x580
    ds_read_b128 a[84:87], v5 offset:36864
    v_mfma_f32_16x16x32_bf16 a[236:239], a[8:11], a[96:99], a[236:239]
    s_waitcnt lgkmcnt(10)
    buffer_load_dwordx4 v15, s[20:23], s57 offen offset:1664 lds
    v_mfma_f32_16x16x32_bf16 v[56:59], a[16:19], a[96:99], v[56:59]
    ds_read_b128 a[92:95], v5 offset:38912
    v_mfma_f32_16x16x32_bf16 v[56:59], a[20:23], a[100:103], v[56:59]
    v_cvt_pk_bf16_f32 v16, v16, v17
    v_cvt_pk_bf16_f32 v17, v18, v19
    v_mfma_f32_16x16x32_bf16 v[48:51], a[20:23], a[108:111], v[48:51]
    ds_read_b128 a[88:91], v4 offset:38912
    v_cvt_pk_bf16_f32 v18, v20, v21
    v_mfma_f32_16x16x32_bf16 v[48:51], a[16:19], a[104:107], v[48:51]
    v_cvt_pk_bf16_f32 v19, v22, v23
    v_cvt_pk_bf16_f32 v24, v24, v25
    v_mfma_f32_16x16x32_bf16 v[40:43], a[16:19], a[112:115], v[40:43]
    ds_read_b64_tr_b16 a[32:33], v10 offset:32768
    v_cvt_pk_bf16_f32 v25, v26, v27
    v_mfma_f32_16x16x32_bf16 v[40:43], a[20:23], a[116:119], v[40:43]
    ds_read_b64_tr_b16 a[34:35], v10 offset:36864
    v_cvt_pk_bf16_f32 v26, v28, v29
    v_mfma_f32_16x16x32_bf16 v[32:35], a[20:23], a[124:127], v[32:35]
    ds_read_b64_tr_b16 a[36:37], v10 offset:49152
    v_cvt_pk_bf16_f32 v27, v30, v31
    v_mfma_f32_16x16x32_bf16 v[32:35], a[16:19], a[120:123], v[32:35]
    s_waitcnt lgkmcnt(11)
    ds_read_b64_tr_b16 a[38:39], v10 offset:53248
    v_accvgpr_read_b32 v20, a224
    v_mfma_f32_16x16x32_bf16 v[36:39], a[24:27], a[120:123], v[36:39]
    ds_read_b64_tr_b16 a[40:41], v11 offset:32768
    v_accvgpr_read_b32 v21, a225
    v_mfma_f32_16x16x32_bf16 v[36:39], a[28:31], a[124:127], v[36:39]
    ds_read_b64_tr_b16 a[42:43], v11 offset:36864
    v_accvgpr_read_b32 v22, a226
    v_mfma_f32_16x16x32_bf16 v[44:47], a[28:31], a[116:119], v[44:47]
    ds_read_b64_tr_b16 a[44:45], v11 offset:49152
    v_accvgpr_read_b32 v23, a227
    v_mfma_f32_16x16x32_bf16 v[44:47], a[24:27], a[112:115], v[44:47]
    ds_read_b64_tr_b16 a[46:47], v11 offset:53248
    v_accvgpr_read_b32 v28, a228
    v_mfma_f32_16x16x32_bf16 v[52:55], a[24:27], a[104:107], v[52:55]
    ds_read_b64_tr_b16 a[48:49], v12 offset:32768
    v_accvgpr_read_b32 v29, a229
    v_mfma_f32_16x16x32_bf16 v[52:55], a[28:31], a[108:111], v[52:55]
    ds_read_b64_tr_b16 a[50:51], v12 offset:36864
    v_accvgpr_read_b32 v30, a230
    v_mfma_f32_16x16x32_bf16 v[60:63], a[28:31], a[100:103], v[60:63]
    ds_read_b64_tr_b16 a[52:53], v12 offset:49152
    v_accvgpr_read_b32 v31, a231
    v_mfma_f32_16x16x32_bf16 v[60:63], a[24:27], a[96:99], v[60:63]
    s_waitcnt lgkmcnt(15)
    ds_read_b64_tr_b16 a[54:55], v12 offset:53248
    v_cvt_pk_bf16_f32 v20, v20, v21
    v_mfma_f32_16x16x32_bf16 v[88:91], a[0:3], a[64:67], v[88:91]
    ds_read_b64_tr_b16 a[56:57], v13 offset:32768
    v_cvt_pk_bf16_f32 v21, v22, v23
    v_mfma_f32_16x16x32_bf16 v[88:91], a[4:7], a[68:71], v[88:91]
    ds_read_b64_tr_b16 a[58:59], v13 offset:36864
    v_cvt_pk_bf16_f32 v22, v28, v29
    v_mfma_f32_16x16x32_bf16 v[80:83], a[4:7], a[76:79], v[80:83]
    ds_read_b64_tr_b16 a[60:61], v13 offset:49152
    v_cvt_pk_bf16_f32 v23, v30, v31
    v_mfma_f32_16x16x32_bf16 v[80:83], a[0:3], a[72:75], v[80:83]
    s_waitcnt lgkmcnt(15)
    ds_read_b64_tr_b16 a[62:63], v13 offset:53248
    v_cvt_pk_bf16_f32 v32, v32, v33
    v_mfma_f32_16x16x32_bf16 v[72:75], a[0:3], a[80:83], v[72:75]
    v_cvt_pk_bf16_f32 v33, v34, v35
    v_cvt_pk_bf16_f32 v34, v36, v37
    v_mfma_f32_16x16x32_bf16 v[72:75], a[4:7], a[84:87], v[72:75]
    v_cvt_pk_bf16_f32 v35, v38, v39
    v_cvt_pk_bf16_f32 v40, v40, v41
    v_mfma_f32_16x16x32_bf16 v[64:67], a[4:7], a[92:95], v[64:67]
    v_cvt_pk_bf16_f32 v41, v42, v43
    v_cvt_pk_bf16_f32 v42, v44, v45
    v_mfma_f32_16x16x32_bf16 v[64:67], a[0:3], a[88:91], v[64:67]
    s_waitcnt lgkmcnt(0)
    v_cvt_pk_bf16_f32 v43, v46, v47
    v_accvgpr_read_b32 v36, a232
    v_mfma_f32_16x16x32_bf16 v[68:71], a[8:11], a[88:91], v[68:71]
    s_barrier
    v_xor_b32 v6, s60, v6
    v_accvgpr_read_b32 v37, a233
    v_mfma_f32_16x16x32_bf16 v[68:71], a[12:15], a[92:95], v[68:71]
    s_add_u32 m0, s29, 32768
    v_add_u32 v2, 0x80000, v2
    v_accvgpr_read_b32 v38, a234
    v_mfma_f32_16x16x32_bf16 v[76:79], a[12:15], a[84:87], v[76:79]
    buffer_load_dwordx4 v2, s[16:19], 0 offen lds
    v_mfma_f32_16x16x32_bf16 v[76:79], a[8:11], a[80:83], v[76:79]
    s_add_u32 s59, s58, 40960
    v_accvgpr_read_b32 v39, a235
    v_accvgpr_read_b32 v44, a236
    v_mfma_f32_16x16x32_bf16 v[84:87], a[8:11], a[72:75], v[84:87]
    buffer_store_dwordx4 v[20:23], v1, s[12:15], s59 offen offset:0 sc1
    v_mfma_f32_16x16x32_bf16 v[84:87], a[12:15], a[76:79], v[84:87]
    v_accvgpr_read_b32 v45, a237
    v_accvgpr_read_b32 v46, a238
    v_mfma_f32_16x16x32_bf16 v[92:95], a[12:15], a[68:71], v[92:95]
    s_add_u32 m0, s29, 36864
    v_accvgpr_read_b32 v47, a239
    v_cvt_pk_bf16_f32 v36, v36, v37
    v_mfma_f32_16x16x32_bf16 v[92:95], a[8:11], a[64:67], v[92:95]
    buffer_load_dwordx4 v2, s[16:19], s48 offen lds
    v_mfma_f32_16x16x32_bf16 v[120:123], a[16:19], a[64:67], v[120:123]
    v_cvt_pk_bf16_f32 v37, v38, v39
    v_cvt_pk_bf16_f32 v38, v44, v45
    v_mfma_f32_16x16x32_bf16 v[120:123], a[20:23], a[68:71], v[120:123]
    v_cvt_pk_bf16_f32 v39, v46, v47
    v_cvt_pk_bf16_f32 v48, v48, v49
    v_mfma_f32_16x16x32_bf16 v[112:115], a[20:23], a[76:79], v[112:115]
    v_cvt_pk_bf16_f32 v49, v50, v51
    v_cvt_pk_bf16_f32 v50, v52, v53
    v_mfma_f32_16x16x32_bf16 v[112:115], a[16:19], a[72:75], v[112:115]
    s_add_u32 m0, s29, 40960
    v_cvt_pk_bf16_f32 v51, v54, v55
    v_cvt_pk_bf16_f32 v56, v56, v57
    v_mfma_f32_16x16x32_bf16 v[104:107], a[16:19], a[80:83], v[104:107]
    buffer_load_dwordx4 v2, s[16:19], s49 offen lds
    v_mfma_f32_16x16x32_bf16 v[104:107], a[20:23], a[84:87], v[104:107]
    v_cvt_pk_bf16_f32 v57, v58, v59
    v_cvt_pk_bf16_f32 v58, v60, v61
    v_mfma_f32_16x16x32_bf16 v[96:99], a[20:23], a[92:95], v[96:99]
    v_cvt_pk_bf16_f32 v59, v62, v63
    v_cvt_pk_bf16_f32 v64, v64, v65
    v_mfma_f32_16x16x32_bf16 v[96:99], a[16:19], a[88:91], v[96:99]
    v_cvt_pk_bf16_f32 v65, v66, v67
    v_cvt_pk_bf16_f32 v66, v68, v69
    v_mfma_f32_16x16x32_bf16 v[100:103], a[24:27], a[88:91], v[100:103]
    s_add_u32 m0, s29, 45056
    v_cvt_pk_bf16_f32 v67, v70, v71
    v_cvt_pk_bf16_f32 v72, v72, v73
    v_mfma_f32_16x16x32_bf16 v[100:103], a[28:31], a[92:95], v[100:103]
    buffer_load_dwordx4 v2, s[16:19], s50 offen lds
    v_mfma_f32_16x16x32_bf16 v[108:111], a[28:31], a[84:87], v[108:111]
    s_add_u32 s59, s58, 32768
    v_cvt_pk_bf16_f32 v73, v74, v75
    v_cvt_pk_bf16_f32 v74, v76, v77
    v_mfma_f32_16x16x32_bf16 v[108:111], a[24:27], a[80:83], v[108:111]
    buffer_store_dwordx4 v[36:39], v1, s[12:15], s59 offen offset:0 sc1
    v_mfma_f32_16x16x32_bf16 v[116:119], a[24:27], a[72:75], v[116:119]
    v_cvt_pk_bf16_f32 v75, v78, v79
    v_cvt_pk_bf16_f32 v80, v80, v81
    v_mfma_f32_16x16x32_bf16 v[116:119], a[28:31], a[76:79], v[116:119]
    s_add_u32 m0, s29, 49152
    v_cvt_pk_bf16_f32 v81, v82, v83
    v_cvt_pk_bf16_f32 v82, v84, v85
    v_mfma_f32_16x16x32_bf16 v[124:127], a[28:31], a[68:71], v[124:127]
    buffer_load_dwordx4 v2, s[16:19], s51 offen lds
    v_mfma_f32_16x16x32_bf16 v[124:127], a[24:27], a[64:67], v[124:127]
    v_cvt_pk_bf16_f32 v83, v86, v87
    v_cvt_pk_bf16_f32 v88, v88, v89
    v_mfma_f32_16x16x32_bf16 v[152:155], a[32:35], a[64:67], v[152:155]
    v_cvt_pk_bf16_f32 v89, v90, v91
    v_cvt_pk_bf16_f32 v90, v92, v93
    v_mfma_f32_16x16x32_bf16 v[152:155], a[36:39], a[68:71], v[152:155]
    v_cvt_pk_bf16_f32 v91, v94, v95
    v_cvt_pk_bf16_f32 v96, v96, v97
    v_mfma_f32_16x16x32_bf16 v[144:147], a[36:39], a[76:79], v[144:147]
    s_add_u32 m0, s29, 53248
    v_cvt_pk_bf16_f32 v97, v98, v99
    v_cvt_pk_bf16_f32 v98, v100, v101
    v_mfma_f32_16x16x32_bf16 v[144:147], a[32:35], a[72:75], v[144:147]
    buffer_load_dwordx4 v2, s[16:19], s52 offen lds
    v_mfma_f32_16x16x32_bf16 v[136:139], a[32:35], a[80:83], v[136:139]
    v_cvt_pk_bf16_f32 v99, v102, v103
    v_cvt_pk_bf16_f32 v104, v104, v105
    v_mfma_f32_16x16x32_bf16 v[136:139], a[36:39], a[84:87], v[136:139]
    v_cvt_pk_bf16_f32 v105, v106, v107
    v_cvt_pk_bf16_f32 v106, v108, v109
    v_mfma_f32_16x16x32_bf16 v[128:131], a[36:39], a[92:95], v[128:131]
    v_cvt_pk_bf16_f32 v107, v110, v111
    v_cvt_pk_bf16_f32 v112, v112, v113
    v_mfma_f32_16x16x32_bf16 v[128:131], a[32:35], a[88:91], v[128:131]
    s_add_u32 m0, s29, 57344
    v_cvt_pk_bf16_f32 v113, v114, v115
    v_cvt_pk_bf16_f32 v114, v116, v117
    v_mfma_f32_16x16x32_bf16 v[132:135], a[40:43], a[88:91], v[132:135]
    buffer_load_dwordx4 v2, s[16:19], s53 offen lds
    v_mfma_f32_16x16x32_bf16 v[132:135], a[44:47], a[92:95], v[132:135]
    s_add_u32 s59, s58, 57344
    v_cvt_pk_bf16_f32 v115, v118, v119
    v_cvt_pk_bf16_f32 v120, v120, v121
    v_mfma_f32_16x16x32_bf16 v[140:143], a[44:47], a[84:87], v[140:143]
    buffer_store_dwordx4 v[16:19], v1, s[12:15], s59 offen offset:0 sc1
    v_mfma_f32_16x16x32_bf16 v[140:143], a[40:43], a[80:83], v[140:143]
    v_cvt_pk_bf16_f32 v121, v122, v123
    v_cvt_pk_bf16_f32 v122, v124, v125
    v_mfma_f32_16x16x32_bf16 v[148:151], a[40:43], a[72:75], v[148:151]
    s_add_u32 m0, s29, 61440
    v_cvt_pk_bf16_f32 v123, v126, v127
    v_mfma_f32_16x16x32_bf16 v[148:151], a[44:47], a[76:79], v[148:151]
    buffer_load_dwordx4 v2, s[16:19], s54 offen lds
    v_mfma_f32_16x16x32_bf16 v[156:159], a[44:47], a[68:71], v[156:159]
    v_mfma_f32_16x16x32_bf16 v[156:159], a[40:43], a[64:67], v[156:159]
    v_mfma_f32_16x16x32_bf16 v[184:187], a[48:51], a[64:67], v[184:187]
    s_add_u32 m0, s29, 98304
    v_add_u32 v2, 0x80000, v2
    v_mfma_f32_16x16x32_bf16 v[184:187], a[52:55], a[68:71], v[184:187]
    buffer_load_dwordx4 v2, s[16:19], 0 offen lds
    v_mfma_f32_16x16x32_bf16 v[176:179], a[52:55], a[76:79], v[176:179]
    v_cvt_pk_bf16_f32 v128, v128, v129
    v_cvt_pk_bf16_f32 v129, v130, v131
    v_mfma_f32_16x16x32_bf16 v[176:179], a[48:51], a[72:75], v[176:179]
    v_cvt_pk_bf16_f32 v130, v132, v133
    v_cvt_pk_bf16_f32 v131, v134, v135
    v_mfma_f32_16x16x32_bf16 v[168:171], a[48:51], a[80:83], v[168:171]
    v_cvt_pk_bf16_f32 v136, v136, v137
    v_cvt_pk_bf16_f32 v137, v138, v139
    v_mfma_f32_16x16x32_bf16 v[168:171], a[52:55], a[84:87], v[168:171]
    s_add_u32 m0, s29, 102400
    v_cvt_pk_bf16_f32 v138, v140, v141
    v_cvt_pk_bf16_f32 v139, v142, v143
    v_mfma_f32_16x16x32_bf16 v[160:163], a[52:55], a[92:95], v[160:163]
    buffer_load_dwordx4 v2, s[16:19], s48 offen lds
    v_mfma_f32_16x16x32_bf16 v[160:163], a[48:51], a[88:91], v[160:163]
    s_add_u32 s59, s58, 49152
    v_cvt_pk_bf16_f32 v144, v144, v145
    v_cvt_pk_bf16_f32 v145, v146, v147
    v_mfma_f32_16x16x32_bf16 v[164:167], a[56:59], a[88:91], v[164:167]
    buffer_store_dwordx4 v[24:27], v1, s[12:15], s59 offen offset:0 sc1
    v_mfma_f32_16x16x32_bf16 v[164:167], a[60:63], a[92:95], v[164:167]
    v_cvt_pk_bf16_f32 v146, v148, v149
    v_cvt_pk_bf16_f32 v147, v150, v151
    v_mfma_f32_16x16x32_bf16 v[172:175], a[60:63], a[84:87], v[172:175]
    s_add_u32 m0, s29, 106496
    v_cvt_pk_bf16_f32 v152, v152, v153
    v_cvt_pk_bf16_f32 v153, v154, v155
    v_mfma_f32_16x16x32_bf16 v[172:175], a[56:59], a[80:83], v[172:175]
    buffer_load_dwordx4 v2, s[16:19], s49 offen lds
    v_mfma_f32_16x16x32_bf16 v[180:183], a[56:59], a[72:75], v[180:183]
    v_cvt_pk_bf16_f32 v154, v156, v157
    v_cvt_pk_bf16_f32 v155, v158, v159
    v_mfma_f32_16x16x32_bf16 v[180:183], a[60:63], a[76:79], v[180:183]
    v_mfma_f32_16x16x32_bf16 v[188:191], a[60:63], a[68:71], v[188:191]
    v_mfma_f32_16x16x32_bf16 v[188:191], a[56:59], a[64:67], v[188:191]
    s_add_u32 m0, s29, 110592
    v_mfma_f32_16x16x32_bf16 v[216:219], a[32:35], a[96:99], v[216:219]
    buffer_load_dwordx4 v2, s[16:19], s50 offen lds
    v_mfma_f32_16x16x32_bf16 v[216:219], a[36:39], a[100:103], v[216:219]
    v_cvt_pk_bf16_f32 v160, v160, v161
    v_cvt_pk_bf16_f32 v161, v162, v163
    v_mfma_f32_16x16x32_bf16 v[208:211], a[36:39], a[108:111], v[208:211]
    v_cvt_pk_bf16_f32 v162, v164, v165
    v_cvt_pk_bf16_f32 v163, v166, v167
    v_mfma_f32_16x16x32_bf16 v[208:211], a[32:35], a[104:107], v[208:211]
    v_cvt_pk_bf16_f32 v168, v168, v169
    v_cvt_pk_bf16_f32 v169, v170, v171
    v_mfma_f32_16x16x32_bf16 v[200:203], a[32:35], a[112:115], v[200:203]
    s_add_u32 m0, s29, 114688
    v_cvt_pk_bf16_f32 v170, v172, v173
    v_cvt_pk_bf16_f32 v171, v174, v175
    v_mfma_f32_16x16x32_bf16 v[200:203], a[36:39], a[116:119], v[200:203]
    buffer_load_dwordx4 v2, s[16:19], s51 offen lds
    v_mfma_f32_16x16x32_bf16 v[192:195], a[36:39], a[124:127], v[192:195]
    s_add_u32 s59, s58, 57344
    v_cvt_pk_bf16_f32 v176, v176, v177
    v_cvt_pk_bf16_f32 v177, v178, v179
    v_mfma_f32_16x16x32_bf16 v[192:195], a[32:35], a[120:123], v[192:195]
    buffer_store_dwordx4 v[32:35], v1, s[12:15], s59 offen offset:1024 sc1
    v_mfma_f32_16x16x32_bf16 v[196:199], a[40:43], a[120:123], v[196:199]
    v_cvt_pk_bf16_f32 v178, v180, v181
    v_cvt_pk_bf16_f32 v179, v182, v183
    v_mfma_f32_16x16x32_bf16 v[196:199], a[44:47], a[124:127], v[196:199]
    s_add_u32 m0, s29, 118784
    v_cvt_pk_bf16_f32 v184, v184, v185
    v_cvt_pk_bf16_f32 v185, v186, v187
    v_mfma_f32_16x16x32_bf16 v[204:207], a[44:47], a[116:119], v[204:207]
    buffer_load_dwordx4 v2, s[16:19], s52 offen lds
    v_mfma_f32_16x16x32_bf16 v[204:207], a[40:43], a[112:115], v[204:207]
    v_cvt_pk_bf16_f32 v186, v188, v189
    v_cvt_pk_bf16_f32 v187, v190, v191
    v_mfma_f32_16x16x32_bf16 v[212:215], a[40:43], a[104:107], v[212:215]
    v_mfma_f32_16x16x32_bf16 v[212:215], a[44:47], a[108:111], v[212:215]
    v_mfma_f32_16x16x32_bf16 v[220:223], a[44:47], a[100:103], v[220:223]
    s_add_u32 m0, s29, 122880
    v_mfma_f32_16x16x32_bf16 v[220:223], a[40:43], a[96:99], v[220:223]
    buffer_load_dwordx4 v2, s[16:19], s53 offen lds
    v_mfma_f32_16x16x32_bf16 v[248:251], a[48:51], a[96:99], v[248:251]
    v_mfma_f32_16x16x32_bf16 v[248:251], a[52:55], a[100:103], v[248:251]
    s_waitcnt vmcnt(20)
    v_cvt_pk_bf16_f32 v192, v192, v193
    v_cvt_pk_bf16_f32 v193, v194, v195
    v_mfma_f32_16x16x32_bf16 v[240:243], a[52:55], a[108:111], v[240:243]
    s_barrier
    v_xor_b32 v7, 0, v6
    v_cvt_pk_bf16_f32 v194, v196, v197
    v_mfma_f32_16x16x32_bf16 v[240:243], a[48:51], a[104:107], v[240:243]
    s_add_u32 m0, s29, 126976
    ds_read_b64_tr_b16 a[64:65], v7 offset:0
    v_cvt_pk_bf16_f32 v195, v198, v199
    v_mfma_f32_16x16x32_bf16 v[232:235], a[48:51], a[112:115], v[232:235]
    ds_read_b64_tr_b16 a[66:67], v7 offset:4096
    buffer_load_dwordx4 v2, s[16:19], s54 offen lds
    v_mfma_f32_16x16x32_bf16 v[232:235], a[52:55], a[116:119], v[232:235]
    ds_read_b64_tr_b16 a[68:69], v7 offset:16384
    v_cvt_pk_bf16_f32 v200, v200, v201
    v_mfma_f32_16x16x32_bf16 v[224:227], a[52:55], a[124:127], v[224:227]
    s_add_u32 s59, s58, 49152
    ds_read_b64_tr_b16 a[70:71], v7 offset:20480
    v_xor_b32 v8, 65536, v6
    v_mfma_f32_16x16x32_bf16 v[224:227], a[48:51], a[120:123], v[224:227]
    ds_read_b64_tr_b16 a[72:73], v8 offset:0
    buffer_store_dwordx4 v[40:43], v1, s[12:15], s59 offen offset:1024 sc1
    v_mfma_f32_16x16x32_bf16 v[228:231], a[56:59], a[120:123], v[228:231]
    ds_read_b64_tr_b16 a[74:75], v8 offset:4096
    v_cvt_pk_bf16_f32 v201, v202, v203
    v_mfma_f32_16x16x32_bf16 v[228:231], a[60:63], a[124:127], v[228:231]
    ds_read_b64_tr_b16 a[76:77], v8 offset:16384
    v_cvt_pk_bf16_f32 v202, v204, v205
    v_mfma_f32_16x16x32_bf16 v[236:239], a[60:63], a[116:119], v[236:239]
    ds_read_b64_tr_b16 a[78:79], v8 offset:20480
    v_xor_b32 v9, 32, v6
    v_mfma_f32_16x16x32_bf16 v[236:239], a[56:59], a[112:115], v[236:239]
    ds_read_b64_tr_b16 a[80:81], v9 offset:0
    v_cvt_pk_bf16_f32 v203, v206, v207
    v_mfma_f32_16x16x32_bf16 v[244:247], a[56:59], a[104:107], v[244:247]
    ds_read_b64_tr_b16 a[82:83], v9 offset:4096
    v_cvt_pk_bf16_f32 v208, v208, v209
    v_mfma_f32_16x16x32_bf16 v[244:247], a[60:63], a[108:111], v[244:247]
    ds_read_b64_tr_b16 a[84:85], v9 offset:16384
    v_cvt_pk_bf16_f32 v209, v210, v211
    v_mfma_f32_16x16x32_bf16 v[252:255], a[60:63], a[100:103], v[252:255]
    ds_read_b64_tr_b16 a[86:87], v9 offset:20480
    v_xor_b32 v10, 65568, v6
    v_mfma_f32_16x16x32_bf16 v[252:255], a[56:59], a[96:99], v[252:255]
    s_waitcnt lgkmcnt(6)
    ds_read_b64_tr_b16 a[88:89], v10 offset:0
    v_cvt_pk_bf16_f32 v210, v212, v213
    v_mfma_f32_16x16x32_bf16 v[28:31], a[64:67], a[128:131], 0
    ds_read_b64_tr_b16 a[90:91], v10 offset:4096
    v_cvt_pk_bf16_f32 v211, v214, v215
    v_mfma_f32_16x16x32_bf16 v[28:31], a[68:71], a[136:139], v[28:31]
    s_add_u32 s59, s58, 40960
    ds_read_b64_tr_b16 a[92:93], v10 offset:16384
    v_xor_b32 v7, 64, v6
    v_mfma_f32_16x16x32_bf16 v[28:31], a[72:75], a[144:147], v[28:31]
    s_waitcnt lgkmcnt(7)
    ds_read_b128 a[112:115], v14 offset:0
    ds_read_b64_tr_b16 a[94:95], v10 offset:20480
    v_mfma_f32_16x16x32_bf16 v[28:31], a[76:79], a[152:155], v[28:31]
    ds_read_b64_tr_b16 a[96:97], v7 offset:0
    buffer_store_dwordx4 v[48:51], v1, s[12:15], s59 offen offset:1024 sc1
    v_mfma_f32_16x16x32_bf16 v[44:47], a[64:67], a[132:135], 0
    ds_read_b128 a[120:123], v3 offset:0
    ds_read_b64_tr_b16 a[98:99], v7 offset:4096
    v_mfma_f32_16x16x32_bf16 v[44:47], a[68:71], a[140:143], v[44:47]
    ds_read_b64_tr_b16 a[100:101], v7 offset:16384
    v_xor_b32 v8, 65600, v6
    v_mfma_f32_16x16x32_bf16 v[44:47], a[72:75], a[148:151], v[44:47]
    ds_read_b128 a[116:119], v14 offset:2048
    ds_read_b64_tr_b16 a[102:103], v7 offset:20480
    v_mfma_f32_16x16x32_bf16 v[44:47], a[76:79], a[156:159], v[44:47]
    s_waitcnt lgkmcnt(9)
    ds_read_b64_tr_b16 a[104:105], v8 offset:0
    v_cvt_pk_bf16_f32 v216, v216, v217
    v_mfma_f32_16x16x32_bf16 v[52:55], a[80:83], a[128:131], 0
    ds_read_b128 a[124:127], v3 offset:2048
    ds_read_b64_tr_b16 a[106:107], v8 offset:4096
    v_mfma_f32_16x16x32_bf16 v[52:55], a[84:87], a[136:139], v[52:55]
    ds_read_b64_tr_b16 a[108:109], v8 offset:16384
    v_cvt_pk_bf16_f32 v217, v218, v219
    v_mfma_f32_16x16x32_bf16 v[52:55], a[88:91], a[144:147], v[52:55]
    s_waitcnt lgkmcnt(10)
    ds_read_b64_tr_b16 a[110:111], v8 offset:20480
    v_xor_b32 v9, 96, v6
    v_mfma_f32_16x16x32_bf16 v[52:55], a[92:95], a[152:155], v[52:55]
    ds_read_b64_tr_b16 a[64:65], v9 offset:0
    v_cvt_pk_bf16_f32 v218, v220, v221
    v_mfma_f32_16x16x32_bf16 v[60:63], a[80:83], a[132:135], 0
    ds_read_b64_tr_b16 a[66:67], v9 offset:4096
    v_cvt_pk_bf16_f32 v219, v222, v223
    v_mfma_f32_16x16x32_bf16 v[60:63], a[84:87], a[140:143], v[60:63]
    ds_read_b64_tr_b16 a[68:69], v9 offset:16384
    v_cvt_pk_bf16_f32 v224, v224, v225
    v_mfma_f32_16x16x32_bf16 v[60:63], a[88:91], a[148:151], v[60:63]
    s_add_u32 s59, s58, 32768
    ds_read_b64_tr_b16 a[70:71], v9 offset:20480
    v_xor_b32 v10, 65632, v6
    v_mfma_f32_16x16x32_bf16 v[60:63], a[92:95], a[156:159], v[60:63]
    s_waitcnt lgkmcnt(6)
    ds_read_b64_tr_b16 a[72:73], v10 offset:0
    buffer_store_dwordx4 v[56:59], v1, s[12:15], s59 offen offset:1024 sc1
    v_mfma_f32_16x16x32_bf16 v[20:23], a[96:99], a[128:131], 0
    ds_read_b64_tr_b16 a[74:75], v10 offset:4096
    v_cvt_pk_bf16_f32 v225, v226, v227
    v_mfma_f32_16x16x32_bf16 v[20:23], a[100:103], a[136:139], v[20:23]
    s_waitcnt lgkmcnt(8)
    ds_read_b64_tr_b16 a[76:77], v10 offset:16384
    v_xor_b32 v7, 128, v6
    v_mfma_f32_16x16x32_bf16 v[20:23], a[104:107], a[144:147], v[20:23]
    s_waitcnt lgkmcnt(7)
    s_barrier
    ds_read_b64_tr_b16 a[78:79], v10 offset:20480
    v_mfma_f32_16x16x32_bf16 v[20:23], a[108:111], a[152:155], v[20:23]
    s_add_u32 m0, s29, 131072
    ds_read_b64_tr_b16 a[80:81], v7 offset:0
    v_add_u32 v2, 0x80000, v2
    v_mfma_f32_16x16x32_bf16 v[36:39], a[96:99], a[132:135], 0
    ds_read_b64_tr_b16 a[82:83], v7 offset:4096
    buffer_load_dwordx4 v2, s[16:19], 0 offen lds
    v_mfma_f32_16x16x32_bf16 v[36:39], a[100:103], a[140:143], v[36:39]
    ds_read_b64_tr_b16 a[84:85], v7 offset:16384
    v_cvt_pk_bf16_f32 v226, v228, v229
    v_mfma_f32_16x16x32_bf16 v[36:39], a[104:107], a[148:151], v[36:39]
    ds_read_b64_tr_b16 a[86:87], v7 offset:20480
    v_xor_b32 v8, 65664, v6
    v_mfma_f32_16x16x32_bf16 v[36:39], a[108:111], a[156:159], v[36:39]
    s_waitcnt lgkmcnt(6)
    ds_read_b64_tr_b16 a[88:89], v8 offset:0
    v_cvt_pk_bf16_f32 v227, v230, v231
    v_mfma_f32_16x16x32_bf16 v[68:71], a[64:67], a[128:131], 0
    ds_read_b64_tr_b16 a[90:91], v8 offset:4096
    v_cvt_pk_bf16_f32 v232, v232, v233
    v_mfma_f32_16x16x32_bf16 v[68:71], a[68:71], a[136:139], v[68:71]
    s_add_u32 m0, s29, 135168
    ds_read_b64_tr_b16 a[92:93], v8 offset:16384
    v_cvt_pk_bf16_f32 v233, v234, v235
    v_mfma_f32_16x16x32_bf16 v[68:71], a[72:75], a[144:147], v[68:71]
    s_waitcnt lgkmcnt(7)
    ds_read_b64_tr_b16 a[94:95], v8 offset:20480
    v_xor_b32 v9, 160, v6
    v_mfma_f32_16x16x32_bf16 v[68:71], a[76:79], a[152:155], v[68:71]
    ds_read_b64_tr_b16 a[96:97], v9 offset:0
    buffer_load_dwordx4 v2, s[16:19], s48 offen lds
    v_mfma_f32_16x16x32_bf16 v[76:79], a[64:67], a[132:135], 0
    s_add_u32 s59, s58, 24576
    ds_read_b64_tr_b16 a[98:99], v9 offset:4096
    v_cvt_pk_bf16_f32 v234, v236, v237
    v_mfma_f32_16x16x32_bf16 v[76:79], a[68:71], a[140:143], v[76:79]
    ds_read_b64_tr_b16 a[100:101], v9 offset:16384
    buffer_store_dwordx4 v[64:67], v1, s[12:15], s59 offen offset:0 sc1
    v_mfma_f32_16x16x32_bf16 v[76:79], a[72:75], a[148:151], v[76:79]
    ds_read_b64_tr_b16 a[102:103], v9 offset:20480
    v_xor_b32 v10, 65696, v6
    v_mfma_f32_16x16x32_bf16 v[76:79], a[76:79], a[156:159], v[76:79]
    s_waitcnt lgkmcnt(6)
    ds_read_b64_tr_b16 a[104:105], v10 offset:0
    v_cvt_pk_bf16_f32 v235, v238, v239
    v_mfma_f32_16x16x32_bf16 v[84:87], a[80:83], a[128:131], 0
    s_add_u32 m0, s29, 139264
    ds_read_b64_tr_b16 a[106:107], v10 offset:4096
    v_cvt_pk_bf16_f32 v240, v240, v241
    v_mfma_f32_16x16x32_bf16 v[84:87], a[84:87], a[136:139], v[84:87]
    ds_read_b64_tr_b16 a[108:109], v10 offset:16384
    buffer_load_dwordx4 v2, s[16:19], s49 offen lds
    v_mfma_f32_16x16x32_bf16 v[84:87], a[88:91], a[144:147], v[84:87]
    s_waitcnt lgkmcnt(7)
    ds_read_b64_tr_b16 a[110:111], v10 offset:20480
    v_xor_b32 v7, 192, v6
    v_mfma_f32_16x16x32_bf16 v[84:87], a[92:95], a[152:155], v[84:87]
    ds_read_b64_tr_b16 a[64:65], v7 offset:0
    v_cvt_pk_bf16_f32 v241, v242, v243
    v_mfma_f32_16x16x32_bf16 v[92:95], a[80:83], a[132:135], 0
    ds_read_b64_tr_b16 a[66:67], v7 offset:4096
    v_cvt_pk_bf16_f32 v242, v244, v245
    v_mfma_f32_16x16x32_bf16 v[92:95], a[84:87], a[140:143], v[92:95]
    ds_read_b64_tr_b16 a[68:69], v7 offset:16384
    v_cvt_pk_bf16_f32 v243, v246, v247
    v_mfma_f32_16x16x32_bf16 v[92:95], a[88:91], a[148:151], v[92:95]
    s_add_u32 m0, s29, 143360
    ds_read_b64_tr_b16 a[70:71], v7 offset:20480
    v_xor_b32 v8, 65728, v6
    v_mfma_f32_16x16x32_bf16 v[92:95], a[92:95], a[156:159], v[92:95]
    s_waitcnt lgkmcnt(6)
    ds_read_b64_tr_b16 a[72:73], v8 offset:0
    buffer_load_dwordx4 v2, s[16:19], s50 offen lds
    v_mfma_f32_16x16x32_bf16 v[100:103], a[96:99], a[128:131], 0
    s_add_u32 s59, s58, 16384
    ds_read_b64_tr_b16 a[74:75], v8 offset:4096
    v_cvt_pk_bf16_f32 v248, v248, v249
    v_mfma_f32_16x16x32_bf16 v[100:103], a[100:103], a[136:139], v[100:103]
    ds_read_b64_tr_b16 a[76:77], v8 offset:16384
    buffer_store_dwordx4 v[72:75], v1, s[12:15], s59 offen offset:0 sc1
    v_mfma_f32_16x16x32_bf16 v[100:103], a[104:107], a[144:147], v[100:103]
    s_waitcnt lgkmcnt(7)
    ds_read_b64_tr_b16 a[78:79], v8 offset:20480
    v_xor_b32 v9, 224, v6
    v_mfma_f32_16x16x32_bf16 v[100:103], a[108:111], a[152:155], v[100:103]
    ds_read_b64_tr_b16 a[80:81], v9 offset:0
    v_cvt_pk_bf16_f32 v249, v250, v251
    v_mfma_f32_16x16x32_bf16 v[108:111], a[96:99], a[132:135], 0
    s_add_u32 m0, s29, 147456
    ds_read_b64_tr_b16 a[82:83], v9 offset:4096
    v_cvt_pk_bf16_f32 v250, v252, v253
    v_mfma_f32_16x16x32_bf16 v[108:111], a[100:103], a[140:143], v[108:111]
    ds_read_b64_tr_b16 a[84:85], v9 offset:16384
    buffer_load_dwordx4 v2, s[16:19], s51 offen lds
    v_mfma_f32_16x16x32_bf16 v[108:111], a[104:107], a[148:151], v[108:111]
    ds_read_b64_tr_b16 a[86:87], v9 offset:20480
    v_xor_b32 v10, 65760, v6
    v_mfma_f32_16x16x32_bf16 v[108:111], a[108:111], a[156:159], v[108:111]
    s_waitcnt lgkmcnt(6)
    ds_read_b64_tr_b16 a[88:89], v10 offset:0
    v_cvt_pk_bf16_f32 v251, v254, v255
    v_mfma_f32_16x16x32_bf16 v[116:119], a[64:67], a[128:131], 0
    ds_read_b64_tr_b16 a[90:91], v10 offset:4096
    v_mov_b32 v11, 1
    v_mfma_f32_16x16x32_bf16 v[116:119], a[68:71], a[136:139], v[116:119]
    s_add_u32 m0, s29, 151552
    ds_read_b64_tr_b16 a[92:93], v10 offset:16384
    v_mfma_f32_16x16x32_bf16 v[116:119], a[72:75], a[144:147], v[116:119]
    s_waitcnt lgkmcnt(7)
    ds_read_b64_tr_b16 a[94:95], v10 offset:20480
    v_xor_b32 v7, 256, v6
    v_mfma_f32_16x16x32_bf16 v[116:119], a[76:79], a[152:155], v[116:119]
    ds_read_b64_tr_b16 a[96:97], v7 offset:0
    buffer_load_dwordx4 v2, s[16:19], s52 offen lds
    v_mfma_f32_16x16x32_bf16 v[124:127], a[64:67], a[132:135], 0
    s_add_u32 s59, s58, 8192
    ds_read_b64_tr_b16 a[98:99], v7 offset:4096
    v_mfma_f32_16x16x32_bf16 v[124:127], a[68:71], a[140:143], v[124:127]
    ds_read_b64_tr_b16 a[100:101], v7 offset:16384
    buffer_store_dwordx4 v[80:83], v1, s[12:15], s59 offen offset:0 sc1
    v_mfma_f32_16x16x32_bf16 v[124:127], a[72:75], a[148:151], v[124:127]
    ds_read_b64_tr_b16 a[102:103], v7 offset:20480
    v_xor_b32 v8, 65792, v6
    v_mfma_f32_16x16x32_bf16 v[124:127], a[76:79], a[156:159], v[124:127]
    s_waitcnt lgkmcnt(6)
    ds_read_b64_tr_b16 a[104:105], v8 offset:0
    v_mfma_f32_16x16x32_bf16 v[132:135], a[80:83], a[128:131], 0
    s_add_u32 m0, s29, 155648
    ds_read_b64_tr_b16 a[106:107], v8 offset:4096
    v_mfma_f32_16x16x32_bf16 v[132:135], a[84:87], a[136:139], v[132:135]
    ds_read_b64_tr_b16 a[108:109], v8 offset:16384
    buffer_load_dwordx4 v2, s[16:19], s53 offen lds
    v_mfma_f32_16x16x32_bf16 v[132:135], a[88:91], a[144:147], v[132:135]
    s_waitcnt lgkmcnt(7)
    ds_read_b64_tr_b16 a[110:111], v8 offset:20480
    v_xor_b32 v9, 288, v6
    v_mfma_f32_16x16x32_bf16 v[132:135], a[92:95], a[152:155], v[132:135]
    ds_read_b64_tr_b16 a[64:65], v9 offset:0
    v_mfma_f32_16x16x32_bf16 v[140:143], a[80:83], a[132:135], 0
    ds_read_b64_tr_b16 a[66:67], v9 offset:4096
    v_mfma_f32_16x16x32_bf16 v[140:143], a[84:87], a[140:143], v[140:143]
    ds_read_b64_tr_b16 a[68:69], v9 offset:16384
    v_mfma_f32_16x16x32_bf16 v[140:143], a[88:91], a[148:151], v[140:143]
    s_add_u32 m0, s29, 159744
    ds_read_b64_tr_b16 a[70:71], v9 offset:20480
    v_xor_b32 v10, 65824, v6
    v_mfma_f32_16x16x32_bf16 v[140:143], a[92:95], a[156:159], v[140:143]
    s_waitcnt lgkmcnt(6)
    ds_read_b64_tr_b16 a[72:73], v10 offset:0
    buffer_load_dwordx4 v2, s[16:19], s54 offen lds
    v_mfma_f32_16x16x32_bf16 v[148:151], a[96:99], a[128:131], 0
    s_add_u32 s59, s58, 0
    ds_read_b64_tr_b16 a[74:75], v10 offset:4096
    v_mfma_f32_16x16x32_bf16 v[148:151], a[100:103], a[136:139], v[148:151]
    ds_read_b64_tr_b16 a[76:77], v10 offset:16384
    buffer_store_dwordx4 v[88:91], v1, s[12:15], s59 offen offset:0 sc1
    v_mfma_f32_16x16x32_bf16 v[148:151], a[104:107], a[144:147], v[148:151]
    s_waitcnt lgkmcnt(7)
    ds_read_b64_tr_b16 a[78:79], v10 offset:20480
    v_xor_b32 v7, 320, v6
    v_mfma_f32_16x16x32_bf16 v[148:151], a[108:111], a[152:155], v[148:151]
    ds_read_b64_tr_b16 a[80:81], v7 offset:0
    v_mfma_f32_16x16x32_bf16 v[156:159], a[96:99], a[132:135], 0
    ds_read_b64_tr_b16 a[82:83], v7 offset:4096
    v_mfma_f32_16x16x32_bf16 v[156:159], a[100:103], a[140:143], v[156:159]
    ds_read_b64_tr_b16 a[84:85], v7 offset:16384
    v_mfma_f32_16x16x32_bf16 v[156:159], a[104:107], a[148:151], v[156:159]
    ds_read_b64_tr_b16 a[86:87], v7 offset:20480
    v_xor_b32 v8, 65856, v6
    v_mfma_f32_16x16x32_bf16 v[156:159], a[108:111], a[156:159], v[156:159]
    s_waitcnt lgkmcnt(6)
    ds_read_b64_tr_b16 a[88:89], v8 offset:0
    v_mfma_f32_16x16x32_bf16 v[164:167], a[64:67], a[128:131], 0
    ds_read_b64_tr_b16 a[90:91], v8 offset:4096
    v_mfma_f32_16x16x32_bf16 v[164:167], a[68:71], a[136:139], v[164:167]
    ds_read_b64_tr_b16 a[92:93], v8 offset:16384
    v_mfma_f32_16x16x32_bf16 v[164:167], a[72:75], a[144:147], v[164:167]
    s_waitcnt lgkmcnt(7)
    ds_read_b64_tr_b16 a[94:95], v8 offset:20480
    v_xor_b32 v9, 352, v6
    v_mfma_f32_16x16x32_bf16 v[164:167], a[76:79], a[152:155], v[164:167]
    ds_read_b64_tr_b16 a[96:97], v9 offset:0
    v_mfma_f32_16x16x32_bf16 v[172:175], a[64:67], a[132:135], 0
    s_add_u32 s59, s58, 24576
    ds_read_b64_tr_b16 a[98:99], v9 offset:4096
    v_mfma_f32_16x16x32_bf16 v[172:175], a[68:71], a[140:143], v[172:175]
    ds_read_b64_tr_b16 a[100:101], v9 offset:16384
    buffer_store_dwordx4 v[96:99], v1, s[12:15], s59 offen offset:1024 sc1
    v_mfma_f32_16x16x32_bf16 v[172:175], a[72:75], a[148:151], v[172:175]
    ds_read_b64_tr_b16 a[102:103], v9 offset:20480
    v_xor_b32 v10, 65888, v6
    v_mfma_f32_16x16x32_bf16 v[172:175], a[76:79], a[156:159], v[172:175]
    s_waitcnt lgkmcnt(6)
    ds_read_b64_tr_b16 a[104:105], v10 offset:0
    v_mfma_f32_16x16x32_bf16 v[180:183], a[80:83], a[128:131], 0
    ds_read_b64_tr_b16 a[106:107], v10 offset:4096
    v_mfma_f32_16x16x32_bf16 v[180:183], a[84:87], a[136:139], v[180:183]
    ds_read_b64_tr_b16 a[108:109], v10 offset:16384
    v_mfma_f32_16x16x32_bf16 v[180:183], a[88:91], a[144:147], v[180:183]
    s_waitcnt lgkmcnt(7)
    ds_read_b64_tr_b16 a[110:111], v10 offset:20480
    v_xor_b32 v7, 384, v6
    v_mfma_f32_16x16x32_bf16 v[180:183], a[92:95], a[152:155], v[180:183]
    ds_read_b64_tr_b16 a[64:65], v7 offset:0
    v_mfma_f32_16x16x32_bf16 v[188:191], a[80:83], a[132:135], 0
    ds_read_b64_tr_b16 a[66:67], v7 offset:4096
    v_mfma_f32_16x16x32_bf16 v[188:191], a[84:87], a[140:143], v[188:191]
    ds_read_b64_tr_b16 a[68:69], v7 offset:16384
    v_mfma_f32_16x16x32_bf16 v[188:191], a[88:91], a[148:151], v[188:191]
    ds_read_b64_tr_b16 a[70:71], v7 offset:20480
    v_xor_b32 v8, 65920, v6
    v_mfma_f32_16x16x32_bf16 v[188:191], a[92:95], a[156:159], v[188:191]
    s_waitcnt lgkmcnt(6)
    ds_read_b64_tr_b16 a[72:73], v8 offset:0
    v_mfma_f32_16x16x32_bf16 v[196:199], a[96:99], a[128:131], 0
    s_add_u32 s59, s58, 16384
    ds_read_b64_tr_b16 a[74:75], v8 offset:4096
    v_mfma_f32_16x16x32_bf16 v[196:199], a[100:103], a[136:139], v[196:199]
    ds_read_b64_tr_b16 a[76:77], v8 offset:16384
    buffer_store_dwordx4 v[104:107], v1, s[12:15], s59 offen offset:1024 sc1
    v_mfma_f32_16x16x32_bf16 v[196:199], a[104:107], a[144:147], v[196:199]
    s_waitcnt lgkmcnt(7)
    ds_read_b64_tr_b16 a[78:79], v8 offset:20480
    v_xor_b32 v9, 416, v6
    v_mfma_f32_16x16x32_bf16 v[196:199], a[108:111], a[152:155], v[196:199]
    ds_read_b64_tr_b16 a[80:81], v9 offset:0
    v_mfma_f32_16x16x32_bf16 v[204:207], a[96:99], a[132:135], 0
    ds_read_b64_tr_b16 a[82:83], v9 offset:4096
    v_mfma_f32_16x16x32_bf16 v[204:207], a[100:103], a[140:143], v[204:207]
    ds_read_b64_tr_b16 a[84:85], v9 offset:16384
    v_mfma_f32_16x16x32_bf16 v[204:207], a[104:107], a[148:151], v[204:207]
    ds_read_b64_tr_b16 a[86:87], v9 offset:20480
    v_xor_b32 v10, 65952, v6
    v_mfma_f32_16x16x32_bf16 v[204:207], a[108:111], a[156:159], v[204:207]
    s_waitcnt lgkmcnt(6)
    ds_read_b64_tr_b16 a[88:89], v10 offset:0
    v_mfma_f32_16x16x32_bf16 v[212:215], a[64:67], a[128:131], 0
    ds_read_b64_tr_b16 a[90:91], v10 offset:4096
    v_mfma_f32_16x16x32_bf16 v[212:215], a[68:71], a[136:139], v[212:215]
    ds_read_b64_tr_b16 a[92:93], v10 offset:16384
    v_mfma_f32_16x16x32_bf16 v[212:215], a[72:75], a[144:147], v[212:215]
    s_waitcnt lgkmcnt(7)
    ds_read_b64_tr_b16 a[94:95], v10 offset:20480
    v_xor_b32 v7, 448, v6
    v_mfma_f32_16x16x32_bf16 v[212:215], a[76:79], a[152:155], v[212:215]
    ds_read_b64_tr_b16 a[96:97], v7 offset:0
    v_mfma_f32_16x16x32_bf16 v[220:223], a[64:67], a[132:135], 0
    s_add_u32 s59, s58, 8192
    ds_read_b64_tr_b16 a[98:99], v7 offset:4096
    v_mfma_f32_16x16x32_bf16 v[220:223], a[68:71], a[140:143], v[220:223]
    ds_read_b64_tr_b16 a[100:101], v7 offset:16384
    buffer_store_dwordx4 v[112:115], v1, s[12:15], s59 offen offset:1024 sc1
    v_mfma_f32_16x16x32_bf16 v[220:223], a[72:75], a[148:151], v[220:223]
    ds_read_b64_tr_b16 a[102:103], v7 offset:20480
    v_xor_b32 v8, 65984, v6
    v_mfma_f32_16x16x32_bf16 v[220:223], a[76:79], a[156:159], v[220:223]
    s_waitcnt lgkmcnt(6)
    ds_read_b64_tr_b16 a[104:105], v8 offset:0
    v_mfma_f32_16x16x32_bf16 v[228:231], a[80:83], a[128:131], 0
    ds_read_b64_tr_b16 a[106:107], v8 offset:4096
    v_mfma_f32_16x16x32_bf16 v[228:231], a[84:87], a[136:139], v[228:231]
    ds_read_b64_tr_b16 a[108:109], v8 offset:16384
    v_mfma_f32_16x16x32_bf16 v[228:231], a[88:91], a[144:147], v[228:231]
    s_waitcnt lgkmcnt(7)
    ds_read_b64_tr_b16 a[110:111], v8 offset:20480
    v_xor_b32 v9, 480, v6
    v_mfma_f32_16x16x32_bf16 v[228:231], a[92:95], a[152:155], v[228:231]
    ds_read_b64_tr_b16 a[64:65], v9 offset:0
    v_mfma_f32_16x16x32_bf16 v[236:239], a[80:83], a[132:135], 0
    ds_read_b64_tr_b16 a[66:67], v9 offset:4096
    v_mfma_f32_16x16x32_bf16 v[236:239], a[84:87], a[140:143], v[236:239]
    ds_read_b64_tr_b16 a[68:69], v9 offset:16384
    v_mfma_f32_16x16x32_bf16 v[236:239], a[88:91], a[148:151], v[236:239]
    ds_read_b64_tr_b16 a[70:71], v9 offset:20480
    v_xor_b32 v10, 66016, v6
    v_mfma_f32_16x16x32_bf16 v[236:239], a[92:95], a[156:159], v[236:239]
    s_waitcnt lgkmcnt(6)
    ds_read_b64_tr_b16 a[72:73], v10 offset:0
    v_mfma_f32_16x16x32_bf16 v[244:247], a[96:99], a[128:131], 0
    ds_read_b64_tr_b16 a[74:75], v10 offset:4096
    v_mfma_f32_16x16x32_bf16 v[244:247], a[100:103], a[136:139], v[244:247]
    s_waitcnt vmcnt(18)
    ds_read_b64_tr_b16 a[76:77], v10 offset:16384
    v_xor_b32 v7, 32768, v6
    v_mfma_f32_16x16x32_bf16 v[244:247], a[104:107], a[144:147], v[244:247]
    s_waitcnt lgkmcnt(7)
    s_barrier
    ds_read_b64_tr_b16 a[78:79], v10 offset:20480
    v_mfma_f32_16x16x32_bf16 v[244:247], a[108:111], a[152:155], v[244:247]
    s_add_u32 s59, s58, 0
    ds_read_b64_tr_b16 a[80:81], v7 offset:0
    v_mfma_f32_16x16x32_bf16 v[252:255], a[96:99], a[132:135], 0
    ds_read_b64_tr_b16 a[82:83], v7 offset:4096
    buffer_store_dwordx4 v[120:123], v1, s[12:15], s59 offen offset:1024 sc1
    v_mfma_f32_16x16x32_bf16 v[252:255], a[100:103], a[140:143], v[252:255]
    ds_read_b64_tr_b16 a[84:85], v7 offset:16384
    v_mfma_f32_16x16x32_bf16 v[252:255], a[104:107], a[148:151], v[252:255]
    ds_read_b64_tr_b16 a[86:87], v7 offset:20480
    v_xor_b32 v8, 98304, v6
    v_mfma_f32_16x16x32_bf16 v[252:255], a[108:111], a[156:159], v[252:255]
    s_waitcnt lgkmcnt(6)
    ds_read_b64_tr_b16 a[88:89], v8 offset:0
    v_mfma_f32_16x16x32_bf16 v[16:19], a[64:67], a[128:131], 0
    ds_read_b64_tr_b16 a[90:91], v8 offset:4096
    v_mfma_f32_16x16x32_bf16 v[16:19], a[68:71], a[136:139], v[16:19]
    ds_read_b64_tr_b16 a[92:93], v8 offset:16384
    v_mfma_f32_16x16x32_bf16 v[16:19], a[72:75], a[144:147], v[16:19]
    s_waitcnt lgkmcnt(7)
    ds_read_b64_tr_b16 a[94:95], v8 offset:20480
    v_xor_b32 v9, 32800, v6
    v_mfma_f32_16x16x32_bf16 v[16:19], a[76:79], a[152:155], v[16:19]
    ds_read_b64_tr_b16 a[96:97], v9 offset:0
    v_mfma_f32_16x16x32_bf16 v[24:27], a[64:67], a[132:135], 0
    s_waitcnt lgkmcnt(9)
    ds_read_b64_tr_b16 a[98:99], v9 offset:4096
    v_mfma_f32_16x16x32_bf16 v[24:27], a[68:71], a[140:143], v[24:27]
    s_barrier
    ds_read_b64_tr_b16 a[100:101], v9 offset:16384
    v_mfma_f32_16x16x32_bf16 v[24:27], a[72:75], a[148:151], v[24:27]
    s_add_u32 m0, s29, 0
    ds_read_b64_tr_b16 a[102:103], v9 offset:20480
    v_xor_b32 v10, 98336, v6
    v_mfma_f32_16x16x32_bf16 v[24:27], a[76:79], a[156:159], v[24:27]
    s_waitcnt lgkmcnt(6)
    ds_read_b64_tr_b16 a[104:105], v10 offset:0
    v_add_u32 v2, 0x80000, v2
    v_mfma_f32_16x16x32_bf16 v[28:31], a[80:83], a[160:163], v[28:31]
    ds_read_b64_tr_b16 a[106:107], v10 offset:4096
    buffer_load_dwordx4 v2, s[16:19], 0 offen lds
    v_mfma_f32_16x16x32_bf16 v[28:31], a[84:87], a[168:171], v[28:31]
    s_add_u32 s59, s58, 24576
    ds_read_b64_tr_b16 a[108:109], v10 offset:16384
    v_mfma_f32_16x16x32_bf16 v[28:31], a[88:91], a[176:179], v[28:31]
    s_waitcnt lgkmcnt(7)
    ds_read_b64_tr_b16 a[110:111], v10 offset:20480
    v_xor_b32 v7, 32832, v6
    v_mfma_f32_16x16x32_bf16 v[28:31], a[92:95], a[184:187], v[28:31]
    ds_read_b64_tr_b16 a[64:65], v7 offset:0
    buffer_store_dwordx4 v[128:131], v1, s[12:15], s59 offen offset:2048 sc1
    v_mfma_f32_16x16x32_bf16 v[44:47], a[80:83], a[164:167], v[44:47]
    s_add_u32 m0, s29, 4096
    ds_read_b64_tr_b16 a[66:67], v7 offset:4096
    v_mfma_f32_16x16x32_bf16 v[44:47], a[84:87], a[172:175], v[44:47]
    ds_read_b64_tr_b16 a[68:69], v7 offset:16384
    buffer_load_dwordx4 v2, s[16:19], s48 offen lds
    v_mfma_f32_16x16x32_bf16 v[44:47], a[88:91], a[180:183], v[44:47]
    ds_read_b64_tr_b16 a[70:71], v7 offset:20480
    v_xor_b32 v8, 98368, v6
    v_mfma_f32_16x16x32_bf16 v[44:47], a[92:95], a[188:191], v[44:47]
    s_waitcnt lgkmcnt(6)
    ds_read_b64_tr_b16 a[72:73], v8 offset:0
    v_mfma_f32_16x16x32_bf16 v[52:55], a[96:99], a[160:163], v[52:55]
    ds_read_b64_tr_b16 a[74:75], v8 offset:4096
    v_mfma_f32_16x16x32_bf16 v[52:55], a[100:103], a[168:171], v[52:55]
    s_add_u32 m0, s29, 8192
    ds_read_b64_tr_b16 a[76:77], v8 offset:16384
    v_mfma_f32_16x16x32_bf16 v[52:55], a[104:107], a[176:179], v[52:55]
    s_waitcnt lgkmcnt(7)
    ds_read_b64_tr_b16 a[78:79], v8 offset:20480
    v_xor_b32 v9, 32864, v6
    v_mfma_f32_16x16x32_bf16 v[52:55], a[108:111], a[184:187], v[52:55]
    ds_read_b64_tr_b16 a[80:81], v9 offset:0
    buffer_load_dwordx4 v2, s[16:19], s49 offen lds
    v_mfma_f32_16x16x32_bf16 v[60:63], a[96:99], a[164:167], v[60:63]
    ds_read_b64_tr_b16 a[82:83], v9 offset:4096
    v_mfma_f32_16x16x32_bf16 v[60:63], a[100:103], a[172:175], v[60:63]
    ds_read_b64_tr_b16 a[84:85], v9 offset:16384
    v_mfma_f32_16x16x32_bf16 v[60:63], a[104:107], a[180:183], v[60:63]
    s_add_u32 m0, s29, 12288
    ds_read_b64_tr_b16 a[86:87], v9 offset:20480
    v_xor_b32 v10, 98400, v6
    v_mfma_f32_16x16x32_bf16 v[60:63], a[108:111], a[188:191], v[60:63]
    s_waitcnt lgkmcnt(6)
    ds_read_b64_tr_b16 a[88:89], v10 offset:0
    v_mfma_f32_16x16x32_bf16 v[20:23], a[64:67], a[160:163], v[20:23]
    ds_read_b64_tr_b16 a[90:91], v10 offset:4096
    buffer_load_dwordx4 v2, s[16:19], s50 offen lds
    v_mfma_f32_16x16x32_bf16 v[20:23], a[68:71], a[168:171], v[20:23]
    s_add_u32 s59, s58, 16384
    ds_read_b64_tr_b16 a[92:93], v10 offset:16384
    v_mfma_f32_16x16x32_bf16 v[20:23], a[72:75], a[176:179], v[20:23]
    s_waitcnt lgkmcnt(7)
    ds_read_b64_tr_b16 a[94:95], v10 offset:20480
    v_xor_b32 v7, 32896, v6
    v_mfma_f32_16x16x32_bf16 v[20:23], a[76:79], a[184:187], v[20:23]
    ds_read_b64_tr_b16 a[96:97], v7 offset:0
    buffer_store_dwordx4 v[136:139], v1, s[12:15], s59 offen offset:2048 sc1
    v_mfma_f32_16x16x32_bf16 v[36:39], a[64:67], a[164:167], v[36:39]
    s_add_u32 m0, s29, 16384
    ds_read_b64_tr_b16 a[98:99], v7 offset:4096
    v_mfma_f32_16x16x32_bf16 v[36:39], a[68:71], a[172:175], v[36:39]
    ds_read_b64_tr_b16 a[100:101], v7 offset:16384
    buffer_load_dwordx4 v2, s[16:19], s51 offen lds
    v_mfma_f32_16x16x32_bf16 v[36:39], a[72:75], a[180:183], v[36:39]
    ds_read_b64_tr_b16 a[102:103], v7 offset:20480
    v_xor_b32 v8, 98432, v6
    v_mfma_f32_16x16x32_bf16 v[36:39], a[76:79], a[188:191], v[36:39]
    s_waitcnt lgkmcnt(6)
    ds_read_b64_tr_b16 a[104:105], v8 offset:0
    v_mfma_f32_16x16x32_bf16 v[68:71], a[80:83], a[160:163], v[68:71]
    ds_read_b64_tr_b16 a[106:107], v8 offset:4096
    v_mfma_f32_16x16x32_bf16 v[68:71], a[84:87], a[168:171], v[68:71]
    s_add_u32 m0, s29, 20480
    ds_read_b64_tr_b16 a[108:109], v8 offset:16384
    v_mfma_f32_16x16x32_bf16 v[68:71], a[88:91], a[176:179], v[68:71]
    s_waitcnt lgkmcnt(7)
    ds_read_b64_tr_b16 a[110:111], v8 offset:20480
    v_xor_b32 v9, 32928, v6
    v_mfma_f32_16x16x32_bf16 v[68:71], a[92:95], a[184:187], v[68:71]
    ds_read_b64_tr_b16 a[64:65], v9 offset:0
    buffer_load_dwordx4 v2, s[16:19], s52 offen lds
    v_mfma_f32_16x16x32_bf16 v[76:79], a[80:83], a[164:167], v[76:79]
    ds_read_b64_tr_b16 a[66:67], v9 offset:4096
    v_mfma_f32_16x16x32_bf16 v[76:79], a[84:87], a[172:175], v[76:79]
    ds_read_b64_tr_b16 a[68:69], v9 offset:16384
    v_mfma_f32_16x16x32_bf16 v[76:79], a[88:91], a[180:183], v[76:79]
    s_add_u32 m0, s29, 24576
    ds_read_b64_tr_b16 a[70:71], v9 offset:20480
    v_xor_b32 v10, 98464, v6
    v_mfma_f32_16x16x32_bf16 v[76:79], a[92:95], a[188:191], v[76:79]
    s_waitcnt lgkmcnt(6)
    ds_read_b64_tr_b16 a[72:73], v10 offset:0
    v_mfma_f32_16x16x32_bf16 v[84:87], a[96:99], a[160:163], v[84:87]
    ds_read_b64_tr_b16 a[74:75], v10 offset:4096
    buffer_load_dwordx4 v2, s[16:19], s53 offen lds
    v_mfma_f32_16x16x32_bf16 v[84:87], a[100:103], a[168:171], v[84:87]
    s_add_u32 s59, s58, 8192
    ds_read_b64_tr_b16 a[76:77], v10 offset:16384
    v_mfma_f32_16x16x32_bf16 v[84:87], a[104:107], a[176:179], v[84:87]
    s_waitcnt lgkmcnt(7)
    ds_read_b64_tr_b16 a[78:79], v10 offset:20480
    v_xor_b32 v7, 32960, v6
    v_mfma_f32_16x16x32_bf16 v[84:87], a[108:111], a[184:187], v[84:87]
    ds_read_b64_tr_b16 a[80:81], v7 offset:0
    buffer_store_dwordx4 v[144:147], v1, s[12:15], s59 offen offset:2048 sc1
    v_mfma_f32_16x16x32_bf16 v[92:95], a[96:99], a[164:167], v[92:95]
    s_add_u32 m0, s29, 28672
    ds_read_b64_tr_b16 a[82:83], v7 offset:4096
    v_mfma_f32_16x16x32_bf16 v[92:95], a[100:103], a[172:175], v[92:95]
    ds_read_b64_tr_b16 a[84:85], v7 offset:16384
    buffer_load_dwordx4 v2, s[16:19], s54 offen lds
    v_mfma_f32_16x16x32_bf16 v[92:95], a[104:107], a[180:183], v[92:95]
    ds_read_b64_tr_b16 a[86:87], v7 offset:20480
    v_xor_b32 v8, 98496, v6
    v_mfma_f32_16x16x32_bf16 v[92:95], a[108:111], a[188:191], v[92:95]
    s_waitcnt lgkmcnt(6)
    ds_read_b64_tr_b16 a[88:89], v8 offset:0
    v_mfma_f32_16x16x32_bf16 v[100:103], a[64:67], a[160:163], v[100:103]
    s_add_u32 m0, s29, 65536
    ds_read_b64_tr_b16 a[90:91], v8 offset:4096
    v_add_u32 v2, 0x80000, v2
    v_mfma_f32_16x16x32_bf16 v[100:103], a[68:71], a[168:171], v[100:103]
    ds_read_b64_tr_b16 a[92:93], v8 offset:16384
    buffer_load_dwordx4 v2, s[16:19], 0 offen lds
    v_mfma_f32_16x16x32_bf16 v[100:103], a[72:75], a[176:179], v[100:103]
    s_waitcnt lgkmcnt(7)
    ds_read_b64_tr_b16 a[94:95], v8 offset:20480
    v_xor_b32 v9, 32992, v6
    v_mfma_f32_16x16x32_bf16 v[100:103], a[76:79], a[184:187], v[100:103]
    ds_read_b64_tr_b16 a[96:97], v9 offset:0
    v_mfma_f32_16x16x32_bf16 v[108:111], a[64:67], a[164:167], v[108:111]
    ds_read_b64_tr_b16 a[98:99], v9 offset:4096
    v_mfma_f32_16x16x32_bf16 v[108:111], a[68:71], a[172:175], v[108:111]
    ds_read_b64_tr_b16 a[100:101], v9 offset:16384
    v_mfma_f32_16x16x32_bf16 v[108:111], a[72:75], a[180:183], v[108:111]
    s_add_u32 m0, s29, 69632
    ds_read_b64_tr_b16 a[102:103], v9 offset:20480
    v_xor_b32 v10, 98528, v6
    v_mfma_f32_16x16x32_bf16 v[108:111], a[76:79], a[188:191], v[108:111]
    s_waitcnt lgkmcnt(6)
    ds_read_b64_tr_b16 a[104:105], v10 offset:0
    buffer_load_dwordx4 v2, s[16:19], s48 offen lds
    v_mfma_f32_16x16x32_bf16 v[116:119], a[80:83], a[160:163], v[116:119]
    s_add_u32 s59, s58, 0
    ds_read_b64_tr_b16 a[106:107], v10 offset:4096
    v_mfma_f32_16x16x32_bf16 v[116:119], a[84:87], a[168:171], v[116:119]
    ds_read_b64_tr_b16 a[108:109], v10 offset:16384
    buffer_store_dwordx4 v[152:155], v1, s[12:15], s59 offen offset:2048 sc1
    v_mfma_f32_16x16x32_bf16 v[116:119], a[88:91], a[176:179], v[116:119]
    s_waitcnt lgkmcnt(7)
    ds_read_b64_tr_b16 a[110:111], v10 offset:20480
    v_xor_b32 v7, 33024, v6
    v_mfma_f32_16x16x32_bf16 v[116:119], a[92:95], a[184:187], v[116:119]
    s_add_u32 m0, s29, 73728
    ds_read_b64_tr_b16 a[64:65], v7 offset:0
    v_mfma_f32_16x16x32_bf16 v[124:127], a[80:83], a[164:167], v[124:127]
    ds_read_b64_tr_b16 a[66:67], v7 offset:4096
    buffer_load_dwordx4 v2, s[16:19], s49 offen lds
    v_mfma_f32_16x16x32_bf16 v[124:127], a[84:87], a[172:175], v[124:127]
    ds_read_b64_tr_b16 a[68:69], v7 offset:16384
    v_mfma_f32_16x16x32_bf16 v[124:127], a[88:91], a[180:183], v[124:127]
    ds_read_b64_tr_b16 a[70:71], v7 offset:20480
    v_xor_b32 v8, 98560, v6
    v_mfma_f32_16x16x32_bf16 v[124:127], a[92:95], a[188:191], v[124:127]
    s_waitcnt lgkmcnt(6)
    ds_read_b64_tr_b16 a[72:73], v8 offset:0
    v_mfma_f32_16x16x32_bf16 v[132:135], a[96:99], a[160:163], v[132:135]
    s_add_u32 m0, s29, 77824
    ds_read_b64_tr_b16 a[74:75], v8 offset:4096
    v_mfma_f32_16x16x32_bf16 v[132:135], a[100:103], a[168:171], v[132:135]
    ds_read_b64_tr_b16 a[76:77], v8 offset:16384
    buffer_load_dwordx4 v2, s[16:19], s50 offen lds
    v_mfma_f32_16x16x32_bf16 v[132:135], a[104:107], a[176:179], v[132:135]
    s_waitcnt lgkmcnt(7)
    ds_read_b64_tr_b16 a[78:79], v8 offset:20480
    v_xor_b32 v9, 33056, v6
    v_mfma_f32_16x16x32_bf16 v[132:135], a[108:111], a[184:187], v[132:135]
    ds_read_b64_tr_b16 a[80:81], v9 offset:0
    v_mfma_f32_16x16x32_bf16 v[140:143], a[96:99], a[164:167], v[140:143]
    s_add_u32 s59, s58, 24576
    ds_read_b64_tr_b16 a[82:83], v9 offset:4096
    v_mfma_f32_16x16x32_bf16 v[140:143], a[100:103], a[172:175], v[140:143]
    ds_read_b64_tr_b16 a[84:85], v9 offset:16384
    buffer_store_dwordx4 v[160:163], v1, s[12:15], s59 offen offset:3072 sc1
    v_mfma_f32_16x16x32_bf16 v[140:143], a[104:107], a[180:183], v[140:143]
    s_add_u32 m0, s29, 81920
    ds_read_b64_tr_b16 a[86:87], v9 offset:20480
    v_xor_b32 v10, 98592, v6
    v_mfma_f32_16x16x32_bf16 v[140:143], a[108:111], a[188:191], v[140:143]
    s_waitcnt lgkmcnt(6)
    ds_read_b64_tr_b16 a[88:89], v10 offset:0
    buffer_load_dwordx4 v2, s[16:19], s51 offen lds
    v_mfma_f32_16x16x32_bf16 v[148:151], a[64:67], a[160:163], v[148:151]
    ds_read_b64_tr_b16 a[90:91], v10 offset:4096
    v_mfma_f32_16x16x32_bf16 v[148:151], a[68:71], a[168:171], v[148:151]
    ds_read_b64_tr_b16 a[92:93], v10 offset:16384
    v_mfma_f32_16x16x32_bf16 v[148:151], a[72:75], a[176:179], v[148:151]
    s_waitcnt lgkmcnt(7)
    ds_read_b64_tr_b16 a[94:95], v10 offset:20480
    v_xor_b32 v7, 33088, v6
    v_mfma_f32_16x16x32_bf16 v[148:151], a[76:79], a[184:187], v[148:151]
    s_add_u32 m0, s29, 86016
    ds_read_b64_tr_b16 a[96:97], v7 offset:0
    v_mfma_f32_16x16x32_bf16 v[156:159], a[64:67], a[164:167], v[156:159]
    ds_read_b64_tr_b16 a[98:99], v7 offset:4096
    buffer_load_dwordx4 v2, s[16:19], s52 offen lds
    v_mfma_f32_16x16x32_bf16 v[156:159], a[68:71], a[172:175], v[156:159]
    ds_read_b64_tr_b16 a[100:101], v7 offset:16384
    v_mfma_f32_16x16x32_bf16 v[156:159], a[72:75], a[180:183], v[156:159]
    ds_read_b64_tr_b16 a[102:103], v7 offset:20480
    v_xor_b32 v8, 98624, v6
    v_mfma_f32_16x16x32_bf16 v[156:159], a[76:79], a[188:191], v[156:159]
    s_waitcnt lgkmcnt(6)
    ds_read_b64_tr_b16 a[104:105], v8 offset:0
    v_mfma_f32_16x16x32_bf16 v[164:167], a[80:83], a[160:163], v[164:167]
    s_add_u32 m0, s29, 90112
    ds_read_b64_tr_b16 a[106:107], v8 offset:4096
    v_mfma_f32_16x16x32_bf16 v[164:167], a[84:87], a[168:171], v[164:167]
    ds_read_b64_tr_b16 a[108:109], v8 offset:16384
    buffer_load_dwordx4 v2, s[16:19], s53 offen lds
    v_mfma_f32_16x16x32_bf16 v[164:167], a[88:91], a[176:179], v[164:167]
    s_waitcnt lgkmcnt(7)
    ds_read_b64_tr_b16 a[110:111], v8 offset:20480
    v_xor_b32 v9, 33120, v6
    v_mfma_f32_16x16x32_bf16 v[164:167], a[92:95], a[184:187], v[164:167]
    s_add_u32 s59, s58, 16384
    ds_read_b64_tr_b16 a[64:65], v9 offset:0
    v_mfma_f32_16x16x32_bf16 v[172:175], a[80:83], a[164:167], v[172:175]
    ds_read_b64_tr_b16 a[66:67], v9 offset:4096
    buffer_store_dwordx4 v[168:171], v1, s[12:15], s59 offen offset:3072 sc1
    v_mfma_f32_16x16x32_bf16 v[172:175], a[84:87], a[172:175], v[172:175]
    ds_read_b64_tr_b16 a[68:69], v9 offset:16384
    v_mfma_f32_16x16x32_bf16 v[172:175], a[88:91], a[180:183], v[172:175]
    s_add_u32 m0, s29, 94208
    ds_read_b64_tr_b16 a[70:71], v9 offset:20480
    v_xor_b32 v10, 98656, v6
    v_mfma_f32_16x16x32_bf16 v[172:175], a[92:95], a[188:191], v[172:175]
    s_waitcnt lgkmcnt(6)
    ds_read_b64_tr_b16 a[72:73], v10 offset:0
    buffer_load_dwordx4 v2, s[16:19], s54 offen lds
    v_mfma_f32_16x16x32_bf16 v[180:183], a[96:99], a[160:163], v[180:183]
    ds_read_b64_tr_b16 a[74:75], v10 offset:4096
    v_mfma_f32_16x16x32_bf16 v[180:183], a[100:103], a[168:171], v[180:183]
    ds_read_b64_tr_b16 a[76:77], v10 offset:16384
    v_mfma_f32_16x16x32_bf16 v[180:183], a[104:107], a[176:179], v[180:183]
    s_waitcnt lgkmcnt(7)
    ds_read_b64_tr_b16 a[78:79], v10 offset:20480
    v_xor_b32 v7, 33152, v6
    v_mfma_f32_16x16x32_bf16 v[180:183], a[108:111], a[184:187], v[180:183]
    ds_read_b64_tr_b16 a[80:81], v7 offset:0
    v_mfma_f32_16x16x32_bf16 v[188:191], a[96:99], a[164:167], v[188:191]
    ds_read_b64_tr_b16 a[82:83], v7 offset:4096
    v_mfma_f32_16x16x32_bf16 v[188:191], a[100:103], a[172:175], v[188:191]
    ds_read_b64_tr_b16 a[84:85], v7 offset:16384
    v_mfma_f32_16x16x32_bf16 v[188:191], a[104:107], a[180:183], v[188:191]
    s_add_u32 s59, s58, 8192
    ds_read_b64_tr_b16 a[86:87], v7 offset:20480
    v_xor_b32 v8, 98688, v6
    v_mfma_f32_16x16x32_bf16 v[188:191], a[108:111], a[188:191], v[188:191]
    s_waitcnt lgkmcnt(6)
    ds_read_b64_tr_b16 a[88:89], v8 offset:0
    v_mfma_f32_16x16x32_bf16 v[196:199], a[64:67], a[160:163], v[196:199]
    ds_read_b64_tr_b16 a[90:91], v8 offset:4096
    buffer_store_dwordx4 v[176:179], v1, s[12:15], s59 offen offset:3072 sc1
    v_mfma_f32_16x16x32_bf16 v[196:199], a[68:71], a[168:171], v[196:199]
    ds_read_b64_tr_b16 a[92:93], v8 offset:16384
    v_mfma_f32_16x16x32_bf16 v[196:199], a[72:75], a[176:179], v[196:199]
    s_waitcnt lgkmcnt(7)
    ds_read_b64_tr_b16 a[94:95], v8 offset:20480
    v_xor_b32 v9, 33184, v6
    v_mfma_f32_16x16x32_bf16 v[196:199], a[76:79], a[184:187], v[196:199]
    ds_read_b64_tr_b16 a[96:97], v9 offset:0
    v_mfma_f32_16x16x32_bf16 v[204:207], a[64:67], a[164:167], v[204:207]
    ds_read_b64_tr_b16 a[98:99], v9 offset:4096
    v_mfma_f32_16x16x32_bf16 v[204:207], a[68:71], a[172:175], v[204:207]
    ds_read_b64_tr_b16 a[100:101], v9 offset:16384
    v_mfma_f32_16x16x32_bf16 v[204:207], a[72:75], a[180:183], v[204:207]
    ds_read_b64_tr_b16 a[102:103], v9 offset:20480
    v_xor_b32 v10, 98720, v6
    v_mfma_f32_16x16x32_bf16 v[204:207], a[76:79], a[188:191], v[204:207]
    s_waitcnt lgkmcnt(6)
    ds_read_b64_tr_b16 a[104:105], v10 offset:0
    v_mfma_f32_16x16x32_bf16 v[212:215], a[80:83], a[160:163], v[212:215]
    ds_read_b64_tr_b16 a[106:107], v10 offset:4096
    v_mfma_f32_16x16x32_bf16 v[212:215], a[84:87], a[168:171], v[212:215]
    ds_read_b64_tr_b16 a[108:109], v10 offset:16384
    v_mfma_f32_16x16x32_bf16 v[212:215], a[88:91], a[176:179], v[212:215]
    s_waitcnt lgkmcnt(7)
    ds_read_b64_tr_b16 a[110:111], v10 offset:20480
    v_xor_b32 v7, 33216, v6
    v_mfma_f32_16x16x32_bf16 v[212:215], a[92:95], a[184:187], v[212:215]
    s_add_u32 s59, s58, 0
    ds_read_b64_tr_b16 a[64:65], v7 offset:0
    v_mfma_f32_16x16x32_bf16 v[220:223], a[80:83], a[164:167], v[220:223]
    ds_read_b64_tr_b16 a[66:67], v7 offset:4096
    buffer_store_dwordx4 v[184:187], v1, s[12:15], s59 offen offset:3072 sc1
    v_mfma_f32_16x16x32_bf16 v[220:223], a[84:87], a[172:175], v[220:223]
    ds_read_b64_tr_b16 a[68:69], v7 offset:16384
    v_mfma_f32_16x16x32_bf16 v[220:223], a[88:91], a[180:183], v[220:223]
    ds_read_b64_tr_b16 a[70:71], v7 offset:20480
    v_xor_b32 v8, 98752, v6
    v_mfma_f32_16x16x32_bf16 v[220:223], a[92:95], a[188:191], v[220:223]
    s_waitcnt lgkmcnt(6)
    ds_read_b64_tr_b16 a[72:73], v8 offset:0
    v_mfma_f32_16x16x32_bf16 v[228:231], a[96:99], a[160:163], v[228:231]
    ds_read_b64_tr_b16 a[74:75], v8 offset:4096
    v_mfma_f32_16x16x32_bf16 v[228:231], a[100:103], a[168:171], v[228:231]
    ds_read_b64_tr_b16 a[76:77], v8 offset:16384
    v_mfma_f32_16x16x32_bf16 v[228:231], a[104:107], a[176:179], v[228:231]
    s_waitcnt lgkmcnt(7)
    ds_read_b64_tr_b16 a[78:79], v8 offset:20480
    v_xor_b32 v9, 33248, v6
    v_mfma_f32_16x16x32_bf16 v[228:231], a[108:111], a[184:187], v[228:231]
    ds_read_b64_tr_b16 a[80:81], v9 offset:0
    v_mfma_f32_16x16x32_bf16 v[236:239], a[96:99], a[164:167], v[236:239]
    ds_read_b64_tr_b16 a[82:83], v9 offset:4096
    v_mfma_f32_16x16x32_bf16 v[236:239], a[100:103], a[172:175], v[236:239]
    ds_read_b64_tr_b16 a[84:85], v9 offset:16384
    v_mfma_f32_16x16x32_bf16 v[236:239], a[104:107], a[180:183], v[236:239]
    s_add_u32 s59, s58, 57344
    ds_read_b64_tr_b16 a[86:87], v9 offset:20480
    v_xor_b32 v10, 98784, v6
    v_mfma_f32_16x16x32_bf16 v[236:239], a[108:111], a[188:191], v[236:239]
    s_waitcnt lgkmcnt(6)
    ds_read_b64_tr_b16 a[88:89], v10 offset:0
    v_mfma_f32_16x16x32_bf16 v[244:247], a[64:67], a[160:163], v[244:247]
    ds_read_b64_tr_b16 a[90:91], v10 offset:4096
    buffer_store_dwordx4 v[192:195], v1, s[12:15], s59 offen offset:2048 sc1
    v_mfma_f32_16x16x32_bf16 v[244:247], a[68:71], a[168:171], v[244:247]
    s_waitcnt vmcnt(3)
    ds_read_b64_tr_b16 a[92:93], v10 offset:16384
    v_xor_b32 v7, 131072, v6
    v_mfma_f32_16x16x32_bf16 v[244:247], a[72:75], a[176:179], v[244:247]
    s_waitcnt lgkmcnt(7)
    s_barrier
    ds_read_b64_tr_b16 a[94:95], v10 offset:20480
    v_mfma_f32_16x16x32_bf16 v[244:247], a[76:79], a[184:187], v[244:247]
    ds_read_b64_tr_b16 a[96:97], v7 offset:0
    v_mfma_f32_16x16x32_bf16 v[252:255], a[64:67], a[164:167], v[252:255]
    ds_read_b64_tr_b16 a[98:99], v7 offset:4096
    v_mfma_f32_16x16x32_bf16 v[252:255], a[68:71], a[172:175], v[252:255]
    ds_read_b64_tr_b16 a[100:101], v7 offset:16384
    v_mfma_f32_16x16x32_bf16 v[252:255], a[72:75], a[180:183], v[252:255]
    ds_read_b64_tr_b16 a[102:103], v7 offset:20480
    v_xor_b32 v8, 0, v6
    v_mfma_f32_16x16x32_bf16 v[252:255], a[76:79], a[188:191], v[252:255]
    s_waitcnt lgkmcnt(6)
    ds_read_b64_tr_b16 a[104:105], v8 offset:0
    v_mfma_f32_16x16x32_bf16 v[16:19], a[80:83], a[160:163], v[16:19]
    ds_read_b64_tr_b16 a[106:107], v8 offset:4096
    v_mfma_f32_16x16x32_bf16 v[16:19], a[84:87], a[168:171], v[16:19]
    ds_read_b64_tr_b16 a[108:109], v8 offset:16384
    v_mfma_f32_16x16x32_bf16 v[16:19], a[88:91], a[176:179], v[16:19]
    s_waitcnt lgkmcnt(7)
    ds_read_b64_tr_b16 a[110:111], v8 offset:20480
    v_xor_b32 v9, 65536, v6
    v_mfma_f32_16x16x32_bf16 v[16:19], a[92:95], a[184:187], v[16:19]
    s_add_u32 s59, s58, 49152
    ds_read_b64_tr_b16 a[64:65], v9 offset:0
    v_mfma_f32_16x16x32_bf16 v[24:27], a[80:83], a[164:167], v[24:27]
    ds_read_b64_tr_b16 a[66:67], v9 offset:4096
    buffer_store_dwordx4 v[200:203], v1, s[12:15], s59 offen offset:2048 sc1
    v_mfma_f32_16x16x32_bf16 v[24:27], a[84:87], a[172:175], v[24:27]
    ds_read_b64_tr_b16 a[68:69], v9 offset:16384
    v_mfma_f32_16x16x32_bf16 v[24:27], a[88:91], a[180:183], v[24:27]
    ds_read_b64_tr_b16 a[70:71], v9 offset:20480
    v_xor_b32 v10, 131104, v6
    v_mfma_f32_16x16x32_bf16 v[24:27], a[92:95], a[188:191], v[24:27]
    s_waitcnt lgkmcnt(6)
    ds_read_b64_tr_b16 a[72:73], v10 offset:0
    v_mfma_f32_16x16x32_bf16 v[28:31], a[96:99], a[192:195], v[28:31]
    ds_read_b64_tr_b16 a[74:75], v10 offset:4096
    v_mfma_f32_16x16x32_bf16 v[28:31], a[100:103], a[200:203], v[28:31]
    ds_read_b64_tr_b16 a[76:77], v10 offset:16384
    v_mfma_f32_16x16x32_bf16 v[28:31], a[104:107], a[208:211], v[28:31]
    s_waitcnt lgkmcnt(3)
    ds_read_b64_tr_b16 a[78:79], v10 offset:20480
    v_xor_b32 v7, 32, v6
    v_mfma_f32_16x16x32_bf16 v[28:31], a[108:111], a[216:219], v[28:31]
    ds_read_b64_tr_b16 a[80:81], v7 offset:0
    v_mfma_f32_16x16x32_bf16 v[28:31], a[64:67], a[112:115], v[28:31]
    ds_read_b64_tr_b16 a[82:83], v7 offset:4096
    v_mfma_f32_16x16x32_bf16 v[28:31], a[68:71], a[120:123], v[28:31]
    ds_read_b64_tr_b16 a[84:85], v7 offset:16384
    v_mfma_f32_16x16x32_bf16 v[44:47], a[96:99], a[196:199], v[44:47]
    ds_read_b64_tr_b16 a[86:87], v7 offset:20480
    v_xor_b32 v8, 65568, v6
    v_mfma_f32_16x16x32_bf16 v[44:47], a[100:103], a[204:207], v[44:47]
    s_add_u32 s59, s58, 40960
    ds_read_b64_tr_b16 a[88:89], v8 offset:0
    v_mfma_f32_16x16x32_bf16 v[44:47], a[104:107], a[212:215], v[44:47]
    ds_read_b64_tr_b16 a[90:91], v8 offset:4096
    buffer_store_dwordx4 v[208:211], v1, s[12:15], s59 offen offset:2048 sc1
    v_mfma_f32_16x16x32_bf16 v[44:47], a[108:111], a[220:223], v[44:47]
    ds_read_b64_tr_b16 a[92:93], v8 offset:16384
    v_mfma_f32_16x16x32_bf16 v[44:47], a[64:67], a[116:119], v[44:47]
    ds_read_b64_tr_b16 a[94:95], v8 offset:20480
    v_xor_b32 v9, 131136, v6
    v_mfma_f32_16x16x32_bf16 v[44:47], a[68:71], a[124:127], v[44:47]
    s_waitcnt lgkmcnt(6)
    ds_read_b64_tr_b16 a[96:97], v9 offset:0
    v_mfma_f32_16x16x32_bf16 v[52:55], a[72:75], a[192:195], v[52:55]
    ds_read_b64_tr_b16 a[98:99], v9 offset:4096
    v_mfma_f32_16x16x32_bf16 v[52:55], a[76:79], a[200:203], v[52:55]
    ds_read_b64_tr_b16 a[100:101], v9 offset:16384
    v_mfma_f32_16x16x32_bf16 v[52:55], a[80:83], a[208:211], v[52:55]
    s_waitcnt lgkmcnt(3)
    ds_read_b64_tr_b16 a[102:103], v9 offset:20480
    v_xor_b32 v10, 64, v6
    v_mfma_f32_16x16x32_bf16 v[52:55], a[84:87], a[216:219], v[52:55]
    ds_read_b64_tr_b16 a[104:105], v10 offset:0
    v_mfma_f32_16x16x32_bf16 v[52:55], a[88:91], a[112:115], v[52:55]
    ds_read_b64_tr_b16 a[106:107], v10 offset:4096
    v_mfma_f32_16x16x32_bf16 v[52:55], a[92:95], a[120:123], v[52:55]
    ds_read_b64_tr_b16 a[108:109], v10 offset:16384
    v_mfma_f32_16x16x32_bf16 v[60:63], a[72:75], a[196:199], v[60:63]
    ds_read_b64_tr_b16 a[110:111], v10 offset:20480
    v_xor_b32 v7, 65600, v6
    v_mfma_f32_16x16x32_bf16 v[60:63], a[76:79], a[204:207], v[60:63]
    s_add_u32 s59, s58, 32768
    ds_read_b64_tr_b16 a[64:65], v7 offset:0
    v_mfma_f32_16x16x32_bf16 v[60:63], a[80:83], a[212:215], v[60:63]
    ds_read_b64_tr_b16 a[66:67], v7 offset:4096
    buffer_store_dwordx4 v[216:219], v1, s[12:15], s59 offen offset:2048 sc1
    v_mfma_f32_16x16x32_bf16 v[60:63], a[84:87], a[220:223], v[60:63]
    ds_read_b64_tr_b16 a[68:69], v7 offset:16384
    v_mfma_f32_16x16x32_bf16 v[60:63], a[88:91], a[116:119], v[60:63]
    ds_read_b64_tr_b16 a[70:71], v7 offset:20480
    v_xor_b32 v8, 131168, v6
    v_mfma_f32_16x16x32_bf16 v[60:63], a[92:95], a[124:127], v[60:63]
    s_waitcnt lgkmcnt(6)
    ds_read_b64_tr_b16 a[72:73], v8 offset:0
    v_mfma_f32_16x16x32_bf16 v[20:23], a[96:99], a[192:195], v[20:23]
    ds_read_b64_tr_b16 a[74:75], v8 offset:4096
    v_mfma_f32_16x16x32_bf16 v[20:23], a[100:103], a[200:203], v[20:23]
    ds_read_b64_tr_b16 a[76:77], v8 offset:16384
    v_mul_f32 v28, s34, v28
    v_mfma_f32_16x16x32_bf16 v[20:23], a[104:107], a[208:211], v[20:23]
    s_waitcnt lgkmcnt(3)
    ds_read_b64_tr_b16 a[78:79], v8 offset:20480
    v_xor_b32 v9, 96, v6
    v_mfma_f32_16x16x32_bf16 v[20:23], a[108:111], a[216:219], v[20:23]
    ds_read_b64_tr_b16 a[80:81], v9 offset:0
    v_mul_f32 v29, s34, v29
    v_mfma_f32_16x16x32_bf16 v[20:23], a[64:67], a[112:115], v[20:23]
    ds_read_b64_tr_b16 a[82:83], v9 offset:4096
    v_mul_f32 v30, s34, v30
    v_mfma_f32_16x16x32_bf16 v[20:23], a[68:71], a[120:123], v[20:23]
    ds_read_b64_tr_b16 a[84:85], v9 offset:16384
    v_mul_f32 v31, s34, v31
    v_mfma_f32_16x16x32_bf16 v[36:39], a[96:99], a[196:199], v[36:39]
    ds_read_b64_tr_b16 a[86:87], v9 offset:20480
    v_xor_b32 v10, 65632, v6
    v_mfma_f32_16x16x32_bf16 v[36:39], a[100:103], a[204:207], v[36:39]
    s_add_u32 s59, s58, 57344
    ds_read_b64_tr_b16 a[88:89], v10 offset:0
    v_mul_f32 v52, s34, v52
    v_mfma_f32_16x16x32_bf16 v[36:39], a[104:107], a[212:215], v[36:39]
    ds_read_b64_tr_b16 a[90:91], v10 offset:4096
    buffer_store_dwordx4 v[224:227], v1, s[12:15], s59 offen offset:3072 sc1
    v_mfma_f32_16x16x32_bf16 v[36:39], a[108:111], a[220:223], v[36:39]
    ds_read_b64_tr_b16 a[92:93], v10 offset:16384
    v_mul_f32 v53, s34, v53
    v_mfma_f32_16x16x32_bf16 v[36:39], a[64:67], a[116:119], v[36:39]
    ds_read_b64_tr_b16 a[94:95], v10 offset:20480
    v_xor_b32 v7, 131200, v6
    v_mfma_f32_16x16x32_bf16 v[36:39], a[68:71], a[124:127], v[36:39]
    s_waitcnt lgkmcnt(6)
    ds_read_b64_tr_b16 a[96:97], v7 offset:0
    v_mul_f32 v54, s34, v54
    v_mfma_f32_16x16x32_bf16 v[68:71], a[72:75], a[192:195], v[68:71]
    ds_read_b64_tr_b16 a[98:99], v7 offset:4096
    v_mul_f32 v55, s34, v55
    v_mfma_f32_16x16x32_bf16 v[68:71], a[76:79], a[200:203], v[68:71]
    ds_read_b64_tr_b16 a[100:101], v7 offset:16384
    v_cvt_pk_bf16_f32 v28, v28, v29
    v_mfma_f32_16x16x32_bf16 v[68:71], a[80:83], a[208:211], v[68:71]
    s_waitcnt lgkmcnt(3)
    ds_read_b64_tr_b16 a[102:103], v7 offset:20480
    v_xor_b32 v8, 128, v6
    v_mfma_f32_16x16x32_bf16 v[68:71], a[84:87], a[216:219], v[68:71]
    ds_read_b64_tr_b16 a[104:105], v8 offset:0
    v_cvt_pk_bf16_f32 v29, v30, v31
    v_mfma_f32_16x16x32_bf16 v[68:71], a[88:91], a[112:115], v[68:71]
    ds_read_b64_tr_b16 a[106:107], v8 offset:4096
    v_cvt_pk_bf16_f32 v30, v52, v53
    v_mfma_f32_16x16x32_bf16 v[68:71], a[92:95], a[120:123], v[68:71]
    ds_read_b64_tr_b16 a[108:109], v8 offset:16384
    v_cvt_pk_bf16_f32 v31, v54, v55
    v_mfma_f32_16x16x32_bf16 v[76:79], a[72:75], a[196:199], v[76:79]
    ds_read_b64_tr_b16 a[110:111], v8 offset:20480
    v_xor_b32 v9, 65664, v6
    v_mfma_f32_16x16x32_bf16 v[76:79], a[76:79], a[204:207], v[76:79]
    s_add_u32 s59, s58, 49152
    ds_read_b64_tr_b16 a[64:65], v9 offset:0
    v_accvgpr_write_b32 a0, v28
    v_mfma_f32_16x16x32_bf16 v[76:79], a[80:83], a[212:215], v[76:79]
    ds_read_b64_tr_b16 a[66:67], v9 offset:4096
    buffer_store_dwordx4 v[232:235], v1, s[12:15], s59 offen offset:3072 sc1
    v_mfma_f32_16x16x32_bf16 v[76:79], a[84:87], a[220:223], v[76:79]
    ds_read_b64_tr_b16 a[68:69], v9 offset:16384
    v_accvgpr_write_b32 a1, v29
    v_mfma_f32_16x16x32_bf16 v[76:79], a[88:91], a[116:119], v[76:79]
    ds_read_b64_tr_b16 a[70:71], v9 offset:20480
    v_xor_b32 v10, 131232, v6
    v_mfma_f32_16x16x32_bf16 v[76:79], a[92:95], a[124:127], v[76:79]
    s_waitcnt lgkmcnt(6)
    ds_read_b64_tr_b16 a[72:73], v10 offset:0
    v_accvgpr_write_b32 a2, v30
    v_mfma_f32_16x16x32_bf16 v[84:87], a[96:99], a[192:195], v[84:87]
    ds_read_b64_tr_b16 a[74:75], v10 offset:4096
    v_accvgpr_write_b32 a3, v31
    v_mfma_f32_16x16x32_bf16 v[84:87], a[100:103], a[200:203], v[84:87]
    ds_read_b64_tr_b16 a[76:77], v10 offset:16384
    v_mul_f32 v44, s34, v44
    v_mfma_f32_16x16x32_bf16 v[84:87], a[104:107], a[208:211], v[84:87]
    s_waitcnt lgkmcnt(3)
    ds_read_b64_tr_b16 a[78:79], v10 offset:20480
    v_xor_b32 v7, 160, v6
    v_mfma_f32_16x16x32_bf16 v[84:87], a[108:111], a[216:219], v[84:87]
    ds_read_b64_tr_b16 a[80:81], v7 offset:0
    v_mul_f32 v45, s34, v45
    v_mfma_f32_16x16x32_bf16 v[84:87], a[64:67], a[112:115], v[84:87]
    ds_read_b64_tr_b16 a[82:83], v7 offset:4096
    v_mul_f32 v46, s34, v46
    v_mfma_f32_16x16x32_bf16 v[84:87], a[68:71], a[120:123], v[84:87]
    ds_read_b64_tr_b16 a[84:85], v7 offset:16384
    v_mul_f32 v47, s34, v47
    v_mfma_f32_16x16x32_bf16 v[92:95], a[96:99], a[196:199], v[92:95]
    ds_read_b64_tr_b16 a[86:87], v7 offset:20480
    v_xor_b32 v8, 65696, v6
    v_mfma_f32_16x16x32_bf16 v[92:95], a[100:103], a[204:207], v[92:95]
    s_add_u32 s59, s58, 40960
    ds_read_b64_tr_b16 a[88:89], v8 offset:0
    v_mul_f32 v60, s34, v60
    v_mfma_f32_16x16x32_bf16 v[92:95], a[104:107], a[212:215], v[92:95]
    ds_read_b64_tr_b16 a[90:91], v8 offset:4096
    buffer_store_dwordx4 v[240:243], v1, s[12:15], s59 offen offset:3072 sc1
    v_mfma_f32_16x16x32_bf16 v[92:95], a[108:111], a[220:223], v[92:95]
    ds_read_b64_tr_b16 a[92:93], v8 offset:16384
    v_mul_f32 v61, s34, v61
    v_mfma_f32_16x16x32_bf16 v[92:95], a[64:67], a[116:119], v[92:95]
    ds_read_b64_tr_b16 a[94:95], v8 offset:20480
    v_xor_b32 v9, 131264, v6
    v_mfma_f32_16x16x32_bf16 v[92:95], a[68:71], a[124:127], v[92:95]
    s_waitcnt lgkmcnt(6)
    ds_read_b64_tr_b16 a[96:97], v9 offset:0
    v_mul_f32 v62, s34, v62
    v_mfma_f32_16x16x32_bf16 v[100:103], a[72:75], a[192:195], v[100:103]
    ds_read_b64_tr_b16 a[98:99], v9 offset:4096
    v_mul_f32 v63, s34, v63
    v_mfma_f32_16x16x32_bf16 v[100:103], a[76:79], a[200:203], v[100:103]
    ds_read_b64_tr_b16 a[100:101], v9 offset:16384
    v_cvt_pk_bf16_f32 v44, v44, v45
    v_mfma_f32_16x16x32_bf16 v[100:103], a[80:83], a[208:211], v[100:103]
    s_waitcnt lgkmcnt(3)
    ds_read_b64_tr_b16 a[102:103], v9 offset:20480
    v_xor_b32 v10, 192, v6
    v_mfma_f32_16x16x32_bf16 v[100:103], a[84:87], a[216:219], v[100:103]
    ds_read_b64_tr_b16 a[104:105], v10 offset:0
    v_cvt_pk_bf16_f32 v45, v46, v47
    v_mfma_f32_16x16x32_bf16 v[100:103], a[88:91], a[112:115], v[100:103]
    ds_read_b64_tr_b16 a[106:107], v10 offset:4096
    v_cvt_pk_bf16_f32 v46, v60, v61
    v_mfma_f32_16x16x32_bf16 v[100:103], a[92:95], a[120:123], v[100:103]
    ds_read_b64_tr_b16 a[108:109], v10 offset:16384
    v_cvt_pk_bf16_f32 v47, v62, v63
    v_mfma_f32_16x16x32_bf16 v[108:111], a[72:75], a[196:199], v[108:111]
    ds_read_b64_tr_b16 a[110:111], v10 offset:20480
    v_xor_b32 v7, 65728, v6
    v_mfma_f32_16x16x32_bf16 v[108:111], a[76:79], a[204:207], v[108:111]
    s_add_u32 s59, s58, 32768
    ds_read_b64_tr_b16 a[64:65], v7 offset:0
    v_accvgpr_write_b32 a32, v44
    v_mfma_f32_16x16x32_bf16 v[108:111], a[80:83], a[212:215], v[108:111]
    ds_read_b64_tr_b16 a[66:67], v7 offset:4096
    buffer_store_dwordx4 v[248:251], v1, s[12:15], s59 offen offset:3072 sc1
    v_mfma_f32_16x16x32_bf16 v[108:111], a[84:87], a[220:223], v[108:111]
    ds_read_b64_tr_b16 a[68:69], v7 offset:16384
    v_accvgpr_write_b32 a33, v45
    v_mfma_f32_16x16x32_bf16 v[108:111], a[88:91], a[116:119], v[108:111]
    ds_read_b64_tr_b16 a[70:71], v7 offset:20480
    v_xor_b32 v8, 131296, v6
    v_mfma_f32_16x16x32_bf16 v[108:111], a[92:95], a[124:127], v[108:111]
    s_waitcnt lgkmcnt(6)
    ds_read_b64_tr_b16 a[72:73], v8 offset:0
    v_accvgpr_write_b32 a34, v46
    v_mfma_f32_16x16x32_bf16 v[116:119], a[96:99], a[192:195], v[116:119]
    ds_read_b64_tr_b16 a[74:75], v8 offset:4096
    v_accvgpr_write_b32 a35, v47
    v_mfma_f32_16x16x32_bf16 v[116:119], a[100:103], a[200:203], v[116:119]
    ds_read_b64_tr_b16 a[76:77], v8 offset:16384
    v_mul_f32 v20, s34, v20
    v_mfma_f32_16x16x32_bf16 v[116:119], a[104:107], a[208:211], v[116:119]
    s_waitcnt lgkmcnt(3)
    ds_read_b64_tr_b16 a[78:79], v8 offset:20480
    v_xor_b32 v9, 224, v6
    v_mfma_f32_16x16x32_bf16 v[116:119], a[108:111], a[216:219], v[116:119]
    ds_read_b64_tr_b16 a[80:81], v9 offset:0
    v_mul_f32 v21, s34, v21
    v_mfma_f32_16x16x32_bf16 v[116:119], a[64:67], a[112:115], v[116:119]
    ds_read_b64_tr_b16 a[82:83], v9 offset:4096
    v_mul_f32 v22, s34, v22
    v_mfma_f32_16x16x32_bf16 v[116:119], a[68:71], a[120:123], v[116:119]
    ds_read_b64_tr_b16 a[84:85], v9 offset:16384
    v_mul_f32 v23, s34, v23
    v_mfma_f32_16x16x32_bf16 v[124:127], a[96:99], a[196:199], v[124:127]
    ds_read_b64_tr_b16 a[86:87], v9 offset:20480
    v_xor_b32 v10, 65760, v6
    v_mfma_f32_16x16x32_bf16 v[124:127], a[100:103], a[204:207], v[124:127]
    ds_read_b64_tr_b16 a[88:89], v10 offset:0
    v_mul_f32 v68, s34, v68
    v_mfma_f32_16x16x32_bf16 v[124:127], a[104:107], a[212:215], v[124:127]
    ds_read_b64_tr_b16 a[90:91], v10 offset:4096
    v_mul_f32 v69, s34, v69
    v_mfma_f32_16x16x32_bf16 v[124:127], a[108:111], a[220:223], v[124:127]
    ds_read_b64_tr_b16 a[92:93], v10 offset:16384
    v_mul_f32 v70, s34, v70
    v_mfma_f32_16x16x32_bf16 v[124:127], a[64:67], a[116:119], v[124:127]
    ds_read_b64_tr_b16 a[94:95], v10 offset:20480
    v_xor_b32 v7, 131328, v6
    v_mfma_f32_16x16x32_bf16 v[124:127], a[68:71], a[124:127], v[124:127]
    s_waitcnt lgkmcnt(6)
    ds_read_b64_tr_b16 a[96:97], v7 offset:0
    v_mul_f32 v71, s34, v71
    v_mfma_f32_16x16x32_bf16 v[132:135], a[72:75], a[192:195], v[132:135]
    ds_read_b64_tr_b16 a[98:99], v7 offset:4096
    v_cvt_pk_bf16_f32 v20, v20, v21
    v_mfma_f32_16x16x32_bf16 v[132:135], a[76:79], a[200:203], v[132:135]
    ds_read_b64_tr_b16 a[100:101], v7 offset:16384
    v_cvt_pk_bf16_f32 v21, v22, v23
    v_mfma_f32_16x16x32_bf16 v[132:135], a[80:83], a[208:211], v[132:135]
    s_waitcnt lgkmcnt(3)
    ds_read_b64_tr_b16 a[102:103], v7 offset:20480
    v_xor_b32 v8, 256, v6
    v_mfma_f32_16x16x32_bf16 v[132:135], a[84:87], a[216:219], v[132:135]
    ds_read_b64_tr_b16 a[104:105], v8 offset:0
    v_cvt_pk_bf16_f32 v22, v68, v69
    v_mfma_f32_16x16x32_bf16 v[132:135], a[88:91], a[112:115], v[132:135]
    ds_read_b64_tr_b16 a[106:107], v8 offset:4096
    v_cvt_pk_bf16_f32 v23, v70, v71
    v_mfma_f32_16x16x32_bf16 v[132:135], a[92:95], a[120:123], v[132:135]
    ds_read_b64_tr_b16 a[108:109], v8 offset:16384
    v_accvgpr_write_b32 a4, v20
    v_mfma_f32_16x16x32_bf16 v[140:143], a[72:75], a[196:199], v[140:143]
    ds_read_b64_tr_b16 a[110:111], v8 offset:20480
    v_xor_b32 v9, 65792, v6
    v_mfma_f32_16x16x32_bf16 v[140:143], a[76:79], a[204:207], v[140:143]
    s_waitcnt vmcnt(0)
    ds_read_b64_tr_b16 a[64:65], v9 offset:0
    v_accvgpr_write_b32 a5, v21
    v_mfma_f32_16x16x32_bf16 v[140:143], a[80:83], a[212:215], v[140:143]
    s_barrier
    ds_read_b64_tr_b16 a[66:67], v9 offset:4096
    v_accvgpr_write_b32 a6, v22
    v_mfma_f32_16x16x32_bf16 v[140:143], a[84:87], a[220:223], v[140:143]
    ds_read_b64_tr_b16 a[68:69], v9 offset:16384
    buffer_store_dword v11, off, s[12:15], s92 sc1
    v_mfma_f32_16x16x32_bf16 v[140:143], a[88:91], a[116:119], v[140:143]
    ds_read_b64_tr_b16 a[70:71], v9 offset:20480
    v_xor_b32 v10, 131360, v6
    v_mfma_f32_16x16x32_bf16 v[140:143], a[92:95], a[124:127], v[140:143]
    s_waitcnt lgkmcnt(6)
    ds_read_b64_tr_b16 a[72:73], v10 offset:0
    v_accvgpr_write_b32 a7, v23
    v_mfma_f32_16x16x32_bf16 v[148:151], a[96:99], a[192:195], v[148:151]
    ds_read_b64_tr_b16 a[74:75], v10 offset:4096
    v_mul_f32 v36, s34, v36
    v_mfma_f32_16x16x32_bf16 v[148:151], a[100:103], a[200:203], v[148:151]
    ds_read_b64_tr_b16 a[76:77], v10 offset:16384
    v_mul_f32 v37, s34, v37
    v_mfma_f32_16x16x32_bf16 v[148:151], a[104:107], a[208:211], v[148:151]
    s_waitcnt lgkmcnt(3)
    ds_read_b64_tr_b16 a[78:79], v10 offset:20480
    v_xor_b32 v7, 288, v6
    v_mfma_f32_16x16x32_bf16 v[148:151], a[108:111], a[216:219], v[148:151]
    ds_read_b64_tr_b16 a[80:81], v7 offset:0
    v_mul_f32 v38, s34, v38
    v_mfma_f32_16x16x32_bf16 v[148:151], a[64:67], a[112:115], v[148:151]
    ds_read_b64_tr_b16 a[82:83], v7 offset:4096
    v_mul_f32 v39, s34, v39
    v_mfma_f32_16x16x32_bf16 v[148:151], a[68:71], a[120:123], v[148:151]
    ds_read_b64_tr_b16 a[84:85], v7 offset:16384
    v_mul_f32 v76, s34, v76
    v_mfma_f32_16x16x32_bf16 v[156:159], a[96:99], a[196:199], v[156:159]
    ds_read_b64_tr_b16 a[86:87], v7 offset:20480
    v_xor_b32 v8, 65824, v6
    v_mfma_f32_16x16x32_bf16 v[156:159], a[100:103], a[204:207], v[156:159]
    ds_read_b64_tr_b16 a[88:89], v8 offset:0
    v_mul_f32 v77, s34, v77
    v_mfma_f32_16x16x32_bf16 v[156:159], a[104:107], a[212:215], v[156:159]
    ds_read_b64_tr_b16 a[90:91], v8 offset:4096
    v_mul_f32 v78, s34, v78
    v_mfma_f32_16x16x32_bf16 v[156:159], a[108:111], a[220:223], v[156:159]
    ds_read_b64_tr_b16 a[92:93], v8 offset:16384
    v_mul_f32 v79, s34, v79
    v_mfma_f32_16x16x32_bf16 v[156:159], a[64:67], a[116:119], v[156:159]
    ds_read_b64_tr_b16 a[94:95], v8 offset:20480
    v_xor_b32 v9, 131392, v6
    v_mfma_f32_16x16x32_bf16 v[156:159], a[68:71], a[124:127], v[156:159]
    s_waitcnt lgkmcnt(6)
    ds_read_b64_tr_b16 a[96:97], v9 offset:0
    v_cvt_pk_bf16_f32 v36, v36, v37
    v_mfma_f32_16x16x32_bf16 v[164:167], a[72:75], a[192:195], v[164:167]
    ds_read_b64_tr_b16 a[98:99], v9 offset:4096
    v_cvt_pk_bf16_f32 v37, v38, v39
    v_mfma_f32_16x16x32_bf16 v[164:167], a[76:79], a[200:203], v[164:167]
    ds_read_b64_tr_b16 a[100:101], v9 offset:16384
    v_cvt_pk_bf16_f32 v38, v76, v77
    v_mfma_f32_16x16x32_bf16 v[164:167], a[80:83], a[208:211], v[164:167]
    s_waitcnt lgkmcnt(3)
    ds_read_b64_tr_b16 a[102:103], v9 offset:20480
    v_xor_b32 v10, 320, v6
    v_mfma_f32_16x16x32_bf16 v[164:167], a[84:87], a[216:219], v[164:167]
    ds_read_b64_tr_b16 a[104:105], v10 offset:0
    v_cvt_pk_bf16_f32 v39, v78, v79
    v_mfma_f32_16x16x32_bf16 v[164:167], a[88:91], a[112:115], v[164:167]
    ds_read_b64_tr_b16 a[106:107], v10 offset:4096
    v_accvgpr_write_b32 a36, v36
    v_mfma_f32_16x16x32_bf16 v[164:167], a[92:95], a[120:123], v[164:167]
    ds_read_b64_tr_b16 a[108:109], v10 offset:16384
    v_accvgpr_write_b32 a37, v37
    v_mfma_f32_16x16x32_bf16 v[172:175], a[72:75], a[196:199], v[172:175]
    ds_read_b64_tr_b16 a[110:111], v10 offset:20480
    v_xor_b32 v7, 65856, v6
    v_mfma_f32_16x16x32_bf16 v[172:175], a[76:79], a[204:207], v[172:175]
    ds_read_b64_tr_b16 a[64:65], v7 offset:0
    v_accvgpr_write_b32 a38, v38
    v_mfma_f32_16x16x32_bf16 v[172:175], a[80:83], a[212:215], v[172:175]
    ds_read_b64_tr_b16 a[66:67], v7 offset:4096
    v_accvgpr_write_b32 a39, v39
    v_mfma_f32_16x16x32_bf16 v[172:175], a[84:87], a[220:223], v[172:175]
    ds_read_b64_tr_b16 a[68:69], v7 offset:16384
    v_mul_f32 v84, s34, v84
    v_mfma_f32_16x16x32_bf16 v[172:175], a[88:91], a[116:119], v[172:175]
    ds_read_b64_tr_b16 a[70:71], v7 offset:20480
    v_xor_b32 v8, 131424, v6
    v_mfma_f32_16x16x32_bf16 v[172:175], a[92:95], a[124:127], v[172:175]
    s_waitcnt lgkmcnt(6)
    ds_read_b64_tr_b16 a[72:73], v8 offset:0
    v_mul_f32 v85, s34, v85
    v_mfma_f32_16x16x32_bf16 v[180:183], a[96:99], a[192:195], v[180:183]
    ds_read_b64_tr_b16 a[74:75], v8 offset:4096
    v_mul_f32 v86, s34, v86
    v_mfma_f32_16x16x32_bf16 v[180:183], a[100:103], a[200:203], v[180:183]
    ds_read_b64_tr_b16 a[76:77], v8 offset:16384
    v_mul_f32 v87, s34, v87
    v_mfma_f32_16x16x32_bf16 v[180:183], a[104:107], a[208:211], v[180:183]
    s_waitcnt lgkmcnt(3)
    ds_read_b64_tr_b16 a[78:79], v8 offset:20480
    v_xor_b32 v9, 352, v6
    v_mfma_f32_16x16x32_bf16 v[180:183], a[108:111], a[216:219], v[180:183]
    ds_read_b64_tr_b16 a[80:81], v9 offset:0
    v_mul_f32 v100, s34, v100
    v_mfma_f32_16x16x32_bf16 v[180:183], a[64:67], a[112:115], v[180:183]
    ds_read_b64_tr_b16 a[82:83], v9 offset:4096
    v_mul_f32 v101, s34, v101
    v_mfma_f32_16x16x32_bf16 v[180:183], a[68:71], a[120:123], v[180:183]
    ds_read_b64_tr_b16 a[84:85], v9 offset:16384
    v_mul_f32 v102, s34, v102
    v_mfma_f32_16x16x32_bf16 v[188:191], a[96:99], a[196:199], v[188:191]
    ds_read_b64_tr_b16 a[86:87], v9 offset:20480
    v_xor_b32 v10, 65888, v6
    v_mfma_f32_16x16x32_bf16 v[188:191], a[100:103], a[204:207], v[188:191]
    ds_read_b64_tr_b16 a[88:89], v10 offset:0
    v_mul_f32 v103, s34, v103
    v_mfma_f32_16x16x32_bf16 v[188:191], a[104:107], a[212:215], v[188:191]
    ds_read_b64_tr_b16 a[90:91], v10 offset:4096
    v_cvt_pk_bf16_f32 v84, v84, v85
    v_mfma_f32_16x16x32_bf16 v[188:191], a[108:111], a[220:223], v[188:191]
    ds_read_b64_tr_b16 a[92:93], v10 offset:16384
    v_cvt_pk_bf16_f32 v85, v86, v87
    v_mfma_f32_16x16x32_bf16 v[188:191], a[64:67], a[116:119], v[188:191]
    ds_read_b64_tr_b16 a[94:95], v10 offset:20480
    v_xor_b32 v7, 131456, v6
    v_mfma_f32_16x16x32_bf16 v[188:191], a[68:71], a[124:127], v[188:191]
    s_waitcnt lgkmcnt(6)
    ds_read_b64_tr_b16 a[96:97], v7 offset:0
    v_cvt_pk_bf16_f32 v86, v100, v101
    v_mfma_f32_16x16x32_bf16 v[196:199], a[72:75], a[192:195], v[196:199]
    ds_read_b64_tr_b16 a[98:99], v7 offset:4096
    v_cvt_pk_bf16_f32 v87, v102, v103
    v_mfma_f32_16x16x32_bf16 v[196:199], a[76:79], a[200:203], v[196:199]
    ds_read_b64_tr_b16 a[100:101], v7 offset:16384
    v_accvgpr_write_b32 a8, v84
    v_mfma_f32_16x16x32_bf16 v[196:199], a[80:83], a[208:211], v[196:199]
    s_waitcnt lgkmcnt(3)
    ds_read_b64_tr_b16 a[102:103], v7 offset:20480
    v_xor_b32 v8, 384, v6
    v_mfma_f32_16x16x32_bf16 v[196:199], a[84:87], a[216:219], v[196:199]
    ds_read_b64_tr_b16 a[104:105], v8 offset:0
    v_accvgpr_write_b32 a9, v85
    v_mfma_f32_16x16x32_bf16 v[196:199], a[88:91], a[112:115], v[196:199]
    ds_read_b64_tr_b16 a[106:107], v8 offset:4096
    v_accvgpr_write_b32 a10, v86
    v_mfma_f32_16x16x32_bf16 v[196:199], a[92:95], a[120:123], v[196:199]
    ds_read_b64_tr_b16 a[108:109], v8 offset:16384
    v_accvgpr_write_b32 a11, v87
    v_mfma_f32_16x16x32_bf16 v[204:207], a[72:75], a[196:199], v[204:207]
    ds_read_b64_tr_b16 a[110:111], v8 offset:20480
    v_xor_b32 v9, 65920, v6
    v_mfma_f32_16x16x32_bf16 v[204:207], a[76:79], a[204:207], v[204:207]
    ds_read_b64_tr_b16 a[64:65], v9 offset:0
    v_mul_f32 v92, s34, v92
    v_mfma_f32_16x16x32_bf16 v[204:207], a[80:83], a[212:215], v[204:207]
    ds_read_b64_tr_b16 a[66:67], v9 offset:4096
    v_mul_f32 v93, s34, v93
    v_mfma_f32_16x16x32_bf16 v[204:207], a[84:87], a[220:223], v[204:207]
    ds_read_b64_tr_b16 a[68:69], v9 offset:16384
    v_mul_f32 v94, s34, v94
    v_mfma_f32_16x16x32_bf16 v[204:207], a[88:91], a[116:119], v[204:207]
    ds_read_b64_tr_b16 a[70:71], v9 offset:20480
    v_xor_b32 v10, 131488, v6
    v_mfma_f32_16x16x32_bf16 v[204:207], a[92:95], a[124:127], v[204:207]
    s_waitcnt lgkmcnt(6)
    ds_read_b64_tr_b16 a[72:73], v10 offset:0
    v_mul_f32 v95, s34, v95
    v_mfma_f32_16x16x32_bf16 v[212:215], a[96:99], a[192:195], v[212:215]
    ds_read_b64_tr_b16 a[74:75], v10 offset:4096
    v_mul_f32 v108, s34, v108
    v_mfma_f32_16x16x32_bf16 v[212:215], a[100:103], a[200:203], v[212:215]
    ds_read_b64_tr_b16 a[76:77], v10 offset:16384
    v_mul_f32 v109, s34, v109
    v_mfma_f32_16x16x32_bf16 v[212:215], a[104:107], a[208:211], v[212:215]
    s_waitcnt lgkmcnt(3)
    ds_read_b64_tr_b16 a[78:79], v10 offset:20480
    v_xor_b32 v7, 416, v6
    v_mfma_f32_16x16x32_bf16 v[212:215], a[108:111], a[216:219], v[212:215]
    ds_read_b64_tr_b16 a[80:81], v7 offset:0
    v_mul_f32 v110, s34, v110
    v_mfma_f32_16x16x32_bf16 v[212:215], a[64:67], a[112:115], v[212:215]
    ds_read_b64_tr_b16 a[82:83], v7 offset:4096
    v_mul_f32 v111, s34, v111
    v_mfma_f32_16x16x32_bf16 v[212:215], a[68:71], a[120:123], v[212:215]
    ds_read_b64_tr_b16 a[84:85], v7 offset:16384
    v_cvt_pk_bf16_f32 v92, v92, v93
    v_mfma_f32_16x16x32_bf16 v[220:223], a[96:99], a[196:199], v[220:223]
    ds_read_b64_tr_b16 a[86:87], v7 offset:20480
    v_xor_b32 v8, 65952, v6
    v_mfma_f32_16x16x32_bf16 v[220:223], a[100:103], a[204:207], v[220:223]
    ds_read_b64_tr_b16 a[88:89], v8 offset:0
    v_cvt_pk_bf16_f32 v93, v94, v95
    v_mfma_f32_16x16x32_bf16 v[220:223], a[104:107], a[212:215], v[220:223]
    ds_read_b64_tr_b16 a[90:91], v8 offset:4096
    v_cvt_pk_bf16_f32 v94, v108, v109
    v_mfma_f32_16x16x32_bf16 v[220:223], a[108:111], a[220:223], v[220:223]
    ds_read_b64_tr_b16 a[92:93], v8 offset:16384
    v_cvt_pk_bf16_f32 v95, v110, v111
    v_mfma_f32_16x16x32_bf16 v[220:223], a[64:67], a[116:119], v[220:223]
    ds_read_b64_tr_b16 a[94:95], v8 offset:20480
    v_xor_b32 v9, 131520, v6
    v_mfma_f32_16x16x32_bf16 v[220:223], a[68:71], a[124:127], v[220:223]
    s_waitcnt lgkmcnt(6)
    ds_read_b64_tr_b16 a[96:97], v9 offset:0
    v_accvgpr_write_b32 a40, v92
    v_mfma_f32_16x16x32_bf16 v[228:231], a[72:75], a[192:195], v[228:231]
    ds_read_b64_tr_b16 a[98:99], v9 offset:4096
    v_accvgpr_write_b32 a41, v93
    v_mfma_f32_16x16x32_bf16 v[228:231], a[76:79], a[200:203], v[228:231]
    ds_read_b64_tr_b16 a[100:101], v9 offset:16384
    v_accvgpr_write_b32 a42, v94
    v_mfma_f32_16x16x32_bf16 v[228:231], a[80:83], a[208:211], v[228:231]
    s_waitcnt lgkmcnt(3)
    ds_read_b64_tr_b16 a[102:103], v9 offset:20480
    v_xor_b32 v10, 448, v6
    v_mfma_f32_16x16x32_bf16 v[228:231], a[84:87], a[216:219], v[228:231]
    ds_read_b64_tr_b16 a[104:105], v10 offset:0
    v_accvgpr_write_b32 a43, v95
    v_mfma_f32_16x16x32_bf16 v[228:231], a[88:91], a[112:115], v[228:231]
    ds_read_b64_tr_b16 a[106:107], v10 offset:4096
    v_mul_f32 v116, s34, v116
    v_mfma_f32_16x16x32_bf16 v[228:231], a[92:95], a[120:123], v[228:231]
    ds_read_b64_tr_b16 a[108:109], v10 offset:16384
    v_mul_f32 v117, s34, v117
    v_mfma_f32_16x16x32_bf16 v[236:239], a[72:75], a[196:199], v[236:239]
    ds_read_b64_tr_b16 a[110:111], v10 offset:20480
    v_xor_b32 v7, 65984, v6
    v_mfma_f32_16x16x32_bf16 v[236:239], a[76:79], a[204:207], v[236:239]
    ds_read_b64_tr_b16 a[64:65], v7 offset:0
    v_mul_f32 v118, s34, v118
    v_mfma_f32_16x16x32_bf16 v[236:239], a[80:83], a[212:215], v[236:239]
    ds_read_b64_tr_b16 a[66:67], v7 offset:4096
    v_mul_f32 v119, s34, v119
    v_mfma_f32_16x16x32_bf16 v[236:239], a[84:87], a[220:223], v[236:239]
    ds_read_b64_tr_b16 a[68:69], v7 offset:16384
    v_mul_f32 v132, s34, v132
    v_mfma_f32_16x16x32_bf16 v[236:239], a[88:91], a[116:119], v[236:239]
    ds_read_b64_tr_b16 a[70:71], v7 offset:20480
    v_xor_b32 v8, 131552, v6
    v_mfma_f32_16x16x32_bf16 v[236:239], a[92:95], a[124:127], v[236:239]
    s_waitcnt lgkmcnt(6)
    ds_read_b64_tr_b16 a[72:73], v8 offset:0
    v_mul_f32 v133, s34, v133
    v_mfma_f32_16x16x32_bf16 v[244:247], a[96:99], a[192:195], v[244:247]
    ds_read_b64_tr_b16 a[74:75], v8 offset:4096
    v_mul_f32 v134, s34, v134
    v_mfma_f32_16x16x32_bf16 v[244:247], a[100:103], a[200:203], v[244:247]
    ds_read_b64_tr_b16 a[76:77], v8 offset:16384
    v_mul_f32 v135, s34, v135
    v_mfma_f32_16x16x32_bf16 v[244:247], a[104:107], a[208:211], v[244:247]
    s_waitcnt lgkmcnt(3)
    ds_read_b64_tr_b16 a[78:79], v8 offset:20480
    v_xor_b32 v9, 480, v6
    v_mfma_f32_16x16x32_bf16 v[244:247], a[108:111], a[216:219], v[244:247]
    ds_read_b64_tr_b16 a[80:81], v9 offset:0
    v_cvt_pk_bf16_f32 v116, v116, v117
    v_mfma_f32_16x16x32_bf16 v[244:247], a[64:67], a[112:115], v[244:247]
    ds_read_b64_tr_b16 a[82:83], v9 offset:4096
    v_cvt_pk_bf16_f32 v117, v118, v119
    v_mfma_f32_16x16x32_bf16 v[244:247], a[68:71], a[120:123], v[244:247]
    ds_read_b64_tr_b16 a[84:85], v9 offset:16384
    v_cvt_pk_bf16_f32 v118, v132, v133
    v_mfma_f32_16x16x32_bf16 v[252:255], a[96:99], a[196:199], v[252:255]
    ds_read_b64_tr_b16 a[86:87], v9 offset:20480
    v_xor_b32 v10, 66016, v6
    v_mfma_f32_16x16x32_bf16 v[252:255], a[100:103], a[204:207], v[252:255]
    ds_read_b64_tr_b16 a[88:89], v10 offset:0
    v_cvt_pk_bf16_f32 v119, v134, v135
    v_mfma_f32_16x16x32_bf16 v[252:255], a[104:107], a[212:215], v[252:255]
    ds_read_b64_tr_b16 a[90:91], v10 offset:4096
    v_accvgpr_write_b32 a12, v116
    v_mfma_f32_16x16x32_bf16 v[252:255], a[108:111], a[220:223], v[252:255]
    ds_read_b64_tr_b16 a[92:93], v10 offset:16384
    v_accvgpr_write_b32 a13, v117
    v_mfma_f32_16x16x32_bf16 v[252:255], a[64:67], a[116:119], v[252:255]
    ds_read_b64_tr_b16 a[94:95], v10 offset:20480
    v_accvgpr_write_b32 a14, v118
    v_mfma_f32_16x16x32_bf16 v[252:255], a[68:71], a[124:127], v[252:255]
    s_waitcnt lgkmcnt(6)
    v_accvgpr_write_b32 a15, v119
    v_mfma_f32_16x16x32_bf16 v[16:19], a[72:75], a[192:195], v[16:19]
    v_mfma_f32_16x16x32_bf16 v[16:19], a[76:79], a[200:203], v[16:19]
    v_mfma_f32_16x16x32_bf16 v[16:19], a[80:83], a[208:211], v[16:19]
    s_waitcnt lgkmcnt(0)
    v_mfma_f32_16x16x32_bf16 v[16:19], a[84:87], a[216:219], v[16:19]
    v_mfma_f32_16x16x32_bf16 v[16:19], a[88:91], a[112:115], v[16:19]
    v_mfma_f32_16x16x32_bf16 v[16:19], a[92:95], a[120:123], v[16:19]
    v_mfma_f32_16x16x32_bf16 v[24:27], a[72:75], a[196:199], v[24:27]
    v_mfma_f32_16x16x32_bf16 v[24:27], a[76:79], a[204:207], v[24:27]
    v_mfma_f32_16x16x32_bf16 v[24:27], a[80:83], a[212:215], v[24:27]
    v_mfma_f32_16x16x32_bf16 v[24:27], a[84:87], a[220:223], v[24:27]
    s_waitcnt lgkmcnt(0)
    v_mfma_f32_16x16x32_bf16 v[24:27], a[88:91], a[116:119], v[24:27]
    s_barrier
    v_mfma_f32_16x16x32_bf16 v[24:27], a[92:95], a[124:127], v[24:27]
    s_nop 3
    v_pk_mul_f32 v[124:125], v[124:125], s[34:35]
    v_pk_mul_f32 v[126:127], v[126:127], s[34:35]
    v_pk_mul_f32 v[140:141], v[140:141], s[34:35]
    v_pk_mul_f32 v[142:143], v[142:143], s[34:35]
    v_cvt_pk_bf16_f32 v124, v124, v125
    v_cvt_pk_bf16_f32 v125, v126, v127
    v_cvt_pk_bf16_f32 v126, v140, v141
    v_cvt_pk_bf16_f32 v127, v142, v143
    v_accvgpr_write_b32 a44, v124
    v_accvgpr_write_b32 a45, v125
    v_accvgpr_write_b32 a46, v126
    v_accvgpr_write_b32 a47, v127
    v_pk_mul_f32 v[148:149], v[148:149], s[34:35]
    v_pk_mul_f32 v[150:151], v[150:151], s[34:35]
    v_pk_mul_f32 v[164:165], v[164:165], s[34:35]
    v_pk_mul_f32 v[166:167], v[166:167], s[34:35]
    v_cvt_pk_bf16_f32 v148, v148, v149
    v_cvt_pk_bf16_f32 v149, v150, v151
    v_cvt_pk_bf16_f32 v150, v164, v165
    v_cvt_pk_bf16_f32 v151, v166, v167
    v_accvgpr_write_b32 a16, v148
    v_accvgpr_write_b32 a17, v149
    v_accvgpr_write_b32 a18, v150
    v_accvgpr_write_b32 a19, v151
    v_pk_mul_f32 v[156:157], v[156:157], s[34:35]
    v_pk_mul_f32 v[158:159], v[158:159], s[34:35]
    v_pk_mul_f32 v[172:173], v[172:173], s[34:35]
    v_pk_mul_f32 v[174:175], v[174:175], s[34:35]
    v_cvt_pk_bf16_f32 v156, v156, v157
    v_cvt_pk_bf16_f32 v157, v158, v159
    v_cvt_pk_bf16_f32 v158, v172, v173
    v_cvt_pk_bf16_f32 v159, v174, v175
    v_accvgpr_write_b32 a48, v156
    v_accvgpr_write_b32 a49, v157
    v_accvgpr_write_b32 a50, v158
    v_accvgpr_write_b32 a51, v159
    v_pk_mul_f32 v[180:181], v[180:181], s[34:35]
    v_pk_mul_f32 v[182:183], v[182:183], s[34:35]
    v_pk_mul_f32 v[196:197], v[196:197], s[34:35]
    v_pk_mul_f32 v[198:199], v[198:199], s[34:35]
    v_cvt_pk_bf16_f32 v180, v180, v181
    v_cvt_pk_bf16_f32 v181, v182, v183
    v_cvt_pk_bf16_f32 v182, v196, v197
    v_cvt_pk_bf16_f32 v183, v198, v199
    v_accvgpr_write_b32 a20, v180
    v_accvgpr_write_b32 a21, v181
    v_accvgpr_write_b32 a22, v182
    v_accvgpr_write_b32 a23, v183
    v_pk_mul_f32 v[188:189], v[188:189], s[34:35]
    v_pk_mul_f32 v[190:191], v[190:191], s[34:35]
    v_pk_mul_f32 v[204:205], v[204:205], s[34:35]
    v_pk_mul_f32 v[206:207], v[206:207], s[34:35]
    v_cvt_pk_bf16_f32 v188, v188, v189
    v_cvt_pk_bf16_f32 v189, v190, v191
    v_cvt_pk_bf16_f32 v190, v204, v205
    v_cvt_pk_bf16_f32 v191, v206, v207
    v_accvgpr_write_b32 a52, v188
    v_accvgpr_write_b32 a53, v189
    v_accvgpr_write_b32 a54, v190
    v_accvgpr_write_b32 a55, v191
    v_pk_mul_f32 v[212:213], v[212:213], s[34:35]
    v_pk_mul_f32 v[214:215], v[214:215], s[34:35]
    v_pk_mul_f32 v[228:229], v[228:229], s[34:35]
    v_pk_mul_f32 v[230:231], v[230:231], s[34:35]
    v_cvt_pk_bf16_f32 v212, v212, v213
    v_cvt_pk_bf16_f32 v213, v214, v215
    v_cvt_pk_bf16_f32 v214, v228, v229
    v_cvt_pk_bf16_f32 v215, v230, v231
    v_accvgpr_write_b32 a24, v212
    v_accvgpr_write_b32 a25, v213
    v_accvgpr_write_b32 a26, v214
    v_accvgpr_write_b32 a27, v215
    v_pk_mul_f32 v[220:221], v[220:221], s[34:35]
    v_pk_mul_f32 v[222:223], v[222:223], s[34:35]
    v_pk_mul_f32 v[236:237], v[236:237], s[34:35]
    v_pk_mul_f32 v[238:239], v[238:239], s[34:35]
    v_cvt_pk_bf16_f32 v220, v220, v221
    v_cvt_pk_bf16_f32 v221, v222, v223
    v_cvt_pk_bf16_f32 v222, v236, v237
    v_cvt_pk_bf16_f32 v223, v238, v239
    v_accvgpr_write_b32 a56, v220
    v_accvgpr_write_b32 a57, v221
    v_accvgpr_write_b32 a58, v222
    v_accvgpr_write_b32 a59, v223
    v_pk_mul_f32 v[244:245], v[244:245], s[34:35]
    v_pk_mul_f32 v[246:247], v[246:247], s[34:35]
    v_pk_mul_f32 v[16:17], v[16:17], s[34:35]
    v_pk_mul_f32 v[18:19], v[18:19], s[34:35]
    v_cvt_pk_bf16_f32 v244, v244, v245
    v_cvt_pk_bf16_f32 v245, v246, v247
    v_cvt_pk_bf16_f32 v246, v16, v17
    v_cvt_pk_bf16_f32 v247, v18, v19
    v_accvgpr_write_b32 a28, v244
    v_accvgpr_write_b32 a29, v245
    v_accvgpr_write_b32 a30, v246
    v_accvgpr_write_b32 a31, v247
    v_pk_mul_f32 v[252:253], v[252:253], s[34:35]
    v_pk_mul_f32 v[254:255], v[254:255], s[34:35]
    v_pk_mul_f32 v[24:25], v[24:25], s[34:35]
    v_pk_mul_f32 v[26:27], v[26:27], s[34:35]
    v_cvt_pk_bf16_f32 v252, v252, v253
    v_cvt_pk_bf16_f32 v253, v254, v255
    v_cvt_pk_bf16_f32 v254, v24, v25
    v_cvt_pk_bf16_f32 v255, v26, v27
    v_accvgpr_write_b32 a60, v252
    v_accvgpr_write_b32 a61, v253
    v_accvgpr_write_b32 a62, v254
    v_accvgpr_write_b32 a63, v255
    s_branch L_kvdone
L_kloop_side:
    s_mov_b64 exec, 1
    global_atomic_add v3, v15, s[90:91] offset:128 sc1
    s_mov_b64 exec, -1
    s_branch L_kloop_back
L_vloop_side:
    s_mov_b64 exec, 1
    global_atomic_add v3, v15, s[90:91] offset:128 sc1
    s_mov_b64 exec, -1
    s_branch L_vloop_back
.p2align 6
L_vloop:
    v_mfma_f32_16x16x32_bf16 v[64:67], a[64:67], a[0:3], v[64:67]
    ds_read_b64_tr_b16 a[24:25], v9 offset:0
    v_mfma_f32_16x16x32_bf16 v[64:67], a[68:71], a[4:7], v[64:67]
    ds_read_b64_tr_b16 a[26:27], v9 offset:4096
    v_mfma_f32_16x16x32_bf16 v[68:71], a[76:79], a[4:7], v[68:71]
    ds_read_b64_tr_b16 a[28:29], v9 offset:16384
    v_mfma_f32_16x16x32_bf16 v[68:71], a[72:75], a[0:3], v[68:71]
    ds_read_b64_tr_b16 a[30:31], v9 offset:20480
    v_mfma_f32_16x16x32_bf16 v[72:75], a[80:83], a[0:3], v[72:75]
    ds_read_b128 a[96:99], v4 offset:8192
    v_mfma_f32_16x16x32_bf16 v[72:75], a[84:87], a[4:7], v[72:75]
    s_cmp_eq_u32 s61, s55
    s_cbranch_scc1 L_vloop_side
L_vloop_back:
    v_mfma_f32_16x16x32_bf16 v[76:79], a[92:95], a[4:7], v[76:79]
    s_waitcnt lgkmcnt(8)
    ds_read_b128 a[100:103], v5 offset:8192
    v_mfma_f32_16x16x32_bf16 v[76:79], a[88:91], a[0:3], v[76:79]
    v_mfma_f32_16x16x32_bf16 v[84:87], a[88:91], a[8:11], v[84:87]
    ds_read_b128 a[108:111], v5 offset:10240
    v_mfma_f32_16x16x32_bf16 v[84:87], a[92:95], a[12:15], v[84:87]
    v_mfma_f32_16x16x32_bf16 v[80:83], a[84:87], a[12:15], v[80:83]
    ds_read_b128 a[104:107], v4 offset:10240
    v_mfma_f32_16x16x32_bf16 v[80:83], a[80:83], a[8:11], v[80:83]
    v_mfma_f32_16x16x32_bf16 v[92:95], a[72:75], a[8:11], v[92:95]
    ds_read_b128 a[112:115], v4 offset:12288
    v_mfma_f32_16x16x32_bf16 v[92:95], a[76:79], a[12:15], v[92:95]
    v_mfma_f32_16x16x32_bf16 v[88:91], a[68:71], a[12:15], v[88:91]
    ds_read_b128 a[116:119], v5 offset:12288
    v_mfma_f32_16x16x32_bf16 v[88:91], a[64:67], a[8:11], v[88:91]
    s_waitcnt lgkmcnt(8)
    v_mfma_f32_16x16x32_bf16 v[96:99], a[64:67], a[16:19], v[96:99]
    ds_read_b128 a[124:127], v5 offset:14336
    v_mfma_f32_16x16x32_bf16 v[96:99], a[68:71], a[20:23], v[96:99]
    v_mfma_f32_16x16x32_bf16 v[100:103], a[76:79], a[20:23], v[100:103]
    ds_read_b128 a[120:123], v4 offset:14336
    v_mfma_f32_16x16x32_bf16 v[100:103], a[72:75], a[16:19], v[100:103]
    v_mfma_f32_16x16x32_bf16 v[104:107], a[80:83], a[16:19], v[104:107]
    ds_read_b64_tr_b16 a[32:33], v10 offset:0
    v_mfma_f32_16x16x32_bf16 v[104:107], a[84:87], a[20:23], v[104:107]
    ds_read_b64_tr_b16 a[34:35], v10 offset:4096
    v_mfma_f32_16x16x32_bf16 v[108:111], a[92:95], a[20:23], v[108:111]
    ds_read_b64_tr_b16 a[36:37], v10 offset:16384
    v_mfma_f32_16x16x32_bf16 v[108:111], a[88:91], a[16:19], v[108:111]
    ds_read_b64_tr_b16 a[38:39], v10 offset:20480
    v_mfma_f32_16x16x32_bf16 v[116:119], a[88:91], a[24:27], v[116:119]
    s_waitcnt lgkmcnt(8)
    ds_read_b64_tr_b16 a[40:41], v11 offset:0
    v_mfma_f32_16x16x32_bf16 v[116:119], a[92:95], a[28:31], v[116:119]
    ds_read_b64_tr_b16 a[42:43], v11 offset:4096
    v_mfma_f32_16x16x32_bf16 v[112:115], a[84:87], a[28:31], v[112:115]
    ds_read_b64_tr_b16 a[44:45], v11 offset:16384
    v_mfma_f32_16x16x32_bf16 v[112:115], a[80:83], a[24:27], v[112:115]
    ds_read_b64_tr_b16 a[46:47], v11 offset:20480
    v_mfma_f32_16x16x32_bf16 v[124:127], a[72:75], a[24:27], v[124:127]
    ds_read_b64_tr_b16 a[48:49], v12 offset:0
    v_mfma_f32_16x16x32_bf16 v[124:127], a[76:79], a[28:31], v[124:127]
    ds_read_b64_tr_b16 a[50:51], v12 offset:4096
    v_mfma_f32_16x16x32_bf16 v[120:123], a[68:71], a[28:31], v[120:123]
    ds_read_b64_tr_b16 a[52:53], v12 offset:16384
    v_mfma_f32_16x16x32_bf16 v[120:123], a[64:67], a[24:27], v[120:123]
    ds_read_b64_tr_b16 a[54:55], v12 offset:20480
    v_mfma_f32_16x16x32_bf16 v[16:19], a[96:99], a[0:3], v[16:19]
    ds_read_b64_tr_b16 a[56:57], v13 offset:0
    v_mfma_f32_16x16x32_bf16 v[16:19], a[100:103], a[4:7], v[16:19]
    ds_read_b64_tr_b16 a[58:59], v13 offset:4096
    v_mfma_f32_16x16x32_bf16 v[20:23], a[108:111], a[4:7], v[20:23]
    ds_read_b64_tr_b16 a[60:61], v13 offset:16384
    v_mfma_f32_16x16x32_bf16 v[20:23], a[104:107], a[0:3], v[20:23]
    s_waitcnt lgkmcnt(8)
    ds_read_b64_tr_b16 a[62:63], v13 offset:20480
    v_mfma_f32_16x16x32_bf16 v[24:27], a[112:115], a[0:3], v[24:27]
    v_mfma_f32_16x16x32_bf16 v[24:27], a[116:119], a[4:7], v[24:27]
    v_mfma_f32_16x16x32_bf16 v[28:31], a[124:127], a[4:7], v[28:31]
    v_mfma_f32_16x16x32_bf16 v[28:31], a[120:123], a[0:3], v[28:31]
    s_waitcnt lgkmcnt(0)
    v_mfma_f32_16x16x32_bf16 a[228:231], a[120:123], a[8:11], a[228:231]
    s_barrier
    v_mfma_f32_16x16x32_bf16 a[228:231], a[124:127], a[12:15], a[228:231]
    s_add_u32 m0, s29, 65536
    v_mfma_f32_16x16x32_bf16 a[224:227], a[116:119], a[12:15], a[224:227]
    buffer_load_dwordx4 v2, s[8:11], 0 offen lds
    v_mfma_f32_16x16x32_bf16 a[224:227], a[112:115], a[8:11], a[224:227]
    v_mfma_f32_16x16x32_bf16 a[236:239], a[104:107], a[8:11], a[236:239]
    v_mfma_f32_16x16x32_bf16 a[236:239], a[108:111], a[12:15], a[236:239]
    v_mfma_f32_16x16x32_bf16 a[232:235], a[100:103], a[12:15], a[232:235]
    s_add_u32 m0, s29, 0
    v_mfma_f32_16x16x32_bf16 a[232:235], a[96:99], a[8:11], a[232:235]
    buffer_load_dwordx4 v1, s[4:7], 0 offen lds
    v_mfma_f32_16x16x32_bf16 v[32:35], a[96:99], a[16:19], v[32:35]
    v_mfma_f32_16x16x32_bf16 v[32:35], a[100:103], a[20:23], v[32:35]
    v_mfma_f32_16x16x32_bf16 v[36:39], a[108:111], a[20:23], v[36:39]
    v_mfma_f32_16x16x32_bf16 v[36:39], a[104:107], a[16:19], v[36:39]
    s_add_u32 m0, s29, 69632
    v_mfma_f32_16x16x32_bf16 v[40:43], a[112:115], a[16:19], v[40:43]
    buffer_load_dwordx4 v2, s[8:11], s48 offen lds
    v_mfma_f32_16x16x32_bf16 v[40:43], a[116:119], a[20:23], v[40:43]
    v_mfma_f32_16x16x32_bf16 v[44:47], a[124:127], a[20:23], v[44:47]
    v_mfma_f32_16x16x32_bf16 v[44:47], a[120:123], a[16:19], v[44:47]
    v_mfma_f32_16x16x32_bf16 v[52:55], a[120:123], a[24:27], v[52:55]
    s_add_u32 m0, s29, 4096
    v_mfma_f32_16x16x32_bf16 v[52:55], a[124:127], a[28:31], v[52:55]
    buffer_load_dwordx4 v1, s[4:7], s41 offen lds
    v_mfma_f32_16x16x32_bf16 v[48:51], a[116:119], a[28:31], v[48:51]
    v_mfma_f32_16x16x32_bf16 v[48:51], a[112:115], a[24:27], v[48:51]
    v_mfma_f32_16x16x32_bf16 v[60:63], a[104:107], a[24:27], v[60:63]
    v_mfma_f32_16x16x32_bf16 v[60:63], a[108:111], a[28:31], v[60:63]
    s_add_u32 m0, s29, 73728
    v_mfma_f32_16x16x32_bf16 v[56:59], a[100:103], a[28:31], v[56:59]
    buffer_load_dwordx4 v2, s[8:11], s49 offen lds
    v_mfma_f32_16x16x32_bf16 v[56:59], a[96:99], a[24:27], v[56:59]
    v_mfma_f32_16x16x32_bf16 v[192:195], a[96:99], a[32:35], v[192:195]
    v_mfma_f32_16x16x32_bf16 v[192:195], a[100:103], a[36:39], v[192:195]
    v_mfma_f32_16x16x32_bf16 v[196:199], a[108:111], a[36:39], v[196:199]
    s_add_u32 m0, s29, 8192
    v_mfma_f32_16x16x32_bf16 v[196:199], a[104:107], a[32:35], v[196:199]
    buffer_load_dwordx4 v1, s[4:7], s42 offen lds
    v_mfma_f32_16x16x32_bf16 v[200:203], a[112:115], a[32:35], v[200:203]
    v_mfma_f32_16x16x32_bf16 v[200:203], a[116:119], a[36:39], v[200:203]
    v_mfma_f32_16x16x32_bf16 v[204:207], a[124:127], a[36:39], v[204:207]
    v_mfma_f32_16x16x32_bf16 v[204:207], a[120:123], a[32:35], v[204:207]
    s_add_u32 m0, s29, 77824
    v_mfma_f32_16x16x32_bf16 v[212:215], a[120:123], a[40:43], v[212:215]
    buffer_load_dwordx4 v2, s[8:11], s50 offen lds
    v_mfma_f32_16x16x32_bf16 v[212:215], a[124:127], a[44:47], v[212:215]
    v_mfma_f32_16x16x32_bf16 v[208:211], a[116:119], a[44:47], v[208:211]
    v_mfma_f32_16x16x32_bf16 v[208:211], a[112:115], a[40:43], v[208:211]
    v_mfma_f32_16x16x32_bf16 v[220:223], a[104:107], a[40:43], v[220:223]
    s_add_u32 m0, s29, 12288
    v_mfma_f32_16x16x32_bf16 v[220:223], a[108:111], a[44:47], v[220:223]
    buffer_load_dwordx4 v1, s[4:7], s43 offen lds
    v_mfma_f32_16x16x32_bf16 v[216:219], a[100:103], a[44:47], v[216:219]
    v_mfma_f32_16x16x32_bf16 v[216:219], a[96:99], a[40:43], v[216:219]
    v_mfma_f32_16x16x32_bf16 v[224:227], a[96:99], a[48:51], v[224:227]
    v_mfma_f32_16x16x32_bf16 v[224:227], a[100:103], a[52:55], v[224:227]
    s_add_u32 m0, s29, 81920
    v_mfma_f32_16x16x32_bf16 v[228:231], a[108:111], a[52:55], v[228:231]
    buffer_load_dwordx4 v2, s[8:11], s51 offen lds
    v_mfma_f32_16x16x32_bf16 v[228:231], a[104:107], a[48:51], v[228:231]
    v_mfma_f32_16x16x32_bf16 v[232:235], a[112:115], a[48:51], v[232:235]
    v_mfma_f32_16x16x32_bf16 v[232:235], a[116:119], a[52:55], v[232:235]
    v_mfma_f32_16x16x32_bf16 v[236:239], a[124:127], a[52:55], v[236:239]
    s_add_u32 m0, s29, 16384
    v_mfma_f32_16x16x32_bf16 v[236:239], a[120:123], a[48:51], v[236:239]
    buffer_load_dwordx4 v1, s[4:7], s44 offen lds
    v_mfma_f32_16x16x32_bf16 v[244:247], a[120:123], a[56:59], v[244:247]
    v_mfma_f32_16x16x32_bf16 v[244:247], a[124:127], a[60:63], v[244:247]
    v_mfma_f32_16x16x32_bf16 v[240:243], a[116:119], a[60:63], v[240:243]
    v_mfma_f32_16x16x32_bf16 v[240:243], a[112:115], a[56:59], v[240:243]
    s_add_u32 m0, s29, 86016
    v_mfma_f32_16x16x32_bf16 v[252:255], a[104:107], a[56:59], v[252:255]
    s_waitcnt vmcnt(11)
    buffer_load_dwordx4 v2, s[8:11], s52 offen lds
    v_mfma_f32_16x16x32_bf16 v[252:255], a[108:111], a[60:63], v[252:255]
    s_barrier
    ds_read_b64_tr_b16 a[0:1], v6 offset:32768
    v_mfma_f32_16x16x32_bf16 v[248:251], a[100:103], a[60:63], v[248:251]
    ds_read_b64_tr_b16 a[2:3], v6 offset:36864
    v_mfma_f32_16x16x32_bf16 v[248:251], a[96:99], a[56:59], v[248:251]
    ds_read_b128 a[96:99], v4 offset:40960
    v_mfma_f32_16x16x32_bf16 v[128:131], a[64:67], a[32:35], v[128:131]
    s_add_u32 m0, s29, 20480
    v_mfma_f32_16x16x32_bf16 v[128:131], a[68:71], a[36:39], v[128:131]
    buffer_load_dwordx4 v1, s[4:7], s45 offen lds
    v_mfma_f32_16x16x32_bf16 v[132:135], a[76:79], a[36:39], v[132:135]
    ds_read_b64_tr_b16 a[4:5], v6 offset:49152
    v_mfma_f32_16x16x32_bf16 v[132:135], a[72:75], a[32:35], v[132:135]
    ds_read_b64_tr_b16 a[6:7], v6 offset:53248
    v_mfma_f32_16x16x32_bf16 v[136:139], a[80:83], a[32:35], v[136:139]
    ds_read_b128 a[100:103], v5 offset:40960
    v_mfma_f32_16x16x32_bf16 v[136:139], a[84:87], a[36:39], v[136:139]
    s_add_u32 m0, s29, 90112
    v_mfma_f32_16x16x32_bf16 v[140:143], a[92:95], a[36:39], v[140:143]
    buffer_load_dwordx4 v2, s[8:11], s53 offen lds
    v_mfma_f32_16x16x32_bf16 v[140:143], a[88:91], a[32:35], v[140:143]
    ds_read_b128 a[108:111], v5 offset:43008
    v_mfma_f32_16x16x32_bf16 v[148:151], a[88:91], a[40:43], v[148:151]
    v_mfma_f32_16x16x32_bf16 v[148:151], a[92:95], a[44:47], v[148:151]
    ds_read_b128 a[104:107], v4 offset:43008
    v_mfma_f32_16x16x32_bf16 v[144:147], a[84:87], a[44:47], v[144:147]
    s_add_u32 m0, s29, 24576
    v_mfma_f32_16x16x32_bf16 v[144:147], a[80:83], a[40:43], v[144:147]
    buffer_load_dwordx4 v1, s[4:7], s46 offen lds
    v_mfma_f32_16x16x32_bf16 v[156:159], a[72:75], a[40:43], v[156:159]
    ds_read_b128 a[112:115], v4 offset:45056
    v_mfma_f32_16x16x32_bf16 v[156:159], a[76:79], a[44:47], v[156:159]
    v_mfma_f32_16x16x32_bf16 v[152:155], a[68:71], a[44:47], v[152:155]
    ds_read_b128 a[116:119], v5 offset:45056
    v_mfma_f32_16x16x32_bf16 v[152:155], a[64:67], a[40:43], v[152:155]
    s_add_u32 m0, s29, 94208
    v_mfma_f32_16x16x32_bf16 v[160:163], a[64:67], a[48:51], v[160:163]
    buffer_load_dwordx4 v2, s[8:11], s54 offen lds
    v_mfma_f32_16x16x32_bf16 v[160:163], a[68:71], a[52:55], v[160:163]
    ds_read_b128 a[124:127], v5 offset:47104
    v_mfma_f32_16x16x32_bf16 v[164:167], a[76:79], a[52:55], v[164:167]
    v_mfma_f32_16x16x32_bf16 v[164:167], a[72:75], a[48:51], v[164:167]
    ds_read_b128 a[120:123], v4 offset:47104
    v_mfma_f32_16x16x32_bf16 v[168:171], a[80:83], a[48:51], v[168:171]
    s_add_u32 m0, s29, 28672
    v_mfma_f32_16x16x32_bf16 v[168:171], a[84:87], a[52:55], v[168:171]
    buffer_load_dwordx4 v1, s[4:7], s47 offen lds
    v_mfma_f32_16x16x32_bf16 v[172:175], a[92:95], a[52:55], v[172:175]
    v_add_u32 v1, 128, v1
    v_add_u32 v2, 0x80000, v2
    v_mfma_f32_16x16x32_bf16 v[172:175], a[88:91], a[48:51], v[172:175]
    ds_read_b64_tr_b16 a[8:9], v7 offset:32768
    v_mfma_f32_16x16x32_bf16 v[180:183], a[88:91], a[56:59], v[180:183]
    buffer_load_dword a243, v14, s[36:39], s56 offen
    v_mfma_f32_16x16x32_bf16 v[180:183], a[92:95], a[60:63], v[180:183]
    s_add_u32 s56, s56, s30
    ds_read_b64_tr_b16 a[10:11], v7 offset:36864
    v_mfma_f32_16x16x32_bf16 v[176:179], a[84:87], a[60:63], v[176:179]
    ds_read_b64_tr_b16 a[12:13], v7 offset:49152
    v_mfma_f32_16x16x32_bf16 v[176:179], a[80:83], a[56:59], v[176:179]
    ds_read_b64_tr_b16 a[14:15], v7 offset:53248
    v_mfma_f32_16x16x32_bf16 v[188:191], a[72:75], a[56:59], v[188:191]
    ds_read_b64_tr_b16 a[16:17], v8 offset:32768
    v_mfma_f32_16x16x32_bf16 v[188:191], a[76:79], a[60:63], v[188:191]
    ds_read_b64_tr_b16 a[18:19], v8 offset:36864
    v_mfma_f32_16x16x32_bf16 v[184:187], a[68:71], a[60:63], v[184:187]
    ds_read_b64_tr_b16 a[20:21], v8 offset:49152
    v_mfma_f32_16x16x32_bf16 v[184:187], a[64:67], a[56:59], v[184:187]
    s_waitcnt lgkmcnt(8)
    ds_read_b64_tr_b16 a[22:23], v8 offset:53248
    v_mfma_f32_16x16x32_bf16 v[16:19], a[96:99], a[0:3], v[16:19]
    ds_read_b64_tr_b16 a[24:25], v9 offset:32768
    v_mfma_f32_16x16x32_bf16 v[16:19], a[100:103], a[4:7], v[16:19]
    ds_read_b64_tr_b16 a[26:27], v9 offset:36864
    v_mfma_f32_16x16x32_bf16 v[20:23], a[108:111], a[4:7], v[20:23]
    ds_read_b64_tr_b16 a[28:29], v9 offset:49152
    v_mfma_f32_16x16x32_bf16 v[20:23], a[104:107], a[0:3], v[20:23]
    ds_read_b64_tr_b16 a[30:31], v9 offset:53248
    v_mfma_f32_16x16x32_bf16 v[24:27], a[112:115], a[0:3], v[24:27]
    ds_read_b128 a[64:67], v4 offset:32768
    v_mfma_f32_16x16x32_bf16 v[24:27], a[116:119], a[4:7], v[24:27]
    v_mfma_f32_16x16x32_bf16 v[28:31], a[124:127], a[4:7], v[28:31]
    s_waitcnt lgkmcnt(8)
    ds_read_b128 a[68:71], v5 offset:32768
    v_mfma_f32_16x16x32_bf16 v[28:31], a[120:123], a[0:3], v[28:31]
    v_mfma_f32_16x16x32_bf16 a[228:231], a[120:123], a[8:11], a[228:231]
    ds_read_b128 a[76:79], v5 offset:34816
    v_mfma_f32_16x16x32_bf16 a[228:231], a[124:127], a[12:15], a[228:231]
    v_mfma_f32_16x16x32_bf16 a[224:227], a[116:119], a[12:15], a[224:227]
    ds_read_b128 a[72:75], v4 offset:34816
    v_mfma_f32_16x16x32_bf16 a[224:227], a[112:115], a[8:11], a[224:227]
    v_mfma_f32_16x16x32_bf16 a[236:239], a[104:107], a[8:11], a[236:239]
    ds_read_b128 a[80:83], v4 offset:36864
    v_mfma_f32_16x16x32_bf16 a[236:239], a[108:111], a[12:15], a[236:239]
    v_mfma_f32_16x16x32_bf16 a[232:235], a[100:103], a[12:15], a[232:235]
    ds_read_b128 a[84:87], v5 offset:36864
    v_mfma_f32_16x16x32_bf16 a[232:235], a[96:99], a[8:11], a[232:235]
    s_waitcnt lgkmcnt(8)
    v_mfma_f32_16x16x32_bf16 v[32:35], a[96:99], a[16:19], v[32:35]
    ds_read_b128 a[92:95], v5 offset:38912
    v_mfma_f32_16x16x32_bf16 v[32:35], a[100:103], a[20:23], v[32:35]
    v_mfma_f32_16x16x32_bf16 v[36:39], a[108:111], a[20:23], v[36:39]
    ds_read_b128 a[88:91], v4 offset:38912
    v_mfma_f32_16x16x32_bf16 v[36:39], a[104:107], a[16:19], v[36:39]
    v_mfma_f32_16x16x32_bf16 v[40:43], a[112:115], a[16:19], v[40:43]
    ds_read_b64_tr_b16 a[32:33], v10 offset:32768
    v_mfma_f32_16x16x32_bf16 v[40:43], a[116:119], a[20:23], v[40:43]
    ds_read_b64_tr_b16 a[34:35], v10 offset:36864
    v_mfma_f32_16x16x32_bf16 v[44:47], a[124:127], a[20:23], v[44:47]
    ds_read_b64_tr_b16 a[36:37], v10 offset:49152
    v_mfma_f32_16x16x32_bf16 v[44:47], a[120:123], a[16:19], v[44:47]
    ds_read_b64_tr_b16 a[38:39], v10 offset:53248
    v_mfma_f32_16x16x32_bf16 v[52:55], a[120:123], a[24:27], v[52:55]
    s_waitcnt lgkmcnt(8)
    ds_read_b64_tr_b16 a[40:41], v11 offset:32768
    v_mfma_f32_16x16x32_bf16 v[52:55], a[124:127], a[28:31], v[52:55]
    ds_read_b64_tr_b16 a[42:43], v11 offset:36864
    v_mfma_f32_16x16x32_bf16 v[48:51], a[116:119], a[28:31], v[48:51]
    ds_read_b64_tr_b16 a[44:45], v11 offset:49152
    v_mfma_f32_16x16x32_bf16 v[48:51], a[112:115], a[24:27], v[48:51]
    ds_read_b64_tr_b16 a[46:47], v11 offset:53248
    v_mfma_f32_16x16x32_bf16 v[60:63], a[104:107], a[24:27], v[60:63]
    ds_read_b64_tr_b16 a[48:49], v12 offset:32768
    v_mfma_f32_16x16x32_bf16 v[60:63], a[108:111], a[28:31], v[60:63]
    ds_read_b64_tr_b16 a[50:51], v12 offset:36864
    v_mfma_f32_16x16x32_bf16 v[56:59], a[100:103], a[28:31], v[56:59]
    ds_read_b64_tr_b16 a[52:53], v12 offset:49152
    v_mfma_f32_16x16x32_bf16 v[56:59], a[96:99], a[24:27], v[56:59]
    ds_read_b64_tr_b16 a[54:55], v12 offset:53248
    v_mfma_f32_16x16x32_bf16 v[64:67], a[64:67], a[0:3], v[64:67]
    ds_read_b64_tr_b16 a[56:57], v13 offset:32768
    v_mfma_f32_16x16x32_bf16 v[64:67], a[68:71], a[4:7], v[64:67]
    ds_read_b64_tr_b16 a[58:59], v13 offset:36864
    v_mfma_f32_16x16x32_bf16 v[68:71], a[76:79], a[4:7], v[68:71]
    ds_read_b64_tr_b16 a[60:61], v13 offset:49152
    v_mfma_f32_16x16x32_bf16 v[68:71], a[72:75], a[0:3], v[68:71]
    s_waitcnt lgkmcnt(8)
    ds_read_b64_tr_b16 a[62:63], v13 offset:53248
    v_mfma_f32_16x16x32_bf16 v[72:75], a[80:83], a[0:3], v[72:75]
    v_mfma_f32_16x16x32_bf16 v[72:75], a[84:87], a[4:7], v[72:75]
    v_mfma_f32_16x16x32_bf16 v[76:79], a[92:95], a[4:7], v[76:79]
    v_mfma_f32_16x16x32_bf16 v[76:79], a[88:91], a[0:3], v[76:79]
    s_waitcnt lgkmcnt(0)
    v_mfma_f32_16x16x32_bf16 v[84:87], a[88:91], a[8:11], v[84:87]
    s_barrier
    v_mfma_f32_16x16x32_bf16 v[84:87], a[92:95], a[12:15], v[84:87]
    s_add_u32 m0, s29, 98304
    v_mfma_f32_16x16x32_bf16 v[80:83], a[84:87], a[12:15], v[80:83]
    buffer_load_dwordx4 v2, s[8:11], 0 offen lds
    v_mfma_f32_16x16x32_bf16 v[80:83], a[80:83], a[8:11], v[80:83]
    v_mfma_f32_16x16x32_bf16 v[92:95], a[72:75], a[8:11], v[92:95]
    v_mfma_f32_16x16x32_bf16 v[92:95], a[76:79], a[12:15], v[92:95]
    v_mfma_f32_16x16x32_bf16 v[88:91], a[68:71], a[12:15], v[88:91]
    s_add_u32 m0, s29, 32768
    v_mfma_f32_16x16x32_bf16 v[88:91], a[64:67], a[8:11], v[88:91]
    buffer_load_dwordx4 v1, s[4:7], 0 offen lds
    v_mfma_f32_16x16x32_bf16 v[96:99], a[64:67], a[16:19], v[96:99]
    v_mfma_f32_16x16x32_bf16 v[96:99], a[68:71], a[20:23], v[96:99]
    v_mfma_f32_16x16x32_bf16 v[100:103], a[76:79], a[20:23], v[100:103]
    v_mfma_f32_16x16x32_bf16 v[100:103], a[72:75], a[16:19], v[100:103]
    s_add_u32 m0, s29, 102400
    v_mfma_f32_16x16x32_bf16 v[104:107], a[80:83], a[16:19], v[104:107]
    buffer_load_dwordx4 v2, s[8:11], s48 offen lds
    v_mfma_f32_16x16x32_bf16 v[104:107], a[84:87], a[20:23], v[104:107]
    v_mfma_f32_16x16x32_bf16 v[108:111], a[92:95], a[20:23], v[108:111]
    v_mfma_f32_16x16x32_bf16 v[108:111], a[88:91], a[16:19], v[108:111]
    v_mfma_f32_16x16x32_bf16 v[116:119], a[88:91], a[24:27], v[116:119]
    s_add_u32 m0, s29, 36864
    v_mfma_f32_16x16x32_bf16 v[116:119], a[92:95], a[28:31], v[116:119]
    buffer_load_dwordx4 v1, s[4:7], s41 offen lds
    v_mfma_f32_16x16x32_bf16 v[112:115], a[84:87], a[28:31], v[112:115]
    v_mfma_f32_16x16x32_bf16 v[112:115], a[80:83], a[24:27], v[112:115]
    v_mfma_f32_16x16x32_bf16 v[124:127], a[72:75], a[24:27], v[124:127]
    v_mfma_f32_16x16x32_bf16 v[124:127], a[76:79], a[28:31], v[124:127]
    s_add_u32 m0, s29, 106496
    v_mfma_f32_16x16x32_bf16 v[120:123], a[68:71], a[28:31], v[120:123]
    buffer_load_dwordx4 v2, s[8:11], s49 offen lds
    v_mfma_f32_16x16x32_bf16 v[120:123], a[64:67], a[24:27], v[120:123]
    v_mfma_f32_16x16x32_bf16 v[128:131], a[64:67], a[32:35], v[128:131]
    v_mfma_f32_16x16x32_bf16 v[128:131], a[68:71], a[36:39], v[128:131]
    v_mfma_f32_16x16x32_bf16 v[132:135], a[76:79], a[36:39], v[132:135]
    s_add_u32 m0, s29, 40960
    v_mfma_f32_16x16x32_bf16 v[132:135], a[72:75], a[32:35], v[132:135]
    buffer_load_dwordx4 v1, s[4:7], s42 offen lds
    v_mfma_f32_16x16x32_bf16 v[136:139], a[80:83], a[32:35], v[136:139]
    v_mfma_f32_16x16x32_bf16 v[136:139], a[84:87], a[36:39], v[136:139]
    v_mfma_f32_16x16x32_bf16 v[140:143], a[92:95], a[36:39], v[140:143]
    v_mfma_f32_16x16x32_bf16 v[140:143], a[88:91], a[32:35], v[140:143]
    s_add_u32 m0, s29, 110592
    v_mfma_f32_16x16x32_bf16 v[148:151], a[88:91], a[40:43], v[148:151]
    buffer_load_dwordx4 v2, s[8:11], s50 offen lds
    v_mfma_f32_16x16x32_bf16 v[148:151], a[92:95], a[44:47], v[148:151]
    v_mfma_f32_16x16x32_bf16 v[144:147], a[84:87], a[44:47], v[144:147]
    v_mfma_f32_16x16x32_bf16 v[144:147], a[80:83], a[40:43], v[144:147]
    v_mfma_f32_16x16x32_bf16 v[156:159], a[72:75], a[40:43], v[156:159]
    s_add_u32 m0, s29, 45056
    v_mfma_f32_16x16x32_bf16 v[156:159], a[76:79], a[44:47], v[156:159]
    buffer_load_dwordx4 v1, s[4:7], s43 offen lds
    v_mfma_f32_16x16x32_bf16 v[152:155], a[68:71], a[44:47], v[152:155]
    v_mfma_f32_16x16x32_bf16 v[152:155], a[64:67], a[40:43], v[152:155]
    v_mfma_f32_16x16x32_bf16 v[160:163], a[64:67], a[48:51], v[160:163]
    v_mfma_f32_16x16x32_bf16 v[160:163], a[68:71], a[52:55], v[160:163]
    s_add_u32 m0, s29, 114688
    v_mfma_f32_16x16x32_bf16 v[164:167], a[76:79], a[52:55], v[164:167]
    buffer_load_dwordx4 v2, s[8:11], s51 offen lds
    v_mfma_f32_16x16x32_bf16 v[164:167], a[72:75], a[48:51], v[164:167]
    v_mfma_f32_16x16x32_bf16 v[168:171], a[80:83], a[48:51], v[168:171]
    v_mfma_f32_16x16x32_bf16 v[168:171], a[84:87], a[52:55], v[168:171]
    v_mfma_f32_16x16x32_bf16 v[172:175], a[92:95], a[52:55], v[172:175]
    s_add_u32 m0, s29, 49152
    v_mfma_f32_16x16x32_bf16 v[172:175], a[88:91], a[48:51], v[172:175]
    buffer_load_dwordx4 v1, s[4:7], s44 offen lds
    v_mfma_f32_16x16x32_bf16 v[180:183], a[88:91], a[56:59], v[180:183]
    v_mfma_f32_16x16x32_bf16 v[180:183], a[92:95], a[60:63], v[180:183]
    v_mfma_f32_16x16x32_bf16 v[176:179], a[84:87], a[60:63], v[176:179]
    v_mfma_f32_16x16x32_bf16 v[176:179], a[80:83], a[56:59], v[176:179]
    s_add_u32 m0, s29, 118784
    v_mfma_f32_16x16x32_bf16 v[188:191], a[72:75], a[56:59], v[188:191]
    s_waitcnt vmcnt(11)
    buffer_load_dwordx4 v2, s[8:11], s52 offen lds
    v_mfma_f32_16x16x32_bf16 v[188:191], a[76:79], a[60:63], v[188:191]
    s_barrier
    ds_read_b64_tr_b16 a[0:1], v6 offset:0
    v_mfma_f32_16x16x32_bf16 v[184:187], a[68:71], a[60:63], v[184:187]
    ds_read_b64_tr_b16 a[2:3], v6 offset:4096
    v_mfma_f32_16x16x32_bf16 v[184:187], a[64:67], a[56:59], v[184:187]
    ds_read_b128 a[64:67], v4 offset:0
    v_mfma_f32_16x16x32_bf16 v[192:195], a[96:99], a[32:35], v[192:195]
    s_add_u32 m0, s29, 53248
    v_mfma_f32_16x16x32_bf16 v[192:195], a[100:103], a[36:39], v[192:195]
    buffer_load_dwordx4 v1, s[4:7], s45 offen lds
    v_mfma_f32_16x16x32_bf16 v[196:199], a[108:111], a[36:39], v[196:199]
    ds_read_b64_tr_b16 a[4:5], v6 offset:16384
    v_mfma_f32_16x16x32_bf16 v[196:199], a[104:107], a[32:35], v[196:199]
    ds_read_b64_tr_b16 a[6:7], v6 offset:20480
    v_mfma_f32_16x16x32_bf16 v[200:203], a[112:115], a[32:35], v[200:203]
    ds_read_b128 a[68:71], v5 offset:0
    v_mfma_f32_16x16x32_bf16 v[200:203], a[116:119], a[36:39], v[200:203]
    s_add_u32 m0, s29, 122880
    v_mfma_f32_16x16x32_bf16 v[204:207], a[124:127], a[36:39], v[204:207]
    buffer_load_dwordx4 v2, s[8:11], s53 offen lds
    v_mfma_f32_16x16x32_bf16 v[204:207], a[120:123], a[32:35], v[204:207]
    ds_read_b128 a[76:79], v5 offset:2048
    v_mfma_f32_16x16x32_bf16 v[212:215], a[120:123], a[40:43], v[212:215]
    v_mfma_f32_16x16x32_bf16 v[212:215], a[124:127], a[44:47], v[212:215]
    ds_read_b128 a[72:75], v4 offset:2048
    v_mfma_f32_16x16x32_bf16 v[208:211], a[116:119], a[44:47], v[208:211]
    s_add_u32 m0, s29, 57344
    v_mfma_f32_16x16x32_bf16 v[208:211], a[112:115], a[40:43], v[208:211]
    buffer_load_dwordx4 v1, s[4:7], s46 offen lds
    v_mfma_f32_16x16x32_bf16 v[220:223], a[104:107], a[40:43], v[220:223]
    ds_read_b128 a[80:83], v4 offset:4096
    v_mfma_f32_16x16x32_bf16 v[220:223], a[108:111], a[44:47], v[220:223]
    v_mfma_f32_16x16x32_bf16 v[216:219], a[100:103], a[44:47], v[216:219]
    ds_read_b128 a[84:87], v5 offset:4096
    v_mfma_f32_16x16x32_bf16 v[216:219], a[96:99], a[40:43], v[216:219]
    s_add_u32 m0, s29, 126976
    v_mfma_f32_16x16x32_bf16 v[224:227], a[96:99], a[48:51], v[224:227]
    buffer_load_dwordx4 v2, s[8:11], s54 offen lds
    v_mfma_f32_16x16x32_bf16 v[224:227], a[100:103], a[52:55], v[224:227]
    ds_read_b128 a[92:95], v5 offset:6144
    v_mfma_f32_16x16x32_bf16 v[228:231], a[108:111], a[52:55], v[228:231]
    v_mfma_f32_16x16x32_bf16 v[228:231], a[104:107], a[48:51], v[228:231]
    ds_read_b128 a[88:91], v4 offset:6144
    v_mfma_f32_16x16x32_bf16 v[232:235], a[112:115], a[48:51], v[232:235]
    s_add_u32 m0, s29, 61440
    v_mfma_f32_16x16x32_bf16 v[232:235], a[116:119], a[52:55], v[232:235]
    buffer_load_dwordx4 v1, s[4:7], s47 offen lds
    v_mfma_f32_16x16x32_bf16 v[236:239], a[124:127], a[52:55], v[236:239]
    v_add_u32 v1, 128, v1
    v_add_u32 v2, 0x80000, v2
    v_mfma_f32_16x16x32_bf16 v[236:239], a[120:123], a[48:51], v[236:239]
    ds_read_b64_tr_b16 a[8:9], v7 offset:0
    v_mfma_f32_16x16x32_bf16 v[244:247], a[120:123], a[56:59], v[244:247]
    buffer_load_dword a243, v14, s[36:39], s56 offen
    v_mfma_f32_16x16x32_bf16 v[244:247], a[124:127], a[60:63], v[244:247]
    s_add_u32 s56, s56, s30
    ds_read_b64_tr_b16 a[10:11], v7 offset:4096
    v_mfma_f32_16x16x32_bf16 v[240:243], a[116:119], a[60:63], v[240:243]
    ds_read_b64_tr_b16 a[12:13], v7 offset:16384
    v_mfma_f32_16x16x32_bf16 v[240:243], a[112:115], a[56:59], v[240:243]
    ds_read_b64_tr_b16 a[14:15], v7 offset:20480
    v_mfma_f32_16x16x32_bf16 v[252:255], a[104:107], a[56:59], v[252:255]
    ds_read_b64_tr_b16 a[16:17], v8 offset:0
    v_mfma_f32_16x16x32_bf16 v[252:255], a[108:111], a[60:63], v[252:255]
    ds_read_b64_tr_b16 a[18:19], v8 offset:4096
    v_mfma_f32_16x16x32_bf16 v[248:251], a[100:103], a[60:63], v[248:251]
    s_add_u32 s61, s61, 1
    ds_read_b64_tr_b16 a[20:21], v8 offset:16384
    v_mfma_f32_16x16x32_bf16 v[248:251], a[96:99], a[56:59], v[248:251]
    s_waitcnt lgkmcnt(8)
    ds_read_b64_tr_b16 a[22:23], v8 offset:20480
    s_cmp_lt_u32 s61, 6
    s_cbranch_scc1 L_vloop
    v_mfma_f32_16x16x32_bf16 v[64:67], a[64:67], a[0:3], v[64:67]
    ds_read_b64_tr_b16 a[24:25], v9 offset:0
    v_accvgpr_read_b32 v15, a240
    v_mfma_f32_16x16x32_bf16 v[64:67], a[68:71], a[4:7], v[64:67]
    ds_read_b64_tr_b16 a[26:27], v9 offset:4096
    v_accvgpr_read_b32 v14, a244
    v_mfma_f32_16x16x32_bf16 v[68:71], a[76:79], a[4:7], v[68:71]
    s_waitcnt lgkmcnt(12)
    ds_read_b64_tr_b16 a[28:29], v9 offset:16384
    global_load_dword a243, v14, s[100:101]
    v_mfma_f32_16x16x32_bf16 v[68:71], a[72:75], a[0:3], v[68:71]
    ds_read_b64_tr_b16 a[30:31], v9 offset:20480
    v_accvgpr_read_b32 v14, a242
    v_mfma_f32_16x16x32_bf16 v[72:75], a[80:83], a[0:3], v[72:75]
    s_add_u32 m0, s33, 0x0
    ds_read_b128 a[96:99], v4 offset:8192
    v_xor_b32 v3, 64, v14
    v_mfma_f32_16x16x32_bf16 v[72:75], a[84:87], a[4:7], v[72:75]
    s_waitcnt lgkmcnt(11)
    v_mfma_f32_16x16x32_bf16 v[76:79], a[92:95], a[4:7], v[76:79]
    ds_read_b128 a[100:103], v5 offset:8192
    buffer_load_dwordx4 v15, s[20:23], 0 offen offset:0 lds
    v_mfma_f32_16x16x32_bf16 v[76:79], a[88:91], a[0:3], v[76:79]
    v_mfma_f32_16x16x32_bf16 v[84:87], a[88:91], a[8:11], v[84:87]
    s_waitcnt lgkmcnt(10)
    ds_read_b128 a[108:111], v5 offset:10240
    v_mfma_f32_16x16x32_bf16 v[84:87], a[92:95], a[12:15], v[84:87]
    s_add_u32 m0, s33, 0x80
    v_mfma_f32_16x16x32_bf16 v[80:83], a[84:87], a[12:15], v[80:83]
    ds_read_b128 a[104:107], v4 offset:10240
    buffer_load_dwordx4 v15, s[20:23], 0 offen offset:896 lds
    v_mfma_f32_16x16x32_bf16 v[80:83], a[80:83], a[8:11], v[80:83]
    v_mfma_f32_16x16x32_bf16 v[92:95], a[72:75], a[8:11], v[92:95]
    ds_read_b128 a[112:115], v4 offset:12288
    v_mfma_f32_16x16x32_bf16 v[92:95], a[76:79], a[12:15], v[92:95]
    s_add_u32 m0, s33, 0x800
    v_mfma_f32_16x16x32_bf16 v[88:91], a[68:71], a[12:15], v[88:91]
    ds_read_b128 a[116:119], v5 offset:12288
    buffer_load_dwordx4 v15, s[20:23], s57 offen offset:0 lds
    v_mfma_f32_16x16x32_bf16 v[88:91], a[64:67], a[8:11], v[88:91]
    s_waitcnt lgkmcnt(10)
    v_mfma_f32_16x16x32_bf16 v[96:99], a[64:67], a[16:19], v[96:99]
    ds_read_b128 a[124:127], v5 offset:14336
    v_mfma_f32_16x16x32_bf16 v[96:99], a[68:71], a[20:23], v[96:99]
    s_add_u32 m0, s33, 0x880
    v_mfma_f32_16x16x32_bf16 v[100:103], a[76:79], a[20:23], v[100:103]
    ds_read_b128 a[120:123], v4 offset:14336
    buffer_load_dwordx4 v15, s[20:23], s57 offen offset:896 lds
    v_mfma_f32_16x16x32_bf16 v[100:103], a[72:75], a[16:19], v[100:103]
    v_mfma_f32_16x16x32_bf16 v[104:107], a[80:83], a[16:19], v[104:107]
    ds_read_b64_tr_b16 a[32:33], v10 offset:0
    v_mfma_f32_16x16x32_bf16 v[104:107], a[84:87], a[20:23], v[104:107]
    s_add_u32 m0, s33, 0xf80
    ds_read_b64_tr_b16 a[34:35], v10 offset:4096
    v_mfma_f32_16x16x32_bf16 v[108:111], a[92:95], a[20:23], v[108:111]
    ds_read_b64_tr_b16 a[36:37], v10 offset:16384
    buffer_load_dwordx4 v15, s[20:23], 0 offen offset:128 lds
    v_mfma_f32_16x16x32_bf16 v[108:111], a[88:91], a[16:19], v[108:111]
    s_waitcnt lgkmcnt(11)
    ds_read_b64_tr_b16 a[38:39], v10 offset:20480
    v_mfma_f32_16x16x32_bf16 v[116:119], a[88:91], a[24:27], v[116:119]
    ds_read_b64_tr_b16 a[40:41], v11 offset:0
    v_mfma_f32_16x16x32_bf16 v[116:119], a[92:95], a[28:31], v[116:119]
    s_add_u32 m0, s33, 0x1000
    ds_read_b64_tr_b16 a[42:43], v11 offset:4096
    v_mfma_f32_16x16x32_bf16 v[112:115], a[84:87], a[28:31], v[112:115]
    ds_read_b64_tr_b16 a[44:45], v11 offset:16384
    buffer_load_dwordx4 v15, s[20:23], 0 offen offset:1024 lds
    v_mfma_f32_16x16x32_bf16 v[112:115], a[80:83], a[24:27], v[112:115]
    ds_read_b64_tr_b16 a[46:47], v11 offset:20480
    v_mfma_f32_16x16x32_bf16 v[124:127], a[72:75], a[24:27], v[124:127]
    ds_read_b64_tr_b16 a[48:49], v12 offset:0
    v_mfma_f32_16x16x32_bf16 v[124:127], a[76:79], a[28:31], v[124:127]
    s_add_u32 m0, s33, 0x1780
    ds_read_b64_tr_b16 a[50:51], v12 offset:4096
    v_mfma_f32_16x16x32_bf16 v[120:123], a[68:71], a[28:31], v[120:123]
    ds_read_b64_tr_b16 a[52:53], v12 offset:16384
    buffer_load_dwordx4 v15, s[20:23], s57 offen offset:128 lds
    v_mfma_f32_16x16x32_bf16 v[120:123], a[64:67], a[24:27], v[120:123]
    s_waitcnt lgkmcnt(15)
    ds_read_b64_tr_b16 a[54:55], v12 offset:20480
    v_mfma_f32_16x16x32_bf16 v[16:19], a[96:99], a[0:3], v[16:19]
    ds_read_b64_tr_b16 a[56:57], v13 offset:0
    v_mfma_f32_16x16x32_bf16 v[16:19], a[100:103], a[4:7], v[16:19]
    s_add_u32 m0, s33, 0x1800
    ds_read_b64_tr_b16 a[58:59], v13 offset:4096
    v_mfma_f32_16x16x32_bf16 v[20:23], a[108:111], a[4:7], v[20:23]
    ds_read_b64_tr_b16 a[60:61], v13 offset:16384
    buffer_load_dwordx4 v15, s[20:23], s57 offen offset:1024 lds
    v_mfma_f32_16x16x32_bf16 v[20:23], a[104:107], a[0:3], v[20:23]
    s_waitcnt lgkmcnt(15)
    ds_read_b64_tr_b16 a[62:63], v13 offset:20480
    v_mfma_f32_16x16x32_bf16 v[24:27], a[112:115], a[0:3], v[24:27]
    v_mfma_f32_16x16x32_bf16 v[24:27], a[116:119], a[4:7], v[24:27]
    v_mfma_f32_16x16x32_bf16 v[28:31], a[124:127], a[4:7], v[28:31]
    v_mfma_f32_16x16x32_bf16 v[28:31], a[120:123], a[0:3], v[28:31]
    s_waitcnt lgkmcnt(0)
    v_mfma_f32_16x16x32_bf16 a[228:231], a[120:123], a[8:11], a[228:231]
    s_barrier
    v_mfma_f32_16x16x32_bf16 a[228:231], a[124:127], a[12:15], a[228:231]
    s_add_u32 m0, s29, 65536
    v_mfma_f32_16x16x32_bf16 a[224:227], a[116:119], a[12:15], a[224:227]
    buffer_load_dwordx4 v2, s[8:11], 0 offen lds
    v_mfma_f32_16x16x32_bf16 a[224:227], a[112:115], a[8:11], a[224:227]
    v_mfma_f32_16x16x32_bf16 a[236:239], a[104:107], a[8:11], a[236:239]
    v_mfma_f32_16x16x32_bf16 a[236:239], a[108:111], a[12:15], a[236:239]
    v_mfma_f32_16x16x32_bf16 a[232:235], a[100:103], a[12:15], a[232:235]
    s_add_u32 m0, s29, 0
    v_mfma_f32_16x16x32_bf16 a[232:235], a[96:99], a[8:11], a[232:235]
    buffer_load_dwordx4 v1, s[4:7], 0 offen lds
    v_mfma_f32_16x16x32_bf16 v[32:35], a[96:99], a[16:19], v[32:35]
    v_mfma_f32_16x16x32_bf16 v[32:35], a[100:103], a[20:23], v[32:35]
    v_mfma_f32_16x16x32_bf16 v[36:39], a[108:111], a[20:23], v[36:39]
    v_mfma_f32_16x16x32_bf16 v[36:39], a[104:107], a[16:19], v[36:39]
    s_add_u32 m0, s29, 69632
    v_mfma_f32_16x16x32_bf16 v[40:43], a[112:115], a[16:19], v[40:43]
    buffer_load_dwordx4 v2, s[8:11], s48 offen lds
    v_mfma_f32_16x16x32_bf16 v[40:43], a[116:119], a[20:23], v[40:43]
    v_mfma_f32_16x16x32_bf16 v[44:47], a[124:127], a[20:23], v[44:47]
    v_mfma_f32_16x16x32_bf16 v[44:47], a[120:123], a[16:19], v[44:47]
    v_mfma_f32_16x16x32_bf16 v[52:55], a[120:123], a[24:27], v[52:55]
    s_add_u32 m0, s29, 4096
    v_mfma_f32_16x16x32_bf16 v[52:55], a[124:127], a[28:31], v[52:55]
    buffer_load_dwordx4 v1, s[4:7], s41 offen lds
    v_mfma_f32_16x16x32_bf16 v[48:51], a[116:119], a[28:31], v[48:51]
    v_mfma_f32_16x16x32_bf16 v[48:51], a[112:115], a[24:27], v[48:51]
    v_mfma_f32_16x16x32_bf16 v[60:63], a[104:107], a[24:27], v[60:63]
    v_mfma_f32_16x16x32_bf16 v[60:63], a[108:111], a[28:31], v[60:63]
    s_add_u32 m0, s29, 73728
    v_mfma_f32_16x16x32_bf16 v[56:59], a[100:103], a[28:31], v[56:59]
    buffer_load_dwordx4 v2, s[8:11], s49 offen lds
    v_mfma_f32_16x16x32_bf16 v[56:59], a[96:99], a[24:27], v[56:59]
    v_mfma_f32_16x16x32_bf16 v[192:195], a[96:99], a[32:35], v[192:195]
    v_mfma_f32_16x16x32_bf16 v[192:195], a[100:103], a[36:39], v[192:195]
    v_mfma_f32_16x16x32_bf16 v[196:199], a[108:111], a[36:39], v[196:199]
    s_add_u32 m0, s29, 8192
    v_mfma_f32_16x16x32_bf16 v[196:199], a[104:107], a[32:35], v[196:199]
    buffer_load_dwordx4 v1, s[4:7], s42 offen lds
    v_mfma_f32_16x16x32_bf16 v[200:203], a[112:115], a[32:35], v[200:203]
    v_mfma_f32_16x16x32_bf16 v[200:203], a[116:119], a[36:39], v[200:203]
    v_mfma_f32_16x16x32_bf16 v[204:207], a[124:127], a[36:39], v[204:207]
    v_mfma_f32_16x16x32_bf16 v[204:207], a[120:123], a[32:35], v[204:207]
    s_add_u32 m0, s29, 77824
    v_mfma_f32_16x16x32_bf16 v[212:215], a[120:123], a[40:43], v[212:215]
    buffer_load_dwordx4 v2, s[8:11], s50 offen lds
    v_mfma_f32_16x16x32_bf16 v[212:215], a[124:127], a[44:47], v[212:215]
    v_mfma_f32_16x16x32_bf16 v[208:211], a[116:119], a[44:47], v[208:211]
    v_mfma_f32_16x16x32_bf16 v[208:211], a[112:115], a[40:43], v[208:211]
    v_mfma_f32_16x16x32_bf16 v[220:223], a[104:107], a[40:43], v[220:223]
    s_add_u32 m0, s29, 12288
    v_mfma_f32_16x16x32_bf16 v[220:223], a[108:111], a[44:47], v[220:223]
    buffer_load_dwordx4 v1, s[4:7], s43 offen lds
    v_mfma_f32_16x16x32_bf16 v[216:219], a[100:103], a[44:47], v[216:219]
    v_mfma_f32_16x16x32_bf16 v[216:219], a[96:99], a[40:43], v[216:219]
    v_mfma_f32_16x16x32_bf16 v[224:227], a[96:99], a[48:51], v[224:227]
    v_mfma_f32_16x16x32_bf16 v[224:227], a[100:103], a[52:55], v[224:227]
    s_add_u32 m0, s29, 81920
    v_mfma_f32_16x16x32_bf16 v[228:231], a[108:111], a[52:55], v[228:231]
    buffer_load_dwordx4 v2, s[8:11], s51 offen lds
    v_mfma_f32_16x16x32_bf16 v[228:231], a[104:107], a[48:51], v[228:231]
    v_mfma_f32_16x16x32_bf16 v[232:235], a[112:115], a[48:51], v[232:235]
    v_mfma_f32_16x16x32_bf16 v[232:235], a[116:119], a[52:55], v[232:235]
    v_mfma_f32_16x16x32_bf16 v[236:239], a[124:127], a[52:55], v[236:239]
    s_add_u32 m0, s29, 16384
    v_mfma_f32_16x16x32_bf16 v[236:239], a[120:123], a[48:51], v[236:239]
    buffer_load_dwordx4 v1, s[4:7], s44 offen lds
    v_mfma_f32_16x16x32_bf16 v[244:247], a[120:123], a[56:59], v[244:247]
    v_mfma_f32_16x16x32_bf16 v[244:247], a[124:127], a[60:63], v[244:247]
    v_mfma_f32_16x16x32_bf16 v[240:243], a[116:119], a[60:63], v[240:243]
    v_mfma_f32_16x16x32_bf16 v[240:243], a[112:115], a[56:59], v[240:243]
    s_add_u32 m0, s29, 86016
    v_mfma_f32_16x16x32_bf16 v[252:255], a[104:107], a[56:59], v[252:255]
    s_waitcnt vmcnt(10)
    buffer_load_dwordx4 v2, s[8:11], s52 offen lds
    v_mfma_f32_16x16x32_bf16 v[252:255], a[108:111], a[60:63], v[252:255]
    s_barrier
    ds_read_b64_tr_b16 a[0:1], v6 offset:32768
    v_mfma_f32_16x16x32_bf16 v[248:251], a[100:103], a[60:63], v[248:251]
    ds_read_b64_tr_b16 a[2:3], v6 offset:36864
    v_mfma_f32_16x16x32_bf16 v[248:251], a[96:99], a[56:59], v[248:251]
    ds_read_b128 a[96:99], v4 offset:40960
    v_mfma_f32_16x16x32_bf16 v[128:131], a[64:67], a[32:35], v[128:131]
    s_add_u32 m0, s29, 20480
    ds_read_b128 a[128:131], v14 offset:0
    v_mfma_f32_16x16x32_bf16 v[128:131], a[68:71], a[36:39], v[128:131]
    buffer_load_dwordx4 v1, s[4:7], s45 offen lds
    v_mfma_f32_16x16x32_bf16 v[132:135], a[76:79], a[36:39], v[132:135]
    ds_read_b64_tr_b16 a[4:5], v6 offset:49152
    v_mfma_f32_16x16x32_bf16 v[132:135], a[72:75], a[32:35], v[132:135]
    ds_read_b64_tr_b16 a[6:7], v6 offset:53248
    v_mfma_f32_16x16x32_bf16 v[136:139], a[80:83], a[32:35], v[136:139]
    ds_read_b128 a[100:103], v5 offset:40960
    v_mfma_f32_16x16x32_bf16 v[136:139], a[84:87], a[36:39], v[136:139]
    s_add_u32 m0, s29, 90112
    ds_read_b128 a[136:139], v3 offset:0
    v_mfma_f32_16x16x32_bf16 v[140:143], a[92:95], a[36:39], v[140:143]
    buffer_load_dwordx4 v2, s[8:11], s53 offen lds
    v_mfma_f32_16x16x32_bf16 v[140:143], a[88:91], a[32:35], v[140:143]
    ds_read_b128 a[108:111], v5 offset:43008
    v_mfma_f32_16x16x32_bf16 v[148:151], a[88:91], a[40:43], v[148:151]
    ds_read_b128 a[132:135], v14 offset:2048
    v_mfma_f32_16x16x32_bf16 v[148:151], a[92:95], a[44:47], v[148:151]
    ds_read_b128 a[104:107], v4 offset:43008
    v_mfma_f32_16x16x32_bf16 v[144:147], a[84:87], a[44:47], v[144:147]
    s_add_u32 m0, s29, 24576
    ds_read_b128 a[140:143], v3 offset:2048
    v_mfma_f32_16x16x32_bf16 v[144:147], a[80:83], a[40:43], v[144:147]
    buffer_load_dwordx4 v1, s[4:7], s46 offen lds
    v_mfma_f32_16x16x32_bf16 v[156:159], a[72:75], a[40:43], v[156:159]
    ds_read_b128 a[112:115], v4 offset:45056
    v_mfma_f32_16x16x32_bf16 v[156:159], a[76:79], a[44:47], v[156:159]
    ds_read_b128 a[144:147], v14 offset:4096
    v_mfma_f32_16x16x32_bf16 v[152:155], a[68:71], a[44:47], v[152:155]
    ds_read_b128 a[116:119], v5 offset:45056
    v_mfma_f32_16x16x32_bf16 v[152:155], a[64:67], a[40:43], v[152:155]
    s_add_u32 m0, s29, 94208
    ds_read_b128 a[152:155], v3 offset:4096
    v_mfma_f32_16x16x32_bf16 v[160:163], a[64:67], a[48:51], v[160:163]
    buffer_load_dwordx4 v2, s[8:11], s54 offen lds
    v_mfma_f32_16x16x32_bf16 v[160:163], a[68:71], a[52:55], v[160:163]
    ds_read_b128 a[124:127], v5 offset:47104
    v_mfma_f32_16x16x32_bf16 v[164:167], a[76:79], a[52:55], v[164:167]
    ds_read_b128 a[148:151], v14 offset:6144
    v_mfma_f32_16x16x32_bf16 v[164:167], a[72:75], a[48:51], v[164:167]
    ds_read_b128 a[120:123], v4 offset:47104
    v_mfma_f32_16x16x32_bf16 v[168:171], a[80:83], a[48:51], v[168:171]
    s_add_u32 m0, s29, 28672
    ds_read_b128 a[156:159], v3 offset:6144
    v_mfma_f32_16x16x32_bf16 v[168:171], a[84:87], a[52:55], v[168:171]
    buffer_load_dwordx4 v1, s[4:7], s47 offen lds
    v_mfma_f32_16x16x32_bf16 v[172:175], a[92:95], a[52:55], v[172:175]
    v_add_u32 v1, 128, v1
    v_add_u32 v2, 0x80000, v2
    v_mfma_f32_16x16x32_bf16 v[172:175], a[88:91], a[48:51], v[172:175]
    ds_read_b64_tr_b16 a[8:9], v7 offset:32768
    v_mfma_f32_16x16x32_bf16 v[180:183], a[88:91], a[56:59], v[180:183]
    v_mfma_f32_16x16x32_bf16 v[180:183], a[92:95], a[60:63], v[180:183]
    ds_read_b64_tr_b16 a[10:11], v7 offset:36864
    v_mfma_f32_16x16x32_bf16 v[176:179], a[84:87], a[60:63], v[176:179]
    ds_read_b64_tr_b16 a[12:13], v7 offset:49152
    v_mfma_f32_16x16x32_bf16 v[176:179], a[80:83], a[56:59], v[176:179]
    ds_read_b64_tr_b16 a[14:15], v7 offset:53248
    v_mfma_f32_16x16x32_bf16 v[188:191], a[72:75], a[56:59], v[188:191]
    ds_read_b64_tr_b16 a[16:17], v8 offset:32768
    v_mfma_f32_16x16x32_bf16 v[188:191], a[76:79], a[60:63], v[188:191]
    ds_read_b64_tr_b16 a[18:19], v8 offset:36864
    v_mfma_f32_16x16x32_bf16 v[184:187], a[68:71], a[60:63], v[184:187]
    ds_read_b64_tr_b16 a[20:21], v8 offset:49152
    v_mfma_f32_16x16x32_bf16 v[184:187], a[64:67], a[56:59], v[184:187]
    s_waitcnt lgkmcnt(15)
    ds_read_b64_tr_b16 a[22:23], v8 offset:53248
    v_mfma_f32_16x16x32_bf16 v[16:19], a[96:99], a[0:3], v[16:19]
    ds_read_b64_tr_b16 a[24:25], v9 offset:32768
    v_mfma_f32_16x16x32_bf16 v[16:19], a[100:103], a[4:7], v[16:19]
    s_add_u32 m0, s33, 0xffffff00
    ds_read_b64_tr_b16 a[26:27], v9 offset:36864
    v_mfma_f32_16x16x32_bf16 v[20:23], a[108:111], a[4:7], v[20:23]
    s_waitcnt lgkmcnt(10)
    ds_read_b64_tr_b16 a[28:29], v9 offset:49152
    v_mfma_f32_16x16x32_bf16 v[20:23], a[104:107], a[0:3], v[20:23]
    ds_read_b64_tr_b16 a[30:31], v9 offset:53248
    buffer_load_dwordx4 v15, s[20:23], 0 offen offset:256 lds
    v_mfma_f32_16x16x32_bf16 v[24:27], a[112:115], a[0:3], v[24:27]
    ds_read_b128 a[64:67], v4 offset:32768
    v_mfma_f32_16x16x32_bf16 v[24:27], a[116:119], a[4:7], v[24:27]
    v_mfma_f32_16x16x32_bf16 v[28:31], a[124:127], a[4:7], v[28:31]
    s_add_u32 m0, s33, 0xffffff80
    ds_read_b128 a[68:71], v5 offset:32768
    v_mfma_f32_16x16x32_bf16 v[28:31], a[120:123], a[0:3], v[28:31]
    s_waitcnt lgkmcnt(10)
    buffer_load_dwordx4 v15, s[20:23], 0 offen offset:1152 lds
    v_mfma_f32_16x16x32_bf16 a[228:231], a[120:123], a[8:11], a[228:231]
    ds_read_b128 a[76:79], v5 offset:34816
    v_mfma_f32_16x16x32_bf16 a[228:231], a[124:127], a[12:15], a[228:231]
    v_mfma_f32_16x16x32_bf16 a[224:227], a[116:119], a[12:15], a[224:227]
    s_add_u32 m0, s33, 0x700
    ds_read_b128 a[72:75], v4 offset:34816
    v_mfma_f32_16x16x32_bf16 a[224:227], a[112:115], a[8:11], a[224:227]
    buffer_load_dwordx4 v15, s[20:23], s57 offen offset:256 lds
    v_mfma_f32_16x16x32_bf16 a[236:239], a[104:107], a[8:11], a[236:239]
    ds_read_b128 a[80:83], v4 offset:36864
    v_mfma_f32_16x16x32_bf16 a[236:239], a[108:111], a[12:15], a[236:239]
    v_mfma_f32_16x16x32_bf16 a[232:235], a[100:103], a[12:15], a[232:235]
    s_add_u32 m0, s33, 0x780
    ds_read_b128 a[84:87], v5 offset:36864
    v_mfma_f32_16x16x32_bf16 a[232:235], a[96:99], a[8:11], a[232:235]
    s_waitcnt lgkmcnt(10)
    buffer_load_dwordx4 v15, s[20:23], s57 offen offset:1152 lds
    v_mfma_f32_16x16x32_bf16 v[32:35], a[96:99], a[16:19], v[32:35]
    ds_read_b128 a[92:95], v5 offset:38912
    v_mfma_f32_16x16x32_bf16 v[32:35], a[100:103], a[20:23], v[32:35]
    v_mfma_f32_16x16x32_bf16 v[36:39], a[108:111], a[20:23], v[36:39]
    s_add_u32 m0, s33, 0xe80
    ds_read_b128 a[88:91], v4 offset:38912
    v_mfma_f32_16x16x32_bf16 v[36:39], a[104:107], a[16:19], v[36:39]
    buffer_load_dwordx4 v15, s[20:23], 0 offen offset:384 lds
    v_mfma_f32_16x16x32_bf16 v[40:43], a[112:115], a[16:19], v[40:43]
    ds_read_b64_tr_b16 a[32:33], v10 offset:32768
    v_mfma_f32_16x16x32_bf16 v[40:43], a[116:119], a[20:23], v[40:43]
    ds_read_b64_tr_b16 a[34:35], v10 offset:36864
    v_mfma_f32_16x16x32_bf16 v[44:47], a[124:127], a[20:23], v[44:47]
    s_add_u32 m0, s33, 0xf00
    ds_read_b64_tr_b16 a[36:37], v10 offset:49152
    v_mfma_f32_16x16x32_bf16 v[44:47], a[120:123], a[16:19], v[44:47]
    s_waitcnt lgkmcnt(11)
    ds_read_b64_tr_b16 a[38:39], v10 offset:53248
    buffer_load_dwordx4 v15, s[20:23], 0 offen offset:1280 lds
    v_mfma_f32_16x16x32_bf16 v[52:55], a[120:123], a[24:27], v[52:55]
    ds_read_b64_tr_b16 a[40:41], v11 offset:32768
    v_mfma_f32_16x16x32_bf16 v[52:55], a[124:127], a[28:31], v[52:55]
    ds_read_b64_tr_b16 a[42:43], v11 offset:36864
    v_mfma_f32_16x16x32_bf16 v[48:51], a[116:119], a[28:31], v[48:51]
    s_add_u32 m0, s33, 0x1680
    ds_read_b64_tr_b16 a[44:45], v11 offset:49152
    v_mfma_f32_16x16x32_bf16 v[48:51], a[112:115], a[24:27], v[48:51]
    ds_read_b64_tr_b16 a[46:47], v11 offset:53248
    buffer_load_dwordx4 v15, s[20:23], s57 offen offset:384 lds
    v_mfma_f32_16x16x32_bf16 v[60:63], a[104:107], a[24:27], v[60:63]
    ds_read_b64_tr_b16 a[48:49], v12 offset:32768
    v_mfma_f32_16x16x32_bf16 v[60:63], a[108:111], a[28:31], v[60:63]
    ds_read_b64_tr_b16 a[50:51], v12 offset:36864
    v_mfma_f32_16x16x32_bf16 v[56:59], a[100:103], a[28:31], v[56:59]
    s_add_u32 m0, s33, 0x1700
    ds_read_b64_tr_b16 a[52:53], v12 offset:49152
    v_mfma_f32_16x16x32_bf16 v[56:59], a[96:99], a[24:27], v[56:59]
    s_waitcnt lgkmcnt(15)
    ds_read_b64_tr_b16 a[54:55], v12 offset:53248
    buffer_load_dwordx4 v15, s[20:23], s57 offen offset:1280 lds
    v_mfma_f32_16x16x32_bf16 v[64:67], a[64:67], a[0:3], v[64:67]
    ds_read_b64_tr_b16 a[56:57], v13 offset:32768
    v_mfma_f32_16x16x32_bf16 v[64:67], a[68:71], a[4:7], v[64:67]
    ds_read_b64_tr_b16 a[58:59], v13 offset:36864
    v_mfma_f32_16x16x32_bf16 v[68:71], a[76:79], a[4:7], v[68:71]
    ds_read_b64_tr_b16 a[60:61], v13 offset:49152
    v_mfma_f32_16x16x32_bf16 v[68:71], a[72:75], a[0:3], v[68:71]
    s_waitcnt lgkmcnt(15)
    ds_read_b64_tr_b16 a[62:63], v13 offset:53248
    v_mfma_f32_16x16x32_bf16 v[72:75], a[80:83], a[0:3], v[72:75]
    v_mfma_f32_16x16x32_bf16 v[72:75], a[84:87], a[4:7], v[72:75]
    v_mfma_f32_16x16x32_bf16 v[76:79], a[92:95], a[4:7], v[76:79]
    v_mfma_f32_16x16x32_bf16 v[76:79], a[88:91], a[0:3], v[76:79]
    s_waitcnt lgkmcnt(0)
    v_mfma_f32_16x16x32_bf16 v[84:87], a[88:91], a[8:11], v[84:87]
    s_barrier
    v_mfma_f32_16x16x32_bf16 v[84:87], a[92:95], a[12:15], v[84:87]
    s_add_u32 m0, s29, 98304
    v_mfma_f32_16x16x32_bf16 v[80:83], a[84:87], a[12:15], v[80:83]
    buffer_load_dwordx4 v2, s[8:11], 0 offen lds
    v_mfma_f32_16x16x32_bf16 v[80:83], a[80:83], a[8:11], v[80:83]
    v_mfma_f32_16x16x32_bf16 v[92:95], a[72:75], a[8:11], v[92:95]
    v_mfma_f32_16x16x32_bf16 v[92:95], a[76:79], a[12:15], v[92:95]
    v_mfma_f32_16x16x32_bf16 v[88:91], a[68:71], a[12:15], v[88:91]
    s_add_u32 m0, s29, 32768
    v_mfma_f32_16x16x32_bf16 v[88:91], a[64:67], a[8:11], v[88:91]
    buffer_load_dwordx4 v1, s[4:7], 0 offen lds
    v_mfma_f32_16x16x32_bf16 v[96:99], a[64:67], a[16:19], v[96:99]
    v_mfma_f32_16x16x32_bf16 v[96:99], a[68:71], a[20:23], v[96:99]
    v_mfma_f32_16x16x32_bf16 v[100:103], a[76:79], a[20:23], v[100:103]
    v_mfma_f32_16x16x32_bf16 v[100:103], a[72:75], a[16:19], v[100:103]
    s_add_u32 m0, s29, 102400
    v_mfma_f32_16x16x32_bf16 v[104:107], a[80:83], a[16:19], v[104:107]
    buffer_load_dwordx4 v2, s[8:11], s48 offen lds
    v_mfma_f32_16x16x32_bf16 v[104:107], a[84:87], a[20:23], v[104:107]
    v_mfma_f32_16x16x32_bf16 v[108:111], a[92:95], a[20:23], v[108:111]
    v_mfma_f32_16x16x32_bf16 v[108:111], a[88:91], a[16:19], v[108:111]
    v_mfma_f32_16x16x32_bf16 v[116:119], a[88:91], a[24:27], v[116:119]
    s_add_u32 m0, s29, 36864
    v_mfma_f32_16x16x32_bf16 v[116:119], a[92:95], a[28:31], v[116:119]
    buffer_load_dwordx4 v1, s[4:7], s41 offen lds
    v_mfma_f32_16x16x32_bf16 v[112:115], a[84:87], a[28:31], v[112:115]
    v_mfma_f32_16x16x32_bf16 v[112:115], a[80:83], a[24:27], v[112:115]
    v_mfma_f32_16x16x32_bf16 v[124:127], a[72:75], a[24:27], v[124:127]
    v_mfma_f32_16x16x32_bf16 v[124:127], a[76:79], a[28:31], v[124:127]
    s_add_u32 m0, s29, 106496
    v_mfma_f32_16x16x32_bf16 v[120:123], a[68:71], a[28:31], v[120:123]
    buffer_load_dwordx4 v2, s[8:11], s49 offen lds
    v_mfma_f32_16x16x32_bf16 v[120:123], a[64:67], a[24:27], v[120:123]
    v_mfma_f32_16x16x32_bf16 v[128:131], a[64:67], a[32:35], v[128:131]
    v_mfma_f32_16x16x32_bf16 v[128:131], a[68:71], a[36:39], v[128:131]
    v_mfma_f32_16x16x32_bf16 v[132:135], a[76:79], a[36:39], v[132:135]
    s_add_u32 m0, s29, 40960
    v_mfma_f32_16x16x32_bf16 v[132:135], a[72:75], a[32:35], v[132:135]
    buffer_load_dwordx4 v1, s[4:7], s42 offen lds
    v_mfma_f32_16x16x32_bf16 v[136:139], a[80:83], a[32:35], v[136:139]
    v_mfma_f32_16x16x32_bf16 v[136:139], a[84:87], a[36:39], v[136:139]
    v_mfma_f32_16x16x32_bf16 v[140:143], a[92:95], a[36:39], v[140:143]
    v_mfma_f32_16x16x32_bf16 v[140:143], a[88:91], a[32:35], v[140:143]
    s_add_u32 m0, s29, 110592
    v_mfma_f32_16x16x32_bf16 v[148:151], a[88:91], a[40:43], v[148:151]
    buffer_load_dwordx4 v2, s[8:11], s50 offen lds
    v_mfma_f32_16x16x32_bf16 v[148:151], a[92:95], a[44:47], v[148:151]
    v_mfma_f32_16x16x32_bf16 v[144:147], a[84:87], a[44:47], v[144:147]
    v_mfma_f32_16x16x32_bf16 v[144:147], a[80:83], a[40:43], v[144:147]
    v_mfma_f32_16x16x32_bf16 v[156:159], a[72:75], a[40:43], v[156:159]
    s_add_u32 m0, s29, 45056
    v_mfma_f32_16x16x32_bf16 v[156:159], a[76:79], a[44:47], v[156:159]
    buffer_load_dwordx4 v1, s[4:7], s43 offen lds
    v_mfma_f32_16x16x32_bf16 v[152:155], a[68:71], a[44:47], v[152:155]
    v_mfma_f32_16x16x32_bf16 v[152:155], a[64:67], a[40:43], v[152:155]
    v_mfma_f32_16x16x32_bf16 v[160:163], a[64:67], a[48:51], v[160:163]
    v_mfma_f32_16x16x32_bf16 v[160:163], a[68:71], a[52:55], v[160:163]
    s_add_u32 m0, s29, 114688
    v_mfma_f32_16x16x32_bf16 v[164:167], a[76:79], a[52:55], v[164:167]
    buffer_load_dwordx4 v2, s[8:11], s51 offen lds
    v_mfma_f32_16x16x32_bf16 v[164:167], a[72:75], a[48:51], v[164:167]
    v_mfma_f32_16x16x32_bf16 v[168:171], a[80:83], a[48:51], v[168:171]
    v_mfma_f32_16x16x32_bf16 v[168:171], a[84:87], a[52:55], v[168:171]
    v_mfma_f32_16x16x32_bf16 v[172:175], a[92:95], a[52:55], v[172:175]
    s_add_u32 m0, s29, 49152
    v_mfma_f32_16x16x32_bf16 v[172:175], a[88:91], a[48:51], v[172:175]
    buffer_load_dwordx4 v1, s[4:7], s44 offen lds
    v_mfma_f32_16x16x32_bf16 v[180:183], a[88:91], a[56:59], v[180:183]
    v_mfma_f32_16x16x32_bf16 v[180:183], a[92:95], a[60:63], v[180:183]
    v_mfma_f32_16x16x32_bf16 v[176:179], a[84:87], a[60:63], v[176:179]
    v_mfma_f32_16x16x32_bf16 v[176:179], a[80:83], a[56:59], v[176:179]
    s_add_u32 m0, s29, 118784
    v_mfma_f32_16x16x32_bf16 v[188:191], a[72:75], a[56:59], v[188:191]
    s_waitcnt vmcnt(10)
    buffer_load_dwordx4 v2, s[8:11], s52 offen lds
    v_mfma_f32_16x16x32_bf16 v[188:191], a[76:79], a[60:63], v[188:191]
    s_barrier
    ds_read_b64_tr_b16 a[0:1], v6 offset:0
    v_mfma_f32_16x16x32_bf16 v[184:187], a[68:71], a[60:63], v[184:187]
    ds_read_b64_tr_b16 a[2:3], v6 offset:4096
    v_mfma_f32_16x16x32_bf16 v[184:187], a[64:67], a[56:59], v[184:187]
    ds_read_b128 a[64:67], v4 offset:0
    v_mfma_f32_16x16x32_bf16 v[192:195], a[96:99], a[32:35], v[192:195]
    s_add_u32 m0, s29, 53248
    ds_read_b128 a[160:163], v14 offset:0
    v_mfma_f32_16x16x32_bf16 v[192:195], a[100:103], a[36:39], v[192:195]
    buffer_load_dwordx4 v1, s[4:7], s45 offen lds
    v_mfma_f32_16x16x32_bf16 v[196:199], a[108:111], a[36:39], v[196:199]
    ds_read_b64_tr_b16 a[4:5], v6 offset:16384
    v_mfma_f32_16x16x32_bf16 v[196:199], a[104:107], a[32:35], v[196:199]
    ds_read_b64_tr_b16 a[6:7], v6 offset:20480
    v_mfma_f32_16x16x32_bf16 v[200:203], a[112:115], a[32:35], v[200:203]
    ds_read_b128 a[68:71], v5 offset:0
    v_mfma_f32_16x16x32_bf16 v[200:203], a[116:119], a[36:39], v[200:203]
    s_add_u32 m0, s29, 122880
    ds_read_b128 a[168:171], v3 offset:0
    v_mfma_f32_16x16x32_bf16 v[204:207], a[124:127], a[36:39], v[204:207]
    buffer_load_dwordx4 v2, s[8:11], s53 offen lds
    v_mfma_f32_16x16x32_bf16 v[204:207], a[120:123], a[32:35], v[204:207]
    ds_read_b128 a[76:79], v5 offset:2048
    v_mfma_f32_16x16x32_bf16 v[212:215], a[120:123], a[40:43], v[212:215]
    ds_read_b128 a[164:167], v14 offset:2048
    v_mfma_f32_16x16x32_bf16 v[212:215], a[124:127], a[44:47], v[212:215]
    ds_read_b128 a[72:75], v4 offset:2048
    v_mfma_f32_16x16x32_bf16 v[208:211], a[116:119], a[44:47], v[208:211]
    s_add_u32 m0, s29, 57344
    ds_read_b128 a[172:175], v3 offset:2048
    v_mfma_f32_16x16x32_bf16 v[208:211], a[112:115], a[40:43], v[208:211]
    buffer_load_dwordx4 v1, s[4:7], s46 offen lds
    v_mfma_f32_16x16x32_bf16 v[220:223], a[104:107], a[40:43], v[220:223]
    ds_read_b128 a[80:83], v4 offset:4096
    v_mfma_f32_16x16x32_bf16 v[220:223], a[108:111], a[44:47], v[220:223]
    ds_read_b128 a[176:179], v14 offset:4096
    v_mfma_f32_16x16x32_bf16 v[216:219], a[100:103], a[44:47], v[216:219]
    ds_read_b128 a[84:87], v5 offset:4096
    v_mfma_f32_16x16x32_bf16 v[216:219], a[96:99], a[40:43], v[216:219]
    s_add_u32 m0, s29, 126976
    ds_read_b128 a[184:187], v3 offset:4096
    v_mfma_f32_16x16x32_bf16 v[224:227], a[96:99], a[48:51], v[224:227]
    buffer_load_dwordx4 v2, s[8:11], s54 offen lds
    v_mfma_f32_16x16x32_bf16 v[224:227], a[100:103], a[52:55], v[224:227]
    ds_read_b128 a[92:95], v5 offset:6144
    v_mfma_f32_16x16x32_bf16 v[228:231], a[108:111], a[52:55], v[228:231]
    ds_read_b128 a[180:183], v14 offset:6144
    v_mfma_f32_16x16x32_bf16 v[228:231], a[104:107], a[48:51], v[228:231]
    ds_read_b128 a[88:91], v4 offset:6144
    v_mfma_f32_16x16x32_bf16 v[232:235], a[112:115], a[48:51], v[232:235]
    s_add_u32 m0, s29, 61440
    ds_read_b128 a[188:191], v3 offset:6144
    v_mfma_f32_16x16x32_bf16 v[232:235], a[116:119], a[52:55], v[232:235]
    buffer_load_dwordx4 v1, s[4:7], s47 offen lds
    v_mfma_f32_16x16x32_bf16 v[236:239], a[124:127], a[52:55], v[236:239]
    v_add_u32 v1, 128, v1
    v_add_u32 v2, 0x80000, v2
    v_mfma_f32_16x16x32_bf16 v[236:239], a[120:123], a[48:51], v[236:239]
    ds_read_b64_tr_b16 a[8:9], v7 offset:0
    v_mfma_f32_16x16x32_bf16 v[244:247], a[120:123], a[56:59], v[244:247]
    v_mfma_f32_16x16x32_bf16 v[244:247], a[124:127], a[60:63], v[244:247]
    ds_read_b64_tr_b16 a[10:11], v7 offset:4096
    v_mfma_f32_16x16x32_bf16 v[240:243], a[116:119], a[60:63], v[240:243]
    ds_read_b64_tr_b16 a[12:13], v7 offset:16384
    v_mfma_f32_16x16x32_bf16 v[240:243], a[112:115], a[56:59], v[240:243]
    ds_read_b64_tr_b16 a[14:15], v7 offset:20480
    v_mfma_f32_16x16x32_bf16 v[252:255], a[104:107], a[56:59], v[252:255]
    ds_read_b64_tr_b16 a[16:17], v8 offset:0
    v_mfma_f32_16x16x32_bf16 v[252:255], a[108:111], a[60:63], v[252:255]
    ds_read_b64_tr_b16 a[18:19], v8 offset:4096
    v_mfma_f32_16x16x32_bf16 v[248:251], a[100:103], a[60:63], v[248:251]
    ds_read_b64_tr_b16 a[20:21], v8 offset:16384
    v_mfma_f32_16x16x32_bf16 v[248:251], a[96:99], a[56:59], v[248:251]
    s_waitcnt lgkmcnt(15)
    ds_read_b64_tr_b16 a[22:23], v8 offset:20480
    v_mfma_f32_16x16x32_bf16 v[64:67], a[64:67], a[0:3], v[64:67]
    ds_read_b64_tr_b16 a[24:25], v9 offset:0
    v_lshlrev_b32 v1, 4, v0
    v_mfma_f32_16x16x32_bf16 v[64:67], a[68:71], a[4:7], v[64:67]
    s_add_u32 m0, s33, 0xfffffe00
    ds_read_b64_tr_b16 a[26:27], v9 offset:4096
    v_mfma_f32_16x16x32_bf16 v[68:71], a[76:79], a[4:7], v[68:71]
    s_waitcnt lgkmcnt(10)
    ds_read_b64_tr_b16 a[28:29], v9 offset:16384
    v_mfma_f32_16x16x32_bf16 v[68:71], a[72:75], a[0:3], v[68:71]
    ds_read_b64_tr_b16 a[30:31], v9 offset:20480
    buffer_load_dwordx4 v15, s[20:23], 0 offen offset:512 lds
    v_mfma_f32_16x16x32_bf16 v[72:75], a[80:83], a[0:3], v[72:75]
    ds_read_b128 a[96:99], v4 offset:8192
    v_mfma_f32_16x16x32_bf16 v[72:75], a[84:87], a[4:7], v[72:75]
    v_mfma_f32_16x16x32_bf16 v[76:79], a[92:95], a[4:7], v[76:79]
    s_add_u32 m0, s33, 0xfffffe80
    ds_read_b128 a[100:103], v5 offset:8192
    v_mfma_f32_16x16x32_bf16 v[76:79], a[88:91], a[0:3], v[76:79]
    s_waitcnt lgkmcnt(10)
    buffer_load_dwordx4 v15, s[20:23], 0 offen offset:1408 lds
    v_mfma_f32_16x16x32_bf16 v[84:87], a[88:91], a[8:11], v[84:87]
    ds_read_b128 a[108:111], v5 offset:10240
    v_mfma_f32_16x16x32_bf16 v[84:87], a[92:95], a[12:15], v[84:87]
    v_mfma_f32_16x16x32_bf16 v[80:83], a[84:87], a[12:15], v[80:83]
    s_add_u32 m0, s33, 0x600
    ds_read_b128 a[104:107], v4 offset:10240
    v_mfma_f32_16x16x32_bf16 v[80:83], a[80:83], a[8:11], v[80:83]
    buffer_load_dwordx4 v15, s[20:23], s57 offen offset:512 lds
    v_mfma_f32_16x16x32_bf16 v[92:95], a[72:75], a[8:11], v[92:95]
    ds_read_b128 a[112:115], v4 offset:12288
    v_mfma_f32_16x16x32_bf16 v[92:95], a[76:79], a[12:15], v[92:95]
    v_mfma_f32_16x16x32_bf16 v[88:91], a[68:71], a[12:15], v[88:91]
    s_add_u32 m0, s33, 0x680
    ds_read_b128 a[116:119], v5 offset:12288
    v_mfma_f32_16x16x32_bf16 v[88:91], a[64:67], a[8:11], v[88:91]
    s_waitcnt lgkmcnt(10)
    buffer_load_dwordx4 v15, s[20:23], s57 offen offset:1408 lds
    v_mfma_f32_16x16x32_bf16 v[96:99], a[64:67], a[16:19], v[96:99]
    ds_read_b128 a[124:127], v5 offset:14336
    v_mfma_f32_16x16x32_bf16 v[96:99], a[68:71], a[20:23], v[96:99]
    v_mfma_f32_16x16x32_bf16 v[100:103], a[76:79], a[20:23], v[100:103]
    s_add_u32 m0, s33, 0xd80
    ds_read_b128 a[120:123], v4 offset:14336
    v_mfma_f32_16x16x32_bf16 v[100:103], a[72:75], a[16:19], v[100:103]
    buffer_load_dwordx4 v15, s[20:23], 0 offen offset:640 lds
    v_mfma_f32_16x16x32_bf16 v[104:107], a[80:83], a[16:19], v[104:107]
    ds_read_b64_tr_b16 a[32:33], v10 offset:0
    v_mfma_f32_16x16x32_bf16 v[104:107], a[84:87], a[20:23], v[104:107]
    ds_read_b64_tr_b16 a[34:35], v10 offset:4096
    v_mfma_f32_16x16x32_bf16 v[108:111], a[92:95], a[20:23], v[108:111]
    s_add_u32 m0, s33, 0xe00
    ds_read_b64_tr_b16 a[36:37], v10 offset:16384
    v_mfma_f32_16x16x32_bf16 v[108:111], a[88:91], a[16:19], v[108:111]
    s_waitcnt lgkmcnt(11)
    ds_read_b64_tr_b16 a[38:39], v10 offset:20480
    buffer_load_dwordx4 v15, s[20:23], 0 offen offset:1536 lds
    v_mfma_f32_16x16x32_bf16 v[116:119], a[88:91], a[24:27], v[116:119]
    ds_read_b64_tr_b16 a[40:41], v11 offset:0
    v_mfma_f32_16x16x32_bf16 v[116:119], a[92:95], a[28:31], v[116:119]
    ds_read_b64_tr_b16 a[42:43], v11 offset:4096
    v_mfma_f32_16x16x32_bf16 v[112:115], a[84:87], a[28:31], v[112:115]
    s_add_u32 m0, s33, 0x1580
    ds_read_b64_tr_b16 a[44:45], v11 offset:16384
    v_mfma_f32_16x16x32_bf16 v[112:115], a[80:83], a[24:27], v[112:115]
    ds_read_b64_tr_b16 a[46:47], v11 offset:20480
    buffer_load_dwordx4 v15, s[20:23], s57 offen offset:640 lds
    v_mfma_f32_16x16x32_bf16 v[124:127], a[72:75], a[24:27], v[124:127]
    ds_read_b64_tr_b16 a[48:49], v12 offset:0
    v_mfma_f32_16x16x32_bf16 v[124:127], a[76:79], a[28:31], v[124:127]
    ds_read_b64_tr_b16 a[50:51], v12 offset:4096
    v_mfma_f32_16x16x32_bf16 v[120:123], a[68:71], a[28:31], v[120:123]
    s_add_u32 m0, s33, 0x1600
    ds_read_b64_tr_b16 a[52:53], v12 offset:16384
    v_mfma_f32_16x16x32_bf16 v[120:123], a[64:67], a[24:27], v[120:123]
    s_waitcnt lgkmcnt(15)
    ds_read_b64_tr_b16 a[54:55], v12 offset:20480
    buffer_load_dwordx4 v15, s[20:23], s57 offen offset:1536 lds
    v_mfma_f32_16x16x32_bf16 v[16:19], a[96:99], a[0:3], v[16:19]
    ds_read_b64_tr_b16 a[56:57], v13 offset:0
    v_mfma_f32_16x16x32_bf16 v[16:19], a[100:103], a[4:7], v[16:19]
    ds_read_b64_tr_b16 a[58:59], v13 offset:4096
    v_mfma_f32_16x16x32_bf16 v[20:23], a[108:111], a[4:7], v[20:23]
    ds_read_b64_tr_b16 a[60:61], v13 offset:16384
    v_mfma_f32_16x16x32_bf16 v[20:23], a[104:107], a[0:3], v[20:23]
    s_waitcnt lgkmcnt(15)
    ds_read_b64_tr_b16 a[62:63], v13 offset:20480
    v_mfma_f32_16x16x32_bf16 v[24:27], a[112:115], a[0:3], v[24:27]
    v_mfma_f32_16x16x32_bf16 v[24:27], a[116:119], a[4:7], v[24:27]
    v_mfma_f32_16x16x32_bf16 v[28:31], a[124:127], a[4:7], v[28:31]
    v_mfma_f32_16x16x32_bf16 v[28:31], a[120:123], a[0:3], v[28:31]
    s_waitcnt lgkmcnt(0)
    v_mfma_f32_16x16x32_bf16 a[228:231], a[120:123], a[8:11], a[228:231]
    s_barrier
    v_mfma_f32_16x16x32_bf16 a[228:231], a[124:127], a[12:15], a[228:231]
    s_add_u32 m0, s29, 0
    v_add_u32 v2, 0xff800000, v2
    v_mfma_f32_16x16x32_bf16 a[224:227], a[116:119], a[12:15], a[224:227]
    buffer_load_dwordx4 v2, s[16:19], 0 offen lds
    v_mfma_f32_16x16x32_bf16 a[224:227], a[112:115], a[8:11], a[224:227]
    v_mfma_f32_16x16x32_bf16 a[236:239], a[104:107], a[8:11], a[236:239]
    v_mfma_f32_16x16x32_bf16 a[236:239], a[108:111], a[12:15], a[236:239]
    v_mfma_f32_16x16x32_bf16 a[232:235], a[100:103], a[12:15], a[232:235]
    s_add_u32 m0, s29, 4096
    v_mfma_f32_16x16x32_bf16 a[232:235], a[96:99], a[8:11], a[232:235]
    buffer_load_dwordx4 v2, s[16:19], s48 offen lds
    v_mfma_f32_16x16x32_bf16 v[32:35], a[96:99], a[16:19], v[32:35]
    v_mfma_f32_16x16x32_bf16 v[32:35], a[100:103], a[20:23], v[32:35]
    v_mfma_f32_16x16x32_bf16 v[36:39], a[108:111], a[20:23], v[36:39]
    v_mfma_f32_16x16x32_bf16 v[36:39], a[104:107], a[16:19], v[36:39]
    s_add_u32 m0, s29, 8192
    v_mfma_f32_16x16x32_bf16 v[40:43], a[112:115], a[16:19], v[40:43]
    buffer_load_dwordx4 v2, s[16:19], s49 offen lds
    v_mfma_f32_16x16x32_bf16 v[40:43], a[116:119], a[20:23], v[40:43]
    v_mfma_f32_16x16x32_bf16 v[44:47], a[124:127], a[20:23], v[44:47]
    v_mfma_f32_16x16x32_bf16 v[44:47], a[120:123], a[16:19], v[44:47]
    v_mfma_f32_16x16x32_bf16 v[52:55], a[120:123], a[24:27], v[52:55]
    s_add_u32 m0, s29, 12288
    v_mfma_f32_16x16x32_bf16 v[52:55], a[124:127], a[28:31], v[52:55]
    buffer_load_dwordx4 v2, s[16:19], s50 offen lds
    v_mfma_f32_16x16x32_bf16 v[48:51], a[116:119], a[28:31], v[48:51]
    v_mfma_f32_16x16x32_bf16 v[48:51], a[112:115], a[24:27], v[48:51]
    v_mfma_f32_16x16x32_bf16 v[60:63], a[104:107], a[24:27], v[60:63]
    v_mfma_f32_16x16x32_bf16 v[60:63], a[108:111], a[28:31], v[60:63]
    s_add_u32 m0, s29, 16384
    v_mfma_f32_16x16x32_bf16 v[56:59], a[100:103], a[28:31], v[56:59]
    buffer_load_dwordx4 v2, s[16:19], s51 offen lds
    v_mfma_f32_16x16x32_bf16 v[56:59], a[96:99], a[24:27], v[56:59]
    v_mfma_f32_16x16x32_bf16 v[192:195], a[96:99], a[32:35], v[192:195]
    v_mfma_f32_16x16x32_bf16 v[192:195], a[100:103], a[36:39], v[192:195]
    v_mfma_f32_16x16x32_bf16 v[196:199], a[108:111], a[36:39], v[196:199]
    s_add_u32 m0, s29, 20480
    v_mfma_f32_16x16x32_bf16 v[196:199], a[104:107], a[32:35], v[196:199]
    buffer_load_dwordx4 v2, s[16:19], s52 offen lds
    v_mfma_f32_16x16x32_bf16 v[200:203], a[112:115], a[32:35], v[200:203]
    v_mfma_f32_16x16x32_bf16 v[200:203], a[116:119], a[36:39], v[200:203]
    v_mfma_f32_16x16x32_bf16 v[204:207], a[124:127], a[36:39], v[204:207]
    v_mfma_f32_16x16x32_bf16 v[204:207], a[120:123], a[32:35], v[204:207]
    s_add_u32 m0, s29, 24576
    v_mfma_f32_16x16x32_bf16 v[212:215], a[120:123], a[40:43], v[212:215]
    buffer_load_dwordx4 v2, s[16:19], s53 offen lds
    v_mfma_f32_16x16x32_bf16 v[212:215], a[124:127], a[44:47], v[212:215]
    v_mfma_f32_16x16x32_bf16 v[208:211], a[116:119], a[44:47], v[208:211]
    v_mfma_f32_16x16x32_bf16 v[208:211], a[112:115], a[40:43], v[208:211]
    v_mfma_f32_16x16x32_bf16 v[220:223], a[104:107], a[40:43], v[220:223]
    s_add_u32 m0, s29, 28672
    v_mfma_f32_16x16x32_bf16 v[220:223], a[108:111], a[44:47], v[220:223]
    buffer_load_dwordx4 v2, s[16:19], s54 offen lds
    v_mfma_f32_16x16x32_bf16 v[216:219], a[100:103], a[44:47], v[216:219]
    v_mfma_f32_16x16x32_bf16 v[216:219], a[96:99], a[40:43], v[216:219]
    v_mfma_f32_16x16x32_bf16 v[224:227], a[96:99], a[48:51], v[224:227]
    s_add_u32 m0, s29, 65536
    v_add_u32 v2, 0x80000, v2
    v_mfma_f32_16x16x32_bf16 v[224:227], a[100:103], a[52:55], v[224:227]
    buffer_load_dwordx4 v2, s[16:19], 0 offen lds
    v_mfma_f32_16x16x32_bf16 v[228:231], a[108:111], a[52:55], v[228:231]
    v_mfma_f32_16x16x32_bf16 v[228:231], a[104:107], a[48:51], v[228:231]
    v_mfma_f32_16x16x32_bf16 v[232:235], a[112:115], a[48:51], v[232:235]
    v_mfma_f32_16x16x32_bf16 v[232:235], a[116:119], a[52:55], v[232:235]
    s_add_u32 m0, s29, 69632
    v_mfma_f32_16x16x32_bf16 v[236:239], a[124:127], a[52:55], v[236:239]
    buffer_load_dwordx4 v2, s[16:19], s48 offen lds
    v_mfma_f32_16x16x32_bf16 v[236:239], a[120:123], a[48:51], v[236:239]
    v_mfma_f32_16x16x32_bf16 v[244:247], a[120:123], a[56:59], v[244:247]
    v_mfma_f32_16x16x32_bf16 v[244:247], a[124:127], a[60:63], v[244:247]
    v_mfma_f32_16x16x32_bf16 v[240:243], a[116:119], a[60:63], v[240:243]
    s_add_u32 m0, s29, 73728
    v_mfma_f32_16x16x32_bf16 v[240:243], a[112:115], a[56:59], v[240:243]
    buffer_load_dwordx4 v2, s[16:19], s49 offen lds
    v_mfma_f32_16x16x32_bf16 v[252:255], a[104:107], a[56:59], v[252:255]
    s_waitcnt vmcnt(11)
    v_mfma_f32_16x16x32_bf16 v[252:255], a[108:111], a[60:63], v[252:255]
    s_barrier
    ds_read_b64_tr_b16 a[0:1], v6 offset:32768
    v_mfma_f32_16x16x32_bf16 v[248:251], a[100:103], a[60:63], v[248:251]
    ds_read_b64_tr_b16 a[2:3], v6 offset:36864
    v_mfma_f32_16x16x32_bf16 v[248:251], a[96:99], a[56:59], v[248:251]
    s_add_u32 m0, s29, 77824
    ds_read_b128 a[96:99], v4 offset:40960
    v_mfma_f32_16x16x32_bf16 v[128:131], a[64:67], a[32:35], v[128:131]
    ds_read_b128 a[192:195], v14 offset:0
    buffer_load_dwordx4 v2, s[16:19], s50 offen lds
    v_mfma_f32_16x16x32_bf16 v[128:131], a[68:71], a[36:39], v[128:131]
    ds_read_b128 a[200:203], v3 offset:0
    v_mfma_f32_16x16x32_bf16 v[132:135], a[76:79], a[36:39], v[132:135]
    ds_read_b64_tr_b16 a[4:5], v6 offset:49152
    v_mfma_f32_16x16x32_bf16 v[132:135], a[72:75], a[32:35], v[132:135]
    ds_read_b64_tr_b16 a[6:7], v6 offset:53248
    v_mfma_f32_16x16x32_bf16 v[136:139], a[80:83], a[32:35], v[136:139]
    s_add_u32 m0, s29, 81920
    ds_read_b128 a[100:103], v5 offset:40960
    v_mfma_f32_16x16x32_bf16 v[136:139], a[84:87], a[36:39], v[136:139]
    ds_read_b128 a[196:199], v14 offset:2048
    buffer_load_dwordx4 v2, s[16:19], s51 offen lds
    v_mfma_f32_16x16x32_bf16 v[140:143], a[92:95], a[36:39], v[140:143]
    ds_read_b128 a[204:207], v3 offset:2048
    v_mfma_f32_16x16x32_bf16 v[140:143], a[88:91], a[32:35], v[140:143]
    ds_read_b128 a[108:111], v5 offset:43008
    v_mfma_f32_16x16x32_bf16 v[148:151], a[88:91], a[40:43], v[148:151]
    ds_read_b128 a[208:211], v14 offset:4096
    v_mfma_f32_16x16x32_bf16 v[148:151], a[92:95], a[44:47], v[148:151]
    s_add_u32 m0, s29, 86016
    ds_read_b128 a[104:107], v4 offset:43008
    v_mfma_f32_16x16x32_bf16 v[144:147], a[84:87], a[44:47], v[144:147]
    ds_read_b128 a[216:219], v3 offset:4096
    buffer_load_dwordx4 v2, s[16:19], s52 offen lds
    v_mfma_f32_16x16x32_bf16 v[144:147], a[80:83], a[40:43], v[144:147]
    ds_read_b128 a[212:215], v14 offset:6144
    v_mfma_f32_16x16x32_bf16 v[156:159], a[72:75], a[40:43], v[156:159]
    ds_read_b128 a[112:115], v4 offset:45056
    v_mfma_f32_16x16x32_bf16 v[156:159], a[76:79], a[44:47], v[156:159]
    ds_read_b128 a[220:223], v3 offset:6144
    v_mfma_f32_16x16x32_bf16 v[152:155], a[68:71], a[44:47], v[152:155]
    s_add_u32 m0, s29, 90112
    ds_read_b128 a[116:119], v5 offset:45056
    v_mfma_f32_16x16x32_bf16 v[152:155], a[64:67], a[40:43], v[152:155]
    buffer_load_dwordx4 v2, s[16:19], s53 offen lds
    v_mfma_f32_16x16x32_bf16 v[160:163], a[64:67], a[48:51], v[160:163]
    v_mfma_f32_16x16x32_bf16 v[160:163], a[68:71], a[52:55], v[160:163]
    ds_read_b128 a[124:127], v5 offset:47104
    v_mfma_f32_16x16x32_bf16 v[164:167], a[76:79], a[52:55], v[164:167]
    v_mfma_f32_16x16x32_bf16 v[164:167], a[72:75], a[48:51], v[164:167]
    s_add_u32 m0, s29, 94208
    ds_read_b128 a[120:123], v4 offset:47104
    v_mfma_f32_16x16x32_bf16 v[168:171], a[80:83], a[48:51], v[168:171]
    buffer_load_dwordx4 v2, s[16:19], s54 offen lds
    v_mfma_f32_16x16x32_bf16 v[168:171], a[84:87], a[52:55], v[168:171]
    v_mfma_f32_16x16x32_bf16 v[172:175], a[92:95], a[52:55], v[172:175]
    v_mfma_f32_16x16x32_bf16 v[172:175], a[88:91], a[48:51], v[172:175]
    ds_read_b64_tr_b16 a[8:9], v7 offset:32768
    v_mfma_f32_16x16x32_bf16 v[180:183], a[88:91], a[56:59], v[180:183]
    v_mfma_f32_16x16x32_bf16 v[180:183], a[92:95], a[60:63], v[180:183]
    ds_read_b64_tr_b16 a[10:11], v7 offset:36864
    v_mfma_f32_16x16x32_bf16 v[176:179], a[84:87], a[60:63], v[176:179]
    ds_read_b64_tr_b16 a[12:13], v7 offset:49152
    v_mfma_f32_16x16x32_bf16 v[176:179], a[80:83], a[56:59], v[176:179]
    ds_read_b64_tr_b16 a[14:15], v7 offset:53248
    v_mfma_f32_16x16x32_bf16 v[188:191], a[72:75], a[56:59], v[188:191]
    ds_read_b64_tr_b16 a[16:17], v8 offset:32768
    v_mfma_f32_16x16x32_bf16 v[188:191], a[76:79], a[60:63], v[188:191]
    ds_read_b64_tr_b16 a[18:19], v8 offset:36864
    v_mfma_f32_16x16x32_bf16 v[184:187], a[68:71], a[60:63], v[184:187]
    ds_read_b64_tr_b16 a[20:21], v8 offset:49152
    v_mfma_f32_16x16x32_bf16 v[184:187], a[64:67], a[56:59], v[184:187]
    s_waitcnt lgkmcnt(15)
    ds_read_b64_tr_b16 a[22:23], v8 offset:53248
    v_mfma_f32_16x16x32_bf16 v[16:19], a[96:99], a[0:3], v[16:19]
    ds_read_b64_tr_b16 a[24:25], v9 offset:32768
    v_mfma_f32_16x16x32_bf16 v[16:19], a[100:103], a[4:7], v[16:19]
    s_add_u32 m0, s33, 0xfffffd00
    ds_read_b64_tr_b16 a[26:27], v9 offset:36864
    v_mfma_f32_16x16x32_bf16 v[20:23], a[108:111], a[4:7], v[20:23]
    s_waitcnt lgkmcnt(13)
    ds_read_b64_tr_b16 a[28:29], v9 offset:49152
    v_mfma_f32_16x16x32_bf16 v[20:23], a[104:107], a[0:3], v[20:23]
    ds_read_b64_tr_b16 a[30:31], v9 offset:53248
    buffer_load_dwordx4 v15, s[20:23], 0 offen offset:768 lds
    v_mfma_f32_16x16x32_bf16 v[24:27], a[112:115], a[0:3], v[24:27]
    s_waitcnt lgkmcnt(12)
    ds_read_b128 a[64:67], v4 offset:32768
    v_mfma_f32_16x16x32_bf16 v[24:27], a[116:119], a[4:7], v[24:27]
    v_mfma_f32_16x16x32_bf16 v[28:31], a[124:127], a[4:7], v[28:31]
    s_add_u32 m0, s33, 0xfffffd80
    ds_read_b128 a[68:71], v5 offset:32768
    v_mfma_f32_16x16x32_bf16 v[28:31], a[120:123], a[0:3], v[28:31]
    s_waitcnt lgkmcnt(10)
    buffer_load_dwordx4 v15, s[20:23], 0 offen offset:1664 lds
    v_mfma_f32_16x16x32_bf16 a[228:231], a[120:123], a[8:11], a[228:231]
    ds_read_b128 a[76:79], v5 offset:34816
    v_mfma_f32_16x16x32_bf16 a[228:231], a[124:127], a[12:15], a[228:231]
    v_mfma_f32_16x16x32_bf16 a[224:227], a[116:119], a[12:15], a[224:227]
    s_add_u32 m0, s33, 0x500
    ds_read_b128 a[72:75], v4 offset:34816
    v_mfma_f32_16x16x32_bf16 a[224:227], a[112:115], a[8:11], a[224:227]
    buffer_load_dwordx4 v15, s[20:23], s57 offen offset:768 lds
    v_mfma_f32_16x16x32_bf16 a[236:239], a[104:107], a[8:11], a[236:239]
    ds_read_b128 a[80:83], v4 offset:36864
    v_cvt_pk_bf16_f32 v16, v16, v17
    v_mfma_f32_16x16x32_bf16 a[236:239], a[108:111], a[12:15], a[236:239]
    v_cvt_pk_bf16_f32 v17, v18, v19
    v_cvt_pk_bf16_f32 v18, v20, v21
    v_mfma_f32_16x16x32_bf16 a[232:235], a[100:103], a[12:15], a[232:235]
    s_add_u32 m0, s33, 0x580
    ds_read_b128 a[84:87], v5 offset:36864
    v_cvt_pk_bf16_f32 v19, v22, v23
    v_mfma_f32_16x16x32_bf16 a[232:235], a[96:99], a[8:11], a[232:235]
    s_waitcnt lgkmcnt(10)
    buffer_load_dwordx4 v15, s[20:23], s57 offen offset:1664 lds
    v_mfma_f32_16x16x32_bf16 v[32:35], a[96:99], a[16:19], v[32:35]
    ds_read_b128 a[92:95], v5 offset:38912
    v_cvt_pk_bf16_f32 v24, v24, v25
    v_mfma_f32_16x16x32_bf16 v[32:35], a[100:103], a[20:23], v[32:35]
    v_cvt_pk_bf16_f32 v25, v26, v27
    v_cvt_pk_bf16_f32 v26, v28, v29
    v_mfma_f32_16x16x32_bf16 v[36:39], a[108:111], a[20:23], v[36:39]
    ds_read_b128 a[88:91], v4 offset:38912
    v_cvt_pk_bf16_f32 v27, v30, v31
    v_mfma_f32_16x16x32_bf16 v[36:39], a[104:107], a[16:19], v[36:39]
    v_accvgpr_read_b32 v20, a224
    v_accvgpr_read_b32 v21, a225
    v_mfma_f32_16x16x32_bf16 v[40:43], a[112:115], a[16:19], v[40:43]
    ds_read_b64_tr_b16 a[32:33], v10 offset:32768
    v_accvgpr_read_b32 v22, a226
    v_mfma_f32_16x16x32_bf16 v[40:43], a[116:119], a[20:23], v[40:43]
    ds_read_b64_tr_b16 a[34:35], v10 offset:36864
    v_accvgpr_read_b32 v23, a227
    v_mfma_f32_16x16x32_bf16 v[44:47], a[124:127], a[20:23], v[44:47]
    ds_read_b64_tr_b16 a[36:37], v10 offset:49152
    v_accvgpr_read_b32 v28, a228
    v_mfma_f32_16x16x32_bf16 v[44:47], a[120:123], a[16:19], v[44:47]
    s_waitcnt lgkmcnt(11)
    ds_read_b64_tr_b16 a[38:39], v10 offset:53248
    v_accvgpr_read_b32 v29, a229
    v_mfma_f32_16x16x32_bf16 v[52:55], a[120:123], a[24:27], v[52:55]
    ds_read_b64_tr_b16 a[40:41], v11 offset:32768
    v_accvgpr_read_b32 v30, a230
    v_mfma_f32_16x16x32_bf16 v[52:55], a[124:127], a[28:31], v[52:55]
    ds_read_b64_tr_b16 a[42:43], v11 offset:36864
    v_accvgpr_read_b32 v31, a231
    v_mfma_f32_16x16x32_bf16 v[48:51], a[116:119], a[28:31], v[48:51]
    ds_read_b64_tr_b16 a[44:45], v11 offset:49152
    v_cvt_pk_bf16_f32 v20, v20, v21
    v_mfma_f32_16x16x32_bf16 v[48:51], a[112:115], a[24:27], v[48:51]
    ds_read_b64_tr_b16 a[46:47], v11 offset:53248
    v_cvt_pk_bf16_f32 v21, v22, v23
    v_mfma_f32_16x16x32_bf16 v[60:63], a[104:107], a[24:27], v[60:63]
    ds_read_b64_tr_b16 a[48:49], v12 offset:32768
    v_cvt_pk_bf16_f32 v22, v28, v29
    v_mfma_f32_16x16x32_bf16 v[60:63], a[108:111], a[28:31], v[60:63]
    ds_read_b64_tr_b16 a[50:51], v12 offset:36864
    v_cvt_pk_bf16_f32 v23, v30, v31
    v_mfma_f32_16x16x32_bf16 v[56:59], a[100:103], a[28:31], v[56:59]
    ds_read_b64_tr_b16 a[52:53], v12 offset:49152
    v_cvt_pk_bf16_f32 v32, v32, v33
    v_mfma_f32_16x16x32_bf16 v[56:59], a[96:99], a[24:27], v[56:59]
    s_waitcnt lgkmcnt(15)
    ds_read_b64_tr_b16 a[54:55], v12 offset:53248
    v_cvt_pk_bf16_f32 v33, v34, v35
    v_mfma_f32_16x16x32_bf16 v[64:67], a[64:67], a[0:3], v[64:67]
    ds_read_b64_tr_b16 a[56:57], v13 offset:32768
    v_cvt_pk_bf16_f32 v34, v36, v37
    v_mfma_f32_16x16x32_bf16 v[64:67], a[68:71], a[4:7], v[64:67]
    ds_read_b64_tr_b16 a[58:59], v13 offset:36864
    v_cvt_pk_bf16_f32 v35, v38, v39
    v_mfma_f32_16x16x32_bf16 v[68:71], a[76:79], a[4:7], v[68:71]
    ds_read_b64_tr_b16 a[60:61], v13 offset:49152
    v_cvt_pk_bf16_f32 v40, v40, v41
    v_mfma_f32_16x16x32_bf16 v[68:71], a[72:75], a[0:3], v[68:71]
    s_waitcnt lgkmcnt(15)
    ds_read_b64_tr_b16 a[62:63], v13 offset:53248
    v_cvt_pk_bf16_f32 v41, v42, v43
    v_mfma_f32_16x16x32_bf16 v[72:75], a[80:83], a[0:3], v[72:75]
    v_cvt_pk_bf16_f32 v42, v44, v45
    v_cvt_pk_bf16_f32 v43, v46, v47
    v_mfma_f32_16x16x32_bf16 v[72:75], a[84:87], a[4:7], v[72:75]
    v_accvgpr_read_b32 v36, a232
    v_accvgpr_read_b32 v37, a233
    v_mfma_f32_16x16x32_bf16 v[76:79], a[92:95], a[4:7], v[76:79]
    v_accvgpr_read_b32 v38, a234
    v_accvgpr_read_b32 v39, a235
    v_mfma_f32_16x16x32_bf16 v[76:79], a[88:91], a[0:3], v[76:79]
    s_waitcnt lgkmcnt(0)
    v_accvgpr_read_b32 v44, a236
    v_accvgpr_read_b32 v45, a237
    v_mfma_f32_16x16x32_bf16 v[84:87], a[88:91], a[8:11], v[84:87]
    s_barrier
    v_xor_b32 v6, s60, v6
    v_accvgpr_read_b32 v46, a238
    v_mfma_f32_16x16x32_bf16 v[84:87], a[92:95], a[12:15], v[84:87]
    s_add_u32 m0, s29, 32768
    v_add_u32 v2, 0x80000, v2
    v_accvgpr_read_b32 v47, a239
    v_mfma_f32_16x16x32_bf16 v[80:83], a[84:87], a[12:15], v[80:83]
    buffer_load_dwordx4 v2, s[16:19], 0 offen lds
    v_mfma_f32_16x16x32_bf16 v[80:83], a[80:83], a[8:11], v[80:83]
    s_add_u32 s59, s58, 49152
    v_cvt_pk_bf16_f32 v36, v36, v37
    v_cvt_pk_bf16_f32 v37, v38, v39
    v_mfma_f32_16x16x32_bf16 v[92:95], a[72:75], a[8:11], v[92:95]
    buffer_store_dwordx4 v[20:23], v1, s[12:15], s59 offen offset:1024 sc1
    v_mfma_f32_16x16x32_bf16 v[92:95], a[76:79], a[12:15], v[92:95]
    v_cvt_pk_bf16_f32 v38, v44, v45
    v_cvt_pk_bf16_f32 v39, v46, v47
    v_mfma_f32_16x16x32_bf16 v[88:91], a[68:71], a[12:15], v[88:91]
    s_add_u32 m0, s29, 36864
    v_cvt_pk_bf16_f32 v48, v48, v49
    v_cvt_pk_bf16_f32 v49, v50, v51
    v_mfma_f32_16x16x32_bf16 v[88:91], a[64:67], a[8:11], v[88:91]
    buffer_load_dwordx4 v2, s[16:19], s48 offen lds
    v_mfma_f32_16x16x32_bf16 v[96:99], a[64:67], a[16:19], v[96:99]
    v_cvt_pk_bf16_f32 v50, v52, v53
    v_cvt_pk_bf16_f32 v51, v54, v55
    v_mfma_f32_16x16x32_bf16 v[96:99], a[68:71], a[20:23], v[96:99]
    v_cvt_pk_bf16_f32 v56, v56, v57
    v_cvt_pk_bf16_f32 v57, v58, v59
    v_mfma_f32_16x16x32_bf16 v[100:103], a[76:79], a[20:23], v[100:103]
    v_cvt_pk_bf16_f32 v58, v60, v61
    v_cvt_pk_bf16_f32 v59, v62, v63
    v_mfma_f32_16x16x32_bf16 v[100:103], a[72:75], a[16:19], v[100:103]
    s_add_u32 m0, s29, 40960
    v_cvt_pk_bf16_f32 v64, v64, v65
    v_cvt_pk_bf16_f32 v65, v66, v67
    v_mfma_f32_16x16x32_bf16 v[104:107], a[80:83], a[16:19], v[104:107]
    buffer_load_dwordx4 v2, s[16:19], s49 offen lds
    v_mfma_f32_16x16x32_bf16 v[104:107], a[84:87], a[20:23], v[104:107]
    v_cvt_pk_bf16_f32 v66, v68, v69
    v_cvt_pk_bf16_f32 v67, v70, v71
    v_mfma_f32_16x16x32_bf16 v[108:111], a[92:95], a[20:23], v[108:111]
    v_cvt_pk_bf16_f32 v72, v72, v73
    v_cvt_pk_bf16_f32 v73, v74, v75
    v_mfma_f32_16x16x32_bf16 v[108:111], a[88:91], a[16:19], v[108:111]
    v_cvt_pk_bf16_f32 v74, v76, v77
    v_cvt_pk_bf16_f32 v75, v78, v79
    v_mfma_f32_16x16x32_bf16 v[116:119], a[88:91], a[24:27], v[116:119]
    s_add_u32 m0, s29, 45056
    v_cvt_pk_bf16_f32 v80, v80, v81
    v_cvt_pk_bf16_f32 v81, v82, v83
    v_mfma_f32_16x16x32_bf16 v[116:119], a[92:95], a[28:31], v[116:119]
    buffer_load_dwordx4 v2, s[16:19], s50 offen lds
    v_mfma_f32_16x16x32_bf16 v[112:115], a[84:87], a[28:31], v[112:115]
    s_add_u32 s59, s58, 32768
    v_cvt_pk_bf16_f32 v82, v84, v85
    v_cvt_pk_bf16_f32 v83, v86, v87
    v_mfma_f32_16x16x32_bf16 v[112:115], a[80:83], a[24:27], v[112:115]
    buffer_store_dwordx4 v[36:39], v1, s[12:15], s59 offen offset:1024 sc1
    v_mfma_f32_16x16x32_bf16 v[124:127], a[72:75], a[24:27], v[124:127]
    v_cvt_pk_bf16_f32 v88, v88, v89
    v_cvt_pk_bf16_f32 v89, v90, v91
    v_mfma_f32_16x16x32_bf16 v[124:127], a[76:79], a[28:31], v[124:127]
    s_add_u32 m0, s29, 49152
    v_cvt_pk_bf16_f32 v90, v92, v93
    v_cvt_pk_bf16_f32 v91, v94, v95
    v_mfma_f32_16x16x32_bf16 v[120:123], a[68:71], a[28:31], v[120:123]
    buffer_load_dwordx4 v2, s[16:19], s51 offen lds
    v_mfma_f32_16x16x32_bf16 v[120:123], a[64:67], a[24:27], v[120:123]
    v_cvt_pk_bf16_f32 v96, v96, v97
    v_cvt_pk_bf16_f32 v97, v98, v99
    v_mfma_f32_16x16x32_bf16 v[128:131], a[64:67], a[32:35], v[128:131]
    v_cvt_pk_bf16_f32 v98, v100, v101
    v_cvt_pk_bf16_f32 v99, v102, v103
    v_mfma_f32_16x16x32_bf16 v[128:131], a[68:71], a[36:39], v[128:131]
    v_cvt_pk_bf16_f32 v104, v104, v105
    v_cvt_pk_bf16_f32 v105, v106, v107
    v_mfma_f32_16x16x32_bf16 v[132:135], a[76:79], a[36:39], v[132:135]
    s_add_u32 m0, s29, 53248
    v_cvt_pk_bf16_f32 v106, v108, v109
    v_cvt_pk_bf16_f32 v107, v110, v111
    v_mfma_f32_16x16x32_bf16 v[132:135], a[72:75], a[32:35], v[132:135]
    buffer_load_dwordx4 v2, s[16:19], s52 offen lds
    v_mfma_f32_16x16x32_bf16 v[136:139], a[80:83], a[32:35], v[136:139]
    v_cvt_pk_bf16_f32 v112, v112, v113
    v_cvt_pk_bf16_f32 v113, v114, v115
    v_mfma_f32_16x16x32_bf16 v[136:139], a[84:87], a[36:39], v[136:139]
    v_cvt_pk_bf16_f32 v114, v116, v117
    v_cvt_pk_bf16_f32 v115, v118, v119
    v_mfma_f32_16x16x32_bf16 v[140:143], a[92:95], a[36:39], v[140:143]
    v_mfma_f32_16x16x32_bf16 v[140:143], a[88:91], a[32:35], v[140:143]
    s_add_u32 m0, s29, 57344
    v_cvt_pk_bf16_f32 v120, v120, v121
    v_cvt_pk_bf16_f32 v121, v122, v123
    v_mfma_f32_16x16x32_bf16 v[148:151], a[88:91], a[40:43], v[148:151]
    buffer_load_dwordx4 v2, s[16:19], s53 offen lds
    v_mfma_f32_16x16x32_bf16 v[148:151], a[92:95], a[44:47], v[148:151]
    s_add_u32 s59, s58, 32768
    v_cvt_pk_bf16_f32 v122, v124, v125
    v_cvt_pk_bf16_f32 v123, v126, v127
    v_mfma_f32_16x16x32_bf16 v[144:147], a[84:87], a[44:47], v[144:147]
    buffer_store_dwordx4 v[16:19], v1, s[12:15], s59 offen offset:0 sc1
    v_mfma_f32_16x16x32_bf16 v[144:147], a[80:83], a[40:43], v[144:147]
    v_cvt_pk_bf16_f32 v128, v128, v129
    v_cvt_pk_bf16_f32 v129, v130, v131
    v_mfma_f32_16x16x32_bf16 v[156:159], a[72:75], a[40:43], v[156:159]
    s_add_u32 m0, s29, 61440
    v_cvt_pk_bf16_f32 v130, v132, v133
    v_cvt_pk_bf16_f32 v131, v134, v135
    v_mfma_f32_16x16x32_bf16 v[156:159], a[76:79], a[44:47], v[156:159]
    buffer_load_dwordx4 v2, s[16:19], s54 offen lds
    v_mfma_f32_16x16x32_bf16 v[152:155], a[68:71], a[44:47], v[152:155]
    v_mfma_f32_16x16x32_bf16 v[152:155], a[64:67], a[40:43], v[152:155]
    v_cvt_pk_bf16_f32 v136, v136, v137
    v_cvt_pk_bf16_f32 v137, v138, v139
    v_mfma_f32_16x16x32_bf16 v[160:163], a[64:67], a[48:51], v[160:163]
    s_add_u32 m0, s29, 98304
    v_add_u32 v2, 0x80000, v2
    v_cvt_pk_bf16_f32 v138, v140, v141
    v_mfma_f32_16x16x32_bf16 v[160:163], a[68:71], a[52:55], v[160:163]
    buffer_load_dwordx4 v2, s[16:19], 0 offen lds
    v_mfma_f32_16x16x32_bf16 v[164:167], a[76:79], a[52:55], v[164:167]
    v_cvt_pk_bf16_f32 v139, v142, v143
    v_mfma_f32_16x16x32_bf16 v[164:167], a[72:75], a[48:51], v[164:167]
    v_cvt_pk_bf16_f32 v144, v144, v145
    v_cvt_pk_bf16_f32 v145, v146, v147
    v_mfma_f32_16x16x32_bf16 v[168:171], a[80:83], a[48:51], v[168:171]
    v_cvt_pk_bf16_f32 v146, v148, v149
    v_cvt_pk_bf16_f32 v147, v150, v151
    v_mfma_f32_16x16x32_bf16 v[168:171], a[84:87], a[52:55], v[168:171]
    s_add_u32 m0, s29, 102400
    v_mfma_f32_16x16x32_bf16 v[172:175], a[92:95], a[52:55], v[172:175]
    buffer_load_dwordx4 v2, s[16:19], s48 offen lds
    v_mfma_f32_16x16x32_bf16 v[172:175], a[88:91], a[48:51], v[172:175]
    s_add_u32 s59, s58, 49152
    v_cvt_pk_bf16_f32 v152, v152, v153
    v_cvt_pk_bf16_f32 v153, v154, v155
    v_mfma_f32_16x16x32_bf16 v[180:183], a[88:91], a[56:59], v[180:183]
    buffer_store_dwordx4 v[24:27], v1, s[12:15], s59 offen offset:0 sc1
    v_mfma_f32_16x16x32_bf16 v[180:183], a[92:95], a[60:63], v[180:183]
    v_cvt_pk_bf16_f32 v154, v156, v157
    v_cvt_pk_bf16_f32 v155, v158, v159
    v_mfma_f32_16x16x32_bf16 v[176:179], a[84:87], a[60:63], v[176:179]
    s_add_u32 m0, s29, 106496
    v_mfma_f32_16x16x32_bf16 v[176:179], a[80:83], a[56:59], v[176:179]
    buffer_load_dwordx4 v2, s[16:19], s49 offen lds
    v_mfma_f32_16x16x32_bf16 v[188:191], a[72:75], a[56:59], v[188:191]
    v_cvt_pk_bf16_f32 v160, v160, v161
    v_cvt_pk_bf16_f32 v161, v162, v163
    v_mfma_f32_16x16x32_bf16 v[188:191], a[76:79], a[60:63], v[188:191]
    v_cvt_pk_bf16_f32 v162, v164, v165
    v_cvt_pk_bf16_f32 v163, v166, v167
    v_mfma_f32_16x16x32_bf16 v[184:187], a[68:71], a[60:63], v[184:187]
    v_mfma_f32_16x16x32_bf16 v[184:187], a[64:67], a[56:59], v[184:187]
    s_add_u32 m0, s29, 110592
    v_cvt_pk_bf16_f32 v168, v168, v169
    v_cvt_pk_bf16_f32 v169, v170, v171
    v_mfma_f32_16x16x32_bf16 v[192:195], a[96:99], a[32:35], v[192:195]
    buffer_load_dwordx4 v2, s[16:19], s50 offen lds
    v_mfma_f32_16x16x32_bf16 v[192:195], a[100:103], a[36:39], v[192:195]
    v_cvt_pk_bf16_f32 v170, v172, v173
    v_cvt_pk_bf16_f32 v171, v174, v175
    v_mfma_f32_16x16x32_bf16 v[196:199], a[108:111], a[36:39], v[196:199]
    v_mfma_f32_16x16x32_bf16 v[196:199], a[104:107], a[32:35], v[196:199]
    v_cvt_pk_bf16_f32 v176, v176, v177
    v_cvt_pk_bf16_f32 v177, v178, v179
    v_mfma_f32_16x16x32_bf16 v[200:203], a[112:115], a[32:35], v[200:203]
    s_add_u32 m0, s29, 114688
    v_cvt_pk_bf16_f32 v178, v180, v181
    v_cvt_pk_bf16_f32 v179, v182, v183
    v_mfma_f32_16x16x32_bf16 v[200:203], a[116:119], a[36:39], v[200:203]
    buffer_load_dwordx4 v2, s[16:19], s51 offen lds
    v_mfma_f32_16x16x32_bf16 v[204:207], a[124:127], a[36:39], v[204:207]
    s_add_u32 s59, s58, 32768
    v_mfma_f32_16x16x32_bf16 v[204:207], a[120:123], a[32:35], v[204:207]
    buffer_store_dwordx4 v[32:35], v1, s[12:15], s59 offen offset:2048 sc1
    v_mfma_f32_16x16x32_bf16 v[212:215], a[120:123], a[40:43], v[212:215]
    v_cvt_pk_bf16_f32 v184, v184, v185
    v_cvt_pk_bf16_f32 v185, v186, v187
    v_mfma_f32_16x16x32_bf16 v[212:215], a[124:127], a[44:47], v[212:215]
    s_add_u32 m0, s29, 118784
    v_cvt_pk_bf16_f32 v186, v188, v189
    v_cvt_pk_bf16_f32 v187, v190, v191
    v_mfma_f32_16x16x32_bf16 v[208:211], a[116:119], a[44:47], v[208:211]
    buffer_load_dwordx4 v2, s[16:19], s52 offen lds
    v_mfma_f32_16x16x32_bf16 v[208:211], a[112:115], a[40:43], v[208:211]
    v_cvt_pk_bf16_f32 v192, v192, v193
    v_cvt_pk_bf16_f32 v193, v194, v195
    v_mfma_f32_16x16x32_bf16 v[220:223], a[104:107], a[40:43], v[220:223]
    v_cvt_pk_bf16_f32 v194, v196, v197
    v_cvt_pk_bf16_f32 v195, v198, v199
    v_mfma_f32_16x16x32_bf16 v[220:223], a[108:111], a[44:47], v[220:223]
    v_mfma_f32_16x16x32_bf16 v[216:219], a[100:103], a[44:47], v[216:219]
    s_add_u32 m0, s29, 122880
    v_mfma_f32_16x16x32_bf16 v[216:219], a[96:99], a[40:43], v[216:219]
    buffer_load_dwordx4 v2, s[16:19], s53 offen lds
    v_mfma_f32_16x16x32_bf16 v[224:227], a[96:99], a[48:51], v[224:227]
    v_cvt_pk_bf16_f32 v200, v200, v201
    v_cvt_pk_bf16_f32 v201, v202, v203
    v_mfma_f32_16x16x32_bf16 v[224:227], a[100:103], a[52:55], v[224:227]
    s_waitcnt vmcnt(20)
    v_cvt_pk_bf16_f32 v202, v204, v205
    v_cvt_pk_bf16_f32 v203, v206, v207
    v_mfma_f32_16x16x32_bf16 v[228:231], a[108:111], a[52:55], v[228:231]
    s_barrier
    v_xor_b32 v7, 0, v6
    v_mfma_f32_16x16x32_bf16 v[228:231], a[104:107], a[48:51], v[228:231]
    s_add_u32 m0, s29, 126976
    ds_read_b64_tr_b16 a[64:65], v7 offset:0
    v_cvt_pk_bf16_f32 v208, v208, v209
    v_mfma_f32_16x16x32_bf16 v[232:235], a[112:115], a[48:51], v[232:235]
    ds_read_b64_tr_b16 a[66:67], v7 offset:4096
    buffer_load_dwordx4 v2, s[16:19], s54 offen lds
    v_mfma_f32_16x16x32_bf16 v[232:235], a[116:119], a[52:55], v[232:235]
    ds_read_b64_tr_b16 a[68:69], v7 offset:16384
    v_cvt_pk_bf16_f32 v209, v210, v211
    v_mfma_f32_16x16x32_bf16 v[236:239], a[124:127], a[52:55], v[236:239]
    s_add_u32 s59, s58, 49152
    ds_read_b64_tr_b16 a[70:71], v7 offset:20480
    v_xor_b32 v8, 65536, v6
    v_mfma_f32_16x16x32_bf16 v[236:239], a[120:123], a[48:51], v[236:239]
    ds_read_b64_tr_b16 a[72:73], v8 offset:0
    buffer_store_dwordx4 v[40:43], v1, s[12:15], s59 offen offset:2048 sc1
    v_mfma_f32_16x16x32_bf16 v[244:247], a[120:123], a[56:59], v[244:247]
    ds_read_b64_tr_b16 a[74:75], v8 offset:4096
    v_cvt_pk_bf16_f32 v210, v212, v213
    v_mfma_f32_16x16x32_bf16 v[244:247], a[124:127], a[60:63], v[244:247]
    ds_read_b64_tr_b16 a[76:77], v8 offset:16384
    v_cvt_pk_bf16_f32 v211, v214, v215
    v_mfma_f32_16x16x32_bf16 v[240:243], a[116:119], a[60:63], v[240:243]
    ds_read_b64_tr_b16 a[78:79], v8 offset:20480
    v_xor_b32 v9, 32, v6
    v_mfma_f32_16x16x32_bf16 v[240:243], a[112:115], a[56:59], v[240:243]
    ds_read_b64_tr_b16 a[80:81], v9 offset:0
    v_cvt_pk_bf16_f32 v216, v216, v217
    v_mfma_f32_16x16x32_bf16 v[252:255], a[104:107], a[56:59], v[252:255]
    ds_read_b64_tr_b16 a[82:83], v9 offset:4096
    v_cvt_pk_bf16_f32 v217, v218, v219
    v_mfma_f32_16x16x32_bf16 v[252:255], a[108:111], a[60:63], v[252:255]
    ds_read_b64_tr_b16 a[84:85], v9 offset:16384
    v_cvt_pk_bf16_f32 v218, v220, v221
    v_mfma_f32_16x16x32_bf16 v[248:251], a[100:103], a[60:63], v[248:251]
    ds_read_b64_tr_b16 a[86:87], v9 offset:20480
    v_xor_b32 v10, 65568, v6
    v_mfma_f32_16x16x32_bf16 v[248:251], a[96:99], a[56:59], v[248:251]
    s_waitcnt lgkmcnt(6)
    ds_read_b64_tr_b16 a[88:89], v10 offset:0
    v_cvt_pk_bf16_f32 v219, v222, v223
    v_mfma_f32_16x16x32_bf16 v[28:31], a[64:67], a[128:131], 0
    ds_read_b64_tr_b16 a[90:91], v10 offset:4096
    v_cvt_pk_bf16_f32 v224, v224, v225
    v_mfma_f32_16x16x32_bf16 v[28:31], a[68:71], a[136:139], v[28:31]
    s_add_u32 s59, s58, 49152
    ds_read_b64_tr_b16 a[92:93], v10 offset:16384
    v_xor_b32 v7, 64, v6
    v_mfma_f32_16x16x32_bf16 v[28:31], a[72:75], a[144:147], v[28:31]
    s_waitcnt lgkmcnt(7)
    ds_read_b128 a[112:115], v14 offset:0
    ds_read_b64_tr_b16 a[94:95], v10 offset:20480
    v_mfma_f32_16x16x32_bf16 v[28:31], a[76:79], a[152:155], v[28:31]
    ds_read_b64_tr_b16 a[96:97], v7 offset:0
    buffer_store_dwordx4 v[48:51], v1, s[12:15], s59 offen offset:3072 sc1
    v_mfma_f32_16x16x32_bf16 v[44:47], a[64:67], a[132:135], 0
    ds_read_b128 a[120:123], v3 offset:0
    ds_read_b64_tr_b16 a[98:99], v7 offset:4096
    v_mfma_f32_16x16x32_bf16 v[44:47], a[68:71], a[140:143], v[44:47]
    ds_read_b64_tr_b16 a[100:101], v7 offset:16384
    v_xor_b32 v8, 65600, v6
    v_mfma_f32_16x16x32_bf16 v[44:47], a[72:75], a[148:151], v[44:47]
    ds_read_b128 a[116:119], v14 offset:2048
    ds_read_b64_tr_b16 a[102:103], v7 offset:20480
    v_mfma_f32_16x16x32_bf16 v[44:47], a[76:79], a[156:159], v[44:47]
    s_waitcnt lgkmcnt(9)
    ds_read_b64_tr_b16 a[104:105], v8 offset:0
    v_cvt_pk_bf16_f32 v225, v226, v227
    v_mfma_f32_16x16x32_bf16 v[52:55], a[80:83], a[128:131], 0
    ds_read_b128 a[124:127], v3 offset:2048
    ds_read_b64_tr_b16 a[106:107], v8 offset:4096
    v_mfma_f32_16x16x32_bf16 v[52:55], a[84:87], a[136:139], v[52:55]
    ds_read_b64_tr_b16 a[108:109], v8 offset:16384
    v_cvt_pk_bf16_f32 v226, v228, v229
    v_mfma_f32_16x16x32_bf16 v[52:55], a[88:91], a[144:147], v[52:55]
    s_waitcnt lgkmcnt(10)
    ds_read_b64_tr_b16 a[110:111], v8 offset:20480
    v_xor_b32 v9, 96, v6
    v_mfma_f32_16x16x32_bf16 v[52:55], a[92:95], a[152:155], v[52:55]
    ds_read_b64_tr_b16 a[64:65], v9 offset:0
    v_cvt_pk_bf16_f32 v227, v230, v231
    v_mfma_f32_16x16x32_bf16 v[60:63], a[80:83], a[132:135], 0
    ds_read_b64_tr_b16 a[66:67], v9 offset:4096
    v_cvt_pk_bf16_f32 v232, v232, v233
    v_mfma_f32_16x16x32_bf16 v[60:63], a[84:87], a[140:143], v[60:63]
    ds_read_b64_tr_b16 a[68:69], v9 offset:16384
    v_cvt_pk_bf16_f32 v233, v234, v235
    v_mfma_f32_16x16x32_bf16 v[60:63], a[88:91], a[148:151], v[60:63]
    s_add_u32 s59, s58, 32768
    ds_read_b64_tr_b16 a[70:71], v9 offset:20480
    v_xor_b32 v10, 65632, v6
    v_mfma_f32_16x16x32_bf16 v[60:63], a[92:95], a[156:159], v[60:63]
    s_waitcnt lgkmcnt(6)
    ds_read_b64_tr_b16 a[72:73], v10 offset:0
    buffer_store_dwordx4 v[56:59], v1, s[12:15], s59 offen offset:3072 sc1
    v_mfma_f32_16x16x32_bf16 v[20:23], a[96:99], a[128:131], 0
    ds_read_b64_tr_b16 a[74:75], v10 offset:4096
    v_cvt_pk_bf16_f32 v234, v236, v237
    v_mfma_f32_16x16x32_bf16 v[20:23], a[100:103], a[136:139], v[20:23]
    s_waitcnt lgkmcnt(8)
    ds_read_b64_tr_b16 a[76:77], v10 offset:16384
    v_xor_b32 v7, 128, v6
    v_mfma_f32_16x16x32_bf16 v[20:23], a[104:107], a[144:147], v[20:23]
    s_waitcnt lgkmcnt(7)
    s_barrier
    ds_read_b64_tr_b16 a[78:79], v10 offset:20480
    v_mfma_f32_16x16x32_bf16 v[20:23], a[108:111], a[152:155], v[20:23]
    s_add_u32 m0, s29, 131072
    ds_read_b64_tr_b16 a[80:81], v7 offset:0
    v_add_u32 v2, 0x80000, v2
    v_mfma_f32_16x16x32_bf16 v[36:39], a[96:99], a[132:135], 0
    ds_read_b64_tr_b16 a[82:83], v7 offset:4096
    buffer_load_dwordx4 v2, s[16:19], 0 offen lds
    v_mfma_f32_16x16x32_bf16 v[36:39], a[100:103], a[140:143], v[36:39]
    ds_read_b64_tr_b16 a[84:85], v7 offset:16384
    v_cvt_pk_bf16_f32 v235, v238, v239
    v_mfma_f32_16x16x32_bf16 v[36:39], a[104:107], a[148:151], v[36:39]
    ds_read_b64_tr_b16 a[86:87], v7 offset:20480
    v_xor_b32 v8, 65664, v6
    v_mfma_f32_16x16x32_bf16 v[36:39], a[108:111], a[156:159], v[36:39]
    s_waitcnt lgkmcnt(6)
    ds_read_b64_tr_b16 a[88:89], v8 offset:0
    v_cvt_pk_bf16_f32 v240, v240, v241
    v_mfma_f32_16x16x32_bf16 v[68:71], a[64:67], a[128:131], 0
    ds_read_b64_tr_b16 a[90:91], v8 offset:4096
    v_cvt_pk_bf16_f32 v241, v242, v243
    v_mfma_f32_16x16x32_bf16 v[68:71], a[68:71], a[136:139], v[68:71]
    s_add_u32 m0, s29, 135168
    ds_read_b64_tr_b16 a[92:93], v8 offset:16384
    v_cvt_pk_bf16_f32 v242, v244, v245
    v_mfma_f32_16x16x32_bf16 v[68:71], a[72:75], a[144:147], v[68:71]
    s_waitcnt lgkmcnt(7)
    ds_read_b64_tr_b16 a[94:95], v8 offset:20480
    v_xor_b32 v9, 160, v6
    v_mfma_f32_16x16x32_bf16 v[68:71], a[76:79], a[152:155], v[68:71]
    ds_read_b64_tr_b16 a[96:97], v9 offset:0
    buffer_load_dwordx4 v2, s[16:19], s48 offen lds
    v_mfma_f32_16x16x32_bf16 v[76:79], a[64:67], a[132:135], 0
    s_add_u32 s59, s58, 0
    ds_read_b64_tr_b16 a[98:99], v9 offset:4096
    v_cvt_pk_bf16_f32 v243, v246, v247
    v_mfma_f32_16x16x32_bf16 v[76:79], a[68:71], a[140:143], v[76:79]
    ds_read_b64_tr_b16 a[100:101], v9 offset:16384
    buffer_store_dwordx4 v[64:67], v1, s[12:15], s59 offen offset:0 sc1
    v_mfma_f32_16x16x32_bf16 v[76:79], a[72:75], a[148:151], v[76:79]
    ds_read_b64_tr_b16 a[102:103], v9 offset:20480
    v_xor_b32 v10, 65696, v6
    v_mfma_f32_16x16x32_bf16 v[76:79], a[76:79], a[156:159], v[76:79]
    s_waitcnt lgkmcnt(6)
    ds_read_b64_tr_b16 a[104:105], v10 offset:0
    v_cvt_pk_bf16_f32 v248, v248, v249
    v_mfma_f32_16x16x32_bf16 v[84:87], a[80:83], a[128:131], 0
    s_add_u32 m0, s29, 139264
    ds_read_b64_tr_b16 a[106:107], v10 offset:4096
    v_cvt_pk_bf16_f32 v249, v250, v251
    v_mfma_f32_16x16x32_bf16 v[84:87], a[84:87], a[136:139], v[84:87]
    ds_read_b64_tr_b16 a[108:109], v10 offset:16384
    buffer_load_dwordx4 v2, s[16:19], s49 offen lds
    v_mfma_f32_16x16x32_bf16 v[84:87], a[88:91], a[144:147], v[84:87]
    s_waitcnt lgkmcnt(7)
    ds_read_b64_tr_b16 a[110:111], v10 offset:20480
    v_xor_b32 v7, 192, v6
    v_mfma_f32_16x16x32_bf16 v[84:87], a[92:95], a[152:155], v[84:87]
    ds_read_b64_tr_b16 a[64:65], v7 offset:0
    v_cvt_pk_bf16_f32 v250, v252, v253
    v_mfma_f32_16x16x32_bf16 v[92:95], a[80:83], a[132:135], 0
    ds_read_b64_tr_b16 a[66:67], v7 offset:4096
    v_cvt_pk_bf16_f32 v251, v254, v255
    v_mfma_f32_16x16x32_bf16 v[92:95], a[84:87], a[140:143], v[92:95]
    ds_read_b64_tr_b16 a[68:69], v7 offset:16384
    v_mov_b32 v11, 1
    v_mfma_f32_16x16x32_bf16 v[92:95], a[88:91], a[148:151], v[92:95]
    s_add_u32 m0, s29, 143360
    ds_read_b64_tr_b16 a[70:71], v7 offset:20480
    v_xor_b32 v8, 65728, v6
    v_mfma_f32_16x16x32_bf16 v[92:95], a[92:95], a[156:159], v[92:95]
    s_waitcnt lgkmcnt(6)
    ds_read_b64_tr_b16 a[72:73], v8 offset:0
    buffer_load_dwordx4 v2, s[16:19], s50 offen lds
    v_mfma_f32_16x16x32_bf16 v[100:103], a[96:99], a[128:131], 0
    s_add_u32 s59, s58, 16384
    ds_read_b64_tr_b16 a[74:75], v8 offset:4096
    v_mfma_f32_16x16x32_bf16 v[100:103], a[100:103], a[136:139], v[100:103]
    ds_read_b64_tr_b16 a[76:77], v8 offset:16384
    buffer_store_dwordx4 v[72:75], v1, s[12:15], s59 offen offset:0 sc1
    v_mfma_f32_16x16x32_bf16 v[100:103], a[104:107], a[144:147], v[100:103]
    s_waitcnt lgkmcnt(7)
    ds_read_b64_tr_b16 a[78:79], v8 offset:20480
    v_xor_b32 v9, 224, v6
    v_mfma_f32_16x16x32_bf16 v[100:103], a[108:111], a[152:155], v[100:103]
    ds_read_b64_tr_b16 a[80:81], v9 offset:0
    v_mfma_f32_16x16x32_bf16 v[108:111], a[96:99], a[132:135], 0
    s_add_u32 m0, s29, 147456
    ds_read_b64_tr_b16 a[82:83], v9 offset:4096
    v_mfma_f32_16x16x32_bf16 v[108:111], a[100:103], a[140:143], v[108:111]
    ds_read_b64_tr_b16 a[84:85], v9 offset:16384
    buffer_load_dwordx4 v2, s[16:19], s51 offen lds
    v_mfma_f32_16x16x32_bf16 v[108:111], a[104:107], a[148:151], v[108:111]
    ds_read_b64_tr_b16 a[86:87], v9 offset:20480
    v_xor_b32 v10, 65760, v6
    v_mfma_f32_16x16x32_bf16 v[108:111], a[108:111], a[156:159], v[108:111]
    s_waitcnt lgkmcnt(6)
    ds_read_b64_tr_b16 a[88:89], v10 offset:0
    v_mfma_f32_16x16x32_bf16 v[116:119], a[64:67], a[128:131], 0
    ds_read_b64_tr_b16 a[90:91], v10 offset:4096
    v_mfma_f32_16x16x32_bf16 v[116:119], a[68:71], a[136:139], v[116:119]
    s_add_u32 m0, s29, 151552
    ds_read_b64_tr_b16 a[92:93], v10 offset:16384
    v_mfma_f32_16x16x32_bf16 v[116:119], a[72:75], a[144:147], v[116:119]
    s_waitcnt lgkmcnt(7)
    ds_read_b64_tr_b16 a[94:95], v10 offset:20480
    v_xor_b32 v7, 256, v6
    v_mfma_f32_16x16x32_bf16 v[116:119], a[76:79], a[152:155], v[116:119]
    ds_read_b64_tr_b16 a[96:97], v7 offset:0
    buffer_load_dwordx4 v2, s[16:19], s52 offen lds
    v_mfma_f32_16x16x32_bf16 v[124:127], a[64:67], a[132:135], 0
    s_add_u32 s59, s58, 16384
    ds_read_b64_tr_b16 a[98:99], v7 offset:4096
    v_mfma_f32_16x16x32_bf16 v[124:127], a[68:71], a[140:143], v[124:127]
    ds_read_b64_tr_b16 a[100:101], v7 offset:16384
    buffer_store_dwordx4 v[80:83], v1, s[12:15], s59 offen offset:1024 sc1
    v_mfma_f32_16x16x32_bf16 v[124:127], a[72:75], a[148:151], v[124:127]
    ds_read_b64_tr_b16 a[102:103], v7 offset:20480
    v_xor_b32 v8, 65792, v6
    v_mfma_f32_16x16x32_bf16 v[124:127], a[76:79], a[156:159], v[124:127]
    s_waitcnt lgkmcnt(6)
    ds_read_b64_tr_b16 a[104:105], v8 offset:0
    v_mfma_f32_16x16x32_bf16 v[132:135], a[80:83], a[128:131], 0
    s_add_u32 m0, s29, 155648
    ds_read_b64_tr_b16 a[106:107], v8 offset:4096
    v_mfma_f32_16x16x32_bf16 v[132:135], a[84:87], a[136:139], v[132:135]
    ds_read_b64_tr_b16 a[108:109], v8 offset:16384
    buffer_load_dwordx4 v2, s[16:19], s53 offen lds
    v_mfma_f32_16x16x32_bf16 v[132:135], a[88:91], a[144:147], v[132:135]
    s_waitcnt lgkmcnt(7)
    ds_read_b64_tr_b16 a[110:111], v8 offset:20480
    v_xor_b32 v9, 288, v6
    v_mfma_f32_16x16x32_bf16 v[132:135], a[92:95], a[152:155], v[132:135]
    ds_read_b64_tr_b16 a[64:65], v9 offset:0
    v_mfma_f32_16x16x32_bf16 v[140:143], a[80:83], a[132:135], 0
    ds_read_b64_tr_b16 a[66:67], v9 offset:4096
    v_mfma_f32_16x16x32_bf16 v[140:143], a[84:87], a[140:143], v[140:143]
    ds_read_b64_tr_b16 a[68:69], v9 offset:16384
    v_mfma_f32_16x16x32_bf16 v[140:143], a[88:91], a[148:151], v[140:143]
    s_add_u32 m0, s29, 159744
    ds_read_b64_tr_b16 a[70:71], v9 offset:20480
    v_xor_b32 v10, 65824, v6
    v_mfma_f32_16x16x32_bf16 v[140:143], a[92:95], a[156:159], v[140:143]
    s_waitcnt lgkmcnt(6)
    ds_read_b64_tr_b16 a[72:73], v10 offset:0
    buffer_load_dwordx4 v2, s[16:19], s54 offen lds
    v_mfma_f32_16x16x32_bf16 v[148:151], a[96:99], a[128:131], 0
    s_add_u32 s59, s58, 0
    ds_read_b64_tr_b16 a[74:75], v10 offset:4096
    v_mfma_f32_16x16x32_bf16 v[148:151], a[100:103], a[136:139], v[148:151]
    ds_read_b64_tr_b16 a[76:77], v10 offset:16384
    buffer_store_dwordx4 v[88:91], v1, s[12:15], s59 offen offset:1024 sc1
    v_mfma_f32_16x16x32_bf16 v[148:151], a[104:107], a[144:147], v[148:151]
    s_waitcnt lgkmcnt(7)
    ds_read_b64_tr_b16 a[78:79], v10 offset:20480
    v_xor_b32 v7, 320, v6
    v_mfma_f32_16x16x32_bf16 v[148:151], a[108:111], a[152:155], v[148:151]
    ds_read_b64_tr_b16 a[80:81], v7 offset:0
    v_mfma_f32_16x16x32_bf16 v[156:159], a[96:99], a[132:135], 0
    ds_read_b64_tr_b16 a[82:83], v7 offset:4096
    v_mfma_f32_16x16x32_bf16 v[156:159], a[100:103], a[140:143], v[156:159]
    ds_read_b64_tr_b16 a[84:85], v7 offset:16384
    v_mfma_f32_16x16x32_bf16 v[156:159], a[104:107], a[148:151], v[156:159]
    ds_read_b64_tr_b16 a[86:87], v7 offset:20480
    v_xor_b32 v8, 65856, v6
    v_mfma_f32_16x16x32_bf16 v[156:159], a[108:111], a[156:159], v[156:159]
    s_waitcnt lgkmcnt(6)
    ds_read_b64_tr_b16 a[88:89], v8 offset:0
    v_mfma_f32_16x16x32_bf16 v[164:167], a[64:67], a[128:131], 0
    ds_read_b64_tr_b16 a[90:91], v8 offset:4096
    v_mfma_f32_16x16x32_bf16 v[164:167], a[68:71], a[136:139], v[164:167]
    ds_read_b64_tr_b16 a[92:93], v8 offset:16384
    v_mfma_f32_16x16x32_bf16 v[164:167], a[72:75], a[144:147], v[164:167]
    s_waitcnt lgkmcnt(7)
    ds_read_b64_tr_b16 a[94:95], v8 offset:20480
    v_xor_b32 v9, 352, v6
    v_mfma_f32_16x16x32_bf16 v[164:167], a[76:79], a[152:155], v[164:167]
    ds_read_b64_tr_b16 a[96:97], v9 offset:0
    v_mfma_f32_16x16x32_bf16 v[172:175], a[64:67], a[132:135], 0
    s_add_u32 s59, s58, 0
    ds_read_b64_tr_b16 a[98:99], v9 offset:4096
    v_mfma_f32_16x16x32_bf16 v[172:175], a[68:71], a[140:143], v[172:175]
    ds_read_b64_tr_b16 a[100:101], v9 offset:16384
    buffer_store_dwordx4 v[96:99], v1, s[12:15], s59 offen offset:2048 sc1
    v_mfma_f32_16x16x32_bf16 v[172:175], a[72:75], a[148:151], v[172:175]
    ds_read_b64_tr_b16 a[102:103], v9 offset:20480
    v_xor_b32 v10, 65888, v6
    v_mfma_f32_16x16x32_bf16 v[172:175], a[76:79], a[156:159], v[172:175]
    s_waitcnt lgkmcnt(6)
    ds_read_b64_tr_b16 a[104:105], v10 offset:0
    v_mfma_f32_16x16x32_bf16 v[180:183], a[80:83], a[128:131], 0
    ds_read_b64_tr_b16 a[106:107], v10 offset:4096
    v_mfma_f32_16x16x32_bf16 v[180:183], a[84:87], a[136:139], v[180:183]
    ds_read_b64_tr_b16 a[108:109], v10 offset:16384
    v_mfma_f32_16x16x32_bf16 v[180:183], a[88:91], a[144:147], v[180:183]
    s_waitcnt lgkmcnt(7)
    ds_read_b64_tr_b16 a[110:111], v10 offset:20480
    v_xor_b32 v7, 384, v6
    v_mfma_f32_16x16x32_bf16 v[180:183], a[92:95], a[152:155], v[180:183]
    ds_read_b64_tr_b16 a[64:65], v7 offset:0
    v_mfma_f32_16x16x32_bf16 v[188:191], a[80:83], a[132:135], 0
    ds_read_b64_tr_b16 a[66:67], v7 offset:4096
    v_mfma_f32_16x16x32_bf16 v[188:191], a[84:87], a[140:143], v[188:191]
    ds_read_b64_tr_b16 a[68:69], v7 offset:16384
    v_mfma_f32_16x16x32_bf16 v[188:191], a[88:91], a[148:151], v[188:191]
    ds_read_b64_tr_b16 a[70:71], v7 offset:20480
    v_xor_b32 v8, 65920, v6
    v_mfma_f32_16x16x32_bf16 v[188:191], a[92:95], a[156:159], v[188:191]
    s_waitcnt lgkmcnt(6)
    ds_read_b64_tr_b16 a[72:73], v8 offset:0
    v_mfma_f32_16x16x32_bf16 v[196:199], a[96:99], a[128:131], 0
    s_add_u32 s59, s58, 16384
    ds_read_b64_tr_b16 a[74:75], v8 offset:4096
    v_mfma_f32_16x16x32_bf16 v[196:199], a[100:103], a[136:139], v[196:199]
    ds_read_b64_tr_b16 a[76:77], v8 offset:16384
    buffer_store_dwordx4 v[104:107], v1, s[12:15], s59 offen offset:2048 sc1
    v_mfma_f32_16x16x32_bf16 v[196:199], a[104:107], a[144:147], v[196:199]
    s_waitcnt lgkmcnt(7)
    ds_read_b64_tr_b16 a[78:79], v8 offset:20480
    v_xor_b32 v9, 416, v6
    v_mfma_f32_16x16x32_bf16 v[196:199], a[108:111], a[152:155], v[196:199]
    ds_read_b64_tr_b16 a[80:81], v9 offset:0
    v_mfma_f32_16x16x32_bf16 v[204:207], a[96:99], a[132:135], 0
    ds_read_b64_tr_b16 a[82:83], v9 offset:4096
    v_mfma_f32_16x16x32_bf16 v[204:207], a[100:103], a[140:143], v[204:207]
    ds_read_b64_tr_b16 a[84:85], v9 offset:16384
    v_mfma_f32_16x16x32_bf16 v[204:207], a[104:107], a[148:151], v[204:207]
    ds_read_b64_tr_b16 a[86:87], v9 offset:20480
    v_xor_b32 v10, 65952, v6
    v_mfma_f32_16x16x32_bf16 v[204:207], a[108:111], a[156:159], v[204:207]
    s_waitcnt lgkmcnt(6)
    ds_read_b64_tr_b16 a[88:89], v10 offset:0
    v_mfma_f32_16x16x32_bf16 v[212:215], a[64:67], a[128:131], 0
    ds_read_b64_tr_b16 a[90:91], v10 offset:4096
    v_mfma_f32_16x16x32_bf16 v[212:215], a[68:71], a[136:139], v[212:215]
    ds_read_b64_tr_b16 a[92:93], v10 offset:16384
    v_mfma_f32_16x16x32_bf16 v[212:215], a[72:75], a[144:147], v[212:215]
    s_waitcnt lgkmcnt(7)
    ds_read_b64_tr_b16 a[94:95], v10 offset:20480
    v_xor_b32 v7, 448, v6
    v_mfma_f32_16x16x32_bf16 v[212:215], a[76:79], a[152:155], v[212:215]
    ds_read_b64_tr_b16 a[96:97], v7 offset:0
    v_mfma_f32_16x16x32_bf16 v[220:223], a[64:67], a[132:135], 0
    s_add_u32 s59, s58, 16384
    ds_read_b64_tr_b16 a[98:99], v7 offset:4096
    v_mfma_f32_16x16x32_bf16 v[220:223], a[68:71], a[140:143], v[220:223]
    ds_read_b64_tr_b16 a[100:101], v7 offset:16384
    buffer_store_dwordx4 v[112:115], v1, s[12:15], s59 offen offset:3072 sc1
    v_mfma_f32_16x16x32_bf16 v[220:223], a[72:75], a[148:151], v[220:223]
    ds_read_b64_tr_b16 a[102:103], v7 offset:20480
    v_xor_b32 v8, 65984, v6
    v_mfma_f32_16x16x32_bf16 v[220:223], a[76:79], a[156:159], v[220:223]
    s_waitcnt lgkmcnt(6)
    ds_read_b64_tr_b16 a[104:105], v8 offset:0
    v_mfma_f32_16x16x32_bf16 v[228:231], a[80:83], a[128:131], 0
    ds_read_b64_tr_b16 a[106:107], v8 offset:4096
    v_mfma_f32_16x16x32_bf16 v[228:231], a[84:87], a[136:139], v[228:231]
    ds_read_b64_tr_b16 a[108:109], v8 offset:16384
    v_mfma_f32_16x16x32_bf16 v[228:231], a[88:91], a[144:147], v[228:231]
    s_waitcnt lgkmcnt(7)
    ds_read_b64_tr_b16 a[110:111], v8 offset:20480
    v_xor_b32 v9, 480, v6
    v_mfma_f32_16x16x32_bf16 v[228:231], a[92:95], a[152:155], v[228:231]
    ds_read_b64_tr_b16 a[64:65], v9 offset:0
    v_mfma_f32_16x16x32_bf16 v[236:239], a[80:83], a[132:135], 0
    ds_read_b64_tr_b16 a[66:67], v9 offset:4096
    v_mfma_f32_16x16x32_bf16 v[236:239], a[84:87], a[140:143], v[236:239]
    ds_read_b64_tr_b16 a[68:69], v9 offset:16384
    v_mfma_f32_16x16x32_bf16 v[236:239], a[88:91], a[148:151], v[236:239]
    ds_read_b64_tr_b16 a[70:71], v9 offset:20480
    v_xor_b32 v10, 66016, v6
    v_mfma_f32_16x16x32_bf16 v[236:239], a[92:95], a[156:159], v[236:239]
    s_waitcnt lgkmcnt(6)
    ds_read_b64_tr_b16 a[72:73], v10 offset:0
    v_mfma_f32_16x16x32_bf16 v[244:247], a[96:99], a[128:131], 0
    ds_read_b64_tr_b16 a[74:75], v10 offset:4096
    v_mfma_f32_16x16x32_bf16 v[244:247], a[100:103], a[136:139], v[244:247]
    s_waitcnt vmcnt(18)
    ds_read_b64_tr_b16 a[76:77], v10 offset:16384
    v_xor_b32 v7, 32768, v6
    v_mfma_f32_16x16x32_bf16 v[244:247], a[104:107], a[144:147], v[244:247]
    s_waitcnt lgkmcnt(7)
    s_barrier
    ds_read_b64_tr_b16 a[78:79], v10 offset:20480
    v_mfma_f32_16x16x32_bf16 v[244:247], a[108:111], a[152:155], v[244:247]
    s_add_u32 s59, s58, 0
    ds_read_b64_tr_b16 a[80:81], v7 offset:0
    v_mfma_f32_16x16x32_bf16 v[252:255], a[96:99], a[132:135], 0
    ds_read_b64_tr_b16 a[82:83], v7 offset:4096
    buffer_store_dwordx4 v[120:123], v1, s[12:15], s59 offen offset:3072 sc1
    v_mfma_f32_16x16x32_bf16 v[252:255], a[100:103], a[140:143], v[252:255]
    ds_read_b64_tr_b16 a[84:85], v7 offset:16384
    v_mfma_f32_16x16x32_bf16 v[252:255], a[104:107], a[148:151], v[252:255]
    ds_read_b64_tr_b16 a[86:87], v7 offset:20480
    v_xor_b32 v8, 98304, v6
    v_mfma_f32_16x16x32_bf16 v[252:255], a[108:111], a[156:159], v[252:255]
    s_waitcnt lgkmcnt(6)
    ds_read_b64_tr_b16 a[88:89], v8 offset:0
    v_mfma_f32_16x16x32_bf16 v[16:19], a[64:67], a[128:131], 0
    ds_read_b64_tr_b16 a[90:91], v8 offset:4096
    v_mfma_f32_16x16x32_bf16 v[16:19], a[68:71], a[136:139], v[16:19]
    ds_read_b64_tr_b16 a[92:93], v8 offset:16384
    v_mfma_f32_16x16x32_bf16 v[16:19], a[72:75], a[144:147], v[16:19]
    s_waitcnt lgkmcnt(7)
    ds_read_b64_tr_b16 a[94:95], v8 offset:20480
    v_xor_b32 v9, 32800, v6
    v_mfma_f32_16x16x32_bf16 v[16:19], a[76:79], a[152:155], v[16:19]
    ds_read_b64_tr_b16 a[96:97], v9 offset:0
    v_mfma_f32_16x16x32_bf16 v[24:27], a[64:67], a[132:135], 0
    s_waitcnt lgkmcnt(9)
    ds_read_b64_tr_b16 a[98:99], v9 offset:4096
    v_mfma_f32_16x16x32_bf16 v[24:27], a[68:71], a[140:143], v[24:27]
    s_barrier
    ds_read_b64_tr_b16 a[100:101], v9 offset:16384
    v_mfma_f32_16x16x32_bf16 v[24:27], a[72:75], a[148:151], v[24:27]
    s_add_u32 m0, s29, 0
    ds_read_b64_tr_b16 a[102:103], v9 offset:20480
    v_xor_b32 v10, 98336, v6
    v_mfma_f32_16x16x32_bf16 v[24:27], a[76:79], a[156:159], v[24:27]
    s_waitcnt lgkmcnt(6)
    ds_read_b64_tr_b16 a[104:105], v10 offset:0
    v_add_u32 v2, 0x80000, v2
    v_mfma_f32_16x16x32_bf16 v[28:31], a[80:83], a[160:163], v[28:31]
    ds_read_b64_tr_b16 a[106:107], v10 offset:4096
    buffer_load_dwordx4 v2, s[16:19], 0 offen lds
    v_mfma_f32_16x16x32_bf16 v[28:31], a[84:87], a[168:171], v[28:31]
    s_add_u32 s59, s58, 4096
    ds_read_b64_tr_b16 a[108:109], v10 offset:16384
    v_mfma_f32_16x16x32_bf16 v[28:31], a[88:91], a[176:179], v[28:31]
    s_waitcnt lgkmcnt(7)
    ds_read_b64_tr_b16 a[110:111], v10 offset:20480
    v_xor_b32 v7, 32832, v6
    v_mfma_f32_16x16x32_bf16 v[28:31], a[92:95], a[184:187], v[28:31]
    ds_read_b64_tr_b16 a[64:65], v7 offset:0
    buffer_store_dwordx4 v[128:131], v1, s[12:15], s59 offen offset:0 sc1
    v_mfma_f32_16x16x32_bf16 v[44:47], a[80:83], a[164:167], v[44:47]
    s_add_u32 m0, s29, 4096
    ds_read_b64_tr_b16 a[66:67], v7 offset:4096
    v_mfma_f32_16x16x32_bf16 v[44:47], a[84:87], a[172:175], v[44:47]
    ds_read_b64_tr_b16 a[68:69], v7 offset:16384
    buffer_load_dwordx4 v2, s[16:19], s48 offen lds
    v_mfma_f32_16x16x32_bf16 v[44:47], a[88:91], a[180:183], v[44:47]
    ds_read_b64_tr_b16 a[70:71], v7 offset:20480
    v_xor_b32 v8, 98368, v6
    v_mfma_f32_16x16x32_bf16 v[44:47], a[92:95], a[188:191], v[44:47]
    s_waitcnt lgkmcnt(6)
    ds_read_b64_tr_b16 a[72:73], v8 offset:0
    v_mfma_f32_16x16x32_bf16 v[52:55], a[96:99], a[160:163], v[52:55]
    ds_read_b64_tr_b16 a[74:75], v8 offset:4096
    v_mfma_f32_16x16x32_bf16 v[52:55], a[100:103], a[168:171], v[52:55]
    s_add_u32 m0, s29, 8192
    ds_read_b64_tr_b16 a[76:77], v8 offset:16384
    v_mfma_f32_16x16x32_bf16 v[52:55], a[104:107], a[176:179], v[52:55]
    s_waitcnt lgkmcnt(7)
    ds_read_b64_tr_b16 a[78:79], v8 offset:20480
    v_xor_b32 v9, 32864, v6
    v_mfma_f32_16x16x32_bf16 v[52:55], a[108:111], a[184:187], v[52:55]
    ds_read_b64_tr_b16 a[80:81], v9 offset:0
    buffer_load_dwordx4 v2, s[16:19], s49 offen lds
    v_mfma_f32_16x16x32_bf16 v[60:63], a[96:99], a[164:167], v[60:63]
    ds_read_b64_tr_b16 a[82:83], v9 offset:4096
    v_mfma_f32_16x16x32_bf16 v[60:63], a[100:103], a[172:175], v[60:63]
    ds_read_b64_tr_b16 a[84:85], v9 offset:16384
    v_mfma_f32_16x16x32_bf16 v[60:63], a[104:107], a[180:183], v[60:63]
    s_add_u32 m0, s29, 12288
    ds_read_b64_tr_b16 a[86:87], v9 offset:20480
    v_xor_b32 v10, 98400, v6
    v_mfma_f32_16x16x32_bf16 v[60:63], a[108:111], a[188:191], v[60:63]
    s_waitcnt lgkmcnt(6)
    ds_read_b64_tr_b16 a[88:89], v10 offset:0
    v_mfma_f32_16x16x32_bf16 v[20:23], a[64:67], a[160:163], v[20:23]
    ds_read_b64_tr_b16 a[90:91], v10 offset:4096
    buffer_load_dwordx4 v2, s[16:19], s50 offen lds
    v_mfma_f32_16x16x32_bf16 v[20:23], a[68:71], a[168:171], v[20:23]
    s_add_u32 s59, s58, 20480
    ds_read_b64_tr_b16 a[92:93], v10 offset:16384
    v_mfma_f32_16x16x32_bf16 v[20:23], a[72:75], a[176:179], v[20:23]
    s_waitcnt lgkmcnt(7)
    ds_read_b64_tr_b16 a[94:95], v10 offset:20480
    v_xor_b32 v7, 32896, v6
    v_mfma_f32_16x16x32_bf16 v[20:23], a[76:79], a[184:187], v[20:23]
    ds_read_b64_tr_b16 a[96:97], v7 offset:0
    buffer_store_dwordx4 v[136:139], v1, s[12:15], s59 offen offset:0 sc1
    v_mfma_f32_16x16x32_bf16 v[36:39], a[64:67], a[164:167], v[36:39]
    s_add_u32 m0, s29, 16384
    ds_read_b64_tr_b16 a[98:99], v7 offset:4096
    v_mfma_f32_16x16x32_bf16 v[36:39], a[68:71], a[172:175], v[36:39]
    ds_read_b64_tr_b16 a[100:101], v7 offset:16384
    buffer_load_dwordx4 v2, s[16:19], s51 offen lds
    v_mfma_f32_16x16x32_bf16 v[36:39], a[72:75], a[180:183], v[36:39]
    ds_read_b64_tr_b16 a[102:103], v7 offset:20480
    v_xor_b32 v8, 98432, v6
    v_mfma_f32_16x16x32_bf16 v[36:39], a[76:79], a[188:191], v[36:39]
    s_waitcnt lgkmcnt(6)
    ds_read_b64_tr_b16 a[104:105], v8 offset:0
    v_mfma_f32_16x16x32_bf16 v[68:71], a[80:83], a[160:163], v[68:71]
    ds_read_b64_tr_b16 a[106:107], v8 offset:4096
    v_mfma_f32_16x16x32_bf16 v[68:71], a[84:87], a[168:171], v[68:71]
    s_add_u32 m0, s29, 20480
    ds_read_b64_tr_b16 a[108:109], v8 offset:16384
    v_mfma_f32_16x16x32_bf16 v[68:71], a[88:91], a[176:179], v[68:71]
    s_waitcnt lgkmcnt(7)
    ds_read_b64_tr_b16 a[110:111], v8 offset:20480
    v_xor_b32 v9, 32928, v6
    v_mfma_f32_16x16x32_bf16 v[68:71], a[92:95], a[184:187], v[68:71]
    ds_read_b64_tr_b16 a[64:65], v9 offset:0
    buffer_load_dwordx4 v2, s[16:19], s52 offen lds
    v_mfma_f32_16x16x32_bf16 v[76:79], a[80:83], a[164:167], v[76:79]
    ds_read_b64_tr_b16 a[66:67], v9 offset:4096
    v_mfma_f32_16x16x32_bf16 v[76:79], a[84:87], a[172:175], v[76:79]
    ds_read_b64_tr_b16 a[68:69], v9 offset:16384
    v_mfma_f32_16x16x32_bf16 v[76:79], a[88:91], a[180:183], v[76:79]
    s_add_u32 m0, s29, 24576
    ds_read_b64_tr_b16 a[70:71], v9 offset:20480
    v_xor_b32 v10, 98464, v6
    v_mfma_f32_16x16x32_bf16 v[76:79], a[92:95], a[188:191], v[76:79]
    s_waitcnt lgkmcnt(6)
    ds_read_b64_tr_b16 a[72:73], v10 offset:0
    v_mfma_f32_16x16x32_bf16 v[84:87], a[96:99], a[160:163], v[84:87]
    ds_read_b64_tr_b16 a[74:75], v10 offset:4096
    buffer_load_dwordx4 v2, s[16:19], s53 offen lds
    v_mfma_f32_16x16x32_bf16 v[84:87], a[100:103], a[168:171], v[84:87]
    s_add_u32 s59, s58, 20480
    ds_read_b64_tr_b16 a[76:77], v10 offset:16384
    v_mfma_f32_16x16x32_bf16 v[84:87], a[104:107], a[176:179], v[84:87]
    s_waitcnt lgkmcnt(7)
    ds_read_b64_tr_b16 a[78:79], v10 offset:20480
    v_xor_b32 v7, 32960, v6
    v_mfma_f32_16x16x32_bf16 v[84:87], a[108:111], a[184:187], v[84:87]
    ds_read_b64_tr_b16 a[80:81], v7 offset:0
    buffer_store_dwordx4 v[144:147], v1, s[12:15], s59 offen offset:1024 sc1
    v_mfma_f32_16x16x32_bf16 v[92:95], a[96:99], a[164:167], v[92:95]
    s_add_u32 m0, s29, 28672
    ds_read_b64_tr_b16 a[82:83], v7 offset:4096
    v_mfma_f32_16x16x32_bf16 v[92:95], a[100:103], a[172:175], v[92:95]
    ds_read_b64_tr_b16 a[84:85], v7 offset:16384
    buffer_load_dwordx4 v2, s[16:19], s54 offen lds
    v_mfma_f32_16x16x32_bf16 v[92:95], a[104:107], a[180:183], v[92:95]
    ds_read_b64_tr_b16 a[86:87], v7 offset:20480
    v_xor_b32 v8, 98496, v6
    v_mfma_f32_16x16x32_bf16 v[92:95], a[108:111], a[188:191], v[92:95]
    s_waitcnt lgkmcnt(6)
    ds_read_b64_tr_b16 a[88:89], v8 offset:0
    v_mfma_f32_16x16x32_bf16 v[100:103], a[64:67], a[160:163], v[100:103]
    s_add_u32 m0, s29, 65536
    ds_read_b64_tr_b16 a[90:91], v8 offset:4096
    v_add_u32 v2, 0x80000, v2
    v_mfma_f32_16x16x32_bf16 v[100:103], a[68:71], a[168:171], v[100:103]
    ds_read_b64_tr_b16 a[92:93], v8 offset:16384
    buffer_load_dwordx4 v2, s[16:19], 0 offen lds
    v_mfma_f32_16x16x32_bf16 v[100:103], a[72:75], a[176:179], v[100:103]
    s_waitcnt lgkmcnt(7)
    ds_read_b64_tr_b16 a[94:95], v8 offset:20480
    v_xor_b32 v9, 32992, v6
    v_mfma_f32_16x16x32_bf16 v[100:103], a[76:79], a[184:187], v[100:103]
    ds_read_b64_tr_b16 a[96:97], v9 offset:0
    v_mfma_f32_16x16x32_bf16 v[108:111], a[64:67], a[164:167], v[108:111]
    ds_read_b64_tr_b16 a[98:99], v9 offset:4096
    v_mfma_f32_16x16x32_bf16 v[108:111], a[68:71], a[172:175], v[108:111]
    ds_read_b64_tr_b16 a[100:101], v9 offset:16384
    v_mfma_f32_16x16x32_bf16 v[108:111], a[72:75], a[180:183], v[108:111]
    s_add_u32 m0, s29, 69632
    ds_read_b64_tr_b16 a[102:103], v9 offset:20480
    v_xor_b32 v10, 98528, v6
    v_mfma_f32_16x16x32_bf16 v[108:111], a[76:79], a[188:191], v[108:111]
    s_waitcnt lgkmcnt(6)
    ds_read_b64_tr_b16 a[104:105], v10 offset:0
    buffer_load_dwordx4 v2, s[16:19], s48 offen lds
    v_mfma_f32_16x16x32_bf16 v[116:119], a[80:83], a[160:163], v[116:119]
    s_add_u32 s59, s58, 4096
    ds_read_b64_tr_b16 a[106:107], v10 offset:4096
    v_mfma_f32_16x16x32_bf16 v[116:119], a[84:87], a[168:171], v[116:119]
    ds_read_b64_tr_b16 a[108:109], v10 offset:16384
    buffer_store_dwordx4 v[152:155], v1, s[12:15], s59 offen offset:1024 sc1
    v_mfma_f32_16x16x32_bf16 v[116:119], a[88:91], a[176:179], v[116:119]
    s_waitcnt lgkmcnt(7)
    ds_read_b64_tr_b16 a[110:111], v10 offset:20480
    v_xor_b32 v7, 33024, v6
    v_mfma_f32_16x16x32_bf16 v[116:119], a[92:95], a[184:187], v[116:119]
    s_add_u32 m0, s29, 73728
    ds_read_b64_tr_b16 a[64:65], v7 offset:0
    v_mfma_f32_16x16x32_bf16 v[124:127], a[80:83], a[164:167], v[124:127]
    ds_read_b64_tr_b16 a[66:67], v7 offset:4096
    buffer_load_dwordx4 v2, s[16:19], s49 offen lds
    v_mfma_f32_16x16x32_bf16 v[124:127], a[84:87], a[172:175], v[124:127]
    ds_read_b64_tr_b16 a[68:69], v7 offset:16384
    v_mfma_f32_16x16x32_bf16 v[124:127], a[88:91], a[180:183], v[124:127]
    ds_read_b64_tr_b16 a[70:71], v7 offset:20480
    v_xor_b32 v8, 98560, v6
    v_mfma_f32_16x16x32_bf16 v[124:127], a[92:95], a[188:191], v[124:127]
    s_waitcnt lgkmcnt(6)
    ds_read_b64_tr_b16 a[72:73], v8 offset:0
    v_mfma_f32_16x16x32_bf16 v[132:135], a[96:99], a[160:163], v[132:135]
    s_add_u32 m0, s29, 77824
    ds_read_b64_tr_b16 a[74:75], v8 offset:4096
    v_mfma_f32_16x16x32_bf16 v[132:135], a[100:103], a[168:171], v[132:135]
    ds_read_b64_tr_b16 a[76:77], v8 offset:16384
    buffer_load_dwordx4 v2, s[16:19], s50 offen lds
    v_mfma_f32_16x16x32_bf16 v[132:135], a[104:107], a[176:179], v[132:135]
    s_waitcnt lgkmcnt(7)
    ds_read_b64_tr_b16 a[78:79], v8 offset:20480
    v_xor_b32 v9, 33056, v6
    v_mfma_f32_16x16x32_bf16 v[132:135], a[108:111], a[184:187], v[132:135]
    ds_read_b64_tr_b16 a[80:81], v9 offset:0
    v_mfma_f32_16x16x32_bf16 v[140:143], a[96:99], a[164:167], v[140:143]
    s_add_u32 s59, s58, 4096
    ds_read_b64_tr_b16 a[82:83], v9 offset:4096
    v_mfma_f32_16x16x32_bf16 v[140:143], a[100:103], a[172:175], v[140:143]
    ds_read_b64_tr_b16 a[84:85], v9 offset:16384
    buffer_store_dwordx4 v[160:163], v1, s[12:15], s59 offen offset:2048 sc1
    v_mfma_f32_16x16x32_bf16 v[140:143], a[104:107], a[180:183], v[140:143]
    s_add_u32 m0, s29, 81920
    ds_read_b64_tr_b16 a[86:87], v9 offset:20480
    v_xor_b32 v10, 98592, v6
    v_mfma_f32_16x16x32_bf16 v[140:143], a[108:111], a[188:191], v[140:143]
    s_waitcnt lgkmcnt(6)
    ds_read_b64_tr_b16 a[88:89], v10 offset:0
    buffer_load_dwordx4 v2, s[16:19], s51 offen lds
    v_mfma_f32_16x16x32_bf16 v[148:151], a[64:67], a[160:163], v[148:151]
    ds_read_b64_tr_b16 a[90:91], v10 offset:4096
    v_mfma_f32_16x16x32_bf16 v[148:151], a[68:71], a[168:171], v[148:151]
    ds_read_b64_tr_b16 a[92:93], v10 offset:16384
    v_mfma_f32_16x16x32_bf16 v[148:151], a[72:75], a[176:179], v[148:151]
    s_waitcnt lgkmcnt(7)
    ds_read_b64_tr_b16 a[94:95], v10 offset:20480
    v_xor_b32 v7, 33088, v6
    v_mfma_f32_16x16x32_bf16 v[148:151], a[76:79], a[184:187], v[148:151]
    s_add_u32 m0, s29, 86016
    ds_read_b64_tr_b16 a[96:97], v7 offset:0
    v_mfma_f32_16x16x32_bf16 v[156:159], a[64:67], a[164:167], v[156:159]
    ds_read_b64_tr_b16 a[98:99], v7 offset:4096
    buffer_load_dwordx4 v2, s[16:19], s52 offen lds
    v_mfma_f32_16x16x32_bf16 v[156:159], a[68:71], a[172:175], v[156:159]
    ds_read_b64_tr_b16 a[100:101], v7 offset:16384
    v_mfma_f32_16x16x32_bf16 v[156:159], a[72:75], a[180:183], v[156:159]
    ds_read_b64_tr_b16 a[102:103], v7 offset:20480
    v_xor_b32 v8, 98624, v6
    v_mfma_f32_16x16x32_bf16 v[156:159], a[76:79], a[188:191], v[156:159]
    s_waitcnt lgkmcnt(6)
    ds_read_b64_tr_b16 a[104:105], v8 offset:0
    v_mfma_f32_16x16x32_bf16 v[164:167], a[80:83], a[160:163], v[164:167]
    s_add_u32 m0, s29, 90112
    ds_read_b64_tr_b16 a[106:107], v8 offset:4096
    v_mfma_f32_16x16x32_bf16 v[164:167], a[84:87], a[168:171], v[164:167]
    ds_read_b64_tr_b16 a[108:109], v8 offset:16384
    buffer_load_dwordx4 v2, s[16:19], s53 offen lds
    v_mfma_f32_16x16x32_bf16 v[164:167], a[88:91], a[176:179], v[164:167]
    s_waitcnt lgkmcnt(7)
    ds_read_b64_tr_b16 a[110:111], v8 offset:20480
    v_xor_b32 v9, 33120, v6
    v_mfma_f32_16x16x32_bf16 v[164:167], a[92:95], a[184:187], v[164:167]
    s_add_u32 s59, s58, 20480
    ds_read_b64_tr_b16 a[64:65], v9 offset:0
    v_mfma_f32_16x16x32_bf16 v[172:175], a[80:83], a[164:167], v[172:175]
    ds_read_b64_tr_b16 a[66:67], v9 offset:4096
    buffer_store_dwordx4 v[168:171], v1, s[12:15], s59 offen offset:2048 sc1
    v_mfma_f32_16x16x32_bf16 v[172:175], a[84:87], a[172:175], v[172:175]
    ds_read_b64_tr_b16 a[68:69], v9 offset:16384
    v_mfma_f32_16x16x32_bf16 v[172:175], a[88:91], a[180:183], v[172:175]
    s_add_u32 m0, s29, 94208
    ds_read_b64_tr_b16 a[70:71], v9 offset:20480
    v_xor_b32 v10, 98656, v6
    v_mfma_f32_16x16x32_bf16 v[172:175], a[92:95], a[188:191], v[172:175]
    s_waitcnt lgkmcnt(6)
    ds_read_b64_tr_b16 a[72:73], v10 offset:0
    buffer_load_dwordx4 v2, s[16:19], s54 offen lds
    v_mfma_f32_16x16x32_bf16 v[180:183], a[96:99], a[160:163], v[180:183]
    ds_read_b64_tr_b16 a[74:75], v10 offset:4096
    v_mfma_f32_16x16x32_bf16 v[180:183], a[100:103], a[168:171], v[180:183]
    ds_read_b64_tr_b16 a[76:77], v10 offset:16384
    v_mfma_f32_16x16x32_bf16 v[180:183], a[104:107], a[176:179], v[180:183]
    s_waitcnt lgkmcnt(7)
    ds_read_b64_tr_b16 a[78:79], v10 offset:20480
    v_xor_b32 v7, 33152, v6
    v_mfma_f32_16x16x32_bf16 v[180:183], a[108:111], a[184:187], v[180:183]
    ds_read_b64_tr_b16 a[80:81], v7 offset:0
    v_mfma_f32_16x16x32_bf16 v[188:191], a[96:99], a[164:167], v[188:191]
    ds_read_b64_tr_b16 a[82:83], v7 offset:4096
    v_mfma_f32_16x16x32_bf16 v[188:191], a[100:103], a[172:175], v[188:191]
    ds_read_b64_tr_b16 a[84:85], v7 offset:16384
    v_mfma_f32_16x16x32_bf16 v[188:191], a[104:107], a[180:183], v[188:191]
    s_add_u32 s59, s58, 20480
    ds_read_b64_tr_b16 a[86:87], v7 offset:20480
    v_xor_b32 v8, 98688, v6
    v_mfma_f32_16x16x32_bf16 v[188:191], a[108:111], a[188:191], v[188:191]
    s_waitcnt lgkmcnt(6)
    ds_read_b64_tr_b16 a[88:89], v8 offset:0
    v_mfma_f32_16x16x32_bf16 v[196:199], a[64:67], a[160:163], v[196:199]
    ds_read_b64_tr_b16 a[90:91], v8 offset:4096
    buffer_store_dwordx4 v[176:179], v1, s[12:15], s59 offen offset:3072 sc1
    v_mfma_f32_16x16x32_bf16 v[196:199], a[68:71], a[168:171], v[196:199]
    ds_read_b64_tr_b16 a[92:93], v8 offset:16384
    v_mfma_f32_16x16x32_bf16 v[196:199], a[72:75], a[176:179], v[196:199]
    s_waitcnt lgkmcnt(7)
    ds_read_b64_tr_b16 a[94:95], v8 offset:20480
    v_xor_b32 v9, 33184, v6
    v_mfma_f32_16x16x32_bf16 v[196:199], a[76:79], a[184:187], v[196:199]
    ds_read_b64_tr_b16 a[96:97], v9 offset:0
    v_mfma_f32_16x16x32_bf16 v[204:207], a[64:67], a[164:167], v[204:207]
    ds_read_b64_tr_b16 a[98:99], v9 offset:4096
    v_mfma_f32_16x16x32_bf16 v[204:207], a[68:71], a[172:175], v[204:207]
    ds_read_b64_tr_b16 a[100:101], v9 offset:16384
    v_mfma_f32_16x16x32_bf16 v[204:207], a[72:75], a[180:183], v[204:207]
    ds_read_b64_tr_b16 a[102:103], v9 offset:20480
    v_xor_b32 v10, 98720, v6
    v_mfma_f32_16x16x32_bf16 v[204:207], a[76:79], a[188:191], v[204:207]
    s_waitcnt lgkmcnt(6)
    ds_read_b64_tr_b16 a[104:105], v10 offset:0
    v_mfma_f32_16x16x32_bf16 v[212:215], a[80:83], a[160:163], v[212:215]
    ds_read_b64_tr_b16 a[106:107], v10 offset:4096
    v_mfma_f32_16x16x32_bf16 v[212:215], a[84:87], a[168:171], v[212:215]
    ds_read_b64_tr_b16 a[108:109], v10 offset:16384
    v_mfma_f32_16x16x32_bf16 v[212:215], a[88:91], a[176:179], v[212:215]
    s_waitcnt lgkmcnt(7)
    ds_read_b64_tr_b16 a[110:111], v10 offset:20480
    v_xor_b32 v7, 33216, v6
    v_mfma_f32_16x16x32_bf16 v[212:215], a[92:95], a[184:187], v[212:215]
    s_add_u32 s59, s58, 4096
    ds_read_b64_tr_b16 a[64:65], v7 offset:0
    v_mfma_f32_16x16x32_bf16 v[220:223], a[80:83], a[164:167], v[220:223]
    ds_read_b64_tr_b16 a[66:67], v7 offset:4096
    buffer_store_dwordx4 v[184:187], v1, s[12:15], s59 offen offset:3072 sc1
    v_mfma_f32_16x16x32_bf16 v[220:223], a[84:87], a[172:175], v[220:223]
    ds_read_b64_tr_b16 a[68:69], v7 offset:16384
    v_mfma_f32_16x16x32_bf16 v[220:223], a[88:91], a[180:183], v[220:223]
    ds_read_b64_tr_b16 a[70:71], v7 offset:20480
    v_xor_b32 v8, 98752, v6
    v_mfma_f32_16x16x32_bf16 v[220:223], a[92:95], a[188:191], v[220:223]
    s_waitcnt lgkmcnt(6)
    ds_read_b64_tr_b16 a[72:73], v8 offset:0
    v_mfma_f32_16x16x32_bf16 v[228:231], a[96:99], a[160:163], v[228:231]
    ds_read_b64_tr_b16 a[74:75], v8 offset:4096
    v_mfma_f32_16x16x32_bf16 v[228:231], a[100:103], a[168:171], v[228:231]
    ds_read_b64_tr_b16 a[76:77], v8 offset:16384
    v_mfma_f32_16x16x32_bf16 v[228:231], a[104:107], a[176:179], v[228:231]
    s_waitcnt lgkmcnt(7)
    ds_read_b64_tr_b16 a[78:79], v8 offset:20480
    v_xor_b32 v9, 33248, v6
    v_mfma_f32_16x16x32_bf16 v[228:231], a[108:111], a[184:187], v[228:231]
    ds_read_b64_tr_b16 a[80:81], v9 offset:0
    v_mfma_f32_16x16x32_bf16 v[236:239], a[96:99], a[164:167], v[236:239]
    ds_read_b64_tr_b16 a[82:83], v9 offset:4096
    v_mfma_f32_16x16x32_bf16 v[236:239], a[100:103], a[172:175], v[236:239]
    ds_read_b64_tr_b16 a[84:85], v9 offset:16384
    v_mfma_f32_16x16x32_bf16 v[236:239], a[104:107], a[180:183], v[236:239]
    s_add_u32 s59, s58, 36864
    ds_read_b64_tr_b16 a[86:87], v9 offset:20480
    v_xor_b32 v10, 98784, v6
    v_mfma_f32_16x16x32_bf16 v[236:239], a[108:111], a[188:191], v[236:239]
    s_waitcnt lgkmcnt(6)
    ds_read_b64_tr_b16 a[88:89], v10 offset:0
    v_mfma_f32_16x16x32_bf16 v[244:247], a[64:67], a[160:163], v[244:247]
    ds_read_b64_tr_b16 a[90:91], v10 offset:4096
    buffer_store_dwordx4 v[192:195], v1, s[12:15], s59 offen offset:0 sc1
    v_mfma_f32_16x16x32_bf16 v[244:247], a[68:71], a[168:171], v[244:247]
    s_waitcnt vmcnt(3)
    ds_read_b64_tr_b16 a[92:93], v10 offset:16384
    v_xor_b32 v7, 131072, v6
    v_mfma_f32_16x16x32_bf16 v[244:247], a[72:75], a[176:179], v[244:247]
    s_waitcnt lgkmcnt(7)
    s_barrier
    ds_read_b64_tr_b16 a[94:95], v10 offset:20480
    v_mfma_f32_16x16x32_bf16 v[244:247], a[76:79], a[184:187], v[244:247]
    ds_read_b64_tr_b16 a[96:97], v7 offset:0
    v_mfma_f32_16x16x32_bf16 v[252:255], a[64:67], a[164:167], v[252:255]
    ds_read_b64_tr_b16 a[98:99], v7 offset:4096
    v_mfma_f32_16x16x32_bf16 v[252:255], a[68:71], a[172:175], v[252:255]
    ds_read_b64_tr_b16 a[100:101], v7 offset:16384
    v_mfma_f32_16x16x32_bf16 v[252:255], a[72:75], a[180:183], v[252:255]
    ds_read_b64_tr_b16 a[102:103], v7 offset:20480
    v_xor_b32 v8, 0, v6
    v_mfma_f32_16x16x32_bf16 v[252:255], a[76:79], a[188:191], v[252:255]
    s_waitcnt lgkmcnt(6)
    ds_read_b64_tr_b16 a[104:105], v8 offset:0
    v_mfma_f32_16x16x32_bf16 v[16:19], a[80:83], a[160:163], v[16:19]
    ds_read_b64_tr_b16 a[106:107], v8 offset:4096
    v_mfma_f32_16x16x32_bf16 v[16:19], a[84:87], a[168:171], v[16:19]
    ds_read_b64_tr_b16 a[108:109], v8 offset:16384
    v_mfma_f32_16x16x32_bf16 v[16:19], a[88:91], a[176:179], v[16:19]
    s_waitcnt lgkmcnt(7)
    ds_read_b64_tr_b16 a[110:111], v8 offset:20480
    v_xor_b32 v9, 65536, v6
    v_mfma_f32_16x16x32_bf16 v[16:19], a[92:95], a[184:187], v[16:19]
    s_add_u32 s59, s58, 53248
    ds_read_b64_tr_b16 a[64:65], v9 offset:0
    v_mfma_f32_16x16x32_bf16 v[24:27], a[80:83], a[164:167], v[24:27]
    ds_read_b64_tr_b16 a[66:67], v9 offset:4096
    buffer_store_dwordx4 v[200:203], v1, s[12:15], s59 offen offset:0 sc1
    v_mfma_f32_16x16x32_bf16 v[24:27], a[84:87], a[172:175], v[24:27]
    ds_read_b64_tr_b16 a[68:69], v9 offset:16384
    v_mfma_f32_16x16x32_bf16 v[24:27], a[88:91], a[180:183], v[24:27]
    ds_read_b64_tr_b16 a[70:71], v9 offset:20480
    v_xor_b32 v10, 131104, v6
    v_mfma_f32_16x16x32_bf16 v[24:27], a[92:95], a[188:191], v[24:27]
    s_waitcnt lgkmcnt(6)
    ds_read_b64_tr_b16 a[72:73], v10 offset:0
    v_mfma_f32_16x16x32_bf16 v[28:31], a[96:99], a[192:195], v[28:31]
    ds_read_b64_tr_b16 a[74:75], v10 offset:4096
    v_mfma_f32_16x16x32_bf16 v[28:31], a[100:103], a[200:203], v[28:31]
    ds_read_b64_tr_b16 a[76:77], v10 offset:16384
    v_mfma_f32_16x16x32_bf16 v[28:31], a[104:107], a[208:211], v[28:31]
    s_waitcnt lgkmcnt(3)
    ds_read_b64_tr_b16 a[78:79], v10 offset:20480
    v_xor_b32 v7, 32, v6
    v_mfma_f32_16x16x32_bf16 v[28:31], a[108:111], a[216:219], v[28:31]
    ds_read_b64_tr_b16 a[80:81], v7 offset:0
    v_mfma_f32_16x16x32_bf16 v[28:31], a[64:67], a[112:115], v[28:31]
    ds_read_b64_tr_b16 a[82:83], v7 offset:4096
    v_mfma_f32_16x16x32_bf16 v[28:31], a[68:71], a[120:123], v[28:31]
    ds_read_b64_tr_b16 a[84:85], v7 offset:16384
    v_mfma_f32_16x16x32_bf16 v[44:47], a[96:99], a[196:199], v[44:47]
    ds_read_b64_tr_b16 a[86:87], v7 offset:20480
    v_xor_b32 v8, 65568, v6
    v_mfma_f32_16x16x32_bf16 v[44:47], a[100:103], a[204:207], v[44:47]
    s_add_u32 s59, s58, 53248
    ds_read_b64_tr_b16 a[88:89], v8 offset:0
    v_mfma_f32_16x16x32_bf16 v[44:47], a[104:107], a[212:215], v[44:47]
    ds_read_b64_tr_b16 a[90:91], v8 offset:4096
    buffer_store_dwordx4 v[208:211], v1, s[12:15], s59 offen offset:1024 sc1
    v_mfma_f32_16x16x32_bf16 v[44:47], a[108:111], a[220:223], v[44:47]
    ds_read_b64_tr_b16 a[92:93], v8 offset:16384
    v_mfma_f32_16x16x32_bf16 v[44:47], a[64:67], a[116:119], v[44:47]
    ds_read_b64_tr_b16 a[94:95], v8 offset:20480
    v_xor_b32 v9, 131136, v6
    v_mfma_f32_16x16x32_bf16 v[44:47], a[68:71], a[124:127], v[44:47]
    s_waitcnt lgkmcnt(6)
    ds_read_b64_tr_b16 a[96:97], v9 offset:0
    v_mfma_f32_16x16x32_bf16 v[52:55], a[72:75], a[192:195], v[52:55]
    ds_read_b64_tr_b16 a[98:99], v9 offset:4096
    v_mfma_f32_16x16x32_bf16 v[52:55], a[76:79], a[200:203], v[52:55]
    ds_read_b64_tr_b16 a[100:101], v9 offset:16384
    v_mfma_f32_16x16x32_bf16 v[52:55], a[80:83], a[208:211], v[52:55]
    s_waitcnt lgkmcnt(3)
    ds_read_b64_tr_b16 a[102:103], v9 offset:20480
    v_xor_b32 v10, 64, v6
    v_mfma_f32_16x16x32_bf16 v[52:55], a[84:87], a[216:219], v[52:55]
    ds_read_b64_tr_b16 a[104:105], v10 offset:0
    v_mfma_f32_16x16x32_bf16 v[52:55], a[88:91], a[112:115], v[52:55]
    ds_read_b64_tr_b16 a[106:107], v10 offset:4096
    v_mfma_f32_16x16x32_bf16 v[52:55], a[92:95], a[120:123], v[52:55]
    ds_read_b64_tr_b16 a[108:109], v10 offset:16384
    v_mfma_f32_16x16x32_bf16 v[60:63], a[72:75], a[196:199], v[60:63]
    ds_read_b64_tr_b16 a[110:111], v10 offset:20480
    v_xor_b32 v7, 65600, v6
    v_mfma_f32_16x16x32_bf16 v[60:63], a[76:79], a[204:207], v[60:63]
    s_add_u32 s59, s58, 36864
    ds_read_b64_tr_b16 a[64:65], v7 offset:0
    v_mfma_f32_16x16x32_bf16 v[60:63], a[80:83], a[212:215], v[60:63]
    ds_read_b64_tr_b16 a[66:67], v7 offset:4096
    buffer_store_dwordx4 v[216:219], v1, s[12:15], s59 offen offset:1024 sc1
    v_mfma_f32_16x16x32_bf16 v[60:63], a[84:87], a[220:223], v[60:63]
    ds_read_b64_tr_b16 a[68:69], v7 offset:16384
    v_mfma_f32_16x16x32_bf16 v[60:63], a[88:91], a[116:119], v[60:63]
    ds_read_b64_tr_b16 a[70:71], v7 offset:20480
    v_xor_b32 v8, 131168, v6
    v_mfma_f32_16x16x32_bf16 v[60:63], a[92:95], a[124:127], v[60:63]
    s_waitcnt lgkmcnt(6)
    ds_read_b64_tr_b16 a[72:73], v8 offset:0
    v_mfma_f32_16x16x32_bf16 v[20:23], a[96:99], a[192:195], v[20:23]
    ds_read_b64_tr_b16 a[74:75], v8 offset:4096
    v_mfma_f32_16x16x32_bf16 v[20:23], a[100:103], a[200:203], v[20:23]
    ds_read_b64_tr_b16 a[76:77], v8 offset:16384
    v_mul_f32 v28, s34, v28
    v_mfma_f32_16x16x32_bf16 v[20:23], a[104:107], a[208:211], v[20:23]
    s_waitcnt lgkmcnt(3)
    ds_read_b64_tr_b16 a[78:79], v8 offset:20480
    v_xor_b32 v9, 96, v6
    v_mfma_f32_16x16x32_bf16 v[20:23], a[108:111], a[216:219], v[20:23]
    ds_read_b64_tr_b16 a[80:81], v9 offset:0
    v_mul_f32 v29, s34, v29
    v_mfma_f32_16x16x32_bf16 v[20:23], a[64:67], a[112:115], v[20:23]
    ds_read_b64_tr_b16 a[82:83], v9 offset:4096
    v_mul_f32 v30, s34, v30
    v_mfma_f32_16x16x32_bf16 v[20:23], a[68:71], a[120:123], v[20:23]
    ds_read_b64_tr_b16 a[84:85], v9 offset:16384
    v_mul_f32 v31, s34, v31
    v_mfma_f32_16x16x32_bf16 v[36:39], a[96:99], a[196:199], v[36:39]
    ds_read_b64_tr_b16 a[86:87], v9 offset:20480
    v_xor_b32 v10, 65632, v6
    v_mfma_f32_16x16x32_bf16 v[36:39], a[100:103], a[204:207], v[36:39]
    s_add_u32 s59, s58, 36864
    ds_read_b64_tr_b16 a[88:89], v10 offset:0
    v_mul_f32 v52, s34, v52
    v_mfma_f32_16x16x32_bf16 v[36:39], a[104:107], a[212:215], v[36:39]
    ds_read_b64_tr_b16 a[90:91], v10 offset:4096
    buffer_store_dwordx4 v[224:227], v1, s[12:15], s59 offen offset:2048 sc1
    v_mfma_f32_16x16x32_bf16 v[36:39], a[108:111], a[220:223], v[36:39]
    ds_read_b64_tr_b16 a[92:93], v10 offset:16384
    v_mul_f32 v53, s34, v53
    v_mfma_f32_16x16x32_bf16 v[36:39], a[64:67], a[116:119], v[36:39]
    ds_read_b64_tr_b16 a[94:95], v10 offset:20480
    v_xor_b32 v7, 131200, v6
    v_mfma_f32_16x16x32_bf16 v[36:39], a[68:71], a[124:127], v[36:39]
    s_waitcnt lgkmcnt(6)
    ds_read_b64_tr_b16 a[96:97], v7 offset:0
    v_mul_f32 v54, s34, v54
    v_mfma_f32_16x16x32_bf16 v[68:71], a[72:75], a[192:195], v[68:71]
    ds_read_b64_tr_b16 a[98:99], v7 offset:4096
    v_mul_f32 v55, s34, v55
    v_mfma_f32_16x16x32_bf16 v[68:71], a[76:79], a[200:203], v[68:71]
    ds_read_b64_tr_b16 a[100:101], v7 offset:16384
    v_cvt_pk_bf16_f32 v28, v28, v29
    v_mfma_f32_16x16x32_bf16 v[68:71], a[80:83], a[208:211], v[68:71]
    s_waitcnt lgkmcnt(3)
    ds_read_b64_tr_b16 a[102:103], v7 offset:20480
    v_xor_b32 v8, 128, v6
    v_mfma_f32_16x16x32_bf16 v[68:71], a[84:87], a[216:219], v[68:71]
    ds_read_b64_tr_b16 a[104:105], v8 offset:0
    v_cvt_pk_bf16_f32 v29, v30, v31
    v_mfma_f32_16x16x32_bf16 v[68:71], a[88:91], a[112:115], v[68:71]
    ds_read_b64_tr_b16 a[106:107], v8 offset:4096
    v_cvt_pk_bf16_f32 v30, v52, v53
    v_mfma_f32_16x16x32_bf16 v[68:71], a[92:95], a[120:123], v[68:71]
    ds_read_b64_tr_b16 a[108:109], v8 offset:16384
    v_cvt_pk_bf16_f32 v31, v54, v55
    v_mfma_f32_16x16x32_bf16 v[76:79], a[72:75], a[196:199], v[76:79]
    ds_read_b64_tr_b16 a[110:111], v8 offset:20480
    v_xor_b32 v9, 65664, v6
    v_mfma_f32_16x16x32_bf16 v[76:79], a[76:79], a[204:207], v[76:79]
    s_add_u32 s59, s58, 53248
    ds_read_b64_tr_b16 a[64:65], v9 offset:0
    v_accvgpr_write_b32 a0, v28
    v_mfma_f32_16x16x32_bf16 v[76:79], a[80:83], a[212:215], v[76:79]
    ds_read_b64_tr_b16 a[66:67], v9 offset:4096
    buffer_store_dwordx4 v[232:235], v1, s[12:15], s59 offen offset:2048 sc1
    v_mfma_f32_16x16x32_bf16 v[76:79], a[84:87], a[220:223], v[76:79]
    ds_read_b64_tr_b16 a[68:69], v9 offset:16384
    v_accvgpr_write_b32 a1, v29
    v_mfma_f32_16x16x32_bf16 v[76:79], a[88:91], a[116:119], v[76:79]
    s_add_u32 s59, s62, 0
    ds_read_b64_tr_b16 a[70:71], v9 offset:20480
    v_xor_b32 v10, 131232, v6
    v_mfma_f32_16x16x32_bf16 v[76:79], a[92:95], a[124:127], v[76:79]
    s_waitcnt lgkmcnt(6)
    ds_read_b64_tr_b16 a[72:73], v10 offset:0
    buffer_store_dwordx4 v[28:31], v1, s[12:15], s59 offen offset:0 sc1
    v_mfma_f32_16x16x32_bf16 v[84:87], a[96:99], a[192:195], v[84:87]
    ds_read_b64_tr_b16 a[74:75], v10 offset:4096
    v_accvgpr_write_b32 a2, v30
    v_mfma_f32_16x16x32_bf16 v[84:87], a[100:103], a[200:203], v[84:87]
    ds_read_b64_tr_b16 a[76:77], v10 offset:16384
    v_accvgpr_write_b32 a3, v31
    v_mfma_f32_16x16x32_bf16 v[84:87], a[104:107], a[208:211], v[84:87]
    s_waitcnt lgkmcnt(3)
    ds_read_b64_tr_b16 a[78:79], v10 offset:20480
    v_xor_b32 v7, 160, v6
    v_mfma_f32_16x16x32_bf16 v[84:87], a[108:111], a[216:219], v[84:87]
    ds_read_b64_tr_b16 a[80:81], v7 offset:0
    v_mul_f32 v44, s34, v44
    v_mfma_f32_16x16x32_bf16 v[84:87], a[64:67], a[112:115], v[84:87]
    ds_read_b64_tr_b16 a[82:83], v7 offset:4096
    v_mul_f32 v45, s34, v45
    v_mfma_f32_16x16x32_bf16 v[84:87], a[68:71], a[120:123], v[84:87]
    ds_read_b64_tr_b16 a[84:85], v7 offset:16384
    v_mul_f32 v46, s34, v46
    v_mfma_f32_16x16x32_bf16 v[92:95], a[96:99], a[196:199], v[92:95]
    ds_read_b64_tr_b16 a[86:87], v7 offset:20480
    v_xor_b32 v8, 65696, v6
    v_mfma_f32_16x16x32_bf16 v[92:95], a[100:103], a[204:207], v[92:95]
    s_add_u32 s59, s58, 53248
    ds_read_b64_tr_b16 a[88:89], v8 offset:0
    v_mul_f32 v47, s34, v47
    v_mfma_f32_16x16x32_bf16 v[92:95], a[104:107], a[212:215], v[92:95]
    ds_read_b64_tr_b16 a[90:91], v8 offset:4096
    buffer_store_dwordx4 v[240:243], v1, s[12:15], s59 offen offset:3072 sc1
    v_mfma_f32_16x16x32_bf16 v[92:95], a[108:111], a[220:223], v[92:95]
    ds_read_b64_tr_b16 a[92:93], v8 offset:16384
    v_mul_f32 v60, s34, v60
    v_mfma_f32_16x16x32_bf16 v[92:95], a[64:67], a[116:119], v[92:95]
    ds_read_b64_tr_b16 a[94:95], v8 offset:20480
    v_xor_b32 v9, 131264, v6
    v_mfma_f32_16x16x32_bf16 v[92:95], a[68:71], a[124:127], v[92:95]
    s_waitcnt lgkmcnt(6)
    ds_read_b64_tr_b16 a[96:97], v9 offset:0
    v_mul_f32 v61, s34, v61
    v_mfma_f32_16x16x32_bf16 v[100:103], a[72:75], a[192:195], v[100:103]
    ds_read_b64_tr_b16 a[98:99], v9 offset:4096
    v_mul_f32 v62, s34, v62
    v_mfma_f32_16x16x32_bf16 v[100:103], a[76:79], a[200:203], v[100:103]
    ds_read_b64_tr_b16 a[100:101], v9 offset:16384
    v_mul_f32 v63, s34, v63
    v_mfma_f32_16x16x32_bf16 v[100:103], a[80:83], a[208:211], v[100:103]
    s_waitcnt lgkmcnt(3)
    ds_read_b64_tr_b16 a[102:103], v9 offset:20480
    v_xor_b32 v10, 192, v6
    v_mfma_f32_16x16x32_bf16 v[100:103], a[84:87], a[216:219], v[100:103]
    ds_read_b64_tr_b16 a[104:105], v10 offset:0
    v_cvt_pk_bf16_f32 v44, v44, v45
    v_mfma_f32_16x16x32_bf16 v[100:103], a[88:91], a[112:115], v[100:103]
    ds_read_b64_tr_b16 a[106:107], v10 offset:4096
    v_cvt_pk_bf16_f32 v45, v46, v47
    v_mfma_f32_16x16x32_bf16 v[100:103], a[92:95], a[120:123], v[100:103]
    ds_read_b64_tr_b16 a[108:109], v10 offset:16384
    v_cvt_pk_bf16_f32 v46, v60, v61
    v_mfma_f32_16x16x32_bf16 v[108:111], a[72:75], a[196:199], v[108:111]
    ds_read_b64_tr_b16 a[110:111], v10 offset:20480
    v_xor_b32 v7, 65728, v6
    v_mfma_f32_16x16x32_bf16 v[108:111], a[76:79], a[204:207], v[108:111]
    s_add_u32 s59, s58, 36864
    ds_read_b64_tr_b16 a[64:65], v7 offset:0
    v_cvt_pk_bf16_f32 v47, v62, v63
    v_mfma_f32_16x16x32_bf16 v[108:111], a[80:83], a[212:215], v[108:111]
    ds_read_b64_tr_b16 a[66:67], v7 offset:4096
    buffer_store_dwordx4 v[248:251], v1, s[12:15], s59 offen offset:3072 sc1
    v_mfma_f32_16x16x32_bf16 v[108:111], a[84:87], a[220:223], v[108:111]
    ds_read_b64_tr_b16 a[68:69], v7 offset:16384
    v_accvgpr_write_b32 a32, v44
    v_mfma_f32_16x16x32_bf16 v[108:111], a[88:91], a[116:119], v[108:111]
    s_add_u32 s59, s62, 32768
    ds_read_b64_tr_b16 a[70:71], v7 offset:20480
    v_xor_b32 v8, 131296, v6
    v_mfma_f32_16x16x32_bf16 v[108:111], a[92:95], a[124:127], v[108:111]
    s_waitcnt lgkmcnt(6)
    ds_read_b64_tr_b16 a[72:73], v8 offset:0
    buffer_store_dwordx4 v[44:47], v1, s[12:15], s59 offen offset:0 sc1
    v_mfma_f32_16x16x32_bf16 v[116:119], a[96:99], a[192:195], v[116:119]
    ds_read_b64_tr_b16 a[74:75], v8 offset:4096
    v_accvgpr_write_b32 a33, v45
    v_mfma_f32_16x16x32_bf16 v[116:119], a[100:103], a[200:203], v[116:119]
    ds_read_b64_tr_b16 a[76:77], v8 offset:16384
    v_accvgpr_write_b32 a34, v46
    v_mfma_f32_16x16x32_bf16 v[116:119], a[104:107], a[208:211], v[116:119]
    s_waitcnt lgkmcnt(3)
    ds_read_b64_tr_b16 a[78:79], v8 offset:20480
    v_xor_b32 v9, 224, v6
    v_mfma_f32_16x16x32_bf16 v[116:119], a[108:111], a[216:219], v[116:119]
    ds_read_b64_tr_b16 a[80:81], v9 offset:0
    v_accvgpr_write_b32 a35, v47
    v_mfma_f32_16x16x32_bf16 v[116:119], a[64:67], a[112:115], v[116:119]
    ds_read_b64_tr_b16 a[82:83], v9 offset:4096
    v_mul_f32 v20, s34, v20
    v_mfma_f32_16x16x32_bf16 v[116:119], a[68:71], a[120:123], v[116:119]
    ds_read_b64_tr_b16 a[84:85], v9 offset:16384
    v_mul_f32 v21, s34, v21
    v_mfma_f32_16x16x32_bf16 v[124:127], a[96:99], a[196:199], v[124:127]
    ds_read_b64_tr_b16 a[86:87], v9 offset:20480
    v_xor_b32 v10, 65760, v6
    v_mfma_f32_16x16x32_bf16 v[124:127], a[100:103], a[204:207], v[124:127]
    ds_read_b64_tr_b16 a[88:89], v10 offset:0
    v_mul_f32 v22, s34, v22
    v_mfma_f32_16x16x32_bf16 v[124:127], a[104:107], a[212:215], v[124:127]
    ds_read_b64_tr_b16 a[90:91], v10 offset:4096
    v_mul_f32 v23, s34, v23
    v_mfma_f32_16x16x32_bf16 v[124:127], a[108:111], a[220:223], v[124:127]
    ds_read_b64_tr_b16 a[92:93], v10 offset:16384
    v_mul_f32 v68, s34, v68
    v_mfma_f32_16x16x32_bf16 v[124:127], a[64:67], a[116:119], v[124:127]
    ds_read_b64_tr_b16 a[94:95], v10 offset:20480
    v_xor_b32 v7, 131328, v6
    v_mfma_f32_16x16x32_bf16 v[124:127], a[68:71], a[124:127], v[124:127]
    s_waitcnt lgkmcnt(6)
    ds_read_b64_tr_b16 a[96:97], v7 offset:0
    v_mul_f32 v69, s34, v69
    v_mfma_f32_16x16x32_bf16 v[132:135], a[72:75], a[192:195], v[132:135]
    ds_read_b64_tr_b16 a[98:99], v7 offset:4096
    v_mul_f32 v70, s34, v70
    v_mfma_f32_16x16x32_bf16 v[132:135], a[76:79], a[200:203], v[132:135]
    ds_read_b64_tr_b16 a[100:101], v7 offset:16384
    v_mul_f32 v71, s34, v71
    v_mfma_f32_16x16x32_bf16 v[132:135], a[80:83], a[208:211], v[132:135]
    s_waitcnt lgkmcnt(3)
    ds_read_b64_tr_b16 a[102:103], v7 offset:20480
    v_xor_b32 v8, 256, v6
    v_mfma_f32_16x16x32_bf16 v[132:135], a[84:87], a[216:219], v[132:135]
    ds_read_b64_tr_b16 a[104:105], v8 offset:0
    v_cvt_pk_bf16_f32 v20, v20, v21
    v_mfma_f32_16x16x32_bf16 v[132:135], a[88:91], a[112:115], v[132:135]
    ds_read_b64_tr_b16 a[106:107], v8 offset:4096
    v_cvt_pk_bf16_f32 v21, v22, v23
    v_mfma_f32_16x16x32_bf16 v[132:135], a[92:95], a[120:123], v[132:135]
    ds_read_b64_tr_b16 a[108:109], v8 offset:16384
    v_cvt_pk_bf16_f32 v22, v68, v69
    v_mfma_f32_16x16x32_bf16 v[140:143], a[72:75], a[196:199], v[140:143]
    ds_read_b64_tr_b16 a[110:111], v8 offset:20480
    v_xor_b32 v9, 65792, v6
    v_mfma_f32_16x16x32_bf16 v[140:143], a[76:79], a[204:207], v[140:143]
    s_waitcnt vmcnt(1)
    ds_read_b64_tr_b16 a[64:65], v9 offset:0
    v_cvt_pk_bf16_f32 v23, v70, v71
    v_mfma_f32_16x16x32_bf16 v[140:143], a[80:83], a[212:215], v[140:143]
    s_barrier
    ds_read_b64_tr_b16 a[66:67], v9 offset:4096
    v_accvgpr_write_b32 a4, v20
    v_mfma_f32_16x16x32_bf16 v[140:143], a[84:87], a[220:223], v[140:143]
    ds_read_b64_tr_b16 a[68:69], v9 offset:16384
    buffer_store_dword v11, off, s[12:15], s92 sc1
    v_mfma_f32_16x16x32_bf16 v[140:143], a[88:91], a[116:119], v[140:143]
    s_add_u32 s59, s62, 0
    ds_read_b64_tr_b16 a[70:71], v9 offset:20480
    v_xor_b32 v10, 131360, v6
    v_mfma_f32_16x16x32_bf16 v[140:143], a[92:95], a[124:127], v[140:143]
    s_waitcnt lgkmcnt(6)
    ds_read_b64_tr_b16 a[72:73], v10 offset:0
    buffer_store_dwordx4 v[20:23], v1, s[12:15], s59 offen offset:1024 sc1
    v_mfma_f32_16x16x32_bf16 v[148:151], a[96:99], a[192:195], v[148:151]
    ds_read_b64_tr_b16 a[74:75], v10 offset:4096
    v_accvgpr_write_b32 a5, v21
    v_mfma_f32_16x16x32_bf16 v[148:151], a[100:103], a[200:203], v[148:151]
    ds_read_b64_tr_b16 a[76:77], v10 offset:16384
    v_accvgpr_write_b32 a6, v22
    v_mfma_f32_16x16x32_bf16 v[148:151], a[104:107], a[208:211], v[148:151]
    s_waitcnt lgkmcnt(3)
    ds_read_b64_tr_b16 a[78:79], v10 offset:20480
    v_xor_b32 v7, 288, v6
    v_mfma_f32_16x16x32_bf16 v[148:151], a[108:111], a[216:219], v[148:151]
    ds_read_b64_tr_b16 a[80:81], v7 offset:0
    v_accvgpr_write_b32 a7, v23
    v_mfma_f32_16x16x32_bf16 v[148:151], a[64:67], a[112:115], v[148:151]
    ds_read_b64_tr_b16 a[82:83], v7 offset:4096
    v_mul_f32 v36, s34, v36
    v_mfma_f32_16x16x32_bf16 v[148:151], a[68:71], a[120:123], v[148:151]
    ds_read_b64_tr_b16 a[84:85], v7 offset:16384
    v_mul_f32 v37, s34, v37
    v_mfma_f32_16x16x32_bf16 v[156:159], a[96:99], a[196:199], v[156:159]
    ds_read_b64_tr_b16 a[86:87], v7 offset:20480
    v_xor_b32 v8, 65824, v6
    v_mfma_f32_16x16x32_bf16 v[156:159], a[100:103], a[204:207], v[156:159]
    ds_read_b64_tr_b16 a[88:89], v8 offset:0
    v_mul_f32 v38, s34, v38
    v_mfma_f32_16x16x32_bf16 v[156:159], a[104:107], a[212:215], v[156:159]
    ds_read_b64_tr_b16 a[90:91], v8 offset:4096
    v_mul_f32 v39, s34, v39
    v_mfma_f32_16x16x32_bf16 v[156:159], a[108:111], a[220:223], v[156:159]
    ds_read_b64_tr_b16 a[92:93], v8 offset:16384
    v_mul_f32 v76, s34, v76
    v_mfma_f32_16x16x32_bf16 v[156:159], a[64:67], a[116:119], v[156:159]
    ds_read_b64_tr_b16 a[94:95], v8 offset:20480
    v_xor_b32 v9, 131392, v6
    v_mfma_f32_16x16x32_bf16 v[156:159], a[68:71], a[124:127], v[156:159]
    s_waitcnt lgkmcnt(6)
    ds_read_b64_tr_b16 a[96:97], v9 offset:0
    v_mul_f32 v77, s34, v77
    v_mfma_f32_16x16x32_bf16 v[164:167], a[72:75], a[192:195], v[164:167]
    ds_read_b64_tr_b16 a[98:99], v9 offset:4096
    v_mul_f32 v78, s34, v78
    v_mfma_f32_16x16x32_bf16 v[164:167], a[76:79], a[200:203], v[164:167]
    ds_read_b64_tr_b16 a[100:101], v9 offset:16384
    v_mul_f32 v79, s34, v79
    v_mfma_f32_16x16x32_bf16 v[164:167], a[80:83], a[208:211], v[164:167]
    s_waitcnt lgkmcnt(3)
    ds_read_b64_tr_b16 a[102:103], v9 offset:20480
    v_xor_b32 v10, 320, v6
    v_mfma_f32_16x16x32_bf16 v[164:167], a[84:87], a[216:219], v[164:167]
    ds_read_b64_tr_b16 a[104:105], v10 offset:0
    v_cvt_pk_bf16_f32 v36, v36, v37
    v_mfma_f32_16x16x32_bf16 v[164:167], a[88:91], a[112:115], v[164:167]
    ds_read_b64_tr_b16 a[106:107], v10 offset:4096
    v_cvt_pk_bf16_f32 v37, v38, v39
    v_mfma_f32_16x16x32_bf16 v[164:167], a[92:95], a[120:123], v[164:167]
    ds_read_b64_tr_b16 a[108:109], v10 offset:16384
    v_cvt_pk_bf16_f32 v38, v76, v77
    v_mfma_f32_16x16x32_bf16 v[172:175], a[72:75], a[196:199], v[172:175]
    ds_read_b64_tr_b16 a[110:111], v10 offset:20480
    v_xor_b32 v7, 65856, v6
    v_mfma_f32_16x16x32_bf16 v[172:175], a[76:79], a[204:207], v[172:175]
    s_add_u32 s59, s62, 32768
    ds_read_b64_tr_b16 a[64:65], v7 offset:0
    v_cvt_pk_bf16_f32 v39, v78, v79
    v_mfma_f32_16x16x32_bf16 v[172:175], a[80:83], a[212:215], v[172:175]
    ds_read_b64_tr_b16 a[66:67], v7 offset:4096
    buffer_store_dwordx4 v[36:39], v1, s[12:15], s59 offen offset:1024 sc1
    v_mfma_f32_16x16x32_bf16 v[172:175], a[84:87], a[220:223], v[172:175]
    ds_read_b64_tr_b16 a[68:69], v7 offset:16384
    v_accvgpr_write_b32 a36, v36
    v_mfma_f32_16x16x32_bf16 v[172:175], a[88:91], a[116:119], v[172:175]
    ds_read_b64_tr_b16 a[70:71], v7 offset:20480
    v_xor_b32 v8, 131424, v6
    v_mfma_f32_16x16x32_bf16 v[172:175], a[92:95], a[124:127], v[172:175]
    s_waitcnt lgkmcnt(6)
    ds_read_b64_tr_b16 a[72:73], v8 offset:0
    v_accvgpr_write_b32 a37, v37
    v_mfma_f32_16x16x32_bf16 v[180:183], a[96:99], a[192:195], v[180:183]
    ds_read_b64_tr_b16 a[74:75], v8 offset:4096
    v_accvgpr_write_b32 a38, v38
    v_mfma_f32_16x16x32_bf16 v[180:183], a[100:103], a[200:203], v[180:183]
    ds_read_b64_tr_b16 a[76:77], v8 offset:16384
    v_accvgpr_write_b32 a39, v39
    v_mfma_f32_16x16x32_bf16 v[180:183], a[104:107], a[208:211], v[180:183]
    s_waitcnt lgkmcnt(3)
    ds_read_b64_tr_b16 a[78:79], v8 offset:20480
    v_xor_b32 v9, 352, v6
    v_mfma_f32_16x16x32_bf16 v[180:183], a[108:111], a[216:219], v[180:183]
    ds_read_b64_tr_b16 a[80:81], v9 offset:0
    v_mul_f32 v84, s34, v84
    v_mfma_f32_16x16x32_bf16 v[180:183], a[64:67], a[112:115], v[180:183]
    ds_read_b64_tr_b16 a[82:83], v9 offset:4096
    v_mul_f32 v85, s34, v85
    v_mfma_f32_16x16x32_bf16 v[180:183], a[68:71], a[120:123], v[180:183]
    ds_read_b64_tr_b16 a[84:85], v9 offset:16384
    v_mul_f32 v86, s34, v86
    v_mfma_f32_16x16x32_bf16 v[188:191], a[96:99], a[196:199], v[188:191]
    ds_read_b64_tr_b16 a[86:87], v9 offset:20480
    v_xor_b32 v10, 65888, v6
    v_mfma_f32_16x16x32_bf16 v[188:191], a[100:103], a[204:207], v[188:191]
    ds_read_b64_tr_b16 a[88:89], v10 offset:0
    v_mul_f32 v87, s34, v87
    v_mfma_f32_16x16x32_bf16 v[188:191], a[104:107], a[212:215], v[188:191]
    ds_read_b64_tr_b16 a[90:91], v10 offset:4096
    v_mul_f32 v100, s34, v100
    v_mfma_f32_16x16x32_bf16 v[188:191], a[108:111], a[220:223], v[188:191]
    ds_read_b64_tr_b16 a[92:93], v10 offset:16384
    v_mul_f32 v101, s34, v101
    v_mfma_f32_16x16x32_bf16 v[188:191], a[64:67], a[116:119], v[188:191]
    ds_read_b64_tr_b16 a[94:95], v10 offset:20480
    v_xor_b32 v7, 131456, v6
    v_mfma_f32_16x16x32_bf16 v[188:191], a[68:71], a[124:127], v[188:191]
    s_waitcnt lgkmcnt(6)
    ds_read_b64_tr_b16 a[96:97], v7 offset:0
    v_mul_f32 v102, s34, v102
    v_mfma_f32_16x16x32_bf16 v[196:199], a[72:75], a[192:195], v[196:199]
    ds_read_b64_tr_b16 a[98:99], v7 offset:4096
    v_mul_f32 v103, s34, v103
    v_mfma_f32_16x16x32_bf16 v[196:199], a[76:79], a[200:203], v[196:199]
    ds_read_b64_tr_b16 a[100:101], v7 offset:16384
    v_cvt_pk_bf16_f32 v84, v84, v85
    v_mfma_f32_16x16x32_bf16 v[196:199], a[80:83], a[208:211], v[196:199]
    s_waitcnt lgkmcnt(3)
    ds_read_b64_tr_b16 a[102:103], v7 offset:20480
    v_xor_b32 v8, 384, v6
    v_mfma_f32_16x16x32_bf16 v[196:199], a[84:87], a[216:219], v[196:199]
    ds_read_b64_tr_b16 a[104:105], v8 offset:0
    v_cvt_pk_bf16_f32 v85, v86, v87
    v_mfma_f32_16x16x32_bf16 v[196:199], a[88:91], a[112:115], v[196:199]
    ds_read_b64_tr_b16 a[106:107], v8 offset:4096
    v_cvt_pk_bf16_f32 v86, v100, v101
    v_mfma_f32_16x16x32_bf16 v[196:199], a[92:95], a[120:123], v[196:199]
    ds_read_b64_tr_b16 a[108:109], v8 offset:16384
    v_cvt_pk_bf16_f32 v87, v102, v103
    v_mfma_f32_16x16x32_bf16 v[204:207], a[72:75], a[196:199], v[204:207]
    s_add_u32 s59, s62, 0
    ds_read_b64_tr_b16 a[110:111], v8 offset:20480
    v_xor_b32 v9, 65920, v6
    v_mfma_f32_16x16x32_bf16 v[204:207], a[76:79], a[204:207], v[204:207]
    ds_read_b64_tr_b16 a[64:65], v9 offset:0
    buffer_store_dwordx4 v[84:87], v1, s[12:15], s59 offen offset:2048 sc1
    v_mfma_f32_16x16x32_bf16 v[204:207], a[80:83], a[212:215], v[204:207]
    ds_read_b64_tr_b16 a[66:67], v9 offset:4096
    v_accvgpr_write_b32 a8, v84
    v_mfma_f32_16x16x32_bf16 v[204:207], a[84:87], a[220:223], v[204:207]
    ds_read_b64_tr_b16 a[68:69], v9 offset:16384
    v_accvgpr_write_b32 a9, v85
    v_mfma_f32_16x16x32_bf16 v[204:207], a[88:91], a[116:119], v[204:207]
    ds_read_b64_tr_b16 a[70:71], v9 offset:20480
    v_xor_b32 v10, 131488, v6
    v_mfma_f32_16x16x32_bf16 v[204:207], a[92:95], a[124:127], v[204:207]
    s_waitcnt lgkmcnt(6)
    ds_read_b64_tr_b16 a[72:73], v10 offset:0
    v_accvgpr_write_b32 a10, v86
    v_mfma_f32_16x16x32_bf16 v[212:215], a[96:99], a[192:195], v[212:215]
    ds_read_b64_tr_b16 a[74:75], v10 offset:4096
    v_accvgpr_write_b32 a11, v87
    v_mfma_f32_16x16x32_bf16 v[212:215], a[100:103], a[200:203], v[212:215]
    ds_read_b64_tr_b16 a[76:77], v10 offset:16384
    v_mul_f32 v92, s34, v92
    v_mfma_f32_16x16x32_bf16 v[212:215], a[104:107], a[208:211], v[212:215]
    s_waitcnt lgkmcnt(3)
    ds_read_b64_tr_b16 a[78:79], v10 offset:20480
    v_xor_b32 v7, 416, v6
    v_mfma_f32_16x16x32_bf16 v[212:215], a[108:111], a[216:219], v[212:215]
    ds_read_b64_tr_b16 a[80:81], v7 offset:0
    v_mul_f32 v93, s34, v93
    v_mfma_f32_16x16x32_bf16 v[212:215], a[64:67], a[112:115], v[212:215]
    ds_read_b64_tr_b16 a[82:83], v7 offset:4096
    v_mul_f32 v94, s34, v94
    v_mfma_f32_16x16x32_bf16 v[212:215], a[68:71], a[120:123], v[212:215]
    ds_read_b64_tr_b16 a[84:85], v7 offset:16384
    v_mul_f32 v95, s34, v95
    v_mfma_f32_16x16x32_bf16 v[220:223], a[96:99], a[196:199], v[220:223]
    ds_read_b64_tr_b16 a[86:87], v7 offset:20480
    v_xor_b32 v8, 65952, v6
    v_mfma_f32_16x16x32_bf16 v[220:223], a[100:103], a[204:207], v[220:223]
    ds_read_b64_tr_b16 a[88:89], v8 offset:0
    v_mul_f32 v108, s34, v108
    v_mfma_f32_16x16x32_bf16 v[220:223], a[104:107], a[212:215], v[220:223]
    ds_read_b64_tr_b16 a[90:91], v8 offset:4096
    v_mul_f32 v109, s34, v109
    v_mfma_f32_16x16x32_bf16 v[220:223], a[108:111], a[220:223], v[220:223]
    ds_read_b64_tr_b16 a[92:93], v8 offset:16384
    v_mul_f32 v110, s34, v110
    v_mfma_f32_16x16x32_bf16 v[220:223], a[64:67], a[116:119], v[220:223]
    ds_read_b64_tr_b16 a[94:95], v8 offset:20480
    v_xor_b32 v9, 131520, v6
    v_mfma_f32_16x16x32_bf16 v[220:223], a[68:71], a[124:127], v[220:223]
    s_waitcnt lgkmcnt(6)
    ds_read_b64_tr_b16 a[96:97], v9 offset:0
    v_mul_f32 v111, s34, v111
    v_mfma_f32_16x16x32_bf16 v[228:231], a[72:75], a[192:195], v[228:231]
    ds_read_b64_tr_b16 a[98:99], v9 offset:4096
    v_cvt_pk_bf16_f32 v92, v92, v93
    v_mfma_f32_16x16x32_bf16 v[228:231], a[76:79], a[200:203], v[228:231]
    ds_read_b64_tr_b16 a[100:101], v9 offset:16384
    v_cvt_pk_bf16_f32 v93, v94, v95
    v_mfma_f32_16x16x32_bf16 v[228:231], a[80:83], a[208:211], v[228:231]
    s_waitcnt lgkmcnt(3)
    ds_read_b64_tr_b16 a[102:103], v9 offset:20480
    v_xor_b32 v10, 448, v6
    v_mfma_f32_16x16x32_bf16 v[228:231], a[84:87], a[216:219], v[228:231]
    ds_read_b64_tr_b16 a[104:105], v10 offset:0
    v_cvt_pk_bf16_f32 v94, v108, v109
    v_mfma_f32_16x16x32_bf16 v[228:231], a[88:91], a[112:115], v[228:231]
    s_add_u32 s59, s62, 32768
    ds_read_b64_tr_b16 a[106:107], v10 offset:4096
    v_cvt_pk_bf16_f32 v95, v110, v111
    v_mfma_f32_16x16x32_bf16 v[228:231], a[92:95], a[120:123], v[228:231]
    ds_read_b64_tr_b16 a[108:109], v10 offset:16384
    buffer_store_dwordx4 v[92:95], v1, s[12:15], s59 offen offset:2048 sc1
    v_mfma_f32_16x16x32_bf16 v[236:239], a[72:75], a[196:199], v[236:239]
    ds_read_b64_tr_b16 a[110:111], v10 offset:20480
    v_xor_b32 v7, 65984, v6
    v_mfma_f32_16x16x32_bf16 v[236:239], a[76:79], a[204:207], v[236:239]
    ds_read_b64_tr_b16 a[64:65], v7 offset:0
    v_accvgpr_write_b32 a40, v92
    v_mfma_f32_16x16x32_bf16 v[236:239], a[80:83], a[212:215], v[236:239]
    ds_read_b64_tr_b16 a[66:67], v7 offset:4096
    v_accvgpr_write_b32 a41, v93
    v_mfma_f32_16x16x32_bf16 v[236:239], a[84:87], a[220:223], v[236:239]
    ds_read_b64_tr_b16 a[68:69], v7 offset:16384
    v_accvgpr_write_b32 a42, v94
    v_mfma_f32_16x16x32_bf16 v[236:239], a[88:91], a[116:119], v[236:239]
    ds_read_b64_tr_b16 a[70:71], v7 offset:20480
    v_xor_b32 v8, 131552, v6
    v_mfma_f32_16x16x32_bf16 v[236:239], a[92:95], a[124:127], v[236:239]
    s_waitcnt lgkmcnt(6)
    ds_read_b64_tr_b16 a[72:73], v8 offset:0
    v_accvgpr_write_b32 a43, v95
    v_mfma_f32_16x16x32_bf16 v[244:247], a[96:99], a[192:195], v[244:247]
    ds_read_b64_tr_b16 a[74:75], v8 offset:4096
    v_mfma_f32_16x16x32_bf16 v[244:247], a[100:103], a[200:203], v[244:247]
    ds_read_b64_tr_b16 a[76:77], v8 offset:16384
    v_mfma_f32_16x16x32_bf16 v[244:247], a[104:107], a[208:211], v[244:247]
    s_waitcnt lgkmcnt(3)
    ds_read_b64_tr_b16 a[78:79], v8 offset:20480
    v_xor_b32 v9, 480, v6
    v_mfma_f32_16x16x32_bf16 v[244:247], a[108:111], a[216:219], v[244:247]
    ds_read_b64_tr_b16 a[80:81], v9 offset:0
    v_mfma_f32_16x16x32_bf16 v[244:247], a[64:67], a[112:115], v[244:247]
    ds_read_b64_tr_b16 a[82:83], v9 offset:4096
    v_mfma_f32_16x16x32_bf16 v[244:247], a[68:71], a[120:123], v[244:247]
    ds_read_b64_tr_b16 a[84:85], v9 offset:16384
    v_mfma_f32_16x16x32_bf16 v[252:255], a[96:99], a[196:199], v[252:255]
    ds_read_b64_tr_b16 a[86:87], v9 offset:20480
    v_xor_b32 v10, 66016, v6
    v_mfma_f32_16x16x32_bf16 v[252:255], a[100:103], a[204:207], v[252:255]
    ds_read_b64_tr_b16 a[88:89], v10 offset:0
    v_mfma_f32_16x16x32_bf16 v[252:255], a[104:107], a[212:215], v[252:255]
    ds_read_b64_tr_b16 a[90:91], v10 offset:4096
    v_mfma_f32_16x16x32_bf16 v[252:255], a[108:111], a[220:223], v[252:255]
    ds_read_b64_tr_b16 a[92:93], v10 offset:16384
    v_mfma_f32_16x16x32_bf16 v[252:255], a[64:67], a[116:119], v[252:255]
    ds_read_b64_tr_b16 a[94:95], v10 offset:20480
    v_mfma_f32_16x16x32_bf16 v[252:255], a[68:71], a[124:127], v[252:255]
    s_waitcnt lgkmcnt(6)
    v_mfma_f32_16x16x32_bf16 v[16:19], a[72:75], a[192:195], v[16:19]
    v_mfma_f32_16x16x32_bf16 v[16:19], a[76:79], a[200:203], v[16:19]
    v_mfma_f32_16x16x32_bf16 v[16:19], a[80:83], a[208:211], v[16:19]
    s_waitcnt lgkmcnt(0)
    v_mfma_f32_16x16x32_bf16 v[16:19], a[84:87], a[216:219], v[16:19]
    v_mfma_f32_16x16x32_bf16 v[16:19], a[88:91], a[112:115], v[16:19]
    v_mfma_f32_16x16x32_bf16 v[16:19], a[92:95], a[120:123], v[16:19]
    v_mfma_f32_16x16x32_bf16 v[24:27], a[72:75], a[196:199], v[24:27]
    v_mfma_f32_16x16x32_bf16 v[24:27], a[76:79], a[204:207], v[24:27]
    v_mfma_f32_16x16x32_bf16 v[24:27], a[80:83], a[212:215], v[24:27]
    v_mfma_f32_16x16x32_bf16 v[24:27], a[84:87], a[220:223], v[24:27]
    s_waitcnt lgkmcnt(0)
    v_mfma_f32_16x16x32_bf16 v[24:27], a[88:91], a[116:119], v[24:27]
    s_barrier
    v_mfma_f32_16x16x32_bf16 v[24:27], a[92:95], a[124:127], v[24:27]
    s_nop 3
    v_pk_mul_f32 v[116:117], v[116:117], s[34:35]
    v_pk_mul_f32 v[118:119], v[118:119], s[34:35]
    v_pk_mul_f32 v[132:133], v[132:133], s[34:35]
    v_pk_mul_f32 v[134:135], v[134:135], s[34:35]
    v_cvt_pk_bf16_f32 v116, v116, v117
    v_cvt_pk_bf16_f32 v117, v118, v119
    v_cvt_pk_bf16_f32 v118, v132, v133
    v_cvt_pk_bf16_f32 v119, v134, v135
    s_add_u32 s59, s62, 0
    buffer_store_dwordx4 v[116:119], v1, s[12:15], s59 offen offset:3072 sc1
    v_accvgpr_write_b32 a12, v116
    v_accvgpr_write_b32 a13, v117
    v_accvgpr_write_b32 a14, v118
    v_accvgpr_write_b32 a15, v119
    v_pk_mul_f32 v[124:125], v[124:125], s[34:35]
    v_pk_mul_f32 v[126:127], v[126:127], s[34:35]
    v_pk_mul_f32 v[140:141], v[140:141], s[34:35]
    v_pk_mul_f32 v[142:143], v[142:143], s[34:35]
    v_cvt_pk_bf16_f32 v124, v124, v125
    v_cvt_pk_bf16_f32 v125, v126, v127
    v_cvt_pk_bf16_f32 v126, v140, v141
    v_cvt_pk_bf16_f32 v127, v142, v143
    s_add_u32 s59, s62, 32768
    buffer_store_dwordx4 v[124:127], v1, s[12:15], s59 offen offset:3072 sc1
    v_accvgpr_write_b32 a44, v124
    v_accvgpr_write_b32 a45, v125
    v_accvgpr_write_b32 a46, v126
    v_accvgpr_write_b32 a47, v127
    v_pk_mul_f32 v[148:149], v[148:149], s[34:35]
    v_pk_mul_f32 v[150:151], v[150:151], s[34:35]
    v_pk_mul_f32 v[164:165], v[164:165], s[34:35]
    v_pk_mul_f32 v[166:167], v[166:167], s[34:35]
    v_cvt_pk_bf16_f32 v148, v148, v149
    v_cvt_pk_bf16_f32 v149, v150, v151
    v_cvt_pk_bf16_f32 v150, v164, v165
    v_cvt_pk_bf16_f32 v151, v166, v167
    s_add_u32 s59, s62, 4096
    buffer_store_dwordx4 v[148:151], v1, s[12:15], s59 offen offset:0 sc1
    v_accvgpr_write_b32 a16, v148
    v_accvgpr_write_b32 a17, v149
    v_accvgpr_write_b32 a18, v150
    v_accvgpr_write_b32 a19, v151
    v_pk_mul_f32 v[156:157], v[156:157], s[34:35]
    v_pk_mul_f32 v[158:159], v[158:159], s[34:35]
    v_pk_mul_f32 v[172:173], v[172:173], s[34:35]
    v_pk_mul_f32 v[174:175], v[174:175], s[34:35]
    v_cvt_pk_bf16_f32 v156, v156, v157
    v_cvt_pk_bf16_f32 v157, v158, v159
    v_cvt_pk_bf16_f32 v158, v172, v173
    v_cvt_pk_bf16_f32 v159, v174, v175
    s_add_u32 s59, s62, 36864
    buffer_store_dwordx4 v[156:159], v1, s[12:15], s59 offen offset:0 sc1
    v_accvgpr_write_b32 a48, v156
    v_accvgpr_write_b32 a49, v157
    v_accvgpr_write_b32 a50, v158
    v_accvgpr_write_b32 a51, v159
    v_pk_mul_f32 v[180:181], v[180:181], s[34:35]
    v_pk_mul_f32 v[182:183], v[182:183], s[34:35]
    v_pk_mul_f32 v[196:197], v[196:197], s[34:35]
    v_pk_mul_f32 v[198:199], v[198:199], s[34:35]
    v_cvt_pk_bf16_f32 v180, v180, v181
    v_cvt_pk_bf16_f32 v181, v182, v183
    v_cvt_pk_bf16_f32 v182, v196, v197
    v_cvt_pk_bf16_f32 v183, v198, v199
    s_add_u32 s59, s62, 4096
    buffer_store_dwordx4 v[180:183], v1, s[12:15], s59 offen offset:1024 sc1
    v_accvgpr_write_b32 a20, v180
    v_accvgpr_write_b32 a21, v181
    v_accvgpr_write_b32 a22, v182
    v_accvgpr_write_b32 a23, v183
    v_pk_mul_f32 v[188:189], v[188:189], s[34:35]
    v_pk_mul_f32 v[190:191], v[190:191], s[34:35]
    v_pk_mul_f32 v[204:205], v[204:205], s[34:35]
    v_pk_mul_f32 v[206:207], v[206:207], s[34:35]
    v_cvt_pk_bf16_f32 v188, v188, v189
    v_cvt_pk_bf16_f32 v189, v190, v191
    v_cvt_pk_bf16_f32 v190, v204, v205
    v_cvt_pk_bf16_f32 v191, v206, v207
    s_add_u32 s59, s62, 36864
    buffer_store_dwordx4 v[188:191], v1, s[12:15], s59 offen offset:1024 sc1
    v_accvgpr_write_b32 a52, v188
    v_accvgpr_write_b32 a53, v189
    v_accvgpr_write_b32 a54, v190
    v_accvgpr_write_b32 a55, v191
    v_pk_mul_f32 v[212:213], v[212:213], s[34:35]
    v_pk_mul_f32 v[214:215], v[214:215], s[34:35]
    v_pk_mul_f32 v[228:229], v[228:229], s[34:35]
    v_pk_mul_f32 v[230:231], v[230:231], s[34:35]
    v_cvt_pk_bf16_f32 v212, v212, v213
    v_cvt_pk_bf16_f32 v213, v214, v215
    v_cvt_pk_bf16_f32 v214, v228, v229
    v_cvt_pk_bf16_f32 v215, v230, v231
    s_add_u32 s59, s62, 4096
    buffer_store_dwordx4 v[212:215], v1, s[12:15], s59 offen offset:2048 sc1
    v_accvgpr_write_b32 a24, v212
    v_accvgpr_write_b32 a25, v213
    v_accvgpr_write_b32 a26, v214
    v_accvgpr_write_b32 a27, v215
    v_pk_mul_f32 v[220:221], v[220:221], s[34:35]
    v_pk_mul_f32 v[222:223], v[222:223], s[34:35]
    v_pk_mul_f32 v[236:237], v[236:237], s[34:35]
    v_pk_mul_f32 v[238:239], v[238:239], s[34:35]
    v_cvt_pk_bf16_f32 v220, v220, v221
    v_cvt_pk_bf16_f32 v221, v222, v223
    v_cvt_pk_bf16_f32 v222, v236, v237
    v_cvt_pk_bf16_f32 v223, v238, v239
    s_add_u32 s59, s62, 36864
    buffer_store_dwordx4 v[220:223], v1, s[12:15], s59 offen offset:2048 sc1
    v_accvgpr_write_b32 a56, v220
    v_accvgpr_write_b32 a57, v221
    v_accvgpr_write_b32 a58, v222
    v_accvgpr_write_b32 a59, v223
    v_pk_mul_f32 v[244:245], v[244:245], s[34:35]
    v_pk_mul_f32 v[246:247], v[246:247], s[34:35]
    v_pk_mul_f32 v[16:17], v[16:17], s[34:35]
    v_pk_mul_f32 v[18:19], v[18:19], s[34:35]
    v_cvt_pk_bf16_f32 v244, v244, v245
    v_cvt_pk_bf16_f32 v245, v246, v247
    v_cvt_pk_bf16_f32 v246, v16, v17
    v_cvt_pk_bf16_f32 v247, v18, v19
    s_add_u32 s59, s62, 4096
    buffer_store_dwordx4 v[244:247], v1, s[12:15], s59 offen offset:3072 sc1
    v_accvgpr_write_b32 a28, v244
    v_accvgpr_write_b32 a29, v245
    v_accvgpr_write_b32 a30, v246
    v_accvgpr_write_b32 a31, v247
    v_pk_mul_f32 v[252:253], v[252:253], s[34:35]
    v_pk_mul_f32 v[254:255], v[254:255], s[34:35]
    v_pk_mul_f32 v[24:25], v[24:25], s[34:35]
    v_pk_mul_f32 v[26:27], v[26:27], s[34:35]
    v_cvt_pk_bf16_f32 v252, v252, v253
    v_cvt_pk_bf16_f32 v253, v254, v255
    v_cvt_pk_bf16_f32 v254, v24, v25
    v_cvt_pk_bf16_f32 v255, v26, v27
    s_add_u32 s59, s62, 36864
    buffer_store_dwordx4 v[252:255], v1, s[12:15], s59 offen offset:3072 sc1
    v_accvgpr_write_b32 a60, v252
    v_accvgpr_write_b32 a61, v253
    v_accvgpr_write_b32 a62, v254
    v_accvgpr_write_b32 a63, v255
L_kvdone:
    s_cmp_ge_u32 s28, 14
    s_cbranch_scc1 L_s1a
    s_and_b32 s33, s95, 31
    s_lshr_b32 s34, s95, 5
    v_lshrrev_b32 v104, 3, v0
    s_lshl_b32 s35, s3, 3
    v_add_u32 v104, s35, v104
    v_lshlrev_b32 v106, 8, v104
    v_lshlrev_b32 v104, 1, v104
    s_lshl_b32 s35, s33, 6
    v_add_u32 v104, s35, v104
    v_mul_u32_u24 v104, 896, v104
    v_and_b32 v105, 7, v0
    v_lshl_add_u32 v104, v105, 4, v104
    s_lshl_b32 s35, s34, 7
    v_add_u32 v104, s35, v104
    v_lshl_add_u32 v106, v105, 4, v106
    v_add_u32 v106, 0x20000, v106
    v_lshlrev_b32 v105, 6, v105
    s_lshl_b32 s35, s34, 9
    v_add_u32 v105, s35, v105
    v_subrev_u32 v107, 2688, v104
    v_subrev_u32 v108, 1792, v104
    v_subrev_u32 v109, 896, v104
    s_mov_b32 s4, s66
    s_mov_b32 s5, s67
    s_mov_b32 s6, 1835008
    s_mov_b32 s7, 0x20000
    s_mov_b32 s8, s68
    s_mov_b32 s9, s69
    s_mov_b32 s10, 1835008
    s_mov_b32 s11, 0x20000
    s_mov_b32 s16, s70
    s_mov_b32 s17, s71
    s_mov_b32 s18, 3584
    s_mov_b32 s19, 0x20000
    buffer_load_dwordx4 v[16:19], v107, s[4:7], 0 offen
    buffer_load_dwordx4 v[20:23], v108, s[4:7], 0 offen
    buffer_load_dwordx4 v[24:27], v109, s[4:7], 0 offen
    buffer_load_dwordx4 v[28:31], v104, s[4:7], 0 offen offset:0
    buffer_load_dwordx4 v[32:35], v104, s[4:7], 0 offen offset:896
    buffer_load_dwordx4 v[36:39], v104, s[8:11], 0 offen offset:0
    buffer_load_dwordx4 v[40:43], v104, s[8:11], 0 offen offset:896
    buffer_load_dwordx4 v[44:47], v105, s[16:19], 0 offen offset:0
    buffer_load_dwordx4 v[48:51], v105, s[16:19], 0 offen offset:16
    buffer_load_dwordx4 v[52:55], v105, s[16:19], 0 offen offset:32
    buffer_load_dwordx4 v[56:59], v105, s[16:19], 0 offen offset:48
L_s1a:
    s_lshl_b32 s37, s26, 7
    s_add_u32 s37, s37, 84934656
    v_and_b32 v14, 15, v0
    v_lshlrev_b32 v14, 2, v14
    v_mov_b32 v13, 0
    s_mov_b32 s32, 0
L_pollA:
    global_load_dword v15, v13, s[90:91] offset:128 sc1
    s_add_u32 s32, s32, 1
    s_waitcnt vmcnt(0)
    v_cmp_gt_u32 vcc, 256, v15
    s_cmp_lt_u32 s32, 0x80000
    s_cselect_b64 vcc, vcc, 0
    s_cbranch_vccnz L_pollA
    v_and_b32 v14, 15, v0
    v_lshlrev_b32 v14, 2, v14
    s_mov_b32 s32, 0
L_poll0:
    buffer_load_dword v15, v14, s[12:15], s37 offen sc1
    s_waitcnt vmcnt(0)
    v_cmp_ne_u32 vcc, 1, v15
    s_cbranch_vccz L_poll0_ok
    s_sleep 2
    s_add_u32 s32, s32, 1
    s_cmp_lt_u32 s32, 0x80000
    s_cbranch_scc1 L_poll0
L_poll0_ok:
    s_lshl_b32 s37, s25, 1
    s_sub_i32 s38, 14, s37
    s_max_i32 s38, s38, 0
    s_lshl_b32 s49, s26, 20
    s_lshl_b32 s50, s3, 13
    s_add_u32 s49, s49, s50
    s_mov_b32 s51, s63
    s_add_u32 s53, s37, 2
    s_sub_u32 s55, 32, s37
    s_sub_u32 s55, s55, s38
    s_cmp_eq_u32 s27, 0
    s_cselect_b32 s53, s53, s55
    s_cselect_b32 s52, 0, s38
    s_cselect_b32 s54, 0, 2
    v_lshlrev_b32 v1, 4, v0
    v_add_u32 v4, 4096, v1
    s_lshl_b32 s55, s52, 15
    s_add_u32 s42, s55, s49
    s_add_u32 s43, s42, 16777216
    s_mov_b32 s40, s50
    s_add_u32 s41, s50, 0x10000
    s_mov_b32 m0, s40
    s_nop 0
    buffer_load_dwordx4 v1, s[12:15], s42 offen offset:0 sc1 lds
    buffer_load_dwordx4 v1, s[12:15], s42 offen offset:1024 sc1 lds
    buffer_load_dwordx4 v1, s[12:15], s42 offen offset:2048 sc1 lds
    buffer_load_dwordx4 v1, s[12:15], s42 offen offset:3072 sc1 lds
    s_bitset1_b32 m0, 12
    s_nop 0
    buffer_load_dwordx4 v4, s[12:15], s42 offen offset:0 sc1 lds
    buffer_load_dwordx4 v4, s[12:15], s42 offen offset:1024 sc1 lds
    buffer_load_dwordx4 v4, s[12:15], s42 offen offset:2048 sc1 lds
    buffer_load_dwordx4 v4, s[12:15], s42 offen offset:3072 sc1 lds
    s_add_u32 s42, s42, 0x8000
    s_xor_b32 s40, s40, 0x8000
    s_mov_b32 m0, s40
    s_nop 0
    buffer_load_dwordx4 v1, s[12:15], s42 offen offset:0 sc1 lds
    buffer_load_dwordx4 v1, s[12:15], s42 offen offset:1024 sc1 lds
    buffer_load_dwordx4 v1, s[12:15], s42 offen offset:2048 sc1 lds
    buffer_load_dwordx4 v1, s[12:15], s42 offen offset:3072 sc1 lds
    s_bitset1_b32 m0, 12
    s_nop 0
    buffer_load_dwordx4 v4, s[12:15], s42 offen offset:0 sc1 lds
    buffer_load_dwordx4 v4, s[12:15], s42 offen offset:1024 sc1 lds
    buffer_load_dwordx4 v4, s[12:15], s42 offen offset:2048 sc1 lds
    buffer_load_dwordx4 v4, s[12:15], s42 offen offset:3072 sc1 lds
    s_add_u32 s42, s42, 0x8000
    s_xor_b32 s40, s40, 0x8000
    s_cmp_ge_u32 s28, 14
    s_cbranch_scc1 L_s1b
    s_mov_b32 s36, 0xffff0000
    v_lshlrev_b32 v64, 16, v16
    v_and_b32 v65, s36, v16
    v_lshlrev_b32 v66, 16, v20
    v_and_b32 v67, s36, v20
    v_lshlrev_b32 v68, 16, v24
    v_and_b32 v69, s36, v24
    v_lshlrev_b32 v70, 16, v28
    v_and_b32 v71, s36, v28
    v_lshlrev_b32 v72, 16, v32
    v_and_b32 v73, s36, v32
    v_lshlrev_b32 v74, 16, v36
    v_and_b32 v75, s36, v36
    v_lshlrev_b32 v76, 16, v40
    v_and_b32 v77, s36, v40
    v_lshlrev_b32 v78, 16, v44
    v_lshlrev_b32 v79, 16, v46
    v_and_b32 v80, s36, v44
    v_and_b32 v81, s36, v46
    v_lshlrev_b32 v82, 16, v45
    v_lshlrev_b32 v83, 16, v47
    v_and_b32 v84, s36, v45
    v_and_b32 v85, s36, v47
    v_pk_mul_f32 v[86:87], v[64:65], v[84:85]
    v_pk_fma_f32 v[86:87], v[66:67], v[82:83], v[86:87]
    v_pk_fma_f32 v[86:87], v[68:69], v[80:81], v[86:87]
    v_pk_fma_f32 v[86:87], v[70:71], v[78:79], v[86:87]
    v_pk_mul_f32 v[86:87], v[86:87], v[74:75]
    v_cvt_pk_bf16_f32 v92, v86, v87
    v_pk_mul_f32 v[88:89], v[66:67], v[84:85]
    v_pk_fma_f32 v[88:89], v[68:69], v[82:83], v[88:89]
    v_pk_fma_f32 v[88:89], v[70:71], v[80:81], v[88:89]
    v_pk_fma_f32 v[88:89], v[72:73], v[78:79], v[88:89]
    v_pk_mul_f32 v[88:89], v[88:89], v[76:77]
    v_cvt_pk_bf16_f32 v96, v88, v89
    v_lshlrev_b32 v64, 16, v17
    v_and_b32 v65, s36, v17
    v_lshlrev_b32 v66, 16, v21
    v_and_b32 v67, s36, v21
    v_lshlrev_b32 v68, 16, v25
    v_and_b32 v69, s36, v25
    v_lshlrev_b32 v70, 16, v29
    v_and_b32 v71, s36, v29
    v_lshlrev_b32 v72, 16, v33
    v_and_b32 v73, s36, v33
    v_lshlrev_b32 v74, 16, v37
    v_and_b32 v75, s36, v37
    v_lshlrev_b32 v76, 16, v41
    v_and_b32 v77, s36, v41
    v_lshlrev_b32 v78, 16, v48
    v_lshlrev_b32 v79, 16, v50
    v_and_b32 v80, s36, v48
    v_and_b32 v81, s36, v50
    v_lshlrev_b32 v82, 16, v49
    v_lshlrev_b32 v83, 16, v51
    v_and_b32 v84, s36, v49
    v_and_b32 v85, s36, v51
    v_pk_mul_f32 v[86:87], v[64:65], v[84:85]
    v_pk_fma_f32 v[86:87], v[66:67], v[82:83], v[86:87]
    v_pk_fma_f32 v[86:87], v[68:69], v[80:81], v[86:87]
    v_pk_fma_f32 v[86:87], v[70:71], v[78:79], v[86:87]
    v_pk_mul_f32 v[86:87], v[86:87], v[74:75]
    v_cvt_pk_bf16_f32 v93, v86, v87
    v_pk_mul_f32 v[88:89], v[66:67], v[84:85]
    v_pk_fma_f32 v[88:89], v[68:69], v[82:83], v[88:89]
    v_pk_fma_f32 v[88:89], v[70:71], v[80:81], v[88:89]
    v_pk_fma_f32 v[88:89], v[72:73], v[78:79], v[88:89]
    v_pk_mul_f32 v[88:89], v[88:89], v[76:77]
    v_cvt_pk_bf16_f32 v97, v88, v89
    v_lshlrev_b32 v64, 16, v18
    v_and_b32 v65, s36, v18
    v_lshlrev_b32 v66, 16, v22
    v_and_b32 v67, s36, v22
    v_lshlrev_b32 v68, 16, v26
    v_and_b32 v69, s36, v26
    v_lshlrev_b32 v70, 16, v30
    v_and_b32 v71, s36, v30
    v_lshlrev_b32 v72, 16, v34
    v_and_b32 v73, s36, v34
    v_lshlrev_b32 v74, 16, v38
    v_and_b32 v75, s36, v38
    v_lshlrev_b32 v76, 16, v42
    v_and_b32 v77, s36, v42
    v_lshlrev_b32 v78, 16, v52
    v_lshlrev_b32 v79, 16, v54
    v_and_b32 v80, s36, v52
    v_and_b32 v81, s36, v54
    v_lshlrev_b32 v82, 16, v53
    v_lshlrev_b32 v83, 16, v55
    v_and_b32 v84, s36, v53
    v_and_b32 v85, s36, v55
    v_pk_mul_f32 v[86:87], v[64:65], v[84:85]
    v_pk_fma_f32 v[86:87], v[66:67], v[82:83], v[86:87]
    v_pk_fma_f32 v[86:87], v[68:69], v[80:81], v[86:87]
    v_pk_fma_f32 v[86:87], v[70:71], v[78:79], v[86:87]
    v_pk_mul_f32 v[86:87], v[86:87], v[74:75]
    v_cvt_pk_bf16_f32 v94, v86, v87
    v_pk_mul_f32 v[88:89], v[66:67], v[84:85]
    v_pk_fma_f32 v[88:89], v[68:69], v[82:83], v[88:89]
    v_pk_fma_f32 v[88:89], v[70:71], v[80:81], v[88:89]
    v_pk_fma_f32 v[88:89], v[72:73], v[78:79], v[88:89]
    v_pk_mul_f32 v[88:89], v[88:89], v[76:77]
    v_cvt_pk_bf16_f32 v98, v88, v89
    v_lshlrev_b32 v64, 16, v19
    v_and_b32 v65, s36, v19
    v_lshlrev_b32 v66, 16, v23
    v_and_b32 v67, s36, v23
    v_lshlrev_b32 v68, 16, v27
    v_and_b32 v69, s36, v27
    v_lshlrev_b32 v70, 16, v31
    v_and_b32 v71, s36, v31
    v_lshlrev_b32 v72, 16, v35
    v_and_b32 v73, s36, v35
    v_lshlrev_b32 v74, 16, v39
    v_and_b32 v75, s36, v39
    v_lshlrev_b32 v76, 16, v43
    v_and_b32 v77, s36, v43
    v_lshlrev_b32 v78, 16, v56
    v_lshlrev_b32 v79, 16, v58
    v_and_b32 v80, s36, v56
    v_and_b32 v81, s36, v58
    v_lshlrev_b32 v82, 16, v57
    v_lshlrev_b32 v83, 16, v59
    v_and_b32 v84, s36, v57
    v_and_b32 v85, s36, v59
    v_pk_mul_f32 v[86:87], v[64:65], v[84:85]
    v_pk_fma_f32 v[86:87], v[66:67], v[82:83], v[86:87]
    v_pk_fma_f32 v[86:87], v[68:69], v[80:81], v[86:87]
    v_pk_fma_f32 v[86:87], v[70:71], v[78:79], v[86:87]
    v_pk_mul_f32 v[86:87], v[86:87], v[74:75]
    v_cvt_pk_bf16_f32 v95, v86, v87
    v_pk_mul_f32 v[88:89], v[66:67], v[84:85]
    v_pk_fma_f32 v[88:89], v[68:69], v[82:83], v[88:89]
    v_pk_fma_f32 v[88:89], v[70:71], v[80:81], v[88:89]
    v_pk_fma_f32 v[88:89], v[72:73], v[78:79], v[88:89]
    v_pk_mul_f32 v[88:89], v[88:89], v[76:77]
    v_cvt_pk_bf16_f32 v99, v88, v89
    ds_write_b128 v106, v[92:95] offset:0
    ds_write_b128 v106, v[96:99] offset:128
    v_bfe_u32 v24, v0, 2, 2
    v_bfe_u32 v26, v0, 4, 1
    v_lshl_add_u32 v24, v26, 3, v24
    v_lshlrev_b32 v24, 2, v24
    v_lshrrev_b32 v26, 5, v0
    v_add_u32 v24, v24, v26
    v_lshlrev_b32 v24, 7, v24
    v_and_b32 v26, 3, v0
    v_lshl_add_u32 v24, v26, 3, v24
    s_lshl_b32 s35, s3, 5
    s_add_u32 s35, s35, 0x20000
    v_add_u32 v24, s35, v24
    v_and_b32 v25, 15, v0
    v_lshlrev_b32 v25, 12, v25
    v_lshrrev_b32 v26, 4, v0
    v_lshl_add_u32 v25, v26, 4, v25
    s_lshl_b32 s35, s34, 2
    s_add_u32 s35, s35, s3
    s_lshl_b32 s35, s35, 16
    s_lshl_b32 s36, s33, 7
    s_add_u32 s35, s35, s36
    s_add_u32 s35, s35, 85983232
    s_waitcnt lgkmcnt(0)
L_s1b:
    v_and_b32 v14, 15, v0
    v_lshrrev_b32 v11, 4, v0
    v_lshlrev_b32 v11, 2, v11
    v_sub_u32 v14, v14, v11
    s_lshl_b32 s48, s3, 4
    v_add_u32 v14, s48, v14
    v_mov_b32 v2, v1
    v_add_u32 v3, 0x10000, v1
    v_mov_b64 v[96:97], 0
    v_mov_b64 v[98:99], 0
    v_mov_b64 v[100:101], 0
    v_mov_b64 v[102:103], 0
    v_mov_b64 v[104:105], 0
    v_mov_b64 v[106:107], 0
    v_mov_b64 v[108:109], 0
    v_mov_b64 v[110:111], 0
    v_mov_b64 v[112:113], 0
    v_mov_b64 v[114:115], 0
    v_mov_b64 v[116:117], 0
    v_mov_b64 v[118:119], 0
    v_mov_b64 v[120:121], 0
    v_mov_b64 v[122:123], 0
    v_mov_b64 v[124:125], 0
    v_mov_b64 v[126:127], 0
    v_mov_b64 v[128:129], 0
    v_mov_b64 v[130:131], 0
    v_mov_b64 v[132:133], 0
    v_mov_b64 v[134:135], 0
    v_mov_b64 v[136:137], 0
    v_mov_b64 v[138:139], 0
    v_mov_b64 v[140:141], 0
    v_mov_b64 v[142:143], 0
    v_mov_b64 v[144:145], 0
    v_mov_b64 v[146:147], 0
    v_mov_b64 v[148:149], 0
    v_mov_b64 v[150:151], 0
    v_mov_b64 v[152:153], 0
    v_mov_b64 v[154:155], 0
    v_mov_b64 v[156:157], 0
    v_mov_b64 v[158:159], 0
    v_mov_b64 v[160:161], 0
    v_mov_b64 v[162:163], 0
    v_mov_b64 v[164:165], 0
    v_mov_b64 v[166:167], 0
    v_mov_b64 v[168:169], 0
    v_mov_b64 v[170:171], 0
    v_mov_b64 v[172:173], 0
    v_mov_b64 v[174:175], 0
    v_mov_b64 v[176:177], 0
    v_mov_b64 v[178:179], 0
    v_mov_b64 v[180:181], 0
    v_mov_b64 v[182:183], 0
    v_mov_b64 v[184:185], 0
    v_mov_b64 v[186:187], 0
    v_mov_b64 v[188:189], 0
    v_mov_b64 v[190:191], 0
    v_mov_b64 v[192:193], 0
    v_mov_b64 v[194:195], 0
    v_mov_b64 v[196:197], 0
    v_mov_b64 v[198:199], 0
    v_mov_b64 v[200:201], 0
    v_mov_b64 v[202:203], 0
    v_mov_b64 v[204:205], 0
    v_mov_b64 v[206:207], 0
    v_mov_b64 v[208:209], 0
    v_mov_b64 v[210:211], 0
    v_mov_b64 v[212:213], 0
    v_mov_b64 v[214:215], 0
    v_mov_b64 v[216:217], 0
    v_mov_b64 v[218:219], 0
    v_mov_b64 v[220:221], 0
    v_mov_b64 v[222:223], 0
    v_mov_b64 v[224:225], 0
    v_mov_b64 v[226:227], 0
    v_mov_b64 v[228:229], 0
    v_mov_b64 v[230:231], 0
    v_mov_b64 v[232:233], 0
    v_mov_b64 v[234:235], 0
    v_mov_b64 v[236:237], 0
    v_mov_b64 v[238:239], 0
    v_mov_b64 v[240:241], 0
    v_mov_b64 v[242:243], 0
    v_mov_b64 v[244:245], 0
    v_mov_b64 v[246:247], 0
    v_mov_b64 v[248:249], 0
    v_mov_b64 v[250:251], 0
    v_mov_b64 v[252:253], 0
    v_mov_b64 v[254:255], 0
    v_mov_b32 v7, 0
    v_mov_b32 v8, 0
    v_mov_b32 v9, 0
    v_mov_b32 v10, 0
    s_mov_b32 s47, 0x4b800000
    s_mov_b32 s45, 2
    s_sub_u32 s44, s53, 1
    s_cmp_ge_u32 s44, 2
    s_cbranch_scc1 L_nomask0
    v_mov_b32 v11, 0xf149f2ca
    v_cmp_gt_i32 s[16:17], 0, v14
    v_cmp_gt_i32 s[18:19], 1, v14
    v_cmp_gt_i32 s[20:21], 2, v14
    v_cmp_gt_i32 s[22:23], 3, v14
    v_cndmask_b32 v96, v9, v11, s[16:17]
    v_cndmask_b32 v97, v9, v11, s[18:19]
    v_cndmask_b32 v98, v9, v11, s[20:21]
    v_cndmask_b32 v99, v9, v11, s[22:23]
    v_cmp_gt_i32 s[16:17], 16, v14
    v_cmp_gt_i32 s[18:19], 17, v14
    v_cmp_gt_i32 s[20:21], 18, v14
    v_cmp_gt_i32 s[22:23], 19, v14
    v_cndmask_b32 v104, v9, v11, s[16:17]
    v_cndmask_b32 v105, v9, v11, s[18:19]
    v_cndmask_b32 v106, v9, v11, s[20:21]
    v_cndmask_b32 v107, v9, v11, s[22:23]
    v_cmp_gt_i32 s[16:17], 32, v14
    v_cmp_gt_i32 s[18:19], 33, v14
    v_cmp_gt_i32 s[20:21], 34, v14
    v_cmp_gt_i32 s[22:23], 35, v14
    v_cndmask_b32 v112, v9, v11, s[16:17]
    v_cndmask_b32 v113, v9, v11, s[18:19]
    v_cndmask_b32 v114, v9, v11, s[20:21]
    v_cndmask_b32 v115, v9, v11, s[22:23]
    v_cmp_gt_i32 s[16:17], 48, v14
    v_cmp_gt_i32 s[18:19], 49, v14
    v_cmp_gt_i32 s[20:21], 50, v14
    v_cmp_gt_i32 s[22:23], 51, v14
    v_cndmask_b32 v120, v9, v11, s[16:17]
    v_cndmask_b32 v121, v9, v11, s[18:19]
    v_cndmask_b32 v122, v9, v11, s[20:21]
    v_cndmask_b32 v123, v9, v11, s[22:23]
L_nomask0:
    v_mov_b32 v27, 1
    s_lshl_b32 s36, s95, 2
    s_add_u32 s36, s36, 84959232
    s_cmp_lt_u32 s28, 14
    s_cselect_b32 s36, s36, s92
    s_add_u32 s33, s94, 4
    s_cmp_eq_u32 s27, 1
    s_cselect_b32 s33, s33, s92
    s_waitcnt vmcnt(8)
    s_barrier
    ds_read_b128 a[64:67], v2 offset:0
    ds_read_b128 a[68:71], v2 offset:1024
    ds_read_b128 a[72:75], v2 offset:2048
    ds_read_b128 a[76:79], v2 offset:3072
    ds_read_b128 a[80:83], v2 offset:4096
    ds_read_b128 a[84:87], v2 offset:5120
    ds_read_b128 a[88:91], v2 offset:6144
    ds_read_b128 a[92:95], v2 offset:7168
    buffer_store_dword v27, off, s[12:15], s33 sc1
    s_cmp_ge_u32 s28, 14
    s_cbranch_scc1 L_s1c
    ds_read_b64_tr_b16 v[16:17], v24 offset:0
    ds_read_b64_tr_b16 v[18:19], v24 offset:2048
    ds_read_b64_tr_b16 v[20:21], v24 offset:256
    ds_read_b64_tr_b16 v[22:23], v24 offset:2304
    s_waitcnt lgkmcnt(0)
    buffer_store_dwordx4 v[16:19], v25, s[12:15], s35 offen offset:0 sc1
    buffer_store_dwordx4 v[20:23], v25, s[12:15], s35 offen offset:64 sc1
L_s1c:
    s_mov_b32 m0, s41
    s_waitcnt lgkmcnt(0)
    v_mfma_f32_16x16x32_bf16 v[32:35], a[64:67], a[0:3], v[96:99]
    ds_read_b128 a[96:99], v2 offset:8192
    v_mfma_f32_16x16x32_bf16 v[32:35], a[68:71], a[4:7], v[32:35]
    buffer_load_dwordx4 v1, s[12:15], s43 offen offset:0 sc1 lds
    v_mfma_f32_16x16x32_bf16 v[32:35], a[72:75], a[8:11], v[32:35]
    ds_read_b128 a[100:103], v2 offset:9216
    v_mfma_f32_16x16x32_bf16 v[32:35], a[76:79], a[12:15], v[32:35]
    v_mfma_f32_16x16x32_bf16 v[32:35], a[80:83], a[16:19], v[32:35]
    ds_read_b128 a[104:107], v2 offset:10240
    v_mfma_f32_16x16x32_bf16 v[32:35], a[84:87], a[20:23], v[32:35]
    buffer_load_dwordx4 v1, s[12:15], s43 offen offset:1024 sc1 lds
    v_mfma_f32_16x16x32_bf16 v[32:35], a[88:91], a[24:27], v[32:35]
    ds_read_b128 a[108:111], v2 offset:11264
    v_mfma_f32_16x16x32_bf16 v[32:35], a[92:95], a[28:31], v[32:35]
    v_mfma_f32_16x16x32_bf16 v[36:39], a[64:67], a[32:35], v[100:103]
    ds_read_b128 a[112:115], v2 offset:12288
    v_mfma_f32_16x16x32_bf16 v[36:39], a[68:71], a[36:39], v[36:39]
    buffer_load_dwordx4 v1, s[12:15], s43 offen offset:2048 sc1 lds
    v_mfma_f32_16x16x32_bf16 v[36:39], a[72:75], a[40:43], v[36:39]
    ds_read_b128 a[116:119], v2 offset:13312
    v_mfma_f32_16x16x32_bf16 v[36:39], a[76:79], a[44:47], v[36:39]
    v_mfma_f32_16x16x32_bf16 v[36:39], a[80:83], a[48:51], v[36:39]
    ds_read_b128 a[120:123], v2 offset:14336
    v_mfma_f32_16x16x32_bf16 v[36:39], a[84:87], a[52:55], v[36:39]
    buffer_load_dwordx4 v1, s[12:15], s43 offen offset:3072 sc1 lds
    v_mfma_f32_16x16x32_bf16 v[36:39], a[88:91], a[56:59], v[36:39]
    ds_read_b128 a[124:127], v2 offset:15360
    v_mfma_f32_16x16x32_bf16 v[36:39], a[92:95], a[60:63], v[36:39]
    s_waitcnt lgkmcnt(6)
    v_exp_f32 v64, v32
    v_mfma_f32_16x16x32_bf16 v[40:43], a[96:99], a[0:3], v[104:107]
    s_bitset1_b32 m0, 12
    ds_read_b128 a[64:67], v2 offset:16384
    v_mfma_f32_16x16x32_bf16 v[40:43], a[100:103], a[4:7], v[40:43]
    s_waitcnt lgkmcnt(5)
    buffer_load_dwordx4 v4, s[12:15], s43 offen offset:0 sc1 lds
    v_mfma_f32_16x16x32_bf16 v[40:43], a[104:107], a[8:11], v[40:43]
    ds_read_b128 a[68:71], v2 offset:17408
    v_mfma_f32_16x16x32_bf16 v[40:43], a[108:111], a[12:15], v[40:43]
    s_waitcnt lgkmcnt(4)
    v_exp_f32 v65, v33
    v_mfma_f32_16x16x32_bf16 v[40:43], a[112:115], a[16:19], v[40:43]
    ds_read_b128 a[72:75], v2 offset:18432
    v_add_f32 v5, v64, v65
    v_mfma_f32_16x16x32_bf16 v[40:43], a[116:119], a[20:23], v[40:43]
    s_waitcnt lgkmcnt(3)
    buffer_load_dwordx4 v4, s[12:15], s43 offen offset:1024 sc1 lds
    v_mfma_f32_16x16x32_bf16 v[40:43], a[120:123], a[24:27], v[40:43]
    ds_read_b128 a[76:79], v2 offset:19456
    v_mfma_f32_16x16x32_bf16 v[40:43], a[124:127], a[28:31], v[40:43]
    v_exp_f32 v66, v34
    v_mfma_f32_16x16x32_bf16 v[44:47], a[96:99], a[32:35], v[108:111]
    ds_read_b128 a[80:83], v2 offset:20480
    v_add_f32 v5, v5, v66
    v_mfma_f32_16x16x32_bf16 v[44:47], a[100:103], a[36:39], v[44:47]
    buffer_load_dwordx4 v4, s[12:15], s43 offen offset:2048 sc1 lds
    v_mfma_f32_16x16x32_bf16 v[44:47], a[104:107], a[40:43], v[44:47]
    ds_read_b128 a[84:87], v2 offset:21504
    v_mfma_f32_16x16x32_bf16 v[44:47], a[108:111], a[44:47], v[44:47]
    v_exp_f32 v67, v35
    v_mfma_f32_16x16x32_bf16 v[44:47], a[112:115], a[48:51], v[44:47]
    ds_read_b128 a[88:91], v2 offset:22528
    v_add_f32 v5, v5, v67
    v_mfma_f32_16x16x32_bf16 v[44:47], a[116:119], a[52:55], v[44:47]
    buffer_load_dwordx4 v4, s[12:15], s43 offen offset:3072 sc1 lds
    v_mfma_f32_16x16x32_bf16 v[44:47], a[120:123], a[56:59], v[44:47]
    ds_read_b128 a[92:95], v2 offset:23552
    v_mfma_f32_16x16x32_bf16 v[44:47], a[124:127], a[60:63], v[44:47]
    s_waitcnt lgkmcnt(6)
    v_exp_f32 v68, v36
    v_mfma_f32_16x16x32_bf16 v[48:51], a[64:67], a[0:3], v[112:115]
    s_add_u32 s43, s43, 0x8000
    ds_read_b128 a[96:99], v2 offset:24576
    v_mfma_f32_16x16x32_bf16 v[48:51], a[68:71], a[4:7], v[48:51]
    s_waitcnt lgkmcnt(5)
    v_exp_f32 v69, v37
    v_mfma_f32_16x16x32_bf16 v[48:51], a[72:75], a[8:11], v[48:51]
    s_xor_b32 s41, s41, 0x8000
    ds_read_b128 a[100:103], v2 offset:25600
    v_add_f32 v6, v68, v69
    v_mfma_f32_16x16x32_bf16 v[48:51], a[76:79], a[12:15], v[48:51]
    s_waitcnt lgkmcnt(4)
    v_exp_f32 v70, v38
    v_mfma_f32_16x16x32_bf16 v[48:51], a[80:83], a[16:19], v[48:51]
    ds_read_b128 a[104:107], v2 offset:26624
    v_add_f32 v6, v6, v70
    v_mfma_f32_16x16x32_bf16 v[48:51], a[84:87], a[20:23], v[48:51]
    s_waitcnt lgkmcnt(3)
    v_exp_f32 v71, v39
    v_mfma_f32_16x16x32_bf16 v[48:51], a[88:91], a[24:27], v[48:51]
    ds_read_b128 a[108:111], v2 offset:27648
    v_add_f32 v6, v6, v71
    v_mfma_f32_16x16x32_bf16 v[48:51], a[92:95], a[28:31], v[48:51]
    v_exp_f32 v72, v40
    v_mfma_f32_16x16x32_bf16 v[52:55], a[64:67], a[32:35], v[116:119]
    ds_read_b128 a[112:115], v2 offset:28672
    v_add_f32 v5, v5, v72
    v_mfma_f32_16x16x32_bf16 v[52:55], a[68:71], a[36:39], v[52:55]
    v_exp_f32 v73, v41
    v_mfma_f32_16x16x32_bf16 v[52:55], a[72:75], a[40:43], v[52:55]
    ds_read_b128 a[116:119], v2 offset:29696
    v_add_f32 v5, v5, v73
    v_mfma_f32_16x16x32_bf16 v[52:55], a[76:79], a[44:47], v[52:55]
    v_exp_f32 v74, v42
    v_mfma_f32_16x16x32_bf16 v[52:55], a[80:83], a[48:51], v[52:55]
    ds_read_b128 a[120:123], v2 offset:30720
    v_add_f32 v5, v5, v74
    v_mfma_f32_16x16x32_bf16 v[52:55], a[84:87], a[52:55], v[52:55]
    v_exp_f32 v75, v43
    v_mfma_f32_16x16x32_bf16 v[52:55], a[88:91], a[56:59], v[52:55]
    ds_read_b128 a[124:127], v2 offset:31744
    v_add_f32 v5, v5, v75
    v_mfma_f32_16x16x32_bf16 v[52:55], a[92:95], a[60:63], v[52:55]
    s_waitcnt lgkmcnt(6)
    v_exp_f32 v76, v44
    v_mfma_f32_16x16x32_bf16 v[56:59], a[96:99], a[0:3], v[120:123]
    v_exp_f32 v77, v45
    v_mfma_f32_16x16x32_bf16 v[56:59], a[100:103], a[4:7], v[56:59]
    s_waitcnt lgkmcnt(4)
    v_exp_f32 v78, v46
    v_mfma_f32_16x16x32_bf16 v[56:59], a[104:107], a[8:11], v[56:59]
    v_exp_f32 v79, v47
    v_mfma_f32_16x16x32_bf16 v[56:59], a[108:111], a[12:15], v[56:59]
    s_waitcnt lgkmcnt(2)
    v_exp_f32 v80, v48
    v_mfma_f32_16x16x32_bf16 v[56:59], a[112:115], a[16:19], v[56:59]
    v_exp_f32 v81, v49
    v_mfma_f32_16x16x32_bf16 v[56:59], a[116:119], a[20:23], v[56:59]
    s_waitcnt lgkmcnt(0)
    v_exp_f32 v82, v50
    v_mfma_f32_16x16x32_bf16 v[56:59], a[120:123], a[24:27], v[56:59]
    v_exp_f32 v83, v51
    v_mfma_f32_16x16x32_bf16 v[56:59], a[124:127], a[28:31], v[56:59]
    v_exp_f32 v84, v52
    v_mfma_f32_16x16x32_bf16 v[60:63], a[96:99], a[32:35], v[124:127]
    v_exp_f32 v85, v53
    v_mfma_f32_16x16x32_bf16 v[60:63], a[100:103], a[36:39], v[60:63]
    v_exp_f32 v86, v54
    v_mfma_f32_16x16x32_bf16 v[60:63], a[104:107], a[40:43], v[60:63]
    v_exp_f32 v87, v55
    v_mfma_f32_16x16x32_bf16 v[60:63], a[108:111], a[44:47], v[60:63]
    v_add_f32 v6, v6, v76
    v_mfma_f32_16x16x32_bf16 v[60:63], a[112:115], a[48:51], v[60:63]
    v_add_f32 v6, v6, v77
    v_mfma_f32_16x16x32_bf16 v[60:63], a[116:119], a[52:55], v[60:63]
    v_exp_f32 v88, v56
    v_mfma_f32_16x16x32_bf16 v[60:63], a[120:123], a[56:59], v[60:63]
    v_exp_f32 v89, v57
    v_mfma_f32_16x16x32_bf16 v[60:63], a[124:127], a[60:63], v[60:63]
    v_exp_f32 v90, v58
    v_xor_b32 v2, 0x8000, v2
    s_waitcnt vmcnt(8)
    s_barrier
    ds_read_b128 a[64:67], v2 offset:0
    ds_read_b128 a[68:71], v2 offset:1024
    ds_read_b128 a[72:75], v2 offset:2048
    ds_read_b128 a[76:79], v2 offset:3072
    ds_read_b128 a[80:83], v2 offset:4096
    ds_read_b128 a[84:87], v2 offset:5120
    ds_read_b128 a[88:91], v2 offset:6144
    ds_read_b128 a[92:95], v2 offset:7168
    buffer_store_dword v27, off, s[12:15], s36 sc1
    v_exp_f32 v91, v59
    v_exp_f32 v92, v60
    v_exp_f32 v93, v61
    v_exp_f32 v94, v62
    v_exp_f32 v95, v63
    v_add_f32 v6, v6, v78
    v_add_f32 v6, v6, v79
    v_add_f32 v5, v5, v80
    v_add_f32 v5, v5, v81
    v_add_f32 v5, v5, v82
    v_add_f32 v5, v5, v83
    v_add_f32 v6, v6, v84
    v_add_f32 v6, v6, v85
    v_add_f32 v6, v6, v86
    v_add_f32 v6, v6, v87
    v_add_f32 v5, v5, v88
    v_add_f32 v5, v5, v89
    v_add_f32 v5, v5, v90
    v_add_f32 v5, v5, v91
    v_add_f32 v6, v6, v92
    v_add_f32 v6, v6, v93
    v_add_f32 v6, v6, v94
    v_add_f32 v6, v6, v95
L_first:
    v_add_f32 v11, v5, v6
    v_min_f32 v12, v5, v6
    v_cmp_nge_f32 vcc, s47, v11
    s_mov_b32 s46, 0xff800000
    s_cbranch_vccnz L_slow2
    v_cmp_gt_f32 vcc, 0x33800000, v12
    s_cbranch_vccnz L_slow2
    s_mov_b32 s46, 0
    s_waitcnt lgkmcnt(0)
    s_branch L_ret
L_slow:
    s_cmp_lg_u32 s47, 0x4b800000
    s_cbranch_scc1 L_switched
    s_nop 5
L_slow2:
    v_max3_f32 v11, v32, v33, v34
    v_max3_f32 v11, v11, v35, v40
    v_max3_f32 v11, v11, v41, v42
    v_max3_f32 v11, v11, v43, v48
    v_max3_f32 v11, v11, v49, v50
    v_max3_f32 v11, v11, v51, v56
    v_max3_f32 v11, v11, v57, v58
    v_max_f32 v11, v11, v59
    v_mov_b32 v13, v11
    s_nop 1
    v_permlane32_swap_b32 v11, v13
    s_nop 1
    v_max_f32 v11, v11, v13
    v_mov_b32 v13, v11
    s_nop 1
    v_permlane16_swap_b32 v11, v13
    s_nop 1
    v_max_f32 v11, v11, v13
    v_max_f32 v11, s46, v11
    v_sub_f32 v9, v9, v11
    v_sub_f32 v32, v32, v11
    v_sub_f32 v33, v33, v11
    v_sub_f32 v34, v34, v11
    v_sub_f32 v35, v35, v11
    v_sub_f32 v40, v40, v11
    v_sub_f32 v41, v41, v11
    v_sub_f32 v42, v42, v11
    v_sub_f32 v43, v43, v11
    v_sub_f32 v48, v48, v11
    v_sub_f32 v49, v49, v11
    v_sub_f32 v50, v50, v11
    v_sub_f32 v51, v51, v11
    v_sub_f32 v56, v56, v11
    v_sub_f32 v57, v57, v11
    v_sub_f32 v58, v58, v11
    v_sub_f32 v59, v59, v11
    v_exp_f32 v64, v32
    v_mov_b32 v96, v9
    v_exp_f32 v65, v33
    v_mov_b32 v97, v9
    v_exp_f32 v66, v34
    v_mov_b32 v98, v9
    v_exp_f32 v67, v35
    v_mov_b32 v99, v9
    v_exp_f32 v72, v40
    v_mov_b32 v104, v9
    v_exp_f32 v73, v41
    v_mov_b32 v105, v9
    v_exp_f32 v74, v42
    v_mov_b32 v106, v9
    v_exp_f32 v75, v43
    v_mov_b32 v107, v9
    v_exp_f32 v80, v48
    v_mov_b32 v112, v9
    v_exp_f32 v81, v49
    v_mov_b32 v113, v9
    v_exp_f32 v82, v50
    v_mov_b32 v114, v9
    v_exp_f32 v83, v51
    v_mov_b32 v115, v9
    v_exp_f32 v88, v56
    v_mov_b32 v120, v9
    v_exp_f32 v89, v57
    v_mov_b32 v121, v9
    v_exp_f32 v90, v58
    v_mov_b32 v122, v9
    v_exp_f32 v91, v59
    v_mov_b32 v123, v9
    v_add_f32 v5, v64, v65
    v_add_f32 v5, v5, v66
    v_add_f32 v5, v5, v67
    v_add_f32 v5, v5, v72
    v_add_f32 v5, v5, v73
    v_add_f32 v5, v5, v74
    v_add_f32 v5, v5, v75
    v_add_f32 v5, v5, v80
    v_add_f32 v5, v5, v81
    v_add_f32 v5, v5, v82
    v_add_f32 v5, v5, v83
    v_add_f32 v5, v5, v88
    v_add_f32 v5, v5, v89
    v_add_f32 v5, v5, v90
    v_add_f32 v5, v5, v91
    v_max3_f32 v12, v36, v37, v38
    v_max3_f32 v12, v12, v39, v44
    v_max3_f32 v12, v12, v45, v46
    v_max3_f32 v12, v12, v47, v52
    v_max3_f32 v12, v12, v53, v54
    v_max3_f32 v12, v12, v55, v60
    v_max3_f32 v12, v12, v61, v62
    v_max_f32 v12, v12, v63
    v_mov_b32 v13, v12
    s_nop 1
    v_permlane32_swap_b32 v12, v13
    s_nop 1
    v_max_f32 v12, v12, v13
    v_mov_b32 v13, v12
    s_nop 1
    v_permlane16_swap_b32 v12, v13
    s_nop 1
    v_max_f32 v12, v12, v13
    v_max_f32 v12, s46, v12
    v_sub_f32 v10, v10, v12
    v_sub_f32 v36, v36, v12
    v_sub_f32 v37, v37, v12
    v_sub_f32 v38, v38, v12
    v_sub_f32 v39, v39, v12
    v_sub_f32 v44, v44, v12
    v_sub_f32 v45, v45, v12
    v_sub_f32 v46, v46, v12
    v_sub_f32 v47, v47, v12
    v_sub_f32 v52, v52, v12
    v_sub_f32 v53, v53, v12
    v_sub_f32 v54, v54, v12
    v_sub_f32 v55, v55, v12
    v_sub_f32 v60, v60, v12
    v_sub_f32 v61, v61, v12
    v_sub_f32 v62, v62, v12
    v_sub_f32 v63, v63, v12
    v_exp_f32 v68, v36
    v_mov_b32 v100, v10
    v_exp_f32 v69, v37
    v_mov_b32 v101, v10
    v_exp_f32 v70, v38
    v_mov_b32 v102, v10
    v_exp_f32 v71, v39
    v_mov_b32 v103, v10
    v_exp_f32 v76, v44
    v_mov_b32 v108, v10
    v_exp_f32 v77, v45
    v_mov_b32 v109, v10
    v_exp_f32 v78, v46
    v_mov_b32 v110, v10
    v_exp_f32 v79, v47
    v_mov_b32 v111, v10
    v_exp_f32 v84, v52
    v_mov_b32 v116, v10
    v_exp_f32 v85, v53
    v_mov_b32 v117, v10
    v_exp_f32 v86, v54
    v_mov_b32 v118, v10
    v_exp_f32 v87, v55
    v_mov_b32 v119, v10
    v_exp_f32 v92, v60
    v_mov_b32 v124, v10
    v_exp_f32 v93, v61
    v_mov_b32 v125, v10
    v_exp_f32 v94, v62
    v_mov_b32 v126, v10
    v_exp_f32 v95, v63
    v_mov_b32 v127, v10
    v_add_f32 v6, v68, v69
    v_add_f32 v6, v6, v70
    v_add_f32 v6, v6, v71
    v_add_f32 v6, v6, v76
    v_add_f32 v6, v6, v77
    v_add_f32 v6, v6, v78
    v_add_f32 v6, v6, v79
    v_add_f32 v6, v6, v84
    v_add_f32 v6, v6, v85
    v_add_f32 v6, v6, v86
    v_add_f32 v6, v6, v87
    v_add_f32 v6, v6, v92
    v_add_f32 v6, v6, v93
    v_add_f32 v6, v6, v94
    v_add_f32 v6, v6, v95
    s_waitcnt lgkmcnt(0)
    s_cmp_lg_u32 s46, 0
    s_mov_b32 s46, 0
    s_cbranch_scc1 L_ret
    v_exp_f32 v11, -v11
    s_nop 0
    v_mul_f32 v7, v7, v11
    v_mul_f32 v128, v128, v11
    v_mul_f32 v129, v129, v11
    v_mul_f32 v130, v130, v11
    v_mul_f32 v131, v131, v11
    v_mul_f32 v132, v132, v11
    v_mul_f32 v133, v133, v11
    v_mul_f32 v134, v134, v11
    v_mul_f32 v135, v135, v11
    v_mul_f32 v136, v136, v11
    v_mul_f32 v137, v137, v11
    v_mul_f32 v138, v138, v11
    v_mul_f32 v139, v139, v11
    v_mul_f32 v140, v140, v11
    v_mul_f32 v141, v141, v11
    v_mul_f32 v142, v142, v11
    v_mul_f32 v143, v143, v11
    v_mul_f32 v144, v144, v11
    v_mul_f32 v145, v145, v11
    v_mul_f32 v146, v146, v11
    v_mul_f32 v147, v147, v11
    v_mul_f32 v148, v148, v11
    v_mul_f32 v149, v149, v11
    v_mul_f32 v150, v150, v11
    v_mul_f32 v151, v151, v11
    v_mul_f32 v152, v152, v11
    v_mul_f32 v153, v153, v11
    v_mul_f32 v154, v154, v11
    v_mul_f32 v155, v155, v11
    v_mul_f32 v156, v156, v11
    v_mul_f32 v157, v157, v11
    v_mul_f32 v158, v158, v11
    v_mul_f32 v159, v159, v11
    v_mul_f32 v160, v160, v11
    v_mul_f32 v161, v161, v11
    v_mul_f32 v162, v162, v11
    v_mul_f32 v163, v163, v11
    v_mul_f32 v164, v164, v11
    v_mul_f32 v165, v165, v11
    v_mul_f32 v166, v166, v11
    v_mul_f32 v167, v167, v11
    v_mul_f32 v168, v168, v11
    v_mul_f32 v169, v169, v11
    v_mul_f32 v170, v170, v11
    v_mul_f32 v171, v171, v11
    v_mul_f32 v172, v172, v11
    v_mul_f32 v173, v173, v11
    v_mul_f32 v174, v174, v11
    v_mul_f32 v175, v175, v11
    v_mul_f32 v176, v176, v11
    v_mul_f32 v177, v177, v11
    v_mul_f32 v178, v178, v11
    v_mul_f32 v179, v179, v11
    v_mul_f32 v180, v180, v11
    v_mul_f32 v181, v181, v11
    v_mul_f32 v182, v182, v11
    v_mul_f32 v183, v183, v11
    v_mul_f32 v184, v184, v11
    v_mul_f32 v185, v185, v11
    v_mul_f32 v186, v186, v11
    v_mul_f32 v187, v187, v11
    v_mul_f32 v188, v188, v11
    v_mul_f32 v189, v189, v11
    v_mul_f32 v190, v190, v11
    v_mul_f32 v191, v191, v11
    v_exp_f32 v12, -v12
    s_nop 0
    v_mul_f32 v8, v8, v12
    v_mul_f32 v192, v192, v12
    v_mul_f32 v193, v193, v12
    v_mul_f32 v194, v194, v12
    v_mul_f32 v195, v195, v12
    v_mul_f32 v196, v196, v12
    v_mul_f32 v197, v197, v12
    v_mul_f32 v198, v198, v12
    v_mul_f32 v199, v199, v12
    v_mul_f32 v200, v200, v12
    v_mul_f32 v201, v201, v12
    v_mul_f32 v202, v202, v12
    v_mul_f32 v203, v203, v12
    v_mul_f32 v204, v204, v12
    v_mul_f32 v205, v205, v12
    v_mul_f32 v206, v206, v12
    v_mul_f32 v207, v207, v12
    v_mul_f32 v208, v208, v12
    v_mul_f32 v209, v209, v12
    v_mul_f32 v210, v210, v12
    v_mul_f32 v211, v211, v12
    v_mul_f32 v212, v212, v12
    v_mul_f32 v213, v213, v12
    v_mul_f32 v214, v214, v12
    v_mul_f32 v215, v215, v12
    v_mul_f32 v216, v216, v12
    v_mul_f32 v217, v217, v12
    v_mul_f32 v218, v218, v12
    v_mul_f32 v219, v219, v12
    v_mul_f32 v220, v220, v12
    v_mul_f32 v221, v221, v12
    v_mul_f32 v222, v222, v12
    v_mul_f32 v223, v223, v12
    v_mul_f32 v224, v224, v12
    v_mul_f32 v225, v225, v12
    v_mul_f32 v226, v226, v12
    v_mul_f32 v227, v227, v12
    v_mul_f32 v228, v228, v12
    v_mul_f32 v229, v229, v12
    v_mul_f32 v230, v230, v12
    v_mul_f32 v231, v231, v12
    v_mul_f32 v232, v232, v12
    v_mul_f32 v233, v233, v12
    v_mul_f32 v234, v234, v12
    v_mul_f32 v235, v235, v12
    v_mul_f32 v236, v236, v12
    v_mul_f32 v237, v237, v12
    v_mul_f32 v238, v238, v12
    v_mul_f32 v239, v239, v12
    v_mul_f32 v240, v240, v12
    v_mul_f32 v241, v241, v12
    v_mul_f32 v242, v242, v12
    v_mul_f32 v243, v243, v12
    v_mul_f32 v244, v244, v12
    v_mul_f32 v245, v245, v12
    v_mul_f32 v246, v246, v12
    v_mul_f32 v247, v247, v12
    v_mul_f32 v248, v248, v12
    v_mul_f32 v249, v249, v12
    v_mul_f32 v250, v250, v12
    v_mul_f32 v251, v251, v12
    v_mul_f32 v252, v252, v12
    v_mul_f32 v253, v253, v12
    v_mul_f32 v254, v254, v12
    v_mul_f32 v255, v255, v12
    s_branch L_ret
.p2align 6
L_loop:
    v_mfma_f32_16x16x32_bf16 v[32:35], a[64:67], a[0:3], v[96:99]
    s_mov_b32 m0, s40
    ds_read_b128 a[96:99], v2 offset:8192
    v_cvt_pk_bf16_f32 v16, v64, v65
    v_mfma_f32_16x16x32_bf16 v[32:35], a[68:71], a[4:7], v[32:35]
    s_waitcnt lgkmcnt(5)
    buffer_load_dwordx4 v1, s[12:15], s42 offen offset:0 sc1 lds
    v_mfma_f32_16x16x32_bf16 v[32:35], a[72:75], a[8:11], v[32:35]
    ds_read_b128 a[100:103], v2 offset:9216
    v_cvt_pk_bf16_f32 v17, v66, v67
    v_mfma_f32_16x16x32_bf16 v[32:35], a[76:79], a[12:15], v[32:35]
    s_waitcnt lgkmcnt(4)
    v_cvt_pk_bf16_f32 v20, v68, v69
    v_cvt_pk_bf16_f32 v21, v70, v71
    v_mfma_f32_16x16x32_bf16 v[32:35], a[80:83], a[16:19], v[32:35]
    ds_read_b128 a[104:107], v2 offset:10240
    v_add_f32 v7, v7, v5
    v_mfma_f32_16x16x32_bf16 v[32:35], a[84:87], a[20:23], v[32:35]
    s_waitcnt lgkmcnt(3)
    v_add_f32 v8, v8, v6
    v_cvt_pk_bf16_f32 v18, v72, v73
    v_mfma_f32_16x16x32_bf16 v[32:35], a[88:91], a[24:27], v[32:35]
    ds_read_b128 a[108:111], v2 offset:11264
    v_cvt_pk_bf16_f32 v19, v74, v75
    v_mfma_f32_16x16x32_bf16 v[32:35], a[92:95], a[28:31], v[32:35]
    buffer_load_dwordx4 v1, s[12:15], s42 offen offset:1024 sc1 lds
    v_mfma_f32_16x16x32_bf16 v[36:39], a[64:67], a[32:35], v[100:103]
    ds_read_b128 a[112:115], v2 offset:12288
    v_cvt_pk_bf16_f32 v22, v76, v77
    v_mfma_f32_16x16x32_bf16 v[36:39], a[68:71], a[36:39], v[36:39]
    v_cvt_pk_bf16_f32 v23, v78, v79
    v_cvt_pk_bf16_f32 v24, v80, v81
    v_mfma_f32_16x16x32_bf16 v[36:39], a[72:75], a[40:43], v[36:39]
    ds_read_b128 a[116:119], v2 offset:13312
    v_cvt_pk_bf16_f32 v25, v82, v83
    v_mfma_f32_16x16x32_bf16 v[36:39], a[76:79], a[44:47], v[36:39]
    v_cvt_pk_bf16_f32 v28, v84, v85
    v_cvt_pk_bf16_f32 v29, v86, v87
    v_mfma_f32_16x16x32_bf16 v[36:39], a[80:83], a[48:51], v[36:39]
    ds_read_b128 a[120:123], v2 offset:14336
    v_cvt_pk_bf16_f32 v26, v88, v89
    v_mfma_f32_16x16x32_bf16 v[36:39], a[84:87], a[52:55], v[36:39]
    buffer_load_dwordx4 v1, s[12:15], s42 offen offset:2048 sc1 lds
    v_mfma_f32_16x16x32_bf16 v[36:39], a[88:91], a[56:59], v[36:39]
    ds_read_b128 a[124:127], v2 offset:15360
    v_cvt_pk_bf16_f32 v27, v90, v91
    v_mfma_f32_16x16x32_bf16 v[36:39], a[92:95], a[60:63], v[36:39]
    s_waitcnt lgkmcnt(6)
    v_exp_f32 v64, v32
    v_mfma_f32_16x16x32_bf16 v[40:43], a[96:99], a[0:3], v[104:107]
    ds_read_b128 a[64:67], v2 offset:16384
    v_cvt_pk_bf16_f32 v30, v92, v93
    v_mfma_f32_16x16x32_bf16 v[40:43], a[100:103], a[4:7], v[40:43]
    s_waitcnt lgkmcnt(5)
    v_exp_f32 v65, v33
    v_mfma_f32_16x16x32_bf16 v[40:43], a[104:107], a[8:11], v[40:43]
    ds_read_b128 a[68:71], v2 offset:17408
    v_cvt_pk_bf16_f32 v31, v94, v95
    v_mfma_f32_16x16x32_bf16 v[40:43], a[108:111], a[12:15], v[40:43]
    s_waitcnt lgkmcnt(4)
    buffer_load_dwordx4 v1, s[12:15], s42 offen offset:3072 sc1 lds
    v_mfma_f32_16x16x32_bf16 v[40:43], a[112:115], a[16:19], v[40:43]
    ds_read_b128 a[72:75], v2 offset:18432
    v_add_f32 v5, v64, v65
    v_mfma_f32_16x16x32_bf16 v[40:43], a[116:119], a[20:23], v[40:43]
    s_waitcnt lgkmcnt(3)
    v_exp_f32 v66, v34
    v_mfma_f32_16x16x32_bf16 v[40:43], a[120:123], a[24:27], v[40:43]
    ds_read_b128 a[76:79], v2 offset:19456
    v_add_f32 v5, v5, v66
    v_mfma_f32_16x16x32_bf16 v[40:43], a[124:127], a[28:31], v[40:43]
    v_exp_f32 v67, v35
    v_mfma_f32_16x16x32_bf16 v[44:47], a[96:99], a[32:35], v[108:111]
    s_bitset1_b32 m0, 12
    ds_read_b128 a[80:83], v2 offset:20480
    v_add_f32 v5, v5, v67
    v_mfma_f32_16x16x32_bf16 v[44:47], a[100:103], a[36:39], v[44:47]
    buffer_load_dwordx4 v4, s[12:15], s42 offen offset:0 sc1 lds
    v_mfma_f32_16x16x32_bf16 v[44:47], a[104:107], a[40:43], v[44:47]
    ds_read_b128 a[84:87], v2 offset:21504
    v_mfma_f32_16x16x32_bf16 v[44:47], a[108:111], a[44:47], v[44:47]
    v_exp_f32 v68, v36
    v_mfma_f32_16x16x32_bf16 v[44:47], a[112:115], a[48:51], v[44:47]
    ds_read_b128 a[88:91], v2 offset:22528
    v_mfma_f32_16x16x32_bf16 v[44:47], a[116:119], a[52:55], v[44:47]
    v_exp_f32 v69, v37
    v_mfma_f32_16x16x32_bf16 v[44:47], a[120:123], a[56:59], v[44:47]
    ds_read_b128 a[92:95], v2 offset:23552
    v_add_f32 v6, v68, v69
    v_mfma_f32_16x16x32_bf16 v[44:47], a[124:127], a[60:63], v[44:47]
    s_waitcnt lgkmcnt(6)
    buffer_load_dwordx4 v4, s[12:15], s42 offen offset:1024 sc1 lds
    v_mfma_f32_16x16x32_bf16 v[48:51], a[64:67], a[0:3], v[112:115]
    ds_read_b128 a[96:99], v2 offset:24576
    v_mfma_f32_16x16x32_bf16 v[48:51], a[68:71], a[4:7], v[48:51]
    s_waitcnt lgkmcnt(5)
    v_exp_f32 v70, v38
    v_mfma_f32_16x16x32_bf16 v[48:51], a[72:75], a[8:11], v[48:51]
    ds_read_b128 a[100:103], v2 offset:25600
    v_add_f32 v6, v6, v70
    v_mfma_f32_16x16x32_bf16 v[48:51], a[76:79], a[12:15], v[48:51]
    s_waitcnt lgkmcnt(4)
    v_exp_f32 v71, v39
    v_mfma_f32_16x16x32_bf16 v[48:51], a[80:83], a[16:19], v[48:51]
    ds_read_b128 a[104:107], v2 offset:26624
    v_add_f32 v6, v6, v71
    v_mfma_f32_16x16x32_bf16 v[48:51], a[84:87], a[20:23], v[48:51]
    s_waitcnt lgkmcnt(3)
    buffer_load_dwordx4 v4, s[12:15], s42 offen offset:2048 sc1 lds
    v_mfma_f32_16x16x32_bf16 v[48:51], a[88:91], a[24:27], v[48:51]
    ds_read_b128 a[108:111], v2 offset:27648
    v_mfma_f32_16x16x32_bf16 v[48:51], a[92:95], a[28:31], v[48:51]
    v_exp_f32 v72, v40
    v_mfma_f32_16x16x32_bf16 v[52:55], a[64:67], a[32:35], v[116:119]
    ds_read_b128 a[112:115], v2 offset:28672
    v_add_f32 v5, v5, v72
    v_mfma_f32_16x16x32_bf16 v[52:55], a[68:71], a[36:39], v[52:55]
    v_exp_f32 v73, v41
    v_mfma_f32_16x16x32_bf16 v[52:55], a[72:75], a[40:43], v[52:55]
    ds_read_b128 a[116:119], v2 offset:29696
    v_add_f32 v5, v5, v73
    v_mfma_f32_16x16x32_bf16 v[52:55], a[76:79], a[44:47], v[52:55]
    buffer_load_dwordx4 v4, s[12:15], s42 offen offset:3072 sc1 lds
    v_mfma_f32_16x16x32_bf16 v[52:55], a[80:83], a[48:51], v[52:55]
    s_add_u32 s42, s42, 0x8000
    ds_read_b128 a[120:123], v2 offset:30720
    v_mfma_f32_16x16x32_bf16 v[52:55], a[84:87], a[52:55], v[52:55]
    s_xor_b32 s40, s40, 0x8000
    v_exp_f32 v74, v42
    v_mfma_f32_16x16x32_bf16 v[52:55], a[88:91], a[56:59], v[52:55]
    s_waitcnt vmcnt(8)
    ds_read_b128 a[124:127], v2 offset:31744
    v_add_f32 v5, v5, v74
    v_mfma_f32_16x16x32_bf16 v[52:55], a[92:95], a[60:63], v[52:55]
    s_waitcnt lgkmcnt(6)
    s_barrier
    v_mfma_f32_16x16x32_bf16 v[56:59], a[96:99], a[0:3], v[120:123]
    s_mov_b32 m0, s41
    ds_read_b128 a[64:67], v3 offset:0
    v_xor_b32 v2, 0x8000, v2
    v_mfma_f32_16x16x32_bf16 v[56:59], a[100:103], a[4:7], v[56:59]
    s_waitcnt lgkmcnt(5)
    buffer_load_dwordx4 v1, s[12:15], s43 offen offset:0 sc1 lds
    v_mfma_f32_16x16x32_bf16 v[56:59], a[104:107], a[8:11], v[56:59]
    ds_read_b128 a[68:71], v3 offset:16384
    v_mfma_f32_16x16x32_bf16 v[56:59], a[108:111], a[12:15], v[56:59]
    s_waitcnt lgkmcnt(4)
    v_exp_f32 v75, v43
    v_mfma_f32_16x16x32_bf16 v[56:59], a[112:115], a[16:19], v[56:59]
    ds_read_b128 a[72:75], v3 offset:1024
    v_add_f32 v5, v5, v75
    v_mfma_f32_16x16x32_bf16 v[56:59], a[116:119], a[20:23], v[56:59]
    s_waitcnt lgkmcnt(3)
    v_exp_f32 v76, v44
    v_mfma_f32_16x16x32_bf16 v[56:59], a[120:123], a[24:27], v[56:59]
    ds_read_b128 a[76:79], v3 offset:17408
    v_add_f32 v6, v6, v76
    v_mfma_f32_16x16x32_bf16 v[56:59], a[124:127], a[28:31], v[56:59]
    buffer_load_dwordx4 v1, s[12:15], s43 offen offset:1024 sc1 lds
    v_mfma_f32_16x16x32_bf16 v[60:63], a[96:99], a[32:35], v[124:127]
    ds_read_b128 a[80:83], v3 offset:2048
    v_mfma_f32_16x16x32_bf16 v[60:63], a[100:103], a[36:39], v[60:63]
    v_exp_f32 v77, v45
    v_mfma_f32_16x16x32_bf16 v[60:63], a[104:107], a[40:43], v[60:63]
    ds_read_b128 a[84:87], v3 offset:18432
    v_add_f32 v6, v6, v77
    v_mfma_f32_16x16x32_bf16 v[60:63], a[108:111], a[44:47], v[60:63]
    v_exp_f32 v78, v46
    v_mfma_f32_16x16x32_bf16 v[60:63], a[112:115], a[48:51], v[60:63]
    ds_read_b128 a[88:91], v3 offset:3072
    v_add_f32 v6, v6, v78
    v_mfma_f32_16x16x32_bf16 v[60:63], a[116:119], a[52:55], v[60:63]
    buffer_load_dwordx4 v1, s[12:15], s43 offen offset:2048 sc1 lds
    v_mfma_f32_16x16x32_bf16 v[60:63], a[120:123], a[56:59], v[60:63]
    ds_read_b128 a[92:95], v3 offset:19456
    v_mfma_f32_16x16x32_bf16 v[60:63], a[124:127], a[60:63], v[60:63]
    s_waitcnt lgkmcnt(6)
    v_exp_f32 v79, v47
    v_mfma_f32_16x16x32_bf16 v[128:131], a[64:67], v[16:19], v[128:131]
    ds_read_b128 a[96:99], v3 offset:4096
    v_add_f32 v6, v6, v79
    v_mfma_f32_16x16x32_bf16 v[128:131], a[68:71], v[24:27], v[128:131]
    v_exp_f32 v80, v48
    v_mfma_f32_16x16x32_bf16 v[192:195], a[68:71], v[28:31], v[192:195]
    ds_read_b128 a[100:103], v3 offset:20480
    v_add_f32 v5, v5, v80
    v_mfma_f32_16x16x32_bf16 v[192:195], a[64:67], v[20:23], v[192:195]
    s_waitcnt lgkmcnt(6)
    buffer_load_dwordx4 v1, s[12:15], s43 offen offset:3072 sc1 lds
    v_mfma_f32_16x16x32_bf16 v[132:135], a[72:75], v[16:19], v[132:135]
    ds_read_b128 a[104:107], v3 offset:5120
    v_mfma_f32_16x16x32_bf16 v[132:135], a[76:79], v[24:27], v[132:135]
    v_exp_f32 v81, v49
    v_mfma_f32_16x16x32_bf16 v[196:199], a[76:79], v[28:31], v[196:199]
    ds_read_b128 a[108:111], v3 offset:21504
    v_add_f32 v5, v5, v81
    v_mfma_f32_16x16x32_bf16 v[196:199], a[72:75], v[20:23], v[196:199]
    s_waitcnt lgkmcnt(6)
    v_exp_f32 v82, v50
    v_mfma_f32_16x16x32_bf16 v[136:139], a[80:83], v[16:19], v[136:139]
    s_bitset1_b32 m0, 12
    ds_read_b128 a[112:115], v3 offset:6144
    v_add_f32 v5, v5, v82
    v_mfma_f32_16x16x32_bf16 v[136:139], a[84:87], v[24:27], v[136:139]
    buffer_load_dwordx4 v4, s[12:15], s43 offen offset:0 sc1 lds
    v_mfma_f32_16x16x32_bf16 v[200:203], a[84:87], v[28:31], v[200:203]
    ds_read_b128 a[116:119], v3 offset:22528
    v_mfma_f32_16x16x32_bf16 v[200:203], a[80:83], v[20:23], v[200:203]
    s_waitcnt lgkmcnt(6)
    v_exp_f32 v83, v51
    v_mfma_f32_16x16x32_bf16 v[140:143], a[88:91], v[16:19], v[140:143]
    ds_read_b128 a[120:123], v3 offset:7168
    v_add_f32 v5, v5, v83
    v_mfma_f32_16x16x32_bf16 v[140:143], a[92:95], v[24:27], v[140:143]
    v_exp_f32 v84, v52
    v_mfma_f32_16x16x32_bf16 v[204:207], a[92:95], v[28:31], v[204:207]
    ds_read_b128 a[124:127], v3 offset:23552
    v_add_f32 v6, v6, v84
    v_mfma_f32_16x16x32_bf16 v[204:207], a[88:91], v[20:23], v[204:207]
    s_waitcnt lgkmcnt(6)
    buffer_load_dwordx4 v4, s[12:15], s43 offen offset:1024 sc1 lds
    v_mfma_f32_16x16x32_bf16 v[144:147], a[96:99], v[16:19], v[144:147]
    ds_read_b128 a[64:67], v3 offset:8192
    v_mfma_f32_16x16x32_bf16 v[144:147], a[100:103], v[24:27], v[144:147]
    v_exp_f32 v85, v53
    v_mfma_f32_16x16x32_bf16 v[208:211], a[100:103], v[28:31], v[208:211]
    ds_read_b128 a[68:71], v3 offset:24576
    v_add_f32 v6, v6, v85
    v_mfma_f32_16x16x32_bf16 v[208:211], a[96:99], v[20:23], v[208:211]
    s_waitcnt lgkmcnt(6)
    v_exp_f32 v86, v54
    v_mfma_f32_16x16x32_bf16 v[148:151], a[104:107], v[16:19], v[148:151]
    ds_read_b128 a[72:75], v3 offset:9216
    v_add_f32 v6, v6, v86
    v_mfma_f32_16x16x32_bf16 v[148:151], a[108:111], v[24:27], v[148:151]
    buffer_load_dwordx4 v4, s[12:15], s43 offen offset:2048 sc1 lds
    v_mfma_f32_16x16x32_bf16 v[212:215], a[108:111], v[28:31], v[212:215]
    ds_read_b128 a[76:79], v3 offset:25600
    v_mfma_f32_16x16x32_bf16 v[212:215], a[104:107], v[20:23], v[212:215]
    s_waitcnt lgkmcnt(6)
    v_exp_f32 v87, v55
    v_mfma_f32_16x16x32_bf16 v[152:155], a[112:115], v[16:19], v[152:155]
    ds_read_b128 a[80:83], v3 offset:10240
    v_add_f32 v6, v6, v87
    v_mfma_f32_16x16x32_bf16 v[152:155], a[116:119], v[24:27], v[152:155]
    v_exp_f32 v88, v56
    v_mfma_f32_16x16x32_bf16 v[216:219], a[116:119], v[28:31], v[216:219]
    ds_read_b128 a[84:87], v3 offset:26624
    v_add_f32 v5, v5, v88
    v_mfma_f32_16x16x32_bf16 v[216:219], a[112:115], v[20:23], v[216:219]
    s_waitcnt lgkmcnt(6)
    buffer_load_dwordx4 v4, s[12:15], s43 offen offset:3072 sc1 lds
    v_mfma_f32_16x16x32_bf16 v[156:159], a[120:123], v[16:19], v[156:159]
    s_add_u32 s43, s43, 0x8000
    ds_read_b128 a[88:91], v3 offset:11264
    v_mfma_f32_16x16x32_bf16 v[156:159], a[124:127], v[24:27], v[156:159]
    s_xor_b32 s41, s41, 0x8000
    v_exp_f32 v89, v57
    v_mfma_f32_16x16x32_bf16 v[220:223], a[124:127], v[28:31], v[220:223]
    ds_read_b128 a[92:95], v3 offset:27648
    v_add_f32 v5, v5, v89
    v_mfma_f32_16x16x32_bf16 v[220:223], a[120:123], v[20:23], v[220:223]
    s_waitcnt lgkmcnt(6)
    v_exp_f32 v90, v58
    v_mfma_f32_16x16x32_bf16 v[160:163], a[64:67], v[16:19], v[160:163]
    ds_read_b128 a[96:99], v3 offset:12288
    v_add_f32 v5, v5, v90
    v_mfma_f32_16x16x32_bf16 v[160:163], a[68:71], v[24:27], v[160:163]
    v_exp_f32 v91, v59
    v_mfma_f32_16x16x32_bf16 v[224:227], a[68:71], v[28:31], v[224:227]
    ds_read_b128 a[100:103], v3 offset:28672
    v_add_f32 v5, v5, v91
    v_mfma_f32_16x16x32_bf16 v[224:227], a[64:67], v[20:23], v[224:227]
    s_waitcnt lgkmcnt(6)
    v_exp_f32 v92, v60
    v_mfma_f32_16x16x32_bf16 v[164:167], a[72:75], v[16:19], v[164:167]
    ds_read_b128 a[104:107], v3 offset:13312
    v_add_f32 v6, v6, v92
    v_mfma_f32_16x16x32_bf16 v[164:167], a[76:79], v[24:27], v[164:167]
    v_exp_f32 v93, v61
    v_mfma_f32_16x16x32_bf16 v[228:231], a[76:79], v[28:31], v[228:231]
    ds_read_b128 a[108:111], v3 offset:29696
    v_add_f32 v6, v6, v93
    v_mfma_f32_16x16x32_bf16 v[228:231], a[72:75], v[20:23], v[228:231]
    s_waitcnt lgkmcnt(6)
    v_exp_f32 v94, v62
    v_mfma_f32_16x16x32_bf16 v[168:171], a[80:83], v[16:19], v[168:171]
    ds_read_b128 a[112:115], v3 offset:14336
    v_add_f32 v6, v6, v94
    v_mfma_f32_16x16x32_bf16 v[168:171], a[84:87], v[24:27], v[168:171]
    v_exp_f32 v95, v63
    v_mfma_f32_16x16x32_bf16 v[232:235], a[84:87], v[28:31], v[232:235]
    ds_read_b128 a[116:119], v3 offset:30720
    v_add_f32 v6, v6, v95
    v_mfma_f32_16x16x32_bf16 v[232:235], a[80:83], v[20:23], v[232:235]
    s_waitcnt lgkmcnt(6)
    v_add_f32 v11, v5, v6
    v_mfma_f32_16x16x32_bf16 v[172:175], a[88:91], v[16:19], v[172:175]
    ds_read_b128 a[120:123], v3 offset:15360
    v_cmp_nge_f32 vcc, s47, v11
    v_mfma_f32_16x16x32_bf16 v[172:175], a[92:95], v[24:27], v[172:175]
    v_mfma_f32_16x16x32_bf16 v[236:239], a[92:95], v[28:31], v[236:239]
    s_waitcnt vmcnt(8)
    ds_read_b128 a[124:127], v3 offset:31744
    v_mfma_f32_16x16x32_bf16 v[236:239], a[88:91], v[20:23], v[236:239]
    s_waitcnt lgkmcnt(6)
    s_barrier
    v_mfma_f32_16x16x32_bf16 v[176:179], a[96:99], v[16:19], v[176:179]
    ds_read_b128 a[64:67], v2 offset:0
    v_xor_b32 v3, 0x8000, v3
    v_mfma_f32_16x16x32_bf16 v[176:179], a[100:103], v[24:27], v[176:179]
    v_mfma_f32_16x16x32_bf16 v[240:243], a[100:103], v[28:31], v[240:243]
    ds_read_b128 a[68:71], v2 offset:1024
    v_mfma_f32_16x16x32_bf16 v[240:243], a[96:99], v[20:23], v[240:243]
    s_waitcnt lgkmcnt(6)
    v_mfma_f32_16x16x32_bf16 v[180:183], a[104:107], v[16:19], v[180:183]
    ds_read_b128 a[72:75], v2 offset:2048
    v_mfma_f32_16x16x32_bf16 v[180:183], a[108:111], v[24:27], v[180:183]
    v_mfma_f32_16x16x32_bf16 v[244:247], a[108:111], v[28:31], v[244:247]
    ds_read_b128 a[76:79], v2 offset:3072
    v_mfma_f32_16x16x32_bf16 v[244:247], a[104:107], v[20:23], v[244:247]
    s_waitcnt lgkmcnt(6)
    v_mfma_f32_16x16x32_bf16 v[184:187], a[112:115], v[16:19], v[184:187]
    s_sub_u32 s44, s44, 1
    ds_read_b128 a[80:83], v2 offset:4096
    v_mfma_f32_16x16x32_bf16 v[184:187], a[116:119], v[24:27], v[184:187]
    v_mfma_f32_16x16x32_bf16 v[248:251], a[116:119], v[28:31], v[248:251]
    ds_read_b128 a[84:87], v2 offset:5120
    v_mfma_f32_16x16x32_bf16 v[248:251], a[112:115], v[20:23], v[248:251]
    s_waitcnt lgkmcnt(6)
    v_mfma_f32_16x16x32_bf16 v[188:191], a[120:123], v[16:19], v[188:191]
    ds_read_b128 a[88:91], v2 offset:6144
    v_mfma_f32_16x16x32_bf16 v[188:191], a[124:127], v[24:27], v[188:191]
    v_mfma_f32_16x16x32_bf16 v[252:255], a[124:127], v[28:31], v[252:255]
    ds_read_b128 a[92:95], v2 offset:7168
    v_mfma_f32_16x16x32_bf16 v[252:255], a[120:123], v[20:23], v[252:255]
    s_waitcnt lgkmcnt(6)
    s_cbranch_vccnz L_slow
L_ret:
    s_cmp_gt_u32 s44, s45
    s_cbranch_scc1 L_loop
    s_cmp_eq_u32 s44, 0
    s_cbranch_scc1 L_segend
    s_cmp_eq_u32 s44, 1
    s_cbranch_scc1 L_d1
    v_mov_b32 v11, 0xf149f2ca
    v_cmp_gt_i32 s[16:17], 0, v14
    v_cmp_gt_i32 s[18:19], 1, v14
    v_cmp_gt_i32 s[20:21], 2, v14
    v_cmp_gt_i32 s[22:23], 3, v14
    v_cndmask_b32 v96, v9, v11, s[16:17]
    v_cndmask_b32 v97, v9, v11, s[18:19]
    v_cndmask_b32 v98, v9, v11, s[20:21]
    v_cndmask_b32 v99, v9, v11, s[22:23]
    v_cmp_gt_i32 s[16:17], 16, v14
    v_cmp_gt_i32 s[18:19], 17, v14
    v_cmp_gt_i32 s[20:21], 18, v14
    v_cmp_gt_i32 s[22:23], 19, v14
    v_cndmask_b32 v104, v9, v11, s[16:17]
    v_cndmask_b32 v105, v9, v11, s[18:19]
    v_cndmask_b32 v106, v9, v11, s[20:21]
    v_cndmask_b32 v107, v9, v11, s[22:23]
    v_cmp_gt_i32 s[16:17], 32, v14
    v_cmp_gt_i32 s[18:19], 33, v14
    v_cmp_gt_i32 s[20:21], 34, v14
    v_cmp_gt_i32 s[22:23], 35, v14
    v_cndmask_b32 v112, v9, v11, s[16:17]
    v_cndmask_b32 v113, v9, v11, s[18:19]
    v_cndmask_b32 v114, v9, v11, s[20:21]
    v_cndmask_b32 v115, v9, v11, s[22:23]
    v_cmp_gt_i32 s[16:17], 48, v14
    v_cmp_gt_i32 s[18:19], 49, v14
    v_cmp_gt_i32 s[20:21], 50, v14
    v_cmp_gt_i32 s[22:23], 51, v14
    v_cndmask_b32 v120, v9, v11, s[16:17]
    v_cndmask_b32 v121, v9, v11, s[18:19]
    v_cndmask_b32 v122, v9, v11, s[20:21]
    v_cndmask_b32 v123, v9, v11, s[22:23]
    s_nop 0
    s_branch L_loop
L_d1:
    s_cmp_eq_u32 s54, 0
    s_cselect_b32 s57, s38, 0
    s_cmp_lg_u32 s57, 0
    s_cselect_b32 s42, s49, 0xf0000000
    s_cbranch_scc0 L_d1b
    s_sub_u32 s58, 15, s25
    s_add_u32 s33, s94, 4
    v_and_b32 v11, 0, v0
    v_lshlrev_b32 v11, 2, v11
    s_mov_b32 s32, 0
L_poll1:
    buffer_load_dword v12, v11, s[12:15], s33 offen sc1
    s_waitcnt vmcnt(0)
    v_cmp_ne_u32 vcc, 1, v12
    s_cbranch_vccz L_poll1_ok
    s_sleep 2
    s_add_u32 s32, s32, 1
    s_cmp_lt_u32 s32, 0x80000
    s_cbranch_scc1 L_poll1
L_poll1_ok:
    s_lshl_b32 s55, s58, 16
    s_add_u32 s55, s55, s49
    s_add_u32 s55, s55, 33554432
    s_add_u32 s56, s55, 0x8000
    buffer_load_dwordx4 a[128:131], v1, s[12:15], s55 offen offset:0 sc1
    buffer_load_dwordx4 a[132:135], v1, s[12:15], s55 offen offset:1024 sc1
    buffer_load_dwordx4 a[136:139], v1, s[12:15], s55 offen offset:2048 sc1
    buffer_load_dwordx4 a[140:143], v1, s[12:15], s55 offen offset:3072 sc1
    buffer_load_dwordx4 a[144:147], v4, s[12:15], s55 offen offset:0 sc1
    buffer_load_dwordx4 a[148:151], v4, s[12:15], s55 offen offset:1024 sc1
    buffer_load_dwordx4 a[152:155], v4, s[12:15], s55 offen offset:2048 sc1
    buffer_load_dwordx4 a[156:159], v4, s[12:15], s55 offen offset:3072 sc1
    buffer_load_dwordx4 a[160:163], v1, s[12:15], s56 offen offset:0 sc1
    buffer_load_dwordx4 a[164:167], v1, s[12:15], s56 offen offset:1024 sc1
    buffer_load_dwordx4 a[168:171], v1, s[12:15], s56 offen offset:2048 sc1
    buffer_load_dwordx4 a[172:175], v1, s[12:15], s56 offen offset:3072 sc1
    buffer_load_dwordx4 a[176:179], v4, s[12:15], s56 offen offset:0 sc1
    buffer_load_dwordx4 a[180:183], v4, s[12:15], s56 offen offset:1024 sc1
    buffer_load_dwordx4 a[184:187], v4, s[12:15], s56 offen offset:2048 sc1
    buffer_load_dwordx4 a[188:191], v4, s[12:15], s56 offen offset:3072 sc1
L_d1b:
    v_mov_b32 v11, 0xf149f2ca
    v_cmp_gt_i32 s[16:17], 0, v14
    v_cmp_gt_i32 s[18:19], 1, v14
    v_cmp_gt_i32 s[20:21], 2, v14
    v_cmp_gt_i32 s[22:23], 3, v14
    v_cndmask_b32 v100, v10, v11, s[16:17]
    v_cndmask_b32 v101, v10, v11, s[18:19]
    v_cndmask_b32 v102, v10, v11, s[20:21]
    v_cndmask_b32 v103, v10, v11, s[22:23]
    v_cmp_gt_i32 s[16:17], 16, v14
    v_cmp_gt_i32 s[18:19], 17, v14
    v_cmp_gt_i32 s[20:21], 18, v14
    v_cmp_gt_i32 s[22:23], 19, v14
    v_cndmask_b32 v108, v10, v11, s[16:17]
    v_cndmask_b32 v109, v10, v11, s[18:19]
    v_cndmask_b32 v110, v10, v11, s[20:21]
    v_cndmask_b32 v111, v10, v11, s[22:23]
    v_cmp_gt_i32 s[16:17], 32, v14
    v_cmp_gt_i32 s[18:19], 33, v14
    v_cmp_gt_i32 s[20:21], 34, v14
    v_cmp_gt_i32 s[22:23], 35, v14
    v_cndmask_b32 v116, v10, v11, s[16:17]
    v_cndmask_b32 v117, v10, v11, s[18:19]
    v_cndmask_b32 v118, v10, v11, s[20:21]
    v_cndmask_b32 v119, v10, v11, s[22:23]
    v_cmp_gt_i32 s[16:17], 48, v14
    v_cmp_gt_i32 s[18:19], 49, v14
    v_cmp_gt_i32 s[20:21], 50, v14
    v_cmp_gt_i32 s[22:23], 51, v14
    v_cndmask_b32 v124, v10, v11, s[16:17]
    v_cndmask_b32 v125, v10, v11, s[18:19]
    v_cndmask_b32 v126, v10, v11, s[20:21]
    v_cndmask_b32 v127, v10, v11, s[22:23]
    v_mov_b32 v96, v11
    v_mov_b32 v97, v11
    v_mov_b32 v98, v11
    v_mov_b32 v99, v11
    v_mov_b32 v104, v11
    v_mov_b32 v105, v11
    v_mov_b32 v106, v11
    v_mov_b32 v107, v11
    v_mov_b32 v112, v11
    v_mov_b32 v113, v11
    v_mov_b32 v114, v11
    v_mov_b32 v115, v11
    v_mov_b32 v120, v11
    v_mov_b32 v121, v11
    v_mov_b32 v122, v11
    v_mov_b32 v123, v11
    s_nop 0
    s_branch L_loop
L_segend:
    s_cmp_eq_u32 s54, 0
    s_cselect_b32 s57, s38, 0
    s_cmp_eq_u32 s57, 0
    s_cbranch_scc1 L_tail
    v_accvgpr_mov_b32 a0, a128
    v_accvgpr_mov_b32 a1, a129
    v_accvgpr_mov_b32 a2, a130
    v_accvgpr_mov_b32 a3, a131
    v_accvgpr_mov_b32 a4, a132
    v_accvgpr_mov_b32 a5, a133
    v_accvgpr_mov_b32 a6, a134
    v_accvgpr_mov_b32 a7, a135
    v_accvgpr_mov_b32 a8, a136
    v_accvgpr_mov_b32 a9, a137
    v_accvgpr_mov_b32 a10, a138
    v_accvgpr_mov_b32 a11, a139
    v_accvgpr_mov_b32 a12, a140
    v_accvgpr_mov_b32 a13, a141
    v_accvgpr_mov_b32 a14, a142
    v_accvgpr_mov_b32 a15, a143
    v_accvgpr_mov_b32 a16, a144
    v_accvgpr_mov_b32 a17, a145
    v_accvgpr_mov_b32 a18, a146
    v_accvgpr_mov_b32 a19, a147
    v_accvgpr_mov_b32 a20, a148
    v_accvgpr_mov_b32 a21, a149
    v_accvgpr_mov_b32 a22, a150
    v_accvgpr_mov_b32 a23, a151
    v_accvgpr_mov_b32 a24, a152
    v_accvgpr_mov_b32 a25, a153
    v_accvgpr_mov_b32 a26, a154
    v_accvgpr_mov_b32 a27, a155
    v_accvgpr_mov_b32 a28, a156
    v_accvgpr_mov_b32 a29, a157
    v_accvgpr_mov_b32 a30, a158
    v_accvgpr_mov_b32 a31, a159
    v_accvgpr_mov_b32 a32, a160
    v_accvgpr_mov_b32 a33, a161
    v_accvgpr_mov_b32 a34, a162
    v_accvgpr_mov_b32 a35, a163
    v_accvgpr_mov_b32 a36, a164
    v_accvgpr_mov_b32 a37, a165
    v_accvgpr_mov_b32 a38, a166
    v_accvgpr_mov_b32 a39, a167
    v_accvgpr_mov_b32 a40, a168
    v_accvgpr_mov_b32 a41, a169
    v_accvgpr_mov_b32 a42, a170
    v_accvgpr_mov_b32 a43, a171
    v_accvgpr_mov_b32 a44, a172
    v_accvgpr_mov_b32 a45, a173
    v_accvgpr_mov_b32 a46, a174
    v_accvgpr_mov_b32 a47, a175
    v_accvgpr_mov_b32 a48, a176
    v_accvgpr_mov_b32 a49, a177
    v_accvgpr_mov_b32 a50, a178
    v_accvgpr_mov_b32 a51, a179
    v_accvgpr_mov_b32 a52, a180
    v_accvgpr_mov_b32 a53, a181
    v_accvgpr_mov_b32 a54, a182
    v_accvgpr_mov_b32 a55, a183
    v_accvgpr_mov_b32 a56, a184
    v_accvgpr_mov_b32 a57, a185
    v_accvgpr_mov_b32 a58, a186
    v_accvgpr_mov_b32 a59, a187
    v_accvgpr_mov_b32 a60, a188
    v_accvgpr_mov_b32 a61, a189
    v_accvgpr_mov_b32 a62, a190
    v_accvgpr_mov_b32 a63, a191
    v_mov_b64 v[96:97], 0
    v_mov_b64 v[98:99], 0
    v_mov_b64 v[100:101], 0
    v_mov_b64 v[102:103], 0
    v_mov_b64 v[104:105], 0
    v_mov_b64 v[106:107], 0
    v_mov_b64 v[108:109], 0
    v_mov_b64 v[110:111], 0
    v_mov_b64 v[112:113], 0
    v_mov_b64 v[114:115], 0
    v_mov_b64 v[116:117], 0
    v_mov_b64 v[118:119], 0
    v_mov_b64 v[120:121], 0
    v_mov_b64 v[122:123], 0
    v_mov_b64 v[124:125], 0
    v_mov_b64 v[126:127], 0
    s_add_u32 s43, s49, 16777216
    s_mov_b32 s44, s38
    s_mov_b32 s45, 0
    s_mov_b32 s47, -1.0
    s_branch L_loop
L_switched:
    v_mov_b32 v13, v7
    s_nop 1
    v_permlane32_swap_b32 v7, v13
    s_nop 1
    v_add_f32 v7, v7, v13
    v_mov_b32 v13, v7
    s_nop 1
    v_permlane16_swap_b32 v7, v13
    s_nop 1
    v_add_f32 v7, v7, v13
    v_mov_b32 v13, v8
    s_nop 1
    v_permlane32_swap_b32 v8, v13
    s_nop 1
    v_add_f32 v8, v8, v13
    v_mov_b32 v13, v8
    s_nop 1
    v_permlane16_swap_b32 v8, v13
    s_nop 1
    v_add_f32 v8, v8, v13
    v_rcp_f32 v16, v7
    v_rcp_f32 v17, v8
    s_lshl_b32 s55, s51, 20
    s_lshl_b32 s57, s3, 17
    s_add_u32 s55, s55, s57
    s_lshl_b32 s57, s26, 13
    s_add_u32 s55, s55, s57
    s_add_u32 s55, s55, 50331648
    s_add_u32 s56, s55, 0x80000
    v_pk_mul_f32 v[128:129], v[128:129], v[16:17] op_sel:[0,0] op_sel_hi:[1,0]
    v_pk_mul_f32 v[130:131], v[130:131], v[16:17] op_sel:[0,0] op_sel_hi:[1,0]
    v_pk_mul_f32 v[132:133], v[132:133], v[16:17] op_sel:[0,0] op_sel_hi:[1,0]
    v_pk_mul_f32 v[134:135], v[134:135], v[16:17] op_sel:[0,0] op_sel_hi:[1,0]
    v_cvt_pk_bf16_f32 v128, v128, v129
    v_cvt_pk_bf16_f32 v129, v130, v131
    v_cvt_pk_bf16_f32 v130, v132, v133
    v_cvt_pk_bf16_f32 v131, v134, v135
    buffer_store_dwordx4 v[128:131], v1, s[12:15], s55 offen offset:0 sc1
    v_pk_mul_f32 v[136:137], v[136:137], v[16:17] op_sel:[0,0] op_sel_hi:[1,0]
    v_pk_mul_f32 v[138:139], v[138:139], v[16:17] op_sel:[0,0] op_sel_hi:[1,0]
    v_pk_mul_f32 v[140:141], v[140:141], v[16:17] op_sel:[0,0] op_sel_hi:[1,0]
    v_pk_mul_f32 v[142:143], v[142:143], v[16:17] op_sel:[0,0] op_sel_hi:[1,0]
    v_cvt_pk_bf16_f32 v136, v136, v137
    v_cvt_pk_bf16_f32 v137, v138, v139
    v_cvt_pk_bf16_f32 v138, v140, v141
    v_cvt_pk_bf16_f32 v139, v142, v143
    buffer_store_dwordx4 v[136:139], v1, s[12:15], s55 offen offset:1024 sc1
    v_pk_mul_f32 v[144:145], v[144:145], v[16:17] op_sel:[0,0] op_sel_hi:[1,0]
    v_pk_mul_f32 v[146:147], v[146:147], v[16:17] op_sel:[0,0] op_sel_hi:[1,0]
    v_pk_mul_f32 v[148:149], v[148:149], v[16:17] op_sel:[0,0] op_sel_hi:[1,0]
    v_pk_mul_f32 v[150:151], v[150:151], v[16:17] op_sel:[0,0] op_sel_hi:[1,0]
    v_cvt_pk_bf16_f32 v144, v144, v145
    v_cvt_pk_bf16_f32 v145, v146, v147
    v_cvt_pk_bf16_f32 v146, v148, v149
    v_cvt_pk_bf16_f32 v147, v150, v151
    buffer_store_dwordx4 v[144:147], v1, s[12:15], s55 offen offset:2048 sc1
    v_pk_mul_f32 v[152:153], v[152:153], v[16:17] op_sel:[0,0] op_sel_hi:[1,0]
    v_pk_mul_f32 v[154:155], v[154:155], v[16:17] op_sel:[0,0] op_sel_hi:[1,0]
    v_pk_mul_f32 v[156:157], v[156:157], v[16:17] op_sel:[0,0] op_sel_hi:[1,0]
    v_pk_mul_f32 v[158:159], v[158:159], v[16:17] op_sel:[0,0] op_sel_hi:[1,0]
    v_cvt_pk_bf16_f32 v152, v152, v153
    v_cvt_pk_bf16_f32 v153, v154, v155
    v_cvt_pk_bf16_f32 v154, v156, v157
    v_cvt_pk_bf16_f32 v155, v158, v159
    buffer_store_dwordx4 v[152:155], v1, s[12:15], s55 offen offset:3072 sc1
    v_pk_mul_f32 v[160:161], v[160:161], v[16:17] op_sel:[0,0] op_sel_hi:[1,0]
    v_pk_mul_f32 v[162:163], v[162:163], v[16:17] op_sel:[0,0] op_sel_hi:[1,0]
    v_pk_mul_f32 v[164:165], v[164:165], v[16:17] op_sel:[0,0] op_sel_hi:[1,0]
    v_pk_mul_f32 v[166:167], v[166:167], v[16:17] op_sel:[0,0] op_sel_hi:[1,0]
    v_cvt_pk_bf16_f32 v160, v160, v161
    v_cvt_pk_bf16_f32 v161, v162, v163
    v_cvt_pk_bf16_f32 v162, v164, v165
    v_cvt_pk_bf16_f32 v163, v166, v167
    buffer_store_dwordx4 v[160:163], v4, s[12:15], s55 offen offset:0 sc1
    v_pk_mul_f32 v[168:169], v[168:169], v[16:17] op_sel:[0,0] op_sel_hi:[1,0]
    v_pk_mul_f32 v[170:171], v[170:171], v[16:17] op_sel:[0,0] op_sel_hi:[1,0]
    v_pk_mul_f32 v[172:173], v[172:173], v[16:17] op_sel:[0,0] op_sel_hi:[1,0]
    v_pk_mul_f32 v[174:175], v[174:175], v[16:17] op_sel:[0,0] op_sel_hi:[1,0]
    v_cvt_pk_bf16_f32 v168, v168, v169
    v_cvt_pk_bf16_f32 v169, v170, v171
    v_cvt_pk_bf16_f32 v170, v172, v173
    v_cvt_pk_bf16_f32 v171, v174, v175
    buffer_store_dwordx4 v[168:171], v4, s[12:15], s55 offen offset:1024 sc1
    v_pk_mul_f32 v[176:177], v[176:177], v[16:17] op_sel:[0,0] op_sel_hi:[1,0]
    v_pk_mul_f32 v[178:179], v[178:179], v[16:17] op_sel:[0,0] op_sel_hi:[1,0]
    v_pk_mul_f32 v[180:181], v[180:181], v[16:17] op_sel:[0,0] op_sel_hi:[1,0]
    v_pk_mul_f32 v[182:183], v[182:183], v[16:17] op_sel:[0,0] op_sel_hi:[1,0]
    v_cvt_pk_bf16_f32 v176, v176, v177
    v_cvt_pk_bf16_f32 v177, v178, v179
    v_cvt_pk_bf16_f32 v178, v180, v181
    v_cvt_pk_bf16_f32 v179, v182, v183
    buffer_store_dwordx4 v[176:179], v4, s[12:15], s55 offen offset:2048 sc1
    v_pk_mul_f32 v[184:185], v[184:185], v[16:17] op_sel:[0,0] op_sel_hi:[1,0]
    v_pk_mul_f32 v[186:187], v[186:187], v[16:17] op_sel:[0,0] op_sel_hi:[1,0]
    v_pk_mul_f32 v[188:189], v[188:189], v[16:17] op_sel:[0,0] op_sel_hi:[1,0]
    v_pk_mul_f32 v[190:191], v[190:191], v[16:17] op_sel:[0,0] op_sel_hi:[1,0]
    v_cvt_pk_bf16_f32 v184, v184, v185
    v_cvt_pk_bf16_f32 v185, v186, v187
    v_cvt_pk_bf16_f32 v186, v188, v189
    v_cvt_pk_bf16_f32 v187, v190, v191
    buffer_store_dwordx4 v[184:187], v4, s[12:15], s55 offen offset:3072 sc1
    v_pk_mul_f32 v[192:193], v[192:193], v[16:17] op_sel:[0,1] op_sel_hi:[1,1]
    v_pk_mul_f32 v[194:195], v[194:195], v[16:17] op_sel:[0,1] op_sel_hi:[1,1]
    v_pk_mul_f32 v[196:197], v[196:197], v[16:17] op_sel:[0,1] op_sel_hi:[1,1]
    v_pk_mul_f32 v[198:199], v[198:199], v[16:17] op_sel:[0,1] op_sel_hi:[1,1]
    v_cvt_pk_bf16_f32 v192, v192, v193
    v_cvt_pk_bf16_f32 v193, v194, v195
    v_cvt_pk_bf16_f32 v194, v196, v197
    v_cvt_pk_bf16_f32 v195, v198, v199
    buffer_store_dwordx4 v[192:195], v1, s[12:15], s56 offen offset:0 sc1
    v_pk_mul_f32 v[200:201], v[200:201], v[16:17] op_sel:[0,1] op_sel_hi:[1,1]
    v_pk_mul_f32 v[202:203], v[202:203], v[16:17] op_sel:[0,1] op_sel_hi:[1,1]
    v_pk_mul_f32 v[204:205], v[204:205], v[16:17] op_sel:[0,1] op_sel_hi:[1,1]
    v_pk_mul_f32 v[206:207], v[206:207], v[16:17] op_sel:[0,1] op_sel_hi:[1,1]
    v_cvt_pk_bf16_f32 v200, v200, v201
    v_cvt_pk_bf16_f32 v201, v202, v203
    v_cvt_pk_bf16_f32 v202, v204, v205
    v_cvt_pk_bf16_f32 v203, v206, v207
    buffer_store_dwordx4 v[200:203], v1, s[12:15], s56 offen offset:1024 sc1
    v_pk_mul_f32 v[208:209], v[208:209], v[16:17] op_sel:[0,1] op_sel_hi:[1,1]
    v_pk_mul_f32 v[210:211], v[210:211], v[16:17] op_sel:[0,1] op_sel_hi:[1,1]
    v_pk_mul_f32 v[212:213], v[212:213], v[16:17] op_sel:[0,1] op_sel_hi:[1,1]
    v_pk_mul_f32 v[214:215], v[214:215], v[16:17] op_sel:[0,1] op_sel_hi:[1,1]
    v_cvt_pk_bf16_f32 v208, v208, v209
    v_cvt_pk_bf16_f32 v209, v210, v211
    v_cvt_pk_bf16_f32 v210, v212, v213
    v_cvt_pk_bf16_f32 v211, v214, v215
    buffer_store_dwordx4 v[208:211], v1, s[12:15], s56 offen offset:2048 sc1
    v_pk_mul_f32 v[216:217], v[216:217], v[16:17] op_sel:[0,1] op_sel_hi:[1,1]
    v_pk_mul_f32 v[218:219], v[218:219], v[16:17] op_sel:[0,1] op_sel_hi:[1,1]
    v_pk_mul_f32 v[220:221], v[220:221], v[16:17] op_sel:[0,1] op_sel_hi:[1,1]
    v_pk_mul_f32 v[222:223], v[222:223], v[16:17] op_sel:[0,1] op_sel_hi:[1,1]
    v_cvt_pk_bf16_f32 v216, v216, v217
    v_cvt_pk_bf16_f32 v217, v218, v219
    v_cvt_pk_bf16_f32 v218, v220, v221
    v_cvt_pk_bf16_f32 v219, v222, v223
    buffer_store_dwordx4 v[216:219], v1, s[12:15], s56 offen offset:3072 sc1
    v_pk_mul_f32 v[224:225], v[224:225], v[16:17] op_sel:[0,1] op_sel_hi:[1,1]
    v_pk_mul_f32 v[226:227], v[226:227], v[16:17] op_sel:[0,1] op_sel_hi:[1,1]
    v_pk_mul_f32 v[228:229], v[228:229], v[16:17] op_sel:[0,1] op_sel_hi:[1,1]
    v_pk_mul_f32 v[230:231], v[230:231], v[16:17] op_sel:[0,1] op_sel_hi:[1,1]
    v_cvt_pk_bf16_f32 v224, v224, v225
    v_cvt_pk_bf16_f32 v225, v226, v227
    v_cvt_pk_bf16_f32 v226, v228, v229
    v_cvt_pk_bf16_f32 v227, v230, v231
    buffer_store_dwordx4 v[224:227], v4, s[12:15], s56 offen offset:0 sc1
    v_pk_mul_f32 v[232:233], v[232:233], v[16:17] op_sel:[0,1] op_sel_hi:[1,1]
    v_pk_mul_f32 v[234:235], v[234:235], v[16:17] op_sel:[0,1] op_sel_hi:[1,1]
    v_pk_mul_f32 v[236:237], v[236:237], v[16:17] op_sel:[0,1] op_sel_hi:[1,1]
    v_pk_mul_f32 v[238:239], v[238:239], v[16:17] op_sel:[0,1] op_sel_hi:[1,1]
    v_cvt_pk_bf16_f32 v232, v232, v233
    v_cvt_pk_bf16_f32 v233, v234, v235
    v_cvt_pk_bf16_f32 v234, v236, v237
    v_cvt_pk_bf16_f32 v235, v238, v239
    buffer_store_dwordx4 v[232:235], v4, s[12:15], s56 offen offset:1024 sc1
    v_pk_mul_f32 v[240:241], v[240:241], v[16:17] op_sel:[0,1] op_sel_hi:[1,1]
    v_pk_mul_f32 v[242:243], v[242:243], v[16:17] op_sel:[0,1] op_sel_hi:[1,1]
    v_pk_mul_f32 v[244:245], v[244:245], v[16:17] op_sel:[0,1] op_sel_hi:[1,1]
    v_pk_mul_f32 v[246:247], v[246:247], v[16:17] op_sel:[0,1] op_sel_hi:[1,1]
    v_cvt_pk_bf16_f32 v240, v240, v241
    v_cvt_pk_bf16_f32 v241, v242, v243
    v_cvt_pk_bf16_f32 v242, v244, v245
    v_cvt_pk_bf16_f32 v243, v246, v247
    buffer_store_dwordx4 v[240:243], v4, s[12:15], s56 offen offset:2048 sc1
    v_pk_mul_f32 v[248:249], v[248:249], v[16:17] op_sel:[0,1] op_sel_hi:[1,1]
    v_pk_mul_f32 v[250:251], v[250:251], v[16:17] op_sel:[0,1] op_sel_hi:[1,1]
    v_pk_mul_f32 v[252:253], v[252:253], v[16:17] op_sel:[0,1] op_sel_hi:[1,1]
    v_pk_mul_f32 v[254:255], v[254:255], v[16:17] op_sel:[0,1] op_sel_hi:[1,1]
    v_cvt_pk_bf16_f32 v248, v248, v249
    v_cvt_pk_bf16_f32 v249, v250, v251
    v_cvt_pk_bf16_f32 v250, v252, v253
    v_cvt_pk_bf16_f32 v251, v254, v255
    buffer_store_dwordx4 v[248:251], v4, s[12:15], s56 offen offset:3072 sc1
    s_nop 0
    v_mov_b64 v[128:129], 0
    v_mov_b64 v[130:131], 0
    v_mov_b64 v[132:133], 0
    v_mov_b64 v[134:135], 0
    v_mov_b64 v[136:137], 0
    v_mov_b64 v[138:139], 0
    v_mov_b64 v[140:141], 0
    v_mov_b64 v[142:143], 0
    v_mov_b64 v[144:145], 0
    v_mov_b64 v[146:147], 0
    v_mov_b64 v[148:149], 0
    v_mov_b64 v[150:151], 0
    v_mov_b64 v[152:153], 0
    v_mov_b64 v[154:155], 0
    v_mov_b64 v[156:157], 0
    v_mov_b64 v[158:159], 0
    v_mov_b64 v[160:161], 0
    v_mov_b64 v[162:163], 0
    v_mov_b64 v[164:165], 0
    v_mov_b64 v[166:167], 0
    v_mov_b64 v[168:169], 0
    v_mov_b64 v[170:171], 0
    v_mov_b64 v[172:173], 0
    v_mov_b64 v[174:175], 0
    v_mov_b64 v[176:177], 0
    v_mov_b64 v[178:179], 0
    v_mov_b64 v[180:181], 0
    v_mov_b64 v[182:183], 0
    v_mov_b64 v[184:185], 0
    v_mov_b64 v[186:187], 0
    v_mov_b64 v[188:189], 0
    v_mov_b64 v[190:191], 0
    v_mov_b64 v[192:193], 0
    v_mov_b64 v[194:195], 0
    v_mov_b64 v[196:197], 0
    v_mov_b64 v[198:199], 0
    v_mov_b64 v[200:201], 0
    v_mov_b64 v[202:203], 0
    v_mov_b64 v[204:205], 0
    v_mov_b64 v[206:207], 0
    v_mov_b64 v[208:209], 0
    v_mov_b64 v[210:211], 0
    v_mov_b64 v[212:213], 0
    v_mov_b64 v[214:215], 0
    v_mov_b64 v[216:217], 0
    v_mov_b64 v[218:219], 0
    v_mov_b64 v[220:221], 0
    v_mov_b64 v[222:223], 0
    v_mov_b64 v[224:225], 0
    v_mov_b64 v[226:227], 0
    v_mov_b64 v[228:229], 0
    v_mov_b64 v[230:231], 0
    v_mov_b64 v[232:233], 0
    v_mov_b64 v[234:235], 0
    v_mov_b64 v[236:237], 0
    v_mov_b64 v[238:239], 0
    v_mov_b64 v[240:241], 0
    v_mov_b64 v[242:243], 0
    v_mov_b64 v[244:245], 0
    v_mov_b64 v[246:247], 0
    v_mov_b64 v[248:249], 0
    v_mov_b64 v[250:251], 0
    v_mov_b64 v[252:253], 0
    v_mov_b64 v[254:255], 0
    v_mov_b32 v7, 0
    v_mov_b32 v8, 0
    v_mov_b32 v9, 0
    v_mov_b32 v10, 0
    s_mov_b32 s47, 0x4b800000
    s_mov_b32 s54, 1
    s_waitcnt vmcnt(0)
    s_barrier
    s_cmp_lg_u32 s3, 0
    s_cbranch_scc1 L_pub2
    v_mov_b32 v11, 0
    v_mov_b32 v12, 1
    s_mov_b64 exec, 1
    buffer_store_dword v12, v11, s[12:15], s93 offen sc1
    s_mov_b64 exec, -1
L_pub2:
    s_branch L_first
L_tail:
    s_waitcnt vmcnt(0) lgkmcnt(0)
    s_barrier
    ds_read_b128 a[64:67], v3 offset:0
    ds_read_b128 a[68:71], v3 offset:16384
    ds_read_b128 a[72:75], v3 offset:1024
    ds_read_b128 a[76:79], v3 offset:17408
    ds_read_b128 a[80:83], v3 offset:2048
    ds_read_b128 a[84:87], v3 offset:18432
    ds_read_b128 a[88:91], v3 offset:3072
    ds_read_b128 a[92:95], v3 offset:19456
    v_cvt_pk_bf16_f32 v16, v64, v65
    v_cvt_pk_bf16_f32 v17, v66, v67
    v_cvt_pk_bf16_f32 v20, v68, v69
    v_cvt_pk_bf16_f32 v21, v70, v71
    v_cvt_pk_bf16_f32 v18, v72, v73
    v_cvt_pk_bf16_f32 v19, v74, v75
    v_cvt_pk_bf16_f32 v22, v76, v77
    v_cvt_pk_bf16_f32 v23, v78, v79
    v_cvt_pk_bf16_f32 v24, v80, v81
    v_cvt_pk_bf16_f32 v25, v82, v83
    v_cvt_pk_bf16_f32 v28, v84, v85
    v_cvt_pk_bf16_f32 v29, v86, v87
    v_cvt_pk_bf16_f32 v26, v88, v89
    v_cvt_pk_bf16_f32 v27, v90, v91
    v_cvt_pk_bf16_f32 v30, v92, v93
    v_cvt_pk_bf16_f32 v31, v94, v95
    v_add_f32 v7, v7, v5
    v_add_f32 v8, v8, v6
    s_waitcnt lgkmcnt(0)
    v_mfma_f32_16x16x32_bf16 v[128:131], a[64:67], v[16:19], v[128:131]
    ds_read_b128 a[96:99], v3 offset:4096
    v_mfma_f32_16x16x32_bf16 v[128:131], a[68:71], v[24:27], v[128:131]
    v_mfma_f32_16x16x32_bf16 v[192:195], a[68:71], v[28:31], v[192:195]
    ds_read_b128 a[100:103], v3 offset:20480
    v_mfma_f32_16x16x32_bf16 v[192:195], a[64:67], v[20:23], v[192:195]
    v_mfma_f32_16x16x32_bf16 v[132:135], a[72:75], v[16:19], v[132:135]
    ds_read_b128 a[104:107], v3 offset:5120
    v_mfma_f32_16x16x32_bf16 v[132:135], a[76:79], v[24:27], v[132:135]
    v_mfma_f32_16x16x32_bf16 v[196:199], a[76:79], v[28:31], v[196:199]
    ds_read_b128 a[108:111], v3 offset:21504
    v_mfma_f32_16x16x32_bf16 v[196:199], a[72:75], v[20:23], v[196:199]
    v_mfma_f32_16x16x32_bf16 v[136:139], a[80:83], v[16:19], v[136:139]
    ds_read_b128 a[112:115], v3 offset:6144
    v_mfma_f32_16x16x32_bf16 v[136:139], a[84:87], v[24:27], v[136:139]
    v_mfma_f32_16x16x32_bf16 v[200:203], a[84:87], v[28:31], v[200:203]
    ds_read_b128 a[116:119], v3 offset:22528
    v_mfma_f32_16x16x32_bf16 v[200:203], a[80:83], v[20:23], v[200:203]
    v_mfma_f32_16x16x32_bf16 v[140:143], a[88:91], v[16:19], v[140:143]
    ds_read_b128 a[120:123], v3 offset:7168
    v_mfma_f32_16x16x32_bf16 v[140:143], a[92:95], v[24:27], v[140:143]
    v_mfma_f32_16x16x32_bf16 v[204:207], a[92:95], v[28:31], v[204:207]
    ds_read_b128 a[124:127], v3 offset:23552
    v_mfma_f32_16x16x32_bf16 v[204:207], a[88:91], v[20:23], v[204:207]
    s_waitcnt lgkmcnt(6)
    v_mfma_f32_16x16x32_bf16 v[144:147], a[96:99], v[16:19], v[144:147]
    ds_read_b128 a[64:67], v3 offset:8192
    v_mfma_f32_16x16x32_bf16 v[144:147], a[100:103], v[24:27], v[144:147]
    v_mfma_f32_16x16x32_bf16 v[208:211], a[100:103], v[28:31], v[208:211]
    ds_read_b128 a[68:71], v3 offset:24576
    v_mfma_f32_16x16x32_bf16 v[208:211], a[96:99], v[20:23], v[208:211]
    s_waitcnt lgkmcnt(6)
    v_mfma_f32_16x16x32_bf16 v[148:151], a[104:107], v[16:19], v[148:151]
    ds_read_b128 a[72:75], v3 offset:9216
    v_mfma_f32_16x16x32_bf16 v[148:151], a[108:111], v[24:27], v[148:151]
    v_mfma_f32_16x16x32_bf16 v[212:215], a[108:111], v[28:31], v[212:215]
    ds_read_b128 a[76:79], v3 offset:25600
    v_mfma_f32_16x16x32_bf16 v[212:215], a[104:107], v[20:23], v[212:215]
    s_waitcnt lgkmcnt(6)
    v_mfma_f32_16x16x32_bf16 v[152:155], a[112:115], v[16:19], v[152:155]
    ds_read_b128 a[80:83], v3 offset:10240
    v_mfma_f32_16x16x32_bf16 v[152:155], a[116:119], v[24:27], v[152:155]
    v_mfma_f32_16x16x32_bf16 v[216:219], a[116:119], v[28:31], v[216:219]
    ds_read_b128 a[84:87], v3 offset:26624
    v_mfma_f32_16x16x32_bf16 v[216:219], a[112:115], v[20:23], v[216:219]
    s_waitcnt lgkmcnt(6)
    v_mfma_f32_16x16x32_bf16 v[156:159], a[120:123], v[16:19], v[156:159]
    ds_read_b128 a[88:91], v3 offset:11264
    v_mfma_f32_16x16x32_bf16 v[156:159], a[124:127], v[24:27], v[156:159]
    v_mfma_f32_16x16x32_bf16 v[220:223], a[124:127], v[28:31], v[220:223]
    ds_read_b128 a[92:95], v3 offset:27648
    v_mfma_f32_16x16x32_bf16 v[220:223], a[120:123], v[20:23], v[220:223]
    s_waitcnt lgkmcnt(6)
    v_mfma_f32_16x16x32_bf16 v[160:163], a[64:67], v[16:19], v[160:163]
    ds_read_b128 a[96:99], v3 offset:12288
    v_mfma_f32_16x16x32_bf16 v[160:163], a[68:71], v[24:27], v[160:163]
    v_mfma_f32_16x16x32_bf16 v[224:227], a[68:71], v[28:31], v[224:227]
    ds_read_b128 a[100:103], v3 offset:28672
    v_mfma_f32_16x16x32_bf16 v[224:227], a[64:67], v[20:23], v[224:227]
    s_waitcnt lgkmcnt(6)
    v_mfma_f32_16x16x32_bf16 v[164:167], a[72:75], v[16:19], v[164:167]
    ds_read_b128 a[104:107], v3 offset:13312
    v_mfma_f32_16x16x32_bf16 v[164:167], a[76:79], v[24:27], v[164:167]
    v_mfma_f32_16x16x32_bf16 v[228:231], a[76:79], v[28:31], v[228:231]
    ds_read_b128 a[108:111], v3 offset:29696
    v_mfma_f32_16x16x32_bf16 v[228:231], a[72:75], v[20:23], v[228:231]
    s_waitcnt lgkmcnt(6)
    v_mfma_f32_16x16x32_bf16 v[168:171], a[80:83], v[16:19], v[168:171]
    ds_read_b128 a[112:115], v3 offset:14336
    v_mfma_f32_16x16x32_bf16 v[168:171], a[84:87], v[24:27], v[168:171]
    v_mfma_f32_16x16x32_bf16 v[232:235], a[84:87], v[28:31], v[232:235]
    ds_read_b128 a[116:119], v3 offset:30720
    v_mfma_f32_16x16x32_bf16 v[232:235], a[80:83], v[20:23], v[232:235]
    s_waitcnt lgkmcnt(6)
    v_mfma_f32_16x16x32_bf16 v[172:175], a[88:91], v[16:19], v[172:175]
    ds_read_b128 a[120:123], v3 offset:15360
    v_mfma_f32_16x16x32_bf16 v[172:175], a[92:95], v[24:27], v[172:175]
    v_mfma_f32_16x16x32_bf16 v[236:239], a[92:95], v[28:31], v[236:239]
    ds_read_b128 a[124:127], v3 offset:31744
    v_mfma_f32_16x16x32_bf16 v[236:239], a[88:91], v[20:23], v[236:239]
    s_waitcnt lgkmcnt(6)
    v_mfma_f32_16x16x32_bf16 v[176:179], a[96:99], v[16:19], v[176:179]
    v_mfma_f32_16x16x32_bf16 v[176:179], a[100:103], v[24:27], v[176:179]
    v_mfma_f32_16x16x32_bf16 v[240:243], a[100:103], v[28:31], v[240:243]
    v_mfma_f32_16x16x32_bf16 v[240:243], a[96:99], v[20:23], v[240:243]
    s_waitcnt lgkmcnt(4)
    v_mfma_f32_16x16x32_bf16 v[180:183], a[104:107], v[16:19], v[180:183]
    v_mfma_f32_16x16x32_bf16 v[180:183], a[108:111], v[24:27], v[180:183]
    v_mfma_f32_16x16x32_bf16 v[244:247], a[108:111], v[28:31], v[244:247]
    v_mfma_f32_16x16x32_bf16 v[244:247], a[104:107], v[20:23], v[244:247]
    s_waitcnt lgkmcnt(2)
    v_mfma_f32_16x16x32_bf16 v[184:187], a[112:115], v[16:19], v[184:187]
    v_mfma_f32_16x16x32_bf16 v[184:187], a[116:119], v[24:27], v[184:187]
    v_mfma_f32_16x16x32_bf16 v[248:251], a[116:119], v[28:31], v[248:251]
    v_mfma_f32_16x16x32_bf16 v[248:251], a[112:115], v[20:23], v[248:251]
    s_waitcnt lgkmcnt(0)
    v_mfma_f32_16x16x32_bf16 v[188:191], a[120:123], v[16:19], v[188:191]
    v_mfma_f32_16x16x32_bf16 v[188:191], a[124:127], v[24:27], v[188:191]
    v_mfma_f32_16x16x32_bf16 v[252:255], a[124:127], v[28:31], v[252:255]
    v_mfma_f32_16x16x32_bf16 v[252:255], a[120:123], v[20:23], v[252:255]
    v_mov_b32 v13, v7
    s_nop 1
    v_permlane32_swap_b32 v7, v13
    s_nop 1
    v_add_f32 v7, v7, v13
    v_mov_b32 v13, v7
    s_nop 1
    v_permlane16_swap_b32 v7, v13
    s_nop 1
    v_add_f32 v7, v7, v13
    v_mov_b32 v13, v8
    s_nop 1
    v_permlane32_swap_b32 v8, v13
    s_nop 1
    v_add_f32 v8, v8, v13
    v_mov_b32 v13, v8
    s_nop 1
    v_permlane16_swap_b32 v8, v13
    s_nop 1
    v_add_f32 v8, v8, v13
    v_log_f32 v5, v7
    v_rcp_f32 v16, v7
    v_log_f32 v6, v8
    v_rcp_f32 v17, v8
    v_sub_f32 v5, v5, v9
    v_sub_f32 v6, v6, v10
    s_cmp_eq_u32 s38, 0
    s_cbranch_scc1 L_store
    s_and_b32 s39, s2, 127
    s_lshl_b32 s55, s39, 16
    s_lshl_b32 s57, s3, 14
    s_add_u32 s55, s55, s57
    s_add_u32 s55, s55, 67108864
    s_add_u32 s56, s55, 0x2000
    s_lshl_b32 s57, s39, 2
    s_add_u32 s57, s57, s3
    s_lshl_b32 s57, s57, 9
    s_add_u32 s57, s57, 83886080
    v_lshrrev_b32 v15, 2, v1
    s_cmp_eq_u32 s54, 2
    s_cbranch_scc1 L_merge
    buffer_store_dword v5, v15, s[12:15], s57 offen offset:0 sc1
    buffer_store_dword v6, v15, s[12:15], s57 offen offset:256 sc1
    v_pk_mul_f32 v[128:129], v[128:129], v[16:17] op_sel:[0,0] op_sel_hi:[1,0]
    v_pk_mul_f32 v[130:131], v[130:131], v[16:17] op_sel:[0,0] op_sel_hi:[1,0]
    v_pk_mul_f32 v[132:133], v[132:133], v[16:17] op_sel:[0,0] op_sel_hi:[1,0]
    v_pk_mul_f32 v[134:135], v[134:135], v[16:17] op_sel:[0,0] op_sel_hi:[1,0]
    v_cvt_pk_bf16_f32 v128, v128, v129
    v_cvt_pk_bf16_f32 v129, v130, v131
    v_cvt_pk_bf16_f32 v130, v132, v133
    v_cvt_pk_bf16_f32 v131, v134, v135
    buffer_store_dwordx4 v[128:131], v1, s[12:15], s55 offen offset:0 sc1
    v_pk_mul_f32 v[136:137], v[136:137], v[16:17] op_sel:[0,0] op_sel_hi:[1,0]
    v_pk_mul_f32 v[138:139], v[138:139], v[16:17] op_sel:[0,0] op_sel_hi:[1,0]
    v_pk_mul_f32 v[140:141], v[140:141], v[16:17] op_sel:[0,0] op_sel_hi:[1,0]
    v_pk_mul_f32 v[142:143], v[142:143], v[16:17] op_sel:[0,0] op_sel_hi:[1,0]
    v_cvt_pk_bf16_f32 v136, v136, v137
    v_cvt_pk_bf16_f32 v137, v138, v139
    v_cvt_pk_bf16_f32 v138, v140, v141
    v_cvt_pk_bf16_f32 v139, v142, v143
    buffer_store_dwordx4 v[136:139], v1, s[12:15], s55 offen offset:1024 sc1
    v_pk_mul_f32 v[144:145], v[144:145], v[16:17] op_sel:[0,0] op_sel_hi:[1,0]
    v_pk_mul_f32 v[146:147], v[146:147], v[16:17] op_sel:[0,0] op_sel_hi:[1,0]
    v_pk_mul_f32 v[148:149], v[148:149], v[16:17] op_sel:[0,0] op_sel_hi:[1,0]
    v_pk_mul_f32 v[150:151], v[150:151], v[16:17] op_sel:[0,0] op_sel_hi:[1,0]
    v_cvt_pk_bf16_f32 v144, v144, v145
    v_cvt_pk_bf16_f32 v145, v146, v147
    v_cvt_pk_bf16_f32 v146, v148, v149
    v_cvt_pk_bf16_f32 v147, v150, v151
    buffer_store_dwordx4 v[144:147], v1, s[12:15], s55 offen offset:2048 sc1
    v_pk_mul_f32 v[152:153], v[152:153], v[16:17] op_sel:[0,0] op_sel_hi:[1,0]
    v_pk_mul_f32 v[154:155], v[154:155], v[16:17] op_sel:[0,0] op_sel_hi:[1,0]
    v_pk_mul_f32 v[156:157], v[156:157], v[16:17] op_sel:[0,0] op_sel_hi:[1,0]
    v_pk_mul_f32 v[158:159], v[158:159], v[16:17] op_sel:[0,0] op_sel_hi:[1,0]
    v_cvt_pk_bf16_f32 v152, v152, v153
    v_cvt_pk_bf16_f32 v153, v154, v155
    v_cvt_pk_bf16_f32 v154, v156, v157
    v_cvt_pk_bf16_f32 v155, v158, v159
    buffer_store_dwordx4 v[152:155], v1, s[12:15], s55 offen offset:3072 sc1
    v_pk_mul_f32 v[160:161], v[160:161], v[16:17] op_sel:[0,0] op_sel_hi:[1,0]
    v_pk_mul_f32 v[162:163], v[162:163], v[16:17] op_sel:[0,0] op_sel_hi:[1,0]
    v_pk_mul_f32 v[164:165], v[164:165], v[16:17] op_sel:[0,0] op_sel_hi:[1,0]
    v_pk_mul_f32 v[166:167], v[166:167], v[16:17] op_sel:[0,0] op_sel_hi:[1,0]
    v_cvt_pk_bf16_f32 v160, v160, v161
    v_cvt_pk_bf16_f32 v161, v162, v163
    v_cvt_pk_bf16_f32 v162, v164, v165
    v_cvt_pk_bf16_f32 v163, v166, v167
    buffer_store_dwordx4 v[160:163], v4, s[12:15], s55 offen offset:0 sc1
    v_pk_mul_f32 v[168:169], v[168:169], v[16:17] op_sel:[0,0] op_sel_hi:[1,0]
    v_pk_mul_f32 v[170:171], v[170:171], v[16:17] op_sel:[0,0] op_sel_hi:[1,0]
    v_pk_mul_f32 v[172:173], v[172:173], v[16:17] op_sel:[0,0] op_sel_hi:[1,0]
    v_pk_mul_f32 v[174:175], v[174:175], v[16:17] op_sel:[0,0] op_sel_hi:[1,0]
    v_cvt_pk_bf16_f32 v168, v168, v169
    v_cvt_pk_bf16_f32 v169, v170, v171
    v_cvt_pk_bf16_f32 v170, v172, v173
    v_cvt_pk_bf16_f32 v171, v174, v175
    buffer_store_dwordx4 v[168:171], v4, s[12:15], s55 offen offset:1024 sc1
    v_pk_mul_f32 v[176:177], v[176:177], v[16:17] op_sel:[0,0] op_sel_hi:[1,0]
    v_pk_mul_f32 v[178:179], v[178:179], v[16:17] op_sel:[0,0] op_sel_hi:[1,0]
    v_pk_mul_f32 v[180:181], v[180:181], v[16:17] op_sel:[0,0] op_sel_hi:[1,0]
    v_pk_mul_f32 v[182:183], v[182:183], v[16:17] op_sel:[0,0] op_sel_hi:[1,0]
    v_cvt_pk_bf16_f32 v176, v176, v177
    v_cvt_pk_bf16_f32 v177, v178, v179
    v_cvt_pk_bf16_f32 v178, v180, v181
    v_cvt_pk_bf16_f32 v179, v182, v183
    buffer_store_dwordx4 v[176:179], v4, s[12:15], s55 offen offset:2048 sc1
    v_pk_mul_f32 v[184:185], v[184:185], v[16:17] op_sel:[0,0] op_sel_hi:[1,0]
    v_pk_mul_f32 v[186:187], v[186:187], v[16:17] op_sel:[0,0] op_sel_hi:[1,0]
    v_pk_mul_f32 v[188:189], v[188:189], v[16:17] op_sel:[0,0] op_sel_hi:[1,0]
    v_pk_mul_f32 v[190:191], v[190:191], v[16:17] op_sel:[0,0] op_sel_hi:[1,0]
    v_cvt_pk_bf16_f32 v184, v184, v185
    v_cvt_pk_bf16_f32 v185, v186, v187
    v_cvt_pk_bf16_f32 v186, v188, v189
    v_cvt_pk_bf16_f32 v187, v190, v191
    buffer_store_dwordx4 v[184:187], v4, s[12:15], s55 offen offset:3072 sc1
    v_pk_mul_f32 v[192:193], v[192:193], v[16:17] op_sel:[0,1] op_sel_hi:[1,1]
    v_pk_mul_f32 v[194:195], v[194:195], v[16:17] op_sel:[0,1] op_sel_hi:[1,1]
    v_pk_mul_f32 v[196:197], v[196:197], v[16:17] op_sel:[0,1] op_sel_hi:[1,1]
    v_pk_mul_f32 v[198:199], v[198:199], v[16:17] op_sel:[0,1] op_sel_hi:[1,1]
    v_cvt_pk_bf16_f32 v192, v192, v193
    v_cvt_pk_bf16_f32 v193, v194, v195
    v_cvt_pk_bf16_f32 v194, v196, v197
    v_cvt_pk_bf16_f32 v195, v198, v199
    buffer_store_dwordx4 v[192:195], v1, s[12:15], s56 offen offset:0 sc1
    v_pk_mul_f32 v[200:201], v[200:201], v[16:17] op_sel:[0,1] op_sel_hi:[1,1]
    v_pk_mul_f32 v[202:203], v[202:203], v[16:17] op_sel:[0,1] op_sel_hi:[1,1]
    v_pk_mul_f32 v[204:205], v[204:205], v[16:17] op_sel:[0,1] op_sel_hi:[1,1]
    v_pk_mul_f32 v[206:207], v[206:207], v[16:17] op_sel:[0,1] op_sel_hi:[1,1]
    v_cvt_pk_bf16_f32 v200, v200, v201
    v_cvt_pk_bf16_f32 v201, v202, v203
    v_cvt_pk_bf16_f32 v202, v204, v205
    v_cvt_pk_bf16_f32 v203, v206, v207
    buffer_store_dwordx4 v[200:203], v1, s[12:15], s56 offen offset:1024 sc1
    v_pk_mul_f32 v[208:209], v[208:209], v[16:17] op_sel:[0,1] op_sel_hi:[1,1]
    v_pk_mul_f32 v[210:211], v[210:211], v[16:17] op_sel:[0,1] op_sel_hi:[1,1]
    v_pk_mul_f32 v[212:213], v[212:213], v[16:17] op_sel:[0,1] op_sel_hi:[1,1]
    v_pk_mul_f32 v[214:215], v[214:215], v[16:17] op_sel:[0,1] op_sel_hi:[1,1]
    v_cvt_pk_bf16_f32 v208, v208, v209
    v_cvt_pk_bf16_f32 v209, v210, v211
    v_cvt_pk_bf16_f32 v210, v212, v213
    v_cvt_pk_bf16_f32 v211, v214, v215
    buffer_store_dwordx4 v[208:211], v1, s[12:15], s56 offen offset:2048 sc1
    v_pk_mul_f32 v[216:217], v[216:217], v[16:17] op_sel:[0,1] op_sel_hi:[1,1]
    v_pk_mul_f32 v[218:219], v[218:219], v[16:17] op_sel:[0,1] op_sel_hi:[1,1]
    v_pk_mul_f32 v[220:221], v[220:221], v[16:17] op_sel:[0,1] op_sel_hi:[1,1]
    v_pk_mul_f32 v[222:223], v[222:223], v[16:17] op_sel:[0,1] op_sel_hi:[1,1]
    v_cvt_pk_bf16_f32 v216, v216, v217
    v_cvt_pk_bf16_f32 v217, v218, v219
    v_cvt_pk_bf16_f32 v218, v220, v221
    v_cvt_pk_bf16_f32 v219, v222, v223
    buffer_store_dwordx4 v[216:219], v1, s[12:15], s56 offen offset:3072 sc1
    v_pk_mul_f32 v[224:225], v[224:225], v[16:17] op_sel:[0,1] op_sel_hi:[1,1]
    v_pk_mul_f32 v[226:227], v[226:227], v[16:17] op_sel:[0,1] op_sel_hi:[1,1]
    v_pk_mul_f32 v[228:229], v[228:229], v[16:17] op_sel:[0,1] op_sel_hi:[1,1]
    v_pk_mul_f32 v[230:231], v[230:231], v[16:17] op_sel:[0,1] op_sel_hi:[1,1]
    v_cvt_pk_bf16_f32 v224, v224, v225
    v_cvt_pk_bf16_f32 v225, v226, v227
    v_cvt_pk_bf16_f32 v226, v228, v229
    v_cvt_pk_bf16_f32 v227, v230, v231
    buffer_store_dwordx4 v[224:227], v4, s[12:15], s56 offen offset:0 sc1
    v_pk_mul_f32 v[232:233], v[232:233], v[16:17] op_sel:[0,1] op_sel_hi:[1,1]
    v_pk_mul_f32 v[234:235], v[234:235], v[16:17] op_sel:[0,1] op_sel_hi:[1,1]
    v_pk_mul_f32 v[236:237], v[236:237], v[16:17] op_sel:[0,1] op_sel_hi:[1,1]
    v_pk_mul_f32 v[238:239], v[238:239], v[16:17] op_sel:[0,1] op_sel_hi:[1,1]
    v_cvt_pk_bf16_f32 v232, v232, v233
    v_cvt_pk_bf16_f32 v233, v234, v235
    v_cvt_pk_bf16_f32 v234, v236, v237
    v_cvt_pk_bf16_f32 v235, v238, v239
    buffer_store_dwordx4 v[232:235], v4, s[12:15], s56 offen offset:1024 sc1
    v_pk_mul_f32 v[240:241], v[240:241], v[16:17] op_sel:[0,1] op_sel_hi:[1,1]
    v_pk_mul_f32 v[242:243], v[242:243], v[16:17] op_sel:[0,1] op_sel_hi:[1,1]
    v_pk_mul_f32 v[244:245], v[244:245], v[16:17] op_sel:[0,1] op_sel_hi:[1,1]
    v_pk_mul_f32 v[246:247], v[246:247], v[16:17] op_sel:[0,1] op_sel_hi:[1,1]
    v_cvt_pk_bf16_f32 v240, v240, v241
    v_cvt_pk_bf16_f32 v241, v242, v243
    v_cvt_pk_bf16_f32 v242, v244, v245
    v_cvt_pk_bf16_f32 v243, v246, v247
    buffer_store_dwordx4 v[240:243], v4, s[12:15], s56 offen offset:2048 sc1
    v_pk_mul_f32 v[248:249], v[248:249], v[16:17] op_sel:[0,1] op_sel_hi:[1,1]
    v_pk_mul_f32 v[250:251], v[250:251], v[16:17] op_sel:[0,1] op_sel_hi:[1,1]
    v_pk_mul_f32 v[252:253], v[252:253], v[16:17] op_sel:[0,1] op_sel_hi:[1,1]
    v_pk_mul_f32 v[254:255], v[254:255], v[16:17] op_sel:[0,1] op_sel_hi:[1,1]
    v_cvt_pk_bf16_f32 v248, v248, v249
    v_cvt_pk_bf16_f32 v249, v250, v251
    v_cvt_pk_bf16_f32 v250, v252, v253
    v_cvt_pk_bf16_f32 v251, v254, v255
    buffer_store_dwordx4 v[248:251], v4, s[12:15], s56 offen offset:3072 sc1
    s_waitcnt vmcnt(0)
    s_barrier
    s_cmp_lg_u32 s3, 0
    s_cbranch_scc1 L_pub3
    v_mov_b32 v11, 0
    v_mov_b32 v12, 1
    s_mov_b64 exec, 1
    buffer_store_dword v12, v11, s[12:15], s94 offen sc1
    s_mov_b64 exec, -1
L_pub3:
    s_branch L_attdone
L_merge:
    v_and_b32 v11, 0, v0
    v_lshlrev_b32 v11, 2, v11
    s_mov_b32 s32, 0
L_poll4:
    buffer_load_dword v12, v11, s[12:15], s94 offen sc1
    s_waitcnt vmcnt(0)
    v_cmp_ne_u32 vcc, 1, v12
    s_cbranch_vccz L_poll4_ok
    s_sleep 2
    s_add_u32 s32, s32, 1
    s_cmp_lt_u32 s32, 0x80000
    s_cbranch_scc1 L_poll4
L_poll4_ok:
    buffer_load_dword v18, v15, s[12:15], s57 offen offset:0 sc1
    buffer_load_dword v19, v15, s[12:15], s57 offen offset:256 sc1
    buffer_load_dwordx4 v[32:35], v1, s[12:15], s55 offen offset:0 sc1
    buffer_load_dwordx4 v[36:39], v1, s[12:15], s55 offen offset:1024 sc1
    buffer_load_dwordx4 v[40:43], v1, s[12:15], s55 offen offset:2048 sc1
    buffer_load_dwordx4 v[44:47], v1, s[12:15], s55 offen offset:3072 sc1
    buffer_load_dwordx4 v[48:51], v4, s[12:15], s55 offen offset:0 sc1
    buffer_load_dwordx4 v[52:55], v4, s[12:15], s55 offen offset:1024 sc1
    buffer_load_dwordx4 v[56:59], v4, s[12:15], s55 offen offset:2048 sc1
    buffer_load_dwordx4 v[60:63], v4, s[12:15], s55 offen offset:3072 sc1
    buffer_load_dwordx4 v[64:67], v1, s[12:15], s56 offen offset:0 sc1
    buffer_load_dwordx4 v[68:71], v1, s[12:15], s56 offen offset:1024 sc1
    buffer_load_dwordx4 v[72:75], v1, s[12:15], s56 offen offset:2048 sc1
    buffer_load_dwordx4 v[76:79], v1, s[12:15], s56 offen offset:3072 sc1
    buffer_load_dwordx4 v[80:83], v4, s[12:15], s56 offen offset:0 sc1
    buffer_load_dwordx4 v[84:87], v4, s[12:15], s56 offen offset:1024 sc1
    buffer_load_dwordx4 v[88:91], v4, s[12:15], s56 offen offset:2048 sc1
    buffer_load_dwordx4 v[92:95], v4, s[12:15], s56 offen offset:3072 sc1
    s_waitcnt vmcnt(16)
    v_max_f32 v20, v18, v5
    v_sub_f32 v21, v5, v20
    v_sub_f32 v22, v18, v20
    v_exp_f32 v21, v21
    v_exp_f32 v22, v22
    s_nop 0
    v_add_f32 v20, v21, v22
    v_rcp_f32 v20, v20
    s_nop 0
    v_mul_f32 v21, v21, v20
    v_mul_f32 v18, v22, v20
    v_mul_f32 v16, v16, v21
    v_max_f32 v20, v19, v6
    v_sub_f32 v21, v6, v20
    v_sub_f32 v22, v19, v20
    v_exp_f32 v21, v21
    v_exp_f32 v22, v22
    s_nop 0
    v_add_f32 v20, v21, v22
    v_rcp_f32 v20, v20
    s_nop 0
    v_mul_f32 v21, v21, v20
    v_mul_f32 v19, v22, v20
    v_mul_f32 v17, v17, v21
    s_lshl_b32 s55, s51, 20
    s_lshl_b32 s57, s3, 17
    s_add_u32 s55, s55, s57
    s_lshl_b32 s57, s26, 13
    s_add_u32 s55, s55, s57
    s_add_u32 s55, s55, 50331648
    s_add_u32 s56, s55, 0x80000
    s_mov_b32 s59, 0xffff0000
    s_waitcnt vmcnt(15)
    v_lshlrev_b32 v24, 16, v32
    v_and_b32 v25, s59, v32
    v_pk_mul_f32 v[24:25], v[24:25], v[18:19] op_sel:[0,0] op_sel_hi:[1,0]
    v_pk_fma_f32 v[128:129], v[128:129], v[16:17], v[24:25] op_sel:[0,0,0] op_sel_hi:[1,0,1]
    v_lshlrev_b32 v26, 16, v33
    v_and_b32 v27, s59, v33
    v_pk_mul_f32 v[26:27], v[26:27], v[18:19] op_sel:[0,0] op_sel_hi:[1,0]
    v_pk_fma_f32 v[130:131], v[130:131], v[16:17], v[26:27] op_sel:[0,0,0] op_sel_hi:[1,0,1]
    v_lshlrev_b32 v28, 16, v34
    v_and_b32 v29, s59, v34
    v_pk_mul_f32 v[28:29], v[28:29], v[18:19] op_sel:[0,0] op_sel_hi:[1,0]
    v_pk_fma_f32 v[132:133], v[132:133], v[16:17], v[28:29] op_sel:[0,0,0] op_sel_hi:[1,0,1]
    v_lshlrev_b32 v30, 16, v35
    v_and_b32 v31, s59, v35
    v_pk_mul_f32 v[30:31], v[30:31], v[18:19] op_sel:[0,0] op_sel_hi:[1,0]
    v_pk_fma_f32 v[134:135], v[134:135], v[16:17], v[30:31] op_sel:[0,0,0] op_sel_hi:[1,0,1]
    v_cvt_pk_bf16_f32 v128, v128, v129
    v_cvt_pk_bf16_f32 v129, v130, v131
    v_cvt_pk_bf16_f32 v130, v132, v133
    v_cvt_pk_bf16_f32 v131, v134, v135
    buffer_store_dwordx4 v[128:131], v1, s[12:15], s55 offen offset:0 sc1
    s_waitcnt vmcnt(15)
    v_lshlrev_b32 v24, 16, v36
    v_and_b32 v25, s59, v36
    v_pk_mul_f32 v[24:25], v[24:25], v[18:19] op_sel:[0,0] op_sel_hi:[1,0]
    v_pk_fma_f32 v[136:137], v[136:137], v[16:17], v[24:25] op_sel:[0,0,0] op_sel_hi:[1,0,1]
    v_lshlrev_b32 v26, 16, v37
    v_and_b32 v27, s59, v37
    v_pk_mul_f32 v[26:27], v[26:27], v[18:19] op_sel:[0,0] op_sel_hi:[1,0]
    v_pk_fma_f32 v[138:139], v[138:139], v[16:17], v[26:27] op_sel:[0,0,0] op_sel_hi:[1,0,1]
    v_lshlrev_b32 v28, 16, v38
    v_and_b32 v29, s59, v38
    v_pk_mul_f32 v[28:29], v[28:29], v[18:19] op_sel:[0,0] op_sel_hi:[1,0]
    v_pk_fma_f32 v[140:141], v[140:141], v[16:17], v[28:29] op_sel:[0,0,0] op_sel_hi:[1,0,1]
    v_lshlrev_b32 v30, 16, v39
    v_and_b32 v31, s59, v39
    v_pk_mul_f32 v[30:31], v[30:31], v[18:19] op_sel:[0,0] op_sel_hi:[1,0]
    v_pk_fma_f32 v[142:143], v[142:143], v[16:17], v[30:31] op_sel:[0,0,0] op_sel_hi:[1,0,1]
    v_cvt_pk_bf16_f32 v136, v136, v137
    v_cvt_pk_bf16_f32 v137, v138, v139
    v_cvt_pk_bf16_f32 v138, v140, v141
    v_cvt_pk_bf16_f32 v139, v142, v143
    buffer_store_dwordx4 v[136:139], v1, s[12:15], s55 offen offset:1024 sc1
    s_waitcnt vmcnt(15)
    v_lshlrev_b32 v24, 16, v40
    v_and_b32 v25, s59, v40
    v_pk_mul_f32 v[24:25], v[24:25], v[18:19] op_sel:[0,0] op_sel_hi:[1,0]
    v_pk_fma_f32 v[144:145], v[144:145], v[16:17], v[24:25] op_sel:[0,0,0] op_sel_hi:[1,0,1]
    v_lshlrev_b32 v26, 16, v41
    v_and_b32 v27, s59, v41
    v_pk_mul_f32 v[26:27], v[26:27], v[18:19] op_sel:[0,0] op_sel_hi:[1,0]
    v_pk_fma_f32 v[146:147], v[146:147], v[16:17], v[26:27] op_sel:[0,0,0] op_sel_hi:[1,0,1]
    v_lshlrev_b32 v28, 16, v42
    v_and_b32 v29, s59, v42
    v_pk_mul_f32 v[28:29], v[28:29], v[18:19] op_sel:[0,0] op_sel_hi:[1,0]
    v_pk_fma_f32 v[148:149], v[148:149], v[16:17], v[28:29] op_sel:[0,0,0] op_sel_hi:[1,0,1]
    v_lshlrev_b32 v30, 16, v43
    v_and_b32 v31, s59, v43
    v_pk_mul_f32 v[30:31], v[30:31], v[18:19] op_sel:[0,0] op_sel_hi:[1,0]
    v_pk_fma_f32 v[150:151], v[150:151], v[16:17], v[30:31] op_sel:[0,0,0] op_sel_hi:[1,0,1]
    v_cvt_pk_bf16_f32 v144, v144, v145
    v_cvt_pk_bf16_f32 v145, v146, v147
    v_cvt_pk_bf16_f32 v146, v148, v149
    v_cvt_pk_bf16_f32 v147, v150, v151
    buffer_store_dwordx4 v[144:147], v1, s[12:15], s55 offen offset:2048 sc1
    s_waitcnt vmcnt(15)
    v_lshlrev_b32 v24, 16, v44
    v_and_b32 v25, s59, v44
    v_pk_mul_f32 v[24:25], v[24:25], v[18:19] op_sel:[0,0] op_sel_hi:[1,0]
    v_pk_fma_f32 v[152:153], v[152:153], v[16:17], v[24:25] op_sel:[0,0,0] op_sel_hi:[1,0,1]
    v_lshlrev_b32 v26, 16, v45
    v_and_b32 v27, s59, v45
    v_pk_mul_f32 v[26:27], v[26:27], v[18:19] op_sel:[0,0] op_sel_hi:[1,0]
    v_pk_fma_f32 v[154:155], v[154:155], v[16:17], v[26:27] op_sel:[0,0,0] op_sel_hi:[1,0,1]
    v_lshlrev_b32 v28, 16, v46
    v_and_b32 v29, s59, v46
    v_pk_mul_f32 v[28:29], v[28:29], v[18:19] op_sel:[0,0] op_sel_hi:[1,0]
    v_pk_fma_f32 v[156:157], v[156:157], v[16:17], v[28:29] op_sel:[0,0,0] op_sel_hi:[1,0,1]
    v_lshlrev_b32 v30, 16, v47
    v_and_b32 v31, s59, v47
    v_pk_mul_f32 v[30:31], v[30:31], v[18:19] op_sel:[0,0] op_sel_hi:[1,0]
    v_pk_fma_f32 v[158:159], v[158:159], v[16:17], v[30:31] op_sel:[0,0,0] op_sel_hi:[1,0,1]
    v_cvt_pk_bf16_f32 v152, v152, v153
    v_cvt_pk_bf16_f32 v153, v154, v155
    v_cvt_pk_bf16_f32 v154, v156, v157
    v_cvt_pk_bf16_f32 v155, v158, v159
    buffer_store_dwordx4 v[152:155], v1, s[12:15], s55 offen offset:3072 sc1
    s_waitcnt vmcnt(15)
    v_lshlrev_b32 v24, 16, v48
    v_and_b32 v25, s59, v48
    v_pk_mul_f32 v[24:25], v[24:25], v[18:19] op_sel:[0,0] op_sel_hi:[1,0]
    v_pk_fma_f32 v[160:161], v[160:161], v[16:17], v[24:25] op_sel:[0,0,0] op_sel_hi:[1,0,1]
    v_lshlrev_b32 v26, 16, v49
    v_and_b32 v27, s59, v49
    v_pk_mul_f32 v[26:27], v[26:27], v[18:19] op_sel:[0,0] op_sel_hi:[1,0]
    v_pk_fma_f32 v[162:163], v[162:163], v[16:17], v[26:27] op_sel:[0,0,0] op_sel_hi:[1,0,1]
    v_lshlrev_b32 v28, 16, v50
    v_and_b32 v29, s59, v50
    v_pk_mul_f32 v[28:29], v[28:29], v[18:19] op_sel:[0,0] op_sel_hi:[1,0]
    v_pk_fma_f32 v[164:165], v[164:165], v[16:17], v[28:29] op_sel:[0,0,0] op_sel_hi:[1,0,1]
    v_lshlrev_b32 v30, 16, v51
    v_and_b32 v31, s59, v51
    v_pk_mul_f32 v[30:31], v[30:31], v[18:19] op_sel:[0,0] op_sel_hi:[1,0]
    v_pk_fma_f32 v[166:167], v[166:167], v[16:17], v[30:31] op_sel:[0,0,0] op_sel_hi:[1,0,1]
    v_cvt_pk_bf16_f32 v160, v160, v161
    v_cvt_pk_bf16_f32 v161, v162, v163
    v_cvt_pk_bf16_f32 v162, v164, v165
    v_cvt_pk_bf16_f32 v163, v166, v167
    buffer_store_dwordx4 v[160:163], v4, s[12:15], s55 offen offset:0 sc1
    s_waitcnt vmcnt(15)
    v_lshlrev_b32 v24, 16, v52
    v_and_b32 v25, s59, v52
    v_pk_mul_f32 v[24:25], v[24:25], v[18:19] op_sel:[0,0] op_sel_hi:[1,0]
    v_pk_fma_f32 v[168:169], v[168:169], v[16:17], v[24:25] op_sel:[0,0,0] op_sel_hi:[1,0,1]
    v_lshlrev_b32 v26, 16, v53
    v_and_b32 v27, s59, v53
    v_pk_mul_f32 v[26:27], v[26:27], v[18:19] op_sel:[0,0] op_sel_hi:[1,0]
    v_pk_fma_f32 v[170:171], v[170:171], v[16:17], v[26:27] op_sel:[0,0,0] op_sel_hi:[1,0,1]
    v_lshlrev_b32 v28, 16, v54
    v_and_b32 v29, s59, v54
    v_pk_mul_f32 v[28:29], v[28:29], v[18:19] op_sel:[0,0] op_sel_hi:[1,0]
    v_pk_fma_f32 v[172:173], v[172:173], v[16:17], v[28:29] op_sel:[0,0,0] op_sel_hi:[1,0,1]
    v_lshlrev_b32 v30, 16, v55
    v_and_b32 v31, s59, v55
    v_pk_mul_f32 v[30:31], v[30:31], v[18:19] op_sel:[0,0] op_sel_hi:[1,0]
    v_pk_fma_f32 v[174:175], v[174:175], v[16:17], v[30:31] op_sel:[0,0,0] op_sel_hi:[1,0,1]
    v_cvt_pk_bf16_f32 v168, v168, v169
    v_cvt_pk_bf16_f32 v169, v170, v171
    v_cvt_pk_bf16_f32 v170, v172, v173
    v_cvt_pk_bf16_f32 v171, v174, v175
    buffer_store_dwordx4 v[168:171], v4, s[12:15], s55 offen offset:1024 sc1
    s_waitcnt vmcnt(15)
    v_lshlrev_b32 v24, 16, v56
    v_and_b32 v25, s59, v56
    v_pk_mul_f32 v[24:25], v[24:25], v[18:19] op_sel:[0,0] op_sel_hi:[1,0]
    v_pk_fma_f32 v[176:177], v[176:177], v[16:17], v[24:25] op_sel:[0,0,0] op_sel_hi:[1,0,1]
    v_lshlrev_b32 v26, 16, v57
    v_and_b32 v27, s59, v57
    v_pk_mul_f32 v[26:27], v[26:27], v[18:19] op_sel:[0,0] op_sel_hi:[1,0]
    v_pk_fma_f32 v[178:179], v[178:179], v[16:17], v[26:27] op_sel:[0,0,0] op_sel_hi:[1,0,1]
    v_lshlrev_b32 v28, 16, v58
    v_and_b32 v29, s59, v58
    v_pk_mul_f32 v[28:29], v[28:29], v[18:19] op_sel:[0,0] op_sel_hi:[1,0]
    v_pk_fma_f32 v[180:181], v[180:181], v[16:17], v[28:29] op_sel:[0,0,0] op_sel_hi:[1,0,1]
    v_lshlrev_b32 v30, 16, v59
    v_and_b32 v31, s59, v59
    v_pk_mul_f32 v[30:31], v[30:31], v[18:19] op_sel:[0,0] op_sel_hi:[1,0]
    v_pk_fma_f32 v[182:183], v[182:183], v[16:17], v[30:31] op_sel:[0,0,0] op_sel_hi:[1,0,1]
    v_cvt_pk_bf16_f32 v176, v176, v177
    v_cvt_pk_bf16_f32 v177, v178, v179
    v_cvt_pk_bf16_f32 v178, v180, v181
    v_cvt_pk_bf16_f32 v179, v182, v183
    buffer_store_dwordx4 v[176:179], v4, s[12:15], s55 offen offset:2048 sc1
    s_waitcnt vmcnt(15)
    v_lshlrev_b32 v24, 16, v60
    v_and_b32 v25, s59, v60
    v_pk_mul_f32 v[24:25], v[24:25], v[18:19] op_sel:[0,0] op_sel_hi:[1,0]
    v_pk_fma_f32 v[184:185], v[184:185], v[16:17], v[24:25] op_sel:[0,0,0] op_sel_hi:[1,0,1]
    v_lshlrev_b32 v26, 16, v61
    v_and_b32 v27, s59, v61
    v_pk_mul_f32 v[26:27], v[26:27], v[18:19] op_sel:[0,0] op_sel_hi:[1,0]
    v_pk_fma_f32 v[186:187], v[186:187], v[16:17], v[26:27] op_sel:[0,0,0] op_sel_hi:[1,0,1]
    v_lshlrev_b32 v28, 16, v62
    v_and_b32 v29, s59, v62
    v_pk_mul_f32 v[28:29], v[28:29], v[18:19] op_sel:[0,0] op_sel_hi:[1,0]
    v_pk_fma_f32 v[188:189], v[188:189], v[16:17], v[28:29] op_sel:[0,0,0] op_sel_hi:[1,0,1]
    v_lshlrev_b32 v30, 16, v63
    v_and_b32 v31, s59, v63
    v_pk_mul_f32 v[30:31], v[30:31], v[18:19] op_sel:[0,0] op_sel_hi:[1,0]
    v_pk_fma_f32 v[190:191], v[190:191], v[16:17], v[30:31] op_sel:[0,0,0] op_sel_hi:[1,0,1]
    v_cvt_pk_bf16_f32 v184, v184, v185
    v_cvt_pk_bf16_f32 v185, v186, v187
    v_cvt_pk_bf16_f32 v186, v188, v189
    v_cvt_pk_bf16_f32 v187, v190, v191
    buffer_store_dwordx4 v[184:187], v4, s[12:15], s55 offen offset:3072 sc1
    s_waitcnt vmcnt(15)
    v_lshlrev_b32 v24, 16, v64
    v_and_b32 v25, s59, v64
    v_pk_mul_f32 v[24:25], v[24:25], v[18:19] op_sel:[0,1] op_sel_hi:[1,1]
    v_pk_fma_f32 v[192:193], v[192:193], v[16:17], v[24:25] op_sel:[0,1,0] op_sel_hi:[1,1,1]
    v_lshlrev_b32 v26, 16, v65
    v_and_b32 v27, s59, v65
    v_pk_mul_f32 v[26:27], v[26:27], v[18:19] op_sel:[0,1] op_sel_hi:[1,1]
    v_pk_fma_f32 v[194:195], v[194:195], v[16:17], v[26:27] op_sel:[0,1,0] op_sel_hi:[1,1,1]
    v_lshlrev_b32 v28, 16, v66
    v_and_b32 v29, s59, v66
    v_pk_mul_f32 v[28:29], v[28:29], v[18:19] op_sel:[0,1] op_sel_hi:[1,1]
    v_pk_fma_f32 v[196:197], v[196:197], v[16:17], v[28:29] op_sel:[0,1,0] op_sel_hi:[1,1,1]
    v_lshlrev_b32 v30, 16, v67
    v_and_b32 v31, s59, v67
    v_pk_mul_f32 v[30:31], v[30:31], v[18:19] op_sel:[0,1] op_sel_hi:[1,1]
    v_pk_fma_f32 v[198:199], v[198:199], v[16:17], v[30:31] op_sel:[0,1,0] op_sel_hi:[1,1,1]
    v_cvt_pk_bf16_f32 v192, v192, v193
    v_cvt_pk_bf16_f32 v193, v194, v195
    v_cvt_pk_bf16_f32 v194, v196, v197
    v_cvt_pk_bf16_f32 v195, v198, v199
    buffer_store_dwordx4 v[192:195], v1, s[12:15], s56 offen offset:0 sc1
    s_waitcnt vmcnt(15)
    v_lshlrev_b32 v24, 16, v68
    v_and_b32 v25, s59, v68
    v_pk_mul_f32 v[24:25], v[24:25], v[18:19] op_sel:[0,1] op_sel_hi:[1,1]
    v_pk_fma_f32 v[200:201], v[200:201], v[16:17], v[24:25] op_sel:[0,1,0] op_sel_hi:[1,1,1]
    v_lshlrev_b32 v26, 16, v69
    v_and_b32 v27, s59, v69
    v_pk_mul_f32 v[26:27], v[26:27], v[18:19] op_sel:[0,1] op_sel_hi:[1,1]
    v_pk_fma_f32 v[202:203], v[202:203], v[16:17], v[26:27] op_sel:[0,1,0] op_sel_hi:[1,1,1]
    v_lshlrev_b32 v28, 16, v70
    v_and_b32 v29, s59, v70
    v_pk_mul_f32 v[28:29], v[28:29], v[18:19] op_sel:[0,1] op_sel_hi:[1,1]
    v_pk_fma_f32 v[204:205], v[204:205], v[16:17], v[28:29] op_sel:[0,1,0] op_sel_hi:[1,1,1]
    v_lshlrev_b32 v30, 16, v71
    v_and_b32 v31, s59, v71
    v_pk_mul_f32 v[30:31], v[30:31], v[18:19] op_sel:[0,1] op_sel_hi:[1,1]
    v_pk_fma_f32 v[206:207], v[206:207], v[16:17], v[30:31] op_sel:[0,1,0] op_sel_hi:[1,1,1]
    v_cvt_pk_bf16_f32 v200, v200, v201
    v_cvt_pk_bf16_f32 v201, v202, v203
    v_cvt_pk_bf16_f32 v202, v204, v205
    v_cvt_pk_bf16_f32 v203, v206, v207
    buffer_store_dwordx4 v[200:203], v1, s[12:15], s56 offen offset:1024 sc1
    s_waitcnt vmcnt(15)
    v_lshlrev_b32 v24, 16, v72
    v_and_b32 v25, s59, v72
    v_pk_mul_f32 v[24:25], v[24:25], v[18:19] op_sel:[0,1] op_sel_hi:[1,1]
    v_pk_fma_f32 v[208:209], v[208:209], v[16:17], v[24:25] op_sel:[0,1,0] op_sel_hi:[1,1,1]
    v_lshlrev_b32 v26, 16, v73
    v_and_b32 v27, s59, v73
    v_pk_mul_f32 v[26:27], v[26:27], v[18:19] op_sel:[0,1] op_sel_hi:[1,1]
    v_pk_fma_f32 v[210:211], v[210:211], v[16:17], v[26:27] op_sel:[0,1,0] op_sel_hi:[1,1,1]
    v_lshlrev_b32 v28, 16, v74
    v_and_b32 v29, s59, v74
    v_pk_mul_f32 v[28:29], v[28:29], v[18:19] op_sel:[0,1] op_sel_hi:[1,1]
    v_pk_fma_f32 v[212:213], v[212:213], v[16:17], v[28:29] op_sel:[0,1,0] op_sel_hi:[1,1,1]
    v_lshlrev_b32 v30, 16, v75
    v_and_b32 v31, s59, v75
    v_pk_mul_f32 v[30:31], v[30:31], v[18:19] op_sel:[0,1] op_sel_hi:[1,1]
    v_pk_fma_f32 v[214:215], v[214:215], v[16:17], v[30:31] op_sel:[0,1,0] op_sel_hi:[1,1,1]
    v_cvt_pk_bf16_f32 v208, v208, v209
    v_cvt_pk_bf16_f32 v209, v210, v211
    v_cvt_pk_bf16_f32 v210, v212, v213
    v_cvt_pk_bf16_f32 v211, v214, v215
    buffer_store_dwordx4 v[208:211], v1, s[12:15], s56 offen offset:2048 sc1
    s_waitcnt vmcnt(15)
    v_lshlrev_b32 v24, 16, v76
    v_and_b32 v25, s59, v76
    v_pk_mul_f32 v[24:25], v[24:25], v[18:19] op_sel:[0,1] op_sel_hi:[1,1]
    v_pk_fma_f32 v[216:217], v[216:217], v[16:17], v[24:25] op_sel:[0,1,0] op_sel_hi:[1,1,1]
    v_lshlrev_b32 v26, 16, v77
    v_and_b32 v27, s59, v77
    v_pk_mul_f32 v[26:27], v[26:27], v[18:19] op_sel:[0,1] op_sel_hi:[1,1]
    v_pk_fma_f32 v[218:219], v[218:219], v[16:17], v[26:27] op_sel:[0,1,0] op_sel_hi:[1,1,1]
    v_lshlrev_b32 v28, 16, v78
    v_and_b32 v29, s59, v78
    v_pk_mul_f32 v[28:29], v[28:29], v[18:19] op_sel:[0,1] op_sel_hi:[1,1]
    v_pk_fma_f32 v[220:221], v[220:221], v[16:17], v[28:29] op_sel:[0,1,0] op_sel_hi:[1,1,1]
    v_lshlrev_b32 v30, 16, v79
    v_and_b32 v31, s59, v79
    v_pk_mul_f32 v[30:31], v[30:31], v[18:19] op_sel:[0,1] op_sel_hi:[1,1]
    v_pk_fma_f32 v[222:223], v[222:223], v[16:17], v[30:31] op_sel:[0,1,0] op_sel_hi:[1,1,1]
    v_cvt_pk_bf16_f32 v216, v216, v217
    v_cvt_pk_bf16_f32 v217, v218, v219
    v_cvt_pk_bf16_f32 v218, v220, v221
    v_cvt_pk_bf16_f32 v219, v222, v223
    buffer_store_dwordx4 v[216:219], v1, s[12:15], s56 offen offset:3072 sc1
    s_waitcnt vmcnt(15)
    v_lshlrev_b32 v24, 16, v80
    v_and_b32 v25, s59, v80
    v_pk_mul_f32 v[24:25], v[24:25], v[18:19] op_sel:[0,1] op_sel_hi:[1,1]
    v_pk_fma_f32 v[224:225], v[224:225], v[16:17], v[24:25] op_sel:[0,1,0] op_sel_hi:[1,1,1]
    v_lshlrev_b32 v26, 16, v81
    v_and_b32 v27, s59, v81
    v_pk_mul_f32 v[26:27], v[26:27], v[18:19] op_sel:[0,1] op_sel_hi:[1,1]
    v_pk_fma_f32 v[226:227], v[226:227], v[16:17], v[26:27] op_sel:[0,1,0] op_sel_hi:[1,1,1]
    v_lshlrev_b32 v28, 16, v82
    v_and_b32 v29, s59, v82
    v_pk_mul_f32 v[28:29], v[28:29], v[18:19] op_sel:[0,1] op_sel_hi:[1,1]
    v_pk_fma_f32 v[228:229], v[228:229], v[16:17], v[28:29] op_sel:[0,1,0] op_sel_hi:[1,1,1]
    v_lshlrev_b32 v30, 16, v83
    v_and_b32 v31, s59, v83
    v_pk_mul_f32 v[30:31], v[30:31], v[18:19] op_sel:[0,1] op_sel_hi:[1,1]
    v_pk_fma_f32 v[230:231], v[230:231], v[16:17], v[30:31] op_sel:[0,1,0] op_sel_hi:[1,1,1]
    v_cvt_pk_bf16_f32 v224, v224, v225
    v_cvt_pk_bf16_f32 v225, v226, v227
    v_cvt_pk_bf16_f32 v226, v228, v229
    v_cvt_pk_bf16_f32 v227, v230, v231
    buffer_store_dwordx4 v[224:227], v4, s[12:15], s56 offen offset:0 sc1
    s_waitcnt vmcnt(15)
    v_lshlrev_b32 v24, 16, v84
    v_and_b32 v25, s59, v84
    v_pk_mul_f32 v[24:25], v[24:25], v[18:19] op_sel:[0,1] op_sel_hi:[1,1]
    v_pk_fma_f32 v[232:233], v[232:233], v[16:17], v[24:25] op_sel:[0,1,0] op_sel_hi:[1,1,1]
    v_lshlrev_b32 v26, 16, v85
    v_and_b32 v27, s59, v85
    v_pk_mul_f32 v[26:27], v[26:27], v[18:19] op_sel:[0,1] op_sel_hi:[1,1]
    v_pk_fma_f32 v[234:235], v[234:235], v[16:17], v[26:27] op_sel:[0,1,0] op_sel_hi:[1,1,1]
    v_lshlrev_b32 v28, 16, v86
    v_and_b32 v29, s59, v86
    v_pk_mul_f32 v[28:29], v[28:29], v[18:19] op_sel:[0,1] op_sel_hi:[1,1]
    v_pk_fma_f32 v[236:237], v[236:237], v[16:17], v[28:29] op_sel:[0,1,0] op_sel_hi:[1,1,1]
    v_lshlrev_b32 v30, 16, v87
    v_and_b32 v31, s59, v87
    v_pk_mul_f32 v[30:31], v[30:31], v[18:19] op_sel:[0,1] op_sel_hi:[1,1]
    v_pk_fma_f32 v[238:239], v[238:239], v[16:17], v[30:31] op_sel:[0,1,0] op_sel_hi:[1,1,1]
    v_cvt_pk_bf16_f32 v232, v232, v233
    v_cvt_pk_bf16_f32 v233, v234, v235
    v_cvt_pk_bf16_f32 v234, v236, v237
    v_cvt_pk_bf16_f32 v235, v238, v239
    buffer_store_dwordx4 v[232:235], v4, s[12:15], s56 offen offset:1024 sc1
    s_waitcnt vmcnt(15)
    v_lshlrev_b32 v24, 16, v88
    v_and_b32 v25, s59, v88
    v_pk_mul_f32 v[24:25], v[24:25], v[18:19] op_sel:[0,1] op_sel_hi:[1,1]
    v_pk_fma_f32 v[240:241], v[240:241], v[16:17], v[24:25] op_sel:[0,1,0] op_sel_hi:[1,1,1]
    v_lshlrev_b32 v26, 16, v89
    v_and_b32 v27, s59, v89
    v_pk_mul_f32 v[26:27], v[26:27], v[18:19] op_sel:[0,1] op_sel_hi:[1,1]
    v_pk_fma_f32 v[242:243], v[242:243], v[16:17], v[26:27] op_sel:[0,1,0] op_sel_hi:[1,1,1]
    v_lshlrev_b32 v28, 16, v90
    v_and_b32 v29, s59, v90
    v_pk_mul_f32 v[28:29], v[28:29], v[18:19] op_sel:[0,1] op_sel_hi:[1,1]
    v_pk_fma_f32 v[244:245], v[244:245], v[16:17], v[28:29] op_sel:[0,1,0] op_sel_hi:[1,1,1]
    v_lshlrev_b32 v30, 16, v91
    v_and_b32 v31, s59, v91
    v_pk_mul_f32 v[30:31], v[30:31], v[18:19] op_sel:[0,1] op_sel_hi:[1,1]
    v_pk_fma_f32 v[246:247], v[246:247], v[16:17], v[30:31] op_sel:[0,1,0] op_sel_hi:[1,1,1]
    v_cvt_pk_bf16_f32 v240, v240, v241
    v_cvt_pk_bf16_f32 v241, v242, v243
    v_cvt_pk_bf16_f32 v242, v244, v245
    v_cvt_pk_bf16_f32 v243, v246, v247
    buffer_store_dwordx4 v[240:243], v4, s[12:15], s56 offen offset:2048 sc1
    s_waitcnt vmcnt(15)
    v_lshlrev_b32 v24, 16, v92
    v_and_b32 v25, s59, v92
    v_pk_mul_f32 v[24:25], v[24:25], v[18:19] op_sel:[0,1] op_sel_hi:[1,1]
    v_pk_fma_f32 v[248:249], v[248:249], v[16:17], v[24:25] op_sel:[0,1,0] op_sel_hi:[1,1,1]
    v_lshlrev_b32 v26, 16, v93
    v_and_b32 v27, s59, v93
    v_pk_mul_f32 v[26:27], v[26:27], v[18:19] op_sel:[0,1] op_sel_hi:[1,1]
    v_pk_fma_f32 v[250:251], v[250:251], v[16:17], v[26:27] op_sel:[0,1,0] op_sel_hi:[1,1,1]
    v_lshlrev_b32 v28, 16, v94
    v_and_b32 v29, s59, v94
    v_pk_mul_f32 v[28:29], v[28:29], v[18:19] op_sel:[0,1] op_sel_hi:[1,1]
    v_pk_fma_f32 v[252:253], v[252:253], v[16:17], v[28:29] op_sel:[0,1,0] op_sel_hi:[1,1,1]
    v_lshlrev_b32 v30, 16, v95
    v_and_b32 v31, s59, v95
    v_pk_mul_f32 v[30:31], v[30:31], v[18:19] op_sel:[0,1] op_sel_hi:[1,1]
    v_pk_fma_f32 v[254:255], v[254:255], v[16:17], v[30:31] op_sel:[0,1,0] op_sel_hi:[1,1,1]
    v_cvt_pk_bf16_f32 v248, v248, v249
    v_cvt_pk_bf16_f32 v249, v250, v251
    v_cvt_pk_bf16_f32 v250, v252, v253
    v_cvt_pk_bf16_f32 v251, v254, v255
    buffer_store_dwordx4 v[248:251], v4, s[12:15], s56 offen offset:3072 sc1
    s_branch L_pubctx
L_store:
    s_lshl_b32 s55, s51, 20
    s_lshl_b32 s57, s3, 17
    s_add_u32 s55, s55, s57
    s_lshl_b32 s57, s26, 13
    s_add_u32 s55, s55, s57
    s_add_u32 s55, s55, 50331648
    s_add_u32 s56, s55, 0x80000
    v_pk_mul_f32 v[128:129], v[128:129], v[16:17] op_sel:[0,0] op_sel_hi:[1,0]
    v_pk_mul_f32 v[130:131], v[130:131], v[16:17] op_sel:[0,0] op_sel_hi:[1,0]
    v_pk_mul_f32 v[132:133], v[132:133], v[16:17] op_sel:[0,0] op_sel_hi:[1,0]
    v_pk_mul_f32 v[134:135], v[134:135], v[16:17] op_sel:[0,0] op_sel_hi:[1,0]
    v_cvt_pk_bf16_f32 v128, v128, v129
    v_cvt_pk_bf16_f32 v129, v130, v131
    v_cvt_pk_bf16_f32 v130, v132, v133
    v_cvt_pk_bf16_f32 v131, v134, v135
    buffer_store_dwordx4 v[128:131], v1, s[12:15], s55 offen offset:0 sc1
    v_pk_mul_f32 v[136:137], v[136:137], v[16:17] op_sel:[0,0] op_sel_hi:[1,0]
    v_pk_mul_f32 v[138:139], v[138:139], v[16:17] op_sel:[0,0] op_sel_hi:[1,0]
    v_pk_mul_f32 v[140:141], v[140:141], v[16:17] op_sel:[0,0] op_sel_hi:[1,0]
    v_pk_mul_f32 v[142:143], v[142:143], v[16:17] op_sel:[0,0] op_sel_hi:[1,0]
    v_cvt_pk_bf16_f32 v136, v136, v137
    v_cvt_pk_bf16_f32 v137, v138, v139
    v_cvt_pk_bf16_f32 v138, v140, v141
    v_cvt_pk_bf16_f32 v139, v142, v143
    buffer_store_dwordx4 v[136:139], v1, s[12:15], s55 offen offset:1024 sc1
    v_pk_mul_f32 v[144:145], v[144:145], v[16:17] op_sel:[0,0] op_sel_hi:[1,0]
    v_pk_mul_f32 v[146:147], v[146:147], v[16:17] op_sel:[0,0] op_sel_hi:[1,0]
    v_pk_mul_f32 v[148:149], v[148:149], v[16:17] op_sel:[0,0] op_sel_hi:[1,0]
    v_pk_mul_f32 v[150:151], v[150:151], v[16:17] op_sel:[0,0] op_sel_hi:[1,0]
    v_cvt_pk_bf16_f32 v144, v144, v145
    v_cvt_pk_bf16_f32 v145, v146, v147
    v_cvt_pk_bf16_f32 v146, v148, v149
    v_cvt_pk_bf16_f32 v147, v150, v151
    buffer_store_dwordx4 v[144:147], v1, s[12:15], s55 offen offset:2048 sc1
    v_pk_mul_f32 v[152:153], v[152:153], v[16:17] op_sel:[0,0] op_sel_hi:[1,0]
    v_pk_mul_f32 v[154:155], v[154:155], v[16:17] op_sel:[0,0] op_sel_hi:[1,0]
    v_pk_mul_f32 v[156:157], v[156:157], v[16:17] op_sel:[0,0] op_sel_hi:[1,0]
    v_pk_mul_f32 v[158:159], v[158:159], v[16:17] op_sel:[0,0] op_sel_hi:[1,0]
    v_cvt_pk_bf16_f32 v152, v152, v153
    v_cvt_pk_bf16_f32 v153, v154, v155
    v_cvt_pk_bf16_f32 v154, v156, v157
    v_cvt_pk_bf16_f32 v155, v158, v159
    buffer_store_dwordx4 v[152:155], v1, s[12:15], s55 offen offset:3072 sc1
    v_pk_mul_f32 v[160:161], v[160:161], v[16:17] op_sel:[0,0] op_sel_hi:[1,0]
    v_pk_mul_f32 v[162:163], v[162:163], v[16:17] op_sel:[0,0] op_sel_hi:[1,0]
    v_pk_mul_f32 v[164:165], v[164:165], v[16:17] op_sel:[0,0] op_sel_hi:[1,0]
    v_pk_mul_f32 v[166:167], v[166:167], v[16:17] op_sel:[0,0] op_sel_hi:[1,0]
    v_cvt_pk_bf16_f32 v160, v160, v161
    v_cvt_pk_bf16_f32 v161, v162, v163
    v_cvt_pk_bf16_f32 v162, v164, v165
    v_cvt_pk_bf16_f32 v163, v166, v167
    buffer_store_dwordx4 v[160:163], v4, s[12:15], s55 offen offset:0 sc1
    v_pk_mul_f32 v[168:169], v[168:169], v[16:17] op_sel:[0,0] op_sel_hi:[1,0]
    v_pk_mul_f32 v[170:171], v[170:171], v[16:17] op_sel:[0,0] op_sel_hi:[1,0]
    v_pk_mul_f32 v[172:173], v[172:173], v[16:17] op_sel:[0,0] op_sel_hi:[1,0]
    v_pk_mul_f32 v[174:175], v[174:175], v[16:17] op_sel:[0,0] op_sel_hi:[1,0]
    v_cvt_pk_bf16_f32 v168, v168, v169
    v_cvt_pk_bf16_f32 v169, v170, v171
    v_cvt_pk_bf16_f32 v170, v172, v173
    v_cvt_pk_bf16_f32 v171, v174, v175
    buffer_store_dwordx4 v[168:171], v4, s[12:15], s55 offen offset:1024 sc1
    v_pk_mul_f32 v[176:177], v[176:177], v[16:17] op_sel:[0,0] op_sel_hi:[1,0]
    v_pk_mul_f32 v[178:179], v[178:179], v[16:17] op_sel:[0,0] op_sel_hi:[1,0]
    v_pk_mul_f32 v[180:181], v[180:181], v[16:17] op_sel:[0,0] op_sel_hi:[1,0]
    v_pk_mul_f32 v[182:183], v[182:183], v[16:17] op_sel:[0,0] op_sel_hi:[1,0]
    v_cvt_pk_bf16_f32 v176, v176, v177
    v_cvt_pk_bf16_f32 v177, v178, v179
    v_cvt_pk_bf16_f32 v178, v180, v181
    v_cvt_pk_bf16_f32 v179, v182, v183
    buffer_store_dwordx4 v[176:179], v4, s[12:15], s55 offen offset:2048 sc1
    v_pk_mul_f32 v[184:185], v[184:185], v[16:17] op_sel:[0,0] op_sel_hi:[1,0]
    v_pk_mul_f32 v[186:187], v[186:187], v[16:17] op_sel:[0,0] op_sel_hi:[1,0]
    v_pk_mul_f32 v[188:189], v[188:189], v[16:17] op_sel:[0,0] op_sel_hi:[1,0]
    v_pk_mul_f32 v[190:191], v[190:191], v[16:17] op_sel:[0,0] op_sel_hi:[1,0]
    v_cvt_pk_bf16_f32 v184, v184, v185
    v_cvt_pk_bf16_f32 v185, v186, v187
    v_cvt_pk_bf16_f32 v186, v188, v189
    v_cvt_pk_bf16_f32 v187, v190, v191
    buffer_store_dwordx4 v[184:187], v4, s[12:15], s55 offen offset:3072 sc1
    v_pk_mul_f32 v[192:193], v[192:193], v[16:17] op_sel:[0,1] op_sel_hi:[1,1]
    v_pk_mul_f32 v[194:195], v[194:195], v[16:17] op_sel:[0,1] op_sel_hi:[1,1]
    v_pk_mul_f32 v[196:197], v[196:197], v[16:17] op_sel:[0,1] op_sel_hi:[1,1]
    v_pk_mul_f32 v[198:199], v[198:199], v[16:17] op_sel:[0,1] op_sel_hi:[1,1]
    v_cvt_pk_bf16_f32 v192, v192, v193
    v_cvt_pk_bf16_f32 v193, v194, v195
    v_cvt_pk_bf16_f32 v194, v196, v197
    v_cvt_pk_bf16_f32 v195, v198, v199
    buffer_store_dwordx4 v[192:195], v1, s[12:15], s56 offen offset:0 sc1
    v_pk_mul_f32 v[200:201], v[200:201], v[16:17] op_sel:[0,1] op_sel_hi:[1,1]
    v_pk_mul_f32 v[202:203], v[202:203], v[16:17] op_sel:[0,1] op_sel_hi:[1,1]
    v_pk_mul_f32 v[204:205], v[204:205], v[16:17] op_sel:[0,1] op_sel_hi:[1,1]
    v_pk_mul_f32 v[206:207], v[206:207], v[16:17] op_sel:[0,1] op_sel_hi:[1,1]
    v_cvt_pk_bf16_f32 v200, v200, v201
    v_cvt_pk_bf16_f32 v201, v202, v203
    v_cvt_pk_bf16_f32 v202, v204, v205
    v_cvt_pk_bf16_f32 v203, v206, v207
    buffer_store_dwordx4 v[200:203], v1, s[12:15], s56 offen offset:1024 sc1
    v_pk_mul_f32 v[208:209], v[208:209], v[16:17] op_sel:[0,1] op_sel_hi:[1,1]
    v_pk_mul_f32 v[210:211], v[210:211], v[16:17] op_sel:[0,1] op_sel_hi:[1,1]
    v_pk_mul_f32 v[212:213], v[212:213], v[16:17] op_sel:[0,1] op_sel_hi:[1,1]
    v_pk_mul_f32 v[214:215], v[214:215], v[16:17] op_sel:[0,1] op_sel_hi:[1,1]
    v_cvt_pk_bf16_f32 v208, v208, v209
    v_cvt_pk_bf16_f32 v209, v210, v211
    v_cvt_pk_bf16_f32 v210, v212, v213
    v_cvt_pk_bf16_f32 v211, v214, v215
    buffer_store_dwordx4 v[208:211], v1, s[12:15], s56 offen offset:2048 sc1
    v_pk_mul_f32 v[216:217], v[216:217], v[16:17] op_sel:[0,1] op_sel_hi:[1,1]
    v_pk_mul_f32 v[218:219], v[218:219], v[16:17] op_sel:[0,1] op_sel_hi:[1,1]
    v_pk_mul_f32 v[220:221], v[220:221], v[16:17] op_sel:[0,1] op_sel_hi:[1,1]
    v_pk_mul_f32 v[222:223], v[222:223], v[16:17] op_sel:[0,1] op_sel_hi:[1,1]
    v_cvt_pk_bf16_f32 v216, v216, v217
    v_cvt_pk_bf16_f32 v217, v218, v219
    v_cvt_pk_bf16_f32 v218, v220, v221
    v_cvt_pk_bf16_f32 v219, v222, v223
    buffer_store_dwordx4 v[216:219], v1, s[12:15], s56 offen offset:3072 sc1
    v_pk_mul_f32 v[224:225], v[224:225], v[16:17] op_sel:[0,1] op_sel_hi:[1,1]
    v_pk_mul_f32 v[226:227], v[226:227], v[16:17] op_sel:[0,1] op_sel_hi:[1,1]
    v_pk_mul_f32 v[228:229], v[228:229], v[16:17] op_sel:[0,1] op_sel_hi:[1,1]
    v_pk_mul_f32 v[230:231], v[230:231], v[16:17] op_sel:[0,1] op_sel_hi:[1,1]
    v_cvt_pk_bf16_f32 v224, v224, v225
    v_cvt_pk_bf16_f32 v225, v226, v227
    v_cvt_pk_bf16_f32 v226, v228, v229
    v_cvt_pk_bf16_f32 v227, v230, v231
    buffer_store_dwordx4 v[224:227], v4, s[12:15], s56 offen offset:0 sc1
    v_pk_mul_f32 v[232:233], v[232:233], v[16:17] op_sel:[0,1] op_sel_hi:[1,1]
    v_pk_mul_f32 v[234:235], v[234:235], v[16:17] op_sel:[0,1] op_sel_hi:[1,1]
    v_pk_mul_f32 v[236:237], v[236:237], v[16:17] op_sel:[0,1] op_sel_hi:[1,1]
    v_pk_mul_f32 v[238:239], v[238:239], v[16:17] op_sel:[0,1] op_sel_hi:[1,1]
    v_cvt_pk_bf16_f32 v232, v232, v233
    v_cvt_pk_bf16_f32 v233, v234, v235
    v_cvt_pk_bf16_f32 v234, v236, v237
    v_cvt_pk_bf16_f32 v235, v238, v239
    buffer_store_dwordx4 v[232:235], v4, s[12:15], s56 offen offset:1024 sc1
    v_pk_mul_f32 v[240:241], v[240:241], v[16:17] op_sel:[0,1] op_sel_hi:[1,1]
    v_pk_mul_f32 v[242:243], v[242:243], v[16:17] op_sel:[0,1] op_sel_hi:[1,1]
    v_pk_mul_f32 v[244:245], v[244:245], v[16:17] op_sel:[0,1] op_sel_hi:[1,1]
    v_pk_mul_f32 v[246:247], v[246:247], v[16:17] op_sel:[0,1] op_sel_hi:[1,1]
    v_cvt_pk_bf16_f32 v240, v240, v241
    v_cvt_pk_bf16_f32 v241, v242, v243
    v_cvt_pk_bf16_f32 v242, v244, v245
    v_cvt_pk_bf16_f32 v243, v246, v247
    buffer_store_dwordx4 v[240:243], v4, s[12:15], s56 offen offset:2048 sc1
    v_pk_mul_f32 v[248:249], v[248:249], v[16:17] op_sel:[0,1] op_sel_hi:[1,1]
    v_pk_mul_f32 v[250:251], v[250:251], v[16:17] op_sel:[0,1] op_sel_hi:[1,1]
    v_pk_mul_f32 v[252:253], v[252:253], v[16:17] op_sel:[0,1] op_sel_hi:[1,1]
    v_pk_mul_f32 v[254:255], v[254:255], v[16:17] op_sel:[0,1] op_sel_hi:[1,1]
    v_cvt_pk_bf16_f32 v248, v248, v249
    v_cvt_pk_bf16_f32 v249, v250, v251
    v_cvt_pk_bf16_f32 v250, v252, v253
    v_cvt_pk_bf16_f32 v251, v254, v255
    buffer_store_dwordx4 v[248:251], v4, s[12:15], s56 offen offset:3072 sc1
L_pubctx:
    s_waitcnt vmcnt(0)
    s_barrier
    s_cmp_lg_u32 s3, 0
    s_cbranch_scc1 L_pub5
    v_mov_b32 v11, 0
    v_mov_b32 v12, 1
    s_mov_b64 exec, 1
    buffer_store_dword v12, v11, s[12:15], s93 offen sc1
    s_mov_b64 exec, -1
L_pub5:
L_attdone:
    s_cmp_ge_u32 s28, 14
    s_cbranch_scc1 L_fin
    s_cmp_lg_u32 s27, 0
    s_cbranch_scc1 L_s2end
    s_lshr_b32 s33, s95, 4
    s_lshl_b32 s33, s33, 7
    s_add_u32 s33, s33, 84959232
    v_and_b32 v14, 31, v0
    v_lshlrev_b32 v14, 2, v14
    s_mov_b32 s32, 0
L_poll6:
    buffer_load_dword v15, v14, s[12:15], s33 offen sc1
    s_waitcnt vmcnt(0)
    v_cmp_ne_u32 vcc, 1, v15
    s_cbranch_vccz L_poll6_ok
    s_sleep 2
    s_add_u32 s32, s32, 1
    s_cmp_lt_u32 s32, 0x80000
    s_cbranch_scc1 L_poll6
L_poll6_ok:
    s_lshl_b32 s34, s95, 2
    s_add_u32 s34, s34, s3
    s_lshl_b32 s35, s34, 12
    s_add_u32 s36, s35, 85983232
    s_mul_i32 s37, s3, 38912
    s_lshr_b32 s38, s34, 1
    s_lshl_b32 s38, s38, 2
    s_load_dword s39, s[74:75], s38
    s_mov_b32 s4, s72
    s_mov_b32 s5, s73
    s_mov_b32 s6, 1835008
    s_mov_b32 s7, 0x20000
    v_lshlrev_b32 v1, 4, v0
    v_lshrrev_b32 v3, 1, v0
    v_lshlrev_b32 v3, 7, v3
    v_and_b32 v4, 1, v0
    v_lshl_add_u32 v3, v4, 4, v3
    s_add_u32 m0, s37, 29536
    s_nop 0
    buffer_load_dwordx4 v1, s[4:7], s35 offen offset:0 lds
    buffer_load_dwordx4 v1, s[4:7], s35 offen offset:1024 lds
    buffer_load_dwordx4 v1, s[4:7], s35 offen offset:2048 lds
    buffer_load_dwordx4 v1, s[4:7], s35 offen offset:3072 lds
    s_add_u32 m0, s37, 128
    s_nop 0
    buffer_load_dwordx4 v3, s[12:15], s36 offen offset:0 sc1 lds
    s_add_u32 m0, s37, 1248
    s_nop 0
    buffer_load_dwordx4 v3, s[12:15], s36 offen offset:32 sc1 lds
    s_add_u32 m0, s37, 2368
    s_nop 0
    buffer_load_dwordx4 v3, s[12:15], s36 offen offset:64 sc1 lds
    s_add_u32 m0, s37, 3488
    s_nop 0
    buffer_load_dwordx4 v3, s[12:15], s36 offen offset:96 sc1 lds
    v_mov_b32 v8, 0
    v_lshlrev_b32 v5, 2, v0
    v_add_u32 v5, s37, v5
    v_and_b32 v6, 31, v0
    v_lshlrev_b32 v6, 2, v6
    v_add_u32 v6, s37, v6
    ds_write_b32 v5, v8 offset:29280
    ds_write_b32 v6, v8 offset:0
    ds_write_b32 v6, v8 offset:1152
    ds_write_b32 v6, v8 offset:2304
    ds_write_b32 v6, v8 offset:3456
    ds_write_b32 v6, v8 offset:12832
    ds_write_b32 v6, v8 offset:21056
    v_and_b32 v14, 15, v0
    v_lshrrev_b32 v15, 4, v0
    v_lshlrev_b32 v9, 3, v14
    v_lshl_add_u32 v9, v15, 4, v9
    v_add_u32 v9, s37, v9
    v_and_b32 v10, 3, v0
    v_bfe_u32 v4, v0, 2, 2
    v_sub_u32 v10, v10, v4
    v_lshlrev_b32 v4, 3, v15
    v_sub_u32 v10, v10, v4
    v_add_u32 v10, 56, v10
    v_lshlrev_b32 v10, 3, v10
    v_add_u32 v10, s37, v10
    v_lshl_add_u32 v11, v15, 6, v14
    v_lshlrev_b32 v11, 2, v11
    v_add_u32 v11, s37, v11
    v_lshlrev_b32 v12, 5, v0
    v_add_u32 v12, s37, v12
    s_add_u32 s42, s35, 90177536
    s_mov_b32 s45, 0xffff0000
    s_waitcnt vmcnt(0) lgkmcnt(0)
    s_lshl_b32 s43, s39, 16
    s_and_b32 s44, s39, s45
    s_bitcmp1_b32 s3, 0
    s_cselect_b32 s43, s44, s43
    ds_read_b64_tr_b16 a[0:1], v10 offset:29312
    ds_read_b64_tr_b16 a[2:3], v10 offset:29280
    ds_read_b64 a[64:65], v9 offset:8
    ds_read_b64 a[66:67], v9 offset:16
    ds_read_b64_tr_b16 a[4:5], v10 offset:29568
    ds_read_b64_tr_b16 a[6:7], v10 offset:29536
    ds_read_b64 a[68:69], v9 offset:72
    ds_read_b64 a[70:71], v9 offset:80
    ds_read_b64_tr_b16 a[8:9], v10 offset:29824
    ds_read_b64_tr_b16 a[10:11], v10 offset:29792
    ds_read_b64 a[72:73], v9 offset:136
    ds_read_b64 a[74:75], v9 offset:144
    s_waitcnt lgkmcnt(4)
    ds_read_b64_tr_b16 a[12:13], v10 offset:30080
    ds_read_b64_tr_b16 a[14:15], v10 offset:30048
    ds_read_b64 a[76:77], v9 offset:200
    ds_read_b64 a[78:79], v9 offset:208
    ds_read_b64_tr_b16 a[16:17], v10 offset:30336
    ds_read_b64_tr_b16 a[18:19], v10 offset:30304
    ds_read_b64 a[80:81], v9 offset:264
    ds_read_b64 a[82:83], v9 offset:272
    ds_read_b64_tr_b16 a[20:21], v10 offset:30592
    ds_read_b64_tr_b16 a[22:23], v10 offset:30560
    ds_read_b64 a[84:85], v9 offset:328
    ds_read_b64 a[86:87], v9 offset:336
    s_waitcnt lgkmcnt(4)
    ds_read_b64_tr_b16 a[24:25], v10 offset:30848
    ds_read_b64_tr_b16 a[26:27], v10 offset:30816
    ds_read_b64 a[88:89], v9 offset:392
    ds_read_b64 a[90:91], v9 offset:400
    ds_read_b64_tr_b16 a[28:29], v10 offset:31104
    ds_read_b64_tr_b16 a[30:31], v10 offset:31072
    ds_read_b64 a[92:93], v9 offset:456
    ds_read_b64 a[94:95], v9 offset:464
    s_waitcnt lgkmcnt(0)
    v_mfma_f32_16x16x32_bf16 v[32:35], a[68:71], a[0:3], 0
    ds_read_b64_tr_b16 a[32:33], v10 offset:31360
    v_mfma_f32_16x16x32_bf16 v[32:35], a[64:67], a[4:7], v[32:35]
    ds_read_b64_tr_b16 a[34:35], v10 offset:31328
    v_mfma_f32_16x16x32_bf16 v[36:39], a[76:79], a[0:3], 0
    ds_read_b64 a[96:97], v9 offset:520
    v_mfma_f32_16x16x32_bf16 v[36:39], a[72:75], a[4:7], v[36:39]
    ds_read_b64 a[98:99], v9 offset:528
    v_mfma_f32_16x16x32_bf16 v[36:39], a[68:71], a[8:11], v[36:39]
    ds_read_b64_tr_b16 a[36:37], v10 offset:31616
    v_mfma_f32_16x16x32_bf16 v[36:39], a[64:67], a[12:15], v[36:39]
    ds_read_b64_tr_b16 a[38:39], v10 offset:31584
    v_mfma_f32_16x16x32_bf16 v[40:43], a[84:87], a[0:3], 0
    ds_read_b64 a[100:101], v9 offset:584
    v_mfma_f32_16x16x32_bf16 v[40:43], a[80:83], a[4:7], v[40:43]
    ds_read_b64 a[102:103], v9 offset:592
    v_mfma_f32_16x16x32_bf16 v[40:43], a[76:79], a[8:11], v[40:43]
    ds_read_b64_tr_b16 a[40:41], v10 offset:31872
    v_mfma_f32_16x16x32_bf16 v[40:43], a[72:75], a[12:15], v[40:43]
    ds_read_b64_tr_b16 a[42:43], v10 offset:31840
    v_mfma_f32_16x16x32_bf16 v[40:43], a[68:71], a[16:19], v[40:43]
    ds_read_b64 a[104:105], v9 offset:648
    v_mfma_f32_16x16x32_bf16 v[40:43], a[64:67], a[20:23], v[40:43]
    ds_read_b64 a[106:107], v9 offset:656
    v_mfma_f32_16x16x32_bf16 v[44:47], a[92:95], a[0:3], 0
    ds_read_b64_tr_b16 a[44:45], v10 offset:32128
    v_mfma_f32_16x16x32_bf16 v[44:47], a[88:91], a[4:7], v[44:47]
    ds_read_b64_tr_b16 a[46:47], v10 offset:32096
    v_mfma_f32_16x16x32_bf16 v[44:47], a[84:87], a[8:11], v[44:47]
    ds_read_b64 a[108:109], v9 offset:712
    v_mfma_f32_16x16x32_bf16 v[44:47], a[80:83], a[12:15], v[44:47]
    ds_read_b64 a[110:111], v9 offset:720
    v_mfma_f32_16x16x32_bf16 v[44:47], a[76:79], a[16:19], v[44:47]
    ds_read_b64_tr_b16 a[48:49], v10 offset:32384
    v_mfma_f32_16x16x32_bf16 v[44:47], a[72:75], a[20:23], v[44:47]
    ds_read_b64_tr_b16 a[50:51], v10 offset:32352
    v_mfma_f32_16x16x32_bf16 v[44:47], a[68:71], a[24:27], v[44:47]
    ds_read_b64 a[112:113], v9 offset:776
    v_mfma_f32_16x16x32_bf16 v[44:47], a[64:67], a[28:31], v[44:47]
    s_waitcnt lgkmcnt(11)
    ds_read_b64 a[114:115], v9 offset:784
    v_mfma_f32_16x16x32_bf16 v[48:51], a[100:103], a[0:3], 0
    ds_read_b64_tr_b16 a[52:53], v10 offset:32640
    v_mfma_f32_16x16x32_bf16 v[48:51], a[96:99], a[4:7], v[48:51]
    ds_read_b64_tr_b16 a[54:55], v10 offset:32608
    v_mfma_f32_16x16x32_bf16 v[48:51], a[92:95], a[8:11], v[48:51]
    ds_read_b64 a[116:117], v9 offset:840
    v_mfma_f32_16x16x32_bf16 v[48:51], a[88:91], a[12:15], v[48:51]
    ds_read_b64 a[118:119], v9 offset:848
    v_mfma_f32_16x16x32_bf16 v[48:51], a[84:87], a[16:19], v[48:51]
    ds_read_b64_tr_b16 a[56:57], v10 offset:32896
    v_mfma_f32_16x16x32_bf16 v[48:51], a[80:83], a[20:23], v[48:51]
    ds_read_b64_tr_b16 a[58:59], v10 offset:32864
    v_mfma_f32_16x16x32_bf16 v[48:51], a[76:79], a[24:27], v[48:51]
    ds_read_b64 a[120:121], v9 offset:904
    v_mfma_f32_16x16x32_bf16 v[48:51], a[72:75], a[28:31], v[48:51]
    ds_read_b64 a[122:123], v9 offset:912
    v_mfma_f32_16x16x32_bf16 v[48:51], a[68:71], a[32:35], v[48:51]
    ds_read_b64_tr_b16 a[60:61], v10 offset:33152
    v_mfma_f32_16x16x32_bf16 v[48:51], a[64:67], a[36:39], v[48:51]
    s_waitcnt lgkmcnt(13)
    ds_read_b64_tr_b16 a[62:63], v10 offset:33120
    v_mfma_f32_16x16x32_bf16 v[52:55], a[108:111], a[0:3], 0
    ds_read_b64 a[124:125], v9 offset:968
    v_mfma_f32_16x16x32_bf16 v[52:55], a[104:107], a[4:7], v[52:55]
    ds_read_b64 a[126:127], v9 offset:976
    v_mfma_f32_16x16x32_bf16 v[52:55], a[100:103], a[8:11], v[52:55]
    ds_read_b64 a[128:129], v9 offset:1160
    v_mfma_f32_16x16x32_bf16 v[52:55], a[96:99], a[12:15], v[52:55]
    ds_read_b64 a[130:131], v9 offset:1168
    v_mfma_f32_16x16x32_bf16 v[52:55], a[92:95], a[16:19], v[52:55]
    ds_read_b64 a[132:133], v9 offset:1224
    v_mfma_f32_16x16x32_bf16 v[52:55], a[88:91], a[20:23], v[52:55]
    ds_read_b64 a[134:135], v9 offset:1232
    v_mfma_f32_16x16x32_bf16 v[52:55], a[84:87], a[24:27], v[52:55]
    ds_read_b64 a[136:137], v9 offset:1288
    v_mfma_f32_16x16x32_bf16 v[52:55], a[80:83], a[28:31], v[52:55]
    ds_read_b64 a[138:139], v9 offset:1296
    v_mfma_f32_16x16x32_bf16 v[52:55], a[76:79], a[32:35], v[52:55]
    ds_read_b64 a[140:141], v9 offset:1352
    v_mfma_f32_16x16x32_bf16 v[52:55], a[72:75], a[36:39], v[52:55]
    ds_read_b64 a[142:143], v9 offset:1360
    v_mfma_f32_16x16x32_bf16 v[52:55], a[68:71], a[40:43], v[52:55]
    ds_read_b64 a[144:145], v9 offset:1416
    v_mfma_f32_16x16x32_bf16 v[52:55], a[64:67], a[44:47], v[52:55]
    s_waitcnt lgkmcnt(15)
    ds_read_b64 a[146:147], v9 offset:1424
    v_mfma_f32_16x16x32_bf16 v[56:59], a[116:119], a[0:3], 0
    ds_read_b64 a[148:149], v9 offset:1480
    v_mfma_f32_16x16x32_bf16 v[56:59], a[112:115], a[4:7], v[56:59]
    ds_read_b64 a[150:151], v9 offset:1488
    v_mfma_f32_16x16x32_bf16 v[56:59], a[108:111], a[8:11], v[56:59]
    ds_read_b64 a[152:153], v9 offset:1544
    v_mfma_f32_16x16x32_bf16 v[56:59], a[104:107], a[12:15], v[56:59]
    ds_read_b64 a[154:155], v9 offset:1552
    v_mfma_f32_16x16x32_bf16 v[56:59], a[100:103], a[16:19], v[56:59]
    ds_read_b64 a[156:157], v9 offset:1608
    v_mfma_f32_16x16x32_bf16 v[56:59], a[96:99], a[20:23], v[56:59]
    ds_read_b64 a[158:159], v9 offset:1616
    v_mfma_f32_16x16x32_bf16 v[56:59], a[92:95], a[24:27], v[56:59]
    ds_read_b64 a[160:161], v9 offset:1672
    v_mfma_f32_16x16x32_bf16 v[56:59], a[88:91], a[28:31], v[56:59]
    ds_read_b64 a[162:163], v9 offset:1680
    v_mfma_f32_16x16x32_bf16 v[56:59], a[84:87], a[32:35], v[56:59]
    ds_read_b64 a[164:165], v9 offset:1736
    v_mfma_f32_16x16x32_bf16 v[56:59], a[80:83], a[36:39], v[56:59]
    ds_read_b64 a[166:167], v9 offset:1744
    v_mfma_f32_16x16x32_bf16 v[56:59], a[76:79], a[40:43], v[56:59]
    ds_read_b64 a[168:169], v9 offset:1800
    v_mfma_f32_16x16x32_bf16 v[56:59], a[72:75], a[44:47], v[56:59]
    ds_read_b64 a[170:171], v9 offset:1808
    v_mfma_f32_16x16x32_bf16 v[56:59], a[68:71], a[48:51], v[56:59]
    ds_read_b64 a[172:173], v9 offset:1864
    v_mfma_f32_16x16x32_bf16 v[56:59], a[64:67], a[52:55], v[56:59]
    s_waitcnt lgkmcnt(15)
    ds_read_b64 a[174:175], v9 offset:1872
    v_mfma_f32_16x16x32_bf16 v[60:63], a[124:127], a[0:3], 0
    ds_read_b64 a[176:177], v9 offset:1928
    v_mfma_f32_16x16x32_bf16 v[60:63], a[120:123], a[4:7], v[60:63]
    ds_read_b64 a[178:179], v9 offset:1936
    v_mfma_f32_16x16x32_bf16 v[60:63], a[116:119], a[8:11], v[60:63]
    ds_read_b64 a[180:181], v9 offset:1992
    v_mfma_f32_16x16x32_bf16 v[60:63], a[112:115], a[12:15], v[60:63]
    ds_read_b64 a[182:183], v9 offset:2000
    v_mfma_f32_16x16x32_bf16 v[60:63], a[108:111], a[16:19], v[60:63]
    ds_read_b64 a[184:185], v9 offset:2056
    v_mfma_f32_16x16x32_bf16 v[60:63], a[104:107], a[20:23], v[60:63]
    ds_read_b64 a[186:187], v9 offset:2064
    v_mfma_f32_16x16x32_bf16 v[60:63], a[100:103], a[24:27], v[60:63]
    ds_read_b64 a[188:189], v9 offset:2120
    v_mfma_f32_16x16x32_bf16 v[60:63], a[96:99], a[28:31], v[60:63]
    ds_read_b64 a[190:191], v9 offset:2128
    v_mfma_f32_16x16x32_bf16 v[60:63], a[92:95], a[32:35], v[60:63]
    v_mfma_f32_16x16x32_bf16 v[60:63], a[88:91], a[36:39], v[60:63]
    ds_write_b32 v11, v32 offset:4608
    v_mfma_f32_16x16x32_bf16 v[60:63], a[84:87], a[40:43], v[60:63]
    ds_write_b32 v11, v33 offset:4672
    v_mfma_f32_16x16x32_bf16 v[60:63], a[80:83], a[44:47], v[60:63]
    ds_write_b32 v11, v34 offset:4736
    v_mfma_f32_16x16x32_bf16 v[60:63], a[76:79], a[48:51], v[60:63]
    ds_write_b32 v11, v35 offset:4800
    v_mfma_f32_16x16x32_bf16 v[60:63], a[72:75], a[52:55], v[60:63]
    ds_write_b32 v11, v36 offset:5632
    v_mfma_f32_16x16x32_bf16 v[60:63], a[68:71], a[56:59], v[60:63]
    ds_write_b32 v11, v37 offset:5696
    v_mfma_f32_16x16x32_bf16 v[60:63], a[64:67], a[60:63], v[60:63]
    ds_write_b32 v11, v38 offset:5760
    v_mfma_f32_16x16x32_bf16 v[64:67], a[132:135], a[0:3], 0
    ds_write_b32 v11, v39 offset:5824
    v_mfma_f32_16x16x32_bf16 v[64:67], a[128:131], a[4:7], v[64:67]
    ds_write_b32 v11, v40 offset:6656
    v_mfma_f32_16x16x32_bf16 v[68:71], a[140:143], a[0:3], 0
    ds_write_b32 v11, v41 offset:6720
    v_mfma_f32_16x16x32_bf16 v[68:71], a[136:139], a[4:7], v[68:71]
    ds_write_b32 v11, v42 offset:6784
    v_mfma_f32_16x16x32_bf16 v[68:71], a[132:135], a[8:11], v[68:71]
    ds_write_b32 v11, v43 offset:6848
    v_mfma_f32_16x16x32_bf16 v[68:71], a[128:131], a[12:15], v[68:71]
    s_waitcnt lgkmcnt(15)
    ds_write_b32 v11, v44 offset:7680
    v_mfma_f32_16x16x32_bf16 v[72:75], a[148:151], a[0:3], 0
    ds_write_b32 v11, v45 offset:7744
    v_mfma_f32_16x16x32_bf16 v[72:75], a[144:147], a[4:7], v[72:75]
    ds_write_b32 v11, v46 offset:7808
    v_mfma_f32_16x16x32_bf16 v[72:75], a[140:143], a[8:11], v[72:75]
    ds_write_b32 v11, v47 offset:7872
    v_mfma_f32_16x16x32_bf16 v[72:75], a[136:139], a[12:15], v[72:75]
    ds_write_b32 v11, v48 offset:8704
    v_mfma_f32_16x16x32_bf16 v[72:75], a[132:135], a[16:19], v[72:75]
    ds_write_b32 v11, v49 offset:8768
    v_mfma_f32_16x16x32_bf16 v[72:75], a[128:131], a[20:23], v[72:75]
    ds_write_b32 v11, v50 offset:8832
    v_mfma_f32_16x16x32_bf16 v[76:79], a[156:159], a[0:3], 0
    ds_write_b32 v11, v51 offset:8896
    v_mfma_f32_16x16x32_bf16 v[76:79], a[152:155], a[4:7], v[76:79]
    ds_write_b32 v11, v52 offset:9728
    v_mfma_f32_16x16x32_bf16 v[76:79], a[148:151], a[8:11], v[76:79]
    ds_write_b32 v11, v53 offset:9792
    v_mfma_f32_16x16x32_bf16 v[76:79], a[144:147], a[12:15], v[76:79]
    ds_write_b32 v11, v54 offset:9856
    v_mfma_f32_16x16x32_bf16 v[76:79], a[140:143], a[16:19], v[76:79]
    ds_write_b32 v11, v55 offset:9920
    v_mfma_f32_16x16x32_bf16 v[76:79], a[136:139], a[20:23], v[76:79]
    ds_write_b32 v11, v56 offset:10752
    v_mfma_f32_16x16x32_bf16 v[76:79], a[132:135], a[24:27], v[76:79]
    ds_write_b32 v11, v57 offset:10816
    v_mfma_f32_16x16x32_bf16 v[76:79], a[128:131], a[28:31], v[76:79]
    ds_write_b32 v11, v58 offset:10880
    v_mfma_f32_16x16x32_bf16 v[80:83], a[164:167], a[0:3], 0
    ds_write_b32 v11, v59 offset:10944
    v_mfma_f32_16x16x32_bf16 v[80:83], a[160:163], a[4:7], v[80:83]
    ds_write_b32 v11, v60 offset:11776
    v_mfma_f32_16x16x32_bf16 v[80:83], a[156:159], a[8:11], v[80:83]
    ds_write_b32 v11, v61 offset:11840
    v_mfma_f32_16x16x32_bf16 v[80:83], a[152:155], a[12:15], v[80:83]
    ds_write_b32 v11, v62 offset:11904
    v_mfma_f32_16x16x32_bf16 v[80:83], a[148:151], a[16:19], v[80:83]
    ds_write_b32 v11, v63 offset:11968
    v_mfma_f32_16x16x32_bf16 v[80:83], a[144:147], a[20:23], v[80:83]
    ds_write_b32 v11, v64 offset:12836
    v_mfma_f32_16x16x32_bf16 v[80:83], a[140:143], a[24:27], v[80:83]
    ds_write_b32 v11, v65 offset:12900
    v_mfma_f32_16x16x32_bf16 v[80:83], a[136:139], a[28:31], v[80:83]
    ds_write_b32 v11, v66 offset:12964
    v_mfma_f32_16x16x32_bf16 v[80:83], a[132:135], a[32:35], v[80:83]
    ds_write_b32 v11, v67 offset:13028
    v_mfma_f32_16x16x32_bf16 v[80:83], a[128:131], a[36:39], v[80:83]
    ds_write_b32 v11, v68 offset:13860
    v_mfma_f32_16x16x32_bf16 v[84:87], a[172:175], a[0:3], 0
    ds_write_b32 v11, v69 offset:13924
    v_mfma_f32_16x16x32_bf16 v[84:87], a[168:171], a[4:7], v[84:87]
    ds_read_b64 a[64:65], v9 offset:2312
    v_mfma_f32_16x16x32_bf16 v[84:87], a[164:167], a[8:11], v[84:87]
    ds_read_b64 a[66:67], v9 offset:2320
    v_mfma_f32_16x16x32_bf16 v[84:87], a[160:163], a[12:15], v[84:87]
    ds_read_b64 a[68:69], v9 offset:2376
    v_mfma_f32_16x16x32_bf16 v[84:87], a[156:159], a[16:19], v[84:87]
    ds_read_b64 a[70:71], v9 offset:2384
    v_mfma_f32_16x16x32_bf16 v[84:87], a[152:155], a[20:23], v[84:87]
    ds_read_b64 a[72:73], v9 offset:2440
    v_mfma_f32_16x16x32_bf16 v[84:87], a[148:151], a[24:27], v[84:87]
    ds_read_b64 a[74:75], v9 offset:2448
    v_mfma_f32_16x16x32_bf16 v[84:87], a[144:147], a[28:31], v[84:87]
    ds_read_b64 a[76:77], v9 offset:2504
    v_mfma_f32_16x16x32_bf16 v[84:87], a[140:143], a[32:35], v[84:87]
    ds_read_b64 a[78:79], v9 offset:2512
    v_mfma_f32_16x16x32_bf16 v[84:87], a[136:139], a[36:39], v[84:87]
    ds_read_b64 a[80:81], v9 offset:2568
    v_mfma_f32_16x16x32_bf16 v[84:87], a[132:135], a[40:43], v[84:87]
    ds_read_b64 a[82:83], v9 offset:2576
    v_mfma_f32_16x16x32_bf16 v[84:87], a[128:131], a[44:47], v[84:87]
    ds_read_b64 a[84:85], v9 offset:2632
    v_mfma_f32_16x16x32_bf16 v[88:91], a[180:183], a[0:3], 0
    ds_read_b64 a[86:87], v9 offset:2640
    v_mfma_f32_16x16x32_bf16 v[88:91], a[176:179], a[4:7], v[88:91]
    ds_read_b64 a[88:89], v9 offset:2696
    v_mfma_f32_16x16x32_bf16 v[88:91], a[172:175], a[8:11], v[88:91]
    ds_read_b64 a[90:91], v9 offset:2704
    v_mfma_f32_16x16x32_bf16 v[88:91], a[168:171], a[12:15], v[88:91]
    ds_read_b64 a[92:93], v9 offset:2760
    v_mfma_f32_16x16x32_bf16 v[88:91], a[164:167], a[16:19], v[88:91]
    ds_read_b64 a[94:95], v9 offset:2768
    v_mfma_f32_16x16x32_bf16 v[88:91], a[160:163], a[20:23], v[88:91]
    ds_read_b64 a[96:97], v9 offset:2824
    v_mfma_f32_16x16x32_bf16 v[88:91], a[156:159], a[24:27], v[88:91]
    ds_read_b64 a[98:99], v9 offset:2832
    v_mfma_f32_16x16x32_bf16 v[88:91], a[152:155], a[28:31], v[88:91]
    ds_read_b64 a[100:101], v9 offset:2888
    v_mfma_f32_16x16x32_bf16 v[88:91], a[148:151], a[32:35], v[88:91]
    ds_read_b64 a[102:103], v9 offset:2896
    v_mfma_f32_16x16x32_bf16 v[88:91], a[144:147], a[36:39], v[88:91]
    ds_read_b64 a[104:105], v9 offset:2952
    v_mfma_f32_16x16x32_bf16 v[88:91], a[140:143], a[40:43], v[88:91]
    ds_read_b64 a[106:107], v9 offset:2960
    v_mfma_f32_16x16x32_bf16 v[88:91], a[136:139], a[44:47], v[88:91]
    ds_read_b64 a[108:109], v9 offset:3016
    v_mfma_f32_16x16x32_bf16 v[88:91], a[132:135], a[48:51], v[88:91]
    ds_read_b64 a[110:111], v9 offset:3024
    v_mfma_f32_16x16x32_bf16 v[88:91], a[128:131], a[52:55], v[88:91]
    s_waitcnt lgkmcnt(15)
    ds_read_b64 a[112:113], v9 offset:3080
    v_mfma_f32_16x16x32_bf16 v[92:95], a[188:191], a[0:3], 0
    ds_read_b64 a[114:115], v9 offset:3088
    v_mfma_f32_16x16x32_bf16 v[92:95], a[184:187], a[4:7], v[92:95]
    ds_read_b64 a[116:117], v9 offset:3144
    v_mfma_f32_16x16x32_bf16 v[92:95], a[180:183], a[8:11], v[92:95]
    ds_read_b64 a[118:119], v9 offset:3152
    v_mfma_f32_16x16x32_bf16 v[92:95], a[176:179], a[12:15], v[92:95]
    ds_read_b64 a[120:121], v9 offset:3208
    v_mfma_f32_16x16x32_bf16 v[92:95], a[172:175], a[16:19], v[92:95]
    ds_read_b64 a[122:123], v9 offset:3216
    v_mfma_f32_16x16x32_bf16 v[92:95], a[168:171], a[20:23], v[92:95]
    ds_read_b64 a[124:125], v9 offset:3272
    v_mfma_f32_16x16x32_bf16 v[92:95], a[164:167], a[24:27], v[92:95]
    ds_read_b64 a[126:127], v9 offset:3280
    v_mfma_f32_16x16x32_bf16 v[92:95], a[160:163], a[28:31], v[92:95]
    ds_write_b32 v11, v70 offset:13988
    v_mfma_f32_16x16x32_bf16 v[92:95], a[156:159], a[32:35], v[92:95]
    ds_write_b32 v11, v71 offset:14052
    v_mfma_f32_16x16x32_bf16 v[92:95], a[152:155], a[36:39], v[92:95]
    ds_write_b32 v11, v72 offset:14884
    v_mfma_f32_16x16x32_bf16 v[92:95], a[148:151], a[40:43], v[92:95]
    ds_write_b32 v11, v73 offset:14948
    v_mfma_f32_16x16x32_bf16 v[92:95], a[144:147], a[44:47], v[92:95]
    ds_write_b32 v11, v74 offset:15012
    v_mfma_f32_16x16x32_bf16 v[92:95], a[140:143], a[48:51], v[92:95]
    ds_write_b32 v11, v75 offset:15076
    v_mfma_f32_16x16x32_bf16 v[92:95], a[136:139], a[52:55], v[92:95]
    ds_write_b32 v11, v76 offset:15908
    v_mfma_f32_16x16x32_bf16 v[92:95], a[132:135], a[56:59], v[92:95]
    ds_write_b32 v11, v77 offset:15972
    v_mfma_f32_16x16x32_bf16 v[92:95], a[128:131], a[60:63], v[92:95]
    ds_write_b32 v11, v78 offset:16036
    v_mfma_f32_16x16x32_bf16 v[32:35], a[68:71], a[0:3], 0
    ds_write_b32 v11, v79 offset:16100
    v_mfma_f32_16x16x32_bf16 v[32:35], a[64:67], a[4:7], v[32:35]
    ds_write_b32 v11, v80 offset:16932
    v_mfma_f32_16x16x32_bf16 v[36:39], a[76:79], a[0:3], 0
    ds_write_b32 v11, v81 offset:16996
    v_mfma_f32_16x16x32_bf16 v[36:39], a[72:75], a[4:7], v[36:39]
    ds_write_b32 v11, v82 offset:17060
    v_mfma_f32_16x16x32_bf16 v[36:39], a[68:71], a[8:11], v[36:39]
    ds_write_b32 v11, v83 offset:17124
    v_mfma_f32_16x16x32_bf16 v[36:39], a[64:67], a[12:15], v[36:39]
    s_waitcnt lgkmcnt(15)
    ds_write_b32 v11, v84 offset:17956
    v_mfma_f32_16x16x32_bf16 v[40:43], a[84:87], a[0:3], 0
    ds_write_b32 v11, v85 offset:18020
    v_mfma_f32_16x16x32_bf16 v[40:43], a[80:83], a[4:7], v[40:43]
    ds_write_b32 v11, v86 offset:18084
    v_mfma_f32_16x16x32_bf16 v[40:43], a[76:79], a[8:11], v[40:43]
    ds_write_b32 v11, v87 offset:18148
    v_mfma_f32_16x16x32_bf16 v[40:43], a[72:75], a[12:15], v[40:43]
    ds_write_b32 v11, v88 offset:18980
    v_mfma_f32_16x16x32_bf16 v[40:43], a[68:71], a[16:19], v[40:43]
    ds_write_b32 v11, v89 offset:19044
    v_mfma_f32_16x16x32_bf16 v[40:43], a[64:67], a[20:23], v[40:43]
    ds_write_b32 v11, v90 offset:19108
    v_mfma_f32_16x16x32_bf16 v[44:47], a[92:95], a[0:3], 0
    ds_write_b32 v11, v91 offset:19172
    v_mfma_f32_16x16x32_bf16 v[44:47], a[88:91], a[4:7], v[44:47]
    ds_write_b32 v11, v92 offset:20004
    v_mfma_f32_16x16x32_bf16 v[44:47], a[84:87], a[8:11], v[44:47]
    ds_write_b32 v11, v93 offset:20068
    v_mfma_f32_16x16x32_bf16 v[44:47], a[80:83], a[12:15], v[44:47]
    ds_write_b32 v11, v94 offset:20132
    v_mfma_f32_16x16x32_bf16 v[44:47], a[76:79], a[16:19], v[44:47]
    ds_write_b32 v11, v95 offset:20196
    v_mfma_f32_16x16x32_bf16 v[44:47], a[72:75], a[20:23], v[44:47]
    ds_write_b32 v11, v32 offset:21064
    v_mfma_f32_16x16x32_bf16 v[44:47], a[68:71], a[24:27], v[44:47]
    ds_write_b32 v11, v33 offset:21128
    v_mfma_f32_16x16x32_bf16 v[44:47], a[64:67], a[28:31], v[44:47]
    ds_write_b32 v11, v34 offset:21192
    v_mfma_f32_16x16x32_bf16 v[48:51], a[100:103], a[0:3], 0
    ds_write_b32 v11, v35 offset:21256
    v_mfma_f32_16x16x32_bf16 v[48:51], a[96:99], a[4:7], v[48:51]
    ds_write_b32 v11, v36 offset:22088
    v_mfma_f32_16x16x32_bf16 v[48:51], a[92:95], a[8:11], v[48:51]
    ds_write_b32 v11, v37 offset:22152
    v_mfma_f32_16x16x32_bf16 v[48:51], a[88:91], a[12:15], v[48:51]
    ds_write_b32 v11, v38 offset:22216
    v_mfma_f32_16x16x32_bf16 v[48:51], a[84:87], a[16:19], v[48:51]
    ds_write_b32 v11, v39 offset:22280
    v_mfma_f32_16x16x32_bf16 v[48:51], a[80:83], a[20:23], v[48:51]
    ds_write_b32 v11, v40 offset:23112
    v_mfma_f32_16x16x32_bf16 v[48:51], a[76:79], a[24:27], v[48:51]
    ds_write_b32 v11, v41 offset:23176
    v_mfma_f32_16x16x32_bf16 v[48:51], a[72:75], a[28:31], v[48:51]
    ds_write_b32 v11, v42 offset:23240
    v_mfma_f32_16x16x32_bf16 v[48:51], a[68:71], a[32:35], v[48:51]
    ds_write_b32 v11, v43 offset:23304
    v_mfma_f32_16x16x32_bf16 v[48:51], a[64:67], a[36:39], v[48:51]
    ds_write_b32 v11, v44 offset:24136
    v_mfma_f32_16x16x32_bf16 v[52:55], a[108:111], a[0:3], 0
    ds_write_b32 v11, v45 offset:24200
    v_mfma_f32_16x16x32_bf16 v[52:55], a[104:107], a[4:7], v[52:55]
    ds_read_b64 a[128:129], v9 offset:3464
    v_mfma_f32_16x16x32_bf16 v[52:55], a[100:103], a[8:11], v[52:55]
    ds_read_b64 a[130:131], v9 offset:3472
    v_mfma_f32_16x16x32_bf16 v[52:55], a[96:99], a[12:15], v[52:55]
    ds_read_b64 a[132:133], v9 offset:3528
    v_mfma_f32_16x16x32_bf16 v[52:55], a[92:95], a[16:19], v[52:55]
    ds_read_b64 a[134:135], v9 offset:3536
    v_mfma_f32_16x16x32_bf16 v[52:55], a[88:91], a[20:23], v[52:55]
    ds_read_b64 a[136:137], v9 offset:3592
    v_mfma_f32_16x16x32_bf16 v[52:55], a[84:87], a[24:27], v[52:55]
    ds_read_b64 a[138:139], v9 offset:3600
    v_mfma_f32_16x16x32_bf16 v[52:55], a[80:83], a[28:31], v[52:55]
    ds_read_b64 a[140:141], v9 offset:3656
    v_mfma_f32_16x16x32_bf16 v[52:55], a[76:79], a[32:35], v[52:55]
    ds_read_b64 a[142:143], v9 offset:3664
    v_mfma_f32_16x16x32_bf16 v[52:55], a[72:75], a[36:39], v[52:55]
    ds_read_b64 a[144:145], v9 offset:3720
    v_mfma_f32_16x16x32_bf16 v[52:55], a[68:71], a[40:43], v[52:55]
    ds_read_b64 a[146:147], v9 offset:3728
    v_mfma_f32_16x16x32_bf16 v[52:55], a[64:67], a[44:47], v[52:55]
    ds_read_b64 a[148:149], v9 offset:3784
    v_mfma_f32_16x16x32_bf16 v[56:59], a[116:119], a[0:3], 0
    ds_read_b64 a[150:151], v9 offset:3792
    v_mfma_f32_16x16x32_bf16 v[56:59], a[112:115], a[4:7], v[56:59]
    ds_read_b64 a[152:153], v9 offset:3848
    v_mfma_f32_16x16x32_bf16 v[56:59], a[108:111], a[8:11], v[56:59]
    ds_read_b64 a[154:155], v9 offset:3856
    v_mfma_f32_16x16x32_bf16 v[56:59], a[104:107], a[12:15], v[56:59]
    ds_read_b64 a[156:157], v9 offset:3912
    v_mfma_f32_16x16x32_bf16 v[56:59], a[100:103], a[16:19], v[56:59]
    ds_read_b64 a[158:159], v9 offset:3920
    v_mfma_f32_16x16x32_bf16 v[56:59], a[96:99], a[20:23], v[56:59]
    ds_read_b64 a[160:161], v9 offset:3976
    v_mfma_f32_16x16x32_bf16 v[56:59], a[92:95], a[24:27], v[56:59]
    ds_read_b64 a[162:163], v9 offset:3984
    v_mfma_f32_16x16x32_bf16 v[56:59], a[88:91], a[28:31], v[56:59]
    ds_read_b64 a[164:165], v9 offset:4040
    v_mfma_f32_16x16x32_bf16 v[56:59], a[84:87], a[32:35], v[56:59]
    ds_read_b64 a[166:167], v9 offset:4048
    v_mfma_f32_16x16x32_bf16 v[56:59], a[80:83], a[36:39], v[56:59]
    ds_read_b64 a[168:169], v9 offset:4104
    v_mfma_f32_16x16x32_bf16 v[56:59], a[76:79], a[40:43], v[56:59]
    ds_read_b64 a[170:171], v9 offset:4112
    v_mfma_f32_16x16x32_bf16 v[56:59], a[72:75], a[44:47], v[56:59]
    ds_read_b64 a[172:173], v9 offset:4168
    v_mfma_f32_16x16x32_bf16 v[56:59], a[68:71], a[48:51], v[56:59]
    ds_read_b64 a[174:175], v9 offset:4176
    v_mfma_f32_16x16x32_bf16 v[56:59], a[64:67], a[52:55], v[56:59]
    s_waitcnt lgkmcnt(15)
    ds_read_b64 a[176:177], v9 offset:4232
    v_mfma_f32_16x16x32_bf16 v[60:63], a[124:127], a[0:3], 0
    ds_read_b64 a[178:179], v9 offset:4240
    v_mfma_f32_16x16x32_bf16 v[60:63], a[120:123], a[4:7], v[60:63]
    ds_read_b64 a[180:181], v9 offset:4296
    v_mfma_f32_16x16x32_bf16 v[60:63], a[116:119], a[8:11], v[60:63]
    ds_read_b64 a[182:183], v9 offset:4304
    v_mfma_f32_16x16x32_bf16 v[60:63], a[112:115], a[12:15], v[60:63]
    ds_read_b64 a[184:185], v9 offset:4360
    v_mfma_f32_16x16x32_bf16 v[60:63], a[108:111], a[16:19], v[60:63]
    ds_read_b64 a[186:187], v9 offset:4368
    v_mfma_f32_16x16x32_bf16 v[60:63], a[104:107], a[20:23], v[60:63]
    ds_read_b64 a[188:189], v9 offset:4424
    v_mfma_f32_16x16x32_bf16 v[60:63], a[100:103], a[24:27], v[60:63]
    ds_read_b64 a[190:191], v9 offset:4432
    v_mfma_f32_16x16x32_bf16 v[60:63], a[96:99], a[28:31], v[60:63]
    ds_write_b32 v11, v46 offset:24264
    v_mfma_f32_16x16x32_bf16 v[60:63], a[92:95], a[32:35], v[60:63]
    ds_write_b32 v11, v47 offset:24328
    v_mfma_f32_16x16x32_bf16 v[60:63], a[88:91], a[36:39], v[60:63]
    ds_write_b32 v11, v48 offset:25160
    v_mfma_f32_16x16x32_bf16 v[60:63], a[84:87], a[40:43], v[60:63]
    ds_write_b32 v11, v49 offset:25224
    v_mfma_f32_16x16x32_bf16 v[60:63], a[80:83], a[44:47], v[60:63]
    ds_write_b32 v11, v50 offset:25288
    v_mfma_f32_16x16x32_bf16 v[60:63], a[76:79], a[48:51], v[60:63]
    ds_write_b32 v11, v51 offset:25352
    v_mfma_f32_16x16x32_bf16 v[60:63], a[72:75], a[52:55], v[60:63]
    ds_write_b32 v11, v52 offset:26184
    v_mfma_f32_16x16x32_bf16 v[60:63], a[68:71], a[56:59], v[60:63]
    ds_write_b32 v11, v53 offset:26248
    v_mfma_f32_16x16x32_bf16 v[60:63], a[64:67], a[60:63], v[60:63]
    ds_write_b32 v11, v54 offset:26312
    v_mfma_f32_16x16x32_bf16 v[64:67], a[132:135], a[0:3], 0
    ds_write_b32 v11, v55 offset:26376
    v_mfma_f32_16x16x32_bf16 v[64:67], a[128:131], a[4:7], v[64:67]
    ds_write_b32 v11, v56 offset:27208
    v_mfma_f32_16x16x32_bf16 v[68:71], a[140:143], a[0:3], 0
    ds_write_b32 v11, v57 offset:27272
    v_mfma_f32_16x16x32_bf16 v[68:71], a[136:139], a[4:7], v[68:71]
    ds_write_b32 v11, v58 offset:27336
    v_mfma_f32_16x16x32_bf16 v[68:71], a[132:135], a[8:11], v[68:71]
    ds_write_b32 v11, v59 offset:27400
    v_mfma_f32_16x16x32_bf16 v[68:71], a[128:131], a[12:15], v[68:71]
    s_waitcnt lgkmcnt(15)
    v_mfma_f32_16x16x32_bf16 v[72:75], a[148:151], a[0:3], 0
    v_mfma_f32_16x16x32_bf16 v[72:75], a[144:147], a[4:7], v[72:75]
    v_mfma_f32_16x16x32_bf16 v[72:75], a[140:143], a[8:11], v[72:75]
    ds_write_b32 v11, v60 offset:28232
    v_mfma_f32_16x16x32_bf16 v[72:75], a[136:139], a[12:15], v[72:75]
    ds_write_b32 v11, v61 offset:28296
    v_mfma_f32_16x16x32_bf16 v[72:75], a[132:135], a[16:19], v[72:75]
    ds_write_b32 v11, v62 offset:28360
    v_mfma_f32_16x16x32_bf16 v[72:75], a[128:131], a[20:23], v[72:75]
    ds_write_b32 v11, v63 offset:28424
    v_mfma_f32_16x16x32_bf16 v[76:79], a[156:159], a[0:3], 0
    ds_write_b32 v11, v64 offset:29292
    v_mfma_f32_16x16x32_bf16 v[76:79], a[152:155], a[4:7], v[76:79]
    ds_write_b32 v11, v65 offset:29356
    v_mfma_f32_16x16x32_bf16 v[76:79], a[148:151], a[8:11], v[76:79]
    ds_write_b32 v11, v66 offset:29420
    v_mfma_f32_16x16x32_bf16 v[76:79], a[144:147], a[12:15], v[76:79]
    ds_write_b32 v11, v67 offset:29484
    v_mfma_f32_16x16x32_bf16 v[76:79], a[140:143], a[16:19], v[76:79]
    ds_write_b32 v11, v68 offset:30316
    v_mfma_f32_16x16x32_bf16 v[76:79], a[136:139], a[20:23], v[76:79]
    ds_write_b32 v11, v69 offset:30380
    v_mfma_f32_16x16x32_bf16 v[76:79], a[132:135], a[24:27], v[76:79]
    ds_write_b32 v11, v70 offset:30444
    v_mfma_f32_16x16x32_bf16 v[76:79], a[128:131], a[28:31], v[76:79]
    ds_write_b32 v11, v71 offset:30508
    v_mfma_f32_16x16x32_bf16 v[80:83], a[164:167], a[0:3], 0
    ds_write_b32 v11, v72 offset:31340
    v_mfma_f32_16x16x32_bf16 v[80:83], a[160:163], a[4:7], v[80:83]
    ds_write_b32 v11, v73 offset:31404
    v_mfma_f32_16x16x32_bf16 v[80:83], a[156:159], a[8:11], v[80:83]
    ds_write_b32 v11, v74 offset:31468
    v_mfma_f32_16x16x32_bf16 v[80:83], a[152:155], a[12:15], v[80:83]
    ds_write_b32 v11, v75 offset:31532
    v_mfma_f32_16x16x32_bf16 v[80:83], a[148:151], a[16:19], v[80:83]
    v_mfma_f32_16x16x32_bf16 v[80:83], a[144:147], a[20:23], v[80:83]
    v_mfma_f32_16x16x32_bf16 v[80:83], a[140:143], a[24:27], v[80:83]
    v_mfma_f32_16x16x32_bf16 v[80:83], a[136:139], a[28:31], v[80:83]
    v_mfma_f32_16x16x32_bf16 v[80:83], a[132:135], a[32:35], v[80:83]
    ds_write_b32 v11, v76 offset:32364
    v_mfma_f32_16x16x32_bf16 v[80:83], a[128:131], a[36:39], v[80:83]
    ds_write_b32 v11, v77 offset:32428
    v_mfma_f32_16x16x32_bf16 v[84:87], a[172:175], a[0:3], 0
    ds_write_b32 v11, v78 offset:32492
    v_mfma_f32_16x16x32_bf16 v[84:87], a[168:171], a[4:7], v[84:87]
    ds_write_b32 v11, v79 offset:32556
    v_mfma_f32_16x16x32_bf16 v[84:87], a[164:167], a[8:11], v[84:87]
    v_mfma_f32_16x16x32_bf16 v[84:87], a[160:163], a[12:15], v[84:87]
    v_mfma_f32_16x16x32_bf16 v[84:87], a[156:159], a[16:19], v[84:87]
    v_mfma_f32_16x16x32_bf16 v[84:87], a[152:155], a[20:23], v[84:87]
    v_mfma_f32_16x16x32_bf16 v[84:87], a[148:151], a[24:27], v[84:87]
    v_mfma_f32_16x16x32_bf16 v[84:87], a[144:147], a[28:31], v[84:87]
    v_mfma_f32_16x16x32_bf16 v[84:87], a[140:143], a[32:35], v[84:87]
    ds_write_b32 v11, v80 offset:33388
    v_mfma_f32_16x16x32_bf16 v[84:87], a[136:139], a[36:39], v[84:87]
    ds_write_b32 v11, v81 offset:33452
    v_mfma_f32_16x16x32_bf16 v[84:87], a[132:135], a[40:43], v[84:87]
    ds_write_b32 v11, v82 offset:33516
    v_mfma_f32_16x16x32_bf16 v[84:87], a[128:131], a[44:47], v[84:87]
    ds_write_b32 v11, v83 offset:33580
    v_mfma_f32_16x16x32_bf16 v[88:91], a[180:183], a[0:3], 0
    v_mfma_f32_16x16x32_bf16 v[88:91], a[176:179], a[4:7], v[88:91]
    v_mfma_f32_16x16x32_bf16 v[88:91], a[172:175], a[8:11], v[88:91]
    v_mfma_f32_16x16x32_bf16 v[88:91], a[168:171], a[12:15], v[88:91]
    v_mfma_f32_16x16x32_bf16 v[88:91], a[164:167], a[16:19], v[88:91]
    v_mfma_f32_16x16x32_bf16 v[88:91], a[160:163], a[20:23], v[88:91]
    v_mfma_f32_16x16x32_bf16 v[88:91], a[156:159], a[24:27], v[88:91]
    v_mfma_f32_16x16x32_bf16 v[88:91], a[152:155], a[28:31], v[88:91]
    v_mfma_f32_16x16x32_bf16 v[88:91], a[148:151], a[32:35], v[88:91]
    ds_write_b32 v11, v84 offset:34412
    v_mfma_f32_16x16x32_bf16 v[88:91], a[144:147], a[36:39], v[88:91]
    ds_write_b32 v11, v85 offset:34476
    v_mfma_f32_16x16x32_bf16 v[88:91], a[140:143], a[40:43], v[88:91]
    ds_write_b32 v11, v86 offset:34540
    v_mfma_f32_16x16x32_bf16 v[88:91], a[136:139], a[44:47], v[88:91]
    ds_write_b32 v11, v87 offset:34604
    v_mfma_f32_16x16x32_bf16 v[88:91], a[132:135], a[48:51], v[88:91]
    v_mfma_f32_16x16x32_bf16 v[88:91], a[128:131], a[52:55], v[88:91]
    s_waitcnt lgkmcnt(15)
    v_mfma_f32_16x16x32_bf16 v[92:95], a[188:191], a[0:3], 0
    v_mfma_f32_16x16x32_bf16 v[92:95], a[184:187], a[4:7], v[92:95]
    v_mfma_f32_16x16x32_bf16 v[92:95], a[180:183], a[8:11], v[92:95]
    v_mfma_f32_16x16x32_bf16 v[92:95], a[176:179], a[12:15], v[92:95]
    v_mfma_f32_16x16x32_bf16 v[92:95], a[172:175], a[16:19], v[92:95]
    v_mfma_f32_16x16x32_bf16 v[92:95], a[168:171], a[20:23], v[92:95]
    v_mfma_f32_16x16x32_bf16 v[92:95], a[164:167], a[24:27], v[92:95]
    v_mfma_f32_16x16x32_bf16 v[92:95], a[160:163], a[28:31], v[92:95]
    v_mfma_f32_16x16x32_bf16 v[92:95], a[156:159], a[32:35], v[92:95]
    ds_write_b32 v11, v88 offset:35436
    v_mfma_f32_16x16x32_bf16 v[92:95], a[152:155], a[36:39], v[92:95]
    ds_write_b32 v11, v89 offset:35500
    v_mfma_f32_16x16x32_bf16 v[92:95], a[148:151], a[40:43], v[92:95]
    ds_write_b32 v11, v90 offset:35564
    v_mfma_f32_16x16x32_bf16 v[92:95], a[144:147], a[44:47], v[92:95]
    ds_write_b32 v11, v91 offset:35628
    v_mfma_f32_16x16x32_bf16 v[92:95], a[140:143], a[48:51], v[92:95]
    v_mfma_f32_16x16x32_bf16 v[92:95], a[136:139], a[52:55], v[92:95]
    v_mfma_f32_16x16x32_bf16 v[92:95], a[132:135], a[56:59], v[92:95]
    v_mfma_f32_16x16x32_bf16 v[92:95], a[128:131], a[60:63], v[92:95]
    s_nop 7
    ds_write_b32 v11, v92 offset:36460
    ds_write_b32 v11, v93 offset:36524
    ds_write_b32 v11, v94 offset:36588
    ds_write_b32 v11, v95 offset:36652
    s_waitcnt lgkmcnt(0)
    ds_read_b128 v[96:99], v12 offset:4608
    ds_read_b128 v[100:103], v12 offset:4624
    ds_read_b32 v128, v5 offset:128
    ds_read_b128 v[104:107], v12 offset:12832
    ds_read_b128 v[108:111], v12 offset:12848
    ds_read_b32 v129, v5 offset:1280
    ds_read_b128 v[112:115], v12 offset:21056
    ds_read_b128 v[116:119], v12 offset:21072
    ds_read_b32 v130, v5 offset:2432
    ds_read_b128 v[120:123], v12 offset:29280
    ds_read_b128 v[124:127], v12 offset:29296
    ds_read_b32 v131, v5 offset:3584
    s_waitcnt lgkmcnt(0)
    v_pk_add_f32 v[96:97], v[96:97], v[104:105]
    v_pk_add_f32 v[112:113], v[112:113], v[120:121]
    v_pk_add_f32 v[96:97], v[96:97], v[112:113]
    v_pk_add_f32 v[98:99], v[98:99], v[106:107]
    v_pk_add_f32 v[114:115], v[114:115], v[122:123]
    v_pk_add_f32 v[98:99], v[98:99], v[114:115]
    v_pk_add_f32 v[100:101], v[100:101], v[108:109]
    v_pk_add_f32 v[116:117], v[116:117], v[124:125]
    v_pk_add_f32 v[100:101], v[100:101], v[116:117]
    v_pk_add_f32 v[102:103], v[102:103], v[110:111]
    v_pk_add_f32 v[118:119], v[118:119], v[126:127]
    v_pk_add_f32 v[102:103], v[102:103], v[118:119]
    v_lshlrev_b32 v16, 16, v128
    v_fmac_f32 v96, s43, v16
    v_lshlrev_b32 v16, 16, v129
    v_fmac_f32 v97, s43, v16
    v_lshlrev_b32 v16, 16, v130
    v_fmac_f32 v98, s43, v16
    v_lshlrev_b32 v16, 16, v131
    v_fmac_f32 v99, s43, v16
    v_and_b32 v16, s45, v128
    v_fmac_f32 v100, s43, v16
    v_and_b32 v16, s45, v129
    v_fmac_f32 v101, s43, v16
    v_and_b32 v16, s45, v130
    v_fmac_f32 v102, s43, v16
    v_and_b32 v16, s45, v131
    v_fmac_f32 v103, s43, v16
    v_cvt_pk_bf16_f32 v132, v96, v97
    v_cvt_pk_bf16_f32 v133, v98, v99
    v_cvt_pk_bf16_f32 v134, v100, v101
    v_cvt_pk_bf16_f32 v135, v102, v103
    buffer_store_dwordx4 v[132:135], v1, s[12:15], s42 offen offset:0 sc1
    ds_read_b128 v[136:139], v12 offset:6656
    ds_read_b128 v[140:143], v12 offset:6672
    ds_read_b32 v168, v5 offset:384
    ds_read_b128 v[144:147], v12 offset:14880
    ds_read_b128 v[148:151], v12 offset:14896
    ds_read_b32 v169, v5 offset:1536
    ds_read_b128 v[152:155], v12 offset:23104
    ds_read_b128 v[156:159], v12 offset:23120
    ds_read_b32 v170, v5 offset:2688
    ds_read_b128 v[160:163], v12 offset:31328
    ds_read_b128 v[164:167], v12 offset:31344
    ds_read_b32 v171, v5 offset:3840
    s_waitcnt lgkmcnt(0)
    v_pk_add_f32 v[136:137], v[136:137], v[144:145]
    v_pk_add_f32 v[152:153], v[152:153], v[160:161]
    v_pk_add_f32 v[136:137], v[136:137], v[152:153]
    v_pk_add_f32 v[138:139], v[138:139], v[146:147]
    v_pk_add_f32 v[154:155], v[154:155], v[162:163]
    v_pk_add_f32 v[138:139], v[138:139], v[154:155]
    v_pk_add_f32 v[140:141], v[140:141], v[148:149]
    v_pk_add_f32 v[156:157], v[156:157], v[164:165]
    v_pk_add_f32 v[140:141], v[140:141], v[156:157]
    v_pk_add_f32 v[142:143], v[142:143], v[150:151]
    v_pk_add_f32 v[158:159], v[158:159], v[166:167]
    v_pk_add_f32 v[142:143], v[142:143], v[158:159]
    v_lshlrev_b32 v16, 16, v168
    v_fmac_f32 v136, s43, v16
    v_lshlrev_b32 v16, 16, v169
    v_fmac_f32 v137, s43, v16
    v_lshlrev_b32 v16, 16, v170
    v_fmac_f32 v138, s43, v16
    v_lshlrev_b32 v16, 16, v171
    v_fmac_f32 v139, s43, v16
    v_and_b32 v16, s45, v168
    v_fmac_f32 v140, s43, v16
    v_and_b32 v16, s45, v169
    v_fmac_f32 v141, s43, v16
    v_and_b32 v16, s45, v170
    v_fmac_f32 v142, s43, v16
    v_and_b32 v16, s45, v171
    v_fmac_f32 v143, s43, v16
    v_cvt_pk_bf16_f32 v172, v136, v137
    v_cvt_pk_bf16_f32 v173, v138, v139
    v_cvt_pk_bf16_f32 v174, v140, v141
    v_cvt_pk_bf16_f32 v175, v142, v143
    buffer_store_dwordx4 v[172:175], v1, s[12:15], s42 offen offset:1024 sc1
    ds_read_b128 v[96:99], v12 offset:8704
    ds_read_b128 v[100:103], v12 offset:8720
    ds_read_b32 v128, v5 offset:640
    ds_read_b128 v[104:107], v12 offset:16928
    ds_read_b128 v[108:111], v12 offset:16944
    ds_read_b32 v129, v5 offset:1792
    ds_read_b128 v[112:115], v12 offset:25152
    ds_read_b128 v[116:119], v12 offset:25168
    ds_read_b32 v130, v5 offset:2944
    ds_read_b128 v[120:123], v12 offset:33376
    ds_read_b128 v[124:127], v12 offset:33392
    ds_read_b32 v131, v5 offset:4096
    s_waitcnt lgkmcnt(0)
    v_pk_add_f32 v[96:97], v[96:97], v[104:105]
    v_pk_add_f32 v[112:113], v[112:113], v[120:121]
    v_pk_add_f32 v[96:97], v[96:97], v[112:113]
    v_pk_add_f32 v[98:99], v[98:99], v[106:107]
    v_pk_add_f32 v[114:115], v[114:115], v[122:123]
    v_pk_add_f32 v[98:99], v[98:99], v[114:115]
    v_pk_add_f32 v[100:101], v[100:101], v[108:109]
    v_pk_add_f32 v[116:117], v[116:117], v[124:125]
    v_pk_add_f32 v[100:101], v[100:101], v[116:117]
    v_pk_add_f32 v[102:103], v[102:103], v[110:111]
    v_pk_add_f32 v[118:119], v[118:119], v[126:127]
    v_pk_add_f32 v[102:103], v[102:103], v[118:119]
    v_lshlrev_b32 v16, 16, v128
    v_fmac_f32 v96, s43, v16
    v_lshlrev_b32 v16, 16, v129
    v_fmac_f32 v97, s43, v16
    v_lshlrev_b32 v16, 16, v130
    v_fmac_f32 v98, s43, v16
    v_lshlrev_b32 v16, 16, v131
    v_fmac_f32 v99, s43, v16
    v_and_b32 v16, s45, v128
    v_fmac_f32 v100, s43, v16
    v_and_b32 v16, s45, v129
    v_fmac_f32 v101, s43, v16
    v_and_b32 v16, s45, v130
    v_fmac_f32 v102, s43, v16
    v_and_b32 v16, s45, v131
    v_fmac_f32 v103, s43, v16
    v_cvt_pk_bf16_f32 v132, v96, v97
    v_cvt_pk_bf16_f32 v133, v98, v99
    v_cvt_pk_bf16_f32 v134, v100, v101
    v_cvt_pk_bf16_f32 v135, v102, v103
    buffer_store_dwordx4 v[132:135], v1, s[12:15], s42 offen offset:2048 sc1
    ds_read_b128 v[136:139], v12 offset:10752
    ds_read_b128 v[140:143], v12 offset:10768
    ds_read_b32 v168, v5 offset:896
    ds_read_b128 v[144:147], v12 offset:18976
    ds_read_b128 v[148:151], v12 offset:18992
    ds_read_b32 v169, v5 offset:2048
    ds_read_b128 v[152:155], v12 offset:27200
    ds_read_b128 v[156:159], v12 offset:27216
    ds_read_b32 v170, v5 offset:3200
    ds_read_b128 v[160:163], v12 offset:35424
    ds_read_b128 v[164:167], v12 offset:35440
    ds_read_b32 v171, v5 offset:4352
    s_waitcnt lgkmcnt(0)
    v_pk_add_f32 v[136:137], v[136:137], v[144:145]
    v_pk_add_f32 v[152:153], v[152:153], v[160:161]
    v_pk_add_f32 v[136:137], v[136:137], v[152:153]
    v_pk_add_f32 v[138:139], v[138:139], v[146:147]
    v_pk_add_f32 v[154:155], v[154:155], v[162:163]
    v_pk_add_f32 v[138:139], v[138:139], v[154:155]
    v_pk_add_f32 v[140:141], v[140:141], v[148:149]
    v_pk_add_f32 v[156:157], v[156:157], v[164:165]
    v_pk_add_f32 v[140:141], v[140:141], v[156:157]
    v_pk_add_f32 v[142:143], v[142:143], v[150:151]
    v_pk_add_f32 v[158:159], v[158:159], v[166:167]
    v_pk_add_f32 v[142:143], v[142:143], v[158:159]
    v_lshlrev_b32 v16, 16, v168
    v_fmac_f32 v136, s43, v16
    v_lshlrev_b32 v16, 16, v169
    v_fmac_f32 v137, s43, v16
    v_lshlrev_b32 v16, 16, v170
    v_fmac_f32 v138, s43, v16
    v_lshlrev_b32 v16, 16, v171
    v_fmac_f32 v139, s43, v16
    v_and_b32 v16, s45, v168
    v_fmac_f32 v140, s43, v16
    v_and_b32 v16, s45, v169
    v_fmac_f32 v141, s43, v16
    v_and_b32 v16, s45, v170
    v_fmac_f32 v142, s43, v16
    v_and_b32 v16, s45, v171
    v_fmac_f32 v143, s43, v16
    v_cvt_pk_bf16_f32 v172, v136, v137
    v_cvt_pk_bf16_f32 v173, v138, v139
    v_cvt_pk_bf16_f32 v174, v140, v141
    v_cvt_pk_bf16_f32 v175, v142, v143
    buffer_store_dwordx4 v[172:175], v1, s[12:15], s42 offen offset:3072 sc1
    s_lshl_b32 s35, s95, 2
    s_add_u32 s35, s35, 84963328
    s_waitcnt vmcnt(0)
    s_barrier
    s_cmp_lg_u32 s3, 0
    s_cbranch_scc1 L_pub7
    v_mov_b32 v14, 0
    v_mov_b32 v15, 1
    s_mov_b64 exec, 1
    buffer_store_dword v15, v14, s[12:15], s35 offen sc1
    s_mov_b64 exec, -1
L_pub7:
L_s2end:
    s_lshl_b32 s33, s24, 1
    s_and_b32 s34, s28, 1
    s_add_u32 s33, s33, s34
    s_xor_b32 s34, s27, 1
    s_lshl_b32 s34, s34, 4
    s_add_u32 s33, s33, s34
    s_lshr_b32 s34, s28, 1
    v_lshlrev_b32 v1, 4, v0
    v_lshrrev_b32 v3, 3, v0
    v_mul_u32_u24 v4, 896, v3
    v_and_b32 v3, 6, v3
    v_xor_b32 v3, v3, v0
    v_and_b32 v3, 7, v3
    v_lshl_add_u32 v3, v3, 4, v4
    v_lshrrev_b32 v8, 2, v0
    v_lshlrev_b32 v4, 7, v8
    v_bfe_u32 v8, v8, 1, 2
    v_lshl_add_u32 v4, v8, 5, v4
    v_and_b32 v8, 3, v0
    v_lshl_add_u32 v4, v8, 3, v4
    s_lshl_b32 s35, s3, 15
    v_add_u32 v4, s35, v4
    v_xor_b32 v5, 32, v4
    v_xor_b32 v6, 64, v4
    v_xor_b32 v7, 96, v4
    s_mul_i32 s36, s3, 917504
    s_lshl_b32 s41, s34, 7
    s_add_u32 s36, s36, s41
    s_lshl_b32 s37, s33, 19
    s_add_u32 s37, s37, s35
    s_add_u32 s37, s37, 50331648
    v_add_u32 v9, 131072, v1
    v_add_u32 v13, 7168, v3
    v_add_u32 v10, 262144, v1
    v_add_u32 v14, 14336, v3
    v_add_u32 v11, 393216, v1
    v_add_u32 v15, 21504, v3
    s_mov_b32 s4, s86
    s_mov_b32 s5, s87
    s_mov_b32 s6, 3670016
    s_mov_b32 s7, 0x20000
    s_mov_b32 s8, s88
    s_mov_b32 s9, s89
    s_mov_b32 s10, 3670016
    s_mov_b32 s11, 0x20000
    s_mov_b32 s16, s64
    s_mov_b32 s17, s65
    s_mov_b32 s18, 1835008
    s_mov_b32 s19, 0x20000
    s_add_u32 m0, s35, 0
    s_nop 0
    buffer_load_dwordx4 v3, s[4:7], s36 offen lds
    s_add_u32 m0, s35, 1024
    s_nop 0
    buffer_load_dwordx4 v13, s[4:7], s36 offen lds
    s_add_u32 m0, s35, 2048
    s_nop 0
    buffer_load_dwordx4 v14, s[4:7], s36 offen lds
    s_add_u32 m0, s35, 3072
    s_nop 0
    buffer_load_dwordx4 v15, s[4:7], s36 offen lds
    s_add_u32 s36, s36, 28672
    s_add_u32 m0, s35, 4096
    s_nop 0
    buffer_load_dwordx4 v3, s[4:7], s36 offen lds
    s_add_u32 m0, s35, 5120
    s_nop 0
    buffer_load_dwordx4 v13, s[4:7], s36 offen lds
    s_add_u32 m0, s35, 6144
    s_nop 0
    buffer_load_dwordx4 v14, s[4:7], s36 offen lds
    s_add_u32 m0, s35, 7168
    s_nop 0
    buffer_load_dwordx4 v15, s[4:7], s36 offen lds
    s_add_u32 s36, s36, 28672
    s_add_u32 m0, s35, 8192
    s_nop 0
    buffer_load_dwordx4 v3, s[4:7], s36 offen lds
    s_add_u32 m0, s35, 9216
    s_nop 0
    buffer_load_dwordx4 v13, s[4:7], s36 offen lds
    s_add_u32 m0, s35, 10240
    s_nop 0
    buffer_load_dwordx4 v14, s[4:7], s36 offen lds
    s_add_u32 m0, s35, 11264
    s_nop 0
    buffer_load_dwordx4 v15, s[4:7], s36 offen lds
    s_add_u32 s36, s36, 28672
    s_add_u32 m0, s35, 12288
    s_nop 0
    buffer_load_dwordx4 v3, s[4:7], s36 offen lds
    s_add_u32 m0, s35, 13312
    s_nop 0
    buffer_load_dwordx4 v13, s[4:7], s36 offen lds
    s_add_u32 m0, s35, 14336
    s_nop 0
    buffer_load_dwordx4 v14, s[4:7], s36 offen lds
    s_add_u32 m0, s35, 15360
    s_nop 0
    buffer_load_dwordx4 v15, s[4:7], s36 offen lds
    s_add_u32 s36, s36, 28672
    s_add_u32 m0, s35, 16384
    s_nop 0
    buffer_load_dwordx4 v3, s[4:7], s36 offen lds
    s_add_u32 m0, s35, 17408
    s_nop 0
    buffer_load_dwordx4 v13, s[4:7], s36 offen lds
    s_add_u32 m0, s35, 18432
    s_nop 0
    buffer_load_dwordx4 v14, s[4:7], s36 offen lds
    s_add_u32 m0, s35, 19456
    s_nop 0
    buffer_load_dwordx4 v15, s[4:7], s36 offen lds
    s_add_u32 s36, s36, 28672
    s_add_u32 m0, s35, 20480
    s_nop 0
    buffer_load_dwordx4 v3, s[4:7], s36 offen lds
    s_add_u32 m0, s35, 21504
    s_nop 0
    buffer_load_dwordx4 v13, s[4:7], s36 offen lds
    s_add_u32 m0, s35, 22528
    s_nop 0
    buffer_load_dwordx4 v14, s[4:7], s36 offen lds
    s_add_u32 m0, s35, 23552
    s_nop 0
    buffer_load_dwordx4 v15, s[4:7], s36 offen lds
    s_add_u32 s36, s36, 28672
    v_mov_b64 v[64:65], 0
    v_mov_b64 v[66:67], 0
    v_mov_b64 v[68:69], 0
    v_mov_b64 v[70:71], 0
    v_mov_b64 v[72:73], 0
    v_mov_b64 v[74:75], 0
    v_mov_b64 v[76:77], 0
    v_mov_b64 v[78:79], 0
    v_mov_b64 v[80:81], 0
    v_mov_b64 v[82:83], 0
    v_mov_b64 v[84:85], 0
    v_mov_b64 v[86:87], 0
    v_mov_b64 v[88:89], 0
    v_mov_b64 v[90:91], 0
    v_mov_b64 v[92:93], 0
    v_mov_b64 v[94:95], 0
    v_mov_b64 v[96:97], 0
    v_mov_b64 v[98:99], 0
    v_mov_b64 v[100:101], 0
    v_mov_b64 v[102:103], 0
    v_mov_b64 v[104:105], 0
    v_mov_b64 v[106:107], 0
    v_mov_b64 v[108:109], 0
    v_mov_b64 v[110:111], 0
    v_mov_b64 v[112:113], 0
    v_mov_b64 v[114:115], 0
    v_mov_b64 v[116:117], 0
    v_mov_b64 v[118:119], 0
    v_mov_b64 v[120:121], 0
    v_mov_b64 v[122:123], 0
    v_mov_b64 v[124:125], 0
    v_mov_b64 v[126:127], 0
    s_lshr_b32 s44, s33, 1
    s_lshl_b32 s44, s44, 7
    s_add_u32 s44, s44, 84938752
    v_and_b32 v16, 15, v0
    v_lshlrev_b32 v16, 2, v16
    s_mov_b32 s32, 0
L_poll8:
    buffer_load_dword v17, v16, s[12:15], s44 offen sc1
    s_waitcnt vmcnt(0)
    v_cmp_ne_u32 vcc, 1, v17
    s_cbranch_vccz L_poll8_ok
    s_sleep 2
    s_add_u32 s32, s32, 1
    s_cmp_lt_u32 s32, 0x80000
    s_cbranch_scc1 L_poll8
L_poll8_ok:
    buffer_load_dwordx4 a[0:3], v1, s[12:15], s37 offen sc1
    buffer_load_dwordx4 a[4:7], v9, s[12:15], s37 offen sc1
    buffer_load_dwordx4 a[8:11], v10, s[12:15], s37 offen sc1
    buffer_load_dwordx4 a[12:15], v11, s[12:15], s37 offen sc1
    s_add_u32 s37, s37, 1024
    buffer_load_dwordx4 a[16:19], v1, s[12:15], s37 offen sc1
    buffer_load_dwordx4 a[20:23], v9, s[12:15], s37 offen sc1
    buffer_load_dwordx4 a[24:27], v10, s[12:15], s37 offen sc1
    buffer_load_dwordx4 a[28:31], v11, s[12:15], s37 offen sc1
    s_add_u32 s37, s37, 1024
    buffer_load_dwordx4 a[32:35], v1, s[12:15], s37 offen sc1
    buffer_load_dwordx4 a[36:39], v9, s[12:15], s37 offen sc1
    buffer_load_dwordx4 a[40:43], v10, s[12:15], s37 offen sc1
    buffer_load_dwordx4 a[44:47], v11, s[12:15], s37 offen sc1
    s_add_u32 s37, s37, 1024
    buffer_load_dwordx4 a[48:51], v1, s[12:15], s37 offen sc1
    buffer_load_dwordx4 a[52:55], v9, s[12:15], s37 offen sc1
    buffer_load_dwordx4 a[56:59], v10, s[12:15], s37 offen sc1
    buffer_load_dwordx4 a[60:63], v11, s[12:15], s37 offen sc1
    s_add_u32 s37, s37, 1024
    buffer_load_dwordx4 a[64:67], v1, s[12:15], s37 offen sc1
    buffer_load_dwordx4 a[68:71], v9, s[12:15], s37 offen sc1
    buffer_load_dwordx4 a[72:75], v10, s[12:15], s37 offen sc1
    buffer_load_dwordx4 a[76:79], v11, s[12:15], s37 offen sc1
    s_add_u32 s37, s37, 1024
    buffer_load_dwordx4 a[80:83], v1, s[12:15], s37 offen sc1
    buffer_load_dwordx4 a[84:87], v9, s[12:15], s37 offen sc1
    buffer_load_dwordx4 a[88:91], v10, s[12:15], s37 offen sc1
    buffer_load_dwordx4 a[92:95], v11, s[12:15], s37 offen sc1
    s_add_u32 s37, s37, 1024
    ds_read_b64_tr_b16 v[32:33], v4 offset:0
    ds_read_b64_tr_b16 v[34:35], v4 offset:2048
    ds_read_b64_tr_b16 v[36:37], v5 offset:0
    ds_read_b64_tr_b16 v[38:39], v5 offset:2048
    ds_read_b64_tr_b16 v[40:41], v6 offset:0
    ds_read_b64_tr_b16 v[42:43], v6 offset:2048
    ds_read_b64_tr_b16 v[44:45], v7 offset:0
    ds_read_b64_tr_b16 v[46:47], v7 offset:2048
    s_waitcnt vmcnt(0)
    s_mov_b32 s42, 0
    s_mov_b32 s43, 0xf0000000
.p2align 6
L_oloop:
    s_waitcnt vmcnt(32) lgkmcnt(0)
    v_mfma_f32_16x16x32_bf16 v[64:67], v[32:35], a[0:3], v[64:67]
    s_add_u32 m0, s35, 24576
    ds_read_b64_tr_b16 v[48:49], v4 offset:4096
    v_mfma_f32_16x16x32_bf16 v[68:71], v[32:35], a[4:7], v[68:71]
    buffer_load_dwordx4 v3, s[4:7], s36 offen lds
    v_mfma_f32_16x16x32_bf16 v[72:75], v[32:35], a[8:11], v[72:75]
    ds_read_b64_tr_b16 v[50:51], v4 offset:6144
    v_mfma_f32_16x16x32_bf16 v[76:79], v[32:35], a[12:15], v[76:79]
    buffer_load_dwordx4 a[96:99], v1, s[12:15], s37 offen sc1
    v_mfma_f32_16x16x32_bf16 v[80:83], v[36:39], a[0:3], v[80:83]
    s_add_u32 m0, s35, 25600
    ds_read_b64_tr_b16 v[52:53], v5 offset:4096
    v_mfma_f32_16x16x32_bf16 v[84:87], v[36:39], a[4:7], v[84:87]
    buffer_load_dwordx4 v13, s[4:7], s36 offen lds
    v_mfma_f32_16x16x32_bf16 v[88:91], v[36:39], a[8:11], v[88:91]
    ds_read_b64_tr_b16 v[54:55], v5 offset:6144
    v_mfma_f32_16x16x32_bf16 v[92:95], v[36:39], a[12:15], v[92:95]
    buffer_load_dwordx4 a[100:103], v9, s[12:15], s37 offen sc1
    v_mfma_f32_16x16x32_bf16 v[96:99], v[40:43], a[0:3], v[96:99]
    s_add_u32 m0, s35, 26624
    ds_read_b64_tr_b16 v[56:57], v6 offset:4096
    v_mfma_f32_16x16x32_bf16 v[100:103], v[40:43], a[4:7], v[100:103]
    buffer_load_dwordx4 v14, s[4:7], s36 offen lds
    v_mfma_f32_16x16x32_bf16 v[104:107], v[40:43], a[8:11], v[104:107]
    ds_read_b64_tr_b16 v[58:59], v6 offset:6144
    v_mfma_f32_16x16x32_bf16 v[108:111], v[40:43], a[12:15], v[108:111]
    buffer_load_dwordx4 a[104:107], v10, s[12:15], s37 offen sc1
    v_mfma_f32_16x16x32_bf16 v[112:115], v[44:47], a[0:3], v[112:115]
    s_add_u32 m0, s35, 27648
    ds_read_b64_tr_b16 v[60:61], v7 offset:4096
    v_mfma_f32_16x16x32_bf16 v[116:119], v[44:47], a[4:7], v[116:119]
    buffer_load_dwordx4 v15, s[4:7], s36 offen lds
    v_mfma_f32_16x16x32_bf16 v[120:123], v[44:47], a[8:11], v[120:123]
    ds_read_b64_tr_b16 v[62:63], v7 offset:6144
    v_mfma_f32_16x16x32_bf16 v[124:127], v[44:47], a[12:15], v[124:127]
    buffer_load_dwordx4 a[108:111], v11, s[12:15], s37 offen sc1
    s_add_u32 s36, s36, 28672
    s_add_u32 s37, s37, 1024
    s_waitcnt vmcnt(32) lgkmcnt(0)
    v_mfma_f32_16x16x32_bf16 v[64:67], v[48:51], a[16:19], v[64:67]
    s_add_u32 m0, s35, 28672
    ds_read_b64_tr_b16 v[32:33], v4 offset:8192
    v_mfma_f32_16x16x32_bf16 v[68:71], v[48:51], a[20:23], v[68:71]
    buffer_load_dwordx4 v3, s[4:7], s36 offen lds
    v_mfma_f32_16x16x32_bf16 v[72:75], v[48:51], a[24:27], v[72:75]
    ds_read_b64_tr_b16 v[34:35], v4 offset:10240
    v_mfma_f32_16x16x32_bf16 v[76:79], v[48:51], a[28:31], v[76:79]
    buffer_load_dwordx4 a[112:115], v1, s[12:15], s37 offen sc1
    v_mfma_f32_16x16x32_bf16 v[80:83], v[52:55], a[16:19], v[80:83]
    s_add_u32 m0, s35, 29696
    ds_read_b64_tr_b16 v[36:37], v5 offset:8192
    v_mfma_f32_16x16x32_bf16 v[84:87], v[52:55], a[20:23], v[84:87]
    buffer_load_dwordx4 v13, s[4:7], s36 offen lds
    v_mfma_f32_16x16x32_bf16 v[88:91], v[52:55], a[24:27], v[88:91]
    ds_read_b64_tr_b16 v[38:39], v5 offset:10240
    v_mfma_f32_16x16x32_bf16 v[92:95], v[52:55], a[28:31], v[92:95]
    buffer_load_dwordx4 a[116:119], v9, s[12:15], s37 offen sc1
    v_mfma_f32_16x16x32_bf16 v[96:99], v[56:59], a[16:19], v[96:99]
    s_add_u32 m0, s35, 30720
    ds_read_b64_tr_b16 v[40:41], v6 offset:8192
    v_mfma_f32_16x16x32_bf16 v[100:103], v[56:59], a[20:23], v[100:103]
    buffer_load_dwordx4 v14, s[4:7], s36 offen lds
    v_mfma_f32_16x16x32_bf16 v[104:107], v[56:59], a[24:27], v[104:107]
    ds_read_b64_tr_b16 v[42:43], v6 offset:10240
    v_mfma_f32_16x16x32_bf16 v[108:111], v[56:59], a[28:31], v[108:111]
    buffer_load_dwordx4 a[120:123], v10, s[12:15], s37 offen sc1
    v_mfma_f32_16x16x32_bf16 v[112:115], v[60:63], a[16:19], v[112:115]
    s_add_u32 m0, s35, 31744
    ds_read_b64_tr_b16 v[44:45], v7 offset:8192
    v_mfma_f32_16x16x32_bf16 v[116:119], v[60:63], a[20:23], v[116:119]
    buffer_load_dwordx4 v15, s[4:7], s36 offen lds
    v_mfma_f32_16x16x32_bf16 v[120:123], v[60:63], a[24:27], v[120:123]
    ds_read_b64_tr_b16 v[46:47], v7 offset:10240
    v_mfma_f32_16x16x32_bf16 v[124:127], v[60:63], a[28:31], v[124:127]
    buffer_load_dwordx4 a[124:127], v11, s[12:15], s37 offen sc1
    s_add_u32 s36, s36, 28672
    s_add_u32 s37, s37, 1024
    s_cmp_eq_u32 s42, 3
    s_cmov_b32 s36, s43
    s_cmov_b32 s37, s43
    s_waitcnt vmcnt(32) lgkmcnt(0)
    v_mfma_f32_16x16x32_bf16 v[64:67], v[32:35], a[32:35], v[64:67]
    s_add_u32 m0, s35, 0
    ds_read_b64_tr_b16 v[48:49], v4 offset:12288
    v_mfma_f32_16x16x32_bf16 v[68:71], v[32:35], a[36:39], v[68:71]
    buffer_load_dwordx4 v3, s[4:7], s36 offen lds
    v_mfma_f32_16x16x32_bf16 v[72:75], v[32:35], a[40:43], v[72:75]
    ds_read_b64_tr_b16 v[50:51], v4 offset:14336
    v_mfma_f32_16x16x32_bf16 v[76:79], v[32:35], a[44:47], v[76:79]
    buffer_load_dwordx4 a[0:3], v1, s[12:15], s37 offen sc1
    v_mfma_f32_16x16x32_bf16 v[80:83], v[36:39], a[32:35], v[80:83]
    s_add_u32 m0, s35, 1024
    ds_read_b64_tr_b16 v[52:53], v5 offset:12288
    v_mfma_f32_16x16x32_bf16 v[84:87], v[36:39], a[36:39], v[84:87]
    buffer_load_dwordx4 v13, s[4:7], s36 offen lds
    v_mfma_f32_16x16x32_bf16 v[88:91], v[36:39], a[40:43], v[88:91]
    ds_read_b64_tr_b16 v[54:55], v5 offset:14336
    v_mfma_f32_16x16x32_bf16 v[92:95], v[36:39], a[44:47], v[92:95]
    buffer_load_dwordx4 a[4:7], v9, s[12:15], s37 offen sc1
    v_mfma_f32_16x16x32_bf16 v[96:99], v[40:43], a[32:35], v[96:99]
    s_add_u32 m0, s35, 2048
    ds_read_b64_tr_b16 v[56:57], v6 offset:12288
    v_mfma_f32_16x16x32_bf16 v[100:103], v[40:43], a[36:39], v[100:103]
    buffer_load_dwordx4 v14, s[4:7], s36 offen lds
    v_mfma_f32_16x16x32_bf16 v[104:107], v[40:43], a[40:43], v[104:107]
    ds_read_b64_tr_b16 v[58:59], v6 offset:14336
    v_mfma_f32_16x16x32_bf16 v[108:111], v[40:43], a[44:47], v[108:111]
    buffer_load_dwordx4 a[8:11], v10, s[12:15], s37 offen sc1
    v_mfma_f32_16x16x32_bf16 v[112:115], v[44:47], a[32:35], v[112:115]
    s_add_u32 m0, s35, 3072
    ds_read_b64_tr_b16 v[60:61], v7 offset:12288
    v_mfma_f32_16x16x32_bf16 v[116:119], v[44:47], a[36:39], v[116:119]
    buffer_load_dwordx4 v15, s[4:7], s36 offen lds
    v_mfma_f32_16x16x32_bf16 v[120:123], v[44:47], a[40:43], v[120:123]
    ds_read_b64_tr_b16 v[62:63], v7 offset:14336
    v_mfma_f32_16x16x32_bf16 v[124:127], v[44:47], a[44:47], v[124:127]
    buffer_load_dwordx4 a[12:15], v11, s[12:15], s37 offen sc1
    s_add_u32 s36, s36, 28672
    s_add_u32 s37, s37, 1024
    s_waitcnt vmcnt(32) lgkmcnt(0)
    v_mfma_f32_16x16x32_bf16 v[64:67], v[48:51], a[48:51], v[64:67]
    s_add_u32 m0, s35, 4096
    ds_read_b64_tr_b16 v[32:33], v4 offset:16384
    v_mfma_f32_16x16x32_bf16 v[68:71], v[48:51], a[52:55], v[68:71]
    buffer_load_dwordx4 v3, s[4:7], s36 offen lds
    v_mfma_f32_16x16x32_bf16 v[72:75], v[48:51], a[56:59], v[72:75]
    ds_read_b64_tr_b16 v[34:35], v4 offset:18432
    v_mfma_f32_16x16x32_bf16 v[76:79], v[48:51], a[60:63], v[76:79]
    buffer_load_dwordx4 a[16:19], v1, s[12:15], s37 offen sc1
    v_mfma_f32_16x16x32_bf16 v[80:83], v[52:55], a[48:51], v[80:83]
    s_add_u32 m0, s35, 5120
    ds_read_b64_tr_b16 v[36:37], v5 offset:16384
    v_mfma_f32_16x16x32_bf16 v[84:87], v[52:55], a[52:55], v[84:87]
    buffer_load_dwordx4 v13, s[4:7], s36 offen lds
    v_mfma_f32_16x16x32_bf16 v[88:91], v[52:55], a[56:59], v[88:91]
    ds_read_b64_tr_b16 v[38:39], v5 offset:18432
    v_mfma_f32_16x16x32_bf16 v[92:95], v[52:55], a[60:63], v[92:95]
    buffer_load_dwordx4 a[20:23], v9, s[12:15], s37 offen sc1
    v_mfma_f32_16x16x32_bf16 v[96:99], v[56:59], a[48:51], v[96:99]
    s_add_u32 m0, s35, 6144
    ds_read_b64_tr_b16 v[40:41], v6 offset:16384
    v_mfma_f32_16x16x32_bf16 v[100:103], v[56:59], a[52:55], v[100:103]
    buffer_load_dwordx4 v14, s[4:7], s36 offen lds
    v_mfma_f32_16x16x32_bf16 v[104:107], v[56:59], a[56:59], v[104:107]
    ds_read_b64_tr_b16 v[42:43], v6 offset:18432
    v_mfma_f32_16x16x32_bf16 v[108:111], v[56:59], a[60:63], v[108:111]
    buffer_load_dwordx4 a[24:27], v10, s[12:15], s37 offen sc1
    v_mfma_f32_16x16x32_bf16 v[112:115], v[60:63], a[48:51], v[112:115]
    s_add_u32 m0, s35, 7168
    ds_read_b64_tr_b16 v[44:45], v7 offset:16384
    v_mfma_f32_16x16x32_bf16 v[116:119], v[60:63], a[52:55], v[116:119]
    buffer_load_dwordx4 v15, s[4:7], s36 offen lds
    v_mfma_f32_16x16x32_bf16 v[120:123], v[60:63], a[56:59], v[120:123]
    ds_read_b64_tr_b16 v[46:47], v7 offset:18432
    v_mfma_f32_16x16x32_bf16 v[124:127], v[60:63], a[60:63], v[124:127]
    buffer_load_dwordx4 a[28:31], v11, s[12:15], s37 offen sc1
    s_add_u32 s36, s36, 28672
    s_add_u32 s37, s37, 1024
    s_waitcnt vmcnt(32) lgkmcnt(0)
    v_mfma_f32_16x16x32_bf16 v[64:67], v[32:35], a[64:67], v[64:67]
    s_add_u32 m0, s35, 8192
    ds_read_b64_tr_b16 v[48:49], v4 offset:20480
    v_mfma_f32_16x16x32_bf16 v[68:71], v[32:35], a[68:71], v[68:71]
    buffer_load_dwordx4 v3, s[4:7], s36 offen lds
    v_mfma_f32_16x16x32_bf16 v[72:75], v[32:35], a[72:75], v[72:75]
    ds_read_b64_tr_b16 v[50:51], v4 offset:22528
    v_mfma_f32_16x16x32_bf16 v[76:79], v[32:35], a[76:79], v[76:79]
    buffer_load_dwordx4 a[32:35], v1, s[12:15], s37 offen sc1
    v_mfma_f32_16x16x32_bf16 v[80:83], v[36:39], a[64:67], v[80:83]
    s_add_u32 m0, s35, 9216
    ds_read_b64_tr_b16 v[52:53], v5 offset:20480
    v_mfma_f32_16x16x32_bf16 v[84:87], v[36:39], a[68:71], v[84:87]
    buffer_load_dwordx4 v13, s[4:7], s36 offen lds
    v_mfma_f32_16x16x32_bf16 v[88:91], v[36:39], a[72:75], v[88:91]
    ds_read_b64_tr_b16 v[54:55], v5 offset:22528
    v_mfma_f32_16x16x32_bf16 v[92:95], v[36:39], a[76:79], v[92:95]
    buffer_load_dwordx4 a[36:39], v9, s[12:15], s37 offen sc1
    v_mfma_f32_16x16x32_bf16 v[96:99], v[40:43], a[64:67], v[96:99]
    s_add_u32 m0, s35, 10240
    ds_read_b64_tr_b16 v[56:57], v6 offset:20480
    v_mfma_f32_16x16x32_bf16 v[100:103], v[40:43], a[68:71], v[100:103]
    buffer_load_dwordx4 v14, s[4:7], s36 offen lds
    v_mfma_f32_16x16x32_bf16 v[104:107], v[40:43], a[72:75], v[104:107]
    ds_read_b64_tr_b16 v[58:59], v6 offset:22528
    v_mfma_f32_16x16x32_bf16 v[108:111], v[40:43], a[76:79], v[108:111]
    buffer_load_dwordx4 a[40:43], v10, s[12:15], s37 offen sc1
    v_mfma_f32_16x16x32_bf16 v[112:115], v[44:47], a[64:67], v[112:115]
    s_add_u32 m0, s35, 11264
    ds_read_b64_tr_b16 v[60:61], v7 offset:20480
    v_mfma_f32_16x16x32_bf16 v[116:119], v[44:47], a[68:71], v[116:119]
    buffer_load_dwordx4 v15, s[4:7], s36 offen lds
    v_mfma_f32_16x16x32_bf16 v[120:123], v[44:47], a[72:75], v[120:123]
    ds_read_b64_tr_b16 v[62:63], v7 offset:22528
    v_mfma_f32_16x16x32_bf16 v[124:127], v[44:47], a[76:79], v[124:127]
    buffer_load_dwordx4 a[44:47], v11, s[12:15], s37 offen sc1
    s_add_u32 s36, s36, 28672
    s_add_u32 s37, s37, 1024
    s_waitcnt vmcnt(32) lgkmcnt(0)
    v_mfma_f32_16x16x32_bf16 v[64:67], v[48:51], a[80:83], v[64:67]
    s_add_u32 m0, s35, 12288
    ds_read_b64_tr_b16 v[32:33], v4 offset:24576
    v_mfma_f32_16x16x32_bf16 v[68:71], v[48:51], a[84:87], v[68:71]
    buffer_load_dwordx4 v3, s[4:7], s36 offen lds
    v_mfma_f32_16x16x32_bf16 v[72:75], v[48:51], a[88:91], v[72:75]
    ds_read_b64_tr_b16 v[34:35], v4 offset:26624
    v_mfma_f32_16x16x32_bf16 v[76:79], v[48:51], a[92:95], v[76:79]
    buffer_load_dwordx4 a[48:51], v1, s[12:15], s37 offen sc1
    v_mfma_f32_16x16x32_bf16 v[80:83], v[52:55], a[80:83], v[80:83]
    s_add_u32 m0, s35, 13312
    ds_read_b64_tr_b16 v[36:37], v5 offset:24576
    v_mfma_f32_16x16x32_bf16 v[84:87], v[52:55], a[84:87], v[84:87]
    buffer_load_dwordx4 v13, s[4:7], s36 offen lds
    v_mfma_f32_16x16x32_bf16 v[88:91], v[52:55], a[88:91], v[88:91]
    ds_read_b64_tr_b16 v[38:39], v5 offset:26624
    v_mfma_f32_16x16x32_bf16 v[92:95], v[52:55], a[92:95], v[92:95]
    buffer_load_dwordx4 a[52:55], v9, s[12:15], s37 offen sc1
    v_mfma_f32_16x16x32_bf16 v[96:99], v[56:59], a[80:83], v[96:99]
    s_add_u32 m0, s35, 14336
    ds_read_b64_tr_b16 v[40:41], v6 offset:24576
    v_mfma_f32_16x16x32_bf16 v[100:103], v[56:59], a[84:87], v[100:103]
    buffer_load_dwordx4 v14, s[4:7], s36 offen lds
    v_mfma_f32_16x16x32_bf16 v[104:107], v[56:59], a[88:91], v[104:107]
    ds_read_b64_tr_b16 v[42:43], v6 offset:26624
    v_mfma_f32_16x16x32_bf16 v[108:111], v[56:59], a[92:95], v[108:111]
    buffer_load_dwordx4 a[56:59], v10, s[12:15], s37 offen sc1
    v_mfma_f32_16x16x32_bf16 v[112:115], v[60:63], a[80:83], v[112:115]
    s_add_u32 m0, s35, 15360
    ds_read_b64_tr_b16 v[44:45], v7 offset:24576
    v_mfma_f32_16x16x32_bf16 v[116:119], v[60:63], a[84:87], v[116:119]
    buffer_load_dwordx4 v15, s[4:7], s36 offen lds
    v_mfma_f32_16x16x32_bf16 v[120:123], v[60:63], a[88:91], v[120:123]
    ds_read_b64_tr_b16 v[46:47], v7 offset:26624
    v_mfma_f32_16x16x32_bf16 v[124:127], v[60:63], a[92:95], v[124:127]
    buffer_load_dwordx4 a[60:63], v11, s[12:15], s37 offen sc1
    s_add_u32 s36, s36, 28672
    s_add_u32 s37, s37, 1024
    s_waitcnt vmcnt(32) lgkmcnt(0)
    v_mfma_f32_16x16x32_bf16 v[64:67], v[32:35], a[96:99], v[64:67]
    s_add_u32 m0, s35, 16384
    ds_read_b64_tr_b16 v[48:49], v4 offset:28672
    v_mfma_f32_16x16x32_bf16 v[68:71], v[32:35], a[100:103], v[68:71]
    buffer_load_dwordx4 v3, s[4:7], s36 offen lds
    v_mfma_f32_16x16x32_bf16 v[72:75], v[32:35], a[104:107], v[72:75]
    ds_read_b64_tr_b16 v[50:51], v4 offset:30720
    v_mfma_f32_16x16x32_bf16 v[76:79], v[32:35], a[108:111], v[76:79]
    buffer_load_dwordx4 a[64:67], v1, s[12:15], s37 offen sc1
    v_mfma_f32_16x16x32_bf16 v[80:83], v[36:39], a[96:99], v[80:83]
    s_add_u32 m0, s35, 17408
    ds_read_b64_tr_b16 v[52:53], v5 offset:28672
    v_mfma_f32_16x16x32_bf16 v[84:87], v[36:39], a[100:103], v[84:87]
    buffer_load_dwordx4 v13, s[4:7], s36 offen lds
    v_mfma_f32_16x16x32_bf16 v[88:91], v[36:39], a[104:107], v[88:91]
    ds_read_b64_tr_b16 v[54:55], v5 offset:30720
    v_mfma_f32_16x16x32_bf16 v[92:95], v[36:39], a[108:111], v[92:95]
    buffer_load_dwordx4 a[68:71], v9, s[12:15], s37 offen sc1
    v_mfma_f32_16x16x32_bf16 v[96:99], v[40:43], a[96:99], v[96:99]
    s_add_u32 m0, s35, 18432
    ds_read_b64_tr_b16 v[56:57], v6 offset:28672
    v_mfma_f32_16x16x32_bf16 v[100:103], v[40:43], a[100:103], v[100:103]
    buffer_load_dwordx4 v14, s[4:7], s36 offen lds
    v_mfma_f32_16x16x32_bf16 v[104:107], v[40:43], a[104:107], v[104:107]
    ds_read_b64_tr_b16 v[58:59], v6 offset:30720
    v_mfma_f32_16x16x32_bf16 v[108:111], v[40:43], a[108:111], v[108:111]
    buffer_load_dwordx4 a[72:75], v10, s[12:15], s37 offen sc1
    v_mfma_f32_16x16x32_bf16 v[112:115], v[44:47], a[96:99], v[112:115]
    s_add_u32 m0, s35, 19456
    ds_read_b64_tr_b16 v[60:61], v7 offset:28672
    v_mfma_f32_16x16x32_bf16 v[116:119], v[44:47], a[100:103], v[116:119]
    buffer_load_dwordx4 v15, s[4:7], s36 offen lds
    v_mfma_f32_16x16x32_bf16 v[120:123], v[44:47], a[104:107], v[120:123]
    ds_read_b64_tr_b16 v[62:63], v7 offset:30720
    v_mfma_f32_16x16x32_bf16 v[124:127], v[44:47], a[108:111], v[124:127]
    buffer_load_dwordx4 a[76:79], v11, s[12:15], s37 offen sc1
    s_add_u32 s36, s36, 28672
    s_add_u32 s37, s37, 1024
    s_waitcnt vmcnt(32) lgkmcnt(0)
    v_mfma_f32_16x16x32_bf16 v[64:67], v[48:51], a[112:115], v[64:67]
    s_add_u32 m0, s35, 20480
    ds_read_b64_tr_b16 v[32:33], v4 offset:0
    v_mfma_f32_16x16x32_bf16 v[68:71], v[48:51], a[116:119], v[68:71]
    buffer_load_dwordx4 v3, s[4:7], s36 offen lds
    v_mfma_f32_16x16x32_bf16 v[72:75], v[48:51], a[120:123], v[72:75]
    ds_read_b64_tr_b16 v[34:35], v4 offset:2048
    v_mfma_f32_16x16x32_bf16 v[76:79], v[48:51], a[124:127], v[76:79]
    buffer_load_dwordx4 a[80:83], v1, s[12:15], s37 offen sc1
    v_mfma_f32_16x16x32_bf16 v[80:83], v[52:55], a[112:115], v[80:83]
    s_add_u32 m0, s35, 21504
    ds_read_b64_tr_b16 v[36:37], v5 offset:0
    v_mfma_f32_16x16x32_bf16 v[84:87], v[52:55], a[116:119], v[84:87]
    buffer_load_dwordx4 v13, s[4:7], s36 offen lds
    v_mfma_f32_16x16x32_bf16 v[88:91], v[52:55], a[120:123], v[88:91]
    ds_read_b64_tr_b16 v[38:39], v5 offset:2048
    v_mfma_f32_16x16x32_bf16 v[92:95], v[52:55], a[124:127], v[92:95]
    buffer_load_dwordx4 a[84:87], v9, s[12:15], s37 offen sc1
    v_mfma_f32_16x16x32_bf16 v[96:99], v[56:59], a[112:115], v[96:99]
    s_add_u32 m0, s35, 22528
    ds_read_b64_tr_b16 v[40:41], v6 offset:0
    v_mfma_f32_16x16x32_bf16 v[100:103], v[56:59], a[116:119], v[100:103]
    buffer_load_dwordx4 v14, s[4:7], s36 offen lds
    v_mfma_f32_16x16x32_bf16 v[104:107], v[56:59], a[120:123], v[104:107]
    ds_read_b64_tr_b16 v[42:43], v6 offset:2048
    v_mfma_f32_16x16x32_bf16 v[108:111], v[56:59], a[124:127], v[108:111]
    buffer_load_dwordx4 a[88:91], v10, s[12:15], s37 offen sc1
    v_mfma_f32_16x16x32_bf16 v[112:115], v[60:63], a[112:115], v[112:115]
    s_add_u32 m0, s35, 23552
    ds_read_b64_tr_b16 v[44:45], v7 offset:0
    v_mfma_f32_16x16x32_bf16 v[116:119], v[60:63], a[116:119], v[116:119]
    buffer_load_dwordx4 v15, s[4:7], s36 offen lds
    v_mfma_f32_16x16x32_bf16 v[120:123], v[60:63], a[120:123], v[120:123]
    ds_read_b64_tr_b16 v[46:47], v7 offset:2048
    v_mfma_f32_16x16x32_bf16 v[124:127], v[60:63], a[124:127], v[124:127]
    buffer_load_dwordx4 a[92:95], v11, s[12:15], s37 offen sc1
    s_add_u32 s36, s36, 28672
    s_add_u32 s37, s37, 1024
    s_add_u32 s42, s42, 1
    s_cmp_lt_u32 s42, 4
    s_cbranch_scc1 L_oloop
    s_lshl_b32 s44, s34, 6
    s_add_u32 s44, s44, 84963328
    s_waitcnt lgkmcnt(0)
    v_and_b32 v16, 15, v0
    v_lshlrev_b32 v16, 2, v16
    s_mov_b32 s32, 0
L_poll9:
    buffer_load_dword v17, v16, s[12:15], s44 offen sc1
    s_waitcnt vmcnt(0)
    v_cmp_ne_u32 vcc, 1, v17
    s_cbranch_vccz L_poll9_ok
    s_sleep 2
    s_add_u32 s32, s32, 1
    s_cmp_lt_u32 s32, 0x80000
    s_cbranch_scc1 L_poll9
L_poll9_ok:
    v_lshrrev_b32 v8, 3, v0
    v_lshlrev_b32 v8, 12, v8
    v_and_b32 v9, 7, v0
    v_lshl_add_u32 v8, v9, 4, v8
    s_lshl_b32 s44, s34, 2
    s_add_u32 s44, s44, s3
    s_lshl_b32 s44, s44, 16
    s_lshl_b32 s45, s33, 7
    s_add_u32 s44, s44, s45
    s_add_u32 s44, s44, 90177536
    s_lshl_b32 s45, s3, 11
    s_add_u32 m0, s45, 0x20000
    s_nop 0
    buffer_load_dwordx4 v8, s[12:15], s44 offen sc1 lds
    s_add_u32 m0, s45, 0x20400
    s_add_u32 s44, s44, 0x8000
    buffer_load_dwordx4 v8, s[12:15], s44 offen sc1 lds
    s_lshl_b32 s44, s33, 6
    s_lshl_b32 s45, s3, 4
    s_add_u32 s44, s44, s45
    v_and_b32 v9, 15, v0
    v_add_u32 v9, s44, v9
    v_mul_u32_u24 v9, 896, v9
    v_lshrrev_b32 v10, 4, v0
    v_lshlrev_b32 v10, 4, v10
    v_add_u32 v10, s41, v10
    v_add_u32 v11, v9, v10
    v_lshl_add_u32 v12, v9, 1, v10
    buffer_load_dwordx4 v[16:19], v11, s[16:19], 0 offen offset:0
    buffer_load_dwordx4 v[20:23], v11, s[16:19], 0 offen offset:64
    v_and_b32 v9, 15, v0
    v_mul_u32_u24 v9, 272, v9
    v_lshrrev_b32 v10, 4, v0
    v_lshl_add_u32 v9, v10, 4, v9
    v_add_u32 v9, s35, v9
    ds_write_b128 v9, v[64:67] offset:0
    ds_write_b128 v9, v[68:71] offset:4352
    ds_write_b128 v9, v[72:75] offset:8704
    ds_write_b128 v9, v[76:79] offset:13056
    ds_write_b128 v9, v[80:83] offset:64
    ds_write_b128 v9, v[84:87] offset:4416
    ds_write_b128 v9, v[88:91] offset:8768
    ds_write_b128 v9, v[92:95] offset:13120
    ds_write_b128 v9, v[96:99] offset:128
    ds_write_b128 v9, v[100:103] offset:4480
    ds_write_b128 v9, v[104:107] offset:8832
    ds_write_b128 v9, v[108:111] offset:13184
    ds_write_b128 v9, v[112:115] offset:192
    ds_write_b128 v9, v[116:119] offset:4544
    ds_write_b128 v9, v[120:123] offset:8896
    ds_write_b128 v9, v[124:127] offset:13248
    v_lshrrev_b32 v9, 3, v0
    v_add_u32 v9, s45, v9
    v_mul_u32_u24 v13, 272, v9
    v_and_b32 v10, 7, v0
    v_lshl_add_u32 v13, v10, 5, v13
    v_add_u32 v14, 0x10000, v13
    s_lshl_b32 s44, s33, 6
    v_add_u32 v9, s44, v9
    v_mul_u32_u24 v9, 1792, v9
    v_lshl_add_u32 v9, v10, 4, v9
    s_add_u32 s46, s41, 896
    s_add_u32 s47, s46, 14336
    v_lshrrev_b32 v10, 4, v0
    v_lshlrev_b32 v10, 3, v10
    v_bfe_u32 v15, v0, 2, 2
    v_add_u32 v10, v10, v15
    v_lshlrev_b32 v10, 7, v10
    v_and_b32 v15, 3, v0
    v_lshl_add_u32 v10, v15, 3, v10
    s_lshl_b32 s48, s3, 5
    s_add_u32 s48, s48, 0x20000
    v_add_u32 v10, s48, v10
    s_mov_b32 s49, 0xffff0000
    s_waitcnt vmcnt(0) lgkmcnt(0)
    s_barrier
    ds_read_b64_tr_b16 v[24:25], v10 offset:0
    ds_read_b64_tr_b16 v[26:27], v10 offset:512
    ds_read_b64_tr_b16 v[28:29], v10 offset:4096
    ds_read_b64_tr_b16 v[30:31], v10 offset:4608
    ds_read_b128 v[64:67], v13 offset:0
    ds_read_b128 v[68:71], v13 offset:16
    ds_read_b128 v[72:75], v13 offset:32768
    ds_read_b128 v[76:79], v13 offset:32784
    ds_read_b128 v[80:83], v14 offset:0
    ds_read_b128 v[84:87], v14 offset:16
    ds_read_b128 v[88:91], v14 offset:32768
    ds_read_b128 v[92:95], v14 offset:32784
    s_waitcnt lgkmcnt(8)
    ds_read_b128 v[96:99], v13 offset:2176
    ds_read_b128 v[100:103], v13 offset:2192
    ds_read_b128 v[104:107], v13 offset:34944
    ds_read_b128 v[108:111], v13 offset:34960
    ds_read_b128 v[112:115], v14 offset:2176
    ds_read_b128 v[116:119], v14 offset:2192
    ds_read_b128 v[120:123], v14 offset:34944
    ds_read_b128 v[124:127], v14 offset:34960
    v_lshlrev_b32 v32, 16, v16
    v_lshlrev_b32 v33, 16, v24
    v_and_b32 v34, s49, v16
    v_and_b32 v35, s49, v24
    v_mul_f32 v32, v32, v33
    v_mul_f32 v34, v34, v35
    v_cvt_pk_bf16_f32 v40, v32, v34
    v_lshlrev_b32 v32, 16, v17
    v_lshlrev_b32 v33, 16, v25
    v_and_b32 v34, s49, v17
    v_and_b32 v35, s49, v25
    v_mul_f32 v32, v32, v33
    v_mul_f32 v34, v34, v35
    v_cvt_pk_bf16_f32 v41, v32, v34
    v_lshlrev_b32 v32, 16, v18
    v_lshlrev_b32 v33, 16, v26
    v_and_b32 v34, s49, v18
    v_and_b32 v35, s49, v26
    v_mul_f32 v32, v32, v33
    v_mul_f32 v34, v34, v35
    v_cvt_pk_bf16_f32 v42, v32, v34
    v_lshlrev_b32 v32, 16, v19
    v_lshlrev_b32 v33, 16, v27
    v_and_b32 v34, s49, v19
    v_and_b32 v35, s49, v27
    v_mul_f32 v32, v32, v33
    v_mul_f32 v34, v34, v35
    v_cvt_pk_bf16_f32 v43, v32, v34
    buffer_store_dwordx4 v[40:43], v12, s[8:11], 0 offen offset:0
    v_lshlrev_b32 v32, 16, v20
    v_lshlrev_b32 v33, 16, v28
    v_and_b32 v34, s49, v20
    v_and_b32 v35, s49, v28
    v_mul_f32 v32, v32, v33
    v_mul_f32 v34, v34, v35
    v_cvt_pk_bf16_f32 v44, v32, v34
    v_lshlrev_b32 v32, 16, v21
    v_lshlrev_b32 v33, 16, v29
    v_and_b32 v34, s49, v21
    v_and_b32 v35, s49, v29
    v_mul_f32 v32, v32, v33
    v_mul_f32 v34, v34, v35
    v_cvt_pk_bf16_f32 v45, v32, v34
    v_lshlrev_b32 v32, 16, v22
    v_lshlrev_b32 v33, 16, v30
    v_and_b32 v34, s49, v22
    v_and_b32 v35, s49, v30
    v_mul_f32 v32, v32, v33
    v_mul_f32 v34, v34, v35
    v_cvt_pk_bf16_f32 v46, v32, v34
    v_lshlrev_b32 v32, 16, v23
    v_lshlrev_b32 v33, 16, v31
    v_and_b32 v34, s49, v23
    v_and_b32 v35, s49, v31
    v_mul_f32 v32, v32, v33
    v_mul_f32 v34, v34, v35
    v_cvt_pk_bf16_f32 v47, v32, v34
    buffer_store_dwordx4 v[44:47], v12, s[8:11], 0 offen offset:64
    s_waitcnt lgkmcnt(0)
    v_pk_add_f32 v[64:65], v[64:65], v[72:73]
    v_pk_add_f32 v[80:81], v[80:81], v[88:89]
    v_pk_add_f32 v[64:65], v[64:65], v[80:81]
    v_pk_add_f32 v[66:67], v[66:67], v[74:75]
    v_pk_add_f32 v[82:83], v[82:83], v[90:91]
    v_pk_add_f32 v[66:67], v[66:67], v[82:83]
    v_pk_add_f32 v[68:69], v[68:69], v[76:77]
    v_pk_add_f32 v[84:85], v[84:85], v[92:93]
    v_pk_add_f32 v[68:69], v[68:69], v[84:85]
    v_pk_add_f32 v[70:71], v[70:71], v[78:79]
    v_pk_add_f32 v[86:87], v[86:87], v[94:95]
    v_pk_add_f32 v[70:71], v[70:71], v[86:87]
    v_cvt_pk_bf16_f32 v48, v64, v65
    v_cvt_pk_bf16_f32 v49, v66, v67
    v_cvt_pk_bf16_f32 v50, v68, v69
    v_cvt_pk_bf16_f32 v51, v70, v71
    buffer_store_dwordx4 v[48:51], v9, s[8:11], s46 offen
    v_pk_add_f32 v[96:97], v[96:97], v[104:105]
    v_pk_add_f32 v[112:113], v[112:113], v[120:121]
    v_pk_add_f32 v[96:97], v[96:97], v[112:113]
    v_pk_add_f32 v[98:99], v[98:99], v[106:107]
    v_pk_add_f32 v[114:115], v[114:115], v[122:123]
    v_pk_add_f32 v[98:99], v[98:99], v[114:115]
    v_pk_add_f32 v[100:101], v[100:101], v[108:109]
    v_pk_add_f32 v[116:117], v[116:117], v[124:125]
    v_pk_add_f32 v[100:101], v[100:101], v[116:117]
    v_pk_add_f32 v[102:103], v[102:103], v[110:111]
    v_pk_add_f32 v[118:119], v[118:119], v[126:127]
    v_pk_add_f32 v[102:103], v[102:103], v[118:119]
    v_cvt_pk_bf16_f32 v52, v96, v97
    v_cvt_pk_bf16_f32 v53, v98, v99
    v_cvt_pk_bf16_f32 v54, v100, v101
    v_cvt_pk_bf16_f32 v55, v102, v103
    buffer_store_dwordx4 v[52:55], v9, s[8:11], s47 offen
L_fin:
    s_endpgm
L_codeend:
.section .rodata,"a"
.p2align 6
.amdhsa_kernel concat_heads__ssm_conv_h3__compressed_kv_cla__prompt_kernel
  .amdhsa_next_free_vgpr 512
  .amdhsa_next_free_sgpr 102
  .amdhsa_accum_offset 256
  .amdhsa_group_segment_fixed_size 0
  .amdhsa_kernarg_size 120
  .amdhsa_user_sgpr_count 2
  .amdhsa_user_sgpr_kernarg_segment_ptr 1
  .amdhsa_system_sgpr_workgroup_id_x 1
.end_amdhsa_kernel
```

```asm
; @launch grid=(256,1,1) block=(256,1,1) lds=163840
.amdgcn_target "amdgcn-amd-amdhsa--gfx950"
.text
.globl concat_heads__ssm_conv_h3__compressed_kv_cla__prompt_kernel
.p2align 8
.type concat_heads__ssm_conv_h3__compressed_kv_cla__prompt_kernel,@function
concat_heads__ssm_conv_h3__compressed_kv_cla__prompt_kernel:
    s_cmp_lt_u32 s2, 256
    s_cbranch_scc1 L_go
    s_endpgm
L_go:
    s_load_dwordx16 s[64:79], s[0:1], 0
    s_load_dwordx8 s[80:87], s[0:1], 64
    s_load_dwordx4 s[88:91], s[0:1], 96
    s_load_dwordx2 s[12:13], s[0:1], 112
    v_lshrrev_b32 v1, 6, v0
    v_and_b32 v0, 63, v0
    v_readfirstlane_b32 s3, v1
    s_and_b32 s24, s2, 7
    s_bfe_u32 s25, s2, 0x30003
    s_bfe_u32 s26, s2, 0x10006
    s_lshl_b32 s37, s24, 1
    s_add_u32 s26, s26, s37
    s_lshr_b32 s27, s2, 7
    s_bfe_u32 s28, s2, 0x40003
    s_lshl_b32 s29, s3, 10
    s_and_b32 s39, s3, 1
    s_lshr_b32 s40, s3, 1
    s_getpc_b64 s[100:101]
L_pc:
    s_sub_u32 s100, s100, L_pc-L_go
    s_subb_u32 s101, s101, 0
    s_lshr_b32 s32, s2, 1
    s_and_b32 s32, s32, 12
    s_add_u32 s32, s32, s3
    s_lshl_b32 s32, s32, 13
    v_lshlrev_b32 v14, 7, v0
    v_add_u32 v14, s32, v14
    v_min_u32 v14, L_codeend-L_go-4, v14
    v_accvgpr_write_b32 a244, v14
    global_load_dword a243, v14, s[100:101]
    s_mov_b32 s41, 65536
    s_mov_b32 s48, 32768
    s_mov_b32 s42, 131072
    s_mov_b32 s49, 131072
    s_mov_b32 s43, 196608
    s_mov_b32 s50, 163840
    s_mov_b32 s44, 262144
    s_mov_b32 s51, 262144
    s_mov_b32 s45, 327680
    s_mov_b32 s52, 294912
    s_mov_b32 s46, 393216
    s_mov_b32 s53, 393216
    s_mov_b32 s47, 458752
    s_mov_b32 s54, 425984
    s_lshl_b32 s56, s39, 1
    s_lshl_b32 s57, s40, 3
    s_add_u32 s56, s56, s57
    s_lshl_b32 s60, s25, 8
    s_lshl_b32 s58, s3, 3
    s_add_u32 s58, s58, s60
    v_lshrrev_b32 v14, 3, v0
    v_add_u32 v14, s58, v14
    v_lshlrev_b32 v14, 11, v14
    s_lshl_b32 s58, s39, 2
    v_lshrrev_b32 v15, 4, v0
    v_add_u32 v15, s58, v15
    v_xor_b32 v15, v0, v15
    v_and_b32 v15, 7, v15
    v_lshl_add_u32 v1, v15, 4, v14
    v_lshrrev_b32 v14, 5, v0
    s_lshl_b32 s58, s3, 1
    v_add_u32 v15, s58, v14
    v_lshlrev_b32 v15, 1, v15
    v_xor_b32 v15, v0, v15
    v_and_b32 v15, 31, v15
    v_lshlrev_b32 v15, 4, v15
    v_add_u32 v14, s56, v14
    v_lshl_add_u32 v14, v14, 13, v15
    s_lshl_b32 s58, s26, 9
    v_add_u32 v2, s58, v14
    s_lshl_b32 s31, s25, 16
    s_add_u32 s31, s31, s58
    v_lshrrev_b32 v15, 3, v0
    v_lshlrev_b32 v15, 13, v15
    v_and_b32 v14, 7, v0
    v_lshlrev_b32 v14, 6, v14
    v_add3_u32 v16, v14, v15, s31
    s_lshl_b32 s31, s25, 2
    s_lshr_b32 s32, s2, 6
    s_add_u32 s31, s31, s32
    s_lshl_b32 s31, s31, 17
    v_lshlrev_b32 v17, 11, v0
    v_add_u32 v17, s31, v17
    s_cmp_eq_u32 s3, 0
    s_cselect_b32 s30, 0x80000, 2.0
    s_cmp_eq_u32 s3, 1
    s_cselect_b32 s31, 128, 2.0
    s_waitcnt lgkmcnt(0)
    s_cmp_eq_u32 s27, 0
    s_cselect_b32 s8, s82, s84
    s_cselect_b32 s9, s83, s85
    s_mov_b32 s10, 8388608
    s_mov_b32 s11, 0x20000
    s_mov_b32 s4, s78
    s_mov_b32 s5, s79
    s_mov_b32 s6, 4194304
    s_mov_b32 s7, 0x20000
    s_mov_b32 s14, 268435456
    s_mov_b32 s15, 0x20000
    s_add_u32 m0, s29, 65536
    s_nop 0
    buffer_load_dwordx4 v2, s[8:11], 0 offen lds
    s_lshl_b32 s58, s27, 3
    s_add_u32 s59, s58, s25
    s_lshl_b32 s59, s59, 2
    s_lshl_b32 s92, s26, 7
    s_add_u32 s92, s92, s59
    s_add_u32 s92, s92, 84934656
    s_add_u32 s58, s58, s24
    s_mul_i32 s95, s58, 14
    s_add_u32 s95, s95, s28
    s_sub_u32 s63, 15, s25
    s_cmp_eq_u32 s27, 0
    s_cselect_b32 s63, s25, s63
    s_add_u32 m0, s29, 0
    s_nop 0
    buffer_load_dwordx4 v1, s[4:7], 0 offen lds
    s_lshl_b32 s93, s63, 7
    s_lshl_b32 s59, s26, 2
    s_add_u32 s93, s93, s59
    s_add_u32 s93, s93, 84938752
    s_and_b32 s94, s2, 127
    s_lshl_b32 s94, s94, 7
    s_add_u32 s94, s94, 84942848
    s_cmp_lg_u32 s3, 0
    s_cbranch_scc1 L_noclr
    s_lshl_b32 s58, s95, 2
    s_add_u32 s59, s58, 84963328
    s_add_u32 s58, s58, 84959232
    s_lshl_b32 s61, s27, 2
    s_add_u32 s61, s61, s94
    s_cmp_lt_u32 s28, 14
    s_cselect_b32 s58, s58, s92
    s_cselect_b32 s59, s59, s92
    v_mov_b32 v14, s92
    v_writelane_b32 v14, s93, 1
    v_writelane_b32 v14, s61, 2
    v_writelane_b32 v14, s58, 3
    v_writelane_b32 v14, s59, 4
    v_mov_b32 v15, 1
    s_mov_b64 exec, 31
    buffer_store_dword v15, v14, s[12:15], 0 offen sc1
    s_mov_b64 exec, -1
L_noclr:
    s_add_u32 m0, s29, 69632
    s_nop 0
    buffer_load_dwordx4 v2, s[8:11], s48 offen lds
    s_add_u32 m0, s29, 4096
    s_nop 0
    buffer_load_dwordx4 v1, s[4:7], s41 offen lds
    s_cmp_eq_u32 s3, 0
    s_cselect_b32 s58, 0, 0x80000000
    v_bfrev_b32 v14, 1
    v_writelane_b32 v14, s58, 0
    v_accvgpr_write_b32 a245, v14
    s_lshl_b32 s58, s39, 7
    s_lshl_b32 s59, s40, 3
    v_and_b32 v14, 15, v0
    v_lshrrev_b32 v15, 4, v0
    s_add_u32 m0, s29, 73728
    s_nop 0
    buffer_load_dwordx4 v2, s[8:11], s49 offen lds
    s_lshl_b32 s60, s63, 7
    s_lshl_b32 s62, s3, 4
    s_add_u32 s60, s60, s62
    v_lshrrev_b32 v13, 3, v0
    v_lshlrev_b32 v13, 1, v13
    v_add_u32 v12, s60, v13
    v_mul_u32_u24 v12, 896, v12
    v_lshrrev_b32 v13, 1, v13
    v_xor_b32 v13, v0, v13
    v_and_b32 v13, 7, v13
    v_lshl_add_u32 v13, v13, 4, v12
    v_accvgpr_write_b32 a240, v13
    s_add_u32 m0, s29, 8192
    s_nop 0
    buffer_load_dwordx4 v1, s[4:7], s42 offen lds
    v_lshrrev_b32 v13, 1, v14
    v_xor_b32 v12, v13, v15
    v_lshlrev_b32 v12, 4, v12
    v_lshl_add_u32 v12, v13, 7, v12
    v_and_b32 v13, 1, v14
    v_lshl_add_u32 v12, v13, 10, v12
    s_lshl_b32 s33, s3, 13
    s_add_u32 s33, s33, 0x20000
    v_add_u32 v12, s33, v12
    v_accvgpr_write_b32 a242, v12
    v_lshrrev_b32 v5, 1, v14
    v_xor_b32 v5, v5, v15
    s_add_u32 m0, s29, 77824
    s_nop 0
    buffer_load_dwordx4 v2, s[8:11], s50 offen lds
    v_add_u32 v14, s58, v14
    v_lshlrev_b32 v14, 7, v14
    v_lshl_add_u32 v4, v5, 4, v14
    v_xor_b32 v5, 64, v4
    v_bfe_u32 v14, v0, 2, 3
    v_lshrrev_b32 v15, 5, v0
    v_lshl_add_u32 v13, v15, 4, v14
    v_lshlrev_b32 v13, 9, v13
    v_xor_b32 v14, s59, v14
    v_lshl_add_u32 v13, v14, 5, v13
    v_and_b32 v14, 3, v0
    v_lshl_add_u32 v13, v14, 3, v13
    s_add_u32 m0, s29, 12288
    s_nop 0
    buffer_load_dwordx4 v1, s[4:7], s43 offen lds
    v_add_u32 v6, 0x10000, v13
    v_xor_b32 v7, 32, v6
    v_xor_b32 v8, 64, v6
    v_xor_b32 v9, 96, v6
    v_xor_b32 v10, 128, v6
    v_xor_b32 v11, 160, v6
    v_xor_b32 v12, 192, v6
    v_xor_b32 v13, 224, v6
    s_mov_b32 s16, s80
    s_mov_b32 s17, s81
    s_mov_b32 s18, 3670016
    s_add_u32 m0, s29, 81920
    s_nop 0
    buffer_load_dwordx4 v2, s[8:11], s51 offen lds
    s_mov_b32 s19, 0x20000
    s_mov_b32 s20, s76
    s_mov_b32 s21, s77
    s_mov_b32 s22, 1835008
    s_mov_b32 s23, 0x20000
    s_lshl_b32 s58, s26, 20
    s_lshl_b32 s62, s63, 16
    s_add_u32 s62, s62, s58
    s_lshl_b32 s59, s3, 13
    s_add_u32 s62, s62, s59
    s_add_u32 s62, s62, 33554432
    s_lshl_b32 s59, s25, 17
    s_add_u32 m0, s29, 16384
    s_nop 0
    buffer_load_dwordx4 v1, s[4:7], s44 offen lds
    s_add_u32 s58, s58, s59
    s_lshl_b32 s59, s39, 16
    s_add_u32 s58, s58, s59
    s_lshl_b32 s59, s40, 12
    s_lshl_b32 s59, s59, s27
    s_add_u32 s58, s58, s59
    s_lshl_b32 s59, s27, 24
    s_add_u32 s58, s58, s59
    s_mov_b32 s57, 57344
    s_lshl_b32 s60, s40, 8
    s_add_u32 s60, s60, 0x10000
    s_mov_b32 s34, 0x3db8aa3b
    s_add_u32 m0, s29, 86016
    s_nop 0
    buffer_load_dwordx4 v2, s[8:11], s52 offen lds
    s_mov_b32 s35, 0x3db8aa3b
    s_mul_i32 s55, s25, 6
    s_lshr_b32 s55, s55, 3
    s_cmp_lg_u32 s3, 0
    s_cmov_b32 s55, 64
    v_mov_b32 v15, 1
    s_mul_i32 s36, s2, 7282
    s_lshr_b32 s36, s36, 16
    s_mul_i32 s37, s36, 9
    s_sub_u32 s37, s2, s37
    s_lshl_b32 s38, s36, 16
    s_mov_b64 s[30:31], s[80:81]
    s_add_u32 m0, s29, 20480
    s_nop 0
    buffer_load_dwordx4 v1, s[4:7], s45 offen lds
    s_cmp_eq_u32 s37, 2
    s_cmov_b64 s[30:31], s[76:77]
    s_cmp_eq_u32 s37, 3
    s_cmov_b64 s[30:31], s[66:67]
    s_cmp_eq_u32 s37, 4
    s_cmov_b64 s[30:31], s[68:69]
    s_cmp_eq_u32 s37, 5
    s_cmov_b64 s[30:31], s[86:87]
    s_cmp_eq_u32 s37, 6
    s_cmov_b64 s[30:31], s[86:87]
    s_cmp_eq_u32 s37, 7
    s_cmov_b64 s[30:31], s[72:73]
    s_add_u32 m0, s29, 90112
    s_nop 0
    buffer_load_dwordx4 v2, s[8:11], s53 offen lds
    s_cmp_eq_u32 s37, 8
    s_cmov_b64 s[30:31], s[64:65]
    s_add_u32 s32, s38, 1835008
    s_cmp_eq_u32 s37, 1
    s_cmov_b32 s38, s32
    s_cmp_eq_u32 s37, 6
    s_cmov_b32 s38, s32
    s_lshl_b32 s32, s39, 15
    s_add_u32 s38, s38, s32
    s_cmp_ge_u32 s37, 9
    s_cmov_b32 s36, 28
    s_cmp_lt_u32 s36, 28
    s_cselect_b32 s32, 0x8000, 0
    s_cselect_b32 s38, s38, 0
    s_add_u32 m0, s29, 24576
    s_nop 0
    buffer_load_dwordx4 v1, s[4:7], s46 offen lds
    s_add_u32 s36, s30, s38
    s_addc_u32 s37, s31, 0
    s_mov_b32 s38, s32
    s_mov_b32 s39, 0x20000
    v_lshlrev_b32 v14, 6, v0
    s_mov_b32 s56, 0xffffd000
    s_movk_i32 s30, 0x1000
    s_cmp_ge_u32 s3, 2
    s_cbranch_scc1 L_pfset
    s_mov_b32 s38, 0
    s_cmp_eq_u32 s3, 0
    s_cselect_b64 s[36:37], s[8:9], s[4:5]
    s_cselect_b32 s38, s10, s6
    s_movk_i32 s30, 128
    s_cmov_b32 s30, 0x80000
    s_cselect_b64 vcc, -1, 0
    s_lshl_b32 s56, s30, 1
    v_cndmask_b32 v14, v17, v16, vcc
L_pfset:
    s_add_u32 m0, s29, 94208
    s_nop 0
    buffer_load_dwordx4 v2, s[8:11], s54 offen lds
    v_mov_b32 v15, 1
    v_mov_b32 v3, 0
    v_mov_b64 v[16:17], 0
    s_add_u32 m0, s29, 28672
    s_nop 0
    buffer_load_dwordx4 v1, s[4:7], s47 offen lds
    v_mov_b64 v[18:19], 0
    v_mov_b64 v[20:21], 0
    v_mov_b64 v[22:23], 0
    v_mov_b64 v[24:25], 0
    v_mov_b64 v[26:27], 0
    v_mov_b64 v[28:29], 0
    v_mov_b64 v[30:31], 0
    v_mov_b64 v[32:33], 0
    v_mov_b64 v[34:35], 0
    v_mov_b64 v[36:37], 0
    v_mov_b64 v[38:39], 0
    v_add_u32 v1, 128, v1
    v_add_u32 v2, 0x80000, v2
    s_add_u32 m0, s29, 98304
    s_nop 0
    buffer_load_dwordx4 v2, s[8:11], 0 offen lds
    v_mov_b64 v[40:41], 0
    v_mov_b64 v[42:43], 0
    v_mov_b64 v[44:45], 0
    v_mov_b64 v[46:47], 0
    v_mov_b64 v[48:49], 0
    v_mov_b64 v[50:51], 0
    v_mov_b64 v[52:53], 0
    v_mov_b64 v[54:55], 0
    s_add_u32 m0, s29, 32768
    s_nop 0
    buffer_load_dwordx4 v1, s[4:7], 0 offen lds
    v_mov_b64 v[56:57], 0
    v_mov_b64 v[58:59], 0
    v_mov_b64 v[60:61], 0
    v_mov_b64 v[62:63], 0
    v_mov_b64 v[64:65], 0
    v_mov_b64 v[66:67], 0
    v_mov_b64 v[68:69], 0
    v_mov_b64 v[70:71], 0
    s_add_u32 m0, s29, 102400
    s_nop 0
    buffer_load_dwordx4 v2, s[8:11], s48 offen lds
    v_mov_b64 v[72:73], 0
    v_mov_b64 v[74:75], 0
    v_mov_b64 v[76:77], 0
    v_mov_b64 v[78:79], 0
    v_mov_b64 v[80:81], 0
    v_mov_b64 v[82:83], 0
    v_mov_b64 v[84:85], 0
    v_mov_b64 v[86:87], 0
    s_add_u32 m0, s29, 36864
    s_nop 0
    buffer_load_dwordx4 v1, s[4:7], s41 offen lds
    v_mov_b64 v[88:89], 0
    v_mov_b64 v[90:91], 0
    v_mov_b64 v[92:93], 0
    v_mov_b64 v[94:95], 0
    v_mov_b64 v[96:97], 0
    v_mov_b64 v[98:99], 0
    v_mov_b64 v[100:101], 0
    s_add_u32 m0, s29, 106496
    s_nop 0
    buffer_load_dwordx4 v2, s[8:11], s49 offen lds
    v_mov_b64 v[102:103], 0
    v_mov_b64 v[104:105], 0
    v_mov_b64 v[106:107], 0
    v_mov_b64 v[108:109], 0
    v_mov_b64 v[110:111], 0
    v_mov_b64 v[112:113], 0
    v_mov_b64 v[114:115], 0
    v_mov_b64 v[116:117], 0
    s_add_u32 m0, s29, 40960
    s_nop 0
    buffer_load_dwordx4 v1, s[4:7], s42 offen lds
    v_mov_b64 v[118:119], 0
    v_mov_b64 v[120:121], 0
    v_mov_b64 v[122:123], 0
    v_mov_b64 v[124:125], 0
    v_mov_b64 v[126:127], 0
    v_mov_b64 v[128:129], 0
    v_mov_b64 v[130:131], 0
    v_mov_b64 v[132:133], 0
    s_add_u32 m0, s29, 110592
    s_nop 0
    buffer_load_dwordx4 v2, s[8:11], s50 offen lds
    v_mov_b64 v[134:135], 0
    v_mov_b64 v[136:137], 0
    v_mov_b64 v[138:139], 0
    v_mov_b64 v[140:141], 0
    v_mov_b64 v[142:143], 0
    v_mov_b64 v[144:145], 0
    v_mov_b64 v[146:147], 0
    v_mov_b64 v[148:149], 0
    s_add_u32 m0, s29, 45056
    s_nop 0
    buffer_load_dwordx4 v1, s[4:7], s43 offen lds
    v_mov_b64 v[150:151], 0
    v_mov_b64 v[152:153], 0
    v_mov_b64 v[154:155], 0
    v_mov_b64 v[156:157], 0
    v_mov_b64 v[158:159], 0
    v_mov_b64 v[160:161], 0
    v_mov_b64 v[162:163], 0
    s_add_u32 m0, s29, 114688
    s_nop 0
    buffer_load_dwordx4 v2, s[8:11], s51 offen lds
    v_mov_b64 v[164:165], 0
    v_mov_b64 v[166:167], 0
    v_mov_b64 v[168:169], 0
    v_mov_b64 v[170:171], 0
    v_mov_b64 v[172:173], 0
    v_mov_b64 v[174:175], 0
    v_mov_b64 v[176:177], 0
    v_mov_b64 v[178:179], 0
    s_add_u32 m0, s29, 49152
    s_nop 0
    buffer_load_dwordx4 v1, s[4:7], s44 offen lds
    v_mov_b64 v[180:181], 0
    v_mov_b64 v[182:183], 0
    v_mov_b64 v[184:185], 0
    v_mov_b64 v[186:187], 0
    v_mov_b64 v[188:189], 0
    v_mov_b64 v[190:191], 0
    v_mov_b64 v[192:193], 0
    v_mov_b64 v[194:195], 0
    s_add_u32 m0, s29, 118784
    s_nop 0
    buffer_load_dwordx4 v2, s[8:11], s52 offen lds
    v_mov_b64 v[196:197], 0
    v_mov_b64 v[198:199], 0
    v_mov_b64 v[200:201], 0
    v_mov_b64 v[202:203], 0
    v_mov_b64 v[204:205], 0
    v_mov_b64 v[206:207], 0
    v_mov_b64 v[208:209], 0
    v_mov_b64 v[210:211], 0
    s_add_u32 m0, s29, 53248
    s_nop 0
    buffer_load_dwordx4 v1, s[4:7], s45 offen lds
    v_mov_b64 v[212:213], 0
    v_mov_b64 v[214:215], 0
    v_mov_b64 v[216:217], 0
    v_mov_b64 v[218:219], 0
    v_mov_b64 v[220:221], 0
    v_mov_b64 v[222:223], 0
    v_mov_b64 v[224:225], 0
    s_add_u32 m0, s29, 122880
    s_nop 0
    buffer_load_dwordx4 v2, s[8:11], s53 offen lds
    v_mov_b64 v[226:227], 0
    v_mov_b64 v[228:229], 0
    v_mov_b64 v[230:231], 0
    v_mov_b64 v[232:233], 0
    v_mov_b64 v[234:235], 0
    v_mov_b64 v[236:237], 0
    v_mov_b64 v[238:239], 0
    v_mov_b64 v[240:241], 0
    s_add_u32 m0, s29, 57344
    s_nop 0
    buffer_load_dwordx4 v1, s[4:7], s46 offen lds
    v_mov_b64 v[242:243], 0
    v_mov_b64 v[244:245], 0
    v_mov_b64 v[246:247], 0
    v_mov_b64 v[248:249], 0
    v_mov_b64 v[250:251], 0
    v_mov_b64 v[252:253], 0
    v_mov_b64 v[254:255], 0
    v_accvgpr_write_b32 a224, 0
    s_add_u32 m0, s29, 126976
    s_nop 0
    buffer_load_dwordx4 v2, s[8:11], s54 offen lds
    v_accvgpr_write_b32 a225, 0
    v_accvgpr_write_b32 a226, 0
    v_accvgpr_write_b32 a227, 0
    v_accvgpr_write_b32 a228, 0
    v_accvgpr_write_b32 a229, 0
    v_accvgpr_write_b32 a230, 0
    v_accvgpr_write_b32 a231, 0
    v_accvgpr_write_b32 a232, 0
    s_add_u32 m0, s29, 61440
    s_nop 0
    buffer_load_dwordx4 v1, s[4:7], s47 offen lds
    v_accvgpr_write_b32 a233, 0
    v_accvgpr_write_b32 a234, 0
    v_accvgpr_write_b32 a235, 0
    v_accvgpr_write_b32 a236, 0
    v_accvgpr_write_b32 a237, 0
    v_accvgpr_write_b32 a238, 0
    v_accvgpr_write_b32 a239, 0
    v_add_u32 v1, 128, v1
    v_add_u32 v2, 0x80000, v2
    buffer_load_dword a243, v14, s[36:39], s56 offen
    s_add_u32 s56, s56, s30
    buffer_load_dword a243, v14, s[36:39], s56 offen
    s_add_u32 s56, s56, s30
    s_mov_b32 s61, 0
    s_waitcnt vmcnt(18)
    s_barrier
    ds_read_b64_tr_b16 a[0:1], v6 offset:0
    ds_read_b64_tr_b16 a[2:3], v6 offset:4096
    ds_read_b128 a[64:67], v4 offset:0
    ds_read_b64_tr_b16 a[4:5], v6 offset:16384
    ds_read_b64_tr_b16 a[6:7], v6 offset:20480
    ds_read_b128 a[68:71], v5 offset:0
    ds_read_b128 a[76:79], v5 offset:2048
    ds_read_b128 a[72:75], v4 offset:2048
    ds_read_b128 a[80:83], v4 offset:4096
    ds_read_b128 a[84:87], v5 offset:4096
    ds_read_b128 a[92:95], v5 offset:6144
    ds_read_b128 a[88:91], v4 offset:6144
    ds_read_b64_tr_b16 a[8:9], v7 offset:0
    ds_read_b64_tr_b16 a[10:11], v7 offset:4096
    ds_read_b64_tr_b16 a[12:13], v7 offset:16384
    ds_read_b64_tr_b16 a[14:15], v7 offset:20480
    ds_read_b64_tr_b16 a[16:17], v8 offset:0
    ds_read_b64_tr_b16 a[18:19], v8 offset:4096
    ds_read_b64_tr_b16 a[20:21], v8 offset:16384
    ds_read_b64_tr_b16 a[22:23], v8 offset:20480
    s_cmp_eq_u32 s27, 0
    s_waitcnt lgkmcnt(0)
    s_cbranch_scc0 L_vloop
.p2align 6
L_kloop:
    v_mfma_f32_16x16x32_bf16 v[88:91], a[0:3], a[64:67], v[88:91]
    ds_read_b64_tr_b16 a[24:25], v9 offset:0
    v_mfma_f32_16x16x32_bf16 v[88:91], a[4:7], a[68:71], v[88:91]
    ds_read_b64_tr_b16 a[26:27], v9 offset:4096
    v_mfma_f32_16x16x32_bf16 v[80:83], a[4:7], a[76:79], v[80:83]
    ds_read_b64_tr_b16 a[28:29], v9 offset:16384
    v_mfma_f32_16x16x32_bf16 v[80:83], a[0:3], a[72:75], v[80:83]
    ds_read_b64_tr_b16 a[30:31], v9 offset:20480
    v_mfma_f32_16x16x32_bf16 v[72:75], a[0:3], a[80:83], v[72:75]
    ds_read_b128 a[96:99], v4 offset:8192
    v_mfma_f32_16x16x32_bf16 v[72:75], a[4:7], a[84:87], v[72:75]
    s_cmp_eq_u32 s61, s55
    s_cbranch_scc1 L_kloop_side
L_kloop_back:
    v_mfma_f32_16x16x32_bf16 v[64:67], a[4:7], a[92:95], v[64:67]
    s_waitcnt lgkmcnt(8)
    ds_read_b128 a[100:103], v5 offset:8192
    v_mfma_f32_16x16x32_bf16 v[64:67], a[0:3], a[88:91], v[64:67]
    v_mfma_f32_16x16x32_bf16 v[68:71], a[8:11], a[88:91], v[68:71]
    ds_read_b128 a[108:111], v5 offset:10240
    v_mfma_f32_16x16x32_bf16 v[68:71], a[12:15], a[92:95], v[68:71]
    v_mfma_f32_16x16x32_bf16 v[76:79], a[12:15], a[84:87], v[76:79]
    ds_read_b128 a[104:107], v4 offset:10240
    v_mfma_f32_16x16x32_bf16 v[76:79], a[8:11], a[80:83], v[76:79]
    v_mfma_f32_16x16x32_bf16 v[84:87], a[8:11], a[72:75], v[84:87]
    ds_read_b128 a[112:115], v4 offset:12288
    v_mfma_f32_16x16x32_bf16 v[84:87], a[12:15], a[76:79], v[84:87]
    v_mfma_f32_16x16x32_bf16 v[92:95], a[12:15], a[68:71], v[92:95]
    ds_read_b128 a[116:119], v5 offset:12288
    v_mfma_f32_16x16x32_bf16 v[92:95], a[8:11], a[64:67], v[92:95]
    s_waitcnt lgkmcnt(8)
    v_mfma_f32_16x16x32_bf16 v[120:123], a[16:19], a[64:67], v[120:123]
    ds_read_b128 a[124:127], v5 offset:14336
    v_mfma_f32_16x16x32_bf16 v[120:123], a[20:23], a[68:71], v[120:123]
    v_mfma_f32_16x16x32_bf16 v[112:115], a[20:23], a[76:79], v[112:115]
    ds_read_b128 a[120:123], v4 offset:14336
    v_mfma_f32_16x16x32_bf16 v[112:115], a[16:19], a[72:75], v[112:115]
    v_mfma_f32_16x16x32_bf16 v[104:107], a[16:19], a[80:83], v[104:107]
    ds_read_b64_tr_b16 a[32:33], v10 offset:0
    v_mfma_f32_16x16x32_bf16 v[104:107], a[20:23], a[84:87], v[104:107]
    ds_read_b64_tr_b16 a[34:35], v10 offset:4096
    v_mfma_f32_16x16x32_bf16 v[96:99], a[20:23], a[92:95], v[96:99]
    ds_read_b64_tr_b16 a[36:37], v10 offset:16384
    v_mfma_f32_16x16x32_bf16 v[96:99], a[16:19], a[88:91], v[96:99]
    ds_read_b64_tr_b16 a[38:39], v10 offset:20480
    v_mfma_f32_16x16x32_bf16 v[100:103], a[24:27], a[88:91], v[100:103]
    s_waitcnt lgkmcnt(8)
    ds_read_b64_tr_b16 a[40:41], v11 offset:0
    v_mfma_f32_16x16x32_bf16 v[100:103], a[28:31], a[92:95], v[100:103]
    ds_read_b64_tr_b16 a[42:43], v11 offset:4096
    v_mfma_f32_16x16x32_bf16 v[108:111], a[28:31], a[84:87], v[108:111]
    ds_read_b64_tr_b16 a[44:45], v11 offset:16384
    v_mfma_f32_16x16x32_bf16 v[108:111], a[24:27], a[80:83], v[108:111]
    ds_read_b64_tr_b16 a[46:47], v11 offset:20480
    v_mfma_f32_16x16x32_bf16 v[116:119], a[24:27], a[72:75], v[116:119]
    ds_read_b64_tr_b16 a[48:49], v12 offset:0
    v_mfma_f32_16x16x32_bf16 v[116:119], a[28:31], a[76:79], v[116:119]
    ds_read_b64_tr_b16 a[50:51], v12 offset:4096
    v_mfma_f32_16x16x32_bf16 v[124:127], a[28:31], a[68:71], v[124:127]
    ds_read_b64_tr_b16 a[52:53], v12 offset:16384
    v_mfma_f32_16x16x32_bf16 v[124:127], a[24:27], a[64:67], v[124:127]
    ds_read_b64_tr_b16 a[54:55], v12 offset:20480
    v_mfma_f32_16x16x32_bf16 a[232:235], a[0:3], a[96:99], a[232:235]
    ds_read_b64_tr_b16 a[56:57], v13 offset:0
    v_mfma_f32_16x16x32_bf16 a[232:235], a[4:7], a[100:103], a[232:235]
    ds_read_b64_tr_b16 a[58:59], v13 offset:4096
    v_mfma_f32_16x16x32_bf16 a[224:227], a[4:7], a[108:111], a[224:227]
    ds_read_b64_tr_b16 a[60:61], v13 offset:16384
    v_mfma_f32_16x16x32_bf16 a[224:227], a[0:3], a[104:107], a[224:227]
    s_waitcnt lgkmcnt(8)
    ds_read_b64_tr_b16 a[62:63], v13 offset:20480
    v_mfma_f32_16x16x32_bf16 v[24:27], a[0:3], a[112:115], v[24:27]
    v_mfma_f32_16x16x32_bf16 v[24:27], a[4:7], a[116:119], v[24:27]
    v_mfma_f32_16x16x32_bf16 v[16:19], a[4:7], a[124:127], v[16:19]
    v_mfma_f32_16x16x32_bf16 v[16:19], a[0:3], a[120:123], v[16:19]
    s_waitcnt lgkmcnt(0)
    v_mfma_f32_16x16x32_bf16 v[20:23], a[8:11], a[120:123], v[20:23]
    s_barrier
    v_mfma_f32_16x16x32_bf16 v[20:23], a[12:15], a[124:127], v[20:23]
    s_add_u32 m0, s29, 65536
    v_mfma_f32_16x16x32_bf16 v[28:31], a[12:15], a[116:119], v[28:31]
    buffer_load_dwordx4 v2, s[8:11], 0 offen lds
    v_mfma_f32_16x16x32_bf16 v[28:31], a[8:11], a[112:115], v[28:31]
    v_mfma_f32_16x16x32_bf16 a[228:231], a[8:11], a[104:107], a[228:231]
    v_mfma_f32_16x16x32_bf16 a[228:231], a[12:15], a[108:111], a[228:231]
    v_mfma_f32_16x16x32_bf16 a[236:239], a[12:15], a[100:103], a[236:239]
    s_add_u32 m0, s29, 0
    v_mfma_f32_16x16x32_bf16 a[236:239], a[8:11], a[96:99], a[236:239]
    buffer_load_dwordx4 v1, s[4:7], 0 offen lds
    v_mfma_f32_16x16x32_bf16 v[56:59], a[16:19], a[96:99], v[56:59]
    v_mfma_f32_16x16x32_bf16 v[56:59], a[20:23], a[100:103], v[56:59]
    v_mfma_f32_16x16x32_bf16 v[48:51], a[20:23], a[108:111], v[48:51]
    v_mfma_f32_16x16x32_bf16 v[48:51], a[16:19], a[104:107], v[48:51]
    s_add_u32 m0, s29, 69632
    v_mfma_f32_16x16x32_bf16 v[40:43], a[16:19], a[112:115], v[40:43]
    buffer_load_dwordx4 v2, s[8:11], s48 offen lds
    v_mfma_f32_16x16x32_bf16 v[40:43], a[20:23], a[116:119], v[40:43]
    v_mfma_f32_16x16x32_bf16 v[32:35], a[20:23], a[124:127], v[32:35]
    v_mfma_f32_16x16x32_bf16 v[32:35], a[16:19], a[120:123], v[32:35]
    v_mfma_f32_16x16x32_bf16 v[36:39], a[24:27], a[120:123], v[36:39]
    s_add_u32 m0, s29, 4096
    v_mfma_f32_16x16x32_bf16 v[36:39], a[28:31], a[124:127], v[36:39]
    buffer_load_dwordx4 v1, s[4:7], s41 offen lds
    v_mfma_f32_16x16x32_bf16 v[44:47], a[28:31], a[116:119], v[44:47]
    v_mfma_f32_16x16x32_bf16 v[44:47], a[24:27], a[112:115], v[44:47]
    v_mfma_f32_16x16x32_bf16 v[52:55], a[24:27], a[104:107], v[52:55]
    v_mfma_f32_16x16x32_bf16 v[52:55], a[28:31], a[108:111], v[52:55]
    s_add_u32 m0, s29, 73728
    v_mfma_f32_16x16x32_bf16 v[60:63], a[28:31], a[100:103], v[60:63]
    buffer_load_dwordx4 v2, s[8:11], s49 offen lds
    v_mfma_f32_16x16x32_bf16 v[60:63], a[24:27], a[96:99], v[60:63]
    v_mfma_f32_16x16x32_bf16 v[216:219], a[32:35], a[96:99], v[216:219]
    v_mfma_f32_16x16x32_bf16 v[216:219], a[36:39], a[100:103], v[216:219]
    v_mfma_f32_16x16x32_bf16 v[208:211], a[36:39], a[108:111], v[208:211]
    s_add_u32 m0, s29, 8192
    v_mfma_f32_16x16x32_bf16 v[208:211], a[32:35], a[104:107], v[208:211]
    buffer_load_dwordx4 v1, s[4:7], s42 offen lds
    v_mfma_f32_16x16x32_bf16 v[200:203], a[32:35], a[112:115], v[200:203]
    v_mfma_f32_16x16x32_bf16 v[200:203], a[36:39], a[116:119], v[200:203]
    v_mfma_f32_16x16x32_bf16 v[192:195], a[36:39], a[124:127], v[192:195]
    v_mfma_f32_16x16x32_bf16 v[192:195], a[32:35], a[120:123], v[192:195]
    s_add_u32 m0, s29, 77824
    v_mfma_f32_16x16x32_bf16 v[196:199], a[40:43], a[120:123], v[196:199]
    buffer_load_dwordx4 v2, s[8:11], s50 offen lds
    v_mfma_f32_16x16x32_bf16 v[196:199], a[44:47], a[124:127], v[196:199]
    v_mfma_f32_16x16x32_bf16 v[204:207], a[44:47], a[116:119], v[204:207]
    v_mfma_f32_16x16x32_bf16 v[204:207], a[40:43], a[112:115], v[204:207]
    v_mfma_f32_16x16x32_bf16 v[212:215], a[40:43], a[104:107], v[212:215]
    s_add_u32 m0, s29, 12288
    v_mfma_f32_16x16x32_bf16 v[212:215], a[44:47], a[108:111], v[212:215]
    buffer_load_dwordx4 v1, s[4:7], s43 offen lds
    v_mfma_f32_16x16x32_bf16 v[220:223], a[44:47], a[100:103], v[220:223]
    v_mfma_f32_16x16x32_bf16 v[220:223], a[40:43], a[96:99], v[220:223]
    v_mfma_f32_16x16x32_bf16 v[248:251], a[48:51], a[96:99], v[248:251]
    v_mfma_f32_16x16x32_bf16 v[248:251], a[52:55], a[100:103], v[248:251]
    s_add_u32 m0, s29, 81920
    v_mfma_f32_16x16x32_bf16 v[240:243], a[52:55], a[108:111], v[240:243]
    buffer_load_dwordx4 v2, s[8:11], s51 offen lds
    v_mfma_f32_16x16x32_bf16 v[240:243], a[48:51], a[104:107], v[240:243]
    v_mfma_f32_16x16x32_bf16 v[232:235], a[48:51], a[112:115], v[232:235]
    v_mfma_f32_16x16x32_bf16 v[232:235], a[52:55], a[116:119], v[232:235]
    v_mfma_f32_16x16x32_bf16 v[224:227], a[52:55], a[124:127], v[224:227]
    s_add_u32 m0, s29, 16384
    v_mfma_f32_16x16x32_bf16 v[224:227], a[48:51], a[120:123], v[224:227]
    buffer_load_dwordx4 v1, s[4:7], s44 offen lds
    v_mfma_f32_16x16x32_bf16 v[228:231], a[56:59], a[120:123], v[228:231]
    v_mfma_f32_16x16x32_bf16 v[228:231], a[60:63], a[124:127], v[228:231]
    v_mfma_f32_16x16x32_bf16 v[236:239], a[60:63], a[116:119], v[236:239]
    v_mfma_f32_16x16x32_bf16 v[236:239], a[56:59], a[112:115], v[236:239]
    s_add_u32 m0, s29, 86016
    v_mfma_f32_16x16x32_bf16 v[244:247], a[56:59], a[104:107], v[244:247]
    s_waitcnt vmcnt(11)
    buffer_load_dwordx4 v2, s[8:11], s52 offen lds
    v_mfma_f32_16x16x32_bf16 v[244:247], a[60:63], a[108:111], v[244:247]
    s_barrier
    ds_read_b64_tr_b16 a[0:1], v6 offset:32768
    v_mfma_f32_16x16x32_bf16 v[252:255], a[60:63], a[100:103], v[252:255]
    ds_read_b64_tr_b16 a[2:3], v6 offset:36864
    v_mfma_f32_16x16x32_bf16 v[252:255], a[56:59], a[96:99], v[252:255]
    ds_read_b128 a[96:99], v4 offset:40960
    v_mfma_f32_16x16x32_bf16 v[152:155], a[32:35], a[64:67], v[152:155]
    s_add_u32 m0, s29, 20480
    v_mfma_f32_16x16x32_bf16 v[152:155], a[36:39], a[68:71], v[152:155]
    buffer_load_dwordx4 v1, s[4:7], s45 offen lds
    v_mfma_f32_16x16x32_bf16 v[144:147], a[36:39], a[76:79], v[144:147]
    ds_read_b64_tr_b16 a[4:5], v6 offset:49152
    v_mfma_f32_16x16x32_bf16 v[144:147], a[32:35], a[72:75], v[144:147]
    ds_read_b64_tr_b16 a[6:7], v6 offset:53248
    v_mfma_f32_16x16x32_bf16 v[136:139], a[32:35], a[80:83], v[136:139]
    ds_read_b128 a[100:103], v5 offset:40960
    v_mfma_f32_16x16x32_bf16 v[136:139], a[36:39], a[84:87], v[136:139]
    s_add_u32 m0, s29, 90112
    v_mfma_f32_16x16x32_bf16 v[128:131], a[36:39], a[92:95], v[128:131]
    buffer_load_dwordx4 v2, s[8:11], s53 offen lds
    v_mfma_f32_16x16x32_bf16 v[128:131], a[32:35], a[88:91], v[128:131]
    ds_read_b128 a[108:111], v5 offset:43008
    v_mfma_f32_16x16x32_bf16 v[132:135], a[40:43], a[88:91], v[132:135]
    v_mfma_f32_16x16x32_bf16 v[132:135], a[44:47], a[92:95], v[132:135]
    ds_read_b128 a[104:107], v4 offset:43008
    v_mfma_f32_16x16x32_bf16 v[140:143], a[44:47], a[84:87], v[140:143]
    s_add_u32 m0, s29, 24576
    v_mfma_f32_16x16x32_bf16 v[140:143], a[40:43], a[80:83], v[140:143]
    buffer_load_dwordx4 v1, s[4:7], s46 offen lds
    v_mfma_f32_16x16x32_bf16 v[148:151], a[40:43], a[72:75], v[148:151]
    ds_read_b128 a[112:115], v4 offset:45056
    v_mfma_f32_16x16x32_bf16 v[148:151], a[44:47], a[76:79], v[148:151]
    v_mfma_f32_16x16x32_bf16 v[156:159], a[44:47], a[68:71], v[156:159]
    ds_read_b128 a[116:119], v5 offset:45056
    v_mfma_f32_16x16x32_bf16 v[156:159], a[40:43], a[64:67], v[156:159]
    s_add_u32 m0, s29, 94208
    v_mfma_f32_16x16x32_bf16 v[184:187], a[48:51], a[64:67], v[184:187]
    buffer_load_dwordx4 v2, s[8:11], s54 offen lds
    v_mfma_f32_16x16x32_bf16 v[184:187], a[52:55], a[68:71], v[184:187]
    ds_read_b128 a[124:127], v5 offset:47104
    v_mfma_f32_16x16x32_bf16 v[176:179], a[52:55], a[76:79], v[176:179]
    v_mfma_f32_16x16x32_bf16 v[176:179], a[48:51], a[72:75], v[176:179]
    ds_read_b128 a[120:123], v4 offset:47104
    v_mfma_f32_16x16x32_bf16 v[168:171], a[48:51], a[80:83], v[168:171]
    s_add_u32 m0, s29, 28672
    v_mfma_f32_16x16x32_bf16 v[168:171], a[52:55], a[84:87], v[168:171]
    buffer_load_dwordx4 v1, s[4:7], s47 offen lds
    v_mfma_f32_16x16x32_bf16 v[160:163], a[52:55], a[92:95], v[160:163]
    v_add_u32 v1, 128, v1
    v_add_u32 v2, 0x80000, v2
    v_mfma_f32_16x16x32_bf16 v[160:163], a[48:51], a[88:91], v[160:163]
    ds_read_b64_tr_b16 a[8:9], v7 offset:32768
    v_mfma_f32_16x16x32_bf16 v[164:167], a[56:59], a[88:91], v[164:167]
    buffer_load_dword a243, v14, s[36:39], s56 offen
    v_mfma_f32_16x16x32_bf16 v[164:167], a[60:63], a[92:95], v[164:167]
    s_add_u32 s56, s56, s30
    ds_read_b64_tr_b16 a[10:11], v7 offset:36864
    v_mfma_f32_16x16x32_bf16 v[172:175], a[60:63], a[84:87], v[172:175]
    ds_read_b64_tr_b16 a[12:13], v7 offset:49152
    v_mfma_f32_16x16x32_bf16 v[172:175], a[56:59], a[80:83], v[172:175]
    ds_read_b64_tr_b16 a[14:15], v7 offset:53248
    v_mfma_f32_16x16x32_bf16 v[180:183], a[56:59], a[72:75], v[180:183]
    ds_read_b64_tr_b16 a[16:17], v8 offset:32768
    v_mfma_f32_16x16x32_bf16 v[180:183], a[60:63], a[76:79], v[180:183]
    ds_read_b64_tr_b16 a[18:19], v8 offset:36864
    v_mfma_f32_16x16x32_bf16 v[188:191], a[60:63], a[68:71], v[188:191]
    ds_read_b64_tr_b16 a[20:21], v8 offset:49152
    v_mfma_f32_16x16x32_bf16 v[188:191], a[56:59], a[64:67], v[188:191]
    s_waitcnt lgkmcnt(8)
    ds_read_b64_tr_b16 a[22:23], v8 offset:53248
    v_mfma_f32_16x16x32_bf16 a[232:235], a[0:3], a[96:99], a[232:235]
    ds_read_b64_tr_b16 a[24:25], v9 offset:32768
    v_mfma_f32_16x16x32_bf16 a[232:235], a[4:7], a[100:103], a[232:235]
    ds_read_b64_tr_b16 a[26:27], v9 offset:36864
    v_mfma_f32_16x16x32_bf16 a[224:227], a[4:7], a[108:111], a[224:227]
    ds_read_b64_tr_b16 a[28:29], v9 offset:49152
    v_mfma_f32_16x16x32_bf16 a[224:227], a[0:3], a[104:107], a[224:227]
    ds_read_b64_tr_b16 a[30:31], v9 offset:53248
    v_mfma_f32_16x16x32_bf16 v[24:27], a[0:3], a[112:115], v[24:27]
    ds_read_b128 a[64:67], v4 offset:32768
    v_mfma_f32_16x16x32_bf16 v[24:27], a[4:7], a[116:119], v[24:27]
    v_mfma_f32_16x16x32_bf16 v[16:19], a[4:7], a[124:127], v[16:19]
    s_waitcnt lgkmcnt(8)
    ds_read_b128 a[68:71], v5 offset:32768
    v_mfma_f32_16x16x32_bf16 v[16:19], a[0:3], a[120:123], v[16:19]
    v_mfma_f32_16x16x32_bf16 v[20:23], a[8:11], a[120:123], v[20:23]
    ds_read_b128 a[76:79], v5 offset:34816
    v_mfma_f32_16x16x32_bf16 v[20:23], a[12:15], a[124:127], v[20:23]
    v_mfma_f32_16x16x32_bf16 v[28:31], a[12:15], a[116:119], v[28:31]
    ds_read_b128 a[72:75], v4 offset:34816
    v_mfma_f32_16x16x32_bf16 v[28:31], a[8:11], a[112:115], v[28:31]
    v_mfma_f32_16x16x32_bf16 a[228:231], a[8:11], a[104:107], a[228:231]
    ds_read_b128 a[80:83], v4 offset:36864
    v_mfma_f32_16x16x32_bf16 a[228:231], a[12:15], a[108:111], a[228:231]
    v_mfma_f32_16x16x32_bf16 a[236:239], a[12:15], a[100:103], a[236:239]
    ds_read_b128 a[84:87], v5 offset:36864
    v_mfma_f32_16x16x32_bf16 a[236:239], a[8:11], a[96:99], a[236:239]
    s_waitcnt lgkmcnt(8)
    v_mfma_f32_16x16x32_bf16 v[56:59], a[16:19], a[96:99], v[56:59]
    ds_read_b128 a[92:95], v5 offset:38912
    v_mfma_f32_16x16x32_bf16 v[56:59], a[20:23], a[100:103], v[56:59]
    v_mfma_f32_16x16x32_bf16 v[48:51], a[20:23], a[108:111], v[48:51]
    ds_read_b128 a[88:91], v4 offset:38912
    v_mfma_f32_16x16x32_bf16 v[48:51], a[16:19], a[104:107], v[48:51]
    v_mfma_f32_16x16x32_bf16 v[40:43], a[16:19], a[112:115], v[40:43]
    ds_read_b64_tr_b16 a[32:33], v10 offset:32768
    v_mfma_f32_16x16x32_bf16 v[40:43], a[20:23], a[116:119], v[40:43]
    ds_read_b64_tr_b16 a[34:35], v10 offset:36864
    v_mfma_f32_16x16x32_bf16 v[32:35], a[20:23], a[124:127], v[32:35]
    ds_read_b64_tr_b16 a[36:37], v10 offset:49152
    v_mfma_f32_16x16x32_bf16 v[32:35], a[16:19], a[120:123], v[32:35]
    ds_read_b64_tr_b16 a[38:39], v10 offset:53248
    v_mfma_f32_16x16x32_bf16 v[36:39], a[24:27], a[120:123], v[36:39]
    s_waitcnt lgkmcnt(8)
    ds_read_b64_tr_b16 a[40:41], v11 offset:32768
    v_mfma_f32_16x16x32_bf16 v[36:39], a[28:31], a[124:127], v[36:39]
    ds_read_b64_tr_b16 a[42:43], v11 offset:36864
    v_mfma_f32_16x16x32_bf16 v[44:47], a[28:31], a[116:119], v[44:47]
    ds_read_b64_tr_b16 a[44:45], v11 offset:49152
    v_mfma_f32_16x16x32_bf16 v[44:47], a[24:27], a[112:115], v[44:47]
    ds_read_b64_tr_b16 a[46:47], v11 offset:53248
    v_mfma_f32_16x16x32_bf16 v[52:55], a[24:27], a[104:107], v[52:55]
    ds_read_b64_tr_b16 a[48:49], v12 offset:32768
    v_mfma_f32_16x16x32_bf16 v[52:55], a[28:31], a[108:111], v[52:55]
    ds_read_b64_tr_b16 a[50:51], v12 offset:36864
    v_mfma_f32_16x16x32_bf16 v[60:63], a[28:31], a[100:103], v[60:63]
    ds_read_b64_tr_b16 a[52:53], v12 offset:49152
    v_mfma_f32_16x16x32_bf16 v[60:63], a[24:27], a[96:99], v[60:63]
    ds_read_b64_tr_b16 a[54:55], v12 offset:53248
    v_mfma_f32_16x16x32_bf16 v[88:91], a[0:3], a[64:67], v[88:91]
    ds_read_b64_tr_b16 a[56:57], v13 offset:32768
    v_mfma_f32_16x16x32_bf16 v[88:91], a[4:7], a[68:71], v[88:91]
    ds_read_b64_tr_b16 a[58:59], v13 offset:36864
    v_mfma_f32_16x16x32_bf16 v[80:83], a[4:7], a[76:79], v[80:83]
    ds_read_b64_tr_b16 a[60:61], v13 offset:49152
    v_mfma_f32_16x16x32_bf16 v[80:83], a[0:3], a[72:75], v[80:83]
    s_waitcnt lgkmcnt(8)
    ds_read_b64_tr_b16 a[62:63], v13 offset:53248
    v_mfma_f32_16x16x32_bf16 v[72:75], a[0:3], a[80:83], v[72:75]
    v_mfma_f32_16x16x32_bf16 v[72:75], a[4:7], a[84:87], v[72:75]
    v_mfma_f32_16x16x32_bf16 v[64:67], a[4:7], a[92:95], v[64:67]
    v_mfma_f32_16x16x32_bf16 v[64:67], a[0:3], a[88:91], v[64:67]
    s_waitcnt lgkmcnt(0)
    v_mfma_f32_16x16x32_bf16 v[68:71], a[8:11], a[88:91], v[68:71]
    s_barrier
    v_mfma_f32_16x16x32_bf16 v[68:71], a[12:15], a[92:95], v[68:71]
    s_add_u32 m0, s29, 98304
    v_mfma_f32_16x16x32_bf16 v[76:79], a[12:15], a[84:87], v[76:79]
    buffer_load_dwordx4 v2, s[8:11], 0 offen lds
    v_mfma_f32_16x16x32_bf16 v[76:79], a[8:11], a[80:83], v[76:79]
    v_mfma_f32_16x16x32_bf16 v[84:87], a[8:11], a[72:75], v[84:87]
    v_mfma_f32_16x16x32_bf16 v[84:87], a[12:15], a[76:79], v[84:87]
    v_mfma_f32_16x16x32_bf16 v[92:95], a[12:15], a[68:71], v[92:95]
    s_add_u32 m0, s29, 32768
    v_mfma_f32_16x16x32_bf16 v[92:95], a[8:11], a[64:67], v[92:95]
    buffer_load_dwordx4 v1, s[4:7], 0 offen lds
    v_mfma_f32_16x16x32_bf16 v[120:123], a[16:19], a[64:67], v[120:123]
    v_mfma_f32_16x16x32_bf16 v[120:123], a[20:23], a[68:71], v[120:123]
    v_mfma_f32_16x16x32_bf16 v[112:115], a[20:23], a[76:79], v[112:115]
    v_mfma_f32_16x16x32_bf16 v[112:115], a[16:19], a[72:75], v[112:115]
    s_add_u32 m0, s29, 102400
    v_mfma_f32_16x16x32_bf16 v[104:107], a[16:19], a[80:83], v[104:107]
    buffer_load_dwordx4 v2, s[8:11], s48 offen lds
    v_mfma_f32_16x16x32_bf16 v[104:107], a[20:23], a[84:87], v[104:107]
    v_mfma_f32_16x16x32_bf16 v[96:99], a[20:23], a[92:95], v[96:99]
    v_mfma_f32_16x16x32_bf16 v[96:99], a[16:19], a[88:91], v[96:99]
    v_mfma_f32_16x16x32_bf16 v[100:103], a[24:27], a[88:91], v[100:103]
    s_add_u32 m0, s29, 36864
    v_mfma_f32_16x16x32_bf16 v[100:103], a[28:31], a[92:95], v[100:103]
    buffer_load_dwordx4 v1, s[4:7], s41 offen lds
    v_mfma_f32_16x16x32_bf16 v[108:111], a[28:31], a[84:87], v[108:111]
    v_mfma_f32_16x16x32_bf16 v[108:111], a[24:27], a[80:83], v[108:111]
    v_mfma_f32_16x16x32_bf16 v[116:119], a[24:27], a[72:75], v[116:119]
    v_mfma_f32_16x16x32_bf16 v[116:119], a[28:31], a[76:79], v[116:119]
    s_add_u32 m0, s29, 106496
    v_mfma_f32_16x16x32_bf16 v[124:127], a[28:31], a[68:71], v[124:127]
    buffer_load_dwordx4 v2, s[8:11], s49 offen lds
    v_mfma_f32_16x16x32_bf16 v[124:127], a[24:27], a[64:67], v[124:127]
    v_mfma_f32_16x16x32_bf16 v[152:155], a[32:35], a[64:67], v[152:155]
    v_mfma_f32_16x16x32_bf16 v[152:155], a[36:39], a[68:71], v[152:155]
    v_mfma_f32_16x16x32_bf16 v[144:147], a[36:39], a[76:79], v[144:147]
    s_add_u32 m0, s29, 40960
    v_mfma_f32_16x16x32_bf16 v[144:147], a[32:35], a[72:75], v[144:147]
    buffer_load_dwordx4 v1, s[4:7], s42 offen lds
    v_mfma_f32_16x16x32_bf16 v[136:139], a[32:35], a[80:83], v[136:139]
    v_mfma_f32_16x16x32_bf16 v[136:139], a[36:39], a[84:87], v[136:139]
    v_mfma_f32_16x16x32_bf16 v[128:131], a[36:39], a[92:95], v[128:131]
    v_mfma_f32_16x16x32_bf16 v[128:131], a[32:35], a[88:91], v[128:131]
    s_add_u32 m0, s29, 110592
    v_mfma_f32_16x16x32_bf16 v[132:135], a[40:43], a[88:91], v[132:135]
    buffer_load_dwordx4 v2, s[8:11], s50 offen lds
    v_mfma_f32_16x16x32_bf16 v[132:135], a[44:47], a[92:95], v[132:135]
    v_mfma_f32_16x16x32_bf16 v[140:143], a[44:47], a[84:87], v[140:143]
    v_mfma_f32_16x16x32_bf16 v[140:143], a[40:43], a[80:83], v[140:143]
    v_mfma_f32_16x16x32_bf16 v[148:151], a[40:43], a[72:75], v[148:151]
    s_add_u32 m0, s29, 45056
    v_mfma_f32_16x16x32_bf16 v[148:151], a[44:47], a[76:79], v[148:151]
    buffer_load_dwordx4 v1, s[4:7], s43 offen lds
    v_mfma_f32_16x16x32_bf16 v[156:159], a[44:47], a[68:71], v[156:159]
    v_mfma_f32_16x16x32_bf16 v[156:159], a[40:43], a[64:67], v[156:159]
    v_mfma_f32_16x16x32_bf16 v[184:187], a[48:51], a[64:67], v[184:187]
    v_mfma_f32_16x16x32_bf16 v[184:187], a[52:55], a[68:71], v[184:187]
    s_add_u32 m0, s29, 114688
    v_mfma_f32_16x16x32_bf16 v[176:179], a[52:55], a[76:79], v[176:179]
    buffer_load_dwordx4 v2, s[8:11], s51 offen lds
    v_mfma_f32_16x16x32_bf16 v[176:179], a[48:51], a[72:75], v[176:179]
    v_mfma_f32_16x16x32_bf16 v[168:171], a[48:51], a[80:83], v[168:171]
    v_mfma_f32_16x16x32_bf16 v[168:171], a[52:55], a[84:87], v[168:171]
    v_mfma_f32_16x16x32_bf16 v[160:163], a[52:55], a[92:95], v[160:163]
    s_add_u32 m0, s29, 49152
    v_mfma_f32_16x16x32_bf16 v[160:163], a[48:51], a[88:91], v[160:163]
    buffer_load_dwordx4 v1, s[4:7], s44 offen lds
    v_mfma_f32_16x16x32_bf16 v[164:167], a[56:59], a[88:91], v[164:167]
    v_mfma_f32_16x16x32_bf16 v[164:167], a[60:63], a[92:95], v[164:167]
    v_mfma_f32_16x16x32_bf16 v[172:175], a[60:63], a[84:87], v[172:175]
    v_mfma_f32_16x16x32_bf16 v[172:175], a[56:59], a[80:83], v[172:175]
    s_add_u32 m0, s29, 118784
    v_mfma_f32_16x16x32_bf16 v[180:183], a[56:59], a[72:75], v[180:183]
    s_waitcnt vmcnt(11)
    buffer_load_dwordx4 v2, s[8:11], s52 offen lds
    v_mfma_f32_16x16x32_bf16 v[180:183], a[60:63], a[76:79], v[180:183]
    s_barrier
    ds_read_b64_tr_b16 a[0:1], v6 offset:0
    v_mfma_f32_16x16x32_bf16 v[188:191], a[60:63], a[68:71], v[188:191]
    ds_read_b64_tr_b16 a[2:3], v6 offset:4096
    v_mfma_f32_16x16x32_bf16 v[188:191], a[56:59], a[64:67], v[188:191]
    ds_read_b128 a[64:67], v4 offset:0
    v_mfma_f32_16x16x32_bf16 v[216:219], a[32:35], a[96:99], v[216:219]
    s_add_u32 m0, s29, 53248
    v_mfma_f32_16x16x32_bf16 v[216:219], a[36:39], a[100:103], v[216:219]
    buffer_load_dwordx4 v1, s[4:7], s45 offen lds
    v_mfma_f32_16x16x32_bf16 v[208:211], a[36:39], a[108:111], v[208:211]
    ds_read_b64_tr_b16 a[4:5], v6 offset:16384
    v_mfma_f32_16x16x32_bf16 v[208:211], a[32:35], a[104:107], v[208:211]
    ds_read_b64_tr_b16 a[6:7], v6 offset:20480
    v_mfma_f32_16x16x32_bf16 v[200:203], a[32:35], a[112:115], v[200:203]
    ds_read_b128 a[68:71], v5 offset:0
    v_mfma_f32_16x16x32_bf16 v[200:203], a[36:39], a[116:119], v[200:203]
    s_add_u32 m0, s29, 122880
    v_mfma_f32_16x16x32_bf16 v[192:195], a[36:39], a[124:127], v[192:195]
    buffer_load_dwordx4 v2, s[8:11], s53 offen lds
    v_mfma_f32_16x16x32_bf16 v[192:195], a[32:35], a[120:123], v[192:195]
    ds_read_b128 a[76:79], v5 offset:2048
    v_mfma_f32_16x16x32_bf16 v[196:199], a[40:43], a[120:123], v[196:199]
    v_mfma_f32_16x16x32_bf16 v[196:199], a[44:47], a[124:127], v[196:199]
    ds_read_b128 a[72:75], v4 offset:2048
    v_mfma_f32_16x16x32_bf16 v[204:207], a[44:47], a[116:119], v[204:207]
    s_add_u32 m0, s29, 57344
    v_mfma_f32_16x16x32_bf16 v[204:207], a[40:43], a[112:115], v[204:207]
    buffer_load_dwordx4 v1, s[4:7], s46 offen lds
    v_mfma_f32_16x16x32_bf16 v[212:215], a[40:43], a[104:107], v[212:215]
    ds_read_b128 a[80:83], v4 offset:4096
    v_mfma_f32_16x16x32_bf16 v[212:215], a[44:47], a[108:111], v[212:215]
    v_mfma_f32_16x16x32_bf16 v[220:223], a[44:47], a[100:103], v[220:223]
    ds_read_b128 a[84:87], v5 offset:4096
    v_mfma_f32_16x16x32_bf16 v[220:223], a[40:43], a[96:99], v[220:223]
    s_add_u32 m0, s29, 126976
    v_mfma_f32_16x16x32_bf16 v[248:251], a[48:51], a[96:99], v[248:251]
    buffer_load_dwordx4 v2, s[8:11], s54 offen lds
    v_mfma_f32_16x16x32_bf16 v[248:251], a[52:55], a[100:103], v[248:251]
    ds_read_b128 a[92:95], v5 offset:6144
    v_mfma_f32_16x16x32_bf16 v[240:243], a[52:55], a[108:111], v[240:243]
    v_mfma_f32_16x16x32_bf16 v[240:243], a[48:51], a[104:107], v[240:243]
    ds_read_b128 a[88:91], v4 offset:6144
    v_mfma_f32_16x16x32_bf16 v[232:235], a[48:51], a[112:115], v[232:235]
    s_add_u32 m0, s29, 61440
    v_mfma_f32_16x16x32_bf16 v[232:235], a[52:55], a[116:119], v[232:235]
    buffer_load_dwordx4 v1, s[4:7], s47 offen lds
    v_mfma_f32_16x16x32_bf16 v[224:227], a[52:55], a[124:127], v[224:227]
    v_add_u32 v1, 128, v1
    v_add_u32 v2, 0x80000, v2
    v_mfma_f32_16x16x32_bf16 v[224:227], a[48:51], a[120:123], v[224:227]
    ds_read_b64_tr_b16 a[8:9], v7 offset:0
    v_mfma_f32_16x16x32_bf16 v[228:231], a[56:59], a[120:123], v[228:231]
    buffer_load_dword a243, v14, s[36:39], s56 offen
    v_mfma_f32_16x16x32_bf16 v[228:231], a[60:63], a[124:127], v[228:231]
    s_add_u32 s56, s56, s30
    ds_read_b64_tr_b16 a[10:11], v7 offset:4096
    v_mfma_f32_16x16x32_bf16 v[236:239], a[60:63], a[116:119], v[236:239]
    ds_read_b64_tr_b16 a[12:13], v7 offset:16384
    v_mfma_f32_16x16x32_bf16 v[236:239], a[56:59], a[112:115], v[236:239]
    ds_read_b64_tr_b16 a[14:15], v7 offset:20480
    v_mfma_f32_16x16x32_bf16 v[244:247], a[56:59], a[104:107], v[244:247]
    ds_read_b64_tr_b16 a[16:17], v8 offset:0
    v_mfma_f32_16x16x32_bf16 v[244:247], a[60:63], a[108:111], v[244:247]
    ds_read_b64_tr_b16 a[18:19], v8 offset:4096
    v_mfma_f32_16x16x32_bf16 v[252:255], a[60:63], a[100:103], v[252:255]
    s_add_u32 s61, s61, 1
    ds_read_b64_tr_b16 a[20:21], v8 offset:16384
    v_mfma_f32_16x16x32_bf16 v[252:255], a[56:59], a[96:99], v[252:255]
    s_waitcnt lgkmcnt(8)
    ds_read_b64_tr_b16 a[22:23], v8 offset:20480
    s_cmp_lt_u32 s61, 6
    s_cbranch_scc1 L_kloop
    v_mfma_f32_16x16x32_bf16 v[88:91], a[0:3], a[64:67], v[88:91]
    ds_read_b64_tr_b16 a[24:25], v9 offset:0
    v_accvgpr_read_b32 v15, a240
    v_mfma_f32_16x16x32_bf16 v[88:91], a[4:7], a[68:71], v[88:91]
    ds_read_b64_tr_b16 a[26:27], v9 offset:4096
    v_accvgpr_read_b32 v14, a244
    v_mfma_f32_16x16x32_bf16 v[80:83], a[4:7], a[76:79], v[80:83]
    s_waitcnt lgkmcnt(12)
    ds_read_b64_tr_b16 a[28:29], v9 offset:16384
    global_load_dword a243, v14, s[100:101]
    v_mfma_f32_16x16x32_bf16 v[80:83], a[0:3], a[72:75], v[80:83]
    ds_read_b64_tr_b16 a[30:31], v9 offset:20480
    v_accvgpr_read_b32 v14, a242
    v_mfma_f32_16x16x32_bf16 v[72:75], a[0:3], a[80:83], v[72:75]
    s_add_u32 m0, s33, 0x0
    ds_read_b128 a[96:99], v4 offset:8192
    v_xor_b32 v3, 64, v14
    v_mfma_f32_16x16x32_bf16 v[72:75], a[4:7], a[84:87], v[72:75]
    s_waitcnt lgkmcnt(11)
    v_mfma_f32_16x16x32_bf16 v[64:67], a[4:7], a[92:95], v[64:67]
    ds_read_b128 a[100:103], v5 offset:8192
    buffer_load_dwordx4 v15, s[20:23], 0 offen offset:0 lds
    v_mfma_f32_16x16x32_bf16 v[64:67], a[0:3], a[88:91], v[64:67]
    v_mfma_f32_16x16x32_bf16 v[68:71], a[8:11], a[88:91], v[68:71]
    s_waitcnt lgkmcnt(10)
    ds_read_b128 a[108:111], v5 offset:10240
    v_mfma_f32_16x16x32_bf16 v[68:71], a[12:15], a[92:95], v[68:71]
    s_add_u32 m0, s33, 0x80
    v_mfma_f32_16x16x32_bf16 v[76:79], a[12:15], a[84:87], v[76:79]
    ds_read_b128 a[104:107], v4 offset:10240
    buffer_load_dwordx4 v15, s[20:23], 0 offen offset:896 lds
    v_mfma_f32_16x16x32_bf16 v[76:79], a[8:11], a[80:83], v[76:79]
    v_mfma_f32_16x16x32_bf16 v[84:87], a[8:11], a[72:75], v[84:87]
    ds_read_b128 a[112:115], v4 offset:12288
    v_mfma_f32_16x16x32_bf16 v[84:87], a[12:15], a[76:79], v[84:87]
    s_add_u32 m0, s33, 0x800
    v_mfma_f32_16x16x32_bf16 v[92:95], a[12:15], a[68:71], v[92:95]
    ds_read_b128 a[116:119], v5 offset:12288
    buffer_load_dwordx4 v15, s[20:23], s57 offen offset:0 lds
    v_mfma_f32_16x16x32_bf16 v[92:95], a[8:11], a[64:67], v[92:95]
    s_waitcnt lgkmcnt(10)
    v_mfma_f32_16x16x32_bf16 v[120:123], a[16:19], a[64:67], v[120:123]
    ds_read_b128 a[124:127], v5 offset:14336
    v_mfma_f32_16x16x32_bf16 v[120:123], a[20:23], a[68:71], v[120:123]
    s_add_u32 m0, s33, 0x880
    v_mfma_f32_16x16x32_bf16 v[112:115], a[20:23], a[76:79], v[112:115]
    ds_read_b128 a[120:123], v4 offset:14336
    buffer_load_dwordx4 v15, s[20:23], s57 offen offset:896 lds
    v_mfma_f32_16x16x32_bf16 v[112:115], a[16:19], a[72:75], v[112:115]
    v_mfma_f32_16x16x32_bf16 v[104:107], a[16:19], a[80:83], v[104:107]
    ds_read_b64_tr_b16 a[32:33], v10 offset:0
    v_mfma_f32_16x16x32_bf16 v[104:107], a[20:23], a[84:87], v[104:107]
    s_add_u32 m0, s33, 0xf80
    ds_read_b64_tr_b16 a[34:35], v10 offset:4096
    v_mfma_f32_16x16x32_bf16 v[96:99], a[20:23], a[92:95], v[96:99]
    ds_read_b64_tr_b16 a[36:37], v10 offset:16384
    buffer_load_dwordx4 v15, s[20:23], 0 offen offset:128 lds
    v_mfma_f32_16x16x32_bf16 v[96:99], a[16:19], a[88:91], v[96:99]
    s_waitcnt lgkmcnt(11)
    ds_read_b64_tr_b16 a[38:39], v10 offset:20480
    v_mfma_f32_16x16x32_bf16 v[100:103], a[24:27], a[88:91], v[100:103]
    ds_read_b64_tr_b16 a[40:41], v11 offset:0
    v_mfma_f32_16x16x32_bf16 v[100:103], a[28:31], a[92:95], v[100:103]
    s_add_u32 m0, s33, 0x1000
    ds_read_b64_tr_b16 a[42:43], v11 offset:4096
    v_mfma_f32_16x16x32_bf16 v[108:111], a[28:31], a[84:87], v[108:111]
    ds_read_b64_tr_b16 a[44:45], v11 offset:16384
    buffer_load_dwordx4 v15, s[20:23], 0 offen offset:1024 lds
    v_mfma_f32_16x16x32_bf16 v[108:111], a[24:27], a[80:83], v[108:111]
    ds_read_b64_tr_b16 a[46:47], v11 offset:20480
    v_mfma_f32_16x16x32_bf16 v[116:119], a[24:27], a[72:75], v[116:119]
    ds_read_b64_tr_b16 a[48:49], v12 offset:0
    v_mfma_f32_16x16x32_bf16 v[116:119], a[28:31], a[76:79], v[116:119]
    s_add_u32 m0, s33, 0x1780
    ds_read_b64_tr_b16 a[50:51], v12 offset:4096
    v_mfma_f32_16x16x32_bf16 v[124:127], a[28:31], a[68:71], v[124:127]
    ds_read_b64_tr_b16 a[52:53], v12 offset:16384
    buffer_load_dwordx4 v15, s[20:23], s57 offen offset:128 lds
    v_mfma_f32_16x16x32_bf16 v[124:127], a[24:27], a[64:67], v[124:127]
    s_waitcnt lgkmcnt(15)
    ds_read_b64_tr_b16 a[54:55], v12 offset:20480
    v_mfma_f32_16x16x32_bf16 a[232:235], a[0:3], a[96:99], a[232:235]
    ds_read_b64_tr_b16 a[56:57], v13 offset:0
    v_mfma_f32_16x16x32_bf16 a[232:235], a[4:7], a[100:103], a[232:235]
    s_add_u32 m0, s33, 0x1800
    ds_read_b64_tr_b16 a[58:59], v13 offset:4096
    v_mfma_f32_16x16x32_bf16 a[224:227], a[4:7], a[108:111], a[224:227]
    ds_read_b64_tr_b16 a[60:61], v13 offset:16384
    buffer_load_dwordx4 v15, s[20:23], s57 offen offset:1024 lds
    v_mfma_f32_16x16x32_bf16 a[224:227], a[0:3], a[104:107], a[224:227]
    s_waitcnt lgkmcnt(15)
    ds_read_b64_tr_b16 a[62:63], v13 offset:20480
    v_mfma_f32_16x16x32_bf16 v[24:27], a[0:3], a[112:115], v[24:27]
    v_mfma_f32_16x16x32_bf16 v[24:27], a[4:7], a[116:119], v[24:27]
    v_mfma_f32_16x16x32_bf16 v[16:19], a[4:7], a[124:127], v[16:19]
    v_mfma_f32_16x16x32_bf16 v[16:19], a[0:3], a[120:123], v[16:19]
    s_waitcnt lgkmcnt(0)
    v_mfma_f32_16x16x32_bf16 v[20:23], a[8:11], a[120:123], v[20:23]
    s_barrier
    v_mfma_f32_16x16x32_bf16 v[20:23], a[12:15], a[124:127], v[20:23]
    s_add_u32 m0, s29, 65536
    v_mfma_f32_16x16x32_bf16 v[28:31], a[12:15], a[116:119], v[28:31]
    buffer_load_dwordx4 v2, s[8:11], 0 offen lds
    v_mfma_f32_16x16x32_bf16 v[28:31], a[8:11], a[112:115], v[28:31]
    v_mfma_f32_16x16x32_bf16 a[228:231], a[8:11], a[104:107], a[228:231]
    v_mfma_f32_16x16x32_bf16 a[228:231], a[12:15], a[108:111], a[228:231]
    v_mfma_f32_16x16x32_bf16 a[236:239], a[12:15], a[100:103], a[236:239]
    s_add_u32 m0, s29, 0
    v_mfma_f32_16x16x32_bf16 a[236:239], a[8:11], a[96:99], a[236:239]
    buffer_load_dwordx4 v1, s[4:7], 0 offen lds
    v_mfma_f32_16x16x32_bf16 v[56:59], a[16:19], a[96:99], v[56:59]
    v_mfma_f32_16x16x32_bf16 v[56:59], a[20:23], a[100:103], v[56:59]
    v_mfma_f32_16x16x32_bf16 v[48:51], a[20:23], a[108:111], v[48:51]
    v_mfma_f32_16x16x32_bf16 v[48:51], a[16:19], a[104:107], v[48:51]
    s_add_u32 m0, s29, 69632
    v_mfma_f32_16x16x32_bf16 v[40:43], a[16:19], a[112:115], v[40:43]
    buffer_load_dwordx4 v2, s[8:11], s48 offen lds
    v_mfma_f32_16x16x32_bf16 v[40:43], a[20:23], a[116:119], v[40:43]
    v_mfma_f32_16x16x32_bf16 v[32:35], a[20:23], a[124:127], v[32:35]
    v_mfma_f32_16x16x32_bf16 v[32:35], a[16:19], a[120:123], v[32:35]
    v_mfma_f32_16x16x32_bf16 v[36:39], a[24:27], a[120:123], v[36:39]
    s_add_u32 m0, s29, 4096
    v_mfma_f32_16x16x32_bf16 v[36:39], a[28:31], a[124:127], v[36:39]
    buffer_load_dwordx4 v1, s[4:7], s41 offen lds
    v_mfma_f32_16x16x32_bf16 v[44:47], a[28:31], a[116:119], v[44:47]
    v_mfma_f32_16x16x32_bf16 v[44:47], a[24:27], a[112:115], v[44:47]
    v_mfma_f32_16x16x32_bf16 v[52:55], a[24:27], a[104:107], v[52:55]
    v_mfma_f32_16x16x32_bf16 v[52:55], a[28:31], a[108:111], v[52:55]
    s_add_u32 m0, s29, 73728
    v_mfma_f32_16x16x32_bf16 v[60:63], a[28:31], a[100:103], v[60:63]
    buffer_load_dwordx4 v2, s[8:11], s49 offen lds
    v_mfma_f32_16x16x32_bf16 v[60:63], a[24:27], a[96:99], v[60:63]
    v_mfma_f32_16x16x32_bf16 v[216:219], a[32:35], a[96:99], v[216:219]
    v_mfma_f32_16x16x32_bf16 v[216:219], a[36:39], a[100:103], v[216:219]
    v_mfma_f32_16x16x32_bf16 v[208:211], a[36:39], a[108:111], v[208:211]
    s_add_u32 m0, s29, 8192
    v_mfma_f32_16x16x32_bf16 v[208:211], a[32:35], a[104:107], v[208:211]
    buffer_load_dwordx4 v1, s[4:7], s42 offen lds
    v_mfma_f32_16x16x32_bf16 v[200:203], a[32:35], a[112:115], v[200:203]
    v_mfma_f32_16x16x32_bf16 v[200:203], a[36:39], a[116:119], v[200:203]
    v_mfma_f32_16x16x32_bf16 v[192:195], a[36:39], a[124:127], v[192:195]
    v_mfma_f32_16x16x32_bf16 v[192:195], a[32:35], a[120:123], v[192:195]
    s_add_u32 m0, s29, 77824
    v_mfma_f32_16x16x32_bf16 v[196:199], a[40:43], a[120:123], v[196:199]
    buffer_load_dwordx4 v2, s[8:11], s50 offen lds
    v_mfma_f32_16x16x32_bf16 v[196:199], a[44:47], a[124:127], v[196:199]
    v_mfma_f32_16x16x32_bf16 v[204:207], a[44:47], a[116:119], v[204:207]
    v_mfma_f32_16x16x32_bf16 v[204:207], a[40:43], a[112:115], v[204:207]
    v_mfma_f32_16x16x32_bf16 v[212:215], a[40:43], a[104:107], v[212:215]
    s_add_u32 m0, s29, 12288
    v_mfma_f32_16x16x32_bf16 v[212:215], a[44:47], a[108:111], v[212:215]
    buffer_load_dwordx4 v1, s[4:7], s43 offen lds
    v_mfma_f32_16x16x32_bf16 v[220:223], a[44:47], a[100:103], v[220:223]
    v_mfma_f32_16x16x32_bf16 v[220:223], a[40:43], a[96:99], v[220:223]
    v_mfma_f32_16x16x32_bf16 v[248:251], a[48:51], a[96:99], v[248:251]
    v_mfma_f32_16x16x32_bf16 v[248:251], a[52:55], a[100:103], v[248:251]
    s_add_u32 m0, s29, 81920
    v_mfma_f32_16x16x32_bf16 v[240:243], a[52:55], a[108:111], v[240:243]
    buffer_load_dwordx4 v2, s[8:11], s51 offen lds
    v_mfma_f32_16x16x32_bf16 v[240:243], a[48:51], a[104:107], v[240:243]
    v_mfma_f32_16x16x32_bf16 v[232:235], a[48:51], a[112:115], v[232:235]
    v_mfma_f32_16x16x32_bf16 v[232:235], a[52:55], a[116:119], v[232:235]
    v_mfma_f32_16x16x32_bf16 v[224:227], a[52:55], a[124:127], v[224:227]
    s_add_u32 m0, s29, 16384
    v_mfma_f32_16x16x32_bf16 v[224:227], a[48:51], a[120:123], v[224:227]
    buffer_load_dwordx4 v1, s[4:7], s44 offen lds
    v_mfma_f32_16x16x32_bf16 v[228:231], a[56:59], a[120:123], v[228:231]
    v_mfma_f32_16x16x32_bf16 v[228:231], a[60:63], a[124:127], v[228:231]
    v_mfma_f32_16x16x32_bf16 v[236:239], a[60:63], a[116:119], v[236:239]
    v_mfma_f32_16x16x32_bf16 v[236:239], a[56:59], a[112:115], v[236:239]
    s_add_u32 m0, s29, 86016
    v_mfma_f32_16x16x32_bf16 v[244:247], a[56:59], a[104:107], v[244:247]
    s_waitcnt vmcnt(10)
    buffer_load_dwordx4 v2, s[8:11], s52 offen lds
    v_mfma_f32_16x16x32_bf16 v[244:247], a[60:63], a[108:111], v[244:247]
    s_barrier
    ds_read_b64_tr_b16 a[0:1], v6 offset:32768
    v_mfma_f32_16x16x32_bf16 v[252:255], a[60:63], a[100:103], v[252:255]
    ds_read_b64_tr_b16 a[2:3], v6 offset:36864
    v_mfma_f32_16x16x32_bf16 v[252:255], a[56:59], a[96:99], v[252:255]
    ds_read_b128 a[96:99], v4 offset:40960
    v_mfma_f32_16x16x32_bf16 v[152:155], a[32:35], a[64:67], v[152:155]
    s_add_u32 m0, s29, 20480
    ds_read_b128 a[128:131], v14 offset:0
    v_mfma_f32_16x16x32_bf16 v[152:155], a[36:39], a[68:71], v[152:155]
    buffer_load_dwordx4 v1, s[4:7], s45 offen lds
    v_mfma_f32_16x16x32_bf16 v[144:147], a[36:39], a[76:79], v[144:147]
    ds_read_b64_tr_b16 a[4:5], v6 offset:49152
    v_mfma_f32_16x16x32_bf16 v[144:147], a[32:35], a[72:75], v[144:147]
    ds_read_b64_tr_b16 a[6:7], v6 offset:53248
    v_mfma_f32_16x16x32_bf16 v[136:139], a[32:35], a[80:83], v[136:139]
    ds_read_b128 a[100:103], v5 offset:40960
    v_mfma_f32_16x16x32_bf16 v[136:139], a[36:39], a[84:87], v[136:139]
    s_add_u32 m0, s29, 90112
    ds_read_b128 a[136:139], v3 offset:0
    v_mfma_f32_16x16x32_bf16 v[128:131], a[36:39], a[92:95], v[128:131]
    buffer_load_dwordx4 v2, s[8:11], s53 offen lds
    v_mfma_f32_16x16x32_bf16 v[128:131], a[32:35], a[88:91], v[128:131]
    ds_read_b128 a[108:111], v5 offset:43008
    v_mfma_f32_16x16x32_bf16 v[132:135], a[40:43], a[88:91], v[132:135]
    ds_read_b128 a[132:135], v14 offset:2048
    v_mfma_f32_16x16x32_bf16 v[132:135], a[44:47], a[92:95], v[132:135]
    ds_read_b128 a[104:107], v4 offset:43008
    v_mfma_f32_16x16x32_bf16 v[140:143], a[44:47], a[84:87], v[140:143]
    s_add_u32 m0, s29, 24576
    ds_read_b128 a[140:143], v3 offset:2048
    v_mfma_f32_16x16x32_bf16 v[140:143], a[40:43], a[80:83], v[140:143]
    buffer_load_dwordx4 v1, s[4:7], s46 offen lds
    v_mfma_f32_16x16x32_bf16 v[148:151], a[40:43], a[72:75], v[148:151]
    ds_read_b128 a[112:115], v4 offset:45056
    v_mfma_f32_16x16x32_bf16 v[148:151], a[44:47], a[76:79], v[148:151]
    ds_read_b128 a[144:147], v14 offset:4096
    v_mfma_f32_16x16x32_bf16 v[156:159], a[44:47], a[68:71], v[156:159]
    ds_read_b128 a[116:119], v5 offset:45056
    v_mfma_f32_16x16x32_bf16 v[156:159], a[40:43], a[64:67], v[156:159]
    s_add_u32 m0, s29, 94208
    ds_read_b128 a[152:155], v3 offset:4096
    v_mfma_f32_16x16x32_bf16 v[184:187], a[48:51], a[64:67], v[184:187]
    buffer_load_dwordx4 v2, s[8:11], s54 offen lds
    v_mfma_f32_16x16x32_bf16 v[184:187], a[52:55], a[68:71], v[184:187]
    ds_read_b128 a[124:127], v5 offset:47104
    v_mfma_f32_16x16x32_bf16 v[176:179], a[52:55], a[76:79], v[176:179]
    ds_read_b128 a[148:151], v14 offset:6144
    v_mfma_f32_16x16x32_bf16 v[176:179], a[48:51], a[72:75], v[176:179]
    ds_read_b128 a[120:123], v4 offset:47104
    v_mfma_f32_16x16x32_bf16 v[168:171], a[48:51], a[80:83], v[168:171]
    s_add_u32 m0, s29, 28672
    ds_read_b128 a[156:159], v3 offset:6144
    v_mfma_f32_16x16x32_bf16 v[168:171], a[52:55], a[84:87], v[168:171]
    buffer_load_dwordx4 v1, s[4:7], s47 offen lds
    v_mfma_f32_16x16x32_bf16 v[160:163], a[52:55], a[92:95], v[160:163]
    v_add_u32 v1, 128, v1
    v_add_u32 v2, 0x80000, v2
    v_mfma_f32_16x16x32_bf16 v[160:163], a[48:51], a[88:91], v[160:163]
    ds_read_b64_tr_b16 a[8:9], v7 offset:32768
    v_mfma_f32_16x16x32_bf16 v[164:167], a[56:59], a[88:91], v[164:167]
    v_mfma_f32_16x16x32_bf16 v[164:167], a[60:63], a[92:95], v[164:167]
    ds_read_b64_tr_b16 a[10:11], v7 offset:36864
    v_mfma_f32_16x16x32_bf16 v[172:175], a[60:63], a[84:87], v[172:175]
    ds_read_b64_tr_b16 a[12:13], v7 offset:49152
    v_mfma_f32_16x16x32_bf16 v[172:175], a[56:59], a[80:83], v[172:175]
    ds_read_b64_tr_b16 a[14:15], v7 offset:53248
    v_mfma_f32_16x16x32_bf16 v[180:183], a[56:59], a[72:75], v[180:183]
    ds_read_b64_tr_b16 a[16:17], v8 offset:32768
    v_mfma_f32_16x16x32_bf16 v[180:183], a[60:63], a[76:79], v[180:183]
    ds_read_b64_tr_b16 a[18:19], v8 offset:36864
    v_mfma_f32_16x16x32_bf16 v[188:191], a[60:63], a[68:71], v[188:191]
    ds_read_b64_tr_b16 a[20:21], v8 offset:49152
    v_mfma_f32_16x16x32_bf16 v[188:191], a[56:59], a[64:67], v[188:191]
    s_waitcnt lgkmcnt(15)
    ds_read_b64_tr_b16 a[22:23], v8 offset:53248
    v_mfma_f32_16x16x32_bf16 a[232:235], a[0:3], a[96:99], a[232:235]
    ds_read_b64_tr_b16 a[24:25], v9 offset:32768
    v_mfma_f32_16x16x32_bf16 a[232:235], a[4:7], a[100:103], a[232:235]
    s_add_u32 m0, s33, 0xffffff00
    ds_read_b64_tr_b16 a[26:27], v9 offset:36864
    v_mfma_f32_16x16x32_bf16 a[224:227], a[4:7], a[108:111], a[224:227]
    s_waitcnt lgkmcnt(10)
    ds_read_b64_tr_b16 a[28:29], v9 offset:49152
    v_mfma_f32_16x16x32_bf16 a[224:227], a[0:3], a[104:107], a[224:227]
    ds_read_b64_tr_b16 a[30:31], v9 offset:53248
    buffer_load_dwordx4 v15, s[20:23], 0 offen offset:256 lds
    v_mfma_f32_16x16x32_bf16 v[24:27], a[0:3], a[112:115], v[24:27]
    ds_read_b128 a[64:67], v4 offset:32768
    v_mfma_f32_16x16x32_bf16 v[24:27], a[4:7], a[116:119], v[24:27]
    v_mfma_f32_16x16x32_bf16 v[16:19], a[4:7], a[124:127], v[16:19]
    s_add_u32 m0, s33, 0xffffff80
    ds_read_b128 a[68:71], v5 offset:32768
    v_mfma_f32_16x16x32_bf16 v[16:19], a[0:3], a[120:123], v[16:19]
    s_waitcnt lgkmcnt(10)
    buffer_load_dwordx4 v15, s[20:23], 0 offen offset:1152 lds
    v_mfma_f32_16x16x32_bf16 v[20:23], a[8:11], a[120:123], v[20:23]
    ds_read_b128 a[76:79], v5 offset:34816
    v_mfma_f32_16x16x32_bf16 v[20:23], a[12:15], a[124:127], v[20:23]
    v_mfma_f32_16x16x32_bf16 v[28:31], a[12:15], a[116:119], v[28:31]
    s_add_u32 m0, s33, 0x700
    ds_read_b128 a[72:75], v4 offset:34816
    v_mfma_f32_16x16x32_bf16 v[28:31], a[8:11], a[112:115], v[28:31]
    buffer_load_dwordx4 v15, s[20:23], s57 offen offset:256 lds
    v_mfma_f32_16x16x32_bf16 a[228:231], a[8:11], a[104:107], a[228:231]
    ds_read_b128 a[80:83], v4 offset:36864
    v_mfma_f32_16x16x32_bf16 a[228:231], a[12:15], a[108:111], a[228:231]
    v_mfma_f32_16x16x32_bf16 a[236:239], a[12:15], a[100:103], a[236:239]
    s_add_u32 m0, s33, 0x780
    ds_read_b128 a[84:87], v5 offset:36864
    v_mfma_f32_16x16x32_bf16 a[236:239], a[8:11], a[96:99], a[236:239]
    s_waitcnt lgkmcnt(10)
    buffer_load_dwordx4 v15, s[20:23], s57 offen offset:1152 lds
    v_mfma_f32_16x16x32_bf16 v[56:59], a[16:19], a[96:99], v[56:59]
    ds_read_b128 a[92:95], v5 offset:38912
    v_mfma_f32_16x16x32_bf16 v[56:59], a[20:23], a[100:103], v[56:59]
    v_mfma_f32_16x16x32_bf16 v[48:51], a[20:23], a[108:111], v[48:51]
    s_add_u32 m0, s33, 0xe80
    ds_read_b128 a[88:91], v4 offset:38912
    v_mfma_f32_16x16x32_bf16 v[48:51], a[16:19], a[104:107], v[48:51]
    buffer_load_dwordx4 v15, s[20:23], 0 offen offset:384 lds
    v_mfma_f32_16x16x32_bf16 v[40:43], a[16:19], a[112:115], v[40:43]
    ds_read_b64_tr_b16 a[32:33], v10 offset:32768
    v_mfma_f32_16x16x32_bf16 v[40:43], a[20:23], a[116:119], v[40:43]
    ds_read_b64_tr_b16 a[34:35], v10 offset:36864
    v_mfma_f32_16x16x32_bf16 v[32:35], a[20:23], a[124:127], v[32:35]
    s_add_u32 m0, s33, 0xf00
    ds_read_b64_tr_b16 a[36:37], v10 offset:49152
    v_mfma_f32_16x16x32_bf16 v[32:35], a[16:19], a[120:123], v[32:35]
    s_waitcnt lgkmcnt(11)
    ds_read_b64_tr_b16 a[38:39], v10 offset:53248
    buffer_load_dwordx4 v15, s[20:23], 0 offen offset:1280 lds
    v_mfma_f32_16x16x32_bf16 v[36:39], a[24:27], a[120:123], v[36:39]
    ds_read_b64_tr_b16 a[40:41], v11 offset:32768
    v_mfma_f32_16x16x32_bf16 v[36:39], a[28:31], a[124:127], v[36:39]
    ds_read_b64_tr_b16 a[42:43], v11 offset:36864
    v_mfma_f32_16x16x32_bf16 v[44:47], a[28:31], a[116:119], v[44:47]
    s_add_u32 m0, s33, 0x1680
    ds_read_b64_tr_b16 a[44:45], v11 offset:49152
    v_mfma_f32_16x16x32_bf16 v[44:47], a[24:27], a[112:115], v[44:47]
    ds_read_b64_tr_b16 a[46:47], v11 offset:53248
    buffer_load_dwordx4 v15, s[20:23], s57 offen offset:384 lds
    v_mfma_f32_16x16x32_bf16 v[52:55], a[24:27], a[104:107], v[52:55]
    ds_read_b64_tr_b16 a[48:49], v12 offset:32768
    v_mfma_f32_16x16x32_bf16 v[52:55], a[28:31], a[108:111], v[52:55]
    ds_read_b64_tr_b16 a[50:51], v12 offset:36864
    v_mfma_f32_16x16x32_bf16 v[60:63], a[28:31], a[100:103], v[60:63]
    s_add_u32 m0, s33, 0x1700
    ds_read_b64_tr_b16 a[52:53], v12 offset:49152
    v_mfma_f32_16x16x32_bf16 v[60:63], a[24:27], a[96:99], v[60:63]
    s_waitcnt lgkmcnt(15)
    ds_read_b64_tr_b16 a[54:55], v12 offset:53248
    buffer_load_dwordx4 v15, s[20:23], s57 offen offset:1280 lds
    v_mfma_f32_16x16x32_bf16 v[88:91], a[0:3], a[64:67], v[88:91]
    ds_read_b64_tr_b16 a[56:57], v13 offset:32768
    v_mfma_f32_16x16x32_bf16 v[88:91], a[4:7], a[68:71], v[88:91]
    ds_read_b64_tr_b16 a[58:59], v13 offset:36864
    v_mfma_f32_16x16x32_bf16 v[80:83], a[4:7], a[76:79], v[80:83]
    ds_read_b64_tr_b16 a[60:61], v13 offset:49152
    v_mfma_f32_16x16x32_bf16 v[80:83], a[0:3], a[72:75], v[80:83]
    s_waitcnt lgkmcnt(15)
    ds_read_b64_tr_b16 a[62:63], v13 offset:53248
    v_mfma_f32_16x16x32_bf16 v[72:75], a[0:3], a[80:83], v[72:75]
    v_mfma_f32_16x16x32_bf16 v[72:75], a[4:7], a[84:87], v[72:75]
    v_mfma_f32_16x16x32_bf16 v[64:67], a[4:7], a[92:95], v[64:67]
    v_mfma_f32_16x16x32_bf16 v[64:67], a[0:3], a[88:91], v[64:67]
    s_waitcnt lgkmcnt(0)
    v_mfma_f32_16x16x32_bf16 v[68:71], a[8:11], a[88:91], v[68:71]
    s_barrier
    v_mfma_f32_16x16x32_bf16 v[68:71], a[12:15], a[92:95], v[68:71]
    s_add_u32 m0, s29, 98304
    v_mfma_f32_16x16x32_bf16 v[76:79], a[12:15], a[84:87], v[76:79]
    buffer_load_dwordx4 v2, s[8:11], 0 offen lds
    v_mfma_f32_16x16x32_bf16 v[76:79], a[8:11], a[80:83], v[76:79]
    v_mfma_f32_16x16x32_bf16 v[84:87], a[8:11], a[72:75], v[84:87]
    v_mfma_f32_16x16x32_bf16 v[84:87], a[12:15], a[76:79], v[84:87]
    v_mfma_f32_16x16x32_bf16 v[92:95], a[12:15], a[68:71], v[92:95]
    s_add_u32 m0, s29, 32768
    v_mfma_f32_16x16x32_bf16 v[92:95], a[8:11], a[64:67], v[92:95]
    buffer_load_dwordx4 v1, s[4:7], 0 offen lds
    v_mfma_f32_16x16x32_bf16 v[120:123], a[16:19], a[64:67], v[120:123]
    v_mfma_f32_16x16x32_bf16 v[120:123], a[20:23], a[68:71], v[120:123]
    v_mfma_f32_16x16x32_bf16 v[112:115], a[20:23], a[76:79], v[112:115]
    v_mfma_f32_16x16x32_bf16 v[112:115], a[16:19], a[72:75], v[112:115]
    s_add_u32 m0, s29, 102400
    v_mfma_f32_16x16x32_bf16 v[104:107], a[16:19], a[80:83], v[104:107]
    buffer_load_dwordx4 v2, s[8:11], s48 offen lds
    v_mfma_f32_16x16x32_bf16 v[104:107], a[20:23], a[84:87], v[104:107]
    v_mfma_f32_16x16x32_bf16 v[96:99], a[20:23], a[92:95], v[96:99]
    v_mfma_f32_16x16x32_bf16 v[96:99], a[16:19], a[88:91], v[96:99]
    v_mfma_f32_16x16x32_bf16 v[100:103], a[24:27], a[88:91], v[100:103]
    s_add_u32 m0, s29, 36864
    v_mfma_f32_16x16x32_bf16 v[100:103], a[28:31], a[92:95], v[100:103]
    buffer_load_dwordx4 v1, s[4:7], s41 offen lds
    v_mfma_f32_16x16x32_bf16 v[108:111], a[28:31], a[84:87], v[108:111]
    v_mfma_f32_16x16x32_bf16 v[108:111], a[24:27], a[80:83], v[108:111]
    v_mfma_f32_16x16x32_bf16 v[116:119], a[24:27], a[72:75], v[116:119]
    v_mfma_f32_16x16x32_bf16 v[116:119], a[28:31], a[76:79], v[116:119]
    s_add_u32 m0, s29, 106496
    v_mfma_f32_16x16x32_bf16 v[124:127], a[28:31], a[68:71], v[124:127]
    buffer_load_dwordx4 v2, s[8:11], s49 offen lds
    v_mfma_f32_16x16x32_bf16 v[124:127], a[24:27], a[64:67], v[124:127]
    v_mfma_f32_16x16x32_bf16 v[152:155], a[32:35], a[64:67], v[152:155]
    v_mfma_f32_16x16x32_bf16 v[152:155], a[36:39], a[68:71], v[152:155]
    v_mfma_f32_16x16x32_bf16 v[144:147], a[36:39], a[76:79], v[144:147]
    s_add_u32 m0, s29, 40960
    v_mfma_f32_16x16x32_bf16 v[144:147], a[32:35], a[72:75], v[144:147]
    buffer_load_dwordx4 v1, s[4:7], s42 offen lds
    v_mfma_f32_16x16x32_bf16 v[136:139], a[32:35], a[80:83], v[136:139]
    v_mfma_f32_16x16x32_bf16 v[136:139], a[36:39], a[84:87], v[136:139]
    v_mfma_f32_16x16x32_bf16 v[128:131], a[36:39], a[92:95], v[128:131]
    v_mfma_f32_16x16x32_bf16 v[128:131], a[32:35], a[88:91], v[128:131]
    s_add_u32 m0, s29, 110592
    v_mfma_f32_16x16x32_bf16 v[132:135], a[40:43], a[88:91], v[132:135]
    buffer_load_dwordx4 v2, s[8:11], s50 offen lds
    v_mfma_f32_16x16x32_bf16 v[132:135], a[44:47], a[92:95], v[132:135]
    v_mfma_f32_16x16x32_bf16 v[140:143], a[44:47], a[84:87], v[140:143]
    v_mfma_f32_16x16x32_bf16 v[140:143], a[40:43], a[80:83], v[140:143]
    v_mfma_f32_16x16x32_bf16 v[148:151], a[40:43], a[72:75], v[148:151]
    s_add_u32 m0, s29, 45056
    v_mfma_f32_16x16x32_bf16 v[148:151], a[44:47], a[76:79], v[148:151]
    buffer_load_dwordx4 v1, s[4:7], s43 offen lds
    v_mfma_f32_16x16x32_bf16 v[156:159], a[44:47], a[68:71], v[156:159]
    v_mfma_f32_16x16x32_bf16 v[156:159], a[40:43], a[64:67], v[156:159]
    v_mfma_f32_16x16x32_bf16 v[184:187], a[48:51], a[64:67], v[184:187]
    v_mfma_f32_16x16x32_bf16 v[184:187], a[52:55], a[68:71], v[184:187]
    s_add_u32 m0, s29, 114688
    v_mfma_f32_16x16x32_bf16 v[176:179], a[52:55], a[76:79], v[176:179]
    buffer_load_dwordx4 v2, s[8:11], s51 offen lds
    v_mfma_f32_16x16x32_bf16 v[176:179], a[48:51], a[72:75], v[176:179]
    v_mfma_f32_16x16x32_bf16 v[168:171], a[48:51], a[80:83], v[168:171]
    v_mfma_f32_16x16x32_bf16 v[168:171], a[52:55], a[84:87], v[168:171]
    v_mfma_f32_16x16x32_bf16 v[160:163], a[52:55], a[92:95], v[160:163]
    s_add_u32 m0, s29, 49152
    v_mfma_f32_16x16x32_bf16 v[160:163], a[48:51], a[88:91], v[160:163]
    buffer_load_dwordx4 v1, s[4:7], s44 offen lds
    v_mfma_f32_16x16x32_bf16 v[164:167], a[56:59], a[88:91], v[164:167]
    v_mfma_f32_16x16x32_bf16 v[164:167], a[60:63], a[92:95], v[164:167]
    v_mfma_f32_16x16x32_bf16 v[172:175], a[60:63], a[84:87], v[172:175]
    v_mfma_f32_16x16x32_bf16 v[172:175], a[56:59], a[80:83], v[172:175]
    s_add_u32 m0, s29, 118784
    v_mfma_f32_16x16x32_bf16 v[180:183], a[56:59], a[72:75], v[180:183]
    s_waitcnt vmcnt(10)
    buffer_load_dwordx4 v2, s[8:11], s52 offen lds
    v_mfma_f32_16x16x32_bf16 v[180:183], a[60:63], a[76:79], v[180:183]
    s_barrier
    ds_read_b64_tr_b16 a[0:1], v6 offset:0
    v_mfma_f32_16x16x32_bf16 v[188:191], a[60:63], a[68:71], v[188:191]
    ds_read_b64_tr_b16 a[2:3], v6 offset:4096
    v_mfma_f32_16x16x32_bf16 v[188:191], a[56:59], a[64:67], v[188:191]
    ds_read_b128 a[64:67], v4 offset:0
    v_mfma_f32_16x16x32_bf16 v[216:219], a[32:35], a[96:99], v[216:219]
    s_add_u32 m0, s29, 53248
    ds_read_b128 a[160:163], v14 offset:0
    v_mfma_f32_16x16x32_bf16 v[216:219], a[36:39], a[100:103], v[216:219]
    buffer_load_dwordx4 v1, s[4:7], s45 offen lds
    v_mfma_f32_16x16x32_bf16 v[208:211], a[36:39], a[108:111], v[208:211]
    ds_read_b64_tr_b16 a[4:5], v6 offset:16384
    v_mfma_f32_16x16x32_bf16 v[208:211], a[32:35], a[104:107], v[208:211]
    ds_read_b64_tr_b16 a[6:7], v6 offset:20480
    v_mfma_f32_16x16x32_bf16 v[200:203], a[32:35], a[112:115], v[200:203]
    ds_read_b128 a[68:71], v5 offset:0
    v_mfma_f32_16x16x32_bf16 v[200:203], a[36:39], a[116:119], v[200:203]
    s_add_u32 m0, s29, 122880
    ds_read_b128 a[168:171], v3 offset:0
    v_mfma_f32_16x16x32_bf16 v[192:195], a[36:39], a[124:127], v[192:195]
    buffer_load_dwordx4 v2, s[8:11], s53 offen lds
    v_mfma_f32_16x16x32_bf16 v[192:195], a[32:35], a[120:123], v[192:195]
    ds_read_b128 a[76:79], v5 offset:2048
    v_mfma_f32_16x16x32_bf16 v[196:199], a[40:43], a[120:123], v[196:199]
    ds_read_b128 a[164:167], v14 offset:2048
    v_mfma_f32_16x16x32_bf16 v[196:199], a[44:47], a[124:127], v[196:199]
    ds_read_b128 a[72:75], v4 offset:2048
    v_mfma_f32_16x16x32_bf16 v[204:207], a[44:47], a[116:119], v[204:207]
    s_add_u32 m0, s29, 57344
    ds_read_b128 a[172:175], v3 offset:2048
    v_mfma_f32_16x16x32_bf16 v[204:207], a[40:43], a[112:115], v[204:207]
    buffer_load_dwordx4 v1, s[4:7], s46 offen lds
    v_mfma_f32_16x16x32_bf16 v[212:215], a[40:43], a[104:107], v[212:215]
    ds_read_b128 a[80:83], v4 offset:4096
    v_mfma_f32_16x16x32_bf16 v[212:215], a[44:47], a[108:111], v[212:215]
    ds_read_b128 a[176:179], v14 offset:4096
    v_mfma_f32_16x16x32_bf16 v[220:223], a[44:47], a[100:103], v[220:223]
    ds_read_b128 a[84:87], v5 offset:4096
    v_mfma_f32_16x16x32_bf16 v[220:223], a[40:43], a[96:99], v[220:223]
    s_add_u32 m0, s29, 126976
    ds_read_b128 a[184:187], v3 offset:4096
    v_mfma_f32_16x16x32_bf16 v[248:251], a[48:51], a[96:99], v[248:251]
    buffer_load_dwordx4 v2, s[8:11], s54 offen lds
    v_mfma_f32_16x16x32_bf16 v[248:251], a[52:55], a[100:103], v[248:251]
    ds_read_b128 a[92:95], v5 offset:6144
    v_mfma_f32_16x16x32_bf16 v[240:243], a[52:55], a[108:111], v[240:243]
    ds_read_b128 a[180:183], v14 offset:6144
    v_mfma_f32_16x16x32_bf16 v[240:243], a[48:51], a[104:107], v[240:243]
    ds_read_b128 a[88:91], v4 offset:6144
    v_mfma_f32_16x16x32_bf16 v[232:235], a[48:51], a[112:115], v[232:235]
    s_add_u32 m0, s29, 61440
    ds_read_b128 a[188:191], v3 offset:6144
    v_mfma_f32_16x16x32_bf16 v[232:235], a[52:55], a[116:119], v[232:235]
    buffer_load_dwordx4 v1, s[4:7], s47 offen lds
    v_mfma_f32_16x16x32_bf16 v[224:227], a[52:55], a[124:127], v[224:227]
    v_add_u32 v1, 128, v1
    v_add_u32 v2, 0x80000, v2
    v_mfma_f32_16x16x32_bf16 v[224:227], a[48:51], a[120:123], v[224:227]
    ds_read_b64_tr_b16 a[8:9], v7 offset:0
    v_mfma_f32_16x16x32_bf16 v[228:231], a[56:59], a[120:123], v[228:231]
    v_mfma_f32_16x16x32_bf16 v[228:231], a[60:63], a[124:127], v[228:231]
    ds_read_b64_tr_b16 a[10:11], v7 offset:4096
    v_mfma_f32_16x16x32_bf16 v[236:239], a[60:63], a[116:119], v[236:239]
    ds_read_b64_tr_b16 a[12:13], v7 offset:16384
    v_mfma_f32_16x16x32_bf16 v[236:239], a[56:59], a[112:115], v[236:239]
    ds_read_b64_tr_b16 a[14:15], v7 offset:20480
    v_mfma_f32_16x16x32_bf16 v[244:247], a[56:59], a[104:107], v[244:247]
    ds_read_b64_tr_b16 a[16:17], v8 offset:0
    v_mfma_f32_16x16x32_bf16 v[244:247], a[60:63], a[108:111], v[244:247]
    ds_read_b64_tr_b16 a[18:19], v8 offset:4096
    v_mfma_f32_16x16x32_bf16 v[252:255], a[60:63], a[100:103], v[252:255]
    ds_read_b64_tr_b16 a[20:21], v8 offset:16384
    v_mfma_f32_16x16x32_bf16 v[252:255], a[56:59], a[96:99], v[252:255]
    s_waitcnt lgkmcnt(15)
    ds_read_b64_tr_b16 a[22:23], v8 offset:20480
    v_mfma_f32_16x16x32_bf16 v[88:91], a[0:3], a[64:67], v[88:91]
    ds_read_b64_tr_b16 a[24:25], v9 offset:0
    v_lshlrev_b32 v1, 4, v0
    v_mfma_f32_16x16x32_bf16 v[88:91], a[4:7], a[68:71], v[88:91]
    s_add_u32 m0, s33, 0xfffffe00
    ds_read_b64_tr_b16 a[26:27], v9 offset:4096
    v_mfma_f32_16x16x32_bf16 v[80:83], a[4:7], a[76:79], v[80:83]
    s_waitcnt lgkmcnt(10)
    ds_read_b64_tr_b16 a[28:29], v9 offset:16384
    v_mfma_f32_16x16x32_bf16 v[80:83], a[0:3], a[72:75], v[80:83]
    ds_read_b64_tr_b16 a[30:31], v9 offset:20480
    buffer_load_dwordx4 v15, s[20:23], 0 offen offset:512 lds
    v_mfma_f32_16x16x32_bf16 v[72:75], a[0:3], a[80:83], v[72:75]
    ds_read_b128 a[96:99], v4 offset:8192
    v_mfma_f32_16x16x32_bf16 v[72:75], a[4:7], a[84:87], v[72:75]
    v_mfma_f32_16x16x32_bf16 v[64:67], a[4:7], a[92:95], v[64:67]
    s_add_u32 m0, s33, 0xfffffe80
    ds_read_b128 a[100:103], v5 offset:8192
    v_mfma_f32_16x16x32_bf16 v[64:67], a[0:3], a[88:91], v[64:67]
    s_waitcnt lgkmcnt(10)
    buffer_load_dwordx4 v15, s[20:23], 0 offen offset:1408 lds
    v_mfma_f32_16x16x32_bf16 v[68:71], a[8:11], a[88:91], v[68:71]
    ds_read_b128 a[108:111], v5 offset:10240
    v_mfma_f32_16x16x32_bf16 v[68:71], a[12:15], a[92:95], v[68:71]
    v_mfma_f32_16x16x32_bf16 v[76:79], a[12:15], a[84:87], v[76:79]
    s_add_u32 m0, s33, 0x600
    ds_read_b128 a[104:107], v4 offset:10240
    v_mfma_f32_16x16x32_bf16 v[76:79], a[8:11], a[80:83], v[76:79]
    buffer_load_dwordx4 v15, s[20:23], s57 offen offset:512 lds
    v_mfma_f32_16x16x32_bf16 v[84:87], a[8:11], a[72:75], v[84:87]
    ds_read_b128 a[112:115], v4 offset:12288
    v_mfma_f32_16x16x32_bf16 v[84:87], a[12:15], a[76:79], v[84:87]
    v_mfma_f32_16x16x32_bf16 v[92:95], a[12:15], a[68:71], v[92:95]
    s_add_u32 m0, s33, 0x680
    ds_read_b128 a[116:119], v5 offset:12288
    v_mfma_f32_16x16x32_bf16 v[92:95], a[8:11], a[64:67], v[92:95]
    s_waitcnt lgkmcnt(10)
    buffer_load_dwordx4 v15, s[20:23], s57 offen offset:1408 lds
    v_mfma_f32_16x16x32_bf16 v[120:123], a[16:19], a[64:67], v[120:123]
    ds_read_b128 a[124:127], v5 offset:14336
    v_mfma_f32_16x16x32_bf16 v[120:123], a[20:23], a[68:71], v[120:123]
    v_mfma_f32_16x16x32_bf16 v[112:115], a[20:23], a[76:79], v[112:115]
    s_add_u32 m0, s33, 0xd80
    ds_read_b128 a[120:123], v4 offset:14336
    v_mfma_f32_16x16x32_bf16 v[112:115], a[16:19], a[72:75], v[112:115]
    buffer_load_dwordx4 v15, s[20:23], 0 offen offset:640 lds
    v_mfma_f32_16x16x32_bf16 v[104:107], a[16:19], a[80:83], v[104:107]
    ds_read_b64_tr_b16 a[32:33], v10 offset:0
    v_mfma_f32_16x16x32_bf16 v[104:107], a[20:23], a[84:87], v[104:107]
    ds_read_b64_tr_b16 a[34:35], v10 offset:4096
    v_mfma_f32_16x16x32_bf16 v[96:99], a[20:23], a[92:95], v[96:99]
    s_add_u32 m0, s33, 0xe00
    ds_read_b64_tr_b16 a[36:37], v10 offset:16384
    v_mfma_f32_16x16x32_bf16 v[96:99], a[16:19], a[88:91], v[96:99]
    s_waitcnt lgkmcnt(11)
    ds_read_b64_tr_b16 a[38:39], v10 offset:20480
    buffer_load_dwordx4 v15, s[20:23], 0 offen offset:1536 lds
    v_mfma_f32_16x16x32_bf16 v[100:103], a[24:27], a[88:91], v[100:103]
    ds_read_b64_tr_b16 a[40:41], v11 offset:0
    v_mfma_f32_16x16x32_bf16 v[100:103], a[28:31], a[92:95], v[100:103]
    ds_read_b64_tr_b16 a[42:43], v11 offset:4096
    v_mfma_f32_16x16x32_bf16 v[108:111], a[28:31], a[84:87], v[108:111]
    s_add_u32 m0, s33, 0x1580
    ds_read_b64_tr_b16 a[44:45], v11 offset:16384
    v_mfma_f32_16x16x32_bf16 v[108:111], a[24:27], a[80:83], v[108:111]
    ds_read_b64_tr_b16 a[46:47], v11 offset:20480
    buffer_load_dwordx4 v15, s[20:23], s57 offen offset:640 lds
    v_mfma_f32_16x16x32_bf16 v[116:119], a[24:27], a[72:75], v[116:119]
    ds_read_b64_tr_b16 a[48:49], v12 offset:0
    v_mfma_f32_16x16x32_bf16 v[116:119], a[28:31], a[76:79], v[116:119]
    ds_read_b64_tr_b16 a[50:51], v12 offset:4096
    v_mfma_f32_16x16x32_bf16 v[124:127], a[28:31], a[68:71], v[124:127]
    s_add_u32 m0, s33, 0x1600
    ds_read_b64_tr_b16 a[52:53], v12 offset:16384
    v_mfma_f32_16x16x32_bf16 v[124:127], a[24:27], a[64:67], v[124:127]
    s_waitcnt lgkmcnt(15)
    ds_read_b64_tr_b16 a[54:55], v12 offset:20480
    buffer_load_dwordx4 v15, s[20:23], s57 offen offset:1536 lds
    v_mfma_f32_16x16x32_bf16 a[232:235], a[0:3], a[96:99], a[232:235]
    ds_read_b64_tr_b16 a[56:57], v13 offset:0
    v_mfma_f32_16x16x32_bf16 a[232:235], a[4:7], a[100:103], a[232:235]
    ds_read_b64_tr_b16 a[58:59], v13 offset:4096
    v_mfma_f32_16x16x32_bf16 a[224:227], a[4:7], a[108:111], a[224:227]
    ds_read_b64_tr_b16 a[60:61], v13 offset:16384
    v_mfma_f32_16x16x32_bf16 a[224:227], a[0:3], a[104:107], a[224:227]
    s_waitcnt lgkmcnt(15)
    ds_read_b64_tr_b16 a[62:63], v13 offset:20480
    v_mfma_f32_16x16x32_bf16 v[24:27], a[0:3], a[112:115], v[24:27]
    v_mfma_f32_16x16x32_bf16 v[24:27], a[4:7], a[116:119], v[24:27]
    v_mfma_f32_16x16x32_bf16 v[16:19], a[4:7], a[124:127], v[16:19]
    v_mfma_f32_16x16x32_bf16 v[16:19], a[0:3], a[120:123], v[16:19]
    s_waitcnt lgkmcnt(0)
    v_mfma_f32_16x16x32_bf16 v[20:23], a[8:11], a[120:123], v[20:23]
    s_barrier
    v_mfma_f32_16x16x32_bf16 v[20:23], a[12:15], a[124:127], v[20:23]
    s_add_u32 m0, s29, 0
    v_add_u32 v2, 0xff800000, v2
    v_mfma_f32_16x16x32_bf16 v[28:31], a[12:15], a[116:119], v[28:31]
    buffer_load_dwordx4 v2, s[16:19], 0 offen lds
    v_mfma_f32_16x16x32_bf16 v[28:31], a[8:11], a[112:115], v[28:31]
    v_mfma_f32_16x16x32_bf16 a[228:231], a[8:11], a[104:107], a[228:231]
    v_mfma_f32_16x16x32_bf16 a[228:231], a[12:15], a[108:111], a[228:231]
    v_mfma_f32_16x16x32_bf16 a[236:239], a[12:15], a[100:103], a[236:239]
    s_add_u32 m0, s29, 4096
    v_mfma_f32_16x16x32_bf16 a[236:239], a[8:11], a[96:99], a[236:239]
    buffer_load_dwordx4 v2, s[16:19], s48 offen lds
    v_mfma_f32_16x16x32_bf16 v[56:59], a[16:19], a[96:99], v[56:59]
    v_mfma_f32_16x16x32_bf16 v[56:59], a[20:23], a[100:103], v[56:59]
    v_mfma_f32_16x16x32_bf16 v[48:51], a[20:23], a[108:111], v[48:51]
    v_mfma_f32_16x16x32_bf16 v[48:51], a[16:19], a[104:107], v[48:51]
    s_add_u32 m0, s29, 8192
    v_mfma_f32_16x16x32_bf16 v[40:43], a[16:19], a[112:115], v[40:43]
    buffer_load_dwordx4 v2, s[16:19], s49 offen lds
    v_mfma_f32_16x16x32_bf16 v[40:43], a[20:23], a[116:119], v[40:43]
    v_mfma_f32_16x16x32_bf16 v[32:35], a[20:23], a[124:127], v[32:35]
    v_mfma_f32_16x16x32_bf16 v[32:35], a[16:19], a[120:123], v[32:35]
    v_mfma_f32_16x16x32_bf16 v[36:39], a[24:27], a[120:123], v[36:39]
    s_add_u32 m0, s29, 12288
    v_mfma_f32_16x16x32_bf16 v[36:39], a[28:31], a[124:127], v[36:39]
    buffer_load_dwordx4 v2, s[16:19], s50 offen lds
    v_mfma_f32_16x16x32_bf16 v[44:47], a[28:31], a[116:119], v[44:47]
    v_mfma_f32_16x16x32_bf16 v[44:47], a[24:27], a[112:115], v[44:47]
    v_mfma_f32_16x16x32_bf16 v[52:55], a[24:27], a[104:107], v[52:55]
    v_mfma_f32_16x16x32_bf16 v[52:55], a[28:31], a[108:111], v[52:55]
    s_add_u32 m0, s29, 16384
    v_mfma_f32_16x16x32_bf16 v[60:63], a[28:31], a[100:103], v[60:63]
    buffer_load_dwordx4 v2, s[16:19], s51 offen lds
    v_mfma_f32_16x16x32_bf16 v[60:63], a[24:27], a[96:99], v[60:63]
    v_mfma_f32_16x16x32_bf16 v[216:219], a[32:35], a[96:99], v[216:219]
    v_mfma_f32_16x16x32_bf16 v[216:219], a[36:39], a[100:103], v[216:219]
    v_mfma_f32_16x16x32_bf16 v[208:211], a[36:39], a[108:111], v[208:211]
    s_add_u32 m0, s29, 20480
    v_mfma_f32_16x16x32_bf16 v[208:211], a[32:35], a[104:107], v[208:211]
    buffer_load_dwordx4 v2, s[16:19], s52 offen lds
    v_mfma_f32_16x16x32_bf16 v[200:203], a[32:35], a[112:115], v[200:203]
    v_mfma_f32_16x16x32_bf16 v[200:203], a[36:39], a[116:119], v[200:203]
    v_mfma_f32_16x16x32_bf16 v[192:195], a[36:39], a[124:127], v[192:195]
    v_mfma_f32_16x16x32_bf16 v[192:195], a[32:35], a[120:123], v[192:195]
    s_add_u32 m0, s29, 24576
    v_mfma_f32_16x16x32_bf16 v[196:199], a[40:43], a[120:123], v[196:199]
    buffer_load_dwordx4 v2, s[16:19], s53 offen lds
    v_mfma_f32_16x16x32_bf16 v[196:199], a[44:47], a[124:127], v[196:199]
    v_mfma_f32_16x16x32_bf16 v[204:207], a[44:47], a[116:119], v[204:207]
    v_mfma_f32_16x16x32_bf16 v[204:207], a[40:43], a[112:115], v[204:207]
    v_mfma_f32_16x16x32_bf16 v[212:215], a[40:43], a[104:107], v[212:215]
    s_add_u32 m0, s29, 28672
    v_mfma_f32_16x16x32_bf16 v[212:215], a[44:47], a[108:111], v[212:215]
    buffer_load_dwordx4 v2, s[16:19], s54 offen lds
    v_mfma_f32_16x16x32_bf16 v[220:223], a[44:47], a[100:103], v[220:223]
    v_mfma_f32_16x16x32_bf16 v[220:223], a[40:43], a[96:99], v[220:223]
    v_mfma_f32_16x16x32_bf16 v[248:251], a[48:51], a[96:99], v[248:251]
    s_add_u32 m0, s29, 65536
    v_add_u32 v2, 0x80000, v2
    v_mfma_f32_16x16x32_bf16 v[248:251], a[52:55], a[100:103], v[248:251]
    buffer_load_dwordx4 v2, s[16:19], 0 offen lds
    v_mfma_f32_16x16x32_bf16 v[240:243], a[52:55], a[108:111], v[240:243]
    v_mfma_f32_16x16x32_bf16 v[240:243], a[48:51], a[104:107], v[240:243]
    v_mfma_f32_16x16x32_bf16 v[232:235], a[48:51], a[112:115], v[232:235]
    v_mfma_f32_16x16x32_bf16 v[232:235], a[52:55], a[116:119], v[232:235]
    s_add_u32 m0, s29, 69632
    v_mfma_f32_16x16x32_bf16 v[224:227], a[52:55], a[124:127], v[224:227]
    buffer_load_dwordx4 v2, s[16:19], s48 offen lds
    v_mfma_f32_16x16x32_bf16 v[224:227], a[48:51], a[120:123], v[224:227]
    v_mfma_f32_16x16x32_bf16 v[228:231], a[56:59], a[120:123], v[228:231]
    v_mfma_f32_16x16x32_bf16 v[228:231], a[60:63], a[124:127], v[228:231]
    v_mfma_f32_16x16x32_bf16 v[236:239], a[60:63], a[116:119], v[236:239]
    s_add_u32 m0, s29, 73728
    v_mfma_f32_16x16x32_bf16 v[236:239], a[56:59], a[112:115], v[236:239]
    buffer_load_dwordx4 v2, s[16:19], s49 offen lds
    v_mfma_f32_16x16x32_bf16 v[244:247], a[56:59], a[104:107], v[244:247]
    s_waitcnt vmcnt(11)
    v_mfma_f32_16x16x32_bf16 v[244:247], a[60:63], a[108:111], v[244:247]
    s_barrier
    ds_read_b64_tr_b16 a[0:1], v6 offset:32768
    v_mfma_f32_16x16x32_bf16 v[252:255], a[60:63], a[100:103], v[252:255]
    ds_read_b64_tr_b16 a[2:3], v6 offset:36864
    v_mfma_f32_16x16x32_bf16 v[252:255], a[56:59], a[96:99], v[252:255]
    s_add_u32 m0, s29, 77824
    ds_read_b128 a[96:99], v4 offset:40960
    v_mfma_f32_16x16x32_bf16 v[152:155], a[32:35], a[64:67], v[152:155]
    ds_read_b128 a[192:195], v14 offset:0
    buffer_load_dwordx4 v2, s[16:19], s50 offen lds
    v_mfma_f32_16x16x32_bf16 v[152:155], a[36:39], a[68:71], v[152:155]
    ds_read_b128 a[200:203], v3 offset:0
    v_mfma_f32_16x16x32_bf16 v[144:147], a[36:39], a[76:79], v[144:147]
    ds_read_b64_tr_b16 a[4:5], v6 offset:49152
    v_mfma_f32_16x16x32_bf16 v[144:147], a[32:35], a[72:75], v[144:147]
    ds_read_b64_tr_b16 a[6:7], v6 offset:53248
    v_mfma_f32_16x16x32_bf16 v[136:139], a[32:35], a[80:83], v[136:139]
    s_add_u32 m0, s29, 81920
    ds_read_b128 a[100:103], v5 offset:40960
    v_mfma_f32_16x16x32_bf16 v[136:139], a[36:39], a[84:87], v[136:139]
    ds_read_b128 a[196:199], v14 offset:2048
    buffer_load_dwordx4 v2, s[16:19], s51 offen lds
    v_mfma_f32_16x16x32_bf16 v[128:131], a[36:39], a[92:95], v[128:131]
    ds_read_b128 a[204:207], v3 offset:2048
    v_mfma_f32_16x16x32_bf16 v[128:131], a[32:35], a[88:91], v[128:131]
    ds_read_b128 a[108:111], v5 offset:43008
    v_mfma_f32_16x16x32_bf16 v[132:135], a[40:43], a[88:91], v[132:135]
    ds_read_b128 a[208:211], v14 offset:4096
    v_mfma_f32_16x16x32_bf16 v[132:135], a[44:47], a[92:95], v[132:135]
    s_add_u32 m0, s29, 86016
    ds_read_b128 a[104:107], v4 offset:43008
    v_mfma_f32_16x16x32_bf16 v[140:143], a[44:47], a[84:87], v[140:143]
    ds_read_b128 a[216:219], v3 offset:4096
    buffer_load_dwordx4 v2, s[16:19], s52 offen lds
    v_mfma_f32_16x16x32_bf16 v[140:143], a[40:43], a[80:83], v[140:143]
    ds_read_b128 a[212:215], v14 offset:6144
    v_mfma_f32_16x16x32_bf16 v[148:151], a[40:43], a[72:75], v[148:151]
    ds_read_b128 a[112:115], v4 offset:45056
    v_mfma_f32_16x16x32_bf16 v[148:151], a[44:47], a[76:79], v[148:151]
    ds_read_b128 a[220:223], v3 offset:6144
    v_mfma_f32_16x16x32_bf16 v[156:159], a[44:47], a[68:71], v[156:159]
    s_add_u32 m0, s29, 90112
    ds_read_b128 a[116:119], v5 offset:45056
    v_mfma_f32_16x16x32_bf16 v[156:159], a[40:43], a[64:67], v[156:159]
    buffer_load_dwordx4 v2, s[16:19], s53 offen lds
    v_mfma_f32_16x16x32_bf16 v[184:187], a[48:51], a[64:67], v[184:187]
    v_mfma_f32_16x16x32_bf16 v[184:187], a[52:55], a[68:71], v[184:187]
    ds_read_b128 a[124:127], v5 offset:47104
    v_mfma_f32_16x16x32_bf16 v[176:179], a[52:55], a[76:79], v[176:179]
    v_mfma_f32_16x16x32_bf16 v[176:179], a[48:51], a[72:75], v[176:179]
    s_add_u32 m0, s29, 94208
    ds_read_b128 a[120:123], v4 offset:47104
    v_mfma_f32_16x16x32_bf16 v[168:171], a[48:51], a[80:83], v[168:171]
    buffer_load_dwordx4 v2, s[16:19], s54 offen lds
    v_mfma_f32_16x16x32_bf16 v[168:171], a[52:55], a[84:87], v[168:171]
    v_mfma_f32_16x16x32_bf16 v[160:163], a[52:55], a[92:95], v[160:163]
    v_mfma_f32_16x16x32_bf16 v[160:163], a[48:51], a[88:91], v[160:163]
    ds_read_b64_tr_b16 a[8:9], v7 offset:32768
    v_mfma_f32_16x16x32_bf16 v[164:167], a[56:59], a[88:91], v[164:167]
    v_mfma_f32_16x16x32_bf16 v[164:167], a[60:63], a[92:95], v[164:167]
    ds_read_b64_tr_b16 a[10:11], v7 offset:36864
    v_mfma_f32_16x16x32_bf16 v[172:175], a[60:63], a[84:87], v[172:175]
    ds_read_b64_tr_b16 a[12:13], v7 offset:49152
    v_mfma_f32_16x16x32_bf16 v[172:175], a[56:59], a[80:83], v[172:175]
    ds_read_b64_tr_b16 a[14:15], v7 offset:53248
    v_mfma_f32_16x16x32_bf16 v[180:183], a[56:59], a[72:75], v[180:183]
    ds_read_b64_tr_b16 a[16:17], v8 offset:32768
    v_mfma_f32_16x16x32_bf16 v[180:183], a[60:63], a[76:79], v[180:183]
    ds_read_b64_tr_b16 a[18:19], v8 offset:36864
    v_mfma_f32_16x16x32_bf16 v[188:191], a[60:63], a[68:71], v[188:191]
    ds_read_b64_tr_b16 a[20:21], v8 offset:49152
    v_mfma_f32_16x16x32_bf16 v[188:191], a[56:59], a[64:67], v[188:191]
    s_waitcnt lgkmcnt(15)
    ds_read_b64_tr_b16 a[22:23], v8 offset:53248
    v_mfma_f32_16x16x32_bf16 a[232:235], a[0:3], a[96:99], a[232:235]
    ds_read_b64_tr_b16 a[24:25], v9 offset:32768
    v_mfma_f32_16x16x32_bf16 a[232:235], a[4:7], a[100:103], a[232:235]
    s_add_u32 m0, s33, 0xfffffd00
    ds_read_b64_tr_b16 a[26:27], v9 offset:36864
    v_mfma_f32_16x16x32_bf16 a[224:227], a[4:7], a[108:111], a[224:227]
    s_waitcnt lgkmcnt(13)
    ds_read_b64_tr_b16 a[28:29], v9 offset:49152
    v_mfma_f32_16x16x32_bf16 a[224:227], a[0:3], a[104:107], a[224:227]
    ds_read_b64_tr_b16 a[30:31], v9 offset:53248
    buffer_load_dwordx4 v15, s[20:23], 0 offen offset:768 lds
    v_mfma_f32_16x16x32_bf16 v[24:27], a[0:3], a[112:115], v[24:27]
    s_waitcnt lgkmcnt(12)
    ds_read_b128 a[64:67], v4 offset:32768
    v_mfma_f32_16x16x32_bf16 v[24:27], a[4:7], a[116:119], v[24:27]
    v_mfma_f32_16x16x32_bf16 v[16:19], a[4:7], a[124:127], v[16:19]
    s_add_u32 m0, s33, 0xfffffd80
    ds_read_b128 a[68:71], v5 offset:32768
    v_mfma_f32_16x16x32_bf16 v[16:19], a[0:3], a[120:123], v[16:19]
    s_waitcnt lgkmcnt(10)
    buffer_load_dwordx4 v15, s[20:23], 0 offen offset:1664 lds
    v_mfma_f32_16x16x32_bf16 v[20:23], a[8:11], a[120:123], v[20:23]
    ds_read_b128 a[76:79], v5 offset:34816
    v_mfma_f32_16x16x32_bf16 v[20:23], a[12:15], a[124:127], v[20:23]
    v_mfma_f32_16x16x32_bf16 v[28:31], a[12:15], a[116:119], v[28:31]
    s_add_u32 m0, s33, 0x500
    ds_read_b128 a[72:75], v4 offset:34816
    v_mfma_f32_16x16x32_bf16 v[28:31], a[8:11], a[112:115], v[28:31]
    buffer_load_dwordx4 v15, s[20:23], s57 offen offset:768 lds
    v_mfma_f32_16x16x32_bf16 a[228:231], a[8:11], a[104:107], a[228:231]
    ds_read_b128 a[80:83], v4 offset:36864
    v_mfma_f32_16x16x32_bf16 a[228:231], a[12:15], a[108:111], a[228:231]
    v_mfma_f32_16x16x32_bf16 a[236:239], a[12:15], a[100:103], a[236:239]
    s_add_u32 m0, s33, 0x580
    ds_read_b128 a[84:87], v5 offset:36864
    v_mfma_f32_16x16x32_bf16 a[236:239], a[8:11], a[96:99], a[236:239]
    s_waitcnt lgkmcnt(10)
    buffer_load_dwordx4 v15, s[20:23], s57 offen offset:1664 lds
    v_mfma_f32_16x16x32_bf16 v[56:59], a[16:19], a[96:99], v[56:59]
    ds_read_b128 a[92:95], v5 offset:38912
    v_mfma_f32_16x16x32_bf16 v[56:59], a[20:23], a[100:103], v[56:59]
    v_cvt_pk_bf16_f32 v16, v16, v17
    v_cvt_pk_bf16_f32 v17, v18, v19
    v_mfma_f32_16x16x32_bf16 v[48:51], a[20:23], a[108:111], v[48:51]
    ds_read_b128 a[88:91], v4 offset:38912
    v_cvt_pk_bf16_f32 v18, v20, v21
    v_mfma_f32_16x16x32_bf16 v[48:51], a[16:19], a[104:107], v[48:51]
    v_cvt_pk_bf16_f32 v19, v22, v23
    v_cvt_pk_bf16_f32 v24, v24, v25
    v_mfma_f32_16x16x32_bf16 v[40:43], a[16:19], a[112:115], v[40:43]
    ds_read_b64_tr_b16 a[32:33], v10 offset:32768
    v_cvt_pk_bf16_f32 v25, v26, v27
    v_mfma_f32_16x16x32_bf16 v[40:43], a[20:23], a[116:119], v[40:43]
    ds_read_b64_tr_b16 a[34:35], v10 offset:36864
    v_cvt_pk_bf16_f32 v26, v28, v29
    v_mfma_f32_16x16x32_bf16 v[32:35], a[20:23], a[124:127], v[32:35]
    ds_read_b64_tr_b16 a[36:37], v10 offset:49152
    v_cvt_pk_bf16_f32 v27, v30, v31
    v_mfma_f32_16x16x32_bf16 v[32:35], a[16:19], a[120:123], v[32:35]
    s_waitcnt lgkmcnt(11)
    ds_read_b64_tr_b16 a[38:39], v10 offset:53248
    v_accvgpr_read_b32 v20, a224
    v_mfma_f32_16x16x32_bf16 v[36:39], a[24:27], a[120:123], v[36:39]
    ds_read_b64_tr_b16 a[40:41], v11 offset:32768
    v_accvgpr_read_b32 v21, a225
    v_mfma_f32_16x16x32_bf16 v[36:39], a[28:31], a[124:127], v[36:39]
    ds_read_b64_tr_b16 a[42:43], v11 offset:36864
    v_accvgpr_read_b32 v22, a226
    v_mfma_f32_16x16x32_bf16 v[44:47], a[28:31], a[116:119], v[44:47]
    ds_read_b64_tr_b16 a[44:45], v11 offset:49152
    v_accvgpr_read_b32 v23, a227
    v_mfma_f32_16x16x32_bf16 v[44:47], a[24:27], a[112:115], v[44:47]
    ds_read_b64_tr_b16 a[46:47], v11 offset:53248
    v_accvgpr_read_b32 v28, a228
    v_mfma_f32_16x16x32_bf16 v[52:55], a[24:27], a[104:107], v[52:55]
    ds_read_b64_tr_b16 a[48:49], v12 offset:32768
    v_accvgpr_read_b32 v29, a229
    v_mfma_f32_16x16x32_bf16 v[52:55], a[28:31], a[108:111], v[52:55]
    ds_read_b64_tr_b16 a[50:51], v12 offset:36864
    v_accvgpr_read_b32 v30, a230
    v_mfma_f32_16x16x32_bf16 v[60:63], a[28:31], a[100:103], v[60:63]
    ds_read_b64_tr_b16 a[52:53], v12 offset:49152
    v_accvgpr_read_b32 v31, a231
    v_mfma_f32_16x16x32_bf16 v[60:63], a[24:27], a[96:99], v[60:63]
    s_waitcnt lgkmcnt(15)
    ds_read_b64_tr_b16 a[54:55], v12 offset:53248
    v_cvt_pk_bf16_f32 v20, v20, v21
    v_mfma_f32_16x16x32_bf16 v[88:91], a[0:3], a[64:67], v[88:91]
    ds_read_b64_tr_b16 a[56:57], v13 offset:32768
    v_cvt_pk_bf16_f32 v21, v22, v23
    v_mfma_f32_16x16x32_bf16 v[88:91], a[4:7], a[68:71], v[88:91]
    ds_read_b64_tr_b16 a[58:59], v13 offset:36864
    v_cvt_pk_bf16_f32 v22, v28, v29
    v_mfma_f32_16x16x32_bf16 v[80:83], a[4:7], a[76:79], v[80:83]
    ds_read_b64_tr_b16 a[60:61], v13 offset:49152
    v_cvt_pk_bf16_f32 v23, v30, v31
    v_mfma_f32_16x16x32_bf16 v[80:83], a[0:3], a[72:75], v[80:83]
    s_waitcnt lgkmcnt(15)
    ds_read_b64_tr_b16 a[62:63], v13 offset:53248
    v_cvt_pk_bf16_f32 v32, v32, v33
    v_mfma_f32_16x16x32_bf16 v[72:75], a[0:3], a[80:83], v[72:75]
    v_cvt_pk_bf16_f32 v33, v34, v35
    v_cvt_pk_bf16_f32 v34, v36, v37
    v_mfma_f32_16x16x32_bf16 v[72:75], a[4:7], a[84:87], v[72:75]
    v_cvt_pk_bf16_f32 v35, v38, v39
    v_cvt_pk_bf16_f32 v40, v40, v41
    v_mfma_f32_16x16x32_bf16 v[64:67], a[4:7], a[92:95], v[64:67]
    v_cvt_pk_bf16_f32 v41, v42, v43
    v_cvt_pk_bf16_f32 v42, v44, v45
    v_mfma_f32_16x16x32_bf16 v[64:67], a[0:3], a[88:91], v[64:67]
    s_waitcnt lgkmcnt(0)
    v_cvt_pk_bf16_f32 v43, v46, v47
    v_accvgpr_read_b32 v36, a232
    v_mfma_f32_16x16x32_bf16 v[68:71], a[8:11], a[88:91], v[68:71]
    s_barrier
    v_xor_b32 v6, s60, v6
    v_accvgpr_read_b32 v37, a233
    v_mfma_f32_16x16x32_bf16 v[68:71], a[12:15], a[92:95], v[68:71]
    s_add_u32 m0, s29, 32768
    v_add_u32 v2, 0x80000, v2
    v_accvgpr_read_b32 v38, a234
    v_mfma_f32_16x16x32_bf16 v[76:79], a[12:15], a[84:87], v[76:79]
    buffer_load_dwordx4 v2, s[16:19], 0 offen lds
    v_mfma_f32_16x16x32_bf16 v[76:79], a[8:11], a[80:83], v[76:79]
    s_add_u32 s59, s58, 40960
    v_accvgpr_read_b32 v39, a235
    v_accvgpr_read_b32 v44, a236
    v_mfma_f32_16x16x32_bf16 v[84:87], a[8:11], a[72:75], v[84:87]
    buffer_store_dwordx4 v[20:23], v1, s[12:15], s59 offen offset:0 sc1
    v_mfma_f32_16x16x32_bf16 v[84:87], a[12:15], a[76:79], v[84:87]
    v_accvgpr_read_b32 v45, a237
    v_accvgpr_read_b32 v46, a238
    v_mfma_f32_16x16x32_bf16 v[92:95], a[12:15], a[68:71], v[92:95]
    s_add_u32 m0, s29, 36864
    v_accvgpr_read_b32 v47, a239
    v_cvt_pk_bf16_f32 v36, v36, v37
    v_mfma_f32_16x16x32_bf16 v[92:95], a[8:11], a[64:67], v[92:95]
    buffer_load_dwordx4 v2, s[16:19], s48 offen lds
    v_mfma_f32_16x16x32_bf16 v[120:123], a[16:19], a[64:67], v[120:123]
    v_cvt_pk_bf16_f32 v37, v38, v39
    v_cvt_pk_bf16_f32 v38, v44, v45
    v_mfma_f32_16x16x32_bf16 v[120:123], a[20:23], a[68:71], v[120:123]
    v_cvt_pk_bf16_f32 v39, v46, v47
    v_cvt_pk_bf16_f32 v48, v48, v49
    v_mfma_f32_16x16x32_bf16 v[112:115], a[20:23], a[76:79], v[112:115]
    v_cvt_pk_bf16_f32 v49, v50, v51
    v_cvt_pk_bf16_f32 v50, v52, v53
    v_mfma_f32_16x16x32_bf16 v[112:115], a[16:19], a[72:75], v[112:115]
    s_add_u32 m0, s29, 40960
    v_cvt_pk_bf16_f32 v51, v54, v55
    v_cvt_pk_bf16_f32 v56, v56, v57
    v_mfma_f32_16x16x32_bf16 v[104:107], a[16:19], a[80:83], v[104:107]
    buffer_load_dwordx4 v2, s[16:19], s49 offen lds
    v_mfma_f32_16x16x32_bf16 v[104:107], a[20:23], a[84:87], v[104:107]
    s_add_u32 s59, s58, 32768
    v_cvt_pk_bf16_f32 v57, v58, v59
    v_cvt_pk_bf16_f32 v58, v60, v61
    v_mfma_f32_16x16x32_bf16 v[96:99], a[20:23], a[92:95], v[96:99]
    buffer_store_dwordx4 v[36:39], v1, s[12:15], s59 offen offset:0 sc1
    v_mfma_f32_16x16x32_bf16 v[96:99], a[16:19], a[88:91], v[96:99]
    v_cvt_pk_bf16_f32 v59, v62, v63
    v_cvt_pk_bf16_f32 v64, v64, v65
    v_mfma_f32_16x16x32_bf16 v[100:103], a[24:27], a[88:91], v[100:103]
    s_add_u32 m0, s29, 45056
    v_cvt_pk_bf16_f32 v65, v66, v67
    v_cvt_pk_bf16_f32 v66, v68, v69
    v_mfma_f32_16x16x32_bf16 v[100:103], a[28:31], a[92:95], v[100:103]
    buffer_load_dwordx4 v2, s[16:19], s50 offen lds
    v_mfma_f32_16x16x32_bf16 v[108:111], a[28:31], a[84:87], v[108:111]
    v_cvt_pk_bf16_f32 v67, v70, v71
    v_cvt_pk_bf16_f32 v72, v72, v73
    v_mfma_f32_16x16x32_bf16 v[108:111], a[24:27], a[80:83], v[108:111]
    v_cvt_pk_bf16_f32 v73, v74, v75
    v_cvt_pk_bf16_f32 v74, v76, v77
    v_mfma_f32_16x16x32_bf16 v[116:119], a[24:27], a[72:75], v[116:119]
    v_cvt_pk_bf16_f32 v75, v78, v79
    v_cvt_pk_bf16_f32 v80, v80, v81
    v_mfma_f32_16x16x32_bf16 v[116:119], a[28:31], a[76:79], v[116:119]
    s_add_u32 m0, s29, 49152
    v_cvt_pk_bf16_f32 v81, v82, v83
    v_cvt_pk_bf16_f32 v82, v84, v85
    v_mfma_f32_16x16x32_bf16 v[124:127], a[28:31], a[68:71], v[124:127]
    buffer_load_dwordx4 v2, s[16:19], s51 offen lds
    v_mfma_f32_16x16x32_bf16 v[124:127], a[24:27], a[64:67], v[124:127]
    s_add_u32 s59, s58, 57344
    v_cvt_pk_bf16_f32 v83, v86, v87
    v_cvt_pk_bf16_f32 v88, v88, v89
    v_mfma_f32_16x16x32_bf16 v[152:155], a[32:35], a[64:67], v[152:155]
    buffer_store_dwordx4 v[16:19], v1, s[12:15], s59 offen offset:0 sc1
    v_mfma_f32_16x16x32_bf16 v[152:155], a[36:39], a[68:71], v[152:155]
    v_cvt_pk_bf16_f32 v89, v90, v91
    v_cvt_pk_bf16_f32 v90, v92, v93
    v_mfma_f32_16x16x32_bf16 v[144:147], a[36:39], a[76:79], v[144:147]
    s_add_u32 m0, s29, 53248
    v_cvt_pk_bf16_f32 v91, v94, v95
    v_cvt_pk_bf16_f32 v96, v96, v97
    v_mfma_f32_16x16x32_bf16 v[144:147], a[32:35], a[72:75], v[144:147]
    buffer_load_dwordx4 v2, s[16:19], s52 offen lds
    v_mfma_f32_16x16x32_bf16 v[136:139], a[32:35], a[80:83], v[136:139]
    v_cvt_pk_bf16_f32 v97, v98, v99
    v_cvt_pk_bf16_f32 v98, v100, v101
    v_mfma_f32_16x16x32_bf16 v[136:139], a[36:39], a[84:87], v[136:139]
    v_cvt_pk_bf16_f32 v99, v102, v103
    v_cvt_pk_bf16_f32 v104, v104, v105
    v_mfma_f32_16x16x32_bf16 v[128:131], a[36:39], a[92:95], v[128:131]
    v_cvt_pk_bf16_f32 v105, v106, v107
    v_cvt_pk_bf16_f32 v106, v108, v109
    v_mfma_f32_16x16x32_bf16 v[128:131], a[32:35], a[88:91], v[128:131]
    s_add_u32 m0, s29, 57344
    v_cvt_pk_bf16_f32 v107, v110, v111
    v_cvt_pk_bf16_f32 v112, v112, v113
    v_mfma_f32_16x16x32_bf16 v[132:135], a[40:43], a[88:91], v[132:135]
    buffer_load_dwordx4 v2, s[16:19], s53 offen lds
    v_mfma_f32_16x16x32_bf16 v[132:135], a[44:47], a[92:95], v[132:135]
    s_add_u32 s59, s58, 49152
    v_cvt_pk_bf16_f32 v113, v114, v115
    v_cvt_pk_bf16_f32 v114, v116, v117
    v_mfma_f32_16x16x32_bf16 v[140:143], a[44:47], a[84:87], v[140:143]
    buffer_store_dwordx4 v[24:27], v1, s[12:15], s59 offen offset:0 sc1
    v_mfma_f32_16x16x32_bf16 v[140:143], a[40:43], a[80:83], v[140:143]
    v_cvt_pk_bf16_f32 v115, v118, v119
    v_cvt_pk_bf16_f32 v120, v120, v121
    v_mfma_f32_16x16x32_bf16 v[148:151], a[40:43], a[72:75], v[148:151]
    s_add_u32 m0, s29, 61440
    v_cvt_pk_bf16_f32 v121, v122, v123
    v_cvt_pk_bf16_f32 v122, v124, v125
    v_mfma_f32_16x16x32_bf16 v[148:151], a[44:47], a[76:79], v[148:151]
    buffer_load_dwordx4 v2, s[16:19], s54 offen lds
    v_mfma_f32_16x16x32_bf16 v[156:159], a[44:47], a[68:71], v[156:159]
    v_cvt_pk_bf16_f32 v123, v126, v127
    v_mfma_f32_16x16x32_bf16 v[156:159], a[40:43], a[64:67], v[156:159]
    v_mfma_f32_16x16x32_bf16 v[184:187], a[48:51], a[64:67], v[184:187]
    s_add_u32 m0, s29, 98304
    v_add_u32 v2, 0x80000, v2
    v_mfma_f32_16x16x32_bf16 v[184:187], a[52:55], a[68:71], v[184:187]
    buffer_load_dwordx4 v2, s[16:19], 0 offen lds
    v_mfma_f32_16x16x32_bf16 v[176:179], a[52:55], a[76:79], v[176:179]
    s_add_u32 s59, s58, 57344
    v_cvt_pk_bf16_f32 v128, v128, v129
    v_cvt_pk_bf16_f32 v129, v130, v131
    v_mfma_f32_16x16x32_bf16 v[176:179], a[48:51], a[72:75], v[176:179]
    buffer_store_dwordx4 v[32:35], v1, s[12:15], s59 offen offset:1024 sc1
    v_mfma_f32_16x16x32_bf16 v[168:171], a[48:51], a[80:83], v[168:171]
    v_cvt_pk_bf16_f32 v130, v132, v133
    v_cvt_pk_bf16_f32 v131, v134, v135
    v_mfma_f32_16x16x32_bf16 v[168:171], a[52:55], a[84:87], v[168:171]
    s_add_u32 m0, s29, 102400
    v_cvt_pk_bf16_f32 v136, v136, v137
    v_cvt_pk_bf16_f32 v137, v138, v139
    v_mfma_f32_16x16x32_bf16 v[160:163], a[52:55], a[92:95], v[160:163]
    buffer_load_dwordx4 v2, s[16:19], s48 offen lds
    v_mfma_f32_16x16x32_bf16 v[160:163], a[48:51], a[88:91], v[160:163]
    v_cvt_pk_bf16_f32 v138, v140, v141
    v_cvt_pk_bf16_f32 v139, v142, v143
    v_mfma_f32_16x16x32_bf16 v[164:167], a[56:59], a[88:91], v[164:167]
    v_cvt_pk_bf16_f32 v144, v144, v145
    v_cvt_pk_bf16_f32 v145, v146, v147
    v_mfma_f32_16x16x32_bf16 v[164:167], a[60:63], a[92:95], v[164:167]
    v_cvt_pk_bf16_f32 v146, v148, v149
    v_cvt_pk_bf16_f32 v147, v150, v151
    v_mfma_f32_16x16x32_bf16 v[172:175], a[60:63], a[84:87], v[172:175]
    s_add_u32 m0, s29, 106496
    v_cvt_pk_bf16_f32 v152, v152, v153
    v_cvt_pk_bf16_f32 v153, v154, v155
    v_mfma_f32_16x16x32_bf16 v[172:175], a[56:59], a[80:83], v[172:175]
    buffer_load_dwordx4 v2, s[16:19], s49 offen lds
    v_mfma_f32_16x16x32_bf16 v[180:183], a[56:59], a[72:75], v[180:183]
    s_add_u32 s59, s58, 49152
    v_cvt_pk_bf16_f32 v154, v156, v157
    v_cvt_pk_bf16_f32 v155, v158, v159
    v_mfma_f32_16x16x32_bf16 v[180:183], a[60:63], a[76:79], v[180:183]
    buffer_store_dwordx4 v[40:43], v1, s[12:15], s59 offen offset:1024 sc1
    v_mfma_f32_16x16x32_bf16 v[188:191], a[60:63], a[68:71], v[188:191]
    v_mfma_f32_16x16x32_bf16 v[188:191], a[56:59], a[64:67], v[188:191]
    s_add_u32 m0, s29, 110592
    v_mfma_f32_16x16x32_bf16 v[216:219], a[32:35], a[96:99], v[216:219]
    buffer_load_dwordx4 v2, s[16:19], s50 offen lds
    v_mfma_f32_16x16x32_bf16 v[216:219], a[36:39], a[100:103], v[216:219]
    v_cvt_pk_bf16_f32 v160, v160, v161
    v_cvt_pk_bf16_f32 v161, v162, v163
    v_mfma_f32_16x16x32_bf16 v[208:211], a[36:39], a[108:111], v[208:211]
    v_cvt_pk_bf16_f32 v162, v164, v165
    v_cvt_pk_bf16_f32 v163, v166, v167
    v_mfma_f32_16x16x32_bf16 v[208:211], a[32:35], a[104:107], v[208:211]
    v_cvt_pk_bf16_f32 v168, v168, v169
    v_cvt_pk_bf16_f32 v169, v170, v171
    v_mfma_f32_16x16x32_bf16 v[200:203], a[32:35], a[112:115], v[200:203]
    s_add_u32 m0, s29, 114688
    v_cvt_pk_bf16_f32 v170, v172, v173
    v_cvt_pk_bf16_f32 v171, v174, v175
    v_mfma_f32_16x16x32_bf16 v[200:203], a[36:39], a[116:119], v[200:203]
    buffer_load_dwordx4 v2, s[16:19], s51 offen lds
    v_mfma_f32_16x16x32_bf16 v[192:195], a[36:39], a[124:127], v[192:195]
    s_add_u32 s59, s58, 40960
    v_cvt_pk_bf16_f32 v176, v176, v177
    v_cvt_pk_bf16_f32 v177, v178, v179
    v_mfma_f32_16x16x32_bf16 v[192:195], a[32:35], a[120:123], v[192:195]
    buffer_store_dwordx4 v[48:51], v1, s[12:15], s59 offen offset:1024 sc1
    v_mfma_f32_16x16x32_bf16 v[196:199], a[40:43], a[120:123], v[196:199]
    v_cvt_pk_bf16_f32 v178, v180, v181
    v_cvt_pk_bf16_f32 v179, v182, v183
    v_mfma_f32_16x16x32_bf16 v[196:199], a[44:47], a[124:127], v[196:199]
    s_add_u32 m0, s29, 118784
    v_cvt_pk_bf16_f32 v184, v184, v185
    v_cvt_pk_bf16_f32 v185, v186, v187
    v_mfma_f32_16x16x32_bf16 v[204:207], a[44:47], a[116:119], v[204:207]
    buffer_load_dwordx4 v2, s[16:19], s52 offen lds
    v_mfma_f32_16x16x32_bf16 v[204:207], a[40:43], a[112:115], v[204:207]
    v_cvt_pk_bf16_f32 v186, v188, v189
    v_cvt_pk_bf16_f32 v187, v190, v191
    v_mfma_f32_16x16x32_bf16 v[212:215], a[40:43], a[104:107], v[212:215]
    v_mfma_f32_16x16x32_bf16 v[212:215], a[44:47], a[108:111], v[212:215]
    v_mfma_f32_16x16x32_bf16 v[220:223], a[44:47], a[100:103], v[220:223]
    s_add_u32 m0, s29, 122880
    v_mfma_f32_16x16x32_bf16 v[220:223], a[40:43], a[96:99], v[220:223]
    buffer_load_dwordx4 v2, s[16:19], s53 offen lds
    v_mfma_f32_16x16x32_bf16 v[248:251], a[48:51], a[96:99], v[248:251]
    s_add_u32 s59, s58, 32768
    v_mfma_f32_16x16x32_bf16 v[248:251], a[52:55], a[100:103], v[248:251]
    s_waitcnt vmcnt(22)
    buffer_store_dwordx4 v[56:59], v1, s[12:15], s59 offen offset:1024 sc1
    v_mfma_f32_16x16x32_bf16 v[240:243], a[52:55], a[108:111], v[240:243]
    s_barrier
    v_xor_b32 v7, 0, v6
    v_cvt_pk_bf16_f32 v192, v192, v193
    v_mfma_f32_16x16x32_bf16 v[240:243], a[48:51], a[104:107], v[240:243]
    s_add_u32 m0, s29, 126976
    ds_read_b64_tr_b16 a[64:65], v7 offset:0
    v_cvt_pk_bf16_f32 v193, v194, v195
    v_mfma_f32_16x16x32_bf16 v[232:235], a[48:51], a[112:115], v[232:235]
    ds_read_b64_tr_b16 a[66:67], v7 offset:4096
    buffer_load_dwordx4 v2, s[16:19], s54 offen lds
    v_mfma_f32_16x16x32_bf16 v[232:235], a[52:55], a[116:119], v[232:235]
    ds_read_b64_tr_b16 a[68:69], v7 offset:16384
    v_cvt_pk_bf16_f32 v194, v196, v197
    v_mfma_f32_16x16x32_bf16 v[224:227], a[52:55], a[124:127], v[224:227]
    ds_read_b64_tr_b16 a[70:71], v7 offset:20480
    v_xor_b32 v8, 65536, v6
    v_mfma_f32_16x16x32_bf16 v[224:227], a[48:51], a[120:123], v[224:227]
    ds_read_b64_tr_b16 a[72:73], v8 offset:0
    v_cvt_pk_bf16_f32 v195, v198, v199
    v_mfma_f32_16x16x32_bf16 v[228:231], a[56:59], a[120:123], v[228:231]
    s_add_u32 s59, s58, 24576
    ds_read_b64_tr_b16 a[74:75], v8 offset:4096
    v_cvt_pk_bf16_f32 v200, v200, v201
    v_mfma_f32_16x16x32_bf16 v[228:231], a[60:63], a[124:127], v[228:231]
    ds_read_b64_tr_b16 a[76:77], v8 offset:16384
    buffer_store_dwordx4 v[64:67], v1, s[12:15], s59 offen offset:0 sc1
    v_mfma_f32_16x16x32_bf16 v[236:239], a[60:63], a[116:119], v[236:239]
    ds_read_b64_tr_b16 a[78:79], v8 offset:20480
    v_xor_b32 v9, 32, v6
    v_mfma_f32_16x16x32_bf16 v[236:239], a[56:59], a[112:115], v[236:239]
    ds_read_b64_tr_b16 a[80:81], v9 offset:0
    v_cvt_pk_bf16_f32 v201, v202, v203
    v_mfma_f32_16x16x32_bf16 v[244:247], a[56:59], a[104:107], v[244:247]
    ds_read_b64_tr_b16 a[82:83], v9 offset:4096
    v_cvt_pk_bf16_f32 v202, v204, v205
    v_mfma_f32_16x16x32_bf16 v[244:247], a[60:63], a[108:111], v[244:247]
    ds_read_b64_tr_b16 a[84:85], v9 offset:16384
    v_cvt_pk_bf16_f32 v203, v206, v207
    v_mfma_f32_16x16x32_bf16 v[252:255], a[60:63], a[100:103], v[252:255]
    ds_read_b64_tr_b16 a[86:87], v9 offset:20480
    v_xor_b32 v10, 65568, v6
    v_mfma_f32_16x16x32_bf16 v[252:255], a[56:59], a[96:99], v[252:255]
    s_waitcnt lgkmcnt(6)
    ds_read_b64_tr_b16 a[88:89], v10 offset:0
    v_cvt_pk_bf16_f32 v208, v208, v209
    v_mfma_f32_16x16x32_bf16 v[28:31], a[64:67], a[128:131], 0
    ds_read_b64_tr_b16 a[90:91], v10 offset:4096
    v_cvt_pk_bf16_f32 v209, v210, v211
    v_mfma_f32_16x16x32_bf16 v[28:31], a[68:71], a[136:139], v[28:31]
    s_add_u32 s59, s58, 16384
    ds_read_b64_tr_b16 a[92:93], v10 offset:16384
    v_xor_b32 v7, 64, v6
    v_mfma_f32_16x16x32_bf16 v[28:31], a[72:75], a[144:147], v[28:31]
    s_waitcnt lgkmcnt(7)
    ds_read_b128 a[112:115], v14 offset:0
    ds_read_b64_tr_b16 a[94:95], v10 offset:20480
    buffer_store_dwordx4 v[72:75], v1, s[12:15], s59 offen offset:0 sc1
    v_mfma_f32_16x16x32_bf16 v[28:31], a[76:79], a[152:155], v[28:31]
    ds_read_b64_tr_b16 a[96:97], v7 offset:0
    v_cvt_pk_bf16_f32 v210, v212, v213
    v_mfma_f32_16x16x32_bf16 v[44:47], a[64:67], a[132:135], 0
    ds_read_b128 a[120:123], v3 offset:0
    ds_read_b64_tr_b16 a[98:99], v7 offset:4096
    v_mfma_f32_16x16x32_bf16 v[44:47], a[68:71], a[140:143], v[44:47]
    ds_read_b64_tr_b16 a[100:101], v7 offset:16384
    v_xor_b32 v8, 65600, v6
    v_mfma_f32_16x16x32_bf16 v[44:47], a[72:75], a[148:151], v[44:47]
    ds_read_b128 a[116:119], v14 offset:2048
    ds_read_b64_tr_b16 a[102:103], v7 offset:20480
    v_mfma_f32_16x16x32_bf16 v[44:47], a[76:79], a[156:159], v[44:47]
    s_waitcnt lgkmcnt(9)
    ds_read_b64_tr_b16 a[104:105], v8 offset:0
    v_cvt_pk_bf16_f32 v211, v214, v215
    v_mfma_f32_16x16x32_bf16 v[52:55], a[80:83], a[128:131], 0
    ds_read_b128 a[124:127], v3 offset:2048
    ds_read_b64_tr_b16 a[106:107], v8 offset:4096
    v_mfma_f32_16x16x32_bf16 v[52:55], a[84:87], a[136:139], v[52:55]
    s_add_u32 s59, s58, 8192
    ds_read_b64_tr_b16 a[108:109], v8 offset:16384
    v_cvt_pk_bf16_f32 v216, v216, v217
    v_mfma_f32_16x16x32_bf16 v[52:55], a[88:91], a[144:147], v[52:55]
    s_waitcnt lgkmcnt(10)
    ds_read_b64_tr_b16 a[110:111], v8 offset:20480
    v_xor_b32 v9, 96, v6
    v_mfma_f32_16x16x32_bf16 v[52:55], a[92:95], a[152:155], v[52:55]
    ds_read_b64_tr_b16 a[64:65], v9 offset:0
    buffer_store_dwordx4 v[80:83], v1, s[12:15], s59 offen offset:0 sc1
    v_mfma_f32_16x16x32_bf16 v[60:63], a[80:83], a[132:135], 0
    ds_read_b64_tr_b16 a[66:67], v9 offset:4096
    v_cvt_pk_bf16_f32 v217, v218, v219
    v_mfma_f32_16x16x32_bf16 v[60:63], a[84:87], a[140:143], v[60:63]
    ds_read_b64_tr_b16 a[68:69], v9 offset:16384
    v_cvt_pk_bf16_f32 v218, v220, v221
    v_mfma_f32_16x16x32_bf16 v[60:63], a[88:91], a[148:151], v[60:63]
    ds_read_b64_tr_b16 a[70:71], v9 offset:20480
    v_xor_b32 v10, 65632, v6
    v_mfma_f32_16x16x32_bf16 v[60:63], a[92:95], a[156:159], v[60:63]
    s_waitcnt lgkmcnt(6)
    ds_read_b64_tr_b16 a[72:73], v10 offset:0
    v_cvt_pk_bf16_f32 v219, v222, v223
    v_mfma_f32_16x16x32_bf16 v[20:23], a[96:99], a[128:131], 0
    ds_read_b64_tr_b16 a[74:75], v10 offset:4096
    v_cvt_pk_bf16_f32 v224, v224, v225
    v_mfma_f32_16x16x32_bf16 v[20:23], a[100:103], a[136:139], v[20:23]
    s_waitcnt lgkmcnt(8)
    ds_read_b64_tr_b16 a[76:77], v10 offset:16384
    v_xor_b32 v7, 128, v6
    v_mfma_f32_16x16x32_bf16 v[20:23], a[104:107], a[144:147], v[20:23]
    s_waitcnt lgkmcnt(7)
    s_barrier
    ds_read_b64_tr_b16 a[78:79], v10 offset:20480
    v_mfma_f32_16x16x32_bf16 v[20:23], a[108:111], a[152:155], v[20:23]
    s_add_u32 m0, s29, 131072
    ds_read_b64_tr_b16 a[80:81], v7 offset:0
    v_add_u32 v2, 0x80000, v2
    v_mfma_f32_16x16x32_bf16 v[36:39], a[96:99], a[132:135], 0
    ds_read_b64_tr_b16 a[82:83], v7 offset:4096
    buffer_load_dwordx4 v2, s[16:19], 0 offen lds
    v_mfma_f32_16x16x32_bf16 v[36:39], a[100:103], a[140:143], v[36:39]
    ds_read_b64_tr_b16 a[84:85], v7 offset:16384
    v_cvt_pk_bf16_f32 v225, v226, v227
    v_mfma_f32_16x16x32_bf16 v[36:39], a[104:107], a[148:151], v[36:39]
    s_add_u32 s59, s58, 0
    ds_read_b64_tr_b16 a[86:87], v7 offset:20480
    v_xor_b32 v8, 65664, v6
    v_mfma_f32_16x16x32_bf16 v[36:39], a[108:111], a[156:159], v[36:39]
    s_waitcnt lgkmcnt(6)
    ds_read_b64_tr_b16 a[88:89], v8 offset:0
    buffer_store_dwordx4 v[88:91], v1, s[12:15], s59 offen offset:0 sc1
    v_mfma_f32_16x16x32_bf16 v[68:71], a[64:67], a[128:131], 0
    ds_read_b64_tr_b16 a[90:91], v8 offset:4096
    v_cvt_pk_bf16_f32 v226, v228, v229
    v_mfma_f32_16x16x32_bf16 v[68:71], a[68:71], a[136:139], v[68:71]
    s_add_u32 m0, s29, 135168
    ds_read_b64_tr_b16 a[92:93], v8 offset:16384
    v_cvt_pk_bf16_f32 v227, v230, v231
    v_mfma_f32_16x16x32_bf16 v[68:71], a[72:75], a[144:147], v[68:71]
    s_waitcnt lgkmcnt(7)
    ds_read_b64_tr_b16 a[94:95], v8 offset:20480
    v_xor_b32 v9, 160, v6
    v_mfma_f32_16x16x32_bf16 v[68:71], a[76:79], a[152:155], v[68:71]
    ds_read_b64_tr_b16 a[96:97], v9 offset:0
    buffer_load_dwordx4 v2, s[16:19], s48 offen lds
    v_mfma_f32_16x16x32_bf16 v[76:79], a[64:67], a[132:135], 0
    ds_read_b64_tr_b16 a[98:99], v9 offset:4096
    v_cvt_pk_bf16_f32 v232, v232, v233
    v_mfma_f32_16x16x32_bf16 v[76:79], a[68:71], a[140:143], v[76:79]
    ds_read_b64_tr_b16 a[100:101], v9 offset:16384
    v_cvt_pk_bf16_f32 v233, v234, v235
    v_mfma_f32_16x16x32_bf16 v[76:79], a[72:75], a[148:151], v[76:79]
    s_add_u32 s59, s58, 24576
    ds_read_b64_tr_b16 a[102:103], v9 offset:20480
    v_xor_b32 v10, 65696, v6
    v_mfma_f32_16x16x32_bf16 v[76:79], a[76:79], a[156:159], v[76:79]
    s_waitcnt lgkmcnt(6)
    ds_read_b64_tr_b16 a[104:105], v10 offset:0
    buffer_store_dwordx4 v[96:99], v1, s[12:15], s59 offen offset:1024 sc1
    v_mfma_f32_16x16x32_bf16 v[84:87], a[80:83], a[128:131], 0
    s_add_u32 m0, s29, 139264
    ds_read_b64_tr_b16 a[106:107], v10 offset:4096
    v_cvt_pk_bf16_f32 v234, v236, v237
    v_mfma_f32_16x16x32_bf16 v[84:87], a[84:87], a[136:139], v[84:87]
    ds_read_b64_tr_b16 a[108:109], v10 offset:16384
    buffer_load_dwordx4 v2, s[16:19], s49 offen lds
    v_mfma_f32_16x16x32_bf16 v[84:87], a[88:91], a[144:147], v[84:87]
    s_waitcnt lgkmcnt(7)
    ds_read_b64_tr_b16 a[110:111], v10 offset:20480
    v_xor_b32 v7, 192, v6
    v_mfma_f32_16x16x32_bf16 v[84:87], a[92:95], a[152:155], v[84:87]
    ds_read_b64_tr_b16 a[64:65], v7 offset:0
    v_cvt_pk_bf16_f32 v235, v238, v239
    v_mfma_f32_16x16x32_bf16 v[92:95], a[80:83], a[132:135], 0
    ds_read_b64_tr_b16 a[66:67], v7 offset:4096
    v_cvt_pk_bf16_f32 v240, v240, v241
    v_mfma_f32_16x16x32_bf16 v[92:95], a[84:87], a[140:143], v[92:95]
    ds_read_b64_tr_b16 a[68:69], v7 offset:16384
    v_cvt_pk_bf16_f32 v241, v242, v243
    v_mfma_f32_16x16x32_bf16 v[92:95], a[88:91], a[148:151], v[92:95]
    s_add_u32 m0, s29, 143360
    ds_read_b64_tr_b16 a[70:71], v7 offset:20480
    v_xor_b32 v8, 65728, v6
    v_mfma_f32_16x16x32_bf16 v[92:95], a[92:95], a[156:159], v[92:95]
    s_waitcnt lgkmcnt(6)
    ds_read_b64_tr_b16 a[72:73], v8 offset:0
    buffer_load_dwordx4 v2, s[16:19], s50 offen lds
    v_mfma_f32_16x16x32_bf16 v[100:103], a[96:99], a[128:131], 0
    s_add_u32 s59, s58, 16384
    ds_read_b64_tr_b16 a[74:75], v8 offset:4096
    v_cvt_pk_bf16_f32 v242, v244, v245
    v_mfma_f32_16x16x32_bf16 v[100:103], a[100:103], a[136:139], v[100:103]
    ds_read_b64_tr_b16 a[76:77], v8 offset:16384
    buffer_store_dwordx4 v[104:107], v1, s[12:15], s59 offen offset:1024 sc1
    v_mfma_f32_16x16x32_bf16 v[100:103], a[104:107], a[144:147], v[100:103]
    s_waitcnt lgkmcnt(7)
    ds_read_b64_tr_b16 a[78:79], v8 offset:20480
    v_xor_b32 v9, 224, v6
    v_mfma_f32_16x16x32_bf16 v[100:103], a[108:111], a[152:155], v[100:103]
    s_and_b32 s36, s95, 31
    ds_read_b64_tr_b16 a[80:81], v9 offset:0
    v_cvt_pk_bf16_f32 v243, v246, v247
    v_mfma_f32_16x16x32_bf16 v[108:111], a[96:99], a[132:135], 0
    s_add_u32 m0, s29, 147456
    ds_read_b64_tr_b16 a[82:83], v9 offset:4096
    v_cvt_pk_bf16_f32 v248, v248, v249
    v_mfma_f32_16x16x32_bf16 v[108:111], a[100:103], a[140:143], v[108:111]
    ds_read_b64_tr_b16 a[84:85], v9 offset:16384
    buffer_load_dwordx4 v2, s[16:19], s51 offen lds
    v_mfma_f32_16x16x32_bf16 v[108:111], a[104:107], a[148:151], v[108:111]
    s_lshr_b32 s37, s95, 5
    ds_read_b64_tr_b16 a[86:87], v9 offset:20480
    v_xor_b32 v10, 65760, v6
    v_mfma_f32_16x16x32_bf16 v[108:111], a[108:111], a[156:159], v[108:111]
    s_waitcnt lgkmcnt(6)
    ds_read_b64_tr_b16 a[88:89], v10 offset:0
    v_cvt_pk_bf16_f32 v249, v250, v251
    v_mfma_f32_16x16x32_bf16 v[116:119], a[64:67], a[128:131], 0
    s_lshl_b32 s38, s3, 4
    ds_read_b64_tr_b16 a[90:91], v10 offset:4096
    v_cvt_pk_bf16_f32 v250, v252, v253
    v_mfma_f32_16x16x32_bf16 v[116:119], a[68:71], a[136:139], v[116:119]
    s_add_u32 m0, s29, 151552
    ds_read_b64_tr_b16 a[92:93], v10 offset:16384
    v_cvt_pk_bf16_f32 v251, v254, v255
    v_mfma_f32_16x16x32_bf16 v[116:119], a[72:75], a[144:147], v[116:119]
    s_waitcnt lgkmcnt(7)
    ds_read_b64_tr_b16 a[94:95], v10 offset:20480
    v_xor_b32 v7, 256, v6
    v_mfma_f32_16x16x32_bf16 v[116:119], a[76:79], a[152:155], v[116:119]
    ds_read_b64_tr_b16 a[96:97], v7 offset:0
    buffer_load_dwordx4 v2, s[16:19], s52 offen lds
    v_mfma_f32_16x16x32_bf16 v[124:127], a[64:67], a[132:135], 0
    s_add_u32 s59, s58, 8192
    ds_read_b64_tr_b16 a[98:99], v7 offset:4096
    v_accvgpr_read_b32 v11, a245
    v_mfma_f32_16x16x32_bf16 v[124:127], a[68:71], a[140:143], v[124:127]
    ds_read_b64_tr_b16 a[100:101], v7 offset:16384
    buffer_store_dwordx4 v[112:115], v1, s[12:15], s59 offen offset:1024 sc1
    v_mfma_f32_16x16x32_bf16 v[124:127], a[72:75], a[148:151], v[124:127]
    s_lshl_b32 s39, s36, 6
    ds_read_b64_tr_b16 a[102:103], v7 offset:20480
    v_xor_b32 v8, 65792, v6
    v_mfma_f32_16x16x32_bf16 v[124:127], a[76:79], a[156:159], v[124:127]
    s_waitcnt lgkmcnt(6)
    ds_read_b64_tr_b16 a[104:105], v8 offset:0
    v_mov_b32 v12, 0
    v_mfma_f32_16x16x32_bf16 v[132:135], a[80:83], a[128:131], 0
    s_add_u32 m0, s29, 155648
    ds_read_b64_tr_b16 a[106:107], v8 offset:4096
    v_mfma_f32_16x16x32_bf16 v[132:135], a[84:87], a[136:139], v[132:135]
    ds_read_b64_tr_b16 a[108:109], v8 offset:16384
    buffer_load_dwordx4 v2, s[16:19], s53 offen lds
    v_mfma_f32_16x16x32_bf16 v[132:135], a[88:91], a[144:147], v[132:135]
    s_waitcnt lgkmcnt(7)
    ds_read_b64_tr_b16 a[110:111], v8 offset:20480
    v_xor_b32 v9, 288, v6
    v_mfma_f32_16x16x32_bf16 v[132:135], a[92:95], a[152:155], v[132:135]
    ds_read_b64_tr_b16 a[64:65], v9 offset:0
    global_load_dword a248, v12, s[90:91] offset:128 sc1
    v_mfma_f32_16x16x32_bf16 v[140:143], a[80:83], a[132:135], 0
    s_add_u32 s59, s58, 0
    ds_read_b64_tr_b16 a[66:67], v9 offset:4096
    v_and_b32 v12, 15, v0
    v_mfma_f32_16x16x32_bf16 v[140:143], a[84:87], a[140:143], v[140:143]
    ds_read_b64_tr_b16 a[68:69], v9 offset:16384
    buffer_store_dwordx4 v[120:123], v1, s[12:15], s59 offen offset:1024 sc1
    v_mfma_f32_16x16x32_bf16 v[140:143], a[88:91], a[148:151], v[140:143]
    s_add_u32 m0, s29, 159744
    ds_read_b64_tr_b16 a[70:71], v9 offset:20480
    v_xor_b32 v10, 65824, v6
    v_mfma_f32_16x16x32_bf16 v[140:143], a[92:95], a[156:159], v[140:143]
    s_waitcnt lgkmcnt(6)
    ds_read_b64_tr_b16 a[72:73], v10 offset:0
    buffer_load_dwordx4 v2, s[16:19], s54 offen lds
    v_mfma_f32_16x16x32_bf16 v[148:151], a[96:99], a[128:131], 0
    s_add_u32 s38, s38, s39
    ds_read_b64_tr_b16 a[74:75], v10 offset:4096
    v_lshlrev_b32 v12, 2, v12
    v_mfma_f32_16x16x32_bf16 v[148:151], a[100:103], a[136:139], v[148:151]
    s_mul_i32 s38, s38, 896
    ds_read_b64_tr_b16 a[76:77], v10 offset:16384
    v_mfma_f32_16x16x32_bf16 v[148:151], a[104:107], a[144:147], v[148:151]
    s_waitcnt lgkmcnt(7)
    ds_read_b64_tr_b16 a[78:79], v10 offset:20480
    v_xor_b32 v7, 320, v6
    v_mfma_f32_16x16x32_bf16 v[148:151], a[108:111], a[152:155], v[148:151]
    s_lshl_b32 s39, s37, 7
    ds_read_b64_tr_b16 a[80:81], v7 offset:0
    v_mfma_f32_16x16x32_bf16 v[156:159], a[96:99], a[132:135], 0
    s_add_u32 s59, s58, 24576
    ds_read_b64_tr_b16 a[82:83], v7 offset:4096
    v_mfma_f32_16x16x32_bf16 v[156:159], a[100:103], a[140:143], v[156:159]
    ds_read_b64_tr_b16 a[84:85], v7 offset:16384
    buffer_store_dwordx4 v[128:131], v1, s[12:15], s59 offen offset:2048 sc1
    v_mfma_f32_16x16x32_bf16 v[156:159], a[104:107], a[148:151], v[156:159]
    s_add_u32 s38, s38, s39
    ds_read_b64_tr_b16 a[86:87], v7 offset:20480
    v_xor_b32 v8, 65856, v6
    v_mfma_f32_16x16x32_bf16 v[156:159], a[108:111], a[156:159], v[156:159]
    s_waitcnt lgkmcnt(6)
    ds_read_b64_tr_b16 a[88:89], v8 offset:0
    v_mfma_f32_16x16x32_bf16 v[164:167], a[64:67], a[128:131], 0
    s_lshl_b32 s39, s37, 9
    ds_read_b64_tr_b16 a[90:91], v8 offset:4096
    v_mfma_f32_16x16x32_bf16 v[164:167], a[68:71], a[136:139], v[164:167]
    s_mov_b32 s4, s66
    ds_read_b64_tr_b16 a[92:93], v8 offset:16384
    v_mfma_f32_16x16x32_bf16 v[164:167], a[72:75], a[144:147], v[164:167]
    s_waitcnt lgkmcnt(7)
    ds_read_b64_tr_b16 a[94:95], v8 offset:20480
    v_xor_b32 v9, 352, v6
    v_mfma_f32_16x16x32_bf16 v[164:167], a[76:79], a[152:155], v[164:167]
    s_mov_b32 s5, s67
    ds_read_b64_tr_b16 a[96:97], v9 offset:0
    v_mfma_f32_16x16x32_bf16 v[172:175], a[64:67], a[132:135], 0
    s_add_u32 s59, s58, 16384
    ds_read_b64_tr_b16 a[98:99], v9 offset:4096
    v_mfma_f32_16x16x32_bf16 v[172:175], a[68:71], a[140:143], v[172:175]
    ds_read_b64_tr_b16 a[100:101], v9 offset:16384
    buffer_store_dwordx4 v[136:139], v1, s[12:15], s59 offen offset:2048 sc1
    v_mfma_f32_16x16x32_bf16 v[172:175], a[72:75], a[148:151], v[172:175]
    s_mov_b32 s6, 1835008
    ds_read_b64_tr_b16 a[102:103], v9 offset:20480
    v_xor_b32 v10, 65888, v6
    v_mfma_f32_16x16x32_bf16 v[172:175], a[76:79], a[156:159], v[172:175]
    s_waitcnt lgkmcnt(6)
    ds_read_b64_tr_b16 a[104:105], v10 offset:0
    v_mfma_f32_16x16x32_bf16 v[180:183], a[80:83], a[128:131], 0
    s_mov_b32 s7, 0x20000
    ds_read_b64_tr_b16 a[106:107], v10 offset:4096
    v_mfma_f32_16x16x32_bf16 v[180:183], a[84:87], a[136:139], v[180:183]
    s_mov_b32 s8, s68
    ds_read_b64_tr_b16 a[108:109], v10 offset:16384
    v_mfma_f32_16x16x32_bf16 v[180:183], a[88:91], a[144:147], v[180:183]
    s_waitcnt lgkmcnt(7)
    ds_read_b64_tr_b16 a[110:111], v10 offset:20480
    v_xor_b32 v7, 384, v6
    v_mfma_f32_16x16x32_bf16 v[180:183], a[92:95], a[152:155], v[180:183]
    s_mov_b32 s9, s69
    ds_read_b64_tr_b16 a[64:65], v7 offset:0
    v_mfma_f32_16x16x32_bf16 v[188:191], a[80:83], a[132:135], 0
    s_add_u32 s59, s58, 8192
    ds_read_b64_tr_b16 a[66:67], v7 offset:4096
    v_mfma_f32_16x16x32_bf16 v[188:191], a[84:87], a[140:143], v[188:191]
    ds_read_b64_tr_b16 a[68:69], v7 offset:16384
    buffer_store_dwordx4 v[144:147], v1, s[12:15], s59 offen offset:2048 sc1
    v_mfma_f32_16x16x32_bf16 v[188:191], a[88:91], a[148:151], v[188:191]
    s_mov_b32 s10, 1835008
    ds_read_b64_tr_b16 a[70:71], v7 offset:20480
    v_xor_b32 v8, 65920, v6
    v_mfma_f32_16x16x32_bf16 v[188:191], a[92:95], a[156:159], v[188:191]
    s_waitcnt lgkmcnt(6)
    ds_read_b64_tr_b16 a[72:73], v8 offset:0
    v_mfma_f32_16x16x32_bf16 v[196:199], a[96:99], a[128:131], 0
    s_mov_b32 s11, 0x20000
    ds_read_b64_tr_b16 a[74:75], v8 offset:4096
    v_mfma_f32_16x16x32_bf16 v[196:199], a[100:103], a[136:139], v[196:199]
    s_mov_b32 s20, s70
    ds_read_b64_tr_b16 a[76:77], v8 offset:16384
    v_mfma_f32_16x16x32_bf16 v[196:199], a[104:107], a[144:147], v[196:199]
    s_waitcnt lgkmcnt(7)
    ds_read_b64_tr_b16 a[78:79], v8 offset:20480
    v_xor_b32 v9, 416, v6
    v_mfma_f32_16x16x32_bf16 v[196:199], a[108:111], a[152:155], v[196:199]
    s_mov_b32 s21, s71
    ds_read_b64_tr_b16 a[80:81], v9 offset:0
    v_mfma_f32_16x16x32_bf16 v[204:207], a[96:99], a[132:135], 0
    s_add_u32 s59, s58, 0
    ds_read_b64_tr_b16 a[82:83], v9 offset:4096
    v_mfma_f32_16x16x32_bf16 v[204:207], a[100:103], a[140:143], v[204:207]
    ds_read_b64_tr_b16 a[84:85], v9 offset:16384
    buffer_store_dwordx4 v[152:155], v1, s[12:15], s59 offen offset:2048 sc1
    v_mfma_f32_16x16x32_bf16 v[204:207], a[104:107], a[148:151], v[204:207]
    s_mov_b32 s22, 3584
    ds_read_b64_tr_b16 a[86:87], v9 offset:20480
    v_xor_b32 v10, 65952, v6
    v_mfma_f32_16x16x32_bf16 v[204:207], a[108:111], a[156:159], v[204:207]
    s_waitcnt lgkmcnt(6)
    ds_read_b64_tr_b16 a[88:89], v10 offset:0
    v_mfma_f32_16x16x32_bf16 v[212:215], a[64:67], a[128:131], 0
    s_mov_b32 s23, 0x20000
    ds_read_b64_tr_b16 a[90:91], v10 offset:4096
    v_mfma_f32_16x16x32_bf16 v[212:215], a[68:71], a[136:139], v[212:215]
    ds_read_b64_tr_b16 a[92:93], v10 offset:16384
    v_lshrrev_b32 v120, 3, v0
    v_mfma_f32_16x16x32_bf16 v[212:215], a[72:75], a[144:147], v[212:215]
    s_waitcnt lgkmcnt(7)
    ds_read_b64_tr_b16 a[94:95], v10 offset:20480
    v_xor_b32 v7, 448, v6
    v_mfma_f32_16x16x32_bf16 v[212:215], a[76:79], a[152:155], v[212:215]
    ds_read_b64_tr_b16 a[96:97], v7 offset:0
    v_mul_u32_u24 v120, 1792, v120
    v_mfma_f32_16x16x32_bf16 v[220:223], a[64:67], a[132:135], 0
    s_add_u32 s59, s58, 24576
    ds_read_b64_tr_b16 a[98:99], v7 offset:4096
    v_and_b32 v121, 7, v0
    v_mfma_f32_16x16x32_bf16 v[220:223], a[68:71], a[140:143], v[220:223]
    ds_read_b64_tr_b16 a[100:101], v7 offset:16384
    buffer_store_dwordx4 v[160:163], v1, s[12:15], s59 offen offset:3072 sc1
    v_mfma_f32_16x16x32_bf16 v[220:223], a[72:75], a[148:151], v[220:223]
    ds_read_b64_tr_b16 a[102:103], v7 offset:20480
    v_xor_b32 v8, 65984, v6
    v_mfma_f32_16x16x32_bf16 v[220:223], a[76:79], a[156:159], v[220:223]
    s_waitcnt lgkmcnt(6)
    ds_read_b64_tr_b16 a[104:105], v8 offset:0
    v_lshl_add_u32 v120, v121, 4, v120
    v_mfma_f32_16x16x32_bf16 v[228:231], a[80:83], a[128:131], 0
    ds_read_b64_tr_b16 a[106:107], v8 offset:4096
    v_add_u32 v120, s38, v120
    v_mfma_f32_16x16x32_bf16 v[228:231], a[84:87], a[136:139], v[228:231]
    ds_read_b64_tr_b16 a[108:109], v8 offset:16384
    v_lshlrev_b32 v121, 6, v121
    v_mfma_f32_16x16x32_bf16 v[228:231], a[88:91], a[144:147], v[228:231]
    s_waitcnt lgkmcnt(7)
    ds_read_b64_tr_b16 a[110:111], v8 offset:20480
    v_xor_b32 v9, 480, v6
    v_mfma_f32_16x16x32_bf16 v[228:231], a[92:95], a[152:155], v[228:231]
    ds_read_b64_tr_b16 a[64:65], v9 offset:0
    v_subrev_u32 v122, 2688, v120
    v_mfma_f32_16x16x32_bf16 v[236:239], a[80:83], a[132:135], 0
    s_add_u32 s59, s58, 16384
    ds_read_b64_tr_b16 a[66:67], v9 offset:4096
    v_subrev_u32 v123, 1792, v120
    v_mfma_f32_16x16x32_bf16 v[236:239], a[84:87], a[140:143], v[236:239]
    ds_read_b64_tr_b16 a[68:69], v9 offset:16384
    buffer_store_dwordx4 v[168:171], v1, s[12:15], s59 offen offset:3072 sc1
    v_mfma_f32_16x16x32_bf16 v[236:239], a[88:91], a[148:151], v[236:239]
    ds_read_b64_tr_b16 a[70:71], v9 offset:20480
    v_xor_b32 v10, 66016, v6
    v_mfma_f32_16x16x32_bf16 v[236:239], a[92:95], a[156:159], v[236:239]
    s_waitcnt lgkmcnt(6)
    ds_read_b64_tr_b16 a[72:73], v10 offset:0
    v_subrev_u32 v128, 896, v120
    v_mfma_f32_16x16x32_bf16 v[244:247], a[96:99], a[128:131], 0
    ds_read_b64_tr_b16 a[74:75], v10 offset:4096
    v_mfma_f32_16x16x32_bf16 v[244:247], a[100:103], a[136:139], v[244:247]
    s_waitcnt vmcnt(23)
    ds_read_b64_tr_b16 a[76:77], v10 offset:16384
    v_xor_b32 v7, 32768, v6
    v_mfma_f32_16x16x32_bf16 v[244:247], a[104:107], a[144:147], v[244:247]
    s_waitcnt lgkmcnt(7)
    s_barrier
    ds_read_b64_tr_b16 a[78:79], v10 offset:20480
    v_mfma_f32_16x16x32_bf16 v[244:247], a[108:111], a[152:155], v[244:247]
    ds_read_b64_tr_b16 a[80:81], v7 offset:0
    v_mfma_f32_16x16x32_bf16 v[252:255], a[96:99], a[132:135], 0
    s_add_u32 s59, s58, 8192
    ds_read_b64_tr_b16 a[82:83], v7 offset:4096
    v_mfma_f32_16x16x32_bf16 v[252:255], a[100:103], a[140:143], v[252:255]
    ds_read_b64_tr_b16 a[84:85], v7 offset:16384
    buffer_store_dwordx4 v[176:179], v1, s[12:15], s59 offen offset:3072 sc1
    v_mfma_f32_16x16x32_bf16 v[252:255], a[104:107], a[148:151], v[252:255]
    ds_read_b64_tr_b16 a[86:87], v7 offset:20480
    v_xor_b32 v8, 98304, v6
    v_mfma_f32_16x16x32_bf16 v[252:255], a[108:111], a[156:159], v[252:255]
    s_waitcnt lgkmcnt(6)
    ds_read_b64_tr_b16 a[88:89], v8 offset:0
    v_mfma_f32_16x16x32_bf16 v[16:19], a[64:67], a[128:131], 0
    ds_read_b64_tr_b16 a[90:91], v8 offset:4096
    v_mfma_f32_16x16x32_bf16 v[16:19], a[68:71], a[136:139], v[16:19]
    ds_read_b64_tr_b16 a[92:93], v8 offset:16384
    v_mfma_f32_16x16x32_bf16 v[16:19], a[72:75], a[144:147], v[16:19]
    s_waitcnt lgkmcnt(7)
    ds_read_b64_tr_b16 a[94:95], v8 offset:20480
    v_xor_b32 v9, 32800, v6
    v_mfma_f32_16x16x32_bf16 v[16:19], a[76:79], a[152:155], v[16:19]
    ds_read_b64_tr_b16 a[96:97], v9 offset:0
    v_mfma_f32_16x16x32_bf16 v[24:27], a[64:67], a[132:135], 0
    s_waitcnt lgkmcnt(9)
    ds_read_b64_tr_b16 a[98:99], v9 offset:4096
    v_mfma_f32_16x16x32_bf16 v[24:27], a[68:71], a[140:143], v[24:27]
    s_barrier
    ds_read_b64_tr_b16 a[100:101], v9 offset:16384
    v_mfma_f32_16x16x32_bf16 v[24:27], a[72:75], a[148:151], v[24:27]
    s_add_u32 m0, s29, 0
    ds_read_b64_tr_b16 a[102:103], v9 offset:20480
    v_xor_b32 v10, 98336, v6
    v_mfma_f32_16x16x32_bf16 v[24:27], a[76:79], a[156:159], v[24:27]
    s_waitcnt lgkmcnt(6)
    ds_read_b64_tr_b16 a[104:105], v10 offset:0
    v_add_u32 v2, 0x80000, v2
    v_mfma_f32_16x16x32_bf16 v[28:31], a[80:83], a[160:163], v[28:31]
    ds_read_b64_tr_b16 a[106:107], v10 offset:4096
    buffer_load_dwordx4 v2, s[16:19], 0 offen lds
    v_mfma_f32_16x16x32_bf16 v[28:31], a[84:87], a[168:171], v[28:31]
    s_add_u32 s59, s58, 0
    ds_read_b64_tr_b16 a[108:109], v10 offset:16384
    v_mfma_f32_16x16x32_bf16 v[28:31], a[88:91], a[176:179], v[28:31]
    s_waitcnt lgkmcnt(7)
    ds_read_b64_tr_b16 a[110:111], v10 offset:20480
    v_xor_b32 v7, 32832, v6
    v_mfma_f32_16x16x32_bf16 v[28:31], a[92:95], a[184:187], v[28:31]
    ds_read_b64_tr_b16 a[64:65], v7 offset:0
    buffer_store_dwordx4 v[184:187], v1, s[12:15], s59 offen offset:3072 sc1
    v_mfma_f32_16x16x32_bf16 v[44:47], a[80:83], a[164:167], v[44:47]
    s_add_u32 m0, s29, 4096
    ds_read_b64_tr_b16 a[66:67], v7 offset:4096
    v_mfma_f32_16x16x32_bf16 v[44:47], a[84:87], a[172:175], v[44:47]
    ds_read_b64_tr_b16 a[68:69], v7 offset:16384
    buffer_load_dwordx4 v2, s[16:19], s48 offen lds
    v_mfma_f32_16x16x32_bf16 v[44:47], a[88:91], a[180:183], v[44:47]
    ds_read_b64_tr_b16 a[70:71], v7 offset:20480
    v_xor_b32 v8, 98368, v6
    v_mfma_f32_16x16x32_bf16 v[44:47], a[92:95], a[188:191], v[44:47]
    s_waitcnt lgkmcnt(6)
    ds_read_b64_tr_b16 a[72:73], v8 offset:0
    v_mfma_f32_16x16x32_bf16 v[52:55], a[96:99], a[160:163], v[52:55]
    ds_read_b64_tr_b16 a[74:75], v8 offset:4096
    v_mfma_f32_16x16x32_bf16 v[52:55], a[100:103], a[168:171], v[52:55]
    s_add_u32 m0, s29, 8192
    ds_read_b64_tr_b16 a[76:77], v8 offset:16384
    v_mfma_f32_16x16x32_bf16 v[52:55], a[104:107], a[176:179], v[52:55]
    s_waitcnt lgkmcnt(7)
    ds_read_b64_tr_b16 a[78:79], v8 offset:20480
    v_xor_b32 v9, 32864, v6
    v_mfma_f32_16x16x32_bf16 v[52:55], a[108:111], a[184:187], v[52:55]
    ds_read_b64_tr_b16 a[80:81], v9 offset:0
    buffer_load_dwordx4 v2, s[16:19], s49 offen lds
    v_mfma_f32_16x16x32_bf16 v[60:63], a[96:99], a[164:167], v[60:63]
    s_add_u32 s59, s58, 57344
    ds_read_b64_tr_b16 a[82:83], v9 offset:4096
    v_mfma_f32_16x16x32_bf16 v[60:63], a[100:103], a[172:175], v[60:63]
    ds_read_b64_tr_b16 a[84:85], v9 offset:16384
    buffer_store_dwordx4 v[192:195], v1, s[12:15], s59 offen offset:2048 sc1
    v_mfma_f32_16x16x32_bf16 v[60:63], a[104:107], a[180:183], v[60:63]
    s_add_u32 m0, s29, 12288
    ds_read_b64_tr_b16 a[86:87], v9 offset:20480
    v_xor_b32 v10, 98400, v6
    v_mfma_f32_16x16x32_bf16 v[60:63], a[108:111], a[188:191], v[60:63]
    s_waitcnt lgkmcnt(6)
    ds_read_b64_tr_b16 a[88:89], v10 offset:0
    v_mfma_f32_16x16x32_bf16 v[20:23], a[64:67], a[160:163], v[20:23]
    ds_read_b64_tr_b16 a[90:91], v10 offset:4096
    buffer_load_dwordx4 v2, s[16:19], s50 offen lds
    v_mfma_f32_16x16x32_bf16 v[20:23], a[68:71], a[168:171], v[20:23]
    ds_read_b64_tr_b16 a[92:93], v10 offset:16384
    v_mfma_f32_16x16x32_bf16 v[20:23], a[72:75], a[176:179], v[20:23]
    s_waitcnt lgkmcnt(7)
    ds_read_b64_tr_b16 a[94:95], v10 offset:20480
    v_xor_b32 v7, 32896, v6
    v_mfma_f32_16x16x32_bf16 v[20:23], a[76:79], a[184:187], v[20:23]
    ds_read_b64_tr_b16 a[96:97], v7 offset:0
    v_mfma_f32_16x16x32_bf16 v[36:39], a[64:67], a[164:167], v[36:39]
    s_add_u32 m0, s29, 16384
    ds_read_b64_tr_b16 a[98:99], v7 offset:4096
    v_mfma_f32_16x16x32_bf16 v[36:39], a[68:71], a[172:175], v[36:39]
    ds_read_b64_tr_b16 a[100:101], v7 offset:16384
    buffer_load_dwordx4 v2, s[16:19], s51 offen lds
    v_mfma_f32_16x16x32_bf16 v[36:39], a[72:75], a[180:183], v[36:39]
    s_add_u32 s59, s58, 49152
    ds_read_b64_tr_b16 a[102:103], v7 offset:20480
    v_xor_b32 v8, 98432, v6
    v_mfma_f32_16x16x32_bf16 v[36:39], a[76:79], a[188:191], v[36:39]
    s_waitcnt lgkmcnt(6)
    ds_read_b64_tr_b16 a[104:105], v8 offset:0
    buffer_store_dwordx4 v[200:203], v1, s[12:15], s59 offen offset:2048 sc1
    v_mfma_f32_16x16x32_bf16 v[68:71], a[80:83], a[160:163], v[68:71]
    ds_read_b64_tr_b16 a[106:107], v8 offset:4096
    v_mfma_f32_16x16x32_bf16 v[68:71], a[84:87], a[168:171], v[68:71]
    s_add_u32 m0, s29, 20480
    ds_read_b64_tr_b16 a[108:109], v8 offset:16384
    v_mfma_f32_16x16x32_bf16 v[68:71], a[88:91], a[176:179], v[68:71]
    s_waitcnt lgkmcnt(7)
    ds_read_b64_tr_b16 a[110:111], v8 offset:20480
    v_xor_b32 v9, 32928, v6
    v_mfma_f32_16x16x32_bf16 v[68:71], a[92:95], a[184:187], v[68:71]
    ds_read_b64_tr_b16 a[64:65], v9 offset:0
    buffer_load_dwordx4 v2, s[16:19], s52 offen lds
    v_mfma_f32_16x16x32_bf16 v[76:79], a[80:83], a[164:167], v[76:79]
    ds_read_b64_tr_b16 a[66:67], v9 offset:4096
    v_mfma_f32_16x16x32_bf16 v[76:79], a[84:87], a[172:175], v[76:79]
    ds_read_b64_tr_b16 a[68:69], v9 offset:16384
    v_mfma_f32_16x16x32_bf16 v[76:79], a[88:91], a[180:183], v[76:79]
    s_add_u32 m0, s29, 24576
    ds_read_b64_tr_b16 a[70:71], v9 offset:20480
    v_xor_b32 v10, 98464, v6
    v_mfma_f32_16x16x32_bf16 v[76:79], a[92:95], a[188:191], v[76:79]
    s_waitcnt lgkmcnt(6)
    ds_read_b64_tr_b16 a[72:73], v10 offset:0
    v_mfma_f32_16x16x32_bf16 v[84:87], a[96:99], a[160:163], v[84:87]
    ds_read_b64_tr_b16 a[74:75], v10 offset:4096
    buffer_load_dwordx4 v2, s[16:19], s53 offen lds
    v_mfma_f32_16x16x32_bf16 v[84:87], a[100:103], a[168:171], v[84:87]
    s_add_u32 s59, s58, 40960
    ds_read_b64_tr_b16 a[76:77], v10 offset:16384
    v_mfma_f32_16x16x32_bf16 v[84:87], a[104:107], a[176:179], v[84:87]
    s_waitcnt lgkmcnt(7)
    ds_read_b64_tr_b16 a[78:79], v10 offset:20480
    v_xor_b32 v7, 32960, v6
    v_mfma_f32_16x16x32_bf16 v[84:87], a[108:111], a[184:187], v[84:87]
    ds_read_b64_tr_b16 a[80:81], v7 offset:0
    buffer_store_dwordx4 v[208:211], v1, s[12:15], s59 offen offset:2048 sc1
    v_mfma_f32_16x16x32_bf16 v[92:95], a[96:99], a[164:167], v[92:95]
    s_add_u32 m0, s29, 28672
    ds_read_b64_tr_b16 a[82:83], v7 offset:4096
    v_mfma_f32_16x16x32_bf16 v[92:95], a[100:103], a[172:175], v[92:95]
    ds_read_b64_tr_b16 a[84:85], v7 offset:16384
    buffer_load_dwordx4 v2, s[16:19], s54 offen lds
    v_mfma_f32_16x16x32_bf16 v[92:95], a[104:107], a[180:183], v[92:95]
    ds_read_b64_tr_b16 a[86:87], v7 offset:20480
    v_xor_b32 v8, 98496, v6
    v_mfma_f32_16x16x32_bf16 v[92:95], a[108:111], a[188:191], v[92:95]
    s_waitcnt lgkmcnt(6)
    ds_read_b64_tr_b16 a[88:89], v8 offset:0
    v_mfma_f32_16x16x32_bf16 v[100:103], a[64:67], a[160:163], v[100:103]
    s_add_u32 m0, s29, 65536
    ds_read_b64_tr_b16 a[90:91], v8 offset:4096
    v_add_u32 v2, 0x80000, v2
    v_mfma_f32_16x16x32_bf16 v[100:103], a[68:71], a[168:171], v[100:103]
    ds_read_b64_tr_b16 a[92:93], v8 offset:16384
    buffer_load_dwordx4 v2, s[16:19], 0 offen lds
    v_mfma_f32_16x16x32_bf16 v[100:103], a[72:75], a[176:179], v[100:103]
    s_waitcnt lgkmcnt(7)
    ds_read_b64_tr_b16 a[94:95], v8 offset:20480
    v_xor_b32 v9, 32992, v6
    v_mfma_f32_16x16x32_bf16 v[100:103], a[76:79], a[184:187], v[100:103]
    s_add_u32 s59, s58, 32768
    ds_read_b64_tr_b16 a[96:97], v9 offset:0
    v_mfma_f32_16x16x32_bf16 v[108:111], a[64:67], a[164:167], v[108:111]
    ds_read_b64_tr_b16 a[98:99], v9 offset:4096
    buffer_store_dwordx4 v[216:219], v1, s[12:15], s59 offen offset:2048 sc1
    v_mfma_f32_16x16x32_bf16 v[108:111], a[68:71], a[172:175], v[108:111]
    ds_read_b64_tr_b16 a[100:101], v9 offset:16384
    v_mfma_f32_16x16x32_bf16 v[108:111], a[72:75], a[180:183], v[108:111]
    s_add_u32 m0, s29, 69632
    ds_read_b64_tr_b16 a[102:103], v9 offset:20480
    v_xor_b32 v10, 98528, v6
    v_mfma_f32_16x16x32_bf16 v[108:111], a[76:79], a[188:191], v[108:111]
    s_waitcnt lgkmcnt(6)
    ds_read_b64_tr_b16 a[104:105], v10 offset:0
    buffer_load_dwordx4 v2, s[16:19], s48 offen lds
    v_mfma_f32_16x16x32_bf16 v[116:119], a[80:83], a[160:163], v[116:119]
    ds_read_b64_tr_b16 a[106:107], v10 offset:4096
    v_mfma_f32_16x16x32_bf16 v[116:119], a[84:87], a[168:171], v[116:119]
    ds_read_b64_tr_b16 a[108:109], v10 offset:16384
    v_mfma_f32_16x16x32_bf16 v[116:119], a[88:91], a[176:179], v[116:119]
    s_waitcnt lgkmcnt(7)
    ds_read_b64_tr_b16 a[110:111], v10 offset:20480
    v_xor_b32 v7, 33024, v6
    v_mfma_f32_16x16x32_bf16 v[116:119], a[92:95], a[184:187], v[116:119]
    s_add_u32 m0, s29, 73728
    ds_read_b64_tr_b16 a[64:65], v7 offset:0
    v_mfma_f32_16x16x32_bf16 v[124:127], a[80:83], a[164:167], v[124:127]
    ds_read_b64_tr_b16 a[66:67], v7 offset:4096
    buffer_load_dwordx4 v2, s[16:19], s49 offen lds
    v_mfma_f32_16x16x32_bf16 v[124:127], a[84:87], a[172:175], v[124:127]
    ds_read_b64_tr_b16 a[68:69], v7 offset:16384
    v_mfma_f32_16x16x32_bf16 v[124:127], a[88:91], a[180:183], v[124:127]
    s_add_u32 s59, s58, 57344
    ds_read_b64_tr_b16 a[70:71], v7 offset:20480
    v_xor_b32 v8, 98560, v6
    v_mfma_f32_16x16x32_bf16 v[124:127], a[92:95], a[188:191], v[124:127]
    s_waitcnt lgkmcnt(6)
    ds_read_b64_tr_b16 a[72:73], v8 offset:0
    buffer_store_dwordx4 v[224:227], v1, s[12:15], s59 offen offset:3072 sc1
    v_mfma_f32_16x16x32_bf16 v[132:135], a[96:99], a[160:163], v[132:135]
    s_add_u32 m0, s29, 77824
    ds_read_b64_tr_b16 a[74:75], v8 offset:4096
    v_mfma_f32_16x16x32_bf16 v[132:135], a[100:103], a[168:171], v[132:135]
    ds_read_b64_tr_b16 a[76:77], v8 offset:16384
    buffer_load_dwordx4 v2, s[16:19], s50 offen lds
    v_mfma_f32_16x16x32_bf16 v[132:135], a[104:107], a[176:179], v[132:135]
    s_waitcnt lgkmcnt(7)
    ds_read_b64_tr_b16 a[78:79], v8 offset:20480
    v_xor_b32 v9, 33056, v6
    v_mfma_f32_16x16x32_bf16 v[132:135], a[108:111], a[184:187], v[132:135]
    ds_read_b64_tr_b16 a[80:81], v9 offset:0
    v_mfma_f32_16x16x32_bf16 v[140:143], a[96:99], a[164:167], v[140:143]
    ds_read_b64_tr_b16 a[82:83], v9 offset:4096
    v_mfma_f32_16x16x32_bf16 v[140:143], a[100:103], a[172:175], v[140:143]
    ds_read_b64_tr_b16 a[84:85], v9 offset:16384
    v_mfma_f32_16x16x32_bf16 v[140:143], a[104:107], a[180:183], v[140:143]
    s_add_u32 m0, s29, 81920
    ds_read_b64_tr_b16 a[86:87], v9 offset:20480
    v_xor_b32 v10, 98592, v6
    v_mfma_f32_16x16x32_bf16 v[140:143], a[108:111], a[188:191], v[140:143]
    s_waitcnt lgkmcnt(6)
    ds_read_b64_tr_b16 a[88:89], v10 offset:0
    buffer_load_dwordx4 v2, s[16:19], s51 offen lds
    v_mfma_f32_16x16x32_bf16 v[148:151], a[64:67], a[160:163], v[148:151]
    s_add_u32 s59, s58, 49152
    ds_read_b64_tr_b16 a[90:91], v10 offset:4096
    v_mfma_f32_16x16x32_bf16 v[148:151], a[68:71], a[168:171], v[148:151]
    ds_read_b64_tr_b16 a[92:93], v10 offset:16384
    buffer_store_dwordx4 v[232:235], v1, s[12:15], s59 offen offset:3072 sc1
    v_mfma_f32_16x16x32_bf16 v[148:151], a[72:75], a[176:179], v[148:151]
    s_waitcnt lgkmcnt(7)
    ds_read_b64_tr_b16 a[94:95], v10 offset:20480
    v_xor_b32 v7, 33088, v6
    v_mfma_f32_16x16x32_bf16 v[148:151], a[76:79], a[184:187], v[148:151]
    s_add_u32 m0, s29, 86016
    ds_read_b64_tr_b16 a[96:97], v7 offset:0
    v_mfma_f32_16x16x32_bf16 v[156:159], a[64:67], a[164:167], v[156:159]
    ds_read_b64_tr_b16 a[98:99], v7 offset:4096
    buffer_load_dwordx4 v2, s[16:19], s52 offen lds
    v_mfma_f32_16x16x32_bf16 v[156:159], a[68:71], a[172:175], v[156:159]
    ds_read_b64_tr_b16 a[100:101], v7 offset:16384
    v_mfma_f32_16x16x32_bf16 v[156:159], a[72:75], a[180:183], v[156:159]
    ds_read_b64_tr_b16 a[102:103], v7 offset:20480
    v_xor_b32 v8, 98624, v6
    v_mfma_f32_16x16x32_bf16 v[156:159], a[76:79], a[188:191], v[156:159]
    s_waitcnt lgkmcnt(6)
    ds_read_b64_tr_b16 a[104:105], v8 offset:0
    v_mfma_f32_16x16x32_bf16 v[164:167], a[80:83], a[160:163], v[164:167]
    s_add_u32 m0, s29, 90112
    ds_read_b64_tr_b16 a[106:107], v8 offset:4096
    v_mfma_f32_16x16x32_bf16 v[164:167], a[84:87], a[168:171], v[164:167]
    ds_read_b64_tr_b16 a[108:109], v8 offset:16384
    buffer_load_dwordx4 v2, s[16:19], s53 offen lds
    v_mfma_f32_16x16x32_bf16 v[164:167], a[88:91], a[176:179], v[164:167]
    s_waitcnt lgkmcnt(7)
    ds_read_b64_tr_b16 a[110:111], v8 offset:20480
    v_xor_b32 v9, 33120, v6
    v_mfma_f32_16x16x32_bf16 v[164:167], a[92:95], a[184:187], v[164:167]
    s_add_u32 s59, s58, 40960
    ds_read_b64_tr_b16 a[64:65], v9 offset:0
    v_mfma_f32_16x16x32_bf16 v[172:175], a[80:83], a[164:167], v[172:175]
    ds_read_b64_tr_b16 a[66:67], v9 offset:4096
    buffer_store_dwordx4 v[240:243], v1, s[12:15], s59 offen offset:3072 sc1
    v_mfma_f32_16x16x32_bf16 v[172:175], a[84:87], a[172:175], v[172:175]
    ds_read_b64_tr_b16 a[68:69], v9 offset:16384
    v_mfma_f32_16x16x32_bf16 v[172:175], a[88:91], a[180:183], v[172:175]
    s_add_u32 m0, s29, 94208
    ds_read_b64_tr_b16 a[70:71], v9 offset:20480
    v_xor_b32 v10, 98656, v6
    v_mfma_f32_16x16x32_bf16 v[172:175], a[92:95], a[188:191], v[172:175]
    s_waitcnt lgkmcnt(6)
    ds_read_b64_tr_b16 a[72:73], v10 offset:0
    buffer_load_dwordx4 v2, s[16:19], s54 offen lds
    v_mfma_f32_16x16x32_bf16 v[180:183], a[96:99], a[160:163], v[180:183]
    ds_read_b64_tr_b16 a[74:75], v10 offset:4096
    v_mfma_f32_16x16x32_bf16 v[180:183], a[100:103], a[168:171], v[180:183]
    ds_read_b64_tr_b16 a[76:77], v10 offset:16384
    v_mfma_f32_16x16x32_bf16 v[180:183], a[104:107], a[176:179], v[180:183]
    s_waitcnt lgkmcnt(7)
    ds_read_b64_tr_b16 a[78:79], v10 offset:20480
    v_xor_b32 v7, 33152, v6
    v_mfma_f32_16x16x32_bf16 v[180:183], a[108:111], a[184:187], v[180:183]
    s_add_u32 s59, s58, 32768
    ds_read_b64_tr_b16 a[80:81], v7 offset:0
    v_mfma_f32_16x16x32_bf16 v[188:191], a[96:99], a[164:167], v[188:191]
    ds_read_b64_tr_b16 a[82:83], v7 offset:4096
    buffer_store_dwordx4 v[248:251], v1, s[12:15], s59 offen offset:3072 sc1
    v_mfma_f32_16x16x32_bf16 v[188:191], a[100:103], a[172:175], v[188:191]
    ds_read_b64_tr_b16 a[84:85], v7 offset:16384
    v_mfma_f32_16x16x32_bf16 v[188:191], a[104:107], a[180:183], v[188:191]
    ds_read_b64_tr_b16 a[86:87], v7 offset:20480
    v_xor_b32 v8, 98688, v6
    v_mfma_f32_16x16x32_bf16 v[188:191], a[108:111], a[188:191], v[188:191]
    s_waitcnt lgkmcnt(6)
    ds_read_b64_tr_b16 a[88:89], v8 offset:0
    v_mfma_f32_16x16x32_bf16 v[196:199], a[64:67], a[160:163], v[196:199]
    ds_read_b64_tr_b16 a[90:91], v8 offset:4096
    v_mfma_f32_16x16x32_bf16 v[196:199], a[68:71], a[168:171], v[196:199]
    ds_read_b64_tr_b16 a[92:93], v8 offset:16384
    v_mfma_f32_16x16x32_bf16 v[196:199], a[72:75], a[176:179], v[196:199]
    s_waitcnt lgkmcnt(7)
    ds_read_b64_tr_b16 a[94:95], v8 offset:20480
    v_xor_b32 v9, 33184, v6
    v_mfma_f32_16x16x32_bf16 v[196:199], a[76:79], a[184:187], v[196:199]
    ds_read_b64_tr_b16 a[96:97], v9 offset:0
    v_mfma_f32_16x16x32_bf16 v[204:207], a[64:67], a[164:167], v[204:207]
    ds_read_b64_tr_b16 a[98:99], v9 offset:4096
    v_mfma_f32_16x16x32_bf16 v[204:207], a[68:71], a[172:175], v[204:207]
    ds_read_b64_tr_b16 a[100:101], v9 offset:16384
    v_mfma_f32_16x16x32_bf16 v[204:207], a[72:75], a[180:183], v[204:207]
    ds_read_b64_tr_b16 a[102:103], v9 offset:20480
    v_xor_b32 v10, 98720, v6
    v_mfma_f32_16x16x32_bf16 v[204:207], a[76:79], a[188:191], v[204:207]
    s_waitcnt lgkmcnt(6)
    ds_read_b64_tr_b16 a[104:105], v10 offset:0
    v_mfma_f32_16x16x32_bf16 v[212:215], a[80:83], a[160:163], v[212:215]
    ds_read_b64_tr_b16 a[106:107], v10 offset:4096
    v_mfma_f32_16x16x32_bf16 v[212:215], a[84:87], a[168:171], v[212:215]
    ds_read_b64_tr_b16 a[108:109], v10 offset:16384
    v_mfma_f32_16x16x32_bf16 v[212:215], a[88:91], a[176:179], v[212:215]
    s_waitcnt lgkmcnt(7)
    ds_read_b64_tr_b16 a[110:111], v10 offset:20480
    v_xor_b32 v7, 33216, v6
    v_mfma_f32_16x16x32_bf16 v[212:215], a[92:95], a[184:187], v[212:215]
    ds_read_b64_tr_b16 a[64:65], v7 offset:0
    v_mfma_f32_16x16x32_bf16 v[220:223], a[80:83], a[164:167], v[220:223]
    ds_read_b64_tr_b16 a[66:67], v7 offset:4096
    v_mfma_f32_16x16x32_bf16 v[220:223], a[84:87], a[172:175], v[220:223]
    ds_read_b64_tr_b16 a[68:69], v7 offset:16384
    v_mfma_f32_16x16x32_bf16 v[220:223], a[88:91], a[180:183], v[220:223]
    ds_read_b64_tr_b16 a[70:71], v7 offset:20480
    v_xor_b32 v8, 98752, v6
    v_mfma_f32_16x16x32_bf16 v[220:223], a[92:95], a[188:191], v[220:223]
    s_waitcnt lgkmcnt(6)
    ds_read_b64_tr_b16 a[72:73], v8 offset:0
    v_mfma_f32_16x16x32_bf16 v[228:231], a[96:99], a[160:163], v[228:231]
    ds_read_b64_tr_b16 a[74:75], v8 offset:4096
    v_mfma_f32_16x16x32_bf16 v[228:231], a[100:103], a[168:171], v[228:231]
    ds_read_b64_tr_b16 a[76:77], v8 offset:16384
    v_mfma_f32_16x16x32_bf16 v[228:231], a[104:107], a[176:179], v[228:231]
    s_waitcnt lgkmcnt(7)
    ds_read_b64_tr_b16 a[78:79], v8 offset:20480
    v_xor_b32 v9, 33248, v6
    v_mfma_f32_16x16x32_bf16 v[228:231], a[108:111], a[184:187], v[228:231]
    ds_read_b64_tr_b16 a[80:81], v9 offset:0
    v_mfma_f32_16x16x32_bf16 v[236:239], a[96:99], a[164:167], v[236:239]
    ds_read_b64_tr_b16 a[82:83], v9 offset:4096
    v_mfma_f32_16x16x32_bf16 v[236:239], a[100:103], a[172:175], v[236:239]
    ds_read_b64_tr_b16 a[84:85], v9 offset:16384
    v_mfma_f32_16x16x32_bf16 v[236:239], a[104:107], a[180:183], v[236:239]
    ds_read_b64_tr_b16 a[86:87], v9 offset:20480
    v_xor_b32 v10, 98784, v6
    v_mfma_f32_16x16x32_bf16 v[236:239], a[108:111], a[188:191], v[236:239]
    s_waitcnt lgkmcnt(6)
    ds_read_b64_tr_b16 a[88:89], v10 offset:0
    v_mfma_f32_16x16x32_bf16 v[244:247], a[64:67], a[160:163], v[244:247]
    ds_read_b64_tr_b16 a[90:91], v10 offset:4096
    v_mfma_f32_16x16x32_bf16 v[244:247], a[68:71], a[168:171], v[244:247]
    s_waitcnt vmcnt(1)
    ds_read_b64_tr_b16 a[92:93], v10 offset:16384
    v_xor_b32 v7, 131072, v6
    v_mfma_f32_16x16x32_bf16 v[244:247], a[72:75], a[176:179], v[244:247]
    s_waitcnt lgkmcnt(7)
    s_barrier
    ds_read_b64_tr_b16 a[94:95], v10 offset:20480
    v_mfma_f32_16x16x32_bf16 v[244:247], a[76:79], a[184:187], v[244:247]
    ds_read_b64_tr_b16 a[96:97], v7 offset:0
    v_mfma_f32_16x16x32_bf16 v[252:255], a[64:67], a[164:167], v[252:255]
    ds_read_b64_tr_b16 a[98:99], v7 offset:4096
    v_mfma_f32_16x16x32_bf16 v[252:255], a[68:71], a[172:175], v[252:255]
    ds_read_b64_tr_b16 a[100:101], v7 offset:16384
    v_mfma_f32_16x16x32_bf16 v[252:255], a[72:75], a[180:183], v[252:255]
    ds_read_b64_tr_b16 a[102:103], v7 offset:20480
    v_xor_b32 v8, 0, v6
    v_mfma_f32_16x16x32_bf16 v[252:255], a[76:79], a[188:191], v[252:255]
    s_waitcnt lgkmcnt(6)
    ds_read_b64_tr_b16 a[104:105], v8 offset:0
    v_mfma_f32_16x16x32_bf16 v[16:19], a[80:83], a[160:163], v[16:19]
    ds_read_b64_tr_b16 a[106:107], v8 offset:4096
    v_mfma_f32_16x16x32_bf16 v[16:19], a[84:87], a[168:171], v[16:19]
    ds_read_b64_tr_b16 a[108:109], v8 offset:16384
    v_mfma_f32_16x16x32_bf16 v[16:19], a[88:91], a[176:179], v[16:19]
    s_waitcnt lgkmcnt(7)
    ds_read_b64_tr_b16 a[110:111], v8 offset:20480
    v_xor_b32 v9, 65536, v6
    v_mfma_f32_16x16x32_bf16 v[16:19], a[92:95], a[184:187], v[16:19]
    ds_read_b64_tr_b16 a[64:65], v9 offset:0
    v_mfma_f32_16x16x32_bf16 v[24:27], a[80:83], a[164:167], v[24:27]
    ds_read_b64_tr_b16 a[66:67], v9 offset:4096
    v_mfma_f32_16x16x32_bf16 v[24:27], a[84:87], a[172:175], v[24:27]
    ds_read_b64_tr_b16 a[68:69], v9 offset:16384
    v_mfma_f32_16x16x32_bf16 v[24:27], a[88:91], a[180:183], v[24:27]
    ds_read_b64_tr_b16 a[70:71], v9 offset:20480
    v_xor_b32 v10, 131104, v6
    v_mfma_f32_16x16x32_bf16 v[24:27], a[92:95], a[188:191], v[24:27]
    s_waitcnt lgkmcnt(6)
    ds_read_b64_tr_b16 a[72:73], v10 offset:0
    v_mfma_f32_16x16x32_bf16 v[28:31], a[96:99], a[192:195], v[28:31]
    ds_read_b64_tr_b16 a[74:75], v10 offset:4096
    v_mfma_f32_16x16x32_bf16 v[28:31], a[100:103], a[200:203], v[28:31]
    ds_read_b64_tr_b16 a[76:77], v10 offset:16384
    v_mfma_f32_16x16x32_bf16 v[28:31], a[104:107], a[208:211], v[28:31]
    s_waitcnt lgkmcnt(3)
    ds_read_b64_tr_b16 a[78:79], v10 offset:20480
    v_xor_b32 v7, 32, v6
    v_mfma_f32_16x16x32_bf16 v[28:31], a[108:111], a[216:219], v[28:31]
    ds_read_b64_tr_b16 a[80:81], v7 offset:0
    v_mfma_f32_16x16x32_bf16 v[28:31], a[64:67], a[112:115], v[28:31]
    ds_read_b64_tr_b16 a[82:83], v7 offset:4096
    v_mfma_f32_16x16x32_bf16 v[28:31], a[68:71], a[120:123], v[28:31]
    ds_read_b64_tr_b16 a[84:85], v7 offset:16384
    v_mfma_f32_16x16x32_bf16 v[44:47], a[96:99], a[196:199], v[44:47]
    ds_read_b64_tr_b16 a[86:87], v7 offset:20480
    v_xor_b32 v8, 65568, v6
    v_mfma_f32_16x16x32_bf16 v[44:47], a[100:103], a[204:207], v[44:47]
    ds_read_b64_tr_b16 a[88:89], v8 offset:0
    v_mfma_f32_16x16x32_bf16 v[44:47], a[104:107], a[212:215], v[44:47]
    ds_read_b64_tr_b16 a[90:91], v8 offset:4096
    v_mfma_f32_16x16x32_bf16 v[44:47], a[108:111], a[220:223], v[44:47]
    ds_read_b64_tr_b16 a[92:93], v8 offset:16384
    v_mfma_f32_16x16x32_bf16 v[44:47], a[64:67], a[116:119], v[44:47]
    ds_read_b64_tr_b16 a[94:95], v8 offset:20480
    v_xor_b32 v9, 131136, v6
    v_mfma_f32_16x16x32_bf16 v[44:47], a[68:71], a[124:127], v[44:47]
    s_waitcnt lgkmcnt(6)
    ds_read_b64_tr_b16 a[96:97], v9 offset:0
    v_mfma_f32_16x16x32_bf16 v[52:55], a[72:75], a[192:195], v[52:55]
    ds_read_b64_tr_b16 a[98:99], v9 offset:4096
    v_mfma_f32_16x16x32_bf16 v[52:55], a[76:79], a[200:203], v[52:55]
    ds_read_b64_tr_b16 a[100:101], v9 offset:16384
    v_mfma_f32_16x16x32_bf16 v[52:55], a[80:83], a[208:211], v[52:55]
    s_waitcnt lgkmcnt(3)
    ds_read_b64_tr_b16 a[102:103], v9 offset:20480
    v_xor_b32 v10, 64, v6
    v_mfma_f32_16x16x32_bf16 v[52:55], a[84:87], a[216:219], v[52:55]
    ds_read_b64_tr_b16 a[104:105], v10 offset:0
    v_mfma_f32_16x16x32_bf16 v[52:55], a[88:91], a[112:115], v[52:55]
    ds_read_b64_tr_b16 a[106:107], v10 offset:4096
    v_mfma_f32_16x16x32_bf16 v[52:55], a[92:95], a[120:123], v[52:55]
    ds_read_b64_tr_b16 a[108:109], v10 offset:16384
    v_mfma_f32_16x16x32_bf16 v[60:63], a[72:75], a[196:199], v[60:63]
    ds_read_b64_tr_b16 a[110:111], v10 offset:20480
    v_xor_b32 v7, 65600, v6
    v_mfma_f32_16x16x32_bf16 v[60:63], a[76:79], a[204:207], v[60:63]
    ds_read_b64_tr_b16 a[64:65], v7 offset:0
    v_mfma_f32_16x16x32_bf16 v[60:63], a[80:83], a[212:215], v[60:63]
    ds_read_b64_tr_b16 a[66:67], v7 offset:4096
    v_mfma_f32_16x16x32_bf16 v[60:63], a[84:87], a[220:223], v[60:63]
    ds_read_b64_tr_b16 a[68:69], v7 offset:16384
    v_mfma_f32_16x16x32_bf16 v[60:63], a[88:91], a[116:119], v[60:63]
    ds_read_b64_tr_b16 a[70:71], v7 offset:20480
    v_xor_b32 v8, 131168, v6
    v_mfma_f32_16x16x32_bf16 v[60:63], a[92:95], a[124:127], v[60:63]
    s_waitcnt lgkmcnt(6)
    ds_read_b64_tr_b16 a[72:73], v8 offset:0
    v_mfma_f32_16x16x32_bf16 v[20:23], a[96:99], a[192:195], v[20:23]
    ds_read_b64_tr_b16 a[74:75], v8 offset:4096
    v_mfma_f32_16x16x32_bf16 v[20:23], a[100:103], a[200:203], v[20:23]
    ds_read_b64_tr_b16 a[76:77], v8 offset:16384
    v_mul_f32 v28, s34, v28
    v_mfma_f32_16x16x32_bf16 v[20:23], a[104:107], a[208:211], v[20:23]
    s_waitcnt lgkmcnt(3)
    ds_read_b64_tr_b16 a[78:79], v8 offset:20480
    v_xor_b32 v9, 96, v6
    v_mfma_f32_16x16x32_bf16 v[20:23], a[108:111], a[216:219], v[20:23]
    ds_read_b64_tr_b16 a[80:81], v9 offset:0
    v_mul_f32 v29, s34, v29
    v_mfma_f32_16x16x32_bf16 v[20:23], a[64:67], a[112:115], v[20:23]
    ds_read_b64_tr_b16 a[82:83], v9 offset:4096
    v_mul_f32 v30, s34, v30
    v_mfma_f32_16x16x32_bf16 v[20:23], a[68:71], a[120:123], v[20:23]
    ds_read_b64_tr_b16 a[84:85], v9 offset:16384
    v_mul_f32 v31, s34, v31
    v_mfma_f32_16x16x32_bf16 v[36:39], a[96:99], a[196:199], v[36:39]
    ds_read_b64_tr_b16 a[86:87], v9 offset:20480
    v_xor_b32 v10, 65632, v6
    v_mfma_f32_16x16x32_bf16 v[36:39], a[100:103], a[204:207], v[36:39]
    ds_read_b64_tr_b16 a[88:89], v10 offset:0
    v_mul_f32 v52, s34, v52
    v_mfma_f32_16x16x32_bf16 v[36:39], a[104:107], a[212:215], v[36:39]
    ds_read_b64_tr_b16 a[90:91], v10 offset:4096
    v_mul_f32 v53, s34, v53
    v_mfma_f32_16x16x32_bf16 v[36:39], a[108:111], a[220:223], v[36:39]
    ds_read_b64_tr_b16 a[92:93], v10 offset:16384
    v_mul_f32 v54, s34, v54
    v_mfma_f32_16x16x32_bf16 v[36:39], a[64:67], a[116:119], v[36:39]
    ds_read_b64_tr_b16 a[94:95], v10 offset:20480
    v_xor_b32 v7, 131200, v6
    v_mfma_f32_16x16x32_bf16 v[36:39], a[68:71], a[124:127], v[36:39]
    s_waitcnt lgkmcnt(6)
    ds_read_b64_tr_b16 a[96:97], v7 offset:0
    v_mul_f32 v55, s34, v55
    v_mfma_f32_16x16x32_bf16 v[68:71], a[72:75], a[192:195], v[68:71]
    ds_read_b64_tr_b16 a[98:99], v7 offset:4096
    v_cvt_pk_bf16_f32 v28, v28, v29
    v_mfma_f32_16x16x32_bf16 v[68:71], a[76:79], a[200:203], v[68:71]
    ds_read_b64_tr_b16 a[100:101], v7 offset:16384
    v_cvt_pk_bf16_f32 v29, v30, v31
    v_mfma_f32_16x16x32_bf16 v[68:71], a[80:83], a[208:211], v[68:71]
    s_waitcnt lgkmcnt(3)
    ds_read_b64_tr_b16 a[102:103], v7 offset:20480
    v_xor_b32 v8, 128, v6
    v_mfma_f32_16x16x32_bf16 v[68:71], a[84:87], a[216:219], v[68:71]
    ds_read_b64_tr_b16 a[104:105], v8 offset:0
    v_cvt_pk_bf16_f32 v30, v52, v53
    v_mfma_f32_16x16x32_bf16 v[68:71], a[88:91], a[112:115], v[68:71]
    ds_read_b64_tr_b16 a[106:107], v8 offset:4096
    v_cvt_pk_bf16_f32 v31, v54, v55
    v_mfma_f32_16x16x32_bf16 v[68:71], a[92:95], a[120:123], v[68:71]
    ds_read_b64_tr_b16 a[108:109], v8 offset:16384
    v_accvgpr_write_b32 a0, v28
    v_mfma_f32_16x16x32_bf16 v[76:79], a[72:75], a[196:199], v[76:79]
    ds_read_b64_tr_b16 a[110:111], v8 offset:20480
    v_xor_b32 v9, 65664, v6
    v_mfma_f32_16x16x32_bf16 v[76:79], a[76:79], a[204:207], v[76:79]
    ds_read_b64_tr_b16 a[64:65], v9 offset:0
    v_accvgpr_write_b32 a1, v29
    v_mfma_f32_16x16x32_bf16 v[76:79], a[80:83], a[212:215], v[76:79]
    ds_read_b64_tr_b16 a[66:67], v9 offset:4096
    v_accvgpr_write_b32 a2, v30
    v_mfma_f32_16x16x32_bf16 v[76:79], a[84:87], a[220:223], v[76:79]
    s_waitcnt vmcnt(0)
    ds_read_b64_tr_b16 a[68:69], v9 offset:16384
    v_accvgpr_write_b32 a3, v31
    v_mfma_f32_16x16x32_bf16 v[76:79], a[88:91], a[116:119], v[76:79]
    s_barrier
    ds_read_b64_tr_b16 a[70:71], v9 offset:20480
    v_xor_b32 v10, 131232, v6
    v_mfma_f32_16x16x32_bf16 v[76:79], a[92:95], a[124:127], v[76:79]
    s_waitcnt lgkmcnt(6)
    ds_read_b64_tr_b16 a[72:73], v10 offset:0
    buffer_store_dword v11, v11, s[12:15], s92 offen sc1
    v_mfma_f32_16x16x32_bf16 v[84:87], a[96:99], a[192:195], v[84:87]
    ds_read_b64_tr_b16 a[74:75], v10 offset:4096
    v_mul_f32 v44, s34, v44
    v_mfma_f32_16x16x32_bf16 v[84:87], a[100:103], a[200:203], v[84:87]
    ds_read_b64_tr_b16 a[76:77], v10 offset:16384
    v_mul_f32 v45, s34, v45
    v_mfma_f32_16x16x32_bf16 v[84:87], a[104:107], a[208:211], v[84:87]
    s_waitcnt lgkmcnt(3)
    ds_read_b64_tr_b16 a[78:79], v10 offset:20480
    v_xor_b32 v7, 160, v6
    v_mfma_f32_16x16x32_bf16 v[84:87], a[108:111], a[216:219], v[84:87]
    ds_read_b64_tr_b16 a[80:81], v7 offset:0
    v_mul_f32 v46, s34, v46
    v_mfma_f32_16x16x32_bf16 v[84:87], a[64:67], a[112:115], v[84:87]
    ds_read_b64_tr_b16 a[82:83], v7 offset:4096
    v_mul_f32 v47, s34, v47
    v_mfma_f32_16x16x32_bf16 v[84:87], a[68:71], a[120:123], v[84:87]
    ds_read_b64_tr_b16 a[84:85], v7 offset:16384
    v_mul_f32 v60, s34, v60
    v_mfma_f32_16x16x32_bf16 v[92:95], a[96:99], a[196:199], v[92:95]
    ds_read_b64_tr_b16 a[86:87], v7 offset:20480
    v_xor_b32 v8, 65696, v6
    v_mfma_f32_16x16x32_bf16 v[92:95], a[100:103], a[204:207], v[92:95]
    ds_read_b64_tr_b16 a[88:89], v8 offset:0
    v_mul_f32 v61, s34, v61
    v_mfma_f32_16x16x32_bf16 v[92:95], a[104:107], a[212:215], v[92:95]
    ds_read_b64_tr_b16 a[90:91], v8 offset:4096
    v_mul_f32 v62, s34, v62
    v_mfma_f32_16x16x32_bf16 v[92:95], a[108:111], a[220:223], v[92:95]
    ds_read_b64_tr_b16 a[92:93], v8 offset:16384
    v_mul_f32 v63, s34, v63
    v_mfma_f32_16x16x32_bf16 v[92:95], a[64:67], a[116:119], v[92:95]
    ds_read_b64_tr_b16 a[94:95], v8 offset:20480
    v_xor_b32 v9, 131264, v6
    v_mfma_f32_16x16x32_bf16 v[92:95], a[68:71], a[124:127], v[92:95]
    s_waitcnt lgkmcnt(6)
    ds_read_b64_tr_b16 a[96:97], v9 offset:0
    v_cvt_pk_bf16_f32 v44, v44, v45
    v_mfma_f32_16x16x32_bf16 v[100:103], a[72:75], a[192:195], v[100:103]
    ds_read_b64_tr_b16 a[98:99], v9 offset:4096
    v_cvt_pk_bf16_f32 v45, v46, v47
    v_mfma_f32_16x16x32_bf16 v[100:103], a[76:79], a[200:203], v[100:103]
    ds_read_b64_tr_b16 a[100:101], v9 offset:16384
    v_cvt_pk_bf16_f32 v46, v60, v61
    v_mfma_f32_16x16x32_bf16 v[100:103], a[80:83], a[208:211], v[100:103]
    s_waitcnt lgkmcnt(3)
    ds_read_b64_tr_b16 a[102:103], v9 offset:20480
    v_xor_b32 v10, 192, v6
    v_mfma_f32_16x16x32_bf16 v[100:103], a[84:87], a[216:219], v[100:103]
    ds_read_b64_tr_b16 a[104:105], v10 offset:0
    v_cvt_pk_bf16_f32 v47, v62, v63
    v_mfma_f32_16x16x32_bf16 v[100:103], a[88:91], a[112:115], v[100:103]
    ds_read_b64_tr_b16 a[106:107], v10 offset:4096
    v_accvgpr_write_b32 a32, v44
    v_mfma_f32_16x16x32_bf16 v[100:103], a[92:95], a[120:123], v[100:103]
    ds_read_b64_tr_b16 a[108:109], v10 offset:16384
    v_accvgpr_write_b32 a33, v45
    v_mfma_f32_16x16x32_bf16 v[108:111], a[72:75], a[196:199], v[108:111]
    ds_read_b64_tr_b16 a[110:111], v10 offset:20480
    v_xor_b32 v7, 65728, v6
    v_mfma_f32_16x16x32_bf16 v[108:111], a[76:79], a[204:207], v[108:111]
    ds_read_b64_tr_b16 a[64:65], v7 offset:0
    v_accvgpr_write_b32 a34, v46
    v_mfma_f32_16x16x32_bf16 v[108:111], a[80:83], a[212:215], v[108:111]
    ds_read_b64_tr_b16 a[66:67], v7 offset:4096
    v_accvgpr_write_b32 a35, v47
    v_mfma_f32_16x16x32_bf16 v[108:111], a[84:87], a[220:223], v[108:111]
    ds_read_b64_tr_b16 a[68:69], v7 offset:16384
    v_mul_f32 v20, s34, v20
    v_mfma_f32_16x16x32_bf16 v[108:111], a[88:91], a[116:119], v[108:111]
    ds_read_b64_tr_b16 a[70:71], v7 offset:20480
    v_xor_b32 v8, 131296, v6
    v_mfma_f32_16x16x32_bf16 v[108:111], a[92:95], a[124:127], v[108:111]
    s_waitcnt lgkmcnt(6)
    ds_read_b64_tr_b16 a[72:73], v8 offset:0
    v_mul_f32 v21, s34, v21
    v_mfma_f32_16x16x32_bf16 v[116:119], a[96:99], a[192:195], v[116:119]
    ds_read_b64_tr_b16 a[74:75], v8 offset:4096
    v_mul_f32 v22, s34, v22
    v_mfma_f32_16x16x32_bf16 v[116:119], a[100:103], a[200:203], v[116:119]
    ds_read_b64_tr_b16 a[76:77], v8 offset:16384
    v_mul_f32 v23, s34, v23
    v_mfma_f32_16x16x32_bf16 v[116:119], a[104:107], a[208:211], v[116:119]
    s_waitcnt lgkmcnt(3)
    ds_read_b64_tr_b16 a[78:79], v8 offset:20480
    v_xor_b32 v9, 224, v6
    v_mfma_f32_16x16x32_bf16 v[116:119], a[108:111], a[216:219], v[116:119]
    ds_read_b64_tr_b16 a[80:81], v9 offset:0
    v_mul_f32 v68, s34, v68
    v_mfma_f32_16x16x32_bf16 v[116:119], a[64:67], a[112:115], v[116:119]
    ds_read_b64_tr_b16 a[82:83], v9 offset:4096
    v_mul_f32 v69, s34, v69
    v_mfma_f32_16x16x32_bf16 v[116:119], a[68:71], a[120:123], v[116:119]
    ds_read_b64_tr_b16 a[84:85], v9 offset:16384
    v_mul_f32 v70, s34, v70
    v_mfma_f32_16x16x32_bf16 v[124:127], a[96:99], a[196:199], v[124:127]
    ds_read_b64_tr_b16 a[86:87], v9 offset:20480
    v_xor_b32 v10, 65760, v6
    v_mfma_f32_16x16x32_bf16 v[124:127], a[100:103], a[204:207], v[124:127]
    ds_read_b64_tr_b16 a[88:89], v10 offset:0
    v_mul_f32 v71, s34, v71
    v_mfma_f32_16x16x32_bf16 v[124:127], a[104:107], a[212:215], v[124:127]
    ds_read_b64_tr_b16 a[90:91], v10 offset:4096
    v_cvt_pk_bf16_f32 v20, v20, v21
    v_mfma_f32_16x16x32_bf16 v[124:127], a[108:111], a[220:223], v[124:127]
    ds_read_b64_tr_b16 a[92:93], v10 offset:16384
    v_cvt_pk_bf16_f32 v21, v22, v23
    v_mfma_f32_16x16x32_bf16 v[124:127], a[64:67], a[116:119], v[124:127]
    ds_read_b64_tr_b16 a[94:95], v10 offset:20480
    v_xor_b32 v7, 131328, v6
    v_mfma_f32_16x16x32_bf16 v[124:127], a[68:71], a[124:127], v[124:127]
    s_waitcnt lgkmcnt(6)
    ds_read_b64_tr_b16 a[96:97], v7 offset:0
    v_cvt_pk_bf16_f32 v22, v68, v69
    v_mfma_f32_16x16x32_bf16 v[132:135], a[72:75], a[192:195], v[132:135]
    ds_read_b64_tr_b16 a[98:99], v7 offset:4096
    buffer_load_dwordx4 v[32:35], v122, s[4:7], 0 offen
    v_mfma_f32_16x16x32_bf16 v[132:135], a[76:79], a[200:203], v[132:135]
    ds_read_b64_tr_b16 a[100:101], v7 offset:16384
    v_cvt_pk_bf16_f32 v23, v70, v71
    v_mfma_f32_16x16x32_bf16 v[132:135], a[80:83], a[208:211], v[132:135]
    s_waitcnt lgkmcnt(3)
    ds_read_b64_tr_b16 a[102:103], v7 offset:20480
    v_xor_b32 v8, 256, v6
    v_mfma_f32_16x16x32_bf16 v[132:135], a[84:87], a[216:219], v[132:135]
    ds_read_b64_tr_b16 a[104:105], v8 offset:0
    v_accvgpr_write_b32 a4, v20
    v_mfma_f32_16x16x32_bf16 v[132:135], a[88:91], a[112:115], v[132:135]
    ds_read_b64_tr_b16 a[106:107], v8 offset:4096
    buffer_load_dwordx4 v[40:43], v123, s[4:7], 0 offen
    v_mfma_f32_16x16x32_bf16 v[132:135], a[92:95], a[120:123], v[132:135]
    ds_read_b64_tr_b16 a[108:109], v8 offset:16384
    v_accvgpr_write_b32 a5, v21
    v_mfma_f32_16x16x32_bf16 v[140:143], a[72:75], a[196:199], v[140:143]
    ds_read_b64_tr_b16 a[110:111], v8 offset:20480
    v_xor_b32 v9, 65792, v6
    v_mfma_f32_16x16x32_bf16 v[140:143], a[76:79], a[204:207], v[140:143]
    ds_read_b64_tr_b16 a[64:65], v9 offset:0
    v_accvgpr_write_b32 a6, v22
    v_mfma_f32_16x16x32_bf16 v[140:143], a[80:83], a[212:215], v[140:143]
    ds_read_b64_tr_b16 a[66:67], v9 offset:4096
    buffer_load_dwordx4 v[48:51], v128, s[4:7], 0 offen
    v_mfma_f32_16x16x32_bf16 v[140:143], a[84:87], a[220:223], v[140:143]
    ds_read_b64_tr_b16 a[68:69], v9 offset:16384
    v_accvgpr_write_b32 a7, v23
    v_mfma_f32_16x16x32_bf16 v[140:143], a[88:91], a[116:119], v[140:143]
    ds_read_b64_tr_b16 a[70:71], v9 offset:20480
    v_xor_b32 v10, 131360, v6
    v_mfma_f32_16x16x32_bf16 v[140:143], a[92:95], a[124:127], v[140:143]
    s_waitcnt lgkmcnt(6)
    ds_read_b64_tr_b16 a[72:73], v10 offset:0
    v_mul_f32 v36, s34, v36
    v_mfma_f32_16x16x32_bf16 v[148:151], a[96:99], a[192:195], v[148:151]
    ds_read_b64_tr_b16 a[74:75], v10 offset:4096
    buffer_load_dwordx4 v[56:59], v120, s[4:7], 0 offen offset:0
    v_mfma_f32_16x16x32_bf16 v[148:151], a[100:103], a[200:203], v[148:151]
    ds_read_b64_tr_b16 a[76:77], v10 offset:16384
    v_mul_f32 v37, s34, v37
    v_mfma_f32_16x16x32_bf16 v[148:151], a[104:107], a[208:211], v[148:151]
    s_waitcnt lgkmcnt(3)
    ds_read_b64_tr_b16 a[78:79], v10 offset:20480
    v_xor_b32 v7, 288, v6
    v_mfma_f32_16x16x32_bf16 v[148:151], a[108:111], a[216:219], v[148:151]
    ds_read_b64_tr_b16 a[80:81], v7 offset:0
    v_mul_f32 v38, s34, v38
    v_mfma_f32_16x16x32_bf16 v[148:151], a[64:67], a[112:115], v[148:151]
    ds_read_b64_tr_b16 a[82:83], v7 offset:4096
    buffer_load_dwordx4 v[64:67], v120, s[4:7], 0 offen offset:896
    v_mfma_f32_16x16x32_bf16 v[148:151], a[68:71], a[120:123], v[148:151]
    ds_read_b64_tr_b16 a[84:85], v7 offset:16384
    v_mul_f32 v39, s34, v39
    v_mfma_f32_16x16x32_bf16 v[156:159], a[96:99], a[196:199], v[156:159]
    ds_read_b64_tr_b16 a[86:87], v7 offset:20480
    v_xor_b32 v8, 65824, v6
    v_mfma_f32_16x16x32_bf16 v[156:159], a[100:103], a[204:207], v[156:159]
    ds_read_b64_tr_b16 a[88:89], v8 offset:0
    v_mul_f32 v76, s34, v76
    v_mfma_f32_16x16x32_bf16 v[156:159], a[104:107], a[212:215], v[156:159]
    ds_read_b64_tr_b16 a[90:91], v8 offset:4096
    buffer_load_dwordx4 v[72:75], v120, s[8:11], 0 offen offset:0
    v_mfma_f32_16x16x32_bf16 v[156:159], a[108:111], a[220:223], v[156:159]
    ds_read_b64_tr_b16 a[92:93], v8 offset:16384
    v_mul_f32 v77, s34, v77
    v_mfma_f32_16x16x32_bf16 v[156:159], a[64:67], a[116:119], v[156:159]
    ds_read_b64_tr_b16 a[94:95], v8 offset:20480
    v_xor_b32 v9, 131392, v6
    v_mfma_f32_16x16x32_bf16 v[156:159], a[68:71], a[124:127], v[156:159]
    s_waitcnt lgkmcnt(6)
    ds_read_b64_tr_b16 a[96:97], v9 offset:0
    v_mul_f32 v78, s34, v78
    v_mfma_f32_16x16x32_bf16 v[164:167], a[72:75], a[192:195], v[164:167]
    ds_read_b64_tr_b16 a[98:99], v9 offset:4096
    buffer_load_dwordx4 v[80:83], v120, s[8:11], 0 offen offset:896
    v_mfma_f32_16x16x32_bf16 v[164:167], a[76:79], a[200:203], v[164:167]
    ds_read_b64_tr_b16 a[100:101], v9 offset:16384
    v_mul_f32 v79, s34, v79
    v_mfma_f32_16x16x32_bf16 v[164:167], a[80:83], a[208:211], v[164:167]
    s_waitcnt lgkmcnt(3)
    ds_read_b64_tr_b16 a[102:103], v9 offset:20480
    v_xor_b32 v10, 320, v6
    v_mfma_f32_16x16x32_bf16 v[164:167], a[84:87], a[216:219], v[164:167]
    ds_read_b64_tr_b16 a[104:105], v10 offset:0
    v_cvt_pk_bf16_f32 v36, v36, v37
    v_mfma_f32_16x16x32_bf16 v[164:167], a[88:91], a[112:115], v[164:167]
    ds_read_b64_tr_b16 a[106:107], v10 offset:4096
    buffer_load_dwordx4 v[88:91], v121, s[20:23], s39 offen offset:0
    v_mfma_f32_16x16x32_bf16 v[164:167], a[92:95], a[120:123], v[164:167]
    ds_read_b64_tr_b16 a[108:109], v10 offset:16384
    v_cvt_pk_bf16_f32 v37, v38, v39
    v_mfma_f32_16x16x32_bf16 v[172:175], a[72:75], a[196:199], v[172:175]
    ds_read_b64_tr_b16 a[110:111], v10 offset:20480
    v_xor_b32 v7, 65856, v6
    v_mfma_f32_16x16x32_bf16 v[172:175], a[76:79], a[204:207], v[172:175]
    ds_read_b64_tr_b16 a[64:65], v7 offset:0
    v_cvt_pk_bf16_f32 v38, v76, v77
    v_mfma_f32_16x16x32_bf16 v[172:175], a[80:83], a[212:215], v[172:175]
    ds_read_b64_tr_b16 a[66:67], v7 offset:4096
    buffer_load_dwordx4 v[96:99], v121, s[20:23], s39 offen offset:16
    v_mfma_f32_16x16x32_bf16 v[172:175], a[84:87], a[220:223], v[172:175]
    ds_read_b64_tr_b16 a[68:69], v7 offset:16384
    v_cvt_pk_bf16_f32 v39, v78, v79
    v_mfma_f32_16x16x32_bf16 v[172:175], a[88:91], a[116:119], v[172:175]
    ds_read_b64_tr_b16 a[70:71], v7 offset:20480
    v_xor_b32 v8, 131424, v6
    v_mfma_f32_16x16x32_bf16 v[172:175], a[92:95], a[124:127], v[172:175]
    s_waitcnt lgkmcnt(6)
    ds_read_b64_tr_b16 a[72:73], v8 offset:0
    v_accvgpr_write_b32 a36, v36
    v_mfma_f32_16x16x32_bf16 v[180:183], a[96:99], a[192:195], v[180:183]
    ds_read_b64_tr_b16 a[74:75], v8 offset:4096
    buffer_load_dwordx4 v[104:107], v121, s[20:23], s39 offen offset:32
    v_mfma_f32_16x16x32_bf16 v[180:183], a[100:103], a[200:203], v[180:183]
    ds_read_b64_tr_b16 a[76:77], v8 offset:16384
    v_accvgpr_write_b32 a37, v37
    v_mfma_f32_16x16x32_bf16 v[180:183], a[104:107], a[208:211], v[180:183]
    s_waitcnt lgkmcnt(3)
    ds_read_b64_tr_b16 a[78:79], v8 offset:20480
    v_xor_b32 v9, 352, v6
    v_mfma_f32_16x16x32_bf16 v[180:183], a[108:111], a[216:219], v[180:183]
    ds_read_b64_tr_b16 a[80:81], v9 offset:0
    v_accvgpr_write_b32 a38, v38
    v_mfma_f32_16x16x32_bf16 v[180:183], a[64:67], a[112:115], v[180:183]
    ds_read_b64_tr_b16 a[82:83], v9 offset:4096
    buffer_load_dwordx4 v[112:115], v121, s[20:23], s39 offen offset:48
    v_mfma_f32_16x16x32_bf16 v[180:183], a[68:71], a[120:123], v[180:183]
    ds_read_b64_tr_b16 a[84:85], v9 offset:16384
    v_accvgpr_write_b32 a39, v39
    v_mfma_f32_16x16x32_bf16 v[188:191], a[96:99], a[196:199], v[188:191]
    ds_read_b64_tr_b16 a[86:87], v9 offset:20480
    v_xor_b32 v10, 65888, v6
    v_mfma_f32_16x16x32_bf16 v[188:191], a[100:103], a[204:207], v[188:191]
    ds_read_b64_tr_b16 a[88:89], v10 offset:0
    v_mul_f32 v84, s34, v84
    v_mfma_f32_16x16x32_bf16 v[188:191], a[104:107], a[212:215], v[188:191]
    ds_read_b64_tr_b16 a[90:91], v10 offset:4096
    v_mul_f32 v85, s34, v85
    v_mfma_f32_16x16x32_bf16 v[188:191], a[108:111], a[220:223], v[188:191]
    ds_read_b64_tr_b16 a[92:93], v10 offset:16384
    v_mul_f32 v86, s34, v86
    v_mfma_f32_16x16x32_bf16 v[188:191], a[64:67], a[116:119], v[188:191]
    ds_read_b64_tr_b16 a[94:95], v10 offset:20480
    v_xor_b32 v7, 131456, v6
    v_mfma_f32_16x16x32_bf16 v[188:191], a[68:71], a[124:127], v[188:191]
    s_waitcnt lgkmcnt(6)
    ds_read_b64_tr_b16 a[96:97], v7 offset:0
    v_mul_f32 v87, s34, v87
    v_mfma_f32_16x16x32_bf16 v[196:199], a[72:75], a[192:195], v[196:199]
    ds_read_b64_tr_b16 a[98:99], v7 offset:4096
    v_mul_f32 v100, s34, v100
    v_mfma_f32_16x16x32_bf16 v[196:199], a[76:79], a[200:203], v[196:199]
    ds_read_b64_tr_b16 a[100:101], v7 offset:16384
    v_mul_f32 v101, s34, v101
    v_mfma_f32_16x16x32_bf16 v[196:199], a[80:83], a[208:211], v[196:199]
    s_waitcnt lgkmcnt(3)
    ds_read_b64_tr_b16 a[102:103], v7 offset:20480
    v_xor_b32 v8, 384, v6
    v_mfma_f32_16x16x32_bf16 v[196:199], a[84:87], a[216:219], v[196:199]
    ds_read_b64_tr_b16 a[104:105], v8 offset:0
    v_mul_f32 v102, s34, v102
    v_mfma_f32_16x16x32_bf16 v[196:199], a[88:91], a[112:115], v[196:199]
    ds_read_b64_tr_b16 a[106:107], v8 offset:4096
    v_mul_f32 v103, s34, v103
    v_mfma_f32_16x16x32_bf16 v[196:199], a[92:95], a[120:123], v[196:199]
    ds_read_b64_tr_b16 a[108:109], v8 offset:16384
    v_cvt_pk_bf16_f32 v84, v84, v85
    v_mfma_f32_16x16x32_bf16 v[204:207], a[72:75], a[196:199], v[204:207]
    ds_read_b64_tr_b16 a[110:111], v8 offset:20480
    v_xor_b32 v9, 65920, v6
    v_mfma_f32_16x16x32_bf16 v[204:207], a[76:79], a[204:207], v[204:207]
    ds_read_b64_tr_b16 a[64:65], v9 offset:0
    v_cvt_pk_bf16_f32 v85, v86, v87
    v_mfma_f32_16x16x32_bf16 v[204:207], a[80:83], a[212:215], v[204:207]
    ds_read_b64_tr_b16 a[66:67], v9 offset:4096
    v_cvt_pk_bf16_f32 v86, v100, v101
    v_mfma_f32_16x16x32_bf16 v[204:207], a[84:87], a[220:223], v[204:207]
    ds_read_b64_tr_b16 a[68:69], v9 offset:16384
    v_cvt_pk_bf16_f32 v87, v102, v103
    v_mfma_f32_16x16x32_bf16 v[204:207], a[88:91], a[116:119], v[204:207]
    ds_read_b64_tr_b16 a[70:71], v9 offset:20480
    v_xor_b32 v10, 131488, v6
    v_mfma_f32_16x16x32_bf16 v[204:207], a[92:95], a[124:127], v[204:207]
    s_waitcnt lgkmcnt(6)
    ds_read_b64_tr_b16 a[72:73], v10 offset:0
    v_accvgpr_write_b32 a8, v84
    v_mfma_f32_16x16x32_bf16 v[212:215], a[96:99], a[192:195], v[212:215]
    ds_read_b64_tr_b16 a[74:75], v10 offset:4096
    v_accvgpr_write_b32 a9, v85
    v_mfma_f32_16x16x32_bf16 v[212:215], a[100:103], a[200:203], v[212:215]
    ds_read_b64_tr_b16 a[76:77], v10 offset:16384
    v_accvgpr_write_b32 a10, v86
    v_mfma_f32_16x16x32_bf16 v[212:215], a[104:107], a[208:211], v[212:215]
    s_waitcnt lgkmcnt(3)
    ds_read_b64_tr_b16 a[78:79], v10 offset:20480
    v_xor_b32 v7, 416, v6
    v_mfma_f32_16x16x32_bf16 v[212:215], a[108:111], a[216:219], v[212:215]
    ds_read_b64_tr_b16 a[80:81], v7 offset:0
    v_accvgpr_write_b32 a11, v87
    v_mfma_f32_16x16x32_bf16 v[212:215], a[64:67], a[112:115], v[212:215]
    ds_read_b64_tr_b16 a[82:83], v7 offset:4096
    v_mul_f32 v92, s34, v92
    v_mfma_f32_16x16x32_bf16 v[212:215], a[68:71], a[120:123], v[212:215]
    ds_read_b64_tr_b16 a[84:85], v7 offset:16384
    v_mul_f32 v93, s34, v93
    v_mfma_f32_16x16x32_bf16 v[220:223], a[96:99], a[196:199], v[220:223]
    ds_read_b64_tr_b16 a[86:87], v7 offset:20480
    v_xor_b32 v8, 65952, v6
    v_mfma_f32_16x16x32_bf16 v[220:223], a[100:103], a[204:207], v[220:223]
    ds_read_b64_tr_b16 a[88:89], v8 offset:0
    v_mul_f32 v94, s34, v94
    v_mfma_f32_16x16x32_bf16 v[220:223], a[104:107], a[212:215], v[220:223]
    ds_read_b64_tr_b16 a[90:91], v8 offset:4096
    v_mul_f32 v95, s34, v95
    v_mfma_f32_16x16x32_bf16 v[220:223], a[108:111], a[220:223], v[220:223]
    ds_read_b64_tr_b16 a[92:93], v8 offset:16384
    v_mul_f32 v108, s34, v108
    v_mfma_f32_16x16x32_bf16 v[220:223], a[64:67], a[116:119], v[220:223]
    ds_read_b64_tr_b16 a[94:95], v8 offset:20480
    v_xor_b32 v9, 131520, v6
    v_mfma_f32_16x16x32_bf16 v[220:223], a[68:71], a[124:127], v[220:223]
    s_waitcnt lgkmcnt(6)
    ds_read_b64_tr_b16 a[96:97], v9 offset:0
    v_mul_f32 v109, s34, v109
    v_mfma_f32_16x16x32_bf16 v[228:231], a[72:75], a[192:195], v[228:231]
    ds_read_b64_tr_b16 a[98:99], v9 offset:4096
    v_mul_f32 v110, s34, v110
    v_mfma_f32_16x16x32_bf16 v[228:231], a[76:79], a[200:203], v[228:231]
    ds_read_b64_tr_b16 a[100:101], v9 offset:16384
    v_mul_f32 v111, s34, v111
    v_mfma_f32_16x16x32_bf16 v[228:231], a[80:83], a[208:211], v[228:231]
    s_waitcnt lgkmcnt(3)
    ds_read_b64_tr_b16 a[102:103], v9 offset:20480
    v_xor_b32 v10, 448, v6
    v_mfma_f32_16x16x32_bf16 v[228:231], a[84:87], a[216:219], v[228:231]
    ds_read_b64_tr_b16 a[104:105], v10 offset:0
    v_cvt_pk_bf16_f32 v92, v92, v93
    v_mfma_f32_16x16x32_bf16 v[228:231], a[88:91], a[112:115], v[228:231]
    ds_read_b64_tr_b16 a[106:107], v10 offset:4096
    v_cvt_pk_bf16_f32 v93, v94, v95
    v_mfma_f32_16x16x32_bf16 v[228:231], a[92:95], a[120:123], v[228:231]
    ds_read_b64_tr_b16 a[108:109], v10 offset:16384
    v_cvt_pk_bf16_f32 v94, v108, v109
    v_mfma_f32_16x16x32_bf16 v[236:239], a[72:75], a[196:199], v[236:239]
    ds_read_b64_tr_b16 a[110:111], v10 offset:20480
    v_xor_b32 v7, 65984, v6
    v_mfma_f32_16x16x32_bf16 v[236:239], a[76:79], a[204:207], v[236:239]
    ds_read_b64_tr_b16 a[64:65], v7 offset:0
    v_cvt_pk_bf16_f32 v95, v110, v111
    v_mfma_f32_16x16x32_bf16 v[236:239], a[80:83], a[212:215], v[236:239]
    ds_read_b64_tr_b16 a[66:67], v7 offset:4096
    v_accvgpr_write_b32 a40, v92
    v_mfma_f32_16x16x32_bf16 v[236:239], a[84:87], a[220:223], v[236:239]
    ds_read_b64_tr_b16 a[68:69], v7 offset:16384
    v_accvgpr_write_b32 a41, v93
    v_mfma_f32_16x16x32_bf16 v[236:239], a[88:91], a[116:119], v[236:239]
    ds_read_b64_tr_b16 a[70:71], v7 offset:20480
    v_xor_b32 v8, 131552, v6
    v_mfma_f32_16x16x32_bf16 v[236:239], a[92:95], a[124:127], v[236:239]
    s_waitcnt lgkmcnt(6)
    ds_read_b64_tr_b16 a[72:73], v8 offset:0
    v_accvgpr_write_b32 a42, v94
    v_mfma_f32_16x16x32_bf16 v[244:247], a[96:99], a[192:195], v[244:247]
    ds_read_b64_tr_b16 a[74:75], v8 offset:4096
    v_accvgpr_write_b32 a43, v95
    v_mfma_f32_16x16x32_bf16 v[244:247], a[100:103], a[200:203], v[244:247]
    ds_read_b64_tr_b16 a[76:77], v8 offset:16384
    v_mfma_f32_16x16x32_bf16 v[244:247], a[104:107], a[208:211], v[244:247]
    s_waitcnt lgkmcnt(3)
    ds_read_b64_tr_b16 a[78:79], v8 offset:20480
    v_xor_b32 v9, 480, v6
    v_mfma_f32_16x16x32_bf16 v[244:247], a[108:111], a[216:219], v[244:247]
    ds_read_b64_tr_b16 a[80:81], v9 offset:0
    v_mfma_f32_16x16x32_bf16 v[244:247], a[64:67], a[112:115], v[244:247]
    ds_read_b64_tr_b16 a[82:83], v9 offset:4096
    v_mfma_f32_16x16x32_bf16 v[244:247], a[68:71], a[120:123], v[244:247]
    ds_read_b64_tr_b16 a[84:85], v9 offset:16384
    v_mfma_f32_16x16x32_bf16 v[252:255], a[96:99], a[196:199], v[252:255]
    ds_read_b64_tr_b16 a[86:87], v9 offset:20480
    v_xor_b32 v10, 66016, v6
    v_mfma_f32_16x16x32_bf16 v[252:255], a[100:103], a[204:207], v[252:255]
    ds_read_b64_tr_b16 a[88:89], v10 offset:0
    v_mfma_f32_16x16x32_bf16 v[252:255], a[104:107], a[212:215], v[252:255]
    ds_read_b64_tr_b16 a[90:91], v10 offset:4096
    v_mfma_f32_16x16x32_bf16 v[252:255], a[108:111], a[220:223], v[252:255]
    ds_read_b64_tr_b16 a[92:93], v10 offset:16384
    v_mfma_f32_16x16x32_bf16 v[252:255], a[64:67], a[116:119], v[252:255]
    ds_read_b64_tr_b16 a[94:95], v10 offset:20480
    v_mfma_f32_16x16x32_bf16 v[252:255], a[68:71], a[124:127], v[252:255]
    s_waitcnt lgkmcnt(6)
    v_mfma_f32_16x16x32_bf16 v[16:19], a[72:75], a[192:195], v[16:19]
    v_mfma_f32_16x16x32_bf16 v[16:19], a[76:79], a[200:203], v[16:19]
    v_mfma_f32_16x16x32_bf16 v[16:19], a[80:83], a[208:211], v[16:19]
    s_waitcnt lgkmcnt(0)
    v_mfma_f32_16x16x32_bf16 v[16:19], a[84:87], a[216:219], v[16:19]
    v_mfma_f32_16x16x32_bf16 v[16:19], a[88:91], a[112:115], v[16:19]
    v_mfma_f32_16x16x32_bf16 v[16:19], a[92:95], a[120:123], v[16:19]
    v_mfma_f32_16x16x32_bf16 v[24:27], a[72:75], a[196:199], v[24:27]
    v_mfma_f32_16x16x32_bf16 v[24:27], a[76:79], a[204:207], v[24:27]
    v_mfma_f32_16x16x32_bf16 v[24:27], a[80:83], a[212:215], v[24:27]
    v_mfma_f32_16x16x32_bf16 v[24:27], a[84:87], a[220:223], v[24:27]
    s_waitcnt lgkmcnt(0)
    v_mfma_f32_16x16x32_bf16 v[24:27], a[88:91], a[116:119], v[24:27]
    s_barrier
    v_mfma_f32_16x16x32_bf16 v[24:27], a[92:95], a[124:127], v[24:27]
    s_nop 3
    v_pk_mul_f32 v[116:117], v[116:117], s[34:35]
    v_pk_mul_f32 v[118:119], v[118:119], s[34:35]
    v_pk_mul_f32 v[132:133], v[132:133], s[34:35]
    v_pk_mul_f32 v[134:135], v[134:135], s[34:35]
    v_cvt_pk_bf16_f32 v116, v116, v117
    v_cvt_pk_bf16_f32 v117, v118, v119
    v_cvt_pk_bf16_f32 v118, v132, v133
    v_cvt_pk_bf16_f32 v119, v134, v135
    v_accvgpr_write_b32 a12, v116
    v_accvgpr_write_b32 a13, v117
    v_accvgpr_write_b32 a14, v118
    v_accvgpr_write_b32 a15, v119
    v_pk_mul_f32 v[124:125], v[124:125], s[34:35]
    v_pk_mul_f32 v[126:127], v[126:127], s[34:35]
    v_pk_mul_f32 v[140:141], v[140:141], s[34:35]
    v_pk_mul_f32 v[142:143], v[142:143], s[34:35]
    v_cvt_pk_bf16_f32 v124, v124, v125
    v_cvt_pk_bf16_f32 v125, v126, v127
    v_cvt_pk_bf16_f32 v126, v140, v141
    v_cvt_pk_bf16_f32 v127, v142, v143
    v_accvgpr_write_b32 a44, v124
    v_accvgpr_write_b32 a45, v125
    v_accvgpr_write_b32 a46, v126
    v_accvgpr_write_b32 a47, v127
    v_pk_mul_f32 v[148:149], v[148:149], s[34:35]
    v_pk_mul_f32 v[150:151], v[150:151], s[34:35]
    v_pk_mul_f32 v[164:165], v[164:165], s[34:35]
    v_pk_mul_f32 v[166:167], v[166:167], s[34:35]
    v_cvt_pk_bf16_f32 v148, v148, v149
    v_cvt_pk_bf16_f32 v149, v150, v151
    v_cvt_pk_bf16_f32 v150, v164, v165
    v_cvt_pk_bf16_f32 v151, v166, v167
    v_accvgpr_write_b32 a16, v148
    v_accvgpr_write_b32 a17, v149
    v_accvgpr_write_b32 a18, v150
    v_accvgpr_write_b32 a19, v151
    v_pk_mul_f32 v[156:157], v[156:157], s[34:35]
    v_pk_mul_f32 v[158:159], v[158:159], s[34:35]
    v_pk_mul_f32 v[172:173], v[172:173], s[34:35]
    v_pk_mul_f32 v[174:175], v[174:175], s[34:35]
    v_cvt_pk_bf16_f32 v156, v156, v157
    v_cvt_pk_bf16_f32 v157, v158, v159
    v_cvt_pk_bf16_f32 v158, v172, v173
    v_cvt_pk_bf16_f32 v159, v174, v175
    v_accvgpr_write_b32 a48, v156
    v_accvgpr_write_b32 a49, v157
    v_accvgpr_write_b32 a50, v158
    v_accvgpr_write_b32 a51, v159
    v_pk_mul_f32 v[180:181], v[180:181], s[34:35]
    v_pk_mul_f32 v[182:183], v[182:183], s[34:35]
    v_pk_mul_f32 v[196:197], v[196:197], s[34:35]
    v_pk_mul_f32 v[198:199], v[198:199], s[34:35]
    v_cvt_pk_bf16_f32 v180, v180, v181
    v_cvt_pk_bf16_f32 v181, v182, v183
    v_cvt_pk_bf16_f32 v182, v196, v197
    v_cvt_pk_bf16_f32 v183, v198, v199
    v_accvgpr_write_b32 a20, v180
    v_accvgpr_write_b32 a21, v181
    v_accvgpr_write_b32 a22, v182
    v_accvgpr_write_b32 a23, v183
    v_pk_mul_f32 v[188:189], v[188:189], s[34:35]
    v_pk_mul_f32 v[190:191], v[190:191], s[34:35]
    v_pk_mul_f32 v[204:205], v[204:205], s[34:35]
    v_pk_mul_f32 v[206:207], v[206:207], s[34:35]
    v_cvt_pk_bf16_f32 v188, v188, v189
    v_cvt_pk_bf16_f32 v189, v190, v191
    v_cvt_pk_bf16_f32 v190, v204, v205
    v_cvt_pk_bf16_f32 v191, v206, v207
    v_accvgpr_write_b32 a52, v188
    v_accvgpr_write_b32 a53, v189
    v_accvgpr_write_b32 a54, v190
    v_accvgpr_write_b32 a55, v191
    v_pk_mul_f32 v[212:213], v[212:213], s[34:35]
    v_pk_mul_f32 v[214:215], v[214:215], s[34:35]
    v_pk_mul_f32 v[228:229], v[228:229], s[34:35]
    v_pk_mul_f32 v[230:231], v[230:231], s[34:35]
    v_cvt_pk_bf16_f32 v212, v212, v213
    v_cvt_pk_bf16_f32 v213, v214, v215
    v_cvt_pk_bf16_f32 v214, v228, v229
    v_cvt_pk_bf16_f32 v215, v230, v231
    v_accvgpr_write_b32 a24, v212
    v_accvgpr_write_b32 a25, v213
    v_accvgpr_write_b32 a26, v214
    v_accvgpr_write_b32 a27, v215
    v_pk_mul_f32 v[220:221], v[220:221], s[34:35]
    v_pk_mul_f32 v[222:223], v[222:223], s[34:35]
    v_pk_mul_f32 v[236:237], v[236:237], s[34:35]
    v_pk_mul_f32 v[238:239], v[238:239], s[34:35]
    v_cvt_pk_bf16_f32 v220, v220, v221
    v_cvt_pk_bf16_f32 v221, v222, v223
    v_cvt_pk_bf16_f32 v222, v236, v237
    v_cvt_pk_bf16_f32 v223, v238, v239
    v_accvgpr_write_b32 a56, v220
    v_accvgpr_write_b32 a57, v221
    v_accvgpr_write_b32 a58, v222
    v_accvgpr_write_b32 a59, v223
    v_pk_mul_f32 v[244:245], v[244:245], s[34:35]
    v_pk_mul_f32 v[246:247], v[246:247], s[34:35]
    v_pk_mul_f32 v[16:17], v[16:17], s[34:35]
    v_pk_mul_f32 v[18:19], v[18:19], s[34:35]
    v_cvt_pk_bf16_f32 v244, v244, v245
    v_cvt_pk_bf16_f32 v245, v246, v247
    v_cvt_pk_bf16_f32 v246, v16, v17
    v_cvt_pk_bf16_f32 v247, v18, v19
    v_accvgpr_write_b32 a28, v244
    v_accvgpr_write_b32 a29, v245
    v_accvgpr_write_b32 a30, v246
    v_accvgpr_write_b32 a31, v247
    v_pk_mul_f32 v[252:253], v[252:253], s[34:35]
    v_pk_mul_f32 v[254:255], v[254:255], s[34:35]
    v_pk_mul_f32 v[24:25], v[24:25], s[34:35]
    v_pk_mul_f32 v[26:27], v[26:27], s[34:35]
    v_cvt_pk_bf16_f32 v252, v252, v253
    v_cvt_pk_bf16_f32 v253, v254, v255
    v_cvt_pk_bf16_f32 v254, v24, v25
    v_cvt_pk_bf16_f32 v255, v26, v27
    v_accvgpr_write_b32 a60, v252
    v_accvgpr_write_b32 a61, v253
    v_accvgpr_write_b32 a62, v254
    v_accvgpr_write_b32 a63, v255
    s_waitcnt vmcnt(0)
    s_branch L_kvdone
L_kloop_side:
    s_mov_b64 exec, 1
    global_atomic_add v3, v15, s[90:91] offset:128 sc1
    s_mov_b64 exec, -1
    s_branch L_kloop_back
L_vloop_side:
    s_mov_b64 exec, 1
    global_atomic_add v3, v15, s[90:91] offset:128 sc1
    s_mov_b64 exec, -1
    s_branch L_vloop_back
.p2align 6
L_vloop:
    v_mfma_f32_16x16x32_bf16 v[64:67], a[64:67], a[0:3], v[64:67]
    ds_read_b64_tr_b16 a[24:25], v9 offset:0
    v_mfma_f32_16x16x32_bf16 v[64:67], a[68:71], a[4:7], v[64:67]
    ds_read_b64_tr_b16 a[26:27], v9 offset:4096
    v_mfma_f32_16x16x32_bf16 v[68:71], a[76:79], a[4:7], v[68:71]
    ds_read_b64_tr_b16 a[28:29], v9 offset:16384
    v_mfma_f32_16x16x32_bf16 v[68:71], a[72:75], a[0:3], v[68:71]
    ds_read_b64_tr_b16 a[30:31], v9 offset:20480
    v_mfma_f32_16x16x32_bf16 v[72:75], a[80:83], a[0:3], v[72:75]
    ds_read_b128 a[96:99], v4 offset:8192
    v_mfma_f32_16x16x32_bf16 v[72:75], a[84:87], a[4:7], v[72:75]
    s_cmp_eq_u32 s61, s55
    s_cbranch_scc1 L_vloop_side
L_vloop_back:
    v_mfma_f32_16x16x32_bf16 v[76:79], a[92:95], a[4:7], v[76:79]
    s_waitcnt lgkmcnt(8)
    ds_read_b128 a[100:103], v5 offset:8192
    v_mfma_f32_16x16x32_bf16 v[76:79], a[88:91], a[0:3], v[76:79]
    v_mfma_f32_16x16x32_bf16 v[84:87], a[88:91], a[8:11], v[84:87]
    ds_read_b128 a[108:111], v5 offset:10240
    v_mfma_f32_16x16x32_bf16 v[84:87], a[92:95], a[12:15], v[84:87]
    v_mfma_f32_16x16x32_bf16 v[80:83], a[84:87], a[12:15], v[80:83]
    ds_read_b128 a[104:107], v4 offset:10240
    v_mfma_f32_16x16x32_bf16 v[80:83], a[80:83], a[8:11], v[80:83]
    v_mfma_f32_16x16x32_bf16 v[92:95], a[72:75], a[8:11], v[92:95]
    ds_read_b128 a[112:115], v4 offset:12288
    v_mfma_f32_16x16x32_bf16 v[92:95], a[76:79], a[12:15], v[92:95]
    v_mfma_f32_16x16x32_bf16 v[88:91], a[68:71], a[12:15], v[88:91]
    ds_read_b128 a[116:119], v5 offset:12288
    v_mfma_f32_16x16x32_bf16 v[88:91], a[64:67], a[8:11], v[88:91]
    s_waitcnt lgkmcnt(8)
    v_mfma_f32_16x16x32_bf16 v[96:99], a[64:67], a[16:19], v[96:99]
    ds_read_b128 a[124:127], v5 offset:14336
    v_mfma_f32_16x16x32_bf16 v[96:99], a[68:71], a[20:23], v[96:99]
    v_mfma_f32_16x16x32_bf16 v[100:103], a[76:79], a[20:23], v[100:103]
    ds_read_b128 a[120:123], v4 offset:14336
    v_mfma_f32_16x16x32_bf16 v[100:103], a[72:75], a[16:19], v[100:103]
    v_mfma_f32_16x16x32_bf16 v[104:107], a[80:83], a[16:19], v[104:107]
    ds_read_b64_tr_b16 a[32:33], v10 offset:0
    v_mfma_f32_16x16x32_bf16 v[104:107], a[84:87], a[20:23], v[104:107]
    ds_read_b64_tr_b16 a[34:35], v10 offset:4096
    v_mfma_f32_16x16x32_bf16 v[108:111], a[92:95], a[20:23], v[108:111]
    ds_read_b64_tr_b16 a[36:37], v10 offset:16384
    v_mfma_f32_16x16x32_bf16 v[108:111], a[88:91], a[16:19], v[108:111]
    ds_read_b64_tr_b16 a[38:39], v10 offset:20480
    v_mfma_f32_16x16x32_bf16 v[116:119], a[88:91], a[24:27], v[116:119]
    s_waitcnt lgkmcnt(8)
    ds_read_b64_tr_b16 a[40:41], v11 offset:0
    v_mfma_f32_16x16x32_bf16 v[116:119], a[92:95], a[28:31], v[116:119]
    ds_read_b64_tr_b16 a[42:43], v11 offset:4096
    v_mfma_f32_16x16x32_bf16 v[112:115], a[84:87], a[28:31], v[112:115]
    ds_read_b64_tr_b16 a[44:45], v11 offset:16384
    v_mfma_f32_16x16x32_bf16 v[112:115], a[80:83], a[24:27], v[112:115]
    ds_read_b64_tr_b16 a[46:47], v11 offset:20480
    v_mfma_f32_16x16x32_bf16 v[124:127], a[72:75], a[24:27], v[124:127]
    ds_read_b64_tr_b16 a[48:49], v12 offset:0
    v_mfma_f32_16x16x32_bf16 v[124:127], a[76:79], a[28:31], v[124:127]
    ds_read_b64_tr_b16 a[50:51], v12 offset:4096
    v_mfma_f32_16x16x32_bf16 v[120:123], a[68:71], a[28:31], v[120:123]
    ds_read_b64_tr_b16 a[52:53], v12 offset:16384
    v_mfma_f32_16x16x32_bf16 v[120:123], a[64:67], a[24:27], v[120:123]
    ds_read_b64_tr_b16 a[54:55], v12 offset:20480
    v_mfma_f32_16x16x32_bf16 v[16:19], a[96:99], a[0:3], v[16:19]
    ds_read_b64_tr_b16 a[56:57], v13 offset:0
    v_mfma_f32_16x16x32_bf16 v[16:19], a[100:103], a[4:7], v[16:19]
    ds_read_b64_tr_b16 a[58:59], v13 offset:4096
    v_mfma_f32_16x16x32_bf16 v[20:23], a[108:111], a[4:7], v[20:23]
    ds_read_b64_tr_b16 a[60:61], v13 offset:16384
    v_mfma_f32_16x16x32_bf16 v[20:23], a[104:107], a[0:3], v[20:23]
    s_waitcnt lgkmcnt(8)
    ds_read_b64_tr_b16 a[62:63], v13 offset:20480
    v_mfma_f32_16x16x32_bf16 v[24:27], a[112:115], a[0:3], v[24:27]
    v_mfma_f32_16x16x32_bf16 v[24:27], a[116:119], a[4:7], v[24:27]
    v_mfma_f32_16x16x32_bf16 v[28:31], a[124:127], a[4:7], v[28:31]
    v_mfma_f32_16x16x32_bf16 v[28:31], a[120:123], a[0:3], v[28:31]
    s_waitcnt lgkmcnt(0)
    v_mfma_f32_16x16x32_bf16 a[228:231], a[120:123], a[8:11], a[228:231]
    s_barrier
    v_mfma_f32_16x16x32_bf16 a[228:231], a[124:127], a[12:15], a[228:231]
    s_add_u32 m0, s29, 65536
    v_mfma_f32_16x16x32_bf16 a[224:227], a[116:119], a[12:15], a[224:227]
    buffer_load_dwordx4 v2, s[8:11], 0 offen lds
    v_mfma_f32_16x16x32_bf16 a[224:227], a[112:115], a[8:11], a[224:227]
    v_mfma_f32_16x16x32_bf16 a[236:239], a[104:107], a[8:11], a[236:239]
    v_mfma_f32_16x16x32_bf16 a[236:239], a[108:111], a[12:15], a[236:239]
    v_mfma_f32_16x16x32_bf16 a[232:235], a[100:103], a[12:15], a[232:235]
    s_add_u32 m0, s29, 0
    v_mfma_f32_16x16x32_bf16 a[232:235], a[96:99], a[8:11], a[232:235]
    buffer_load_dwordx4 v1, s[4:7], 0 offen lds
    v_mfma_f32_16x16x32_bf16 v[32:35], a[96:99], a[16:19], v[32:35]
    v_mfma_f32_16x16x32_bf16 v[32:35], a[100:103], a[20:23], v[32:35]
    v_mfma_f32_16x16x32_bf16 v[36:39], a[108:111], a[20:23], v[36:39]
    v_mfma_f32_16x16x32_bf16 v[36:39], a[104:107], a[16:19], v[36:39]
    s_add_u32 m0, s29, 69632
    v_mfma_f32_16x16x32_bf16 v[40:43], a[112:115], a[16:19], v[40:43]
    buffer_load_dwordx4 v2, s[8:11], s48 offen lds
    v_mfma_f32_16x16x32_bf16 v[40:43], a[116:119], a[20:23], v[40:43]
    v_mfma_f32_16x16x32_bf16 v[44:47], a[124:127], a[20:23], v[44:47]
    v_mfma_f32_16x16x32_bf16 v[44:47], a[120:123], a[16:19], v[44:47]
    v_mfma_f32_16x16x32_bf16 v[52:55], a[120:123], a[24:27], v[52:55]
    s_add_u32 m0, s29, 4096
    v_mfma_f32_16x16x32_bf16 v[52:55], a[124:127], a[28:31], v[52:55]
    buffer_load_dwordx4 v1, s[4:7], s41 offen lds
    v_mfma_f32_16x16x32_bf16 v[48:51], a[116:119], a[28:31], v[48:51]
    v_mfma_f32_16x16x32_bf16 v[48:51], a[112:115], a[24:27], v[48:51]
    v_mfma_f32_16x16x32_bf16 v[60:63], a[104:107], a[24:27], v[60:63]
    v_mfma_f32_16x16x32_bf16 v[60:63], a[108:111], a[28:31], v[60:63]
    s_add_u32 m0, s29, 73728
    v_mfma_f32_16x16x32_bf16 v[56:59], a[100:103], a[28:31], v[56:59]
    buffer_load_dwordx4 v2, s[8:11], s49 offen lds
    v_mfma_f32_16x16x32_bf16 v[56:59], a[96:99], a[24:27], v[56:59]
    v_mfma_f32_16x16x32_bf16 v[192:195], a[96:99], a[32:35], v[192:195]
    v_mfma_f32_16x16x32_bf16 v[192:195], a[100:103], a[36:39], v[192:195]
    v_mfma_f32_16x16x32_bf16 v[196:199], a[108:111], a[36:39], v[196:199]
    s_add_u32 m0, s29, 8192
    v_mfma_f32_16x16x32_bf16 v[196:199], a[104:107], a[32:35], v[196:199]
    buffer_load_dwordx4 v1, s[4:7], s42 offen lds
    v_mfma_f32_16x16x32_bf16 v[200:203], a[112:115], a[32:35], v[200:203]
    v_mfma_f32_16x16x32_bf16 v[200:203], a[116:119], a[36:39], v[200:203]
    v_mfma_f32_16x16x32_bf16 v[204:207], a[124:127], a[36:39], v[204:207]
    v_mfma_f32_16x16x32_bf16 v[204:207], a[120:123], a[32:35], v[204:207]
    s_add_u32 m0, s29, 77824
    v_mfma_f32_16x16x32_bf16 v[212:215], a[120:123], a[40:43], v[212:215]
    buffer_load_dwordx4 v2, s[8:11], s50 offen lds
    v_mfma_f32_16x16x32_bf16 v[212:215], a[124:127], a[44:47], v[212:215]
    v_mfma_f32_16x16x32_bf16 v[208:211], a[116:119], a[44:47], v[208:211]
    v_mfma_f32_16x16x32_bf16 v[208:211], a[112:115], a[40:43], v[208:211]
    v_mfma_f32_16x16x32_bf16 v[220:223], a[104:107], a[40:43], v[220:223]
    s_add_u32 m0, s29, 12288
    v_mfma_f32_16x16x32_bf16 v[220:223], a[108:111], a[44:47], v[220:223]
    buffer_load_dwordx4 v1, s[4:7], s43 offen lds
    v_mfma_f32_16x16x32_bf16 v[216:219], a[100:103], a[44:47], v[216:219]
    v_mfma_f32_16x16x32_bf16 v[216:219], a[96:99], a[40:43], v[216:219]
    v_mfma_f32_16x16x32_bf16 v[224:227], a[96:99], a[48:51], v[224:227]
    v_mfma_f32_16x16x32_bf16 v[224:227], a[100:103], a[52:55], v[224:227]
    s_add_u32 m0, s29, 81920
    v_mfma_f32_16x16x32_bf16 v[228:231], a[108:111], a[52:55], v[228:231]
    buffer_load_dwordx4 v2, s[8:11], s51 offen lds
    v_mfma_f32_16x16x32_bf16 v[228:231], a[104:107], a[48:51], v[228:231]
    v_mfma_f32_16x16x32_bf16 v[232:235], a[112:115], a[48:51], v[232:235]
    v_mfma_f32_16x16x32_bf16 v[232:235], a[116:119], a[52:55], v[232:235]
    v_mfma_f32_16x16x32_bf16 v[236:239], a[124:127], a[52:55], v[236:239]
    s_add_u32 m0, s29, 16384
    v_mfma_f32_16x16x32_bf16 v[236:239], a[120:123], a[48:51], v[236:239]
    buffer_load_dwordx4 v1, s[4:7], s44 offen lds
    v_mfma_f32_16x16x32_bf16 v[244:247], a[120:123], a[56:59], v[244:247]
    v_mfma_f32_16x16x32_bf16 v[244:247], a[124:127], a[60:63], v[244:247]
    v_mfma_f32_16x16x32_bf16 v[240:243], a[116:119], a[60:63], v[240:243]
    v_mfma_f32_16x16x32_bf16 v[240:243], a[112:115], a[56:59], v[240:243]
    s_add_u32 m0, s29, 86016
    v_mfma_f32_16x16x32_bf16 v[252:255], a[104:107], a[56:59], v[252:255]
    s_waitcnt vmcnt(11)
    buffer_load_dwordx4 v2, s[8:11], s52 offen lds
    v_mfma_f32_16x16x32_bf16 v[252:255], a[108:111], a[60:63], v[252:255]
    s_barrier
    ds_read_b64_tr_b16 a[0:1], v6 offset:32768
    v_mfma_f32_16x16x32_bf16 v[248:251], a[100:103], a[60:63], v[248:251]
    ds_read_b64_tr_b16 a[2:3], v6 offset:36864
    v_mfma_f32_16x16x32_bf16 v[248:251], a[96:99], a[56:59], v[248:251]
    ds_read_b128 a[96:99], v4 offset:40960
    v_mfma_f32_16x16x32_bf16 v[128:131], a[64:67], a[32:35], v[128:131]
    s_add_u32 m0, s29, 20480
    v_mfma_f32_16x16x32_bf16 v[128:131], a[68:71], a[36:39], v[128:131]
    buffer_load_dwordx4 v1, s[4:7], s45 offen lds
    v_mfma_f32_16x16x32_bf16 v[132:135], a[76:79], a[36:39], v[132:135]
    ds_read_b64_tr_b16 a[4:5], v6 offset:49152
    v_mfma_f32_16x16x32_bf16 v[132:135], a[72:75], a[32:35], v[132:135]
    ds_read_b64_tr_b16 a[6:7], v6 offset:53248
    v_mfma_f32_16x16x32_bf16 v[136:139], a[80:83], a[32:35], v[136:139]
    ds_read_b128 a[100:103], v5 offset:40960
    v_mfma_f32_16x16x32_bf16 v[136:139], a[84:87], a[36:39], v[136:139]
    s_add_u32 m0, s29, 90112
    v_mfma_f32_16x16x32_bf16 v[140:143], a[92:95], a[36:39], v[140:143]
    buffer_load_dwordx4 v2, s[8:11], s53 offen lds
    v_mfma_f32_16x16x32_bf16 v[140:143], a[88:91], a[32:35], v[140:143]
    ds_read_b128 a[108:111], v5 offset:43008
    v_mfma_f32_16x16x32_bf16 v[148:151], a[88:91], a[40:43], v[148:151]
    v_mfma_f32_16x16x32_bf16 v[148:151], a[92:95], a[44:47], v[148:151]
    ds_read_b128 a[104:107], v4 offset:43008
    v_mfma_f32_16x16x32_bf16 v[144:147], a[84:87], a[44:47], v[144:147]
    s_add_u32 m0, s29, 24576
    v_mfma_f32_16x16x32_bf16 v[144:147], a[80:83], a[40:43], v[144:147]
    buffer_load_dwordx4 v1, s[4:7], s46 offen lds
    v_mfma_f32_16x16x32_bf16 v[156:159], a[72:75], a[40:43], v[156:159]
    ds_read_b128 a[112:115], v4 offset:45056
    v_mfma_f32_16x16x32_bf16 v[156:159], a[76:79], a[44:47], v[156:159]
    v_mfma_f32_16x16x32_bf16 v[152:155], a[68:71], a[44:47], v[152:155]
    ds_read_b128 a[116:119], v5 offset:45056
    v_mfma_f32_16x16x32_bf16 v[152:155], a[64:67], a[40:43], v[152:155]
    s_add_u32 m0, s29, 94208
    v_mfma_f32_16x16x32_bf16 v[160:163], a[64:67], a[48:51], v[160:163]
    buffer_load_dwordx4 v2, s[8:11], s54 offen lds
    v_mfma_f32_16x16x32_bf16 v[160:163], a[68:71], a[52:55], v[160:163]
    ds_read_b128 a[124:127], v5 offset:47104
    v_mfma_f32_16x16x32_bf16 v[164:167], a[76:79], a[52:55], v[164:167]
    v_mfma_f32_16x16x32_bf16 v[164:167], a[72:75], a[48:51], v[164:167]
    ds_read_b128 a[120:123], v4 offset:47104
    v_mfma_f32_16x16x32_bf16 v[168:171], a[80:83], a[48:51], v[168:171]
    s_add_u32 m0, s29, 28672
    v_mfma_f32_16x16x32_bf16 v[168:171], a[84:87], a[52:55], v[168:171]
    buffer_load_dwordx4 v1, s[4:7], s47 offen lds
    v_mfma_f32_16x16x32_bf16 v[172:175], a[92:95], a[52:55], v[172:175]
    v_add_u32 v1, 128, v1
    v_add_u32 v2, 0x80000, v2
    v_mfma_f32_16x16x32_bf16 v[172:175], a[88:91], a[48:51], v[172:175]
    ds_read_b64_tr_b16 a[8:9], v7 offset:32768
    v_mfma_f32_16x16x32_bf16 v[180:183], a[88:91], a[56:59], v[180:183]
    buffer_load_dword a243, v14, s[36:39], s56 offen
    v_mfma_f32_16x16x32_bf16 v[180:183], a[92:95], a[60:63], v[180:183]
    s_add_u32 s56, s56, s30
    ds_read_b64_tr_b16 a[10:11], v7 offset:36864
    v_mfma_f32_16x16x32_bf16 v[176:179], a[84:87], a[60:63], v[176:179]
    ds_read_b64_tr_b16 a[12:13], v7 offset:49152
    v_mfma_f32_16x16x32_bf16 v[176:179], a[80:83], a[56:59], v[176:179]
    ds_read_b64_tr_b16 a[14:15], v7 offset:53248
    v_mfma_f32_16x16x32_bf16 v[188:191], a[72:75], a[56:59], v[188:191]
    ds_read_b64_tr_b16 a[16:17], v8 offset:32768
    v_mfma_f32_16x16x32_bf16 v[188:191], a[76:79], a[60:63], v[188:191]
    ds_read_b64_tr_b16 a[18:19], v8 offset:36864
    v_mfma_f32_16x16x32_bf16 v[184:187], a[68:71], a[60:63], v[184:187]
    ds_read_b64_tr_b16 a[20:21], v8 offset:49152
    v_mfma_f32_16x16x32_bf16 v[184:187], a[64:67], a[56:59], v[184:187]
    s_waitcnt lgkmcnt(8)
    ds_read_b64_tr_b16 a[22:23], v8 offset:53248
    v_mfma_f32_16x16x32_bf16 v[16:19], a[96:99], a[0:3], v[16:19]
    ds_read_b64_tr_b16 a[24:25], v9 offset:32768
    v_mfma_f32_16x16x32_bf16 v[16:19], a[100:103], a[4:7], v[16:19]
    ds_read_b64_tr_b16 a[26:27], v9 offset:36864
    v_mfma_f32_16x16x32_bf16 v[20:23], a[108:111], a[4:7], v[20:23]
    ds_read_b64_tr_b16 a[28:29], v9 offset:49152
    v_mfma_f32_16x16x32_bf16 v[20:23], a[104:107], a[0:3], v[20:23]
    ds_read_b64_tr_b16 a[30:31], v9 offset:53248
    v_mfma_f32_16x16x32_bf16 v[24:27], a[112:115], a[0:3], v[24:27]
    ds_read_b128 a[64:67], v4 offset:32768
    v_mfma_f32_16x16x32_bf16 v[24:27], a[116:119], a[4:7], v[24:27]
    v_mfma_f32_16x16x32_bf16 v[28:31], a[124:127], a[4:7], v[28:31]
    s_waitcnt lgkmcnt(8)
    ds_read_b128 a[68:71], v5 offset:32768
    v_mfma_f32_16x16x32_bf16 v[28:31], a[120:123], a[0:3], v[28:31]
    v_mfma_f32_16x16x32_bf16 a[228:231], a[120:123], a[8:11], a[228:231]
    ds_read_b128 a[76:79], v5 offset:34816
    v_mfma_f32_16x16x32_bf16 a[228:231], a[124:127], a[12:15], a[228:231]
    v_mfma_f32_16x16x32_bf16 a[224:227], a[116:119], a[12:15], a[224:227]
    ds_read_b128 a[72:75], v4 offset:34816
    v_mfma_f32_16x16x32_bf16 a[224:227], a[112:115], a[8:11], a[224:227]
    v_mfma_f32_16x16x32_bf16 a[236:239], a[104:107], a[8:11], a[236:239]
    ds_read_b128 a[80:83], v4 offset:36864
    v_mfma_f32_16x16x32_bf16 a[236:239], a[108:111], a[12:15], a[236:239]
    v_mfma_f32_16x16x32_bf16 a[232:235], a[100:103], a[12:15], a[232:235]
    ds_read_b128 a[84:87], v5 offset:36864
    v_mfma_f32_16x16x32_bf16 a[232:235], a[96:99], a[8:11], a[232:235]
    s_waitcnt lgkmcnt(8)
    v_mfma_f32_16x16x32_bf16 v[32:35], a[96:99], a[16:19], v[32:35]
    ds_read_b128 a[92:95], v5 offset:38912
    v_mfma_f32_16x16x32_bf16 v[32:35], a[100:103], a[20:23], v[32:35]
    v_mfma_f32_16x16x32_bf16 v[36:39], a[108:111], a[20:23], v[36:39]
    ds_read_b128 a[88:91], v4 offset:38912
    v_mfma_f32_16x16x32_bf16 v[36:39], a[104:107], a[16:19], v[36:39]
    v_mfma_f32_16x16x32_bf16 v[40:43], a[112:115], a[16:19], v[40:43]
    ds_read_b64_tr_b16 a[32:33], v10 offset:32768
    v_mfma_f32_16x16x32_bf16 v[40:43], a[116:119], a[20:23], v[40:43]
    ds_read_b64_tr_b16 a[34:35], v10 offset:36864
    v_mfma_f32_16x16x32_bf16 v[44:47], a[124:127], a[20:23], v[44:47]
    ds_read_b64_tr_b16 a[36:37], v10 offset:49152
    v_mfma_f32_16x16x32_bf16 v[44:47], a[120:123], a[16:19], v[44:47]
    ds_read_b64_tr_b16 a[38:39], v10 offset:53248
    v_mfma_f32_16x16x32_bf16 v[52:55], a[120:123], a[24:27], v[52:55]
    s_waitcnt lgkmcnt(8)
    ds_read_b64_tr_b16 a[40:41], v11 offset:32768
    v_mfma_f32_16x16x32_bf16 v[52:55], a[124:127], a[28:31], v[52:55]
    ds_read_b64_tr_b16 a[42:43], v11 offset:36864
    v_mfma_f32_16x16x32_bf16 v[48:51], a[116:119], a[28:31], v[48:51]
    ds_read_b64_tr_b16 a[44:45], v11 offset:49152
    v_mfma_f32_16x16x32_bf16 v[48:51], a[112:115], a[24:27], v[48:51]
    ds_read_b64_tr_b16 a[46:47], v11 offset:53248
    v_mfma_f32_16x16x32_bf16 v[60:63], a[104:107], a[24:27], v[60:63]
    ds_read_b64_tr_b16 a[48:49], v12 offset:32768
    v_mfma_f32_16x16x32_bf16 v[60:63], a[108:111], a[28:31], v[60:63]
    ds_read_b64_tr_b16 a[50:51], v12 offset:36864
    v_mfma_f32_16x16x32_bf16 v[56:59], a[100:103], a[28:31], v[56:59]
    ds_read_b64_tr_b16 a[52:53], v12 offset:49152
    v_mfma_f32_16x16x32_bf16 v[56:59], a[96:99], a[24:27], v[56:59]
    ds_read_b64_tr_b16 a[54:55], v12 offset:53248
    v_mfma_f32_16x16x32_bf16 v[64:67], a[64:67], a[0:3], v[64:67]
    ds_read_b64_tr_b16 a[56:57], v13 offset:32768
    v_mfma_f32_16x16x32_bf16 v[64:67], a[68:71], a[4:7], v[64:67]
    ds_read_b64_tr_b16 a[58:59], v13 offset:36864
    v_mfma_f32_16x16x32_bf16 v[68:71], a[76:79], a[4:7], v[68:71]
    ds_read_b64_tr_b16 a[60:61], v13 offset:49152
    v_mfma_f32_16x16x32_bf16 v[68:71], a[72:75], a[0:3], v[68:71]
    s_waitcnt lgkmcnt(8)
    ds_read_b64_tr_b16 a[62:63], v13 offset:53248
    v_mfma_f32_16x16x32_bf16 v[72:75], a[80:83], a[0:3], v[72:75]
    v_mfma_f32_16x16x32_bf16 v[72:75], a[84:87], a[4:7], v[72:75]
    v_mfma_f32_16x16x32_bf16 v[76:79], a[92:95], a[4:7], v[76:79]
    v_mfma_f32_16x16x32_bf16 v[76:79], a[88:91], a[0:3], v[76:79]
    s_waitcnt lgkmcnt(0)
    v_mfma_f32_16x16x32_bf16 v[84:87], a[88:91], a[8:11], v[84:87]
    s_barrier
    v_mfma_f32_16x16x32_bf16 v[84:87], a[92:95], a[12:15], v[84:87]
    s_add_u32 m0, s29, 98304
    v_mfma_f32_16x16x32_bf16 v[80:83], a[84:87], a[12:15], v[80:83]
    buffer_load_dwordx4 v2, s[8:11], 0 offen lds
    v_mfma_f32_16x16x32_bf16 v[80:83], a[80:83], a[8:11], v[80:83]
    v_mfma_f32_16x16x32_bf16 v[92:95], a[72:75], a[8:11], v[92:95]
    v_mfma_f32_16x16x32_bf16 v[92:95], a[76:79], a[12:15], v[92:95]
    v_mfma_f32_16x16x32_bf16 v[88:91], a[68:71], a[12:15], v[88:91]
    s_add_u32 m0, s29, 32768
    v_mfma_f32_16x16x32_bf16 v[88:91], a[64:67], a[8:11], v[88:91]
    buffer_load_dwordx4 v1, s[4:7], 0 offen lds
    v_mfma_f32_16x16x32_bf16 v[96:99], a[64:67], a[16:19], v[96:99]
    v_mfma_f32_16x16x32_bf16 v[96:99], a[68:71], a[20:23], v[96:99]
    v_mfma_f32_16x16x32_bf16 v[100:103], a[76:79], a[20:23], v[100:103]
    v_mfma_f32_16x16x32_bf16 v[100:103], a[72:75], a[16:19], v[100:103]
    s_add_u32 m0, s29, 102400
    v_mfma_f32_16x16x32_bf16 v[104:107], a[80:83], a[16:19], v[104:107]
    buffer_load_dwordx4 v2, s[8:11], s48 offen lds
    v_mfma_f32_16x16x32_bf16 v[104:107], a[84:87], a[20:23], v[104:107]
    v_mfma_f32_16x16x32_bf16 v[108:111], a[92:95], a[20:23], v[108:111]
    v_mfma_f32_16x16x32_bf16 v[108:111], a[88:91], a[16:19], v[108:111]
    v_mfma_f32_16x16x32_bf16 v[116:119], a[88:91], a[24:27], v[116:119]
    s_add_u32 m0, s29, 36864
    v_mfma_f32_16x16x32_bf16 v[116:119], a[92:95], a[28:31], v[116:119]
    buffer_load_dwordx4 v1, s[4:7], s41 offen lds
    v_mfma_f32_16x16x32_bf16 v[112:115], a[84:87], a[28:31], v[112:115]
    v_mfma_f32_16x16x32_bf16 v[112:115], a[80:83], a[24:27], v[112:115]
    v_mfma_f32_16x16x32_bf16 v[124:127], a[72:75], a[24:27], v[124:127]
    v_mfma_f32_16x16x32_bf16 v[124:127], a[76:79], a[28:31], v[124:127]
    s_add_u32 m0, s29, 106496
    v_mfma_f32_16x16x32_bf16 v[120:123], a[68:71], a[28:31], v[120:123]
    buffer_load_dwordx4 v2, s[8:11], s49 offen lds
    v_mfma_f32_16x16x32_bf16 v[120:123], a[64:67], a[24:27], v[120:123]
    v_mfma_f32_16x16x32_bf16 v[128:131], a[64:67], a[32:35], v[128:131]
    v_mfma_f32_16x16x32_bf16 v[128:131], a[68:71], a[36:39], v[128:131]
    v_mfma_f32_16x16x32_bf16 v[132:135], a[76:79], a[36:39], v[132:135]
    s_add_u32 m0, s29, 40960
    v_mfma_f32_16x16x32_bf16 v[132:135], a[72:75], a[32:35], v[132:135]
    buffer_load_dwordx4 v1, s[4:7], s42 offen lds
    v_mfma_f32_16x16x32_bf16 v[136:139], a[80:83], a[32:35], v[136:139]
    v_mfma_f32_16x16x32_bf16 v[136:139], a[84:87], a[36:39], v[136:139]
    v_mfma_f32_16x16x32_bf16 v[140:143], a[92:95], a[36:39], v[140:143]
    v_mfma_f32_16x16x32_bf16 v[140:143], a[88:91], a[32:35], v[140:143]
    s_add_u32 m0, s29, 110592
    v_mfma_f32_16x16x32_bf16 v[148:151], a[88:91], a[40:43], v[148:151]
    buffer_load_dwordx4 v2, s[8:11], s50 offen lds
    v_mfma_f32_16x16x32_bf16 v[148:151], a[92:95], a[44:47], v[148:151]
    v_mfma_f32_16x16x32_bf16 v[144:147], a[84:87], a[44:47], v[144:147]
    v_mfma_f32_16x16x32_bf16 v[144:147], a[80:83], a[40:43], v[144:147]
    v_mfma_f32_16x16x32_bf16 v[156:159], a[72:75], a[40:43], v[156:159]
    s_add_u32 m0, s29, 45056
    v_mfma_f32_16x16x32_bf16 v[156:159], a[76:79], a[44:47], v[156:159]
    buffer_load_dwordx4 v1, s[4:7], s43 offen lds
    v_mfma_f32_16x16x32_bf16 v[152:155], a[68:71], a[44:47], v[152:155]
    v_mfma_f32_16x16x32_bf16 v[152:155], a[64:67], a[40:43], v[152:155]
    v_mfma_f32_16x16x32_bf16 v[160:163], a[64:67], a[48:51], v[160:163]
    v_mfma_f32_16x16x32_bf16 v[160:163], a[68:71], a[52:55], v[160:163]
    s_add_u32 m0, s29, 114688
    v_mfma_f32_16x16x32_bf16 v[164:167], a[76:79], a[52:55], v[164:167]
    buffer_load_dwordx4 v2, s[8:11], s51 offen lds
    v_mfma_f32_16x16x32_bf16 v[164:167], a[72:75], a[48:51], v[164:167]
    v_mfma_f32_16x16x32_bf16 v[168:171], a[80:83], a[48:51], v[168:171]
    v_mfma_f32_16x16x32_bf16 v[168:171], a[84:87], a[52:55], v[168:171]
    v_mfma_f32_16x16x32_bf16 v[172:175], a[92:95], a[52:55], v[172:175]
    s_add_u32 m0, s29, 49152
    v_mfma_f32_16x16x32_bf16 v[172:175], a[88:91], a[48:51], v[172:175]
    buffer_load_dwordx4 v1, s[4:7], s44 offen lds
    v_mfma_f32_16x16x32_bf16 v[180:183], a[88:91], a[56:59], v[180:183]
    v_mfma_f32_16x16x32_bf16 v[180:183], a[92:95], a[60:63], v[180:183]
    v_mfma_f32_16x16x32_bf16 v[176:179], a[84:87], a[60:63], v[176:179]
    v_mfma_f32_16x16x32_bf16 v[176:179], a[80:83], a[56:59], v[176:179]
    s_add_u32 m0, s29, 118784
    v_mfma_f32_16x16x32_bf16 v[188:191], a[72:75], a[56:59], v[188:191]
    s_waitcnt vmcnt(11)
    buffer_load_dwordx4 v2, s[8:11], s52 offen lds
    v_mfma_f32_16x16x32_bf16 v[188:191], a[76:79], a[60:63], v[188:191]
    s_barrier
    ds_read_b64_tr_b16 a[0:1], v6 offset:0
    v_mfma_f32_16x16x32_bf16 v[184:187], a[68:71], a[60:63], v[184:187]
    ds_read_b64_tr_b16 a[2:3], v6 offset:4096
    v_mfma_f32_16x16x32_bf16 v[184:187], a[64:67], a[56:59], v[184:187]
    ds_read_b128 a[64:67], v4 offset:0
    v_mfma_f32_16x16x32_bf16 v[192:195], a[96:99], a[32:35], v[192:195]
    s_add_u32 m0, s29, 53248
    v_mfma_f32_16x16x32_bf16 v[192:195], a[100:103], a[36:39], v[192:195]
    buffer_load_dwordx4 v1, s[4:7], s45 offen lds
    v_mfma_f32_16x16x32_bf16 v[196:199], a[108:111], a[36:39], v[196:199]
    ds_read_b64_tr_b16 a[4:5], v6 offset:16384
    v_mfma_f32_16x16x32_bf16 v[196:199], a[104:107], a[32:35], v[196:199]
    ds_read_b64_tr_b16 a[6:7], v6 offset:20480
    v_mfma_f32_16x16x32_bf16 v[200:203], a[112:115], a[32:35], v[200:203]
    ds_read_b128 a[68:71], v5 offset:0
    v_mfma_f32_16x16x32_bf16 v[200:203], a[116:119], a[36:39], v[200:203]
    s_add_u32 m0, s29, 122880
    v_mfma_f32_16x16x32_bf16 v[204:207], a[124:127], a[36:39], v[204:207]
    buffer_load_dwordx4 v2, s[8:11], s53 offen lds
    v_mfma_f32_16x16x32_bf16 v[204:207], a[120:123], a[32:35], v[204:207]
    ds_read_b128 a[76:79], v5 offset:2048
    v_mfma_f32_16x16x32_bf16 v[212:215], a[120:123], a[40:43], v[212:215]
    v_mfma_f32_16x16x32_bf16 v[212:215], a[124:127], a[44:47], v[212:215]
    ds_read_b128 a[72:75], v4 offset:2048
    v_mfma_f32_16x16x32_bf16 v[208:211], a[116:119], a[44:47], v[208:211]
    s_add_u32 m0, s29, 57344
    v_mfma_f32_16x16x32_bf16 v[208:211], a[112:115], a[40:43], v[208:211]
    buffer_load_dwordx4 v1, s[4:7], s46 offen lds
    v_mfma_f32_16x16x32_bf16 v[220:223], a[104:107], a[40:43], v[220:223]
    ds_read_b128 a[80:83], v4 offset:4096
    v_mfma_f32_16x16x32_bf16 v[220:223], a[108:111], a[44:47], v[220:223]
    v_mfma_f32_16x16x32_bf16 v[216:219], a[100:103], a[44:47], v[216:219]
    ds_read_b128 a[84:87], v5 offset:4096
    v_mfma_f32_16x16x32_bf16 v[216:219], a[96:99], a[40:43], v[216:219]
    s_add_u32 m0, s29, 126976
    v_mfma_f32_16x16x32_bf16 v[224:227], a[96:99], a[48:51], v[224:227]
    buffer_load_dwordx4 v2, s[8:11], s54 offen lds
    v_mfma_f32_16x16x32_bf16 v[224:227], a[100:103], a[52:55], v[224:227]
    ds_read_b128 a[92:95], v5 offset:6144
    v_mfma_f32_16x16x32_bf16 v[228:231], a[108:111], a[52:55], v[228:231]
    v_mfma_f32_16x16x32_bf16 v[228:231], a[104:107], a[48:51], v[228:231]
    ds_read_b128 a[88:91], v4 offset:6144
    v_mfma_f32_16x16x32_bf16 v[232:235], a[112:115], a[48:51], v[232:235]
    s_add_u32 m0, s29, 61440
    v_mfma_f32_16x16x32_bf16 v[232:235], a[116:119], a[52:55], v[232:235]
    buffer_load_dwordx4 v1, s[4:7], s47 offen lds
    v_mfma_f32_16x16x32_bf16 v[236:239], a[124:127], a[52:55], v[236:239]
    v_add_u32 v1, 128, v1
    v_add_u32 v2, 0x80000, v2
    v_mfma_f32_16x16x32_bf16 v[236:239], a[120:123], a[48:51], v[236:239]
    ds_read_b64_tr_b16 a[8:9], v7 offset:0
    v_mfma_f32_16x16x32_bf16 v[244:247], a[120:123], a[56:59], v[244:247]
    buffer_load_dword a243, v14, s[36:39], s56 offen
    v_mfma_f32_16x16x32_bf16 v[244:247], a[124:127], a[60:63], v[244:247]
    s_add_u32 s56, s56, s30
    ds_read_b64_tr_b16 a[10:11], v7 offset:4096
    v_mfma_f32_16x16x32_bf16 v[240:243], a[116:119], a[60:63], v[240:243]
    ds_read_b64_tr_b16 a[12:13], v7 offset:16384
    v_mfma_f32_16x16x32_bf16 v[240:243], a[112:115], a[56:59], v[240:243]
    ds_read_b64_tr_b16 a[14:15], v7 offset:20480
    v_mfma_f32_16x16x32_bf16 v[252:255], a[104:107], a[56:59], v[252:255]
    ds_read_b64_tr_b16 a[16:17], v8 offset:0
    v_mfma_f32_16x16x32_bf16 v[252:255], a[108:111], a[60:63], v[252:255]
    ds_read_b64_tr_b16 a[18:19], v8 offset:4096
    v_mfma_f32_16x16x32_bf16 v[248:251], a[100:103], a[60:63], v[248:251]
    s_add_u32 s61, s61, 1
    ds_read_b64_tr_b16 a[20:21], v8 offset:16384
    v_mfma_f32_16x16x32_bf16 v[248:251], a[96:99], a[56:59], v[248:251]
    s_waitcnt lgkmcnt(8)
    ds_read_b64_tr_b16 a[22:23], v8 offset:20480
    s_cmp_lt_u32 s61, 6
    s_cbranch_scc1 L_vloop
    v_mfma_f32_16x16x32_bf16 v[64:67], a[64:67], a[0:3], v[64:67]
    ds_read_b64_tr_b16 a[24:25], v9 offset:0
    v_accvgpr_read_b32 v15, a240
    v_mfma_f32_16x16x32_bf16 v[64:67], a[68:71], a[4:7], v[64:67]
    ds_read_b64_tr_b16 a[26:27], v9 offset:4096
    v_accvgpr_read_b32 v14, a244
    v_mfma_f32_16x16x32_bf16 v[68:71], a[76:79], a[4:7], v[68:71]
    s_waitcnt lgkmcnt(12)
    ds_read_b64_tr_b16 a[28:29], v9 offset:16384
    global_load_dword a243, v14, s[100:101]
    v_mfma_f32_16x16x32_bf16 v[68:71], a[72:75], a[0:3], v[68:71]
    ds_read_b64_tr_b16 a[30:31], v9 offset:20480
    v_accvgpr_read_b32 v14, a242
    v_mfma_f32_16x16x32_bf16 v[72:75], a[80:83], a[0:3], v[72:75]
    s_add_u32 m0, s33, 0x0
    ds_read_b128 a[96:99], v4 offset:8192
    v_xor_b32 v3, 64, v14
    v_mfma_f32_16x16x32_bf16 v[72:75], a[84:87], a[4:7], v[72:75]
    s_waitcnt lgkmcnt(11)
    v_mfma_f32_16x16x32_bf16 v[76:79], a[92:95], a[4:7], v[76:79]
    ds_read_b128 a[100:103], v5 offset:8192
    buffer_load_dwordx4 v15, s[20:23], 0 offen offset:0 lds
    v_mfma_f32_16x16x32_bf16 v[76:79], a[88:91], a[0:3], v[76:79]
    v_mfma_f32_16x16x32_bf16 v[84:87], a[88:91], a[8:11], v[84:87]
    s_waitcnt lgkmcnt(10)
    ds_read_b128 a[108:111], v5 offset:10240
    v_mfma_f32_16x16x32_bf16 v[84:87], a[92:95], a[12:15], v[84:87]
    s_add_u32 m0, s33, 0x80
    v_mfma_f32_16x16x32_bf16 v[80:83], a[84:87], a[12:15], v[80:83]
    ds_read_b128 a[104:107], v4 offset:10240
    buffer_load_dwordx4 v15, s[20:23], 0 offen offset:896 lds
    v_mfma_f32_16x16x32_bf16 v[80:83], a[80:83], a[8:11], v[80:83]
    v_mfma_f32_16x16x32_bf16 v[92:95], a[72:75], a[8:11], v[92:95]
    ds_read_b128 a[112:115], v4 offset:12288
    v_mfma_f32_16x16x32_bf16 v[92:95], a[76:79], a[12:15], v[92:95]
    s_add_u32 m0, s33, 0x800
    v_mfma_f32_16x16x32_bf16 v[88:91], a[68:71], a[12:15], v[88:91]
    ds_read_b128 a[116:119], v5 offset:12288
    buffer_load_dwordx4 v15, s[20:23], s57 offen offset:0 lds
    v_mfma_f32_16x16x32_bf16 v[88:91], a[64:67], a[8:11], v[88:91]
    s_waitcnt lgkmcnt(10)
    v_mfma_f32_16x16x32_bf16 v[96:99], a[64:67], a[16:19], v[96:99]
    ds_read_b128 a[124:127], v5 offset:14336
    v_mfma_f32_16x16x32_bf16 v[96:99], a[68:71], a[20:23], v[96:99]
    s_add_u32 m0, s33, 0x880
    v_mfma_f32_16x16x32_bf16 v[100:103], a[76:79], a[20:23], v[100:103]
    ds_read_b128 a[120:123], v4 offset:14336
    buffer_load_dwordx4 v15, s[20:23], s57 offen offset:896 lds
    v_mfma_f32_16x16x32_bf16 v[100:103], a[72:75], a[16:19], v[100:103]
    v_mfma_f32_16x16x32_bf16 v[104:107], a[80:83], a[16:19], v[104:107]
    ds_read_b64_tr_b16 a[32:33], v10 offset:0
    v_mfma_f32_16x16x32_bf16 v[104:107], a[84:87], a[20:23], v[104:107]
    s_add_u32 m0, s33, 0xf80
    ds_read_b64_tr_b16 a[34:35], v10 offset:4096
    v_mfma_f32_16x16x32_bf16 v[108:111], a[92:95], a[20:23], v[108:111]
    ds_read_b64_tr_b16 a[36:37], v10 offset:16384
    buffer_load_dwordx4 v15, s[20:23], 0 offen offset:128 lds
    v_mfma_f32_16x16x32_bf16 v[108:111], a[88:91], a[16:19], v[108:111]
    s_waitcnt lgkmcnt(11)
    ds_read_b64_tr_b16 a[38:39], v10 offset:20480
    v_mfma_f32_16x16x32_bf16 v[116:119], a[88:91], a[24:27], v[116:119]
    ds_read_b64_tr_b16 a[40:41], v11 offset:0
    v_mfma_f32_16x16x32_bf16 v[116:119], a[92:95], a[28:31], v[116:119]
    s_add_u32 m0, s33, 0x1000
    ds_read_b64_tr_b16 a[42:43], v11 offset:4096
    v_mfma_f32_16x16x32_bf16 v[112:115], a[84:87], a[28:31], v[112:115]
    ds_read_b64_tr_b16 a[44:45], v11 offset:16384
    buffer_load_dwordx4 v15, s[20:23], 0 offen offset:1024 lds
    v_mfma_f32_16x16x32_bf16 v[112:115], a[80:83], a[24:27], v[112:115]
    ds_read_b64_tr_b16 a[46:47], v11 offset:20480
    v_mfma_f32_16x16x32_bf16 v[124:127], a[72:75], a[24:27], v[124:127]
    ds_read_b64_tr_b16 a[48:49], v12 offset:0
    v_mfma_f32_16x16x32_bf16 v[124:127], a[76:79], a[28:31], v[124:127]
    s_add_u32 m0, s33, 0x1780
    ds_read_b64_tr_b16 a[50:51], v12 offset:4096
    v_mfma_f32_16x16x32_bf16 v[120:123], a[68:71], a[28:31], v[120:123]
    ds_read_b64_tr_b16 a[52:53], v12 offset:16384
    buffer_load_dwordx4 v15, s[20:23], s57 offen offset:128 lds
    v_mfma_f32_16x16x32_bf16 v[120:123], a[64:67], a[24:27], v[120:123]
    s_waitcnt lgkmcnt(15)
    ds_read_b64_tr_b16 a[54:55], v12 offset:20480
    v_mfma_f32_16x16x32_bf16 v[16:19], a[96:99], a[0:3], v[16:19]
    ds_read_b64_tr_b16 a[56:57], v13 offset:0
    v_mfma_f32_16x16x32_bf16 v[16:19], a[100:103], a[4:7], v[16:19]
    s_add_u32 m0, s33, 0x1800
    ds_read_b64_tr_b16 a[58:59], v13 offset:4096
    v_mfma_f32_16x16x32_bf16 v[20:23], a[108:111], a[4:7], v[20:23]
    ds_read_b64_tr_b16 a[60:61], v13 offset:16384
    buffer_load_dwordx4 v15, s[20:23], s57 offen offset:1024 lds
    v_mfma_f32_16x16x32_bf16 v[20:23], a[104:107], a[0:3], v[20:23]
    s_waitcnt lgkmcnt(15)
    ds_read_b64_tr_b16 a[62:63], v13 offset:20480
    v_mfma_f32_16x16x32_bf16 v[24:27], a[112:115], a[0:3], v[24:27]
    v_mfma_f32_16x16x32_bf16 v[24:27], a[116:119], a[4:7], v[24:27]
    v_mfma_f32_16x16x32_bf16 v[28:31], a[124:127], a[4:7], v[28:31]
    v_mfma_f32_16x16x32_bf16 v[28:31], a[120:123], a[0:3], v[28:31]
    s_waitcnt lgkmcnt(0)
    v_mfma_f32_16x16x32_bf16 a[228:231], a[120:123], a[8:11], a[228:231]
    s_barrier
    v_mfma_f32_16x16x32_bf16 a[228:231], a[124:127], a[12:15], a[228:231]
    s_add_u32 m0, s29, 65536
    v_mfma_f32_16x16x32_bf16 a[224:227], a[116:119], a[12:15], a[224:227]
    buffer_load_dwordx4 v2, s[8:11], 0 offen lds
    v_mfma_f32_16x16x32_bf16 a[224:227], a[112:115], a[8:11], a[224:227]
    v_mfma_f32_16x16x32_bf16 a[236:239], a[104:107], a[8:11], a[236:239]
    v_mfma_f32_16x16x32_bf16 a[236:239], a[108:111], a[12:15], a[236:239]
    v_mfma_f32_16x16x32_bf16 a[232:235], a[100:103], a[12:15], a[232:235]
    s_add_u32 m0, s29, 0
    v_mfma_f32_16x16x32_bf16 a[232:235], a[96:99], a[8:11], a[232:235]
    buffer_load_dwordx4 v1, s[4:7], 0 offen lds
    v_mfma_f32_16x16x32_bf16 v[32:35], a[96:99], a[16:19], v[32:35]
    v_mfma_f32_16x16x32_bf16 v[32:35], a[100:103], a[20:23], v[32:35]
    v_mfma_f32_16x16x32_bf16 v[36:39], a[108:111], a[20:23], v[36:39]
    v_mfma_f32_16x16x32_bf16 v[36:39], a[104:107], a[16:19], v[36:39]
    s_add_u32 m0, s29, 69632
    v_mfma_f32_16x16x32_bf16 v[40:43], a[112:115], a[16:19], v[40:43]
    buffer_load_dwordx4 v2, s[8:11], s48 offen lds
    v_mfma_f32_16x16x32_bf16 v[40:43], a[116:119], a[20:23], v[40:43]
    v_mfma_f32_16x16x32_bf16 v[44:47], a[124:127], a[20:23], v[44:47]
    v_mfma_f32_16x16x32_bf16 v[44:47], a[120:123], a[16:19], v[44:47]
    v_mfma_f32_16x16x32_bf16 v[52:55], a[120:123], a[24:27], v[52:55]
    s_add_u32 m0, s29, 4096
    v_mfma_f32_16x16x32_bf16 v[52:55], a[124:127], a[28:31], v[52:55]
    buffer_load_dwordx4 v1, s[4:7], s41 offen lds
    v_mfma_f32_16x16x32_bf16 v[48:51], a[116:119], a[28:31], v[48:51]
    v_mfma_f32_16x16x32_bf16 v[48:51], a[112:115], a[24:27], v[48:51]
    v_mfma_f32_16x16x32_bf16 v[60:63], a[104:107], a[24:27], v[60:63]
    v_mfma_f32_16x16x32_bf16 v[60:63], a[108:111], a[28:31], v[60:63]
    s_add_u32 m0, s29, 73728
    v_mfma_f32_16x16x32_bf16 v[56:59], a[100:103], a[28:31], v[56:59]
    buffer_load_dwordx4 v2, s[8:11], s49 offen lds
    v_mfma_f32_16x16x32_bf16 v[56:59], a[96:99], a[24:27], v[56:59]
    v_mfma_f32_16x16x32_bf16 v[192:195], a[96:99], a[32:35], v[192:195]
    v_mfma_f32_16x16x32_bf16 v[192:195], a[100:103], a[36:39], v[192:195]
    v_mfma_f32_16x16x32_bf16 v[196:199], a[108:111], a[36:39], v[196:199]
    s_add_u32 m0, s29, 8192
    v_mfma_f32_16x16x32_bf16 v[196:199], a[104:107], a[32:35], v[196:199]
    buffer_load_dwordx4 v1, s[4:7], s42 offen lds
    v_mfma_f32_16x16x32_bf16 v[200:203], a[112:115], a[32:35], v[200:203]
    v_mfma_f32_16x16x32_bf16 v[200:203], a[116:119], a[36:39], v[200:203]
    v_mfma_f32_16x16x32_bf16 v[204:207], a[124:127], a[36:39], v[204:207]
    v_mfma_f32_16x16x32_bf16 v[204:207], a[120:123], a[32:35], v[204:207]
    s_add_u32 m0, s29, 77824
    v_mfma_f32_16x16x32_bf16 v[212:215], a[120:123], a[40:43], v[212:215]
    buffer_load_dwordx4 v2, s[8:11], s50 offen lds
    v_mfma_f32_16x16x32_bf16 v[212:215], a[124:127], a[44:47], v[212:215]
    v_mfma_f32_16x16x32_bf16 v[208:211], a[116:119], a[44:47], v[208:211]
    v_mfma_f32_16x16x32_bf16 v[208:211], a[112:115], a[40:43], v[208:211]
    v_mfma_f32_16x16x32_bf16 v[220:223], a[104:107], a[40:43], v[220:223]
    s_add_u32 m0, s29, 12288
    v_mfma_f32_16x16x32_bf16 v[220:223], a[108:111], a[44:47], v[220:223]
    buffer_load_dwordx4 v1, s[4:7], s43 offen lds
    v_mfma_f32_16x16x32_bf16 v[216:219], a[100:103], a[44:47], v[216:219]
    v_mfma_f32_16x16x32_bf16 v[216:219], a[96:99], a[40:43], v[216:219]
    v_mfma_f32_16x16x32_bf16 v[224:227], a[96:99], a[48:51], v[224:227]
    v_mfma_f32_16x16x32_bf16 v[224:227], a[100:103], a[52:55], v[224:227]
    s_add_u32 m0, s29, 81920
    v_mfma_f32_16x16x32_bf16 v[228:231], a[108:111], a[52:55], v[228:231]
    buffer_load_dwordx4 v2, s[8:11], s51 offen lds
    v_mfma_f32_16x16x32_bf16 v[228:231], a[104:107], a[48:51], v[228:231]
    v_mfma_f32_16x16x32_bf16 v[232:235], a[112:115], a[48:51], v[232:235]
    v_mfma_f32_16x16x32_bf16 v[232:235], a[116:119], a[52:55], v[232:235]
    v_mfma_f32_16x16x32_bf16 v[236:239], a[124:127], a[52:55], v[236:239]
    s_add_u32 m0, s29, 16384
    v_mfma_f32_16x16x32_bf16 v[236:239], a[120:123], a[48:51], v[236:239]
    buffer_load_dwordx4 v1, s[4:7], s44 offen lds
    v_mfma_f32_16x16x32_bf16 v[244:247], a[120:123], a[56:59], v[244:247]
    v_mfma_f32_16x16x32_bf16 v[244:247], a[124:127], a[60:63], v[244:247]
    v_mfma_f32_16x16x32_bf16 v[240:243], a[116:119], a[60:63], v[240:243]
    v_mfma_f32_16x16x32_bf16 v[240:243], a[112:115], a[56:59], v[240:243]
    s_add_u32 m0, s29, 86016
    v_mfma_f32_16x16x32_bf16 v[252:255], a[104:107], a[56:59], v[252:255]
    s_waitcnt vmcnt(10)
    buffer_load_dwordx4 v2, s[8:11], s52 offen lds
    v_mfma_f32_16x16x32_bf16 v[252:255], a[108:111], a[60:63], v[252:255]
    s_barrier
    ds_read_b64_tr_b16 a[0:1], v6 offset:32768
    v_mfma_f32_16x16x32_bf16 v[248:251], a[100:103], a[60:63], v[248:251]
    ds_read_b64_tr_b16 a[2:3], v6 offset:36864
    v_mfma_f32_16x16x32_bf16 v[248:251], a[96:99], a[56:59], v[248:251]
    ds_read_b128 a[96:99], v4 offset:40960
    v_mfma_f32_16x16x32_bf16 v[128:131], a[64:67], a[32:35], v[128:131]
    s_add_u32 m0, s29, 20480
    ds_read_b128 a[128:131], v14 offset:0
    v_mfma_f32_16x16x32_bf16 v[128:131], a[68:71], a[36:39], v[128:131]
    buffer_load_dwordx4 v1, s[4:7], s45 offen lds
    v_mfma_f32_16x16x32_bf16 v[132:135], a[76:79], a[36:39], v[132:135]
    ds_read_b64_tr_b16 a[4:5], v6 offset:49152
    v_mfma_f32_16x16x32_bf16 v[132:135], a[72:75], a[32:35], v[132:135]
    ds_read_b64_tr_b16 a[6:7], v6 offset:53248
    v_mfma_f32_16x16x32_bf16 v[136:139], a[80:83], a[32:35], v[136:139]
    ds_read_b128 a[100:103], v5 offset:40960
    v_mfma_f32_16x16x32_bf16 v[136:139], a[84:87], a[36:39], v[136:139]
    s_add_u32 m0, s29, 90112
    ds_read_b128 a[136:139], v3 offset:0
    v_mfma_f32_16x16x32_bf16 v[140:143], a[92:95], a[36:39], v[140:143]
    buffer_load_dwordx4 v2, s[8:11], s53 offen lds
    v_mfma_f32_16x16x32_bf16 v[140:143], a[88:91], a[32:35], v[140:143]
    ds_read_b128 a[108:111], v5 offset:43008
    v_mfma_f32_16x16x32_bf16 v[148:151], a[88:91], a[40:43], v[148:151]
    ds_read_b128 a[132:135], v14 offset:2048
    v_mfma_f32_16x16x32_bf16 v[148:151], a[92:95], a[44:47], v[148:151]
    ds_read_b128 a[104:107], v4 offset:43008
    v_mfma_f32_16x16x32_bf16 v[144:147], a[84:87], a[44:47], v[144:147]
    s_add_u32 m0, s29, 24576
    ds_read_b128 a[140:143], v3 offset:2048
    v_mfma_f32_16x16x32_bf16 v[144:147], a[80:83], a[40:43], v[144:147]
    buffer_load_dwordx4 v1, s[4:7], s46 offen lds
    v_mfma_f32_16x16x32_bf16 v[156:159], a[72:75], a[40:43], v[156:159]
    ds_read_b128 a[112:115], v4 offset:45056
    v_mfma_f32_16x16x32_bf16 v[156:159], a[76:79], a[44:47], v[156:159]
    ds_read_b128 a[144:147], v14 offset:4096
    v_mfma_f32_16x16x32_bf16 v[152:155], a[68:71], a[44:47], v[152:155]
    ds_read_b128 a[116:119], v5 offset:45056
    v_mfma_f32_16x16x32_bf16 v[152:155], a[64:67], a[40:43], v[152:155]
    s_add_u32 m0, s29, 94208
    ds_read_b128 a[152:155], v3 offset:4096
    v_mfma_f32_16x16x32_bf16 v[160:163], a[64:67], a[48:51], v[160:163]
    buffer_load_dwordx4 v2, s[8:11], s54 offen lds
    v_mfma_f32_16x16x32_bf16 v[160:163], a[68:71], a[52:55], v[160:163]
    ds_read_b128 a[124:127], v5 offset:47104
    v_mfma_f32_16x16x32_bf16 v[164:167], a[76:79], a[52:55], v[164:167]
    ds_read_b128 a[148:151], v14 offset:6144
    v_mfma_f32_16x16x32_bf16 v[164:167], a[72:75], a[48:51], v[164:167]
    ds_read_b128 a[120:123], v4 offset:47104
    v_mfma_f32_16x16x32_bf16 v[168:171], a[80:83], a[48:51], v[168:171]
    s_add_u32 m0, s29, 28672
    ds_read_b128 a[156:159], v3 offset:6144
    v_mfma_f32_16x16x32_bf16 v[168:171], a[84:87], a[52:55], v[168:171]
    buffer_load_dwordx4 v1, s[4:7], s47 offen lds
    v_mfma_f32_16x16x32_bf16 v[172:175], a[92:95], a[52:55], v[172:175]
    v_add_u32 v1, 128, v1
    v_add_u32 v2, 0x80000, v2
    v_mfma_f32_16x16x32_bf16 v[172:175], a[88:91], a[48:51], v[172:175]
    ds_read_b64_tr_b16 a[8:9], v7 offset:32768
    v_mfma_f32_16x16x32_bf16 v[180:183], a[88:91], a[56:59], v[180:183]
    v_mfma_f32_16x16x32_bf16 v[180:183], a[92:95], a[60:63], v[180:183]
    ds_read_b64_tr_b16 a[10:11], v7 offset:36864
    v_mfma_f32_16x16x32_bf16 v[176:179], a[84:87], a[60:63], v[176:179]
    ds_read_b64_tr_b16 a[12:13], v7 offset:49152
    v_mfma_f32_16x16x32_bf16 v[176:179], a[80:83], a[56:59], v[176:179]
    ds_read_b64_tr_b16 a[14:15], v7 offset:53248
    v_mfma_f32_16x16x32_bf16 v[188:191], a[72:75], a[56:59], v[188:191]
    ds_read_b64_tr_b16 a[16:17], v8 offset:32768
    v_mfma_f32_16x16x32_bf16 v[188:191], a[76:79], a[60:63], v[188:191]
    ds_read_b64_tr_b16 a[18:19], v8 offset:36864
    v_mfma_f32_16x16x32_bf16 v[184:187], a[68:71], a[60:63], v[184:187]
    ds_read_b64_tr_b16 a[20:21], v8 offset:49152
    v_mfma_f32_16x16x32_bf16 v[184:187], a[64:67], a[56:59], v[184:187]
    s_waitcnt lgkmcnt(15)
    ds_read_b64_tr_b16 a[22:23], v8 offset:53248
    v_mfma_f32_16x16x32_bf16 v[16:19], a[96:99], a[0:3], v[16:19]
    ds_read_b64_tr_b16 a[24:25], v9 offset:32768
    v_mfma_f32_16x16x32_bf16 v[16:19], a[100:103], a[4:7], v[16:19]
    s_add_u32 m0, s33, 0xffffff00
    ds_read_b64_tr_b16 a[26:27], v9 offset:36864
    v_mfma_f32_16x16x32_bf16 v[20:23], a[108:111], a[4:7], v[20:23]
    s_waitcnt lgkmcnt(10)
    ds_read_b64_tr_b16 a[28:29], v9 offset:49152
    v_mfma_f32_16x16x32_bf16 v[20:23], a[104:107], a[0:3], v[20:23]
    ds_read_b64_tr_b16 a[30:31], v9 offset:53248
    buffer_load_dwordx4 v15, s[20:23], 0 offen offset:256 lds
    v_mfma_f32_16x16x32_bf16 v[24:27], a[112:115], a[0:3], v[24:27]
    ds_read_b128 a[64:67], v4 offset:32768
    v_mfma_f32_16x16x32_bf16 v[24:27], a[116:119], a[4:7], v[24:27]
    v_mfma_f32_16x16x32_bf16 v[28:31], a[124:127], a[4:7], v[28:31]
    s_add_u32 m0, s33, 0xffffff80
    ds_read_b128 a[68:71], v5 offset:32768
    v_mfma_f32_16x16x32_bf16 v[28:31], a[120:123], a[0:3], v[28:31]
    s_waitcnt lgkmcnt(10)
    buffer_load_dwordx4 v15, s[20:23], 0 offen offset:1152 lds
    v_mfma_f32_16x16x32_bf16 a[228:231], a[120:123], a[8:11], a[228:231]
    ds_read_b128 a[76:79], v5 offset:34816
    v_mfma_f32_16x16x32_bf16 a[228:231], a[124:127], a[12:15], a[228:231]
    v_mfma_f32_16x16x32_bf16 a[224:227], a[116:119], a[12:15], a[224:227]
    s_add_u32 m0, s33, 0x700
    ds_read_b128 a[72:75], v4 offset:34816
    v_mfma_f32_16x16x32_bf16 a[224:227], a[112:115], a[8:11], a[224:227]
    buffer_load_dwordx4 v15, s[20:23], s57 offen offset:256 lds
    v_mfma_f32_16x16x32_bf16 a[236:239], a[104:107], a[8:11], a[236:239]
    ds_read_b128 a[80:83], v4 offset:36864
    v_mfma_f32_16x16x32_bf16 a[236:239], a[108:111], a[12:15], a[236:239]
    v_mfma_f32_16x16x32_bf16 a[232:235], a[100:103], a[12:15], a[232:235]
    s_add_u32 m0, s33, 0x780
    ds_read_b128 a[84:87], v5 offset:36864
    v_mfma_f32_16x16x32_bf16 a[232:235], a[96:99], a[8:11], a[232:235]
    s_waitcnt lgkmcnt(10)
    buffer_load_dwordx4 v15, s[20:23], s57 offen offset:1152 lds
    v_mfma_f32_16x16x32_bf16 v[32:35], a[96:99], a[16:19], v[32:35]
    ds_read_b128 a[92:95], v5 offset:38912
    v_mfma_f32_16x16x32_bf16 v[32:35], a[100:103], a[20:23], v[32:35]
    v_mfma_f32_16x16x32_bf16 v[36:39], a[108:111], a[20:23], v[36:39]
    s_add_u32 m0, s33, 0xe80
    ds_read_b128 a[88:91], v4 offset:38912
    v_mfma_f32_16x16x32_bf16 v[36:39], a[104:107], a[16:19], v[36:39]
    buffer_load_dwordx4 v15, s[20:23], 0 offen offset:384 lds
    v_mfma_f32_16x16x32_bf16 v[40:43], a[112:115], a[16:19], v[40:43]
    ds_read_b64_tr_b16 a[32:33], v10 offset:32768
    v_mfma_f32_16x16x32_bf16 v[40:43], a[116:119], a[20:23], v[40:43]
    ds_read_b64_tr_b16 a[34:35], v10 offset:36864
    v_mfma_f32_16x16x32_bf16 v[44:47], a[124:127], a[20:23], v[44:47]
    s_add_u32 m0, s33, 0xf00
    ds_read_b64_tr_b16 a[36:37], v10 offset:49152
    v_mfma_f32_16x16x32_bf16 v[44:47], a[120:123], a[16:19], v[44:47]
    s_waitcnt lgkmcnt(11)
    ds_read_b64_tr_b16 a[38:39], v10 offset:53248
    buffer_load_dwordx4 v15, s[20:23], 0 offen offset:1280 lds
    v_mfma_f32_16x16x32_bf16 v[52:55], a[120:123], a[24:27], v[52:55]
    ds_read_b64_tr_b16 a[40:41], v11 offset:32768
    v_mfma_f32_16x16x32_bf16 v[52:55], a[124:127], a[28:31], v[52:55]
    ds_read_b64_tr_b16 a[42:43], v11 offset:36864
    v_mfma_f32_16x16x32_bf16 v[48:51], a[116:119], a[28:31], v[48:51]
    s_add_u32 m0, s33, 0x1680
    ds_read_b64_tr_b16 a[44:45], v11 offset:49152
    v_mfma_f32_16x16x32_bf16 v[48:51], a[112:115], a[24:27], v[48:51]
    ds_read_b64_tr_b16 a[46:47], v11 offset:53248
    buffer_load_dwordx4 v15, s[20:23], s57 offen offset:384 lds
    v_mfma_f32_16x16x32_bf16 v[60:63], a[104:107], a[24:27], v[60:63]
    ds_read_b64_tr_b16 a[48:49], v12 offset:32768
    v_mfma_f32_16x16x32_bf16 v[60:63], a[108:111], a[28:31], v[60:63]
    ds_read_b64_tr_b16 a[50:51], v12 offset:36864
    v_mfma_f32_16x16x32_bf16 v[56:59], a[100:103], a[28:31], v[56:59]
    s_add_u32 m0, s33, 0x1700
    ds_read_b64_tr_b16 a[52:53], v12 offset:49152
    v_mfma_f32_16x16x32_bf16 v[56:59], a[96:99], a[24:27], v[56:59]
    s_waitcnt lgkmcnt(15)
    ds_read_b64_tr_b16 a[54:55], v12 offset:53248
    buffer_load_dwordx4 v15, s[20:23], s57 offen offset:1280 lds
    v_mfma_f32_16x16x32_bf16 v[64:67], a[64:67], a[0:3], v[64:67]
    ds_read_b64_tr_b16 a[56:57], v13 offset:32768
    v_mfma_f32_16x16x32_bf16 v[64:67], a[68:71], a[4:7], v[64:67]
    ds_read_b64_tr_b16 a[58:59], v13 offset:36864
    v_mfma_f32_16x16x32_bf16 v[68:71], a[76:79], a[4:7], v[68:71]
    ds_read_b64_tr_b16 a[60:61], v13 offset:49152
    v_mfma_f32_16x16x32_bf16 v[68:71], a[72:75], a[0:3], v[68:71]
    s_waitcnt lgkmcnt(15)
    ds_read_b64_tr_b16 a[62:63], v13 offset:53248
    v_mfma_f32_16x16x32_bf16 v[72:75], a[80:83], a[0:3], v[72:75]
    v_mfma_f32_16x16x32_bf16 v[72:75], a[84:87], a[4:7], v[72:75]
    v_mfma_f32_16x16x32_bf16 v[76:79], a[92:95], a[4:7], v[76:79]
    v_mfma_f32_16x16x32_bf16 v[76:79], a[88:91], a[0:3], v[76:79]
    s_waitcnt lgkmcnt(0)
    v_mfma_f32_16x16x32_bf16 v[84:87], a[88:91], a[8:11], v[84:87]
    s_barrier
    v_mfma_f32_16x16x32_bf16 v[84:87], a[92:95], a[12:15], v[84:87]
    s_add_u32 m0, s29, 98304
    v_mfma_f32_16x16x32_bf16 v[80:83], a[84:87], a[12:15], v[80:83]
    buffer_load_dwordx4 v2, s[8:11], 0 offen lds
    v_mfma_f32_16x16x32_bf16 v[80:83], a[80:83], a[8:11], v[80:83]
    v_mfma_f32_16x16x32_bf16 v[92:95], a[72:75], a[8:11], v[92:95]
    v_mfma_f32_16x16x32_bf16 v[92:95], a[76:79], a[12:15], v[92:95]
    v_mfma_f32_16x16x32_bf16 v[88:91], a[68:71], a[12:15], v[88:91]
    s_add_u32 m0, s29, 32768
    v_mfma_f32_16x16x32_bf16 v[88:91], a[64:67], a[8:11], v[88:91]
    buffer_load_dwordx4 v1, s[4:7], 0 offen lds
    v_mfma_f32_16x16x32_bf16 v[96:99], a[64:67], a[16:19], v[96:99]
    v_mfma_f32_16x16x32_bf16 v[96:99], a[68:71], a[20:23], v[96:99]
    v_mfma_f32_16x16x32_bf16 v[100:103], a[76:79], a[20:23], v[100:103]
    v_mfma_f32_16x16x32_bf16 v[100:103], a[72:75], a[16:19], v[100:103]
    s_add_u32 m0, s29, 102400
    v_mfma_f32_16x16x32_bf16 v[104:107], a[80:83], a[16:19], v[104:107]
    buffer_load_dwordx4 v2, s[8:11], s48 offen lds
    v_mfma_f32_16x16x32_bf16 v[104:107], a[84:87], a[20:23], v[104:107]
    v_mfma_f32_16x16x32_bf16 v[108:111], a[92:95], a[20:23], v[108:111]
    v_mfma_f32_16x16x32_bf16 v[108:111], a[88:91], a[16:19], v[108:111]
    v_mfma_f32_16x16x32_bf16 v[116:119], a[88:91], a[24:27], v[116:119]
    s_add_u32 m0, s29, 36864
    v_mfma_f32_16x16x32_bf16 v[116:119], a[92:95], a[28:31], v[116:119]
    buffer_load_dwordx4 v1, s[4:7], s41 offen lds
    v_mfma_f32_16x16x32_bf16 v[112:115], a[84:87], a[28:31], v[112:115]
    v_mfma_f32_16x16x32_bf16 v[112:115], a[80:83], a[24:27], v[112:115]
    v_mfma_f32_16x16x32_bf16 v[124:127], a[72:75], a[24:27], v[124:127]
    v_mfma_f32_16x16x32_bf16 v[124:127], a[76:79], a[28:31], v[124:127]
    s_add_u32 m0, s29, 106496
    v_mfma_f32_16x16x32_bf16 v[120:123], a[68:71], a[28:31], v[120:123]
    buffer_load_dwordx4 v2, s[8:11], s49 offen lds
    v_mfma_f32_16x16x32_bf16 v[120:123], a[64:67], a[24:27], v[120:123]
    v_mfma_f32_16x16x32_bf16 v[128:131], a[64:67], a[32:35], v[128:131]
    v_mfma_f32_16x16x32_bf16 v[128:131], a[68:71], a[36:39], v[128:131]
    v_mfma_f32_16x16x32_bf16 v[132:135], a[76:79], a[36:39], v[132:135]
    s_add_u32 m0, s29, 40960
    v_mfma_f32_16x16x32_bf16 v[132:135], a[72:75], a[32:35], v[132:135]
    buffer_load_dwordx4 v1, s[4:7], s42 offen lds
    v_mfma_f32_16x16x32_bf16 v[136:139], a[80:83], a[32:35], v[136:139]
    v_mfma_f32_16x16x32_bf16 v[136:139], a[84:87], a[36:39], v[136:139]
    v_mfma_f32_16x16x32_bf16 v[140:143], a[92:95], a[36:39], v[140:143]
    v_mfma_f32_16x16x32_bf16 v[140:143], a[88:91], a[32:35], v[140:143]
    s_add_u32 m0, s29, 110592
    v_mfma_f32_16x16x32_bf16 v[148:151], a[88:91], a[40:43], v[148:151]
    buffer_load_dwordx4 v2, s[8:11], s50 offen lds
    v_mfma_f32_16x16x32_bf16 v[148:151], a[92:95], a[44:47], v[148:151]
    v_mfma_f32_16x16x32_bf16 v[144:147], a[84:87], a[44:47], v[144:147]
    v_mfma_f32_16x16x32_bf16 v[144:147], a[80:83], a[40:43], v[144:147]
    v_mfma_f32_16x16x32_bf16 v[156:159], a[72:75], a[40:43], v[156:159]
    s_add_u32 m0, s29, 45056
    v_mfma_f32_16x16x32_bf16 v[156:159], a[76:79], a[44:47], v[156:159]
    buffer_load_dwordx4 v1, s[4:7], s43 offen lds
    v_mfma_f32_16x16x32_bf16 v[152:155], a[68:71], a[44:47], v[152:155]
    v_mfma_f32_16x16x32_bf16 v[152:155], a[64:67], a[40:43], v[152:155]
    v_mfma_f32_16x16x32_bf16 v[160:163], a[64:67], a[48:51], v[160:163]
    v_mfma_f32_16x16x32_bf16 v[160:163], a[68:71], a[52:55], v[160:163]
    s_add_u32 m0, s29, 114688
    v_mfma_f32_16x16x32_bf16 v[164:167], a[76:79], a[52:55], v[164:167]
    buffer_load_dwordx4 v2, s[8:11], s51 offen lds
    v_mfma_f32_16x16x32_bf16 v[164:167], a[72:75], a[48:51], v[164:167]
    v_mfma_f32_16x16x32_bf16 v[168:171], a[80:83], a[48:51], v[168:171]
    v_mfma_f32_16x16x32_bf16 v[168:171], a[84:87], a[52:55], v[168:171]
    v_mfma_f32_16x16x32_bf16 v[172:175], a[92:95], a[52:55], v[172:175]
    s_add_u32 m0, s29, 49152
    v_mfma_f32_16x16x32_bf16 v[172:175], a[88:91], a[48:51], v[172:175]
    buffer_load_dwordx4 v1, s[4:7], s44 offen lds
    v_mfma_f32_16x16x32_bf16 v[180:183], a[88:91], a[56:59], v[180:183]
    v_mfma_f32_16x16x32_bf16 v[180:183], a[92:95], a[60:63], v[180:183]
    v_mfma_f32_16x16x32_bf16 v[176:179], a[84:87], a[60:63], v[176:179]
    v_mfma_f32_16x16x32_bf16 v[176:179], a[80:83], a[56:59], v[176:179]
    s_add_u32 m0, s29, 118784
    v_mfma_f32_16x16x32_bf16 v[188:191], a[72:75], a[56:59], v[188:191]
    s_waitcnt vmcnt(10)
    buffer_load_dwordx4 v2, s[8:11], s52 offen lds
    v_mfma_f32_16x16x32_bf16 v[188:191], a[76:79], a[60:63], v[188:191]
    s_barrier
    ds_read_b64_tr_b16 a[0:1], v6 offset:0
    v_mfma_f32_16x16x32_bf16 v[184:187], a[68:71], a[60:63], v[184:187]
    ds_read_b64_tr_b16 a[2:3], v6 offset:4096
    v_mfma_f32_16x16x32_bf16 v[184:187], a[64:67], a[56:59], v[184:187]
    ds_read_b128 a[64:67], v4 offset:0
    v_mfma_f32_16x16x32_bf16 v[192:195], a[96:99], a[32:35], v[192:195]
    s_add_u32 m0, s29, 53248
    ds_read_b128 a[160:163], v14 offset:0
    v_mfma_f32_16x16x32_bf16 v[192:195], a[100:103], a[36:39], v[192:195]
    buffer_load_dwordx4 v1, s[4:7], s45 offen lds
    v_mfma_f32_16x16x32_bf16 v[196:199], a[108:111], a[36:39], v[196:199]
    ds_read_b64_tr_b16 a[4:5], v6 offset:16384
    v_mfma_f32_16x16x32_bf16 v[196:199], a[104:107], a[32:35], v[196:199]
    ds_read_b64_tr_b16 a[6:7], v6 offset:20480
    v_mfma_f32_16x16x32_bf16 v[200:203], a[112:115], a[32:35], v[200:203]
    ds_read_b128 a[68:71], v5 offset:0
    v_mfma_f32_16x16x32_bf16 v[200:203], a[116:119], a[36:39], v[200:203]
    s_add_u32 m0, s29, 122880
    ds_read_b128 a[168:171], v3 offset:0
    v_mfma_f32_16x16x32_bf16 v[204:207], a[124:127], a[36:39], v[204:207]
    buffer_load_dwordx4 v2, s[8:11], s53 offen lds
    v_mfma_f32_16x16x32_bf16 v[204:207], a[120:123], a[32:35], v[204:207]
    ds_read_b128 a[76:79], v5 offset:2048
    v_mfma_f32_16x16x32_bf16 v[212:215], a[120:123], a[40:43], v[212:215]
    ds_read_b128 a[164:167], v14 offset:2048
    v_mfma_f32_16x16x32_bf16 v[212:215], a[124:127], a[44:47], v[212:215]
    ds_read_b128 a[72:75], v4 offset:2048
    v_mfma_f32_16x16x32_bf16 v[208:211], a[116:119], a[44:47], v[208:211]
    s_add_u32 m0, s29, 57344
    ds_read_b128 a[172:175], v3 offset:2048
    v_mfma_f32_16x16x32_bf16 v[208:211], a[112:115], a[40:43], v[208:211]
    buffer_load_dwordx4 v1, s[4:7], s46 offen lds
    v_mfma_f32_16x16x32_bf16 v[220:223], a[104:107], a[40:43], v[220:223]
    ds_read_b128 a[80:83], v4 offset:4096
    v_mfma_f32_16x16x32_bf16 v[220:223], a[108:111], a[44:47], v[220:223]
    ds_read_b128 a[176:179], v14 offset:4096
    v_mfma_f32_16x16x32_bf16 v[216:219], a[100:103], a[44:47], v[216:219]
    ds_read_b128 a[84:87], v5 offset:4096
    v_mfma_f32_16x16x32_bf16 v[216:219], a[96:99], a[40:43], v[216:219]
    s_add_u32 m0, s29, 126976
    ds_read_b128 a[184:187], v3 offset:4096
    v_mfma_f32_16x16x32_bf16 v[224:227], a[96:99], a[48:51], v[224:227]
    buffer_load_dwordx4 v2, s[8:11], s54 offen lds
    v_mfma_f32_16x16x32_bf16 v[224:227], a[100:103], a[52:55], v[224:227]
    ds_read_b128 a[92:95], v5 offset:6144
    v_mfma_f32_16x16x32_bf16 v[228:231], a[108:111], a[52:55], v[228:231]
    ds_read_b128 a[180:183], v14 offset:6144
    v_mfma_f32_16x16x32_bf16 v[228:231], a[104:107], a[48:51], v[228:231]
    ds_read_b128 a[88:91], v4 offset:6144
    v_mfma_f32_16x16x32_bf16 v[232:235], a[112:115], a[48:51], v[232:235]
    s_add_u32 m0, s29, 61440
    ds_read_b128 a[188:191], v3 offset:6144
    v_mfma_f32_16x16x32_bf16 v[232:235], a[116:119], a[52:55], v[232:235]
    buffer_load_dwordx4 v1, s[4:7], s47 offen lds
    v_mfma_f32_16x16x32_bf16 v[236:239], a[124:127], a[52:55], v[236:239]
    v_add_u32 v1, 128, v1
    v_add_u32 v2, 0x80000, v2
    v_mfma_f32_16x16x32_bf16 v[236:239], a[120:123], a[48:51], v[236:239]
    ds_read_b64_tr_b16 a[8:9], v7 offset:0
    v_mfma_f32_16x16x32_bf16 v[244:247], a[120:123], a[56:59], v[244:247]
    v_mfma_f32_16x16x32_bf16 v[244:247], a[124:127], a[60:63], v[244:247]
    ds_read_b64_tr_b16 a[10:11], v7 offset:4096
    v_mfma_f32_16x16x32_bf16 v[240:243], a[116:119], a[60:63], v[240:243]
    ds_read_b64_tr_b16 a[12:13], v7 offset:16384
    v_mfma_f32_16x16x32_bf16 v[240:243], a[112:115], a[56:59], v[240:243]
    ds_read_b64_tr_b16 a[14:15], v7 offset:20480
    v_mfma_f32_16x16x32_bf16 v[252:255], a[104:107], a[56:59], v[252:255]
    ds_read_b64_tr_b16 a[16:17], v8 offset:0
    v_mfma_f32_16x16x32_bf16 v[252:255], a[108:111], a[60:63], v[252:255]
    ds_read_b64_tr_b16 a[18:19], v8 offset:4096
    v_mfma_f32_16x16x32_bf16 v[248:251], a[100:103], a[60:63], v[248:251]
    ds_read_b64_tr_b16 a[20:21], v8 offset:16384
    v_mfma_f32_16x16x32_bf16 v[248:251], a[96:99], a[56:59], v[248:251]
    s_waitcnt lgkmcnt(15)
    ds_read_b64_tr_b16 a[22:23], v8 offset:20480
    v_mfma_f32_16x16x32_bf16 v[64:67], a[64:67], a[0:3], v[64:67]
    ds_read_b64_tr_b16 a[24:25], v9 offset:0
    v_lshlrev_b32 v1, 4, v0
    v_mfma_f32_16x16x32_bf16 v[64:67], a[68:71], a[4:7], v[64:67]
    s_add_u32 m0, s33, 0xfffffe00
    ds_read_b64_tr_b16 a[26:27], v9 offset:4096
    v_mfma_f32_16x16x32_bf16 v[68:71], a[76:79], a[4:7], v[68:71]
    s_waitcnt lgkmcnt(10)
    ds_read_b64_tr_b16 a[28:29], v9 offset:16384
    v_mfma_f32_16x16x32_bf16 v[68:71], a[72:75], a[0:3], v[68:71]
    ds_read_b64_tr_b16 a[30:31], v9 offset:20480
    buffer_load_dwordx4 v15, s[20:23], 0 offen offset:512 lds
    v_mfma_f32_16x16x32_bf16 v[72:75], a[80:83], a[0:3], v[72:75]
    ds_read_b128 a[96:99], v4 offset:8192
    v_mfma_f32_16x16x32_bf16 v[72:75], a[84:87], a[4:7], v[72:75]
    v_mfma_f32_16x16x32_bf16 v[76:79], a[92:95], a[4:7], v[76:79]
    s_add_u32 m0, s33, 0xfffffe80
    ds_read_b128 a[100:103], v5 offset:8192
    v_mfma_f32_16x16x32_bf16 v[76:79], a[88:91], a[0:3], v[76:79]
    s_waitcnt lgkmcnt(10)
    buffer_load_dwordx4 v15, s[20:23], 0 offen offset:1408 lds
    v_mfma_f32_16x16x32_bf16 v[84:87], a[88:91], a[8:11], v[84:87]
    ds_read_b128 a[108:111], v5 offset:10240
    v_mfma_f32_16x16x32_bf16 v[84:87], a[92:95], a[12:15], v[84:87]
    v_mfma_f32_16x16x32_bf16 v[80:83], a[84:87], a[12:15], v[80:83]
    s_add_u32 m0, s33, 0x600
    ds_read_b128 a[104:107], v4 offset:10240
    v_mfma_f32_16x16x32_bf16 v[80:83], a[80:83], a[8:11], v[80:83]
    buffer_load_dwordx4 v15, s[20:23], s57 offen offset:512 lds
    v_mfma_f32_16x16x32_bf16 v[92:95], a[72:75], a[8:11], v[92:95]
    ds_read_b128 a[112:115], v4 offset:12288
    v_mfma_f32_16x16x32_bf16 v[92:95], a[76:79], a[12:15], v[92:95]
    v_mfma_f32_16x16x32_bf16 v[88:91], a[68:71], a[12:15], v[88:91]
    s_add_u32 m0, s33, 0x680
    ds_read_b128 a[116:119], v5 offset:12288
    v_mfma_f32_16x16x32_bf16 v[88:91], a[64:67], a[8:11], v[88:91]
    s_waitcnt lgkmcnt(10)
    buffer_load_dwordx4 v15, s[20:23], s57 offen offset:1408 lds
    v_mfma_f32_16x16x32_bf16 v[96:99], a[64:67], a[16:19], v[96:99]
    ds_read_b128 a[124:127], v5 offset:14336
    v_mfma_f32_16x16x32_bf16 v[96:99], a[68:71], a[20:23], v[96:99]
    v_mfma_f32_16x16x32_bf16 v[100:103], a[76:79], a[20:23], v[100:103]
    s_add_u32 m0, s33, 0xd80
    ds_read_b128 a[120:123], v4 offset:14336
    v_mfma_f32_16x16x32_bf16 v[100:103], a[72:75], a[16:19], v[100:103]
    buffer_load_dwordx4 v15, s[20:23], 0 offen offset:640 lds
    v_mfma_f32_16x16x32_bf16 v[104:107], a[80:83], a[16:19], v[104:107]
    ds_read_b64_tr_b16 a[32:33], v10 offset:0
    v_mfma_f32_16x16x32_bf16 v[104:107], a[84:87], a[20:23], v[104:107]
    ds_read_b64_tr_b16 a[34:35], v10 offset:4096
    v_mfma_f32_16x16x32_bf16 v[108:111], a[92:95], a[20:23], v[108:111]
    s_add_u32 m0, s33, 0xe00
    ds_read_b64_tr_b16 a[36:37], v10 offset:16384
    v_mfma_f32_16x16x32_bf16 v[108:111], a[88:91], a[16:19], v[108:111]
    s_waitcnt lgkmcnt(11)
    ds_read_b64_tr_b16 a[38:39], v10 offset:20480
    buffer_load_dwordx4 v15, s[20:23], 0 offen offset:1536 lds
    v_mfma_f32_16x16x32_bf16 v[116:119], a[88:91], a[24:27], v[116:119]
    ds_read_b64_tr_b16 a[40:41], v11 offset:0
    v_mfma_f32_16x16x32_bf16 v[116:119], a[92:95], a[28:31], v[116:119]
    ds_read_b64_tr_b16 a[42:43], v11 offset:4096
    v_mfma_f32_16x16x32_bf16 v[112:115], a[84:87], a[28:31], v[112:115]
    s_add_u32 m0, s33, 0x1580
    ds_read_b64_tr_b16 a[44:45], v11 offset:16384
    v_mfma_f32_16x16x32_bf16 v[112:115], a[80:83], a[24:27], v[112:115]
    ds_read_b64_tr_b16 a[46:47], v11 offset:20480
    buffer_load_dwordx4 v15, s[20:23], s57 offen offset:640 lds
    v_mfma_f32_16x16x32_bf16 v[124:127], a[72:75], a[24:27], v[124:127]
    ds_read_b64_tr_b16 a[48:49], v12 offset:0
    v_mfma_f32_16x16x32_bf16 v[124:127], a[76:79], a[28:31], v[124:127]
    ds_read_b64_tr_b16 a[50:51], v12 offset:4096
    v_mfma_f32_16x16x32_bf16 v[120:123], a[68:71], a[28:31], v[120:123]
    s_add_u32 m0, s33, 0x1600
    ds_read_b64_tr_b16 a[52:53], v12 offset:16384
    v_mfma_f32_16x16x32_bf16 v[120:123], a[64:67], a[24:27], v[120:123]
    s_waitcnt lgkmcnt(15)
    ds_read_b64_tr_b16 a[54:55], v12 offset:20480
    buffer_load_dwordx4 v15, s[20:23], s57 offen offset:1536 lds
    v_mfma_f32_16x16x32_bf16 v[16:19], a[96:99], a[0:3], v[16:19]
    ds_read_b64_tr_b16 a[56:57], v13 offset:0
    v_mfma_f32_16x16x32_bf16 v[16:19], a[100:103], a[4:7], v[16:19]
    ds_read_b64_tr_b16 a[58:59], v13 offset:4096
    v_mfma_f32_16x16x32_bf16 v[20:23], a[108:111], a[4:7], v[20:23]
    ds_read_b64_tr_b16 a[60:61], v13 offset:16384
    v_mfma_f32_16x16x32_bf16 v[20:23], a[104:107], a[0:3], v[20:23]
    s_waitcnt lgkmcnt(15)
    ds_read_b64_tr_b16 a[62:63], v13 offset:20480
    v_mfma_f32_16x16x32_bf16 v[24:27], a[112:115], a[0:3], v[24:27]
    v_mfma_f32_16x16x32_bf16 v[24:27], a[116:119], a[4:7], v[24:27]
    v_mfma_f32_16x16x32_bf16 v[28:31], a[124:127], a[4:7], v[28:31]
    v_mfma_f32_16x16x32_bf16 v[28:31], a[120:123], a[0:3], v[28:31]
    s_waitcnt lgkmcnt(0)
    v_mfma_f32_16x16x32_bf16 a[228:231], a[120:123], a[8:11], a[228:231]
    s_barrier
    v_mfma_f32_16x16x32_bf16 a[228:231], a[124:127], a[12:15], a[228:231]
    s_add_u32 m0, s29, 0
    v_add_u32 v2, 0xff800000, v2
    v_mfma_f32_16x16x32_bf16 a[224:227], a[116:119], a[12:15], a[224:227]
    buffer_load_dwordx4 v2, s[16:19], 0 offen lds
    v_mfma_f32_16x16x32_bf16 a[224:227], a[112:115], a[8:11], a[224:227]
    v_mfma_f32_16x16x32_bf16 a[236:239], a[104:107], a[8:11], a[236:239]
    v_mfma_f32_16x16x32_bf16 a[236:239], a[108:111], a[12:15], a[236:239]
    v_mfma_f32_16x16x32_bf16 a[232:235], a[100:103], a[12:15], a[232:235]
    s_add_u32 m0, s29, 4096
    v_mfma_f32_16x16x32_bf16 a[232:235], a[96:99], a[8:11], a[232:235]
    buffer_load_dwordx4 v2, s[16:19], s48 offen lds
    v_mfma_f32_16x16x32_bf16 v[32:35], a[96:99], a[16:19], v[32:35]
    v_mfma_f32_16x16x32_bf16 v[32:35], a[100:103], a[20:23], v[32:35]
    v_mfma_f32_16x16x32_bf16 v[36:39], a[108:111], a[20:23], v[36:39]
    v_mfma_f32_16x16x32_bf16 v[36:39], a[104:107], a[16:19], v[36:39]
    s_add_u32 m0, s29, 8192
    v_mfma_f32_16x16x32_bf16 v[40:43], a[112:115], a[16:19], v[40:43]
    buffer_load_dwordx4 v2, s[16:19], s49 offen lds
    v_mfma_f32_16x16x32_bf16 v[40:43], a[116:119], a[20:23], v[40:43]
    v_mfma_f32_16x16x32_bf16 v[44:47], a[124:127], a[20:23], v[44:47]
    v_mfma_f32_16x16x32_bf16 v[44:47], a[120:123], a[16:19], v[44:47]
    v_mfma_f32_16x16x32_bf16 v[52:55], a[120:123], a[24:27], v[52:55]
    s_add_u32 m0, s29, 12288
    v_mfma_f32_16x16x32_bf16 v[52:55], a[124:127], a[28:31], v[52:55]
    buffer_load_dwordx4 v2, s[16:19], s50 offen lds
    v_mfma_f32_16x16x32_bf16 v[48:51], a[116:119], a[28:31], v[48:51]
    v_mfma_f32_16x16x32_bf16 v[48:51], a[112:115], a[24:27], v[48:51]
    v_mfma_f32_16x16x32_bf16 v[60:63], a[104:107], a[24:27], v[60:63]
    v_mfma_f32_16x16x32_bf16 v[60:63], a[108:111], a[28:31], v[60:63]
    s_add_u32 m0, s29, 16384
    v_mfma_f32_16x16x32_bf16 v[56:59], a[100:103], a[28:31], v[56:59]
    buffer_load_dwordx4 v2, s[16:19], s51 offen lds
    v_mfma_f32_16x16x32_bf16 v[56:59], a[96:99], a[24:27], v[56:59]
    v_mfma_f32_16x16x32_bf16 v[192:195], a[96:99], a[32:35], v[192:195]
    v_mfma_f32_16x16x32_bf16 v[192:195], a[100:103], a[36:39], v[192:195]
    v_mfma_f32_16x16x32_bf16 v[196:199], a[108:111], a[36:39], v[196:199]
    s_add_u32 m0, s29, 20480
    v_mfma_f32_16x16x32_bf16 v[196:199], a[104:107], a[32:35], v[196:199]
    buffer_load_dwordx4 v2, s[16:19], s52 offen lds
    v_mfma_f32_16x16x32_bf16 v[200:203], a[112:115], a[32:35], v[200:203]
    v_mfma_f32_16x16x32_bf16 v[200:203], a[116:119], a[36:39], v[200:203]
    v_mfma_f32_16x16x32_bf16 v[204:207], a[124:127], a[36:39], v[204:207]
    v_mfma_f32_16x16x32_bf16 v[204:207], a[120:123], a[32:35], v[204:207]
    s_add_u32 m0, s29, 24576
    v_mfma_f32_16x16x32_bf16 v[212:215], a[120:123], a[40:43], v[212:215]
    buffer_load_dwordx4 v2, s[16:19], s53 offen lds
    v_mfma_f32_16x16x32_bf16 v[212:215], a[124:127], a[44:47], v[212:215]
    v_mfma_f32_16x16x32_bf16 v[208:211], a[116:119], a[44:47], v[208:211]
    v_mfma_f32_16x16x32_bf16 v[208:211], a[112:115], a[40:43], v[208:211]
    v_mfma_f32_16x16x32_bf16 v[220:223], a[104:107], a[40:43], v[220:223]
    s_add_u32 m0, s29, 28672
    v_mfma_f32_16x16x32_bf16 v[220:223], a[108:111], a[44:47], v[220:223]
    buffer_load_dwordx4 v2, s[16:19], s54 offen lds
    v_mfma_f32_16x16x32_bf16 v[216:219], a[100:103], a[44:47], v[216:219]
    v_mfma_f32_16x16x32_bf16 v[216:219], a[96:99], a[40:43], v[216:219]
    v_mfma_f32_16x16x32_bf16 v[224:227], a[96:99], a[48:51], v[224:227]
    s_add_u32 m0, s29, 65536
    v_add_u32 v2, 0x80000, v2
    v_mfma_f32_16x16x32_bf16 v[224:227], a[100:103], a[52:55], v[224:227]
    buffer_load_dwordx4 v2, s[16:19], 0 offen lds
    v_mfma_f32_16x16x32_bf16 v[228:231], a[108:111], a[52:55], v[228:231]
    v_mfma_f32_16x16x32_bf16 v[228:231], a[104:107], a[48:51], v[228:231]
    v_mfma_f32_16x16x32_bf16 v[232:235], a[112:115], a[48:51], v[232:235]
    v_mfma_f32_16x16x32_bf16 v[232:235], a[116:119], a[52:55], v[232:235]
    s_add_u32 m0, s29, 69632
    v_mfma_f32_16x16x32_bf16 v[236:239], a[124:127], a[52:55], v[236:239]
    buffer_load_dwordx4 v2, s[16:19], s48 offen lds
    v_mfma_f32_16x16x32_bf16 v[236:239], a[120:123], a[48:51], v[236:239]
    v_mfma_f32_16x16x32_bf16 v[244:247], a[120:123], a[56:59], v[244:247]
    v_mfma_f32_16x16x32_bf16 v[244:247], a[124:127], a[60:63], v[244:247]
    v_mfma_f32_16x16x32_bf16 v[240:243], a[116:119], a[60:63], v[240:243]
    s_add_u32 m0, s29, 73728
    v_mfma_f32_16x16x32_bf16 v[240:243], a[112:115], a[56:59], v[240:243]
    buffer_load_dwordx4 v2, s[16:19], s49 offen lds
    v_mfma_f32_16x16x32_bf16 v[252:255], a[104:107], a[56:59], v[252:255]
    s_waitcnt vmcnt(11)
    v_mfma_f32_16x16x32_bf16 v[252:255], a[108:111], a[60:63], v[252:255]
    s_barrier
    ds_read_b64_tr_b16 a[0:1], v6 offset:32768
    v_mfma_f32_16x16x32_bf16 v[248:251], a[100:103], a[60:63], v[248:251]
    ds_read_b64_tr_b16 a[2:3], v6 offset:36864
    v_mfma_f32_16x16x32_bf16 v[248:251], a[96:99], a[56:59], v[248:251]
    s_add_u32 m0, s29, 77824
    ds_read_b128 a[96:99], v4 offset:40960
    v_mfma_f32_16x16x32_bf16 v[128:131], a[64:67], a[32:35], v[128:131]
    ds_read_b128 a[192:195], v14 offset:0
    buffer_load_dwordx4 v2, s[16:19], s50 offen lds
    v_mfma_f32_16x16x32_bf16 v[128:131], a[68:71], a[36:39], v[128:131]
    ds_read_b128 a[200:203], v3 offset:0
    v_mfma_f32_16x16x32_bf16 v[132:135], a[76:79], a[36:39], v[132:135]
    ds_read_b64_tr_b16 a[4:5], v6 offset:49152
    v_mfma_f32_16x16x32_bf16 v[132:135], a[72:75], a[32:35], v[132:135]
    ds_read_b64_tr_b16 a[6:7], v6 offset:53248
    v_mfma_f32_16x16x32_bf16 v[136:139], a[80:83], a[32:35], v[136:139]
    s_add_u32 m0, s29, 81920
    ds_read_b128 a[100:103], v5 offset:40960
    v_mfma_f32_16x16x32_bf16 v[136:139], a[84:87], a[36:39], v[136:139]
    ds_read_b128 a[196:199], v14 offset:2048
    buffer_load_dwordx4 v2, s[16:19], s51 offen lds
    v_mfma_f32_16x16x32_bf16 v[140:143], a[92:95], a[36:39], v[140:143]
    ds_read_b128 a[204:207], v3 offset:2048
    v_mfma_f32_16x16x32_bf16 v[140:143], a[88:91], a[32:35], v[140:143]
    ds_read_b128 a[108:111], v5 offset:43008
    v_mfma_f32_16x16x32_bf16 v[148:151], a[88:91], a[40:43], v[148:151]
    ds_read_b128 a[208:211], v14 offset:4096
    v_mfma_f32_16x16x32_bf16 v[148:151], a[92:95], a[44:47], v[148:151]
    s_add_u32 m0, s29, 86016
    ds_read_b128 a[104:107], v4 offset:43008
    v_mfma_f32_16x16x32_bf16 v[144:147], a[84:87], a[44:47], v[144:147]
    ds_read_b128 a[216:219], v3 offset:4096
    buffer_load_dwordx4 v2, s[16:19], s52 offen lds
    v_mfma_f32_16x16x32_bf16 v[144:147], a[80:83], a[40:43], v[144:147]
    ds_read_b128 a[212:215], v14 offset:6144
    v_mfma_f32_16x16x32_bf16 v[156:159], a[72:75], a[40:43], v[156:159]
    ds_read_b128 a[112:115], v4 offset:45056
    v_mfma_f32_16x16x32_bf16 v[156:159], a[76:79], a[44:47], v[156:159]
    ds_read_b128 a[220:223], v3 offset:6144
    v_mfma_f32_16x16x32_bf16 v[152:155], a[68:71], a[44:47], v[152:155]
    s_add_u32 m0, s29, 90112
    ds_read_b128 a[116:119], v5 offset:45056
    v_mfma_f32_16x16x32_bf16 v[152:155], a[64:67], a[40:43], v[152:155]
    buffer_load_dwordx4 v2, s[16:19], s53 offen lds
    v_mfma_f32_16x16x32_bf16 v[160:163], a[64:67], a[48:51], v[160:163]
    v_mfma_f32_16x16x32_bf16 v[160:163], a[68:71], a[52:55], v[160:163]
    ds_read_b128 a[124:127], v5 offset:47104
    v_mfma_f32_16x16x32_bf16 v[164:167], a[76:79], a[52:55], v[164:167]
    v_mfma_f32_16x16x32_bf16 v[164:167], a[72:75], a[48:51], v[164:167]
    s_add_u32 m0, s29, 94208
    ds_read_b128 a[120:123], v4 offset:47104
    v_mfma_f32_16x16x32_bf16 v[168:171], a[80:83], a[48:51], v[168:171]
    buffer_load_dwordx4 v2, s[16:19], s54 offen lds
    v_mfma_f32_16x16x32_bf16 v[168:171], a[84:87], a[52:55], v[168:171]
    v_mfma_f32_16x16x32_bf16 v[172:175], a[92:95], a[52:55], v[172:175]
    v_mfma_f32_16x16x32_bf16 v[172:175], a[88:91], a[48:51], v[172:175]
    ds_read_b64_tr_b16 a[8:9], v7 offset:32768
    v_mfma_f32_16x16x32_bf16 v[180:183], a[88:91], a[56:59], v[180:183]
    v_mfma_f32_16x16x32_bf16 v[180:183], a[92:95], a[60:63], v[180:183]
    ds_read_b64_tr_b16 a[10:11], v7 offset:36864
    v_mfma_f32_16x16x32_bf16 v[176:179], a[84:87], a[60:63], v[176:179]
    ds_read_b64_tr_b16 a[12:13], v7 offset:49152
    v_mfma_f32_16x16x32_bf16 v[176:179], a[80:83], a[56:59], v[176:179]
    ds_read_b64_tr_b16 a[14:15], v7 offset:53248
    v_mfma_f32_16x16x32_bf16 v[188:191], a[72:75], a[56:59], v[188:191]
    ds_read_b64_tr_b16 a[16:17], v8 offset:32768
    v_mfma_f32_16x16x32_bf16 v[188:191], a[76:79], a[60:63], v[188:191]
    ds_read_b64_tr_b16 a[18:19], v8 offset:36864
    v_mfma_f32_16x16x32_bf16 v[184:187], a[68:71], a[60:63], v[184:187]
    ds_read_b64_tr_b16 a[20:21], v8 offset:49152
    v_mfma_f32_16x16x32_bf16 v[184:187], a[64:67], a[56:59], v[184:187]
    s_waitcnt lgkmcnt(15)
    ds_read_b64_tr_b16 a[22:23], v8 offset:53248
    v_mfma_f32_16x16x32_bf16 v[16:19], a[96:99], a[0:3], v[16:19]
    ds_read_b64_tr_b16 a[24:25], v9 offset:32768
    v_mfma_f32_16x16x32_bf16 v[16:19], a[100:103], a[4:7], v[16:19]
    s_add_u32 m0, s33, 0xfffffd00
    ds_read_b64_tr_b16 a[26:27], v9 offset:36864
    v_mfma_f32_16x16x32_bf16 v[20:23], a[108:111], a[4:7], v[20:23]
    s_waitcnt lgkmcnt(13)
    ds_read_b64_tr_b16 a[28:29], v9 offset:49152
    v_mfma_f32_16x16x32_bf16 v[20:23], a[104:107], a[0:3], v[20:23]
    ds_read_b64_tr_b16 a[30:31], v9 offset:53248
    buffer_load_dwordx4 v15, s[20:23], 0 offen offset:768 lds
    v_mfma_f32_16x16x32_bf16 v[24:27], a[112:115], a[0:3], v[24:27]
    s_waitcnt lgkmcnt(12)
    ds_read_b128 a[64:67], v4 offset:32768
    v_mfma_f32_16x16x32_bf16 v[24:27], a[116:119], a[4:7], v[24:27]
    v_mfma_f32_16x16x32_bf16 v[28:31], a[124:127], a[4:7], v[28:31]
    s_add_u32 m0, s33, 0xfffffd80
    ds_read_b128 a[68:71], v5 offset:32768
    v_mfma_f32_16x16x32_bf16 v[28:31], a[120:123], a[0:3], v[28:31]
    s_waitcnt lgkmcnt(10)
    buffer_load_dwordx4 v15, s[20:23], 0 offen offset:1664 lds
    v_mfma_f32_16x16x32_bf16 a[228:231], a[120:123], a[8:11], a[228:231]
    ds_read_b128 a[76:79], v5 offset:34816
    v_mfma_f32_16x16x32_bf16 a[228:231], a[124:127], a[12:15], a[228:231]
    v_mfma_f32_16x16x32_bf16 a[224:227], a[116:119], a[12:15], a[224:227]
    s_add_u32 m0, s33, 0x500
    ds_read_b128 a[72:75], v4 offset:34816
    v_mfma_f32_16x16x32_bf16 a[224:227], a[112:115], a[8:11], a[224:227]
    buffer_load_dwordx4 v15, s[20:23], s57 offen offset:768 lds
    v_mfma_f32_16x16x32_bf16 a[236:239], a[104:107], a[8:11], a[236:239]
    ds_read_b128 a[80:83], v4 offset:36864
    v_cvt_pk_bf16_f32 v16, v16, v17
    v_mfma_f32_16x16x32_bf16 a[236:239], a[108:111], a[12:15], a[236:239]
    v_cvt_pk_bf16_f32 v17, v18, v19
    v_cvt_pk_bf16_f32 v18, v20, v21
    v_mfma_f32_16x16x32_bf16 a[232:235], a[100:103], a[12:15], a[232:235]
    s_add_u32 m0, s33, 0x580
    ds_read_b128 a[84:87], v5 offset:36864
    v_cvt_pk_bf16_f32 v19, v22, v23
    v_mfma_f32_16x16x32_bf16 a[232:235], a[96:99], a[8:11], a[232:235]
    s_waitcnt lgkmcnt(10)
    buffer_load_dwordx4 v15, s[20:23], s57 offen offset:1664 lds
    v_mfma_f32_16x16x32_bf16 v[32:35], a[96:99], a[16:19], v[32:35]
    ds_read_b128 a[92:95], v5 offset:38912
    v_cvt_pk_bf16_f32 v24, v24, v25
    v_mfma_f32_16x16x32_bf16 v[32:35], a[100:103], a[20:23], v[32:35]
    v_cvt_pk_bf16_f32 v25, v26, v27
    v_cvt_pk_bf16_f32 v26, v28, v29
    v_mfma_f32_16x16x32_bf16 v[36:39], a[108:111], a[20:23], v[36:39]
    ds_read_b128 a[88:91], v4 offset:38912
    v_cvt_pk_bf16_f32 v27, v30, v31
    v_mfma_f32_16x16x32_bf16 v[36:39], a[104:107], a[16:19], v[36:39]
    v_accvgpr_read_b32 v20, a224
    v_accvgpr_read_b32 v21, a225
    v_mfma_f32_16x16x32_bf16 v[40:43], a[112:115], a[16:19], v[40:43]
    ds_read_b64_tr_b16 a[32:33], v10 offset:32768
    v_accvgpr_read_b32 v22, a226
    v_mfma_f32_16x16x32_bf16 v[40:43], a[116:119], a[20:23], v[40:43]
    ds_read_b64_tr_b16 a[34:35], v10 offset:36864
    v_accvgpr_read_b32 v23, a227
    v_mfma_f32_16x16x32_bf16 v[44:47], a[124:127], a[20:23], v[44:47]
    ds_read_b64_tr_b16 a[36:37], v10 offset:49152
    v_accvgpr_read_b32 v28, a228
    v_mfma_f32_16x16x32_bf16 v[44:47], a[120:123], a[16:19], v[44:47]
    s_waitcnt lgkmcnt(11)
    ds_read_b64_tr_b16 a[38:39], v10 offset:53248
    v_accvgpr_read_b32 v29, a229
    v_mfma_f32_16x16x32_bf16 v[52:55], a[120:123], a[24:27], v[52:55]
    ds_read_b64_tr_b16 a[40:41], v11 offset:32768
    v_accvgpr_read_b32 v30, a230
    v_mfma_f32_16x16x32_bf16 v[52:55], a[124:127], a[28:31], v[52:55]
    ds_read_b64_tr_b16 a[42:43], v11 offset:36864
    v_accvgpr_read_b32 v31, a231
    v_mfma_f32_16x16x32_bf16 v[48:51], a[116:119], a[28:31], v[48:51]
    ds_read_b64_tr_b16 a[44:45], v11 offset:49152
    v_cvt_pk_bf16_f32 v20, v20, v21
    v_mfma_f32_16x16x32_bf16 v[48:51], a[112:115], a[24:27], v[48:51]
    ds_read_b64_tr_b16 a[46:47], v11 offset:53248
    v_cvt_pk_bf16_f32 v21, v22, v23
    v_mfma_f32_16x16x32_bf16 v[60:63], a[104:107], a[24:27], v[60:63]
    ds_read_b64_tr_b16 a[48:49], v12 offset:32768
    v_cvt_pk_bf16_f32 v22, v28, v29
    v_mfma_f32_16x16x32_bf16 v[60:63], a[108:111], a[28:31], v[60:63]
    ds_read_b64_tr_b16 a[50:51], v12 offset:36864
    v_cvt_pk_bf16_f32 v23, v30, v31
    v_mfma_f32_16x16x32_bf16 v[56:59], a[100:103], a[28:31], v[56:59]
    ds_read_b64_tr_b16 a[52:53], v12 offset:49152
    v_cvt_pk_bf16_f32 v32, v32, v33
    v_mfma_f32_16x16x32_bf16 v[56:59], a[96:99], a[24:27], v[56:59]
    s_waitcnt lgkmcnt(15)
    ds_read_b64_tr_b16 a[54:55], v12 offset:53248
    v_cvt_pk_bf16_f32 v33, v34, v35
    v_mfma_f32_16x16x32_bf16 v[64:67], a[64:67], a[0:3], v[64:67]
    ds_read_b64_tr_b16 a[56:57], v13 offset:32768
    v_cvt_pk_bf16_f32 v34, v36, v37
    v_mfma_f32_16x16x32_bf16 v[64:67], a[68:71], a[4:7], v[64:67]
    ds_read_b64_tr_b16 a[58:59], v13 offset:36864
    v_cvt_pk_bf16_f32 v35, v38, v39
    v_mfma_f32_16x16x32_bf16 v[68:71], a[76:79], a[4:7], v[68:71]
    ds_read_b64_tr_b16 a[60:61], v13 offset:49152
    v_cvt_pk_bf16_f32 v40, v40, v41
    v_mfma_f32_16x16x32_bf16 v[68:71], a[72:75], a[0:3], v[68:71]
    s_waitcnt lgkmcnt(15)
    ds_read_b64_tr_b16 a[62:63], v13 offset:53248
    v_cvt_pk_bf16_f32 v41, v42, v43
    v_mfma_f32_16x16x32_bf16 v[72:75], a[80:83], a[0:3], v[72:75]
    v_cvt_pk_bf16_f32 v42, v44, v45
    v_cvt_pk_bf16_f32 v43, v46, v47
    v_mfma_f32_16x16x32_bf16 v[72:75], a[84:87], a[4:7], v[72:75]
    v_accvgpr_read_b32 v36, a232
    v_accvgpr_read_b32 v37, a233
    v_mfma_f32_16x16x32_bf16 v[76:79], a[92:95], a[4:7], v[76:79]
    v_accvgpr_read_b32 v38, a234
    v_accvgpr_read_b32 v39, a235
    v_mfma_f32_16x16x32_bf16 v[76:79], a[88:91], a[0:3], v[76:79]
    s_waitcnt lgkmcnt(0)
    v_accvgpr_read_b32 v44, a236
    v_accvgpr_read_b32 v45, a237
    v_mfma_f32_16x16x32_bf16 v[84:87], a[88:91], a[8:11], v[84:87]
    s_barrier
    v_xor_b32 v6, s60, v6
    v_accvgpr_read_b32 v46, a238
    v_mfma_f32_16x16x32_bf16 v[84:87], a[92:95], a[12:15], v[84:87]
    s_add_u32 m0, s29, 32768
    v_add_u32 v2, 0x80000, v2
    v_accvgpr_read_b32 v47, a239
    v_mfma_f32_16x16x32_bf16 v[80:83], a[84:87], a[12:15], v[80:83]
    buffer_load_dwordx4 v2, s[16:19], 0 offen lds
    v_mfma_f32_16x16x32_bf16 v[80:83], a[80:83], a[8:11], v[80:83]
    s_add_u32 s59, s58, 49152
    v_cvt_pk_bf16_f32 v36, v36, v37
    v_cvt_pk_bf16_f32 v37, v38, v39
    v_mfma_f32_16x16x32_bf16 v[92:95], a[72:75], a[8:11], v[92:95]
    buffer_store_dwordx4 v[20:23], v1, s[12:15], s59 offen offset:1024 sc1
    v_mfma_f32_16x16x32_bf16 v[92:95], a[76:79], a[12:15], v[92:95]
    v_cvt_pk_bf16_f32 v38, v44, v45
    v_cvt_pk_bf16_f32 v39, v46, v47
    v_mfma_f32_16x16x32_bf16 v[88:91], a[68:71], a[12:15], v[88:91]
    s_add_u32 m0, s29, 36864
    v_cvt_pk_bf16_f32 v48, v48, v49
    v_cvt_pk_bf16_f32 v49, v50, v51
    v_mfma_f32_16x16x32_bf16 v[88:91], a[64:67], a[8:11], v[88:91]
    buffer_load_dwordx4 v2, s[16:19], s48 offen lds
    v_mfma_f32_16x16x32_bf16 v[96:99], a[64:67], a[16:19], v[96:99]
    v_cvt_pk_bf16_f32 v50, v52, v53
    v_cvt_pk_bf16_f32 v51, v54, v55
    v_mfma_f32_16x16x32_bf16 v[96:99], a[68:71], a[20:23], v[96:99]
    v_cvt_pk_bf16_f32 v56, v56, v57
    v_cvt_pk_bf16_f32 v57, v58, v59
    v_mfma_f32_16x16x32_bf16 v[100:103], a[76:79], a[20:23], v[100:103]
    v_cvt_pk_bf16_f32 v58, v60, v61
    v_cvt_pk_bf16_f32 v59, v62, v63
    v_mfma_f32_16x16x32_bf16 v[100:103], a[72:75], a[16:19], v[100:103]
    s_add_u32 m0, s29, 40960
    v_cvt_pk_bf16_f32 v64, v64, v65
    v_cvt_pk_bf16_f32 v65, v66, v67
    v_mfma_f32_16x16x32_bf16 v[104:107], a[80:83], a[16:19], v[104:107]
    buffer_load_dwordx4 v2, s[16:19], s49 offen lds
    v_mfma_f32_16x16x32_bf16 v[104:107], a[84:87], a[20:23], v[104:107]
    s_add_u32 s59, s58, 32768
    v_cvt_pk_bf16_f32 v66, v68, v69
    v_cvt_pk_bf16_f32 v67, v70, v71
    v_mfma_f32_16x16x32_bf16 v[108:111], a[92:95], a[20:23], v[108:111]
    buffer_store_dwordx4 v[36:39], v1, s[12:15], s59 offen offset:1024 sc1
    v_mfma_f32_16x16x32_bf16 v[108:111], a[88:91], a[16:19], v[108:111]
    v_cvt_pk_bf16_f32 v72, v72, v73
    v_cvt_pk_bf16_f32 v73, v74, v75
    v_mfma_f32_16x16x32_bf16 v[116:119], a[88:91], a[24:27], v[116:119]
    s_add_u32 m0, s29, 45056
    v_cvt_pk_bf16_f32 v74, v76, v77
    v_cvt_pk_bf16_f32 v75, v78, v79
    v_mfma_f32_16x16x32_bf16 v[116:119], a[92:95], a[28:31], v[116:119]
    buffer_load_dwordx4 v2, s[16:19], s50 offen lds
    v_mfma_f32_16x16x32_bf16 v[112:115], a[84:87], a[28:31], v[112:115]
    v_cvt_pk_bf16_f32 v80, v80, v81
    v_cvt_pk_bf16_f32 v81, v82, v83
    v_mfma_f32_16x16x32_bf16 v[112:115], a[80:83], a[24:27], v[112:115]
    v_cvt_pk_bf16_f32 v82, v84, v85
    v_cvt_pk_bf16_f32 v83, v86, v87
    v_mfma_f32_16x16x32_bf16 v[124:127], a[72:75], a[24:27], v[124:127]
    v_cvt_pk_bf16_f32 v88, v88, v89
    v_cvt_pk_bf16_f32 v89, v90, v91
    v_mfma_f32_16x16x32_bf16 v[124:127], a[76:79], a[28:31], v[124:127]
    s_add_u32 m0, s29, 49152
    v_cvt_pk_bf16_f32 v90, v92, v93
    v_cvt_pk_bf16_f32 v91, v94, v95
    v_mfma_f32_16x16x32_bf16 v[120:123], a[68:71], a[28:31], v[120:123]
    buffer_load_dwordx4 v2, s[16:19], s51 offen lds
    v_mfma_f32_16x16x32_bf16 v[120:123], a[64:67], a[24:27], v[120:123]
    s_add_u32 s59, s58, 32768
    v_cvt_pk_bf16_f32 v96, v96, v97
    v_cvt_pk_bf16_f32 v97, v98, v99
    v_mfma_f32_16x16x32_bf16 v[128:131], a[64:67], a[32:35], v[128:131]
    buffer_store_dwordx4 v[16:19], v1, s[12:15], s59 offen offset:0 sc1
    v_mfma_f32_16x16x32_bf16 v[128:131], a[68:71], a[36:39], v[128:131]
    v_cvt_pk_bf16_f32 v98, v100, v101
    v_cvt_pk_bf16_f32 v99, v102, v103
    v_mfma_f32_16x16x32_bf16 v[132:135], a[76:79], a[36:39], v[132:135]
    s_add_u32 m0, s29, 53248
    v_cvt_pk_bf16_f32 v104, v104, v105
    v_cvt_pk_bf16_f32 v105, v106, v107
    v_mfma_f32_16x16x32_bf16 v[132:135], a[72:75], a[32:35], v[132:135]
    buffer_load_dwordx4 v2, s[16:19], s52 offen lds
    v_mfma_f32_16x16x32_bf16 v[136:139], a[80:83], a[32:35], v[136:139]
    v_cvt_pk_bf16_f32 v106, v108, v109
    v_cvt_pk_bf16_f32 v107, v110, v111
    v_mfma_f32_16x16x32_bf16 v[136:139], a[84:87], a[36:39], v[136:139]
    v_cvt_pk_bf16_f32 v112, v112, v113
    v_cvt_pk_bf16_f32 v113, v114, v115
    v_mfma_f32_16x16x32_bf16 v[140:143], a[92:95], a[36:39], v[140:143]
    v_cvt_pk_bf16_f32 v114, v116, v117
    v_cvt_pk_bf16_f32 v115, v118, v119
    v_mfma_f32_16x16x32_bf16 v[140:143], a[88:91], a[32:35], v[140:143]
    s_add_u32 m0, s29, 57344
    v_cvt_pk_bf16_f32 v120, v120, v121
    v_cvt_pk_bf16_f32 v121, v122, v123
    v_mfma_f32_16x16x32_bf16 v[148:151], a[88:91], a[40:43], v[148:151]
    buffer_load_dwordx4 v2, s[16:19], s53 offen lds
    v_mfma_f32_16x16x32_bf16 v[148:151], a[92:95], a[44:47], v[148:151]
    s_add_u32 s59, s58, 49152
    v_cvt_pk_bf16_f32 v122, v124, v125
    v_cvt_pk_bf16_f32 v123, v126, v127
    v_mfma_f32_16x16x32_bf16 v[144:147], a[84:87], a[44:47], v[144:147]
    buffer_store_dwordx4 v[24:27], v1, s[12:15], s59 offen offset:0 sc1
    v_mfma_f32_16x16x32_bf16 v[144:147], a[80:83], a[40:43], v[144:147]
    v_cvt_pk_bf16_f32 v128, v128, v129
    v_cvt_pk_bf16_f32 v129, v130, v131
    v_mfma_f32_16x16x32_bf16 v[156:159], a[72:75], a[40:43], v[156:159]
    s_add_u32 m0, s29, 61440
    v_cvt_pk_bf16_f32 v130, v132, v133
    v_cvt_pk_bf16_f32 v131, v134, v135
    v_mfma_f32_16x16x32_bf16 v[156:159], a[76:79], a[44:47], v[156:159]
    buffer_load_dwordx4 v2, s[16:19], s54 offen lds
    v_mfma_f32_16x16x32_bf16 v[152:155], a[68:71], a[44:47], v[152:155]
    v_mfma_f32_16x16x32_bf16 v[152:155], a[64:67], a[40:43], v[152:155]
    v_cvt_pk_bf16_f32 v136, v136, v137
    v_cvt_pk_bf16_f32 v137, v138, v139
    v_mfma_f32_16x16x32_bf16 v[160:163], a[64:67], a[48:51], v[160:163]
    s_add_u32 m0, s29, 98304
    v_add_u32 v2, 0x80000, v2
    v_cvt_pk_bf16_f32 v138, v140, v141
    v_mfma_f32_16x16x32_bf16 v[160:163], a[68:71], a[52:55], v[160:163]
    buffer_load_dwordx4 v2, s[16:19], 0 offen lds
    v_mfma_f32_16x16x32_bf16 v[164:167], a[76:79], a[52:55], v[164:167]
    s_add_u32 s59, s58, 32768
    v_cvt_pk_bf16_f32 v139, v142, v143
    v_mfma_f32_16x16x32_bf16 v[164:167], a[72:75], a[48:51], v[164:167]
    buffer_store_dwordx4 v[32:35], v1, s[12:15], s59 offen offset:2048 sc1
    v_mfma_f32_16x16x32_bf16 v[168:171], a[80:83], a[48:51], v[168:171]
    v_cvt_pk_bf16_f32 v144, v144, v145
    v_cvt_pk_bf16_f32 v145, v146, v147
    v_mfma_f32_16x16x32_bf16 v[168:171], a[84:87], a[52:55], v[168:171]
    s_add_u32 m0, s29, 102400
    v_cvt_pk_bf16_f32 v146, v148, v149
    v_cvt_pk_bf16_f32 v147, v150, v151
    v_mfma_f32_16x16x32_bf16 v[172:175], a[92:95], a[52:55], v[172:175]
    buffer_load_dwordx4 v2, s[16:19], s48 offen lds
    v_mfma_f32_16x16x32_bf16 v[172:175], a[88:91], a[48:51], v[172:175]
    v_cvt_pk_bf16_f32 v152, v152, v153
    v_cvt_pk_bf16_f32 v153, v154, v155
    v_mfma_f32_16x16x32_bf16 v[180:183], a[88:91], a[56:59], v[180:183]
    v_cvt_pk_bf16_f32 v154, v156, v157
    v_cvt_pk_bf16_f32 v155, v158, v159
    v_mfma_f32_16x16x32_bf16 v[180:183], a[92:95], a[60:63], v[180:183]
    v_mfma_f32_16x16x32_bf16 v[176:179], a[84:87], a[60:63], v[176:179]
    s_add_u32 m0, s29, 106496
    v_mfma_f32_16x16x32_bf16 v[176:179], a[80:83], a[56:59], v[176:179]
    buffer_load_dwordx4 v2, s[16:19], s49 offen lds
    v_mfma_f32_16x16x32_bf16 v[188:191], a[72:75], a[56:59], v[188:191]
    s_add_u32 s59, s58, 49152
    v_cvt_pk_bf16_f32 v160, v160, v161
    v_cvt_pk_bf16_f32 v161, v162, v163
    v_mfma_f32_16x16x32_bf16 v[188:191], a[76:79], a[60:63], v[188:191]
    buffer_store_dwordx4 v[40:43], v1, s[12:15], s59 offen offset:2048 sc1
    v_mfma_f32_16x16x32_bf16 v[184:187], a[68:71], a[60:63], v[184:187]
    v_cvt_pk_bf16_f32 v162, v164, v165
    v_cvt_pk_bf16_f32 v163, v166, v167
    v_mfma_f32_16x16x32_bf16 v[184:187], a[64:67], a[56:59], v[184:187]
    s_add_u32 m0, s29, 110592
    v_cvt_pk_bf16_f32 v168, v168, v169
    v_cvt_pk_bf16_f32 v169, v170, v171
    v_mfma_f32_16x16x32_bf16 v[192:195], a[96:99], a[32:35], v[192:195]
    buffer_load_dwordx4 v2, s[16:19], s50 offen lds
    v_mfma_f32_16x16x32_bf16 v[192:195], a[100:103], a[36:39], v[192:195]
    v_cvt_pk_bf16_f32 v170, v172, v173
    v_cvt_pk_bf16_f32 v171, v174, v175
    v_mfma_f32_16x16x32_bf16 v[196:199], a[108:111], a[36:39], v[196:199]
    v_mfma_f32_16x16x32_bf16 v[196:199], a[104:107], a[32:35], v[196:199]
    v_cvt_pk_bf16_f32 v176, v176, v177
    v_cvt_pk_bf16_f32 v177, v178, v179
    v_mfma_f32_16x16x32_bf16 v[200:203], a[112:115], a[32:35], v[200:203]
    s_add_u32 m0, s29, 114688
    v_cvt_pk_bf16_f32 v178, v180, v181
    v_cvt_pk_bf16_f32 v179, v182, v183
    v_mfma_f32_16x16x32_bf16 v[200:203], a[116:119], a[36:39], v[200:203]
    buffer_load_dwordx4 v2, s[16:19], s51 offen lds
    v_mfma_f32_16x16x32_bf16 v[204:207], a[124:127], a[36:39], v[204:207]
    s_add_u32 s59, s58, 49152
    v_mfma_f32_16x16x32_bf16 v[204:207], a[120:123], a[32:35], v[204:207]
    buffer_store_dwordx4 v[48:51], v1, s[12:15], s59 offen offset:3072 sc1
    v_mfma_f32_16x16x32_bf16 v[212:215], a[120:123], a[40:43], v[212:215]
    v_cvt_pk_bf16_f32 v184, v184, v185
    v_cvt_pk_bf16_f32 v185, v186, v187
    v_mfma_f32_16x16x32_bf16 v[212:215], a[124:127], a[44:47], v[212:215]
    s_add_u32 m0, s29, 118784
    v_cvt_pk_bf16_f32 v186, v188, v189
    v_cvt_pk_bf16_f32 v187, v190, v191
    v_mfma_f32_16x16x32_bf16 v[208:211], a[116:119], a[44:47], v[208:211]
    buffer_load_dwordx4 v2, s[16:19], s52 offen lds
    v_mfma_f32_16x16x32_bf16 v[208:211], a[112:115], a[40:43], v[208:211]
    v_cvt_pk_bf16_f32 v192, v192, v193
    v_cvt_pk_bf16_f32 v193, v194, v195
    v_mfma_f32_16x16x32_bf16 v[220:223], a[104:107], a[40:43], v[220:223]
    v_cvt_pk_bf16_f32 v194, v196, v197
    v_cvt_pk_bf16_f32 v195, v198, v199
    v_mfma_f32_16x16x32_bf16 v[220:223], a[108:111], a[44:47], v[220:223]
    v_mfma_f32_16x16x32_bf16 v[216:219], a[100:103], a[44:47], v[216:219]
    s_add_u32 m0, s29, 122880
    v_mfma_f32_16x16x32_bf16 v[216:219], a[96:99], a[40:43], v[216:219]
    buffer_load_dwordx4 v2, s[16:19], s53 offen lds
    v_mfma_f32_16x16x32_bf16 v[224:227], a[96:99], a[48:51], v[224:227]
    s_add_u32 s59, s58, 32768
    v_cvt_pk_bf16_f32 v200, v200, v201
    v_cvt_pk_bf16_f32 v201, v202, v203
    v_mfma_f32_16x16x32_bf16 v[224:227], a[100:103], a[52:55], v[224:227]
    s_waitcnt vmcnt(22)
    buffer_store_dwordx4 v[56:59], v1, s[12:15], s59 offen offset:3072 sc1
    v_mfma_f32_16x16x32_bf16 v[228:231], a[108:111], a[52:55], v[228:231]
    s_barrier
    v_xor_b32 v7, 0, v6
    v_cvt_pk_bf16_f32 v202, v204, v205
    v_mfma_f32_16x16x32_bf16 v[228:231], a[104:107], a[48:51], v[228:231]
    s_add_u32 m0, s29, 126976
    ds_read_b64_tr_b16 a[64:65], v7 offset:0
    v_cvt_pk_bf16_f32 v203, v206, v207
    v_mfma_f32_16x16x32_bf16 v[232:235], a[112:115], a[48:51], v[232:235]
    ds_read_b64_tr_b16 a[66:67], v7 offset:4096
    buffer_load_dwordx4 v2, s[16:19], s54 offen lds
    v_mfma_f32_16x16x32_bf16 v[232:235], a[116:119], a[52:55], v[232:235]
    ds_read_b64_tr_b16 a[68:69], v7 offset:16384
    v_cvt_pk_bf16_f32 v208, v208, v209
    v_mfma_f32_16x16x32_bf16 v[236:239], a[124:127], a[52:55], v[236:239]
    ds_read_b64_tr_b16 a[70:71], v7 offset:20480
    v_xor_b32 v8, 65536, v6
    v_mfma_f32_16x16x32_bf16 v[236:239], a[120:123], a[48:51], v[236:239]
    ds_read_b64_tr_b16 a[72:73], v8 offset:0
    v_cvt_pk_bf16_f32 v209, v210, v211
    v_mfma_f32_16x16x32_bf16 v[244:247], a[120:123], a[56:59], v[244:247]
    s_add_u32 s59, s58, 0
    ds_read_b64_tr_b16 a[74:75], v8 offset:4096
    v_cvt_pk_bf16_f32 v210, v212, v213
    v_mfma_f32_16x16x32_bf16 v[244:247], a[124:127], a[60:63], v[244:247]
    ds_read_b64_tr_b16 a[76:77], v8 offset:16384
    buffer_store_dwordx4 v[64:67], v1, s[12:15], s59 offen offset:0 sc1
    v_mfma_f32_16x16x32_bf16 v[240:243], a[116:119], a[60:63], v[240:243]
    ds_read_b64_tr_b16 a[78:79], v8 offset:20480
    v_xor_b32 v9, 32, v6
    v_mfma_f32_16x16x32_bf16 v[240:243], a[112:115], a[56:59], v[240:243]
    ds_read_b64_tr_b16 a[80:81], v9 offset:0
    v_cvt_pk_bf16_f32 v211, v214, v215
    v_mfma_f32_16x16x32_bf16 v[252:255], a[104:107], a[56:59], v[252:255]
    ds_read_b64_tr_b16 a[82:83], v9 offset:4096
    v_cvt_pk_bf16_f32 v216, v216, v217
    v_mfma_f32_16x16x32_bf16 v[252:255], a[108:111], a[60:63], v[252:255]
    ds_read_b64_tr_b16 a[84:85], v9 offset:16384
    v_cvt_pk_bf16_f32 v217, v218, v219
    v_mfma_f32_16x16x32_bf16 v[248:251], a[100:103], a[60:63], v[248:251]
    ds_read_b64_tr_b16 a[86:87], v9 offset:20480
    v_xor_b32 v10, 65568, v6
    v_mfma_f32_16x16x32_bf16 v[248:251], a[96:99], a[56:59], v[248:251]
    s_waitcnt lgkmcnt(6)
    ds_read_b64_tr_b16 a[88:89], v10 offset:0
    v_cvt_pk_bf16_f32 v218, v220, v221
    v_mfma_f32_16x16x32_bf16 v[28:31], a[64:67], a[128:131], 0
    ds_read_b64_tr_b16 a[90:91], v10 offset:4096
    v_cvt_pk_bf16_f32 v219, v222, v223
    v_mfma_f32_16x16x32_bf16 v[28:31], a[68:71], a[136:139], v[28:31]
    s_add_u32 s59, s58, 16384
    ds_read_b64_tr_b16 a[92:93], v10 offset:16384
    v_xor_b32 v7, 64, v6
    v_mfma_f32_16x16x32_bf16 v[28:31], a[72:75], a[144:147], v[28:31]
    s_waitcnt lgkmcnt(7)
    ds_read_b128 a[112:115], v14 offset:0
    ds_read_b64_tr_b16 a[94:95], v10 offset:20480
    buffer_store_dwordx4 v[72:75], v1, s[12:15], s59 offen offset:0 sc1
    v_mfma_f32_16x16x32_bf16 v[28:31], a[76:79], a[152:155], v[28:31]
    ds_read_b64_tr_b16 a[96:97], v7 offset:0
    v_cvt_pk_bf16_f32 v224, v224, v225
    v_mfma_f32_16x16x32_bf16 v[44:47], a[64:67], a[132:135], 0
    ds_read_b128 a[120:123], v3 offset:0
    ds_read_b64_tr_b16 a[98:99], v7 offset:4096
    v_mfma_f32_16x16x32_bf16 v[44:47], a[68:71], a[140:143], v[44:47]
    ds_read_b64_tr_b16 a[100:101], v7 offset:16384
    v_xor_b32 v8, 65600, v6
    v_mfma_f32_16x16x32_bf16 v[44:47], a[72:75], a[148:151], v[44:47]
    ds_read_b128 a[116:119], v14 offset:2048
    ds_read_b64_tr_b16 a[102:103], v7 offset:20480
    v_mfma_f32_16x16x32_bf16 v[44:47], a[76:79], a[156:159], v[44:47]
    s_waitcnt lgkmcnt(9)
    ds_read_b64_tr_b16 a[104:105], v8 offset:0
    v_cvt_pk_bf16_f32 v225, v226, v227
    v_mfma_f32_16x16x32_bf16 v[52:55], a[80:83], a[128:131], 0
    ds_read_b128 a[124:127], v3 offset:2048
    ds_read_b64_tr_b16 a[106:107], v8 offset:4096
    v_mfma_f32_16x16x32_bf16 v[52:55], a[84:87], a[136:139], v[52:55]
    s_add_u32 s59, s58, 16384
    ds_read_b64_tr_b16 a[108:109], v8 offset:16384
    v_cvt_pk_bf16_f32 v226, v228, v229
    v_mfma_f32_16x16x32_bf16 v[52:55], a[88:91], a[144:147], v[52:55]
    s_waitcnt lgkmcnt(10)
    ds_read_b64_tr_b16 a[110:111], v8 offset:20480
    v_xor_b32 v9, 96, v6
    v_mfma_f32_16x16x32_bf16 v[52:55], a[92:95], a[152:155], v[52:55]
    ds_read_b64_tr_b16 a[64:65], v9 offset:0
    buffer_store_dwordx4 v[80:83], v1, s[12:15], s59 offen offset:1024 sc1
    v_mfma_f32_16x16x32_bf16 v[60:63], a[80:83], a[132:135], 0
    ds_read_b64_tr_b16 a[66:67], v9 offset:4096
    v_cvt_pk_bf16_f32 v227, v230, v231
    v_mfma_f32_16x16x32_bf16 v[60:63], a[84:87], a[140:143], v[60:63]
    ds_read_b64_tr_b16 a[68:69], v9 offset:16384
    v_cvt_pk_bf16_f32 v232, v232, v233
    v_mfma_f32_16x16x32_bf16 v[60:63], a[88:91], a[148:151], v[60:63]
    ds_read_b64_tr_b16 a[70:71], v9 offset:20480
    v_xor_b32 v10, 65632, v6
    v_mfma_f32_16x16x32_bf16 v[60:63], a[92:95], a[156:159], v[60:63]
    s_waitcnt lgkmcnt(6)
    ds_read_b64_tr_b16 a[72:73], v10 offset:0
    v_cvt_pk_bf16_f32 v233, v234, v235
    v_mfma_f32_16x16x32_bf16 v[20:23], a[96:99], a[128:131], 0
    ds_read_b64_tr_b16 a[74:75], v10 offset:4096
    v_cvt_pk_bf16_f32 v234, v236, v237
    v_mfma_f32_16x16x32_bf16 v[20:23], a[100:103], a[136:139], v[20:23]
    s_waitcnt lgkmcnt(8)
    ds_read_b64_tr_b16 a[76:77], v10 offset:16384
    v_xor_b32 v7, 128, v6
    v_mfma_f32_16x16x32_bf16 v[20:23], a[104:107], a[144:147], v[20:23]
    s_waitcnt lgkmcnt(7)
    s_barrier
    ds_read_b64_tr_b16 a[78:79], v10 offset:20480
    v_mfma_f32_16x16x32_bf16 v[20:23], a[108:111], a[152:155], v[20:23]
    s_add_u32 m0, s29, 131072
    ds_read_b64_tr_b16 a[80:81], v7 offset:0
    v_add_u32 v2, 0x80000, v2
    v_mfma_f32_16x16x32_bf16 v[36:39], a[96:99], a[132:135], 0
    ds_read_b64_tr_b16 a[82:83], v7 offset:4096
    buffer_load_dwordx4 v2, s[16:19], 0 offen lds
    v_mfma_f32_16x16x32_bf16 v[36:39], a[100:103], a[140:143], v[36:39]
    ds_read_b64_tr_b16 a[84:85], v7 offset:16384
    v_cvt_pk_bf16_f32 v235, v238, v239
    v_mfma_f32_16x16x32_bf16 v[36:39], a[104:107], a[148:151], v[36:39]
    s_add_u32 s59, s58, 0
    ds_read_b64_tr_b16 a[86:87], v7 offset:20480
    v_xor_b32 v8, 65664, v6
    v_mfma_f32_16x16x32_bf16 v[36:39], a[108:111], a[156:159], v[36:39]
    s_waitcnt lgkmcnt(6)
    ds_read_b64_tr_b16 a[88:89], v8 offset:0
    buffer_store_dwordx4 v[88:91], v1, s[12:15], s59 offen offset:1024 sc1
    v_mfma_f32_16x16x32_bf16 v[68:71], a[64:67], a[128:131], 0
    ds_read_b64_tr_b16 a[90:91], v8 offset:4096
    v_cvt_pk_bf16_f32 v240, v240, v241
    v_mfma_f32_16x16x32_bf16 v[68:71], a[68:71], a[136:139], v[68:71]
    s_add_u32 m0, s29, 135168
    ds_read_b64_tr_b16 a[92:93], v8 offset:16384
    v_cvt_pk_bf16_f32 v241, v242, v243
    v_mfma_f32_16x16x32_bf16 v[68:71], a[72:75], a[144:147], v[68:71]
    s_waitcnt lgkmcnt(7)
    ds_read_b64_tr_b16 a[94:95], v8 offset:20480
    v_xor_b32 v9, 160, v6
    v_mfma_f32_16x16x32_bf16 v[68:71], a[76:79], a[152:155], v[68:71]
    ds_read_b64_tr_b16 a[96:97], v9 offset:0
    buffer_load_dwordx4 v2, s[16:19], s48 offen lds
    v_mfma_f32_16x16x32_bf16 v[76:79], a[64:67], a[132:135], 0
    ds_read_b64_tr_b16 a[98:99], v9 offset:4096
    v_cvt_pk_bf16_f32 v242, v244, v245
    v_mfma_f32_16x16x32_bf16 v[76:79], a[68:71], a[140:143], v[76:79]
    ds_read_b64_tr_b16 a[100:101], v9 offset:16384
    v_cvt_pk_bf16_f32 v243, v246, v247
    v_mfma_f32_16x16x32_bf16 v[76:79], a[72:75], a[148:151], v[76:79]
    s_add_u32 s59, s58, 0
    ds_read_b64_tr_b16 a[102:103], v9 offset:20480
    v_xor_b32 v10, 65696, v6
    v_mfma_f32_16x16x32_bf16 v[76:79], a[76:79], a[156:159], v[76:79]
    s_waitcnt lgkmcnt(6)
    ds_read_b64_tr_b16 a[104:105], v10 offset:0
    buffer_store_dwordx4 v[96:99], v1, s[12:15], s59 offen offset:2048 sc1
    v_mfma_f32_16x16x32_bf16 v[84:87], a[80:83], a[128:131], 0
    s_add_u32 m0, s29, 139264
    ds_read_b64_tr_b16 a[106:107], v10 offset:4096
    v_cvt_pk_bf16_f32 v248, v248, v249
    v_mfma_f32_16x16x32_bf16 v[84:87], a[84:87], a[136:139], v[84:87]
    ds_read_b64_tr_b16 a[108:109], v10 offset:16384
    buffer_load_dwordx4 v2, s[16:19], s49 offen lds
    v_mfma_f32_16x16x32_bf16 v[84:87], a[88:91], a[144:147], v[84:87]
    s_waitcnt lgkmcnt(7)
    ds_read_b64_tr_b16 a[110:111], v10 offset:20480
    v_xor_b32 v7, 192, v6
    v_mfma_f32_16x16x32_bf16 v[84:87], a[92:95], a[152:155], v[84:87]
    ds_read_b64_tr_b16 a[64:65], v7 offset:0
    v_cvt_pk_bf16_f32 v249, v250, v251
    v_mfma_f32_16x16x32_bf16 v[92:95], a[80:83], a[132:135], 0
    ds_read_b64_tr_b16 a[66:67], v7 offset:4096
    v_cvt_pk_bf16_f32 v250, v252, v253
    v_mfma_f32_16x16x32_bf16 v[92:95], a[84:87], a[140:143], v[92:95]
    ds_read_b64_tr_b16 a[68:69], v7 offset:16384
    v_cvt_pk_bf16_f32 v251, v254, v255
    v_mfma_f32_16x16x32_bf16 v[92:95], a[88:91], a[148:151], v[92:95]
    s_add_u32 m0, s29, 143360
    ds_read_b64_tr_b16 a[70:71], v7 offset:20480
    v_xor_b32 v8, 65728, v6
    v_mfma_f32_16x16x32_bf16 v[92:95], a[92:95], a[156:159], v[92:95]
    s_waitcnt lgkmcnt(6)
    ds_read_b64_tr_b16 a[72:73], v8 offset:0
    buffer_load_dwordx4 v2, s[16:19], s50 offen lds
    v_mfma_f32_16x16x32_bf16 v[100:103], a[96:99], a[128:131], 0
    s_add_u32 s59, s58, 16384
    ds_read_b64_tr_b16 a[74:75], v8 offset:4096
    v_accvgpr_read_b32 v11, a245
    v_mfma_f32_16x16x32_bf16 v[100:103], a[100:103], a[136:139], v[100:103]
    ds_read_b64_tr_b16 a[76:77], v8 offset:16384
    buffer_store_dwordx4 v[104:107], v1, s[12:15], s59 offen offset:2048 sc1
    v_mfma_f32_16x16x32_bf16 v[100:103], a[104:107], a[144:147], v[100:103]
    s_waitcnt lgkmcnt(7)
    ds_read_b64_tr_b16 a[78:79], v8 offset:20480
    v_xor_b32 v9, 224, v6
    v_mfma_f32_16x16x32_bf16 v[100:103], a[108:111], a[152:155], v[100:103]
    s_and_b32 s36, s95, 31
    ds_read_b64_tr_b16 a[80:81], v9 offset:0
    v_mov_b32 v12, 0
    v_mfma_f32_16x16x32_bf16 v[108:111], a[96:99], a[132:135], 0
    s_add_u32 m0, s29, 147456
    ds_read_b64_tr_b16 a[82:83], v9 offset:4096
    v_mfma_f32_16x16x32_bf16 v[108:111], a[100:103], a[140:143], v[108:111]
    ds_read_b64_tr_b16 a[84:85], v9 offset:16384
    buffer_load_dwordx4 v2, s[16:19], s51 offen lds
    v_mfma_f32_16x16x32_bf16 v[108:111], a[104:107], a[148:151], v[108:111]
    s_lshr_b32 s37, s95, 5
    ds_read_b64_tr_b16 a[86:87], v9 offset:20480
    v_xor_b32 v10, 65760, v6
    v_mfma_f32_16x16x32_bf16 v[108:111], a[108:111], a[156:159], v[108:111]
    s_waitcnt lgkmcnt(6)
    ds_read_b64_tr_b16 a[88:89], v10 offset:0
    global_load_dword a248, v12, s[90:91] offset:128 sc1
    v_mfma_f32_16x16x32_bf16 v[116:119], a[64:67], a[128:131], 0
    s_lshl_b32 s38, s3, 4
    ds_read_b64_tr_b16 a[90:91], v10 offset:4096
    v_and_b32 v12, 15, v0
    v_mfma_f32_16x16x32_bf16 v[116:119], a[68:71], a[136:139], v[116:119]
    s_add_u32 m0, s29, 151552
    ds_read_b64_tr_b16 a[92:93], v10 offset:16384
    v_lshlrev_b32 v12, 2, v12
    v_mfma_f32_16x16x32_bf16 v[116:119], a[72:75], a[144:147], v[116:119]
    s_waitcnt lgkmcnt(7)
    ds_read_b64_tr_b16 a[94:95], v10 offset:20480
    v_xor_b32 v7, 256, v6
    v_mfma_f32_16x16x32_bf16 v[116:119], a[76:79], a[152:155], v[116:119]
    ds_read_b64_tr_b16 a[96:97], v7 offset:0
    buffer_load_dwordx4 v2, s[16:19], s52 offen lds
    v_mfma_f32_16x16x32_bf16 v[124:127], a[64:67], a[132:135], 0
    s_add_u32 s59, s58, 16384
    ds_read_b64_tr_b16 a[98:99], v7 offset:4096
    v_mfma_f32_16x16x32_bf16 v[124:127], a[68:71], a[140:143], v[124:127]
    ds_read_b64_tr_b16 a[100:101], v7 offset:16384
    buffer_store_dwordx4 v[112:115], v1, s[12:15], s59 offen offset:3072 sc1
    v_mfma_f32_16x16x32_bf16 v[124:127], a[72:75], a[148:151], v[124:127]
    s_lshl_b32 s39, s36, 6
    ds_read_b64_tr_b16 a[102:103], v7 offset:20480
    v_xor_b32 v8, 65792, v6
    v_mfma_f32_16x16x32_bf16 v[124:127], a[76:79], a[156:159], v[124:127]
    s_waitcnt lgkmcnt(6)
    ds_read_b64_tr_b16 a[104:105], v8 offset:0
    v_mfma_f32_16x16x32_bf16 v[132:135], a[80:83], a[128:131], 0
    s_add_u32 m0, s29, 155648
    ds_read_b64_tr_b16 a[106:107], v8 offset:4096
    v_mfma_f32_16x16x32_bf16 v[132:135], a[84:87], a[136:139], v[132:135]
    ds_read_b64_tr_b16 a[108:109], v8 offset:16384
    buffer_load_dwordx4 v2, s[16:19], s53 offen lds
    v_mfma_f32_16x16x32_bf16 v[132:135], a[88:91], a[144:147], v[132:135]
    s_waitcnt lgkmcnt(7)
    ds_read_b64_tr_b16 a[110:111], v8 offset:20480
    v_xor_b32 v9, 288, v6
    v_mfma_f32_16x16x32_bf16 v[132:135], a[92:95], a[152:155], v[132:135]
    s_add_u32 s38, s38, s39
    ds_read_b64_tr_b16 a[64:65], v9 offset:0
    v_mfma_f32_16x16x32_bf16 v[140:143], a[80:83], a[132:135], 0
    s_add_u32 s59, s58, 0
    ds_read_b64_tr_b16 a[66:67], v9 offset:4096
    v_mfma_f32_16x16x32_bf16 v[140:143], a[84:87], a[140:143], v[140:143]
    ds_read_b64_tr_b16 a[68:69], v9 offset:16384
    buffer_store_dwordx4 v[120:123], v1, s[12:15], s59 offen offset:3072 sc1
    v_mfma_f32_16x16x32_bf16 v[140:143], a[88:91], a[148:151], v[140:143]
    s_add_u32 m0, s29, 159744
    ds_read_b64_tr_b16 a[70:71], v9 offset:20480
    v_xor_b32 v10, 65824, v6
    v_mfma_f32_16x16x32_bf16 v[140:143], a[92:95], a[156:159], v[140:143]
    s_waitcnt lgkmcnt(6)
    ds_read_b64_tr_b16 a[72:73], v10 offset:0
    buffer_load_dwordx4 v2, s[16:19], s54 offen lds
    v_mfma_f32_16x16x32_bf16 v[148:151], a[96:99], a[128:131], 0
    s_mul_i32 s38, s38, 896
    ds_read_b64_tr_b16 a[74:75], v10 offset:4096
    v_mfma_f32_16x16x32_bf16 v[148:151], a[100:103], a[136:139], v[148:151]
    s_lshl_b32 s39, s37, 7
    ds_read_b64_tr_b16 a[76:77], v10 offset:16384
    v_mfma_f32_16x16x32_bf16 v[148:151], a[104:107], a[144:147], v[148:151]
    s_waitcnt lgkmcnt(7)
    ds_read_b64_tr_b16 a[78:79], v10 offset:20480
    v_xor_b32 v7, 320, v6
    v_mfma_f32_16x16x32_bf16 v[148:151], a[108:111], a[152:155], v[148:151]
    s_add_u32 s38, s38, s39
    ds_read_b64_tr_b16 a[80:81], v7 offset:0
    v_mfma_f32_16x16x32_bf16 v[156:159], a[96:99], a[132:135], 0
    s_add_u32 s59, s58, 4096
    ds_read_b64_tr_b16 a[82:83], v7 offset:4096
    v_mfma_f32_16x16x32_bf16 v[156:159], a[100:103], a[140:143], v[156:159]
    ds_read_b64_tr_b16 a[84:85], v7 offset:16384
    buffer_store_dwordx4 v[128:131], v1, s[12:15], s59 offen offset:0 sc1
    v_mfma_f32_16x16x32_bf16 v[156:159], a[104:107], a[148:151], v[156:159]
    s_lshl_b32 s39, s37, 9
    ds_read_b64_tr_b16 a[86:87], v7 offset:20480
    v_xor_b32 v8, 65856, v6
    v_mfma_f32_16x16x32_bf16 v[156:159], a[108:111], a[156:159], v[156:159]
    s_waitcnt lgkmcnt(6)
    ds_read_b64_tr_b16 a[88:89], v8 offset:0
    v_mfma_f32_16x16x32_bf16 v[164:167], a[64:67], a[128:131], 0
    s_mov_b32 s4, s66
    ds_read_b64_tr_b16 a[90:91], v8 offset:4096
    v_mfma_f32_16x16x32_bf16 v[164:167], a[68:71], a[136:139], v[164:167]
    s_mov_b32 s5, s67
    ds_read_b64_tr_b16 a[92:93], v8 offset:16384
    v_mfma_f32_16x16x32_bf16 v[164:167], a[72:75], a[144:147], v[164:167]
    s_waitcnt lgkmcnt(7)
    ds_read_b64_tr_b16 a[94:95], v8 offset:20480
    v_xor_b32 v9, 352, v6
    v_mfma_f32_16x16x32_bf16 v[164:167], a[76:79], a[152:155], v[164:167]
    s_mov_b32 s6, 1835008
    ds_read_b64_tr_b16 a[96:97], v9 offset:0
    v_mfma_f32_16x16x32_bf16 v[172:175], a[64:67], a[132:135], 0
    s_add_u32 s59, s58, 20480
    ds_read_b64_tr_b16 a[98:99], v9 offset:4096
    v_mfma_f32_16x16x32_bf16 v[172:175], a[68:71], a[140:143], v[172:175]
    ds_read_b64_tr_b16 a[100:101], v9 offset:16384
    buffer_store_dwordx4 v[136:139], v1, s[12:15], s59 offen offset:0 sc1
    v_mfma_f32_16x16x32_bf16 v[172:175], a[72:75], a[148:151], v[172:175]
    s_mov_b32 s7, 0x20000
    ds_read_b64_tr_b16 a[102:103], v9 offset:20480
    v_xor_b32 v10, 65888, v6
    v_mfma_f32_16x16x32_bf16 v[172:175], a[76:79], a[156:159], v[172:175]
    s_waitcnt lgkmcnt(6)
    ds_read_b64_tr_b16 a[104:105], v10 offset:0
    v_mfma_f32_16x16x32_bf16 v[180:183], a[80:83], a[128:131], 0
    s_mov_b32 s8, s68
    ds_read_b64_tr_b16 a[106:107], v10 offset:4096
    v_mfma_f32_16x16x32_bf16 v[180:183], a[84:87], a[136:139], v[180:183]
    s_mov_b32 s9, s69
    ds_read_b64_tr_b16 a[108:109], v10 offset:16384
    v_mfma_f32_16x16x32_bf16 v[180:183], a[88:91], a[144:147], v[180:183]
    s_waitcnt lgkmcnt(7)
    ds_read_b64_tr_b16 a[110:111], v10 offset:20480
    v_xor_b32 v7, 384, v6
    v_mfma_f32_16x16x32_bf16 v[180:183], a[92:95], a[152:155], v[180:183]
    s_mov_b32 s10, 1835008
    ds_read_b64_tr_b16 a[64:65], v7 offset:0
    v_mfma_f32_16x16x32_bf16 v[188:191], a[80:83], a[132:135], 0
    s_add_u32 s59, s58, 20480
    ds_read_b64_tr_b16 a[66:67], v7 offset:4096
    v_mfma_f32_16x16x32_bf16 v[188:191], a[84:87], a[140:143], v[188:191]
    ds_read_b64_tr_b16 a[68:69], v7 offset:16384
    buffer_store_dwordx4 v[144:147], v1, s[12:15], s59 offen offset:1024 sc1
    v_mfma_f32_16x16x32_bf16 v[188:191], a[88:91], a[148:151], v[188:191]
    s_mov_b32 s11, 0x20000
    ds_read_b64_tr_b16 a[70:71], v7 offset:20480
    v_xor_b32 v8, 65920, v6
    v_mfma_f32_16x16x32_bf16 v[188:191], a[92:95], a[156:159], v[188:191]
    s_waitcnt lgkmcnt(6)
    ds_read_b64_tr_b16 a[72:73], v8 offset:0
    v_mfma_f32_16x16x32_bf16 v[196:199], a[96:99], a[128:131], 0
    s_mov_b32 s20, s70
    ds_read_b64_tr_b16 a[74:75], v8 offset:4096
    v_mfma_f32_16x16x32_bf16 v[196:199], a[100:103], a[136:139], v[196:199]
    s_mov_b32 s21, s71
    ds_read_b64_tr_b16 a[76:77], v8 offset:16384
    v_mfma_f32_16x16x32_bf16 v[196:199], a[104:107], a[144:147], v[196:199]
    s_waitcnt lgkmcnt(7)
    ds_read_b64_tr_b16 a[78:79], v8 offset:20480
    v_xor_b32 v9, 416, v6
    v_mfma_f32_16x16x32_bf16 v[196:199], a[108:111], a[152:155], v[196:199]
    s_mov_b32 s22, 3584
    ds_read_b64_tr_b16 a[80:81], v9 offset:0
    v_mfma_f32_16x16x32_bf16 v[204:207], a[96:99], a[132:135], 0
    s_add_u32 s59, s58, 4096
    ds_read_b64_tr_b16 a[82:83], v9 offset:4096
    v_mfma_f32_16x16x32_bf16 v[204:207], a[100:103], a[140:143], v[204:207]
    ds_read_b64_tr_b16 a[84:85], v9 offset:16384
    buffer_store_dwordx4 v[152:155], v1, s[12:15], s59 offen offset:1024 sc1
    v_mfma_f32_16x16x32_bf16 v[204:207], a[104:107], a[148:151], v[204:207]
    s_mov_b32 s23, 0x20000
    ds_read_b64_tr_b16 a[86:87], v9 offset:20480
    v_xor_b32 v10, 65952, v6
    v_mfma_f32_16x16x32_bf16 v[204:207], a[108:111], a[156:159], v[204:207]
    s_waitcnt lgkmcnt(6)
    ds_read_b64_tr_b16 a[88:89], v10 offset:0
    v_lshrrev_b32 v120, 3, v0
    v_mfma_f32_16x16x32_bf16 v[212:215], a[64:67], a[128:131], 0
    ds_read_b64_tr_b16 a[90:91], v10 offset:4096
    v_mul_u32_u24 v120, 1792, v120
    v_mfma_f32_16x16x32_bf16 v[212:215], a[68:71], a[136:139], v[212:215]
    ds_read_b64_tr_b16 a[92:93], v10 offset:16384
    v_and_b32 v121, 7, v0
    v_mfma_f32_16x16x32_bf16 v[212:215], a[72:75], a[144:147], v[212:215]
    s_waitcnt lgkmcnt(7)
    ds_read_b64_tr_b16 a[94:95], v10 offset:20480
    v_xor_b32 v7, 448, v6
    v_mfma_f32_16x16x32_bf16 v[212:215], a[76:79], a[152:155], v[212:215]
    ds_read_b64_tr_b16 a[96:97], v7 offset:0
    v_lshl_add_u32 v120, v121, 4, v120
    v_mfma_f32_16x16x32_bf16 v[220:223], a[64:67], a[132:135], 0
    s_add_u32 s59, s58, 4096
    ds_read_b64_tr_b16 a[98:99], v7 offset:4096
    v_add_u32 v120, s38, v120
    v_mfma_f32_16x16x32_bf16 v[220:223], a[68:71], a[140:143], v[220:223]
    ds_read_b64_tr_b16 a[100:101], v7 offset:16384
    buffer_store_dwordx4 v[160:163], v1, s[12:15], s59 offen offset:2048 sc1
    v_mfma_f32_16x16x32_bf16 v[220:223], a[72:75], a[148:151], v[220:223]
    ds_read_b64_tr_b16 a[102:103], v7 offset:20480
    v_xor_b32 v8, 65984, v6
    v_mfma_f32_16x16x32_bf16 v[220:223], a[76:79], a[156:159], v[220:223]
    s_waitcnt lgkmcnt(6)
    ds_read_b64_tr_b16 a[104:105], v8 offset:0
    v_lshlrev_b32 v121, 6, v121
    v_mfma_f32_16x16x32_bf16 v[228:231], a[80:83], a[128:131], 0
    ds_read_b64_tr_b16 a[106:107], v8 offset:4096
    v_subrev_u32 v122, 2688, v120
    v_mfma_f32_16x16x32_bf16 v[228:231], a[84:87], a[136:139], v[228:231]
    ds_read_b64_tr_b16 a[108:109], v8 offset:16384
    v_subrev_u32 v123, 1792, v120
    v_mfma_f32_16x16x32_bf16 v[228:231], a[88:91], a[144:147], v[228:231]
    s_waitcnt lgkmcnt(7)
    ds_read_b64_tr_b16 a[110:111], v8 offset:20480
    v_xor_b32 v9, 480, v6
    v_mfma_f32_16x16x32_bf16 v[228:231], a[92:95], a[152:155], v[228:231]
    ds_read_b64_tr_b16 a[64:65], v9 offset:0
    v_subrev_u32 v128, 896, v120
    v_mfma_f32_16x16x32_bf16 v[236:239], a[80:83], a[132:135], 0
    s_add_u32 s59, s58, 20480
    ds_read_b64_tr_b16 a[66:67], v9 offset:4096
    v_mfma_f32_16x16x32_bf16 v[236:239], a[84:87], a[140:143], v[236:239]
    ds_read_b64_tr_b16 a[68:69], v9 offset:16384
    buffer_store_dwordx4 v[168:171], v1, s[12:15], s59 offen offset:2048 sc1
    v_mfma_f32_16x16x32_bf16 v[236:239], a[88:91], a[148:151], v[236:239]
    ds_read_b64_tr_b16 a[70:71], v9 offset:20480
    v_xor_b32 v10, 66016, v6
    v_mfma_f32_16x16x32_bf16 v[236:239], a[92:95], a[156:159], v[236:239]
    s_waitcnt lgkmcnt(6)
    ds_read_b64_tr_b16 a[72:73], v10 offset:0
    v_mfma_f32_16x16x32_bf16 v[244:247], a[96:99], a[128:131], 0
    ds_read_b64_tr_b16 a[74:75], v10 offset:4096
    v_mfma_f32_16x16x32_bf16 v[244:247], a[100:103], a[136:139], v[244:247]
    s_waitcnt vmcnt(23)
    ds_read_b64_tr_b16 a[76:77], v10 offset:16384
    v_xor_b32 v7, 32768, v6
    v_mfma_f32_16x16x32_bf16 v[244:247], a[104:107], a[144:147], v[244:247]
    s_waitcnt lgkmcnt(7)
    s_barrier
    ds_read_b64_tr_b16 a[78:79], v10 offset:20480
    v_mfma_f32_16x16x32_bf16 v[244:247], a[108:111], a[152:155], v[244:247]
    ds_read_b64_tr_b16 a[80:81], v7 offset:0
    v_mfma_f32_16x16x32_bf16 v[252:255], a[96:99], a[132:135], 0
    s_add_u32 s59, s58, 20480
    ds_read_b64_tr_b16 a[82:83], v7 offset:4096
    v_mfma_f32_16x16x32_bf16 v[252:255], a[100:103], a[140:143], v[252:255]
    ds_read_b64_tr_b16 a[84:85], v7 offset:16384
    buffer_store_dwordx4 v[176:179], v1, s[12:15], s59 offen offset:3072 sc1
    v_mfma_f32_16x16x32_bf16 v[252:255], a[104:107], a[148:151], v[252:255]
    ds_read_b64_tr_b16 a[86:87], v7 offset:20480
    v_xor_b32 v8, 98304, v6
    v_mfma_f32_16x16x32_bf16 v[252:255], a[108:111], a[156:159], v[252:255]
    s_waitcnt lgkmcnt(6)
    ds_read_b64_tr_b16 a[88:89], v8 offset:0
    v_mfma_f32_16x16x32_bf16 v[16:19], a[64:67], a[128:131], 0
    ds_read_b64_tr_b16 a[90:91], v8 offset:4096
    v_mfma_f32_16x16x32_bf16 v[16:19], a[68:71], a[136:139], v[16:19]
    ds_read_b64_tr_b16 a[92:93], v8 offset:16384
    v_mfma_f32_16x16x32_bf16 v[16:19], a[72:75], a[144:147], v[16:19]
    s_waitcnt lgkmcnt(7)
    ds_read_b64_tr_b16 a[94:95], v8 offset:20480
    v_xor_b32 v9, 32800, v6
    v_mfma_f32_16x16x32_bf16 v[16:19], a[76:79], a[152:155], v[16:19]
    ds_read_b64_tr_b16 a[96:97], v9 offset:0
    v_mfma_f32_16x16x32_bf16 v[24:27], a[64:67], a[132:135], 0
    s_waitcnt lgkmcnt(9)
    ds_read_b64_tr_b16 a[98:99], v9 offset:4096
    v_mfma_f32_16x16x32_bf16 v[24:27], a[68:71], a[140:143], v[24:27]
    s_barrier
    ds_read_b64_tr_b16 a[100:101], v9 offset:16384
    v_mfma_f32_16x16x32_bf16 v[24:27], a[72:75], a[148:151], v[24:27]
    s_add_u32 m0, s29, 0
    ds_read_b64_tr_b16 a[102:103], v9 offset:20480
    v_xor_b32 v10, 98336, v6
    v_mfma_f32_16x16x32_bf16 v[24:27], a[76:79], a[156:159], v[24:27]
    s_waitcnt lgkmcnt(6)
    ds_read_b64_tr_b16 a[104:105], v10 offset:0
    v_add_u32 v2, 0x80000, v2
    v_mfma_f32_16x16x32_bf16 v[28:31], a[80:83], a[160:163], v[28:31]
    ds_read_b64_tr_b16 a[106:107], v10 offset:4096
    buffer_load_dwordx4 v2, s[16:19], 0 offen lds
    v_mfma_f32_16x16x32_bf16 v[28:31], a[84:87], a[168:171], v[28:31]
    s_add_u32 s59, s58, 4096
    ds_read_b64_tr_b16 a[108:109], v10 offset:16384
    v_mfma_f32_16x16x32_bf16 v[28:31], a[88:91], a[176:179], v[28:31]
    s_waitcnt lgkmcnt(7)
    ds_read_b64_tr_b16 a[110:111], v10 offset:20480
    v_xor_b32 v7, 32832, v6
    v_mfma_f32_16x16x32_bf16 v[28:31], a[92:95], a[184:187], v[28:31]
    ds_read_b64_tr_b16 a[64:65], v7 offset:0
    buffer_store_dwordx4 v[184:187], v1, s[12:15], s59 offen offset:3072 sc1
    v_mfma_f32_16x16x32_bf16 v[44:47], a[80:83], a[164:167], v[44:47]
    s_add_u32 m0, s29, 4096
    ds_read_b64_tr_b16 a[66:67], v7 offset:4096
    v_mfma_f32_16x16x32_bf16 v[44:47], a[84:87], a[172:175], v[44:47]
    ds_read_b64_tr_b16 a[68:69], v7 offset:16384
    buffer_load_dwordx4 v2, s[16:19], s48 offen lds
    v_mfma_f32_16x16x32_bf16 v[44:47], a[88:91], a[180:183], v[44:47]
    ds_read_b64_tr_b16 a[70:71], v7 offset:20480
    v_xor_b32 v8, 98368, v6
    v_mfma_f32_16x16x32_bf16 v[44:47], a[92:95], a[188:191], v[44:47]
    s_waitcnt lgkmcnt(6)
    ds_read_b64_tr_b16 a[72:73], v8 offset:0
    v_mfma_f32_16x16x32_bf16 v[52:55], a[96:99], a[160:163], v[52:55]
    ds_read_b64_tr_b16 a[74:75], v8 offset:4096
    v_mfma_f32_16x16x32_bf16 v[52:55], a[100:103], a[168:171], v[52:55]
    s_add_u32 m0, s29, 8192
    ds_read_b64_tr_b16 a[76:77], v8 offset:16384
    v_mfma_f32_16x16x32_bf16 v[52:55], a[104:107], a[176:179], v[52:55]
    s_waitcnt lgkmcnt(7)
    ds_read_b64_tr_b16 a[78:79], v8 offset:20480
    v_xor_b32 v9, 32864, v6
    v_mfma_f32_16x16x32_bf16 v[52:55], a[108:111], a[184:187], v[52:55]
    ds_read_b64_tr_b16 a[80:81], v9 offset:0
    buffer_load_dwordx4 v2, s[16:19], s49 offen lds
    v_mfma_f32_16x16x32_bf16 v[60:63], a[96:99], a[164:167], v[60:63]
    s_add_u32 s59, s58, 36864
    ds_read_b64_tr_b16 a[82:83], v9 offset:4096
    v_mfma_f32_16x16x32_bf16 v[60:63], a[100:103], a[172:175], v[60:63]
    ds_read_b64_tr_b16 a[84:85], v9 offset:16384
    buffer_store_dwordx4 v[192:195], v1, s[12:15], s59 offen offset:0 sc1
    v_mfma_f32_16x16x32_bf16 v[60:63], a[104:107], a[180:183], v[60:63]
    s_add_u32 m0, s29, 12288
    ds_read_b64_tr_b16 a[86:87], v9 offset:20480
    v_xor_b32 v10, 98400, v6
    v_mfma_f32_16x16x32_bf16 v[60:63], a[108:111], a[188:191], v[60:63]
    s_waitcnt lgkmcnt(6)
    ds_read_b64_tr_b16 a[88:89], v10 offset:0
    v_mfma_f32_16x16x32_bf16 v[20:23], a[64:67], a[160:163], v[20:23]
    ds_read_b64_tr_b16 a[90:91], v10 offset:4096
    buffer_load_dwordx4 v2, s[16:19], s50 offen lds
    v_mfma_f32_16x16x32_bf16 v[20:23], a[68:71], a[168:171], v[20:23]
    ds_read_b64_tr_b16 a[92:93], v10 offset:16384
    v_mfma_f32_16x16x32_bf16 v[20:23], a[72:75], a[176:179], v[20:23]
    s_waitcnt lgkmcnt(7)
    ds_read_b64_tr_b16 a[94:95], v10 offset:20480
    v_xor_b32 v7, 32896, v6
    v_mfma_f32_16x16x32_bf16 v[20:23], a[76:79], a[184:187], v[20:23]
    ds_read_b64_tr_b16 a[96:97], v7 offset:0
    v_mfma_f32_16x16x32_bf16 v[36:39], a[64:67], a[164:167], v[36:39]
    s_add_u32 m0, s29, 16384
    ds_read_b64_tr_b16 a[98:99], v7 offset:4096
    v_mfma_f32_16x16x32_bf16 v[36:39], a[68:71], a[172:175], v[36:39]
    ds_read_b64_tr_b16 a[100:101], v7 offset:16384
    buffer_load_dwordx4 v2, s[16:19], s51 offen lds
    v_mfma_f32_16x16x32_bf16 v[36:39], a[72:75], a[180:183], v[36:39]
    s_add_u32 s59, s58, 53248
    ds_read_b64_tr_b16 a[102:103], v7 offset:20480
    v_xor_b32 v8, 98432, v6
    v_mfma_f32_16x16x32_bf16 v[36:39], a[76:79], a[188:191], v[36:39]
    s_waitcnt lgkmcnt(6)
    ds_read_b64_tr_b16 a[104:105], v8 offset:0
    buffer_store_dwordx4 v[200:203], v1, s[12:15], s59 offen offset:0 sc1
    v_mfma_f32_16x16x32_bf16 v[68:71], a[80:83], a[160:163], v[68:71]
    ds_read_b64_tr_b16 a[106:107], v8 offset:4096
    v_mfma_f32_16x16x32_bf16 v[68:71], a[84:87], a[168:171], v[68:71]
    s_add_u32 m0, s29, 20480
    ds_read_b64_tr_b16 a[108:109], v8 offset:16384
    v_mfma_f32_16x16x32_bf16 v[68:71], a[88:91], a[176:179], v[68:71]
    s_waitcnt lgkmcnt(7)
    ds_read_b64_tr_b16 a[110:111], v8 offset:20480
    v_xor_b32 v9, 32928, v6
    v_mfma_f32_16x16x32_bf16 v[68:71], a[92:95], a[184:187], v[68:71]
    ds_read_b64_tr_b16 a[64:65], v9 offset:0
    buffer_load_dwordx4 v2, s[16:19], s52 offen lds
    v_mfma_f32_16x16x32_bf16 v[76:79], a[80:83], a[164:167], v[76:79]
    ds_read_b64_tr_b16 a[66:67], v9 offset:4096
    v_mfma_f32_16x16x32_bf16 v[76:79], a[84:87], a[172:175], v[76:79]
    ds_read_b64_tr_b16 a[68:69], v9 offset:16384
    v_mfma_f32_16x16x32_bf16 v[76:79], a[88:91], a[180:183], v[76:79]
    s_add_u32 m0, s29, 24576
    ds_read_b64_tr_b16 a[70:71], v9 offset:20480
    v_xor_b32 v10, 98464, v6
    v_mfma_f32_16x16x32_bf16 v[76:79], a[92:95], a[188:191], v[76:79]
    s_waitcnt lgkmcnt(6)
    ds_read_b64_tr_b16 a[72:73], v10 offset:0
    v_mfma_f32_16x16x32_bf16 v[84:87], a[96:99], a[160:163], v[84:87]
    ds_read_b64_tr_b16 a[74:75], v10 offset:4096
    buffer_load_dwordx4 v2, s[16:19], s53 offen lds
    v_mfma_f32_16x16x32_bf16 v[84:87], a[100:103], a[168:171], v[84:87]
    s_add_u32 s59, s58, 53248
    ds_read_b64_tr_b16 a[76:77], v10 offset:16384
    v_mfma_f32_16x16x32_bf16 v[84:87], a[104:107], a[176:179], v[84:87]
    s_waitcnt lgkmcnt(7)
    ds_read_b64_tr_b16 a[78:79], v10 offset:20480
    v_xor_b32 v7, 32960, v6
    v_mfma_f32_16x16x32_bf16 v[84:87], a[108:111], a[184:187], v[84:87]
    ds_read_b64_tr_b16 a[80:81], v7 offset:0
    buffer_store_dwordx4 v[208:211], v1, s[12:15], s59 offen offset:1024 sc1
    v_mfma_f32_16x16x32_bf16 v[92:95], a[96:99], a[164:167], v[92:95]
    s_add_u32 m0, s29, 28672
    ds_read_b64_tr_b16 a[82:83], v7 offset:4096
    v_mfma_f32_16x16x32_bf16 v[92:95], a[100:103], a[172:175], v[92:95]
    ds_read_b64_tr_b16 a[84:85], v7 offset:16384
    buffer_load_dwordx4 v2, s[16:19], s54 offen lds
    v_mfma_f32_16x16x32_bf16 v[92:95], a[104:107], a[180:183], v[92:95]
    ds_read_b64_tr_b16 a[86:87], v7 offset:20480
    v_xor_b32 v8, 98496, v6
    v_mfma_f32_16x16x32_bf16 v[92:95], a[108:111], a[188:191], v[92:95]
    s_waitcnt lgkmcnt(6)
    ds_read_b64_tr_b16 a[88:89], v8 offset:0
    v_mfma_f32_16x16x32_bf16 v[100:103], a[64:67], a[160:163], v[100:103]
    s_add_u32 m0, s29, 65536
    ds_read_b64_tr_b16 a[90:91], v8 offset:4096
    v_add_u32 v2, 0x80000, v2
    v_mfma_f32_16x16x32_bf16 v[100:103], a[68:71], a[168:171], v[100:103]
    ds_read_b64_tr_b16 a[92:93], v8 offset:16384
    buffer_load_dwordx4 v2, s[16:19], 0 offen lds
    v_mfma_f32_16x16x32_bf16 v[100:103], a[72:75], a[176:179], v[100:103]
    s_waitcnt lgkmcnt(7)
    ds_read_b64_tr_b16 a[94:95], v8 offset:20480
    v_xor_b32 v9, 32992, v6
    v_mfma_f32_16x16x32_bf16 v[100:103], a[76:79], a[184:187], v[100:103]
    s_add_u32 s59, s58, 36864
    ds_read_b64_tr_b16 a[96:97], v9 offset:0
    v_mfma_f32_16x16x32_bf16 v[108:111], a[64:67], a[164:167], v[108:111]
    ds_read_b64_tr_b16 a[98:99], v9 offset:4096
    buffer_store_dwordx4 v[216:219], v1, s[12:15], s59 offen offset:1024 sc1
    v_mfma_f32_16x16x32_bf16 v[108:111], a[68:71], a[172:175], v[108:111]
    ds_read_b64_tr_b16 a[100:101], v9 offset:16384
    v_mfma_f32_16x16x32_bf16 v[108:111], a[72:75], a[180:183], v[108:111]
    s_add_u32 m0, s29, 69632
    ds_read_b64_tr_b16 a[102:103], v9 offset:20480
    v_xor_b32 v10, 98528, v6
    v_mfma_f32_16x16x32_bf16 v[108:111], a[76:79], a[188:191], v[108:111]
    s_waitcnt lgkmcnt(6)
    ds_read_b64_tr_b16 a[104:105], v10 offset:0
    buffer_load_dwordx4 v2, s[16:19], s48 offen lds
    v_mfma_f32_16x16x32_bf16 v[116:119], a[80:83], a[160:163], v[116:119]
    ds_read_b64_tr_b16 a[106:107], v10 offset:4096
    v_mfma_f32_16x16x32_bf16 v[116:119], a[84:87], a[168:171], v[116:119]
    ds_read_b64_tr_b16 a[108:109], v10 offset:16384
    v_mfma_f32_16x16x32_bf16 v[116:119], a[88:91], a[176:179], v[116:119]
    s_waitcnt lgkmcnt(7)
    ds_read_b64_tr_b16 a[110:111], v10 offset:20480
    v_xor_b32 v7, 33024, v6
    v_mfma_f32_16x16x32_bf16 v[116:119], a[92:95], a[184:187], v[116:119]
    s_add_u32 m0, s29, 73728
    ds_read_b64_tr_b16 a[64:65], v7 offset:0
    v_mfma_f32_16x16x32_bf16 v[124:127], a[80:83], a[164:167], v[124:127]
    ds_read_b64_tr_b16 a[66:67], v7 offset:4096
    buffer_load_dwordx4 v2, s[16:19], s49 offen lds
    v_mfma_f32_16x16x32_bf16 v[124:127], a[84:87], a[172:175], v[124:127]
    ds_read_b64_tr_b16 a[68:69], v7 offset:16384
    v_mfma_f32_16x16x32_bf16 v[124:127], a[88:91], a[180:183], v[124:127]
    s_add_u32 s59, s58, 36864
    ds_read_b64_tr_b16 a[70:71], v7 offset:20480
    v_xor_b32 v8, 98560, v6
    v_mfma_f32_16x16x32_bf16 v[124:127], a[92:95], a[188:191], v[124:127]
    s_waitcnt lgkmcnt(6)
    ds_read_b64_tr_b16 a[72:73], v8 offset:0
    buffer_store_dwordx4 v[224:227], v1, s[12:15], s59 offen offset:2048 sc1
    v_mfma_f32_16x16x32_bf16 v[132:135], a[96:99], a[160:163], v[132:135]
    s_add_u32 m0, s29, 77824
    ds_read_b64_tr_b16 a[74:75], v8 offset:4096
    v_mfma_f32_16x16x32_bf16 v[132:135], a[100:103], a[168:171], v[132:135]
    ds_read_b64_tr_b16 a[76:77], v8 offset:16384
    buffer_load_dwordx4 v2, s[16:19], s50 offen lds
    v_mfma_f32_16x16x32_bf16 v[132:135], a[104:107], a[176:179], v[132:135]
    s_waitcnt lgkmcnt(7)
    ds_read_b64_tr_b16 a[78:79], v8 offset:20480
    v_xor_b32 v9, 33056, v6
    v_mfma_f32_16x16x32_bf16 v[132:135], a[108:111], a[184:187], v[132:135]
    ds_read_b64_tr_b16 a[80:81], v9 offset:0
    v_mfma_f32_16x16x32_bf16 v[140:143], a[96:99], a[164:167], v[140:143]
    ds_read_b64_tr_b16 a[82:83], v9 offset:4096
    v_mfma_f32_16x16x32_bf16 v[140:143], a[100:103], a[172:175], v[140:143]
    ds_read_b64_tr_b16 a[84:85], v9 offset:16384
    v_mfma_f32_16x16x32_bf16 v[140:143], a[104:107], a[180:183], v[140:143]
    s_add_u32 m0, s29, 81920
    ds_read_b64_tr_b16 a[86:87], v9 offset:20480
    v_xor_b32 v10, 98592, v6
    v_mfma_f32_16x16x32_bf16 v[140:143], a[108:111], a[188:191], v[140:143]
    s_waitcnt lgkmcnt(6)
    ds_read_b64_tr_b16 a[88:89], v10 offset:0
    buffer_load_dwordx4 v2, s[16:19], s51 offen lds
    v_mfma_f32_16x16x32_bf16 v[148:151], a[64:67], a[160:163], v[148:151]
    s_add_u32 s59, s58, 53248
    ds_read_b64_tr_b16 a[90:91], v10 offset:4096
    v_mfma_f32_16x16x32_bf16 v[148:151], a[68:71], a[168:171], v[148:151]
    ds_read_b64_tr_b16 a[92:93], v10 offset:16384
    buffer_store_dwordx4 v[232:235], v1, s[12:15], s59 offen offset:2048 sc1
    v_mfma_f32_16x16x32_bf16 v[148:151], a[72:75], a[176:179], v[148:151]
    s_waitcnt lgkmcnt(7)
    ds_read_b64_tr_b16 a[94:95], v10 offset:20480
    v_xor_b32 v7, 33088, v6
    v_mfma_f32_16x16x32_bf16 v[148:151], a[76:79], a[184:187], v[148:151]
    s_add_u32 m0, s29, 86016
    ds_read_b64_tr_b16 a[96:97], v7 offset:0
    v_mfma_f32_16x16x32_bf16 v[156:159], a[64:67], a[164:167], v[156:159]
    ds_read_b64_tr_b16 a[98:99], v7 offset:4096
    buffer_load_dwordx4 v2, s[16:19], s52 offen lds
    v_mfma_f32_16x16x32_bf16 v[156:159], a[68:71], a[172:175], v[156:159]
    ds_read_b64_tr_b16 a[100:101], v7 offset:16384
    v_mfma_f32_16x16x32_bf16 v[156:159], a[72:75], a[180:183], v[156:159]
    ds_read_b64_tr_b16 a[102:103], v7 offset:20480
    v_xor_b32 v8, 98624, v6
    v_mfma_f32_16x16x32_bf16 v[156:159], a[76:79], a[188:191], v[156:159]
    s_waitcnt lgkmcnt(6)
    ds_read_b64_tr_b16 a[104:105], v8 offset:0
    v_mfma_f32_16x16x32_bf16 v[164:167], a[80:83], a[160:163], v[164:167]
    s_add_u32 m0, s29, 90112
    ds_read_b64_tr_b16 a[106:107], v8 offset:4096
    v_mfma_f32_16x16x32_bf16 v[164:167], a[84:87], a[168:171], v[164:167]
    ds_read_b64_tr_b16 a[108:109], v8 offset:16384
    buffer_load_dwordx4 v2, s[16:19], s53 offen lds
    v_mfma_f32_16x16x32_bf16 v[164:167], a[88:91], a[176:179], v[164:167]
    s_waitcnt lgkmcnt(7)
    ds_read_b64_tr_b16 a[110:111], v8 offset:20480
    v_xor_b32 v9, 33120, v6
    v_mfma_f32_16x16x32_bf16 v[164:167], a[92:95], a[184:187], v[164:167]
    s_add_u32 s59, s58, 53248
    ds_read_b64_tr_b16 a[64:65], v9 offset:0
    v_mfma_f32_16x16x32_bf16 v[172:175], a[80:83], a[164:167], v[172:175]
    ds_read_b64_tr_b16 a[66:67], v9 offset:4096
    buffer_store_dwordx4 v[240:243], v1, s[12:15], s59 offen offset:3072 sc1
    v_mfma_f32_16x16x32_bf16 v[172:175], a[84:87], a[172:175], v[172:175]
    ds_read_b64_tr_b16 a[68:69], v9 offset:16384
    v_mfma_f32_16x16x32_bf16 v[172:175], a[88:91], a[180:183], v[172:175]
    s_add_u32 m0, s29, 94208
    ds_read_b64_tr_b16 a[70:71], v9 offset:20480
    v_xor_b32 v10, 98656, v6
    v_mfma_f32_16x16x32_bf16 v[172:175], a[92:95], a[188:191], v[172:175]
    s_waitcnt lgkmcnt(6)
    ds_read_b64_tr_b16 a[72:73], v10 offset:0
    buffer_load_dwordx4 v2, s[16:19], s54 offen lds
    v_mfma_f32_16x16x32_bf16 v[180:183], a[96:99], a[160:163], v[180:183]
    ds_read_b64_tr_b16 a[74:75], v10 offset:4096
    v_mfma_f32_16x16x32_bf16 v[180:183], a[100:103], a[168:171], v[180:183]
    ds_read_b64_tr_b16 a[76:77], v10 offset:16384
    v_mfma_f32_16x16x32_bf16 v[180:183], a[104:107], a[176:179], v[180:183]
    s_waitcnt lgkmcnt(7)
    ds_read_b64_tr_b16 a[78:79], v10 offset:20480
    v_xor_b32 v7, 33152, v6
    v_mfma_f32_16x16x32_bf16 v[180:183], a[108:111], a[184:187], v[180:183]
    s_add_u32 s59, s58, 36864
    ds_read_b64_tr_b16 a[80:81], v7 offset:0
    v_mfma_f32_16x16x32_bf16 v[188:191], a[96:99], a[164:167], v[188:191]
    ds_read_b64_tr_b16 a[82:83], v7 offset:4096
    buffer_store_dwordx4 v[248:251], v1, s[12:15], s59 offen offset:3072 sc1
    v_mfma_f32_16x16x32_bf16 v[188:191], a[100:103], a[172:175], v[188:191]
    ds_read_b64_tr_b16 a[84:85], v7 offset:16384
    v_mfma_f32_16x16x32_bf16 v[188:191], a[104:107], a[180:183], v[188:191]
    ds_read_b64_tr_b16 a[86:87], v7 offset:20480
    v_xor_b32 v8, 98688, v6
    v_mfma_f32_16x16x32_bf16 v[188:191], a[108:111], a[188:191], v[188:191]
    s_waitcnt lgkmcnt(6)
    ds_read_b64_tr_b16 a[88:89], v8 offset:0
    v_mfma_f32_16x16x32_bf16 v[196:199], a[64:67], a[160:163], v[196:199]
    ds_read_b64_tr_b16 a[90:91], v8 offset:4096
    v_mfma_f32_16x16x32_bf16 v[196:199], a[68:71], a[168:171], v[196:199]
    ds_read_b64_tr_b16 a[92:93], v8 offset:16384
    v_mfma_f32_16x16x32_bf16 v[196:199], a[72:75], a[176:179], v[196:199]
    s_waitcnt lgkmcnt(7)
    ds_read_b64_tr_b16 a[94:95], v8 offset:20480
    v_xor_b32 v9, 33184, v6
    v_mfma_f32_16x16x32_bf16 v[196:199], a[76:79], a[184:187], v[196:199]
    ds_read_b64_tr_b16 a[96:97], v9 offset:0
    v_mfma_f32_16x16x32_bf16 v[204:207], a[64:67], a[164:167], v[204:207]
    ds_read_b64_tr_b16 a[98:99], v9 offset:4096
    v_mfma_f32_16x16x32_bf16 v[204:207], a[68:71], a[172:175], v[204:207]
    ds_read_b64_tr_b16 a[100:101], v9 offset:16384
    v_mfma_f32_16x16x32_bf16 v[204:207], a[72:75], a[180:183], v[204:207]
    ds_read_b64_tr_b16 a[102:103], v9 offset:20480
    v_xor_b32 v10, 98720, v6
    v_mfma_f32_16x16x32_bf16 v[204:207], a[76:79], a[188:191], v[204:207]
    s_waitcnt lgkmcnt(6)
    ds_read_b64_tr_b16 a[104:105], v10 offset:0
    v_mfma_f32_16x16x32_bf16 v[212:215], a[80:83], a[160:163], v[212:215]
    ds_read_b64_tr_b16 a[106:107], v10 offset:4096
    v_mfma_f32_16x16x32_bf16 v[212:215], a[84:87], a[168:171], v[212:215]
    ds_read_b64_tr_b16 a[108:109], v10 offset:16384
    v_mfma_f32_16x16x32_bf16 v[212:215], a[88:91], a[176:179], v[212:215]
    s_waitcnt lgkmcnt(7)
    ds_read_b64_tr_b16 a[110:111], v10 offset:20480
    v_xor_b32 v7, 33216, v6
    v_mfma_f32_16x16x32_bf16 v[212:215], a[92:95], a[184:187], v[212:215]
    ds_read_b64_tr_b16 a[64:65], v7 offset:0
    v_mfma_f32_16x16x32_bf16 v[220:223], a[80:83], a[164:167], v[220:223]
    ds_read_b64_tr_b16 a[66:67], v7 offset:4096
    v_mfma_f32_16x16x32_bf16 v[220:223], a[84:87], a[172:175], v[220:223]
    ds_read_b64_tr_b16 a[68:69], v7 offset:16384
    v_mfma_f32_16x16x32_bf16 v[220:223], a[88:91], a[180:183], v[220:223]
    ds_read_b64_tr_b16 a[70:71], v7 offset:20480
    v_xor_b32 v8, 98752, v6
    v_mfma_f32_16x16x32_bf16 v[220:223], a[92:95], a[188:191], v[220:223]
    s_waitcnt lgkmcnt(6)
    ds_read_b64_tr_b16 a[72:73], v8 offset:0
    v_mfma_f32_16x16x32_bf16 v[228:231], a[96:99], a[160:163], v[228:231]
    ds_read_b64_tr_b16 a[74:75], v8 offset:4096
    v_mfma_f32_16x16x32_bf16 v[228:231], a[100:103], a[168:171], v[228:231]
    ds_read_b64_tr_b16 a[76:77], v8 offset:16384
    v_mfma_f32_16x16x32_bf16 v[228:231], a[104:107], a[176:179], v[228:231]
    s_waitcnt lgkmcnt(7)
    ds_read_b64_tr_b16 a[78:79], v8 offset:20480
    v_xor_b32 v9, 33248, v6
    v_mfma_f32_16x16x32_bf16 v[228:231], a[108:111], a[184:187], v[228:231]
    ds_read_b64_tr_b16 a[80:81], v9 offset:0
    v_mfma_f32_16x16x32_bf16 v[236:239], a[96:99], a[164:167], v[236:239]
    ds_read_b64_tr_b16 a[82:83], v9 offset:4096
    v_mfma_f32_16x16x32_bf16 v[236:239], a[100:103], a[172:175], v[236:239]
    ds_read_b64_tr_b16 a[84:85], v9 offset:16384
    v_mfma_f32_16x16x32_bf16 v[236:239], a[104:107], a[180:183], v[236:239]
    ds_read_b64_tr_b16 a[86:87], v9 offset:20480
    v_xor_b32 v10, 98784, v6
    v_mfma_f32_16x16x32_bf16 v[236:239], a[108:111], a[188:191], v[236:239]
    s_waitcnt lgkmcnt(6)
    ds_read_b64_tr_b16 a[88:89], v10 offset:0
    v_mfma_f32_16x16x32_bf16 v[244:247], a[64:67], a[160:163], v[244:247]
    ds_read_b64_tr_b16 a[90:91], v10 offset:4096
    v_mfma_f32_16x16x32_bf16 v[244:247], a[68:71], a[168:171], v[244:247]
    s_waitcnt vmcnt(1)
    ds_read_b64_tr_b16 a[92:93], v10 offset:16384
    v_xor_b32 v7, 131072, v6
    v_mfma_f32_16x16x32_bf16 v[244:247], a[72:75], a[176:179], v[244:247]
    s_waitcnt lgkmcnt(7)
    s_barrier
    ds_read_b64_tr_b16 a[94:95], v10 offset:20480
    v_mfma_f32_16x16x32_bf16 v[244:247], a[76:79], a[184:187], v[244:247]
    ds_read_b64_tr_b16 a[96:97], v7 offset:0
    v_mfma_f32_16x16x32_bf16 v[252:255], a[64:67], a[164:167], v[252:255]
    ds_read_b64_tr_b16 a[98:99], v7 offset:4096
    v_mfma_f32_16x16x32_bf16 v[252:255], a[68:71], a[172:175], v[252:255]
    ds_read_b64_tr_b16 a[100:101], v7 offset:16384
    v_mfma_f32_16x16x32_bf16 v[252:255], a[72:75], a[180:183], v[252:255]
    ds_read_b64_tr_b16 a[102:103], v7 offset:20480
    v_xor_b32 v8, 0, v6
    v_mfma_f32_16x16x32_bf16 v[252:255], a[76:79], a[188:191], v[252:255]
    s_waitcnt lgkmcnt(6)
    ds_read_b64_tr_b16 a[104:105], v8 offset:0
    v_mfma_f32_16x16x32_bf16 v[16:19], a[80:83], a[160:163], v[16:19]
    ds_read_b64_tr_b16 a[106:107], v8 offset:4096
    v_mfma_f32_16x16x32_bf16 v[16:19], a[84:87], a[168:171], v[16:19]
    ds_read_b64_tr_b16 a[108:109], v8 offset:16384
    v_mfma_f32_16x16x32_bf16 v[16:19], a[88:91], a[176:179], v[16:19]
    s_waitcnt lgkmcnt(7)
    ds_read_b64_tr_b16 a[110:111], v8 offset:20480
    v_xor_b32 v9, 65536, v6
    v_mfma_f32_16x16x32_bf16 v[16:19], a[92:95], a[184:187], v[16:19]
    ds_read_b64_tr_b16 a[64:65], v9 offset:0
    v_mfma_f32_16x16x32_bf16 v[24:27], a[80:83], a[164:167], v[24:27]
    ds_read_b64_tr_b16 a[66:67], v9 offset:4096
    v_mfma_f32_16x16x32_bf16 v[24:27], a[84:87], a[172:175], v[24:27]
    ds_read_b64_tr_b16 a[68:69], v9 offset:16384
    v_mfma_f32_16x16x32_bf16 v[24:27], a[88:91], a[180:183], v[24:27]
    ds_read_b64_tr_b16 a[70:71], v9 offset:20480
    v_xor_b32 v10, 131104, v6
    v_mfma_f32_16x16x32_bf16 v[24:27], a[92:95], a[188:191], v[24:27]
    s_waitcnt lgkmcnt(6)
    ds_read_b64_tr_b16 a[72:73], v10 offset:0
    v_mfma_f32_16x16x32_bf16 v[28:31], a[96:99], a[192:195], v[28:31]
    ds_read_b64_tr_b16 a[74:75], v10 offset:4096
    v_mfma_f32_16x16x32_bf16 v[28:31], a[100:103], a[200:203], v[28:31]
    ds_read_b64_tr_b16 a[76:77], v10 offset:16384
    v_mfma_f32_16x16x32_bf16 v[28:31], a[104:107], a[208:211], v[28:31]
    s_waitcnt lgkmcnt(3)
    ds_read_b64_tr_b16 a[78:79], v10 offset:20480
    v_xor_b32 v7, 32, v6
    v_mfma_f32_16x16x32_bf16 v[28:31], a[108:111], a[216:219], v[28:31]
    ds_read_b64_tr_b16 a[80:81], v7 offset:0
    v_mfma_f32_16x16x32_bf16 v[28:31], a[64:67], a[112:115], v[28:31]
    ds_read_b64_tr_b16 a[82:83], v7 offset:4096
    v_mfma_f32_16x16x32_bf16 v[28:31], a[68:71], a[120:123], v[28:31]
    ds_read_b64_tr_b16 a[84:85], v7 offset:16384
    v_mfma_f32_16x16x32_bf16 v[44:47], a[96:99], a[196:199], v[44:47]
    ds_read_b64_tr_b16 a[86:87], v7 offset:20480
    v_xor_b32 v8, 65568, v6
    v_mfma_f32_16x16x32_bf16 v[44:47], a[100:103], a[204:207], v[44:47]
    ds_read_b64_tr_b16 a[88:89], v8 offset:0
    v_mfma_f32_16x16x32_bf16 v[44:47], a[104:107], a[212:215], v[44:47]
    ds_read_b64_tr_b16 a[90:91], v8 offset:4096
    v_mfma_f32_16x16x32_bf16 v[44:47], a[108:111], a[220:223], v[44:47]
    ds_read_b64_tr_b16 a[92:93], v8 offset:16384
    v_mfma_f32_16x16x32_bf16 v[44:47], a[64:67], a[116:119], v[44:47]
    ds_read_b64_tr_b16 a[94:95], v8 offset:20480
    v_xor_b32 v9, 131136, v6
    v_mfma_f32_16x16x32_bf16 v[44:47], a[68:71], a[124:127], v[44:47]
    s_waitcnt lgkmcnt(6)
    ds_read_b64_tr_b16 a[96:97], v9 offset:0
    v_mfma_f32_16x16x32_bf16 v[52:55], a[72:75], a[192:195], v[52:55]
    ds_read_b64_tr_b16 a[98:99], v9 offset:4096
    v_mfma_f32_16x16x32_bf16 v[52:55], a[76:79], a[200:203], v[52:55]
    ds_read_b64_tr_b16 a[100:101], v9 offset:16384
    v_mfma_f32_16x16x32_bf16 v[52:55], a[80:83], a[208:211], v[52:55]
    s_waitcnt lgkmcnt(3)
    ds_read_b64_tr_b16 a[102:103], v9 offset:20480
    v_xor_b32 v10, 64, v6
    v_mfma_f32_16x16x32_bf16 v[52:55], a[84:87], a[216:219], v[52:55]
    ds_read_b64_tr_b16 a[104:105], v10 offset:0
    v_mfma_f32_16x16x32_bf16 v[52:55], a[88:91], a[112:115], v[52:55]
    ds_read_b64_tr_b16 a[106:107], v10 offset:4096
    v_mfma_f32_16x16x32_bf16 v[52:55], a[92:95], a[120:123], v[52:55]
    ds_read_b64_tr_b16 a[108:109], v10 offset:16384
    v_mfma_f32_16x16x32_bf16 v[60:63], a[72:75], a[196:199], v[60:63]
    ds_read_b64_tr_b16 a[110:111], v10 offset:20480
    v_xor_b32 v7, 65600, v6
    v_mfma_f32_16x16x32_bf16 v[60:63], a[76:79], a[204:207], v[60:63]
    ds_read_b64_tr_b16 a[64:65], v7 offset:0
    v_mfma_f32_16x16x32_bf16 v[60:63], a[80:83], a[212:215], v[60:63]
    ds_read_b64_tr_b16 a[66:67], v7 offset:4096
    v_mfma_f32_16x16x32_bf16 v[60:63], a[84:87], a[220:223], v[60:63]
    ds_read_b64_tr_b16 a[68:69], v7 offset:16384
    v_mfma_f32_16x16x32_bf16 v[60:63], a[88:91], a[116:119], v[60:63]
    ds_read_b64_tr_b16 a[70:71], v7 offset:20480
    v_xor_b32 v8, 131168, v6
    v_mfma_f32_16x16x32_bf16 v[60:63], a[92:95], a[124:127], v[60:63]
    s_waitcnt lgkmcnt(6)
    ds_read_b64_tr_b16 a[72:73], v8 offset:0
    v_mfma_f32_16x16x32_bf16 v[20:23], a[96:99], a[192:195], v[20:23]
    ds_read_b64_tr_b16 a[74:75], v8 offset:4096
    v_mfma_f32_16x16x32_bf16 v[20:23], a[100:103], a[200:203], v[20:23]
    ds_read_b64_tr_b16 a[76:77], v8 offset:16384
    v_mul_f32 v28, s34, v28
    v_mfma_f32_16x16x32_bf16 v[20:23], a[104:107], a[208:211], v[20:23]
    s_waitcnt lgkmcnt(3)
    ds_read_b64_tr_b16 a[78:79], v8 offset:20480
    v_xor_b32 v9, 96, v6
    v_mfma_f32_16x16x32_bf16 v[20:23], a[108:111], a[216:219], v[20:23]
    ds_read_b64_tr_b16 a[80:81], v9 offset:0
    v_mul_f32 v29, s34, v29
    v_mfma_f32_16x16x32_bf16 v[20:23], a[64:67], a[112:115], v[20:23]
    ds_read_b64_tr_b16 a[82:83], v9 offset:4096
    v_mul_f32 v30, s34, v30
    v_mfma_f32_16x16x32_bf16 v[20:23], a[68:71], a[120:123], v[20:23]
    ds_read_b64_tr_b16 a[84:85], v9 offset:16384
    v_mul_f32 v31, s34, v31
    v_mfma_f32_16x16x32_bf16 v[36:39], a[96:99], a[196:199], v[36:39]
    ds_read_b64_tr_b16 a[86:87], v9 offset:20480
    v_xor_b32 v10, 65632, v6
    v_mfma_f32_16x16x32_bf16 v[36:39], a[100:103], a[204:207], v[36:39]
    ds_read_b64_tr_b16 a[88:89], v10 offset:0
    v_mul_f32 v52, s34, v52
    v_mfma_f32_16x16x32_bf16 v[36:39], a[104:107], a[212:215], v[36:39]
    ds_read_b64_tr_b16 a[90:91], v10 offset:4096
    v_mul_f32 v53, s34, v53
    v_mfma_f32_16x16x32_bf16 v[36:39], a[108:111], a[220:223], v[36:39]
    ds_read_b64_tr_b16 a[92:93], v10 offset:16384
    v_mul_f32 v54, s34, v54
    v_mfma_f32_16x16x32_bf16 v[36:39], a[64:67], a[116:119], v[36:39]
    ds_read_b64_tr_b16 a[94:95], v10 offset:20480
    v_xor_b32 v7, 131200, v6
    v_mfma_f32_16x16x32_bf16 v[36:39], a[68:71], a[124:127], v[36:39]
    s_waitcnt lgkmcnt(6)
    ds_read_b64_tr_b16 a[96:97], v7 offset:0
    v_mul_f32 v55, s34, v55
    v_mfma_f32_16x16x32_bf16 v[68:71], a[72:75], a[192:195], v[68:71]
    ds_read_b64_tr_b16 a[98:99], v7 offset:4096
    v_cvt_pk_bf16_f32 v28, v28, v29
    v_mfma_f32_16x16x32_bf16 v[68:71], a[76:79], a[200:203], v[68:71]
    ds_read_b64_tr_b16 a[100:101], v7 offset:16384
    v_cvt_pk_bf16_f32 v29, v30, v31
    v_mfma_f32_16x16x32_bf16 v[68:71], a[80:83], a[208:211], v[68:71]
    s_waitcnt lgkmcnt(3)
    ds_read_b64_tr_b16 a[102:103], v7 offset:20480
    v_xor_b32 v8, 128, v6
    v_mfma_f32_16x16x32_bf16 v[68:71], a[84:87], a[216:219], v[68:71]
    ds_read_b64_tr_b16 a[104:105], v8 offset:0
    v_cvt_pk_bf16_f32 v30, v52, v53
    v_mfma_f32_16x16x32_bf16 v[68:71], a[88:91], a[112:115], v[68:71]
    s_add_u32 s59, s62, 0
    ds_read_b64_tr_b16 a[106:107], v8 offset:4096
    v_cvt_pk_bf16_f32 v31, v54, v55
    v_mfma_f32_16x16x32_bf16 v[68:71], a[92:95], a[120:123], v[68:71]
    ds_read_b64_tr_b16 a[108:109], v8 offset:16384
    buffer_store_dwordx4 v[28:31], v1, s[12:15], s59 offen offset:0 sc1
    v_mfma_f32_16x16x32_bf16 v[76:79], a[72:75], a[196:199], v[76:79]
    ds_read_b64_tr_b16 a[110:111], v8 offset:20480
    v_xor_b32 v9, 65664, v6
    v_mfma_f32_16x16x32_bf16 v[76:79], a[76:79], a[204:207], v[76:79]
    ds_read_b64_tr_b16 a[64:65], v9 offset:0
    v_accvgpr_write_b32 a0, v28
    v_mfma_f32_16x16x32_bf16 v[76:79], a[80:83], a[212:215], v[76:79]
    ds_read_b64_tr_b16 a[66:67], v9 offset:4096
    v_accvgpr_write_b32 a1, v29
    v_mfma_f32_16x16x32_bf16 v[76:79], a[84:87], a[220:223], v[76:79]
    s_waitcnt vmcnt(1)
    ds_read_b64_tr_b16 a[68:69], v9 offset:16384
    v_accvgpr_write_b32 a2, v30
    v_mfma_f32_16x16x32_bf16 v[76:79], a[88:91], a[116:119], v[76:79]
    s_barrier
    ds_read_b64_tr_b16 a[70:71], v9 offset:20480
    v_xor_b32 v10, 131232, v6
    v_mfma_f32_16x16x32_bf16 v[76:79], a[92:95], a[124:127], v[76:79]
    s_waitcnt lgkmcnt(6)
    ds_read_b64_tr_b16 a[72:73], v10 offset:0
    buffer_store_dword v11, v11, s[12:15], s92 offen sc1
    v_mfma_f32_16x16x32_bf16 v[84:87], a[96:99], a[192:195], v[84:87]
    ds_read_b64_tr_b16 a[74:75], v10 offset:4096
    v_accvgpr_write_b32 a3, v31
    v_mfma_f32_16x16x32_bf16 v[84:87], a[100:103], a[200:203], v[84:87]
    ds_read_b64_tr_b16 a[76:77], v10 offset:16384
    v_mul_f32 v44, s34, v44
    v_mfma_f32_16x16x32_bf16 v[84:87], a[104:107], a[208:211], v[84:87]
    s_waitcnt lgkmcnt(3)
    ds_read_b64_tr_b16 a[78:79], v10 offset:20480
    v_xor_b32 v7, 160, v6
    v_mfma_f32_16x16x32_bf16 v[84:87], a[108:111], a[216:219], v[84:87]
    ds_read_b64_tr_b16 a[80:81], v7 offset:0
    v_mul_f32 v45, s34, v45
    v_mfma_f32_16x16x32_bf16 v[84:87], a[64:67], a[112:115], v[84:87]
    ds_read_b64_tr_b16 a[82:83], v7 offset:4096
    v_mul_f32 v46, s34, v46
    v_mfma_f32_16x16x32_bf16 v[84:87], a[68:71], a[120:123], v[84:87]
    ds_read_b64_tr_b16 a[84:85], v7 offset:16384
    v_mul_f32 v47, s34, v47
    v_mfma_f32_16x16x32_bf16 v[92:95], a[96:99], a[196:199], v[92:95]
    ds_read_b64_tr_b16 a[86:87], v7 offset:20480
    v_xor_b32 v8, 65696, v6
    v_mfma_f32_16x16x32_bf16 v[92:95], a[100:103], a[204:207], v[92:95]
    ds_read_b64_tr_b16 a[88:89], v8 offset:0
    v_mul_f32 v60, s34, v60
    v_mfma_f32_16x16x32_bf16 v[92:95], a[104:107], a[212:215], v[92:95]
    ds_read_b64_tr_b16 a[90:91], v8 offset:4096
    v_mul_f32 v61, s34, v61
    v_mfma_f32_16x16x32_bf16 v[92:95], a[108:111], a[220:223], v[92:95]
    ds_read_b64_tr_b16 a[92:93], v8 offset:16384
    v_mul_f32 v62, s34, v62
    v_mfma_f32_16x16x32_bf16 v[92:95], a[64:67], a[116:119], v[92:95]
    ds_read_b64_tr_b16 a[94:95], v8 offset:20480
    v_xor_b32 v9, 131264, v6
    v_mfma_f32_16x16x32_bf16 v[92:95], a[68:71], a[124:127], v[92:95]
    s_waitcnt lgkmcnt(6)
    ds_read_b64_tr_b16 a[96:97], v9 offset:0
    v_mul_f32 v63, s34, v63
    v_mfma_f32_16x16x32_bf16 v[100:103], a[72:75], a[192:195], v[100:103]
    ds_read_b64_tr_b16 a[98:99], v9 offset:4096
    v_cvt_pk_bf16_f32 v44, v44, v45
    v_mfma_f32_16x16x32_bf16 v[100:103], a[76:79], a[200:203], v[100:103]
    ds_read_b64_tr_b16 a[100:101], v9 offset:16384
    v_cvt_pk_bf16_f32 v45, v46, v47
    v_mfma_f32_16x16x32_bf16 v[100:103], a[80:83], a[208:211], v[100:103]
    s_waitcnt lgkmcnt(3)
    ds_read_b64_tr_b16 a[102:103], v9 offset:20480
    v_xor_b32 v10, 192, v6
    v_mfma_f32_16x16x32_bf16 v[100:103], a[84:87], a[216:219], v[100:103]
    ds_read_b64_tr_b16 a[104:105], v10 offset:0
    v_cvt_pk_bf16_f32 v46, v60, v61
    v_mfma_f32_16x16x32_bf16 v[100:103], a[88:91], a[112:115], v[100:103]
    s_add_u32 s59, s62, 32768
    ds_read_b64_tr_b16 a[106:107], v10 offset:4096
    v_cvt_pk_bf16_f32 v47, v62, v63
    v_mfma_f32_16x16x32_bf16 v[100:103], a[92:95], a[120:123], v[100:103]
    ds_read_b64_tr_b16 a[108:109], v10 offset:16384
    buffer_store_dwordx4 v[44:47], v1, s[12:15], s59 offen offset:0 sc1
    v_mfma_f32_16x16x32_bf16 v[108:111], a[72:75], a[196:199], v[108:111]
    ds_read_b64_tr_b16 a[110:111], v10 offset:20480
    v_xor_b32 v7, 65728, v6
    v_mfma_f32_16x16x32_bf16 v[108:111], a[76:79], a[204:207], v[108:111]
    ds_read_b64_tr_b16 a[64:65], v7 offset:0
    v_accvgpr_write_b32 a32, v44
    v_mfma_f32_16x16x32_bf16 v[108:111], a[80:83], a[212:215], v[108:111]
    ds_read_b64_tr_b16 a[66:67], v7 offset:4096
    v_accvgpr_write_b32 a33, v45
    v_mfma_f32_16x16x32_bf16 v[108:111], a[84:87], a[220:223], v[108:111]
    ds_read_b64_tr_b16 a[68:69], v7 offset:16384
    v_accvgpr_write_b32 a34, v46
    v_mfma_f32_16x16x32_bf16 v[108:111], a[88:91], a[116:119], v[108:111]
    ds_read_b64_tr_b16 a[70:71], v7 offset:20480
    v_xor_b32 v8, 131296, v6
    v_mfma_f32_16x16x32_bf16 v[108:111], a[92:95], a[124:127], v[108:111]
    s_waitcnt lgkmcnt(6)
    ds_read_b64_tr_b16 a[72:73], v8 offset:0
    v_accvgpr_write_b32 a35, v47
    v_mfma_f32_16x16x32_bf16 v[116:119], a[96:99], a[192:195], v[116:119]
    ds_read_b64_tr_b16 a[74:75], v8 offset:4096
    v_mul_f32 v20, s34, v20
    v_mfma_f32_16x16x32_bf16 v[116:119], a[100:103], a[200:203], v[116:119]
    ds_read_b64_tr_b16 a[76:77], v8 offset:16384
    v_mul_f32 v21, s34, v21
    v_mfma_f32_16x16x32_bf16 v[116:119], a[104:107], a[208:211], v[116:119]
    s_waitcnt lgkmcnt(3)
    ds_read_b64_tr_b16 a[78:79], v8 offset:20480
    v_xor_b32 v9, 224, v6
    v_mfma_f32_16x16x32_bf16 v[116:119], a[108:111], a[216:219], v[116:119]
    ds_read_b64_tr_b16 a[80:81], v9 offset:0
    v_mul_f32 v22, s34, v22
    v_mfma_f32_16x16x32_bf16 v[116:119], a[64:67], a[112:115], v[116:119]
    ds_read_b64_tr_b16 a[82:83], v9 offset:4096
    v_mul_f32 v23, s34, v23
    v_mfma_f32_16x16x32_bf16 v[116:119], a[68:71], a[120:123], v[116:119]
    ds_read_b64_tr_b16 a[84:85], v9 offset:16384
    v_mul_f32 v68, s34, v68
    v_mfma_f32_16x16x32_bf16 v[124:127], a[96:99], a[196:199], v[124:127]
    ds_read_b64_tr_b16 a[86:87], v9 offset:20480
    v_xor_b32 v10, 65760, v6
    v_mfma_f32_16x16x32_bf16 v[124:127], a[100:103], a[204:207], v[124:127]
    ds_read_b64_tr_b16 a[88:89], v10 offset:0
    v_mul_f32 v69, s34, v69
    v_mfma_f32_16x16x32_bf16 v[124:127], a[104:107], a[212:215], v[124:127]
    ds_read_b64_tr_b16 a[90:91], v10 offset:4096
    v_mul_f32 v70, s34, v70
    v_mfma_f32_16x16x32_bf16 v[124:127], a[108:111], a[220:223], v[124:127]
    ds_read_b64_tr_b16 a[92:93], v10 offset:16384
    v_mul_f32 v71, s34, v71
    v_mfma_f32_16x16x32_bf16 v[124:127], a[64:67], a[116:119], v[124:127]
    ds_read_b64_tr_b16 a[94:95], v10 offset:20480
    v_xor_b32 v7, 131328, v6
    v_mfma_f32_16x16x32_bf16 v[124:127], a[68:71], a[124:127], v[124:127]
    s_waitcnt lgkmcnt(6)
    ds_read_b64_tr_b16 a[96:97], v7 offset:0
    v_cvt_pk_bf16_f32 v20, v20, v21
    v_mfma_f32_16x16x32_bf16 v[132:135], a[72:75], a[192:195], v[132:135]
    ds_read_b64_tr_b16 a[98:99], v7 offset:4096
    buffer_load_dwordx4 v[32:35], v122, s[4:7], 0 offen
    v_mfma_f32_16x16x32_bf16 v[132:135], a[76:79], a[200:203], v[132:135]
    ds_read_b64_tr_b16 a[100:101], v7 offset:16384
    v_cvt_pk_bf16_f32 v21, v22, v23
    v_mfma_f32_16x16x32_bf16 v[132:135], a[80:83], a[208:211], v[132:135]
    s_waitcnt lgkmcnt(3)
    ds_read_b64_tr_b16 a[102:103], v7 offset:20480
    v_xor_b32 v8, 256, v6
    v_mfma_f32_16x16x32_bf16 v[132:135], a[84:87], a[216:219], v[132:135]
    ds_read_b64_tr_b16 a[104:105], v8 offset:0
    v_cvt_pk_bf16_f32 v22, v68, v69
    v_mfma_f32_16x16x32_bf16 v[132:135], a[88:91], a[112:115], v[132:135]
    ds_read_b64_tr_b16 a[106:107], v8 offset:4096
    buffer_load_dwordx4 v[40:43], v123, s[4:7], 0 offen
    v_mfma_f32_16x16x32_bf16 v[132:135], a[92:95], a[120:123], v[132:135]
    ds_read_b64_tr_b16 a[108:109], v8 offset:16384
    v_cvt_pk_bf16_f32 v23, v70, v71
    v_mfma_f32_16x16x32_bf16 v[140:143], a[72:75], a[196:199], v[140:143]
    ds_read_b64_tr_b16 a[110:111], v8 offset:20480
    v_xor_b32 v9, 65792, v6
    v_mfma_f32_16x16x32_bf16 v[140:143], a[76:79], a[204:207], v[140:143]
    ds_read_b64_tr_b16 a[64:65], v9 offset:0
    v_accvgpr_write_b32 a4, v20
    v_mfma_f32_16x16x32_bf16 v[140:143], a[80:83], a[212:215], v[140:143]
    ds_read_b64_tr_b16 a[66:67], v9 offset:4096
    buffer_load_dwordx4 v[48:51], v128, s[4:7], 0 offen
    v_mfma_f32_16x16x32_bf16 v[140:143], a[84:87], a[220:223], v[140:143]
    ds_read_b64_tr_b16 a[68:69], v9 offset:16384
    v_accvgpr_write_b32 a5, v21
    v_mfma_f32_16x16x32_bf16 v[140:143], a[88:91], a[116:119], v[140:143]
    ds_read_b64_tr_b16 a[70:71], v9 offset:20480
    v_xor_b32 v10, 131360, v6
    v_mfma_f32_16x16x32_bf16 v[140:143], a[92:95], a[124:127], v[140:143]
    s_waitcnt lgkmcnt(6)
    ds_read_b64_tr_b16 a[72:73], v10 offset:0
    v_accvgpr_write_b32 a6, v22
    v_mfma_f32_16x16x32_bf16 v[148:151], a[96:99], a[192:195], v[148:151]
    ds_read_b64_tr_b16 a[74:75], v10 offset:4096
    buffer_load_dwordx4 v[56:59], v120, s[4:7], 0 offen offset:0
    v_mfma_f32_16x16x32_bf16 v[148:151], a[100:103], a[200:203], v[148:151]
    ds_read_b64_tr_b16 a[76:77], v10 offset:16384
    v_accvgpr_write_b32 a7, v23
    v_mfma_f32_16x16x32_bf16 v[148:151], a[104:107], a[208:211], v[148:151]
    s_waitcnt lgkmcnt(3)
    ds_read_b64_tr_b16 a[78:79], v10 offset:20480
    v_xor_b32 v7, 288, v6
    v_mfma_f32_16x16x32_bf16 v[148:151], a[108:111], a[216:219], v[148:151]
    ds_read_b64_tr_b16 a[80:81], v7 offset:0
    v_mul_f32 v36, s34, v36
    v_mfma_f32_16x16x32_bf16 v[148:151], a[64:67], a[112:115], v[148:151]
    ds_read_b64_tr_b16 a[82:83], v7 offset:4096
    buffer_load_dwordx4 v[64:67], v120, s[4:7], 0 offen offset:896
    v_mfma_f32_16x16x32_bf16 v[148:151], a[68:71], a[120:123], v[148:151]
    ds_read_b64_tr_b16 a[84:85], v7 offset:16384
    v_mul_f32 v37, s34, v37
    v_mfma_f32_16x16x32_bf16 v[156:159], a[96:99], a[196:199], v[156:159]
    ds_read_b64_tr_b16 a[86:87], v7 offset:20480
    v_xor_b32 v8, 65824, v6
    v_mfma_f32_16x16x32_bf16 v[156:159], a[100:103], a[204:207], v[156:159]
    ds_read_b64_tr_b16 a[88:89], v8 offset:0
    v_mul_f32 v38, s34, v38
    v_mfma_f32_16x16x32_bf16 v[156:159], a[104:107], a[212:215], v[156:159]
    ds_read_b64_tr_b16 a[90:91], v8 offset:4096
    buffer_load_dwordx4 v[72:75], v120, s[8:11], 0 offen offset:0
    v_mfma_f32_16x16x32_bf16 v[156:159], a[108:111], a[220:223], v[156:159]
    ds_read_b64_tr_b16 a[92:93], v8 offset:16384
    v_mul_f32 v39, s34, v39
    v_mfma_f32_16x16x32_bf16 v[156:159], a[64:67], a[116:119], v[156:159]
    ds_read_b64_tr_b16 a[94:95], v8 offset:20480
    v_xor_b32 v9, 131392, v6
    v_mfma_f32_16x16x32_bf16 v[156:159], a[68:71], a[124:127], v[156:159]
    s_waitcnt lgkmcnt(6)
    ds_read_b64_tr_b16 a[96:97], v9 offset:0
    v_mul_f32 v76, s34, v76
    v_mfma_f32_16x16x32_bf16 v[164:167], a[72:75], a[192:195], v[164:167]
    ds_read_b64_tr_b16 a[98:99], v9 offset:4096
    buffer_load_dwordx4 v[80:83], v120, s[8:11], 0 offen offset:896
    v_mfma_f32_16x16x32_bf16 v[164:167], a[76:79], a[200:203], v[164:167]
    ds_read_b64_tr_b16 a[100:101], v9 offset:16384
    v_mul_f32 v77, s34, v77
    v_mfma_f32_16x16x32_bf16 v[164:167], a[80:83], a[208:211], v[164:167]
    s_waitcnt lgkmcnt(3)
    ds_read_b64_tr_b16 a[102:103], v9 offset:20480
    v_xor_b32 v10, 320, v6
    v_mfma_f32_16x16x32_bf16 v[164:167], a[84:87], a[216:219], v[164:167]
    ds_read_b64_tr_b16 a[104:105], v10 offset:0
    v_mul_f32 v78, s34, v78
    v_mfma_f32_16x16x32_bf16 v[164:167], a[88:91], a[112:115], v[164:167]
    ds_read_b64_tr_b16 a[106:107], v10 offset:4096
    buffer_load_dwordx4 v[88:91], v121, s[20:23], s39 offen offset:0
    v_mfma_f32_16x16x32_bf16 v[164:167], a[92:95], a[120:123], v[164:167]
    ds_read_b64_tr_b16 a[108:109], v10 offset:16384
    v_mul_f32 v79, s34, v79
    v_mfma_f32_16x16x32_bf16 v[172:175], a[72:75], a[196:199], v[172:175]
    ds_read_b64_tr_b16 a[110:111], v10 offset:20480
    v_xor_b32 v7, 65856, v6
    v_mfma_f32_16x16x32_bf16 v[172:175], a[76:79], a[204:207], v[172:175]
    ds_read_b64_tr_b16 a[64:65], v7 offset:0
    v_cvt_pk_bf16_f32 v36, v36, v37
    v_mfma_f32_16x16x32_bf16 v[172:175], a[80:83], a[212:215], v[172:175]
    ds_read_b64_tr_b16 a[66:67], v7 offset:4096
    buffer_load_dwordx4 v[96:99], v121, s[20:23], s39 offen offset:16
    v_mfma_f32_16x16x32_bf16 v[172:175], a[84:87], a[220:223], v[172:175]
    ds_read_b64_tr_b16 a[68:69], v7 offset:16384
    v_cvt_pk_bf16_f32 v37, v38, v39
    v_mfma_f32_16x16x32_bf16 v[172:175], a[88:91], a[116:119], v[172:175]
    ds_read_b64_tr_b16 a[70:71], v7 offset:20480
    v_xor_b32 v8, 131424, v6
    v_mfma_f32_16x16x32_bf16 v[172:175], a[92:95], a[124:127], v[172:175]
    s_waitcnt lgkmcnt(6)
    ds_read_b64_tr_b16 a[72:73], v8 offset:0
    v_cvt_pk_bf16_f32 v38, v76, v77
    v_mfma_f32_16x16x32_bf16 v[180:183], a[96:99], a[192:195], v[180:183]
    ds_read_b64_tr_b16 a[74:75], v8 offset:4096
    buffer_load_dwordx4 v[104:107], v121, s[20:23], s39 offen offset:32
    v_mfma_f32_16x16x32_bf16 v[180:183], a[100:103], a[200:203], v[180:183]
    ds_read_b64_tr_b16 a[76:77], v8 offset:16384
    v_cvt_pk_bf16_f32 v39, v78, v79
    v_mfma_f32_16x16x32_bf16 v[180:183], a[104:107], a[208:211], v[180:183]
    s_waitcnt lgkmcnt(3)
    ds_read_b64_tr_b16 a[78:79], v8 offset:20480
    v_xor_b32 v9, 352, v6
    v_mfma_f32_16x16x32_bf16 v[180:183], a[108:111], a[216:219], v[180:183]
    ds_read_b64_tr_b16 a[80:81], v9 offset:0
    v_accvgpr_write_b32 a36, v36
    v_mfma_f32_16x16x32_bf16 v[180:183], a[64:67], a[112:115], v[180:183]
    ds_read_b64_tr_b16 a[82:83], v9 offset:4096
    buffer_load_dwordx4 v[112:115], v121, s[20:23], s39 offen offset:48
    v_mfma_f32_16x16x32_bf16 v[180:183], a[68:71], a[120:123], v[180:183]
    ds_read_b64_tr_b16 a[84:85], v9 offset:16384
    v_accvgpr_write_b32 a37, v37
    v_mfma_f32_16x16x32_bf16 v[188:191], a[96:99], a[196:199], v[188:191]
    s_add_u32 s59, s62, 0
    ds_read_b64_tr_b16 a[86:87], v9 offset:20480
    v_xor_b32 v10, 65888, v6
    v_mfma_f32_16x16x32_bf16 v[188:191], a[100:103], a[204:207], v[188:191]
    ds_read_b64_tr_b16 a[88:89], v10 offset:0
    buffer_store_dwordx4 v[20:23], v1, s[12:15], s59 offen offset:1024 sc1
    v_mfma_f32_16x16x32_bf16 v[188:191], a[104:107], a[212:215], v[188:191]
    s_add_u32 s59, s62, 32768
    ds_read_b64_tr_b16 a[90:91], v10 offset:4096
    v_accvgpr_write_b32 a38, v38
    v_mfma_f32_16x16x32_bf16 v[188:191], a[108:111], a[220:223], v[188:191]
    ds_read_b64_tr_b16 a[92:93], v10 offset:16384
    buffer_store_dwordx4 v[36:39], v1, s[12:15], s59 offen offset:1024 sc1
    v_mfma_f32_16x16x32_bf16 v[188:191], a[64:67], a[116:119], v[188:191]
    ds_read_b64_tr_b16 a[94:95], v10 offset:20480
    v_xor_b32 v7, 131456, v6
    v_mfma_f32_16x16x32_bf16 v[188:191], a[68:71], a[124:127], v[188:191]
    s_waitcnt lgkmcnt(6)
    ds_read_b64_tr_b16 a[96:97], v7 offset:0
    v_accvgpr_write_b32 a39, v39
    v_mfma_f32_16x16x32_bf16 v[196:199], a[72:75], a[192:195], v[196:199]
    ds_read_b64_tr_b16 a[98:99], v7 offset:4096
    v_mul_f32 v84, s34, v84
    v_mfma_f32_16x16x32_bf16 v[196:199], a[76:79], a[200:203], v[196:199]
    ds_read_b64_tr_b16 a[100:101], v7 offset:16384
    v_mul_f32 v85, s34, v85
    v_mfma_f32_16x16x32_bf16 v[196:199], a[80:83], a[208:211], v[196:199]
    s_waitcnt lgkmcnt(3)
    ds_read_b64_tr_b16 a[102:103], v7 offset:20480
    v_xor_b32 v8, 384, v6
    v_mfma_f32_16x16x32_bf16 v[196:199], a[84:87], a[216:219], v[196:199]
    ds_read_b64_tr_b16 a[104:105], v8 offset:0
    v_mul_f32 v86, s34, v86
    v_mfma_f32_16x16x32_bf16 v[196:199], a[88:91], a[112:115], v[196:199]
    ds_read_b64_tr_b16 a[106:107], v8 offset:4096
    v_mul_f32 v87, s34, v87
    v_mfma_f32_16x16x32_bf16 v[196:199], a[92:95], a[120:123], v[196:199]
    ds_read_b64_tr_b16 a[108:109], v8 offset:16384
    v_mul_f32 v100, s34, v100
    v_mfma_f32_16x16x32_bf16 v[204:207], a[72:75], a[196:199], v[204:207]
    ds_read_b64_tr_b16 a[110:111], v8 offset:20480
    v_xor_b32 v9, 65920, v6
    v_mfma_f32_16x16x32_bf16 v[204:207], a[76:79], a[204:207], v[204:207]
    ds_read_b64_tr_b16 a[64:65], v9 offset:0
    v_mul_f32 v101, s34, v101
    v_mfma_f32_16x16x32_bf16 v[204:207], a[80:83], a[212:215], v[204:207]
    ds_read_b64_tr_b16 a[66:67], v9 offset:4096
    v_mul_f32 v102, s34, v102
    v_mfma_f32_16x16x32_bf16 v[204:207], a[84:87], a[220:223], v[204:207]
    ds_read_b64_tr_b16 a[68:69], v9 offset:16384
    v_mul_f32 v103, s34, v103
    v_mfma_f32_16x16x32_bf16 v[204:207], a[88:91], a[116:119], v[204:207]
    ds_read_b64_tr_b16 a[70:71], v9 offset:20480
    v_xor_b32 v10, 131488, v6
    v_mfma_f32_16x16x32_bf16 v[204:207], a[92:95], a[124:127], v[204:207]
    s_waitcnt lgkmcnt(6)
    ds_read_b64_tr_b16 a[72:73], v10 offset:0
    v_cvt_pk_bf16_f32 v84, v84, v85
    v_mfma_f32_16x16x32_bf16 v[212:215], a[96:99], a[192:195], v[212:215]
    ds_read_b64_tr_b16 a[74:75], v10 offset:4096
    v_cvt_pk_bf16_f32 v85, v86, v87
    v_mfma_f32_16x16x32_bf16 v[212:215], a[100:103], a[200:203], v[212:215]
    ds_read_b64_tr_b16 a[76:77], v10 offset:16384
    v_cvt_pk_bf16_f32 v86, v100, v101
    v_mfma_f32_16x16x32_bf16 v[212:215], a[104:107], a[208:211], v[212:215]
    s_waitcnt lgkmcnt(3)
    ds_read_b64_tr_b16 a[78:79], v10 offset:20480
    v_xor_b32 v7, 416, v6
    v_mfma_f32_16x16x32_bf16 v[212:215], a[108:111], a[216:219], v[212:215]
    s_add_u32 s59, s62, 0
    ds_read_b64_tr_b16 a[80:81], v7 offset:0
    v_cvt_pk_bf16_f32 v87, v102, v103
    v_mfma_f32_16x16x32_bf16 v[212:215], a[64:67], a[112:115], v[212:215]
    ds_read_b64_tr_b16 a[82:83], v7 offset:4096
    buffer_store_dwordx4 v[84:87], v1, s[12:15], s59 offen offset:2048 sc1
    v_mfma_f32_16x16x32_bf16 v[212:215], a[68:71], a[120:123], v[212:215]
    ds_read_b64_tr_b16 a[84:85], v7 offset:16384
    v_accvgpr_write_b32 a8, v84
    v_mfma_f32_16x16x32_bf16 v[220:223], a[96:99], a[196:199], v[220:223]
    ds_read_b64_tr_b16 a[86:87], v7 offset:20480
    v_xor_b32 v8, 65952, v6
    v_mfma_f32_16x16x32_bf16 v[220:223], a[100:103], a[204:207], v[220:223]
    ds_read_b64_tr_b16 a[88:89], v8 offset:0
    v_accvgpr_write_b32 a9, v85
    v_mfma_f32_16x16x32_bf16 v[220:223], a[104:107], a[212:215], v[220:223]
    ds_read_b64_tr_b16 a[90:91], v8 offset:4096
    v_accvgpr_write_b32 a10, v86
    v_mfma_f32_16x16x32_bf16 v[220:223], a[108:111], a[220:223], v[220:223]
    ds_read_b64_tr_b16 a[92:93], v8 offset:16384
    v_accvgpr_write_b32 a11, v87
    v_mfma_f32_16x16x32_bf16 v[220:223], a[64:67], a[116:119], v[220:223]
    ds_read_b64_tr_b16 a[94:95], v8 offset:20480
    v_xor_b32 v9, 131520, v6
    v_mfma_f32_16x16x32_bf16 v[220:223], a[68:71], a[124:127], v[220:223]
    s_waitcnt lgkmcnt(6)
    ds_read_b64_tr_b16 a[96:97], v9 offset:0
    v_mul_f32 v92, s34, v92
    v_mfma_f32_16x16x32_bf16 v[228:231], a[72:75], a[192:195], v[228:231]
    ds_read_b64_tr_b16 a[98:99], v9 offset:4096
    v_mul_f32 v93, s34, v93
    v_mfma_f32_16x16x32_bf16 v[228:231], a[76:79], a[200:203], v[228:231]
    ds_read_b64_tr_b16 a[100:101], v9 offset:16384
    v_mul_f32 v94, s34, v94
    v_mfma_f32_16x16x32_bf16 v[228:231], a[80:83], a[208:211], v[228:231]
    s_waitcnt lgkmcnt(3)
    ds_read_b64_tr_b16 a[102:103], v9 offset:20480
    v_xor_b32 v10, 448, v6
    v_mfma_f32_16x16x32_bf16 v[228:231], a[84:87], a[216:219], v[228:231]
    ds_read_b64_tr_b16 a[104:105], v10 offset:0
    v_mul_f32 v95, s34, v95
    v_mfma_f32_16x16x32_bf16 v[228:231], a[88:91], a[112:115], v[228:231]
    ds_read_b64_tr_b16 a[106:107], v10 offset:4096
    v_mul_f32 v108, s34, v108
    v_mfma_f32_16x16x32_bf16 v[228:231], a[92:95], a[120:123], v[228:231]
    ds_read_b64_tr_b16 a[108:109], v10 offset:16384
    v_mul_f32 v109, s34, v109
    v_mfma_f32_16x16x32_bf16 v[236:239], a[72:75], a[196:199], v[236:239]
    ds_read_b64_tr_b16 a[110:111], v10 offset:20480
    v_xor_b32 v7, 65984, v6
    v_mfma_f32_16x16x32_bf16 v[236:239], a[76:79], a[204:207], v[236:239]
    ds_read_b64_tr_b16 a[64:65], v7 offset:0
    v_mul_f32 v110, s34, v110
    v_mfma_f32_16x16x32_bf16 v[236:239], a[80:83], a[212:215], v[236:239]
    ds_read_b64_tr_b16 a[66:67], v7 offset:4096
    v_mul_f32 v111, s34, v111
    v_mfma_f32_16x16x32_bf16 v[236:239], a[84:87], a[220:223], v[236:239]
    ds_read_b64_tr_b16 a[68:69], v7 offset:16384
    v_cvt_pk_bf16_f32 v92, v92, v93
    v_mfma_f32_16x16x32_bf16 v[236:239], a[88:91], a[116:119], v[236:239]
    ds_read_b64_tr_b16 a[70:71], v7 offset:20480
    v_xor_b32 v8, 131552, v6
    v_mfma_f32_16x16x32_bf16 v[236:239], a[92:95], a[124:127], v[236:239]
    s_waitcnt lgkmcnt(6)
    ds_read_b64_tr_b16 a[72:73], v8 offset:0
    v_cvt_pk_bf16_f32 v93, v94, v95
    v_mfma_f32_16x16x32_bf16 v[244:247], a[96:99], a[192:195], v[244:247]
    ds_read_b64_tr_b16 a[74:75], v8 offset:4096
    v_cvt_pk_bf16_f32 v94, v108, v109
    v_mfma_f32_16x16x32_bf16 v[244:247], a[100:103], a[200:203], v[244:247]
    s_add_u32 s59, s62, 32768
    ds_read_b64_tr_b16 a[76:77], v8 offset:16384
    v_cvt_pk_bf16_f32 v95, v110, v111
    v_mfma_f32_16x16x32_bf16 v[244:247], a[104:107], a[208:211], v[244:247]
    s_waitcnt lgkmcnt(3)
    ds_read_b64_tr_b16 a[78:79], v8 offset:20480
    v_xor_b32 v9, 480, v6
    v_mfma_f32_16x16x32_bf16 v[244:247], a[108:111], a[216:219], v[244:247]
    ds_read_b64_tr_b16 a[80:81], v9 offset:0
    buffer_store_dwordx4 v[92:95], v1, s[12:15], s59 offen offset:2048 sc1
    v_mfma_f32_16x16x32_bf16 v[244:247], a[64:67], a[112:115], v[244:247]
    ds_read_b64_tr_b16 a[82:83], v9 offset:4096
    v_accvgpr_write_b32 a40, v92
    v_mfma_f32_16x16x32_bf16 v[244:247], a[68:71], a[120:123], v[244:247]
    ds_read_b64_tr_b16 a[84:85], v9 offset:16384
    v_accvgpr_write_b32 a41, v93
    v_mfma_f32_16x16x32_bf16 v[252:255], a[96:99], a[196:199], v[252:255]
    ds_read_b64_tr_b16 a[86:87], v9 offset:20480
    v_xor_b32 v10, 66016, v6
    v_mfma_f32_16x16x32_bf16 v[252:255], a[100:103], a[204:207], v[252:255]
    ds_read_b64_tr_b16 a[88:89], v10 offset:0
    v_accvgpr_write_b32 a42, v94
    v_mfma_f32_16x16x32_bf16 v[252:255], a[104:107], a[212:215], v[252:255]
    ds_read_b64_tr_b16 a[90:91], v10 offset:4096
    v_accvgpr_write_b32 a43, v95
    v_mfma_f32_16x16x32_bf16 v[252:255], a[108:111], a[220:223], v[252:255]
    ds_read_b64_tr_b16 a[92:93], v10 offset:16384
    v_mfma_f32_16x16x32_bf16 v[252:255], a[64:67], a[116:119], v[252:255]
    ds_read_b64_tr_b16 a[94:95], v10 offset:20480
    v_mfma_f32_16x16x32_bf16 v[252:255], a[68:71], a[124:127], v[252:255]
    s_waitcnt lgkmcnt(6)
    v_mfma_f32_16x16x32_bf16 v[16:19], a[72:75], a[192:195], v[16:19]
    v_mfma_f32_16x16x32_bf16 v[16:19], a[76:79], a[200:203], v[16:19]
    v_mfma_f32_16x16x32_bf16 v[16:19], a[80:83], a[208:211], v[16:19]
    s_waitcnt lgkmcnt(0)
    v_mfma_f32_16x16x32_bf16 v[16:19], a[84:87], a[216:219], v[16:19]
    v_mfma_f32_16x16x32_bf16 v[16:19], a[88:91], a[112:115], v[16:19]
    v_mfma_f32_16x16x32_bf16 v[16:19], a[92:95], a[120:123], v[16:19]
    v_mfma_f32_16x16x32_bf16 v[24:27], a[72:75], a[196:199], v[24:27]
    v_mfma_f32_16x16x32_bf16 v[24:27], a[76:79], a[204:207], v[24:27]
    v_mfma_f32_16x16x32_bf16 v[24:27], a[80:83], a[212:215], v[24:27]
    v_mfma_f32_16x16x32_bf16 v[24:27], a[84:87], a[220:223], v[24:27]
    s_waitcnt lgkmcnt(0)
    v_mfma_f32_16x16x32_bf16 v[24:27], a[88:91], a[116:119], v[24:27]
    s_barrier
    v_mfma_f32_16x16x32_bf16 v[24:27], a[92:95], a[124:127], v[24:27]
    s_nop 3
    v_pk_mul_f32 v[116:117], v[116:117], s[34:35]
    v_pk_mul_f32 v[118:119], v[118:119], s[34:35]
    v_pk_mul_f32 v[132:133], v[132:133], s[34:35]
    v_pk_mul_f32 v[134:135], v[134:135], s[34:35]
    v_cvt_pk_bf16_f32 v116, v116, v117
    v_cvt_pk_bf16_f32 v117, v118, v119
    v_cvt_pk_bf16_f32 v118, v132, v133
    v_cvt_pk_bf16_f32 v119, v134, v135
    s_add_u32 s59, s62, 0
    buffer_store_dwordx4 v[116:119], v1, s[12:15], s59 offen offset:3072 sc1
    v_accvgpr_write_b32 a12, v116
    v_accvgpr_write_b32 a13, v117
    v_accvgpr_write_b32 a14, v118
    v_accvgpr_write_b32 a15, v119
    v_pk_mul_f32 v[124:125], v[124:125], s[34:35]
    v_pk_mul_f32 v[126:127], v[126:127], s[34:35]
    v_pk_mul_f32 v[140:141], v[140:141], s[34:35]
    v_pk_mul_f32 v[142:143], v[142:143], s[34:35]
    v_cvt_pk_bf16_f32 v124, v124, v125
    v_cvt_pk_bf16_f32 v125, v126, v127
    v_cvt_pk_bf16_f32 v126, v140, v141
    v_cvt_pk_bf16_f32 v127, v142, v143
    s_add_u32 s59, s62, 32768
    buffer_store_dwordx4 v[124:127], v1, s[12:15], s59 offen offset:3072 sc1
    v_accvgpr_write_b32 a44, v124
    v_accvgpr_write_b32 a45, v125
    v_accvgpr_write_b32 a46, v126
    v_accvgpr_write_b32 a47, v127
    v_pk_mul_f32 v[148:149], v[148:149], s[34:35]
    v_pk_mul_f32 v[150:151], v[150:151], s[34:35]
    v_pk_mul_f32 v[164:165], v[164:165], s[34:35]
    v_pk_mul_f32 v[166:167], v[166:167], s[34:35]
    v_cvt_pk_bf16_f32 v148, v148, v149
    v_cvt_pk_bf16_f32 v149, v150, v151
    v_cvt_pk_bf16_f32 v150, v164, v165
    v_cvt_pk_bf16_f32 v151, v166, v167
    s_add_u32 s59, s62, 4096
    buffer_store_dwordx4 v[148:151], v1, s[12:15], s59 offen offset:0 sc1
    v_accvgpr_write_b32 a16, v148
    v_accvgpr_write_b32 a17, v149
    v_accvgpr_write_b32 a18, v150
    v_accvgpr_write_b32 a19, v151
    v_pk_mul_f32 v[156:157], v[156:157], s[34:35]
    v_pk_mul_f32 v[158:159], v[158:159], s[34:35]
    v_pk_mul_f32 v[172:173], v[172:173], s[34:35]
    v_pk_mul_f32 v[174:175], v[174:175], s[34:35]
    v_cvt_pk_bf16_f32 v156, v156, v157
    v_cvt_pk_bf16_f32 v157, v158, v159
    v_cvt_pk_bf16_f32 v158, v172, v173
    v_cvt_pk_bf16_f32 v159, v174, v175
    s_add_u32 s59, s62, 36864
    buffer_store_dwordx4 v[156:159], v1, s[12:15], s59 offen offset:0 sc1
    v_accvgpr_write_b32 a48, v156
    v_accvgpr_write_b32 a49, v157
    v_accvgpr_write_b32 a50, v158
    v_accvgpr_write_b32 a51, v159
    v_pk_mul_f32 v[180:181], v[180:181], s[34:35]
    v_pk_mul_f32 v[182:183], v[182:183], s[34:35]
    v_pk_mul_f32 v[196:197], v[196:197], s[34:35]
    v_pk_mul_f32 v[198:199], v[198:199], s[34:35]
    v_cvt_pk_bf16_f32 v180, v180, v181
    v_cvt_pk_bf16_f32 v181, v182, v183
    v_cvt_pk_bf16_f32 v182, v196, v197
    v_cvt_pk_bf16_f32 v183, v198, v199
    s_add_u32 s59, s62, 4096
    buffer_store_dwordx4 v[180:183], v1, s[12:15], s59 offen offset:1024 sc1
    v_accvgpr_write_b32 a20, v180
    v_accvgpr_write_b32 a21, v181
    v_accvgpr_write_b32 a22, v182
    v_accvgpr_write_b32 a23, v183
    v_pk_mul_f32 v[188:189], v[188:189], s[34:35]
    v_pk_mul_f32 v[190:191], v[190:191], s[34:35]
    v_pk_mul_f32 v[204:205], v[204:205], s[34:35]
    v_pk_mul_f32 v[206:207], v[206:207], s[34:35]
    v_cvt_pk_bf16_f32 v188, v188, v189
    v_cvt_pk_bf16_f32 v189, v190, v191
    v_cvt_pk_bf16_f32 v190, v204, v205
    v_cvt_pk_bf16_f32 v191, v206, v207
    s_add_u32 s59, s62, 36864
    buffer_store_dwordx4 v[188:191], v1, s[12:15], s59 offen offset:1024 sc1
    v_accvgpr_write_b32 a52, v188
    v_accvgpr_write_b32 a53, v189
    v_accvgpr_write_b32 a54, v190
    v_accvgpr_write_b32 a55, v191
    v_pk_mul_f32 v[212:213], v[212:213], s[34:35]
    v_pk_mul_f32 v[214:215], v[214:215], s[34:35]
    v_pk_mul_f32 v[228:229], v[228:229], s[34:35]
    v_pk_mul_f32 v[230:231], v[230:231], s[34:35]
    v_cvt_pk_bf16_f32 v212, v212, v213
    v_cvt_pk_bf16_f32 v213, v214, v215
    v_cvt_pk_bf16_f32 v214, v228, v229
    v_cvt_pk_bf16_f32 v215, v230, v231
    s_add_u32 s59, s62, 4096
    buffer_store_dwordx4 v[212:215], v1, s[12:15], s59 offen offset:2048 sc1
    v_accvgpr_write_b32 a24, v212
    v_accvgpr_write_b32 a25, v213
    v_accvgpr_write_b32 a26, v214
    v_accvgpr_write_b32 a27, v215
    v_pk_mul_f32 v[220:221], v[220:221], s[34:35]
    v_pk_mul_f32 v[222:223], v[222:223], s[34:35]
    v_pk_mul_f32 v[236:237], v[236:237], s[34:35]
    v_pk_mul_f32 v[238:239], v[238:239], s[34:35]
    v_cvt_pk_bf16_f32 v220, v220, v221
    v_cvt_pk_bf16_f32 v221, v222, v223
    v_cvt_pk_bf16_f32 v222, v236, v237
    v_cvt_pk_bf16_f32 v223, v238, v239
    s_add_u32 s59, s62, 36864
    buffer_store_dwordx4 v[220:223], v1, s[12:15], s59 offen offset:2048 sc1
    v_accvgpr_write_b32 a56, v220
    v_accvgpr_write_b32 a57, v221
    v_accvgpr_write_b32 a58, v222
    v_accvgpr_write_b32 a59, v223
    v_pk_mul_f32 v[244:245], v[244:245], s[34:35]
    v_pk_mul_f32 v[246:247], v[246:247], s[34:35]
    v_pk_mul_f32 v[16:17], v[16:17], s[34:35]
    v_pk_mul_f32 v[18:19], v[18:19], s[34:35]
    v_cvt_pk_bf16_f32 v244, v244, v245
    v_cvt_pk_bf16_f32 v245, v246, v247
    v_cvt_pk_bf16_f32 v246, v16, v17
    v_cvt_pk_bf16_f32 v247, v18, v19
    s_add_u32 s59, s62, 4096
    buffer_store_dwordx4 v[244:247], v1, s[12:15], s59 offen offset:3072 sc1
    v_accvgpr_write_b32 a28, v244
    v_accvgpr_write_b32 a29, v245
    v_accvgpr_write_b32 a30, v246
    v_accvgpr_write_b32 a31, v247
    v_pk_mul_f32 v[252:253], v[252:253], s[34:35]
    v_pk_mul_f32 v[254:255], v[254:255], s[34:35]
    v_pk_mul_f32 v[24:25], v[24:25], s[34:35]
    v_pk_mul_f32 v[26:27], v[26:27], s[34:35]
    v_cvt_pk_bf16_f32 v252, v252, v253
    v_cvt_pk_bf16_f32 v253, v254, v255
    v_cvt_pk_bf16_f32 v254, v24, v25
    v_cvt_pk_bf16_f32 v255, v26, v27
    s_add_u32 s59, s62, 36864
    buffer_store_dwordx4 v[252:255], v1, s[12:15], s59 offen offset:3072 sc1
    v_accvgpr_write_b32 a60, v252
    v_accvgpr_write_b32 a61, v253
    v_accvgpr_write_b32 a62, v254
    v_accvgpr_write_b32 a63, v255
    s_waitcnt vmcnt(14)
L_kvdone:
    s_cmp_ge_u32 s28, 14
    s_cbranch_scc1 L_s1b
    s_mov_b32 s36, 0xffff0000
    s_and_b32 s33, s95, 31
    s_lshr_b32 s34, s95, 5
    v_lshlrev_b32 v128, 16, v32
    v_and_b32 v129, s36, v32
    v_lshlrev_b32 v130, 16, v40
    v_and_b32 v131, s36, v40
    v_lshlrev_b32 v132, 16, v48
    v_and_b32 v133, s36, v48
    v_lshlrev_b32 v134, 16, v56
    v_and_b32 v135, s36, v56
    v_lshlrev_b32 v136, 16, v64
    v_and_b32 v137, s36, v64
    v_lshlrev_b32 v138, 16, v72
    v_and_b32 v139, s36, v72
    v_lshlrev_b32 v140, 16, v80
    v_and_b32 v141, s36, v80
    v_lshlrev_b32 v142, 16, v88
    v_lshlrev_b32 v143, 16, v90
    v_and_b32 v144, s36, v88
    v_and_b32 v145, s36, v90
    v_lshlrev_b32 v146, 16, v89
    v_lshlrev_b32 v147, 16, v91
    v_and_b32 v148, s36, v89
    v_and_b32 v149, s36, v91
    v_pk_mul_f32 v[150:151], v[128:129], v[148:149]
    v_pk_fma_f32 v[150:151], v[130:131], v[146:147], v[150:151]
    v_pk_fma_f32 v[150:151], v[132:133], v[144:145], v[150:151]
    v_pk_fma_f32 v[150:151], v[134:135], v[142:143], v[150:151]
    v_pk_mul_f32 v[150:151], v[150:151], v[138:139]
    v_cvt_pk_bf16_f32 v16, v150, v151
    v_pk_mul_f32 v[152:153], v[130:131], v[148:149]
    v_pk_fma_f32 v[152:153], v[132:133], v[146:147], v[152:153]
    v_pk_fma_f32 v[152:153], v[134:135], v[144:145], v[152:153]
    v_pk_fma_f32 v[152:153], v[136:137], v[142:143], v[152:153]
    v_pk_mul_f32 v[152:153], v[152:153], v[140:141]
    v_cvt_pk_bf16_f32 v20, v152, v153
    v_lshlrev_b32 v128, 16, v33
    v_and_b32 v129, s36, v33
    v_lshlrev_b32 v130, 16, v41
    v_and_b32 v131, s36, v41
    v_lshlrev_b32 v132, 16, v49
    v_and_b32 v133, s36, v49
    v_lshlrev_b32 v134, 16, v57
    v_and_b32 v135, s36, v57
    v_lshlrev_b32 v136, 16, v65
    v_and_b32 v137, s36, v65
    v_lshlrev_b32 v138, 16, v73
    v_and_b32 v139, s36, v73
    v_lshlrev_b32 v140, 16, v81
    v_and_b32 v141, s36, v81
    v_lshlrev_b32 v142, 16, v96
    v_lshlrev_b32 v143, 16, v98
    v_and_b32 v144, s36, v96
    v_and_b32 v145, s36, v98
    v_lshlrev_b32 v146, 16, v97
    v_lshlrev_b32 v147, 16, v99
    v_and_b32 v148, s36, v97
    v_and_b32 v149, s36, v99
    v_pk_mul_f32 v[150:151], v[128:129], v[148:149]
    v_pk_fma_f32 v[150:151], v[130:131], v[146:147], v[150:151]
    v_pk_fma_f32 v[150:151], v[132:133], v[144:145], v[150:151]
    v_pk_fma_f32 v[150:151], v[134:135], v[142:143], v[150:151]
    v_pk_mul_f32 v[150:151], v[150:151], v[138:139]
    v_cvt_pk_bf16_f32 v17, v150, v151
    v_pk_mul_f32 v[152:153], v[130:131], v[148:149]
    v_pk_fma_f32 v[152:153], v[132:133], v[146:147], v[152:153]
    v_pk_fma_f32 v[152:153], v[134:135], v[144:145], v[152:153]
    v_pk_fma_f32 v[152:153], v[136:137], v[142:143], v[152:153]
    v_pk_mul_f32 v[152:153], v[152:153], v[140:141]
    v_cvt_pk_bf16_f32 v21, v152, v153
    v_lshlrev_b32 v128, 16, v34
    v_and_b32 v129, s36, v34
    v_lshlrev_b32 v130, 16, v42
    v_and_b32 v131, s36, v42
    v_lshlrev_b32 v132, 16, v50
    v_and_b32 v133, s36, v50
    v_lshlrev_b32 v134, 16, v58
    v_and_b32 v135, s36, v58
    v_lshlrev_b32 v136, 16, v66
    v_and_b32 v137, s36, v66
    v_lshlrev_b32 v138, 16, v74
    v_and_b32 v139, s36, v74
    v_lshlrev_b32 v140, 16, v82
    v_and_b32 v141, s36, v82
    v_lshlrev_b32 v142, 16, v104
    v_lshlrev_b32 v143, 16, v106
    v_and_b32 v144, s36, v104
    v_and_b32 v145, s36, v106
    v_lshlrev_b32 v146, 16, v105
    v_lshlrev_b32 v147, 16, v107
    v_and_b32 v148, s36, v105
    v_and_b32 v149, s36, v107
    v_pk_mul_f32 v[150:151], v[128:129], v[148:149]
    v_pk_fma_f32 v[150:151], v[130:131], v[146:147], v[150:151]
    v_pk_fma_f32 v[150:151], v[132:133], v[144:145], v[150:151]
    v_pk_fma_f32 v[150:151], v[134:135], v[142:143], v[150:151]
    v_pk_mul_f32 v[150:151], v[150:151], v[138:139]
    v_cvt_pk_bf16_f32 v18, v150, v151
    v_pk_mul_f32 v[152:153], v[130:131], v[148:149]
    v_pk_fma_f32 v[152:153], v[132:133], v[146:147], v[152:153]
    v_pk_fma_f32 v[152:153], v[134:135], v[144:145], v[152:153]
    v_pk_fma_f32 v[152:153], v[136:137], v[142:143], v[152:153]
    v_pk_mul_f32 v[152:153], v[152:153], v[140:141]
    v_cvt_pk_bf16_f32 v22, v152, v153
    v_lshlrev_b32 v128, 16, v35
    v_and_b32 v129, s36, v35
    v_lshlrev_b32 v130, 16, v43
    v_and_b32 v131, s36, v43
    v_lshlrev_b32 v132, 16, v51
    v_and_b32 v133, s36, v51
    v_lshlrev_b32 v134, 16, v59
    v_and_b32 v135, s36, v59
    v_lshlrev_b32 v136, 16, v67
    v_and_b32 v137, s36, v67
    v_lshlrev_b32 v138, 16, v75
    v_and_b32 v139, s36, v75
    v_lshlrev_b32 v140, 16, v83
    v_and_b32 v141, s36, v83
    v_lshlrev_b32 v142, 16, v112
    v_lshlrev_b32 v143, 16, v114
    v_and_b32 v144, s36, v112
    v_and_b32 v145, s36, v114
    v_lshlrev_b32 v146, 16, v113
    v_lshlrev_b32 v147, 16, v115
    v_and_b32 v148, s36, v113
    v_and_b32 v149, s36, v115
    v_pk_mul_f32 v[150:151], v[128:129], v[148:149]
    v_pk_fma_f32 v[150:151], v[130:131], v[146:147], v[150:151]
    v_pk_fma_f32 v[150:151], v[132:133], v[144:145], v[150:151]
    v_pk_fma_f32 v[150:151], v[134:135], v[142:143], v[150:151]
    v_pk_mul_f32 v[150:151], v[150:151], v[138:139]
    v_cvt_pk_bf16_f32 v19, v150, v151
    v_pk_mul_f32 v[152:153], v[130:131], v[148:149]
    v_pk_fma_f32 v[152:153], v[132:133], v[146:147], v[152:153]
    v_pk_fma_f32 v[152:153], v[134:135], v[144:145], v[152:153]
    v_pk_fma_f32 v[152:153], v[136:137], v[142:143], v[152:153]
    v_pk_mul_f32 v[152:153], v[152:153], v[140:141]
    v_cvt_pk_bf16_f32 v23, v152, v153
    v_lshrrev_b32 v26, 3, v0
    v_lshlrev_b32 v26, 8, v26
    v_and_b32 v25, 7, v0
    v_lshl_add_u32 v26, v25, 4, v26
    s_lshl_b32 s35, s3, 11
    s_add_u32 s35, s35, 0x20000
    v_add_u32 v26, s35, v26
    ds_write_b128 v26, v[16:19] offset:0
    ds_write_b128 v26, v[20:23] offset:128
    v_bfe_u32 v24, v0, 2, 2
    v_bfe_u32 v28, v0, 4, 1
    v_lshl_add_u32 v24, v28, 3, v24
    v_lshlrev_b32 v24, 2, v24
    v_lshrrev_b32 v28, 5, v0
    v_add_u32 v24, v24, v28
    v_lshlrev_b32 v24, 7, v24
    v_and_b32 v28, 3, v0
    v_lshl_add_u32 v24, v28, 3, v24
    s_lshl_b32 s35, s3, 5
    s_add_u32 s35, s35, 0x20000
    v_add_u32 v24, s35, v24
    v_and_b32 v25, 15, v0
    v_lshlrev_b32 v25, 12, v25
    v_lshrrev_b32 v28, 4, v0
    v_lshl_add_u32 v25, v28, 4, v25
    s_lshl_b32 s35, s34, 2
    s_add_u32 s35, s35, s3
    s_lshl_b32 s35, s35, 16
    s_lshl_b32 s36, s33, 7
    s_add_u32 s35, s35, s36
    s_add_u32 s35, s35, 85983232
L_s1b:
    s_and_b32 s59, s92, ~127
    s_mov_b32 s58, s62
    buffer_load_dword a249, v12, s[12:15], s59 offen sc1
    s_lshl_b32 s37, s25, 1
    s_sub_i32 s38, 13, s37
    s_max_i32 s38, s38, 0
    s_lshl_b32 s49, s26, 20
    s_lshl_b32 s50, s3, 13
    s_add_u32 s49, s49, s50
    s_mov_b32 s51, s63
    s_add_u32 s53, s37, 2
    s_sub_u32 s55, 32, s37
    s_sub_u32 s55, s55, s38
    s_cmp_eq_u32 s27, 0
    s_cselect_b32 s53, s53, s55
    s_cselect_b32 s52, 0, s38
    s_cselect_b32 s54, 0, 2
    v_lshlrev_b32 v1, 4, v0
    v_add_u32 v4, 4096, v1
    s_lshl_b32 s55, s52, 15
    s_add_u32 s42, s55, s49
    s_add_u32 s43, s42, 16777216
    s_mov_b32 s40, s50
    s_add_u32 s41, s50, 0x10000
    v_and_b32 v14, 15, v0
    v_lshrrev_b32 v11, 4, v0
    v_lshlrev_b32 v11, 2, v11
    v_sub_u32 v14, v14, v11
    s_lshl_b32 s48, s3, 4
    v_add_u32 v14, s48, v14
    v_mov_b32 v2, v1
    v_add_u32 v3, 0x10000, v1
    v_mov_b64 v[96:97], 0
    v_mov_b64 v[98:99], 0
    v_mov_b64 v[100:101], 0
    v_mov_b64 v[102:103], 0
    v_mov_b64 v[104:105], 0
    v_mov_b64 v[106:107], 0
    v_mov_b64 v[108:109], 0
    v_mov_b64 v[110:111], 0
    v_mov_b64 v[112:113], 0
    v_mov_b64 v[114:115], 0
    v_mov_b64 v[116:117], 0
    v_mov_b64 v[118:119], 0
    v_mov_b64 v[120:121], 0
    v_mov_b64 v[122:123], 0
    v_mov_b64 v[124:125], 0
    v_mov_b64 v[126:127], 0
    v_mov_b64 v[128:129], 0
    v_mov_b64 v[130:131], 0
    v_mov_b64 v[132:133], 0
    v_mov_b64 v[134:135], 0
    v_mov_b64 v[136:137], 0
    v_mov_b64 v[138:139], 0
    v_mov_b64 v[140:141], 0
    v_mov_b64 v[142:143], 0
    v_mov_b64 v[144:145], 0
    v_mov_b64 v[146:147], 0
    v_mov_b64 v[148:149], 0
    v_mov_b64 v[150:151], 0
    v_mov_b64 v[152:153], 0
    v_mov_b64 v[154:155], 0
    v_mov_b64 v[156:157], 0
    v_mov_b64 v[158:159], 0
    v_mov_b64 v[160:161], 0
    v_mov_b64 v[162:163], 0
    v_mov_b64 v[164:165], 0
    v_mov_b64 v[166:167], 0
    v_mov_b64 v[168:169], 0
    v_mov_b64 v[170:171], 0
    v_mov_b64 v[172:173], 0
    v_mov_b64 v[174:175], 0
    v_mov_b64 v[176:177], 0
    v_mov_b64 v[178:179], 0
    v_mov_b64 v[180:181], 0
    v_mov_b64 v[182:183], 0
    v_mov_b64 v[184:185], 0
    v_mov_b64 v[186:187], 0
    v_mov_b64 v[188:189], 0
    v_mov_b64 v[190:191], 0
    v_mov_b64 v[192:193], 0
    v_mov_b64 v[194:195], 0
    v_mov_b64 v[196:197], 0
    v_mov_b64 v[198:199], 0
    v_mov_b64 v[200:201], 0
    v_mov_b64 v[202:203], 0
    v_mov_b64 v[204:205], 0
    v_mov_b64 v[206:207], 0
    v_mov_b64 v[208:209], 0
    v_mov_b64 v[210:211], 0
    v_mov_b64 v[212:213], 0
    v_mov_b64 v[214:215], 0
    v_mov_b64 v[216:217], 0
    v_mov_b64 v[218:219], 0
    v_mov_b64 v[220:221], 0
    v_mov_b64 v[222:223], 0
    v_mov_b64 v[224:225], 0
    v_mov_b64 v[226:227], 0
    v_mov_b64 v[228:229], 0
    v_mov_b64 v[230:231], 0
    v_mov_b64 v[232:233], 0
    v_mov_b64 v[234:235], 0
    v_mov_b64 v[236:237], 0
    v_mov_b64 v[238:239], 0
    v_mov_b64 v[240:241], 0
    v_mov_b64 v[242:243], 0
    v_mov_b64 v[244:245], 0
    v_mov_b64 v[246:247], 0
    v_mov_b64 v[248:249], 0
    v_mov_b64 v[250:251], 0
    v_mov_b64 v[252:253], 0
    v_mov_b64 v[254:255], 0
    v_mov_b32 v7, 0
    v_mov_b32 v8, 0
    v_mov_b32 v9, 0
    v_mov_b32 v10, 0
    v_accvgpr_write_b32 a246, 1
    v_accvgpr_write_b32 a247, 1
    s_xor_b32 s60, s27, 1
    s_lshl_b32 s60, s60, 2
    s_add_u32 s60, s60, s94
    s_lshr_b32 s61, s95, 4
    s_lshl_b32 s61, s61, 7
    s_add_u32 s61, s61, 84959232
    s_cmp_lt_u32 s28, 14
    s_cselect_b32 s62, 1, 0
    s_andn2_b32 s62, s62, s27
    s_lshl_b32 s30, s95, 1
    s_lshr_b32 s31, s3, 1
    s_add_u32 s30, s30, s31
    s_min_u32 s30, s30, 223
    s_lshl_b32 s30, s30, 2
    s_load_dword s31, s[74:75], s30
    s_mov_b32 s47, 0x4b800000
    s_mov_b32 s45, 2
    s_sub_u32 s44, s53, 1
    s_cmp_ge_u32 s44, 2
    s_cbranch_scc1 L_nomask0
    v_mov_b32 v11, 0xf149f2ca
    v_cmp_gt_i32 s[16:17], 0, v14
    v_cmp_gt_i32 s[18:19], 1, v14
    v_cmp_gt_i32 s[20:21], 2, v14
    v_cmp_gt_i32 s[22:23], 3, v14
    v_cndmask_b32 v96, v9, v11, s[16:17]
    v_cndmask_b32 v97, v9, v11, s[18:19]
    v_cndmask_b32 v98, v9, v11, s[20:21]
    v_cndmask_b32 v99, v9, v11, s[22:23]
    v_cmp_gt_i32 s[16:17], 16, v14
    v_cmp_gt_i32 s[18:19], 17, v14
    v_cmp_gt_i32 s[20:21], 18, v14
    v_cmp_gt_i32 s[22:23], 19, v14
    v_cndmask_b32 v104, v9, v11, s[16:17]
    v_cndmask_b32 v105, v9, v11, s[18:19]
    v_cndmask_b32 v106, v9, v11, s[20:21]
    v_cndmask_b32 v107, v9, v11, s[22:23]
    v_cmp_gt_i32 s[16:17], 32, v14
    v_cmp_gt_i32 s[18:19], 33, v14
    v_cmp_gt_i32 s[20:21], 34, v14
    v_cmp_gt_i32 s[22:23], 35, v14
    v_cndmask_b32 v112, v9, v11, s[16:17]
    v_cndmask_b32 v113, v9, v11, s[18:19]
    v_cndmask_b32 v114, v9, v11, s[20:21]
    v_cndmask_b32 v115, v9, v11, s[22:23]
    v_cmp_gt_i32 s[16:17], 48, v14
    v_cmp_gt_i32 s[18:19], 49, v14
    v_cmp_gt_i32 s[20:21], 50, v14
    v_cmp_gt_i32 s[22:23], 51, v14
    v_cndmask_b32 v120, v9, v11, s[16:17]
    v_cndmask_b32 v121, v9, v11, s[18:19]
    v_cndmask_b32 v122, v9, v11, s[20:21]
    v_cndmask_b32 v123, v9, v11, s[22:23]
L_nomask0:
    v_accvgpr_read_b32 v27, a245
    s_lshl_b32 s36, s95, 2
    s_add_u32 s36, s36, 84959232
    s_cmp_lt_u32 s28, 14
    s_cselect_b32 s36, s36, 2.0
    s_add_u32 s33, s94, 4
    s_cmp_eq_u32 s27, 1
    s_cselect_b32 s33, s33, 2.0
    s_waitcnt vmcnt(0)
    v_accvgpr_read_b32 v28, a248
    v_mov_b32 v29, 0
    v_cmp_gt_u32 vcc, 256, v28
    s_cbranch_vccz L_armed
    s_mov_b32 s32, 0
    v_accvgpr_write_b32 a249, 1
L_pollA:
    global_load_dword v28, v29, s[90:91] offset:128 sc1
    s_add_u32 s32, s32, 1
    s_waitcnt vmcnt(0)
    v_cmp_gt_u32 vcc, 256, v28
    s_cmp_lt_u32 s32, 0x80000
    s_cselect_b64 vcc, vcc, 0
    s_cbranch_vccnz L_pollA
L_armed:
    v_accvgpr_read_b32 v29, a249
    v_cmp_ne_u32 vcc, 0, v29
    s_cbranch_vccz L_poll0_ok
    v_and_b32 v28, 15, v0
    v_lshlrev_b32 v28, 2, v28
    s_mov_b32 s32, 0
L_poll0:
    buffer_load_dword v29, v28, s[12:15], s59 offen sc1
    s_waitcnt vmcnt(0)
    v_cmp_ne_u32 vcc, 0, v29
    s_cbranch_vccz L_poll0_ok
    s_sleep 8
    s_add_u32 s32, s32, 1
    s_cmp_lt_u32 s32, 0x80000
    s_cbranch_scc1 L_poll0
L_poll0_ok:
    s_mov_b32 m0, s40
    s_nop 0
    buffer_load_dwordx4 v1, s[12:15], s42 offen offset:0 sc1 lds
    buffer_load_dwordx4 v1, s[12:15], s42 offen offset:1024 sc1 lds
    buffer_load_dwordx4 v1, s[12:15], s42 offen offset:2048 sc1 lds
    buffer_load_dwordx4 v1, s[12:15], s42 offen offset:3072 sc1 lds
    s_bitset1_b32 m0, 12
    s_nop 0
    buffer_load_dwordx4 v4, s[12:15], s42 offen offset:0 sc1 lds
    buffer_load_dwordx4 v4, s[12:15], s42 offen offset:1024 sc1 lds
    buffer_load_dwordx4 v4, s[12:15], s42 offen offset:2048 sc1 lds
    buffer_load_dwordx4 v4, s[12:15], s42 offen offset:3072 sc1 lds
    s_add_u32 s42, s42, 0x8000
    s_xor_b32 s40, s40, 0x8000
    s_mov_b32 m0, s40
    s_nop 0
    buffer_load_dwordx4 v1, s[12:15], s42 offen offset:0 sc1 lds
    buffer_load_dwordx4 v1, s[12:15], s42 offen offset:1024 sc1 lds
    buffer_load_dwordx4 v1, s[12:15], s42 offen offset:2048 sc1 lds
    buffer_load_dwordx4 v1, s[12:15], s42 offen offset:3072 sc1 lds
    s_bitset1_b32 m0, 12
    s_nop 0
    buffer_load_dwordx4 v4, s[12:15], s42 offen offset:0 sc1 lds
    buffer_load_dwordx4 v4, s[12:15], s42 offen offset:1024 sc1 lds
    buffer_load_dwordx4 v4, s[12:15], s42 offen offset:2048 sc1 lds
    buffer_load_dwordx4 v4, s[12:15], s42 offen offset:3072 sc1 lds
    s_add_u32 s42, s42, 0x8000
    s_xor_b32 s40, s40, 0x8000
    s_waitcnt vmcnt(8) lgkmcnt(0)
    s_barrier
    ds_read_b128 a[64:67], v2 offset:0
    ds_read_b128 a[68:71], v2 offset:1024
    ds_read_b128 a[72:75], v2 offset:2048
    ds_read_b128 a[76:79], v2 offset:3072
    ds_read_b128 a[80:83], v2 offset:4096
    ds_read_b128 a[84:87], v2 offset:5120
    ds_read_b128 a[88:91], v2 offset:6144
    ds_read_b128 a[92:95], v2 offset:7168
    buffer_store_dword v27, v27, s[12:15], s33 offen sc1
    s_cmp_ge_u32 s28, 14
    s_cbranch_scc1 L_s1c
    ds_read_b64_tr_b16 v[16:17], v24 offset:0
    ds_read_b64_tr_b16 v[18:19], v24 offset:2048
    ds_read_b64_tr_b16 v[20:21], v24 offset:256
    ds_read_b64_tr_b16 v[22:23], v24 offset:2304
    s_waitcnt lgkmcnt(0)
    buffer_store_dwordx4 v[16:19], v25, s[12:15], s35 offen offset:0 sc1
    buffer_store_dwordx4 v[20:23], v25, s[12:15], s35 offen offset:64 sc1
L_s1c:
    s_mov_b32 m0, s41
    s_waitcnt lgkmcnt(0)
    v_mfma_f32_16x16x32_bf16 v[32:35], a[64:67], a[0:3], v[96:99]
    ds_read_b128 a[96:99], v2 offset:8192
    v_mfma_f32_16x16x32_bf16 v[32:35], a[68:71], a[4:7], v[32:35]
    buffer_load_dwordx4 v1, s[12:15], s43 offen offset:0 sc1 lds
    v_mfma_f32_16x16x32_bf16 v[32:35], a[72:75], a[8:11], v[32:35]
    ds_read_b128 a[100:103], v2 offset:9216
    v_mfma_f32_16x16x32_bf16 v[32:35], a[76:79], a[12:15], v[32:35]
    v_mfma_f32_16x16x32_bf16 v[32:35], a[80:83], a[16:19], v[32:35]
    ds_read_b128 a[104:107], v2 offset:10240
    v_mfma_f32_16x16x32_bf16 v[32:35], a[84:87], a[20:23], v[32:35]
    buffer_load_dwordx4 v1, s[12:15], s43 offen offset:1024 sc1 lds
    v_mfma_f32_16x16x32_bf16 v[32:35], a[88:91], a[24:27], v[32:35]
    ds_read_b128 a[108:111], v2 offset:11264
    v_mfma_f32_16x16x32_bf16 v[32:35], a[92:95], a[28:31], v[32:35]
    v_mfma_f32_16x16x32_bf16 v[36:39], a[64:67], a[32:35], v[100:103]
    ds_read_b128 a[112:115], v2 offset:12288
    v_mfma_f32_16x16x32_bf16 v[36:39], a[68:71], a[36:39], v[36:39]
    buffer_load_dwordx4 v1, s[12:15], s43 offen offset:2048 sc1 lds
    v_mfma_f32_16x16x32_bf16 v[36:39], a[72:75], a[40:43], v[36:39]
    ds_read_b128 a[116:119], v2 offset:13312
    v_mfma_f32_16x16x32_bf16 v[36:39], a[76:79], a[44:47], v[36:39]
    v_mfma_f32_16x16x32_bf16 v[36:39], a[80:83], a[48:51], v[36:39]
    ds_read_b128 a[120:123], v2 offset:14336
    v_mfma_f32_16x16x32_bf16 v[36:39], a[84:87], a[52:55], v[36:39]
    buffer_load_dwordx4 v1, s[12:15], s43 offen offset:3072 sc1 lds
    v_mfma_f32_16x16x32_bf16 v[36:39], a[88:91], a[56:59], v[36:39]
    ds_read_b128 a[124:127], v2 offset:15360
    v_mfma_f32_16x16x32_bf16 v[36:39], a[92:95], a[60:63], v[36:39]
    s_waitcnt lgkmcnt(6)
    v_exp_f32 v64, v32
    v_mfma_f32_16x16x32_bf16 v[40:43], a[96:99], a[0:3], v[104:107]
    s_bitset1_b32 m0, 12
    ds_read_b128 a[64:67], v2 offset:16384
    v_mfma_f32_16x16x32_bf16 v[40:43], a[100:103], a[4:7], v[40:43]
    s_waitcnt lgkmcnt(5)
    buffer_load_dwordx4 v4, s[12:15], s43 offen offset:0 sc1 lds
    v_mfma_f32_16x16x32_bf16 v[40:43], a[104:107], a[8:11], v[40:43]
    ds_read_b128 a[68:71], v2 offset:17408
    v_mfma_f32_16x16x32_bf16 v[40:43], a[108:111], a[12:15], v[40:43]
    s_waitcnt lgkmcnt(4)
    v_exp_f32 v65, v33
    v_mfma_f32_16x16x32_bf16 v[40:43], a[112:115], a[16:19], v[40:43]
    ds_read_b128 a[72:75], v2 offset:18432
    v_add_f32 v5, v64, v65
    v_mfma_f32_16x16x32_bf16 v[40:43], a[116:119], a[20:23], v[40:43]
    s_waitcnt lgkmcnt(3)
    buffer_load_dwordx4 v4, s[12:15], s43 offen offset:1024 sc1 lds
    v_mfma_f32_16x16x32_bf16 v[40:43], a[120:123], a[24:27], v[40:43]
    ds_read_b128 a[76:79], v2 offset:19456
    v_mfma_f32_16x16x32_bf16 v[40:43], a[124:127], a[28:31], v[40:43]
    v_exp_f32 v66, v34
    v_mfma_f32_16x16x32_bf16 v[44:47], a[96:99], a[32:35], v[108:111]
    ds_read_b128 a[80:83], v2 offset:20480
    v_add_f32 v5, v5, v66
    v_mfma_f32_16x16x32_bf16 v[44:47], a[100:103], a[36:39], v[44:47]
    buffer_load_dwordx4 v4, s[12:15], s43 offen offset:2048 sc1 lds
    v_mfma_f32_16x16x32_bf16 v[44:47], a[104:107], a[40:43], v[44:47]
    ds_read_b128 a[84:87], v2 offset:21504
    v_mfma_f32_16x16x32_bf16 v[44:47], a[108:111], a[44:47], v[44:47]
    v_exp_f32 v67, v35
    v_mfma_f32_16x16x32_bf16 v[44:47], a[112:115], a[48:51], v[44:47]
    ds_read_b128 a[88:91], v2 offset:22528
    v_add_f32 v5, v5, v67
    v_mfma_f32_16x16x32_bf16 v[44:47], a[116:119], a[52:55], v[44:47]
    buffer_load_dwordx4 v4, s[12:15], s43 offen offset:3072 sc1 lds
    v_mfma_f32_16x16x32_bf16 v[44:47], a[120:123], a[56:59], v[44:47]
    ds_read_b128 a[92:95], v2 offset:23552
    v_mfma_f32_16x16x32_bf16 v[44:47], a[124:127], a[60:63], v[44:47]
    s_waitcnt lgkmcnt(6)
    v_exp_f32 v68, v36
    v_mfma_f32_16x16x32_bf16 v[48:51], a[64:67], a[0:3], v[112:115]
    s_add_u32 s43, s43, 0x8000
    ds_read_b128 a[96:99], v2 offset:24576
    v_mfma_f32_16x16x32_bf16 v[48:51], a[68:71], a[4:7], v[48:51]
    s_waitcnt lgkmcnt(5)
    v_exp_f32 v69, v37
    v_mfma_f32_16x16x32_bf16 v[48:51], a[72:75], a[8:11], v[48:51]
    s_xor_b32 s41, s41, 0x8000
    ds_read_b128 a[100:103], v2 offset:25600
    v_add_f32 v6, v68, v69
    v_mfma_f32_16x16x32_bf16 v[48:51], a[76:79], a[12:15], v[48:51]
    s_waitcnt lgkmcnt(4)
    v_exp_f32 v70, v38
    v_mfma_f32_16x16x32_bf16 v[48:51], a[80:83], a[16:19], v[48:51]
    ds_read_b128 a[104:107], v2 offset:26624
    v_add_f32 v6, v6, v70
    v_mfma_f32_16x16x32_bf16 v[48:51], a[84:87], a[20:23], v[48:51]
    s_waitcnt lgkmcnt(3)
    v_exp_f32 v71, v39
    v_mfma_f32_16x16x32_bf16 v[48:51], a[88:91], a[24:27], v[48:51]
    ds_read_b128 a[108:111], v2 offset:27648
    v_add_f32 v6, v6, v71
    v_mfma_f32_16x16x32_bf16 v[48:51], a[92:95], a[28:31], v[48:51]
    v_exp_f32 v72, v40
    v_mfma_f32_16x16x32_bf16 v[52:55], a[64:67], a[32:35], v[116:119]
    ds_read_b128 a[112:115], v2 offset:28672
    v_add_f32 v5, v5, v72
    v_mfma_f32_16x16x32_bf16 v[52:55], a[68:71], a[36:39], v[52:55]
    v_exp_f32 v73, v41
    v_mfma_f32_16x16x32_bf16 v[52:55], a[72:75], a[40:43], v[52:55]
    ds_read_b128 a[116:119], v2 offset:29696
    v_add_f32 v5, v5, v73
    v_mfma_f32_16x16x32_bf16 v[52:55], a[76:79], a[44:47], v[52:55]
    v_exp_f32 v74, v42
    v_mfma_f32_16x16x32_bf16 v[52:55], a[80:83], a[48:51], v[52:55]
    ds_read_b128 a[120:123], v2 offset:30720
    v_add_f32 v5, v5, v74
    v_mfma_f32_16x16x32_bf16 v[52:55], a[84:87], a[52:55], v[52:55]
    v_exp_f32 v75, v43
    v_mfma_f32_16x16x32_bf16 v[52:55], a[88:91], a[56:59], v[52:55]
    ds_read_b128 a[124:127], v2 offset:31744
    v_add_f32 v5, v5, v75
    v_mfma_f32_16x16x32_bf16 v[52:55], a[92:95], a[60:63], v[52:55]
    s_waitcnt lgkmcnt(6)
    v_exp_f32 v76, v44
    v_mfma_f32_16x16x32_bf16 v[56:59], a[96:99], a[0:3], v[120:123]
    v_exp_f32 v77, v45
    v_mfma_f32_16x16x32_bf16 v[56:59], a[100:103], a[4:7], v[56:59]
    s_waitcnt lgkmcnt(4)
    v_exp_f32 v78, v46
    v_mfma_f32_16x16x32_bf16 v[56:59], a[104:107], a[8:11], v[56:59]
    v_exp_f32 v79, v47
    v_mfma_f32_16x16x32_bf16 v[56:59], a[108:111], a[12:15], v[56:59]
    s_waitcnt lgkmcnt(2)
    v_exp_f32 v80, v48
    v_mfma_f32_16x16x32_bf16 v[56:59], a[112:115], a[16:19], v[56:59]
    v_exp_f32 v81, v49
    v_mfma_f32_16x16x32_bf16 v[56:59], a[116:119], a[20:23], v[56:59]
    s_waitcnt lgkmcnt(0)
    v_exp_f32 v82, v50
    v_mfma_f32_16x16x32_bf16 v[56:59], a[120:123], a[24:27], v[56:59]
    v_exp_f32 v83, v51
    v_mfma_f32_16x16x32_bf16 v[56:59], a[124:127], a[28:31], v[56:59]
    v_exp_f32 v84, v52
    v_mfma_f32_16x16x32_bf16 v[60:63], a[96:99], a[32:35], v[124:127]
    v_exp_f32 v85, v53
    v_mfma_f32_16x16x32_bf16 v[60:63], a[100:103], a[36:39], v[60:63]
    v_exp_f32 v86, v54
    v_mfma_f32_16x16x32_bf16 v[60:63], a[104:107], a[40:43], v[60:63]
    v_exp_f32 v87, v55
    v_mfma_f32_16x16x32_bf16 v[60:63], a[108:111], a[44:47], v[60:63]
    v_add_f32 v6, v6, v76
    v_mfma_f32_16x16x32_bf16 v[60:63], a[112:115], a[48:51], v[60:63]
    v_add_f32 v6, v6, v77
    v_mfma_f32_16x16x32_bf16 v[60:63], a[116:119], a[52:55], v[60:63]
    v_exp_f32 v88, v56
    v_mfma_f32_16x16x32_bf16 v[60:63], a[120:123], a[56:59], v[60:63]
    v_exp_f32 v89, v57
    v_mfma_f32_16x16x32_bf16 v[60:63], a[124:127], a[60:63], v[60:63]
    v_exp_f32 v90, v58
    v_xor_b32 v2, 0x8000, v2
    s_waitcnt vmcnt(8)
    s_barrier
    ds_read_b128 a[64:67], v2 offset:0
    ds_read_b128 a[68:71], v2 offset:1024
    ds_read_b128 a[72:75], v2 offset:2048
    ds_read_b128 a[76:79], v2 offset:3072
    ds_read_b128 a[80:83], v2 offset:4096
    ds_read_b128 a[84:87], v2 offset:5120
    ds_read_b128 a[88:91], v2 offset:6144
    ds_read_b128 a[92:95], v2 offset:7168
    buffer_store_dword v27, v27, s[12:15], s36 offen sc1
    v_exp_f32 v91, v59
    v_exp_f32 v92, v60
    v_exp_f32 v93, v61
    v_exp_f32 v94, v62
    v_exp_f32 v95, v63
    v_add_f32 v6, v6, v78
    v_add_f32 v6, v6, v79
    v_add_f32 v5, v5, v80
    v_add_f32 v5, v5, v81
    v_add_f32 v5, v5, v82
    v_add_f32 v5, v5, v83
    v_add_f32 v6, v6, v84
    v_add_f32 v6, v6, v85
    v_add_f32 v6, v6, v86
    v_add_f32 v6, v6, v87
    v_add_f32 v5, v5, v88
    v_add_f32 v5, v5, v89
    v_add_f32 v5, v5, v90
    v_add_f32 v5, v5, v91
    v_add_f32 v6, v6, v92
    v_add_f32 v6, v6, v93
    v_add_f32 v6, v6, v94
    v_add_f32 v6, v6, v95
L_first:
    v_add_f32 v11, v5, v6
    v_min_f32 v12, v5, v6
    v_cmp_nge_f32 vcc, s47, v11
    s_mov_b32 s46, 0xff800000
    s_cbranch_vccnz L_slow2
    v_cmp_gt_f32 vcc, 0x33800000, v12
    s_cbranch_vccnz L_slow2
    s_mov_b32 s46, 0
    s_waitcnt lgkmcnt(0)
    s_branch L_ret
L_slow:
    s_cmp_lg_u32 s47, 0x4b800000
    s_cbranch_scc1 L_switched
    s_nop 5
L_slow2:
    v_max3_f32 v11, v32, v33, v34
    v_max3_f32 v11, v11, v35, v40
    v_max3_f32 v11, v11, v41, v42
    v_max3_f32 v11, v11, v43, v48
    v_max3_f32 v11, v11, v49, v50
    v_max3_f32 v11, v11, v51, v56
    v_max3_f32 v11, v11, v57, v58
    v_max_f32 v11, v11, v59
    v_mov_b32 v13, v11
    s_nop 1
    v_permlane32_swap_b32 v11, v13
    s_nop 1
    v_max_f32 v11, v11, v13
    v_mov_b32 v13, v11
    s_nop 1
    v_permlane16_swap_b32 v11, v13
    s_nop 1
    v_max_f32 v11, v11, v13
    v_max_f32 v11, s46, v11
    v_sub_f32 v9, v9, v11
    v_sub_f32 v32, v32, v11
    v_sub_f32 v33, v33, v11
    v_sub_f32 v34, v34, v11
    v_sub_f32 v35, v35, v11
    v_sub_f32 v40, v40, v11
    v_sub_f32 v41, v41, v11
    v_sub_f32 v42, v42, v11
    v_sub_f32 v43, v43, v11
    v_sub_f32 v48, v48, v11
    v_sub_f32 v49, v49, v11
    v_sub_f32 v50, v50, v11
    v_sub_f32 v51, v51, v11
    v_sub_f32 v56, v56, v11
    v_sub_f32 v57, v57, v11
    v_sub_f32 v58, v58, v11
    v_sub_f32 v59, v59, v11
    v_exp_f32 v64, v32
    v_mov_b32 v96, v9
    v_exp_f32 v65, v33
    v_mov_b32 v97, v9
    v_exp_f32 v66, v34
    v_mov_b32 v98, v9
    v_exp_f32 v67, v35
    v_mov_b32 v99, v9
    v_exp_f32 v72, v40
    v_mov_b32 v104, v9
    v_exp_f32 v73, v41
    v_mov_b32 v105, v9
    v_exp_f32 v74, v42
    v_mov_b32 v106, v9
    v_exp_f32 v75, v43
    v_mov_b32 v107, v9
    v_exp_f32 v80, v48
    v_mov_b32 v112, v9
    v_exp_f32 v81, v49
    v_mov_b32 v113, v9
    v_exp_f32 v82, v50
    v_mov_b32 v114, v9
    v_exp_f32 v83, v51
    v_mov_b32 v115, v9
    v_exp_f32 v88, v56
    v_mov_b32 v120, v9
    v_exp_f32 v89, v57
    v_mov_b32 v121, v9
    v_exp_f32 v90, v58
    v_mov_b32 v122, v9
    v_exp_f32 v91, v59
    v_mov_b32 v123, v9
    v_add_f32 v5, v64, v65
    v_add_f32 v5, v5, v66
    v_add_f32 v5, v5, v67
    v_add_f32 v5, v5, v72
    v_add_f32 v5, v5, v73
    v_add_f32 v5, v5, v74
    v_add_f32 v5, v5, v75
    v_add_f32 v5, v5, v80
    v_add_f32 v5, v5, v81
    v_add_f32 v5, v5, v82
    v_add_f32 v5, v5, v83
    v_add_f32 v5, v5, v88
    v_add_f32 v5, v5, v89
    v_add_f32 v5, v5, v90
    v_add_f32 v5, v5, v91
    v_max3_f32 v12, v36, v37, v38
    v_max3_f32 v12, v12, v39, v44
    v_max3_f32 v12, v12, v45, v46
    v_max3_f32 v12, v12, v47, v52
    v_max3_f32 v12, v12, v53, v54
    v_max3_f32 v12, v12, v55, v60
    v_max3_f32 v12, v12, v61, v62
    v_max_f32 v12, v12, v63
    v_mov_b32 v13, v12
    s_nop 1
    v_permlane32_swap_b32 v12, v13
    s_nop 1
    v_max_f32 v12, v12, v13
    v_mov_b32 v13, v12
    s_nop 1
    v_permlane16_swap_b32 v12, v13
    s_nop 1
    v_max_f32 v12, v12, v13
    v_max_f32 v12, s46, v12
    v_sub_f32 v10, v10, v12
    v_sub_f32 v36, v36, v12
    v_sub_f32 v37, v37, v12
    v_sub_f32 v38, v38, v12
    v_sub_f32 v39, v39, v12
    v_sub_f32 v44, v44, v12
    v_sub_f32 v45, v45, v12
    v_sub_f32 v46, v46, v12
    v_sub_f32 v47, v47, v12
    v_sub_f32 v52, v52, v12
    v_sub_f32 v53, v53, v12
    v_sub_f32 v54, v54, v12
    v_sub_f32 v55, v55, v12
    v_sub_f32 v60, v60, v12
    v_sub_f32 v61, v61, v12
    v_sub_f32 v62, v62, v12
    v_sub_f32 v63, v63, v12
    v_exp_f32 v68, v36
    v_mov_b32 v100, v10
    v_exp_f32 v69, v37
    v_mov_b32 v101, v10
    v_exp_f32 v70, v38
    v_mov_b32 v102, v10
    v_exp_f32 v71, v39
    v_mov_b32 v103, v10
    v_exp_f32 v76, v44
    v_mov_b32 v108, v10
    v_exp_f32 v77, v45
    v_mov_b32 v109, v10
    v_exp_f32 v78, v46
    v_mov_b32 v110, v10
    v_exp_f32 v79, v47
    v_mov_b32 v111, v10
    v_exp_f32 v84, v52
    v_mov_b32 v116, v10
    v_exp_f32 v85, v53
    v_mov_b32 v117, v10
    v_exp_f32 v86, v54
    v_mov_b32 v118, v10
    v_exp_f32 v87, v55
    v_mov_b32 v119, v10
    v_exp_f32 v92, v60
    v_mov_b32 v124, v10
    v_exp_f32 v93, v61
    v_mov_b32 v125, v10
    v_exp_f32 v94, v62
    v_mov_b32 v126, v10
    v_exp_f32 v95, v63
    v_mov_b32 v127, v10
    v_add_f32 v6, v68, v69
    v_add_f32 v6, v6, v70
    v_add_f32 v6, v6, v71
    v_add_f32 v6, v6, v76
    v_add_f32 v6, v6, v77
    v_add_f32 v6, v6, v78
    v_add_f32 v6, v6, v79
    v_add_f32 v6, v6, v84
    v_add_f32 v6, v6, v85
    v_add_f32 v6, v6, v86
    v_add_f32 v6, v6, v87
    v_add_f32 v6, v6, v92
    v_add_f32 v6, v6, v93
    v_add_f32 v6, v6, v94
    v_add_f32 v6, v6, v95
    s_waitcnt lgkmcnt(0)
    s_cmp_lg_u32 s46, 0
    s_mov_b32 s46, 0
    s_cbranch_scc1 L_ret
    v_exp_f32 v11, -v11
    s_nop 0
    v_mul_f32 v7, v7, v11
    v_mul_f32 v128, v128, v11
    v_mul_f32 v129, v129, v11
    v_mul_f32 v130, v130, v11
    v_mul_f32 v131, v131, v11
    v_mul_f32 v132, v132, v11
    v_mul_f32 v133, v133, v11
    v_mul_f32 v134, v134, v11
    v_mul_f32 v135, v135, v11
    v_mul_f32 v136, v136, v11
    v_mul_f32 v137, v137, v11
    v_mul_f32 v138, v138, v11
    v_mul_f32 v139, v139, v11
    v_mul_f32 v140, v140, v11
    v_mul_f32 v141, v141, v11
    v_mul_f32 v142, v142, v11
    v_mul_f32 v143, v143, v11
    v_mul_f32 v144, v144, v11
    v_mul_f32 v145, v145, v11
    v_mul_f32 v146, v146, v11
    v_mul_f32 v147, v147, v11
    v_mul_f32 v148, v148, v11
    v_mul_f32 v149, v149, v11
    v_mul_f32 v150, v150, v11
    v_mul_f32 v151, v151, v11
    v_mul_f32 v152, v152, v11
    v_mul_f32 v153, v153, v11
    v_mul_f32 v154, v154, v11
    v_mul_f32 v155, v155, v11
    v_mul_f32 v156, v156, v11
    v_mul_f32 v157, v157, v11
    v_mul_f32 v158, v158, v11
    v_mul_f32 v159, v159, v11
    v_mul_f32 v160, v160, v11
    v_mul_f32 v161, v161, v11
    v_mul_f32 v162, v162, v11
    v_mul_f32 v163, v163, v11
    v_mul_f32 v164, v164, v11
    v_mul_f32 v165, v165, v11
    v_mul_f32 v166, v166, v11
    v_mul_f32 v167, v167, v11
    v_mul_f32 v168, v168, v11
    v_mul_f32 v169, v169, v11
    v_mul_f32 v170, v170, v11
    v_mul_f32 v171, v171, v11
    v_mul_f32 v172, v172, v11
    v_mul_f32 v173, v173, v11
    v_mul_f32 v174, v174, v11
    v_mul_f32 v175, v175, v11
    v_mul_f32 v176, v176, v11
    v_mul_f32 v177, v177, v11
    v_mul_f32 v178, v178, v11
    v_mul_f32 v179, v179, v11
    v_mul_f32 v180, v180, v11
    v_mul_f32 v181, v181, v11
    v_mul_f32 v182, v182, v11
    v_mul_f32 v183, v183, v11
    v_mul_f32 v184, v184, v11
    v_mul_f32 v185, v185, v11
    v_mul_f32 v186, v186, v11
    v_mul_f32 v187, v187, v11
    v_mul_f32 v188, v188, v11
    v_mul_f32 v189, v189, v11
    v_mul_f32 v190, v190, v11
    v_mul_f32 v191, v191, v11
    v_exp_f32 v12, -v12
    s_nop 0
    v_mul_f32 v8, v8, v12
    v_mul_f32 v192, v192, v12
    v_mul_f32 v193, v193, v12
    v_mul_f32 v194, v194, v12
    v_mul_f32 v195, v195, v12
    v_mul_f32 v196, v196, v12
    v_mul_f32 v197, v197, v12
    v_mul_f32 v198, v198, v12
    v_mul_f32 v199, v199, v12
    v_mul_f32 v200, v200, v12
    v_mul_f32 v201, v201, v12
    v_mul_f32 v202, v202, v12
    v_mul_f32 v203, v203, v12
    v_mul_f32 v204, v204, v12
    v_mul_f32 v205, v205, v12
    v_mul_f32 v206, v206, v12
    v_mul_f32 v207, v207, v12
    v_mul_f32 v208, v208, v12
    v_mul_f32 v209, v209, v12
    v_mul_f32 v210, v210, v12
    v_mul_f32 v211, v211, v12
    v_mul_f32 v212, v212, v12
    v_mul_f32 v213, v213, v12
    v_mul_f32 v214, v214, v12
    v_mul_f32 v215, v215, v12
    v_mul_f32 v216, v216, v12
    v_mul_f32 v217, v217, v12
    v_mul_f32 v218, v218, v12
    v_mul_f32 v219, v219, v12
    v_mul_f32 v220, v220, v12
    v_mul_f32 v221, v221, v12
    v_mul_f32 v222, v222, v12
    v_mul_f32 v223, v223, v12
    v_mul_f32 v224, v224, v12
    v_mul_f32 v225, v225, v12
    v_mul_f32 v226, v226, v12
    v_mul_f32 v227, v227, v12
    v_mul_f32 v228, v228, v12
    v_mul_f32 v229, v229, v12
    v_mul_f32 v230, v230, v12
    v_mul_f32 v231, v231, v12
    v_mul_f32 v232, v232, v12
    v_mul_f32 v233, v233, v12
    v_mul_f32 v234, v234, v12
    v_mul_f32 v235, v235, v12
    v_mul_f32 v236, v236, v12
    v_mul_f32 v237, v237, v12
    v_mul_f32 v238, v238, v12
    v_mul_f32 v239, v239, v12
    v_mul_f32 v240, v240, v12
    v_mul_f32 v241, v241, v12
    v_mul_f32 v242, v242, v12
    v_mul_f32 v243, v243, v12
    v_mul_f32 v244, v244, v12
    v_mul_f32 v245, v245, v12
    v_mul_f32 v246, v246, v12
    v_mul_f32 v247, v247, v12
    v_mul_f32 v248, v248, v12
    v_mul_f32 v249, v249, v12
    v_mul_f32 v250, v250, v12
    v_mul_f32 v251, v251, v12
    v_mul_f32 v252, v252, v12
    v_mul_f32 v253, v253, v12
    v_mul_f32 v254, v254, v12
    v_mul_f32 v255, v255, v12
    s_branch L_ret
.p2align 6
L_loop:
    v_mfma_f32_16x16x32_bf16 v[32:35], a[64:67], a[0:3], v[96:99]
    s_mov_b32 m0, s40
    ds_read_b128 a[96:99], v2 offset:8192
    v_cvt_pk_bf16_f32 v16, v64, v65
    v_mfma_f32_16x16x32_bf16 v[32:35], a[68:71], a[4:7], v[32:35]
    s_waitcnt lgkmcnt(5)
    buffer_load_dwordx4 v1, s[12:15], s42 offen offset:0 sc1 lds
    v_mfma_f32_16x16x32_bf16 v[32:35], a[72:75], a[8:11], v[32:35]
    ds_read_b128 a[100:103], v2 offset:9216
    v_cvt_pk_bf16_f32 v17, v66, v67
    v_mfma_f32_16x16x32_bf16 v[32:35], a[76:79], a[12:15], v[32:35]
    s_waitcnt lgkmcnt(4)
    v_cvt_pk_bf16_f32 v20, v68, v69
    v_cvt_pk_bf16_f32 v21, v70, v71
    v_mfma_f32_16x16x32_bf16 v[32:35], a[80:83], a[16:19], v[32:35]
    ds_read_b128 a[104:107], v2 offset:10240
    v_add_f32 v7, v7, v5
    v_mfma_f32_16x16x32_bf16 v[32:35], a[84:87], a[20:23], v[32:35]
    s_waitcnt lgkmcnt(3)
    v_add_f32 v8, v8, v6
    v_cvt_pk_bf16_f32 v18, v72, v73
    v_mfma_f32_16x16x32_bf16 v[32:35], a[88:91], a[24:27], v[32:35]
    ds_read_b128 a[108:111], v2 offset:11264
    v_cvt_pk_bf16_f32 v19, v74, v75
    v_mfma_f32_16x16x32_bf16 v[32:35], a[92:95], a[28:31], v[32:35]
    buffer_load_dwordx4 v1, s[12:15], s42 offen offset:1024 sc1 lds
    v_mfma_f32_16x16x32_bf16 v[36:39], a[64:67], a[32:35], v[100:103]
    ds_read_b128 a[112:115], v2 offset:12288
    v_cvt_pk_bf16_f32 v22, v76, v77
    v_mfma_f32_16x16x32_bf16 v[36:39], a[68:71], a[36:39], v[36:39]
    v_cvt_pk_bf16_f32 v23, v78, v79
    v_cvt_pk_bf16_f32 v24, v80, v81
    v_mfma_f32_16x16x32_bf16 v[36:39], a[72:75], a[40:43], v[36:39]
    ds_read_b128 a[116:119], v2 offset:13312
    v_cvt_pk_bf16_f32 v25, v82, v83
    v_mfma_f32_16x16x32_bf16 v[36:39], a[76:79], a[44:47], v[36:39]
    v_cvt_pk_bf16_f32 v28, v84, v85
    v_cvt_pk_bf16_f32 v29, v86, v87
    v_mfma_f32_16x16x32_bf16 v[36:39], a[80:83], a[48:51], v[36:39]
    ds_read_b128 a[120:123], v2 offset:14336
    v_cvt_pk_bf16_f32 v26, v88, v89
    v_mfma_f32_16x16x32_bf16 v[36:39], a[84:87], a[52:55], v[36:39]
    buffer_load_dwordx4 v1, s[12:15], s42 offen offset:2048 sc1 lds
    v_mfma_f32_16x16x32_bf16 v[36:39], a[88:91], a[56:59], v[36:39]
    ds_read_b128 a[124:127], v2 offset:15360
    v_cvt_pk_bf16_f32 v27, v90, v91
    v_mfma_f32_16x16x32_bf16 v[36:39], a[92:95], a[60:63], v[36:39]
    s_waitcnt lgkmcnt(6)
    v_exp_f32 v64, v32
    v_mfma_f32_16x16x32_bf16 v[40:43], a[96:99], a[0:3], v[104:107]
    ds_read_b128 a[64:67], v2 offset:16384
    v_cvt_pk_bf16_f32 v30, v92, v93
    v_mfma_f32_16x16x32_bf16 v[40:43], a[100:103], a[4:7], v[40:43]
    s_waitcnt lgkmcnt(5)
    v_exp_f32 v65, v33
    v_mfma_f32_16x16x32_bf16 v[40:43], a[104:107], a[8:11], v[40:43]
    ds_read_b128 a[68:71], v2 offset:17408
    v_cvt_pk_bf16_f32 v31, v94, v95
    v_mfma_f32_16x16x32_bf16 v[40:43], a[108:111], a[12:15], v[40:43]
    s_waitcnt lgkmcnt(4)
    buffer_load_dwordx4 v1, s[12:15], s42 offen offset:3072 sc1 lds
    v_mfma_f32_16x16x32_bf16 v[40:43], a[112:115], a[16:19], v[40:43]
    ds_read_b128 a[72:75], v2 offset:18432
    v_add_f32 v5, v64, v65
    v_mfma_f32_16x16x32_bf16 v[40:43], a[116:119], a[20:23], v[40:43]
    s_waitcnt lgkmcnt(3)
    v_exp_f32 v66, v34
    v_mfma_f32_16x16x32_bf16 v[40:43], a[120:123], a[24:27], v[40:43]
    ds_read_b128 a[76:79], v2 offset:19456
    v_add_f32 v5, v5, v66
    v_mfma_f32_16x16x32_bf16 v[40:43], a[124:127], a[28:31], v[40:43]
    v_exp_f32 v67, v35
    v_mfma_f32_16x16x32_bf16 v[44:47], a[96:99], a[32:35], v[108:111]
    s_bitset1_b32 m0, 12
    ds_read_b128 a[80:83], v2 offset:20480
    v_add_f32 v5, v5, v67
    v_mfma_f32_16x16x32_bf16 v[44:47], a[100:103], a[36:39], v[44:47]
    buffer_load_dwordx4 v4, s[12:15], s42 offen offset:0 sc1 lds
    v_mfma_f32_16x16x32_bf16 v[44:47], a[104:107], a[40:43], v[44:47]
    ds_read_b128 a[84:87], v2 offset:21504
    v_mfma_f32_16x16x32_bf16 v[44:47], a[108:111], a[44:47], v[44:47]
    v_exp_f32 v68, v36
    v_mfma_f32_16x16x32_bf16 v[44:47], a[112:115], a[48:51], v[44:47]
    ds_read_b128 a[88:91], v2 offset:22528
    v_mfma_f32_16x16x32_bf16 v[44:47], a[116:119], a[52:55], v[44:47]
    v_exp_f32 v69, v37
    v_mfma_f32_16x16x32_bf16 v[44:47], a[120:123], a[56:59], v[44:47]
    ds_read_b128 a[92:95], v2 offset:23552
    v_add_f32 v6, v68, v69
    v_mfma_f32_16x16x32_bf16 v[44:47], a[124:127], a[60:63], v[44:47]
    s_waitcnt lgkmcnt(6)
    buffer_load_dwordx4 v4, s[12:15], s42 offen offset:1024 sc1 lds
    v_mfma_f32_16x16x32_bf16 v[48:51], a[64:67], a[0:3], v[112:115]
    ds_read_b128 a[96:99], v2 offset:24576
    v_mfma_f32_16x16x32_bf16 v[48:51], a[68:71], a[4:7], v[48:51]
    s_waitcnt lgkmcnt(5)
    v_exp_f32 v70, v38
    v_mfma_f32_16x16x32_bf16 v[48:51], a[72:75], a[8:11], v[48:51]
    ds_read_b128 a[100:103], v2 offset:25600
    v_add_f32 v6, v6, v70
    v_mfma_f32_16x16x32_bf16 v[48:51], a[76:79], a[12:15], v[48:51]
    s_waitcnt lgkmcnt(4)
    v_exp_f32 v71, v39
    v_mfma_f32_16x16x32_bf16 v[48:51], a[80:83], a[16:19], v[48:51]
    ds_read_b128 a[104:107], v2 offset:26624
    v_add_f32 v6, v6, v71
    v_mfma_f32_16x16x32_bf16 v[48:51], a[84:87], a[20:23], v[48:51]
    s_waitcnt lgkmcnt(3)
    buffer_load_dwordx4 v4, s[12:15], s42 offen offset:2048 sc1 lds
    v_mfma_f32_16x16x32_bf16 v[48:51], a[88:91], a[24:27], v[48:51]
    ds_read_b128 a[108:111], v2 offset:27648
    v_mfma_f32_16x16x32_bf16 v[48:51], a[92:95], a[28:31], v[48:51]
    v_exp_f32 v72, v40
    v_mfma_f32_16x16x32_bf16 v[52:55], a[64:67], a[32:35], v[116:119]
    ds_read_b128 a[112:115], v2 offset:28672
    v_add_f32 v5, v5, v72
    v_mfma_f32_16x16x32_bf16 v[52:55], a[68:71], a[36:39], v[52:55]
    v_exp_f32 v73, v41
    v_mfma_f32_16x16x32_bf16 v[52:55], a[72:75], a[40:43], v[52:55]
    ds_read_b128 a[116:119], v2 offset:29696
    v_add_f32 v5, v5, v73
    v_mfma_f32_16x16x32_bf16 v[52:55], a[76:79], a[44:47], v[52:55]
    buffer_load_dwordx4 v4, s[12:15], s42 offen offset:3072 sc1 lds
    v_mfma_f32_16x16x32_bf16 v[52:55], a[80:83], a[48:51], v[52:55]
    s_add_u32 s42, s42, 0x8000
    ds_read_b128 a[120:123], v2 offset:30720
    v_mfma_f32_16x16x32_bf16 v[52:55], a[84:87], a[52:55], v[52:55]
    s_xor_b32 s40, s40, 0x8000
    v_exp_f32 v74, v42
    v_mfma_f32_16x16x32_bf16 v[52:55], a[88:91], a[56:59], v[52:55]
    s_waitcnt vmcnt(8)
    ds_read_b128 a[124:127], v2 offset:31744
    v_add_f32 v5, v5, v74
    v_mfma_f32_16x16x32_bf16 v[52:55], a[92:95], a[60:63], v[52:55]
    s_waitcnt lgkmcnt(6)
    s_barrier
    v_mfma_f32_16x16x32_bf16 v[56:59], a[96:99], a[0:3], v[120:123]
    s_mov_b32 m0, s41
    ds_read_b128 a[64:67], v3 offset:0
    v_xor_b32 v2, 0x8000, v2
    v_mfma_f32_16x16x32_bf16 v[56:59], a[100:103], a[4:7], v[56:59]
    s_waitcnt lgkmcnt(5)
    buffer_load_dwordx4 v1, s[12:15], s43 offen offset:0 sc1 lds
    v_mfma_f32_16x16x32_bf16 v[56:59], a[104:107], a[8:11], v[56:59]
    ds_read_b128 a[68:71], v3 offset:16384
    v_mfma_f32_16x16x32_bf16 v[56:59], a[108:111], a[12:15], v[56:59]
    s_waitcnt lgkmcnt(4)
    v_exp_f32 v75, v43
    v_mfma_f32_16x16x32_bf16 v[56:59], a[112:115], a[16:19], v[56:59]
    ds_read_b128 a[72:75], v3 offset:1024
    v_add_f32 v5, v5, v75
    v_mfma_f32_16x16x32_bf16 v[56:59], a[116:119], a[20:23], v[56:59]
    s_waitcnt lgkmcnt(3)
    v_exp_f32 v76, v44
    v_mfma_f32_16x16x32_bf16 v[56:59], a[120:123], a[24:27], v[56:59]
    ds_read_b128 a[76:79], v3 offset:17408
    v_add_f32 v6, v6, v76
    v_mfma_f32_16x16x32_bf16 v[56:59], a[124:127], a[28:31], v[56:59]
    buffer_load_dwordx4 v1, s[12:15], s43 offen offset:1024 sc1 lds
    v_mfma_f32_16x16x32_bf16 v[60:63], a[96:99], a[32:35], v[124:127]
    ds_read_b128 a[80:83], v3 offset:2048
    v_mfma_f32_16x16x32_bf16 v[60:63], a[100:103], a[36:39], v[60:63]
    v_exp_f32 v77, v45
    v_mfma_f32_16x16x32_bf16 v[60:63], a[104:107], a[40:43], v[60:63]
    ds_read_b128 a[84:87], v3 offset:18432
    v_add_f32 v6, v6, v77
    v_mfma_f32_16x16x32_bf16 v[60:63], a[108:111], a[44:47], v[60:63]
    v_exp_f32 v78, v46
    v_mfma_f32_16x16x32_bf16 v[60:63], a[112:115], a[48:51], v[60:63]
    ds_read_b128 a[88:91], v3 offset:3072
    v_add_f32 v6, v6, v78
    v_mfma_f32_16x16x32_bf16 v[60:63], a[116:119], a[52:55], v[60:63]
    buffer_load_dwordx4 v1, s[12:15], s43 offen offset:2048 sc1 lds
    v_mfma_f32_16x16x32_bf16 v[60:63], a[120:123], a[56:59], v[60:63]
    ds_read_b128 a[92:95], v3 offset:19456
    v_mfma_f32_16x16x32_bf16 v[60:63], a[124:127], a[60:63], v[60:63]
    s_waitcnt lgkmcnt(6)
    v_exp_f32 v79, v47
    v_mfma_f32_16x16x32_bf16 v[128:131], a[64:67], v[16:19], v[128:131]
    ds_read_b128 a[96:99], v3 offset:4096
    v_add_f32 v6, v6, v79
    v_mfma_f32_16x16x32_bf16 v[128:131], a[68:71], v[24:27], v[128:131]
    v_exp_f32 v80, v48
    v_mfma_f32_16x16x32_bf16 v[192:195], a[68:71], v[28:31], v[192:195]
    ds_read_b128 a[100:103], v3 offset:20480
    v_add_f32 v5, v5, v80
    v_mfma_f32_16x16x32_bf16 v[192:195], a[64:67], v[20:23], v[192:195]
    s_waitcnt lgkmcnt(6)
    buffer_load_dwordx4 v1, s[12:15], s43 offen offset:3072 sc1 lds
    v_mfma_f32_16x16x32_bf16 v[132:135], a[72:75], v[16:19], v[132:135]
    ds_read_b128 a[104:107], v3 offset:5120
    v_mfma_f32_16x16x32_bf16 v[132:135], a[76:79], v[24:27], v[132:135]
    v_exp_f32 v81, v49
    v_mfma_f32_16x16x32_bf16 v[196:199], a[76:79], v[28:31], v[196:199]
    ds_read_b128 a[108:111], v3 offset:21504
    v_add_f32 v5, v5, v81
    v_mfma_f32_16x16x32_bf16 v[196:199], a[72:75], v[20:23], v[196:199]
    s_waitcnt lgkmcnt(6)
    v_exp_f32 v82, v50
    v_mfma_f32_16x16x32_bf16 v[136:139], a[80:83], v[16:19], v[136:139]
    s_bitset1_b32 m0, 12
    ds_read_b128 a[112:115], v3 offset:6144
    v_add_f32 v5, v5, v82
    v_mfma_f32_16x16x32_bf16 v[136:139], a[84:87], v[24:27], v[136:139]
    buffer_load_dwordx4 v4, s[12:15], s43 offen offset:0 sc1 lds
    v_mfma_f32_16x16x32_bf16 v[200:203], a[84:87], v[28:31], v[200:203]
    ds_read_b128 a[116:119], v3 offset:22528
    v_mfma_f32_16x16x32_bf16 v[200:203], a[80:83], v[20:23], v[200:203]
    s_waitcnt lgkmcnt(6)
    v_exp_f32 v83, v51
    v_mfma_f32_16x16x32_bf16 v[140:143], a[88:91], v[16:19], v[140:143]
    ds_read_b128 a[120:123], v3 offset:7168
    v_add_f32 v5, v5, v83
    v_mfma_f32_16x16x32_bf16 v[140:143], a[92:95], v[24:27], v[140:143]
    v_exp_f32 v84, v52
    v_mfma_f32_16x16x32_bf16 v[204:207], a[92:95], v[28:31], v[204:207]
    ds_read_b128 a[124:127], v3 offset:23552
    v_add_f32 v6, v6, v84
    v_mfma_f32_16x16x32_bf16 v[204:207], a[88:91], v[20:23], v[204:207]
    s_waitcnt lgkmcnt(6)
    buffer_load_dwordx4 v4, s[12:15], s43 offen offset:1024 sc1 lds
    v_mfma_f32_16x16x32_bf16 v[144:147], a[96:99], v[16:19], v[144:147]
    ds_read_b128 a[64:67], v3 offset:8192
    v_mfma_f32_16x16x32_bf16 v[144:147], a[100:103], v[24:27], v[144:147]
    v_exp_f32 v85, v53
    v_mfma_f32_16x16x32_bf16 v[208:211], a[100:103], v[28:31], v[208:211]
    ds_read_b128 a[68:71], v3 offset:24576
    v_add_f32 v6, v6, v85
    v_mfma_f32_16x16x32_bf16 v[208:211], a[96:99], v[20:23], v[208:211]
    s_waitcnt lgkmcnt(6)
    v_exp_f32 v86, v54
    v_mfma_f32_16x16x32_bf16 v[148:151], a[104:107], v[16:19], v[148:151]
    ds_read_b128 a[72:75], v3 offset:9216
    v_add_f32 v6, v6, v86
    v_mfma_f32_16x16x32_bf16 v[148:151], a[108:111], v[24:27], v[148:151]
    buffer_load_dwordx4 v4, s[12:15], s43 offen offset:2048 sc1 lds
    v_mfma_f32_16x16x32_bf16 v[212:215], a[108:111], v[28:31], v[212:215]
    ds_read_b128 a[76:79], v3 offset:25600
    v_mfma_f32_16x16x32_bf16 v[212:215], a[104:107], v[20:23], v[212:215]
    s_waitcnt lgkmcnt(6)
    v_exp_f32 v87, v55
    v_mfma_f32_16x16x32_bf16 v[152:155], a[112:115], v[16:19], v[152:155]
    ds_read_b128 a[80:83], v3 offset:10240
    v_add_f32 v6, v6, v87
    v_mfma_f32_16x16x32_bf16 v[152:155], a[116:119], v[24:27], v[152:155]
    v_exp_f32 v88, v56
    v_mfma_f32_16x16x32_bf16 v[216:219], a[116:119], v[28:31], v[216:219]
    ds_read_b128 a[84:87], v3 offset:26624
    v_add_f32 v5, v5, v88
    v_mfma_f32_16x16x32_bf16 v[216:219], a[112:115], v[20:23], v[216:219]
    s_waitcnt lgkmcnt(6)
    buffer_load_dwordx4 v4, s[12:15], s43 offen offset:3072 sc1 lds
    v_mfma_f32_16x16x32_bf16 v[156:159], a[120:123], v[16:19], v[156:159]
    s_add_u32 s43, s43, 0x8000
    ds_read_b128 a[88:91], v3 offset:11264
    v_mfma_f32_16x16x32_bf16 v[156:159], a[124:127], v[24:27], v[156:159]
    s_xor_b32 s41, s41, 0x8000
    v_exp_f32 v89, v57
    v_mfma_f32_16x16x32_bf16 v[220:223], a[124:127], v[28:31], v[220:223]
    ds_read_b128 a[92:95], v3 offset:27648
    v_add_f32 v5, v5, v89
    v_mfma_f32_16x16x32_bf16 v[220:223], a[120:123], v[20:23], v[220:223]
    s_waitcnt lgkmcnt(6)
    v_exp_f32 v90, v58
    v_mfma_f32_16x16x32_bf16 v[160:163], a[64:67], v[16:19], v[160:163]
    ds_read_b128 a[96:99], v3 offset:12288
    v_add_f32 v5, v5, v90
    v_mfma_f32_16x16x32_bf16 v[160:163], a[68:71], v[24:27], v[160:163]
    v_exp_f32 v91, v59
    v_mfma_f32_16x16x32_bf16 v[224:227], a[68:71], v[28:31], v[224:227]
    ds_read_b128 a[100:103], v3 offset:28672
    v_add_f32 v5, v5, v91
    v_mfma_f32_16x16x32_bf16 v[224:227], a[64:67], v[20:23], v[224:227]
    s_waitcnt lgkmcnt(6)
    v_exp_f32 v92, v60
    v_mfma_f32_16x16x32_bf16 v[164:167], a[72:75], v[16:19], v[164:167]
    ds_read_b128 a[104:107], v3 offset:13312
    v_add_f32 v6, v6, v92
    v_mfma_f32_16x16x32_bf16 v[164:167], a[76:79], v[24:27], v[164:167]
    v_exp_f32 v93, v61
    v_mfma_f32_16x16x32_bf16 v[228:231], a[76:79], v[28:31], v[228:231]
    ds_read_b128 a[108:111], v3 offset:29696
    v_add_f32 v6, v6, v93
    v_mfma_f32_16x16x32_bf16 v[228:231], a[72:75], v[20:23], v[228:231]
    s_waitcnt lgkmcnt(6)
    v_exp_f32 v94, v62
    v_mfma_f32_16x16x32_bf16 v[168:171], a[80:83], v[16:19], v[168:171]
    ds_read_b128 a[112:115], v3 offset:14336
    v_add_f32 v6, v6, v94
    v_mfma_f32_16x16x32_bf16 v[168:171], a[84:87], v[24:27], v[168:171]
    v_exp_f32 v95, v63
    v_mfma_f32_16x16x32_bf16 v[232:235], a[84:87], v[28:31], v[232:235]
    ds_read_b128 a[116:119], v3 offset:30720
    v_add_f32 v6, v6, v95
    v_mfma_f32_16x16x32_bf16 v[232:235], a[80:83], v[20:23], v[232:235]
    s_waitcnt lgkmcnt(6)
    v_add_f32 v11, v5, v6
    v_mfma_f32_16x16x32_bf16 v[172:175], a[88:91], v[16:19], v[172:175]
    ds_read_b128 a[120:123], v3 offset:15360
    v_cmp_nge_f32 vcc, s47, v11
    v_mfma_f32_16x16x32_bf16 v[172:175], a[92:95], v[24:27], v[172:175]
    buffer_load_dword a246, off, s[12:15], s60 sc1
    v_mfma_f32_16x16x32_bf16 v[236:239], a[92:95], v[28:31], v[236:239]
    s_waitcnt vmcnt(9)
    ds_read_b128 a[124:127], v3 offset:31744
    v_mfma_f32_16x16x32_bf16 v[236:239], a[88:91], v[20:23], v[236:239]
    s_waitcnt lgkmcnt(6)
    s_barrier
    v_mfma_f32_16x16x32_bf16 v[176:179], a[96:99], v[16:19], v[176:179]
    ds_read_b128 a[64:67], v2 offset:0
    v_xor_b32 v3, 0x8000, v3
    v_mfma_f32_16x16x32_bf16 v[176:179], a[100:103], v[24:27], v[176:179]
    v_mfma_f32_16x16x32_bf16 v[240:243], a[100:103], v[28:31], v[240:243]
    ds_read_b128 a[68:71], v2 offset:1024
    v_mfma_f32_16x16x32_bf16 v[240:243], a[96:99], v[20:23], v[240:243]
    s_waitcnt lgkmcnt(6)
    v_mfma_f32_16x16x32_bf16 v[180:183], a[104:107], v[16:19], v[180:183]
    ds_read_b128 a[72:75], v2 offset:2048
    v_mfma_f32_16x16x32_bf16 v[180:183], a[108:111], v[24:27], v[180:183]
    v_mfma_f32_16x16x32_bf16 v[244:247], a[108:111], v[28:31], v[244:247]
    ds_read_b128 a[76:79], v2 offset:3072
    v_mfma_f32_16x16x32_bf16 v[244:247], a[104:107], v[20:23], v[244:247]
    s_waitcnt lgkmcnt(6)
    v_mfma_f32_16x16x32_bf16 v[184:187], a[112:115], v[16:19], v[184:187]
    s_sub_u32 s44, s44, 1
    ds_read_b128 a[80:83], v2 offset:4096
    v_mfma_f32_16x16x32_bf16 v[184:187], a[116:119], v[24:27], v[184:187]
    v_mfma_f32_16x16x32_bf16 v[248:251], a[116:119], v[28:31], v[248:251]
    ds_read_b128 a[84:87], v2 offset:5120
    v_mfma_f32_16x16x32_bf16 v[248:251], a[112:115], v[20:23], v[248:251]
    s_waitcnt lgkmcnt(6)
    v_mfma_f32_16x16x32_bf16 v[188:191], a[120:123], v[16:19], v[188:191]
    ds_read_b128 a[88:91], v2 offset:6144
    v_mfma_f32_16x16x32_bf16 v[188:191], a[124:127], v[24:27], v[188:191]
    v_mfma_f32_16x16x32_bf16 v[252:255], a[124:127], v[28:31], v[252:255]
    ds_read_b128 a[92:95], v2 offset:7168
    v_mfma_f32_16x16x32_bf16 v[252:255], a[120:123], v[20:23], v[252:255]
    s_waitcnt lgkmcnt(6)
    s_cbranch_vccnz L_slow
L_ret:
    s_cmp_gt_u32 s44, s45
    s_cbranch_scc1 L_loop
    s_cmp_eq_u32 s44, 0
    s_cbranch_scc1 L_segend
    s_cmp_eq_u32 s44, 1
    s_cbranch_scc1 L_d1
    v_mov_b32 v11, 0xf149f2ca
    v_cmp_gt_i32 s[16:17], 0, v14
    v_cmp_gt_i32 s[18:19], 1, v14
    v_cmp_gt_i32 s[20:21], 2, v14
    v_cmp_gt_i32 s[22:23], 3, v14
    v_cndmask_b32 v96, v9, v11, s[16:17]
    v_cndmask_b32 v97, v9, v11, s[18:19]
    v_cndmask_b32 v98, v9, v11, s[20:21]
    v_cndmask_b32 v99, v9, v11, s[22:23]
    v_cmp_gt_i32 s[16:17], 16, v14
    v_cmp_gt_i32 s[18:19], 17, v14
    v_cmp_gt_i32 s[20:21], 18, v14
    v_cmp_gt_i32 s[22:23], 19, v14
    v_cndmask_b32 v104, v9, v11, s[16:17]
    v_cndmask_b32 v105, v9, v11, s[18:19]
    v_cndmask_b32 v106, v9, v11, s[20:21]
    v_cndmask_b32 v107, v9, v11, s[22:23]
    v_cmp_gt_i32 s[16:17], 32, v14
    v_cmp_gt_i32 s[18:19], 33, v14
    v_cmp_gt_i32 s[20:21], 34, v14
    v_cmp_gt_i32 s[22:23], 35, v14
    v_cndmask_b32 v112, v9, v11, s[16:17]
    v_cndmask_b32 v113, v9, v11, s[18:19]
    v_cndmask_b32 v114, v9, v11, s[20:21]
    v_cndmask_b32 v115, v9, v11, s[22:23]
    v_cmp_gt_i32 s[16:17], 48, v14
    v_cmp_gt_i32 s[18:19], 49, v14
    v_cmp_gt_i32 s[20:21], 50, v14
    v_cmp_gt_i32 s[22:23], 51, v14
    v_cndmask_b32 v120, v9, v11, s[16:17]
    v_cndmask_b32 v121, v9, v11, s[18:19]
    v_cndmask_b32 v122, v9, v11, s[20:21]
    v_cndmask_b32 v123, v9, v11, s[22:23]
    s_nop 0
    s_branch L_loop
L_d1:
    s_cmp_eq_u32 s54, 0
    s_cselect_b32 s57, s38, 0
    s_cmp_lg_u32 s57, 0
    s_cselect_b32 s42, s49, 0xf0000000
    s_cbranch_scc0 L_d1b
    s_sub_u32 s58, 15, s25
    s_waitcnt vmcnt(0)
    v_accvgpr_read_b32 v12, a246
    v_cmp_ne_u32 vcc, 0, v12
    s_cbranch_vccz L_poll1_ok
    v_and_b32 v11, 0, v0
    v_lshlrev_b32 v11, 2, v11
    s_mov_b32 s32, 0
L_poll1:
    buffer_load_dword v12, v11, s[12:15], s60 offen sc1
    s_waitcnt vmcnt(0)
    v_cmp_ne_u32 vcc, 0, v12
    s_cbranch_vccz L_poll1_ok
    s_sleep 8
    s_add_u32 s32, s32, 1
    s_cmp_lt_u32 s32, 0x80000
    s_cbranch_scc1 L_poll1
L_poll1_ok:
    s_lshl_b32 s55, s58, 16
    s_add_u32 s55, s55, s49
    s_add_u32 s55, s55, 33554432
    s_add_u32 s56, s55, 0x8000
    buffer_load_dwordx4 a[128:131], v1, s[12:15], s55 offen offset:0 sc1
    buffer_load_dwordx4 a[132:135], v1, s[12:15], s55 offen offset:1024 sc1
    buffer_load_dwordx4 a[136:139], v1, s[12:15], s55 offen offset:2048 sc1
    buffer_load_dwordx4 a[140:143], v1, s[12:15], s55 offen offset:3072 sc1
    buffer_load_dwordx4 a[144:147], v4, s[12:15], s55 offen offset:0 sc1
    buffer_load_dwordx4 a[148:151], v4, s[12:15], s55 offen offset:1024 sc1
    buffer_load_dwordx4 a[152:155], v4, s[12:15], s55 offen offset:2048 sc1
    buffer_load_dwordx4 a[156:159], v4, s[12:15], s55 offen offset:3072 sc1
    buffer_load_dwordx4 a[160:163], v1, s[12:15], s56 offen offset:0 sc1
    buffer_load_dwordx4 a[164:167], v1, s[12:15], s56 offen offset:1024 sc1
    buffer_load_dwordx4 a[168:171], v1, s[12:15], s56 offen offset:2048 sc1
    buffer_load_dwordx4 a[172:175], v1, s[12:15], s56 offen offset:3072 sc1
    buffer_load_dwordx4 a[176:179], v4, s[12:15], s56 offen offset:0 sc1
    buffer_load_dwordx4 a[180:183], v4, s[12:15], s56 offen offset:1024 sc1
    buffer_load_dwordx4 a[184:187], v4, s[12:15], s56 offen offset:2048 sc1
    buffer_load_dwordx4 a[188:191], v4, s[12:15], s56 offen offset:3072 sc1
L_d1b:
    v_and_b32 v11, 31, v0
    v_lshlrev_b32 v11, 2, v11
    buffer_load_dword a247, v11, s[12:15], s61 offen sc1
    v_accvgpr_read_b32 v12, a244
    global_load_dword a243, v12, s[100:101]
    v_mov_b32 v11, 0xf149f2ca
    v_cmp_gt_i32 s[16:17], 0, v14
    v_cmp_gt_i32 s[18:19], 1, v14
    v_cmp_gt_i32 s[20:21], 2, v14
    v_cmp_gt_i32 s[22:23], 3, v14
    v_cndmask_b32 v100, v10, v11, s[16:17]
    v_cndmask_b32 v101, v10, v11, s[18:19]
    v_cndmask_b32 v102, v10, v11, s[20:21]
    v_cndmask_b32 v103, v10, v11, s[22:23]
    v_cmp_gt_i32 s[16:17], 16, v14
    v_cmp_gt_i32 s[18:19], 17, v14
    v_cmp_gt_i32 s[20:21], 18, v14
    v_cmp_gt_i32 s[22:23], 19, v14
    v_cndmask_b32 v108, v10, v11, s[16:17]
    v_cndmask_b32 v109, v10, v11, s[18:19]
    v_cndmask_b32 v110, v10, v11, s[20:21]
    v_cndmask_b32 v111, v10, v11, s[22:23]
    v_cmp_gt_i32 s[16:17], 32, v14
    v_cmp_gt_i32 s[18:19], 33, v14
    v_cmp_gt_i32 s[20:21], 34, v14
    v_cmp_gt_i32 s[22:23], 35, v14
    v_cndmask_b32 v116, v10, v11, s[16:17]
    v_cndmask_b32 v117, v10, v11, s[18:19]
    v_cndmask_b32 v118, v10, v11, s[20:21]
    v_cndmask_b32 v119, v10, v11, s[22:23]
    v_cmp_gt_i32 s[16:17], 48, v14
    v_cmp_gt_i32 s[18:19], 49, v14
    v_cmp_gt_i32 s[20:21], 50, v14
    v_cmp_gt_i32 s[22:23], 51, v14
    v_cndmask_b32 v124, v10, v11, s[16:17]
    v_cndmask_b32 v125, v10, v11, s[18:19]
    v_cndmask_b32 v126, v10, v11, s[20:21]
    v_cndmask_b32 v127, v10, v11, s[22:23]
    v_mov_b32 v96, v11
    v_mov_b32 v97, v11
    v_mov_b32 v98, v11
    v_mov_b32 v99, v11
    v_mov_b32 v104, v11
    v_mov_b32 v105, v11
    v_mov_b32 v106, v11
    v_mov_b32 v107, v11
    v_mov_b32 v112, v11
    v_mov_b32 v113, v11
    v_mov_b32 v114, v11
    v_mov_b32 v115, v11
    v_mov_b32 v120, v11
    v_mov_b32 v121, v11
    v_mov_b32 v122, v11
    v_mov_b32 v123, v11
    s_nop 0
    s_branch L_loop
L_segend:
    s_cmp_eq_u32 s54, 0
    s_cselect_b32 s57, s38, 0
    s_cmp_eq_u32 s57, 0
    s_cbranch_scc1 L_tail
    v_accvgpr_mov_b32 a0, a128
    v_accvgpr_mov_b32 a1, a129
    v_accvgpr_mov_b32 a2, a130
    v_accvgpr_mov_b32 a3, a131
    v_accvgpr_mov_b32 a4, a132
    v_accvgpr_mov_b32 a5, a133
    v_accvgpr_mov_b32 a6, a134
    v_accvgpr_mov_b32 a7, a135
    v_accvgpr_mov_b32 a8, a136
    v_accvgpr_mov_b32 a9, a137
    v_accvgpr_mov_b32 a10, a138
    v_accvgpr_mov_b32 a11, a139
    v_accvgpr_mov_b32 a12, a140
    v_accvgpr_mov_b32 a13, a141
    v_accvgpr_mov_b32 a14, a142
    v_accvgpr_mov_b32 a15, a143
    v_accvgpr_mov_b32 a16, a144
    v_accvgpr_mov_b32 a17, a145
    v_accvgpr_mov_b32 a18, a146
    v_accvgpr_mov_b32 a19, a147
    v_accvgpr_mov_b32 a20, a148
    v_accvgpr_mov_b32 a21, a149
    v_accvgpr_mov_b32 a22, a150
    v_accvgpr_mov_b32 a23, a151
    v_accvgpr_mov_b32 a24, a152
    v_accvgpr_mov_b32 a25, a153
    v_accvgpr_mov_b32 a26, a154
    v_accvgpr_mov_b32 a27, a155
    v_accvgpr_mov_b32 a28, a156
    v_accvgpr_mov_b32 a29, a157
    v_accvgpr_mov_b32 a30, a158
    v_accvgpr_mov_b32 a31, a159
    v_accvgpr_mov_b32 a32, a160
    v_accvgpr_mov_b32 a33, a161
    v_accvgpr_mov_b32 a34, a162
    v_accvgpr_mov_b32 a35, a163
    v_accvgpr_mov_b32 a36, a164
    v_accvgpr_mov_b32 a37, a165
    v_accvgpr_mov_b32 a38, a166
    v_accvgpr_mov_b32 a39, a167
    v_accvgpr_mov_b32 a40, a168
    v_accvgpr_mov_b32 a41, a169
    v_accvgpr_mov_b32 a42, a170
    v_accvgpr_mov_b32 a43, a171
    v_accvgpr_mov_b32 a44, a172
    v_accvgpr_mov_b32 a45, a173
    v_accvgpr_mov_b32 a46, a174
    v_accvgpr_mov_b32 a47, a175
    v_accvgpr_mov_b32 a48, a176
    v_accvgpr_mov_b32 a49, a177
    v_accvgpr_mov_b32 a50, a178
    v_accvgpr_mov_b32 a51, a179
    v_accvgpr_mov_b32 a52, a180
    v_accvgpr_mov_b32 a53, a181
    v_accvgpr_mov_b32 a54, a182
    v_accvgpr_mov_b32 a55, a183
    v_accvgpr_mov_b32 a56, a184
    v_accvgpr_mov_b32 a57, a185
    v_accvgpr_mov_b32 a58, a186
    v_accvgpr_mov_b32 a59, a187
    v_accvgpr_mov_b32 a60, a188
    v_accvgpr_mov_b32 a61, a189
    v_accvgpr_mov_b32 a62, a190
    v_accvgpr_mov_b32 a63, a191
    v_mov_b64 v[96:97], 0
    v_mov_b64 v[98:99], 0
    v_mov_b64 v[100:101], 0
    v_mov_b64 v[102:103], 0
    v_mov_b64 v[104:105], 0
    v_mov_b64 v[106:107], 0
    v_mov_b64 v[108:109], 0
    v_mov_b64 v[110:111], 0
    v_mov_b64 v[112:113], 0
    v_mov_b64 v[114:115], 0
    v_mov_b64 v[116:117], 0
    v_mov_b64 v[118:119], 0
    v_mov_b64 v[120:121], 0
    v_mov_b64 v[122:123], 0
    v_mov_b64 v[124:125], 0
    v_mov_b64 v[126:127], 0
    s_add_u32 s43, s49, 16777216
    s_mov_b32 s44, s38
    s_mov_b32 s45, 0
    s_mov_b32 s47, -1.0
    s_branch L_loop
L_switched:
    v_mov_b32 v18, v7
    v_mov_b32 v19, v8
    s_nop 0
    v_permlane32_swap_b32 v7, v18
    v_permlane32_swap_b32 v8, v19
    s_nop 0
    v_add_f32 v7, v7, v18
    v_add_f32 v8, v8, v19
    s_nop 0
    v_mov_b32 v18, v7
    v_mov_b32 v19, v8
    s_nop 0
    v_permlane16_swap_b32 v7, v18
    v_permlane16_swap_b32 v8, v19
    s_nop 0
    v_add_f32 v7, v7, v18
    v_add_f32 v8, v8, v19
    s_nop 0
    v_rcp_f32 v16, v7
    v_rcp_f32 v17, v8
    s_mov_b32 s47, 0x4b800000
    s_mov_b32 s54, 1
    v_pk_mul_f32 v[128:129], v[128:129], v[16:17] op_sel:[0,0] op_sel_hi:[1,0]
    v_pk_mul_f32 v[130:131], v[130:131], v[16:17] op_sel:[0,0] op_sel_hi:[1,0]
    v_pk_mul_f32 v[132:133], v[132:133], v[16:17] op_sel:[0,0] op_sel_hi:[1,0]
    v_pk_mul_f32 v[134:135], v[134:135], v[16:17] op_sel:[0,0] op_sel_hi:[1,0]
    v_cvt_pk_bf16_f32 v128, v128, v129
    v_cvt_pk_bf16_f32 v129, v130, v131
    v_cvt_pk_bf16_f32 v130, v132, v133
    v_cvt_pk_bf16_f32 v131, v134, v135
    v_accvgpr_write_b32 a128, v128
    v_accvgpr_write_b32 a129, v129
    v_accvgpr_write_b32 a130, v130
    v_accvgpr_write_b32 a131, v131
    v_pk_mul_f32 v[136:137], v[136:137], v[16:17] op_sel:[0,0] op_sel_hi:[1,0]
    v_pk_mul_f32 v[138:139], v[138:139], v[16:17] op_sel:[0,0] op_sel_hi:[1,0]
    v_pk_mul_f32 v[140:141], v[140:141], v[16:17] op_sel:[0,0] op_sel_hi:[1,0]
    v_pk_mul_f32 v[142:143], v[142:143], v[16:17] op_sel:[0,0] op_sel_hi:[1,0]
    v_cvt_pk_bf16_f32 v136, v136, v137
    v_cvt_pk_bf16_f32 v137, v138, v139
    v_cvt_pk_bf16_f32 v138, v140, v141
    v_cvt_pk_bf16_f32 v139, v142, v143
    v_accvgpr_write_b32 a132, v136
    v_accvgpr_write_b32 a133, v137
    v_accvgpr_write_b32 a134, v138
    v_accvgpr_write_b32 a135, v139
    v_pk_mul_f32 v[144:145], v[144:145], v[16:17] op_sel:[0,0] op_sel_hi:[1,0]
    v_pk_mul_f32 v[146:147], v[146:147], v[16:17] op_sel:[0,0] op_sel_hi:[1,0]
    v_pk_mul_f32 v[148:149], v[148:149], v[16:17] op_sel:[0,0] op_sel_hi:[1,0]
    v_pk_mul_f32 v[150:151], v[150:151], v[16:17] op_sel:[0,0] op_sel_hi:[1,0]
    v_cvt_pk_bf16_f32 v144, v144, v145
    v_cvt_pk_bf16_f32 v145, v146, v147
    v_cvt_pk_bf16_f32 v146, v148, v149
    v_cvt_pk_bf16_f32 v147, v150, v151
    v_accvgpr_write_b32 a136, v144
    v_accvgpr_write_b32 a137, v145
    v_accvgpr_write_b32 a138, v146
    v_accvgpr_write_b32 a139, v147
    v_pk_mul_f32 v[152:153], v[152:153], v[16:17] op_sel:[0,0] op_sel_hi:[1,0]
    v_pk_mul_f32 v[154:155], v[154:155], v[16:17] op_sel:[0,0] op_sel_hi:[1,0]
    v_pk_mul_f32 v[156:157], v[156:157], v[16:17] op_sel:[0,0] op_sel_hi:[1,0]
    v_pk_mul_f32 v[158:159], v[158:159], v[16:17] op_sel:[0,0] op_sel_hi:[1,0]
    v_cvt_pk_bf16_f32 v152, v152, v153
    v_cvt_pk_bf16_f32 v153, v154, v155
    v_cvt_pk_bf16_f32 v154, v156, v157
    v_cvt_pk_bf16_f32 v155, v158, v159
    v_accvgpr_write_b32 a140, v152
    v_accvgpr_write_b32 a141, v153
    v_accvgpr_write_b32 a142, v154
    v_accvgpr_write_b32 a143, v155
    v_pk_mul_f32 v[160:161], v[160:161], v[16:17] op_sel:[0,0] op_sel_hi:[1,0]
    v_pk_mul_f32 v[162:163], v[162:163], v[16:17] op_sel:[0,0] op_sel_hi:[1,0]
    v_pk_mul_f32 v[164:165], v[164:165], v[16:17] op_sel:[0,0] op_sel_hi:[1,0]
    v_pk_mul_f32 v[166:167], v[166:167], v[16:17] op_sel:[0,0] op_sel_hi:[1,0]
    v_cvt_pk_bf16_f32 v160, v160, v161
    v_cvt_pk_bf16_f32 v161, v162, v163
    v_cvt_pk_bf16_f32 v162, v164, v165
    v_cvt_pk_bf16_f32 v163, v166, v167
    v_accvgpr_write_b32 a144, v160
    v_accvgpr_write_b32 a145, v161
    v_accvgpr_write_b32 a146, v162
    v_accvgpr_write_b32 a147, v163
    v_pk_mul_f32 v[168:169], v[168:169], v[16:17] op_sel:[0,0] op_sel_hi:[1,0]
    v_pk_mul_f32 v[170:171], v[170:171], v[16:17] op_sel:[0,0] op_sel_hi:[1,0]
    v_pk_mul_f32 v[172:173], v[172:173], v[16:17] op_sel:[0,0] op_sel_hi:[1,0]
    v_pk_mul_f32 v[174:175], v[174:175], v[16:17] op_sel:[0,0] op_sel_hi:[1,0]
    v_cvt_pk_bf16_f32 v168, v168, v169
    v_cvt_pk_bf16_f32 v169, v170, v171
    v_cvt_pk_bf16_f32 v170, v172, v173
    v_cvt_pk_bf16_f32 v171, v174, v175
    v_accvgpr_write_b32 a148, v168
    v_accvgpr_write_b32 a149, v169
    v_accvgpr_write_b32 a150, v170
    v_accvgpr_write_b32 a151, v171
    v_pk_mul_f32 v[176:177], v[176:177], v[16:17] op_sel:[0,0] op_sel_hi:[1,0]
    v_pk_mul_f32 v[178:179], v[178:179], v[16:17] op_sel:[0,0] op_sel_hi:[1,0]
    v_pk_mul_f32 v[180:181], v[180:181], v[16:17] op_sel:[0,0] op_sel_hi:[1,0]
    v_pk_mul_f32 v[182:183], v[182:183], v[16:17] op_sel:[0,0] op_sel_hi:[1,0]
    v_cvt_pk_bf16_f32 v176, v176, v177
    v_cvt_pk_bf16_f32 v177, v178, v179
    v_cvt_pk_bf16_f32 v178, v180, v181
    v_cvt_pk_bf16_f32 v179, v182, v183
    v_accvgpr_write_b32 a152, v176
    v_accvgpr_write_b32 a153, v177
    v_accvgpr_write_b32 a154, v178
    v_accvgpr_write_b32 a155, v179
    v_pk_mul_f32 v[184:185], v[184:185], v[16:17] op_sel:[0,0] op_sel_hi:[1,0]
    v_pk_mul_f32 v[186:187], v[186:187], v[16:17] op_sel:[0,0] op_sel_hi:[1,0]
    v_pk_mul_f32 v[188:189], v[188:189], v[16:17] op_sel:[0,0] op_sel_hi:[1,0]
    v_pk_mul_f32 v[190:191], v[190:191], v[16:17] op_sel:[0,0] op_sel_hi:[1,0]
    v_cvt_pk_bf16_f32 v184, v184, v185
    v_cvt_pk_bf16_f32 v185, v186, v187
    v_cvt_pk_bf16_f32 v186, v188, v189
    v_cvt_pk_bf16_f32 v187, v190, v191
    v_accvgpr_write_b32 a156, v184
    v_accvgpr_write_b32 a157, v185
    v_accvgpr_write_b32 a158, v186
    v_accvgpr_write_b32 a159, v187
    v_pk_mul_f32 v[192:193], v[192:193], v[16:17] op_sel:[0,1] op_sel_hi:[1,1]
    v_pk_mul_f32 v[194:195], v[194:195], v[16:17] op_sel:[0,1] op_sel_hi:[1,1]
    v_pk_mul_f32 v[196:197], v[196:197], v[16:17] op_sel:[0,1] op_sel_hi:[1,1]
    v_pk_mul_f32 v[198:199], v[198:199], v[16:17] op_sel:[0,1] op_sel_hi:[1,1]
    v_cvt_pk_bf16_f32 v192, v192, v193
    v_cvt_pk_bf16_f32 v193, v194, v195
    v_cvt_pk_bf16_f32 v194, v196, v197
    v_cvt_pk_bf16_f32 v195, v198, v199
    v_accvgpr_write_b32 a160, v192
    v_accvgpr_write_b32 a161, v193
    v_accvgpr_write_b32 a162, v194
    v_accvgpr_write_b32 a163, v195
    v_pk_mul_f32 v[200:201], v[200:201], v[16:17] op_sel:[0,1] op_sel_hi:[1,1]
    v_pk_mul_f32 v[202:203], v[202:203], v[16:17] op_sel:[0,1] op_sel_hi:[1,1]
    v_pk_mul_f32 v[204:205], v[204:205], v[16:17] op_sel:[0,1] op_sel_hi:[1,1]
    v_pk_mul_f32 v[206:207], v[206:207], v[16:17] op_sel:[0,1] op_sel_hi:[1,1]
    v_cvt_pk_bf16_f32 v200, v200, v201
    v_cvt_pk_bf16_f32 v201, v202, v203
    v_cvt_pk_bf16_f32 v202, v204, v205
    v_cvt_pk_bf16_f32 v203, v206, v207
    v_accvgpr_write_b32 a164, v200
    v_accvgpr_write_b32 a165, v201
    v_accvgpr_write_b32 a166, v202
    v_accvgpr_write_b32 a167, v203
    v_pk_mul_f32 v[208:209], v[208:209], v[16:17] op_sel:[0,1] op_sel_hi:[1,1]
    v_pk_mul_f32 v[210:211], v[210:211], v[16:17] op_sel:[0,1] op_sel_hi:[1,1]
    v_pk_mul_f32 v[212:213], v[212:213], v[16:17] op_sel:[0,1] op_sel_hi:[1,1]
    v_pk_mul_f32 v[214:215], v[214:215], v[16:17] op_sel:[0,1] op_sel_hi:[1,1]
    v_cvt_pk_bf16_f32 v208, v208, v209
    v_cvt_pk_bf16_f32 v209, v210, v211
    v_cvt_pk_bf16_f32 v210, v212, v213
    v_cvt_pk_bf16_f32 v211, v214, v215
    v_accvgpr_write_b32 a168, v208
    v_accvgpr_write_b32 a169, v209
    v_accvgpr_write_b32 a170, v210
    v_accvgpr_write_b32 a171, v211
    v_pk_mul_f32 v[216:217], v[216:217], v[16:17] op_sel:[0,1] op_sel_hi:[1,1]
    v_pk_mul_f32 v[218:219], v[218:219], v[16:17] op_sel:[0,1] op_sel_hi:[1,1]
    v_pk_mul_f32 v[220:221], v[220:221], v[16:17] op_sel:[0,1] op_sel_hi:[1,1]
    v_pk_mul_f32 v[222:223], v[222:223], v[16:17] op_sel:[0,1] op_sel_hi:[1,1]
    v_cvt_pk_bf16_f32 v216, v216, v217
    v_cvt_pk_bf16_f32 v217, v218, v219
    v_cvt_pk_bf16_f32 v218, v220, v221
    v_cvt_pk_bf16_f32 v219, v222, v223
    v_accvgpr_write_b32 a172, v216
    v_accvgpr_write_b32 a173, v217
    v_accvgpr_write_b32 a174, v218
    v_accvgpr_write_b32 a175, v219
    v_pk_mul_f32 v[224:225], v[224:225], v[16:17] op_sel:[0,1] op_sel_hi:[1,1]
    v_pk_mul_f32 v[226:227], v[226:227], v[16:17] op_sel:[0,1] op_sel_hi:[1,1]
    v_pk_mul_f32 v[228:229], v[228:229], v[16:17] op_sel:[0,1] op_sel_hi:[1,1]
    v_pk_mul_f32 v[230:231], v[230:231], v[16:17] op_sel:[0,1] op_sel_hi:[1,1]
    v_cvt_pk_bf16_f32 v224, v224, v225
    v_cvt_pk_bf16_f32 v225, v226, v227
    v_cvt_pk_bf16_f32 v226, v228, v229
    v_cvt_pk_bf16_f32 v227, v230, v231
    v_accvgpr_write_b32 a176, v224
    v_accvgpr_write_b32 a177, v225
    v_accvgpr_write_b32 a178, v226
    v_accvgpr_write_b32 a179, v227
    v_pk_mul_f32 v[232:233], v[232:233], v[16:17] op_sel:[0,1] op_sel_hi:[1,1]
    v_pk_mul_f32 v[234:235], v[234:235], v[16:17] op_sel:[0,1] op_sel_hi:[1,1]
    v_pk_mul_f32 v[236:237], v[236:237], v[16:17] op_sel:[0,1] op_sel_hi:[1,1]
    v_pk_mul_f32 v[238:239], v[238:239], v[16:17] op_sel:[0,1] op_sel_hi:[1,1]
    v_cvt_pk_bf16_f32 v232, v232, v233
    v_cvt_pk_bf16_f32 v233, v234, v235
    v_cvt_pk_bf16_f32 v234, v236, v237
    v_cvt_pk_bf16_f32 v235, v238, v239
    v_accvgpr_write_b32 a180, v232
    v_accvgpr_write_b32 a181, v233
    v_accvgpr_write_b32 a182, v234
    v_accvgpr_write_b32 a183, v235
    v_pk_mul_f32 v[240:241], v[240:241], v[16:17] op_sel:[0,1] op_sel_hi:[1,1]
    v_pk_mul_f32 v[242:243], v[242:243], v[16:17] op_sel:[0,1] op_sel_hi:[1,1]
    v_pk_mul_f32 v[244:245], v[244:245], v[16:17] op_sel:[0,1] op_sel_hi:[1,1]
    v_pk_mul_f32 v[246:247], v[246:247], v[16:17] op_sel:[0,1] op_sel_hi:[1,1]
    v_cvt_pk_bf16_f32 v240, v240, v241
    v_cvt_pk_bf16_f32 v241, v242, v243
    v_cvt_pk_bf16_f32 v242, v244, v245
    v_cvt_pk_bf16_f32 v243, v246, v247
    v_accvgpr_write_b32 a184, v240
    v_accvgpr_write_b32 a185, v241
    v_accvgpr_write_b32 a186, v242
    v_accvgpr_write_b32 a187, v243
    v_pk_mul_f32 v[248:249], v[248:249], v[16:17] op_sel:[0,1] op_sel_hi:[1,1]
    v_pk_mul_f32 v[250:251], v[250:251], v[16:17] op_sel:[0,1] op_sel_hi:[1,1]
    v_pk_mul_f32 v[252:253], v[252:253], v[16:17] op_sel:[0,1] op_sel_hi:[1,1]
    v_pk_mul_f32 v[254:255], v[254:255], v[16:17] op_sel:[0,1] op_sel_hi:[1,1]
    v_cvt_pk_bf16_f32 v248, v248, v249
    v_cvt_pk_bf16_f32 v249, v250, v251
    v_cvt_pk_bf16_f32 v250, v252, v253
    v_cvt_pk_bf16_f32 v251, v254, v255
    v_accvgpr_write_b32 a188, v248
    v_accvgpr_write_b32 a189, v249
    v_accvgpr_write_b32 a190, v250
    v_accvgpr_write_b32 a191, v251
    v_mov_b64 v[128:129], 0
    v_mov_b64 v[130:131], 0
    v_mov_b64 v[132:133], 0
    v_mov_b64 v[134:135], 0
    v_mov_b64 v[136:137], 0
    v_mov_b64 v[138:139], 0
    v_mov_b64 v[140:141], 0
    v_mov_b64 v[142:143], 0
    v_mov_b64 v[144:145], 0
    v_mov_b64 v[146:147], 0
    v_mov_b64 v[148:149], 0
    v_mov_b64 v[150:151], 0
    v_mov_b64 v[152:153], 0
    v_mov_b64 v[154:155], 0
    v_mov_b64 v[156:157], 0
    v_mov_b64 v[158:159], 0
    v_mov_b64 v[160:161], 0
    v_mov_b64 v[162:163], 0
    v_mov_b64 v[164:165], 0
    v_mov_b64 v[166:167], 0
    v_mov_b64 v[168:169], 0
    v_mov_b64 v[170:171], 0
    v_mov_b64 v[172:173], 0
    v_mov_b64 v[174:175], 0
    v_mov_b64 v[176:177], 0
    v_mov_b64 v[178:179], 0
    v_mov_b64 v[180:181], 0
    v_mov_b64 v[182:183], 0
    v_mov_b64 v[184:185], 0
    v_mov_b64 v[186:187], 0
    v_mov_b64 v[188:189], 0
    v_mov_b64 v[190:191], 0
    v_mov_b64 v[192:193], 0
    v_mov_b64 v[194:195], 0
    v_mov_b64 v[196:197], 0
    v_mov_b64 v[198:199], 0
    v_mov_b64 v[200:201], 0
    v_mov_b64 v[202:203], 0
    v_mov_b64 v[204:205], 0
    v_mov_b64 v[206:207], 0
    v_mov_b64 v[208:209], 0
    v_mov_b64 v[210:211], 0
    v_mov_b64 v[212:213], 0
    v_mov_b64 v[214:215], 0
    v_mov_b64 v[216:217], 0
    v_mov_b64 v[218:219], 0
    v_mov_b64 v[220:221], 0
    v_mov_b64 v[222:223], 0
    v_mov_b64 v[224:225], 0
    v_mov_b64 v[226:227], 0
    v_mov_b64 v[228:229], 0
    v_mov_b64 v[230:231], 0
    v_mov_b64 v[232:233], 0
    v_mov_b64 v[234:235], 0
    v_mov_b64 v[236:237], 0
    v_mov_b64 v[238:239], 0
    v_mov_b64 v[240:241], 0
    v_mov_b64 v[242:243], 0
    v_mov_b64 v[244:245], 0
    v_mov_b64 v[246:247], 0
    v_mov_b64 v[248:249], 0
    v_mov_b64 v[250:251], 0
    v_mov_b64 v[252:253], 0
    v_mov_b64 v[254:255], 0
    v_mov_b32 v7, 0
    v_mov_b32 v8, 0
    v_mov_b32 v9, 0
    v_mov_b32 v10, 0
    v_and_b32 v11, 31, v0
    v_lshlrev_b32 v11, 2, v11
    buffer_load_dword a247, v11, s[12:15], s61 offen sc1
    s_branch L_first
L_tail:
    v_lshrrev_b32 v14, 3, v0
    s_lshl_b32 s40, s3, 3
    v_add_u32 v2, s40, v14
    v_mul_u32_u24 v2, 896, v2
    v_and_b32 v14, 6, v14
    v_xor_b32 v14, v14, v0
    v_and_b32 v14, 7, v14
    v_lshl_add_u32 v2, v14, 4, v2
    s_mul_i32 s40, s26, 229376
    s_add_u32 s41, s40, 28672
    s_add_u32 s42, s40, 57344
    s_add_u32 s43, s40, 86016
    s_add_u32 s44, s40, 114688
    s_add_u32 s45, s40, 143360
    s_add_u32 s46, s40, 172032
    s_add_u32 s47, s40, 200704
    s_mov_b32 s16, s86
    s_mov_b32 s17, s87
    s_mov_b32 s18, 3670016
    s_mov_b32 s19, 0x20000
    s_and_b32 s39, s2, 127
    s_lshl_b32 s55, s39, 16
    s_lshl_b32 s57, s3, 14
    s_add_u32 s55, s55, s57
    s_add_u32 s55, s55, 67108864
    s_add_u32 s56, s55, 0x2000
    s_lshl_b32 s57, s39, 2
    s_add_u32 s57, s57, s3
    s_lshl_b32 s57, s57, 9
    s_add_u32 s57, s57, 83886080
    v_lshrrev_b32 v15, 2, v1
    s_waitcnt vmcnt(0) lgkmcnt(0)
    s_barrier
    ds_read_b128 a[64:67], v3 offset:0
    ds_read_b128 a[68:71], v3 offset:16384
    ds_read_b128 a[72:75], v3 offset:1024
    ds_read_b128 a[76:79], v3 offset:17408
    ds_read_b128 a[80:83], v3 offset:2048
    ds_read_b128 a[84:87], v3 offset:18432
    ds_read_b128 a[88:91], v3 offset:3072
    ds_read_b128 a[92:95], v3 offset:19456
    v_accvgpr_read_b32 v11, a246
    s_cmp_lg_u32 s54, 2
    s_cbranch_scc1 L_noearly
    v_cmp_ne_u32 vcc, 0, v11
    s_cbranch_vccnz L_noearly
    s_mov_b32 s54, 3
    buffer_load_dword v12, v15, s[12:15], s57 offen offset:0 sc1
    buffer_load_dword v13, v15, s[12:15], s57 offen offset:256 sc1
    buffer_load_dwordx4 v[32:35], v1, s[12:15], s55 offen offset:0 sc1
    buffer_load_dwordx4 v[36:39], v1, s[12:15], s55 offen offset:1024 sc1
    buffer_load_dwordx4 v[40:43], v1, s[12:15], s55 offen offset:2048 sc1
    buffer_load_dwordx4 v[44:47], v1, s[12:15], s55 offen offset:3072 sc1
    buffer_load_dwordx4 v[48:51], v4, s[12:15], s55 offen offset:0 sc1
    buffer_load_dwordx4 v[52:55], v4, s[12:15], s55 offen offset:1024 sc1
    buffer_load_dwordx4 v[56:59], v4, s[12:15], s55 offen offset:2048 sc1
    buffer_load_dwordx4 v[60:63], v4, s[12:15], s55 offen offset:3072 sc1
    buffer_load_dwordx4 v[96:99], v1, s[12:15], s56 offen offset:0 sc1
    buffer_load_dwordx4 v[100:103], v1, s[12:15], s56 offen offset:1024 sc1
    buffer_load_dwordx4 v[104:107], v1, s[12:15], s56 offen offset:2048 sc1
    buffer_load_dwordx4 v[108:111], v1, s[12:15], s56 offen offset:3072 sc1
    buffer_load_dwordx4 v[112:115], v4, s[12:15], s56 offen offset:0 sc1
    buffer_load_dwordx4 v[116:119], v4, s[12:15], s56 offen offset:1024 sc1
    buffer_load_dwordx4 v[120:123], v4, s[12:15], s56 offen offset:2048 sc1
    buffer_load_dwordx4 v[124:127], v4, s[12:15], s56 offen offset:3072 sc1
L_noearly:
    s_cmp_eq_u32 s62, 0
    s_cbranch_scc1 L_nou
    v_accvgpr_read_b32 v12, a247
    v_cmp_ne_u32 vcc, 0, v12
    s_cbranch_vccz L_poll2_ok
    v_and_b32 v11, 31, v0
    v_lshlrev_b32 v11, 2, v11
    s_mov_b32 s32, 0
L_poll2:
    buffer_load_dword v12, v11, s[12:15], s61 offen sc1
    s_waitcnt vmcnt(0)
    v_cmp_ne_u32 vcc, 0, v12
    s_cbranch_vccz L_poll2_ok
    s_sleep 8
    s_add_u32 s32, s32, 1
    s_cmp_lt_u32 s32, 0x80000
    s_cbranch_scc1 L_poll2
L_poll2_ok:
L_nou:
    v_cvt_pk_bf16_f32 v16, v64, v65
    v_cvt_pk_bf16_f32 v17, v66, v67
    v_cvt_pk_bf16_f32 v20, v68, v69
    v_cvt_pk_bf16_f32 v21, v70, v71
    v_cvt_pk_bf16_f32 v18, v72, v73
    v_cvt_pk_bf16_f32 v19, v74, v75
    v_cvt_pk_bf16_f32 v22, v76, v77
    v_cvt_pk_bf16_f32 v23, v78, v79
    v_cvt_pk_bf16_f32 v24, v80, v81
    v_cvt_pk_bf16_f32 v25, v82, v83
    v_cvt_pk_bf16_f32 v28, v84, v85
    v_cvt_pk_bf16_f32 v29, v86, v87
    v_cvt_pk_bf16_f32 v26, v88, v89
    v_cvt_pk_bf16_f32 v27, v90, v91
    v_cvt_pk_bf16_f32 v30, v92, v93
    v_cvt_pk_bf16_f32 v31, v94, v95
    v_add_f32 v7, v7, v5
    v_add_f32 v8, v8, v6
    s_waitcnt lgkmcnt(0)
    v_mfma_f32_16x16x32_bf16 v[128:131], a[64:67], v[16:19], v[128:131]
    s_add_u32 m0, s29, 0
    ds_read_b128 a[96:99], v3 offset:4096
    v_mfma_f32_16x16x32_bf16 v[128:131], a[68:71], v[24:27], v[128:131]
    buffer_load_dwordx4 v2, s[16:19], s40 offen lds
    v_mfma_f32_16x16x32_bf16 v[192:195], a[68:71], v[28:31], v[192:195]
    ds_read_b128 a[100:103], v3 offset:20480
    v_mfma_f32_16x16x32_bf16 v[192:195], a[64:67], v[20:23], v[192:195]
    v_mov_b32 v68, v7
    v_mov_b32 v69, v8
    v_mfma_f32_16x16x32_bf16 v[132:135], a[72:75], v[16:19], v[132:135]
    s_add_u32 m0, s29, 4096
    ds_read_b128 a[104:107], v3 offset:5120
    v_mfma_f32_16x16x32_bf16 v[132:135], a[76:79], v[24:27], v[132:135]
    buffer_load_dwordx4 v2, s[16:19], s41 offen lds
    v_mfma_f32_16x16x32_bf16 v[196:199], a[76:79], v[28:31], v[196:199]
    ds_read_b128 a[108:111], v3 offset:21504
    v_mfma_f32_16x16x32_bf16 v[196:199], a[72:75], v[20:23], v[196:199]
    v_permlane32_swap_b32 v7, v68
    v_permlane32_swap_b32 v8, v69
    v_mfma_f32_16x16x32_bf16 v[136:139], a[80:83], v[16:19], v[136:139]
    s_add_u32 m0, s29, 8192
    ds_read_b128 a[112:115], v3 offset:6144
    v_mfma_f32_16x16x32_bf16 v[136:139], a[84:87], v[24:27], v[136:139]
    buffer_load_dwordx4 v2, s[16:19], s42 offen lds
    v_mfma_f32_16x16x32_bf16 v[200:203], a[84:87], v[28:31], v[200:203]
    ds_read_b128 a[116:119], v3 offset:22528
    v_mfma_f32_16x16x32_bf16 v[200:203], a[80:83], v[20:23], v[200:203]
    v_add_f32 v7, v7, v68
    v_add_f32 v8, v8, v69
    v_mfma_f32_16x16x32_bf16 v[140:143], a[88:91], v[16:19], v[140:143]
    s_add_u32 m0, s29, 12288
    ds_read_b128 a[120:123], v3 offset:7168
    v_mfma_f32_16x16x32_bf16 v[140:143], a[92:95], v[24:27], v[140:143]
    buffer_load_dwordx4 v2, s[16:19], s43 offen lds
    v_mfma_f32_16x16x32_bf16 v[204:207], a[92:95], v[28:31], v[204:207]
    ds_read_b128 a[124:127], v3 offset:23552
    v_mfma_f32_16x16x32_bf16 v[204:207], a[88:91], v[20:23], v[204:207]
    s_waitcnt lgkmcnt(6)
    v_mov_b32 v68, v7
    v_mov_b32 v69, v8
    v_mfma_f32_16x16x32_bf16 v[144:147], a[96:99], v[16:19], v[144:147]
    s_add_u32 m0, s29, 16384
    ds_read_b128 a[64:67], v3 offset:8192
    v_mfma_f32_16x16x32_bf16 v[144:147], a[100:103], v[24:27], v[144:147]
    buffer_load_dwordx4 v2, s[16:19], s44 offen lds
    v_mfma_f32_16x16x32_bf16 v[208:211], a[100:103], v[28:31], v[208:211]
    ds_read_b128 a[68:71], v3 offset:24576
    v_mfma_f32_16x16x32_bf16 v[208:211], a[96:99], v[20:23], v[208:211]
    s_waitcnt lgkmcnt(6)
    v_permlane16_swap_b32 v7, v68
    v_permlane16_swap_b32 v8, v69
    v_mfma_f32_16x16x32_bf16 v[148:151], a[104:107], v[16:19], v[148:151]
    s_add_u32 m0, s29, 20480
    ds_read_b128 a[72:75], v3 offset:9216
    v_mfma_f32_16x16x32_bf16 v[148:151], a[108:111], v[24:27], v[148:151]
    buffer_load_dwordx4 v2, s[16:19], s45 offen lds
    v_mfma_f32_16x16x32_bf16 v[212:215], a[108:111], v[28:31], v[212:215]
    ds_read_b128 a[76:79], v3 offset:25600
    v_mfma_f32_16x16x32_bf16 v[212:215], a[104:107], v[20:23], v[212:215]
    s_waitcnt lgkmcnt(6)
    v_add_f32 v7, v7, v68
    v_add_f32 v8, v8, v69
    v_mfma_f32_16x16x32_bf16 v[152:155], a[112:115], v[16:19], v[152:155]
    s_add_u32 m0, s29, 24576
    ds_read_b128 a[80:83], v3 offset:10240
    v_mfma_f32_16x16x32_bf16 v[152:155], a[116:119], v[24:27], v[152:155]
    buffer_load_dwordx4 v2, s[16:19], s46 offen lds
    v_mfma_f32_16x16x32_bf16 v[216:219], a[116:119], v[28:31], v[216:219]
    ds_read_b128 a[84:87], v3 offset:26624
    v_mfma_f32_16x16x32_bf16 v[216:219], a[112:115], v[20:23], v[216:219]
    s_waitcnt lgkmcnt(6)
    v_log_f32 v5, v7
    v_mfma_f32_16x16x32_bf16 v[156:159], a[120:123], v[16:19], v[156:159]
    s_add_u32 m0, s29, 28672
    ds_read_b128 a[88:91], v3 offset:11264
    v_mfma_f32_16x16x32_bf16 v[156:159], a[124:127], v[24:27], v[156:159]
    buffer_load_dwordx4 v2, s[16:19], s47 offen lds
    v_mfma_f32_16x16x32_bf16 v[220:223], a[124:127], v[28:31], v[220:223]
    ds_read_b128 a[92:95], v3 offset:27648
    v_add_u32 v2, 128, v2
    v_mfma_f32_16x16x32_bf16 v[220:223], a[120:123], v[20:23], v[220:223]
    s_waitcnt lgkmcnt(6)
    v_rcp_f32 v64, v7
    v_mfma_f32_16x16x32_bf16 v[160:163], a[64:67], v[16:19], v[160:163]
    s_add_u32 m0, s29, 32768
    ds_read_b128 a[96:99], v3 offset:12288
    v_mfma_f32_16x16x32_bf16 v[160:163], a[68:71], v[24:27], v[160:163]
    buffer_load_dwordx4 v2, s[16:19], s40 offen lds
    v_mfma_f32_16x16x32_bf16 v[224:227], a[68:71], v[28:31], v[224:227]
    ds_read_b128 a[100:103], v3 offset:28672
    v_mfma_f32_16x16x32_bf16 v[224:227], a[64:67], v[20:23], v[224:227]
    s_waitcnt lgkmcnt(6)
    v_log_f32 v6, v8
    v_mfma_f32_16x16x32_bf16 v[164:167], a[72:75], v[16:19], v[164:167]
    s_add_u32 m0, s29, 36864
    ds_read_b128 a[104:107], v3 offset:13312
    v_mfma_f32_16x16x32_bf16 v[164:167], a[76:79], v[24:27], v[164:167]
    buffer_load_dwordx4 v2, s[16:19], s41 offen lds
    v_mfma_f32_16x16x32_bf16 v[228:231], a[76:79], v[28:31], v[228:231]
    ds_read_b128 a[108:111], v3 offset:29696
    v_mfma_f32_16x16x32_bf16 v[228:231], a[72:75], v[20:23], v[228:231]
    s_waitcnt lgkmcnt(6)
    v_rcp_f32 v65, v8
    v_mfma_f32_16x16x32_bf16 v[168:171], a[80:83], v[16:19], v[168:171]
    s_add_u32 m0, s29, 40960
    ds_read_b128 a[112:115], v3 offset:14336
    v_mfma_f32_16x16x32_bf16 v[168:171], a[84:87], v[24:27], v[168:171]
    buffer_load_dwordx4 v2, s[16:19], s42 offen lds
    v_mfma_f32_16x16x32_bf16 v[232:235], a[84:87], v[28:31], v[232:235]
    ds_read_b128 a[116:119], v3 offset:30720
    v_mfma_f32_16x16x32_bf16 v[232:235], a[80:83], v[20:23], v[232:235]
    s_waitcnt lgkmcnt(6)
    v_sub_f32 v5, v5, v9
    v_sub_f32 v6, v6, v10
    v_mfma_f32_16x16x32_bf16 v[172:175], a[88:91], v[16:19], v[172:175]
    s_add_u32 m0, s29, 45056
    ds_read_b128 a[120:123], v3 offset:15360
    v_mfma_f32_16x16x32_bf16 v[172:175], a[92:95], v[24:27], v[172:175]
    buffer_load_dwordx4 v2, s[16:19], s43 offen lds
    v_mfma_f32_16x16x32_bf16 v[236:239], a[92:95], v[28:31], v[236:239]
    ds_read_b128 a[124:127], v3 offset:31744
    v_mfma_f32_16x16x32_bf16 v[236:239], a[88:91], v[20:23], v[236:239]
    s_waitcnt lgkmcnt(6)
    v_mfma_f32_16x16x32_bf16 v[176:179], a[96:99], v[16:19], v[176:179]
    s_add_u32 m0, s29, 49152
    v_mfma_f32_16x16x32_bf16 v[176:179], a[100:103], v[24:27], v[176:179]
    buffer_load_dwordx4 v2, s[16:19], s44 offen lds
    v_mfma_f32_16x16x32_bf16 v[240:243], a[100:103], v[28:31], v[240:243]
    v_mfma_f32_16x16x32_bf16 v[240:243], a[96:99], v[20:23], v[240:243]
    s_waitcnt lgkmcnt(4)
    v_mfma_f32_16x16x32_bf16 v[180:183], a[104:107], v[16:19], v[180:183]
    s_add_u32 m0, s29, 53248
    v_mfma_f32_16x16x32_bf16 v[180:183], a[108:111], v[24:27], v[180:183]
    buffer_load_dwordx4 v2, s[16:19], s45 offen lds
    v_mfma_f32_16x16x32_bf16 v[244:247], a[108:111], v[28:31], v[244:247]
    v_mfma_f32_16x16x32_bf16 v[244:247], a[104:107], v[20:23], v[244:247]
    s_waitcnt lgkmcnt(2)
    v_mfma_f32_16x16x32_bf16 v[184:187], a[112:115], v[16:19], v[184:187]
    s_add_u32 m0, s29, 57344
    v_mfma_f32_16x16x32_bf16 v[184:187], a[116:119], v[24:27], v[184:187]
    buffer_load_dwordx4 v2, s[16:19], s46 offen lds
    v_mfma_f32_16x16x32_bf16 v[248:251], a[116:119], v[28:31], v[248:251]
    v_mfma_f32_16x16x32_bf16 v[248:251], a[112:115], v[20:23], v[248:251]
    s_waitcnt lgkmcnt(0)
    v_mfma_f32_16x16x32_bf16 v[188:191], a[120:123], v[16:19], v[188:191]
    s_add_u32 m0, s29, 61440
    v_mfma_f32_16x16x32_bf16 v[188:191], a[124:127], v[24:27], v[188:191]
    buffer_load_dwordx4 v2, s[16:19], s47 offen lds
    v_mfma_f32_16x16x32_bf16 v[252:255], a[124:127], v[28:31], v[252:255]
    v_add_u32 v2, 128, v2
    v_mfma_f32_16x16x32_bf16 v[252:255], a[120:123], v[20:23], v[252:255]
    s_cmp_eq_u32 s38, 0
    s_cbranch_scc1 L_store
    s_cmp_ge_u32 s54, 2
    s_cbranch_scc1 L_merge
    buffer_store_dword v5, v15, s[12:15], s57 offen offset:0 sc1
    buffer_store_dword v6, v15, s[12:15], s57 offen offset:256 sc1
    s_nop 1
    v_pk_mul_f32 v[128:129], v[128:129], v[64:65] op_sel:[0,0] op_sel_hi:[1,0]
    v_pk_mul_f32 v[130:131], v[130:131], v[64:65] op_sel:[0,0] op_sel_hi:[1,0]
    v_pk_mul_f32 v[132:133], v[132:133], v[64:65] op_sel:[0,0] op_sel_hi:[1,0]
    v_pk_mul_f32 v[134:135], v[134:135], v[64:65] op_sel:[0,0] op_sel_hi:[1,0]
    v_cvt_pk_bf16_f32 v128, v128, v129
    v_cvt_pk_bf16_f32 v129, v130, v131
    v_cvt_pk_bf16_f32 v130, v132, v133
    v_cvt_pk_bf16_f32 v131, v134, v135
    buffer_store_dwordx4 v[128:131], v1, s[12:15], s55 offen offset:0 sc1
    v_pk_mul_f32 v[136:137], v[136:137], v[64:65] op_sel:[0,0] op_sel_hi:[1,0]
    v_pk_mul_f32 v[138:139], v[138:139], v[64:65] op_sel:[0,0] op_sel_hi:[1,0]
    v_pk_mul_f32 v[140:141], v[140:141], v[64:65] op_sel:[0,0] op_sel_hi:[1,0]
    v_pk_mul_f32 v[142:143], v[142:143], v[64:65] op_sel:[0,0] op_sel_hi:[1,0]
    v_cvt_pk_bf16_f32 v136, v136, v137
    v_cvt_pk_bf16_f32 v137, v138, v139
    v_cvt_pk_bf16_f32 v138, v140, v141
    v_cvt_pk_bf16_f32 v139, v142, v143
    buffer_store_dwordx4 v[136:139], v1, s[12:15], s55 offen offset:1024 sc1
    v_accvgpr_read_b32 v128, a128
    v_accvgpr_read_b32 v129, a129
    v_accvgpr_read_b32 v130, a130
    v_accvgpr_read_b32 v131, a131
    v_pk_mul_f32 v[144:145], v[144:145], v[64:65] op_sel:[0,0] op_sel_hi:[1,0]
    v_pk_mul_f32 v[146:147], v[146:147], v[64:65] op_sel:[0,0] op_sel_hi:[1,0]
    v_pk_mul_f32 v[148:149], v[148:149], v[64:65] op_sel:[0,0] op_sel_hi:[1,0]
    v_pk_mul_f32 v[150:151], v[150:151], v[64:65] op_sel:[0,0] op_sel_hi:[1,0]
    v_cvt_pk_bf16_f32 v144, v144, v145
    v_cvt_pk_bf16_f32 v145, v146, v147
    v_cvt_pk_bf16_f32 v146, v148, v149
    v_cvt_pk_bf16_f32 v147, v150, v151
    buffer_store_dwordx4 v[144:147], v1, s[12:15], s55 offen offset:2048 sc1
    v_accvgpr_read_b32 v136, a132
    v_accvgpr_read_b32 v137, a133
    v_accvgpr_read_b32 v138, a134
    v_accvgpr_read_b32 v139, a135
    v_pk_mul_f32 v[152:153], v[152:153], v[64:65] op_sel:[0,0] op_sel_hi:[1,0]
    v_pk_mul_f32 v[154:155], v[154:155], v[64:65] op_sel:[0,0] op_sel_hi:[1,0]
    v_pk_mul_f32 v[156:157], v[156:157], v[64:65] op_sel:[0,0] op_sel_hi:[1,0]
    v_pk_mul_f32 v[158:159], v[158:159], v[64:65] op_sel:[0,0] op_sel_hi:[1,0]
    v_cvt_pk_bf16_f32 v152, v152, v153
    v_cvt_pk_bf16_f32 v153, v154, v155
    v_cvt_pk_bf16_f32 v154, v156, v157
    v_cvt_pk_bf16_f32 v155, v158, v159
    buffer_store_dwordx4 v[152:155], v1, s[12:15], s55 offen offset:3072 sc1
    v_accvgpr_read_b32 v144, a136
    v_accvgpr_read_b32 v145, a137
    v_accvgpr_read_b32 v146, a138
    v_accvgpr_read_b32 v147, a139
    v_pk_mul_f32 v[160:161], v[160:161], v[64:65] op_sel:[0,0] op_sel_hi:[1,0]
    v_pk_mul_f32 v[162:163], v[162:163], v[64:65] op_sel:[0,0] op_sel_hi:[1,0]
    v_pk_mul_f32 v[164:165], v[164:165], v[64:65] op_sel:[0,0] op_sel_hi:[1,0]
    v_pk_mul_f32 v[166:167], v[166:167], v[64:65] op_sel:[0,0] op_sel_hi:[1,0]
    v_cvt_pk_bf16_f32 v160, v160, v161
    v_cvt_pk_bf16_f32 v161, v162, v163
    v_cvt_pk_bf16_f32 v162, v164, v165
    v_cvt_pk_bf16_f32 v163, v166, v167
    buffer_store_dwordx4 v[160:163], v4, s[12:15], s55 offen offset:0 sc1
    v_accvgpr_read_b32 v152, a140
    v_accvgpr_read_b32 v153, a141
    v_accvgpr_read_b32 v154, a142
    v_accvgpr_read_b32 v155, a143
    v_pk_mul_f32 v[168:169], v[168:169], v[64:65] op_sel:[0,0] op_sel_hi:[1,0]
    v_pk_mul_f32 v[170:171], v[170:171], v[64:65] op_sel:[0,0] op_sel_hi:[1,0]
    v_pk_mul_f32 v[172:173], v[172:173], v[64:65] op_sel:[0,0] op_sel_hi:[1,0]
    v_pk_mul_f32 v[174:175], v[174:175], v[64:65] op_sel:[0,0] op_sel_hi:[1,0]
    v_cvt_pk_bf16_f32 v168, v168, v169
    v_cvt_pk_bf16_f32 v169, v170, v171
    v_cvt_pk_bf16_f32 v170, v172, v173
    v_cvt_pk_bf16_f32 v171, v174, v175
    buffer_store_dwordx4 v[168:171], v4, s[12:15], s55 offen offset:1024 sc1
    v_accvgpr_read_b32 v160, a144
    v_accvgpr_read_b32 v161, a145
    v_accvgpr_read_b32 v162, a146
    v_accvgpr_read_b32 v163, a147
    v_pk_mul_f32 v[176:177], v[176:177], v[64:65] op_sel:[0,0] op_sel_hi:[1,0]
    v_pk_mul_f32 v[178:179], v[178:179], v[64:65] op_sel:[0,0] op_sel_hi:[1,0]
    v_pk_mul_f32 v[180:181], v[180:181], v[64:65] op_sel:[0,0] op_sel_hi:[1,0]
    v_pk_mul_f32 v[182:183], v[182:183], v[64:65] op_sel:[0,0] op_sel_hi:[1,0]
    v_cvt_pk_bf16_f32 v176, v176, v177
    v_cvt_pk_bf16_f32 v177, v178, v179
    v_cvt_pk_bf16_f32 v178, v180, v181
    v_cvt_pk_bf16_f32 v179, v182, v183
    buffer_store_dwordx4 v[176:179], v4, s[12:15], s55 offen offset:2048 sc1
    v_accvgpr_read_b32 v168, a148
    v_accvgpr_read_b32 v169, a149
    v_accvgpr_read_b32 v170, a150
    v_accvgpr_read_b32 v171, a151
    v_pk_mul_f32 v[184:185], v[184:185], v[64:65] op_sel:[0,0] op_sel_hi:[1,0]
    v_pk_mul_f32 v[186:187], v[186:187], v[64:65] op_sel:[0,0] op_sel_hi:[1,0]
    v_pk_mul_f32 v[188:189], v[188:189], v[64:65] op_sel:[0,0] op_sel_hi:[1,0]
    v_pk_mul_f32 v[190:191], v[190:191], v[64:65] op_sel:[0,0] op_sel_hi:[1,0]
    v_cvt_pk_bf16_f32 v184, v184, v185
    v_cvt_pk_bf16_f32 v185, v186, v187
    v_cvt_pk_bf16_f32 v186, v188, v189
    v_cvt_pk_bf16_f32 v187, v190, v191
    buffer_store_dwordx4 v[184:187], v4, s[12:15], s55 offen offset:3072 sc1
    v_accvgpr_read_b32 v176, a152
    v_accvgpr_read_b32 v177, a153
    v_accvgpr_read_b32 v178, a154
    v_accvgpr_read_b32 v179, a155
    v_pk_mul_f32 v[192:193], v[192:193], v[64:65] op_sel:[0,1] op_sel_hi:[1,1]
    v_pk_mul_f32 v[194:195], v[194:195], v[64:65] op_sel:[0,1] op_sel_hi:[1,1]
    v_pk_mul_f32 v[196:197], v[196:197], v[64:65] op_sel:[0,1] op_sel_hi:[1,1]
    v_pk_mul_f32 v[198:199], v[198:199], v[64:65] op_sel:[0,1] op_sel_hi:[1,1]
    v_cvt_pk_bf16_f32 v192, v192, v193
    v_cvt_pk_bf16_f32 v193, v194, v195
    v_cvt_pk_bf16_f32 v194, v196, v197
    v_cvt_pk_bf16_f32 v195, v198, v199
    buffer_store_dwordx4 v[192:195], v1, s[12:15], s56 offen offset:0 sc1
    v_accvgpr_read_b32 v184, a156
    v_accvgpr_read_b32 v185, a157
    v_accvgpr_read_b32 v186, a158
    v_accvgpr_read_b32 v187, a159
    v_pk_mul_f32 v[200:201], v[200:201], v[64:65] op_sel:[0,1] op_sel_hi:[1,1]
    v_pk_mul_f32 v[202:203], v[202:203], v[64:65] op_sel:[0,1] op_sel_hi:[1,1]
    v_pk_mul_f32 v[204:205], v[204:205], v[64:65] op_sel:[0,1] op_sel_hi:[1,1]
    v_pk_mul_f32 v[206:207], v[206:207], v[64:65] op_sel:[0,1] op_sel_hi:[1,1]
    v_cvt_pk_bf16_f32 v200, v200, v201
    v_cvt_pk_bf16_f32 v201, v202, v203
    v_cvt_pk_bf16_f32 v202, v204, v205
    v_cvt_pk_bf16_f32 v203, v206, v207
    buffer_store_dwordx4 v[200:203], v1, s[12:15], s56 offen offset:1024 sc1
    v_accvgpr_read_b32 v192, a160
    v_accvgpr_read_b32 v193, a161
    v_accvgpr_read_b32 v194, a162
    v_accvgpr_read_b32 v195, a163
    v_pk_mul_f32 v[208:209], v[208:209], v[64:65] op_sel:[0,1] op_sel_hi:[1,1]
    v_pk_mul_f32 v[210:211], v[210:211], v[64:65] op_sel:[0,1] op_sel_hi:[1,1]
    v_pk_mul_f32 v[212:213], v[212:213], v[64:65] op_sel:[0,1] op_sel_hi:[1,1]
    v_pk_mul_f32 v[214:215], v[214:215], v[64:65] op_sel:[0,1] op_sel_hi:[1,1]
    v_cvt_pk_bf16_f32 v208, v208, v209
    v_cvt_pk_bf16_f32 v209, v210, v211
    v_cvt_pk_bf16_f32 v210, v212, v213
    v_cvt_pk_bf16_f32 v211, v214, v215
    buffer_store_dwordx4 v[208:211], v1, s[12:15], s56 offen offset:2048 sc1
    v_accvgpr_read_b32 v200, a164
    v_accvgpr_read_b32 v201, a165
    v_accvgpr_read_b32 v202, a166
    v_accvgpr_read_b32 v203, a167
    v_pk_mul_f32 v[216:217], v[216:217], v[64:65] op_sel:[0,1] op_sel_hi:[1,1]
    v_pk_mul_f32 v[218:219], v[218:219], v[64:65] op_sel:[0,1] op_sel_hi:[1,1]
    v_pk_mul_f32 v[220:221], v[220:221], v[64:65] op_sel:[0,1] op_sel_hi:[1,1]
    v_pk_mul_f32 v[222:223], v[222:223], v[64:65] op_sel:[0,1] op_sel_hi:[1,1]
    v_cvt_pk_bf16_f32 v216, v216, v217
    v_cvt_pk_bf16_f32 v217, v218, v219
    v_cvt_pk_bf16_f32 v218, v220, v221
    v_cvt_pk_bf16_f32 v219, v222, v223
    buffer_store_dwordx4 v[216:219], v1, s[12:15], s56 offen offset:3072 sc1
    v_accvgpr_read_b32 v208, a168
    v_accvgpr_read_b32 v209, a169
    v_accvgpr_read_b32 v210, a170
    v_accvgpr_read_b32 v211, a171
    v_pk_mul_f32 v[224:225], v[224:225], v[64:65] op_sel:[0,1] op_sel_hi:[1,1]
    v_pk_mul_f32 v[226:227], v[226:227], v[64:65] op_sel:[0,1] op_sel_hi:[1,1]
    v_pk_mul_f32 v[228:229], v[228:229], v[64:65] op_sel:[0,1] op_sel_hi:[1,1]
    v_pk_mul_f32 v[230:231], v[230:231], v[64:65] op_sel:[0,1] op_sel_hi:[1,1]
    v_cvt_pk_bf16_f32 v224, v224, v225
    v_cvt_pk_bf16_f32 v225, v226, v227
    v_cvt_pk_bf16_f32 v226, v228, v229
    v_cvt_pk_bf16_f32 v227, v230, v231
    buffer_store_dwordx4 v[224:227], v4, s[12:15], s56 offen offset:0 sc1
    v_accvgpr_read_b32 v216, a172
    v_accvgpr_read_b32 v217, a173
    v_accvgpr_read_b32 v218, a174
    v_accvgpr_read_b32 v219, a175
    v_pk_mul_f32 v[232:233], v[232:233], v[64:65] op_sel:[0,1] op_sel_hi:[1,1]
    v_pk_mul_f32 v[234:235], v[234:235], v[64:65] op_sel:[0,1] op_sel_hi:[1,1]
    v_pk_mul_f32 v[236:237], v[236:237], v[64:65] op_sel:[0,1] op_sel_hi:[1,1]
    v_pk_mul_f32 v[238:239], v[238:239], v[64:65] op_sel:[0,1] op_sel_hi:[1,1]
    v_cvt_pk_bf16_f32 v232, v232, v233
    v_cvt_pk_bf16_f32 v233, v234, v235
    v_cvt_pk_bf16_f32 v234, v236, v237
    v_cvt_pk_bf16_f32 v235, v238, v239
    buffer_store_dwordx4 v[232:235], v4, s[12:15], s56 offen offset:1024 sc1
    v_accvgpr_read_b32 v224, a176
    v_accvgpr_read_b32 v225, a177
    v_accvgpr_read_b32 v226, a178
    v_accvgpr_read_b32 v227, a179
    v_pk_mul_f32 v[240:241], v[240:241], v[64:65] op_sel:[0,1] op_sel_hi:[1,1]
    v_pk_mul_f32 v[242:243], v[242:243], v[64:65] op_sel:[0,1] op_sel_hi:[1,1]
    v_pk_mul_f32 v[244:245], v[244:245], v[64:65] op_sel:[0,1] op_sel_hi:[1,1]
    v_pk_mul_f32 v[246:247], v[246:247], v[64:65] op_sel:[0,1] op_sel_hi:[1,1]
    v_cvt_pk_bf16_f32 v240, v240, v241
    v_cvt_pk_bf16_f32 v241, v242, v243
    v_cvt_pk_bf16_f32 v242, v244, v245
    v_cvt_pk_bf16_f32 v243, v246, v247
    buffer_store_dwordx4 v[240:243], v4, s[12:15], s56 offen offset:2048 sc1
    v_accvgpr_read_b32 v232, a180
    v_accvgpr_read_b32 v233, a181
    v_accvgpr_read_b32 v234, a182
    v_accvgpr_read_b32 v235, a183
    v_pk_mul_f32 v[248:249], v[248:249], v[64:65] op_sel:[0,1] op_sel_hi:[1,1]
    v_pk_mul_f32 v[250:251], v[250:251], v[64:65] op_sel:[0,1] op_sel_hi:[1,1]
    v_pk_mul_f32 v[252:253], v[252:253], v[64:65] op_sel:[0,1] op_sel_hi:[1,1]
    v_pk_mul_f32 v[254:255], v[254:255], v[64:65] op_sel:[0,1] op_sel_hi:[1,1]
    v_cvt_pk_bf16_f32 v248, v248, v249
    v_cvt_pk_bf16_f32 v249, v250, v251
    v_cvt_pk_bf16_f32 v250, v252, v253
    v_cvt_pk_bf16_f32 v251, v254, v255
    buffer_store_dwordx4 v[248:251], v4, s[12:15], s56 offen offset:3072 sc1
    v_accvgpr_read_b32 v240, a184
    v_accvgpr_read_b32 v241, a185
    v_accvgpr_read_b32 v242, a186
    v_accvgpr_read_b32 v243, a187
    v_accvgpr_read_b32 v248, a188
    v_accvgpr_read_b32 v249, a189
    v_accvgpr_read_b32 v250, a190
    v_accvgpr_read_b32 v251, a191
    s_mov_b32 s59, s94
    s_waitcnt vmcnt(18)
    s_branch L_attdone
L_merge:
    s_cmp_eq_u32 s54, 3
    s_cbranch_scc1 L_merge2
    v_and_b32 v11, 0, v0
    v_lshlrev_b32 v11, 2, v11
    s_mov_b32 s32, 0
L_poll3:
    buffer_load_dword v12, v11, s[12:15], s94 offen sc1
    s_waitcnt vmcnt(0)
    v_cmp_ne_u32 vcc, 0, v12
    s_cbranch_vccz L_poll3_ok
    s_sleep 8
    s_add_u32 s32, s32, 1
    s_cmp_lt_u32 s32, 0x80000
    s_cbranch_scc1 L_poll3
L_poll3_ok:
    buffer_load_dword v12, v15, s[12:15], s57 offen offset:0 sc1
    buffer_load_dword v13, v15, s[12:15], s57 offen offset:256 sc1
    buffer_load_dwordx4 v[32:35], v1, s[12:15], s55 offen offset:0 sc1
    buffer_load_dwordx4 v[36:39], v1, s[12:15], s55 offen offset:1024 sc1
    buffer_load_dwordx4 v[40:43], v1, s[12:15], s55 offen offset:2048 sc1
    buffer_load_dwordx4 v[44:47], v1, s[12:15], s55 offen offset:3072 sc1
    buffer_load_dwordx4 v[48:51], v4, s[12:15], s55 offen offset:0 sc1
    buffer_load_dwordx4 v[52:55], v4, s[12:15], s55 offen offset:1024 sc1
    buffer_load_dwordx4 v[56:59], v4, s[12:15], s55 offen offset:2048 sc1
    buffer_load_dwordx4 v[60:63], v4, s[12:15], s55 offen offset:3072 sc1
    buffer_load_dwordx4 v[96:99], v1, s[12:15], s56 offen offset:0 sc1
    buffer_load_dwordx4 v[100:103], v1, s[12:15], s56 offen offset:1024 sc1
    buffer_load_dwordx4 v[104:107], v1, s[12:15], s56 offen offset:2048 sc1
    buffer_load_dwordx4 v[108:111], v1, s[12:15], s56 offen offset:3072 sc1
    buffer_load_dwordx4 v[112:115], v4, s[12:15], s56 offen offset:0 sc1
    buffer_load_dwordx4 v[116:119], v4, s[12:15], s56 offen offset:1024 sc1
    buffer_load_dwordx4 v[120:123], v4, s[12:15], s56 offen offset:2048 sc1
    buffer_load_dwordx4 v[124:127], v4, s[12:15], s56 offen offset:3072 sc1
    s_waitcnt vmcnt(0)
L_merge2:
    s_waitcnt vmcnt(16)
    v_max_f32 v20, v12, v5
    v_sub_f32 v21, v5, v20
    v_sub_f32 v22, v12, v20
    v_exp_f32 v21, v21
    v_exp_f32 v22, v22
    s_nop 0
    v_add_f32 v20, v21, v22
    v_rcp_f32 v20, v20
    s_nop 0
    v_mul_f32 v21, v21, v20
    v_mul_f32 v18, v22, v20
    v_mul_f32 v64, v64, v21
    v_max_f32 v20, v13, v6
    v_sub_f32 v21, v6, v20
    v_sub_f32 v22, v13, v20
    v_exp_f32 v21, v21
    v_exp_f32 v22, v22
    s_nop 0
    v_add_f32 v20, v21, v22
    v_rcp_f32 v20, v20
    s_nop 0
    v_mul_f32 v21, v21, v20
    v_mul_f32 v19, v22, v20
    v_mul_f32 v65, v65, v21
    s_mov_b32 s59, 0xffff0000
    v_lshlrev_b32 v24, 16, v32
    v_and_b32 v25, s59, v32
    v_pk_mul_f32 v[24:25], v[24:25], v[18:19] op_sel:[0,0] op_sel_hi:[1,0]
    v_pk_fma_f32 v[128:129], v[128:129], v[64:65], v[24:25] op_sel:[0,0,0] op_sel_hi:[1,0,1]
    v_lshlrev_b32 v26, 16, v33
    v_and_b32 v27, s59, v33
    v_pk_mul_f32 v[26:27], v[26:27], v[18:19] op_sel:[0,0] op_sel_hi:[1,0]
    v_pk_fma_f32 v[130:131], v[130:131], v[64:65], v[26:27] op_sel:[0,0,0] op_sel_hi:[1,0,1]
    v_lshlrev_b32 v28, 16, v34
    v_and_b32 v29, s59, v34
    v_pk_mul_f32 v[28:29], v[28:29], v[18:19] op_sel:[0,0] op_sel_hi:[1,0]
    v_pk_fma_f32 v[132:133], v[132:133], v[64:65], v[28:29] op_sel:[0,0,0] op_sel_hi:[1,0,1]
    v_lshlrev_b32 v30, 16, v35
    v_and_b32 v31, s59, v35
    v_pk_mul_f32 v[30:31], v[30:31], v[18:19] op_sel:[0,0] op_sel_hi:[1,0]
    v_pk_fma_f32 v[134:135], v[134:135], v[64:65], v[30:31] op_sel:[0,0,0] op_sel_hi:[1,0,1]
    v_cvt_pk_bf16_f32 v128, v128, v129
    v_cvt_pk_bf16_f32 v129, v130, v131
    v_cvt_pk_bf16_f32 v130, v132, v133
    v_cvt_pk_bf16_f32 v131, v134, v135
    v_lshlrev_b32 v24, 16, v36
    v_and_b32 v25, s59, v36
    v_pk_mul_f32 v[24:25], v[24:25], v[18:19] op_sel:[0,0] op_sel_hi:[1,0]
    v_pk_fma_f32 v[136:137], v[136:137], v[64:65], v[24:25] op_sel:[0,0,0] op_sel_hi:[1,0,1]
    v_lshlrev_b32 v26, 16, v37
    v_and_b32 v27, s59, v37
    v_pk_mul_f32 v[26:27], v[26:27], v[18:19] op_sel:[0,0] op_sel_hi:[1,0]
    v_pk_fma_f32 v[138:139], v[138:139], v[64:65], v[26:27] op_sel:[0,0,0] op_sel_hi:[1,0,1]
    v_lshlrev_b32 v28, 16, v38
    v_and_b32 v29, s59, v38
    v_pk_mul_f32 v[28:29], v[28:29], v[18:19] op_sel:[0,0] op_sel_hi:[1,0]
    v_pk_fma_f32 v[140:141], v[140:141], v[64:65], v[28:29] op_sel:[0,0,0] op_sel_hi:[1,0,1]
    v_lshlrev_b32 v30, 16, v39
    v_and_b32 v31, s59, v39
    v_pk_mul_f32 v[30:31], v[30:31], v[18:19] op_sel:[0,0] op_sel_hi:[1,0]
    v_pk_fma_f32 v[142:143], v[142:143], v[64:65], v[30:31] op_sel:[0,0,0] op_sel_hi:[1,0,1]
    v_cvt_pk_bf16_f32 v136, v136, v137
    v_cvt_pk_bf16_f32 v137, v138, v139
    v_cvt_pk_bf16_f32 v138, v140, v141
    v_cvt_pk_bf16_f32 v139, v142, v143
    v_lshlrev_b32 v24, 16, v40
    v_and_b32 v25, s59, v40
    v_pk_mul_f32 v[24:25], v[24:25], v[18:19] op_sel:[0,0] op_sel_hi:[1,0]
    v_pk_fma_f32 v[144:145], v[144:145], v[64:65], v[24:25] op_sel:[0,0,0] op_sel_hi:[1,0,1]
    v_lshlrev_b32 v26, 16, v41
    v_and_b32 v27, s59, v41
    v_pk_mul_f32 v[26:27], v[26:27], v[18:19] op_sel:[0,0] op_sel_hi:[1,0]
    v_pk_fma_f32 v[146:147], v[146:147], v[64:65], v[26:27] op_sel:[0,0,0] op_sel_hi:[1,0,1]
    v_lshlrev_b32 v28, 16, v42
    v_and_b32 v29, s59, v42
    v_pk_mul_f32 v[28:29], v[28:29], v[18:19] op_sel:[0,0] op_sel_hi:[1,0]
    v_pk_fma_f32 v[148:149], v[148:149], v[64:65], v[28:29] op_sel:[0,0,0] op_sel_hi:[1,0,1]
    v_lshlrev_b32 v30, 16, v43
    v_and_b32 v31, s59, v43
    v_pk_mul_f32 v[30:31], v[30:31], v[18:19] op_sel:[0,0] op_sel_hi:[1,0]
    v_pk_fma_f32 v[150:151], v[150:151], v[64:65], v[30:31] op_sel:[0,0,0] op_sel_hi:[1,0,1]
    v_cvt_pk_bf16_f32 v144, v144, v145
    v_cvt_pk_bf16_f32 v145, v146, v147
    v_cvt_pk_bf16_f32 v146, v148, v149
    v_cvt_pk_bf16_f32 v147, v150, v151
    v_lshlrev_b32 v24, 16, v44
    v_and_b32 v25, s59, v44
    v_pk_mul_f32 v[24:25], v[24:25], v[18:19] op_sel:[0,0] op_sel_hi:[1,0]
    v_pk_fma_f32 v[152:153], v[152:153], v[64:65], v[24:25] op_sel:[0,0,0] op_sel_hi:[1,0,1]
    v_lshlrev_b32 v26, 16, v45
    v_and_b32 v27, s59, v45
    v_pk_mul_f32 v[26:27], v[26:27], v[18:19] op_sel:[0,0] op_sel_hi:[1,0]
    v_pk_fma_f32 v[154:155], v[154:155], v[64:65], v[26:27] op_sel:[0,0,0] op_sel_hi:[1,0,1]
    v_lshlrev_b32 v28, 16, v46
    v_and_b32 v29, s59, v46
    v_pk_mul_f32 v[28:29], v[28:29], v[18:19] op_sel:[0,0] op_sel_hi:[1,0]
    v_pk_fma_f32 v[156:157], v[156:157], v[64:65], v[28:29] op_sel:[0,0,0] op_sel_hi:[1,0,1]
    v_lshlrev_b32 v30, 16, v47
    v_and_b32 v31, s59, v47
    v_pk_mul_f32 v[30:31], v[30:31], v[18:19] op_sel:[0,0] op_sel_hi:[1,0]
    v_pk_fma_f32 v[158:159], v[158:159], v[64:65], v[30:31] op_sel:[0,0,0] op_sel_hi:[1,0,1]
    v_cvt_pk_bf16_f32 v152, v152, v153
    v_cvt_pk_bf16_f32 v153, v154, v155
    v_cvt_pk_bf16_f32 v154, v156, v157
    v_cvt_pk_bf16_f32 v155, v158, v159
    v_lshlrev_b32 v24, 16, v48
    v_and_b32 v25, s59, v48
    v_pk_mul_f32 v[24:25], v[24:25], v[18:19] op_sel:[0,0] op_sel_hi:[1,0]
    v_pk_fma_f32 v[160:161], v[160:161], v[64:65], v[24:25] op_sel:[0,0,0] op_sel_hi:[1,0,1]
    v_lshlrev_b32 v26, 16, v49
    v_and_b32 v27, s59, v49
    v_pk_mul_f32 v[26:27], v[26:27], v[18:19] op_sel:[0,0] op_sel_hi:[1,0]
    v_pk_fma_f32 v[162:163], v[162:163], v[64:65], v[26:27] op_sel:[0,0,0] op_sel_hi:[1,0,1]
    v_lshlrev_b32 v28, 16, v50
    v_and_b32 v29, s59, v50
    v_pk_mul_f32 v[28:29], v[28:29], v[18:19] op_sel:[0,0] op_sel_hi:[1,0]
    v_pk_fma_f32 v[164:165], v[164:165], v[64:65], v[28:29] op_sel:[0,0,0] op_sel_hi:[1,0,1]
    v_lshlrev_b32 v30, 16, v51
    v_and_b32 v31, s59, v51
    v_pk_mul_f32 v[30:31], v[30:31], v[18:19] op_sel:[0,0] op_sel_hi:[1,0]
    v_pk_fma_f32 v[166:167], v[166:167], v[64:65], v[30:31] op_sel:[0,0,0] op_sel_hi:[1,0,1]
    v_cvt_pk_bf16_f32 v160, v160, v161
    v_cvt_pk_bf16_f32 v161, v162, v163
    v_cvt_pk_bf16_f32 v162, v164, v165
    v_cvt_pk_bf16_f32 v163, v166, v167
    v_lshlrev_b32 v24, 16, v52
    v_and_b32 v25, s59, v52
    v_pk_mul_f32 v[24:25], v[24:25], v[18:19] op_sel:[0,0] op_sel_hi:[1,0]
    v_pk_fma_f32 v[168:169], v[168:169], v[64:65], v[24:25] op_sel:[0,0,0] op_sel_hi:[1,0,1]
    v_lshlrev_b32 v26, 16, v53
    v_and_b32 v27, s59, v53
    v_pk_mul_f32 v[26:27], v[26:27], v[18:19] op_sel:[0,0] op_sel_hi:[1,0]
    v_pk_fma_f32 v[170:171], v[170:171], v[64:65], v[26:27] op_sel:[0,0,0] op_sel_hi:[1,0,1]
    v_lshlrev_b32 v28, 16, v54
    v_and_b32 v29, s59, v54
    v_pk_mul_f32 v[28:29], v[28:29], v[18:19] op_sel:[0,0] op_sel_hi:[1,0]
    v_pk_fma_f32 v[172:173], v[172:173], v[64:65], v[28:29] op_sel:[0,0,0] op_sel_hi:[1,0,1]
    v_lshlrev_b32 v30, 16, v55
    v_and_b32 v31, s59, v55
    v_pk_mul_f32 v[30:31], v[30:31], v[18:19] op_sel:[0,0] op_sel_hi:[1,0]
    v_pk_fma_f32 v[174:175], v[174:175], v[64:65], v[30:31] op_sel:[0,0,0] op_sel_hi:[1,0,1]
    v_cvt_pk_bf16_f32 v168, v168, v169
    v_cvt_pk_bf16_f32 v169, v170, v171
    v_cvt_pk_bf16_f32 v170, v172, v173
    v_cvt_pk_bf16_f32 v171, v174, v175
    v_lshlrev_b32 v24, 16, v56
    v_and_b32 v25, s59, v56
    v_pk_mul_f32 v[24:25], v[24:25], v[18:19] op_sel:[0,0] op_sel_hi:[1,0]
    v_pk_fma_f32 v[176:177], v[176:177], v[64:65], v[24:25] op_sel:[0,0,0] op_sel_hi:[1,0,1]
    v_lshlrev_b32 v26, 16, v57
    v_and_b32 v27, s59, v57
    v_pk_mul_f32 v[26:27], v[26:27], v[18:19] op_sel:[0,0] op_sel_hi:[1,0]
    v_pk_fma_f32 v[178:179], v[178:179], v[64:65], v[26:27] op_sel:[0,0,0] op_sel_hi:[1,0,1]
    v_lshlrev_b32 v28, 16, v58
    v_and_b32 v29, s59, v58
    v_pk_mul_f32 v[28:29], v[28:29], v[18:19] op_sel:[0,0] op_sel_hi:[1,0]
    v_pk_fma_f32 v[180:181], v[180:181], v[64:65], v[28:29] op_sel:[0,0,0] op_sel_hi:[1,0,1]
    v_lshlrev_b32 v30, 16, v59
    v_and_b32 v31, s59, v59
    v_pk_mul_f32 v[30:31], v[30:31], v[18:19] op_sel:[0,0] op_sel_hi:[1,0]
    v_pk_fma_f32 v[182:183], v[182:183], v[64:65], v[30:31] op_sel:[0,0,0] op_sel_hi:[1,0,1]
    v_cvt_pk_bf16_f32 v176, v176, v177
    v_cvt_pk_bf16_f32 v177, v178, v179
    v_cvt_pk_bf16_f32 v178, v180, v181
    v_cvt_pk_bf16_f32 v179, v182, v183
    v_lshlrev_b32 v24, 16, v60
    v_and_b32 v25, s59, v60
    v_pk_mul_f32 v[24:25], v[24:25], v[18:19] op_sel:[0,0] op_sel_hi:[1,0]
    v_pk_fma_f32 v[184:185], v[184:185], v[64:65], v[24:25] op_sel:[0,0,0] op_sel_hi:[1,0,1]
    v_lshlrev_b32 v26, 16, v61
    v_and_b32 v27, s59, v61
    v_pk_mul_f32 v[26:27], v[26:27], v[18:19] op_sel:[0,0] op_sel_hi:[1,0]
    v_pk_fma_f32 v[186:187], v[186:187], v[64:65], v[26:27] op_sel:[0,0,0] op_sel_hi:[1,0,1]
    v_lshlrev_b32 v28, 16, v62
    v_and_b32 v29, s59, v62
    v_pk_mul_f32 v[28:29], v[28:29], v[18:19] op_sel:[0,0] op_sel_hi:[1,0]
    v_pk_fma_f32 v[188:189], v[188:189], v[64:65], v[28:29] op_sel:[0,0,0] op_sel_hi:[1,0,1]
    v_lshlrev_b32 v30, 16, v63
    v_and_b32 v31, s59, v63
    v_pk_mul_f32 v[30:31], v[30:31], v[18:19] op_sel:[0,0] op_sel_hi:[1,0]
    v_pk_fma_f32 v[190:191], v[190:191], v[64:65], v[30:31] op_sel:[0,0,0] op_sel_hi:[1,0,1]
    v_cvt_pk_bf16_f32 v184, v184, v185
    v_cvt_pk_bf16_f32 v185, v186, v187
    v_cvt_pk_bf16_f32 v186, v188, v189
    v_cvt_pk_bf16_f32 v187, v190, v191
    v_lshlrev_b32 v24, 16, v96
    v_and_b32 v25, s59, v96
    v_pk_mul_f32 v[24:25], v[24:25], v[18:19] op_sel:[0,1] op_sel_hi:[1,1]
    v_pk_fma_f32 v[192:193], v[192:193], v[64:65], v[24:25] op_sel:[0,1,0] op_sel_hi:[1,1,1]
    v_lshlrev_b32 v26, 16, v97
    v_and_b32 v27, s59, v97
    v_pk_mul_f32 v[26:27], v[26:27], v[18:19] op_sel:[0,1] op_sel_hi:[1,1]
    v_pk_fma_f32 v[194:195], v[194:195], v[64:65], v[26:27] op_sel:[0,1,0] op_sel_hi:[1,1,1]
    v_lshlrev_b32 v28, 16, v98
    v_and_b32 v29, s59, v98
    v_pk_mul_f32 v[28:29], v[28:29], v[18:19] op_sel:[0,1] op_sel_hi:[1,1]
    v_pk_fma_f32 v[196:197], v[196:197], v[64:65], v[28:29] op_sel:[0,1,0] op_sel_hi:[1,1,1]
    v_lshlrev_b32 v30, 16, v99
    v_and_b32 v31, s59, v99
    v_pk_mul_f32 v[30:31], v[30:31], v[18:19] op_sel:[0,1] op_sel_hi:[1,1]
    v_pk_fma_f32 v[198:199], v[198:199], v[64:65], v[30:31] op_sel:[0,1,0] op_sel_hi:[1,1,1]
    v_cvt_pk_bf16_f32 v192, v192, v193
    v_cvt_pk_bf16_f32 v193, v194, v195
    v_cvt_pk_bf16_f32 v194, v196, v197
    v_cvt_pk_bf16_f32 v195, v198, v199
    v_lshlrev_b32 v24, 16, v100
    v_and_b32 v25, s59, v100
    v_pk_mul_f32 v[24:25], v[24:25], v[18:19] op_sel:[0,1] op_sel_hi:[1,1]
    v_pk_fma_f32 v[200:201], v[200:201], v[64:65], v[24:25] op_sel:[0,1,0] op_sel_hi:[1,1,1]
    v_lshlrev_b32 v26, 16, v101
    v_and_b32 v27, s59, v101
    v_pk_mul_f32 v[26:27], v[26:27], v[18:19] op_sel:[0,1] op_sel_hi:[1,1]
    v_pk_fma_f32 v[202:203], v[202:203], v[64:65], v[26:27] op_sel:[0,1,0] op_sel_hi:[1,1,1]
    v_lshlrev_b32 v28, 16, v102
    v_and_b32 v29, s59, v102
    v_pk_mul_f32 v[28:29], v[28:29], v[18:19] op_sel:[0,1] op_sel_hi:[1,1]
    v_pk_fma_f32 v[204:205], v[204:205], v[64:65], v[28:29] op_sel:[0,1,0] op_sel_hi:[1,1,1]
    v_lshlrev_b32 v30, 16, v103
    v_and_b32 v31, s59, v103
    v_pk_mul_f32 v[30:31], v[30:31], v[18:19] op_sel:[0,1] op_sel_hi:[1,1]
    v_pk_fma_f32 v[206:207], v[206:207], v[64:65], v[30:31] op_sel:[0,1,0] op_sel_hi:[1,1,1]
    v_cvt_pk_bf16_f32 v200, v200, v201
    v_cvt_pk_bf16_f32 v201, v202, v203
    v_cvt_pk_bf16_f32 v202, v204, v205
    v_cvt_pk_bf16_f32 v203, v206, v207
    v_lshlrev_b32 v24, 16, v104
    v_and_b32 v25, s59, v104
    v_pk_mul_f32 v[24:25], v[24:25], v[18:19] op_sel:[0,1] op_sel_hi:[1,1]
    v_pk_fma_f32 v[208:209], v[208:209], v[64:65], v[24:25] op_sel:[0,1,0] op_sel_hi:[1,1,1]
    v_lshlrev_b32 v26, 16, v105
    v_and_b32 v27, s59, v105
    v_pk_mul_f32 v[26:27], v[26:27], v[18:19] op_sel:[0,1] op_sel_hi:[1,1]
    v_pk_fma_f32 v[210:211], v[210:211], v[64:65], v[26:27] op_sel:[0,1,0] op_sel_hi:[1,1,1]
    v_lshlrev_b32 v28, 16, v106
    v_and_b32 v29, s59, v106
    v_pk_mul_f32 v[28:29], v[28:29], v[18:19] op_sel:[0,1] op_sel_hi:[1,1]
    v_pk_fma_f32 v[212:213], v[212:213], v[64:65], v[28:29] op_sel:[0,1,0] op_sel_hi:[1,1,1]
    v_lshlrev_b32 v30, 16, v107
    v_and_b32 v31, s59, v107
    v_pk_mul_f32 v[30:31], v[30:31], v[18:19] op_sel:[0,1] op_sel_hi:[1,1]
    v_pk_fma_f32 v[214:215], v[214:215], v[64:65], v[30:31] op_sel:[0,1,0] op_sel_hi:[1,1,1]
    v_cvt_pk_bf16_f32 v208, v208, v209
    v_cvt_pk_bf16_f32 v209, v210, v211
    v_cvt_pk_bf16_f32 v210, v212, v213
    v_cvt_pk_bf16_f32 v211, v214, v215
    v_lshlrev_b32 v24, 16, v108
    v_and_b32 v25, s59, v108
    v_pk_mul_f32 v[24:25], v[24:25], v[18:19] op_sel:[0,1] op_sel_hi:[1,1]
    v_pk_fma_f32 v[216:217], v[216:217], v[64:65], v[24:25] op_sel:[0,1,0] op_sel_hi:[1,1,1]
    v_lshlrev_b32 v26, 16, v109
    v_and_b32 v27, s59, v109
    v_pk_mul_f32 v[26:27], v[26:27], v[18:19] op_sel:[0,1] op_sel_hi:[1,1]
    v_pk_fma_f32 v[218:219], v[218:219], v[64:65], v[26:27] op_sel:[0,1,0] op_sel_hi:[1,1,1]
    v_lshlrev_b32 v28, 16, v110
    v_and_b32 v29, s59, v110
    v_pk_mul_f32 v[28:29], v[28:29], v[18:19] op_sel:[0,1] op_sel_hi:[1,1]
    v_pk_fma_f32 v[220:221], v[220:221], v[64:65], v[28:29] op_sel:[0,1,0] op_sel_hi:[1,1,1]
    v_lshlrev_b32 v30, 16, v111
    v_and_b32 v31, s59, v111
    v_pk_mul_f32 v[30:31], v[30:31], v[18:19] op_sel:[0,1] op_sel_hi:[1,1]
    v_pk_fma_f32 v[222:223], v[222:223], v[64:65], v[30:31] op_sel:[0,1,0] op_sel_hi:[1,1,1]
    v_cvt_pk_bf16_f32 v216, v216, v217
    v_cvt_pk_bf16_f32 v217, v218, v219
    v_cvt_pk_bf16_f32 v218, v220, v221
    v_cvt_pk_bf16_f32 v219, v222, v223
    v_lshlrev_b32 v24, 16, v112
    v_and_b32 v25, s59, v112
    v_pk_mul_f32 v[24:25], v[24:25], v[18:19] op_sel:[0,1] op_sel_hi:[1,1]
    v_pk_fma_f32 v[224:225], v[224:225], v[64:65], v[24:25] op_sel:[0,1,0] op_sel_hi:[1,1,1]
    v_lshlrev_b32 v26, 16, v113
    v_and_b32 v27, s59, v113
    v_pk_mul_f32 v[26:27], v[26:27], v[18:19] op_sel:[0,1] op_sel_hi:[1,1]
    v_pk_fma_f32 v[226:227], v[226:227], v[64:65], v[26:27] op_sel:[0,1,0] op_sel_hi:[1,1,1]
    v_lshlrev_b32 v28, 16, v114
    v_and_b32 v29, s59, v114
    v_pk_mul_f32 v[28:29], v[28:29], v[18:19] op_sel:[0,1] op_sel_hi:[1,1]
    v_pk_fma_f32 v[228:229], v[228:229], v[64:65], v[28:29] op_sel:[0,1,0] op_sel_hi:[1,1,1]
    v_lshlrev_b32 v30, 16, v115
    v_and_b32 v31, s59, v115
    v_pk_mul_f32 v[30:31], v[30:31], v[18:19] op_sel:[0,1] op_sel_hi:[1,1]
    v_pk_fma_f32 v[230:231], v[230:231], v[64:65], v[30:31] op_sel:[0,1,0] op_sel_hi:[1,1,1]
    v_cvt_pk_bf16_f32 v224, v224, v225
    v_cvt_pk_bf16_f32 v225, v226, v227
    v_cvt_pk_bf16_f32 v226, v228, v229
    v_cvt_pk_bf16_f32 v227, v230, v231
    v_lshlrev_b32 v24, 16, v116
    v_and_b32 v25, s59, v116
    v_pk_mul_f32 v[24:25], v[24:25], v[18:19] op_sel:[0,1] op_sel_hi:[1,1]
    v_pk_fma_f32 v[232:233], v[232:233], v[64:65], v[24:25] op_sel:[0,1,0] op_sel_hi:[1,1,1]
    v_lshlrev_b32 v26, 16, v117
    v_and_b32 v27, s59, v117
    v_pk_mul_f32 v[26:27], v[26:27], v[18:19] op_sel:[0,1] op_sel_hi:[1,1]
    v_pk_fma_f32 v[234:235], v[234:235], v[64:65], v[26:27] op_sel:[0,1,0] op_sel_hi:[1,1,1]
    v_lshlrev_b32 v28, 16, v118
    v_and_b32 v29, s59, v118
    v_pk_mul_f32 v[28:29], v[28:29], v[18:19] op_sel:[0,1] op_sel_hi:[1,1]
    v_pk_fma_f32 v[236:237], v[236:237], v[64:65], v[28:29] op_sel:[0,1,0] op_sel_hi:[1,1,1]
    v_lshlrev_b32 v30, 16, v119
    v_and_b32 v31, s59, v119
    v_pk_mul_f32 v[30:31], v[30:31], v[18:19] op_sel:[0,1] op_sel_hi:[1,1]
    v_pk_fma_f32 v[238:239], v[238:239], v[64:65], v[30:31] op_sel:[0,1,0] op_sel_hi:[1,1,1]
    v_cvt_pk_bf16_f32 v232, v232, v233
    v_cvt_pk_bf16_f32 v233, v234, v235
    v_cvt_pk_bf16_f32 v234, v236, v237
    v_cvt_pk_bf16_f32 v235, v238, v239
    v_lshlrev_b32 v24, 16, v120
    v_and_b32 v25, s59, v120
    v_pk_mul_f32 v[24:25], v[24:25], v[18:19] op_sel:[0,1] op_sel_hi:[1,1]
    v_pk_fma_f32 v[240:241], v[240:241], v[64:65], v[24:25] op_sel:[0,1,0] op_sel_hi:[1,1,1]
    v_lshlrev_b32 v26, 16, v121
    v_and_b32 v27, s59, v121
    v_pk_mul_f32 v[26:27], v[26:27], v[18:19] op_sel:[0,1] op_sel_hi:[1,1]
    v_pk_fma_f32 v[242:243], v[242:243], v[64:65], v[26:27] op_sel:[0,1,0] op_sel_hi:[1,1,1]
    v_lshlrev_b32 v28, 16, v122
    v_and_b32 v29, s59, v122
    v_pk_mul_f32 v[28:29], v[28:29], v[18:19] op_sel:[0,1] op_sel_hi:[1,1]
    v_pk_fma_f32 v[244:245], v[244:245], v[64:65], v[28:29] op_sel:[0,1,0] op_sel_hi:[1,1,1]
    v_lshlrev_b32 v30, 16, v123
    v_and_b32 v31, s59, v123
    v_pk_mul_f32 v[30:31], v[30:31], v[18:19] op_sel:[0,1] op_sel_hi:[1,1]
    v_pk_fma_f32 v[246:247], v[246:247], v[64:65], v[30:31] op_sel:[0,1,0] op_sel_hi:[1,1,1]
    v_cvt_pk_bf16_f32 v240, v240, v241
    v_cvt_pk_bf16_f32 v241, v242, v243
    v_cvt_pk_bf16_f32 v242, v244, v245
    v_cvt_pk_bf16_f32 v243, v246, v247
    v_lshlrev_b32 v24, 16, v124
    v_and_b32 v25, s59, v124
    v_pk_mul_f32 v[24:25], v[24:25], v[18:19] op_sel:[0,1] op_sel_hi:[1,1]
    v_pk_fma_f32 v[248:249], v[248:249], v[64:65], v[24:25] op_sel:[0,1,0] op_sel_hi:[1,1,1]
    v_lshlrev_b32 v26, 16, v125
    v_and_b32 v27, s59, v125
    v_pk_mul_f32 v[26:27], v[26:27], v[18:19] op_sel:[0,1] op_sel_hi:[1,1]
    v_pk_fma_f32 v[250:251], v[250:251], v[64:65], v[26:27] op_sel:[0,1,0] op_sel_hi:[1,1,1]
    v_lshlrev_b32 v28, 16, v126
    v_and_b32 v29, s59, v126
    v_pk_mul_f32 v[28:29], v[28:29], v[18:19] op_sel:[0,1] op_sel_hi:[1,1]
    v_pk_fma_f32 v[252:253], v[252:253], v[64:65], v[28:29] op_sel:[0,1,0] op_sel_hi:[1,1,1]
    v_lshlrev_b32 v30, 16, v127
    v_and_b32 v31, s59, v127
    v_pk_mul_f32 v[30:31], v[30:31], v[18:19] op_sel:[0,1] op_sel_hi:[1,1]
    v_pk_fma_f32 v[254:255], v[254:255], v[64:65], v[30:31] op_sel:[0,1,0] op_sel_hi:[1,1,1]
    v_cvt_pk_bf16_f32 v248, v248, v249
    v_cvt_pk_bf16_f32 v249, v250, v251
    v_cvt_pk_bf16_f32 v250, v252, v253
    v_cvt_pk_bf16_f32 v251, v254, v255
    s_branch L_nopo
L_store:
    s_nop 5
    v_pk_mul_f32 v[128:129], v[128:129], v[64:65] op_sel:[0,0] op_sel_hi:[1,0]
    v_pk_mul_f32 v[130:131], v[130:131], v[64:65] op_sel:[0,0] op_sel_hi:[1,0]
    v_pk_mul_f32 v[132:133], v[132:133], v[64:65] op_sel:[0,0] op_sel_hi:[1,0]
    v_pk_mul_f32 v[134:135], v[134:135], v[64:65] op_sel:[0,0] op_sel_hi:[1,0]
    v_cvt_pk_bf16_f32 v128, v128, v129
    v_cvt_pk_bf16_f32 v129, v130, v131
    v_cvt_pk_bf16_f32 v130, v132, v133
    v_cvt_pk_bf16_f32 v131, v134, v135
    v_pk_mul_f32 v[136:137], v[136:137], v[64:65] op_sel:[0,0] op_sel_hi:[1,0]
    v_pk_mul_f32 v[138:139], v[138:139], v[64:65] op_sel:[0,0] op_sel_hi:[1,0]
    v_pk_mul_f32 v[140:141], v[140:141], v[64:65] op_sel:[0,0] op_sel_hi:[1,0]
    v_pk_mul_f32 v[142:143], v[142:143], v[64:65] op_sel:[0,0] op_sel_hi:[1,0]
    v_cvt_pk_bf16_f32 v136, v136, v137
    v_cvt_pk_bf16_f32 v137, v138, v139
    v_cvt_pk_bf16_f32 v138, v140, v141
    v_cvt_pk_bf16_f32 v139, v142, v143
    v_pk_mul_f32 v[144:145], v[144:145], v[64:65] op_sel:[0,0] op_sel_hi:[1,0]
    v_pk_mul_f32 v[146:147], v[146:147], v[64:65] op_sel:[0,0] op_sel_hi:[1,0]
    v_pk_mul_f32 v[148:149], v[148:149], v[64:65] op_sel:[0,0] op_sel_hi:[1,0]
    v_pk_mul_f32 v[150:151], v[150:151], v[64:65] op_sel:[0,0] op_sel_hi:[1,0]
    v_cvt_pk_bf16_f32 v144, v144, v145
    v_cvt_pk_bf16_f32 v145, v146, v147
    v_cvt_pk_bf16_f32 v146, v148, v149
    v_cvt_pk_bf16_f32 v147, v150, v151
    v_pk_mul_f32 v[152:153], v[152:153], v[64:65] op_sel:[0,0] op_sel_hi:[1,0]
    v_pk_mul_f32 v[154:155], v[154:155], v[64:65] op_sel:[0,0] op_sel_hi:[1,0]
    v_pk_mul_f32 v[156:157], v[156:157], v[64:65] op_sel:[0,0] op_sel_hi:[1,0]
    v_pk_mul_f32 v[158:159], v[158:159], v[64:65] op_sel:[0,0] op_sel_hi:[1,0]
    v_cvt_pk_bf16_f32 v152, v152, v153
    v_cvt_pk_bf16_f32 v153, v154, v155
    v_cvt_pk_bf16_f32 v154, v156, v157
    v_cvt_pk_bf16_f32 v155, v158, v159
    v_pk_mul_f32 v[160:161], v[160:161], v[64:65] op_sel:[0,0] op_sel_hi:[1,0]
    v_pk_mul_f32 v[162:163], v[162:163], v[64:65] op_sel:[0,0] op_sel_hi:[1,0]
    v_pk_mul_f32 v[164:165], v[164:165], v[64:65] op_sel:[0,0] op_sel_hi:[1,0]
    v_pk_mul_f32 v[166:167], v[166:167], v[64:65] op_sel:[0,0] op_sel_hi:[1,0]
    v_cvt_pk_bf16_f32 v160, v160, v161
    v_cvt_pk_bf16_f32 v161, v162, v163
    v_cvt_pk_bf16_f32 v162, v164, v165
    v_cvt_pk_bf16_f32 v163, v166, v167
    v_pk_mul_f32 v[168:169], v[168:169], v[64:65] op_sel:[0,0] op_sel_hi:[1,0]
    v_pk_mul_f32 v[170:171], v[170:171], v[64:65] op_sel:[0,0] op_sel_hi:[1,0]
    v_pk_mul_f32 v[172:173], v[172:173], v[64:65] op_sel:[0,0] op_sel_hi:[1,0]
    v_pk_mul_f32 v[174:175], v[174:175], v[64:65] op_sel:[0,0] op_sel_hi:[1,0]
    v_cvt_pk_bf16_f32 v168, v168, v169
    v_cvt_pk_bf16_f32 v169, v170, v171
    v_cvt_pk_bf16_f32 v170, v172, v173
    v_cvt_pk_bf16_f32 v171, v174, v175
    v_pk_mul_f32 v[176:177], v[176:177], v[64:65] op_sel:[0,0] op_sel_hi:[1,0]
    v_pk_mul_f32 v[178:179], v[178:179], v[64:65] op_sel:[0,0] op_sel_hi:[1,0]
    v_pk_mul_f32 v[180:181], v[180:181], v[64:65] op_sel:[0,0] op_sel_hi:[1,0]
    v_pk_mul_f32 v[182:183], v[182:183], v[64:65] op_sel:[0,0] op_sel_hi:[1,0]
    v_cvt_pk_bf16_f32 v176, v176, v177
    v_cvt_pk_bf16_f32 v177, v178, v179
    v_cvt_pk_bf16_f32 v178, v180, v181
    v_cvt_pk_bf16_f32 v179, v182, v183
    v_pk_mul_f32 v[184:185], v[184:185], v[64:65] op_sel:[0,0] op_sel_hi:[1,0]
    v_pk_mul_f32 v[186:187], v[186:187], v[64:65] op_sel:[0,0] op_sel_hi:[1,0]
    v_pk_mul_f32 v[188:189], v[188:189], v[64:65] op_sel:[0,0] op_sel_hi:[1,0]
    v_pk_mul_f32 v[190:191], v[190:191], v[64:65] op_sel:[0,0] op_sel_hi:[1,0]
    v_cvt_pk_bf16_f32 v184, v184, v185
    v_cvt_pk_bf16_f32 v185, v186, v187
    v_cvt_pk_bf16_f32 v186, v188, v189
    v_cvt_pk_bf16_f32 v187, v190, v191
    v_pk_mul_f32 v[192:193], v[192:193], v[64:65] op_sel:[0,1] op_sel_hi:[1,1]
    v_pk_mul_f32 v[194:195], v[194:195], v[64:65] op_sel:[0,1] op_sel_hi:[1,1]
    v_pk_mul_f32 v[196:197], v[196:197], v[64:65] op_sel:[0,1] op_sel_hi:[1,1]
    v_pk_mul_f32 v[198:199], v[198:199], v[64:65] op_sel:[0,1] op_sel_hi:[1,1]
    v_cvt_pk_bf16_f32 v192, v192, v193
    v_cvt_pk_bf16_f32 v193, v194, v195
    v_cvt_pk_bf16_f32 v194, v196, v197
    v_cvt_pk_bf16_f32 v195, v198, v199
    v_pk_mul_f32 v[200:201], v[200:201], v[64:65] op_sel:[0,1] op_sel_hi:[1,1]
    v_pk_mul_f32 v[202:203], v[202:203], v[64:65] op_sel:[0,1] op_sel_hi:[1,1]
    v_pk_mul_f32 v[204:205], v[204:205], v[64:65] op_sel:[0,1] op_sel_hi:[1,1]
    v_pk_mul_f32 v[206:207], v[206:207], v[64:65] op_sel:[0,1] op_sel_hi:[1,1]
    v_cvt_pk_bf16_f32 v200, v200, v201
    v_cvt_pk_bf16_f32 v201, v202, v203
    v_cvt_pk_bf16_f32 v202, v204, v205
    v_cvt_pk_bf16_f32 v203, v206, v207
    v_pk_mul_f32 v[208:209], v[208:209], v[64:65] op_sel:[0,1] op_sel_hi:[1,1]
    v_pk_mul_f32 v[210:211], v[210:211], v[64:65] op_sel:[0,1] op_sel_hi:[1,1]
    v_pk_mul_f32 v[212:213], v[212:213], v[64:65] op_sel:[0,1] op_sel_hi:[1,1]
    v_pk_mul_f32 v[214:215], v[214:215], v[64:65] op_sel:[0,1] op_sel_hi:[1,1]
    v_cvt_pk_bf16_f32 v208, v208, v209
    v_cvt_pk_bf16_f32 v209, v210, v211
    v_cvt_pk_bf16_f32 v210, v212, v213
    v_cvt_pk_bf16_f32 v211, v214, v215
    v_pk_mul_f32 v[216:217], v[216:217], v[64:65] op_sel:[0,1] op_sel_hi:[1,1]
    v_pk_mul_f32 v[218:219], v[218:219], v[64:65] op_sel:[0,1] op_sel_hi:[1,1]
    v_pk_mul_f32 v[220:221], v[220:221], v[64:65] op_sel:[0,1] op_sel_hi:[1,1]
    v_pk_mul_f32 v[222:223], v[222:223], v[64:65] op_sel:[0,1] op_sel_hi:[1,1]
    v_cvt_pk_bf16_f32 v216, v216, v217
    v_cvt_pk_bf16_f32 v217, v218, v219
    v_cvt_pk_bf16_f32 v218, v220, v221
    v_cvt_pk_bf16_f32 v219, v222, v223
    v_pk_mul_f32 v[224:225], v[224:225], v[64:65] op_sel:[0,1] op_sel_hi:[1,1]
    v_pk_mul_f32 v[226:227], v[226:227], v[64:65] op_sel:[0,1] op_sel_hi:[1,1]
    v_pk_mul_f32 v[228:229], v[228:229], v[64:65] op_sel:[0,1] op_sel_hi:[1,1]
    v_pk_mul_f32 v[230:231], v[230:231], v[64:65] op_sel:[0,1] op_sel_hi:[1,1]
    v_cvt_pk_bf16_f32 v224, v224, v225
    v_cvt_pk_bf16_f32 v225, v226, v227
    v_cvt_pk_bf16_f32 v226, v228, v229
    v_cvt_pk_bf16_f32 v227, v230, v231
    v_pk_mul_f32 v[232:233], v[232:233], v[64:65] op_sel:[0,1] op_sel_hi:[1,1]
    v_pk_mul_f32 v[234:235], v[234:235], v[64:65] op_sel:[0,1] op_sel_hi:[1,1]
    v_pk_mul_f32 v[236:237], v[236:237], v[64:65] op_sel:[0,1] op_sel_hi:[1,1]
    v_pk_mul_f32 v[238:239], v[238:239], v[64:65] op_sel:[0,1] op_sel_hi:[1,1]
    v_cvt_pk_bf16_f32 v232, v232, v233
    v_cvt_pk_bf16_f32 v233, v234, v235
    v_cvt_pk_bf16_f32 v234, v236, v237
    v_cvt_pk_bf16_f32 v235, v238, v239
    v_pk_mul_f32 v[240:241], v[240:241], v[64:65] op_sel:[0,1] op_sel_hi:[1,1]
    v_pk_mul_f32 v[242:243], v[242:243], v[64:65] op_sel:[0,1] op_sel_hi:[1,1]
    v_pk_mul_f32 v[244:245], v[244:245], v[64:65] op_sel:[0,1] op_sel_hi:[1,1]
    v_pk_mul_f32 v[246:247], v[246:247], v[64:65] op_sel:[0,1] op_sel_hi:[1,1]
    v_cvt_pk_bf16_f32 v240, v240, v241
    v_cvt_pk_bf16_f32 v241, v242, v243
    v_cvt_pk_bf16_f32 v242, v244, v245
    v_cvt_pk_bf16_f32 v243, v246, v247
    v_pk_mul_f32 v[248:249], v[248:249], v[64:65] op_sel:[0,1] op_sel_hi:[1,1]
    v_pk_mul_f32 v[250:251], v[250:251], v[64:65] op_sel:[0,1] op_sel_hi:[1,1]
    v_pk_mul_f32 v[252:253], v[252:253], v[64:65] op_sel:[0,1] op_sel_hi:[1,1]
    v_pk_mul_f32 v[254:255], v[254:255], v[64:65] op_sel:[0,1] op_sel_hi:[1,1]
    v_cvt_pk_bf16_f32 v248, v248, v249
    v_cvt_pk_bf16_f32 v249, v250, v251
    v_cvt_pk_bf16_f32 v250, v252, v253
    v_cvt_pk_bf16_f32 v251, v254, v255
L_nopo:
    s_mov_b32 s59, 2.0
    s_waitcnt vmcnt(0)
L_attdone:
    v_lshrrev_b32 v8, 2, v0
    v_lshlrev_b32 v4, 7, v8
    v_bfe_u32 v8, v8, 1, 2
    v_lshl_add_u32 v4, v8, 5, v4
    v_and_b32 v8, 3, v0
    v_lshl_add_u32 v4, v8, 3, v4
    v_xor_b32 v5, 32, v4
    v_xor_b32 v6, 64, v4
    v_xor_b32 v7, 96, v4
    s_barrier
    ds_read_b64_tr_b16 a[0:1], v4 offset:0
    ds_read_b64_tr_b16 a[2:3], v4 offset:2048
    ds_read_b64_tr_b16 a[4:5], v4 offset:4096
    ds_read_b64_tr_b16 a[6:7], v4 offset:6144
    ds_read_b64_tr_b16 a[8:9], v4 offset:8192
    ds_read_b64_tr_b16 a[10:11], v4 offset:10240
    ds_read_b64_tr_b16 a[12:13], v4 offset:12288
    ds_read_b64_tr_b16 a[14:15], v4 offset:14336
    ds_read_b64_tr_b16 a[16:17], v4 offset:16384
    ds_read_b64_tr_b16 a[18:19], v4 offset:18432
    ds_read_b64_tr_b16 a[20:21], v4 offset:20480
    ds_read_b64_tr_b16 a[22:23], v4 offset:22528
    ds_read_b64_tr_b16 a[24:25], v4 offset:24576
    ds_read_b64_tr_b16 a[26:27], v4 offset:26624
    s_lshl_b32 s34, s95, 2
    s_add_u32 s34, s34, s3
    s_lshl_b32 s34, s34, 12
    s_cmp_eq_u32 s62, 0
    s_cmov_b32 s34, 2.0
    s_add_u32 s35, s34, 85983232
    s_mul_i32 s33, s3, 8736
    s_add_u32 s33, s33, 0x10000
    s_mov_b32 s4, s72
    s_mov_b32 s5, s73
    s_mov_b32 s6, 1835008
    s_mov_b32 s7, 0x20000
    v_lshrrev_b32 v10, 1, v0
    v_lshlrev_b32 v10, 7, v10
    v_and_b32 v11, 1, v0
    v_lshl_add_u32 v10, v11, 4, v10
    v_and_b32 v11, 31, v0
    v_lshl_add_u32 v11, v11, 2, s33
    v_and_b32 v12, 7, v0
    v_lshl_add_u32 v12, v12, 2, s33
    v_mov_b32 v13, 0
    v_accvgpr_read_b32 v9, a245
    s_lshl_b32 s48, s63, 3
    s_add_u32 s48, s48, s3
    s_mul_i32 s48, s48, 229376
    s_lshl_b32 s58, s26, 10
    s_add_u32 s48, s48, s58
    s_add_u32 s48, s48, 117440512
    s_waitcnt lgkmcnt(7)
    v_mfma_f32_16x16x32_bf16 v[32:35], a[0:3], v[128:131], 0
    s_add_u32 m0, s29, 131072
    ds_read_b64_tr_b16 a[28:29], v4 offset:28672
    v_mfma_f32_16x16x32_bf16 v[32:35], a[4:7], v[136:139], v[32:35]
    ds_read_b64_tr_b16 a[30:31], v4 offset:30720
    buffer_load_dwordx4 v2, s[16:19], s40 offen lds
    v_mfma_f32_16x16x32_bf16 v[32:35], a[8:11], v[144:147], v[32:35]
    s_waitcnt lgkmcnt(4)
    ds_read_b64_tr_b16 a[32:33], v5 offset:0
    v_mfma_f32_16x16x32_bf16 v[32:35], a[12:15], v[152:155], v[32:35]
    ds_read_b64_tr_b16 a[34:35], v5 offset:2048
    v_mfma_f32_16x16x32_bf16 v[32:35], a[16:19], v[160:163], v[32:35]
    s_add_u32 m0, s29, 135168
    ds_read_b64_tr_b16 a[36:37], v5 offset:4096
    v_mfma_f32_16x16x32_bf16 v[32:35], a[20:23], v[168:171], v[32:35]
    s_waitcnt lgkmcnt(3)
    ds_read_b64_tr_b16 a[38:39], v5 offset:6144
    v_mfma_f32_16x16x32_bf16 v[32:35], a[24:27], v[176:179], v[32:35]
    ds_read_b64_tr_b16 a[40:41], v5 offset:8192
    buffer_load_dwordx4 v2, s[16:19], s41 offen lds
    v_mfma_f32_16x16x32_bf16 v[32:35], a[28:31], v[184:187], v[32:35]
    s_waitcnt vmcnt(2)
    ds_read_b64_tr_b16 a[42:43], v5 offset:10240
    v_mfma_f32_16x16x32_bf16 v[40:43], a[0:3], v[192:195], 0
    s_barrier
    ds_read_b64_tr_b16 a[44:45], v5 offset:12288
    v_mfma_f32_16x16x32_bf16 v[40:43], a[4:7], v[200:203], v[40:43]
    ds_read_b64_tr_b16 a[46:47], v5 offset:14336
    buffer_store_dword v9, v9, s[12:15], s59 offen sc1
    v_mfma_f32_16x16x32_bf16 v[40:43], a[8:11], v[208:211], v[40:43]
    s_add_u32 m0, s29, 139264
    ds_read_b64_tr_b16 a[48:49], v5 offset:16384
    v_mfma_f32_16x16x32_bf16 v[40:43], a[12:15], v[216:219], v[40:43]
    ds_read_b64_tr_b16 a[50:51], v5 offset:18432
    buffer_load_dwordx4 v2, s[16:19], s42 offen lds
    v_mfma_f32_16x16x32_bf16 v[40:43], a[16:19], v[224:227], v[40:43]
    ds_read_b64_tr_b16 a[52:53], v5 offset:20480
    v_mfma_f32_16x16x32_bf16 v[40:43], a[20:23], v[232:235], v[40:43]
    ds_read_b64_tr_b16 a[54:55], v5 offset:22528
    v_mfma_f32_16x16x32_bf16 v[40:43], a[24:27], v[240:243], v[40:43]
    s_add_u32 m0, s29, 143360
    ds_read_b64_tr_b16 a[56:57], v5 offset:24576
    v_mfma_f32_16x16x32_bf16 v[40:43], a[28:31], v[248:251], v[40:43]
    s_waitcnt lgkmcnt(7)
    ds_read_b64_tr_b16 a[58:59], v5 offset:26624
    v_mfma_f32_16x16x32_bf16 v[36:39], a[32:35], v[128:131], 0
    ds_read_b64_tr_b16 a[60:61], v5 offset:28672
    buffer_load_dwordx4 v2, s[16:19], s43 offen lds
    v_mfma_f32_16x16x32_bf16 v[36:39], a[36:39], v[136:139], v[36:39]
    ds_read_b64_tr_b16 a[62:63], v5 offset:30720
    v_mfma_f32_16x16x32_bf16 v[36:39], a[40:43], v[144:147], v[36:39]
    s_waitcnt lgkmcnt(4)
    ds_read_b64_tr_b16 a[0:1], v6 offset:0
    v_mfma_f32_16x16x32_bf16 v[36:39], a[44:47], v[152:155], v[36:39]
    ds_read_b64_tr_b16 a[2:3], v6 offset:2048
    v_mfma_f32_16x16x32_bf16 v[36:39], a[48:51], v[160:163], v[36:39]
    s_add_u32 m0, s29, 147456
    ds_read_b64_tr_b16 a[4:5], v6 offset:4096
    v_mfma_f32_16x16x32_bf16 v[36:39], a[52:55], v[168:171], v[36:39]
    s_waitcnt lgkmcnt(3)
    ds_read_b64_tr_b16 a[6:7], v6 offset:6144
    buffer_load_dwordx4 v2, s[16:19], s44 offen lds
    v_mfma_f32_16x16x32_bf16 v[36:39], a[56:59], v[176:179], v[36:39]
    ds_read_b64_tr_b16 a[8:9], v6 offset:8192
    v_mfma_f32_16x16x32_bf16 v[36:39], a[60:63], v[184:187], v[36:39]
    ds_read_b64_tr_b16 a[10:11], v6 offset:10240
    v_mfma_f32_16x16x32_bf16 v[44:47], a[32:35], v[192:195], 0
    ds_read_b64_tr_b16 a[12:13], v6 offset:12288
    v_mfma_f32_16x16x32_bf16 v[44:47], a[36:39], v[200:203], v[44:47]
    s_add_u32 m0, s29, 151552
    ds_read_b64_tr_b16 a[14:15], v6 offset:14336
    v_mfma_f32_16x16x32_bf16 v[44:47], a[40:43], v[208:211], v[44:47]
    ds_read_b64_tr_b16 a[16:17], v6 offset:16384
    buffer_load_dwordx4 v2, s[16:19], s45 offen lds
    v_mfma_f32_16x16x32_bf16 v[44:47], a[44:47], v[216:219], v[44:47]
    ds_read_b64_tr_b16 a[18:19], v6 offset:18432
    v_mfma_f32_16x16x32_bf16 v[44:47], a[48:51], v[224:227], v[44:47]
    ds_read_b64_tr_b16 a[20:21], v6 offset:20480
    v_cvt_pk_bf16_f32 v32, v32, v33
    v_mfma_f32_16x16x32_bf16 v[44:47], a[52:55], v[232:235], v[44:47]
    ds_read_b64_tr_b16 a[22:23], v6 offset:22528
    v_cvt_pk_bf16_f32 v33, v34, v35
    v_mfma_f32_16x16x32_bf16 v[44:47], a[56:59], v[240:243], v[44:47]
    s_add_u32 s58, s48, 0
    ds_read_b64_tr_b16 a[24:25], v6 offset:24576
    v_cvt_pk_bf16_f32 v34, v36, v37
    v_mfma_f32_16x16x32_bf16 v[44:47], a[60:63], v[248:251], v[44:47]
    s_waitcnt lgkmcnt(7)
    ds_read_b64_tr_b16 a[26:27], v6 offset:26624
    v_cvt_pk_bf16_f32 v35, v38, v39
    v_mfma_f32_16x16x32_bf16 v[48:51], a[0:3], v[128:131], 0
    ds_read_b64_tr_b16 a[28:29], v6 offset:28672
    buffer_store_dwordx4 v[32:35], v1, s[12:15], s58 offen sc1
    v_mfma_f32_16x16x32_bf16 v[48:51], a[4:7], v[136:139], v[48:51]
    s_add_u32 m0, s29, 155648
    ds_read_b64_tr_b16 a[30:31], v6 offset:30720
    v_mfma_f32_16x16x32_bf16 v[48:51], a[8:11], v[144:147], v[48:51]
    s_waitcnt lgkmcnt(4)
    ds_read_b64_tr_b16 a[32:33], v7 offset:0
    buffer_load_dwordx4 v2, s[16:19], s46 offen lds
    v_mfma_f32_16x16x32_bf16 v[48:51], a[12:15], v[152:155], v[48:51]
    ds_read_b64_tr_b16 a[34:35], v7 offset:2048
    v_mfma_f32_16x16x32_bf16 v[48:51], a[16:19], v[160:163], v[48:51]
    ds_read_b64_tr_b16 a[36:37], v7 offset:4096
    v_cvt_pk_bf16_f32 v40, v40, v41
    v_mfma_f32_16x16x32_bf16 v[48:51], a[20:23], v[168:171], v[48:51]
    s_waitcnt lgkmcnt(3)
    ds_read_b64_tr_b16 a[38:39], v7 offset:6144
    v_cvt_pk_bf16_f32 v41, v42, v43
    v_mfma_f32_16x16x32_bf16 v[48:51], a[24:27], v[176:179], v[48:51]
    ds_read_b64_tr_b16 a[40:41], v7 offset:8192
    v_cvt_pk_bf16_f32 v42, v44, v45
    v_mfma_f32_16x16x32_bf16 v[48:51], a[28:31], v[184:187], v[48:51]
    s_add_u32 s58, s48, 917504
    ds_read_b64_tr_b16 a[42:43], v7 offset:10240
    v_cvt_pk_bf16_f32 v43, v46, v47
    v_mfma_f32_16x16x32_bf16 v[56:59], a[0:3], v[192:195], 0
    ds_read_b64_tr_b16 a[44:45], v7 offset:12288
    buffer_store_dwordx4 v[40:43], v1, s[12:15], s58 offen sc1
    v_mfma_f32_16x16x32_bf16 v[56:59], a[4:7], v[200:203], v[56:59]
    s_add_u32 m0, s29, 159744
    ds_read_b64_tr_b16 a[46:47], v7 offset:14336
    v_mfma_f32_16x16x32_bf16 v[56:59], a[8:11], v[208:211], v[56:59]
    ds_read_b64_tr_b16 a[48:49], v7 offset:16384
    buffer_load_dwordx4 v2, s[16:19], s47 offen lds
    v_mfma_f32_16x16x32_bf16 v[56:59], a[12:15], v[216:219], v[56:59]
    ds_read_b64_tr_b16 a[50:51], v7 offset:18432
    v_add_u32 v2, 128, v2
    v_mfma_f32_16x16x32_bf16 v[56:59], a[16:19], v[224:227], v[56:59]
    ds_read_b64_tr_b16 a[52:53], v7 offset:20480
    v_mfma_f32_16x16x32_bf16 v[56:59], a[20:23], v[232:235], v[56:59]
    ds_read_b64_tr_b16 a[54:55], v7 offset:22528
    v_mfma_f32_16x16x32_bf16 v[56:59], a[24:27], v[240:243], v[56:59]
    s_add_u32 m0, s29, 65536
    ds_read_b64_tr_b16 a[56:57], v7 offset:24576
    v_mfma_f32_16x16x32_bf16 v[56:59], a[28:31], v[248:251], v[56:59]
    s_waitcnt lgkmcnt(7)
    ds_read_b64_tr_b16 a[58:59], v7 offset:26624
    buffer_load_dwordx4 v2, s[16:19], s40 offen lds
    v_mfma_f32_16x16x32_bf16 v[52:55], a[32:35], v[128:131], 0
    ds_read_b64_tr_b16 a[60:61], v7 offset:28672
    v_mfma_f32_16x16x32_bf16 v[52:55], a[36:39], v[136:139], v[52:55]
    ds_read_b64_tr_b16 a[62:63], v7 offset:30720
    v_mfma_f32_16x16x32_bf16 v[52:55], a[40:43], v[144:147], v[52:55]
    s_waitcnt lgkmcnt(4)
    ds_read_b64_tr_b16 a[0:1], v4 offset:32768
    v_mfma_f32_16x16x32_bf16 v[52:55], a[44:47], v[152:155], v[52:55]
    s_add_u32 m0, s29, 69632
    ds_read_b64_tr_b16 a[2:3], v4 offset:34816
    v_mfma_f32_16x16x32_bf16 v[52:55], a[48:51], v[160:163], v[52:55]
    ds_read_b64_tr_b16 a[4:5], v4 offset:36864
    buffer_load_dwordx4 v2, s[16:19], s41 offen lds
    v_mfma_f32_16x16x32_bf16 v[52:55], a[52:55], v[168:171], v[52:55]
    s_waitcnt lgkmcnt(3)
    ds_read_b64_tr_b16 a[6:7], v4 offset:38912
    v_mfma_f32_16x16x32_bf16 v[52:55], a[56:59], v[176:179], v[52:55]
    ds_read_b64_tr_b16 a[8:9], v4 offset:40960
    v_mfma_f32_16x16x32_bf16 v[52:55], a[60:63], v[184:187], v[52:55]
    ds_read_b64_tr_b16 a[10:11], v4 offset:43008
    v_mfma_f32_16x16x32_bf16 v[60:63], a[32:35], v[192:195], 0
    s_add_u32 m0, s29, 73728
    ds_read_b64_tr_b16 a[12:13], v4 offset:45056
    v_mfma_f32_16x16x32_bf16 v[60:63], a[36:39], v[200:203], v[60:63]
    ds_read_b64_tr_b16 a[14:15], v4 offset:47104
    buffer_load_dwordx4 v2, s[16:19], s42 offen lds
    v_mfma_f32_16x16x32_bf16 v[60:63], a[40:43], v[208:211], v[60:63]
    ds_read_b64_tr_b16 a[16:17], v4 offset:49152
    v_mfma_f32_16x16x32_bf16 v[60:63], a[44:47], v[216:219], v[60:63]
    ds_read_b64_tr_b16 a[18:19], v4 offset:51200
    v_mfma_f32_16x16x32_bf16 v[60:63], a[48:51], v[224:227], v[60:63]
    ds_read_b64_tr_b16 a[20:21], v4 offset:53248
    v_cvt_pk_bf16_f32 v48, v48, v49
    v_mfma_f32_16x16x32_bf16 v[60:63], a[52:55], v[232:235], v[60:63]
    ds_read_b64_tr_b16 a[22:23], v4 offset:55296
    v_cvt_pk_bf16_f32 v49, v50, v51
    v_mfma_f32_16x16x32_bf16 v[60:63], a[56:59], v[240:243], v[60:63]
    s_add_u32 s58, s48, 16384
    ds_read_b64_tr_b16 a[24:25], v4 offset:57344
    v_cvt_pk_bf16_f32 v50, v52, v53
    v_mfma_f32_16x16x32_bf16 v[60:63], a[60:63], v[248:251], v[60:63]
    s_waitcnt lgkmcnt(7)
    ds_read_b64_tr_b16 a[26:27], v4 offset:59392
    v_cvt_pk_bf16_f32 v51, v54, v55
    v_mfma_f32_16x16x32_bf16 v[32:35], a[0:3], v[128:131], 0
    ds_read_b64_tr_b16 a[28:29], v4 offset:61440
    buffer_store_dwordx4 v[48:51], v1, s[12:15], s58 offen sc1
    v_mfma_f32_16x16x32_bf16 v[32:35], a[4:7], v[136:139], v[32:35]
    s_add_u32 m0, s29, 77824
    ds_read_b64_tr_b16 a[30:31], v4 offset:63488
    v_mfma_f32_16x16x32_bf16 v[32:35], a[8:11], v[144:147], v[32:35]
    s_waitcnt lgkmcnt(4)
    ds_read_b64_tr_b16 a[32:33], v5 offset:32768
    buffer_load_dwordx4 v2, s[16:19], s43 offen lds
    v_mfma_f32_16x16x32_bf16 v[32:35], a[12:15], v[152:155], v[32:35]
    ds_read_b64_tr_b16 a[34:35], v5 offset:34816
    v_mfma_f32_16x16x32_bf16 v[32:35], a[16:19], v[160:163], v[32:35]
    ds_read_b64_tr_b16 a[36:37], v5 offset:36864
    v_cvt_pk_bf16_f32 v56, v56, v57
    v_mfma_f32_16x16x32_bf16 v[32:35], a[20:23], v[168:171], v[32:35]
    s_waitcnt lgkmcnt(3)
    ds_read_b64_tr_b16 a[38:39], v5 offset:38912
    v_cvt_pk_bf16_f32 v57, v58, v59
    v_mfma_f32_16x16x32_bf16 v[32:35], a[24:27], v[176:179], v[32:35]
    ds_read_b64_tr_b16 a[40:41], v5 offset:40960
    v_cvt_pk_bf16_f32 v58, v60, v61
    v_mfma_f32_16x16x32_bf16 v[32:35], a[28:31], v[184:187], v[32:35]
    s_add_u32 s58, s48, 933888
    ds_read_b64_tr_b16 a[42:43], v5 offset:43008
    v_cvt_pk_bf16_f32 v59, v62, v63
    v_mfma_f32_16x16x32_bf16 v[40:43], a[0:3], v[192:195], 0
    ds_read_b64_tr_b16 a[44:45], v5 offset:45056
    buffer_store_dwordx4 v[56:59], v1, s[12:15], s58 offen sc1
    v_mfma_f32_16x16x32_bf16 v[40:43], a[4:7], v[200:203], v[40:43]
    s_add_u32 m0, s29, 81920
    ds_read_b64_tr_b16 a[46:47], v5 offset:47104
    v_mfma_f32_16x16x32_bf16 v[40:43], a[8:11], v[208:211], v[40:43]
    ds_read_b64_tr_b16 a[48:49], v5 offset:49152
    buffer_load_dwordx4 v2, s[16:19], s44 offen lds
    v_mfma_f32_16x16x32_bf16 v[40:43], a[12:15], v[216:219], v[40:43]
    ds_read_b64_tr_b16 a[50:51], v5 offset:51200
    v_mfma_f32_16x16x32_bf16 v[40:43], a[16:19], v[224:227], v[40:43]
    ds_read_b64_tr_b16 a[52:53], v5 offset:53248
    v_mfma_f32_16x16x32_bf16 v[40:43], a[20:23], v[232:235], v[40:43]
    ds_read_b64_tr_b16 a[54:55], v5 offset:55296
    v_mfma_f32_16x16x32_bf16 v[40:43], a[24:27], v[240:243], v[40:43]
    s_add_u32 m0, s29, 86016
    ds_read_b64_tr_b16 a[56:57], v5 offset:57344
    v_mfma_f32_16x16x32_bf16 v[40:43], a[28:31], v[248:251], v[40:43]
    s_waitcnt lgkmcnt(7)
    ds_read_b64_tr_b16 a[58:59], v5 offset:59392
    buffer_load_dwordx4 v2, s[16:19], s45 offen lds
    v_mfma_f32_16x16x32_bf16 v[36:39], a[32:35], v[128:131], 0
    ds_read_b64_tr_b16 a[60:61], v5 offset:61440
    v_mfma_f32_16x16x32_bf16 v[36:39], a[36:39], v[136:139], v[36:39]
    ds_read_b64_tr_b16 a[62:63], v5 offset:63488
    v_mfma_f32_16x16x32_bf16 v[36:39], a[40:43], v[144:147], v[36:39]
    s_waitcnt lgkmcnt(4)
    ds_read_b64_tr_b16 a[0:1], v6 offset:32768
    v_mfma_f32_16x16x32_bf16 v[36:39], a[44:47], v[152:155], v[36:39]
    s_add_u32 m0, s29, 90112
    ds_read_b64_tr_b16 a[2:3], v6 offset:34816
    v_mfma_f32_16x16x32_bf16 v[36:39], a[48:51], v[160:163], v[36:39]
    ds_read_b64_tr_b16 a[4:5], v6 offset:36864
    buffer_load_dwordx4 v2, s[16:19], s46 offen lds
    v_mfma_f32_16x16x32_bf16 v[36:39], a[52:55], v[168:171], v[36:39]
    s_waitcnt lgkmcnt(3)
    ds_read_b64_tr_b16 a[6:7], v6 offset:38912
    v_mfma_f32_16x16x32_bf16 v[36:39], a[56:59], v[176:179], v[36:39]
    ds_read_b64_tr_b16 a[8:9], v6 offset:40960
    v_mfma_f32_16x16x32_bf16 v[36:39], a[60:63], v[184:187], v[36:39]
    ds_read_b64_tr_b16 a[10:11], v6 offset:43008
    v_mfma_f32_16x16x32_bf16 v[44:47], a[32:35], v[192:195], 0
    s_add_u32 m0, s29, 94208
    ds_read_b64_tr_b16 a[12:13], v6 offset:45056
    v_mfma_f32_16x16x32_bf16 v[44:47], a[36:39], v[200:203], v[44:47]
    ds_read_b64_tr_b16 a[14:15], v6 offset:47104
    buffer_load_dwordx4 v2, s[16:19], s47 offen lds
    v_mfma_f32_16x16x32_bf16 v[44:47], a[40:43], v[208:211], v[44:47]
    ds_read_b64_tr_b16 a[16:17], v6 offset:49152
    v_add_u32 v2, 128, v2
    v_mfma_f32_16x16x32_bf16 v[44:47], a[44:47], v[216:219], v[44:47]
    ds_read_b64_tr_b16 a[18:19], v6 offset:51200
    v_mfma_f32_16x16x32_bf16 v[44:47], a[48:51], v[224:227], v[44:47]
    ds_read_b64_tr_b16 a[20:21], v6 offset:53248
    v_cvt_pk_bf16_f32 v32, v32, v33
    v_mfma_f32_16x16x32_bf16 v[44:47], a[52:55], v[232:235], v[44:47]
    ds_read_b64_tr_b16 a[22:23], v6 offset:55296
    v_cvt_pk_bf16_f32 v33, v34, v35
    v_mfma_f32_16x16x32_bf16 v[44:47], a[56:59], v[240:243], v[44:47]
    s_add_u32 s58, s48, 32768
    ds_read_b64_tr_b16 a[24:25], v6 offset:57344
    v_cvt_pk_bf16_f32 v34, v36, v37
    v_mfma_f32_16x16x32_bf16 v[44:47], a[60:63], v[248:251], v[44:47]
    s_waitcnt lgkmcnt(7)
    ds_read_b64_tr_b16 a[26:27], v6 offset:59392
    v_cvt_pk_bf16_f32 v35, v38, v39
    v_mfma_f32_16x16x32_bf16 v[48:51], a[0:3], v[128:131], 0
    ds_read_b64_tr_b16 a[28:29], v6 offset:61440
    buffer_store_dwordx4 v[32:35], v1, s[12:15], s58 offen sc1
    v_mfma_f32_16x16x32_bf16 v[48:51], a[4:7], v[136:139], v[48:51]
    s_add_u32 m0, s29, 98304
    ds_read_b64_tr_b16 a[30:31], v6 offset:63488
    v_mfma_f32_16x16x32_bf16 v[48:51], a[8:11], v[144:147], v[48:51]
    s_waitcnt lgkmcnt(4)
    ds_read_b64_tr_b16 a[32:33], v7 offset:32768
    buffer_load_dwordx4 v2, s[16:19], s40 offen lds
    v_mfma_f32_16x16x32_bf16 v[48:51], a[12:15], v[152:155], v[48:51]
    ds_read_b64_tr_b16 a[34:35], v7 offset:34816
    v_mfma_f32_16x16x32_bf16 v[48:51], a[16:19], v[160:163], v[48:51]
    ds_read_b64_tr_b16 a[36:37], v7 offset:36864
    v_cvt_pk_bf16_f32 v40, v40, v41
    v_mfma_f32_16x16x32_bf16 v[48:51], a[20:23], v[168:171], v[48:51]
    s_waitcnt lgkmcnt(3)
    ds_read_b64_tr_b16 a[38:39], v7 offset:38912
    v_cvt_pk_bf16_f32 v41, v42, v43
    v_mfma_f32_16x16x32_bf16 v[48:51], a[24:27], v[176:179], v[48:51]
    ds_read_b64_tr_b16 a[40:41], v7 offset:40960
    v_cvt_pk_bf16_f32 v42, v44, v45
    v_mfma_f32_16x16x32_bf16 v[48:51], a[28:31], v[184:187], v[48:51]
    s_add_u32 s58, s48, 950272
    ds_read_b64_tr_b16 a[42:43], v7 offset:43008
    v_cvt_pk_bf16_f32 v43, v46, v47
    v_mfma_f32_16x16x32_bf16 v[56:59], a[0:3], v[192:195], 0
    ds_read_b64_tr_b16 a[44:45], v7 offset:45056
    buffer_store_dwordx4 v[40:43], v1, s[12:15], s58 offen sc1
    v_mfma_f32_16x16x32_bf16 v[56:59], a[4:7], v[200:203], v[56:59]
    s_add_u32 m0, s29, 102400
    ds_read_b64_tr_b16 a[46:47], v7 offset:47104
    v_mfma_f32_16x16x32_bf16 v[56:59], a[8:11], v[208:211], v[56:59]
    ds_read_b64_tr_b16 a[48:49], v7 offset:49152
    buffer_load_dwordx4 v2, s[16:19], s41 offen lds
    v_mfma_f32_16x16x32_bf16 v[56:59], a[12:15], v[216:219], v[56:59]
    ds_read_b64_tr_b16 a[50:51], v7 offset:51200
    v_mfma_f32_16x16x32_bf16 v[56:59], a[16:19], v[224:227], v[56:59]
    ds_read_b64_tr_b16 a[52:53], v7 offset:53248
    v_mfma_f32_16x16x32_bf16 v[56:59], a[20:23], v[232:235], v[56:59]
    ds_read_b64_tr_b16 a[54:55], v7 offset:55296
    v_mfma_f32_16x16x32_bf16 v[56:59], a[24:27], v[240:243], v[56:59]
    s_add_u32 m0, s29, 106496
    ds_read_b64_tr_b16 a[56:57], v7 offset:57344
    v_mfma_f32_16x16x32_bf16 v[56:59], a[28:31], v[248:251], v[56:59]
    s_waitcnt lgkmcnt(7)
    ds_read_b64_tr_b16 a[58:59], v7 offset:59392
    buffer_load_dwordx4 v2, s[16:19], s42 offen lds
    v_mfma_f32_16x16x32_bf16 v[52:55], a[32:35], v[128:131], 0
    s_waitcnt vmcnt(15)
    ds_read_b64_tr_b16 a[60:61], v7 offset:61440
    v_mfma_f32_16x16x32_bf16 v[52:55], a[36:39], v[136:139], v[52:55]
    s_barrier
    ds_read_b64_tr_b16 a[62:63], v7 offset:63488
    v_xor_b32 v4, 0x20000, v4
    v_mfma_f32_16x16x32_bf16 v[52:55], a[40:43], v[144:147], v[52:55]
    s_waitcnt lgkmcnt(4)
    ds_read_b64_tr_b16 a[0:1], v4 offset:0
    v_mfma_f32_16x16x32_bf16 v[52:55], a[44:47], v[152:155], v[52:55]
    s_add_u32 m0, s29, 110592
    ds_read_b64_tr_b16 a[2:3], v4 offset:2048
    v_mfma_f32_16x16x32_bf16 v[52:55], a[48:51], v[160:163], v[52:55]
    ds_read_b64_tr_b16 a[4:5], v4 offset:4096
    buffer_load_dwordx4 v2, s[16:19], s43 offen lds
    v_mfma_f32_16x16x32_bf16 v[52:55], a[52:55], v[168:171], v[52:55]
    s_waitcnt lgkmcnt(3)
    ds_read_b64_tr_b16 a[6:7], v4 offset:6144
    v_mfma_f32_16x16x32_bf16 v[52:55], a[56:59], v[176:179], v[52:55]
    ds_read_b64_tr_b16 a[8:9], v4 offset:8192
    v_mfma_f32_16x16x32_bf16 v[52:55], a[60:63], v[184:187], v[52:55]
    ds_read_b64_tr_b16 a[10:11], v4 offset:10240
    v_mfma_f32_16x16x32_bf16 v[60:63], a[32:35], v[192:195], 0
    s_add_u32 m0, s29, 114688
    ds_read_b64_tr_b16 a[12:13], v4 offset:12288
    v_mfma_f32_16x16x32_bf16 v[60:63], a[36:39], v[200:203], v[60:63]
    ds_read_b64_tr_b16 a[14:15], v4 offset:14336
    buffer_load_dwordx4 v2, s[16:19], s44 offen lds
    v_mfma_f32_16x16x32_bf16 v[60:63], a[40:43], v[208:211], v[60:63]
    ds_read_b64_tr_b16 a[16:17], v4 offset:16384
    v_mfma_f32_16x16x32_bf16 v[60:63], a[44:47], v[216:219], v[60:63]
    s_waitcnt lgkmcnt(9)
    ds_read_b64_tr_b16 a[18:19], v4 offset:18432
    v_mfma_f32_16x16x32_bf16 v[60:63], a[48:51], v[224:227], v[60:63]
    s_barrier
    ds_read_b64_tr_b16 a[20:21], v4 offset:20480
    v_cvt_pk_bf16_f32 v48, v48, v49
    v_mfma_f32_16x16x32_bf16 v[60:63], a[52:55], v[232:235], v[60:63]
    ds_read_b64_tr_b16 a[22:23], v4 offset:22528
    v_cvt_pk_bf16_f32 v49, v50, v51
    v_mfma_f32_16x16x32_bf16 v[60:63], a[56:59], v[240:243], v[60:63]
    s_add_u32 s58, s48, 49152
    ds_read_b64_tr_b16 a[24:25], v4 offset:24576
    v_cvt_pk_bf16_f32 v50, v52, v53
    v_mfma_f32_16x16x32_bf16 v[60:63], a[60:63], v[248:251], v[60:63]
    s_waitcnt lgkmcnt(7)
    ds_read_b64_tr_b16 a[26:27], v4 offset:26624
    v_cvt_pk_bf16_f32 v51, v54, v55
    v_mfma_f32_16x16x32_bf16 v[32:35], a[0:3], v[128:131], 0
    ds_read_b64_tr_b16 a[28:29], v4 offset:28672
    buffer_store_dwordx4 v[48:51], v1, s[12:15], s58 offen sc1
    v_mfma_f32_16x16x32_bf16 v[32:35], a[4:7], v[136:139], v[32:35]
    s_add_u32 m0, s29, 118784
    ds_read_b64_tr_b16 a[30:31], v4 offset:30720
    v_xor_b32 v5, 0x20000, v5
    v_mfma_f32_16x16x32_bf16 v[32:35], a[8:11], v[144:147], v[32:35]
    s_waitcnt lgkmcnt(4)
    ds_read_b64_tr_b16 a[32:33], v5 offset:0
    buffer_load_dwordx4 v2, s[16:19], s45 offen lds
    v_mfma_f32_16x16x32_bf16 v[32:35], a[12:15], v[152:155], v[32:35]
    ds_read_b64_tr_b16 a[34:35], v5 offset:2048
    v_mfma_f32_16x16x32_bf16 v[32:35], a[16:19], v[160:163], v[32:35]
    ds_read_b64_tr_b16 a[36:37], v5 offset:4096
    v_cvt_pk_bf16_f32 v56, v56, v57
    v_mfma_f32_16x16x32_bf16 v[32:35], a[20:23], v[168:171], v[32:35]
    s_waitcnt lgkmcnt(3)
    ds_read_b64_tr_b16 a[38:39], v5 offset:6144
    v_cvt_pk_bf16_f32 v57, v58, v59
    v_mfma_f32_16x16x32_bf16 v[32:35], a[24:27], v[176:179], v[32:35]
    ds_read_b64_tr_b16 a[40:41], v5 offset:8192
    v_cvt_pk_bf16_f32 v58, v60, v61
    v_mfma_f32_16x16x32_bf16 v[32:35], a[28:31], v[184:187], v[32:35]
    s_add_u32 s58, s48, 966656
    ds_read_b64_tr_b16 a[42:43], v5 offset:10240
    v_cvt_pk_bf16_f32 v59, v62, v63
    v_mfma_f32_16x16x32_bf16 v[40:43], a[0:3], v[192:195], 0
    ds_read_b64_tr_b16 a[44:45], v5 offset:12288
    buffer_store_dwordx4 v[56:59], v1, s[12:15], s58 offen sc1
    v_mfma_f32_16x16x32_bf16 v[40:43], a[4:7], v[200:203], v[40:43]
    s_add_u32 m0, s29, 122880
    ds_read_b64_tr_b16 a[46:47], v5 offset:14336
    v_mfma_f32_16x16x32_bf16 v[40:43], a[8:11], v[208:211], v[40:43]
    ds_read_b64_tr_b16 a[48:49], v5 offset:16384
    buffer_load_dwordx4 v2, s[16:19], s46 offen lds
    v_mfma_f32_16x16x32_bf16 v[40:43], a[12:15], v[216:219], v[40:43]
    ds_read_b64_tr_b16 a[50:51], v5 offset:18432
    v_mfma_f32_16x16x32_bf16 v[40:43], a[16:19], v[224:227], v[40:43]
    ds_read_b64_tr_b16 a[52:53], v5 offset:20480
    v_mfma_f32_16x16x32_bf16 v[40:43], a[20:23], v[232:235], v[40:43]
    ds_read_b64_tr_b16 a[54:55], v5 offset:22528
    v_mfma_f32_16x16x32_bf16 v[40:43], a[24:27], v[240:243], v[40:43]
    s_add_u32 m0, s29, 126976
    ds_read_b64_tr_b16 a[56:57], v5 offset:24576
    v_mfma_f32_16x16x32_bf16 v[40:43], a[28:31], v[248:251], v[40:43]
    s_waitcnt lgkmcnt(7)
    ds_read_b64_tr_b16 a[58:59], v5 offset:26624
    buffer_load_dwordx4 v2, s[16:19], s47 offen lds
    v_mfma_f32_16x16x32_bf16 v[36:39], a[32:35], v[128:131], 0
    ds_read_b64_tr_b16 a[60:61], v5 offset:28672
    v_add_u32 v2, 128, v2
    v_mfma_f32_16x16x32_bf16 v[36:39], a[36:39], v[136:139], v[36:39]
    ds_read_b64_tr_b16 a[62:63], v5 offset:30720
    v_xor_b32 v6, 0x20000, v6
    v_mfma_f32_16x16x32_bf16 v[36:39], a[40:43], v[144:147], v[36:39]
    s_waitcnt lgkmcnt(4)
    ds_read_b64_tr_b16 a[0:1], v6 offset:0
    v_mfma_f32_16x16x32_bf16 v[36:39], a[44:47], v[152:155], v[36:39]
    s_add_u32 m0, s29, 0
    ds_read_b64_tr_b16 a[2:3], v6 offset:2048
    v_mfma_f32_16x16x32_bf16 v[36:39], a[48:51], v[160:163], v[36:39]
    ds_read_b64_tr_b16 a[4:5], v6 offset:4096
    buffer_load_dwordx4 v2, s[16:19], s40 offen lds
    v_mfma_f32_16x16x32_bf16 v[36:39], a[52:55], v[168:171], v[36:39]
    s_waitcnt lgkmcnt(3)
    ds_read_b64_tr_b16 a[6:7], v6 offset:6144
    v_mfma_f32_16x16x32_bf16 v[36:39], a[56:59], v[176:179], v[36:39]
    ds_read_b64_tr_b16 a[8:9], v6 offset:8192
    v_mfma_f32_16x16x32_bf16 v[36:39], a[60:63], v[184:187], v[36:39]
    ds_read_b64_tr_b16 a[10:11], v6 offset:10240
    v_mfma_f32_16x16x32_bf16 v[44:47], a[32:35], v[192:195], 0
    s_add_u32 m0, s29, 4096
    ds_read_b64_tr_b16 a[12:13], v6 offset:12288
    v_mfma_f32_16x16x32_bf16 v[44:47], a[36:39], v[200:203], v[44:47]
    ds_read_b64_tr_b16 a[14:15], v6 offset:14336
    buffer_load_dwordx4 v2, s[16:19], s41 offen lds
    v_mfma_f32_16x16x32_bf16 v[44:47], a[40:43], v[208:211], v[44:47]
    ds_read_b64_tr_b16 a[16:17], v6 offset:16384
    v_mfma_f32_16x16x32_bf16 v[44:47], a[44:47], v[216:219], v[44:47]
    ds_read_b64_tr_b16 a[18:19], v6 offset:18432
    v_mfma_f32_16x16x32_bf16 v[44:47], a[48:51], v[224:227], v[44:47]
    ds_read_b64_tr_b16 a[20:21], v6 offset:20480
    v_cvt_pk_bf16_f32 v32, v32, v33
    v_mfma_f32_16x16x32_bf16 v[44:47], a[52:55], v[232:235], v[44:47]
    ds_read_b64_tr_b16 a[22:23], v6 offset:22528
    v_cvt_pk_bf16_f32 v33, v34, v35
    v_mfma_f32_16x16x32_bf16 v[44:47], a[56:59], v[240:243], v[44:47]
    s_add_u32 s58, s48, 65536
    ds_read_b64_tr_b16 a[24:25], v6 offset:24576
    v_cvt_pk_bf16_f32 v34, v36, v37
    v_mfma_f32_16x16x32_bf16 v[44:47], a[60:63], v[248:251], v[44:47]
    s_waitcnt lgkmcnt(7)
    ds_read_b64_tr_b16 a[26:27], v6 offset:26624
    v_cvt_pk_bf16_f32 v35, v38, v39
    v_mfma_f32_16x16x32_bf16 v[48:51], a[0:3], v[128:131], 0
    ds_read_b64_tr_b16 a[28:29], v6 offset:28672
    buffer_store_dwordx4 v[32:35], v1, s[12:15], s58 offen sc1
    v_mfma_f32_16x16x32_bf16 v[48:51], a[4:7], v[136:139], v[48:51]
    s_add_u32 m0, s29, 8192
    ds_read_b64_tr_b16 a[30:31], v6 offset:30720
    v_xor_b32 v7, 0x20000, v7
    v_mfma_f32_16x16x32_bf16 v[48:51], a[8:11], v[144:147], v[48:51]
    s_waitcnt lgkmcnt(4)
    ds_read_b64_tr_b16 a[32:33], v7 offset:0
    buffer_load_dwordx4 v2, s[16:19], s42 offen lds
    v_mfma_f32_16x16x32_bf16 v[48:51], a[12:15], v[152:155], v[48:51]
    ds_read_b64_tr_b16 a[34:35], v7 offset:2048
    v_mfma_f32_16x16x32_bf16 v[48:51], a[16:19], v[160:163], v[48:51]
    ds_read_b64_tr_b16 a[36:37], v7 offset:4096
    v_cvt_pk_bf16_f32 v40, v40, v41
    v_mfma_f32_16x16x32_bf16 v[48:51], a[20:23], v[168:171], v[48:51]
    s_waitcnt lgkmcnt(3)
    ds_read_b64_tr_b16 a[38:39], v7 offset:6144
    v_cvt_pk_bf16_f32 v41, v42, v43
    v_mfma_f32_16x16x32_bf16 v[48:51], a[24:27], v[176:179], v[48:51]
    ds_read_b64_tr_b16 a[40:41], v7 offset:8192
    v_cvt_pk_bf16_f32 v42, v44, v45
    v_mfma_f32_16x16x32_bf16 v[48:51], a[28:31], v[184:187], v[48:51]
    s_add_u32 s58, s48, 983040
    ds_read_b64_tr_b16 a[42:43], v7 offset:10240
    v_cvt_pk_bf16_f32 v43, v46, v47
    v_mfma_f32_16x16x32_bf16 v[56:59], a[0:3], v[192:195], 0
    ds_read_b64_tr_b16 a[44:45], v7 offset:12288
    buffer_store_dwordx4 v[40:43], v1, s[12:15], s58 offen sc1
    v_mfma_f32_16x16x32_bf16 v[56:59], a[4:7], v[200:203], v[56:59]
    s_add_u32 m0, s29, 12288
    ds_read_b64_tr_b16 a[46:47], v7 offset:14336
    v_mfma_f32_16x16x32_bf16 v[56:59], a[8:11], v[208:211], v[56:59]
    ds_read_b64_tr_b16 a[48:49], v7 offset:16384
    buffer_load_dwordx4 v2, s[16:19], s43 offen lds
    v_mfma_f32_16x16x32_bf16 v[56:59], a[12:15], v[216:219], v[56:59]
    ds_read_b64_tr_b16 a[50:51], v7 offset:18432
    v_mfma_f32_16x16x32_bf16 v[56:59], a[16:19], v[224:227], v[56:59]
    ds_read_b64_tr_b16 a[52:53], v7 offset:20480
    v_mfma_f32_16x16x32_bf16 v[56:59], a[20:23], v[232:235], v[56:59]
    ds_read_b64_tr_b16 a[54:55], v7 offset:22528
    v_mfma_f32_16x16x32_bf16 v[56:59], a[24:27], v[240:243], v[56:59]
    s_add_u32 m0, s29, 16384
    ds_read_b64_tr_b16 a[56:57], v7 offset:24576
    v_mfma_f32_16x16x32_bf16 v[56:59], a[28:31], v[248:251], v[56:59]
    s_waitcnt lgkmcnt(7)
    ds_read_b64_tr_b16 a[58:59], v7 offset:26624
    buffer_load_dwordx4 v2, s[16:19], s44 offen lds
    v_mfma_f32_16x16x32_bf16 v[52:55], a[32:35], v[128:131], 0
    s_waitcnt vmcnt(7)
    ds_read_b64_tr_b16 a[60:61], v7 offset:28672
    v_mfma_f32_16x16x32_bf16 v[52:55], a[36:39], v[136:139], v[52:55]
    s_barrier
    ds_read_b64_tr_b16 a[62:63], v7 offset:30720
    v_xor_b32 v4, 0x30000, v4
    v_mfma_f32_16x16x32_bf16 v[52:55], a[40:43], v[144:147], v[52:55]
    s_waitcnt lgkmcnt(4)
    ds_read_b64_tr_b16 a[0:1], v4 offset:0
    v_mfma_f32_16x16x32_bf16 v[52:55], a[44:47], v[152:155], v[52:55]
    s_add_u32 m0, s29, 20480
    ds_read_b64_tr_b16 a[2:3], v4 offset:2048
    v_mfma_f32_16x16x32_bf16 v[52:55], a[48:51], v[160:163], v[52:55]
    ds_read_b64_tr_b16 a[4:5], v4 offset:4096
    buffer_load_dwordx4 v2, s[16:19], s45 offen lds
    v_mfma_f32_16x16x32_bf16 v[52:55], a[52:55], v[168:171], v[52:55]
    s_waitcnt lgkmcnt(3)
    ds_read_b64_tr_b16 a[6:7], v4 offset:6144
    v_mfma_f32_16x16x32_bf16 v[52:55], a[56:59], v[176:179], v[52:55]
    ds_read_b64_tr_b16 a[8:9], v4 offset:8192
    v_mfma_f32_16x16x32_bf16 v[52:55], a[60:63], v[184:187], v[52:55]
    ds_read_b64_tr_b16 a[10:11], v4 offset:10240
    v_mfma_f32_16x16x32_bf16 v[60:63], a[32:35], v[192:195], 0
    s_add_u32 m0, s29, 24576
    ds_read_b64_tr_b16 a[12:13], v4 offset:12288
    v_mfma_f32_16x16x32_bf16 v[60:63], a[36:39], v[200:203], v[60:63]
    ds_read_b64_tr_b16 a[14:15], v4 offset:14336
    buffer_load_dwordx4 v2, s[16:19], s46 offen lds
    v_mfma_f32_16x16x32_bf16 v[60:63], a[40:43], v[208:211], v[60:63]
    ds_read_b64_tr_b16 a[16:17], v4 offset:16384
    v_mfma_f32_16x16x32_bf16 v[60:63], a[44:47], v[216:219], v[60:63]
    ds_read_b64_tr_b16 a[18:19], v4 offset:18432
    v_mfma_f32_16x16x32_bf16 v[60:63], a[48:51], v[224:227], v[60:63]
    ds_read_b64_tr_b16 a[20:21], v4 offset:20480
    v_cvt_pk_bf16_f32 v48, v48, v49
    v_mfma_f32_16x16x32_bf16 v[60:63], a[52:55], v[232:235], v[60:63]
    ds_read_b64_tr_b16 a[22:23], v4 offset:22528
    v_cvt_pk_bf16_f32 v49, v50, v51
    v_mfma_f32_16x16x32_bf16 v[60:63], a[56:59], v[240:243], v[60:63]
    s_add_u32 s58, s48, 81920
    ds_read_b64_tr_b16 a[24:25], v4 offset:24576
    v_cvt_pk_bf16_f32 v50, v52, v53
    v_mfma_f32_16x16x32_bf16 v[60:63], a[60:63], v[248:251], v[60:63]
    s_waitcnt lgkmcnt(7)
    ds_read_b64_tr_b16 a[26:27], v4 offset:26624
    v_cvt_pk_bf16_f32 v51, v54, v55
    v_mfma_f32_16x16x32_bf16 v[32:35], a[0:3], v[128:131], 0
    ds_read_b64_tr_b16 a[28:29], v4 offset:28672
    buffer_store_dwordx4 v[48:51], v1, s[12:15], s58 offen sc1
    v_mfma_f32_16x16x32_bf16 v[32:35], a[4:7], v[136:139], v[32:35]
    s_add_u32 m0, s29, 28672
    ds_read_b64_tr_b16 a[30:31], v4 offset:30720
    v_xor_b32 v5, 0x30000, v5
    v_mfma_f32_16x16x32_bf16 v[32:35], a[8:11], v[144:147], v[32:35]
    s_waitcnt lgkmcnt(4)
    ds_read_b64_tr_b16 a[32:33], v5 offset:0
    buffer_load_dwordx4 v2, s[16:19], s47 offen lds
    v_mfma_f32_16x16x32_bf16 v[32:35], a[12:15], v[152:155], v[32:35]
    ds_read_b64_tr_b16 a[34:35], v5 offset:2048
    v_add_u32 v2, 128, v2
    v_mfma_f32_16x16x32_bf16 v[32:35], a[16:19], v[160:163], v[32:35]
    ds_read_b64_tr_b16 a[36:37], v5 offset:4096
    v_cvt_pk_bf16_f32 v56, v56, v57
    v_mfma_f32_16x16x32_bf16 v[32:35], a[20:23], v[168:171], v[32:35]
    s_waitcnt lgkmcnt(3)
    ds_read_b64_tr_b16 a[38:39], v5 offset:6144
    v_cvt_pk_bf16_f32 v57, v58, v59
    v_mfma_f32_16x16x32_bf16 v[32:35], a[24:27], v[176:179], v[32:35]
    ds_read_b64_tr_b16 a[40:41], v5 offset:8192
    v_cvt_pk_bf16_f32 v58, v60, v61
    v_mfma_f32_16x16x32_bf16 v[32:35], a[28:31], v[184:187], v[32:35]
    s_add_u32 s58, s48, 999424
    ds_read_b64_tr_b16 a[42:43], v5 offset:10240
    v_cvt_pk_bf16_f32 v59, v62, v63
    v_mfma_f32_16x16x32_bf16 v[40:43], a[0:3], v[192:195], 0
    ds_read_b64_tr_b16 a[44:45], v5 offset:12288
    buffer_store_dwordx4 v[56:59], v1, s[12:15], s58 offen sc1
    v_mfma_f32_16x16x32_bf16 v[40:43], a[4:7], v[200:203], v[40:43]
    s_add_u32 m0, s29, 32768
    ds_read_b64_tr_b16 a[46:47], v5 offset:14336
    v_mfma_f32_16x16x32_bf16 v[40:43], a[8:11], v[208:211], v[40:43]
    ds_read_b64_tr_b16 a[48:49], v5 offset:16384
    buffer_load_dwordx4 v2, s[16:19], s40 offen lds
    v_mfma_f32_16x16x32_bf16 v[40:43], a[12:15], v[216:219], v[40:43]
    ds_read_b64_tr_b16 a[50:51], v5 offset:18432
    v_mfma_f32_16x16x32_bf16 v[40:43], a[16:19], v[224:227], v[40:43]
    ds_read_b64_tr_b16 a[52:53], v5 offset:20480
    v_mfma_f32_16x16x32_bf16 v[40:43], a[20:23], v[232:235], v[40:43]
    ds_read_b64_tr_b16 a[54:55], v5 offset:22528
    v_mfma_f32_16x16x32_bf16 v[40:43], a[24:27], v[240:243], v[40:43]
    s_add_u32 m0, s29, 36864
    ds_read_b64_tr_b16 a[56:57], v5 offset:24576
    v_mfma_f32_16x16x32_bf16 v[40:43], a[28:31], v[248:251], v[40:43]
    s_waitcnt lgkmcnt(7)
    ds_read_b64_tr_b16 a[58:59], v5 offset:26624
    buffer_load_dwordx4 v2, s[16:19], s41 offen lds
    v_mfma_f32_16x16x32_bf16 v[36:39], a[32:35], v[128:131], 0
    ds_read_b64_tr_b16 a[60:61], v5 offset:28672
    v_mfma_f32_16x16x32_bf16 v[36:39], a[36:39], v[136:139], v[36:39]
    ds_read_b64_tr_b16 a[62:63], v5 offset:30720
    v_xor_b32 v6, 0x30000, v6
    v_mfma_f32_16x16x32_bf16 v[36:39], a[40:43], v[144:147], v[36:39]
    s_waitcnt lgkmcnt(4)
    ds_read_b64_tr_b16 a[0:1], v6 offset:0
    v_mfma_f32_16x16x32_bf16 v[36:39], a[44:47], v[152:155], v[36:39]
    s_add_u32 m0, s29, 40960
    ds_read_b64_tr_b16 a[2:3], v6 offset:2048
    v_mfma_f32_16x16x32_bf16 v[36:39], a[48:51], v[160:163], v[36:39]
    ds_read_b64_tr_b16 a[4:5], v6 offset:4096
    buffer_load_dwordx4 v2, s[16:19], s42 offen lds
    v_mfma_f32_16x16x32_bf16 v[36:39], a[52:55], v[168:171], v[36:39]
    s_waitcnt lgkmcnt(3)
    ds_read_b64_tr_b16 a[6:7], v6 offset:6144
    v_mfma_f32_16x16x32_bf16 v[36:39], a[56:59], v[176:179], v[36:39]
    ds_read_b64_tr_b16 a[8:9], v6 offset:8192
    v_mfma_f32_16x16x32_bf16 v[36:39], a[60:63], v[184:187], v[36:39]
    ds_read_b64_tr_b16 a[10:11], v6 offset:10240
    v_mfma_f32_16x16x32_bf16 v[44:47], a[32:35], v[192:195], 0
    s_add_u32 m0, s29, 45056
    ds_read_b64_tr_b16 a[12:13], v6 offset:12288
    v_mfma_f32_16x16x32_bf16 v[44:47], a[36:39], v[200:203], v[44:47]
    ds_read_b64_tr_b16 a[14:15], v6 offset:14336
    buffer_load_dwordx4 v2, s[16:19], s43 offen lds
    v_mfma_f32_16x16x32_bf16 v[44:47], a[40:43], v[208:211], v[44:47]
    ds_read_b64_tr_b16 a[16:17], v6 offset:16384
    v_mfma_f32_16x16x32_bf16 v[44:47], a[44:47], v[216:219], v[44:47]
    ds_read_b64_tr_b16 a[18:19], v6 offset:18432
    v_mfma_f32_16x16x32_bf16 v[44:47], a[48:51], v[224:227], v[44:47]
    ds_read_b64_tr_b16 a[20:21], v6 offset:20480
    v_cvt_pk_bf16_f32 v32, v32, v33
    v_mfma_f32_16x16x32_bf16 v[44:47], a[52:55], v[232:235], v[44:47]
    ds_read_b64_tr_b16 a[22:23], v6 offset:22528
    v_cvt_pk_bf16_f32 v33, v34, v35
    v_mfma_f32_16x16x32_bf16 v[44:47], a[56:59], v[240:243], v[44:47]
    s_add_u32 s58, s48, 98304
    ds_read_b64_tr_b16 a[24:25], v6 offset:24576
    v_cvt_pk_bf16_f32 v34, v36, v37
    v_mfma_f32_16x16x32_bf16 v[44:47], a[60:63], v[248:251], v[44:47]
    s_waitcnt lgkmcnt(7)
    ds_read_b64_tr_b16 a[26:27], v6 offset:26624
    v_cvt_pk_bf16_f32 v35, v38, v39
    v_mfma_f32_16x16x32_bf16 v[48:51], a[0:3], v[128:131], 0
    ds_read_b64_tr_b16 a[28:29], v6 offset:28672
    buffer_store_dwordx4 v[32:35], v1, s[12:15], s58 offen sc1
    v_mfma_f32_16x16x32_bf16 v[48:51], a[4:7], v[136:139], v[48:51]
    s_add_u32 m0, s29, 49152
    ds_read_b64_tr_b16 a[30:31], v6 offset:30720
    v_xor_b32 v7, 0x30000, v7
    v_mfma_f32_16x16x32_bf16 v[48:51], a[8:11], v[144:147], v[48:51]
    s_waitcnt lgkmcnt(4)
    ds_read_b64_tr_b16 a[32:33], v7 offset:0
    buffer_load_dwordx4 v2, s[16:19], s44 offen lds
    v_mfma_f32_16x16x32_bf16 v[48:51], a[12:15], v[152:155], v[48:51]
    ds_read_b64_tr_b16 a[34:35], v7 offset:2048
    v_mfma_f32_16x16x32_bf16 v[48:51], a[16:19], v[160:163], v[48:51]
    ds_read_b64_tr_b16 a[36:37], v7 offset:4096
    v_cvt_pk_bf16_f32 v40, v40, v41
    v_mfma_f32_16x16x32_bf16 v[48:51], a[20:23], v[168:171], v[48:51]
    s_waitcnt lgkmcnt(3)
    ds_read_b64_tr_b16 a[38:39], v7 offset:6144
    v_cvt_pk_bf16_f32 v41, v42, v43
    v_mfma_f32_16x16x32_bf16 v[48:51], a[24:27], v[176:179], v[48:51]
    ds_read_b64_tr_b16 a[40:41], v7 offset:8192
    v_cvt_pk_bf16_f32 v42, v44, v45
    v_mfma_f32_16x16x32_bf16 v[48:51], a[28:31], v[184:187], v[48:51]
    s_add_u32 s58, s48, 1015808
    ds_read_b64_tr_b16 a[42:43], v7 offset:10240
    v_cvt_pk_bf16_f32 v43, v46, v47
    v_mfma_f32_16x16x32_bf16 v[56:59], a[0:3], v[192:195], 0
    ds_read_b64_tr_b16 a[44:45], v7 offset:12288
    buffer_store_dwordx4 v[40:43], v1, s[12:15], s58 offen sc1
    v_mfma_f32_16x16x32_bf16 v[56:59], a[4:7], v[200:203], v[56:59]
    s_add_u32 m0, s29, 53248
    ds_read_b64_tr_b16 a[46:47], v7 offset:14336
    v_mfma_f32_16x16x32_bf16 v[56:59], a[8:11], v[208:211], v[56:59]
    ds_read_b64_tr_b16 a[48:49], v7 offset:16384
    buffer_load_dwordx4 v2, s[16:19], s45 offen lds
    v_mfma_f32_16x16x32_bf16 v[56:59], a[12:15], v[216:219], v[56:59]
    ds_read_b64_tr_b16 a[50:51], v7 offset:18432
    v_mfma_f32_16x16x32_bf16 v[56:59], a[16:19], v[224:227], v[56:59]
    ds_read_b64_tr_b16 a[52:53], v7 offset:20480
    v_mfma_f32_16x16x32_bf16 v[56:59], a[20:23], v[232:235], v[56:59]
    ds_read_b64_tr_b16 a[54:55], v7 offset:22528
    v_mfma_f32_16x16x32_bf16 v[56:59], a[24:27], v[240:243], v[56:59]
    s_add_u32 m0, s29, 57344
    ds_read_b64_tr_b16 a[56:57], v7 offset:24576
    v_mfma_f32_16x16x32_bf16 v[56:59], a[28:31], v[248:251], v[56:59]
    s_waitcnt lgkmcnt(7)
    ds_read_b64_tr_b16 a[58:59], v7 offset:26624
    buffer_load_dwordx4 v2, s[16:19], s46 offen lds
    v_mfma_f32_16x16x32_bf16 v[52:55], a[32:35], v[128:131], 0
    ds_read_b64_tr_b16 a[60:61], v7 offset:28672
    v_mfma_f32_16x16x32_bf16 v[52:55], a[36:39], v[136:139], v[52:55]
    ds_read_b64_tr_b16 a[62:63], v7 offset:30720
    v_mfma_f32_16x16x32_bf16 v[52:55], a[40:43], v[144:147], v[52:55]
    s_waitcnt lgkmcnt(4)
    ds_read_b64_tr_b16 a[0:1], v4 offset:32768
    v_mfma_f32_16x16x32_bf16 v[52:55], a[44:47], v[152:155], v[52:55]
    s_add_u32 m0, s29, 61440
    ds_read_b64_tr_b16 a[2:3], v4 offset:34816
    v_mfma_f32_16x16x32_bf16 v[52:55], a[48:51], v[160:163], v[52:55]
    ds_read_b64_tr_b16 a[4:5], v4 offset:36864
    buffer_load_dwordx4 v2, s[16:19], s47 offen lds
    v_mfma_f32_16x16x32_bf16 v[52:55], a[52:55], v[168:171], v[52:55]
    s_waitcnt lgkmcnt(3)
    ds_read_b64_tr_b16 a[6:7], v4 offset:38912
    v_add_u32 v2, 128, v2
    v_mfma_f32_16x16x32_bf16 v[52:55], a[56:59], v[176:179], v[52:55]
    ds_read_b64_tr_b16 a[8:9], v4 offset:40960
    v_mfma_f32_16x16x32_bf16 v[52:55], a[60:63], v[184:187], v[52:55]
    ds_read_b64_tr_b16 a[10:11], v4 offset:43008
    v_mfma_f32_16x16x32_bf16 v[60:63], a[32:35], v[192:195], 0
    ds_read_b64_tr_b16 a[12:13], v4 offset:45056
    v_mfma_f32_16x16x32_bf16 v[60:63], a[36:39], v[200:203], v[60:63]
    ds_read_b64_tr_b16 a[14:15], v4 offset:47104
    v_mfma_f32_16x16x32_bf16 v[60:63], a[40:43], v[208:211], v[60:63]
    ds_read_b64_tr_b16 a[16:17], v4 offset:49152
    v_mfma_f32_16x16x32_bf16 v[60:63], a[44:47], v[216:219], v[60:63]
    ds_read_b64_tr_b16 a[18:19], v4 offset:51200
    v_mfma_f32_16x16x32_bf16 v[60:63], a[48:51], v[224:227], v[60:63]
    ds_read_b64_tr_b16 a[20:21], v4 offset:53248
    v_cvt_pk_bf16_f32 v48, v48, v49
    v_mfma_f32_16x16x32_bf16 v[60:63], a[52:55], v[232:235], v[60:63]
    ds_read_b64_tr_b16 a[22:23], v4 offset:55296
    v_cvt_pk_bf16_f32 v49, v50, v51
    v_mfma_f32_16x16x32_bf16 v[60:63], a[56:59], v[240:243], v[60:63]
    s_add_u32 s58, s48, 114688
    ds_read_b64_tr_b16 a[24:25], v4 offset:57344
    v_cvt_pk_bf16_f32 v50, v52, v53
    v_mfma_f32_16x16x32_bf16 v[60:63], a[60:63], v[248:251], v[60:63]
    s_waitcnt lgkmcnt(7)
    ds_read_b64_tr_b16 a[26:27], v4 offset:59392
    v_cvt_pk_bf16_f32 v51, v54, v55
    v_mfma_f32_16x16x32_bf16 v[32:35], a[0:3], v[128:131], 0
    ds_read_b64_tr_b16 a[28:29], v4 offset:61440
    buffer_store_dwordx4 v[48:51], v1, s[12:15], s58 offen sc1
    v_mfma_f32_16x16x32_bf16 v[32:35], a[4:7], v[136:139], v[32:35]
    ds_read_b64_tr_b16 a[30:31], v4 offset:63488
    v_mfma_f32_16x16x32_bf16 v[32:35], a[8:11], v[144:147], v[32:35]
    s_waitcnt lgkmcnt(4)
    ds_read_b64_tr_b16 a[32:33], v5 offset:32768
    v_mfma_f32_16x16x32_bf16 v[32:35], a[12:15], v[152:155], v[32:35]
    ds_read_b64_tr_b16 a[34:35], v5 offset:34816
    v_mfma_f32_16x16x32_bf16 v[32:35], a[16:19], v[160:163], v[32:35]
    ds_read_b64_tr_b16 a[36:37], v5 offset:36864
    v_cvt_pk_bf16_f32 v56, v56, v57
    v_mfma_f32_16x16x32_bf16 v[32:35], a[20:23], v[168:171], v[32:35]
    s_waitcnt lgkmcnt(3)
    ds_read_b64_tr_b16 a[38:39], v5 offset:38912
    v_cvt_pk_bf16_f32 v57, v58, v59
    v_mfma_f32_16x16x32_bf16 v[32:35], a[24:27], v[176:179], v[32:35]
    ds_read_b64_tr_b16 a[40:41], v5 offset:40960
    v_cvt_pk_bf16_f32 v58, v60, v61
    v_mfma_f32_16x16x32_bf16 v[32:35], a[28:31], v[184:187], v[32:35]
    s_add_u32 s58, s48, 1032192
    ds_read_b64_tr_b16 a[42:43], v5 offset:43008
    v_cvt_pk_bf16_f32 v59, v62, v63
    v_mfma_f32_16x16x32_bf16 v[40:43], a[0:3], v[192:195], 0
    ds_read_b64_tr_b16 a[44:45], v5 offset:45056
    buffer_store_dwordx4 v[56:59], v1, s[12:15], s58 offen sc1
    v_mfma_f32_16x16x32_bf16 v[40:43], a[4:7], v[200:203], v[40:43]
    ds_read_b64_tr_b16 a[46:47], v5 offset:47104
    v_mfma_f32_16x16x32_bf16 v[40:43], a[8:11], v[208:211], v[40:43]
    ds_read_b64_tr_b16 a[48:49], v5 offset:49152
    v_mfma_f32_16x16x32_bf16 v[40:43], a[12:15], v[216:219], v[40:43]
    ds_read_b64_tr_b16 a[50:51], v5 offset:51200
    v_mfma_f32_16x16x32_bf16 v[40:43], a[16:19], v[224:227], v[40:43]
    ds_read_b64_tr_b16 a[52:53], v5 offset:53248
    v_mfma_f32_16x16x32_bf16 v[40:43], a[20:23], v[232:235], v[40:43]
    ds_read_b64_tr_b16 a[54:55], v5 offset:55296
    v_mfma_f32_16x16x32_bf16 v[40:43], a[24:27], v[240:243], v[40:43]
    ds_read_b64_tr_b16 a[56:57], v5 offset:57344
    v_mfma_f32_16x16x32_bf16 v[40:43], a[28:31], v[248:251], v[40:43]
    s_waitcnt lgkmcnt(7)
    ds_read_b64_tr_b16 a[58:59], v5 offset:59392
    v_mfma_f32_16x16x32_bf16 v[36:39], a[32:35], v[128:131], 0
    ds_read_b64_tr_b16 a[60:61], v5 offset:61440
    v_mfma_f32_16x16x32_bf16 v[36:39], a[36:39], v[136:139], v[36:39]
    ds_read_b64_tr_b16 a[62:63], v5 offset:63488
    v_mfma_f32_16x16x32_bf16 v[36:39], a[40:43], v[144:147], v[36:39]
    s_waitcnt lgkmcnt(4)
    ds_read_b64_tr_b16 a[0:1], v6 offset:32768
    v_mfma_f32_16x16x32_bf16 v[36:39], a[44:47], v[152:155], v[36:39]
    ds_read_b64_tr_b16 a[2:3], v6 offset:34816
    v_mfma_f32_16x16x32_bf16 v[36:39], a[48:51], v[160:163], v[36:39]
    ds_read_b64_tr_b16 a[4:5], v6 offset:36864
    v_mfma_f32_16x16x32_bf16 v[36:39], a[52:55], v[168:171], v[36:39]
    s_waitcnt lgkmcnt(3)
    ds_read_b64_tr_b16 a[6:7], v6 offset:38912
    v_mfma_f32_16x16x32_bf16 v[36:39], a[56:59], v[176:179], v[36:39]
    ds_read_b64_tr_b16 a[8:9], v6 offset:40960
    v_mfma_f32_16x16x32_bf16 v[36:39], a[60:63], v[184:187], v[36:39]
    ds_read_b64_tr_b16 a[10:11], v6 offset:43008
    v_mfma_f32_16x16x32_bf16 v[44:47], a[32:35], v[192:195], 0
    ds_read_b64_tr_b16 a[12:13], v6 offset:45056
    v_mfma_f32_16x16x32_bf16 v[44:47], a[36:39], v[200:203], v[44:47]
    ds_read_b64_tr_b16 a[14:15], v6 offset:47104
    v_mfma_f32_16x16x32_bf16 v[44:47], a[40:43], v[208:211], v[44:47]
    ds_read_b64_tr_b16 a[16:17], v6 offset:49152
    v_mfma_f32_16x16x32_bf16 v[44:47], a[44:47], v[216:219], v[44:47]
    ds_read_b64_tr_b16 a[18:19], v6 offset:51200
    v_mfma_f32_16x16x32_bf16 v[44:47], a[48:51], v[224:227], v[44:47]
    ds_read_b64_tr_b16 a[20:21], v6 offset:53248
    v_cvt_pk_bf16_f32 v32, v32, v33
    v_mfma_f32_16x16x32_bf16 v[44:47], a[52:55], v[232:235], v[44:47]
    ds_read_b64_tr_b16 a[22:23], v6 offset:55296
    v_cvt_pk_bf16_f32 v33, v34, v35
    v_mfma_f32_16x16x32_bf16 v[44:47], a[56:59], v[240:243], v[44:47]
    s_add_u32 s58, s48, 131072
    ds_read_b64_tr_b16 a[24:25], v6 offset:57344
    v_cvt_pk_bf16_f32 v34, v36, v37
    v_mfma_f32_16x16x32_bf16 v[44:47], a[60:63], v[248:251], v[44:47]
    s_waitcnt lgkmcnt(7)
    ds_read_b64_tr_b16 a[26:27], v6 offset:59392
    v_cvt_pk_bf16_f32 v35, v38, v39
    v_mfma_f32_16x16x32_bf16 v[48:51], a[0:3], v[128:131], 0
    ds_read_b64_tr_b16 a[28:29], v6 offset:61440
    buffer_store_dwordx4 v[32:35], v1, s[12:15], s58 offen sc1
    v_mfma_f32_16x16x32_bf16 v[48:51], a[4:7], v[136:139], v[48:51]
    ds_read_b64_tr_b16 a[30:31], v6 offset:63488
    v_mfma_f32_16x16x32_bf16 v[48:51], a[8:11], v[144:147], v[48:51]
    s_waitcnt lgkmcnt(4)
    ds_read_b64_tr_b16 a[32:33], v7 offset:32768
    v_mfma_f32_16x16x32_bf16 v[48:51], a[12:15], v[152:155], v[48:51]
    ds_read_b64_tr_b16 a[34:35], v7 offset:34816
    v_mfma_f32_16x16x32_bf16 v[48:51], a[16:19], v[160:163], v[48:51]
    ds_read_b64_tr_b16 a[36:37], v7 offset:36864
    v_cvt_pk_bf16_f32 v40, v40, v41
    v_mfma_f32_16x16x32_bf16 v[48:51], a[20:23], v[168:171], v[48:51]
    s_waitcnt lgkmcnt(3)
    ds_read_b64_tr_b16 a[38:39], v7 offset:38912
    v_cvt_pk_bf16_f32 v41, v42, v43
    v_mfma_f32_16x16x32_bf16 v[48:51], a[24:27], v[176:179], v[48:51]
    ds_read_b64_tr_b16 a[40:41], v7 offset:40960
    v_cvt_pk_bf16_f32 v42, v44, v45
    v_mfma_f32_16x16x32_bf16 v[48:51], a[28:31], v[184:187], v[48:51]
    s_add_u32 s58, s48, 1048576
    ds_read_b64_tr_b16 a[42:43], v7 offset:43008
    v_cvt_pk_bf16_f32 v43, v46, v47
    v_mfma_f32_16x16x32_bf16 v[56:59], a[0:3], v[192:195], 0
    ds_read_b64_tr_b16 a[44:45], v7 offset:45056
    buffer_store_dwordx4 v[40:43], v1, s[12:15], s58 offen sc1
    v_mfma_f32_16x16x32_bf16 v[56:59], a[4:7], v[200:203], v[56:59]
    ds_read_b64_tr_b16 a[46:47], v7 offset:47104
    v_mfma_f32_16x16x32_bf16 v[56:59], a[8:11], v[208:211], v[56:59]
    ds_read_b64_tr_b16 a[48:49], v7 offset:49152
    v_mfma_f32_16x16x32_bf16 v[56:59], a[12:15], v[216:219], v[56:59]
    ds_read_b64_tr_b16 a[50:51], v7 offset:51200
    v_mfma_f32_16x16x32_bf16 v[56:59], a[16:19], v[224:227], v[56:59]
    ds_read_b64_tr_b16 a[52:53], v7 offset:53248
    v_mfma_f32_16x16x32_bf16 v[56:59], a[20:23], v[232:235], v[56:59]
    ds_read_b64_tr_b16 a[54:55], v7 offset:55296
    v_mfma_f32_16x16x32_bf16 v[56:59], a[24:27], v[240:243], v[56:59]
    ds_read_b64_tr_b16 a[56:57], v7 offset:57344
    v_mfma_f32_16x16x32_bf16 v[56:59], a[28:31], v[248:251], v[56:59]
    s_waitcnt lgkmcnt(7)
    ds_read_b64_tr_b16 a[58:59], v7 offset:59392
    v_mfma_f32_16x16x32_bf16 v[52:55], a[32:35], v[128:131], 0
    s_waitcnt vmcnt(4)
    ds_read_b64_tr_b16 a[60:61], v7 offset:61440
    v_mfma_f32_16x16x32_bf16 v[52:55], a[36:39], v[136:139], v[52:55]
    s_barrier
    ds_read_b64_tr_b16 a[62:63], v7 offset:63488
    v_xor_b32 v4, 0x10000, v4
    v_mfma_f32_16x16x32_bf16 v[52:55], a[40:43], v[144:147], v[52:55]
    s_waitcnt lgkmcnt(4)
    ds_read_b64_tr_b16 a[0:1], v4 offset:0
    v_mfma_f32_16x16x32_bf16 v[52:55], a[44:47], v[152:155], v[52:55]
    ds_read_b64_tr_b16 a[2:3], v4 offset:2048
    v_mfma_f32_16x16x32_bf16 v[52:55], a[48:51], v[160:163], v[52:55]
    ds_read_b64_tr_b16 a[4:5], v4 offset:4096
    v_mfma_f32_16x16x32_bf16 v[52:55], a[52:55], v[168:171], v[52:55]
    s_waitcnt lgkmcnt(3)
    ds_read_b64_tr_b16 a[6:7], v4 offset:6144
    v_mfma_f32_16x16x32_bf16 v[52:55], a[56:59], v[176:179], v[52:55]
    ds_read_b64_tr_b16 a[8:9], v4 offset:8192
    v_mfma_f32_16x16x32_bf16 v[52:55], a[60:63], v[184:187], v[52:55]
    ds_read_b64_tr_b16 a[10:11], v4 offset:10240
    v_mfma_f32_16x16x32_bf16 v[60:63], a[32:35], v[192:195], 0
    ds_read_b64_tr_b16 a[12:13], v4 offset:12288
    v_mfma_f32_16x16x32_bf16 v[60:63], a[36:39], v[200:203], v[60:63]
    ds_read_b64_tr_b16 a[14:15], v4 offset:14336
    v_mfma_f32_16x16x32_bf16 v[60:63], a[40:43], v[208:211], v[60:63]
    ds_read_b64_tr_b16 a[16:17], v4 offset:16384
    v_mfma_f32_16x16x32_bf16 v[60:63], a[44:47], v[216:219], v[60:63]
    s_waitcnt lgkmcnt(9)
    ds_read_b64_tr_b16 a[18:19], v4 offset:18432
    v_mfma_f32_16x16x32_bf16 v[60:63], a[48:51], v[224:227], v[60:63]
    s_barrier
    ds_read_b64_tr_b16 a[20:21], v4 offset:20480
    v_cvt_pk_bf16_f32 v48, v48, v49
    v_mfma_f32_16x16x32_bf16 v[60:63], a[52:55], v[232:235], v[60:63]
    ds_read_b64_tr_b16 a[22:23], v4 offset:22528
    v_cvt_pk_bf16_f32 v49, v50, v51
    v_mfma_f32_16x16x32_bf16 v[60:63], a[56:59], v[240:243], v[60:63]
    s_add_u32 s58, s48, 147456
    ds_read_b64_tr_b16 a[24:25], v4 offset:24576
    v_cvt_pk_bf16_f32 v50, v52, v53
    v_mfma_f32_16x16x32_bf16 v[60:63], a[60:63], v[248:251], v[60:63]
    s_waitcnt lgkmcnt(7)
    ds_read_b64_tr_b16 a[26:27], v4 offset:26624
    v_cvt_pk_bf16_f32 v51, v54, v55
    v_mfma_f32_16x16x32_bf16 v[32:35], a[0:3], v[128:131], 0
    ds_read_b64_tr_b16 a[28:29], v4 offset:28672
    buffer_store_dwordx4 v[48:51], v1, s[12:15], s58 offen sc1
    v_mfma_f32_16x16x32_bf16 v[32:35], a[4:7], v[136:139], v[32:35]
    s_add_u32 m0, s33, 4640
    ds_read_b64_tr_b16 a[30:31], v4 offset:30720
    v_xor_b32 v5, 0x10000, v5
    v_mfma_f32_16x16x32_bf16 v[32:35], a[8:11], v[144:147], v[32:35]
    s_waitcnt lgkmcnt(4)
    ds_read_b64_tr_b16 a[32:33], v5 offset:0
    buffer_load_dwordx4 v1, s[4:7], s34 offen offset:0 lds
    v_mfma_f32_16x16x32_bf16 v[32:35], a[12:15], v[152:155], v[32:35]
    ds_read_b64_tr_b16 a[34:35], v5 offset:2048
    v_mfma_f32_16x16x32_bf16 v[32:35], a[16:19], v[160:163], v[32:35]
    ds_read_b64_tr_b16 a[36:37], v5 offset:4096
    v_cvt_pk_bf16_f32 v56, v56, v57
    v_mfma_f32_16x16x32_bf16 v[32:35], a[20:23], v[168:171], v[32:35]
    s_waitcnt lgkmcnt(3)
    ds_read_b64_tr_b16 a[38:39], v5 offset:6144
    v_cvt_pk_bf16_f32 v57, v58, v59
    v_mfma_f32_16x16x32_bf16 v[32:35], a[24:27], v[176:179], v[32:35]
    ds_read_b64_tr_b16 a[40:41], v5 offset:8192
    v_cvt_pk_bf16_f32 v58, v60, v61
    v_mfma_f32_16x16x32_bf16 v[32:35], a[28:31], v[184:187], v[32:35]
    s_add_u32 s58, s48, 1064960
    ds_read_b64_tr_b16 a[42:43], v5 offset:10240
    v_cvt_pk_bf16_f32 v59, v62, v63
    v_mfma_f32_16x16x32_bf16 v[40:43], a[0:3], v[192:195], 0
    ds_read_b64_tr_b16 a[44:45], v5 offset:12288
    buffer_store_dwordx4 v[56:59], v1, s[12:15], s58 offen sc1
    v_mfma_f32_16x16x32_bf16 v[40:43], a[4:7], v[200:203], v[40:43]
    ds_read_b64_tr_b16 a[46:47], v5 offset:14336
    v_mfma_f32_16x16x32_bf16 v[40:43], a[8:11], v[208:211], v[40:43]
    ds_read_b64_tr_b16 a[48:49], v5 offset:16384
    buffer_load_dwordx4 v1, s[4:7], s34 offen offset:1024 lds
    v_mfma_f32_16x16x32_bf16 v[40:43], a[12:15], v[216:219], v[40:43]
    ds_read_b64_tr_b16 a[50:51], v5 offset:18432
    v_mfma_f32_16x16x32_bf16 v[40:43], a[16:19], v[224:227], v[40:43]
    ds_read_b64_tr_b16 a[52:53], v5 offset:20480
    v_mfma_f32_16x16x32_bf16 v[40:43], a[20:23], v[232:235], v[40:43]
    ds_read_b64_tr_b16 a[54:55], v5 offset:22528
    v_mfma_f32_16x16x32_bf16 v[40:43], a[24:27], v[240:243], v[40:43]
    ds_read_b64_tr_b16 a[56:57], v5 offset:24576
    v_mfma_f32_16x16x32_bf16 v[40:43], a[28:31], v[248:251], v[40:43]
    s_waitcnt lgkmcnt(7)
    ds_read_b64_tr_b16 a[58:59], v5 offset:26624
    buffer_load_dwordx4 v1, s[4:7], s34 offen offset:2048 lds
    v_mfma_f32_16x16x32_bf16 v[36:39], a[32:35], v[128:131], 0
    ds_read_b64_tr_b16 a[60:61], v5 offset:28672
    v_mfma_f32_16x16x32_bf16 v[36:39], a[36:39], v[136:139], v[36:39]
    ds_read_b64_tr_b16 a[62:63], v5 offset:30720
    v_xor_b32 v6, 0x10000, v6
    v_mfma_f32_16x16x32_bf16 v[36:39], a[40:43], v[144:147], v[36:39]
    s_waitcnt lgkmcnt(4)
    ds_read_b64_tr_b16 a[0:1], v6 offset:0
    v_mfma_f32_16x16x32_bf16 v[36:39], a[44:47], v[152:155], v[36:39]
    ds_read_b64_tr_b16 a[2:3], v6 offset:2048
    v_mfma_f32_16x16x32_bf16 v[36:39], a[48:51], v[160:163], v[36:39]
    ds_read_b64_tr_b16 a[4:5], v6 offset:4096
    buffer_load_dwordx4 v1, s[4:7], s34 offen offset:3072 lds
    v_mfma_f32_16x16x32_bf16 v[36:39], a[52:55], v[168:171], v[36:39]
    s_waitcnt lgkmcnt(3)
    ds_read_b64_tr_b16 a[6:7], v6 offset:6144
    v_mfma_f32_16x16x32_bf16 v[36:39], a[56:59], v[176:179], v[36:39]
    ds_read_b64_tr_b16 a[8:9], v6 offset:8192
    v_mfma_f32_16x16x32_bf16 v[36:39], a[60:63], v[184:187], v[36:39]
    ds_read_b64_tr_b16 a[10:11], v6 offset:10240
    v_mfma_f32_16x16x32_bf16 v[44:47], a[32:35], v[192:195], 0
    s_add_u32 m0, s33, 128
    ds_read_b64_tr_b16 a[12:13], v6 offset:12288
    v_mfma_f32_16x16x32_bf16 v[44:47], a[36:39], v[200:203], v[44:47]
    ds_read_b64_tr_b16 a[14:15], v6 offset:14336
    buffer_load_dwordx4 v10, s[12:15], s35 offen offset:0 sc1 lds
    v_mfma_f32_16x16x32_bf16 v[44:47], a[40:43], v[208:211], v[44:47]
    ds_read_b64_tr_b16 a[16:17], v6 offset:16384
    v_mfma_f32_16x16x32_bf16 v[44:47], a[44:47], v[216:219], v[44:47]
    ds_read_b64_tr_b16 a[18:19], v6 offset:18432
    v_mfma_f32_16x16x32_bf16 v[44:47], a[48:51], v[224:227], v[44:47]
    ds_read_b64_tr_b16 a[20:21], v6 offset:20480
    v_cvt_pk_bf16_f32 v32, v32, v33
    v_mfma_f32_16x16x32_bf16 v[44:47], a[52:55], v[232:235], v[44:47]
    ds_read_b64_tr_b16 a[22:23], v6 offset:22528
    v_cvt_pk_bf16_f32 v33, v34, v35
    v_mfma_f32_16x16x32_bf16 v[44:47], a[56:59], v[240:243], v[44:47]
    s_add_u32 s58, s48, 163840
    ds_read_b64_tr_b16 a[24:25], v6 offset:24576
    v_cvt_pk_bf16_f32 v34, v36, v37
    v_mfma_f32_16x16x32_bf16 v[44:47], a[60:63], v[248:251], v[44:47]
    s_waitcnt lgkmcnt(7)
    ds_read_b64_tr_b16 a[26:27], v6 offset:26624
    v_cvt_pk_bf16_f32 v35, v38, v39
    v_mfma_f32_16x16x32_bf16 v[48:51], a[0:3], v[128:131], 0
    ds_read_b64_tr_b16 a[28:29], v6 offset:28672
    buffer_store_dwordx4 v[32:35], v1, s[12:15], s58 offen sc1
    v_mfma_f32_16x16x32_bf16 v[48:51], a[4:7], v[136:139], v[48:51]
    s_add_u32 m0, s33, 1248
    ds_read_b64_tr_b16 a[30:31], v6 offset:30720
    v_xor_b32 v7, 0x10000, v7
    v_mfma_f32_16x16x32_bf16 v[48:51], a[8:11], v[144:147], v[48:51]
    s_waitcnt lgkmcnt(4)
    ds_read_b64_tr_b16 a[32:33], v7 offset:0
    buffer_load_dwordx4 v10, s[12:15], s35 offen offset:32 sc1 lds
    v_mfma_f32_16x16x32_bf16 v[48:51], a[12:15], v[152:155], v[48:51]
    ds_read_b64_tr_b16 a[34:35], v7 offset:2048
    v_mfma_f32_16x16x32_bf16 v[48:51], a[16:19], v[160:163], v[48:51]
    ds_read_b64_tr_b16 a[36:37], v7 offset:4096
    v_cvt_pk_bf16_f32 v40, v40, v41
    v_mfma_f32_16x16x32_bf16 v[48:51], a[20:23], v[168:171], v[48:51]
    s_waitcnt lgkmcnt(3)
    ds_read_b64_tr_b16 a[38:39], v7 offset:6144
    v_cvt_pk_bf16_f32 v41, v42, v43
    v_mfma_f32_16x16x32_bf16 v[48:51], a[24:27], v[176:179], v[48:51]
    ds_read_b64_tr_b16 a[40:41], v7 offset:8192
    v_cvt_pk_bf16_f32 v42, v44, v45
    v_mfma_f32_16x16x32_bf16 v[48:51], a[28:31], v[184:187], v[48:51]
    s_add_u32 s58, s48, 1081344
    ds_read_b64_tr_b16 a[42:43], v7 offset:10240
    v_cvt_pk_bf16_f32 v43, v46, v47
    v_mfma_f32_16x16x32_bf16 v[56:59], a[0:3], v[192:195], 0
    ds_read_b64_tr_b16 a[44:45], v7 offset:12288
    buffer_store_dwordx4 v[40:43], v1, s[12:15], s58 offen sc1
    v_mfma_f32_16x16x32_bf16 v[56:59], a[4:7], v[200:203], v[56:59]
    s_add_u32 m0, s33, 2368
    ds_read_b64_tr_b16 a[46:47], v7 offset:14336
    v_mfma_f32_16x16x32_bf16 v[56:59], a[8:11], v[208:211], v[56:59]
    ds_read_b64_tr_b16 a[48:49], v7 offset:16384
    buffer_load_dwordx4 v10, s[12:15], s35 offen offset:64 sc1 lds
    v_mfma_f32_16x16x32_bf16 v[56:59], a[12:15], v[216:219], v[56:59]
    ds_read_b64_tr_b16 a[50:51], v7 offset:18432
    v_mfma_f32_16x16x32_bf16 v[56:59], a[16:19], v[224:227], v[56:59]
    ds_read_b64_tr_b16 a[52:53], v7 offset:20480
    v_mfma_f32_16x16x32_bf16 v[56:59], a[20:23], v[232:235], v[56:59]
    ds_read_b64_tr_b16 a[54:55], v7 offset:22528
    v_mfma_f32_16x16x32_bf16 v[56:59], a[24:27], v[240:243], v[56:59]
    s_add_u32 m0, s33, 3488
    ds_read_b64_tr_b16 a[56:57], v7 offset:24576
    v_mfma_f32_16x16x32_bf16 v[56:59], a[28:31], v[248:251], v[56:59]
    s_waitcnt lgkmcnt(7)
    ds_read_b64_tr_b16 a[58:59], v7 offset:26624
    buffer_load_dwordx4 v10, s[12:15], s35 offen offset:96 sc1 lds
    v_mfma_f32_16x16x32_bf16 v[52:55], a[32:35], v[128:131], 0
    ds_read_b64_tr_b16 a[60:61], v7 offset:28672
    v_mfma_f32_16x16x32_bf16 v[52:55], a[36:39], v[136:139], v[52:55]
    ds_read_b64_tr_b16 a[62:63], v7 offset:30720
    v_mfma_f32_16x16x32_bf16 v[52:55], a[40:43], v[144:147], v[52:55]
    s_waitcnt lgkmcnt(4)
    ds_read_b64_tr_b16 a[0:1], v4 offset:32768
    v_mfma_f32_16x16x32_bf16 v[52:55], a[44:47], v[152:155], v[52:55]
    ds_read_b64_tr_b16 a[2:3], v4 offset:34816
    v_mfma_f32_16x16x32_bf16 v[52:55], a[48:51], v[160:163], v[52:55]
    ds_read_b64_tr_b16 a[4:5], v4 offset:36864
    v_mfma_f32_16x16x32_bf16 v[52:55], a[52:55], v[168:171], v[52:55]
    s_waitcnt lgkmcnt(3)
    ds_read_b64_tr_b16 a[6:7], v4 offset:38912
    v_mfma_f32_16x16x32_bf16 v[52:55], a[56:59], v[176:179], v[52:55]
    ds_read_b64_tr_b16 a[8:9], v4 offset:40960
    v_mfma_f32_16x16x32_bf16 v[52:55], a[60:63], v[184:187], v[52:55]
    ds_read_b64_tr_b16 a[10:11], v4 offset:43008
    v_mfma_f32_16x16x32_bf16 v[60:63], a[32:35], v[192:195], 0
    ds_read_b64_tr_b16 a[12:13], v4 offset:45056
    v_mfma_f32_16x16x32_bf16 v[60:63], a[36:39], v[200:203], v[60:63]
    ds_read_b64_tr_b16 a[14:15], v4 offset:47104
    v_mfma_f32_16x16x32_bf16 v[60:63], a[40:43], v[208:211], v[60:63]
    ds_read_b64_tr_b16 a[16:17], v4 offset:49152
    v_mfma_f32_16x16x32_bf16 v[60:63], a[44:47], v[216:219], v[60:63]
    ds_read_b64_tr_b16 a[18:19], v4 offset:51200
    v_mfma_f32_16x16x32_bf16 v[60:63], a[48:51], v[224:227], v[60:63]
    ds_read_b64_tr_b16 a[20:21], v4 offset:53248
    v_cvt_pk_bf16_f32 v48, v48, v49
    v_mfma_f32_16x16x32_bf16 v[60:63], a[52:55], v[232:235], v[60:63]
    ds_read_b64_tr_b16 a[22:23], v4 offset:55296
    v_cvt_pk_bf16_f32 v49, v50, v51
    v_mfma_f32_16x16x32_bf16 v[60:63], a[56:59], v[240:243], v[60:63]
    s_add_u32 s58, s48, 180224
    ds_read_b64_tr_b16 a[24:25], v4 offset:57344
    v_cvt_pk_bf16_f32 v50, v52, v53
    v_mfma_f32_16x16x32_bf16 v[60:63], a[60:63], v[248:251], v[60:63]
    s_waitcnt lgkmcnt(7)
    ds_read_b64_tr_b16 a[26:27], v4 offset:59392
    v_cvt_pk_bf16_f32 v51, v54, v55
    v_mfma_f32_16x16x32_bf16 v[32:35], a[0:3], v[128:131], 0
    ds_read_b64_tr_b16 a[28:29], v4 offset:61440
    buffer_store_dwordx4 v[48:51], v1, s[12:15], s58 offen sc1
    v_mfma_f32_16x16x32_bf16 v[32:35], a[4:7], v[136:139], v[32:35]
    ds_read_b64_tr_b16 a[30:31], v4 offset:63488
    v_mfma_f32_16x16x32_bf16 v[32:35], a[8:11], v[144:147], v[32:35]
    s_waitcnt lgkmcnt(4)
    ds_read_b64_tr_b16 a[32:33], v5 offset:32768
    v_mfma_f32_16x16x32_bf16 v[32:35], a[12:15], v[152:155], v[32:35]
    ds_read_b64_tr_b16 a[34:35], v5 offset:34816
    v_mfma_f32_16x16x32_bf16 v[32:35], a[16:19], v[160:163], v[32:35]
    ds_read_b64_tr_b16 a[36:37], v5 offset:36864
    v_cvt_pk_bf16_f32 v56, v56, v57
    v_mfma_f32_16x16x32_bf16 v[32:35], a[20:23], v[168:171], v[32:35]
    s_waitcnt lgkmcnt(3)
    ds_read_b64_tr_b16 a[38:39], v5 offset:38912
    v_cvt_pk_bf16_f32 v57, v58, v59
    v_mfma_f32_16x16x32_bf16 v[32:35], a[24:27], v[176:179], v[32:35]
    ds_read_b64_tr_b16 a[40:41], v5 offset:40960
    v_cvt_pk_bf16_f32 v58, v60, v61
    v_mfma_f32_16x16x32_bf16 v[32:35], a[28:31], v[184:187], v[32:35]
    s_add_u32 s58, s48, 1097728
    ds_read_b64_tr_b16 a[42:43], v5 offset:43008
    v_cvt_pk_bf16_f32 v59, v62, v63
    v_mfma_f32_16x16x32_bf16 v[40:43], a[0:3], v[192:195], 0
    ds_read_b64_tr_b16 a[44:45], v5 offset:45056
    buffer_store_dwordx4 v[56:59], v1, s[12:15], s58 offen sc1
    v_mfma_f32_16x16x32_bf16 v[40:43], a[4:7], v[200:203], v[40:43]
    ds_read_b64_tr_b16 a[46:47], v5 offset:47104
    v_mfma_f32_16x16x32_bf16 v[40:43], a[8:11], v[208:211], v[40:43]
    ds_read_b64_tr_b16 a[48:49], v5 offset:49152
    v_mfma_f32_16x16x32_bf16 v[40:43], a[12:15], v[216:219], v[40:43]
    ds_read_b64_tr_b16 a[50:51], v5 offset:51200
    v_mfma_f32_16x16x32_bf16 v[40:43], a[16:19], v[224:227], v[40:43]
    ds_read_b64_tr_b16 a[52:53], v5 offset:53248
    v_mfma_f32_16x16x32_bf16 v[40:43], a[20:23], v[232:235], v[40:43]
    ds_read_b64_tr_b16 a[54:55], v5 offset:55296
    v_mfma_f32_16x16x32_bf16 v[40:43], a[24:27], v[240:243], v[40:43]
    ds_read_b64_tr_b16 a[56:57], v5 offset:57344
    v_mfma_f32_16x16x32_bf16 v[40:43], a[28:31], v[248:251], v[40:43]
    s_waitcnt lgkmcnt(7)
    ds_read_b64_tr_b16 a[58:59], v5 offset:59392
    v_mfma_f32_16x16x32_bf16 v[36:39], a[32:35], v[128:131], 0
    ds_read_b64_tr_b16 a[60:61], v5 offset:61440
    v_mfma_f32_16x16x32_bf16 v[36:39], a[36:39], v[136:139], v[36:39]
    ds_read_b64_tr_b16 a[62:63], v5 offset:63488
    v_mfma_f32_16x16x32_bf16 v[36:39], a[40:43], v[144:147], v[36:39]
    s_waitcnt lgkmcnt(4)
    ds_read_b64_tr_b16 a[0:1], v6 offset:32768
    v_mfma_f32_16x16x32_bf16 v[36:39], a[44:47], v[152:155], v[36:39]
    ds_read_b64_tr_b16 a[2:3], v6 offset:34816
    v_mfma_f32_16x16x32_bf16 v[36:39], a[48:51], v[160:163], v[36:39]
    ds_read_b64_tr_b16 a[4:5], v6 offset:36864
    v_mfma_f32_16x16x32_bf16 v[36:39], a[52:55], v[168:171], v[36:39]
    s_waitcnt lgkmcnt(3)
    ds_read_b64_tr_b16 a[6:7], v6 offset:38912
    v_mfma_f32_16x16x32_bf16 v[36:39], a[56:59], v[176:179], v[36:39]
    ds_read_b64_tr_b16 a[8:9], v6 offset:40960
    v_mfma_f32_16x16x32_bf16 v[36:39], a[60:63], v[184:187], v[36:39]
    ds_read_b64_tr_b16 a[10:11], v6 offset:43008
    v_mfma_f32_16x16x32_bf16 v[44:47], a[32:35], v[192:195], 0
    ds_read_b64_tr_b16 a[12:13], v6 offset:45056
    v_mfma_f32_16x16x32_bf16 v[44:47], a[36:39], v[200:203], v[44:47]
    ds_read_b64_tr_b16 a[14:15], v6 offset:47104
    v_mfma_f32_16x16x32_bf16 v[44:47], a[40:43], v[208:211], v[44:47]
    ds_read_b64_tr_b16 a[16:17], v6 offset:49152
    v_mfma_f32_16x16x32_bf16 v[44:47], a[44:47], v[216:219], v[44:47]
    ds_read_b64_tr_b16 a[18:19], v6 offset:51200
    v_mfma_f32_16x16x32_bf16 v[44:47], a[48:51], v[224:227], v[44:47]
    ds_read_b64_tr_b16 a[20:21], v6 offset:53248
    v_cvt_pk_bf16_f32 v32, v32, v33
    v_mfma_f32_16x16x32_bf16 v[44:47], a[52:55], v[232:235], v[44:47]
    ds_read_b64_tr_b16 a[22:23], v6 offset:55296
    v_cvt_pk_bf16_f32 v33, v34, v35
    v_mfma_f32_16x16x32_bf16 v[44:47], a[56:59], v[240:243], v[44:47]
    s_add_u32 s58, s48, 196608
    ds_read_b64_tr_b16 a[24:25], v6 offset:57344
    v_cvt_pk_bf16_f32 v34, v36, v37
    v_mfma_f32_16x16x32_bf16 v[44:47], a[60:63], v[248:251], v[44:47]
    s_waitcnt lgkmcnt(7)
    ds_read_b64_tr_b16 a[26:27], v6 offset:59392
    v_cvt_pk_bf16_f32 v35, v38, v39
    v_mfma_f32_16x16x32_bf16 v[48:51], a[0:3], v[128:131], 0
    ds_read_b64_tr_b16 a[28:29], v6 offset:61440
    buffer_store_dwordx4 v[32:35], v1, s[12:15], s58 offen sc1
    v_mfma_f32_16x16x32_bf16 v[48:51], a[4:7], v[136:139], v[48:51]
    ds_read_b64_tr_b16 a[30:31], v6 offset:63488
    v_mfma_f32_16x16x32_bf16 v[48:51], a[8:11], v[144:147], v[48:51]
    s_waitcnt lgkmcnt(4)
    ds_read_b64_tr_b16 a[32:33], v7 offset:32768
    v_mfma_f32_16x16x32_bf16 v[48:51], a[12:15], v[152:155], v[48:51]
    ds_read_b64_tr_b16 a[34:35], v7 offset:34816
    v_mfma_f32_16x16x32_bf16 v[48:51], a[16:19], v[160:163], v[48:51]
    ds_read_b64_tr_b16 a[36:37], v7 offset:36864
    v_cvt_pk_bf16_f32 v40, v40, v41
    v_mfma_f32_16x16x32_bf16 v[48:51], a[20:23], v[168:171], v[48:51]
    s_waitcnt lgkmcnt(3)
    ds_read_b64_tr_b16 a[38:39], v7 offset:38912
    v_cvt_pk_bf16_f32 v41, v42, v43
    v_mfma_f32_16x16x32_bf16 v[48:51], a[24:27], v[176:179], v[48:51]
    ds_read_b64_tr_b16 a[40:41], v7 offset:40960
    v_cvt_pk_bf16_f32 v42, v44, v45
    v_mfma_f32_16x16x32_bf16 v[48:51], a[28:31], v[184:187], v[48:51]
    s_add_u32 s58, s48, 1114112
    ds_read_b64_tr_b16 a[42:43], v7 offset:43008
    v_cvt_pk_bf16_f32 v43, v46, v47
    v_mfma_f32_16x16x32_bf16 v[56:59], a[0:3], v[192:195], 0
    ds_read_b64_tr_b16 a[44:45], v7 offset:45056
    buffer_store_dwordx4 v[40:43], v1, s[12:15], s58 offen sc1
    v_mfma_f32_16x16x32_bf16 v[56:59], a[4:7], v[200:203], v[56:59]
    ds_read_b64_tr_b16 a[46:47], v7 offset:47104
    v_mfma_f32_16x16x32_bf16 v[56:59], a[8:11], v[208:211], v[56:59]
    ds_read_b64_tr_b16 a[48:49], v7 offset:49152
    v_mfma_f32_16x16x32_bf16 v[56:59], a[12:15], v[216:219], v[56:59]
    ds_read_b64_tr_b16 a[50:51], v7 offset:51200
    v_mfma_f32_16x16x32_bf16 v[56:59], a[16:19], v[224:227], v[56:59]
    ds_read_b64_tr_b16 a[52:53], v7 offset:53248
    v_mfma_f32_16x16x32_bf16 v[56:59], a[20:23], v[232:235], v[56:59]
    ds_read_b64_tr_b16 a[54:55], v7 offset:55296
    v_mfma_f32_16x16x32_bf16 v[56:59], a[24:27], v[240:243], v[56:59]
    ds_read_b64_tr_b16 a[56:57], v7 offset:57344
    v_mfma_f32_16x16x32_bf16 v[56:59], a[28:31], v[248:251], v[56:59]
    s_waitcnt lgkmcnt(7)
    ds_read_b64_tr_b16 a[58:59], v7 offset:59392
    v_mfma_f32_16x16x32_bf16 v[52:55], a[32:35], v[128:131], 0
    ds_read_b64_tr_b16 a[60:61], v7 offset:61440
    v_mfma_f32_16x16x32_bf16 v[52:55], a[36:39], v[136:139], v[52:55]
    ds_read_b64_tr_b16 a[62:63], v7 offset:63488
    v_mfma_f32_16x16x32_bf16 v[52:55], a[40:43], v[144:147], v[52:55]
    s_waitcnt lgkmcnt(4)
    v_mfma_f32_16x16x32_bf16 v[52:55], a[44:47], v[152:155], v[52:55]
    ds_write_b32 v11, v13 offset:0
    v_mfma_f32_16x16x32_bf16 v[52:55], a[48:51], v[160:163], v[52:55]
    ds_write_b32 v11, v13 offset:1152
    v_mfma_f32_16x16x32_bf16 v[52:55], a[52:55], v[168:171], v[52:55]
    s_waitcnt lgkmcnt(0)
    ds_write_b32 v11, v13 offset:2304
    v_mfma_f32_16x16x32_bf16 v[52:55], a[56:59], v[176:179], v[52:55]
    ds_write_b32 v11, v13 offset:3456
    v_mfma_f32_16x16x32_bf16 v[52:55], a[60:63], v[184:187], v[52:55]
    ds_write_b32 v12, v13 offset:4608
    v_mfma_f32_16x16x32_bf16 v[60:63], a[32:35], v[192:195], 0
    v_mfma_f32_16x16x32_bf16 v[60:63], a[36:39], v[200:203], v[60:63]
    v_mfma_f32_16x16x32_bf16 v[60:63], a[40:43], v[208:211], v[60:63]
    v_mfma_f32_16x16x32_bf16 v[60:63], a[44:47], v[216:219], v[60:63]
    v_mfma_f32_16x16x32_bf16 v[60:63], a[48:51], v[224:227], v[60:63]
    v_mfma_f32_16x16x32_bf16 v[60:63], a[52:55], v[232:235], v[60:63]
    v_mfma_f32_16x16x32_bf16 v[60:63], a[56:59], v[240:243], v[60:63]
    v_mfma_f32_16x16x32_bf16 v[60:63], a[60:63], v[248:251], v[60:63]
    s_nop 4
    v_cvt_pk_bf16_f32 v48, v48, v49
    v_cvt_pk_bf16_f32 v49, v50, v51
    v_cvt_pk_bf16_f32 v50, v52, v53
    v_cvt_pk_bf16_f32 v51, v54, v55
    s_add_u32 s58, s48, 212992
    buffer_store_dwordx4 v[48:51], v1, s[12:15], s58 offen sc1
    v_cvt_pk_bf16_f32 v56, v56, v57
    v_cvt_pk_bf16_f32 v57, v58, v59
    v_cvt_pk_bf16_f32 v58, v60, v61
    v_cvt_pk_bf16_f32 v59, v62, v63
    s_add_u32 s58, s48, 1130496
    buffer_store_dwordx4 v[56:59], v1, s[12:15], s58 offen sc1
    s_cmp_lt_u32 s28, 14
    s_cbranch_scc1 L_tile
    s_waitcnt vmcnt(0)
    s_barrier
    s_cmp_lg_u32 s3, 0
    s_cbranch_scc1 L_pub4
    v_mov_b32 v11, 0
    s_mov_b64 exec, 1
    buffer_store_dword v11, v11, s[12:15], s93 offen sc1
    s_mov_b64 exec, -1
L_pub4:
    s_branch L_fin
L_tile:
    v_mov_b32 v21, v9
    s_cmp_lg_u32 s27, 0
    s_cbranch_scc1 L_noconv
    v_and_b32 v22, 15, v0
    v_lshrrev_b32 v23, 4, v0
    v_lshl_add_u32 v18, v22, 3, s33
    v_lshl_add_u32 v16, v23, 4, v18
    v_lshl_add_u32 v18, v23, 1, v18
    v_and_b32 v17, 3, v0
    v_bfe_u32 v24, v0, 2, 2
    v_sub_u32 v17, v17, v24
    v_lshlrev_b32 v24, 3, v23
    v_sub_u32 v17, v17, v24
    v_add_u32 v17, 32, v17
    v_lshl_add_u32 v17, v17, 3, s33
    v_lshlrev_b32 v20, 5, v22
    v_lshl_add_u32 v20, v23, 3, v20
    v_add_u32 v24, -1, v0
    v_and_b32 v24, 15, v24
    v_add_u32 v24, 48, v24
    v_add_u32 v19, -16, v0
    v_cmp_gt_u32 vcc, 16, v0
    v_accvgpr_read_b32 v21, a245
    s_add_u32 s34, s34, 90177536
    v_cndmask_b32 v19, v19, v24, vcc
    v_lshlrev_b32 v19, 2, v19
    v_cmp_eq_u32 vcc, 63, v0
    s_lshl_b32 s30, s31, 16
    s_and_b32 s31, s31, 0xffff0000
    s_bitcmp1_b32 s3, 0
    s_cselect_b32 s31, s31, s30
    v_mov_b64 v[224:225], 0
    v_mov_b64 v[226:227], 0
    v_mov_b64 v[228:229], 0
    v_mov_b64 v[230:231], 0
    v_mov_b64 v[232:233], 0
    v_mov_b64 v[234:235], 0
    v_mov_b64 v[236:237], 0
    v_mov_b64 v[238:239], 0
    v_mov_b64 v[240:241], 0
    v_mov_b64 v[242:243], 0
    v_mov_b64 v[244:245], 0
    v_mov_b64 v[246:247], 0
    v_mov_b64 v[248:249], 0
    v_mov_b64 v[250:251], 0
    v_mov_b64 v[252:253], 0
    v_mov_b64 v[254:255], 0
    s_waitcnt vmcnt(6) lgkmcnt(0)
    ds_read_b64_tr_b16 v[160:161], v17 offset:4608
    ds_read_b64_tr_b16 v[162:163], v17 offset:4576
    ds_read_b64_tr_b16 v[164:165], v17 offset:4864
    ds_read_b64_tr_b16 v[166:167], v17 offset:4832
    ds_read_b64 a[4:5], v16 offset:72
    ds_read_b64 a[6:7], v16 offset:80
    ds_read_b64 a[0:1], v16 offset:8
    ds_read_b64 a[2:3], v16 offset:16
    s_waitcnt lgkmcnt(6)
    ds_read_b64 a[68:69], v16 offset:1224
    ds_read_b64 a[70:71], v16 offset:1232
    ds_read_b64 a[64:65], v16 offset:1160
    ds_read_b64 a[66:67], v16 offset:1168
    ds_read_b64 a[132:133], v16 offset:2376
    ds_read_b64 a[134:135], v16 offset:2384
    ds_read_b64 a[128:129], v16 offset:2312
    ds_read_b64 a[130:131], v16 offset:2320
    s_waitcnt lgkmcnt(6)
    ds_read_b64 a[196:197], v16 offset:3528
    ds_read_b64 a[198:199], v16 offset:3536
    ds_read_b64 a[192:193], v16 offset:3464
    ds_read_b64 a[194:195], v16 offset:3472
    ds_read_b64_tr_b16 v[168:169], v17 offset:5120
    ds_read_b64_tr_b16 v[170:171], v17 offset:5088
    ds_read_b64_tr_b16 v[172:173], v17 offset:5376
    ds_read_b64_tr_b16 v[174:175], v17 offset:5344
    s_waitcnt lgkmcnt(6)
    ds_read_b64 a[12:13], v16 offset:200
    ds_read_b64 a[14:15], v16 offset:208
    ds_read_b64 a[8:9], v16 offset:136
    ds_read_b64 a[10:11], v16 offset:144
    ds_read_b64 a[76:77], v16 offset:1352
    ds_read_b64 a[78:79], v16 offset:1360
    ds_read_b64 a[72:73], v16 offset:1288
    ds_read_b64 a[74:75], v16 offset:1296
    s_waitcnt lgkmcnt(6)
    ds_read_b64 a[140:141], v16 offset:2504
    ds_read_b64 a[142:143], v16 offset:2512
    ds_read_b64 a[136:137], v16 offset:2440
    ds_read_b64 a[138:139], v16 offset:2448
    ds_read_b64 a[204:205], v16 offset:3656
    ds_read_b64 a[206:207], v16 offset:3664
    ds_read_b64 a[200:201], v16 offset:3592
    ds_read_b64 a[202:203], v16 offset:3600
    s_waitcnt lgkmcnt(6)
    ds_read_b64_tr_b16 v[176:177], v17 offset:5632
    ds_read_b64_tr_b16 v[178:179], v17 offset:5600
    ds_read_b64_tr_b16 v[180:181], v17 offset:5888
    ds_read_b64_tr_b16 v[182:183], v17 offset:5856
    s_waitcnt lgkmcnt(0)
    v_mfma_f32_16x16x32_bf16 v[32:35], v[160:163], a[4:7], 0
    ds_read_b64 a[20:21], v16 offset:328
    v_mfma_f32_16x16x32_bf16 v[32:35], v[164:167], a[0:3], v[32:35]
    ds_read_b64 a[22:23], v16 offset:336
    v_mfma_f32_16x16x32_bf16 v[36:39], v[160:163], a[68:71], 0
    ds_read_b64 a[16:17], v16 offset:264
    v_mfma_f32_16x16x32_bf16 v[36:39], v[164:167], a[64:67], v[36:39]
    ds_read_b64 a[18:19], v16 offset:272
    v_mfma_f32_16x16x32_bf16 v[40:43], v[160:163], a[132:135], 0
    ds_read_b64 a[84:85], v16 offset:1480
    v_mfma_f32_16x16x32_bf16 v[40:43], v[164:167], a[128:131], v[40:43]
    ds_read_b64 a[86:87], v16 offset:1488
    v_mfma_f32_16x16x32_bf16 v[44:47], v[160:163], a[196:199], 0
    ds_read_b64 a[80:81], v16 offset:1416
    v_mfma_f32_16x16x32_bf16 v[44:47], v[164:167], a[192:195], v[44:47]
    ds_read_b64 a[82:83], v16 offset:1424
    v_mfma_f32_16x16x32_bf16 v[48:51], v[160:163], a[12:15], 0
    ds_read_b64 a[148:149], v16 offset:2632
    v_mfma_f32_16x16x32_bf16 v[48:51], v[164:167], a[8:11], v[48:51]
    ds_read_b64 a[150:151], v16 offset:2640
    v_mfma_f32_16x16x32_bf16 v[48:51], v[168:171], a[4:7], v[48:51]
    ds_read_b64 a[144:145], v16 offset:2568
    v_mfma_f32_16x16x32_bf16 v[48:51], v[172:175], a[0:3], v[48:51]
    ds_read_b64 a[146:147], v16 offset:2576
    v_mfma_f32_16x16x32_bf16 v[52:55], v[160:163], a[76:79], 0
    ds_read_b64 a[212:213], v16 offset:3784
    v_mfma_f32_16x16x32_bf16 v[52:55], v[164:167], a[72:75], v[52:55]
    ds_read_b64 a[214:215], v16 offset:3792
    v_mfma_f32_16x16x32_bf16 v[52:55], v[168:171], a[68:71], v[52:55]
    ds_read_b64 a[208:209], v16 offset:3720
    v_mfma_f32_16x16x32_bf16 v[52:55], v[172:175], a[64:67], v[52:55]
    s_waitcnt vmcnt(0)
    ds_read_b64 a[210:211], v16 offset:3728
    v_mfma_f32_16x16x32_bf16 v[56:59], v[160:163], a[140:143], 0
    s_barrier
    ds_read_b64_tr_b16 v[184:185], v17 offset:6144
    v_mfma_f32_16x16x32_bf16 v[56:59], v[164:167], a[136:139], v[56:59]
    ds_read_b64_tr_b16 v[186:187], v17 offset:6112
    buffer_store_dword v21, v21, s[12:15], s93 offen sc1
    v_mfma_f32_16x16x32_bf16 v[56:59], v[168:171], a[132:135], v[56:59]
    ds_read_b64_tr_b16 v[188:189], v17 offset:6400
    v_mfma_f32_16x16x32_bf16 v[56:59], v[172:175], a[128:131], v[56:59]
    ds_read_b64_tr_b16 v[190:191], v17 offset:6368
    v_mfma_f32_16x16x32_bf16 v[60:63], v[160:163], a[204:207], 0
    ds_read_b64 a[28:29], v16 offset:456
    v_mfma_f32_16x16x32_bf16 v[60:63], v[164:167], a[200:203], v[60:63]
    ds_read_b64 a[30:31], v16 offset:464
    v_mfma_f32_16x16x32_bf16 v[60:63], v[168:171], a[196:199], v[60:63]
    ds_read_b64 a[24:25], v16 offset:392
    v_mfma_f32_16x16x32_bf16 v[60:63], v[172:175], a[192:195], v[60:63]
    s_waitcnt lgkmcnt(15)
    ds_read_b64 a[26:27], v16 offset:400
    v_mfma_f32_16x16x32_bf16 v[64:67], v[160:163], a[20:23], 0
    ds_read_b64 a[92:93], v16 offset:1608
    v_mfma_f32_16x16x32_bf16 v[64:67], v[164:167], a[16:19], v[64:67]
    ds_read_b64 a[94:95], v16 offset:1616
    v_mfma_f32_16x16x32_bf16 v[64:67], v[168:171], a[12:15], v[64:67]
    ds_read_b64 a[88:89], v16 offset:1544
    v_mfma_f32_16x16x32_bf16 v[64:67], v[172:175], a[8:11], v[64:67]
    ds_read_b64 a[90:91], v16 offset:1552
    v_mfma_f32_16x16x32_bf16 v[64:67], v[176:179], a[4:7], v[64:67]
    ds_read_b64 a[156:157], v16 offset:2760
    v_mfma_f32_16x16x32_bf16 v[64:67], v[180:183], a[0:3], v[64:67]
    ds_read_b64 a[158:159], v16 offset:2768
    v_mfma_f32_16x16x32_bf16 v[68:71], v[160:163], a[84:87], 0
    ds_read_b64 a[152:153], v16 offset:2696
    v_mfma_f32_16x16x32_bf16 v[68:71], v[164:167], a[80:83], v[68:71]
    ds_read_b64 a[154:155], v16 offset:2704
    v_mfma_f32_16x16x32_bf16 v[68:71], v[168:171], a[76:79], v[68:71]
    ds_read_b64 a[220:221], v16 offset:3912
    v_mfma_f32_16x16x32_bf16 v[68:71], v[172:175], a[72:75], v[68:71]
    ds_read_b64 a[222:223], v16 offset:3920
    v_mfma_f32_16x16x32_bf16 v[68:71], v[176:179], a[68:71], v[68:71]
    ds_read_b64 a[216:217], v16 offset:3848
    v_mfma_f32_16x16x32_bf16 v[68:71], v[180:183], a[64:67], v[68:71]
    s_waitcnt lgkmcnt(15)
    ds_read_b64 a[218:219], v16 offset:3856
    v_mfma_f32_16x16x32_bf16 v[72:75], v[160:163], a[148:151], 0
    ds_read_b64_tr_b16 v[192:193], v17 offset:6656
    v_mfma_f32_16x16x32_bf16 v[72:75], v[164:167], a[144:147], v[72:75]
    ds_read_b64_tr_b16 v[194:195], v17 offset:6624
    v_mfma_f32_16x16x32_bf16 v[72:75], v[168:171], a[140:143], v[72:75]
    ds_read_b64_tr_b16 v[196:197], v17 offset:6912
    v_mfma_f32_16x16x32_bf16 v[72:75], v[172:175], a[136:139], v[72:75]
    ds_read_b64_tr_b16 v[198:199], v17 offset:6880
    v_mfma_f32_16x16x32_bf16 v[72:75], v[176:179], a[132:135], v[72:75]
    ds_read_b64 a[36:37], v16 offset:584
    v_mfma_f32_16x16x32_bf16 v[72:75], v[180:183], a[128:131], v[72:75]
    ds_read_b64 a[38:39], v16 offset:592
    v_mfma_f32_16x16x32_bf16 v[76:79], v[160:163], a[212:215], 0
    ds_read_b64 a[32:33], v16 offset:520
    v_mfma_f32_16x16x32_bf16 v[76:79], v[164:167], a[208:211], v[76:79]
    ds_read_b64 a[34:35], v16 offset:528
    v_mfma_f32_16x16x32_bf16 v[76:79], v[168:171], a[204:207], v[76:79]
    ds_read_b64 a[100:101], v16 offset:1736
    v_mfma_f32_16x16x32_bf16 v[76:79], v[172:175], a[200:203], v[76:79]
    ds_read_b64 a[102:103], v16 offset:1744
    v_mfma_f32_16x16x32_bf16 v[76:79], v[176:179], a[196:199], v[76:79]
    ds_read_b64 a[96:97], v16 offset:1672
    v_mfma_f32_16x16x32_bf16 v[76:79], v[180:183], a[192:195], v[76:79]
    s_waitcnt lgkmcnt(15)
    ds_read_b64 a[98:99], v16 offset:1680
    v_mfma_f32_16x16x32_bf16 v[80:83], v[160:163], a[28:31], 0
    ds_read_b64 a[164:165], v16 offset:2888
    v_mfma_f32_16x16x32_bf16 v[80:83], v[164:167], a[24:27], v[80:83]
    ds_read_b64 a[166:167], v16 offset:2896
    v_mfma_f32_16x16x32_bf16 v[80:83], v[168:171], a[20:23], v[80:83]
    ds_read_b64 a[160:161], v16 offset:2824
    v_mfma_f32_16x16x32_bf16 v[80:83], v[172:175], a[16:19], v[80:83]
    ds_read_b64 a[162:163], v16 offset:2832
    v_mfma_f32_16x16x32_bf16 v[80:83], v[176:179], a[12:15], v[80:83]
    ds_read_b64 a[228:229], v16 offset:4040
    v_mfma_f32_16x16x32_bf16 v[80:83], v[180:183], a[8:11], v[80:83]
    ds_read_b64 a[230:231], v16 offset:4048
    v_mfma_f32_16x16x32_bf16 v[80:83], v[184:187], a[4:7], v[80:83]
    ds_read_b64 a[224:225], v16 offset:3976
    v_mfma_f32_16x16x32_bf16 v[80:83], v[188:191], a[0:3], v[80:83]
    ds_read_b64 a[226:227], v16 offset:3984
    v_mfma_f32_16x16x32_bf16 v[84:87], v[160:163], a[92:95], 0
    ds_read_b64_tr_b16 v[200:201], v17 offset:7168
    v_mfma_f32_16x16x32_bf16 v[84:87], v[164:167], a[88:91], v[84:87]
    ds_read_b64_tr_b16 v[202:203], v17 offset:7136
    v_mfma_f32_16x16x32_bf16 v[84:87], v[168:171], a[84:87], v[84:87]
    ds_read_b64_tr_b16 v[204:205], v17 offset:7424
    v_mfma_f32_16x16x32_bf16 v[84:87], v[172:175], a[80:83], v[84:87]
    ds_read_b64_tr_b16 v[206:207], v17 offset:7392
    v_mfma_f32_16x16x32_bf16 v[84:87], v[176:179], a[76:79], v[84:87]
    ds_read_b64 a[44:45], v16 offset:712
    v_mfma_f32_16x16x32_bf16 v[84:87], v[180:183], a[72:75], v[84:87]
    ds_read_b64 a[46:47], v16 offset:720
    v_mfma_f32_16x16x32_bf16 v[84:87], v[184:187], a[68:71], v[84:87]
    ds_read_b64 a[40:41], v16 offset:648
    v_mfma_f32_16x16x32_bf16 v[84:87], v[188:191], a[64:67], v[84:87]
    ds_read_b64 a[42:43], v16 offset:656
    v_mfma_f32_16x16x32_bf16 v[88:91], v[160:163], a[156:159], 0
    ds_read_b64 a[108:109], v16 offset:1864
    v_mfma_f32_16x16x32_bf16 v[88:91], v[164:167], a[152:155], v[88:91]
    ds_read_b64 a[110:111], v16 offset:1872
    v_mfma_f32_16x16x32_bf16 v[88:91], v[168:171], a[148:151], v[88:91]
    ds_read_b64 a[104:105], v16 offset:1800
    v_mfma_f32_16x16x32_bf16 v[88:91], v[172:175], a[144:147], v[88:91]
    ds_read_b64 a[106:107], v16 offset:1808
    v_mfma_f32_16x16x32_bf16 v[88:91], v[176:179], a[140:143], v[88:91]
    ds_read_b64 a[172:173], v16 offset:3016
    v_mfma_f32_16x16x32_bf16 v[88:91], v[180:183], a[136:139], v[88:91]
    ds_read_b64 a[174:175], v16 offset:3024
    v_mfma_f32_16x16x32_bf16 v[88:91], v[184:187], a[132:135], v[88:91]
    ds_read_b64 a[168:169], v16 offset:2952
    v_mfma_f32_16x16x32_bf16 v[88:91], v[188:191], a[128:131], v[88:91]
    s_waitcnt lgkmcnt(15)
    ds_read_b64 a[170:171], v16 offset:2960
    v_mfma_f32_16x16x32_bf16 v[92:95], v[160:163], a[220:223], 0
    ds_read_b64 a[236:237], v16 offset:4168
    v_mfma_f32_16x16x32_bf16 v[92:95], v[164:167], a[216:219], v[92:95]
    ds_read_b64 a[238:239], v16 offset:4176
    v_mfma_f32_16x16x32_bf16 v[92:95], v[168:171], a[212:215], v[92:95]
    ds_read_b64 a[232:233], v16 offset:4104
    v_mfma_f32_16x16x32_bf16 v[92:95], v[172:175], a[208:211], v[92:95]
    ds_read_b64 a[234:235], v16 offset:4112
    v_mfma_f32_16x16x32_bf16 v[92:95], v[176:179], a[204:207], v[92:95]
    ds_read_b64_tr_b16 v[208:209], v17 offset:7680
    v_mfma_f32_16x16x32_bf16 v[92:95], v[180:183], a[200:203], v[92:95]
    ds_read_b64_tr_b16 v[210:211], v17 offset:7648
    v_mfma_f32_16x16x32_bf16 v[92:95], v[184:187], a[196:199], v[92:95]
    ds_read_b64_tr_b16 v[212:213], v17 offset:7936
    v_mfma_f32_16x16x32_bf16 v[92:95], v[188:191], a[192:195], v[92:95]
    ds_read_b64_tr_b16 v[214:215], v17 offset:7904
    v_mfma_f32_16x16x32_bf16 v[96:99], v[160:163], a[36:39], 0
    ds_read_b64 a[52:53], v16 offset:840
    v_mfma_f32_16x16x32_bf16 v[96:99], v[164:167], a[32:35], v[96:99]
    ds_read_b64 a[54:55], v16 offset:848
    v_mfma_f32_16x16x32_bf16 v[96:99], v[168:171], a[28:31], v[96:99]
    ds_read_b64 a[48:49], v16 offset:776
    v_mfma_f32_16x16x32_bf16 v[96:99], v[172:175], a[24:27], v[96:99]
    ds_read_b64 a[50:51], v16 offset:784
    v_mfma_f32_16x16x32_bf16 v[96:99], v[176:179], a[20:23], v[96:99]
    ds_read_b64 a[116:117], v16 offset:1992
    v_mfma_f32_16x16x32_bf16 v[96:99], v[180:183], a[16:19], v[96:99]
    ds_read_b64 a[118:119], v16 offset:2000
    v_mfma_f32_16x16x32_bf16 v[96:99], v[184:187], a[12:15], v[96:99]
    ds_read_b64 a[112:113], v16 offset:1928
    v_add_f32 v39, v39, v42
    v_mfma_f32_16x16x32_bf16 v[96:99], v[188:191], a[8:11], v[96:99]
    ds_read_b64 a[114:115], v16 offset:1936
    v_add_f32 v43, v43, v46
    v_mfma_f32_16x16x32_bf16 v[96:99], v[192:195], a[4:7], v[96:99]
    ds_read_b64 a[180:181], v16 offset:3144
    v_add_f32 v39, v39, v45
    v_mfma_f32_16x16x32_bf16 v[96:99], v[196:199], a[0:3], v[96:99]
    ds_read_b64 a[182:183], v16 offset:3152
    v_cndmask_b32_e64 v224, v39, 0, vcc
    v_mfma_f32_16x16x32_bf16 v[100:103], v[160:163], a[100:103], 0
    ds_read_b64 a[176:177], v16 offset:3080
    v_cndmask_b32_e64 v225, v43, 0, vcc
    v_mfma_f32_16x16x32_bf16 v[100:103], v[164:167], a[96:99], v[100:103]
    ds_read_b64 a[178:179], v16 offset:3088
    v_cndmask_b32_e64 v226, v47, 0, vcc
    v_mfma_f32_16x16x32_bf16 v[100:103], v[168:171], a[92:95], v[100:103]
    ds_read_b64 a[244:245], v16 offset:4296
    v_add_f32 v33, v33, v36
    v_mfma_f32_16x16x32_bf16 v[100:103], v[172:175], a[88:91], v[100:103]
    ds_read_b64 a[246:247], v16 offset:4304
    v_add_f32 v34, v34, v37
    v_mfma_f32_16x16x32_bf16 v[100:103], v[176:179], a[84:87], v[100:103]
    ds_read_b64 a[240:241], v16 offset:4232
    v_add_f32 v35, v35, v38
    v_mfma_f32_16x16x32_bf16 v[100:103], v[180:183], a[80:83], v[100:103]
    ds_read_b64 a[242:243], v16 offset:4240
    v_add_f32 v34, v34, v40
    v_mfma_f32_16x16x32_bf16 v[100:103], v[184:187], a[76:79], v[100:103]
    ds_read_b64_tr_b16 v[216:217], v17 offset:8192
    v_add_f32 v35, v35, v41
    v_mfma_f32_16x16x32_bf16 v[100:103], v[188:191], a[72:75], v[100:103]
    ds_read_b64_tr_b16 v[218:219], v17 offset:8160
    v_add_f32 v35, v35, v44
    v_mfma_f32_16x16x32_bf16 v[100:103], v[192:195], a[68:71], v[100:103]
    ds_read_b64_tr_b16 v[220:221], v17 offset:8448
    v_add_f32 v55, v55, v58
    v_mfma_f32_16x16x32_bf16 v[100:103], v[196:199], a[64:67], v[100:103]
    ds_read_b64_tr_b16 v[222:223], v17 offset:8416
    v_add_f32 v59, v59, v62
    v_mfma_f32_16x16x32_bf16 v[104:107], v[160:163], a[164:167], 0
    ds_read_b64 a[60:61], v16 offset:968
    v_add_f32 v55, v55, v61
    v_mfma_f32_16x16x32_bf16 v[104:107], v[164:167], a[160:163], v[104:107]
    ds_read_b64 a[62:63], v16 offset:976
    v_cndmask_b32_e64 v232, v55, v39, vcc
    v_mfma_f32_16x16x32_bf16 v[104:107], v[168:171], a[156:159], v[104:107]
    ds_read_b64 a[56:57], v16 offset:904
    v_cndmask_b32_e64 v233, v59, v43, vcc
    v_mfma_f32_16x16x32_bf16 v[104:107], v[172:175], a[152:155], v[104:107]
    ds_read_b64 a[58:59], v16 offset:912
    v_cndmask_b32_e64 v234, v63, v47, vcc
    v_mfma_f32_16x16x32_bf16 v[104:107], v[176:179], a[148:151], v[104:107]
    ds_read_b64 a[124:125], v16 offset:2120
    v_add_f32 v49, v49, v52
    v_mfma_f32_16x16x32_bf16 v[104:107], v[180:183], a[144:147], v[104:107]
    ds_read_b64 a[126:127], v16 offset:2128
    v_add_f32 v50, v50, v53
    v_mfma_f32_16x16x32_bf16 v[104:107], v[184:187], a[140:143], v[104:107]
    ds_read_b64 a[120:121], v16 offset:2056
    v_add_f32 v51, v51, v54
    v_mfma_f32_16x16x32_bf16 v[104:107], v[188:191], a[136:139], v[104:107]
    ds_read_b64 a[122:123], v16 offset:2064
    v_add_f32 v50, v50, v56
    v_mfma_f32_16x16x32_bf16 v[104:107], v[192:195], a[132:135], v[104:107]
    ds_read_b64 a[188:189], v16 offset:3272
    v_add_f32 v51, v51, v57
    v_mfma_f32_16x16x32_bf16 v[104:107], v[196:199], a[128:131], v[104:107]
    ds_read_b64 a[190:191], v16 offset:3280
    v_add_f32 v51, v51, v60
    v_mfma_f32_16x16x32_bf16 v[108:111], v[160:163], a[228:231], 0
    ds_read_b64 a[184:185], v16 offset:3208
    v_add_f32 v71, v71, v74
    v_mfma_f32_16x16x32_bf16 v[108:111], v[164:167], a[224:227], v[108:111]
    ds_read_b64 a[186:187], v16 offset:3216
    v_add_f32 v75, v75, v78
    v_mfma_f32_16x16x32_bf16 v[108:111], v[168:171], a[220:223], v[108:111]
    ds_read_b64 v[28:29], v16 offset:4424
    v_add_f32 v71, v71, v77
    v_mfma_f32_16x16x32_bf16 v[108:111], v[172:175], a[216:219], v[108:111]
    ds_read_b64 v[30:31], v16 offset:4432
    v_cndmask_b32_e64 v240, v71, v55, vcc
    v_mfma_f32_16x16x32_bf16 v[108:111], v[176:179], a[212:215], v[108:111]
    ds_read_b64 a[248:249], v16 offset:4360
    v_cndmask_b32_e64 v241, v75, v59, vcc
    v_mfma_f32_16x16x32_bf16 v[108:111], v[180:183], a[208:211], v[108:111]
    ds_read_b64 a[250:251], v16 offset:4368
    v_cndmask_b32_e64 v242, v79, v63, vcc
    v_mfma_f32_16x16x32_bf16 v[108:111], v[184:187], a[204:207], v[108:111]
    ds_bpermute_b32 v224, v19, v224
    v_add_f32 v65, v65, v68
    v_mfma_f32_16x16x32_bf16 v[108:111], v[188:191], a[200:203], v[108:111]
    ds_bpermute_b32 v225, v19, v225
    v_add_f32 v66, v66, v69
    v_mfma_f32_16x16x32_bf16 v[108:111], v[192:195], a[196:199], v[108:111]
    ds_bpermute_b32 v226, v19, v226
    v_add_f32 v67, v67, v70
    v_mfma_f32_16x16x32_bf16 v[108:111], v[196:199], a[192:195], v[108:111]
    s_waitcnt lgkmcnt(15)
    ds_read_u16_d16_hi v228, v18 offset:128
    v_add_f32 v66, v66, v72
    v_mfma_f32_16x16x32_bf16 v[112:115], v[160:163], a[44:47], 0
    ds_read_u16_d16_hi v229, v18 offset:1280
    v_add_f32 v67, v67, v73
    v_mfma_f32_16x16x32_bf16 v[112:115], v[164:167], a[40:43], v[112:115]
    ds_read_u16_d16_hi v230, v18 offset:2432
    v_add_f32 v67, v67, v76
    v_mfma_f32_16x16x32_bf16 v[112:115], v[168:171], a[36:39], v[112:115]
    ds_read_u16_d16_hi v231, v18 offset:3584
    v_add_f32 v87, v87, v90
    v_mfma_f32_16x16x32_bf16 v[112:115], v[172:175], a[32:35], v[112:115]
    ds_bpermute_b32 v232, v19, v232
    v_add_f32 v91, v91, v94
    v_mfma_f32_16x16x32_bf16 v[112:115], v[176:179], a[28:31], v[112:115]
    ds_bpermute_b32 v233, v19, v233
    v_add_f32 v87, v87, v93
    v_mfma_f32_16x16x32_bf16 v[112:115], v[180:183], a[24:27], v[112:115]
    ds_bpermute_b32 v234, v19, v234
    v_cndmask_b32_e64 v248, v87, v71, vcc
    v_mfma_f32_16x16x32_bf16 v[112:115], v[184:187], a[20:23], v[112:115]
    ds_read_u16_d16_hi v236, v18 offset:256
    v_cndmask_b32_e64 v249, v91, v75, vcc
    v_mfma_f32_16x16x32_bf16 v[112:115], v[188:191], a[16:19], v[112:115]
    ds_read_u16_d16_hi v237, v18 offset:1408
    v_cndmask_b32_e64 v250, v95, v79, vcc
    v_mfma_f32_16x16x32_bf16 v[112:115], v[192:195], a[12:15], v[112:115]
    s_waitcnt lgkmcnt(10)
    v_add_f32 v32, v32, v224
    v_add_f32 v33, v33, v225
    v_mfma_f32_16x16x32_bf16 v[112:115], v[196:199], a[8:11], v[112:115]
    s_waitcnt lgkmcnt(8)
    v_add_f32 v34, v34, v226
    v_fmac_f32 v32, s31, v228
    v_mfma_f32_16x16x32_bf16 v[112:115], v[200:203], a[4:7], v[112:115]
    s_waitcnt lgkmcnt(6)
    v_fmac_f32 v33, s31, v229
    v_fmac_f32 v34, s31, v230
    v_mfma_f32_16x16x32_bf16 v[112:115], v[204:207], a[0:3], v[112:115]
    s_waitcnt lgkmcnt(5)
    v_fmac_f32 v35, s31, v231
    v_cvt_pk_bf16_f32 v32, v32, v33
    v_mfma_f32_16x16x32_bf16 v[116:119], v[160:163], a[108:111], 0
    ds_read_u16_d16_hi v238, v18 offset:2560
    v_cvt_pk_bf16_f32 v33, v34, v35
    v_mfma_f32_16x16x32_bf16 v[116:119], v[164:167], a[104:107], v[116:119]
    buffer_store_dwordx2 v[32:33], v20, s[12:15], s34 offen offset:0 sc1
    v_mfma_f32_16x16x32_bf16 v[116:119], v[168:171], a[100:103], v[116:119]
    ds_read_u16_d16_hi v239, v18 offset:3712
    v_add_f32 v81, v81, v84
    v_mfma_f32_16x16x32_bf16 v[116:119], v[172:175], a[96:99], v[116:119]
    ds_bpermute_b32 v240, v19, v240
    v_add_f32 v82, v82, v85
    v_mfma_f32_16x16x32_bf16 v[116:119], v[176:179], a[92:95], v[116:119]
    ds_bpermute_b32 v241, v19, v241
    v_add_f32 v83, v83, v86
    v_mfma_f32_16x16x32_bf16 v[116:119], v[180:183], a[88:91], v[116:119]
    ds_bpermute_b32 v242, v19, v242
    v_add_f32 v82, v82, v88
    v_mfma_f32_16x16x32_bf16 v[116:119], v[184:187], a[84:87], v[116:119]
    ds_read_u16_d16_hi v244, v18 offset:384
    v_add_f32 v83, v83, v89
    v_mfma_f32_16x16x32_bf16 v[116:119], v[188:191], a[80:83], v[116:119]
    ds_read_u16_d16_hi v245, v18 offset:1536
    v_add_f32 v83, v83, v92
    v_mfma_f32_16x16x32_bf16 v[116:119], v[192:195], a[76:79], v[116:119]
    s_waitcnt lgkmcnt(10)
    v_add_f32 v48, v48, v232
    v_add_f32 v49, v49, v233
    v_mfma_f32_16x16x32_bf16 v[116:119], v[196:199], a[72:75], v[116:119]
    s_waitcnt lgkmcnt(8)
    v_add_f32 v50, v50, v234
    v_fmac_f32 v48, s31, v236
    v_mfma_f32_16x16x32_bf16 v[116:119], v[200:203], a[68:71], v[116:119]
    s_waitcnt lgkmcnt(6)
    v_fmac_f32 v49, s31, v237
    v_fmac_f32 v50, s31, v238
    v_mfma_f32_16x16x32_bf16 v[116:119], v[204:207], a[64:67], v[116:119]
    s_waitcnt lgkmcnt(5)
    v_fmac_f32 v51, s31, v239
    v_cvt_pk_bf16_f32 v48, v48, v49
    v_mfma_f32_16x16x32_bf16 v[120:123], v[160:163], a[172:175], 0
    ds_read_u16_d16_hi v246, v18 offset:2688
    v_cvt_pk_bf16_f32 v49, v50, v51
    v_mfma_f32_16x16x32_bf16 v[120:123], v[164:167], a[168:171], v[120:123]
    buffer_store_dwordx2 v[48:49], v20, s[12:15], s34 offen offset:512 sc1
    v_mfma_f32_16x16x32_bf16 v[120:123], v[168:171], a[164:167], v[120:123]
    ds_read_u16_d16_hi v247, v18 offset:3840
    v_add_f32 v103, v103, v106
    v_mfma_f32_16x16x32_bf16 v[120:123], v[172:175], a[160:163], v[120:123]
    ds_bpermute_b32 v248, v19, v248
    v_add_f32 v107, v107, v110
    v_mfma_f32_16x16x32_bf16 v[120:123], v[176:179], a[156:159], v[120:123]
    ds_bpermute_b32 v249, v19, v249
    v_add_f32 v103, v103, v109
    v_mfma_f32_16x16x32_bf16 v[120:123], v[180:183], a[152:155], v[120:123]
    ds_bpermute_b32 v250, v19, v250
    v_cndmask_b32_e64 v224, v103, v87, vcc
    v_mfma_f32_16x16x32_bf16 v[120:123], v[184:187], a[148:151], v[120:123]
    ds_read_u16_d16_hi v252, v18 offset:512
    v_cndmask_b32_e64 v225, v107, v91, vcc
    v_mfma_f32_16x16x32_bf16 v[120:123], v[188:191], a[144:147], v[120:123]
    ds_read_u16_d16_hi v253, v18 offset:1664
    v_cndmask_b32_e64 v226, v111, v95, vcc
    v_mfma_f32_16x16x32_bf16 v[120:123], v[192:195], a[140:143], v[120:123]
    s_waitcnt lgkmcnt(10)
    v_add_f32 v64, v64, v240
    v_add_f32 v65, v65, v241
    v_mfma_f32_16x16x32_bf16 v[120:123], v[196:199], a[136:139], v[120:123]
    s_waitcnt lgkmcnt(8)
    v_add_f32 v66, v66, v242
    v_fmac_f32 v64, s31, v244
    v_mfma_f32_16x16x32_bf16 v[120:123], v[200:203], a[132:135], v[120:123]
    s_waitcnt lgkmcnt(6)
    v_fmac_f32 v65, s31, v245
    v_fmac_f32 v66, s31, v246
    v_mfma_f32_16x16x32_bf16 v[120:123], v[204:207], a[128:131], v[120:123]
    s_waitcnt lgkmcnt(5)
    v_fmac_f32 v67, s31, v247
    v_cvt_pk_bf16_f32 v64, v64, v65
    v_mfma_f32_16x16x32_bf16 v[124:127], v[160:163], a[236:239], 0
    ds_read_u16_d16_hi v254, v18 offset:2816
    v_cvt_pk_bf16_f32 v65, v66, v67
    v_mfma_f32_16x16x32_bf16 v[124:127], v[164:167], a[232:235], v[124:127]
    buffer_store_dwordx2 v[64:65], v20, s[12:15], s34 offen offset:1024 sc1
    v_mfma_f32_16x16x32_bf16 v[124:127], v[168:171], a[228:231], v[124:127]
    ds_read_u16_d16_hi v255, v18 offset:3968
    v_add_f32 v97, v97, v100
    v_mfma_f32_16x16x32_bf16 v[124:127], v[172:175], a[224:227], v[124:127]
    ds_bpermute_b32 v224, v19, v224
    v_add_f32 v98, v98, v101
    v_mfma_f32_16x16x32_bf16 v[124:127], v[176:179], a[220:223], v[124:127]
    ds_bpermute_b32 v225, v19, v225
    v_add_f32 v99, v99, v102
    v_mfma_f32_16x16x32_bf16 v[124:127], v[180:183], a[216:219], v[124:127]
    ds_bpermute_b32 v226, v19, v226
    v_add_f32 v98, v98, v104
    v_mfma_f32_16x16x32_bf16 v[124:127], v[184:187], a[212:215], v[124:127]
    ds_read_u16_d16_hi v228, v18 offset:640
    v_add_f32 v99, v99, v105
    v_mfma_f32_16x16x32_bf16 v[124:127], v[188:191], a[208:211], v[124:127]
    ds_read_u16_d16_hi v229, v18 offset:1792
    v_add_f32 v99, v99, v108
    v_mfma_f32_16x16x32_bf16 v[124:127], v[192:195], a[204:207], v[124:127]
    s_waitcnt lgkmcnt(10)
    v_add_f32 v80, v80, v248
    v_add_f32 v81, v81, v249
    v_mfma_f32_16x16x32_bf16 v[124:127], v[196:199], a[200:203], v[124:127]
    s_waitcnt lgkmcnt(8)
    v_add_f32 v82, v82, v250
    v_fmac_f32 v80, s31, v252
    v_mfma_f32_16x16x32_bf16 v[124:127], v[200:203], a[196:199], v[124:127]
    s_waitcnt lgkmcnt(6)
    v_fmac_f32 v81, s31, v253
    v_fmac_f32 v82, s31, v254
    v_mfma_f32_16x16x32_bf16 v[124:127], v[204:207], a[192:195], v[124:127]
    s_waitcnt lgkmcnt(5)
    v_fmac_f32 v83, s31, v255
    v_cvt_pk_bf16_f32 v80, v80, v81
    v_mfma_f32_16x16x32_bf16 v[128:131], v[160:163], a[52:55], 0
    ds_read_u16_d16_hi v230, v18 offset:2944
    v_cvt_pk_bf16_f32 v81, v82, v83
    v_mfma_f32_16x16x32_bf16 v[128:131], v[164:167], a[48:51], v[128:131]
    buffer_store_dwordx2 v[80:81], v20, s[12:15], s34 offen offset:1536 sc1
    v_mfma_f32_16x16x32_bf16 v[128:131], v[168:171], a[44:47], v[128:131]
    ds_read_u16_d16_hi v231, v18 offset:4096
    v_mfma_f32_16x16x32_bf16 v[128:131], v[172:175], a[40:43], v[128:131]
    v_mfma_f32_16x16x32_bf16 v[128:131], v[176:179], a[36:39], v[128:131]
    v_mfma_f32_16x16x32_bf16 v[128:131], v[180:183], a[32:35], v[128:131]
    v_mfma_f32_16x16x32_bf16 v[128:131], v[184:187], a[28:31], v[128:131]
    v_mfma_f32_16x16x32_bf16 v[128:131], v[188:191], a[24:27], v[128:131]
    v_add_f32 v119, v119, v122
    v_add_f32 v123, v123, v126
    v_mfma_f32_16x16x32_bf16 v[128:131], v[192:195], a[20:23], v[128:131]
    s_waitcnt lgkmcnt(5)
    v_add_f32 v96, v96, v224
    v_add_f32 v97, v97, v225
    v_mfma_f32_16x16x32_bf16 v[128:131], v[196:199], a[16:19], v[128:131]
    s_waitcnt lgkmcnt(3)
    v_add_f32 v98, v98, v226
    v_fmac_f32 v96, s31, v228
    v_mfma_f32_16x16x32_bf16 v[128:131], v[200:203], a[12:15], v[128:131]
    s_waitcnt lgkmcnt(1)
    v_fmac_f32 v97, s31, v229
    v_fmac_f32 v98, s31, v230
    v_mfma_f32_16x16x32_bf16 v[128:131], v[204:207], a[8:11], v[128:131]
    s_waitcnt lgkmcnt(0)
    v_fmac_f32 v99, s31, v231
    v_cvt_pk_bf16_f32 v96, v96, v97
    v_mfma_f32_16x16x32_bf16 v[128:131], v[208:211], a[4:7], v[128:131]
    v_cvt_pk_bf16_f32 v97, v98, v99
    v_add_f32 v119, v119, v125
    v_mfma_f32_16x16x32_bf16 v[128:131], v[212:215], a[0:3], v[128:131]
    buffer_store_dwordx2 v[96:97], v20, s[12:15], s34 offen offset:2048 sc1
    v_mfma_f32_16x16x32_bf16 v[132:135], v[160:163], a[116:119], 0
    v_cndmask_b32_e64 v232, v119, v103, vcc
    v_cndmask_b32_e64 v233, v123, v107, vcc
    v_mfma_f32_16x16x32_bf16 v[132:135], v[164:167], a[112:115], v[132:135]
    v_cndmask_b32_e64 v234, v127, v111, vcc
    v_add_f32 v113, v113, v116
    v_mfma_f32_16x16x32_bf16 v[132:135], v[168:171], a[108:111], v[132:135]
    ds_bpermute_b32 v232, v19, v232
    v_add_f32 v114, v114, v117
    v_mfma_f32_16x16x32_bf16 v[132:135], v[172:175], a[104:107], v[132:135]
    ds_bpermute_b32 v233, v19, v233
    v_add_f32 v115, v115, v118
    v_mfma_f32_16x16x32_bf16 v[132:135], v[176:179], a[100:103], v[132:135]
    ds_bpermute_b32 v234, v19, v234
    v_add_f32 v114, v114, v120
    v_mfma_f32_16x16x32_bf16 v[132:135], v[180:183], a[96:99], v[132:135]
    ds_read_u16_d16_hi v236, v18 offset:768
    v_add_f32 v115, v115, v121
    v_mfma_f32_16x16x32_bf16 v[132:135], v[184:187], a[92:95], v[132:135]
    ds_read_u16_d16_hi v237, v18 offset:1920
    v_add_f32 v115, v115, v124
    v_mfma_f32_16x16x32_bf16 v[132:135], v[188:191], a[88:91], v[132:135]
    ds_read_u16_d16_hi v238, v18 offset:3072
    v_mfma_f32_16x16x32_bf16 v[132:135], v[192:195], a[84:87], v[132:135]
    ds_read_u16_d16_hi v239, v18 offset:4224
    v_mfma_f32_16x16x32_bf16 v[132:135], v[196:199], a[80:83], v[132:135]
    v_mfma_f32_16x16x32_bf16 v[132:135], v[200:203], a[76:79], v[132:135]
    v_mfma_f32_16x16x32_bf16 v[132:135], v[204:207], a[72:75], v[132:135]
    v_mfma_f32_16x16x32_bf16 v[132:135], v[208:211], a[68:71], v[132:135]
    v_mfma_f32_16x16x32_bf16 v[132:135], v[212:215], a[64:67], v[132:135]
    v_mfma_f32_16x16x32_bf16 v[136:139], v[160:163], a[180:183], 0
    s_waitcnt lgkmcnt(5)
    v_add_f32 v112, v112, v232
    v_add_f32 v113, v113, v233
    v_mfma_f32_16x16x32_bf16 v[136:139], v[164:167], a[176:179], v[136:139]
    s_waitcnt lgkmcnt(3)
    v_add_f32 v114, v114, v234
    v_fmac_f32 v112, s31, v236
    v_mfma_f32_16x16x32_bf16 v[136:139], v[168:171], a[172:175], v[136:139]
    s_waitcnt lgkmcnt(1)
    v_fmac_f32 v113, s31, v237
    v_fmac_f32 v114, s31, v238
    v_mfma_f32_16x16x32_bf16 v[136:139], v[172:175], a[168:171], v[136:139]
    s_waitcnt lgkmcnt(0)
    v_fmac_f32 v115, s31, v239
    v_cvt_pk_bf16_f32 v112, v112, v113
    v_mfma_f32_16x16x32_bf16 v[136:139], v[176:179], a[164:167], v[136:139]
    v_cvt_pk_bf16_f32 v113, v114, v115
    v_mfma_f32_16x16x32_bf16 v[136:139], v[180:183], a[160:163], v[136:139]
    buffer_store_dwordx2 v[112:113], v20, s[12:15], s34 offen offset:2560 sc1
    v_mfma_f32_16x16x32_bf16 v[136:139], v[184:187], a[156:159], v[136:139]
    v_mfma_f32_16x16x32_bf16 v[136:139], v[188:191], a[152:155], v[136:139]
    v_mfma_f32_16x16x32_bf16 v[136:139], v[192:195], a[148:151], v[136:139]
    v_mfma_f32_16x16x32_bf16 v[136:139], v[196:199], a[144:147], v[136:139]
    v_mfma_f32_16x16x32_bf16 v[136:139], v[200:203], a[140:143], v[136:139]
    v_mfma_f32_16x16x32_bf16 v[136:139], v[204:207], a[136:139], v[136:139]
    v_mfma_f32_16x16x32_bf16 v[136:139], v[208:211], a[132:135], v[136:139]
    v_mfma_f32_16x16x32_bf16 v[136:139], v[212:215], a[128:131], v[136:139]
    v_mfma_f32_16x16x32_bf16 v[140:143], v[160:163], a[244:247], 0
    v_mfma_f32_16x16x32_bf16 v[140:143], v[164:167], a[240:243], v[140:143]
    v_mfma_f32_16x16x32_bf16 v[140:143], v[168:171], a[236:239], v[140:143]
    v_mfma_f32_16x16x32_bf16 v[140:143], v[172:175], a[232:235], v[140:143]
    v_mfma_f32_16x16x32_bf16 v[140:143], v[176:179], a[228:231], v[140:143]
    v_mfma_f32_16x16x32_bf16 v[140:143], v[180:183], a[224:227], v[140:143]
    v_mfma_f32_16x16x32_bf16 v[140:143], v[184:187], a[220:223], v[140:143]
    v_mfma_f32_16x16x32_bf16 v[140:143], v[188:191], a[216:219], v[140:143]
    v_mfma_f32_16x16x32_bf16 v[140:143], v[192:195], a[212:215], v[140:143]
    v_mfma_f32_16x16x32_bf16 v[140:143], v[196:199], a[208:211], v[140:143]
    v_mfma_f32_16x16x32_bf16 v[140:143], v[200:203], a[204:207], v[140:143]
    v_mfma_f32_16x16x32_bf16 v[140:143], v[204:207], a[200:203], v[140:143]
    v_mfma_f32_16x16x32_bf16 v[140:143], v[208:211], a[196:199], v[140:143]
    v_mfma_f32_16x16x32_bf16 v[140:143], v[212:215], a[192:195], v[140:143]
    v_mfma_f32_16x16x32_bf16 v[144:147], v[160:163], a[60:63], 0
    v_mfma_f32_16x16x32_bf16 v[144:147], v[164:167], a[56:59], v[144:147]
    v_mfma_f32_16x16x32_bf16 v[144:147], v[168:171], a[52:55], v[144:147]
    v_mfma_f32_16x16x32_bf16 v[144:147], v[172:175], a[48:51], v[144:147]
    v_mfma_f32_16x16x32_bf16 v[144:147], v[176:179], a[44:47], v[144:147]
    v_mfma_f32_16x16x32_bf16 v[144:147], v[180:183], a[40:43], v[144:147]
    v_mfma_f32_16x16x32_bf16 v[144:147], v[184:187], a[36:39], v[144:147]
    v_mfma_f32_16x16x32_bf16 v[144:147], v[188:191], a[32:35], v[144:147]
    v_add_f32 v135, v135, v138
    v_add_f32 v139, v139, v142
    v_mfma_f32_16x16x32_bf16 v[144:147], v[192:195], a[28:31], v[144:147]
    v_add_f32 v135, v135, v141
    v_cndmask_b32_e64 v240, v135, v119, vcc
    v_mfma_f32_16x16x32_bf16 v[144:147], v[196:199], a[24:27], v[144:147]
    v_cndmask_b32_e64 v241, v139, v123, vcc
    v_cndmask_b32_e64 v242, v143, v127, vcc
    v_mfma_f32_16x16x32_bf16 v[144:147], v[200:203], a[20:23], v[144:147]
    ds_bpermute_b32 v240, v19, v240
    v_add_f32 v129, v129, v132
    v_mfma_f32_16x16x32_bf16 v[144:147], v[204:207], a[16:19], v[144:147]
    ds_bpermute_b32 v241, v19, v241
    v_add_f32 v130, v130, v133
    v_mfma_f32_16x16x32_bf16 v[144:147], v[208:211], a[12:15], v[144:147]
    ds_bpermute_b32 v242, v19, v242
    v_add_f32 v131, v131, v134
    v_mfma_f32_16x16x32_bf16 v[144:147], v[212:215], a[8:11], v[144:147]
    ds_read_u16_d16_hi v244, v18 offset:896
    v_add_f32 v130, v130, v136
    v_mfma_f32_16x16x32_bf16 v[144:147], v[216:219], a[4:7], v[144:147]
    ds_read_u16_d16_hi v245, v18 offset:2048
    v_add_f32 v131, v131, v137
    v_mfma_f32_16x16x32_bf16 v[144:147], v[220:223], a[0:3], v[144:147]
    ds_read_u16_d16_hi v246, v18 offset:3200
    v_add_f32 v131, v131, v140
    v_mfma_f32_16x16x32_bf16 v[148:151], v[160:163], a[124:127], 0
    ds_read_u16_d16_hi v247, v18 offset:4352
    v_mfma_f32_16x16x32_bf16 v[148:151], v[164:167], a[120:123], v[148:151]
    v_mfma_f32_16x16x32_bf16 v[148:151], v[168:171], a[116:119], v[148:151]
    v_mfma_f32_16x16x32_bf16 v[148:151], v[172:175], a[112:115], v[148:151]
    v_mfma_f32_16x16x32_bf16 v[148:151], v[176:179], a[108:111], v[148:151]
    v_mfma_f32_16x16x32_bf16 v[148:151], v[180:183], a[104:107], v[148:151]
    v_mfma_f32_16x16x32_bf16 v[148:151], v[184:187], a[100:103], v[148:151]
    s_waitcnt lgkmcnt(5)
    v_add_f32 v128, v128, v240
    v_add_f32 v129, v129, v241
    v_mfma_f32_16x16x32_bf16 v[148:151], v[188:191], a[96:99], v[148:151]
    s_waitcnt lgkmcnt(3)
    v_add_f32 v130, v130, v242
    v_fmac_f32 v128, s31, v244
    v_mfma_f32_16x16x32_bf16 v[148:151], v[192:195], a[92:95], v[148:151]
    s_waitcnt lgkmcnt(1)
    v_fmac_f32 v129, s31, v245
    v_fmac_f32 v130, s31, v246
    v_mfma_f32_16x16x32_bf16 v[148:151], v[196:199], a[88:91], v[148:151]
    s_waitcnt lgkmcnt(0)
    v_fmac_f32 v131, s31, v247
    v_cvt_pk_bf16_f32 v128, v128, v129
    v_mfma_f32_16x16x32_bf16 v[148:151], v[200:203], a[84:87], v[148:151]
    v_cvt_pk_bf16_f32 v129, v130, v131
    v_mfma_f32_16x16x32_bf16 v[148:151], v[204:207], a[80:83], v[148:151]
    buffer_store_dwordx2 v[128:129], v20, s[12:15], s34 offen offset:3072 sc1
    v_mfma_f32_16x16x32_bf16 v[148:151], v[208:211], a[76:79], v[148:151]
    v_mfma_f32_16x16x32_bf16 v[148:151], v[212:215], a[72:75], v[148:151]
    v_mfma_f32_16x16x32_bf16 v[148:151], v[216:219], a[68:71], v[148:151]
    v_mfma_f32_16x16x32_bf16 v[148:151], v[220:223], a[64:67], v[148:151]
    v_mfma_f32_16x16x32_bf16 v[152:155], v[160:163], a[188:191], 0
    v_mfma_f32_16x16x32_bf16 v[152:155], v[164:167], a[184:187], v[152:155]
    v_mfma_f32_16x16x32_bf16 v[152:155], v[168:171], a[180:183], v[152:155]
    v_mfma_f32_16x16x32_bf16 v[152:155], v[172:175], a[176:179], v[152:155]
    v_mfma_f32_16x16x32_bf16 v[152:155], v[176:179], a[172:175], v[152:155]
    v_mfma_f32_16x16x32_bf16 v[152:155], v[180:183], a[168:171], v[152:155]
    v_mfma_f32_16x16x32_bf16 v[152:155], v[184:187], a[164:167], v[152:155]
    v_mfma_f32_16x16x32_bf16 v[152:155], v[188:191], a[160:163], v[152:155]
    v_mfma_f32_16x16x32_bf16 v[152:155], v[192:195], a[156:159], v[152:155]
    v_mfma_f32_16x16x32_bf16 v[152:155], v[196:199], a[152:155], v[152:155]
    v_mfma_f32_16x16x32_bf16 v[152:155], v[200:203], a[148:151], v[152:155]
    v_mfma_f32_16x16x32_bf16 v[152:155], v[204:207], a[144:147], v[152:155]
    v_mfma_f32_16x16x32_bf16 v[152:155], v[208:211], a[140:143], v[152:155]
    v_mfma_f32_16x16x32_bf16 v[152:155], v[212:215], a[136:139], v[152:155]
    v_mfma_f32_16x16x32_bf16 v[152:155], v[216:219], a[132:135], v[152:155]
    v_mfma_f32_16x16x32_bf16 v[152:155], v[220:223], a[128:131], v[152:155]
    v_mfma_f32_16x16x32_bf16 v[156:159], v[160:163], v[28:31], 0
    v_mfma_f32_16x16x32_bf16 v[156:159], v[164:167], a[248:251], v[156:159]
    v_mfma_f32_16x16x32_bf16 v[156:159], v[168:171], a[244:247], v[156:159]
    v_mfma_f32_16x16x32_bf16 v[156:159], v[172:175], a[240:243], v[156:159]
    v_mfma_f32_16x16x32_bf16 v[156:159], v[176:179], a[236:239], v[156:159]
    v_mfma_f32_16x16x32_bf16 v[156:159], v[180:183], a[232:235], v[156:159]
    v_mfma_f32_16x16x32_bf16 v[156:159], v[184:187], a[228:231], v[156:159]
    v_mfma_f32_16x16x32_bf16 v[156:159], v[188:191], a[224:227], v[156:159]
    v_mfma_f32_16x16x32_bf16 v[156:159], v[192:195], a[220:223], v[156:159]
    v_mfma_f32_16x16x32_bf16 v[156:159], v[196:199], a[216:219], v[156:159]
    v_mfma_f32_16x16x32_bf16 v[156:159], v[200:203], a[212:215], v[156:159]
    v_mfma_f32_16x16x32_bf16 v[156:159], v[204:207], a[208:211], v[156:159]
    v_mfma_f32_16x16x32_bf16 v[156:159], v[208:211], a[204:207], v[156:159]
    v_mfma_f32_16x16x32_bf16 v[156:159], v[212:215], a[200:203], v[156:159]
    v_mfma_f32_16x16x32_bf16 v[156:159], v[216:219], a[196:199], v[156:159]
    v_mfma_f32_16x16x32_bf16 v[156:159], v[220:223], a[192:195], v[156:159]
    s_nop 7
    v_add_f32 v151, v151, v154
    v_add_f32 v155, v155, v158
    v_add_f32 v151, v151, v157
    v_cndmask_b32_e64 v248, v151, v135, vcc
    v_cndmask_b32_e64 v249, v155, v139, vcc
    v_cndmask_b32_e64 v250, v159, v143, vcc
    ds_bpermute_b32 v248, v19, v248
    ds_bpermute_b32 v249, v19, v249
    ds_bpermute_b32 v250, v19, v250
    ds_read_u16_d16_hi v252, v18 offset:1024
    ds_read_u16_d16_hi v253, v18 offset:2176
    ds_read_u16_d16_hi v254, v18 offset:3328
    ds_read_u16_d16_hi v255, v18 offset:4480
    v_add_f32 v145, v145, v148
    v_add_f32 v146, v146, v149
    v_add_f32 v147, v147, v150
    v_add_f32 v146, v146, v152
    v_add_f32 v147, v147, v153
    v_add_f32 v147, v147, v156
    s_waitcnt lgkmcnt(0)
    v_add_f32 v144, v144, v248
    v_add_f32 v145, v145, v249
    v_add_f32 v146, v146, v250
    v_fmac_f32 v144, s31, v252
    v_fmac_f32 v145, s31, v253
    v_fmac_f32 v146, s31, v254
    v_fmac_f32 v147, s31, v255
    v_cvt_pk_bf16_f32 v144, v144, v145
    v_cvt_pk_bf16_f32 v145, v146, v147
    buffer_store_dwordx2 v[144:145], v20, s[12:15], s34 offen offset:3584 sc1
    s_lshl_b32 s93, s95, 2
    s_add_u32 s93, s93, 84963328
L_noconv:
    s_lshl_b32 s40, s24, 1
    s_and_b32 s41, s28, 1
    s_add_u32 s40, s40, s41
    s_lshr_b32 s41, s28, 1
    s_lshl_b32 s44, s24, 7
    s_add_u32 s44, s44, 84938752
    s_add_u32 s45, s44, 1024
    s_lshl_b32 s43, s41, 6
    s_add_u32 s43, s43, 84963328
    s_cmp_eq_u32 s27, 0
    s_cselect_b32 s44, s44, s43
    v_and_b32 v17, 15, v0
    v_lshlrev_b32 v17, 2, v17
    buffer_load_dword a246, v17, s[12:15], s44 offen sc1
    s_lshl_b32 s42, s40, 2
    s_add_u32 s42, s42, s3
    s_mul_i32 s37, s42, 229376
    s_lshl_b32 s43, s41, 15
    s_add_u32 s37, s37, s43
    s_add_u32 s37, s37, 117440512
    s_lshl_b32 s43, s27, 14
    s_add_u32 s38, s37, s43
    s_add_u32 s38, s38, 14680064
    s_lshl_b32 s42, s42, 4
    s_lshl_b32 s39, s41, 7
    s_add_u32 s36, s39, 896
    s_lshl_b32 s43, s27, 6
    s_add_u32 s35, s36, s43
    s_add_u32 s35, s35, 1835008
    s_mov_b32 s8, s88
    s_mov_b32 s9, s89
    s_mov_b32 s10, 3670016
    s_mov_b32 s11, 0x20000
    v_and_b32 v2, 15, v0
    v_add_u32 v2, s42, v2
    v_mul_u32_u24 v7, 896, v2
    v_lshrrev_b32 v3, 4, v0
    v_lshlrev_b32 v8, 4, v3
    v_lshl_add_u32 v2, v7, 1, v8
    v_add_u32 v7, v7, v8
    v_and_b32 v4, 1, v0
    v_lshlrev_b32 v4, 4, v4
    v_mov_b32 v5, 0x3f80
    v_lshlrev_b32 v4, v4, v5
    v_bfe_u32 v5, v0, 3, 1
    v_bfe_u32 v6, v0, 1, 1
    v_lshl_add_u32 v5, v5, 1, v6
    v_bfe_u32 v6, v0, 2, 1
    v_lshlrev_b32 v6, 1, v6
    v_sub_u32 v6, v3, v6
    v_lshl_add_u32 v5, v6, 2, v5
    v_cmp_eq_u32 s[46:47], 0, v5
    v_cmp_eq_u32 s[48:49], 1, v5
    v_cmp_eq_u32 s[50:51], 2, v5
    v_cmp_eq_u32 s[52:53], 3, v5
    v_cndmask_b32 v24, 0, v4, s[46:47]
    v_cndmask_b32 v25, 0, v4, s[48:49]
    v_cndmask_b32 v26, 0, v4, s[50:51]
    v_cndmask_b32 v27, 0, v4, s[52:53]
    v_cmp_eq_u32 s[46:47], 4, v5
    v_cmp_eq_u32 s[48:49], 5, v5
    v_cmp_eq_u32 s[50:51], 6, v5
    v_cmp_eq_u32 s[52:53], 7, v5
    v_cndmask_b32 v28, 0, v4, s[46:47]
    v_cndmask_b32 v29, 0, v4, s[48:49]
    v_cndmask_b32 v30, 0, v4, s[50:51]
    v_cndmask_b32 v31, 0, v4, s[52:53]
    s_waitcnt vmcnt(0)
    s_barrier
    buffer_store_dword v21, v21, s[12:15], s93 offen sc1
    s_cmp_eq_u32 s27, 0
    s_cbranch_scc1 L_noq
    s_mov_b32 s16, s64
    s_mov_b32 s17, s65
    s_mov_b32 s18, 1835008
    s_mov_b32 s19, 0x20000
    s_add_u32 s54, s39, 917504
    s_add_u32 s55, s39, 1835008
    buffer_load_dwordx4 v[48:51], v7, s[16:19], s39 offen offset:0
    buffer_load_dwordx4 v[52:55], v7, s[16:19], s39 offen offset:64
    buffer_load_dwordx4 v[56:59], v7, s[16:19], s54 offen offset:0
    buffer_load_dwordx4 v[60:63], v7, s[16:19], s54 offen offset:64
    v_lshrrev_b32 v8, 1, v0
    v_lshlrev_b32 v8, 12, v8
    v_and_b32 v9, 1, v0
    v_lshl_add_u32 v8, v9, 4, v8
    s_lshl_b32 s56, s42, 1
    s_lshl_b32 s57, s41, 18
    s_add_u32 s56, s56, s57
    s_add_u32 s56, s56, 90177536
    s_add_u32 s57, s56, 0x20000
    s_lshl_b32 s58, s3, 12
    v_lshlrev_b32 v10, 3, v3
    v_bfe_u32 v15, v0, 2, 2
    v_add_u32 v10, v10, v15
    v_lshlrev_b32 v10, 5, v10
    v_and_b32 v15, 3, v0
    v_lshl_add_u32 v10, v15, 3, v10
    v_add_u32 v10, s58, v10
    s_mov_b32 s59, 0xffff0000
L_noq:
    v_accvgpr_read_b32 v17, a246
    v_cmp_ne_u32 vcc, 0, v17
    s_cbranch_vccz L_poll5_ok
    v_and_b32 v16, 15, v0
    v_lshlrev_b32 v16, 2, v16
    s_mov_b32 s32, 0
L_poll5:
    buffer_load_dword v17, v16, s[12:15], s44 offen sc1
    s_waitcnt vmcnt(0)
    v_cmp_ne_u32 vcc, 0, v17
    s_cbranch_vccz L_poll5_ok
    s_sleep 8
    s_add_u32 s32, s32, 1
    s_cmp_lt_u32 s32, 0x80000
    s_cbranch_scc1 L_poll5
L_poll5_ok:
    s_cmp_eq_u32 s27, 0
    s_cbranch_scc1 L_short
    s_add_u32 m0, s58, 0
    s_nop 0
    buffer_load_dwordx4 v8, s[12:15], s56 offen offset:0 sc1 lds
    s_add_u32 m0, s58, 1024
    s_nop 0
    buffer_load_dwordx4 v8, s[12:15], s57 offen offset:0 sc1 lds
    s_add_u32 m0, s58, 0
    s_nop 0
    buffer_load_dwordx4 v8, s[12:15], s56 offen offset:2048 sc1 lds
    s_add_u32 m0, s58, 1024
    s_nop 0
    buffer_load_dwordx4 v8, s[12:15], s57 offen offset:2048 sc1 lds
    v_and_b32 v17, 15, v0
    v_lshlrev_b32 v17, 2, v17
    buffer_load_dword a246, v17, s[12:15], s45 offen sc1
    s_waitcnt vmcnt(4)
    ds_read_b64_tr_b16 v[12:13], v10 offset:0
    ds_read_b64_tr_b16 v[14:15], v10 offset:128
    s_waitcnt lgkmcnt(0)
    v_lshlrev_b32 v16, 16, v48
    v_and_b32 v17, s59, v48
    v_lshlrev_b32 v18, 16, v12
    v_and_b32 v19, s59, v12
    v_pk_mul_f32 v[16:17], v[16:17], v[18:19]
    v_cvt_pk_bf16_f32 v48, v16, v17
    v_lshlrev_b32 v16, 16, v49
    v_and_b32 v17, s59, v49
    v_lshlrev_b32 v18, 16, v13
    v_and_b32 v19, s59, v13
    v_pk_mul_f32 v[16:17], v[16:17], v[18:19]
    v_cvt_pk_bf16_f32 v49, v16, v17
    v_lshlrev_b32 v16, 16, v50
    v_and_b32 v17, s59, v50
    v_lshlrev_b32 v18, 16, v14
    v_and_b32 v19, s59, v14
    v_pk_mul_f32 v[16:17], v[16:17], v[18:19]
    v_cvt_pk_bf16_f32 v50, v16, v17
    v_lshlrev_b32 v16, 16, v51
    v_and_b32 v17, s59, v51
    v_lshlrev_b32 v18, 16, v15
    v_and_b32 v19, s59, v15
    v_pk_mul_f32 v[16:17], v[16:17], v[18:19]
    v_cvt_pk_bf16_f32 v51, v16, v17
    buffer_store_dwordx4 v[48:51], v2, s[8:11], s39 offen offset:0
    s_waitcnt vmcnt(4)
    ds_read_b64_tr_b16 v[12:13], v10 offset:1024
    ds_read_b64_tr_b16 v[14:15], v10 offset:1152
    s_waitcnt lgkmcnt(0)
    v_lshlrev_b32 v16, 16, v52
    v_and_b32 v17, s59, v52
    v_lshlrev_b32 v18, 16, v12
    v_and_b32 v19, s59, v12
    v_pk_mul_f32 v[16:17], v[16:17], v[18:19]
    v_cvt_pk_bf16_f32 v52, v16, v17
    v_lshlrev_b32 v16, 16, v53
    v_and_b32 v17, s59, v53
    v_lshlrev_b32 v18, 16, v13
    v_and_b32 v19, s59, v13
    v_pk_mul_f32 v[16:17], v[16:17], v[18:19]
    v_cvt_pk_bf16_f32 v53, v16, v17
    v_lshlrev_b32 v16, 16, v54
    v_and_b32 v17, s59, v54
    v_lshlrev_b32 v18, 16, v14
    v_and_b32 v19, s59, v14
    v_pk_mul_f32 v[16:17], v[16:17], v[18:19]
    v_cvt_pk_bf16_f32 v54, v16, v17
    v_lshlrev_b32 v16, 16, v55
    v_and_b32 v17, s59, v55
    v_lshlrev_b32 v18, 16, v15
    v_and_b32 v19, s59, v15
    v_pk_mul_f32 v[16:17], v[16:17], v[18:19]
    v_cvt_pk_bf16_f32 v55, v16, v17
    buffer_store_dwordx4 v[52:55], v2, s[8:11], s39 offen offset:64
    s_waitcnt vmcnt(4)
    ds_read_b64_tr_b16 v[12:13], v10 offset:2048
    ds_read_b64_tr_b16 v[14:15], v10 offset:2176
    s_waitcnt lgkmcnt(0)
    v_lshlrev_b32 v16, 16, v56
    v_and_b32 v17, s59, v56
    v_lshlrev_b32 v18, 16, v12
    v_and_b32 v19, s59, v12
    v_pk_mul_f32 v[16:17], v[16:17], v[18:19]
    v_cvt_pk_bf16_f32 v56, v16, v17
    v_lshlrev_b32 v16, 16, v57
    v_and_b32 v17, s59, v57
    v_lshlrev_b32 v18, 16, v13
    v_and_b32 v19, s59, v13
    v_pk_mul_f32 v[16:17], v[16:17], v[18:19]
    v_cvt_pk_bf16_f32 v57, v16, v17
    v_lshlrev_b32 v16, 16, v58
    v_and_b32 v17, s59, v58
    v_lshlrev_b32 v18, 16, v14
    v_and_b32 v19, s59, v14
    v_pk_mul_f32 v[16:17], v[16:17], v[18:19]
    v_cvt_pk_bf16_f32 v58, v16, v17
    v_lshlrev_b32 v16, 16, v59
    v_and_b32 v17, s59, v59
    v_lshlrev_b32 v18, 16, v15
    v_and_b32 v19, s59, v15
    v_pk_mul_f32 v[16:17], v[16:17], v[18:19]
    v_cvt_pk_bf16_f32 v59, v16, v17
    buffer_store_dwordx4 v[56:59], v2, s[8:11], s55 offen offset:0
    s_waitcnt vmcnt(4)
    ds_read_b64_tr_b16 v[12:13], v10 offset:3072
    ds_read_b64_tr_b16 v[14:15], v10 offset:3200
    s_waitcnt lgkmcnt(0)
    v_lshlrev_b32 v16, 16, v60
    v_and_b32 v17, s59, v60
    v_lshlrev_b32 v18, 16, v12
    v_and_b32 v19, s59, v12
    v_pk_mul_f32 v[16:17], v[16:17], v[18:19]
    v_cvt_pk_bf16_f32 v60, v16, v17
    v_lshlrev_b32 v16, 16, v61
    v_and_b32 v17, s59, v61
    v_lshlrev_b32 v18, 16, v13
    v_and_b32 v19, s59, v13
    v_pk_mul_f32 v[16:17], v[16:17], v[18:19]
    v_cvt_pk_bf16_f32 v61, v16, v17
    v_lshlrev_b32 v16, 16, v62
    v_and_b32 v17, s59, v62
    v_lshlrev_b32 v18, 16, v14
    v_and_b32 v19, s59, v14
    v_pk_mul_f32 v[16:17], v[16:17], v[18:19]
    v_cvt_pk_bf16_f32 v62, v16, v17
    v_lshlrev_b32 v16, 16, v63
    v_and_b32 v17, s59, v63
    v_lshlrev_b32 v18, 16, v15
    v_and_b32 v19, s59, v15
    v_pk_mul_f32 v[16:17], v[16:17], v[18:19]
    v_cvt_pk_bf16_f32 v63, v16, v17
    buffer_store_dwordx4 v[60:63], v2, s[8:11], s55 offen offset:64
    s_waitcnt vmcnt(4)
    s_branch L_long
L_short:
    buffer_load_dwordx4 a[0:3], v1, s[12:15], s37 offen offset:0 sc1
    buffer_load_dwordx4 a[4:7], v1, s[12:15], s37 offen offset:1024 sc1
    buffer_load_dwordx4 a[8:11], v1, s[12:15], s37 offen offset:2048 sc1
    buffer_load_dwordx4 a[12:15], v1, s[12:15], s37 offen offset:3072 sc1
    s_add_u32 s37, s37, 4096
    buffer_load_dwordx4 a[16:19], v1, s[12:15], s37 offen offset:0 sc1
    buffer_load_dwordx4 a[20:23], v1, s[12:15], s37 offen offset:1024 sc1
    buffer_load_dwordx4 a[24:27], v1, s[12:15], s37 offen offset:2048 sc1
    buffer_load_dwordx4 a[28:31], v1, s[12:15], s37 offen offset:3072 sc1
    s_add_u32 s37, s37, 4096
    buffer_load_dwordx4 a[32:35], v1, s[12:15], s37 offen offset:0 sc1
    buffer_load_dwordx4 a[36:39], v1, s[12:15], s37 offen offset:1024 sc1
    buffer_load_dwordx4 a[40:43], v1, s[12:15], s37 offen offset:2048 sc1
    buffer_load_dwordx4 a[44:47], v1, s[12:15], s37 offen offset:3072 sc1
    s_add_u32 s37, s37, 4096
    buffer_load_dwordx4 a[48:51], v1, s[12:15], s37 offen offset:0 sc1
    buffer_load_dwordx4 a[52:55], v1, s[12:15], s37 offen offset:1024 sc1
    buffer_load_dwordx4 a[56:59], v1, s[12:15], s37 offen offset:2048 sc1
    buffer_load_dwordx4 a[60:63], v1, s[12:15], s37 offen offset:3072 sc1
    s_add_u32 s37, s37, 4096
    buffer_load_dwordx4 a[64:67], v1, s[12:15], s37 offen offset:0 sc1
    buffer_load_dwordx4 a[68:71], v1, s[12:15], s37 offen offset:1024 sc1
    buffer_load_dwordx4 a[72:75], v1, s[12:15], s37 offen offset:2048 sc1
    buffer_load_dwordx4 a[76:79], v1, s[12:15], s37 offen offset:3072 sc1
    s_add_u32 s37, s37, 4096
    buffer_load_dwordx4 a[80:83], v1, s[12:15], s37 offen offset:0 sc1
    buffer_load_dwordx4 a[84:87], v1, s[12:15], s37 offen offset:1024 sc1
    buffer_load_dwordx4 a[88:91], v1, s[12:15], s37 offen offset:2048 sc1
    buffer_load_dwordx4 a[92:95], v1, s[12:15], s37 offen offset:3072 sc1
    s_add_u32 s37, s37, 4096
    buffer_load_dwordx4 a[96:99], v1, s[12:15], s37 offen offset:0 sc1
    buffer_load_dwordx4 a[100:103], v1, s[12:15], s37 offen offset:1024 sc1
    buffer_load_dwordx4 a[104:107], v1, s[12:15], s37 offen offset:2048 sc1
    buffer_load_dwordx4 a[108:111], v1, s[12:15], s37 offen offset:3072 sc1
    s_add_u32 s37, s37, 4096
    buffer_load_dwordx4 a[112:115], v1, s[12:15], s37 offen offset:0 sc1
    buffer_load_dwordx4 a[116:119], v1, s[12:15], s37 offen offset:1024 sc1
    buffer_load_dwordx4 a[120:123], v1, s[12:15], s37 offen offset:2048 sc1
    buffer_load_dwordx4 a[124:127], v1, s[12:15], s37 offen offset:3072 sc1
    s_add_u32 s37, s37, 4096
    v_and_b32 v17, 15, v0
    v_lshlrev_b32 v17, 2, v17
    buffer_load_dword a246, v17, s[12:15], s45 offen sc1
    s_waitcnt vmcnt(32)
    v_mfma_f32_16x16x32_bf16 v[32:35], v[24:27], a[0:3], 0
    v_mfma_f32_16x16x32_bf16 v[36:39], v[28:31], a[0:3], 0
    s_waitcnt vmcnt(31)
    v_mfma_f32_16x16x32_bf16 v[32:35], v[24:27], a[4:7], v[32:35]
    v_mfma_f32_16x16x32_bf16 v[36:39], v[28:31], a[4:7], v[36:39]
    s_waitcnt vmcnt(30)
    v_mfma_f32_16x16x32_bf16 v[32:35], v[24:27], a[8:11], v[32:35]
    v_mfma_f32_16x16x32_bf16 v[36:39], v[28:31], a[8:11], v[36:39]
    s_waitcnt vmcnt(29)
    v_mfma_f32_16x16x32_bf16 v[32:35], v[24:27], a[12:15], v[32:35]
    v_mfma_f32_16x16x32_bf16 v[36:39], v[28:31], a[12:15], v[36:39]
    s_waitcnt vmcnt(28)
    v_mfma_f32_16x16x32_bf16 v[32:35], v[24:27], a[16:19], v[32:35]
    v_mfma_f32_16x16x32_bf16 v[36:39], v[28:31], a[16:19], v[36:39]
    s_waitcnt vmcnt(27)
    v_mfma_f32_16x16x32_bf16 v[32:35], v[24:27], a[20:23], v[32:35]
    v_mfma_f32_16x16x32_bf16 v[36:39], v[28:31], a[20:23], v[36:39]
    s_waitcnt vmcnt(26)
    v_mfma_f32_16x16x32_bf16 v[32:35], v[24:27], a[24:27], v[32:35]
    v_mfma_f32_16x16x32_bf16 v[36:39], v[28:31], a[24:27], v[36:39]
    s_waitcnt vmcnt(25)
    v_mfma_f32_16x16x32_bf16 v[32:35], v[24:27], a[28:31], v[32:35]
    v_mfma_f32_16x16x32_bf16 v[36:39], v[28:31], a[28:31], v[36:39]
    s_waitcnt vmcnt(24)
    v_mfma_f32_16x16x32_bf16 v[32:35], v[24:27], a[32:35], v[32:35]
    v_mfma_f32_16x16x32_bf16 v[36:39], v[28:31], a[32:35], v[36:39]
    s_waitcnt vmcnt(23)
    v_mfma_f32_16x16x32_bf16 v[32:35], v[24:27], a[36:39], v[32:35]
    v_mfma_f32_16x16x32_bf16 v[36:39], v[28:31], a[36:39], v[36:39]
    s_waitcnt vmcnt(22)
    v_mfma_f32_16x16x32_bf16 v[32:35], v[24:27], a[40:43], v[32:35]
    v_mfma_f32_16x16x32_bf16 v[36:39], v[28:31], a[40:43], v[36:39]
    s_waitcnt vmcnt(21)
    v_mfma_f32_16x16x32_bf16 v[32:35], v[24:27], a[44:47], v[32:35]
    v_mfma_f32_16x16x32_bf16 v[36:39], v[28:31], a[44:47], v[36:39]
    s_waitcnt vmcnt(20)
    v_mfma_f32_16x16x32_bf16 v[32:35], v[24:27], a[48:51], v[32:35]
    v_mfma_f32_16x16x32_bf16 v[36:39], v[28:31], a[48:51], v[36:39]
    s_waitcnt vmcnt(19)
    v_mfma_f32_16x16x32_bf16 v[32:35], v[24:27], a[52:55], v[32:35]
    v_mfma_f32_16x16x32_bf16 v[36:39], v[28:31], a[52:55], v[36:39]
    s_waitcnt vmcnt(18)
    v_mfma_f32_16x16x32_bf16 v[32:35], v[24:27], a[56:59], v[32:35]
    v_mfma_f32_16x16x32_bf16 v[36:39], v[28:31], a[56:59], v[36:39]
    s_waitcnt vmcnt(17)
    v_mfma_f32_16x16x32_bf16 v[32:35], v[24:27], a[60:63], v[32:35]
    v_mfma_f32_16x16x32_bf16 v[36:39], v[28:31], a[60:63], v[36:39]
    s_waitcnt vmcnt(16)
    v_mfma_f32_16x16x32_bf16 v[40:43], v[24:27], a[64:67], 0
    v_mfma_f32_16x16x32_bf16 v[44:47], v[28:31], a[64:67], 0
    s_waitcnt vmcnt(15)
    v_mfma_f32_16x16x32_bf16 v[40:43], v[24:27], a[68:71], v[40:43]
    v_mfma_f32_16x16x32_bf16 v[44:47], v[28:31], a[68:71], v[44:47]
    s_waitcnt vmcnt(14)
    v_mfma_f32_16x16x32_bf16 v[40:43], v[24:27], a[72:75], v[40:43]
    v_mfma_f32_16x16x32_bf16 v[44:47], v[28:31], a[72:75], v[44:47]
    s_waitcnt vmcnt(13)
    v_mfma_f32_16x16x32_bf16 v[40:43], v[24:27], a[76:79], v[40:43]
    v_mfma_f32_16x16x32_bf16 v[44:47], v[28:31], a[76:79], v[44:47]
    s_waitcnt vmcnt(12)
    v_mfma_f32_16x16x32_bf16 v[40:43], v[24:27], a[80:83], v[40:43]
    v_mfma_f32_16x16x32_bf16 v[44:47], v[28:31], a[80:83], v[44:47]
    s_waitcnt vmcnt(11)
    v_mfma_f32_16x16x32_bf16 v[40:43], v[24:27], a[84:87], v[40:43]
    v_mfma_f32_16x16x32_bf16 v[44:47], v[28:31], a[84:87], v[44:47]
    s_waitcnt vmcnt(10)
    v_mfma_f32_16x16x32_bf16 v[40:43], v[24:27], a[88:91], v[40:43]
    v_mfma_f32_16x16x32_bf16 v[44:47], v[28:31], a[88:91], v[44:47]
    s_waitcnt vmcnt(9)
    v_mfma_f32_16x16x32_bf16 v[40:43], v[24:27], a[92:95], v[40:43]
    v_mfma_f32_16x16x32_bf16 v[44:47], v[28:31], a[92:95], v[44:47]
    s_waitcnt vmcnt(8)
    v_mfma_f32_16x16x32_bf16 v[40:43], v[24:27], a[96:99], v[40:43]
    v_mfma_f32_16x16x32_bf16 v[44:47], v[28:31], a[96:99], v[44:47]
    s_waitcnt vmcnt(7)
    v_mfma_f32_16x16x32_bf16 v[40:43], v[24:27], a[100:103], v[40:43]
    v_mfma_f32_16x16x32_bf16 v[44:47], v[28:31], a[100:103], v[44:47]
    s_waitcnt vmcnt(6)
    v_mfma_f32_16x16x32_bf16 v[40:43], v[24:27], a[104:107], v[40:43]
    v_mfma_f32_16x16x32_bf16 v[44:47], v[28:31], a[104:107], v[44:47]
    s_waitcnt vmcnt(5)
    v_mfma_f32_16x16x32_bf16 v[40:43], v[24:27], a[108:111], v[40:43]
    v_mfma_f32_16x16x32_bf16 v[44:47], v[28:31], a[108:111], v[44:47]
    s_waitcnt vmcnt(4)
    v_mfma_f32_16x16x32_bf16 v[40:43], v[24:27], a[112:115], v[40:43]
    v_mfma_f32_16x16x32_bf16 v[44:47], v[28:31], a[112:115], v[44:47]
    s_waitcnt vmcnt(3)
    v_mfma_f32_16x16x32_bf16 v[40:43], v[24:27], a[116:119], v[40:43]
    v_mfma_f32_16x16x32_bf16 v[44:47], v[28:31], a[116:119], v[44:47]
    s_waitcnt vmcnt(2)
    v_mfma_f32_16x16x32_bf16 v[40:43], v[24:27], a[120:123], v[40:43]
    v_mfma_f32_16x16x32_bf16 v[44:47], v[28:31], a[120:123], v[44:47]
    s_waitcnt vmcnt(1)
    v_mfma_f32_16x16x32_bf16 v[40:43], v[24:27], a[124:127], v[40:43]
    v_mfma_f32_16x16x32_bf16 v[44:47], v[28:31], a[124:127], v[44:47]
    v_cvt_pk_bf16_f32 v32, v32, v33
    v_cvt_pk_bf16_f32 v33, v34, v35
    v_cvt_pk_bf16_f32 v34, v36, v37
    v_cvt_pk_bf16_f32 v35, v38, v39
    buffer_store_dwordx4 v[32:35], v2, s[8:11], s36 offen offset:0
    s_nop 2
    v_cvt_pk_bf16_f32 v40, v40, v41
    v_cvt_pk_bf16_f32 v41, v42, v43
    v_cvt_pk_bf16_f32 v42, v44, v45
    v_cvt_pk_bf16_f32 v43, v46, v47
    buffer_store_dwordx4 v[40:43], v2, s[8:11], s36 offen offset:64
    s_waitcnt vmcnt(2)
L_long:
    v_accvgpr_read_b32 v17, a246
    v_cmp_ne_u32 vcc, 0, v17
    s_cbranch_vccz L_poll6_ok
    v_and_b32 v16, 15, v0
    v_lshlrev_b32 v16, 2, v16
    s_mov_b32 s32, 0
L_poll6:
    buffer_load_dword v17, v16, s[12:15], s45 offen sc1
    s_waitcnt vmcnt(0)
    v_cmp_ne_u32 vcc, 0, v17
    s_cbranch_vccz L_poll6_ok
    s_sleep 8
    s_add_u32 s32, s32, 1
    s_cmp_lt_u32 s32, 0x80000
    s_cbranch_scc1 L_poll6
L_poll6_ok:
    buffer_load_dwordx4 a[0:3], v1, s[12:15], s38 offen offset:0 sc1
    buffer_load_dwordx4 a[4:7], v1, s[12:15], s38 offen offset:1024 sc1
    buffer_load_dwordx4 a[8:11], v1, s[12:15], s38 offen offset:2048 sc1
    buffer_load_dwordx4 a[12:15], v1, s[12:15], s38 offen offset:3072 sc1
    s_add_u32 s38, s38, 4096
    buffer_load_dwordx4 a[16:19], v1, s[12:15], s38 offen offset:0 sc1
    buffer_load_dwordx4 a[20:23], v1, s[12:15], s38 offen offset:1024 sc1
    buffer_load_dwordx4 a[24:27], v1, s[12:15], s38 offen offset:2048 sc1
    buffer_load_dwordx4 a[28:31], v1, s[12:15], s38 offen offset:3072 sc1
    s_add_u32 s38, s38, 4096
    buffer_load_dwordx4 a[32:35], v1, s[12:15], s38 offen offset:0 sc1
    buffer_load_dwordx4 a[36:39], v1, s[12:15], s38 offen offset:1024 sc1
    buffer_load_dwordx4 a[40:43], v1, s[12:15], s38 offen offset:2048 sc1
    buffer_load_dwordx4 a[44:47], v1, s[12:15], s38 offen offset:3072 sc1
    s_add_u32 s38, s38, 4096
    buffer_load_dwordx4 a[48:51], v1, s[12:15], s38 offen offset:0 sc1
    buffer_load_dwordx4 a[52:55], v1, s[12:15], s38 offen offset:1024 sc1
    buffer_load_dwordx4 a[56:59], v1, s[12:15], s38 offen offset:2048 sc1
    buffer_load_dwordx4 a[60:63], v1, s[12:15], s38 offen offset:3072 sc1
    s_add_u32 s38, s38, 4096
    s_waitcnt vmcnt(15)
    v_mfma_f32_16x16x32_bf16 v[32:35], v[24:27], a[0:3], 0
    v_mfma_f32_16x16x32_bf16 v[36:39], v[28:31], a[0:3], 0
    s_waitcnt vmcnt(14)
    v_mfma_f32_16x16x32_bf16 v[32:35], v[24:27], a[4:7], v[32:35]
    v_mfma_f32_16x16x32_bf16 v[36:39], v[28:31], a[4:7], v[36:39]
    s_waitcnt vmcnt(13)
    v_mfma_f32_16x16x32_bf16 v[32:35], v[24:27], a[8:11], v[32:35]
    v_mfma_f32_16x16x32_bf16 v[36:39], v[28:31], a[8:11], v[36:39]
    s_waitcnt vmcnt(12)
    v_mfma_f32_16x16x32_bf16 v[32:35], v[24:27], a[12:15], v[32:35]
    v_mfma_f32_16x16x32_bf16 v[36:39], v[28:31], a[12:15], v[36:39]
    s_waitcnt vmcnt(11)
    v_mfma_f32_16x16x32_bf16 v[32:35], v[24:27], a[16:19], v[32:35]
    v_mfma_f32_16x16x32_bf16 v[36:39], v[28:31], a[16:19], v[36:39]
    s_waitcnt vmcnt(10)
    v_mfma_f32_16x16x32_bf16 v[32:35], v[24:27], a[20:23], v[32:35]
    v_mfma_f32_16x16x32_bf16 v[36:39], v[28:31], a[20:23], v[36:39]
    s_waitcnt vmcnt(9)
    v_mfma_f32_16x16x32_bf16 v[32:35], v[24:27], a[24:27], v[32:35]
    v_mfma_f32_16x16x32_bf16 v[36:39], v[28:31], a[24:27], v[36:39]
    s_waitcnt vmcnt(8)
    v_mfma_f32_16x16x32_bf16 v[32:35], v[24:27], a[28:31], v[32:35]
    v_mfma_f32_16x16x32_bf16 v[36:39], v[28:31], a[28:31], v[36:39]
    s_waitcnt vmcnt(7)
    v_mfma_f32_16x16x32_bf16 v[32:35], v[24:27], a[32:35], v[32:35]
    v_mfma_f32_16x16x32_bf16 v[36:39], v[28:31], a[32:35], v[36:39]
    s_waitcnt vmcnt(6)
    v_mfma_f32_16x16x32_bf16 v[32:35], v[24:27], a[36:39], v[32:35]
    v_mfma_f32_16x16x32_bf16 v[36:39], v[28:31], a[36:39], v[36:39]
    s_waitcnt vmcnt(5)
    v_mfma_f32_16x16x32_bf16 v[32:35], v[24:27], a[40:43], v[32:35]
    v_mfma_f32_16x16x32_bf16 v[36:39], v[28:31], a[40:43], v[36:39]
    s_waitcnt vmcnt(4)
    v_mfma_f32_16x16x32_bf16 v[32:35], v[24:27], a[44:47], v[32:35]
    v_mfma_f32_16x16x32_bf16 v[36:39], v[28:31], a[44:47], v[36:39]
    s_waitcnt vmcnt(3)
    v_mfma_f32_16x16x32_bf16 v[32:35], v[24:27], a[48:51], v[32:35]
    v_mfma_f32_16x16x32_bf16 v[36:39], v[28:31], a[48:51], v[36:39]
    s_waitcnt vmcnt(2)
    v_mfma_f32_16x16x32_bf16 v[32:35], v[24:27], a[52:55], v[32:35]
    v_mfma_f32_16x16x32_bf16 v[36:39], v[28:31], a[52:55], v[36:39]
    s_waitcnt vmcnt(1)
    v_mfma_f32_16x16x32_bf16 v[32:35], v[24:27], a[56:59], v[32:35]
    v_mfma_f32_16x16x32_bf16 v[36:39], v[28:31], a[56:59], v[36:39]
    s_waitcnt vmcnt(0)
    v_mfma_f32_16x16x32_bf16 v[32:35], v[24:27], a[60:63], v[32:35]
    v_mfma_f32_16x16x32_bf16 v[36:39], v[28:31], a[60:63], v[36:39]
    s_nop 7
    v_cvt_pk_bf16_f32 v32, v32, v33
    v_cvt_pk_bf16_f32 v33, v34, v35
    v_cvt_pk_bf16_f32 v34, v36, v37
    v_cvt_pk_bf16_f32 v35, v38, v39
    buffer_store_dwordx4 v[32:35], v2, s[8:11], s35 offen offset:0
L_fin:
    s_endpgm
L_codeend:
.section .rodata,"a"
.p2align 6
.amdhsa_kernel concat_heads__ssm_conv_h3__compressed_kv_cla__prompt_kernel
  .amdhsa_next_free_vgpr 512
  .amdhsa_next_free_sgpr 102
  .amdhsa_accum_offset 256
  .amdhsa_group_segment_fixed_size 0
  .amdhsa_kernarg_size 120
  .amdhsa_user_sgpr_count 2
  .amdhsa_user_sgpr_kernarg_segment_ptr 1
  .amdhsa_system_sgpr_workgroup_id_x 1
.end_amdhsa_kernel
```

```asm
; @launch grid=(256,1,1) block=(256,1,1) lds=163840
.amdgcn_target "amdgcn-amd-amdhsa--gfx950"
.text
.globl concat_heads__ssm_conv_h3__compressed_kv_cla__prompt_kernel
.p2align 8
.type concat_heads__ssm_conv_h3__compressed_kv_cla__prompt_kernel,@function
concat_heads__ssm_conv_h3__compressed_kv_cla__prompt_kernel:
    s_cmp_lt_u32 s2, 256
    s_cbranch_scc1 L_go
    s_endpgm
L_go:
    s_load_dwordx16 s[64:79], s[0:1], 0
    s_load_dwordx8 s[80:87], s[0:1], 64
    s_load_dwordx4 s[88:91], s[0:1], 96
    s_load_dwordx2 s[12:13], s[0:1], 112
    v_lshrrev_b32 v1, 6, v0
    v_and_b32 v0, 63, v0
    v_readfirstlane_b32 s3, v1
    s_and_b32 s24, s2, 7
    s_bfe_u32 s25, s2, 0x30003
    s_bfe_u32 s26, s2, 0x10006
    s_lshl_b32 s37, s24, 1
    s_add_u32 s26, s26, s37
    s_lshr_b32 s27, s2, 7
    s_bfe_u32 s28, s2, 0x40003
    s_lshl_b32 s29, s3, 10
    s_and_b32 s39, s3, 1
    s_lshr_b32 s40, s3, 1
    s_getpc_b64 s[100:101]
L_pc:
    s_sub_u32 s100, s100, L_pc-L_go
    s_subb_u32 s101, s101, 0
    s_lshr_b32 s32, s2, 1
    s_and_b32 s32, s32, 12
    s_add_u32 s32, s32, s3
    s_lshl_b32 s32, s32, 13
    v_lshlrev_b32 v14, 7, v0
    v_add_u32 v14, s32, v14
    v_min_u32 v14, L_codeend-L_go-4, v14
    v_accvgpr_write_b32 a244, v14
    global_load_dword a243, v14, s[100:101]
    s_mov_b32 s41, 65536
    s_mov_b32 s48, 32768
    s_mov_b32 s42, 131072
    s_mov_b32 s49, 131072
    s_mov_b32 s43, 196608
    s_mov_b32 s50, 163840
    s_mov_b32 s44, 262144
    s_mov_b32 s51, 262144
    s_mov_b32 s45, 327680
    s_mov_b32 s52, 294912
    s_mov_b32 s46, 393216
    s_mov_b32 s53, 393216
    s_mov_b32 s47, 458752
    s_mov_b32 s54, 425984
    s_lshl_b32 s56, s39, 1
    s_lshl_b32 s57, s40, 3
    s_add_u32 s56, s56, s57
    s_lshl_b32 s60, s25, 8
    s_lshl_b32 s58, s3, 3
    s_add_u32 s58, s58, s60
    v_lshrrev_b32 v14, 3, v0
    v_add_u32 v14, s58, v14
    v_lshlrev_b32 v14, 11, v14
    s_lshl_b32 s58, s39, 2
    v_lshrrev_b32 v15, 4, v0
    v_add_u32 v15, s58, v15
    v_xor_b32 v15, v0, v15
    v_and_b32 v15, 7, v15
    v_lshl_add_u32 v1, v15, 4, v14
    v_lshrrev_b32 v14, 5, v0
    s_lshl_b32 s58, s3, 1
    v_add_u32 v15, s58, v14
    v_lshlrev_b32 v15, 1, v15
    v_xor_b32 v15, v0, v15
    v_and_b32 v15, 31, v15
    v_lshlrev_b32 v15, 4, v15
    v_add_u32 v14, s56, v14
    v_lshl_add_u32 v14, v14, 13, v15
    s_lshl_b32 s58, s26, 9
    v_add_u32 v2, s58, v14
    s_lshl_b32 s31, s25, 16
    s_add_u32 s31, s31, s58
    v_lshrrev_b32 v15, 3, v0
    v_lshlrev_b32 v15, 13, v15
    v_and_b32 v14, 7, v0
    v_lshlrev_b32 v14, 6, v14
    v_add3_u32 v16, v14, v15, s31
    s_lshl_b32 s31, s25, 2
    s_lshr_b32 s32, s2, 6
    s_add_u32 s31, s31, s32
    s_lshl_b32 s31, s31, 17
    v_lshlrev_b32 v17, 11, v0
    v_add_u32 v17, s31, v17
    s_cmp_eq_u32 s3, 0
    s_cselect_b32 s30, 0x80000, 2.0
    s_cmp_eq_u32 s3, 1
    s_cselect_b32 s31, 128, 2.0
    s_waitcnt lgkmcnt(0)
    s_cmp_eq_u32 s27, 0
    s_cselect_b32 s8, s82, s84
    s_cselect_b32 s9, s83, s85
    s_mov_b32 s10, 8388608
    s_mov_b32 s11, 0x20000
    s_mov_b32 s4, s78
    s_mov_b32 s5, s79
    s_mov_b32 s6, 4194304
    s_mov_b32 s7, 0x20000
    s_mov_b32 s14, 268435456
    s_mov_b32 s15, 0x20000
    s_add_u32 m0, s29, 65536
    s_nop 0
    buffer_load_dwordx4 v2, s[8:11], 0 offen lds
    s_lshl_b32 s58, s27, 3
    s_add_u32 s59, s58, s25
    s_lshl_b32 s59, s59, 2
    s_lshl_b32 s92, s26, 7
    s_add_u32 s92, s92, s59
    s_add_u32 s92, s92, 84934656
    s_add_u32 s58, s58, s24
    s_mul_i32 s95, s58, 14
    s_add_u32 s95, s95, s28
    s_sub_u32 s63, 15, s25
    s_cmp_eq_u32 s27, 0
    s_cselect_b32 s63, s25, s63
    s_add_u32 m0, s29, 0
    s_nop 0
    buffer_load_dwordx4 v1, s[4:7], 0 offen lds
    s_lshl_b32 s93, s63, 7
    s_lshl_b32 s59, s26, 2
    s_add_u32 s93, s93, s59
    s_add_u32 s93, s93, 84938752
    s_and_b32 s94, s2, 127
    s_lshl_b32 s94, s94, 7
    s_add_u32 s94, s94, 84942848
    s_cmp_lg_u32 s3, 0
    s_cbranch_scc1 L_noclr
    s_lshl_b32 s58, s95, 2
    s_add_u32 s59, s58, 84963328
    s_add_u32 s58, s58, 84959232
    s_lshl_b32 s61, s27, 2
    s_add_u32 s61, s61, s94
    s_cmp_lt_u32 s28, 14
    s_cselect_b32 s58, s58, s92
    s_cselect_b32 s59, s59, s92
    v_mov_b32 v14, s92
    v_writelane_b32 v14, s93, 1
    v_writelane_b32 v14, s61, 2
    v_writelane_b32 v14, s58, 3
    v_writelane_b32 v14, s59, 4
    s_add_u32 s58, s93, 64
    v_writelane_b32 v14, s58, 5
    v_mov_b32 v15, 1
    s_mov_b64 exec, 63
    buffer_store_dword v15, v14, s[12:15], 0 offen sc1
    s_mov_b64 exec, -1
L_noclr:
    s_add_u32 m0, s29, 69632
    s_nop 0
    buffer_load_dwordx4 v2, s[8:11], s48 offen lds
    s_add_u32 m0, s29, 4096
    s_nop 0
    buffer_load_dwordx4 v1, s[4:7], s41 offen lds
    s_cmp_eq_u32 s3, 0
    s_cselect_b32 s58, 0, 0x80000000
    v_bfrev_b32 v14, 1
    v_writelane_b32 v14, s58, 0
    v_accvgpr_write_b32 a245, v14
    s_lshl_b32 s58, s39, 7
    s_lshl_b32 s59, s40, 3
    s_add_u32 m0, s29, 73728
    s_nop 0
    buffer_load_dwordx4 v2, s[8:11], s49 offen lds
    v_and_b32 v14, 15, v0
    v_lshrrev_b32 v15, 4, v0
    s_lshl_b32 s60, s63, 7
    s_lshl_b32 s62, s3, 4
    s_add_u32 s60, s60, s62
    v_lshrrev_b32 v13, 3, v0
    v_lshlrev_b32 v13, 1, v13
    v_add_u32 v12, s60, v13
    v_mul_u32_u24 v12, 896, v12
    v_lshrrev_b32 v13, 1, v13
    v_xor_b32 v13, v0, v13
    v_and_b32 v13, 7, v13
    s_add_u32 m0, s29, 8192
    s_nop 0
    buffer_load_dwordx4 v1, s[4:7], s42 offen lds
    v_lshl_add_u32 v13, v13, 4, v12
    v_accvgpr_write_b32 a240, v13
    v_lshrrev_b32 v13, 1, v14
    v_xor_b32 v12, v13, v15
    v_lshlrev_b32 v12, 4, v12
    v_lshl_add_u32 v12, v13, 7, v12
    v_and_b32 v13, 1, v14
    v_lshl_add_u32 v12, v13, 10, v12
    s_lshl_b32 s33, s3, 13
    s_add_u32 s33, s33, 0x20000
    v_add_u32 v12, s33, v12
    v_accvgpr_write_b32 a242, v12
    s_add_u32 m0, s29, 77824
    s_nop 0
    buffer_load_dwordx4 v2, s[8:11], s50 offen lds
    v_lshrrev_b32 v5, 1, v14
    v_xor_b32 v5, v5, v15
    v_add_u32 v14, s58, v14
    v_lshlrev_b32 v14, 7, v14
    v_lshl_add_u32 v4, v5, 4, v14
    v_xor_b32 v5, 64, v4
    v_bfe_u32 v14, v0, 2, 3
    v_lshrrev_b32 v15, 5, v0
    v_lshl_add_u32 v13, v15, 4, v14
    v_lshlrev_b32 v13, 9, v13
    v_xor_b32 v14, s59, v14
    v_lshl_add_u32 v13, v14, 5, v13
    s_add_u32 m0, s29, 12288
    s_nop 0
    buffer_load_dwordx4 v1, s[4:7], s43 offen lds
    v_and_b32 v14, 3, v0
    v_lshl_add_u32 v13, v14, 3, v13
    v_add_u32 v6, 0x10000, v13
    v_xor_b32 v7, 32, v6
    v_xor_b32 v8, 64, v6
    v_xor_b32 v9, 96, v6
    v_xor_b32 v10, 128, v6
    v_xor_b32 v11, 160, v6
    v_xor_b32 v12, 192, v6
    v_xor_b32 v13, 224, v6
    s_mov_b32 s16, s80
    s_add_u32 m0, s29, 81920
    s_nop 0
    buffer_load_dwordx4 v2, s[8:11], s51 offen lds
    s_mov_b32 s17, s81
    s_mov_b32 s18, 3670016
    s_mov_b32 s19, 0x20000
    s_mov_b32 s20, s76
    s_mov_b32 s21, s77
    s_mov_b32 s22, 1835008
    s_mov_b32 s23, 0x20000
    s_lshl_b32 s58, s26, 20
    s_lshl_b32 s62, s63, 16
    s_add_u32 s62, s62, s58
    s_lshl_b32 s59, s3, 13
    s_add_u32 s62, s62, s59
    s_add_u32 m0, s29, 16384
    s_nop 0
    buffer_load_dwordx4 v1, s[4:7], s44 offen lds
    s_add_u32 s62, s62, 33554432
    s_lshl_b32 s59, s25, 17
    s_add_u32 s58, s58, s59
    s_lshl_b32 s59, s39, 16
    s_add_u32 s58, s58, s59
    s_lshl_b32 s59, s40, 12
    s_lshl_b32 s59, s59, s27
    s_add_u32 s58, s58, s59
    s_lshl_b32 s59, s27, 24
    s_add_u32 s58, s58, s59
    s_mov_b32 s57, 57344
    s_lshl_b32 s60, s40, 8
    s_add_u32 m0, s29, 86016
    s_nop 0
    buffer_load_dwordx4 v2, s[8:11], s52 offen lds
    s_add_u32 s60, s60, 0x10000
    s_mov_b32 s34, 0x3db8aa3b
    s_mov_b32 s35, 0x3db8aa3b
    s_mul_i32 s55, s25, 6
    s_lshr_b32 s55, s55, 3
    s_cmp_lg_u32 s3, 0
    s_cmov_b32 s55, 64
    v_mov_b32 v15, 1
    s_mul_i32 s36, s2, 7282
    s_lshr_b32 s36, s36, 16
    s_mul_i32 s37, s36, 9
    s_sub_u32 s37, s2, s37
    s_add_u32 m0, s29, 20480
    s_nop 0
    buffer_load_dwordx4 v1, s[4:7], s45 offen lds
    s_lshl_b32 s38, s36, 16
    s_mov_b64 s[30:31], s[80:81]
    s_cmp_eq_u32 s37, 2
    s_cmov_b64 s[30:31], s[76:77]
    s_cmp_eq_u32 s37, 3
    s_cmov_b64 s[30:31], s[66:67]
    s_cmp_eq_u32 s37, 4
    s_cmov_b64 s[30:31], s[68:69]
    s_cmp_eq_u32 s37, 5
    s_cmov_b64 s[30:31], s[86:87]
    s_cmp_eq_u32 s37, 6
    s_cmov_b64 s[30:31], s[86:87]
    s_add_u32 m0, s29, 90112
    s_nop 0
    buffer_load_dwordx4 v2, s[8:11], s53 offen lds
    s_cmp_eq_u32 s37, 7
    s_cmov_b64 s[30:31], s[72:73]
    s_cmp_eq_u32 s37, 8
    s_cmov_b64 s[30:31], s[64:65]
    s_add_u32 s32, s38, 1835008
    s_cmp_eq_u32 s37, 1
    s_cmov_b32 s38, s32
    s_cmp_eq_u32 s37, 6
    s_cmov_b32 s38, s32
    s_lshl_b32 s32, s39, 15
    s_add_u32 s38, s38, s32
    s_cmp_ge_u32 s37, 9
    s_cmov_b32 s36, 28
    s_add_u32 m0, s29, 24576
    s_nop 0
    buffer_load_dwordx4 v1, s[4:7], s46 offen lds
    s_cmp_lt_u32 s36, 28
    s_cselect_b32 s32, 0x8000, 0
    s_cselect_b32 s38, s38, 0
    s_add_u32 s36, s30, s38
    s_addc_u32 s37, s31, 0
    s_mov_b32 s38, s32
    s_mov_b32 s39, 0x20000
    v_lshlrev_b32 v14, 6, v0
    s_mov_b32 s56, 0xffffd000
    s_movk_i32 s30, 0x1000
    s_cmp_ge_u32 s3, 2
    s_cbranch_scc1 L_pfset
    s_mov_b32 s38, 0
    s_cmp_eq_u32 s3, 0
    s_cselect_b64 s[36:37], s[8:9], s[4:5]
    s_cselect_b32 s38, s10, s6
    s_movk_i32 s30, 128
    s_cmov_b32 s30, 0x80000
    s_cselect_b64 vcc, -1, 0
    s_lshl_b32 s56, s30, 1
    v_cndmask_b32 v14, v17, v16, vcc
L_pfset:
    s_add_u32 m0, s29, 94208
    s_nop 0
    buffer_load_dwordx4 v2, s[8:11], s54 offen lds
    v_mov_b32 v15, 1
    s_add_u32 m0, s29, 28672
    s_nop 0
    buffer_load_dwordx4 v1, s[4:7], s47 offen lds
    v_mov_b32 v3, 0
    v_mov_b64 v[16:17], 0
    v_mov_b64 v[18:19], 0
    v_mov_b64 v[20:21], 0
    v_mov_b64 v[22:23], 0
    v_mov_b64 v[24:25], 0
    v_mov_b64 v[26:27], 0
    v_mov_b64 v[28:29], 0
    v_mov_b64 v[30:31], 0
    v_mov_b64 v[32:33], 0
    v_mov_b64 v[34:35], 0
    v_add_u32 v1, 128, v1
    v_add_u32 v2, 0x80000, v2
    s_add_u32 m0, s29, 98304
    s_nop 0
    buffer_load_dwordx4 v2, s[8:11], 0 offen lds
    v_mov_b64 v[36:37], 0
    v_mov_b64 v[38:39], 0
    v_mov_b64 v[40:41], 0
    v_mov_b64 v[42:43], 0
    v_mov_b64 v[44:45], 0
    v_mov_b64 v[46:47], 0
    v_mov_b64 v[48:49], 0
    v_mov_b64 v[50:51], 0
    s_add_u32 m0, s29, 32768
    s_nop 0
    buffer_load_dwordx4 v1, s[4:7], 0 offen lds
    v_mov_b64 v[52:53], 0
    v_mov_b64 v[54:55], 0
    v_mov_b64 v[56:57], 0
    v_mov_b64 v[58:59], 0
    v_mov_b64 v[60:61], 0
    v_mov_b64 v[62:63], 0
    v_mov_b64 v[64:65], 0
    v_mov_b64 v[66:67], 0
    s_add_u32 m0, s29, 102400
    s_nop 0
    buffer_load_dwordx4 v2, s[8:11], s48 offen lds
    v_mov_b64 v[68:69], 0
    v_mov_b64 v[70:71], 0
    v_mov_b64 v[72:73], 0
    v_mov_b64 v[74:75], 0
    v_mov_b64 v[76:77], 0
    v_mov_b64 v[78:79], 0
    v_mov_b64 v[80:81], 0
    v_mov_b64 v[82:83], 0
    s_add_u32 m0, s29, 36864
    s_nop 0
    buffer_load_dwordx4 v1, s[4:7], s41 offen lds
    v_mov_b64 v[84:85], 0
    v_mov_b64 v[86:87], 0
    v_mov_b64 v[88:89], 0
    v_mov_b64 v[90:91], 0
    v_mov_b64 v[92:93], 0
    v_mov_b64 v[94:95], 0
    v_mov_b64 v[96:97], 0
    v_mov_b64 v[98:99], 0
    s_add_u32 m0, s29, 106496
    s_nop 0
    buffer_load_dwordx4 v2, s[8:11], s49 offen lds
    v_mov_b64 v[100:101], 0
    v_mov_b64 v[102:103], 0
    v_mov_b64 v[104:105], 0
    v_mov_b64 v[106:107], 0
    v_mov_b64 v[108:109], 0
    v_mov_b64 v[110:111], 0
    v_mov_b64 v[112:113], 0
    v_mov_b64 v[114:115], 0
    s_add_u32 m0, s29, 40960
    s_nop 0
    buffer_load_dwordx4 v1, s[4:7], s42 offen lds
    v_mov_b64 v[116:117], 0
    v_mov_b64 v[118:119], 0
    v_mov_b64 v[120:121], 0
    v_mov_b64 v[122:123], 0
    v_mov_b64 v[124:125], 0
    v_mov_b64 v[126:127], 0
    v_mov_b64 v[128:129], 0
    v_mov_b64 v[130:131], 0
    s_add_u32 m0, s29, 110592
    s_nop 0
    buffer_load_dwordx4 v2, s[8:11], s50 offen lds
    v_mov_b64 v[132:133], 0
    v_mov_b64 v[134:135], 0
    v_mov_b64 v[136:137], 0
    v_mov_b64 v[138:139], 0
    v_mov_b64 v[140:141], 0
    v_mov_b64 v[142:143], 0
    v_mov_b64 v[144:145], 0
    v_mov_b64 v[146:147], 0
    s_add_u32 m0, s29, 45056
    s_nop 0
    buffer_load_dwordx4 v1, s[4:7], s43 offen lds
    v_mov_b64 v[148:149], 0
    v_mov_b64 v[150:151], 0
    v_mov_b64 v[152:153], 0
    v_mov_b64 v[154:155], 0
    v_mov_b64 v[156:157], 0
    v_mov_b64 v[158:159], 0
    v_mov_b64 v[160:161], 0
    s_add_u32 m0, s29, 114688
    s_nop 0
    buffer_load_dwordx4 v2, s[8:11], s51 offen lds
    v_mov_b64 v[162:163], 0
    v_mov_b64 v[164:165], 0
    v_mov_b64 v[166:167], 0
    v_mov_b64 v[168:169], 0
    v_mov_b64 v[170:171], 0
    v_mov_b64 v[172:173], 0
    v_mov_b64 v[174:175], 0
    v_mov_b64 v[176:177], 0
    s_add_u32 m0, s29, 49152
    s_nop 0
    buffer_load_dwordx4 v1, s[4:7], s44 offen lds
    v_mov_b64 v[178:179], 0
    v_mov_b64 v[180:181], 0
    v_mov_b64 v[182:183], 0
    v_mov_b64 v[184:185], 0
    v_mov_b64 v[186:187], 0
    v_mov_b64 v[188:189], 0
    v_mov_b64 v[190:191], 0
    v_mov_b64 v[192:193], 0
    s_add_u32 m0, s29, 118784
    s_nop 0
    buffer_load_dwordx4 v2, s[8:11], s52 offen lds
    v_mov_b64 v[194:195], 0
    v_mov_b64 v[196:197], 0
    v_mov_b64 v[198:199], 0
    v_mov_b64 v[200:201], 0
    v_mov_b64 v[202:203], 0
    v_mov_b64 v[204:205], 0
    v_mov_b64 v[206:207], 0
    v_mov_b64 v[208:209], 0
    s_add_u32 m0, s29, 53248
    s_nop 0
    buffer_load_dwordx4 v1, s[4:7], s45 offen lds
    v_mov_b64 v[210:211], 0
    v_mov_b64 v[212:213], 0
    v_mov_b64 v[214:215], 0
    v_mov_b64 v[216:217], 0
    v_mov_b64 v[218:219], 0
    v_mov_b64 v[220:221], 0
    v_mov_b64 v[222:223], 0
    v_mov_b64 v[224:225], 0
    s_add_u32 m0, s29, 122880
    s_nop 0
    buffer_load_dwordx4 v2, s[8:11], s53 offen lds
    v_mov_b64 v[226:227], 0
    v_mov_b64 v[228:229], 0
    v_mov_b64 v[230:231], 0
    v_mov_b64 v[232:233], 0
    v_mov_b64 v[234:235], 0
    v_mov_b64 v[236:237], 0
    v_mov_b64 v[238:239], 0
    v_mov_b64 v[240:241], 0
    s_add_u32 m0, s29, 57344
    s_nop 0
    buffer_load_dwordx4 v1, s[4:7], s46 offen lds
    v_mov_b64 v[242:243], 0
    v_mov_b64 v[244:245], 0
    v_mov_b64 v[246:247], 0
    v_mov_b64 v[248:249], 0
    v_mov_b64 v[250:251], 0
    v_mov_b64 v[252:253], 0
    v_mov_b64 v[254:255], 0
    v_accvgpr_write_b32 a224, 0
    s_add_u32 m0, s29, 126976
    s_nop 0
    buffer_load_dwordx4 v2, s[8:11], s54 offen lds
    v_accvgpr_write_b32 a225, 0
    v_accvgpr_write_b32 a226, 0
    v_accvgpr_write_b32 a227, 0
    v_accvgpr_write_b32 a228, 0
    v_accvgpr_write_b32 a229, 0
    v_accvgpr_write_b32 a230, 0
    v_accvgpr_write_b32 a231, 0
    v_accvgpr_write_b32 a232, 0
    s_add_u32 m0, s29, 61440
    s_nop 0
    buffer_load_dwordx4 v1, s[4:7], s47 offen lds
    v_accvgpr_write_b32 a233, 0
    v_accvgpr_write_b32 a234, 0
    v_accvgpr_write_b32 a235, 0
    v_accvgpr_write_b32 a236, 0
    v_accvgpr_write_b32 a237, 0
    v_accvgpr_write_b32 a238, 0
    v_accvgpr_write_b32 a239, 0
    v_add_u32 v1, 128, v1
    v_add_u32 v2, 0x80000, v2
    buffer_load_dword a243, v14, s[36:39], s56 offen
    s_add_u32 s56, s56, s30
    buffer_load_dword a243, v14, s[36:39], s56 offen
    s_add_u32 s56, s56, s30
    s_mov_b32 s61, 0
    s_waitcnt vmcnt(18)
    s_barrier
    ds_read_b64_tr_b16 a[0:1], v6 offset:0
    ds_read_b64_tr_b16 a[2:3], v6 offset:4096
    ds_read_b128 a[64:67], v4 offset:0
    ds_read_b64_tr_b16 a[4:5], v6 offset:16384
    ds_read_b64_tr_b16 a[6:7], v6 offset:20480
    ds_read_b128 a[68:71], v5 offset:0
    ds_read_b128 a[76:79], v5 offset:2048
    ds_read_b128 a[72:75], v4 offset:2048
    ds_read_b128 a[80:83], v4 offset:4096
    ds_read_b128 a[84:87], v5 offset:4096
    ds_read_b128 a[92:95], v5 offset:6144
    ds_read_b128 a[88:91], v4 offset:6144
    ds_read_b64_tr_b16 a[8:9], v7 offset:0
    ds_read_b64_tr_b16 a[10:11], v7 offset:4096
    ds_read_b64_tr_b16 a[12:13], v7 offset:16384
    ds_read_b64_tr_b16 a[14:15], v7 offset:20480
    ds_read_b64_tr_b16 a[16:17], v8 offset:0
    ds_read_b64_tr_b16 a[18:19], v8 offset:4096
    ds_read_b64_tr_b16 a[20:21], v8 offset:16384
    ds_read_b64_tr_b16 a[22:23], v8 offset:20480
    s_cmp_eq_u32 s27, 0
    s_waitcnt lgkmcnt(0)
    s_cbranch_scc0 L_vloop
.p2align 6
L_kloop:
    v_mfma_f32_16x16x32_bf16 v[88:91], a[0:3], a[64:67], v[88:91]
    ds_read_b64_tr_b16 a[24:25], v9 offset:0
    v_mfma_f32_16x16x32_bf16 v[88:91], a[4:7], a[68:71], v[88:91]
    ds_read_b64_tr_b16 a[26:27], v9 offset:4096
    v_mfma_f32_16x16x32_bf16 v[80:83], a[4:7], a[76:79], v[80:83]
    ds_read_b64_tr_b16 a[28:29], v9 offset:16384
    v_mfma_f32_16x16x32_bf16 v[80:83], a[0:3], a[72:75], v[80:83]
    ds_read_b64_tr_b16 a[30:31], v9 offset:20480
    v_mfma_f32_16x16x32_bf16 v[72:75], a[0:3], a[80:83], v[72:75]
    ds_read_b128 a[96:99], v4 offset:8192
    v_mfma_f32_16x16x32_bf16 v[72:75], a[4:7], a[84:87], v[72:75]
    s_cmp_eq_u32 s61, s55
    s_cbranch_scc1 L_kloop_side
L_kloop_back:
    v_mfma_f32_16x16x32_bf16 v[64:67], a[4:7], a[92:95], v[64:67]
    s_waitcnt lgkmcnt(8)
    ds_read_b128 a[100:103], v5 offset:8192
    v_mfma_f32_16x16x32_bf16 v[64:67], a[0:3], a[88:91], v[64:67]
    v_mfma_f32_16x16x32_bf16 v[68:71], a[8:11], a[88:91], v[68:71]
    ds_read_b128 a[108:111], v5 offset:10240
    v_mfma_f32_16x16x32_bf16 v[68:71], a[12:15], a[92:95], v[68:71]
    v_mfma_f32_16x16x32_bf16 v[76:79], a[12:15], a[84:87], v[76:79]
    ds_read_b128 a[104:107], v4 offset:10240
    v_mfma_f32_16x16x32_bf16 v[76:79], a[8:11], a[80:83], v[76:79]
    v_mfma_f32_16x16x32_bf16 v[84:87], a[8:11], a[72:75], v[84:87]
    ds_read_b128 a[112:115], v4 offset:12288
    v_mfma_f32_16x16x32_bf16 v[84:87], a[12:15], a[76:79], v[84:87]
    v_mfma_f32_16x16x32_bf16 v[92:95], a[12:15], a[68:71], v[92:95]
    ds_read_b128 a[116:119], v5 offset:12288
    v_mfma_f32_16x16x32_bf16 v[92:95], a[8:11], a[64:67], v[92:95]
    s_waitcnt lgkmcnt(8)
    v_mfma_f32_16x16x32_bf16 v[120:123], a[16:19], a[64:67], v[120:123]
    ds_read_b128 a[124:127], v5 offset:14336
    v_mfma_f32_16x16x32_bf16 v[120:123], a[20:23], a[68:71], v[120:123]
    v_mfma_f32_16x16x32_bf16 v[112:115], a[20:23], a[76:79], v[112:115]
    ds_read_b128 a[120:123], v4 offset:14336
    v_mfma_f32_16x16x32_bf16 v[112:115], a[16:19], a[72:75], v[112:115]
    v_mfma_f32_16x16x32_bf16 v[104:107], a[16:19], a[80:83], v[104:107]
    ds_read_b64_tr_b16 a[32:33], v10 offset:0
    v_mfma_f32_16x16x32_bf16 v[104:107], a[20:23], a[84:87], v[104:107]
    ds_read_b64_tr_b16 a[34:35], v10 offset:4096
    v_mfma_f32_16x16x32_bf16 v[96:99], a[20:23], a[92:95], v[96:99]
    ds_read_b64_tr_b16 a[36:37], v10 offset:16384
    v_mfma_f32_16x16x32_bf16 v[96:99], a[16:19], a[88:91], v[96:99]
    ds_read_b64_tr_b16 a[38:39], v10 offset:20480
    v_mfma_f32_16x16x32_bf16 v[100:103], a[24:27], a[88:91], v[100:103]
    s_waitcnt lgkmcnt(8)
    ds_read_b64_tr_b16 a[40:41], v11 offset:0
    v_mfma_f32_16x16x32_bf16 v[100:103], a[28:31], a[92:95], v[100:103]
    ds_read_b64_tr_b16 a[42:43], v11 offset:4096
    v_mfma_f32_16x16x32_bf16 v[108:111], a[28:31], a[84:87], v[108:111]
    ds_read_b64_tr_b16 a[44:45], v11 offset:16384
    v_mfma_f32_16x16x32_bf16 v[108:111], a[24:27], a[80:83], v[108:111]
    ds_read_b64_tr_b16 a[46:47], v11 offset:20480
    v_mfma_f32_16x16x32_bf16 v[116:119], a[24:27], a[72:75], v[116:119]
    ds_read_b64_tr_b16 a[48:49], v12 offset:0
    v_mfma_f32_16x16x32_bf16 v[116:119], a[28:31], a[76:79], v[116:119]
    ds_read_b64_tr_b16 a[50:51], v12 offset:4096
    v_mfma_f32_16x16x32_bf16 v[124:127], a[28:31], a[68:71], v[124:127]
    ds_read_b64_tr_b16 a[52:53], v12 offset:16384
    v_mfma_f32_16x16x32_bf16 v[124:127], a[24:27], a[64:67], v[124:127]
    ds_read_b64_tr_b16 a[54:55], v12 offset:20480
    v_mfma_f32_16x16x32_bf16 a[232:235], a[0:3], a[96:99], a[232:235]
    ds_read_b64_tr_b16 a[56:57], v13 offset:0
    v_mfma_f32_16x16x32_bf16 a[232:235], a[4:7], a[100:103], a[232:235]
    ds_read_b64_tr_b16 a[58:59], v13 offset:4096
    v_mfma_f32_16x16x32_bf16 a[224:227], a[4:7], a[108:111], a[224:227]
    ds_read_b64_tr_b16 a[60:61], v13 offset:16384
    v_mfma_f32_16x16x32_bf16 a[224:227], a[0:3], a[104:107], a[224:227]
    s_waitcnt lgkmcnt(8)
    ds_read_b64_tr_b16 a[62:63], v13 offset:20480
    v_mfma_f32_16x16x32_bf16 v[24:27], a[0:3], a[112:115], v[24:27]
    v_mfma_f32_16x16x32_bf16 v[24:27], a[4:7], a[116:119], v[24:27]
    v_mfma_f32_16x16x32_bf16 v[16:19], a[4:7], a[124:127], v[16:19]
    v_mfma_f32_16x16x32_bf16 v[16:19], a[0:3], a[120:123], v[16:19]
    s_waitcnt lgkmcnt(0)
    v_mfma_f32_16x16x32_bf16 v[20:23], a[8:11], a[120:123], v[20:23]
    s_barrier
    v_mfma_f32_16x16x32_bf16 v[20:23], a[12:15], a[124:127], v[20:23]
    s_add_u32 m0, s29, 65536
    v_mfma_f32_16x16x32_bf16 v[28:31], a[12:15], a[116:119], v[28:31]
    buffer_load_dwordx4 v2, s[8:11], 0 offen lds
    v_mfma_f32_16x16x32_bf16 v[28:31], a[8:11], a[112:115], v[28:31]
    v_mfma_f32_16x16x32_bf16 a[228:231], a[8:11], a[104:107], a[228:231]
    v_mfma_f32_16x16x32_bf16 a[228:231], a[12:15], a[108:111], a[228:231]
    v_mfma_f32_16x16x32_bf16 a[236:239], a[12:15], a[100:103], a[236:239]
    s_add_u32 m0, s29, 0
    v_mfma_f32_16x16x32_bf16 a[236:239], a[8:11], a[96:99], a[236:239]
    buffer_load_dwordx4 v1, s[4:7], 0 offen lds
    v_mfma_f32_16x16x32_bf16 v[56:59], a[16:19], a[96:99], v[56:59]
    v_mfma_f32_16x16x32_bf16 v[56:59], a[20:23], a[100:103], v[56:59]
    v_mfma_f32_16x16x32_bf16 v[48:51], a[20:23], a[108:111], v[48:51]
    v_mfma_f32_16x16x32_bf16 v[48:51], a[16:19], a[104:107], v[48:51]
    s_add_u32 m0, s29, 69632
    v_mfma_f32_16x16x32_bf16 v[40:43], a[16:19], a[112:115], v[40:43]
    buffer_load_dwordx4 v2, s[8:11], s48 offen lds
    v_mfma_f32_16x16x32_bf16 v[40:43], a[20:23], a[116:119], v[40:43]
    v_mfma_f32_16x16x32_bf16 v[32:35], a[20:23], a[124:127], v[32:35]
    v_mfma_f32_16x16x32_bf16 v[32:35], a[16:19], a[120:123], v[32:35]
    v_mfma_f32_16x16x32_bf16 v[36:39], a[24:27], a[120:123], v[36:39]
    s_add_u32 m0, s29, 4096
    v_mfma_f32_16x16x32_bf16 v[36:39], a[28:31], a[124:127], v[36:39]
    buffer_load_dwordx4 v1, s[4:7], s41 offen lds
    v_mfma_f32_16x16x32_bf16 v[44:47], a[28:31], a[116:119], v[44:47]
    v_mfma_f32_16x16x32_bf16 v[44:47], a[24:27], a[112:115], v[44:47]
    v_mfma_f32_16x16x32_bf16 v[52:55], a[24:27], a[104:107], v[52:55]
    v_mfma_f32_16x16x32_bf16 v[52:55], a[28:31], a[108:111], v[52:55]
    s_add_u32 m0, s29, 73728
    v_mfma_f32_16x16x32_bf16 v[60:63], a[28:31], a[100:103], v[60:63]
    buffer_load_dwordx4 v2, s[8:11], s49 offen lds
    v_mfma_f32_16x16x32_bf16 v[60:63], a[24:27], a[96:99], v[60:63]
    v_mfma_f32_16x16x32_bf16 v[216:219], a[32:35], a[96:99], v[216:219]
    v_mfma_f32_16x16x32_bf16 v[216:219], a[36:39], a[100:103], v[216:219]
    v_mfma_f32_16x16x32_bf16 v[208:211], a[36:39], a[108:111], v[208:211]
    s_add_u32 m0, s29, 8192
    v_mfma_f32_16x16x32_bf16 v[208:211], a[32:35], a[104:107], v[208:211]
    buffer_load_dwordx4 v1, s[4:7], s42 offen lds
    v_mfma_f32_16x16x32_bf16 v[200:203], a[32:35], a[112:115], v[200:203]
    v_mfma_f32_16x16x32_bf16 v[200:203], a[36:39], a[116:119], v[200:203]
    v_mfma_f32_16x16x32_bf16 v[192:195], a[36:39], a[124:127], v[192:195]
    v_mfma_f32_16x16x32_bf16 v[192:195], a[32:35], a[120:123], v[192:195]
    s_add_u32 m0, s29, 77824
    v_mfma_f32_16x16x32_bf16 v[196:199], a[40:43], a[120:123], v[196:199]
    buffer_load_dwordx4 v2, s[8:11], s50 offen lds
    v_mfma_f32_16x16x32_bf16 v[196:199], a[44:47], a[124:127], v[196:199]
    v_mfma_f32_16x16x32_bf16 v[204:207], a[44:47], a[116:119], v[204:207]
    v_mfma_f32_16x16x32_bf16 v[204:207], a[40:43], a[112:115], v[204:207]
    v_mfma_f32_16x16x32_bf16 v[212:215], a[40:43], a[104:107], v[212:215]
    s_add_u32 m0, s29, 12288
    v_mfma_f32_16x16x32_bf16 v[212:215], a[44:47], a[108:111], v[212:215]
    buffer_load_dwordx4 v1, s[4:7], s43 offen lds
    v_mfma_f32_16x16x32_bf16 v[220:223], a[44:47], a[100:103], v[220:223]
    v_mfma_f32_16x16x32_bf16 v[220:223], a[40:43], a[96:99], v[220:223]
    v_mfma_f32_16x16x32_bf16 v[248:251], a[48:51], a[96:99], v[248:251]
    v_mfma_f32_16x16x32_bf16 v[248:251], a[52:55], a[100:103], v[248:251]
    s_add_u32 m0, s29, 81920
    v_mfma_f32_16x16x32_bf16 v[240:243], a[52:55], a[108:111], v[240:243]
    buffer_load_dwordx4 v2, s[8:11], s51 offen lds
    v_mfma_f32_16x16x32_bf16 v[240:243], a[48:51], a[104:107], v[240:243]
    v_mfma_f32_16x16x32_bf16 v[232:235], a[48:51], a[112:115], v[232:235]
    v_mfma_f32_16x16x32_bf16 v[232:235], a[52:55], a[116:119], v[232:235]
    v_mfma_f32_16x16x32_bf16 v[224:227], a[52:55], a[124:127], v[224:227]
    s_add_u32 m0, s29, 16384
    v_mfma_f32_16x16x32_bf16 v[224:227], a[48:51], a[120:123], v[224:227]
    buffer_load_dwordx4 v1, s[4:7], s44 offen lds
    v_mfma_f32_16x16x32_bf16 v[228:231], a[56:59], a[120:123], v[228:231]
    v_mfma_f32_16x16x32_bf16 v[228:231], a[60:63], a[124:127], v[228:231]
    v_mfma_f32_16x16x32_bf16 v[236:239], a[60:63], a[116:119], v[236:239]
    v_mfma_f32_16x16x32_bf16 v[236:239], a[56:59], a[112:115], v[236:239]
    s_add_u32 m0, s29, 86016
    v_mfma_f32_16x16x32_bf16 v[244:247], a[56:59], a[104:107], v[244:247]
    s_waitcnt vmcnt(11)
    buffer_load_dwordx4 v2, s[8:11], s52 offen lds
    v_mfma_f32_16x16x32_bf16 v[244:247], a[60:63], a[108:111], v[244:247]
    s_barrier
    ds_read_b64_tr_b16 a[0:1], v6 offset:32768
    v_mfma_f32_16x16x32_bf16 v[252:255], a[60:63], a[100:103], v[252:255]
    ds_read_b64_tr_b16 a[2:3], v6 offset:36864
    v_mfma_f32_16x16x32_bf16 v[252:255], a[56:59], a[96:99], v[252:255]
    ds_read_b128 a[96:99], v4 offset:40960
    v_mfma_f32_16x16x32_bf16 v[152:155], a[32:35], a[64:67], v[152:155]
    s_add_u32 m0, s29, 20480
    v_mfma_f32_16x16x32_bf16 v[152:155], a[36:39], a[68:71], v[152:155]
    buffer_load_dwordx4 v1, s[4:7], s45 offen lds
    v_mfma_f32_16x16x32_bf16 v[144:147], a[36:39], a[76:79], v[144:147]
    ds_read_b64_tr_b16 a[4:5], v6 offset:49152
    v_mfma_f32_16x16x32_bf16 v[144:147], a[32:35], a[72:75], v[144:147]
    ds_read_b64_tr_b16 a[6:7], v6 offset:53248
    v_mfma_f32_16x16x32_bf16 v[136:139], a[32:35], a[80:83], v[136:139]
    ds_read_b128 a[100:103], v5 offset:40960
    v_mfma_f32_16x16x32_bf16 v[136:139], a[36:39], a[84:87], v[136:139]
    s_add_u32 m0, s29, 90112
    v_mfma_f32_16x16x32_bf16 v[128:131], a[36:39], a[92:95], v[128:131]
    buffer_load_dwordx4 v2, s[8:11], s53 offen lds
    v_mfma_f32_16x16x32_bf16 v[128:131], a[32:35], a[88:91], v[128:131]
    ds_read_b128 a[108:111], v5 offset:43008
    v_mfma_f32_16x16x32_bf16 v[132:135], a[40:43], a[88:91], v[132:135]
    v_mfma_f32_16x16x32_bf16 v[132:135], a[44:47], a[92:95], v[132:135]
    ds_read_b128 a[104:107], v4 offset:43008
    v_mfma_f32_16x16x32_bf16 v[140:143], a[44:47], a[84:87], v[140:143]
    s_add_u32 m0, s29, 24576
    v_mfma_f32_16x16x32_bf16 v[140:143], a[40:43], a[80:83], v[140:143]
    buffer_load_dwordx4 v1, s[4:7], s46 offen lds
    v_mfma_f32_16x16x32_bf16 v[148:151], a[40:43], a[72:75], v[148:151]
    ds_read_b128 a[112:115], v4 offset:45056
    v_mfma_f32_16x16x32_bf16 v[148:151], a[44:47], a[76:79], v[148:151]
    v_mfma_f32_16x16x32_bf16 v[156:159], a[44:47], a[68:71], v[156:159]
    ds_read_b128 a[116:119], v5 offset:45056
    v_mfma_f32_16x16x32_bf16 v[156:159], a[40:43], a[64:67], v[156:159]
    s_add_u32 m0, s29, 94208
    v_mfma_f32_16x16x32_bf16 v[184:187], a[48:51], a[64:67], v[184:187]
    buffer_load_dwordx4 v2, s[8:11], s54 offen lds
    v_mfma_f32_16x16x32_bf16 v[184:187], a[52:55], a[68:71], v[184:187]
    ds_read_b128 a[124:127], v5 offset:47104
    v_mfma_f32_16x16x32_bf16 v[176:179], a[52:55], a[76:79], v[176:179]
    v_mfma_f32_16x16x32_bf16 v[176:179], a[48:51], a[72:75], v[176:179]
    ds_read_b128 a[120:123], v4 offset:47104
    v_mfma_f32_16x16x32_bf16 v[168:171], a[48:51], a[80:83], v[168:171]
    s_add_u32 m0, s29, 28672
    v_mfma_f32_16x16x32_bf16 v[168:171], a[52:55], a[84:87], v[168:171]
    buffer_load_dwordx4 v1, s[4:7], s47 offen lds
    v_mfma_f32_16x16x32_bf16 v[160:163], a[52:55], a[92:95], v[160:163]
    v_add_u32 v1, 128, v1
    v_add_u32 v2, 0x80000, v2
    v_mfma_f32_16x16x32_bf16 v[160:163], a[48:51], a[88:91], v[160:163]
    ds_read_b64_tr_b16 a[8:9], v7 offset:32768
    v_mfma_f32_16x16x32_bf16 v[164:167], a[56:59], a[88:91], v[164:167]
    buffer_load_dword a243, v14, s[36:39], s56 offen
    v_mfma_f32_16x16x32_bf16 v[164:167], a[60:63], a[92:95], v[164:167]
    s_add_u32 s56, s56, s30
    ds_read_b64_tr_b16 a[10:11], v7 offset:36864
    v_mfma_f32_16x16x32_bf16 v[172:175], a[60:63], a[84:87], v[172:175]
    ds_read_b64_tr_b16 a[12:13], v7 offset:49152
    v_mfma_f32_16x16x32_bf16 v[172:175], a[56:59], a[80:83], v[172:175]
    ds_read_b64_tr_b16 a[14:15], v7 offset:53248
    v_mfma_f32_16x16x32_bf16 v[180:183], a[56:59], a[72:75], v[180:183]
    ds_read_b64_tr_b16 a[16:17], v8 offset:32768
    v_mfma_f32_16x16x32_bf16 v[180:183], a[60:63], a[76:79], v[180:183]
    ds_read_b64_tr_b16 a[18:19], v8 offset:36864
    v_mfma_f32_16x16x32_bf16 v[188:191], a[60:63], a[68:71], v[188:191]
    ds_read_b64_tr_b16 a[20:21], v8 offset:49152
    v_mfma_f32_16x16x32_bf16 v[188:191], a[56:59], a[64:67], v[188:191]
    s_waitcnt lgkmcnt(8)
    ds_read_b64_tr_b16 a[22:23], v8 offset:53248
    v_mfma_f32_16x16x32_bf16 a[232:235], a[0:3], a[96:99], a[232:235]
    ds_read_b64_tr_b16 a[24:25], v9 offset:32768
    v_mfma_f32_16x16x32_bf16 a[232:235], a[4:7], a[100:103], a[232:235]
    ds_read_b64_tr_b16 a[26:27], v9 offset:36864
    v_mfma_f32_16x16x32_bf16 a[224:227], a[4:7], a[108:111], a[224:227]
    ds_read_b64_tr_b16 a[28:29], v9 offset:49152
    v_mfma_f32_16x16x32_bf16 a[224:227], a[0:3], a[104:107], a[224:227]
    ds_read_b64_tr_b16 a[30:31], v9 offset:53248
    v_mfma_f32_16x16x32_bf16 v[24:27], a[0:3], a[112:115], v[24:27]
    ds_read_b128 a[64:67], v4 offset:32768
    v_mfma_f32_16x16x32_bf16 v[24:27], a[4:7], a[116:119], v[24:27]
    v_mfma_f32_16x16x32_bf16 v[16:19], a[4:7], a[124:127], v[16:19]
    s_waitcnt lgkmcnt(8)
    ds_read_b128 a[68:71], v5 offset:32768
    v_mfma_f32_16x16x32_bf16 v[16:19], a[0:3], a[120:123], v[16:19]
    v_mfma_f32_16x16x32_bf16 v[20:23], a[8:11], a[120:123], v[20:23]
    ds_read_b128 a[76:79], v5 offset:34816
    v_mfma_f32_16x16x32_bf16 v[20:23], a[12:15], a[124:127], v[20:23]
    v_mfma_f32_16x16x32_bf16 v[28:31], a[12:15], a[116:119], v[28:31]
    ds_read_b128 a[72:75], v4 offset:34816
    v_mfma_f32_16x16x32_bf16 v[28:31], a[8:11], a[112:115], v[28:31]
    v_mfma_f32_16x16x32_bf16 a[228:231], a[8:11], a[104:107], a[228:231]
    ds_read_b128 a[80:83], v4 offset:36864
    v_mfma_f32_16x16x32_bf16 a[228:231], a[12:15], a[108:111], a[228:231]
    v_mfma_f32_16x16x32_bf16 a[236:239], a[12:15], a[100:103], a[236:239]
    ds_read_b128 a[84:87], v5 offset:36864
    v_mfma_f32_16x16x32_bf16 a[236:239], a[8:11], a[96:99], a[236:239]
    s_waitcnt lgkmcnt(8)
    v_mfma_f32_16x16x32_bf16 v[56:59], a[16:19], a[96:99], v[56:59]
    ds_read_b128 a[92:95], v5 offset:38912
    v_mfma_f32_16x16x32_bf16 v[56:59], a[20:23], a[100:103], v[56:59]
    v_mfma_f32_16x16x32_bf16 v[48:51], a[20:23], a[108:111], v[48:51]
    ds_read_b128 a[88:91], v4 offset:38912
    v_mfma_f32_16x16x32_bf16 v[48:51], a[16:19], a[104:107], v[48:51]
    v_mfma_f32_16x16x32_bf16 v[40:43], a[16:19], a[112:115], v[40:43]
    ds_read_b64_tr_b16 a[32:33], v10 offset:32768
    v_mfma_f32_16x16x32_bf16 v[40:43], a[20:23], a[116:119], v[40:43]
    ds_read_b64_tr_b16 a[34:35], v10 offset:36864
    v_mfma_f32_16x16x32_bf16 v[32:35], a[20:23], a[124:127], v[32:35]
    ds_read_b64_tr_b16 a[36:37], v10 offset:49152
    v_mfma_f32_16x16x32_bf16 v[32:35], a[16:19], a[120:123], v[32:35]
    ds_read_b64_tr_b16 a[38:39], v10 offset:53248
    v_mfma_f32_16x16x32_bf16 v[36:39], a[24:27], a[120:123], v[36:39]
    s_waitcnt lgkmcnt(8)
    ds_read_b64_tr_b16 a[40:41], v11 offset:32768
    v_mfma_f32_16x16x32_bf16 v[36:39], a[28:31], a[124:127], v[36:39]
    ds_read_b64_tr_b16 a[42:43], v11 offset:36864
    v_mfma_f32_16x16x32_bf16 v[44:47], a[28:31], a[116:119], v[44:47]
    ds_read_b64_tr_b16 a[44:45], v11 offset:49152
    v_mfma_f32_16x16x32_bf16 v[44:47], a[24:27], a[112:115], v[44:47]
    ds_read_b64_tr_b16 a[46:47], v11 offset:53248
    v_mfma_f32_16x16x32_bf16 v[52:55], a[24:27], a[104:107], v[52:55]
    ds_read_b64_tr_b16 a[48:49], v12 offset:32768
    v_mfma_f32_16x16x32_bf16 v[52:55], a[28:31], a[108:111], v[52:55]
    ds_read_b64_tr_b16 a[50:51], v12 offset:36864
    v_mfma_f32_16x16x32_bf16 v[60:63], a[28:31], a[100:103], v[60:63]
    ds_read_b64_tr_b16 a[52:53], v12 offset:49152
    v_mfma_f32_16x16x32_bf16 v[60:63], a[24:27], a[96:99], v[60:63]
    ds_read_b64_tr_b16 a[54:55], v12 offset:53248
    v_mfma_f32_16x16x32_bf16 v[88:91], a[0:3], a[64:67], v[88:91]
    ds_read_b64_tr_b16 a[56:57], v13 offset:32768
    v_mfma_f32_16x16x32_bf16 v[88:91], a[4:7], a[68:71], v[88:91]
    ds_read_b64_tr_b16 a[58:59], v13 offset:36864
    v_mfma_f32_16x16x32_bf16 v[80:83], a[4:7], a[76:79], v[80:83]
    ds_read_b64_tr_b16 a[60:61], v13 offset:49152
    v_mfma_f32_16x16x32_bf16 v[80:83], a[0:3], a[72:75], v[80:83]
    s_waitcnt lgkmcnt(8)
    ds_read_b64_tr_b16 a[62:63], v13 offset:53248
    v_mfma_f32_16x16x32_bf16 v[72:75], a[0:3], a[80:83], v[72:75]
    v_mfma_f32_16x16x32_bf16 v[72:75], a[4:7], a[84:87], v[72:75]
    v_mfma_f32_16x16x32_bf16 v[64:67], a[4:7], a[92:95], v[64:67]
    v_mfma_f32_16x16x32_bf16 v[64:67], a[0:3], a[88:91], v[64:67]
    s_waitcnt lgkmcnt(0)
    v_mfma_f32_16x16x32_bf16 v[68:71], a[8:11], a[88:91], v[68:71]
    s_barrier
    v_mfma_f32_16x16x32_bf16 v[68:71], a[12:15], a[92:95], v[68:71]
    s_add_u32 m0, s29, 98304
    v_mfma_f32_16x16x32_bf16 v[76:79], a[12:15], a[84:87], v[76:79]
    buffer_load_dwordx4 v2, s[8:11], 0 offen lds
    v_mfma_f32_16x16x32_bf16 v[76:79], a[8:11], a[80:83], v[76:79]
    v_mfma_f32_16x16x32_bf16 v[84:87], a[8:11], a[72:75], v[84:87]
    v_mfma_f32_16x16x32_bf16 v[84:87], a[12:15], a[76:79], v[84:87]
    v_mfma_f32_16x16x32_bf16 v[92:95], a[12:15], a[68:71], v[92:95]
    s_add_u32 m0, s29, 32768
    v_mfma_f32_16x16x32_bf16 v[92:95], a[8:11], a[64:67], v[92:95]
    buffer_load_dwordx4 v1, s[4:7], 0 offen lds
    v_mfma_f32_16x16x32_bf16 v[120:123], a[16:19], a[64:67], v[120:123]
    v_mfma_f32_16x16x32_bf16 v[120:123], a[20:23], a[68:71], v[120:123]
    v_mfma_f32_16x16x32_bf16 v[112:115], a[20:23], a[76:79], v[112:115]
    v_mfma_f32_16x16x32_bf16 v[112:115], a[16:19], a[72:75], v[112:115]
    s_add_u32 m0, s29, 102400
    v_mfma_f32_16x16x32_bf16 v[104:107], a[16:19], a[80:83], v[104:107]
    buffer_load_dwordx4 v2, s[8:11], s48 offen lds
    v_mfma_f32_16x16x32_bf16 v[104:107], a[20:23], a[84:87], v[104:107]
    v_mfma_f32_16x16x32_bf16 v[96:99], a[20:23], a[92:95], v[96:99]
    v_mfma_f32_16x16x32_bf16 v[96:99], a[16:19], a[88:91], v[96:99]
    v_mfma_f32_16x16x32_bf16 v[100:103], a[24:27], a[88:91], v[100:103]
    s_add_u32 m0, s29, 36864
    v_mfma_f32_16x16x32_bf16 v[100:103], a[28:31], a[92:95], v[100:103]
    buffer_load_dwordx4 v1, s[4:7], s41 offen lds
    v_mfma_f32_16x16x32_bf16 v[108:111], a[28:31], a[84:87], v[108:111]
    v_mfma_f32_16x16x32_bf16 v[108:111], a[24:27], a[80:83], v[108:111]
    v_mfma_f32_16x16x32_bf16 v[116:119], a[24:27], a[72:75], v[116:119]
    v_mfma_f32_16x16x32_bf16 v[116:119], a[28:31], a[76:79], v[116:119]
    s_add_u32 m0, s29, 106496
    v_mfma_f32_16x16x32_bf16 v[124:127], a[28:31], a[68:71], v[124:127]
    buffer_load_dwordx4 v2, s[8:11], s49 offen lds
    v_mfma_f32_16x16x32_bf16 v[124:127], a[24:27], a[64:67], v[124:127]
    v_mfma_f32_16x16x32_bf16 v[152:155], a[32:35], a[64:67], v[152:155]
    v_mfma_f32_16x16x32_bf16 v[152:155], a[36:39], a[68:71], v[152:155]
    v_mfma_f32_16x16x32_bf16 v[144:147], a[36:39], a[76:79], v[144:147]
    s_add_u32 m0, s29, 40960
    v_mfma_f32_16x16x32_bf16 v[144:147], a[32:35], a[72:75], v[144:147]
    buffer_load_dwordx4 v1, s[4:7], s42 offen lds
    v_mfma_f32_16x16x32_bf16 v[136:139], a[32:35], a[80:83], v[136:139]
    v_mfma_f32_16x16x32_bf16 v[136:139], a[36:39], a[84:87], v[136:139]
    v_mfma_f32_16x16x32_bf16 v[128:131], a[36:39], a[92:95], v[128:131]
    v_mfma_f32_16x16x32_bf16 v[128:131], a[32:35], a[88:91], v[128:131]
    s_add_u32 m0, s29, 110592
    v_mfma_f32_16x16x32_bf16 v[132:135], a[40:43], a[88:91], v[132:135]
    buffer_load_dwordx4 v2, s[8:11], s50 offen lds
    v_mfma_f32_16x16x32_bf16 v[132:135], a[44:47], a[92:95], v[132:135]
    v_mfma_f32_16x16x32_bf16 v[140:143], a[44:47], a[84:87], v[140:143]
    v_mfma_f32_16x16x32_bf16 v[140:143], a[40:43], a[80:83], v[140:143]
    v_mfma_f32_16x16x32_bf16 v[148:151], a[40:43], a[72:75], v[148:151]
    s_add_u32 m0, s29, 45056
    v_mfma_f32_16x16x32_bf16 v[148:151], a[44:47], a[76:79], v[148:151]
    buffer_load_dwordx4 v1, s[4:7], s43 offen lds
    v_mfma_f32_16x16x32_bf16 v[156:159], a[44:47], a[68:71], v[156:159]
    v_mfma_f32_16x16x32_bf16 v[156:159], a[40:43], a[64:67], v[156:159]
    v_mfma_f32_16x16x32_bf16 v[184:187], a[48:51], a[64:67], v[184:187]
    v_mfma_f32_16x16x32_bf16 v[184:187], a[52:55], a[68:71], v[184:187]
    s_add_u32 m0, s29, 114688
    v_mfma_f32_16x16x32_bf16 v[176:179], a[52:55], a[76:79], v[176:179]
    buffer_load_dwordx4 v2, s[8:11], s51 offen lds
    v_mfma_f32_16x16x32_bf16 v[176:179], a[48:51], a[72:75], v[176:179]
    v_mfma_f32_16x16x32_bf16 v[168:171], a[48:51], a[80:83], v[168:171]
    v_mfma_f32_16x16x32_bf16 v[168:171], a[52:55], a[84:87], v[168:171]
    v_mfma_f32_16x16x32_bf16 v[160:163], a[52:55], a[92:95], v[160:163]
    s_add_u32 m0, s29, 49152
    v_mfma_f32_16x16x32_bf16 v[160:163], a[48:51], a[88:91], v[160:163]
    buffer_load_dwordx4 v1, s[4:7], s44 offen lds
    v_mfma_f32_16x16x32_bf16 v[164:167], a[56:59], a[88:91], v[164:167]
    v_mfma_f32_16x16x32_bf16 v[164:167], a[60:63], a[92:95], v[164:167]
    v_mfma_f32_16x16x32_bf16 v[172:175], a[60:63], a[84:87], v[172:175]
    v_mfma_f32_16x16x32_bf16 v[172:175], a[56:59], a[80:83], v[172:175]
    s_add_u32 m0, s29, 118784
    v_mfma_f32_16x16x32_bf16 v[180:183], a[56:59], a[72:75], v[180:183]
    s_waitcnt vmcnt(11)
    buffer_load_dwordx4 v2, s[8:11], s52 offen lds
    v_mfma_f32_16x16x32_bf16 v[180:183], a[60:63], a[76:79], v[180:183]
    s_barrier
    ds_read_b64_tr_b16 a[0:1], v6 offset:0
    v_mfma_f32_16x16x32_bf16 v[188:191], a[60:63], a[68:71], v[188:191]
    ds_read_b64_tr_b16 a[2:3], v6 offset:4096
    v_mfma_f32_16x16x32_bf16 v[188:191], a[56:59], a[64:67], v[188:191]
    ds_read_b128 a[64:67], v4 offset:0
    v_mfma_f32_16x16x32_bf16 v[216:219], a[32:35], a[96:99], v[216:219]
    s_add_u32 m0, s29, 53248
    v_mfma_f32_16x16x32_bf16 v[216:219], a[36:39], a[100:103], v[216:219]
    buffer_load_dwordx4 v1, s[4:7], s45 offen lds
    v_mfma_f32_16x16x32_bf16 v[208:211], a[36:39], a[108:111], v[208:211]
    ds_read_b64_tr_b16 a[4:5], v6 offset:16384
    v_mfma_f32_16x16x32_bf16 v[208:211], a[32:35], a[104:107], v[208:211]
    ds_read_b64_tr_b16 a[6:7], v6 offset:20480
    v_mfma_f32_16x16x32_bf16 v[200:203], a[32:35], a[112:115], v[200:203]
    ds_read_b128 a[68:71], v5 offset:0
    v_mfma_f32_16x16x32_bf16 v[200:203], a[36:39], a[116:119], v[200:203]
    s_add_u32 m0, s29, 122880
    v_mfma_f32_16x16x32_bf16 v[192:195], a[36:39], a[124:127], v[192:195]
    buffer_load_dwordx4 v2, s[8:11], s53 offen lds
    v_mfma_f32_16x16x32_bf16 v[192:195], a[32:35], a[120:123], v[192:195]
    ds_read_b128 a[76:79], v5 offset:2048
    v_mfma_f32_16x16x32_bf16 v[196:199], a[40:43], a[120:123], v[196:199]
    v_mfma_f32_16x16x32_bf16 v[196:199], a[44:47], a[124:127], v[196:199]
    ds_read_b128 a[72:75], v4 offset:2048
    v_mfma_f32_16x16x32_bf16 v[204:207], a[44:47], a[116:119], v[204:207]
    s_add_u32 m0, s29, 57344
    v_mfma_f32_16x16x32_bf16 v[204:207], a[40:43], a[112:115], v[204:207]
    buffer_load_dwordx4 v1, s[4:7], s46 offen lds
    v_mfma_f32_16x16x32_bf16 v[212:215], a[40:43], a[104:107], v[212:215]
    ds_read_b128 a[80:83], v4 offset:4096
    v_mfma_f32_16x16x32_bf16 v[212:215], a[44:47], a[108:111], v[212:215]
    v_mfma_f32_16x16x32_bf16 v[220:223], a[44:47], a[100:103], v[220:223]
    ds_read_b128 a[84:87], v5 offset:4096
    v_mfma_f32_16x16x32_bf16 v[220:223], a[40:43], a[96:99], v[220:223]
    s_add_u32 m0, s29, 126976
    v_mfma_f32_16x16x32_bf16 v[248:251], a[48:51], a[96:99], v[248:251]
    buffer_load_dwordx4 v2, s[8:11], s54 offen lds
    v_mfma_f32_16x16x32_bf16 v[248:251], a[52:55], a[100:103], v[248:251]
    ds_read_b128 a[92:95], v5 offset:6144
    v_mfma_f32_16x16x32_bf16 v[240:243], a[52:55], a[108:111], v[240:243]
    v_mfma_f32_16x16x32_bf16 v[240:243], a[48:51], a[104:107], v[240:243]
    ds_read_b128 a[88:91], v4 offset:6144
    v_mfma_f32_16x16x32_bf16 v[232:235], a[48:51], a[112:115], v[232:235]
    s_add_u32 m0, s29, 61440
    v_mfma_f32_16x16x32_bf16 v[232:235], a[52:55], a[116:119], v[232:235]
    buffer_load_dwordx4 v1, s[4:7], s47 offen lds
    v_mfma_f32_16x16x32_bf16 v[224:227], a[52:55], a[124:127], v[224:227]
    v_add_u32 v1, 128, v1
    v_add_u32 v2, 0x80000, v2
    v_mfma_f32_16x16x32_bf16 v[224:227], a[48:51], a[120:123], v[224:227]
    ds_read_b64_tr_b16 a[8:9], v7 offset:0
    v_mfma_f32_16x16x32_bf16 v[228:231], a[56:59], a[120:123], v[228:231]
    buffer_load_dword a243, v14, s[36:39], s56 offen
    v_mfma_f32_16x16x32_bf16 v[228:231], a[60:63], a[124:127], v[228:231]
    s_add_u32 s56, s56, s30
    ds_read_b64_tr_b16 a[10:11], v7 offset:4096
    v_mfma_f32_16x16x32_bf16 v[236:239], a[60:63], a[116:119], v[236:239]
    ds_read_b64_tr_b16 a[12:13], v7 offset:16384
    v_mfma_f32_16x16x32_bf16 v[236:239], a[56:59], a[112:115], v[236:239]
    ds_read_b64_tr_b16 a[14:15], v7 offset:20480
    v_mfma_f32_16x16x32_bf16 v[244:247], a[56:59], a[104:107], v[244:247]
    ds_read_b64_tr_b16 a[16:17], v8 offset:0
    v_mfma_f32_16x16x32_bf16 v[244:247], a[60:63], a[108:111], v[244:247]
    ds_read_b64_tr_b16 a[18:19], v8 offset:4096
    v_mfma_f32_16x16x32_bf16 v[252:255], a[60:63], a[100:103], v[252:255]
    s_add_u32 s61, s61, 1
    ds_read_b64_tr_b16 a[20:21], v8 offset:16384
    v_mfma_f32_16x16x32_bf16 v[252:255], a[56:59], a[96:99], v[252:255]
    s_waitcnt lgkmcnt(8)
    ds_read_b64_tr_b16 a[22:23], v8 offset:20480
    s_cmp_lt_u32 s61, 6
    s_cbranch_scc1 L_kloop
    v_mfma_f32_16x16x32_bf16 v[88:91], a[0:3], a[64:67], v[88:91]
    ds_read_b64_tr_b16 a[24:25], v9 offset:0
    v_accvgpr_read_b32 v15, a240
    v_mfma_f32_16x16x32_bf16 v[88:91], a[4:7], a[68:71], v[88:91]
    ds_read_b64_tr_b16 a[26:27], v9 offset:4096
    v_accvgpr_read_b32 v14, a244
    v_mfma_f32_16x16x32_bf16 v[80:83], a[4:7], a[76:79], v[80:83]
    s_waitcnt lgkmcnt(12)
    ds_read_b64_tr_b16 a[28:29], v9 offset:16384
    global_load_dword a243, v14, s[100:101]
    v_mfma_f32_16x16x32_bf16 v[80:83], a[0:3], a[72:75], v[80:83]
    ds_read_b64_tr_b16 a[30:31], v9 offset:20480
    v_accvgpr_read_b32 v14, a242
    v_mfma_f32_16x16x32_bf16 v[72:75], a[0:3], a[80:83], v[72:75]
    s_add_u32 m0, s33, 0x0
    ds_read_b128 a[96:99], v4 offset:8192
    v_xor_b32 v3, 64, v14
    v_mfma_f32_16x16x32_bf16 v[72:75], a[4:7], a[84:87], v[72:75]
    s_waitcnt lgkmcnt(11)
    v_mfma_f32_16x16x32_bf16 v[64:67], a[4:7], a[92:95], v[64:67]
    ds_read_b128 a[100:103], v5 offset:8192
    buffer_load_dwordx4 v15, s[20:23], 0 offen offset:0 lds
    v_mfma_f32_16x16x32_bf16 v[64:67], a[0:3], a[88:91], v[64:67]
    v_mfma_f32_16x16x32_bf16 v[68:71], a[8:11], a[88:91], v[68:71]
    s_waitcnt lgkmcnt(10)
    ds_read_b128 a[108:111], v5 offset:10240
    v_mfma_f32_16x16x32_bf16 v[68:71], a[12:15], a[92:95], v[68:71]
    s_add_u32 m0, s33, 0x80
    v_mfma_f32_16x16x32_bf16 v[76:79], a[12:15], a[84:87], v[76:79]
    ds_read_b128 a[104:107], v4 offset:10240
    buffer_load_dwordx4 v15, s[20:23], 0 offen offset:896 lds
    v_mfma_f32_16x16x32_bf16 v[76:79], a[8:11], a[80:83], v[76:79]
    v_mfma_f32_16x16x32_bf16 v[84:87], a[8:11], a[72:75], v[84:87]
    ds_read_b128 a[112:115], v4 offset:12288
    v_mfma_f32_16x16x32_bf16 v[84:87], a[12:15], a[76:79], v[84:87]
    s_add_u32 m0, s33, 0x800
    v_mfma_f32_16x16x32_bf16 v[92:95], a[12:15], a[68:71], v[92:95]
    ds_read_b128 a[116:119], v5 offset:12288
    buffer_load_dwordx4 v15, s[20:23], s57 offen offset:0 lds
    v_mfma_f32_16x16x32_bf16 v[92:95], a[8:11], a[64:67], v[92:95]
    s_waitcnt lgkmcnt(10)
    v_mfma_f32_16x16x32_bf16 v[120:123], a[16:19], a[64:67], v[120:123]
    ds_read_b128 a[124:127], v5 offset:14336
    v_mfma_f32_16x16x32_bf16 v[120:123], a[20:23], a[68:71], v[120:123]
    s_add_u32 m0, s33, 0x880
    v_mfma_f32_16x16x32_bf16 v[112:115], a[20:23], a[76:79], v[112:115]
    ds_read_b128 a[120:123], v4 offset:14336
    buffer_load_dwordx4 v15, s[20:23], s57 offen offset:896 lds
    v_mfma_f32_16x16x32_bf16 v[112:115], a[16:19], a[72:75], v[112:115]
    v_mfma_f32_16x16x32_bf16 v[104:107], a[16:19], a[80:83], v[104:107]
    ds_read_b64_tr_b16 a[32:33], v10 offset:0
    v_mfma_f32_16x16x32_bf16 v[104:107], a[20:23], a[84:87], v[104:107]
    s_add_u32 m0, s33, 0xf80
    ds_read_b64_tr_b16 a[34:35], v10 offset:4096
    v_mfma_f32_16x16x32_bf16 v[96:99], a[20:23], a[92:95], v[96:99]
    ds_read_b64_tr_b16 a[36:37], v10 offset:16384
    buffer_load_dwordx4 v15, s[20:23], 0 offen offset:128 lds
    v_mfma_f32_16x16x32_bf16 v[96:99], a[16:19], a[88:91], v[96:99]
    s_waitcnt lgkmcnt(11)
    ds_read_b64_tr_b16 a[38:39], v10 offset:20480
    v_mfma_f32_16x16x32_bf16 v[100:103], a[24:27], a[88:91], v[100:103]
    ds_read_b64_tr_b16 a[40:41], v11 offset:0
    v_mfma_f32_16x16x32_bf16 v[100:103], a[28:31], a[92:95], v[100:103]
    s_add_u32 m0, s33, 0x1000
    ds_read_b64_tr_b16 a[42:43], v11 offset:4096
    v_mfma_f32_16x16x32_bf16 v[108:111], a[28:31], a[84:87], v[108:111]
    ds_read_b64_tr_b16 a[44:45], v11 offset:16384
    buffer_load_dwordx4 v15, s[20:23], 0 offen offset:1024 lds
    v_mfma_f32_16x16x32_bf16 v[108:111], a[24:27], a[80:83], v[108:111]
    ds_read_b64_tr_b16 a[46:47], v11 offset:20480
    v_mfma_f32_16x16x32_bf16 v[116:119], a[24:27], a[72:75], v[116:119]
    ds_read_b64_tr_b16 a[48:49], v12 offset:0
    v_mfma_f32_16x16x32_bf16 v[116:119], a[28:31], a[76:79], v[116:119]
    s_add_u32 m0, s33, 0x1780
    ds_read_b64_tr_b16 a[50:51], v12 offset:4096
    v_mfma_f32_16x16x32_bf16 v[124:127], a[28:31], a[68:71], v[124:127]
    ds_read_b64_tr_b16 a[52:53], v12 offset:16384
    buffer_load_dwordx4 v15, s[20:23], s57 offen offset:128 lds
    v_mfma_f32_16x16x32_bf16 v[124:127], a[24:27], a[64:67], v[124:127]
    s_waitcnt lgkmcnt(15)
    ds_read_b64_tr_b16 a[54:55], v12 offset:20480
    v_mfma_f32_16x16x32_bf16 a[232:235], a[0:3], a[96:99], a[232:235]
    ds_read_b64_tr_b16 a[56:57], v13 offset:0
    v_mfma_f32_16x16x32_bf16 a[232:235], a[4:7], a[100:103], a[232:235]
    s_add_u32 m0, s33, 0x1800
    ds_read_b64_tr_b16 a[58:59], v13 offset:4096
    v_mfma_f32_16x16x32_bf16 a[224:227], a[4:7], a[108:111], a[224:227]
    ds_read_b64_tr_b16 a[60:61], v13 offset:16384
    buffer_load_dwordx4 v15, s[20:23], s57 offen offset:1024 lds
    v_mfma_f32_16x16x32_bf16 a[224:227], a[0:3], a[104:107], a[224:227]
    s_waitcnt lgkmcnt(15)
    ds_read_b64_tr_b16 a[62:63], v13 offset:20480
    v_mfma_f32_16x16x32_bf16 v[24:27], a[0:3], a[112:115], v[24:27]
    v_mfma_f32_16x16x32_bf16 v[24:27], a[4:7], a[116:119], v[24:27]
    v_mfma_f32_16x16x32_bf16 v[16:19], a[4:7], a[124:127], v[16:19]
    v_mfma_f32_16x16x32_bf16 v[16:19], a[0:3], a[120:123], v[16:19]
    s_waitcnt lgkmcnt(0)
    v_mfma_f32_16x16x32_bf16 v[20:23], a[8:11], a[120:123], v[20:23]
    s_barrier
    v_mfma_f32_16x16x32_bf16 v[20:23], a[12:15], a[124:127], v[20:23]
    s_add_u32 m0, s29, 65536
    v_mfma_f32_16x16x32_bf16 v[28:31], a[12:15], a[116:119], v[28:31]
    buffer_load_dwordx4 v2, s[8:11], 0 offen lds
    v_mfma_f32_16x16x32_bf16 v[28:31], a[8:11], a[112:115], v[28:31]
    v_mfma_f32_16x16x32_bf16 a[228:231], a[8:11], a[104:107], a[228:231]
    v_mfma_f32_16x16x32_bf16 a[228:231], a[12:15], a[108:111], a[228:231]
    v_mfma_f32_16x16x32_bf16 a[236:239], a[12:15], a[100:103], a[236:239]
    s_add_u32 m0, s29, 0
    v_mfma_f32_16x16x32_bf16 a[236:239], a[8:11], a[96:99], a[236:239]
    buffer_load_dwordx4 v1, s[4:7], 0 offen lds
    v_mfma_f32_16x16x32_bf16 v[56:59], a[16:19], a[96:99], v[56:59]
    v_mfma_f32_16x16x32_bf16 v[56:59], a[20:23], a[100:103], v[56:59]
    v_mfma_f32_16x16x32_bf16 v[48:51], a[20:23], a[108:111], v[48:51]
    v_mfma_f32_16x16x32_bf16 v[48:51], a[16:19], a[104:107], v[48:51]
    s_add_u32 m0, s29, 69632
    v_mfma_f32_16x16x32_bf16 v[40:43], a[16:19], a[112:115], v[40:43]
    buffer_load_dwordx4 v2, s[8:11], s48 offen lds
    v_mfma_f32_16x16x32_bf16 v[40:43], a[20:23], a[116:119], v[40:43]
    v_mfma_f32_16x16x32_bf16 v[32:35], a[20:23], a[124:127], v[32:35]
    v_mfma_f32_16x16x32_bf16 v[32:35], a[16:19], a[120:123], v[32:35]
    v_mfma_f32_16x16x32_bf16 v[36:39], a[24:27], a[120:123], v[36:39]
    s_add_u32 m0, s29, 4096
    v_mfma_f32_16x16x32_bf16 v[36:39], a[28:31], a[124:127], v[36:39]
    buffer_load_dwordx4 v1, s[4:7], s41 offen lds
    v_mfma_f32_16x16x32_bf16 v[44:47], a[28:31], a[116:119], v[44:47]
    v_mfma_f32_16x16x32_bf16 v[44:47], a[24:27], a[112:115], v[44:47]
    v_mfma_f32_16x16x32_bf16 v[52:55], a[24:27], a[104:107], v[52:55]
    v_mfma_f32_16x16x32_bf16 v[52:55], a[28:31], a[108:111], v[52:55]
    s_add_u32 m0, s29, 73728
    v_mfma_f32_16x16x32_bf16 v[60:63], a[28:31], a[100:103], v[60:63]
    buffer_load_dwordx4 v2, s[8:11], s49 offen lds
    v_mfma_f32_16x16x32_bf16 v[60:63], a[24:27], a[96:99], v[60:63]
    v_mfma_f32_16x16x32_bf16 v[216:219], a[32:35], a[96:99], v[216:219]
    v_mfma_f32_16x16x32_bf16 v[216:219], a[36:39], a[100:103], v[216:219]
    v_mfma_f32_16x16x32_bf16 v[208:211], a[36:39], a[108:111], v[208:211]
    s_add_u32 m0, s29, 8192
    v_mfma_f32_16x16x32_bf16 v[208:211], a[32:35], a[104:107], v[208:211]
    buffer_load_dwordx4 v1, s[4:7], s42 offen lds
    v_mfma_f32_16x16x32_bf16 v[200:203], a[32:35], a[112:115], v[200:203]
    v_mfma_f32_16x16x32_bf16 v[200:203], a[36:39], a[116:119], v[200:203]
    v_mfma_f32_16x16x32_bf16 v[192:195], a[36:39], a[124:127], v[192:195]
    v_mfma_f32_16x16x32_bf16 v[192:195], a[32:35], a[120:123], v[192:195]
    s_add_u32 m0, s29, 77824
    v_mfma_f32_16x16x32_bf16 v[196:199], a[40:43], a[120:123], v[196:199]
    buffer_load_dwordx4 v2, s[8:11], s50 offen lds
    v_mfma_f32_16x16x32_bf16 v[196:199], a[44:47], a[124:127], v[196:199]
    v_mfma_f32_16x16x32_bf16 v[204:207], a[44:47], a[116:119], v[204:207]
    v_mfma_f32_16x16x32_bf16 v[204:207], a[40:43], a[112:115], v[204:207]
    v_mfma_f32_16x16x32_bf16 v[212:215], a[40:43], a[104:107], v[212:215]
    s_add_u32 m0, s29, 12288
    v_mfma_f32_16x16x32_bf16 v[212:215], a[44:47], a[108:111], v[212:215]
    buffer_load_dwordx4 v1, s[4:7], s43 offen lds
    v_mfma_f32_16x16x32_bf16 v[220:223], a[44:47], a[100:103], v[220:223]
    v_mfma_f32_16x16x32_bf16 v[220:223], a[40:43], a[96:99], v[220:223]
    v_mfma_f32_16x16x32_bf16 v[248:251], a[48:51], a[96:99], v[248:251]
    v_mfma_f32_16x16x32_bf16 v[248:251], a[52:55], a[100:103], v[248:251]
    s_add_u32 m0, s29, 81920
    v_mfma_f32_16x16x32_bf16 v[240:243], a[52:55], a[108:111], v[240:243]
    buffer_load_dwordx4 v2, s[8:11], s51 offen lds
    v_mfma_f32_16x16x32_bf16 v[240:243], a[48:51], a[104:107], v[240:243]
    v_mfma_f32_16x16x32_bf16 v[232:235], a[48:51], a[112:115], v[232:235]
    v_mfma_f32_16x16x32_bf16 v[232:235], a[52:55], a[116:119], v[232:235]
    v_mfma_f32_16x16x32_bf16 v[224:227], a[52:55], a[124:127], v[224:227]
    s_add_u32 m0, s29, 16384
    v_mfma_f32_16x16x32_bf16 v[224:227], a[48:51], a[120:123], v[224:227]
    buffer_load_dwordx4 v1, s[4:7], s44 offen lds
    v_mfma_f32_16x16x32_bf16 v[228:231], a[56:59], a[120:123], v[228:231]
    v_mfma_f32_16x16x32_bf16 v[228:231], a[60:63], a[124:127], v[228:231]
    v_mfma_f32_16x16x32_bf16 v[236:239], a[60:63], a[116:119], v[236:239]
    v_mfma_f32_16x16x32_bf16 v[236:239], a[56:59], a[112:115], v[236:239]
    s_add_u32 m0, s29, 86016
    v_mfma_f32_16x16x32_bf16 v[244:247], a[56:59], a[104:107], v[244:247]
    s_waitcnt vmcnt(10)
    buffer_load_dwordx4 v2, s[8:11], s52 offen lds
    v_mfma_f32_16x16x32_bf16 v[244:247], a[60:63], a[108:111], v[244:247]
    s_barrier
    ds_read_b64_tr_b16 a[0:1], v6 offset:32768
    v_mfma_f32_16x16x32_bf16 v[252:255], a[60:63], a[100:103], v[252:255]
    ds_read_b64_tr_b16 a[2:3], v6 offset:36864
    v_mfma_f32_16x16x32_bf16 v[252:255], a[56:59], a[96:99], v[252:255]
    ds_read_b128 a[96:99], v4 offset:40960
    v_mfma_f32_16x16x32_bf16 v[152:155], a[32:35], a[64:67], v[152:155]
    s_add_u32 m0, s29, 20480
    ds_read_b128 a[128:131], v14 offset:0
    v_mfma_f32_16x16x32_bf16 v[152:155], a[36:39], a[68:71], v[152:155]
    buffer_load_dwordx4 v1, s[4:7], s45 offen lds
    v_mfma_f32_16x16x32_bf16 v[144:147], a[36:39], a[76:79], v[144:147]
    ds_read_b64_tr_b16 a[4:5], v6 offset:49152
    v_mfma_f32_16x16x32_bf16 v[144:147], a[32:35], a[72:75], v[144:147]
    ds_read_b64_tr_b16 a[6:7], v6 offset:53248
    v_mfma_f32_16x16x32_bf16 v[136:139], a[32:35], a[80:83], v[136:139]
    ds_read_b128 a[100:103], v5 offset:40960
    v_mfma_f32_16x16x32_bf16 v[136:139], a[36:39], a[84:87], v[136:139]
    s_add_u32 m0, s29, 90112
    ds_read_b128 a[136:139], v3 offset:0
    v_mfma_f32_16x16x32_bf16 v[128:131], a[36:39], a[92:95], v[128:131]
    buffer_load_dwordx4 v2, s[8:11], s53 offen lds
    v_mfma_f32_16x16x32_bf16 v[128:131], a[32:35], a[88:91], v[128:131]
    ds_read_b128 a[108:111], v5 offset:43008
    v_mfma_f32_16x16x32_bf16 v[132:135], a[40:43], a[88:91], v[132:135]
    ds_read_b128 a[132:135], v14 offset:2048
    v_mfma_f32_16x16x32_bf16 v[132:135], a[44:47], a[92:95], v[132:135]
    ds_read_b128 a[104:107], v4 offset:43008
    v_mfma_f32_16x16x32_bf16 v[140:143], a[44:47], a[84:87], v[140:143]
    s_add_u32 m0, s29, 24576
    ds_read_b128 a[140:143], v3 offset:2048
    v_mfma_f32_16x16x32_bf16 v[140:143], a[40:43], a[80:83], v[140:143]
    buffer_load_dwordx4 v1, s[4:7], s46 offen lds
    v_mfma_f32_16x16x32_bf16 v[148:151], a[40:43], a[72:75], v[148:151]
    ds_read_b128 a[112:115], v4 offset:45056
    v_mfma_f32_16x16x32_bf16 v[148:151], a[44:47], a[76:79], v[148:151]
    ds_read_b128 a[144:147], v14 offset:4096
    v_mfma_f32_16x16x32_bf16 v[156:159], a[44:47], a[68:71], v[156:159]
    ds_read_b128 a[116:119], v5 offset:45056
    v_mfma_f32_16x16x32_bf16 v[156:159], a[40:43], a[64:67], v[156:159]
    s_add_u32 m0, s29, 94208
    ds_read_b128 a[152:155], v3 offset:4096
    v_mfma_f32_16x16x32_bf16 v[184:187], a[48:51], a[64:67], v[184:187]
    buffer_load_dwordx4 v2, s[8:11], s54 offen lds
    v_mfma_f32_16x16x32_bf16 v[184:187], a[52:55], a[68:71], v[184:187]
    ds_read_b128 a[124:127], v5 offset:47104
    v_mfma_f32_16x16x32_bf16 v[176:179], a[52:55], a[76:79], v[176:179]
    ds_read_b128 a[148:151], v14 offset:6144
    v_mfma_f32_16x16x32_bf16 v[176:179], a[48:51], a[72:75], v[176:179]
    ds_read_b128 a[120:123], v4 offset:47104
    v_mfma_f32_16x16x32_bf16 v[168:171], a[48:51], a[80:83], v[168:171]
    s_add_u32 m0, s29, 28672
    ds_read_b128 a[156:159], v3 offset:6144
    v_mfma_f32_16x16x32_bf16 v[168:171], a[52:55], a[84:87], v[168:171]
    buffer_load_dwordx4 v1, s[4:7], s47 offen lds
    v_mfma_f32_16x16x32_bf16 v[160:163], a[52:55], a[92:95], v[160:163]
    v_add_u32 v1, 128, v1
    v_add_u32 v2, 0x80000, v2
    v_mfma_f32_16x16x32_bf16 v[160:163], a[48:51], a[88:91], v[160:163]
    ds_read_b64_tr_b16 a[8:9], v7 offset:32768
    v_mfma_f32_16x16x32_bf16 v[164:167], a[56:59], a[88:91], v[164:167]
    v_mfma_f32_16x16x32_bf16 v[164:167], a[60:63], a[92:95], v[164:167]
    ds_read_b64_tr_b16 a[10:11], v7 offset:36864
    v_mfma_f32_16x16x32_bf16 v[172:175], a[60:63], a[84:87], v[172:175]
    ds_read_b64_tr_b16 a[12:13], v7 offset:49152
    v_mfma_f32_16x16x32_bf16 v[172:175], a[56:59], a[80:83], v[172:175]
    ds_read_b64_tr_b16 a[14:15], v7 offset:53248
    v_mfma_f32_16x16x32_bf16 v[180:183], a[56:59], a[72:75], v[180:183]
    ds_read_b64_tr_b16 a[16:17], v8 offset:32768
    v_mfma_f32_16x16x32_bf16 v[180:183], a[60:63], a[76:79], v[180:183]
    ds_read_b64_tr_b16 a[18:19], v8 offset:36864
    v_mfma_f32_16x16x32_bf16 v[188:191], a[60:63], a[68:71], v[188:191]
    ds_read_b64_tr_b16 a[20:21], v8 offset:49152
    v_mfma_f32_16x16x32_bf16 v[188:191], a[56:59], a[64:67], v[188:191]
    s_waitcnt lgkmcnt(15)
    ds_read_b64_tr_b16 a[22:23], v8 offset:53248
    v_mfma_f32_16x16x32_bf16 a[232:235], a[0:3], a[96:99], a[232:235]
    ds_read_b64_tr_b16 a[24:25], v9 offset:32768
    v_mfma_f32_16x16x32_bf16 a[232:235], a[4:7], a[100:103], a[232:235]
    s_add_u32 m0, s33, 0xffffff00
    ds_read_b64_tr_b16 a[26:27], v9 offset:36864
    v_mfma_f32_16x16x32_bf16 a[224:227], a[4:7], a[108:111], a[224:227]
    s_waitcnt lgkmcnt(10)
    ds_read_b64_tr_b16 a[28:29], v9 offset:49152
    v_mfma_f32_16x16x32_bf16 a[224:227], a[0:3], a[104:107], a[224:227]
    ds_read_b64_tr_b16 a[30:31], v9 offset:53248
    buffer_load_dwordx4 v15, s[20:23], 0 offen offset:256 lds
    v_mfma_f32_16x16x32_bf16 v[24:27], a[0:3], a[112:115], v[24:27]
    ds_read_b128 a[64:67], v4 offset:32768
    v_mfma_f32_16x16x32_bf16 v[24:27], a[4:7], a[116:119], v[24:27]
    v_mfma_f32_16x16x32_bf16 v[16:19], a[4:7], a[124:127], v[16:19]
    s_add_u32 m0, s33, 0xffffff80
    ds_read_b128 a[68:71], v5 offset:32768
    v_mfma_f32_16x16x32_bf16 v[16:19], a[0:3], a[120:123], v[16:19]
    s_waitcnt lgkmcnt(10)
    buffer_load_dwordx4 v15, s[20:23], 0 offen offset:1152 lds
    v_mfma_f32_16x16x32_bf16 v[20:23], a[8:11], a[120:123], v[20:23]
    ds_read_b128 a[76:79], v5 offset:34816
    v_mfma_f32_16x16x32_bf16 v[20:23], a[12:15], a[124:127], v[20:23]
    v_mfma_f32_16x16x32_bf16 v[28:31], a[12:15], a[116:119], v[28:31]
    s_add_u32 m0, s33, 0x700
    ds_read_b128 a[72:75], v4 offset:34816
    v_mfma_f32_16x16x32_bf16 v[28:31], a[8:11], a[112:115], v[28:31]
    buffer_load_dwordx4 v15, s[20:23], s57 offen offset:256 lds
    v_mfma_f32_16x16x32_bf16 a[228:231], a[8:11], a[104:107], a[228:231]
    ds_read_b128 a[80:83], v4 offset:36864
    v_mfma_f32_16x16x32_bf16 a[228:231], a[12:15], a[108:111], a[228:231]
    v_mfma_f32_16x16x32_bf16 a[236:239], a[12:15], a[100:103], a[236:239]
    s_add_u32 m0, s33, 0x780
    ds_read_b128 a[84:87], v5 offset:36864
    v_mfma_f32_16x16x32_bf16 a[236:239], a[8:11], a[96:99], a[236:239]
    s_waitcnt lgkmcnt(10)
    buffer_load_dwordx4 v15, s[20:23], s57 offen offset:1152 lds
    v_mfma_f32_16x16x32_bf16 v[56:59], a[16:19], a[96:99], v[56:59]
    ds_read_b128 a[92:95], v5 offset:38912
    v_mfma_f32_16x16x32_bf16 v[56:59], a[20:23], a[100:103], v[56:59]
    v_mfma_f32_16x16x32_bf16 v[48:51], a[20:23], a[108:111], v[48:51]
    s_add_u32 m0, s33, 0xe80
    ds_read_b128 a[88:91], v4 offset:38912
    v_mfma_f32_16x16x32_bf16 v[48:51], a[16:19], a[104:107], v[48:51]
    buffer_load_dwordx4 v15, s[20:23], 0 offen offset:384 lds
    v_mfma_f32_16x16x32_bf16 v[40:43], a[16:19], a[112:115], v[40:43]
    ds_read_b64_tr_b16 a[32:33], v10 offset:32768
    v_mfma_f32_16x16x32_bf16 v[40:43], a[20:23], a[116:119], v[40:43]
    ds_read_b64_tr_b16 a[34:35], v10 offset:36864
    v_mfma_f32_16x16x32_bf16 v[32:35], a[20:23], a[124:127], v[32:35]
    s_add_u32 m0, s33, 0xf00
    ds_read_b64_tr_b16 a[36:37], v10 offset:49152
    v_mfma_f32_16x16x32_bf16 v[32:35], a[16:19], a[120:123], v[32:35]
    s_waitcnt lgkmcnt(11)
    ds_read_b64_tr_b16 a[38:39], v10 offset:53248
    buffer_load_dwordx4 v15, s[20:23], 0 offen offset:1280 lds
    v_mfma_f32_16x16x32_bf16 v[36:39], a[24:27], a[120:123], v[36:39]
    ds_read_b64_tr_b16 a[40:41], v11 offset:32768
    v_mfma_f32_16x16x32_bf16 v[36:39], a[28:31], a[124:127], v[36:39]
    ds_read_b64_tr_b16 a[42:43], v11 offset:36864
    v_mfma_f32_16x16x32_bf16 v[44:47], a[28:31], a[116:119], v[44:47]
    s_add_u32 m0, s33, 0x1680
    ds_read_b64_tr_b16 a[44:45], v11 offset:49152
    v_mfma_f32_16x16x32_bf16 v[44:47], a[24:27], a[112:115], v[44:47]
    ds_read_b64_tr_b16 a[46:47], v11 offset:53248
    buffer_load_dwordx4 v15, s[20:23], s57 offen offset:384 lds
    v_mfma_f32_16x16x32_bf16 v[52:55], a[24:27], a[104:107], v[52:55]
    ds_read_b64_tr_b16 a[48:49], v12 offset:32768
    v_mfma_f32_16x16x32_bf16 v[52:55], a[28:31], a[108:111], v[52:55]
    ds_read_b64_tr_b16 a[50:51], v12 offset:36864
    v_mfma_f32_16x16x32_bf16 v[60:63], a[28:31], a[100:103], v[60:63]
    s_add_u32 m0, s33, 0x1700
    ds_read_b64_tr_b16 a[52:53], v12 offset:49152
    v_mfma_f32_16x16x32_bf16 v[60:63], a[24:27], a[96:99], v[60:63]
    s_waitcnt lgkmcnt(15)
    ds_read_b64_tr_b16 a[54:55], v12 offset:53248
    buffer_load_dwordx4 v15, s[20:23], s57 offen offset:1280 lds
    v_mfma_f32_16x16x32_bf16 v[88:91], a[0:3], a[64:67], v[88:91]
    ds_read_b64_tr_b16 a[56:57], v13 offset:32768
    v_mfma_f32_16x16x32_bf16 v[88:91], a[4:7], a[68:71], v[88:91]
    ds_read_b64_tr_b16 a[58:59], v13 offset:36864
    v_mfma_f32_16x16x32_bf16 v[80:83], a[4:7], a[76:79], v[80:83]
    ds_read_b64_tr_b16 a[60:61], v13 offset:49152
    v_mfma_f32_16x16x32_bf16 v[80:83], a[0:3], a[72:75], v[80:83]
    s_waitcnt lgkmcnt(15)
    ds_read_b64_tr_b16 a[62:63], v13 offset:53248
    v_mfma_f32_16x16x32_bf16 v[72:75], a[0:3], a[80:83], v[72:75]
    v_mfma_f32_16x16x32_bf16 v[72:75], a[4:7], a[84:87], v[72:75]
    v_mfma_f32_16x16x32_bf16 v[64:67], a[4:7], a[92:95], v[64:67]
    v_mfma_f32_16x16x32_bf16 v[64:67], a[0:3], a[88:91], v[64:67]
    s_waitcnt lgkmcnt(0)
    v_mfma_f32_16x16x32_bf16 v[68:71], a[8:11], a[88:91], v[68:71]
    s_barrier
    v_mfma_f32_16x16x32_bf16 v[68:71], a[12:15], a[92:95], v[68:71]
    s_add_u32 m0, s29, 98304
    v_mfma_f32_16x16x32_bf16 v[76:79], a[12:15], a[84:87], v[76:79]
    buffer_load_dwordx4 v2, s[8:11], 0 offen lds
    v_mfma_f32_16x16x32_bf16 v[76:79], a[8:11], a[80:83], v[76:79]
    v_mfma_f32_16x16x32_bf16 v[84:87], a[8:11], a[72:75], v[84:87]
    v_mfma_f32_16x16x32_bf16 v[84:87], a[12:15], a[76:79], v[84:87]
    v_mfma_f32_16x16x32_bf16 v[92:95], a[12:15], a[68:71], v[92:95]
    s_add_u32 m0, s29, 32768
    v_mfma_f32_16x16x32_bf16 v[92:95], a[8:11], a[64:67], v[92:95]
    buffer_load_dwordx4 v1, s[4:7], 0 offen lds
    v_mfma_f32_16x16x32_bf16 v[120:123], a[16:19], a[64:67], v[120:123]
    v_mfma_f32_16x16x32_bf16 v[120:123], a[20:23], a[68:71], v[120:123]
    v_mfma_f32_16x16x32_bf16 v[112:115], a[20:23], a[76:79], v[112:115]
    v_mfma_f32_16x16x32_bf16 v[112:115], a[16:19], a[72:75], v[112:115]
    s_add_u32 m0, s29, 102400
    v_mfma_f32_16x16x32_bf16 v[104:107], a[16:19], a[80:83], v[104:107]
    buffer_load_dwordx4 v2, s[8:11], s48 offen lds
    v_mfma_f32_16x16x32_bf16 v[104:107], a[20:23], a[84:87], v[104:107]
    v_mfma_f32_16x16x32_bf16 v[96:99], a[20:23], a[92:95], v[96:99]
    v_mfma_f32_16x16x32_bf16 v[96:99], a[16:19], a[88:91], v[96:99]
    v_mfma_f32_16x16x32_bf16 v[100:103], a[24:27], a[88:91], v[100:103]
    s_add_u32 m0, s29, 36864
    v_mfma_f32_16x16x32_bf16 v[100:103], a[28:31], a[92:95], v[100:103]
    buffer_load_dwordx4 v1, s[4:7], s41 offen lds
    v_mfma_f32_16x16x32_bf16 v[108:111], a[28:31], a[84:87], v[108:111]
    v_mfma_f32_16x16x32_bf16 v[108:111], a[24:27], a[80:83], v[108:111]
    v_mfma_f32_16x16x32_bf16 v[116:119], a[24:27], a[72:75], v[116:119]
    v_mfma_f32_16x16x32_bf16 v[116:119], a[28:31], a[76:79], v[116:119]
    s_add_u32 m0, s29, 106496
    v_mfma_f32_16x16x32_bf16 v[124:127], a[28:31], a[68:71], v[124:127]
    buffer_load_dwordx4 v2, s[8:11], s49 offen lds
    v_mfma_f32_16x16x32_bf16 v[124:127], a[24:27], a[64:67], v[124:127]
    v_mfma_f32_16x16x32_bf16 v[152:155], a[32:35], a[64:67], v[152:155]
    v_mfma_f32_16x16x32_bf16 v[152:155], a[36:39], a[68:71], v[152:155]
    v_mfma_f32_16x16x32_bf16 v[144:147], a[36:39], a[76:79], v[144:147]
    s_add_u32 m0, s29, 40960
    v_mfma_f32_16x16x32_bf16 v[144:147], a[32:35], a[72:75], v[144:147]
    buffer_load_dwordx4 v1, s[4:7], s42 offen lds
    v_mfma_f32_16x16x32_bf16 v[136:139], a[32:35], a[80:83], v[136:139]
    v_mfma_f32_16x16x32_bf16 v[136:139], a[36:39], a[84:87], v[136:139]
    v_mfma_f32_16x16x32_bf16 v[128:131], a[36:39], a[92:95], v[128:131]
    v_mfma_f32_16x16x32_bf16 v[128:131], a[32:35], a[88:91], v[128:131]
    s_add_u32 m0, s29, 110592
    v_mfma_f32_16x16x32_bf16 v[132:135], a[40:43], a[88:91], v[132:135]
    buffer_load_dwordx4 v2, s[8:11], s50 offen lds
    v_mfma_f32_16x16x32_bf16 v[132:135], a[44:47], a[92:95], v[132:135]
    v_mfma_f32_16x16x32_bf16 v[140:143], a[44:47], a[84:87], v[140:143]
    v_mfma_f32_16x16x32_bf16 v[140:143], a[40:43], a[80:83], v[140:143]
    v_mfma_f32_16x16x32_bf16 v[148:151], a[40:43], a[72:75], v[148:151]
    s_add_u32 m0, s29, 45056
    v_mfma_f32_16x16x32_bf16 v[148:151], a[44:47], a[76:79], v[148:151]
    buffer_load_dwordx4 v1, s[4:7], s43 offen lds
    v_mfma_f32_16x16x32_bf16 v[156:159], a[44:47], a[68:71], v[156:159]
    v_mfma_f32_16x16x32_bf16 v[156:159], a[40:43], a[64:67], v[156:159]
    v_mfma_f32_16x16x32_bf16 v[184:187], a[48:51], a[64:67], v[184:187]
    v_mfma_f32_16x16x32_bf16 v[184:187], a[52:55], a[68:71], v[184:187]
    s_add_u32 m0, s29, 114688
    v_mfma_f32_16x16x32_bf16 v[176:179], a[52:55], a[76:79], v[176:179]
    buffer_load_dwordx4 v2, s[8:11], s51 offen lds
    v_mfma_f32_16x16x32_bf16 v[176:179], a[48:51], a[72:75], v[176:179]
    v_mfma_f32_16x16x32_bf16 v[168:171], a[48:51], a[80:83], v[168:171]
    v_mfma_f32_16x16x32_bf16 v[168:171], a[52:55], a[84:87], v[168:171]
    v_mfma_f32_16x16x32_bf16 v[160:163], a[52:55], a[92:95], v[160:163]
    s_add_u32 m0, s29, 49152
    v_mfma_f32_16x16x32_bf16 v[160:163], a[48:51], a[88:91], v[160:163]
    buffer_load_dwordx4 v1, s[4:7], s44 offen lds
    v_mfma_f32_16x16x32_bf16 v[164:167], a[56:59], a[88:91], v[164:167]
    v_mfma_f32_16x16x32_bf16 v[164:167], a[60:63], a[92:95], v[164:167]
    v_mfma_f32_16x16x32_bf16 v[172:175], a[60:63], a[84:87], v[172:175]
    v_mfma_f32_16x16x32_bf16 v[172:175], a[56:59], a[80:83], v[172:175]
    s_add_u32 m0, s29, 118784
    v_mfma_f32_16x16x32_bf16 v[180:183], a[56:59], a[72:75], v[180:183]
    s_waitcnt vmcnt(10)
    buffer_load_dwordx4 v2, s[8:11], s52 offen lds
    v_mfma_f32_16x16x32_bf16 v[180:183], a[60:63], a[76:79], v[180:183]
    s_barrier
    ds_read_b64_tr_b16 a[0:1], v6 offset:0
    v_mfma_f32_16x16x32_bf16 v[188:191], a[60:63], a[68:71], v[188:191]
    ds_read_b64_tr_b16 a[2:3], v6 offset:4096
    v_mfma_f32_16x16x32_bf16 v[188:191], a[56:59], a[64:67], v[188:191]
    ds_read_b128 a[64:67], v4 offset:0
    v_mfma_f32_16x16x32_bf16 v[216:219], a[32:35], a[96:99], v[216:219]
    s_add_u32 m0, s29, 53248
    ds_read_b128 a[160:163], v14 offset:0
    v_mfma_f32_16x16x32_bf16 v[216:219], a[36:39], a[100:103], v[216:219]
    buffer_load_dwordx4 v1, s[4:7], s45 offen lds
    v_mfma_f32_16x16x32_bf16 v[208:211], a[36:39], a[108:111], v[208:211]
    ds_read_b64_tr_b16 a[4:5], v6 offset:16384
    v_mfma_f32_16x16x32_bf16 v[208:211], a[32:35], a[104:107], v[208:211]
    ds_read_b64_tr_b16 a[6:7], v6 offset:20480
    v_mfma_f32_16x16x32_bf16 v[200:203], a[32:35], a[112:115], v[200:203]
    ds_read_b128 a[68:71], v5 offset:0
    v_mfma_f32_16x16x32_bf16 v[200:203], a[36:39], a[116:119], v[200:203]
    s_add_u32 m0, s29, 122880
    ds_read_b128 a[168:171], v3 offset:0
    v_mfma_f32_16x16x32_bf16 v[192:195], a[36:39], a[124:127], v[192:195]
    buffer_load_dwordx4 v2, s[8:11], s53 offen lds
    v_mfma_f32_16x16x32_bf16 v[192:195], a[32:35], a[120:123], v[192:195]
    ds_read_b128 a[76:79], v5 offset:2048
    v_mfma_f32_16x16x32_bf16 v[196:199], a[40:43], a[120:123], v[196:199]
    ds_read_b128 a[164:167], v14 offset:2048
    v_mfma_f32_16x16x32_bf16 v[196:199], a[44:47], a[124:127], v[196:199]
    ds_read_b128 a[72:75], v4 offset:2048
    v_mfma_f32_16x16x32_bf16 v[204:207], a[44:47], a[116:119], v[204:207]
    s_add_u32 m0, s29, 57344
    ds_read_b128 a[172:175], v3 offset:2048
    v_mfma_f32_16x16x32_bf16 v[204:207], a[40:43], a[112:115], v[204:207]
    buffer_load_dwordx4 v1, s[4:7], s46 offen lds
    v_mfma_f32_16x16x32_bf16 v[212:215], a[40:43], a[104:107], v[212:215]
    ds_read_b128 a[80:83], v4 offset:4096
    v_mfma_f32_16x16x32_bf16 v[212:215], a[44:47], a[108:111], v[212:215]
    ds_read_b128 a[176:179], v14 offset:4096
    v_mfma_f32_16x16x32_bf16 v[220:223], a[44:47], a[100:103], v[220:223]
    ds_read_b128 a[84:87], v5 offset:4096
    v_mfma_f32_16x16x32_bf16 v[220:223], a[40:43], a[96:99], v[220:223]
    s_add_u32 m0, s29, 126976
    ds_read_b128 a[184:187], v3 offset:4096
    v_mfma_f32_16x16x32_bf16 v[248:251], a[48:51], a[96:99], v[248:251]
    buffer_load_dwordx4 v2, s[8:11], s54 offen lds
    v_mfma_f32_16x16x32_bf16 v[248:251], a[52:55], a[100:103], v[248:251]
    ds_read_b128 a[92:95], v5 offset:6144
    v_mfma_f32_16x16x32_bf16 v[240:243], a[52:55], a[108:111], v[240:243]
    ds_read_b128 a[180:183], v14 offset:6144
    v_mfma_f32_16x16x32_bf16 v[240:243], a[48:51], a[104:107], v[240:243]
    ds_read_b128 a[88:91], v4 offset:6144
    v_mfma_f32_16x16x32_bf16 v[232:235], a[48:51], a[112:115], v[232:235]
    s_add_u32 m0, s29, 61440
    ds_read_b128 a[188:191], v3 offset:6144
    v_mfma_f32_16x16x32_bf16 v[232:235], a[52:55], a[116:119], v[232:235]
    buffer_load_dwordx4 v1, s[4:7], s47 offen lds
    v_mfma_f32_16x16x32_bf16 v[224:227], a[52:55], a[124:127], v[224:227]
    v_add_u32 v1, 128, v1
    v_add_u32 v2, 0x80000, v2
    v_mfma_f32_16x16x32_bf16 v[224:227], a[48:51], a[120:123], v[224:227]
    ds_read_b64_tr_b16 a[8:9], v7 offset:0
    v_mfma_f32_16x16x32_bf16 v[228:231], a[56:59], a[120:123], v[228:231]
    v_mfma_f32_16x16x32_bf16 v[228:231], a[60:63], a[124:127], v[228:231]
    ds_read_b64_tr_b16 a[10:11], v7 offset:4096
    v_mfma_f32_16x16x32_bf16 v[236:239], a[60:63], a[116:119], v[236:239]
    ds_read_b64_tr_b16 a[12:13], v7 offset:16384
    v_mfma_f32_16x16x32_bf16 v[236:239], a[56:59], a[112:115], v[236:239]
    ds_read_b64_tr_b16 a[14:15], v7 offset:20480
    v_mfma_f32_16x16x32_bf16 v[244:247], a[56:59], a[104:107], v[244:247]
    ds_read_b64_tr_b16 a[16:17], v8 offset:0
    v_mfma_f32_16x16x32_bf16 v[244:247], a[60:63], a[108:111], v[244:247]
    ds_read_b64_tr_b16 a[18:19], v8 offset:4096
    v_mfma_f32_16x16x32_bf16 v[252:255], a[60:63], a[100:103], v[252:255]
    ds_read_b64_tr_b16 a[20:21], v8 offset:16384
    v_mfma_f32_16x16x32_bf16 v[252:255], a[56:59], a[96:99], v[252:255]
    s_waitcnt lgkmcnt(15)
    ds_read_b64_tr_b16 a[22:23], v8 offset:20480
    v_mfma_f32_16x16x32_bf16 v[88:91], a[0:3], a[64:67], v[88:91]
    ds_read_b64_tr_b16 a[24:25], v9 offset:0
    v_lshlrev_b32 v1, 4, v0
    v_mfma_f32_16x16x32_bf16 v[88:91], a[4:7], a[68:71], v[88:91]
    s_add_u32 m0, s33, 0xfffffe00
    ds_read_b64_tr_b16 a[26:27], v9 offset:4096
    v_mfma_f32_16x16x32_bf16 v[80:83], a[4:7], a[76:79], v[80:83]
    s_waitcnt lgkmcnt(10)
    ds_read_b64_tr_b16 a[28:29], v9 offset:16384
    v_mfma_f32_16x16x32_bf16 v[80:83], a[0:3], a[72:75], v[80:83]
    ds_read_b64_tr_b16 a[30:31], v9 offset:20480
    buffer_load_dwordx4 v15, s[20:23], 0 offen offset:512 lds
    v_mfma_f32_16x16x32_bf16 v[72:75], a[0:3], a[80:83], v[72:75]
    ds_read_b128 a[96:99], v4 offset:8192
    v_mfma_f32_16x16x32_bf16 v[72:75], a[4:7], a[84:87], v[72:75]
    v_mfma_f32_16x16x32_bf16 v[64:67], a[4:7], a[92:95], v[64:67]
    s_add_u32 m0, s33, 0xfffffe80
    ds_read_b128 a[100:103], v5 offset:8192
    v_mfma_f32_16x16x32_bf16 v[64:67], a[0:3], a[88:91], v[64:67]
    s_waitcnt lgkmcnt(10)
    buffer_load_dwordx4 v15, s[20:23], 0 offen offset:1408 lds
    v_mfma_f32_16x16x32_bf16 v[68:71], a[8:11], a[88:91], v[68:71]
    ds_read_b128 a[108:111], v5 offset:10240
    v_mfma_f32_16x16x32_bf16 v[68:71], a[12:15], a[92:95], v[68:71]
    v_mfma_f32_16x16x32_bf16 v[76:79], a[12:15], a[84:87], v[76:79]
    s_add_u32 m0, s33, 0x600
    ds_read_b128 a[104:107], v4 offset:10240
    v_mfma_f32_16x16x32_bf16 v[76:79], a[8:11], a[80:83], v[76:79]
    buffer_load_dwordx4 v15, s[20:23], s57 offen offset:512 lds
    v_mfma_f32_16x16x32_bf16 v[84:87], a[8:11], a[72:75], v[84:87]
    ds_read_b128 a[112:115], v4 offset:12288
    v_mfma_f32_16x16x32_bf16 v[84:87], a[12:15], a[76:79], v[84:87]
    v_mfma_f32_16x16x32_bf16 v[92:95], a[12:15], a[68:71], v[92:95]
    s_add_u32 m0, s33, 0x680
    ds_read_b128 a[116:119], v5 offset:12288
    v_mfma_f32_16x16x32_bf16 v[92:95], a[8:11], a[64:67], v[92:95]
    s_waitcnt lgkmcnt(10)
    buffer_load_dwordx4 v15, s[20:23], s57 offen offset:1408 lds
    v_mfma_f32_16x16x32_bf16 v[120:123], a[16:19], a[64:67], v[120:123]
    ds_read_b128 a[124:127], v5 offset:14336
    v_mfma_f32_16x16x32_bf16 v[120:123], a[20:23], a[68:71], v[120:123]
    v_mfma_f32_16x16x32_bf16 v[112:115], a[20:23], a[76:79], v[112:115]
    s_add_u32 m0, s33, 0xd80
    ds_read_b128 a[120:123], v4 offset:14336
    v_mfma_f32_16x16x32_bf16 v[112:115], a[16:19], a[72:75], v[112:115]
    buffer_load_dwordx4 v15, s[20:23], 0 offen offset:640 lds
    v_mfma_f32_16x16x32_bf16 v[104:107], a[16:19], a[80:83], v[104:107]
    ds_read_b64_tr_b16 a[32:33], v10 offset:0
    v_mfma_f32_16x16x32_bf16 v[104:107], a[20:23], a[84:87], v[104:107]
    ds_read_b64_tr_b16 a[34:35], v10 offset:4096
    v_mfma_f32_16x16x32_bf16 v[96:99], a[20:23], a[92:95], v[96:99]
    s_add_u32 m0, s33, 0xe00
    ds_read_b64_tr_b16 a[36:37], v10 offset:16384
    v_mfma_f32_16x16x32_bf16 v[96:99], a[16:19], a[88:91], v[96:99]
    s_waitcnt lgkmcnt(11)
    ds_read_b64_tr_b16 a[38:39], v10 offset:20480
    buffer_load_dwordx4 v15, s[20:23], 0 offen offset:1536 lds
    v_mfma_f32_16x16x32_bf16 v[100:103], a[24:27], a[88:91], v[100:103]
    ds_read_b64_tr_b16 a[40:41], v11 offset:0
    v_mfma_f32_16x16x32_bf16 v[100:103], a[28:31], a[92:95], v[100:103]
    ds_read_b64_tr_b16 a[42:43], v11 offset:4096
    v_mfma_f32_16x16x32_bf16 v[108:111], a[28:31], a[84:87], v[108:111]
    s_add_u32 m0, s33, 0x1580
    ds_read_b64_tr_b16 a[44:45], v11 offset:16384
    v_mfma_f32_16x16x32_bf16 v[108:111], a[24:27], a[80:83], v[108:111]
    ds_read_b64_tr_b16 a[46:47], v11 offset:20480
    buffer_load_dwordx4 v15, s[20:23], s57 offen offset:640 lds
    v_mfma_f32_16x16x32_bf16 v[116:119], a[24:27], a[72:75], v[116:119]
    ds_read_b64_tr_b16 a[48:49], v12 offset:0
    v_mfma_f32_16x16x32_bf16 v[116:119], a[28:31], a[76:79], v[116:119]
    ds_read_b64_tr_b16 a[50:51], v12 offset:4096
    v_mfma_f32_16x16x32_bf16 v[124:127], a[28:31], a[68:71], v[124:127]
    s_add_u32 m0, s33, 0x1600
    ds_read_b64_tr_b16 a[52:53], v12 offset:16384
    v_mfma_f32_16x16x32_bf16 v[124:127], a[24:27], a[64:67], v[124:127]
    s_waitcnt lgkmcnt(15)
    ds_read_b64_tr_b16 a[54:55], v12 offset:20480
    buffer_load_dwordx4 v15, s[20:23], s57 offen offset:1536 lds
    v_mfma_f32_16x16x32_bf16 a[232:235], a[0:3], a[96:99], a[232:235]
    ds_read_b64_tr_b16 a[56:57], v13 offset:0
    v_mfma_f32_16x16x32_bf16 a[232:235], a[4:7], a[100:103], a[232:235]
    ds_read_b64_tr_b16 a[58:59], v13 offset:4096
    v_mfma_f32_16x16x32_bf16 a[224:227], a[4:7], a[108:111], a[224:227]
    ds_read_b64_tr_b16 a[60:61], v13 offset:16384
    v_mfma_f32_16x16x32_bf16 a[224:227], a[0:3], a[104:107], a[224:227]
    s_waitcnt lgkmcnt(15)
    ds_read_b64_tr_b16 a[62:63], v13 offset:20480
    v_mfma_f32_16x16x32_bf16 v[24:27], a[0:3], a[112:115], v[24:27]
    v_mfma_f32_16x16x32_bf16 v[24:27], a[4:7], a[116:119], v[24:27]
    v_mfma_f32_16x16x32_bf16 v[16:19], a[4:7], a[124:127], v[16:19]
    v_mfma_f32_16x16x32_bf16 v[16:19], a[0:3], a[120:123], v[16:19]
    s_waitcnt lgkmcnt(0)
    v_mfma_f32_16x16x32_bf16 v[20:23], a[8:11], a[120:123], v[20:23]
    s_barrier
    v_mfma_f32_16x16x32_bf16 v[20:23], a[12:15], a[124:127], v[20:23]
    s_add_u32 m0, s29, 0
    v_add_u32 v2, 0xff800000, v2
    v_mfma_f32_16x16x32_bf16 v[28:31], a[12:15], a[116:119], v[28:31]
    buffer_load_dwordx4 v2, s[16:19], 0 offen lds
    v_mfma_f32_16x16x32_bf16 v[28:31], a[8:11], a[112:115], v[28:31]
    v_mfma_f32_16x16x32_bf16 a[228:231], a[8:11], a[104:107], a[228:231]
    v_mfma_f32_16x16x32_bf16 a[228:231], a[12:15], a[108:111], a[228:231]
    v_mfma_f32_16x16x32_bf16 a[236:239], a[12:15], a[100:103], a[236:239]
    s_add_u32 m0, s29, 4096
    v_mfma_f32_16x16x32_bf16 a[236:239], a[8:11], a[96:99], a[236:239]
    buffer_load_dwordx4 v2, s[16:19], s48 offen lds
    v_mfma_f32_16x16x32_bf16 v[56:59], a[16:19], a[96:99], v[56:59]
    v_mfma_f32_16x16x32_bf16 v[56:59], a[20:23], a[100:103], v[56:59]
    v_mfma_f32_16x16x32_bf16 v[48:51], a[20:23], a[108:111], v[48:51]
    v_mfma_f32_16x16x32_bf16 v[48:51], a[16:19], a[104:107], v[48:51]
    s_add_u32 m0, s29, 8192
    v_mfma_f32_16x16x32_bf16 v[40:43], a[16:19], a[112:115], v[40:43]
    buffer_load_dwordx4 v2, s[16:19], s49 offen lds
    v_mfma_f32_16x16x32_bf16 v[40:43], a[20:23], a[116:119], v[40:43]
    v_mfma_f32_16x16x32_bf16 v[32:35], a[20:23], a[124:127], v[32:35]
    v_mfma_f32_16x16x32_bf16 v[32:35], a[16:19], a[120:123], v[32:35]
    v_mfma_f32_16x16x32_bf16 v[36:39], a[24:27], a[120:123], v[36:39]
    s_add_u32 m0, s29, 12288
    v_mfma_f32_16x16x32_bf16 v[36:39], a[28:31], a[124:127], v[36:39]
    buffer_load_dwordx4 v2, s[16:19], s50 offen lds
    v_mfma_f32_16x16x32_bf16 v[44:47], a[28:31], a[116:119], v[44:47]
    v_mfma_f32_16x16x32_bf16 v[44:47], a[24:27], a[112:115], v[44:47]
    v_mfma_f32_16x16x32_bf16 v[52:55], a[24:27], a[104:107], v[52:55]
    v_mfma_f32_16x16x32_bf16 v[52:55], a[28:31], a[108:111], v[52:55]
    s_add_u32 m0, s29, 16384
    v_mfma_f32_16x16x32_bf16 v[60:63], a[28:31], a[100:103], v[60:63]
    buffer_load_dwordx4 v2, s[16:19], s51 offen lds
    v_mfma_f32_16x16x32_bf16 v[60:63], a[24:27], a[96:99], v[60:63]
    v_mfma_f32_16x16x32_bf16 v[216:219], a[32:35], a[96:99], v[216:219]
    v_mfma_f32_16x16x32_bf16 v[216:219], a[36:39], a[100:103], v[216:219]
    v_mfma_f32_16x16x32_bf16 v[208:211], a[36:39], a[108:111], v[208:211]
    s_add_u32 m0, s29, 20480
    v_mfma_f32_16x16x32_bf16 v[208:211], a[32:35], a[104:107], v[208:211]
    buffer_load_dwordx4 v2, s[16:19], s52 offen lds
    v_mfma_f32_16x16x32_bf16 v[200:203], a[32:35], a[112:115], v[200:203]
    v_mfma_f32_16x16x32_bf16 v[200:203], a[36:39], a[116:119], v[200:203]
    v_mfma_f32_16x16x32_bf16 v[192:195], a[36:39], a[124:127], v[192:195]
    v_mfma_f32_16x16x32_bf16 v[192:195], a[32:35], a[120:123], v[192:195]
    s_add_u32 m0, s29, 24576
    v_mfma_f32_16x16x32_bf16 v[196:199], a[40:43], a[120:123], v[196:199]
    buffer_load_dwordx4 v2, s[16:19], s53 offen lds
    v_mfma_f32_16x16x32_bf16 v[196:199], a[44:47], a[124:127], v[196:199]
    v_mfma_f32_16x16x32_bf16 v[204:207], a[44:47], a[116:119], v[204:207]
    v_mfma_f32_16x16x32_bf16 v[204:207], a[40:43], a[112:115], v[204:207]
    v_mfma_f32_16x16x32_bf16 v[212:215], a[40:43], a[104:107], v[212:215]
    s_add_u32 m0, s29, 28672
    v_mfma_f32_16x16x32_bf16 v[212:215], a[44:47], a[108:111], v[212:215]
    buffer_load_dwordx4 v2, s[16:19], s54 offen lds
    v_mfma_f32_16x16x32_bf16 v[220:223], a[44:47], a[100:103], v[220:223]
    v_mfma_f32_16x16x32_bf16 v[220:223], a[40:43], a[96:99], v[220:223]
    v_mfma_f32_16x16x32_bf16 v[248:251], a[48:51], a[96:99], v[248:251]
    s_add_u32 m0, s29, 65536
    v_add_u32 v2, 0x80000, v2
    v_mfma_f32_16x16x32_bf16 v[248:251], a[52:55], a[100:103], v[248:251]
    buffer_load_dwordx4 v2, s[16:19], 0 offen lds
    v_mfma_f32_16x16x32_bf16 v[240:243], a[52:55], a[108:111], v[240:243]
    v_mfma_f32_16x16x32_bf16 v[240:243], a[48:51], a[104:107], v[240:243]
    v_mfma_f32_16x16x32_bf16 v[232:235], a[48:51], a[112:115], v[232:235]
    v_mfma_f32_16x16x32_bf16 v[232:235], a[52:55], a[116:119], v[232:235]
    s_add_u32 m0, s29, 69632
    v_mfma_f32_16x16x32_bf16 v[224:227], a[52:55], a[124:127], v[224:227]
    buffer_load_dwordx4 v2, s[16:19], s48 offen lds
    v_mfma_f32_16x16x32_bf16 v[224:227], a[48:51], a[120:123], v[224:227]
    v_mfma_f32_16x16x32_bf16 v[228:231], a[56:59], a[120:123], v[228:231]
    v_mfma_f32_16x16x32_bf16 v[228:231], a[60:63], a[124:127], v[228:231]
    v_mfma_f32_16x16x32_bf16 v[236:239], a[60:63], a[116:119], v[236:239]
    s_add_u32 m0, s29, 73728
    v_mfma_f32_16x16x32_bf16 v[236:239], a[56:59], a[112:115], v[236:239]
    buffer_load_dwordx4 v2, s[16:19], s49 offen lds
    v_mfma_f32_16x16x32_bf16 v[244:247], a[56:59], a[104:107], v[244:247]
    s_waitcnt vmcnt(11)
    v_mfma_f32_16x16x32_bf16 v[244:247], a[60:63], a[108:111], v[244:247]
    s_barrier
    ds_read_b64_tr_b16 a[0:1], v6 offset:32768
    v_mfma_f32_16x16x32_bf16 v[252:255], a[60:63], a[100:103], v[252:255]
    ds_read_b64_tr_b16 a[2:3], v6 offset:36864
    v_mfma_f32_16x16x32_bf16 v[252:255], a[56:59], a[96:99], v[252:255]
    s_add_u32 m0, s29, 77824
    ds_read_b128 a[96:99], v4 offset:40960
    v_mfma_f32_16x16x32_bf16 v[152:155], a[32:35], a[64:67], v[152:155]
    ds_read_b128 a[192:195], v14 offset:0
    buffer_load_dwordx4 v2, s[16:19], s50 offen lds
    v_mfma_f32_16x16x32_bf16 v[152:155], a[36:39], a[68:71], v[152:155]
    ds_read_b128 a[200:203], v3 offset:0
    v_mfma_f32_16x16x32_bf16 v[144:147], a[36:39], a[76:79], v[144:147]
    ds_read_b64_tr_b16 a[4:5], v6 offset:49152
    v_mfma_f32_16x16x32_bf16 v[144:147], a[32:35], a[72:75], v[144:147]
    ds_read_b64_tr_b16 a[6:7], v6 offset:53248
    v_mfma_f32_16x16x32_bf16 v[136:139], a[32:35], a[80:83], v[136:139]
    s_add_u32 m0, s29, 81920
    ds_read_b128 a[100:103], v5 offset:40960
    v_mfma_f32_16x16x32_bf16 v[136:139], a[36:39], a[84:87], v[136:139]
    ds_read_b128 a[196:199], v14 offset:2048
    buffer_load_dwordx4 v2, s[16:19], s51 offen lds
    v_mfma_f32_16x16x32_bf16 v[128:131], a[36:39], a[92:95], v[128:131]
    ds_read_b128 a[204:207], v3 offset:2048
    v_mfma_f32_16x16x32_bf16 v[128:131], a[32:35], a[88:91], v[128:131]
    ds_read_b128 a[108:111], v5 offset:43008
    v_mfma_f32_16x16x32_bf16 v[132:135], a[40:43], a[88:91], v[132:135]
    ds_read_b128 a[208:211], v14 offset:4096
    v_mfma_f32_16x16x32_bf16 v[132:135], a[44:47], a[92:95], v[132:135]
    s_add_u32 m0, s29, 86016
    ds_read_b128 a[104:107], v4 offset:43008
    v_mfma_f32_16x16x32_bf16 v[140:143], a[44:47], a[84:87], v[140:143]
    ds_read_b128 a[216:219], v3 offset:4096
    buffer_load_dwordx4 v2, s[16:19], s52 offen lds
    v_mfma_f32_16x16x32_bf16 v[140:143], a[40:43], a[80:83], v[140:143]
    ds_read_b128 a[212:215], v14 offset:6144
    v_mfma_f32_16x16x32_bf16 v[148:151], a[40:43], a[72:75], v[148:151]
    ds_read_b128 a[112:115], v4 offset:45056
    v_mfma_f32_16x16x32_bf16 v[148:151], a[44:47], a[76:79], v[148:151]
    ds_read_b128 a[220:223], v3 offset:6144
    v_mfma_f32_16x16x32_bf16 v[156:159], a[44:47], a[68:71], v[156:159]
    s_add_u32 m0, s29, 90112
    ds_read_b128 a[116:119], v5 offset:45056
    v_mfma_f32_16x16x32_bf16 v[156:159], a[40:43], a[64:67], v[156:159]
    buffer_load_dwordx4 v2, s[16:19], s53 offen lds
    v_mfma_f32_16x16x32_bf16 v[184:187], a[48:51], a[64:67], v[184:187]
    v_mfma_f32_16x16x32_bf16 v[184:187], a[52:55], a[68:71], v[184:187]
    ds_read_b128 a[124:127], v5 offset:47104
    v_mfma_f32_16x16x32_bf16 v[176:179], a[52:55], a[76:79], v[176:179]
    v_mfma_f32_16x16x32_bf16 v[176:179], a[48:51], a[72:75], v[176:179]
    s_add_u32 m0, s29, 94208
    ds_read_b128 a[120:123], v4 offset:47104
    v_mfma_f32_16x16x32_bf16 v[168:171], a[48:51], a[80:83], v[168:171]
    buffer_load_dwordx4 v2, s[16:19], s54 offen lds
    v_mfma_f32_16x16x32_bf16 v[168:171], a[52:55], a[84:87], v[168:171]
    v_mfma_f32_16x16x32_bf16 v[160:163], a[52:55], a[92:95], v[160:163]
    v_mfma_f32_16x16x32_bf16 v[160:163], a[48:51], a[88:91], v[160:163]
    ds_read_b64_tr_b16 a[8:9], v7 offset:32768
    v_mfma_f32_16x16x32_bf16 v[164:167], a[56:59], a[88:91], v[164:167]
    v_mfma_f32_16x16x32_bf16 v[164:167], a[60:63], a[92:95], v[164:167]
    ds_read_b64_tr_b16 a[10:11], v7 offset:36864
    v_mfma_f32_16x16x32_bf16 v[172:175], a[60:63], a[84:87], v[172:175]
    ds_read_b64_tr_b16 a[12:13], v7 offset:49152
    v_mfma_f32_16x16x32_bf16 v[172:175], a[56:59], a[80:83], v[172:175]
    ds_read_b64_tr_b16 a[14:15], v7 offset:53248
    v_mfma_f32_16x16x32_bf16 v[180:183], a[56:59], a[72:75], v[180:183]
    ds_read_b64_tr_b16 a[16:17], v8 offset:32768
    v_mfma_f32_16x16x32_bf16 v[180:183], a[60:63], a[76:79], v[180:183]
    ds_read_b64_tr_b16 a[18:19], v8 offset:36864
    v_mfma_f32_16x16x32_bf16 v[188:191], a[60:63], a[68:71], v[188:191]
    ds_read_b64_tr_b16 a[20:21], v8 offset:49152
    v_mfma_f32_16x16x32_bf16 v[188:191], a[56:59], a[64:67], v[188:191]
    s_waitcnt lgkmcnt(15)
    ds_read_b64_tr_b16 a[22:23], v8 offset:53248
    v_mfma_f32_16x16x32_bf16 a[232:235], a[0:3], a[96:99], a[232:235]
    ds_read_b64_tr_b16 a[24:25], v9 offset:32768
    v_mfma_f32_16x16x32_bf16 a[232:235], a[4:7], a[100:103], a[232:235]
    s_add_u32 m0, s33, 0xfffffd00
    ds_read_b64_tr_b16 a[26:27], v9 offset:36864
    v_mfma_f32_16x16x32_bf16 a[224:227], a[4:7], a[108:111], a[224:227]
    s_waitcnt lgkmcnt(13)
    ds_read_b64_tr_b16 a[28:29], v9 offset:49152
    v_mfma_f32_16x16x32_bf16 a[224:227], a[0:3], a[104:107], a[224:227]
    ds_read_b64_tr_b16 a[30:31], v9 offset:53248
    buffer_load_dwordx4 v15, s[20:23], 0 offen offset:768 lds
    v_mfma_f32_16x16x32_bf16 v[24:27], a[0:3], a[112:115], v[24:27]
    s_waitcnt lgkmcnt(12)
    ds_read_b128 a[64:67], v4 offset:32768
    v_mfma_f32_16x16x32_bf16 v[24:27], a[4:7], a[116:119], v[24:27]
    v_mfma_f32_16x16x32_bf16 v[16:19], a[4:7], a[124:127], v[16:19]
    s_add_u32 m0, s33, 0xfffffd80
    ds_read_b128 a[68:71], v5 offset:32768
    v_mfma_f32_16x16x32_bf16 v[16:19], a[0:3], a[120:123], v[16:19]
    s_waitcnt lgkmcnt(10)
    buffer_load_dwordx4 v15, s[20:23], 0 offen offset:1664 lds
    v_mfma_f32_16x16x32_bf16 v[20:23], a[8:11], a[120:123], v[20:23]
    ds_read_b128 a[76:79], v5 offset:34816
    v_mfma_f32_16x16x32_bf16 v[20:23], a[12:15], a[124:127], v[20:23]
    v_mfma_f32_16x16x32_bf16 v[28:31], a[12:15], a[116:119], v[28:31]
    s_add_u32 m0, s33, 0x500
    ds_read_b128 a[72:75], v4 offset:34816
    v_mfma_f32_16x16x32_bf16 v[28:31], a[8:11], a[112:115], v[28:31]
    buffer_load_dwordx4 v15, s[20:23], s57 offen offset:768 lds
    v_mfma_f32_16x16x32_bf16 a[228:231], a[8:11], a[104:107], a[228:231]
    ds_read_b128 a[80:83], v4 offset:36864
    v_mfma_f32_16x16x32_bf16 a[228:231], a[12:15], a[108:111], a[228:231]
    v_mfma_f32_16x16x32_bf16 a[236:239], a[12:15], a[100:103], a[236:239]
    s_add_u32 m0, s33, 0x580
    ds_read_b128 a[84:87], v5 offset:36864
    v_mfma_f32_16x16x32_bf16 a[236:239], a[8:11], a[96:99], a[236:239]
    s_waitcnt lgkmcnt(10)
    buffer_load_dwordx4 v15, s[20:23], s57 offen offset:1664 lds
    v_mfma_f32_16x16x32_bf16 v[56:59], a[16:19], a[96:99], v[56:59]
    ds_read_b128 a[92:95], v5 offset:38912
    v_mfma_f32_16x16x32_bf16 v[56:59], a[20:23], a[100:103], v[56:59]
    v_cvt_pk_bf16_f32 v16, v16, v17
    v_cvt_pk_bf16_f32 v17, v18, v19
    v_mfma_f32_16x16x32_bf16 v[48:51], a[20:23], a[108:111], v[48:51]
    ds_read_b128 a[88:91], v4 offset:38912
    v_cvt_pk_bf16_f32 v18, v20, v21
    v_mfma_f32_16x16x32_bf16 v[48:51], a[16:19], a[104:107], v[48:51]
    v_cvt_pk_bf16_f32 v19, v22, v23
    v_cvt_pk_bf16_f32 v24, v24, v25
    v_mfma_f32_16x16x32_bf16 v[40:43], a[16:19], a[112:115], v[40:43]
    ds_read_b64_tr_b16 a[32:33], v10 offset:32768
    v_cvt_pk_bf16_f32 v25, v26, v27
    v_mfma_f32_16x16x32_bf16 v[40:43], a[20:23], a[116:119], v[40:43]
    ds_read_b64_tr_b16 a[34:35], v10 offset:36864
    v_cvt_pk_bf16_f32 v26, v28, v29
    v_mfma_f32_16x16x32_bf16 v[32:35], a[20:23], a[124:127], v[32:35]
    ds_read_b64_tr_b16 a[36:37], v10 offset:49152
    v_cvt_pk_bf16_f32 v27, v30, v31
    v_mfma_f32_16x16x32_bf16 v[32:35], a[16:19], a[120:123], v[32:35]
    s_waitcnt lgkmcnt(11)
    ds_read_b64_tr_b16 a[38:39], v10 offset:53248
    v_accvgpr_read_b32 v20, a224
    v_mfma_f32_16x16x32_bf16 v[36:39], a[24:27], a[120:123], v[36:39]
    ds_read_b64_tr_b16 a[40:41], v11 offset:32768
    v_accvgpr_read_b32 v21, a225
    v_mfma_f32_16x16x32_bf16 v[36:39], a[28:31], a[124:127], v[36:39]
    ds_read_b64_tr_b16 a[42:43], v11 offset:36864
    v_accvgpr_read_b32 v22, a226
    v_mfma_f32_16x16x32_bf16 v[44:47], a[28:31], a[116:119], v[44:47]
    ds_read_b64_tr_b16 a[44:45], v11 offset:49152
    v_accvgpr_read_b32 v23, a227
    v_mfma_f32_16x16x32_bf16 v[44:47], a[24:27], a[112:115], v[44:47]
    ds_read_b64_tr_b16 a[46:47], v11 offset:53248
    v_accvgpr_read_b32 v28, a228
    v_mfma_f32_16x16x32_bf16 v[52:55], a[24:27], a[104:107], v[52:55]
    ds_read_b64_tr_b16 a[48:49], v12 offset:32768
    v_accvgpr_read_b32 v29, a229
    v_mfma_f32_16x16x32_bf16 v[52:55], a[28:31], a[108:111], v[52:55]
    ds_read_b64_tr_b16 a[50:51], v12 offset:36864
    v_accvgpr_read_b32 v30, a230
    v_mfma_f32_16x16x32_bf16 v[60:63], a[28:31], a[100:103], v[60:63]
    ds_read_b64_tr_b16 a[52:53], v12 offset:49152
    v_accvgpr_read_b32 v31, a231
    v_mfma_f32_16x16x32_bf16 v[60:63], a[24:27], a[96:99], v[60:63]
    s_waitcnt lgkmcnt(15)
    ds_read_b64_tr_b16 a[54:55], v12 offset:53248
    v_cvt_pk_bf16_f32 v20, v20, v21
    v_mfma_f32_16x16x32_bf16 v[88:91], a[0:3], a[64:67], v[88:91]
    ds_read_b64_tr_b16 a[56:57], v13 offset:32768
    v_cvt_pk_bf16_f32 v21, v22, v23
    v_mfma_f32_16x16x32_bf16 v[88:91], a[4:7], a[68:71], v[88:91]
    ds_read_b64_tr_b16 a[58:59], v13 offset:36864
    v_cvt_pk_bf16_f32 v22, v28, v29
    v_mfma_f32_16x16x32_bf16 v[80:83], a[4:7], a[76:79], v[80:83]
    ds_read_b64_tr_b16 a[60:61], v13 offset:49152
    v_cvt_pk_bf16_f32 v23, v30, v31
    v_mfma_f32_16x16x32_bf16 v[80:83], a[0:3], a[72:75], v[80:83]
    s_waitcnt lgkmcnt(15)
    ds_read_b64_tr_b16 a[62:63], v13 offset:53248
    v_cvt_pk_bf16_f32 v32, v32, v33
    v_mfma_f32_16x16x32_bf16 v[72:75], a[0:3], a[80:83], v[72:75]
    v_cvt_pk_bf16_f32 v33, v34, v35
    v_cvt_pk_bf16_f32 v34, v36, v37
    v_mfma_f32_16x16x32_bf16 v[72:75], a[4:7], a[84:87], v[72:75]
    v_cvt_pk_bf16_f32 v35, v38, v39
    v_cvt_pk_bf16_f32 v40, v40, v41
    v_mfma_f32_16x16x32_bf16 v[64:67], a[4:7], a[92:95], v[64:67]
    v_cvt_pk_bf16_f32 v41, v42, v43
    v_cvt_pk_bf16_f32 v42, v44, v45
    v_mfma_f32_16x16x32_bf16 v[64:67], a[0:3], a[88:91], v[64:67]
    s_waitcnt lgkmcnt(0)
    v_cvt_pk_bf16_f32 v43, v46, v47
    v_accvgpr_read_b32 v36, a232
    v_mfma_f32_16x16x32_bf16 v[68:71], a[8:11], a[88:91], v[68:71]
    s_barrier
    v_xor_b32 v6, s60, v6
    v_accvgpr_read_b32 v37, a233
    v_mfma_f32_16x16x32_bf16 v[68:71], a[12:15], a[92:95], v[68:71]
    s_add_u32 m0, s29, 32768
    v_add_u32 v2, 0x80000, v2
    v_accvgpr_read_b32 v38, a234
    v_mfma_f32_16x16x32_bf16 v[76:79], a[12:15], a[84:87], v[76:79]
    buffer_load_dwordx4 v2, s[16:19], 0 offen lds
    v_mfma_f32_16x16x32_bf16 v[76:79], a[8:11], a[80:83], v[76:79]
    s_add_u32 s59, s58, 40960
    v_accvgpr_read_b32 v39, a235
    v_accvgpr_read_b32 v44, a236
    v_mfma_f32_16x16x32_bf16 v[84:87], a[8:11], a[72:75], v[84:87]
    buffer_store_dwordx4 v[20:23], v1, s[12:15], s59 offen offset:0 sc1
    v_mfma_f32_16x16x32_bf16 v[84:87], a[12:15], a[76:79], v[84:87]
    v_accvgpr_read_b32 v45, a237
    v_accvgpr_read_b32 v46, a238
    v_mfma_f32_16x16x32_bf16 v[92:95], a[12:15], a[68:71], v[92:95]
    s_add_u32 m0, s29, 36864
    v_accvgpr_read_b32 v47, a239
    v_cvt_pk_bf16_f32 v36, v36, v37
    v_mfma_f32_16x16x32_bf16 v[92:95], a[8:11], a[64:67], v[92:95]
    buffer_load_dwordx4 v2, s[16:19], s48 offen lds
    v_mfma_f32_16x16x32_bf16 v[120:123], a[16:19], a[64:67], v[120:123]
    v_cvt_pk_bf16_f32 v37, v38, v39
    v_cvt_pk_bf16_f32 v38, v44, v45
    v_mfma_f32_16x16x32_bf16 v[120:123], a[20:23], a[68:71], v[120:123]
    v_cvt_pk_bf16_f32 v39, v46, v47
    v_cvt_pk_bf16_f32 v48, v48, v49
    v_mfma_f32_16x16x32_bf16 v[112:115], a[20:23], a[76:79], v[112:115]
    v_cvt_pk_bf16_f32 v49, v50, v51
    v_cvt_pk_bf16_f32 v50, v52, v53
    v_mfma_f32_16x16x32_bf16 v[112:115], a[16:19], a[72:75], v[112:115]
    s_add_u32 m0, s29, 40960
    v_cvt_pk_bf16_f32 v51, v54, v55
    v_cvt_pk_bf16_f32 v56, v56, v57
    v_mfma_f32_16x16x32_bf16 v[104:107], a[16:19], a[80:83], v[104:107]
    buffer_load_dwordx4 v2, s[16:19], s49 offen lds
    v_mfma_f32_16x16x32_bf16 v[104:107], a[20:23], a[84:87], v[104:107]
    s_add_u32 s59, s58, 32768
    v_cvt_pk_bf16_f32 v57, v58, v59
    v_cvt_pk_bf16_f32 v58, v60, v61
    v_mfma_f32_16x16x32_bf16 v[96:99], a[20:23], a[92:95], v[96:99]
    buffer_store_dwordx4 v[36:39], v1, s[12:15], s59 offen offset:0 sc1
    v_mfma_f32_16x16x32_bf16 v[96:99], a[16:19], a[88:91], v[96:99]
    v_cvt_pk_bf16_f32 v59, v62, v63
    v_cvt_pk_bf16_f32 v64, v64, v65
    v_mfma_f32_16x16x32_bf16 v[100:103], a[24:27], a[88:91], v[100:103]
    s_add_u32 m0, s29, 45056
    v_cvt_pk_bf16_f32 v65, v66, v67
    v_cvt_pk_bf16_f32 v66, v68, v69
    v_mfma_f32_16x16x32_bf16 v[100:103], a[28:31], a[92:95], v[100:103]
    buffer_load_dwordx4 v2, s[16:19], s50 offen lds
    v_mfma_f32_16x16x32_bf16 v[108:111], a[28:31], a[84:87], v[108:111]
    v_cvt_pk_bf16_f32 v67, v70, v71
    v_cvt_pk_bf16_f32 v72, v72, v73
    v_mfma_f32_16x16x32_bf16 v[108:111], a[24:27], a[80:83], v[108:111]
    v_cvt_pk_bf16_f32 v73, v74, v75
    v_cvt_pk_bf16_f32 v74, v76, v77
    v_mfma_f32_16x16x32_bf16 v[116:119], a[24:27], a[72:75], v[116:119]
    v_cvt_pk_bf16_f32 v75, v78, v79
    v_cvt_pk_bf16_f32 v80, v80, v81
    v_mfma_f32_16x16x32_bf16 v[116:119], a[28:31], a[76:79], v[116:119]
    s_add_u32 m0, s29, 49152
    v_cvt_pk_bf16_f32 v81, v82, v83
    v_cvt_pk_bf16_f32 v82, v84, v85
    v_mfma_f32_16x16x32_bf16 v[124:127], a[28:31], a[68:71], v[124:127]
    buffer_load_dwordx4 v2, s[16:19], s51 offen lds
    v_mfma_f32_16x16x32_bf16 v[124:127], a[24:27], a[64:67], v[124:127]
    s_add_u32 s59, s58, 57344
    v_cvt_pk_bf16_f32 v83, v86, v87
    v_cvt_pk_bf16_f32 v88, v88, v89
    v_mfma_f32_16x16x32_bf16 v[152:155], a[32:35], a[64:67], v[152:155]
    buffer_store_dwordx4 v[16:19], v1, s[12:15], s59 offen offset:0 sc1
    v_mfma_f32_16x16x32_bf16 v[152:155], a[36:39], a[68:71], v[152:155]
    v_cvt_pk_bf16_f32 v89, v90, v91
    v_cvt_pk_bf16_f32 v90, v92, v93
    v_mfma_f32_16x16x32_bf16 v[144:147], a[36:39], a[76:79], v[144:147]
    s_add_u32 m0, s29, 53248
    v_cvt_pk_bf16_f32 v91, v94, v95
    v_cvt_pk_bf16_f32 v96, v96, v97
    v_mfma_f32_16x16x32_bf16 v[144:147], a[32:35], a[72:75], v[144:147]
    buffer_load_dwordx4 v2, s[16:19], s52 offen lds
    v_mfma_f32_16x16x32_bf16 v[136:139], a[32:35], a[80:83], v[136:139]
    v_cvt_pk_bf16_f32 v97, v98, v99
    v_cvt_pk_bf16_f32 v98, v100, v101
    v_mfma_f32_16x16x32_bf16 v[136:139], a[36:39], a[84:87], v[136:139]
    v_cvt_pk_bf16_f32 v99, v102, v103
    v_cvt_pk_bf16_f32 v104, v104, v105
    v_mfma_f32_16x16x32_bf16 v[128:131], a[36:39], a[92:95], v[128:131]
    v_cvt_pk_bf16_f32 v105, v106, v107
    v_cvt_pk_bf16_f32 v106, v108, v109
    v_mfma_f32_16x16x32_bf16 v[128:131], a[32:35], a[88:91], v[128:131]
    s_add_u32 m0, s29, 57344
    v_cvt_pk_bf16_f32 v107, v110, v111
    v_cvt_pk_bf16_f32 v112, v112, v113
    v_mfma_f32_16x16x32_bf16 v[132:135], a[40:43], a[88:91], v[132:135]
    buffer_load_dwordx4 v2, s[16:19], s53 offen lds
    v_mfma_f32_16x16x32_bf16 v[132:135], a[44:47], a[92:95], v[132:135]
    s_add_u32 s59, s58, 49152
    v_cvt_pk_bf16_f32 v113, v114, v115
    v_cvt_pk_bf16_f32 v114, v116, v117
    v_mfma_f32_16x16x32_bf16 v[140:143], a[44:47], a[84:87], v[140:143]
    buffer_store_dwordx4 v[24:27], v1, s[12:15], s59 offen offset:0 sc1
    v_mfma_f32_16x16x32_bf16 v[140:143], a[40:43], a[80:83], v[140:143]
    v_cvt_pk_bf16_f32 v115, v118, v119
    v_cvt_pk_bf16_f32 v120, v120, v121
    v_mfma_f32_16x16x32_bf16 v[148:151], a[40:43], a[72:75], v[148:151]
    s_add_u32 m0, s29, 61440
    v_cvt_pk_bf16_f32 v121, v122, v123
    v_cvt_pk_bf16_f32 v122, v124, v125
    v_mfma_f32_16x16x32_bf16 v[148:151], a[44:47], a[76:79], v[148:151]
    buffer_load_dwordx4 v2, s[16:19], s54 offen lds
    v_mfma_f32_16x16x32_bf16 v[156:159], a[44:47], a[68:71], v[156:159]
    v_cvt_pk_bf16_f32 v123, v126, v127
    v_mfma_f32_16x16x32_bf16 v[156:159], a[40:43], a[64:67], v[156:159]
    v_mfma_f32_16x16x32_bf16 v[184:187], a[48:51], a[64:67], v[184:187]
    s_add_u32 m0, s29, 98304
    v_add_u32 v2, 0x80000, v2
    v_mfma_f32_16x16x32_bf16 v[184:187], a[52:55], a[68:71], v[184:187]
    buffer_load_dwordx4 v2, s[16:19], 0 offen lds
    v_mfma_f32_16x16x32_bf16 v[176:179], a[52:55], a[76:79], v[176:179]
    s_add_u32 s59, s58, 57344
    v_cvt_pk_bf16_f32 v128, v128, v129
    v_cvt_pk_bf16_f32 v129, v130, v131
    v_mfma_f32_16x16x32_bf16 v[176:179], a[48:51], a[72:75], v[176:179]
    buffer_store_dwordx4 v[32:35], v1, s[12:15], s59 offen offset:1024 sc1
    v_mfma_f32_16x16x32_bf16 v[168:171], a[48:51], a[80:83], v[168:171]
    v_cvt_pk_bf16_f32 v130, v132, v133
    v_cvt_pk_bf16_f32 v131, v134, v135
    v_mfma_f32_16x16x32_bf16 v[168:171], a[52:55], a[84:87], v[168:171]
    s_add_u32 m0, s29, 102400
    v_cvt_pk_bf16_f32 v136, v136, v137
    v_cvt_pk_bf16_f32 v137, v138, v139
    v_mfma_f32_16x16x32_bf16 v[160:163], a[52:55], a[92:95], v[160:163]
    buffer_load_dwordx4 v2, s[16:19], s48 offen lds
    v_mfma_f32_16x16x32_bf16 v[160:163], a[48:51], a[88:91], v[160:163]
    v_cvt_pk_bf16_f32 v138, v140, v141
    v_cvt_pk_bf16_f32 v139, v142, v143
    v_mfma_f32_16x16x32_bf16 v[164:167], a[56:59], a[88:91], v[164:167]
    v_cvt_pk_bf16_f32 v144, v144, v145
    v_cvt_pk_bf16_f32 v145, v146, v147
    v_mfma_f32_16x16x32_bf16 v[164:167], a[60:63], a[92:95], v[164:167]
    v_cvt_pk_bf16_f32 v146, v148, v149
    v_cvt_pk_bf16_f32 v147, v150, v151
    v_mfma_f32_16x16x32_bf16 v[172:175], a[60:63], a[84:87], v[172:175]
    s_add_u32 m0, s29, 106496
    v_cvt_pk_bf16_f32 v152, v152, v153
    v_cvt_pk_bf16_f32 v153, v154, v155
    v_mfma_f32_16x16x32_bf16 v[172:175], a[56:59], a[80:83], v[172:175]
    buffer_load_dwordx4 v2, s[16:19], s49 offen lds
    v_mfma_f32_16x16x32_bf16 v[180:183], a[56:59], a[72:75], v[180:183]
    s_add_u32 s59, s58, 49152
    v_cvt_pk_bf16_f32 v154, v156, v157
    v_cvt_pk_bf16_f32 v155, v158, v159
    v_mfma_f32_16x16x32_bf16 v[180:183], a[60:63], a[76:79], v[180:183]
    buffer_store_dwordx4 v[40:43], v1, s[12:15], s59 offen offset:1024 sc1
    v_mfma_f32_16x16x32_bf16 v[188:191], a[60:63], a[68:71], v[188:191]
    v_mfma_f32_16x16x32_bf16 v[188:191], a[56:59], a[64:67], v[188:191]
    s_add_u32 m0, s29, 110592
    v_mfma_f32_16x16x32_bf16 v[216:219], a[32:35], a[96:99], v[216:219]
    buffer_load_dwordx4 v2, s[16:19], s50 offen lds
    v_mfma_f32_16x16x32_bf16 v[216:219], a[36:39], a[100:103], v[216:219]
    v_cvt_pk_bf16_f32 v160, v160, v161
    v_cvt_pk_bf16_f32 v161, v162, v163
    v_mfma_f32_16x16x32_bf16 v[208:211], a[36:39], a[108:111], v[208:211]
    v_cvt_pk_bf16_f32 v162, v164, v165
    v_cvt_pk_bf16_f32 v163, v166, v167
    v_mfma_f32_16x16x32_bf16 v[208:211], a[32:35], a[104:107], v[208:211]
    v_cvt_pk_bf16_f32 v168, v168, v169
    v_cvt_pk_bf16_f32 v169, v170, v171
    v_mfma_f32_16x16x32_bf16 v[200:203], a[32:35], a[112:115], v[200:203]
    s_add_u32 m0, s29, 114688
    v_cvt_pk_bf16_f32 v170, v172, v173
    v_cvt_pk_bf16_f32 v171, v174, v175
    v_mfma_f32_16x16x32_bf16 v[200:203], a[36:39], a[116:119], v[200:203]
    buffer_load_dwordx4 v2, s[16:19], s51 offen lds
    v_mfma_f32_16x16x32_bf16 v[192:195], a[36:39], a[124:127], v[192:195]
    s_add_u32 s59, s58, 40960
    v_cvt_pk_bf16_f32 v176, v176, v177
    v_cvt_pk_bf16_f32 v177, v178, v179
    v_mfma_f32_16x16x32_bf16 v[192:195], a[32:35], a[120:123], v[192:195]
    buffer_store_dwordx4 v[48:51], v1, s[12:15], s59 offen offset:1024 sc1
    v_mfma_f32_16x16x32_bf16 v[196:199], a[40:43], a[120:123], v[196:199]
    v_cvt_pk_bf16_f32 v178, v180, v181
    v_cvt_pk_bf16_f32 v179, v182, v183
    v_mfma_f32_16x16x32_bf16 v[196:199], a[44:47], a[124:127], v[196:199]
    s_add_u32 m0, s29, 118784
    v_cvt_pk_bf16_f32 v184, v184, v185
    v_cvt_pk_bf16_f32 v185, v186, v187
    v_mfma_f32_16x16x32_bf16 v[204:207], a[44:47], a[116:119], v[204:207]
    buffer_load_dwordx4 v2, s[16:19], s52 offen lds
    v_mfma_f32_16x16x32_bf16 v[204:207], a[40:43], a[112:115], v[204:207]
    v_cvt_pk_bf16_f32 v186, v188, v189
    v_cvt_pk_bf16_f32 v187, v190, v191
    v_mfma_f32_16x16x32_bf16 v[212:215], a[40:43], a[104:107], v[212:215]
    v_mfma_f32_16x16x32_bf16 v[212:215], a[44:47], a[108:111], v[212:215]
    v_mfma_f32_16x16x32_bf16 v[220:223], a[44:47], a[100:103], v[220:223]
    s_add_u32 m0, s29, 122880
    v_mfma_f32_16x16x32_bf16 v[220:223], a[40:43], a[96:99], v[220:223]
    buffer_load_dwordx4 v2, s[16:19], s53 offen lds
    v_mfma_f32_16x16x32_bf16 v[248:251], a[48:51], a[96:99], v[248:251]
    s_add_u32 s59, s58, 32768
    v_mfma_f32_16x16x32_bf16 v[248:251], a[52:55], a[100:103], v[248:251]
    s_waitcnt vmcnt(22)
    buffer_store_dwordx4 v[56:59], v1, s[12:15], s59 offen offset:1024 sc1
    v_mfma_f32_16x16x32_bf16 v[240:243], a[52:55], a[108:111], v[240:243]
    s_barrier
    v_xor_b32 v7, 0, v6
    v_cvt_pk_bf16_f32 v192, v192, v193
    v_mfma_f32_16x16x32_bf16 v[240:243], a[48:51], a[104:107], v[240:243]
    s_add_u32 m0, s29, 126976
    ds_read_b64_tr_b16 a[64:65], v7 offset:0
    v_cvt_pk_bf16_f32 v193, v194, v195
    v_mfma_f32_16x16x32_bf16 v[232:235], a[48:51], a[112:115], v[232:235]
    ds_read_b64_tr_b16 a[66:67], v7 offset:4096
    buffer_load_dwordx4 v2, s[16:19], s54 offen lds
    v_mfma_f32_16x16x32_bf16 v[232:235], a[52:55], a[116:119], v[232:235]
    ds_read_b64_tr_b16 a[68:69], v7 offset:16384
    v_cvt_pk_bf16_f32 v194, v196, v197
    v_mfma_f32_16x16x32_bf16 v[224:227], a[52:55], a[124:127], v[224:227]
    ds_read_b64_tr_b16 a[70:71], v7 offset:20480
    v_xor_b32 v8, 65536, v6
    v_mfma_f32_16x16x32_bf16 v[224:227], a[48:51], a[120:123], v[224:227]
    ds_read_b64_tr_b16 a[72:73], v8 offset:0
    v_cvt_pk_bf16_f32 v195, v198, v199
    v_mfma_f32_16x16x32_bf16 v[228:231], a[56:59], a[120:123], v[228:231]
    s_add_u32 s59, s58, 24576
    ds_read_b64_tr_b16 a[74:75], v8 offset:4096
    v_cvt_pk_bf16_f32 v200, v200, v201
    v_mfma_f32_16x16x32_bf16 v[228:231], a[60:63], a[124:127], v[228:231]
    ds_read_b64_tr_b16 a[76:77], v8 offset:16384
    buffer_store_dwordx4 v[64:67], v1, s[12:15], s59 offen offset:0 sc1
    v_mfma_f32_16x16x32_bf16 v[236:239], a[60:63], a[116:119], v[236:239]
    ds_read_b64_tr_b16 a[78:79], v8 offset:20480
    v_xor_b32 v9, 32, v6
    v_mfma_f32_16x16x32_bf16 v[236:239], a[56:59], a[112:115], v[236:239]
    ds_read_b64_tr_b16 a[80:81], v9 offset:0
    v_cvt_pk_bf16_f32 v201, v202, v203
    v_mfma_f32_16x16x32_bf16 v[244:247], a[56:59], a[104:107], v[244:247]
    ds_read_b64_tr_b16 a[82:83], v9 offset:4096
    v_cvt_pk_bf16_f32 v202, v204, v205
    v_mfma_f32_16x16x32_bf16 v[244:247], a[60:63], a[108:111], v[244:247]
    ds_read_b64_tr_b16 a[84:85], v9 offset:16384
    v_cvt_pk_bf16_f32 v203, v206, v207
    v_mfma_f32_16x16x32_bf16 v[252:255], a[60:63], a[100:103], v[252:255]
    ds_read_b64_tr_b16 a[86:87], v9 offset:20480
    v_xor_b32 v10, 65568, v6
    v_mfma_f32_16x16x32_bf16 v[252:255], a[56:59], a[96:99], v[252:255]
    s_waitcnt lgkmcnt(6)
    ds_read_b64_tr_b16 a[88:89], v10 offset:0
    v_cvt_pk_bf16_f32 v208, v208, v209
    v_mfma_f32_16x16x32_bf16 v[28:31], a[64:67], a[128:131], 0
    ds_read_b64_tr_b16 a[90:91], v10 offset:4096
    v_cvt_pk_bf16_f32 v209, v210, v211
    v_mfma_f32_16x16x32_bf16 v[28:31], a[68:71], a[136:139], v[28:31]
    s_add_u32 s59, s58, 16384
    ds_read_b64_tr_b16 a[92:93], v10 offset:16384
    v_xor_b32 v7, 64, v6
    v_mfma_f32_16x16x32_bf16 v[28:31], a[72:75], a[144:147], v[28:31]
    s_waitcnt lgkmcnt(7)
    ds_read_b128 a[112:115], v14 offset:0
    ds_read_b64_tr_b16 a[94:95], v10 offset:20480
    buffer_store_dwordx4 v[72:75], v1, s[12:15], s59 offen offset:0 sc1
    v_mfma_f32_16x16x32_bf16 v[28:31], a[76:79], a[152:155], v[28:31]
    ds_read_b64_tr_b16 a[96:97], v7 offset:0
    v_cvt_pk_bf16_f32 v210, v212, v213
    v_mfma_f32_16x16x32_bf16 v[44:47], a[64:67], a[132:135], 0
    ds_read_b128 a[120:123], v3 offset:0
    ds_read_b64_tr_b16 a[98:99], v7 offset:4096
    v_mfma_f32_16x16x32_bf16 v[44:47], a[68:71], a[140:143], v[44:47]
    ds_read_b64_tr_b16 a[100:101], v7 offset:16384
    v_xor_b32 v8, 65600, v6
    v_mfma_f32_16x16x32_bf16 v[44:47], a[72:75], a[148:151], v[44:47]
    ds_read_b128 a[116:119], v14 offset:2048
    ds_read_b64_tr_b16 a[102:103], v7 offset:20480
    v_mfma_f32_16x16x32_bf16 v[44:47], a[76:79], a[156:159], v[44:47]
    s_waitcnt lgkmcnt(9)
    ds_read_b64_tr_b16 a[104:105], v8 offset:0
    v_cvt_pk_bf16_f32 v211, v214, v215
    v_mfma_f32_16x16x32_bf16 v[52:55], a[80:83], a[128:131], 0
    ds_read_b128 a[124:127], v3 offset:2048
    ds_read_b64_tr_b16 a[106:107], v8 offset:4096
    v_mfma_f32_16x16x32_bf16 v[52:55], a[84:87], a[136:139], v[52:55]
    s_add_u32 s59, s58, 8192
    ds_read_b64_tr_b16 a[108:109], v8 offset:16384
    v_cvt_pk_bf16_f32 v216, v216, v217
    v_mfma_f32_16x16x32_bf16 v[52:55], a[88:91], a[144:147], v[52:55]
    s_waitcnt lgkmcnt(10)
    ds_read_b64_tr_b16 a[110:111], v8 offset:20480
    v_xor_b32 v9, 96, v6
    v_mfma_f32_16x16x32_bf16 v[52:55], a[92:95], a[152:155], v[52:55]
    ds_read_b64_tr_b16 a[64:65], v9 offset:0
    buffer_store_dwordx4 v[80:83], v1, s[12:15], s59 offen offset:0 sc1
    v_mfma_f32_16x16x32_bf16 v[60:63], a[80:83], a[132:135], 0
    ds_read_b64_tr_b16 a[66:67], v9 offset:4096
    v_cvt_pk_bf16_f32 v217, v218, v219
    v_mfma_f32_16x16x32_bf16 v[60:63], a[84:87], a[140:143], v[60:63]
    ds_read_b64_tr_b16 a[68:69], v9 offset:16384
    v_cvt_pk_bf16_f32 v218, v220, v221
    v_mfma_f32_16x16x32_bf16 v[60:63], a[88:91], a[148:151], v[60:63]
    ds_read_b64_tr_b16 a[70:71], v9 offset:20480
    v_xor_b32 v10, 65632, v6
    v_mfma_f32_16x16x32_bf16 v[60:63], a[92:95], a[156:159], v[60:63]
    s_waitcnt lgkmcnt(6)
    ds_read_b64_tr_b16 a[72:73], v10 offset:0
    v_cvt_pk_bf16_f32 v219, v222, v223
    v_mfma_f32_16x16x32_bf16 v[20:23], a[96:99], a[128:131], 0
    ds_read_b64_tr_b16 a[74:75], v10 offset:4096
    v_cvt_pk_bf16_f32 v224, v224, v225
    v_mfma_f32_16x16x32_bf16 v[20:23], a[100:103], a[136:139], v[20:23]
    s_waitcnt lgkmcnt(8)
    ds_read_b64_tr_b16 a[76:77], v10 offset:16384
    v_xor_b32 v7, 128, v6
    v_mfma_f32_16x16x32_bf16 v[20:23], a[104:107], a[144:147], v[20:23]
    s_waitcnt lgkmcnt(7)
    s_barrier
    ds_read_b64_tr_b16 a[78:79], v10 offset:20480
    v_mfma_f32_16x16x32_bf16 v[20:23], a[108:111], a[152:155], v[20:23]
    s_add_u32 m0, s29, 131072
    ds_read_b64_tr_b16 a[80:81], v7 offset:0
    v_add_u32 v2, 0x80000, v2
    v_mfma_f32_16x16x32_bf16 v[36:39], a[96:99], a[132:135], 0
    ds_read_b64_tr_b16 a[82:83], v7 offset:4096
    buffer_load_dwordx4 v2, s[16:19], 0 offen lds
    v_mfma_f32_16x16x32_bf16 v[36:39], a[100:103], a[140:143], v[36:39]
    ds_read_b64_tr_b16 a[84:85], v7 offset:16384
    v_cvt_pk_bf16_f32 v225, v226, v227
    v_mfma_f32_16x16x32_bf16 v[36:39], a[104:107], a[148:151], v[36:39]
    s_add_u32 s59, s58, 0
    ds_read_b64_tr_b16 a[86:87], v7 offset:20480
    v_xor_b32 v8, 65664, v6
    v_mfma_f32_16x16x32_bf16 v[36:39], a[108:111], a[156:159], v[36:39]
    s_waitcnt lgkmcnt(6)
    ds_read_b64_tr_b16 a[88:89], v8 offset:0
    buffer_store_dwordx4 v[88:91], v1, s[12:15], s59 offen offset:0 sc1
    v_mfma_f32_16x16x32_bf16 v[68:71], a[64:67], a[128:131], 0
    ds_read_b64_tr_b16 a[90:91], v8 offset:4096
    v_cvt_pk_bf16_f32 v226, v228, v229
    v_mfma_f32_16x16x32_bf16 v[68:71], a[68:71], a[136:139], v[68:71]
    s_add_u32 m0, s29, 135168
    ds_read_b64_tr_b16 a[92:93], v8 offset:16384
    v_cvt_pk_bf16_f32 v227, v230, v231
    v_mfma_f32_16x16x32_bf16 v[68:71], a[72:75], a[144:147], v[68:71]
    s_waitcnt lgkmcnt(7)
    ds_read_b64_tr_b16 a[94:95], v8 offset:20480
    v_xor_b32 v9, 160, v6
    v_mfma_f32_16x16x32_bf16 v[68:71], a[76:79], a[152:155], v[68:71]
    ds_read_b64_tr_b16 a[96:97], v9 offset:0
    buffer_load_dwordx4 v2, s[16:19], s48 offen lds
    v_mfma_f32_16x16x32_bf16 v[76:79], a[64:67], a[132:135], 0
    ds_read_b64_tr_b16 a[98:99], v9 offset:4096
    v_cvt_pk_bf16_f32 v232, v232, v233
    v_mfma_f32_16x16x32_bf16 v[76:79], a[68:71], a[140:143], v[76:79]
    ds_read_b64_tr_b16 a[100:101], v9 offset:16384
    v_cvt_pk_bf16_f32 v233, v234, v235
    v_mfma_f32_16x16x32_bf16 v[76:79], a[72:75], a[148:151], v[76:79]
    s_add_u32 s59, s58, 24576
    ds_read_b64_tr_b16 a[102:103], v9 offset:20480
    v_xor_b32 v10, 65696, v6
    v_mfma_f32_16x16x32_bf16 v[76:79], a[76:79], a[156:159], v[76:79]
    s_waitcnt lgkmcnt(6)
    ds_read_b64_tr_b16 a[104:105], v10 offset:0
    buffer_store_dwordx4 v[96:99], v1, s[12:15], s59 offen offset:1024 sc1
    v_mfma_f32_16x16x32_bf16 v[84:87], a[80:83], a[128:131], 0
    s_add_u32 m0, s29, 139264
    ds_read_b64_tr_b16 a[106:107], v10 offset:4096
    v_cvt_pk_bf16_f32 v234, v236, v237
    v_mfma_f32_16x16x32_bf16 v[84:87], a[84:87], a[136:139], v[84:87]
    ds_read_b64_tr_b16 a[108:109], v10 offset:16384
    buffer_load_dwordx4 v2, s[16:19], s49 offen lds
    v_mfma_f32_16x16x32_bf16 v[84:87], a[88:91], a[144:147], v[84:87]
    s_waitcnt lgkmcnt(7)
    ds_read_b64_tr_b16 a[110:111], v10 offset:20480
    v_xor_b32 v7, 192, v6
    v_mfma_f32_16x16x32_bf16 v[84:87], a[92:95], a[152:155], v[84:87]
    ds_read_b64_tr_b16 a[64:65], v7 offset:0
    v_cvt_pk_bf16_f32 v235, v238, v239
    v_mfma_f32_16x16x32_bf16 v[92:95], a[80:83], a[132:135], 0
    ds_read_b64_tr_b16 a[66:67], v7 offset:4096
    v_cvt_pk_bf16_f32 v240, v240, v241
    v_mfma_f32_16x16x32_bf16 v[92:95], a[84:87], a[140:143], v[92:95]
    ds_read_b64_tr_b16 a[68:69], v7 offset:16384
    v_cvt_pk_bf16_f32 v241, v242, v243
    v_mfma_f32_16x16x32_bf16 v[92:95], a[88:91], a[148:151], v[92:95]
    s_add_u32 m0, s29, 143360
    ds_read_b64_tr_b16 a[70:71], v7 offset:20480
    v_xor_b32 v8, 65728, v6
    v_mfma_f32_16x16x32_bf16 v[92:95], a[92:95], a[156:159], v[92:95]
    s_waitcnt lgkmcnt(6)
    ds_read_b64_tr_b16 a[72:73], v8 offset:0
    buffer_load_dwordx4 v2, s[16:19], s50 offen lds
    v_mfma_f32_16x16x32_bf16 v[100:103], a[96:99], a[128:131], 0
    s_add_u32 s59, s58, 16384
    ds_read_b64_tr_b16 a[74:75], v8 offset:4096
    v_cvt_pk_bf16_f32 v242, v244, v245
    v_mfma_f32_16x16x32_bf16 v[100:103], a[100:103], a[136:139], v[100:103]
    ds_read_b64_tr_b16 a[76:77], v8 offset:16384
    buffer_store_dwordx4 v[104:107], v1, s[12:15], s59 offen offset:1024 sc1
    v_mfma_f32_16x16x32_bf16 v[100:103], a[104:107], a[144:147], v[100:103]
    s_waitcnt lgkmcnt(7)
    ds_read_b64_tr_b16 a[78:79], v8 offset:20480
    v_xor_b32 v9, 224, v6
    v_mfma_f32_16x16x32_bf16 v[100:103], a[108:111], a[152:155], v[100:103]
    s_and_b32 s36, s95, 31
    ds_read_b64_tr_b16 a[80:81], v9 offset:0
    v_cvt_pk_bf16_f32 v243, v246, v247
    v_mfma_f32_16x16x32_bf16 v[108:111], a[96:99], a[132:135], 0
    s_add_u32 m0, s29, 147456
    ds_read_b64_tr_b16 a[82:83], v9 offset:4096
    v_cvt_pk_bf16_f32 v248, v248, v249
    v_mfma_f32_16x16x32_bf16 v[108:111], a[100:103], a[140:143], v[108:111]
    ds_read_b64_tr_b16 a[84:85], v9 offset:16384
    buffer_load_dwordx4 v2, s[16:19], s51 offen lds
    v_mfma_f32_16x16x32_bf16 v[108:111], a[104:107], a[148:151], v[108:111]
    s_lshr_b32 s37, s95, 5
    ds_read_b64_tr_b16 a[86:87], v9 offset:20480
    v_xor_b32 v10, 65760, v6
    v_mfma_f32_16x16x32_bf16 v[108:111], a[108:111], a[156:159], v[108:111]
    s_waitcnt lgkmcnt(6)
    ds_read_b64_tr_b16 a[88:89], v10 offset:0
    v_cvt_pk_bf16_f32 v249, v250, v251
    v_mfma_f32_16x16x32_bf16 v[116:119], a[64:67], a[128:131], 0
    s_lshl_b32 s38, s3, 4
    ds_read_b64_tr_b16 a[90:91], v10 offset:4096
    v_cvt_pk_bf16_f32 v250, v252, v253
    v_mfma_f32_16x16x32_bf16 v[116:119], a[68:71], a[136:139], v[116:119]
    s_add_u32 m0, s29, 151552
    ds_read_b64_tr_b16 a[92:93], v10 offset:16384
    v_cvt_pk_bf16_f32 v251, v254, v255
    v_mfma_f32_16x16x32_bf16 v[116:119], a[72:75], a[144:147], v[116:119]
    s_waitcnt lgkmcnt(7)
    ds_read_b64_tr_b16 a[94:95], v10 offset:20480
    v_xor_b32 v7, 256, v6
    v_mfma_f32_16x16x32_bf16 v[116:119], a[76:79], a[152:155], v[116:119]
    ds_read_b64_tr_b16 a[96:97], v7 offset:0
    buffer_load_dwordx4 v2, s[16:19], s52 offen lds
    v_mfma_f32_16x16x32_bf16 v[124:127], a[64:67], a[132:135], 0
    s_add_u32 s59, s58, 8192
    ds_read_b64_tr_b16 a[98:99], v7 offset:4096
    v_accvgpr_read_b32 v11, a245
    v_mfma_f32_16x16x32_bf16 v[124:127], a[68:71], a[140:143], v[124:127]
    ds_read_b64_tr_b16 a[100:101], v7 offset:16384
    buffer_store_dwordx4 v[112:115], v1, s[12:15], s59 offen offset:1024 sc1
    v_mfma_f32_16x16x32_bf16 v[124:127], a[72:75], a[148:151], v[124:127]
    s_lshl_b32 s39, s36, 6
    ds_read_b64_tr_b16 a[102:103], v7 offset:20480
    v_xor_b32 v8, 65792, v6
    v_mfma_f32_16x16x32_bf16 v[124:127], a[76:79], a[156:159], v[124:127]
    s_waitcnt lgkmcnt(6)
    ds_read_b64_tr_b16 a[104:105], v8 offset:0
    v_mov_b32 v12, 0
    v_mfma_f32_16x16x32_bf16 v[132:135], a[80:83], a[128:131], 0
    s_add_u32 m0, s29, 155648
    ds_read_b64_tr_b16 a[106:107], v8 offset:4096
    v_mfma_f32_16x16x32_bf16 v[132:135], a[84:87], a[136:139], v[132:135]
    ds_read_b64_tr_b16 a[108:109], v8 offset:16384
    buffer_load_dwordx4 v2, s[16:19], s53 offen lds
    v_mfma_f32_16x16x32_bf16 v[132:135], a[88:91], a[144:147], v[132:135]
    s_waitcnt lgkmcnt(7)
    ds_read_b64_tr_b16 a[110:111], v8 offset:20480
    v_xor_b32 v9, 288, v6
    v_mfma_f32_16x16x32_bf16 v[132:135], a[92:95], a[152:155], v[132:135]
    ds_read_b64_tr_b16 a[64:65], v9 offset:0
    global_load_dword a248, v12, s[90:91] offset:128 sc1
    v_mfma_f32_16x16x32_bf16 v[140:143], a[80:83], a[132:135], 0
    s_add_u32 s59, s58, 0
    ds_read_b64_tr_b16 a[66:67], v9 offset:4096
    v_and_b32 v12, 15, v0
    v_mfma_f32_16x16x32_bf16 v[140:143], a[84:87], a[140:143], v[140:143]
    ds_read_b64_tr_b16 a[68:69], v9 offset:16384
    buffer_store_dwordx4 v[120:123], v1, s[12:15], s59 offen offset:1024 sc1
    v_mfma_f32_16x16x32_bf16 v[140:143], a[88:91], a[148:151], v[140:143]
    s_add_u32 m0, s29, 159744
    ds_read_b64_tr_b16 a[70:71], v9 offset:20480
    v_xor_b32 v10, 65824, v6
    v_mfma_f32_16x16x32_bf16 v[140:143], a[92:95], a[156:159], v[140:143]
    s_waitcnt lgkmcnt(6)
    ds_read_b64_tr_b16 a[72:73], v10 offset:0
    buffer_load_dwordx4 v2, s[16:19], s54 offen lds
    v_mfma_f32_16x16x32_bf16 v[148:151], a[96:99], a[128:131], 0
    s_add_u32 s38, s38, s39
    ds_read_b64_tr_b16 a[74:75], v10 offset:4096
    v_lshlrev_b32 v12, 2, v12
    v_mfma_f32_16x16x32_bf16 v[148:151], a[100:103], a[136:139], v[148:151]
    s_mul_i32 s38, s38, 896
    ds_read_b64_tr_b16 a[76:77], v10 offset:16384
    v_mfma_f32_16x16x32_bf16 v[148:151], a[104:107], a[144:147], v[148:151]
    s_waitcnt lgkmcnt(7)
    ds_read_b64_tr_b16 a[78:79], v10 offset:20480
    v_xor_b32 v7, 320, v6
    v_mfma_f32_16x16x32_bf16 v[148:151], a[108:111], a[152:155], v[148:151]
    s_lshl_b32 s39, s37, 7
    ds_read_b64_tr_b16 a[80:81], v7 offset:0
    v_mfma_f32_16x16x32_bf16 v[156:159], a[96:99], a[132:135], 0
    s_add_u32 s59, s58, 24576
    ds_read_b64_tr_b16 a[82:83], v7 offset:4096
    v_mfma_f32_16x16x32_bf16 v[156:159], a[100:103], a[140:143], v[156:159]
    ds_read_b64_tr_b16 a[84:85], v7 offset:16384
    buffer_store_dwordx4 v[128:131], v1, s[12:15], s59 offen offset:2048 sc1
    v_mfma_f32_16x16x32_bf16 v[156:159], a[104:107], a[148:151], v[156:159]
    s_add_u32 s38, s38, s39
    ds_read_b64_tr_b16 a[86:87], v7 offset:20480
    v_xor_b32 v8, 65856, v6
    v_mfma_f32_16x16x32_bf16 v[156:159], a[108:111], a[156:159], v[156:159]
    s_waitcnt lgkmcnt(6)
    ds_read_b64_tr_b16 a[88:89], v8 offset:0
    v_mfma_f32_16x16x32_bf16 v[164:167], a[64:67], a[128:131], 0
    s_lshl_b32 s39, s37, 9
    ds_read_b64_tr_b16 a[90:91], v8 offset:4096
    v_mfma_f32_16x16x32_bf16 v[164:167], a[68:71], a[136:139], v[164:167]
    s_mov_b32 s4, s66
    ds_read_b64_tr_b16 a[92:93], v8 offset:16384
    v_mfma_f32_16x16x32_bf16 v[164:167], a[72:75], a[144:147], v[164:167]
    s_waitcnt lgkmcnt(7)
    ds_read_b64_tr_b16 a[94:95], v8 offset:20480
    v_xor_b32 v9, 352, v6
    v_mfma_f32_16x16x32_bf16 v[164:167], a[76:79], a[152:155], v[164:167]
    s_mov_b32 s5, s67
    ds_read_b64_tr_b16 a[96:97], v9 offset:0
    v_mfma_f32_16x16x32_bf16 v[172:175], a[64:67], a[132:135], 0
    s_add_u32 s59, s58, 16384
    ds_read_b64_tr_b16 a[98:99], v9 offset:4096
    v_mfma_f32_16x16x32_bf16 v[172:175], a[68:71], a[140:143], v[172:175]
    ds_read_b64_tr_b16 a[100:101], v9 offset:16384
    buffer_store_dwordx4 v[136:139], v1, s[12:15], s59 offen offset:2048 sc1
    v_mfma_f32_16x16x32_bf16 v[172:175], a[72:75], a[148:151], v[172:175]
    s_mov_b32 s6, 1835008
    ds_read_b64_tr_b16 a[102:103], v9 offset:20480
    v_xor_b32 v10, 65888, v6
    v_mfma_f32_16x16x32_bf16 v[172:175], a[76:79], a[156:159], v[172:175]
    s_waitcnt lgkmcnt(6)
    ds_read_b64_tr_b16 a[104:105], v10 offset:0
    v_mfma_f32_16x16x32_bf16 v[180:183], a[80:83], a[128:131], 0
    s_mov_b32 s7, 0x20000
    ds_read_b64_tr_b16 a[106:107], v10 offset:4096
    v_mfma_f32_16x16x32_bf16 v[180:183], a[84:87], a[136:139], v[180:183]
    s_mov_b32 s8, s68
    ds_read_b64_tr_b16 a[108:109], v10 offset:16384
    v_mfma_f32_16x16x32_bf16 v[180:183], a[88:91], a[144:147], v[180:183]
    s_waitcnt lgkmcnt(7)
    ds_read_b64_tr_b16 a[110:111], v10 offset:20480
    v_xor_b32 v7, 384, v6
    v_mfma_f32_16x16x32_bf16 v[180:183], a[92:95], a[152:155], v[180:183]
    s_mov_b32 s9, s69
    ds_read_b64_tr_b16 a[64:65], v7 offset:0
    v_mfma_f32_16x16x32_bf16 v[188:191], a[80:83], a[132:135], 0
    s_add_u32 s59, s58, 8192
    ds_read_b64_tr_b16 a[66:67], v7 offset:4096
    v_mfma_f32_16x16x32_bf16 v[188:191], a[84:87], a[140:143], v[188:191]
    ds_read_b64_tr_b16 a[68:69], v7 offset:16384
    buffer_store_dwordx4 v[144:147], v1, s[12:15], s59 offen offset:2048 sc1
    v_mfma_f32_16x16x32_bf16 v[188:191], a[88:91], a[148:151], v[188:191]
    s_mov_b32 s10, 1835008
    ds_read_b64_tr_b16 a[70:71], v7 offset:20480
    v_xor_b32 v8, 65920, v6
    v_mfma_f32_16x16x32_bf16 v[188:191], a[92:95], a[156:159], v[188:191]
    s_waitcnt lgkmcnt(6)
    ds_read_b64_tr_b16 a[72:73], v8 offset:0
    v_mfma_f32_16x16x32_bf16 v[196:199], a[96:99], a[128:131], 0
    s_mov_b32 s11, 0x20000
    ds_read_b64_tr_b16 a[74:75], v8 offset:4096
    v_mfma_f32_16x16x32_bf16 v[196:199], a[100:103], a[136:139], v[196:199]
    s_mov_b32 s20, s70
    ds_read_b64_tr_b16 a[76:77], v8 offset:16384
    v_mfma_f32_16x16x32_bf16 v[196:199], a[104:107], a[144:147], v[196:199]
    s_waitcnt lgkmcnt(7)
    ds_read_b64_tr_b16 a[78:79], v8 offset:20480
    v_xor_b32 v9, 416, v6
    v_mfma_f32_16x16x32_bf16 v[196:199], a[108:111], a[152:155], v[196:199]
    s_mov_b32 s21, s71
    ds_read_b64_tr_b16 a[80:81], v9 offset:0
    v_mfma_f32_16x16x32_bf16 v[204:207], a[96:99], a[132:135], 0
    s_add_u32 s59, s58, 0
    ds_read_b64_tr_b16 a[82:83], v9 offset:4096
    v_mfma_f32_16x16x32_bf16 v[204:207], a[100:103], a[140:143], v[204:207]
    ds_read_b64_tr_b16 a[84:85], v9 offset:16384
    buffer_store_dwordx4 v[152:155], v1, s[12:15], s59 offen offset:2048 sc1
    v_mfma_f32_16x16x32_bf16 v[204:207], a[104:107], a[148:151], v[204:207]
    s_mov_b32 s22, 3584
    ds_read_b64_tr_b16 a[86:87], v9 offset:20480
    v_xor_b32 v10, 65952, v6
    v_mfma_f32_16x16x32_bf16 v[204:207], a[108:111], a[156:159], v[204:207]
    s_waitcnt lgkmcnt(6)
    ds_read_b64_tr_b16 a[88:89], v10 offset:0
    v_mfma_f32_16x16x32_bf16 v[212:215], a[64:67], a[128:131], 0
    s_mov_b32 s23, 0x20000
    ds_read_b64_tr_b16 a[90:91], v10 offset:4096
    v_mfma_f32_16x16x32_bf16 v[212:215], a[68:71], a[136:139], v[212:215]
    ds_read_b64_tr_b16 a[92:93], v10 offset:16384
    v_lshrrev_b32 v120, 3, v0
    v_mfma_f32_16x16x32_bf16 v[212:215], a[72:75], a[144:147], v[212:215]
    s_waitcnt lgkmcnt(7)
    ds_read_b64_tr_b16 a[94:95], v10 offset:20480
    v_xor_b32 v7, 448, v6
    v_mfma_f32_16x16x32_bf16 v[212:215], a[76:79], a[152:155], v[212:215]
    ds_read_b64_tr_b16 a[96:97], v7 offset:0
    v_mul_u32_u24 v120, 1792, v120
    v_mfma_f32_16x16x32_bf16 v[220:223], a[64:67], a[132:135], 0
    s_add_u32 s59, s58, 24576
    ds_read_b64_tr_b16 a[98:99], v7 offset:4096
    v_and_b32 v121, 7, v0
    v_mfma_f32_16x16x32_bf16 v[220:223], a[68:71], a[140:143], v[220:223]
    ds_read_b64_tr_b16 a[100:101], v7 offset:16384
    buffer_store_dwordx4 v[160:163], v1, s[12:15], s59 offen offset:3072 sc1
    v_mfma_f32_16x16x32_bf16 v[220:223], a[72:75], a[148:151], v[220:223]
    ds_read_b64_tr_b16 a[102:103], v7 offset:20480
    v_xor_b32 v8, 65984, v6
    v_mfma_f32_16x16x32_bf16 v[220:223], a[76:79], a[156:159], v[220:223]
    s_waitcnt lgkmcnt(6)
    ds_read_b64_tr_b16 a[104:105], v8 offset:0
    v_lshl_add_u32 v120, v121, 4, v120
    v_mfma_f32_16x16x32_bf16 v[228:231], a[80:83], a[128:131], 0
    ds_read_b64_tr_b16 a[106:107], v8 offset:4096
    v_add_u32 v120, s38, v120
    v_mfma_f32_16x16x32_bf16 v[228:231], a[84:87], a[136:139], v[228:231]
    ds_read_b64_tr_b16 a[108:109], v8 offset:16384
    v_lshlrev_b32 v121, 6, v121
    v_mfma_f32_16x16x32_bf16 v[228:231], a[88:91], a[144:147], v[228:231]
    s_waitcnt lgkmcnt(7)
    ds_read_b64_tr_b16 a[110:111], v8 offset:20480
    v_xor_b32 v9, 480, v6
    v_mfma_f32_16x16x32_bf16 v[228:231], a[92:95], a[152:155], v[228:231]
    ds_read_b64_tr_b16 a[64:65], v9 offset:0
    v_subrev_u32 v122, 2688, v120
    v_mfma_f32_16x16x32_bf16 v[236:239], a[80:83], a[132:135], 0
    s_add_u32 s59, s58, 16384
    ds_read_b64_tr_b16 a[66:67], v9 offset:4096
    v_subrev_u32 v123, 1792, v120
    v_mfma_f32_16x16x32_bf16 v[236:239], a[84:87], a[140:143], v[236:239]
    ds_read_b64_tr_b16 a[68:69], v9 offset:16384
    buffer_store_dwordx4 v[168:171], v1, s[12:15], s59 offen offset:3072 sc1
    v_mfma_f32_16x16x32_bf16 v[236:239], a[88:91], a[148:151], v[236:239]
    ds_read_b64_tr_b16 a[70:71], v9 offset:20480
    v_xor_b32 v10, 66016, v6
    v_mfma_f32_16x16x32_bf16 v[236:239], a[92:95], a[156:159], v[236:239]
    s_waitcnt lgkmcnt(6)
    ds_read_b64_tr_b16 a[72:73], v10 offset:0
    v_subrev_u32 v128, 896, v120
    v_mfma_f32_16x16x32_bf16 v[244:247], a[96:99], a[128:131], 0
    ds_read_b64_tr_b16 a[74:75], v10 offset:4096
    v_mfma_f32_16x16x32_bf16 v[244:247], a[100:103], a[136:139], v[244:247]
    s_waitcnt vmcnt(23)
    ds_read_b64_tr_b16 a[76:77], v10 offset:16384
    v_xor_b32 v7, 32768, v6
    v_mfma_f32_16x16x32_bf16 v[244:247], a[104:107], a[144:147], v[244:247]
    s_waitcnt lgkmcnt(7)
    s_barrier
    ds_read_b64_tr_b16 a[78:79], v10 offset:20480
    v_mfma_f32_16x16x32_bf16 v[244:247], a[108:111], a[152:155], v[244:247]
    ds_read_b64_tr_b16 a[80:81], v7 offset:0
    v_mfma_f32_16x16x32_bf16 v[252:255], a[96:99], a[132:135], 0
    s_add_u32 s59, s58, 8192
    ds_read_b64_tr_b16 a[82:83], v7 offset:4096
    v_mfma_f32_16x16x32_bf16 v[252:255], a[100:103], a[140:143], v[252:255]
    ds_read_b64_tr_b16 a[84:85], v7 offset:16384
    buffer_store_dwordx4 v[176:179], v1, s[12:15], s59 offen offset:3072 sc1
    v_mfma_f32_16x16x32_bf16 v[252:255], a[104:107], a[148:151], v[252:255]
    ds_read_b64_tr_b16 a[86:87], v7 offset:20480
    v_xor_b32 v8, 98304, v6
    v_mfma_f32_16x16x32_bf16 v[252:255], a[108:111], a[156:159], v[252:255]
    s_waitcnt lgkmcnt(6)
    ds_read_b64_tr_b16 a[88:89], v8 offset:0
    v_mfma_f32_16x16x32_bf16 v[16:19], a[64:67], a[128:131], 0
    ds_read_b64_tr_b16 a[90:91], v8 offset:4096
    v_mfma_f32_16x16x32_bf16 v[16:19], a[68:71], a[136:139], v[16:19]
    ds_read_b64_tr_b16 a[92:93], v8 offset:16384
    v_mfma_f32_16x16x32_bf16 v[16:19], a[72:75], a[144:147], v[16:19]
    s_waitcnt lgkmcnt(7)
    ds_read_b64_tr_b16 a[94:95], v8 offset:20480
    v_xor_b32 v9, 32800, v6
    v_mfma_f32_16x16x32_bf16 v[16:19], a[76:79], a[152:155], v[16:19]
    ds_read_b64_tr_b16 a[96:97], v9 offset:0
    v_mfma_f32_16x16x32_bf16 v[24:27], a[64:67], a[132:135], 0
    s_waitcnt lgkmcnt(9)
    ds_read_b64_tr_b16 a[98:99], v9 offset:4096
    v_mfma_f32_16x16x32_bf16 v[24:27], a[68:71], a[140:143], v[24:27]
    s_barrier
    ds_read_b64_tr_b16 a[100:101], v9 offset:16384
    v_mfma_f32_16x16x32_bf16 v[24:27], a[72:75], a[148:151], v[24:27]
    s_add_u32 m0, s29, 0
    ds_read_b64_tr_b16 a[102:103], v9 offset:20480
    v_xor_b32 v10, 98336, v6
    v_mfma_f32_16x16x32_bf16 v[24:27], a[76:79], a[156:159], v[24:27]
    s_waitcnt lgkmcnt(6)
    ds_read_b64_tr_b16 a[104:105], v10 offset:0
    v_add_u32 v2, 0x80000, v2
    v_mfma_f32_16x16x32_bf16 v[28:31], a[80:83], a[160:163], v[28:31]
    ds_read_b64_tr_b16 a[106:107], v10 offset:4096
    buffer_load_dwordx4 v2, s[16:19], 0 offen lds
    v_mfma_f32_16x16x32_bf16 v[28:31], a[84:87], a[168:171], v[28:31]
    s_add_u32 s59, s58, 0
    ds_read_b64_tr_b16 a[108:109], v10 offset:16384
    v_mfma_f32_16x16x32_bf16 v[28:31], a[88:91], a[176:179], v[28:31]
    s_waitcnt lgkmcnt(7)
    ds_read_b64_tr_b16 a[110:111], v10 offset:20480
    v_xor_b32 v7, 32832, v6
    v_mfma_f32_16x16x32_bf16 v[28:31], a[92:95], a[184:187], v[28:31]
    ds_read_b64_tr_b16 a[64:65], v7 offset:0
    buffer_store_dwordx4 v[184:187], v1, s[12:15], s59 offen offset:3072 sc1
    v_mfma_f32_16x16x32_bf16 v[44:47], a[80:83], a[164:167], v[44:47]
    s_add_u32 m0, s29, 4096
    ds_read_b64_tr_b16 a[66:67], v7 offset:4096
    v_mfma_f32_16x16x32_bf16 v[44:47], a[84:87], a[172:175], v[44:47]
    ds_read_b64_tr_b16 a[68:69], v7 offset:16384
    buffer_load_dwordx4 v2, s[16:19], s48 offen lds
    v_mfma_f32_16x16x32_bf16 v[44:47], a[88:91], a[180:183], v[44:47]
    ds_read_b64_tr_b16 a[70:71], v7 offset:20480
    v_xor_b32 v8, 98368, v6
    v_mfma_f32_16x16x32_bf16 v[44:47], a[92:95], a[188:191], v[44:47]
    s_waitcnt lgkmcnt(6)
    ds_read_b64_tr_b16 a[72:73], v8 offset:0
    v_mfma_f32_16x16x32_bf16 v[52:55], a[96:99], a[160:163], v[52:55]
    ds_read_b64_tr_b16 a[74:75], v8 offset:4096
    v_mfma_f32_16x16x32_bf16 v[52:55], a[100:103], a[168:171], v[52:55]
    s_add_u32 m0, s29, 8192
    ds_read_b64_tr_b16 a[76:77], v8 offset:16384
    v_mfma_f32_16x16x32_bf16 v[52:55], a[104:107], a[176:179], v[52:55]
    s_waitcnt lgkmcnt(7)
    ds_read_b64_tr_b16 a[78:79], v8 offset:20480
    v_xor_b32 v9, 32864, v6
    v_mfma_f32_16x16x32_bf16 v[52:55], a[108:111], a[184:187], v[52:55]
    ds_read_b64_tr_b16 a[80:81], v9 offset:0
    buffer_load_dwordx4 v2, s[16:19], s49 offen lds
    v_mfma_f32_16x16x32_bf16 v[60:63], a[96:99], a[164:167], v[60:63]
    s_add_u32 s59, s58, 57344
    ds_read_b64_tr_b16 a[82:83], v9 offset:4096
    v_mfma_f32_16x16x32_bf16 v[60:63], a[100:103], a[172:175], v[60:63]
    ds_read_b64_tr_b16 a[84:85], v9 offset:16384
    buffer_store_dwordx4 v[192:195], v1, s[12:15], s59 offen offset:2048 sc1
    v_mfma_f32_16x16x32_bf16 v[60:63], a[104:107], a[180:183], v[60:63]
    s_add_u32 m0, s29, 12288
    ds_read_b64_tr_b16 a[86:87], v9 offset:20480
    v_xor_b32 v10, 98400, v6
    v_mfma_f32_16x16x32_bf16 v[60:63], a[108:111], a[188:191], v[60:63]
    s_waitcnt lgkmcnt(6)
    ds_read_b64_tr_b16 a[88:89], v10 offset:0
    v_mfma_f32_16x16x32_bf16 v[20:23], a[64:67], a[160:163], v[20:23]
    ds_read_b64_tr_b16 a[90:91], v10 offset:4096
    buffer_load_dwordx4 v2, s[16:19], s50 offen lds
    v_mfma_f32_16x16x32_bf16 v[20:23], a[68:71], a[168:171], v[20:23]
    ds_read_b64_tr_b16 a[92:93], v10 offset:16384
    v_mfma_f32_16x16x32_bf16 v[20:23], a[72:75], a[176:179], v[20:23]
    s_waitcnt lgkmcnt(7)
    ds_read_b64_tr_b16 a[94:95], v10 offset:20480
    v_xor_b32 v7, 32896, v6
    v_mfma_f32_16x16x32_bf16 v[20:23], a[76:79], a[184:187], v[20:23]
    ds_read_b64_tr_b16 a[96:97], v7 offset:0
    v_mfma_f32_16x16x32_bf16 v[36:39], a[64:67], a[164:167], v[36:39]
    s_add_u32 m0, s29, 16384
    ds_read_b64_tr_b16 a[98:99], v7 offset:4096
    v_mfma_f32_16x16x32_bf16 v[36:39], a[68:71], a[172:175], v[36:39]
    ds_read_b64_tr_b16 a[100:101], v7 offset:16384
    buffer_load_dwordx4 v2, s[16:19], s51 offen lds
    v_mfma_f32_16x16x32_bf16 v[36:39], a[72:75], a[180:183], v[36:39]
    s_add_u32 s59, s58, 49152
    ds_read_b64_tr_b16 a[102:103], v7 offset:20480
    v_xor_b32 v8, 98432, v6
    v_mfma_f32_16x16x32_bf16 v[36:39], a[76:79], a[188:191], v[36:39]
    s_waitcnt lgkmcnt(6)
    ds_read_b64_tr_b16 a[104:105], v8 offset:0
    buffer_store_dwordx4 v[200:203], v1, s[12:15], s59 offen offset:2048 sc1
    v_mfma_f32_16x16x32_bf16 v[68:71], a[80:83], a[160:163], v[68:71]
    ds_read_b64_tr_b16 a[106:107], v8 offset:4096
    v_mfma_f32_16x16x32_bf16 v[68:71], a[84:87], a[168:171], v[68:71]
    s_add_u32 m0, s29, 20480
    ds_read_b64_tr_b16 a[108:109], v8 offset:16384
    v_mfma_f32_16x16x32_bf16 v[68:71], a[88:91], a[176:179], v[68:71]
    s_waitcnt lgkmcnt(7)
    ds_read_b64_tr_b16 a[110:111], v8 offset:20480
    v_xor_b32 v9, 32928, v6
    v_mfma_f32_16x16x32_bf16 v[68:71], a[92:95], a[184:187], v[68:71]
    ds_read_b64_tr_b16 a[64:65], v9 offset:0
    buffer_load_dwordx4 v2, s[16:19], s52 offen lds
    v_mfma_f32_16x16x32_bf16 v[76:79], a[80:83], a[164:167], v[76:79]
    ds_read_b64_tr_b16 a[66:67], v9 offset:4096
    v_mfma_f32_16x16x32_bf16 v[76:79], a[84:87], a[172:175], v[76:79]
    ds_read_b64_tr_b16 a[68:69], v9 offset:16384
    v_mfma_f32_16x16x32_bf16 v[76:79], a[88:91], a[180:183], v[76:79]
    s_add_u32 m0, s29, 24576
    ds_read_b64_tr_b16 a[70:71], v9 offset:20480
    v_xor_b32 v10, 98464, v6
    v_mfma_f32_16x16x32_bf16 v[76:79], a[92:95], a[188:191], v[76:79]
    s_waitcnt lgkmcnt(6)
    ds_read_b64_tr_b16 a[72:73], v10 offset:0
    v_mfma_f32_16x16x32_bf16 v[84:87], a[96:99], a[160:163], v[84:87]
    ds_read_b64_tr_b16 a[74:75], v10 offset:4096
    buffer_load_dwordx4 v2, s[16:19], s53 offen lds
    v_mfma_f32_16x16x32_bf16 v[84:87], a[100:103], a[168:171], v[84:87]
    s_add_u32 s59, s58, 40960
    ds_read_b64_tr_b16 a[76:77], v10 offset:16384
    v_mfma_f32_16x16x32_bf16 v[84:87], a[104:107], a[176:179], v[84:87]
    s_waitcnt lgkmcnt(7)
    ds_read_b64_tr_b16 a[78:79], v10 offset:20480
    v_xor_b32 v7, 32960, v6
    v_mfma_f32_16x16x32_bf16 v[84:87], a[108:111], a[184:187], v[84:87]
    ds_read_b64_tr_b16 a[80:81], v7 offset:0
    buffer_store_dwordx4 v[208:211], v1, s[12:15], s59 offen offset:2048 sc1
    v_mfma_f32_16x16x32_bf16 v[92:95], a[96:99], a[164:167], v[92:95]
    s_add_u32 m0, s29, 28672
    ds_read_b64_tr_b16 a[82:83], v7 offset:4096
    v_mfma_f32_16x16x32_bf16 v[92:95], a[100:103], a[172:175], v[92:95]
    ds_read_b64_tr_b16 a[84:85], v7 offset:16384
    buffer_load_dwordx4 v2, s[16:19], s54 offen lds
    v_mfma_f32_16x16x32_bf16 v[92:95], a[104:107], a[180:183], v[92:95]
    ds_read_b64_tr_b16 a[86:87], v7 offset:20480
    v_xor_b32 v8, 98496, v6
    v_mfma_f32_16x16x32_bf16 v[92:95], a[108:111], a[188:191], v[92:95]
    s_waitcnt lgkmcnt(6)
    ds_read_b64_tr_b16 a[88:89], v8 offset:0
    v_mfma_f32_16x16x32_bf16 v[100:103], a[64:67], a[160:163], v[100:103]
    s_add_u32 m0, s29, 65536
    ds_read_b64_tr_b16 a[90:91], v8 offset:4096
    v_add_u32 v2, 0x80000, v2
    v_mfma_f32_16x16x32_bf16 v[100:103], a[68:71], a[168:171], v[100:103]
    ds_read_b64_tr_b16 a[92:93], v8 offset:16384
    buffer_load_dwordx4 v2, s[16:19], 0 offen lds
    v_mfma_f32_16x16x32_bf16 v[100:103], a[72:75], a[176:179], v[100:103]
    s_waitcnt lgkmcnt(7)
    ds_read_b64_tr_b16 a[94:95], v8 offset:20480
    v_xor_b32 v9, 32992, v6
    v_mfma_f32_16x16x32_bf16 v[100:103], a[76:79], a[184:187], v[100:103]
    s_add_u32 s59, s58, 32768
    ds_read_b64_tr_b16 a[96:97], v9 offset:0
    v_mfma_f32_16x16x32_bf16 v[108:111], a[64:67], a[164:167], v[108:111]
    ds_read_b64_tr_b16 a[98:99], v9 offset:4096
    buffer_store_dwordx4 v[216:219], v1, s[12:15], s59 offen offset:2048 sc1
    v_mfma_f32_16x16x32_bf16 v[108:111], a[68:71], a[172:175], v[108:111]
    ds_read_b64_tr_b16 a[100:101], v9 offset:16384
    v_mfma_f32_16x16x32_bf16 v[108:111], a[72:75], a[180:183], v[108:111]
    s_add_u32 m0, s29, 69632
    ds_read_b64_tr_b16 a[102:103], v9 offset:20480
    v_xor_b32 v10, 98528, v6
    v_mfma_f32_16x16x32_bf16 v[108:111], a[76:79], a[188:191], v[108:111]
    s_waitcnt lgkmcnt(6)
    ds_read_b64_tr_b16 a[104:105], v10 offset:0
    buffer_load_dwordx4 v2, s[16:19], s48 offen lds
    v_mfma_f32_16x16x32_bf16 v[116:119], a[80:83], a[160:163], v[116:119]
    ds_read_b64_tr_b16 a[106:107], v10 offset:4096
    v_mfma_f32_16x16x32_bf16 v[116:119], a[84:87], a[168:171], v[116:119]
    ds_read_b64_tr_b16 a[108:109], v10 offset:16384
    v_mfma_f32_16x16x32_bf16 v[116:119], a[88:91], a[176:179], v[116:119]
    s_waitcnt lgkmcnt(7)
    ds_read_b64_tr_b16 a[110:111], v10 offset:20480
    v_xor_b32 v7, 33024, v6
    v_mfma_f32_16x16x32_bf16 v[116:119], a[92:95], a[184:187], v[116:119]
    s_add_u32 m0, s29, 73728
    ds_read_b64_tr_b16 a[64:65], v7 offset:0
    v_mfma_f32_16x16x32_bf16 v[124:127], a[80:83], a[164:167], v[124:127]
    ds_read_b64_tr_b16 a[66:67], v7 offset:4096
    buffer_load_dwordx4 v2, s[16:19], s49 offen lds
    v_mfma_f32_16x16x32_bf16 v[124:127], a[84:87], a[172:175], v[124:127]
    ds_read_b64_tr_b16 a[68:69], v7 offset:16384
    v_mfma_f32_16x16x32_bf16 v[124:127], a[88:91], a[180:183], v[124:127]
    s_add_u32 s59, s58, 57344
    ds_read_b64_tr_b16 a[70:71], v7 offset:20480
    v_xor_b32 v8, 98560, v6
    v_mfma_f32_16x16x32_bf16 v[124:127], a[92:95], a[188:191], v[124:127]
    s_waitcnt lgkmcnt(6)
    ds_read_b64_tr_b16 a[72:73], v8 offset:0
    buffer_store_dwordx4 v[224:227], v1, s[12:15], s59 offen offset:3072 sc1
    v_mfma_f32_16x16x32_bf16 v[132:135], a[96:99], a[160:163], v[132:135]
    s_add_u32 m0, s29, 77824
    ds_read_b64_tr_b16 a[74:75], v8 offset:4096
    v_mfma_f32_16x16x32_bf16 v[132:135], a[100:103], a[168:171], v[132:135]
    ds_read_b64_tr_b16 a[76:77], v8 offset:16384
    buffer_load_dwordx4 v2, s[16:19], s50 offen lds
    v_mfma_f32_16x16x32_bf16 v[132:135], a[104:107], a[176:179], v[132:135]
    s_waitcnt lgkmcnt(7)
    ds_read_b64_tr_b16 a[78:79], v8 offset:20480
    v_xor_b32 v9, 33056, v6
    v_mfma_f32_16x16x32_bf16 v[132:135], a[108:111], a[184:187], v[132:135]
    ds_read_b64_tr_b16 a[80:81], v9 offset:0
    v_mfma_f32_16x16x32_bf16 v[140:143], a[96:99], a[164:167], v[140:143]
    ds_read_b64_tr_b16 a[82:83], v9 offset:4096
    v_mfma_f32_16x16x32_bf16 v[140:143], a[100:103], a[172:175], v[140:143]
    ds_read_b64_tr_b16 a[84:85], v9 offset:16384
    v_mfma_f32_16x16x32_bf16 v[140:143], a[104:107], a[180:183], v[140:143]
    s_add_u32 m0, s29, 81920
    ds_read_b64_tr_b16 a[86:87], v9 offset:20480
    v_xor_b32 v10, 98592, v6
    v_mfma_f32_16x16x32_bf16 v[140:143], a[108:111], a[188:191], v[140:143]
    s_waitcnt lgkmcnt(6)
    ds_read_b64_tr_b16 a[88:89], v10 offset:0
    buffer_load_dwordx4 v2, s[16:19], s51 offen lds
    v_mfma_f32_16x16x32_bf16 v[148:151], a[64:67], a[160:163], v[148:151]
    s_add_u32 s59, s58, 49152
    ds_read_b64_tr_b16 a[90:91], v10 offset:4096
    v_mfma_f32_16x16x32_bf16 v[148:151], a[68:71], a[168:171], v[148:151]
    ds_read_b64_tr_b16 a[92:93], v10 offset:16384
    buffer_store_dwordx4 v[232:235], v1, s[12:15], s59 offen offset:3072 sc1
    v_mfma_f32_16x16x32_bf16 v[148:151], a[72:75], a[176:179], v[148:151]
    s_waitcnt lgkmcnt(7)
    ds_read_b64_tr_b16 a[94:95], v10 offset:20480
    v_xor_b32 v7, 33088, v6
    v_mfma_f32_16x16x32_bf16 v[148:151], a[76:79], a[184:187], v[148:151]
    s_add_u32 m0, s29, 86016
    ds_read_b64_tr_b16 a[96:97], v7 offset:0
    v_mfma_f32_16x16x32_bf16 v[156:159], a[64:67], a[164:167], v[156:159]
    ds_read_b64_tr_b16 a[98:99], v7 offset:4096
    buffer_load_dwordx4 v2, s[16:19], s52 offen lds
    v_mfma_f32_16x16x32_bf16 v[156:159], a[68:71], a[172:175], v[156:159]
    ds_read_b64_tr_b16 a[100:101], v7 offset:16384
    v_mfma_f32_16x16x32_bf16 v[156:159], a[72:75], a[180:183], v[156:159]
    ds_read_b64_tr_b16 a[102:103], v7 offset:20480
    v_xor_b32 v8, 98624, v6
    v_mfma_f32_16x16x32_bf16 v[156:159], a[76:79], a[188:191], v[156:159]
    s_waitcnt lgkmcnt(6)
    ds_read_b64_tr_b16 a[104:105], v8 offset:0
    v_mfma_f32_16x16x32_bf16 v[164:167], a[80:83], a[160:163], v[164:167]
    s_add_u32 m0, s29, 90112
    ds_read_b64_tr_b16 a[106:107], v8 offset:4096
    v_mfma_f32_16x16x32_bf16 v[164:167], a[84:87], a[168:171], v[164:167]
    ds_read_b64_tr_b16 a[108:109], v8 offset:16384
    buffer_load_dwordx4 v2, s[16:19], s53 offen lds
    v_mfma_f32_16x16x32_bf16 v[164:167], a[88:91], a[176:179], v[164:167]
    s_waitcnt lgkmcnt(7)
    ds_read_b64_tr_b16 a[110:111], v8 offset:20480
    v_xor_b32 v9, 33120, v6
    v_mfma_f32_16x16x32_bf16 v[164:167], a[92:95], a[184:187], v[164:167]
    s_add_u32 s59, s58, 40960
    ds_read_b64_tr_b16 a[64:65], v9 offset:0
    v_mfma_f32_16x16x32_bf16 v[172:175], a[80:83], a[164:167], v[172:175]
    ds_read_b64_tr_b16 a[66:67], v9 offset:4096
    buffer_store_dwordx4 v[240:243], v1, s[12:15], s59 offen offset:3072 sc1
    v_mfma_f32_16x16x32_bf16 v[172:175], a[84:87], a[172:175], v[172:175]
    ds_read_b64_tr_b16 a[68:69], v9 offset:16384
    v_mfma_f32_16x16x32_bf16 v[172:175], a[88:91], a[180:183], v[172:175]
    s_add_u32 m0, s29, 94208
    ds_read_b64_tr_b16 a[70:71], v9 offset:20480
    v_xor_b32 v10, 98656, v6
    v_mfma_f32_16x16x32_bf16 v[172:175], a[92:95], a[188:191], v[172:175]
    s_waitcnt lgkmcnt(6)
    ds_read_b64_tr_b16 a[72:73], v10 offset:0
    buffer_load_dwordx4 v2, s[16:19], s54 offen lds
    v_mfma_f32_16x16x32_bf16 v[180:183], a[96:99], a[160:163], v[180:183]
    ds_read_b64_tr_b16 a[74:75], v10 offset:4096
    v_mfma_f32_16x16x32_bf16 v[180:183], a[100:103], a[168:171], v[180:183]
    ds_read_b64_tr_b16 a[76:77], v10 offset:16384
    v_mfma_f32_16x16x32_bf16 v[180:183], a[104:107], a[176:179], v[180:183]
    s_waitcnt lgkmcnt(7)
    ds_read_b64_tr_b16 a[78:79], v10 offset:20480
    v_xor_b32 v7, 33152, v6
    v_mfma_f32_16x16x32_bf16 v[180:183], a[108:111], a[184:187], v[180:183]
    s_add_u32 s59, s58, 32768
    ds_read_b64_tr_b16 a[80:81], v7 offset:0
    v_mfma_f32_16x16x32_bf16 v[188:191], a[96:99], a[164:167], v[188:191]
    ds_read_b64_tr_b16 a[82:83], v7 offset:4096
    buffer_store_dwordx4 v[248:251], v1, s[12:15], s59 offen offset:3072 sc1
    v_mfma_f32_16x16x32_bf16 v[188:191], a[100:103], a[172:175], v[188:191]
    ds_read_b64_tr_b16 a[84:85], v7 offset:16384
    v_mfma_f32_16x16x32_bf16 v[188:191], a[104:107], a[180:183], v[188:191]
    ds_read_b64_tr_b16 a[86:87], v7 offset:20480
    v_xor_b32 v8, 98688, v6
    v_mfma_f32_16x16x32_bf16 v[188:191], a[108:111], a[188:191], v[188:191]
    s_waitcnt lgkmcnt(6)
    ds_read_b64_tr_b16 a[88:89], v8 offset:0
    v_mfma_f32_16x16x32_bf16 v[196:199], a[64:67], a[160:163], v[196:199]
    ds_read_b64_tr_b16 a[90:91], v8 offset:4096
    v_mfma_f32_16x16x32_bf16 v[196:199], a[68:71], a[168:171], v[196:199]
    ds_read_b64_tr_b16 a[92:93], v8 offset:16384
    v_mfma_f32_16x16x32_bf16 v[196:199], a[72:75], a[176:179], v[196:199]
    s_waitcnt lgkmcnt(7)
    ds_read_b64_tr_b16 a[94:95], v8 offset:20480
    v_xor_b32 v9, 33184, v6
    v_mfma_f32_16x16x32_bf16 v[196:199], a[76:79], a[184:187], v[196:199]
    ds_read_b64_tr_b16 a[96:97], v9 offset:0
    v_mfma_f32_16x16x32_bf16 v[204:207], a[64:67], a[164:167], v[204:207]
    ds_read_b64_tr_b16 a[98:99], v9 offset:4096
    v_mfma_f32_16x16x32_bf16 v[204:207], a[68:71], a[172:175], v[204:207]
    ds_read_b64_tr_b16 a[100:101], v9 offset:16384
    v_mfma_f32_16x16x32_bf16 v[204:207], a[72:75], a[180:183], v[204:207]
    ds_read_b64_tr_b16 a[102:103], v9 offset:20480
    v_xor_b32 v10, 98720, v6
    v_mfma_f32_16x16x32_bf16 v[204:207], a[76:79], a[188:191], v[204:207]
    s_waitcnt lgkmcnt(6)
    ds_read_b64_tr_b16 a[104:105], v10 offset:0
    v_mfma_f32_16x16x32_bf16 v[212:215], a[80:83], a[160:163], v[212:215]
    ds_read_b64_tr_b16 a[106:107], v10 offset:4096
    v_mfma_f32_16x16x32_bf16 v[212:215], a[84:87], a[168:171], v[212:215]
    ds_read_b64_tr_b16 a[108:109], v10 offset:16384
    v_mfma_f32_16x16x32_bf16 v[212:215], a[88:91], a[176:179], v[212:215]
    s_waitcnt lgkmcnt(7)
    ds_read_b64_tr_b16 a[110:111], v10 offset:20480
    v_xor_b32 v7, 33216, v6
    v_mfma_f32_16x16x32_bf16 v[212:215], a[92:95], a[184:187], v[212:215]
    ds_read_b64_tr_b16 a[64:65], v7 offset:0
    v_mfma_f32_16x16x32_bf16 v[220:223], a[80:83], a[164:167], v[220:223]
    ds_read_b64_tr_b16 a[66:67], v7 offset:4096
    v_mfma_f32_16x16x32_bf16 v[220:223], a[84:87], a[172:175], v[220:223]
    ds_read_b64_tr_b16 a[68:69], v7 offset:16384
    v_mfma_f32_16x16x32_bf16 v[220:223], a[88:91], a[180:183], v[220:223]
    ds_read_b64_tr_b16 a[70:71], v7 offset:20480
    v_xor_b32 v8, 98752, v6
    v_mfma_f32_16x16x32_bf16 v[220:223], a[92:95], a[188:191], v[220:223]
    s_waitcnt lgkmcnt(6)
    ds_read_b64_tr_b16 a[72:73], v8 offset:0
    v_mfma_f32_16x16x32_bf16 v[228:231], a[96:99], a[160:163], v[228:231]
    ds_read_b64_tr_b16 a[74:75], v8 offset:4096
    v_mfma_f32_16x16x32_bf16 v[228:231], a[100:103], a[168:171], v[228:231]
    ds_read_b64_tr_b16 a[76:77], v8 offset:16384
    v_mfma_f32_16x16x32_bf16 v[228:231], a[104:107], a[176:179], v[228:231]
    s_waitcnt lgkmcnt(7)
    ds_read_b64_tr_b16 a[78:79], v8 offset:20480
    v_xor_b32 v9, 33248, v6
    v_mfma_f32_16x16x32_bf16 v[228:231], a[108:111], a[184:187], v[228:231]
    ds_read_b64_tr_b16 a[80:81], v9 offset:0
    v_mfma_f32_16x16x32_bf16 v[236:239], a[96:99], a[164:167], v[236:239]
    ds_read_b64_tr_b16 a[82:83], v9 offset:4096
    v_mfma_f32_16x16x32_bf16 v[236:239], a[100:103], a[172:175], v[236:239]
    ds_read_b64_tr_b16 a[84:85], v9 offset:16384
    v_mfma_f32_16x16x32_bf16 v[236:239], a[104:107], a[180:183], v[236:239]
    ds_read_b64_tr_b16 a[86:87], v9 offset:20480
    v_xor_b32 v10, 98784, v6
    v_mfma_f32_16x16x32_bf16 v[236:239], a[108:111], a[188:191], v[236:239]
    s_waitcnt lgkmcnt(6)
    ds_read_b64_tr_b16 a[88:89], v10 offset:0
    v_mfma_f32_16x16x32_bf16 v[244:247], a[64:67], a[160:163], v[244:247]
    ds_read_b64_tr_b16 a[90:91], v10 offset:4096
    v_mfma_f32_16x16x32_bf16 v[244:247], a[68:71], a[168:171], v[244:247]
    s_waitcnt vmcnt(1)
    ds_read_b64_tr_b16 a[92:93], v10 offset:16384
    v_xor_b32 v7, 131072, v6
    v_mfma_f32_16x16x32_bf16 v[244:247], a[72:75], a[176:179], v[244:247]
    s_waitcnt lgkmcnt(7)
    s_barrier
    ds_read_b64_tr_b16 a[94:95], v10 offset:20480
    v_mfma_f32_16x16x32_bf16 v[244:247], a[76:79], a[184:187], v[244:247]
    ds_read_b64_tr_b16 a[96:97], v7 offset:0
    v_mfma_f32_16x16x32_bf16 v[252:255], a[64:67], a[164:167], v[252:255]
    ds_read_b64_tr_b16 a[98:99], v7 offset:4096
    v_mfma_f32_16x16x32_bf16 v[252:255], a[68:71], a[172:175], v[252:255]
    ds_read_b64_tr_b16 a[100:101], v7 offset:16384
    v_mfma_f32_16x16x32_bf16 v[252:255], a[72:75], a[180:183], v[252:255]
    ds_read_b64_tr_b16 a[102:103], v7 offset:20480
    v_xor_b32 v8, 0, v6
    v_mfma_f32_16x16x32_bf16 v[252:255], a[76:79], a[188:191], v[252:255]
    s_waitcnt lgkmcnt(6)
    ds_read_b64_tr_b16 a[104:105], v8 offset:0
    v_mfma_f32_16x16x32_bf16 v[16:19], a[80:83], a[160:163], v[16:19]
    ds_read_b64_tr_b16 a[106:107], v8 offset:4096
    v_mfma_f32_16x16x32_bf16 v[16:19], a[84:87], a[168:171], v[16:19]
    ds_read_b64_tr_b16 a[108:109], v8 offset:16384
    v_mfma_f32_16x16x32_bf16 v[16:19], a[88:91], a[176:179], v[16:19]
    s_waitcnt lgkmcnt(7)
    ds_read_b64_tr_b16 a[110:111], v8 offset:20480
    v_xor_b32 v9, 65536, v6
    v_mfma_f32_16x16x32_bf16 v[16:19], a[92:95], a[184:187], v[16:19]
    ds_read_b64_tr_b16 a[64:65], v9 offset:0
    v_mfma_f32_16x16x32_bf16 v[24:27], a[80:83], a[164:167], v[24:27]
    ds_read_b64_tr_b16 a[66:67], v9 offset:4096
    v_mfma_f32_16x16x32_bf16 v[24:27], a[84:87], a[172:175], v[24:27]
    ds_read_b64_tr_b16 a[68:69], v9 offset:16384
    v_mfma_f32_16x16x32_bf16 v[24:27], a[88:91], a[180:183], v[24:27]
    ds_read_b64_tr_b16 a[70:71], v9 offset:20480
    v_xor_b32 v10, 131104, v6
    v_mfma_f32_16x16x32_bf16 v[24:27], a[92:95], a[188:191], v[24:27]
    s_waitcnt lgkmcnt(6)
    ds_read_b64_tr_b16 a[72:73], v10 offset:0
    v_mfma_f32_16x16x32_bf16 v[28:31], a[96:99], a[192:195], v[28:31]
    ds_read_b64_tr_b16 a[74:75], v10 offset:4096
    v_mfma_f32_16x16x32_bf16 v[28:31], a[100:103], a[200:203], v[28:31]
    ds_read_b64_tr_b16 a[76:77], v10 offset:16384
    v_mfma_f32_16x16x32_bf16 v[28:31], a[104:107], a[208:211], v[28:31]
    s_waitcnt lgkmcnt(3)
    ds_read_b64_tr_b16 a[78:79], v10 offset:20480
    v_xor_b32 v7, 32, v6
    v_mfma_f32_16x16x32_bf16 v[28:31], a[108:111], a[216:219], v[28:31]
    ds_read_b64_tr_b16 a[80:81], v7 offset:0
    v_mfma_f32_16x16x32_bf16 v[28:31], a[64:67], a[112:115], v[28:31]
    ds_read_b64_tr_b16 a[82:83], v7 offset:4096
    v_mfma_f32_16x16x32_bf16 v[28:31], a[68:71], a[120:123], v[28:31]
    ds_read_b64_tr_b16 a[84:85], v7 offset:16384
    v_mfma_f32_16x16x32_bf16 v[44:47], a[96:99], a[196:199], v[44:47]
    ds_read_b64_tr_b16 a[86:87], v7 offset:20480
    v_xor_b32 v8, 65568, v6
    v_mfma_f32_16x16x32_bf16 v[44:47], a[100:103], a[204:207], v[44:47]
    ds_read_b64_tr_b16 a[88:89], v8 offset:0
    v_mfma_f32_16x16x32_bf16 v[44:47], a[104:107], a[212:215], v[44:47]
    ds_read_b64_tr_b16 a[90:91], v8 offset:4096
    v_mfma_f32_16x16x32_bf16 v[44:47], a[108:111], a[220:223], v[44:47]
    ds_read_b64_tr_b16 a[92:93], v8 offset:16384
    v_mfma_f32_16x16x32_bf16 v[44:47], a[64:67], a[116:119], v[44:47]
    ds_read_b64_tr_b16 a[94:95], v8 offset:20480
    v_xor_b32 v9, 131136, v6
    v_mfma_f32_16x16x32_bf16 v[44:47], a[68:71], a[124:127], v[44:47]
    s_waitcnt lgkmcnt(6)
    ds_read_b64_tr_b16 a[96:97], v9 offset:0
    v_mfma_f32_16x16x32_bf16 v[52:55], a[72:75], a[192:195], v[52:55]
    ds_read_b64_tr_b16 a[98:99], v9 offset:4096
    v_mfma_f32_16x16x32_bf16 v[52:55], a[76:79], a[200:203], v[52:55]
    ds_read_b64_tr_b16 a[100:101], v9 offset:16384
    v_mfma_f32_16x16x32_bf16 v[52:55], a[80:83], a[208:211], v[52:55]
    s_waitcnt lgkmcnt(3)
    ds_read_b64_tr_b16 a[102:103], v9 offset:20480
    v_xor_b32 v10, 64, v6
    v_mfma_f32_16x16x32_bf16 v[52:55], a[84:87], a[216:219], v[52:55]
    ds_read_b64_tr_b16 a[104:105], v10 offset:0
    v_mfma_f32_16x16x32_bf16 v[52:55], a[88:91], a[112:115], v[52:55]
    ds_read_b64_tr_b16 a[106:107], v10 offset:4096
    v_mfma_f32_16x16x32_bf16 v[52:55], a[92:95], a[120:123], v[52:55]
    ds_read_b64_tr_b16 a[108:109], v10 offset:16384
    v_mfma_f32_16x16x32_bf16 v[60:63], a[72:75], a[196:199], v[60:63]
    ds_read_b64_tr_b16 a[110:111], v10 offset:20480
    v_xor_b32 v7, 65600, v6
    v_mfma_f32_16x16x32_bf16 v[60:63], a[76:79], a[204:207], v[60:63]
    ds_read_b64_tr_b16 a[64:65], v7 offset:0
    v_mfma_f32_16x16x32_bf16 v[60:63], a[80:83], a[212:215], v[60:63]
    ds_read_b64_tr_b16 a[66:67], v7 offset:4096
    v_mfma_f32_16x16x32_bf16 v[60:63], a[84:87], a[220:223], v[60:63]
    ds_read_b64_tr_b16 a[68:69], v7 offset:16384
    v_mfma_f32_16x16x32_bf16 v[60:63], a[88:91], a[116:119], v[60:63]
    ds_read_b64_tr_b16 a[70:71], v7 offset:20480
    v_xor_b32 v8, 131168, v6
    v_mfma_f32_16x16x32_bf16 v[60:63], a[92:95], a[124:127], v[60:63]
    s_waitcnt lgkmcnt(6)
    ds_read_b64_tr_b16 a[72:73], v8 offset:0
    v_mfma_f32_16x16x32_bf16 v[20:23], a[96:99], a[192:195], v[20:23]
    ds_read_b64_tr_b16 a[74:75], v8 offset:4096
    v_mfma_f32_16x16x32_bf16 v[20:23], a[100:103], a[200:203], v[20:23]
    ds_read_b64_tr_b16 a[76:77], v8 offset:16384
    v_mul_f32 v28, s34, v28
    v_mfma_f32_16x16x32_bf16 v[20:23], a[104:107], a[208:211], v[20:23]
    s_waitcnt lgkmcnt(3)
    ds_read_b64_tr_b16 a[78:79], v8 offset:20480
    v_xor_b32 v9, 96, v6
    v_mfma_f32_16x16x32_bf16 v[20:23], a[108:111], a[216:219], v[20:23]
    ds_read_b64_tr_b16 a[80:81], v9 offset:0
    v_mul_f32 v29, s34, v29
    v_mfma_f32_16x16x32_bf16 v[20:23], a[64:67], a[112:115], v[20:23]
    ds_read_b64_tr_b16 a[82:83], v9 offset:4096
    v_mul_f32 v30, s34, v30
    v_mfma_f32_16x16x32_bf16 v[20:23], a[68:71], a[120:123], v[20:23]
    ds_read_b64_tr_b16 a[84:85], v9 offset:16384
    v_mul_f32 v31, s34, v31
    v_mfma_f32_16x16x32_bf16 v[36:39], a[96:99], a[196:199], v[36:39]
    ds_read_b64_tr_b16 a[86:87], v9 offset:20480
    v_xor_b32 v10, 65632, v6
    v_mfma_f32_16x16x32_bf16 v[36:39], a[100:103], a[204:207], v[36:39]
    ds_read_b64_tr_b16 a[88:89], v10 offset:0
    v_mul_f32 v52, s34, v52
    v_mfma_f32_16x16x32_bf16 v[36:39], a[104:107], a[212:215], v[36:39]
    ds_read_b64_tr_b16 a[90:91], v10 offset:4096
    v_mul_f32 v53, s34, v53
    v_mfma_f32_16x16x32_bf16 v[36:39], a[108:111], a[220:223], v[36:39]
    ds_read_b64_tr_b16 a[92:93], v10 offset:16384
    v_mul_f32 v54, s34, v54
    v_mfma_f32_16x16x32_bf16 v[36:39], a[64:67], a[116:119], v[36:39]
    ds_read_b64_tr_b16 a[94:95], v10 offset:20480
    v_xor_b32 v7, 131200, v6
    v_mfma_f32_16x16x32_bf16 v[36:39], a[68:71], a[124:127], v[36:39]
    s_waitcnt lgkmcnt(6)
    ds_read_b64_tr_b16 a[96:97], v7 offset:0
    v_mul_f32 v55, s34, v55
    v_mfma_f32_16x16x32_bf16 v[68:71], a[72:75], a[192:195], v[68:71]
    ds_read_b64_tr_b16 a[98:99], v7 offset:4096
    v_cvt_pk_bf16_f32 v28, v28, v29
    v_mfma_f32_16x16x32_bf16 v[68:71], a[76:79], a[200:203], v[68:71]
    ds_read_b64_tr_b16 a[100:101], v7 offset:16384
    v_cvt_pk_bf16_f32 v29, v30, v31
    v_mfma_f32_16x16x32_bf16 v[68:71], a[80:83], a[208:211], v[68:71]
    s_waitcnt lgkmcnt(3)
    ds_read_b64_tr_b16 a[102:103], v7 offset:20480
    v_xor_b32 v8, 128, v6
    v_mfma_f32_16x16x32_bf16 v[68:71], a[84:87], a[216:219], v[68:71]
    ds_read_b64_tr_b16 a[104:105], v8 offset:0
    v_cvt_pk_bf16_f32 v30, v52, v53
    v_mfma_f32_16x16x32_bf16 v[68:71], a[88:91], a[112:115], v[68:71]
    ds_read_b64_tr_b16 a[106:107], v8 offset:4096
    v_cvt_pk_bf16_f32 v31, v54, v55
    v_mfma_f32_16x16x32_bf16 v[68:71], a[92:95], a[120:123], v[68:71]
    ds_read_b64_tr_b16 a[108:109], v8 offset:16384
    v_accvgpr_write_b32 a0, v28
    v_mfma_f32_16x16x32_bf16 v[76:79], a[72:75], a[196:199], v[76:79]
    ds_read_b64_tr_b16 a[110:111], v8 offset:20480
    v_xor_b32 v9, 65664, v6
    v_mfma_f32_16x16x32_bf16 v[76:79], a[76:79], a[204:207], v[76:79]
    ds_read_b64_tr_b16 a[64:65], v9 offset:0
    v_accvgpr_write_b32 a1, v29
    v_mfma_f32_16x16x32_bf16 v[76:79], a[80:83], a[212:215], v[76:79]
    ds_read_b64_tr_b16 a[66:67], v9 offset:4096
    v_accvgpr_write_b32 a2, v30
    v_mfma_f32_16x16x32_bf16 v[76:79], a[84:87], a[220:223], v[76:79]
    s_waitcnt vmcnt(0)
    ds_read_b64_tr_b16 a[68:69], v9 offset:16384
    v_accvgpr_write_b32 a3, v31
    v_mfma_f32_16x16x32_bf16 v[76:79], a[88:91], a[116:119], v[76:79]
    s_barrier
    ds_read_b64_tr_b16 a[70:71], v9 offset:20480
    v_xor_b32 v10, 131232, v6
    v_mfma_f32_16x16x32_bf16 v[76:79], a[92:95], a[124:127], v[76:79]
    s_waitcnt lgkmcnt(6)
    ds_read_b64_tr_b16 a[72:73], v10 offset:0
    buffer_store_dword v11, v11, s[12:15], s92 offen sc1
    v_mfma_f32_16x16x32_bf16 v[84:87], a[96:99], a[192:195], v[84:87]
    ds_read_b64_tr_b16 a[74:75], v10 offset:4096
    v_mul_f32 v44, s34, v44
    v_mfma_f32_16x16x32_bf16 v[84:87], a[100:103], a[200:203], v[84:87]
    ds_read_b64_tr_b16 a[76:77], v10 offset:16384
    v_mul_f32 v45, s34, v45
    v_mfma_f32_16x16x32_bf16 v[84:87], a[104:107], a[208:211], v[84:87]
    s_waitcnt lgkmcnt(3)
    ds_read_b64_tr_b16 a[78:79], v10 offset:20480
    v_xor_b32 v7, 160, v6
    v_mfma_f32_16x16x32_bf16 v[84:87], a[108:111], a[216:219], v[84:87]
    ds_read_b64_tr_b16 a[80:81], v7 offset:0
    v_mul_f32 v46, s34, v46
    v_mfma_f32_16x16x32_bf16 v[84:87], a[64:67], a[112:115], v[84:87]
    ds_read_b64_tr_b16 a[82:83], v7 offset:4096
    v_mul_f32 v47, s34, v47
    v_mfma_f32_16x16x32_bf16 v[84:87], a[68:71], a[120:123], v[84:87]
    ds_read_b64_tr_b16 a[84:85], v7 offset:16384
    v_mul_f32 v60, s34, v60
    v_mfma_f32_16x16x32_bf16 v[92:95], a[96:99], a[196:199], v[92:95]
    ds_read_b64_tr_b16 a[86:87], v7 offset:20480
    v_xor_b32 v8, 65696, v6
    v_mfma_f32_16x16x32_bf16 v[92:95], a[100:103], a[204:207], v[92:95]
    ds_read_b64_tr_b16 a[88:89], v8 offset:0
    v_mul_f32 v61, s34, v61
    v_mfma_f32_16x16x32_bf16 v[92:95], a[104:107], a[212:215], v[92:95]
    ds_read_b64_tr_b16 a[90:91], v8 offset:4096
    v_mul_f32 v62, s34, v62
    v_mfma_f32_16x16x32_bf16 v[92:95], a[108:111], a[220:223], v[92:95]
    ds_read_b64_tr_b16 a[92:93], v8 offset:16384
    v_mul_f32 v63, s34, v63
    v_mfma_f32_16x16x32_bf16 v[92:95], a[64:67], a[116:119], v[92:95]
    ds_read_b64_tr_b16 a[94:95], v8 offset:20480
    v_xor_b32 v9, 131264, v6
    v_mfma_f32_16x16x32_bf16 v[92:95], a[68:71], a[124:127], v[92:95]
    s_waitcnt lgkmcnt(6)
    ds_read_b64_tr_b16 a[96:97], v9 offset:0
    v_cvt_pk_bf16_f32 v44, v44, v45
    v_mfma_f32_16x16x32_bf16 v[100:103], a[72:75], a[192:195], v[100:103]
    ds_read_b64_tr_b16 a[98:99], v9 offset:4096
    v_cvt_pk_bf16_f32 v45, v46, v47
    v_mfma_f32_16x16x32_bf16 v[100:103], a[76:79], a[200:203], v[100:103]
    ds_read_b64_tr_b16 a[100:101], v9 offset:16384
    v_cvt_pk_bf16_f32 v46, v60, v61
    v_mfma_f32_16x16x32_bf16 v[100:103], a[80:83], a[208:211], v[100:103]
    s_waitcnt lgkmcnt(3)
    ds_read_b64_tr_b16 a[102:103], v9 offset:20480
    v_xor_b32 v10, 192, v6
    v_mfma_f32_16x16x32_bf16 v[100:103], a[84:87], a[216:219], v[100:103]
    ds_read_b64_tr_b16 a[104:105], v10 offset:0
    v_cvt_pk_bf16_f32 v47, v62, v63
    v_mfma_f32_16x16x32_bf16 v[100:103], a[88:91], a[112:115], v[100:103]
    ds_read_b64_tr_b16 a[106:107], v10 offset:4096
    v_accvgpr_write_b32 a32, v44
    v_mfma_f32_16x16x32_bf16 v[100:103], a[92:95], a[120:123], v[100:103]
    ds_read_b64_tr_b16 a[108:109], v10 offset:16384
    v_accvgpr_write_b32 a33, v45
    v_mfma_f32_16x16x32_bf16 v[108:111], a[72:75], a[196:199], v[108:111]
    ds_read_b64_tr_b16 a[110:111], v10 offset:20480
    v_xor_b32 v7, 65728, v6
    v_mfma_f32_16x16x32_bf16 v[108:111], a[76:79], a[204:207], v[108:111]
    ds_read_b64_tr_b16 a[64:65], v7 offset:0
    v_accvgpr_write_b32 a34, v46
    v_mfma_f32_16x16x32_bf16 v[108:111], a[80:83], a[212:215], v[108:111]
    ds_read_b64_tr_b16 a[66:67], v7 offset:4096
    v_accvgpr_write_b32 a35, v47
    v_mfma_f32_16x16x32_bf16 v[108:111], a[84:87], a[220:223], v[108:111]
    ds_read_b64_tr_b16 a[68:69], v7 offset:16384
    v_mul_f32 v20, s34, v20
    v_mfma_f32_16x16x32_bf16 v[108:111], a[88:91], a[116:119], v[108:111]
    ds_read_b64_tr_b16 a[70:71], v7 offset:20480
    v_xor_b32 v8, 131296, v6
    v_mfma_f32_16x16x32_bf16 v[108:111], a[92:95], a[124:127], v[108:111]
    s_waitcnt lgkmcnt(6)
    ds_read_b64_tr_b16 a[72:73], v8 offset:0
    v_mul_f32 v21, s34, v21
    v_mfma_f32_16x16x32_bf16 v[116:119], a[96:99], a[192:195], v[116:119]
    ds_read_b64_tr_b16 a[74:75], v8 offset:4096
    v_mul_f32 v22, s34, v22
    v_mfma_f32_16x16x32_bf16 v[116:119], a[100:103], a[200:203], v[116:119]
    ds_read_b64_tr_b16 a[76:77], v8 offset:16384
    v_mul_f32 v23, s34, v23
    v_mfma_f32_16x16x32_bf16 v[116:119], a[104:107], a[208:211], v[116:119]
    s_waitcnt lgkmcnt(3)
    ds_read_b64_tr_b16 a[78:79], v8 offset:20480
    v_xor_b32 v9, 224, v6
    v_mfma_f32_16x16x32_bf16 v[116:119], a[108:111], a[216:219], v[116:119]
    ds_read_b64_tr_b16 a[80:81], v9 offset:0
    v_mul_f32 v68, s34, v68
    v_mfma_f32_16x16x32_bf16 v[116:119], a[64:67], a[112:115], v[116:119]
    ds_read_b64_tr_b16 a[82:83], v9 offset:4096
    v_mul_f32 v69, s34, v69
    v_mfma_f32_16x16x32_bf16 v[116:119], a[68:71], a[120:123], v[116:119]
    ds_read_b64_tr_b16 a[84:85], v9 offset:16384
    v_mul_f32 v70, s34, v70
    v_mfma_f32_16x16x32_bf16 v[124:127], a[96:99], a[196:199], v[124:127]
    ds_read_b64_tr_b16 a[86:87], v9 offset:20480
    v_xor_b32 v10, 65760, v6
    v_mfma_f32_16x16x32_bf16 v[124:127], a[100:103], a[204:207], v[124:127]
    ds_read_b64_tr_b16 a[88:89], v10 offset:0
    v_mul_f32 v71, s34, v71
    v_mfma_f32_16x16x32_bf16 v[124:127], a[104:107], a[212:215], v[124:127]
    ds_read_b64_tr_b16 a[90:91], v10 offset:4096
    v_cvt_pk_bf16_f32 v20, v20, v21
    v_mfma_f32_16x16x32_bf16 v[124:127], a[108:111], a[220:223], v[124:127]
    ds_read_b64_tr_b16 a[92:93], v10 offset:16384
    v_cvt_pk_bf16_f32 v21, v22, v23
    v_mfma_f32_16x16x32_bf16 v[124:127], a[64:67], a[116:119], v[124:127]
    ds_read_b64_tr_b16 a[94:95], v10 offset:20480
    v_xor_b32 v7, 131328, v6
    v_mfma_f32_16x16x32_bf16 v[124:127], a[68:71], a[124:127], v[124:127]
    s_waitcnt lgkmcnt(6)
    ds_read_b64_tr_b16 a[96:97], v7 offset:0
    v_cvt_pk_bf16_f32 v22, v68, v69
    v_mfma_f32_16x16x32_bf16 v[132:135], a[72:75], a[192:195], v[132:135]
    ds_read_b64_tr_b16 a[98:99], v7 offset:4096
    buffer_load_dwordx4 v[32:35], v122, s[4:7], 0 offen
    v_mfma_f32_16x16x32_bf16 v[132:135], a[76:79], a[200:203], v[132:135]
    ds_read_b64_tr_b16 a[100:101], v7 offset:16384
    v_cvt_pk_bf16_f32 v23, v70, v71
    v_mfma_f32_16x16x32_bf16 v[132:135], a[80:83], a[208:211], v[132:135]
    s_waitcnt lgkmcnt(3)
    ds_read_b64_tr_b16 a[102:103], v7 offset:20480
    v_xor_b32 v8, 256, v6
    v_mfma_f32_16x16x32_bf16 v[132:135], a[84:87], a[216:219], v[132:135]
    ds_read_b64_tr_b16 a[104:105], v8 offset:0
    v_accvgpr_write_b32 a4, v20
    v_mfma_f32_16x16x32_bf16 v[132:135], a[88:91], a[112:115], v[132:135]
    ds_read_b64_tr_b16 a[106:107], v8 offset:4096
    buffer_load_dwordx4 v[40:43], v123, s[4:7], 0 offen
    v_mfma_f32_16x16x32_bf16 v[132:135], a[92:95], a[120:123], v[132:135]
    ds_read_b64_tr_b16 a[108:109], v8 offset:16384
    v_accvgpr_write_b32 a5, v21
    v_mfma_f32_16x16x32_bf16 v[140:143], a[72:75], a[196:199], v[140:143]
    ds_read_b64_tr_b16 a[110:111], v8 offset:20480
    v_xor_b32 v9, 65792, v6
    v_mfma_f32_16x16x32_bf16 v[140:143], a[76:79], a[204:207], v[140:143]
    ds_read_b64_tr_b16 a[64:65], v9 offset:0
    v_accvgpr_write_b32 a6, v22
    v_mfma_f32_16x16x32_bf16 v[140:143], a[80:83], a[212:215], v[140:143]
    ds_read_b64_tr_b16 a[66:67], v9 offset:4096
    buffer_load_dwordx4 v[48:51], v128, s[4:7], 0 offen
    v_mfma_f32_16x16x32_bf16 v[140:143], a[84:87], a[220:223], v[140:143]
    ds_read_b64_tr_b16 a[68:69], v9 offset:16384
    v_accvgpr_write_b32 a7, v23
    v_mfma_f32_16x16x32_bf16 v[140:143], a[88:91], a[116:119], v[140:143]
    ds_read_b64_tr_b16 a[70:71], v9 offset:20480
    v_xor_b32 v10, 131360, v6
    v_mfma_f32_16x16x32_bf16 v[140:143], a[92:95], a[124:127], v[140:143]
    s_waitcnt lgkmcnt(6)
    ds_read_b64_tr_b16 a[72:73], v10 offset:0
    v_mul_f32 v36, s34, v36
    v_mfma_f32_16x16x32_bf16 v[148:151], a[96:99], a[192:195], v[148:151]
    ds_read_b64_tr_b16 a[74:75], v10 offset:4096
    buffer_load_dwordx4 v[56:59], v120, s[4:7], 0 offen offset:0
    v_mfma_f32_16x16x32_bf16 v[148:151], a[100:103], a[200:203], v[148:151]
    ds_read_b64_tr_b16 a[76:77], v10 offset:16384
    v_mul_f32 v37, s34, v37
    v_mfma_f32_16x16x32_bf16 v[148:151], a[104:107], a[208:211], v[148:151]
    s_waitcnt lgkmcnt(3)
    ds_read_b64_tr_b16 a[78:79], v10 offset:20480
    v_xor_b32 v7, 288, v6
    v_mfma_f32_16x16x32_bf16 v[148:151], a[108:111], a[216:219], v[148:151]
    ds_read_b64_tr_b16 a[80:81], v7 offset:0
    v_mul_f32 v38, s34, v38
    v_mfma_f32_16x16x32_bf16 v[148:151], a[64:67], a[112:115], v[148:151]
    ds_read_b64_tr_b16 a[82:83], v7 offset:4096
    buffer_load_dwordx4 v[64:67], v120, s[4:7], 0 offen offset:896
    v_mfma_f32_16x16x32_bf16 v[148:151], a[68:71], a[120:123], v[148:151]
    ds_read_b64_tr_b16 a[84:85], v7 offset:16384
    v_mul_f32 v39, s34, v39
    v_mfma_f32_16x16x32_bf16 v[156:159], a[96:99], a[196:199], v[156:159]
    ds_read_b64_tr_b16 a[86:87], v7 offset:20480
    v_xor_b32 v8, 65824, v6
    v_mfma_f32_16x16x32_bf16 v[156:159], a[100:103], a[204:207], v[156:159]
    ds_read_b64_tr_b16 a[88:89], v8 offset:0
    v_mul_f32 v76, s34, v76
    v_mfma_f32_16x16x32_bf16 v[156:159], a[104:107], a[212:215], v[156:159]
    ds_read_b64_tr_b16 a[90:91], v8 offset:4096
    buffer_load_dwordx4 v[72:75], v120, s[8:11], 0 offen offset:0
    v_mfma_f32_16x16x32_bf16 v[156:159], a[108:111], a[220:223], v[156:159]
    ds_read_b64_tr_b16 a[92:93], v8 offset:16384
    v_mul_f32 v77, s34, v77
    v_mfma_f32_16x16x32_bf16 v[156:159], a[64:67], a[116:119], v[156:159]
    ds_read_b64_tr_b16 a[94:95], v8 offset:20480
    v_xor_b32 v9, 131392, v6
    v_mfma_f32_16x16x32_bf16 v[156:159], a[68:71], a[124:127], v[156:159]
    s_waitcnt lgkmcnt(6)
    ds_read_b64_tr_b16 a[96:97], v9 offset:0
    v_mul_f32 v78, s34, v78
    v_mfma_f32_16x16x32_bf16 v[164:167], a[72:75], a[192:195], v[164:167]
    ds_read_b64_tr_b16 a[98:99], v9 offset:4096
    buffer_load_dwordx4 v[80:83], v120, s[8:11], 0 offen offset:896
    v_mfma_f32_16x16x32_bf16 v[164:167], a[76:79], a[200:203], v[164:167]
    ds_read_b64_tr_b16 a[100:101], v9 offset:16384
    v_mul_f32 v79, s34, v79
    v_mfma_f32_16x16x32_bf16 v[164:167], a[80:83], a[208:211], v[164:167]
    s_waitcnt lgkmcnt(3)
    ds_read_b64_tr_b16 a[102:103], v9 offset:20480
    v_xor_b32 v10, 320, v6
    v_mfma_f32_16x16x32_bf16 v[164:167], a[84:87], a[216:219], v[164:167]
    ds_read_b64_tr_b16 a[104:105], v10 offset:0
    v_cvt_pk_bf16_f32 v36, v36, v37
    v_mfma_f32_16x16x32_bf16 v[164:167], a[88:91], a[112:115], v[164:167]
    ds_read_b64_tr_b16 a[106:107], v10 offset:4096
    buffer_load_dwordx4 v[88:91], v121, s[20:23], s39 offen offset:0
    v_mfma_f32_16x16x32_bf16 v[164:167], a[92:95], a[120:123], v[164:167]
    ds_read_b64_tr_b16 a[108:109], v10 offset:16384
    v_cvt_pk_bf16_f32 v37, v38, v39
    v_mfma_f32_16x16x32_bf16 v[172:175], a[72:75], a[196:199], v[172:175]
    ds_read_b64_tr_b16 a[110:111], v10 offset:20480
    v_xor_b32 v7, 65856, v6
    v_mfma_f32_16x16x32_bf16 v[172:175], a[76:79], a[204:207], v[172:175]
    ds_read_b64_tr_b16 a[64:65], v7 offset:0
    v_cvt_pk_bf16_f32 v38, v76, v77
    v_mfma_f32_16x16x32_bf16 v[172:175], a[80:83], a[212:215], v[172:175]
    ds_read_b64_tr_b16 a[66:67], v7 offset:4096
    buffer_load_dwordx4 v[96:99], v121, s[20:23], s39 offen offset:16
    v_mfma_f32_16x16x32_bf16 v[172:175], a[84:87], a[220:223], v[172:175]
    ds_read_b64_tr_b16 a[68:69], v7 offset:16384
    v_cvt_pk_bf16_f32 v39, v78, v79
    v_mfma_f32_16x16x32_bf16 v[172:175], a[88:91], a[116:119], v[172:175]
    ds_read_b64_tr_b16 a[70:71], v7 offset:20480
    v_xor_b32 v8, 131424, v6
    v_mfma_f32_16x16x32_bf16 v[172:175], a[92:95], a[124:127], v[172:175]
    s_waitcnt lgkmcnt(6)
    ds_read_b64_tr_b16 a[72:73], v8 offset:0
    v_accvgpr_write_b32 a36, v36
    v_mfma_f32_16x16x32_bf16 v[180:183], a[96:99], a[192:195], v[180:183]
    ds_read_b64_tr_b16 a[74:75], v8 offset:4096
    buffer_load_dwordx4 v[104:107], v121, s[20:23], s39 offen offset:32
    v_mfma_f32_16x16x32_bf16 v[180:183], a[100:103], a[200:203], v[180:183]
    ds_read_b64_tr_b16 a[76:77], v8 offset:16384
    v_accvgpr_write_b32 a37, v37
    v_mfma_f32_16x16x32_bf16 v[180:183], a[104:107], a[208:211], v[180:183]
    s_waitcnt lgkmcnt(3)
    ds_read_b64_tr_b16 a[78:79], v8 offset:20480
    v_xor_b32 v9, 352, v6
    v_mfma_f32_16x16x32_bf16 v[180:183], a[108:111], a[216:219], v[180:183]
    ds_read_b64_tr_b16 a[80:81], v9 offset:0
    v_accvgpr_write_b32 a38, v38
    v_mfma_f32_16x16x32_bf16 v[180:183], a[64:67], a[112:115], v[180:183]
    ds_read_b64_tr_b16 a[82:83], v9 offset:4096
    buffer_load_dwordx4 v[112:115], v121, s[20:23], s39 offen offset:48
    v_mfma_f32_16x16x32_bf16 v[180:183], a[68:71], a[120:123], v[180:183]
    ds_read_b64_tr_b16 a[84:85], v9 offset:16384
    v_accvgpr_write_b32 a39, v39
    v_mfma_f32_16x16x32_bf16 v[188:191], a[96:99], a[196:199], v[188:191]
    ds_read_b64_tr_b16 a[86:87], v9 offset:20480
    v_xor_b32 v10, 65888, v6
    v_mfma_f32_16x16x32_bf16 v[188:191], a[100:103], a[204:207], v[188:191]
    ds_read_b64_tr_b16 a[88:89], v10 offset:0
    v_mul_f32 v84, s34, v84
    v_mfma_f32_16x16x32_bf16 v[188:191], a[104:107], a[212:215], v[188:191]
    ds_read_b64_tr_b16 a[90:91], v10 offset:4096
    v_mul_f32 v85, s34, v85
    v_mfma_f32_16x16x32_bf16 v[188:191], a[108:111], a[220:223], v[188:191]
    ds_read_b64_tr_b16 a[92:93], v10 offset:16384
    v_mul_f32 v86, s34, v86
    v_mfma_f32_16x16x32_bf16 v[188:191], a[64:67], a[116:119], v[188:191]
    ds_read_b64_tr_b16 a[94:95], v10 offset:20480
    v_xor_b32 v7, 131456, v6
    v_mfma_f32_16x16x32_bf16 v[188:191], a[68:71], a[124:127], v[188:191]
    s_waitcnt lgkmcnt(6)
    ds_read_b64_tr_b16 a[96:97], v7 offset:0
    v_mul_f32 v87, s34, v87
    v_mfma_f32_16x16x32_bf16 v[196:199], a[72:75], a[192:195], v[196:199]
    ds_read_b64_tr_b16 a[98:99], v7 offset:4096
    v_mul_f32 v100, s34, v100
    v_mfma_f32_16x16x32_bf16 v[196:199], a[76:79], a[200:203], v[196:199]
    ds_read_b64_tr_b16 a[100:101], v7 offset:16384
    v_mul_f32 v101, s34, v101
    v_mfma_f32_16x16x32_bf16 v[196:199], a[80:83], a[208:211], v[196:199]
    s_waitcnt lgkmcnt(3)
    ds_read_b64_tr_b16 a[102:103], v7 offset:20480
    v_xor_b32 v8, 384, v6
    v_mfma_f32_16x16x32_bf16 v[196:199], a[84:87], a[216:219], v[196:199]
    ds_read_b64_tr_b16 a[104:105], v8 offset:0
    v_mul_f32 v102, s34, v102
    v_mfma_f32_16x16x32_bf16 v[196:199], a[88:91], a[112:115], v[196:199]
    ds_read_b64_tr_b16 a[106:107], v8 offset:4096
    v_mul_f32 v103, s34, v103
    v_mfma_f32_16x16x32_bf16 v[196:199], a[92:95], a[120:123], v[196:199]
    ds_read_b64_tr_b16 a[108:109], v8 offset:16384
    v_cvt_pk_bf16_f32 v84, v84, v85
    v_mfma_f32_16x16x32_bf16 v[204:207], a[72:75], a[196:199], v[204:207]
    ds_read_b64_tr_b16 a[110:111], v8 offset:20480
    v_xor_b32 v9, 65920, v6
    v_mfma_f32_16x16x32_bf16 v[204:207], a[76:79], a[204:207], v[204:207]
    ds_read_b64_tr_b16 a[64:65], v9 offset:0
    v_cvt_pk_bf16_f32 v85, v86, v87
    v_mfma_f32_16x16x32_bf16 v[204:207], a[80:83], a[212:215], v[204:207]
    ds_read_b64_tr_b16 a[66:67], v9 offset:4096
    v_cvt_pk_bf16_f32 v86, v100, v101
    v_mfma_f32_16x16x32_bf16 v[204:207], a[84:87], a[220:223], v[204:207]
    ds_read_b64_tr_b16 a[68:69], v9 offset:16384
    v_cvt_pk_bf16_f32 v87, v102, v103
    v_mfma_f32_16x16x32_bf16 v[204:207], a[88:91], a[116:119], v[204:207]
    ds_read_b64_tr_b16 a[70:71], v9 offset:20480
    v_xor_b32 v10, 131488, v6
    v_mfma_f32_16x16x32_bf16 v[204:207], a[92:95], a[124:127], v[204:207]
    s_waitcnt lgkmcnt(6)
    ds_read_b64_tr_b16 a[72:73], v10 offset:0
    v_accvgpr_write_b32 a8, v84
    v_mfma_f32_16x16x32_bf16 v[212:215], a[96:99], a[192:195], v[212:215]
    ds_read_b64_tr_b16 a[74:75], v10 offset:4096
    v_accvgpr_write_b32 a9, v85
    v_mfma_f32_16x16x32_bf16 v[212:215], a[100:103], a[200:203], v[212:215]
    ds_read_b64_tr_b16 a[76:77], v10 offset:16384
    v_accvgpr_write_b32 a10, v86
    v_mfma_f32_16x16x32_bf16 v[212:215], a[104:107], a[208:211], v[212:215]
    s_waitcnt lgkmcnt(3)
    ds_read_b64_tr_b16 a[78:79], v10 offset:20480
    v_xor_b32 v7, 416, v6
    v_mfma_f32_16x16x32_bf16 v[212:215], a[108:111], a[216:219], v[212:215]
    ds_read_b64_tr_b16 a[80:81], v7 offset:0
    v_accvgpr_write_b32 a11, v87
    v_mfma_f32_16x16x32_bf16 v[212:215], a[64:67], a[112:115], v[212:215]
    ds_read_b64_tr_b16 a[82:83], v7 offset:4096
    v_mul_f32 v92, s34, v92
    v_mfma_f32_16x16x32_bf16 v[212:215], a[68:71], a[120:123], v[212:215]
    ds_read_b64_tr_b16 a[84:85], v7 offset:16384
    v_mul_f32 v93, s34, v93
    v_mfma_f32_16x16x32_bf16 v[220:223], a[96:99], a[196:199], v[220:223]
    ds_read_b64_tr_b16 a[86:87], v7 offset:20480
    v_xor_b32 v8, 65952, v6
    v_mfma_f32_16x16x32_bf16 v[220:223], a[100:103], a[204:207], v[220:223]
    ds_read_b64_tr_b16 a[88:89], v8 offset:0
    v_mul_f32 v94, s34, v94
    v_mfma_f32_16x16x32_bf16 v[220:223], a[104:107], a[212:215], v[220:223]
    ds_read_b64_tr_b16 a[90:91], v8 offset:4096
    v_mul_f32 v95, s34, v95
    v_mfma_f32_16x16x32_bf16 v[220:223], a[108:111], a[220:223], v[220:223]
    ds_read_b64_tr_b16 a[92:93], v8 offset:16384
    v_mul_f32 v108, s34, v108
    v_mfma_f32_16x16x32_bf16 v[220:223], a[64:67], a[116:119], v[220:223]
    ds_read_b64_tr_b16 a[94:95], v8 offset:20480
    v_xor_b32 v9, 131520, v6
    v_mfma_f32_16x16x32_bf16 v[220:223], a[68:71], a[124:127], v[220:223]
    s_waitcnt lgkmcnt(6)
    ds_read_b64_tr_b16 a[96:97], v9 offset:0
    v_mul_f32 v109, s34, v109
    v_mfma_f32_16x16x32_bf16 v[228:231], a[72:75], a[192:195], v[228:231]
    ds_read_b64_tr_b16 a[98:99], v9 offset:4096
    v_mul_f32 v110, s34, v110
    v_mfma_f32_16x16x32_bf16 v[228:231], a[76:79], a[200:203], v[228:231]
    ds_read_b64_tr_b16 a[100:101], v9 offset:16384
    v_mul_f32 v111, s34, v111
    v_mfma_f32_16x16x32_bf16 v[228:231], a[80:83], a[208:211], v[228:231]
    s_waitcnt lgkmcnt(3)
    ds_read_b64_tr_b16 a[102:103], v9 offset:20480
    v_xor_b32 v10, 448, v6
    v_mfma_f32_16x16x32_bf16 v[228:231], a[84:87], a[216:219], v[228:231]
    ds_read_b64_tr_b16 a[104:105], v10 offset:0
    v_cvt_pk_bf16_f32 v92, v92, v93
    v_mfma_f32_16x16x32_bf16 v[228:231], a[88:91], a[112:115], v[228:231]
    ds_read_b64_tr_b16 a[106:107], v10 offset:4096
    v_cvt_pk_bf16_f32 v93, v94, v95
    v_mfma_f32_16x16x32_bf16 v[228:231], a[92:95], a[120:123], v[228:231]
    ds_read_b64_tr_b16 a[108:109], v10 offset:16384
    v_cvt_pk_bf16_f32 v94, v108, v109
    v_mfma_f32_16x16x32_bf16 v[236:239], a[72:75], a[196:199], v[236:239]
    ds_read_b64_tr_b16 a[110:111], v10 offset:20480
    v_xor_b32 v7, 65984, v6
    v_mfma_f32_16x16x32_bf16 v[236:239], a[76:79], a[204:207], v[236:239]
    ds_read_b64_tr_b16 a[64:65], v7 offset:0
    v_cvt_pk_bf16_f32 v95, v110, v111
    v_mfma_f32_16x16x32_bf16 v[236:239], a[80:83], a[212:215], v[236:239]
    ds_read_b64_tr_b16 a[66:67], v7 offset:4096
    v_accvgpr_write_b32 a40, v92
    v_mfma_f32_16x16x32_bf16 v[236:239], a[84:87], a[220:223], v[236:239]
    ds_read_b64_tr_b16 a[68:69], v7 offset:16384
    v_accvgpr_write_b32 a41, v93
    v_mfma_f32_16x16x32_bf16 v[236:239], a[88:91], a[116:119], v[236:239]
    ds_read_b64_tr_b16 a[70:71], v7 offset:20480
    v_xor_b32 v8, 131552, v6
    v_mfma_f32_16x16x32_bf16 v[236:239], a[92:95], a[124:127], v[236:239]
    s_waitcnt lgkmcnt(6)
    ds_read_b64_tr_b16 a[72:73], v8 offset:0
    v_accvgpr_write_b32 a42, v94
    v_mfma_f32_16x16x32_bf16 v[244:247], a[96:99], a[192:195], v[244:247]
    ds_read_b64_tr_b16 a[74:75], v8 offset:4096
    v_accvgpr_write_b32 a43, v95
    v_mfma_f32_16x16x32_bf16 v[244:247], a[100:103], a[200:203], v[244:247]
    ds_read_b64_tr_b16 a[76:77], v8 offset:16384
    v_mfma_f32_16x16x32_bf16 v[244:247], a[104:107], a[208:211], v[244:247]
    s_waitcnt lgkmcnt(3)
    ds_read_b64_tr_b16 a[78:79], v8 offset:20480
    v_xor_b32 v9, 480, v6
    v_mfma_f32_16x16x32_bf16 v[244:247], a[108:111], a[216:219], v[244:247]
    ds_read_b64_tr_b16 a[80:81], v9 offset:0
    v_mfma_f32_16x16x32_bf16 v[244:247], a[64:67], a[112:115], v[244:247]
    ds_read_b64_tr_b16 a[82:83], v9 offset:4096
    v_mfma_f32_16x16x32_bf16 v[244:247], a[68:71], a[120:123], v[244:247]
    ds_read_b64_tr_b16 a[84:85], v9 offset:16384
    v_mfma_f32_16x16x32_bf16 v[252:255], a[96:99], a[196:199], v[252:255]
    ds_read_b64_tr_b16 a[86:87], v9 offset:20480
    v_xor_b32 v10, 66016, v6
    v_mfma_f32_16x16x32_bf16 v[252:255], a[100:103], a[204:207], v[252:255]
    ds_read_b64_tr_b16 a[88:89], v10 offset:0
    v_mfma_f32_16x16x32_bf16 v[252:255], a[104:107], a[212:215], v[252:255]
    ds_read_b64_tr_b16 a[90:91], v10 offset:4096
    v_mfma_f32_16x16x32_bf16 v[252:255], a[108:111], a[220:223], v[252:255]
    ds_read_b64_tr_b16 a[92:93], v10 offset:16384
    v_mfma_f32_16x16x32_bf16 v[252:255], a[64:67], a[116:119], v[252:255]
    ds_read_b64_tr_b16 a[94:95], v10 offset:20480
    v_mfma_f32_16x16x32_bf16 v[252:255], a[68:71], a[124:127], v[252:255]
    s_waitcnt lgkmcnt(6)
    v_mfma_f32_16x16x32_bf16 v[16:19], a[72:75], a[192:195], v[16:19]
    v_mfma_f32_16x16x32_bf16 v[16:19], a[76:79], a[200:203], v[16:19]
    v_mfma_f32_16x16x32_bf16 v[16:19], a[80:83], a[208:211], v[16:19]
    s_waitcnt lgkmcnt(0)
    v_mfma_f32_16x16x32_bf16 v[16:19], a[84:87], a[216:219], v[16:19]
    v_mfma_f32_16x16x32_bf16 v[16:19], a[88:91], a[112:115], v[16:19]
    v_mfma_f32_16x16x32_bf16 v[16:19], a[92:95], a[120:123], v[16:19]
    v_mfma_f32_16x16x32_bf16 v[24:27], a[72:75], a[196:199], v[24:27]
    v_mfma_f32_16x16x32_bf16 v[24:27], a[76:79], a[204:207], v[24:27]
    v_mfma_f32_16x16x32_bf16 v[24:27], a[80:83], a[212:215], v[24:27]
    v_mfma_f32_16x16x32_bf16 v[24:27], a[84:87], a[220:223], v[24:27]
    s_waitcnt lgkmcnt(0)
    v_mfma_f32_16x16x32_bf16 v[24:27], a[88:91], a[116:119], v[24:27]
    s_barrier
    v_mfma_f32_16x16x32_bf16 v[24:27], a[92:95], a[124:127], v[24:27]
    s_nop 3
    v_pk_mul_f32 v[116:117], v[116:117], s[34:35]
    v_pk_mul_f32 v[118:119], v[118:119], s[34:35]
    v_pk_mul_f32 v[132:133], v[132:133], s[34:35]
    v_pk_mul_f32 v[134:135], v[134:135], s[34:35]
    v_cvt_pk_bf16_f32 v116, v116, v117
    v_cvt_pk_bf16_f32 v117, v118, v119
    v_cvt_pk_bf16_f32 v118, v132, v133
    v_cvt_pk_bf16_f32 v119, v134, v135
    v_accvgpr_write_b32 a12, v116
    v_accvgpr_write_b32 a13, v117
    v_accvgpr_write_b32 a14, v118
    v_accvgpr_write_b32 a15, v119
    v_pk_mul_f32 v[124:125], v[124:125], s[34:35]
    v_pk_mul_f32 v[126:127], v[126:127], s[34:35]
    v_pk_mul_f32 v[140:141], v[140:141], s[34:35]
    v_pk_mul_f32 v[142:143], v[142:143], s[34:35]
    v_cvt_pk_bf16_f32 v124, v124, v125
    v_cvt_pk_bf16_f32 v125, v126, v127
    v_cvt_pk_bf16_f32 v126, v140, v141
    v_cvt_pk_bf16_f32 v127, v142, v143
    v_accvgpr_write_b32 a44, v124
    v_accvgpr_write_b32 a45, v125
    v_accvgpr_write_b32 a46, v126
    v_accvgpr_write_b32 a47, v127
    v_pk_mul_f32 v[148:149], v[148:149], s[34:35]
    v_pk_mul_f32 v[150:151], v[150:151], s[34:35]
    v_pk_mul_f32 v[164:165], v[164:165], s[34:35]
    v_pk_mul_f32 v[166:167], v[166:167], s[34:35]
    v_cvt_pk_bf16_f32 v148, v148, v149
    v_cvt_pk_bf16_f32 v149, v150, v151
    v_cvt_pk_bf16_f32 v150, v164, v165
    v_cvt_pk_bf16_f32 v151, v166, v167
    v_accvgpr_write_b32 a16, v148
    v_accvgpr_write_b32 a17, v149
    v_accvgpr_write_b32 a18, v150
    v_accvgpr_write_b32 a19, v151
    v_pk_mul_f32 v[156:157], v[156:157], s[34:35]
    v_pk_mul_f32 v[158:159], v[158:159], s[34:35]
    v_pk_mul_f32 v[172:173], v[172:173], s[34:35]
    v_pk_mul_f32 v[174:175], v[174:175], s[34:35]
    v_cvt_pk_bf16_f32 v156, v156, v157
    v_cvt_pk_bf16_f32 v157, v158, v159
    v_cvt_pk_bf16_f32 v158, v172, v173
    v_cvt_pk_bf16_f32 v159, v174, v175
    v_accvgpr_write_b32 a48, v156
    v_accvgpr_write_b32 a49, v157
    v_accvgpr_write_b32 a50, v158
    v_accvgpr_write_b32 a51, v159
    v_pk_mul_f32 v[180:181], v[180:181], s[34:35]
    v_pk_mul_f32 v[182:183], v[182:183], s[34:35]
    v_pk_mul_f32 v[196:197], v[196:197], s[34:35]
    v_pk_mul_f32 v[198:199], v[198:199], s[34:35]
    v_cvt_pk_bf16_f32 v180, v180, v181
    v_cvt_pk_bf16_f32 v181, v182, v183
    v_cvt_pk_bf16_f32 v182, v196, v197
    v_cvt_pk_bf16_f32 v183, v198, v199
    v_accvgpr_write_b32 a20, v180
    v_accvgpr_write_b32 a21, v181
    v_accvgpr_write_b32 a22, v182
    v_accvgpr_write_b32 a23, v183
    v_pk_mul_f32 v[188:189], v[188:189], s[34:35]
    v_pk_mul_f32 v[190:191], v[190:191], s[34:35]
    v_pk_mul_f32 v[204:205], v[204:205], s[34:35]
    v_pk_mul_f32 v[206:207], v[206:207], s[34:35]
    v_cvt_pk_bf16_f32 v188, v188, v189
    v_cvt_pk_bf16_f32 v189, v190, v191
    v_cvt_pk_bf16_f32 v190, v204, v205
    v_cvt_pk_bf16_f32 v191, v206, v207
    v_accvgpr_write_b32 a52, v188
    v_accvgpr_write_b32 a53, v189
    v_accvgpr_write_b32 a54, v190
    v_accvgpr_write_b32 a55, v191
    v_pk_mul_f32 v[212:213], v[212:213], s[34:35]
    v_pk_mul_f32 v[214:215], v[214:215], s[34:35]
    v_pk_mul_f32 v[228:229], v[228:229], s[34:35]
    v_pk_mul_f32 v[230:231], v[230:231], s[34:35]
    v_cvt_pk_bf16_f32 v212, v212, v213
    v_cvt_pk_bf16_f32 v213, v214, v215
    v_cvt_pk_bf16_f32 v214, v228, v229
    v_cvt_pk_bf16_f32 v215, v230, v231
    v_accvgpr_write_b32 a24, v212
    v_accvgpr_write_b32 a25, v213
    v_accvgpr_write_b32 a26, v214
    v_accvgpr_write_b32 a27, v215
    v_pk_mul_f32 v[220:221], v[220:221], s[34:35]
    v_pk_mul_f32 v[222:223], v[222:223], s[34:35]
    v_pk_mul_f32 v[236:237], v[236:237], s[34:35]
    v_pk_mul_f32 v[238:239], v[238:239], s[34:35]
    v_cvt_pk_bf16_f32 v220, v220, v221
    v_cvt_pk_bf16_f32 v221, v222, v223
    v_cvt_pk_bf16_f32 v222, v236, v237
    v_cvt_pk_bf16_f32 v223, v238, v239
    v_accvgpr_write_b32 a56, v220
    v_accvgpr_write_b32 a57, v221
    v_accvgpr_write_b32 a58, v222
    v_accvgpr_write_b32 a59, v223
    v_pk_mul_f32 v[244:245], v[244:245], s[34:35]
    v_pk_mul_f32 v[246:247], v[246:247], s[34:35]
    v_pk_mul_f32 v[16:17], v[16:17], s[34:35]
    v_pk_mul_f32 v[18:19], v[18:19], s[34:35]
    v_cvt_pk_bf16_f32 v244, v244, v245
    v_cvt_pk_bf16_f32 v245, v246, v247
    v_cvt_pk_bf16_f32 v246, v16, v17
    v_cvt_pk_bf16_f32 v247, v18, v19
    v_accvgpr_write_b32 a28, v244
    v_accvgpr_write_b32 a29, v245
    v_accvgpr_write_b32 a30, v246
    v_accvgpr_write_b32 a31, v247
    v_pk_mul_f32 v[252:253], v[252:253], s[34:35]
    v_pk_mul_f32 v[254:255], v[254:255], s[34:35]
    v_pk_mul_f32 v[24:25], v[24:25], s[34:35]
    v_pk_mul_f32 v[26:27], v[26:27], s[34:35]
    v_cvt_pk_bf16_f32 v252, v252, v253
    v_cvt_pk_bf16_f32 v253, v254, v255
    v_cvt_pk_bf16_f32 v254, v24, v25
    v_cvt_pk_bf16_f32 v255, v26, v27
    v_accvgpr_write_b32 a60, v252
    v_accvgpr_write_b32 a61, v253
    v_accvgpr_write_b32 a62, v254
    v_accvgpr_write_b32 a63, v255
    s_waitcnt vmcnt(0)
    s_branch L_kvdone
L_kloop_side:
    s_mov_b64 exec, 1
    global_atomic_add v3, v15, s[90:91] offset:128 sc1
    s_mov_b64 exec, -1
    s_branch L_kloop_back
L_vloop_side:
    s_mov_b64 exec, 1
    global_atomic_add v3, v15, s[90:91] offset:128 sc1
    s_mov_b64 exec, -1
    s_branch L_vloop_back
.p2align 6
L_vloop:
    v_mfma_f32_16x16x32_bf16 v[64:67], a[64:67], a[0:3], v[64:67]
    ds_read_b64_tr_b16 a[24:25], v9 offset:0
    v_mfma_f32_16x16x32_bf16 v[64:67], a[68:71], a[4:7], v[64:67]
    ds_read_b64_tr_b16 a[26:27], v9 offset:4096
    v_mfma_f32_16x16x32_bf16 v[68:71], a[76:79], a[4:7], v[68:71]
    ds_read_b64_tr_b16 a[28:29], v9 offset:16384
    v_mfma_f32_16x16x32_bf16 v[68:71], a[72:75], a[0:3], v[68:71]
    ds_read_b64_tr_b16 a[30:31], v9 offset:20480
    v_mfma_f32_16x16x32_bf16 v[72:75], a[80:83], a[0:3], v[72:75]
    ds_read_b128 a[96:99], v4 offset:8192
    v_mfma_f32_16x16x32_bf16 v[72:75], a[84:87], a[4:7], v[72:75]
    s_cmp_eq_u32 s61, s55
    s_cbranch_scc1 L_vloop_side
L_vloop_back:
    v_mfma_f32_16x16x32_bf16 v[76:79], a[92:95], a[4:7], v[76:79]
    s_waitcnt lgkmcnt(8)
    ds_read_b128 a[100:103], v5 offset:8192
    v_mfma_f32_16x16x32_bf16 v[76:79], a[88:91], a[0:3], v[76:79]
    v_mfma_f32_16x16x32_bf16 v[84:87], a[88:91], a[8:11], v[84:87]
    ds_read_b128 a[108:111], v5 offset:10240
    v_mfma_f32_16x16x32_bf16 v[84:87], a[92:95], a[12:15], v[84:87]
    v_mfma_f32_16x16x32_bf16 v[80:83], a[84:87], a[12:15], v[80:83]
    ds_read_b128 a[104:107], v4 offset:10240
    v_mfma_f32_16x16x32_bf16 v[80:83], a[80:83], a[8:11], v[80:83]
    v_mfma_f32_16x16x32_bf16 v[92:95], a[72:75], a[8:11], v[92:95]
    ds_read_b128 a[112:115], v4 offset:12288
    v_mfma_f32_16x16x32_bf16 v[92:95], a[76:79], a[12:15], v[92:95]
    v_mfma_f32_16x16x32_bf16 v[88:91], a[68:71], a[12:15], v[88:91]
    ds_read_b128 a[116:119], v5 offset:12288
    v_mfma_f32_16x16x32_bf16 v[88:91], a[64:67], a[8:11], v[88:91]
    s_waitcnt lgkmcnt(8)
    v_mfma_f32_16x16x32_bf16 v[96:99], a[64:67], a[16:19], v[96:99]
    ds_read_b128 a[124:127], v5 offset:14336
    v_mfma_f32_16x16x32_bf16 v[96:99], a[68:71], a[20:23], v[96:99]
    v_mfma_f32_16x16x32_bf16 v[100:103], a[76:79], a[20:23], v[100:103]
    ds_read_b128 a[120:123], v4 offset:14336
    v_mfma_f32_16x16x32_bf16 v[100:103], a[72:75], a[16:19], v[100:103]
    v_mfma_f32_16x16x32_bf16 v[104:107], a[80:83], a[16:19], v[104:107]
    ds_read_b64_tr_b16 a[32:33], v10 offset:0
    v_mfma_f32_16x16x32_bf16 v[104:107], a[84:87], a[20:23], v[104:107]
    ds_read_b64_tr_b16 a[34:35], v10 offset:4096
    v_mfma_f32_16x16x32_bf16 v[108:111], a[92:95], a[20:23], v[108:111]
    ds_read_b64_tr_b16 a[36:37], v10 offset:16384
    v_mfma_f32_16x16x32_bf16 v[108:111], a[88:91], a[16:19], v[108:111]
    ds_read_b64_tr_b16 a[38:39], v10 offset:20480
    v_mfma_f32_16x16x32_bf16 v[116:119], a[88:91], a[24:27], v[116:119]
    s_waitcnt lgkmcnt(8)
    ds_read_b64_tr_b16 a[40:41], v11 offset:0
    v_mfma_f32_16x16x32_bf16 v[116:119], a[92:95], a[28:31], v[116:119]
    ds_read_b64_tr_b16 a[42:43], v11 offset:4096
    v_mfma_f32_16x16x32_bf16 v[112:115], a[84:87], a[28:31], v[112:115]
    ds_read_b64_tr_b16 a[44:45], v11 offset:16384
    v_mfma_f32_16x16x32_bf16 v[112:115], a[80:83], a[24:27], v[112:115]
    ds_read_b64_tr_b16 a[46:47], v11 offset:20480
    v_mfma_f32_16x16x32_bf16 v[124:127], a[72:75], a[24:27], v[124:127]
    ds_read_b64_tr_b16 a[48:49], v12 offset:0
    v_mfma_f32_16x16x32_bf16 v[124:127], a[76:79], a[28:31], v[124:127]
    ds_read_b64_tr_b16 a[50:51], v12 offset:4096
    v_mfma_f32_16x16x32_bf16 v[120:123], a[68:71], a[28:31], v[120:123]
    ds_read_b64_tr_b16 a[52:53], v12 offset:16384
    v_mfma_f32_16x16x32_bf16 v[120:123], a[64:67], a[24:27], v[120:123]
    ds_read_b64_tr_b16 a[54:55], v12 offset:20480
    v_mfma_f32_16x16x32_bf16 v[16:19], a[96:99], a[0:3], v[16:19]
    ds_read_b64_tr_b16 a[56:57], v13 offset:0
    v_mfma_f32_16x16x32_bf16 v[16:19], a[100:103], a[4:7], v[16:19]
    ds_read_b64_tr_b16 a[58:59], v13 offset:4096
    v_mfma_f32_16x16x32_bf16 v[20:23], a[108:111], a[4:7], v[20:23]
    ds_read_b64_tr_b16 a[60:61], v13 offset:16384
    v_mfma_f32_16x16x32_bf16 v[20:23], a[104:107], a[0:3], v[20:23]
    s_waitcnt lgkmcnt(8)
    ds_read_b64_tr_b16 a[62:63], v13 offset:20480
    v_mfma_f32_16x16x32_bf16 v[24:27], a[112:115], a[0:3], v[24:27]
    v_mfma_f32_16x16x32_bf16 v[24:27], a[116:119], a[4:7], v[24:27]
    v_mfma_f32_16x16x32_bf16 v[28:31], a[124:127], a[4:7], v[28:31]
    v_mfma_f32_16x16x32_bf16 v[28:31], a[120:123], a[0:3], v[28:31]
    s_waitcnt lgkmcnt(0)
    v_mfma_f32_16x16x32_bf16 a[228:231], a[120:123], a[8:11], a[228:231]
    s_barrier
    v_mfma_f32_16x16x32_bf16 a[228:231], a[124:127], a[12:15], a[228:231]
    s_add_u32 m0, s29, 65536
    v_mfma_f32_16x16x32_bf16 a[224:227], a[116:119], a[12:15], a[224:227]
    buffer_load_dwordx4 v2, s[8:11], 0 offen lds
    v_mfma_f32_16x16x32_bf16 a[224:227], a[112:115], a[8:11], a[224:227]
    v_mfma_f32_16x16x32_bf16 a[236:239], a[104:107], a[8:11], a[236:239]
    v_mfma_f32_16x16x32_bf16 a[236:239], a[108:111], a[12:15], a[236:239]
    v_mfma_f32_16x16x32_bf16 a[232:235], a[100:103], a[12:15], a[232:235]
    s_add_u32 m0, s29, 0
    v_mfma_f32_16x16x32_bf16 a[232:235], a[96:99], a[8:11], a[232:235]
    buffer_load_dwordx4 v1, s[4:7], 0 offen lds
    v_mfma_f32_16x16x32_bf16 v[32:35], a[96:99], a[16:19], v[32:35]
    v_mfma_f32_16x16x32_bf16 v[32:35], a[100:103], a[20:23], v[32:35]
    v_mfma_f32_16x16x32_bf16 v[36:39], a[108:111], a[20:23], v[36:39]
    v_mfma_f32_16x16x32_bf16 v[36:39], a[104:107], a[16:19], v[36:39]
    s_add_u32 m0, s29, 69632
    v_mfma_f32_16x16x32_bf16 v[40:43], a[112:115], a[16:19], v[40:43]
    buffer_load_dwordx4 v2, s[8:11], s48 offen lds
    v_mfma_f32_16x16x32_bf16 v[40:43], a[116:119], a[20:23], v[40:43]
    v_mfma_f32_16x16x32_bf16 v[44:47], a[124:127], a[20:23], v[44:47]
    v_mfma_f32_16x16x32_bf16 v[44:47], a[120:123], a[16:19], v[44:47]
    v_mfma_f32_16x16x32_bf16 v[52:55], a[120:123], a[24:27], v[52:55]
    s_add_u32 m0, s29, 4096
    v_mfma_f32_16x16x32_bf16 v[52:55], a[124:127], a[28:31], v[52:55]
    buffer_load_dwordx4 v1, s[4:7], s41 offen lds
    v_mfma_f32_16x16x32_bf16 v[48:51], a[116:119], a[28:31], v[48:51]
    v_mfma_f32_16x16x32_bf16 v[48:51], a[112:115], a[24:27], v[48:51]
    v_mfma_f32_16x16x32_bf16 v[60:63], a[104:107], a[24:27], v[60:63]
    v_mfma_f32_16x16x32_bf16 v[60:63], a[108:111], a[28:31], v[60:63]
    s_add_u32 m0, s29, 73728
    v_mfma_f32_16x16x32_bf16 v[56:59], a[100:103], a[28:31], v[56:59]
    buffer_load_dwordx4 v2, s[8:11], s49 offen lds
    v_mfma_f32_16x16x32_bf16 v[56:59], a[96:99], a[24:27], v[56:59]
    v_mfma_f32_16x16x32_bf16 v[192:195], a[96:99], a[32:35], v[192:195]
    v_mfma_f32_16x16x32_bf16 v[192:195], a[100:103], a[36:39], v[192:195]
    v_mfma_f32_16x16x32_bf16 v[196:199], a[108:111], a[36:39], v[196:199]
    s_add_u32 m0, s29, 8192
    v_mfma_f32_16x16x32_bf16 v[196:199], a[104:107], a[32:35], v[196:199]
    buffer_load_dwordx4 v1, s[4:7], s42 offen lds
    v_mfma_f32_16x16x32_bf16 v[200:203], a[112:115], a[32:35], v[200:203]
    v_mfma_f32_16x16x32_bf16 v[200:203], a[116:119], a[36:39], v[200:203]
    v_mfma_f32_16x16x32_bf16 v[204:207], a[124:127], a[36:39], v[204:207]
    v_mfma_f32_16x16x32_bf16 v[204:207], a[120:123], a[32:35], v[204:207]
    s_add_u32 m0, s29, 77824
    v_mfma_f32_16x16x32_bf16 v[212:215], a[120:123], a[40:43], v[212:215]
    buffer_load_dwordx4 v2, s[8:11], s50 offen lds
    v_mfma_f32_16x16x32_bf16 v[212:215], a[124:127], a[44:47], v[212:215]
    v_mfma_f32_16x16x32_bf16 v[208:211], a[116:119], a[44:47], v[208:211]
    v_mfma_f32_16x16x32_bf16 v[208:211], a[112:115], a[40:43], v[208:211]
    v_mfma_f32_16x16x32_bf16 v[220:223], a[104:107], a[40:43], v[220:223]
    s_add_u32 m0, s29, 12288
    v_mfma_f32_16x16x32_bf16 v[220:223], a[108:111], a[44:47], v[220:223]
    buffer_load_dwordx4 v1, s[4:7], s43 offen lds
    v_mfma_f32_16x16x32_bf16 v[216:219], a[100:103], a[44:47], v[216:219]
    v_mfma_f32_16x16x32_bf16 v[216:219], a[96:99], a[40:43], v[216:219]
    v_mfma_f32_16x16x32_bf16 v[224:227], a[96:99], a[48:51], v[224:227]
    v_mfma_f32_16x16x32_bf16 v[224:227], a[100:103], a[52:55], v[224:227]
    s_add_u32 m0, s29, 81920
    v_mfma_f32_16x16x32_bf16 v[228:231], a[108:111], a[52:55], v[228:231]
    buffer_load_dwordx4 v2, s[8:11], s51 offen lds
    v_mfma_f32_16x16x32_bf16 v[228:231], a[104:107], a[48:51], v[228:231]
    v_mfma_f32_16x16x32_bf16 v[232:235], a[112:115], a[48:51], v[232:235]
    v_mfma_f32_16x16x32_bf16 v[232:235], a[116:119], a[52:55], v[232:235]
    v_mfma_f32_16x16x32_bf16 v[236:239], a[124:127], a[52:55], v[236:239]
    s_add_u32 m0, s29, 16384
    v_mfma_f32_16x16x32_bf16 v[236:239], a[120:123], a[48:51], v[236:239]
    buffer_load_dwordx4 v1, s[4:7], s44 offen lds
    v_mfma_f32_16x16x32_bf16 v[244:247], a[120:123], a[56:59], v[244:247]
    v_mfma_f32_16x16x32_bf16 v[244:247], a[124:127], a[60:63], v[244:247]
    v_mfma_f32_16x16x32_bf16 v[240:243], a[116:119], a[60:63], v[240:243]
    v_mfma_f32_16x16x32_bf16 v[240:243], a[112:115], a[56:59], v[240:243]
    s_add_u32 m0, s29, 86016
    v_mfma_f32_16x16x32_bf16 v[252:255], a[104:107], a[56:59], v[252:255]
    s_waitcnt vmcnt(11)
    buffer_load_dwordx4 v2, s[8:11], s52 offen lds
    v_mfma_f32_16x16x32_bf16 v[252:255], a[108:111], a[60:63], v[252:255]
    s_barrier
    ds_read_b64_tr_b16 a[0:1], v6 offset:32768
    v_mfma_f32_16x16x32_bf16 v[248:251], a[100:103], a[60:63], v[248:251]
    ds_read_b64_tr_b16 a[2:3], v6 offset:36864
    v_mfma_f32_16x16x32_bf16 v[248:251], a[96:99], a[56:59], v[248:251]
    ds_read_b128 a[96:99], v4 offset:40960
    v_mfma_f32_16x16x32_bf16 v[128:131], a[64:67], a[32:35], v[128:131]
    s_add_u32 m0, s29, 20480
    v_mfma_f32_16x16x32_bf16 v[128:131], a[68:71], a[36:39], v[128:131]
    buffer_load_dwordx4 v1, s[4:7], s45 offen lds
    v_mfma_f32_16x16x32_bf16 v[132:135], a[76:79], a[36:39], v[132:135]
    ds_read_b64_tr_b16 a[4:5], v6 offset:49152
    v_mfma_f32_16x16x32_bf16 v[132:135], a[72:75], a[32:35], v[132:135]
    ds_read_b64_tr_b16 a[6:7], v6 offset:53248
    v_mfma_f32_16x16x32_bf16 v[136:139], a[80:83], a[32:35], v[136:139]
    ds_read_b128 a[100:103], v5 offset:40960
    v_mfma_f32_16x16x32_bf16 v[136:139], a[84:87], a[36:39], v[136:139]
    s_add_u32 m0, s29, 90112
    v_mfma_f32_16x16x32_bf16 v[140:143], a[92:95], a[36:39], v[140:143]
    buffer_load_dwordx4 v2, s[8:11], s53 offen lds
    v_mfma_f32_16x16x32_bf16 v[140:143], a[88:91], a[32:35], v[140:143]
    ds_read_b128 a[108:111], v5 offset:43008
    v_mfma_f32_16x16x32_bf16 v[148:151], a[88:91], a[40:43], v[148:151]
    v_mfma_f32_16x16x32_bf16 v[148:151], a[92:95], a[44:47], v[148:151]
    ds_read_b128 a[104:107], v4 offset:43008
    v_mfma_f32_16x16x32_bf16 v[144:147], a[84:87], a[44:47], v[144:147]
    s_add_u32 m0, s29, 24576
    v_mfma_f32_16x16x32_bf16 v[144:147], a[80:83], a[40:43], v[144:147]
    buffer_load_dwordx4 v1, s[4:7], s46 offen lds
    v_mfma_f32_16x16x32_bf16 v[156:159], a[72:75], a[40:43], v[156:159]
    ds_read_b128 a[112:115], v4 offset:45056
    v_mfma_f32_16x16x32_bf16 v[156:159], a[76:79], a[44:47], v[156:159]
    v_mfma_f32_16x16x32_bf16 v[152:155], a[68:71], a[44:47], v[152:155]
    ds_read_b128 a[116:119], v5 offset:45056
    v_mfma_f32_16x16x32_bf16 v[152:155], a[64:67], a[40:43], v[152:155]
    s_add_u32 m0, s29, 94208
    v_mfma_f32_16x16x32_bf16 v[160:163], a[64:67], a[48:51], v[160:163]
    buffer_load_dwordx4 v2, s[8:11], s54 offen lds
    v_mfma_f32_16x16x32_bf16 v[160:163], a[68:71], a[52:55], v[160:163]
    ds_read_b128 a[124:127], v5 offset:47104
    v_mfma_f32_16x16x32_bf16 v[164:167], a[76:79], a[52:55], v[164:167]
    v_mfma_f32_16x16x32_bf16 v[164:167], a[72:75], a[48:51], v[164:167]
    ds_read_b128 a[120:123], v4 offset:47104
    v_mfma_f32_16x16x32_bf16 v[168:171], a[80:83], a[48:51], v[168:171]
    s_add_u32 m0, s29, 28672
    v_mfma_f32_16x16x32_bf16 v[168:171], a[84:87], a[52:55], v[168:171]
    buffer_load_dwordx4 v1, s[4:7], s47 offen lds
    v_mfma_f32_16x16x32_bf16 v[172:175], a[92:95], a[52:55], v[172:175]
    v_add_u32 v1, 128, v1
    v_add_u32 v2, 0x80000, v2
    v_mfma_f32_16x16x32_bf16 v[172:175], a[88:91], a[48:51], v[172:175]
    ds_read_b64_tr_b16 a[8:9], v7 offset:32768
    v_mfma_f32_16x16x32_bf16 v[180:183], a[88:91], a[56:59], v[180:183]
    buffer_load_dword a243, v14, s[36:39], s56 offen
    v_mfma_f32_16x16x32_bf16 v[180:183], a[92:95], a[60:63], v[180:183]
    s_add_u32 s56, s56, s30
    ds_read_b64_tr_b16 a[10:11], v7 offset:36864
    v_mfma_f32_16x16x32_bf16 v[176:179], a[84:87], a[60:63], v[176:179]
    ds_read_b64_tr_b16 a[12:13], v7 offset:49152
    v_mfma_f32_16x16x32_bf16 v[176:179], a[80:83], a[56:59], v[176:179]
    ds_read_b64_tr_b16 a[14:15], v7 offset:53248
    v_mfma_f32_16x16x32_bf16 v[188:191], a[72:75], a[56:59], v[188:191]
    ds_read_b64_tr_b16 a[16:17], v8 offset:32768
    v_mfma_f32_16x16x32_bf16 v[188:191], a[76:79], a[60:63], v[188:191]
    ds_read_b64_tr_b16 a[18:19], v8 offset:36864
    v_mfma_f32_16x16x32_bf16 v[184:187], a[68:71], a[60:63], v[184:187]
    ds_read_b64_tr_b16 a[20:21], v8 offset:49152
    v_mfma_f32_16x16x32_bf16 v[184:187], a[64:67], a[56:59], v[184:187]
    s_waitcnt lgkmcnt(8)
    ds_read_b64_tr_b16 a[22:23], v8 offset:53248
    v_mfma_f32_16x16x32_bf16 v[16:19], a[96:99], a[0:3], v[16:19]
    ds_read_b64_tr_b16 a[24:25], v9 offset:32768
    v_mfma_f32_16x16x32_bf16 v[16:19], a[100:103], a[4:7], v[16:19]
    ds_read_b64_tr_b16 a[26:27], v9 offset:36864
    v_mfma_f32_16x16x32_bf16 v[20:23], a[108:111], a[4:7], v[20:23]
    ds_read_b64_tr_b16 a[28:29], v9 offset:49152
    v_mfma_f32_16x16x32_bf16 v[20:23], a[104:107], a[0:3], v[20:23]
    ds_read_b64_tr_b16 a[30:31], v9 offset:53248
    v_mfma_f32_16x16x32_bf16 v[24:27], a[112:115], a[0:3], v[24:27]
    ds_read_b128 a[64:67], v4 offset:32768
    v_mfma_f32_16x16x32_bf16 v[24:27], a[116:119], a[4:7], v[24:27]
    v_mfma_f32_16x16x32_bf16 v[28:31], a[124:127], a[4:7], v[28:31]
    s_waitcnt lgkmcnt(8)
    ds_read_b128 a[68:71], v5 offset:32768
    v_mfma_f32_16x16x32_bf16 v[28:31], a[120:123], a[0:3], v[28:31]
    v_mfma_f32_16x16x32_bf16 a[228:231], a[120:123], a[8:11], a[228:231]
    ds_read_b128 a[76:79], v5 offset:34816
    v_mfma_f32_16x16x32_bf16 a[228:231], a[124:127], a[12:15], a[228:231]
    v_mfma_f32_16x16x32_bf16 a[224:227], a[116:119], a[12:15], a[224:227]
    ds_read_b128 a[72:75], v4 offset:34816
    v_mfma_f32_16x16x32_bf16 a[224:227], a[112:115], a[8:11], a[224:227]
    v_mfma_f32_16x16x32_bf16 a[236:239], a[104:107], a[8:11], a[236:239]
    ds_read_b128 a[80:83], v4 offset:36864
    v_mfma_f32_16x16x32_bf16 a[236:239], a[108:111], a[12:15], a[236:239]
    v_mfma_f32_16x16x32_bf16 a[232:235], a[100:103], a[12:15], a[232:235]
    ds_read_b128 a[84:87], v5 offset:36864
    v_mfma_f32_16x16x32_bf16 a[232:235], a[96:99], a[8:11], a[232:235]
    s_waitcnt lgkmcnt(8)
    v_mfma_f32_16x16x32_bf16 v[32:35], a[96:99], a[16:19], v[32:35]
    ds_read_b128 a[92:95], v5 offset:38912
    v_mfma_f32_16x16x32_bf16 v[32:35], a[100:103], a[20:23], v[32:35]
    v_mfma_f32_16x16x32_bf16 v[36:39], a[108:111], a[20:23], v[36:39]
    ds_read_b128 a[88:91], v4 offset:38912
    v_mfma_f32_16x16x32_bf16 v[36:39], a[104:107], a[16:19], v[36:39]
    v_mfma_f32_16x16x32_bf16 v[40:43], a[112:115], a[16:19], v[40:43]
    ds_read_b64_tr_b16 a[32:33], v10 offset:32768
    v_mfma_f32_16x16x32_bf16 v[40:43], a[116:119], a[20:23], v[40:43]
    ds_read_b64_tr_b16 a[34:35], v10 offset:36864
    v_mfma_f32_16x16x32_bf16 v[44:47], a[124:127], a[20:23], v[44:47]
    ds_read_b64_tr_b16 a[36:37], v10 offset:49152
    v_mfma_f32_16x16x32_bf16 v[44:47], a[120:123], a[16:19], v[44:47]
    ds_read_b64_tr_b16 a[38:39], v10 offset:53248
    v_mfma_f32_16x16x32_bf16 v[52:55], a[120:123], a[24:27], v[52:55]
    s_waitcnt lgkmcnt(8)
    ds_read_b64_tr_b16 a[40:41], v11 offset:32768
    v_mfma_f32_16x16x32_bf16 v[52:55], a[124:127], a[28:31], v[52:55]
    ds_read_b64_tr_b16 a[42:43], v11 offset:36864
    v_mfma_f32_16x16x32_bf16 v[48:51], a[116:119], a[28:31], v[48:51]
    ds_read_b64_tr_b16 a[44:45], v11 offset:49152
    v_mfma_f32_16x16x32_bf16 v[48:51], a[112:115], a[24:27], v[48:51]
    ds_read_b64_tr_b16 a[46:47], v11 offset:53248
    v_mfma_f32_16x16x32_bf16 v[60:63], a[104:107], a[24:27], v[60:63]
    ds_read_b64_tr_b16 a[48:49], v12 offset:32768
    v_mfma_f32_16x16x32_bf16 v[60:63], a[108:111], a[28:31], v[60:63]
    ds_read_b64_tr_b16 a[50:51], v12 offset:36864
    v_mfma_f32_16x16x32_bf16 v[56:59], a[100:103], a[28:31], v[56:59]
    ds_read_b64_tr_b16 a[52:53], v12 offset:49152
    v_mfma_f32_16x16x32_bf16 v[56:59], a[96:99], a[24:27], v[56:59]
    ds_read_b64_tr_b16 a[54:55], v12 offset:53248
    v_mfma_f32_16x16x32_bf16 v[64:67], a[64:67], a[0:3], v[64:67]
    ds_read_b64_tr_b16 a[56:57], v13 offset:32768
    v_mfma_f32_16x16x32_bf16 v[64:67], a[68:71], a[4:7], v[64:67]
    ds_read_b64_tr_b16 a[58:59], v13 offset:36864
    v_mfma_f32_16x16x32_bf16 v[68:71], a[76:79], a[4:7], v[68:71]
    ds_read_b64_tr_b16 a[60:61], v13 offset:49152
    v_mfma_f32_16x16x32_bf16 v[68:71], a[72:75], a[0:3], v[68:71]
    s_waitcnt lgkmcnt(8)
    ds_read_b64_tr_b16 a[62:63], v13 offset:53248
    v_mfma_f32_16x16x32_bf16 v[72:75], a[80:83], a[0:3], v[72:75]
    v_mfma_f32_16x16x32_bf16 v[72:75], a[84:87], a[4:7], v[72:75]
    v_mfma_f32_16x16x32_bf16 v[76:79], a[92:95], a[4:7], v[76:79]
    v_mfma_f32_16x16x32_bf16 v[76:79], a[88:91], a[0:3], v[76:79]
    s_waitcnt lgkmcnt(0)
    v_mfma_f32_16x16x32_bf16 v[84:87], a[88:91], a[8:11], v[84:87]
    s_barrier
    v_mfma_f32_16x16x32_bf16 v[84:87], a[92:95], a[12:15], v[84:87]
    s_add_u32 m0, s29, 98304
    v_mfma_f32_16x16x32_bf16 v[80:83], a[84:87], a[12:15], v[80:83]
    buffer_load_dwordx4 v2, s[8:11], 0 offen lds
    v_mfma_f32_16x16x32_bf16 v[80:83], a[80:83], a[8:11], v[80:83]
    v_mfma_f32_16x16x32_bf16 v[92:95], a[72:75], a[8:11], v[92:95]
    v_mfma_f32_16x16x32_bf16 v[92:95], a[76:79], a[12:15], v[92:95]
    v_mfma_f32_16x16x32_bf16 v[88:91], a[68:71], a[12:15], v[88:91]
    s_add_u32 m0, s29, 32768
    v_mfma_f32_16x16x32_bf16 v[88:91], a[64:67], a[8:11], v[88:91]
    buffer_load_dwordx4 v1, s[4:7], 0 offen lds
    v_mfma_f32_16x16x32_bf16 v[96:99], a[64:67], a[16:19], v[96:99]
    v_mfma_f32_16x16x32_bf16 v[96:99], a[68:71], a[20:23], v[96:99]
    v_mfma_f32_16x16x32_bf16 v[100:103], a[76:79], a[20:23], v[100:103]
    v_mfma_f32_16x16x32_bf16 v[100:103], a[72:75], a[16:19], v[100:103]
    s_add_u32 m0, s29, 102400
    v_mfma_f32_16x16x32_bf16 v[104:107], a[80:83], a[16:19], v[104:107]
    buffer_load_dwordx4 v2, s[8:11], s48 offen lds
    v_mfma_f32_16x16x32_bf16 v[104:107], a[84:87], a[20:23], v[104:107]
    v_mfma_f32_16x16x32_bf16 v[108:111], a[92:95], a[20:23], v[108:111]
    v_mfma_f32_16x16x32_bf16 v[108:111], a[88:91], a[16:19], v[108:111]
    v_mfma_f32_16x16x32_bf16 v[116:119], a[88:91], a[24:27], v[116:119]
    s_add_u32 m0, s29, 36864
    v_mfma_f32_16x16x32_bf16 v[116:119], a[92:95], a[28:31], v[116:119]
    buffer_load_dwordx4 v1, s[4:7], s41 offen lds
    v_mfma_f32_16x16x32_bf16 v[112:115], a[84:87], a[28:31], v[112:115]
    v_mfma_f32_16x16x32_bf16 v[112:115], a[80:83], a[24:27], v[112:115]
    v_mfma_f32_16x16x32_bf16 v[124:127], a[72:75], a[24:27], v[124:127]
    v_mfma_f32_16x16x32_bf16 v[124:127], a[76:79], a[28:31], v[124:127]
    s_add_u32 m0, s29, 106496
    v_mfma_f32_16x16x32_bf16 v[120:123], a[68:71], a[28:31], v[120:123]
    buffer_load_dwordx4 v2, s[8:11], s49 offen lds
    v_mfma_f32_16x16x32_bf16 v[120:123], a[64:67], a[24:27], v[120:123]
    v_mfma_f32_16x16x32_bf16 v[128:131], a[64:67], a[32:35], v[128:131]
    v_mfma_f32_16x16x32_bf16 v[128:131], a[68:71], a[36:39], v[128:131]
    v_mfma_f32_16x16x32_bf16 v[132:135], a[76:79], a[36:39], v[132:135]
    s_add_u32 m0, s29, 40960
    v_mfma_f32_16x16x32_bf16 v[132:135], a[72:75], a[32:35], v[132:135]
    buffer_load_dwordx4 v1, s[4:7], s42 offen lds
    v_mfma_f32_16x16x32_bf16 v[136:139], a[80:83], a[32:35], v[136:139]
    v_mfma_f32_16x16x32_bf16 v[136:139], a[84:87], a[36:39], v[136:139]
    v_mfma_f32_16x16x32_bf16 v[140:143], a[92:95], a[36:39], v[140:143]
    v_mfma_f32_16x16x32_bf16 v[140:143], a[88:91], a[32:35], v[140:143]
    s_add_u32 m0, s29, 110592
    v_mfma_f32_16x16x32_bf16 v[148:151], a[88:91], a[40:43], v[148:151]
    buffer_load_dwordx4 v2, s[8:11], s50 offen lds
    v_mfma_f32_16x16x32_bf16 v[148:151], a[92:95], a[44:47], v[148:151]
    v_mfma_f32_16x16x32_bf16 v[144:147], a[84:87], a[44:47], v[144:147]
    v_mfma_f32_16x16x32_bf16 v[144:147], a[80:83], a[40:43], v[144:147]
    v_mfma_f32_16x16x32_bf16 v[156:159], a[72:75], a[40:43], v[156:159]
    s_add_u32 m0, s29, 45056
    v_mfma_f32_16x16x32_bf16 v[156:159], a[76:79], a[44:47], v[156:159]
    buffer_load_dwordx4 v1, s[4:7], s43 offen lds
    v_mfma_f32_16x16x32_bf16 v[152:155], a[68:71], a[44:47], v[152:155]
    v_mfma_f32_16x16x32_bf16 v[152:155], a[64:67], a[40:43], v[152:155]
    v_mfma_f32_16x16x32_bf16 v[160:163], a[64:67], a[48:51], v[160:163]
    v_mfma_f32_16x16x32_bf16 v[160:163], a[68:71], a[52:55], v[160:163]
    s_add_u32 m0, s29, 114688
    v_mfma_f32_16x16x32_bf16 v[164:167], a[76:79], a[52:55], v[164:167]
    buffer_load_dwordx4 v2, s[8:11], s51 offen lds
    v_mfma_f32_16x16x32_bf16 v[164:167], a[72:75], a[48:51], v[164:167]
    v_mfma_f32_16x16x32_bf16 v[168:171], a[80:83], a[48:51], v[168:171]
    v_mfma_f32_16x16x32_bf16 v[168:171], a[84:87], a[52:55], v[168:171]
    v_mfma_f32_16x16x32_bf16 v[172:175], a[92:95], a[52:55], v[172:175]
    s_add_u32 m0, s29, 49152
    v_mfma_f32_16x16x32_bf16 v[172:175], a[88:91], a[48:51], v[172:175]
    buffer_load_dwordx4 v1, s[4:7], s44 offen lds
    v_mfma_f32_16x16x32_bf16 v[180:183], a[88:91], a[56:59], v[180:183]
    v_mfma_f32_16x16x32_bf16 v[180:183], a[92:95], a[60:63], v[180:183]
    v_mfma_f32_16x16x32_bf16 v[176:179], a[84:87], a[60:63], v[176:179]
    v_mfma_f32_16x16x32_bf16 v[176:179], a[80:83], a[56:59], v[176:179]
    s_add_u32 m0, s29, 118784
    v_mfma_f32_16x16x32_bf16 v[188:191], a[72:75], a[56:59], v[188:191]
    s_waitcnt vmcnt(11)
    buffer_load_dwordx4 v2, s[8:11], s52 offen lds
    v_mfma_f32_16x16x32_bf16 v[188:191], a[76:79], a[60:63], v[188:191]
    s_barrier
    ds_read_b64_tr_b16 a[0:1], v6 offset:0
    v_mfma_f32_16x16x32_bf16 v[184:187], a[68:71], a[60:63], v[184:187]
    ds_read_b64_tr_b16 a[2:3], v6 offset:4096
    v_mfma_f32_16x16x32_bf16 v[184:187], a[64:67], a[56:59], v[184:187]
    ds_read_b128 a[64:67], v4 offset:0
    v_mfma_f32_16x16x32_bf16 v[192:195], a[96:99], a[32:35], v[192:195]
    s_add_u32 m0, s29, 53248
    v_mfma_f32_16x16x32_bf16 v[192:195], a[100:103], a[36:39], v[192:195]
    buffer_load_dwordx4 v1, s[4:7], s45 offen lds
    v_mfma_f32_16x16x32_bf16 v[196:199], a[108:111], a[36:39], v[196:199]
    ds_read_b64_tr_b16 a[4:5], v6 offset:16384
    v_mfma_f32_16x16x32_bf16 v[196:199], a[104:107], a[32:35], v[196:199]
    ds_read_b64_tr_b16 a[6:7], v6 offset:20480
    v_mfma_f32_16x16x32_bf16 v[200:203], a[112:115], a[32:35], v[200:203]
    ds_read_b128 a[68:71], v5 offset:0
    v_mfma_f32_16x16x32_bf16 v[200:203], a[116:119], a[36:39], v[200:203]
    s_add_u32 m0, s29, 122880
    v_mfma_f32_16x16x32_bf16 v[204:207], a[124:127], a[36:39], v[204:207]
    buffer_load_dwordx4 v2, s[8:11], s53 offen lds
    v_mfma_f32_16x16x32_bf16 v[204:207], a[120:123], a[32:35], v[204:207]
    ds_read_b128 a[76:79], v5 offset:2048
    v_mfma_f32_16x16x32_bf16 v[212:215], a[120:123], a[40:43], v[212:215]
    v_mfma_f32_16x16x32_bf16 v[212:215], a[124:127], a[44:47], v[212:215]
    ds_read_b128 a[72:75], v4 offset:2048
    v_mfma_f32_16x16x32_bf16 v[208:211], a[116:119], a[44:47], v[208:211]
    s_add_u32 m0, s29, 57344
    v_mfma_f32_16x16x32_bf16 v[208:211], a[112:115], a[40:43], v[208:211]
    buffer_load_dwordx4 v1, s[4:7], s46 offen lds
    v_mfma_f32_16x16x32_bf16 v[220:223], a[104:107], a[40:43], v[220:223]
    ds_read_b128 a[80:83], v4 offset:4096
    v_mfma_f32_16x16x32_bf16 v[220:223], a[108:111], a[44:47], v[220:223]
    v_mfma_f32_16x16x32_bf16 v[216:219], a[100:103], a[44:47], v[216:219]
    ds_read_b128 a[84:87], v5 offset:4096
    v_mfma_f32_16x16x32_bf16 v[216:219], a[96:99], a[40:43], v[216:219]
    s_add_u32 m0, s29, 126976
    v_mfma_f32_16x16x32_bf16 v[224:227], a[96:99], a[48:51], v[224:227]
    buffer_load_dwordx4 v2, s[8:11], s54 offen lds
    v_mfma_f32_16x16x32_bf16 v[224:227], a[100:103], a[52:55], v[224:227]
    ds_read_b128 a[92:95], v5 offset:6144
    v_mfma_f32_16x16x32_bf16 v[228:231], a[108:111], a[52:55], v[228:231]
    v_mfma_f32_16x16x32_bf16 v[228:231], a[104:107], a[48:51], v[228:231]
    ds_read_b128 a[88:91], v4 offset:6144
    v_mfma_f32_16x16x32_bf16 v[232:235], a[112:115], a[48:51], v[232:235]
    s_add_u32 m0, s29, 61440
    v_mfma_f32_16x16x32_bf16 v[232:235], a[116:119], a[52:55], v[232:235]
    buffer_load_dwordx4 v1, s[4:7], s47 offen lds
    v_mfma_f32_16x16x32_bf16 v[236:239], a[124:127], a[52:55], v[236:239]
    v_add_u32 v1, 128, v1
    v_add_u32 v2, 0x80000, v2
    v_mfma_f32_16x16x32_bf16 v[236:239], a[120:123], a[48:51], v[236:239]
    ds_read_b64_tr_b16 a[8:9], v7 offset:0
    v_mfma_f32_16x16x32_bf16 v[244:247], a[120:123], a[56:59], v[244:247]
    buffer_load_dword a243, v14, s[36:39], s56 offen
    v_mfma_f32_16x16x32_bf16 v[244:247], a[124:127], a[60:63], v[244:247]
    s_add_u32 s56, s56, s30
    ds_read_b64_tr_b16 a[10:11], v7 offset:4096
    v_mfma_f32_16x16x32_bf16 v[240:243], a[116:119], a[60:63], v[240:243]
    ds_read_b64_tr_b16 a[12:13], v7 offset:16384
    v_mfma_f32_16x16x32_bf16 v[240:243], a[112:115], a[56:59], v[240:243]
    ds_read_b64_tr_b16 a[14:15], v7 offset:20480
    v_mfma_f32_16x16x32_bf16 v[252:255], a[104:107], a[56:59], v[252:255]
    ds_read_b64_tr_b16 a[16:17], v8 offset:0
    v_mfma_f32_16x16x32_bf16 v[252:255], a[108:111], a[60:63], v[252:255]
    ds_read_b64_tr_b16 a[18:19], v8 offset:4096
    v_mfma_f32_16x16x32_bf16 v[248:251], a[100:103], a[60:63], v[248:251]
    s_add_u32 s61, s61, 1
    ds_read_b64_tr_b16 a[20:21], v8 offset:16384
    v_mfma_f32_16x16x32_bf16 v[248:251], a[96:99], a[56:59], v[248:251]
    s_waitcnt lgkmcnt(8)
    ds_read_b64_tr_b16 a[22:23], v8 offset:20480
    s_cmp_lt_u32 s61, 6
    s_cbranch_scc1 L_vloop
    v_mfma_f32_16x16x32_bf16 v[64:67], a[64:67], a[0:3], v[64:67]
    ds_read_b64_tr_b16 a[24:25], v9 offset:0
    v_accvgpr_read_b32 v15, a240
    v_mfma_f32_16x16x32_bf16 v[64:67], a[68:71], a[4:7], v[64:67]
    ds_read_b64_tr_b16 a[26:27], v9 offset:4096
    v_accvgpr_read_b32 v14, a244
    v_mfma_f32_16x16x32_bf16 v[68:71], a[76:79], a[4:7], v[68:71]
    s_waitcnt lgkmcnt(12)
    ds_read_b64_tr_b16 a[28:29], v9 offset:16384
    global_load_dword a243, v14, s[100:101]
    v_mfma_f32_16x16x32_bf16 v[68:71], a[72:75], a[0:3], v[68:71]
    ds_read_b64_tr_b16 a[30:31], v9 offset:20480
    v_accvgpr_read_b32 v14, a242
    v_mfma_f32_16x16x32_bf16 v[72:75], a[80:83], a[0:3], v[72:75]
    s_add_u32 m0, s33, 0x0
    ds_read_b128 a[96:99], v4 offset:8192
    v_xor_b32 v3, 64, v14
    v_mfma_f32_16x16x32_bf16 v[72:75], a[84:87], a[4:7], v[72:75]
    s_waitcnt lgkmcnt(11)
    v_mfma_f32_16x16x32_bf16 v[76:79], a[92:95], a[4:7], v[76:79]
    ds_read_b128 a[100:103], v5 offset:8192
    buffer_load_dwordx4 v15, s[20:23], 0 offen offset:0 lds
    v_mfma_f32_16x16x32_bf16 v[76:79], a[88:91], a[0:3], v[76:79]
    v_mfma_f32_16x16x32_bf16 v[84:87], a[88:91], a[8:11], v[84:87]
    s_waitcnt lgkmcnt(10)
    ds_read_b128 a[108:111], v5 offset:10240
    v_mfma_f32_16x16x32_bf16 v[84:87], a[92:95], a[12:15], v[84:87]
    s_add_u32 m0, s33, 0x80
    v_mfma_f32_16x16x32_bf16 v[80:83], a[84:87], a[12:15], v[80:83]
    ds_read_b128 a[104:107], v4 offset:10240
    buffer_load_dwordx4 v15, s[20:23], 0 offen offset:896 lds
    v_mfma_f32_16x16x32_bf16 v[80:83], a[80:83], a[8:11], v[80:83]
    v_mfma_f32_16x16x32_bf16 v[92:95], a[72:75], a[8:11], v[92:95]
    ds_read_b128 a[112:115], v4 offset:12288
    v_mfma_f32_16x16x32_bf16 v[92:95], a[76:79], a[12:15], v[92:95]
    s_add_u32 m0, s33, 0x800
    v_mfma_f32_16x16x32_bf16 v[88:91], a[68:71], a[12:15], v[88:91]
    ds_read_b128 a[116:119], v5 offset:12288
    buffer_load_dwordx4 v15, s[20:23], s57 offen offset:0 lds
    v_mfma_f32_16x16x32_bf16 v[88:91], a[64:67], a[8:11], v[88:91]
    s_waitcnt lgkmcnt(10)
    v_mfma_f32_16x16x32_bf16 v[96:99], a[64:67], a[16:19], v[96:99]
    ds_read_b128 a[124:127], v5 offset:14336
    v_mfma_f32_16x16x32_bf16 v[96:99], a[68:71], a[20:23], v[96:99]
    s_add_u32 m0, s33, 0x880
    v_mfma_f32_16x16x32_bf16 v[100:103], a[76:79], a[20:23], v[100:103]
    ds_read_b128 a[120:123], v4 offset:14336
    buffer_load_dwordx4 v15, s[20:23], s57 offen offset:896 lds
    v_mfma_f32_16x16x32_bf16 v[100:103], a[72:75], a[16:19], v[100:103]
    v_mfma_f32_16x16x32_bf16 v[104:107], a[80:83], a[16:19], v[104:107]
    ds_read_b64_tr_b16 a[32:33], v10 offset:0
    v_mfma_f32_16x16x32_bf16 v[104:107], a[84:87], a[20:23], v[104:107]
    s_add_u32 m0, s33, 0xf80
    ds_read_b64_tr_b16 a[34:35], v10 offset:4096
    v_mfma_f32_16x16x32_bf16 v[108:111], a[92:95], a[20:23], v[108:111]
    ds_read_b64_tr_b16 a[36:37], v10 offset:16384
    buffer_load_dwordx4 v15, s[20:23], 0 offen offset:128 lds
    v_mfma_f32_16x16x32_bf16 v[108:111], a[88:91], a[16:19], v[108:111]
    s_waitcnt lgkmcnt(11)
    ds_read_b64_tr_b16 a[38:39], v10 offset:20480
    v_mfma_f32_16x16x32_bf16 v[116:119], a[88:91], a[24:27], v[116:119]
    ds_read_b64_tr_b16 a[40:41], v11 offset:0
    v_mfma_f32_16x16x32_bf16 v[116:119], a[92:95], a[28:31], v[116:119]
    s_add_u32 m0, s33, 0x1000
    ds_read_b64_tr_b16 a[42:43], v11 offset:4096
    v_mfma_f32_16x16x32_bf16 v[112:115], a[84:87], a[28:31], v[112:115]
    ds_read_b64_tr_b16 a[44:45], v11 offset:16384
    buffer_load_dwordx4 v15, s[20:23], 0 offen offset:1024 lds
    v_mfma_f32_16x16x32_bf16 v[112:115], a[80:83], a[24:27], v[112:115]
    ds_read_b64_tr_b16 a[46:47], v11 offset:20480
    v_mfma_f32_16x16x32_bf16 v[124:127], a[72:75], a[24:27], v[124:127]
    ds_read_b64_tr_b16 a[48:49], v12 offset:0
    v_mfma_f32_16x16x32_bf16 v[124:127], a[76:79], a[28:31], v[124:127]
    s_add_u32 m0, s33, 0x1780
    ds_read_b64_tr_b16 a[50:51], v12 offset:4096
    v_mfma_f32_16x16x32_bf16 v[120:123], a[68:71], a[28:31], v[120:123]
    ds_read_b64_tr_b16 a[52:53], v12 offset:16384
    buffer_load_dwordx4 v15, s[20:23], s57 offen offset:128 lds
    v_mfma_f32_16x16x32_bf16 v[120:123], a[64:67], a[24:27], v[120:123]
    s_waitcnt lgkmcnt(15)
    ds_read_b64_tr_b16 a[54:55], v12 offset:20480
    v_mfma_f32_16x16x32_bf16 v[16:19], a[96:99], a[0:3], v[16:19]
    ds_read_b64_tr_b16 a[56:57], v13 offset:0
    v_mfma_f32_16x16x32_bf16 v[16:19], a[100:103], a[4:7], v[16:19]
    s_add_u32 m0, s33, 0x1800
    ds_read_b64_tr_b16 a[58:59], v13 offset:4096
    v_mfma_f32_16x16x32_bf16 v[20:23], a[108:111], a[4:7], v[20:23]
    ds_read_b64_tr_b16 a[60:61], v13 offset:16384
    buffer_load_dwordx4 v15, s[20:23], s57 offen offset:1024 lds
    v_mfma_f32_16x16x32_bf16 v[20:23], a[104:107], a[0:3], v[20:23]
    s_waitcnt lgkmcnt(15)
    ds_read_b64_tr_b16 a[62:63], v13 offset:20480
    v_mfma_f32_16x16x32_bf16 v[24:27], a[112:115], a[0:3], v[24:27]
    v_mfma_f32_16x16x32_bf16 v[24:27], a[116:119], a[4:7], v[24:27]
    v_mfma_f32_16x16x32_bf16 v[28:31], a[124:127], a[4:7], v[28:31]
    v_mfma_f32_16x16x32_bf16 v[28:31], a[120:123], a[0:3], v[28:31]
    s_waitcnt lgkmcnt(0)
    v_mfma_f32_16x16x32_bf16 a[228:231], a[120:123], a[8:11], a[228:231]
    s_barrier
    v_mfma_f32_16x16x32_bf16 a[228:231], a[124:127], a[12:15], a[228:231]
    s_add_u32 m0, s29, 65536
    v_mfma_f32_16x16x32_bf16 a[224:227], a[116:119], a[12:15], a[224:227]
    buffer_load_dwordx4 v2, s[8:11], 0 offen lds
    v_mfma_f32_16x16x32_bf16 a[224:227], a[112:115], a[8:11], a[224:227]
    v_mfma_f32_16x16x32_bf16 a[236:239], a[104:107], a[8:11], a[236:239]
    v_mfma_f32_16x16x32_bf16 a[236:239], a[108:111], a[12:15], a[236:239]
    v_mfma_f32_16x16x32_bf16 a[232:235], a[100:103], a[12:15], a[232:235]
    s_add_u32 m0, s29, 0
    v_mfma_f32_16x16x32_bf16 a[232:235], a[96:99], a[8:11], a[232:235]
    buffer_load_dwordx4 v1, s[4:7], 0 offen lds
    v_mfma_f32_16x16x32_bf16 v[32:35], a[96:99], a[16:19], v[32:35]
    v_mfma_f32_16x16x32_bf16 v[32:35], a[100:103], a[20:23], v[32:35]
    v_mfma_f32_16x16x32_bf16 v[36:39], a[108:111], a[20:23], v[36:39]
    v_mfma_f32_16x16x32_bf16 v[36:39], a[104:107], a[16:19], v[36:39]
    s_add_u32 m0, s29, 69632
    v_mfma_f32_16x16x32_bf16 v[40:43], a[112:115], a[16:19], v[40:43]
    buffer_load_dwordx4 v2, s[8:11], s48 offen lds
    v_mfma_f32_16x16x32_bf16 v[40:43], a[116:119], a[20:23], v[40:43]
    v_mfma_f32_16x16x32_bf16 v[44:47], a[124:127], a[20:23], v[44:47]
    v_mfma_f32_16x16x32_bf16 v[44:47], a[120:123], a[16:19], v[44:47]
    v_mfma_f32_16x16x32_bf16 v[52:55], a[120:123], a[24:27], v[52:55]
    s_add_u32 m0, s29, 4096
    v_mfma_f32_16x16x32_bf16 v[52:55], a[124:127], a[28:31], v[52:55]
    buffer_load_dwordx4 v1, s[4:7], s41 offen lds
    v_mfma_f32_16x16x32_bf16 v[48:51], a[116:119], a[28:31], v[48:51]
    v_mfma_f32_16x16x32_bf16 v[48:51], a[112:115], a[24:27], v[48:51]
    v_mfma_f32_16x16x32_bf16 v[60:63], a[104:107], a[24:27], v[60:63]
    v_mfma_f32_16x16x32_bf16 v[60:63], a[108:111], a[28:31], v[60:63]
    s_add_u32 m0, s29, 73728
    v_mfma_f32_16x16x32_bf16 v[56:59], a[100:103], a[28:31], v[56:59]
    buffer_load_dwordx4 v2, s[8:11], s49 offen lds
    v_mfma_f32_16x16x32_bf16 v[56:59], a[96:99], a[24:27], v[56:59]
    v_mfma_f32_16x16x32_bf16 v[192:195], a[96:99], a[32:35], v[192:195]
    v_mfma_f32_16x16x32_bf16 v[192:195], a[100:103], a[36:39], v[192:195]
    v_mfma_f32_16x16x32_bf16 v[196:199], a[108:111], a[36:39], v[196:199]
    s_add_u32 m0, s29, 8192
    v_mfma_f32_16x16x32_bf16 v[196:199], a[104:107], a[32:35], v[196:199]
    buffer_load_dwordx4 v1, s[4:7], s42 offen lds
    v_mfma_f32_16x16x32_bf16 v[200:203], a[112:115], a[32:35], v[200:203]
    v_mfma_f32_16x16x32_bf16 v[200:203], a[116:119], a[36:39], v[200:203]
    v_mfma_f32_16x16x32_bf16 v[204:207], a[124:127], a[36:39], v[204:207]
    v_mfma_f32_16x16x32_bf16 v[204:207], a[120:123], a[32:35], v[204:207]
    s_add_u32 m0, s29, 77824
    v_mfma_f32_16x16x32_bf16 v[212:215], a[120:123], a[40:43], v[212:215]
    buffer_load_dwordx4 v2, s[8:11], s50 offen lds
    v_mfma_f32_16x16x32_bf16 v[212:215], a[124:127], a[44:47], v[212:215]
    v_mfma_f32_16x16x32_bf16 v[208:211], a[116:119], a[44:47], v[208:211]
    v_mfma_f32_16x16x32_bf16 v[208:211], a[112:115], a[40:43], v[208:211]
    v_mfma_f32_16x16x32_bf16 v[220:223], a[104:107], a[40:43], v[220:223]
    s_add_u32 m0, s29, 12288
    v_mfma_f32_16x16x32_bf16 v[220:223], a[108:111], a[44:47], v[220:223]
    buffer_load_dwordx4 v1, s[4:7], s43 offen lds
    v_mfma_f32_16x16x32_bf16 v[216:219], a[100:103], a[44:47], v[216:219]
    v_mfma_f32_16x16x32_bf16 v[216:219], a[96:99], a[40:43], v[216:219]
    v_mfma_f32_16x16x32_bf16 v[224:227], a[96:99], a[48:51], v[224:227]
    v_mfma_f32_16x16x32_bf16 v[224:227], a[100:103], a[52:55], v[224:227]
    s_add_u32 m0, s29, 81920
    v_mfma_f32_16x16x32_bf16 v[228:231], a[108:111], a[52:55], v[228:231]
    buffer_load_dwordx4 v2, s[8:11], s51 offen lds
    v_mfma_f32_16x16x32_bf16 v[228:231], a[104:107], a[48:51], v[228:231]
    v_mfma_f32_16x16x32_bf16 v[232:235], a[112:115], a[48:51], v[232:235]
    v_mfma_f32_16x16x32_bf16 v[232:235], a[116:119], a[52:55], v[232:235]
    v_mfma_f32_16x16x32_bf16 v[236:239], a[124:127], a[52:55], v[236:239]
    s_add_u32 m0, s29, 16384
    v_mfma_f32_16x16x32_bf16 v[236:239], a[120:123], a[48:51], v[236:239]
    buffer_load_dwordx4 v1, s[4:7], s44 offen lds
    v_mfma_f32_16x16x32_bf16 v[244:247], a[120:123], a[56:59], v[244:247]
    v_mfma_f32_16x16x32_bf16 v[244:247], a[124:127], a[60:63], v[244:247]
    v_mfma_f32_16x16x32_bf16 v[240:243], a[116:119], a[60:63], v[240:243]
    v_mfma_f32_16x16x32_bf16 v[240:243], a[112:115], a[56:59], v[240:243]
    s_add_u32 m0, s29, 86016
    v_mfma_f32_16x16x32_bf16 v[252:255], a[104:107], a[56:59], v[252:255]
    s_waitcnt vmcnt(10)
    buffer_load_dwordx4 v2, s[8:11], s52 offen lds
    v_mfma_f32_16x16x32_bf16 v[252:255], a[108:111], a[60:63], v[252:255]
    s_barrier
    ds_read_b64_tr_b16 a[0:1], v6 offset:32768
    v_mfma_f32_16x16x32_bf16 v[248:251], a[100:103], a[60:63], v[248:251]
    ds_read_b64_tr_b16 a[2:3], v6 offset:36864
    v_mfma_f32_16x16x32_bf16 v[248:251], a[96:99], a[56:59], v[248:251]
    ds_read_b128 a[96:99], v4 offset:40960
    v_mfma_f32_16x16x32_bf16 v[128:131], a[64:67], a[32:35], v[128:131]
    s_add_u32 m0, s29, 20480
    ds_read_b128 a[128:131], v14 offset:0
    v_mfma_f32_16x16x32_bf16 v[128:131], a[68:71], a[36:39], v[128:131]
    buffer_load_dwordx4 v1, s[4:7], s45 offen lds
    v_mfma_f32_16x16x32_bf16 v[132:135], a[76:79], a[36:39], v[132:135]
    ds_read_b64_tr_b16 a[4:5], v6 offset:49152
    v_mfma_f32_16x16x32_bf16 v[132:135], a[72:75], a[32:35], v[132:135]
    ds_read_b64_tr_b16 a[6:7], v6 offset:53248
    v_mfma_f32_16x16x32_bf16 v[136:139], a[80:83], a[32:35], v[136:139]
    ds_read_b128 a[100:103], v5 offset:40960
    v_mfma_f32_16x16x32_bf16 v[136:139], a[84:87], a[36:39], v[136:139]
    s_add_u32 m0, s29, 90112
    ds_read_b128 a[136:139], v3 offset:0
    v_mfma_f32_16x16x32_bf16 v[140:143], a[92:95], a[36:39], v[140:143]
    buffer_load_dwordx4 v2, s[8:11], s53 offen lds
    v_mfma_f32_16x16x32_bf16 v[140:143], a[88:91], a[32:35], v[140:143]
    ds_read_b128 a[108:111], v5 offset:43008
    v_mfma_f32_16x16x32_bf16 v[148:151], a[88:91], a[40:43], v[148:151]
    ds_read_b128 a[132:135], v14 offset:2048
    v_mfma_f32_16x16x32_bf16 v[148:151], a[92:95], a[44:47], v[148:151]
    ds_read_b128 a[104:107], v4 offset:43008
    v_mfma_f32_16x16x32_bf16 v[144:147], a[84:87], a[44:47], v[144:147]
    s_add_u32 m0, s29, 24576
    ds_read_b128 a[140:143], v3 offset:2048
    v_mfma_f32_16x16x32_bf16 v[144:147], a[80:83], a[40:43], v[144:147]
    buffer_load_dwordx4 v1, s[4:7], s46 offen lds
    v_mfma_f32_16x16x32_bf16 v[156:159], a[72:75], a[40:43], v[156:159]
    ds_read_b128 a[112:115], v4 offset:45056
    v_mfma_f32_16x16x32_bf16 v[156:159], a[76:79], a[44:47], v[156:159]
    ds_read_b128 a[144:147], v14 offset:4096
    v_mfma_f32_16x16x32_bf16 v[152:155], a[68:71], a[44:47], v[152:155]
    ds_read_b128 a[116:119], v5 offset:45056
    v_mfma_f32_16x16x32_bf16 v[152:155], a[64:67], a[40:43], v[152:155]
    s_add_u32 m0, s29, 94208
    ds_read_b128 a[152:155], v3 offset:4096
    v_mfma_f32_16x16x32_bf16 v[160:163], a[64:67], a[48:51], v[160:163]
    buffer_load_dwordx4 v2, s[8:11], s54 offen lds
    v_mfma_f32_16x16x32_bf16 v[160:163], a[68:71], a[52:55], v[160:163]
    ds_read_b128 a[124:127], v5 offset:47104
    v_mfma_f32_16x16x32_bf16 v[164:167], a[76:79], a[52:55], v[164:167]
    ds_read_b128 a[148:151], v14 offset:6144
    v_mfma_f32_16x16x32_bf16 v[164:167], a[72:75], a[48:51], v[164:167]
    ds_read_b128 a[120:123], v4 offset:47104
    v_mfma_f32_16x16x32_bf16 v[168:171], a[80:83], a[48:51], v[168:171]
    s_add_u32 m0, s29, 28672
    ds_read_b128 a[156:159], v3 offset:6144
    v_mfma_f32_16x16x32_bf16 v[168:171], a[84:87], a[52:55], v[168:171]
    buffer_load_dwordx4 v1, s[4:7], s47 offen lds
    v_mfma_f32_16x16x32_bf16 v[172:175], a[92:95], a[52:55], v[172:175]
    v_add_u32 v1, 128, v1
    v_add_u32 v2, 0x80000, v2
    v_mfma_f32_16x16x32_bf16 v[172:175], a[88:91], a[48:51], v[172:175]
    ds_read_b64_tr_b16 a[8:9], v7 offset:32768
    v_mfma_f32_16x16x32_bf16 v[180:183], a[88:91], a[56:59], v[180:183]
    v_mfma_f32_16x16x32_bf16 v[180:183], a[92:95], a[60:63], v[180:183]
    ds_read_b64_tr_b16 a[10:11], v7 offset:36864
    v_mfma_f32_16x16x32_bf16 v[176:179], a[84:87], a[60:63], v[176:179]
    ds_read_b64_tr_b16 a[12:13], v7 offset:49152
    v_mfma_f32_16x16x32_bf16 v[176:179], a[80:83], a[56:59], v[176:179]
    ds_read_b64_tr_b16 a[14:15], v7 offset:53248
    v_mfma_f32_16x16x32_bf16 v[188:191], a[72:75], a[56:59], v[188:191]
    ds_read_b64_tr_b16 a[16:17], v8 offset:32768
    v_mfma_f32_16x16x32_bf16 v[188:191], a[76:79], a[60:63], v[188:191]
    ds_read_b64_tr_b16 a[18:19], v8 offset:36864
    v_mfma_f32_16x16x32_bf16 v[184:187], a[68:71], a[60:63], v[184:187]
    ds_read_b64_tr_b16 a[20:21], v8 offset:49152
    v_mfma_f32_16x16x32_bf16 v[184:187], a[64:67], a[56:59], v[184:187]
    s_waitcnt lgkmcnt(15)
    ds_read_b64_tr_b16 a[22:23], v8 offset:53248
    v_mfma_f32_16x16x32_bf16 v[16:19], a[96:99], a[0:3], v[16:19]
    ds_read_b64_tr_b16 a[24:25], v9 offset:32768
    v_mfma_f32_16x16x32_bf16 v[16:19], a[100:103], a[4:7], v[16:19]
    s_add_u32 m0, s33, 0xffffff00
    ds_read_b64_tr_b16 a[26:27], v9 offset:36864
    v_mfma_f32_16x16x32_bf16 v[20:23], a[108:111], a[4:7], v[20:23]
    s_waitcnt lgkmcnt(10)
    ds_read_b64_tr_b16 a[28:29], v9 offset:49152
    v_mfma_f32_16x16x32_bf16 v[20:23], a[104:107], a[0:3], v[20:23]
    ds_read_b64_tr_b16 a[30:31], v9 offset:53248
    buffer_load_dwordx4 v15, s[20:23], 0 offen offset:256 lds
    v_mfma_f32_16x16x32_bf16 v[24:27], a[112:115], a[0:3], v[24:27]
    ds_read_b128 a[64:67], v4 offset:32768
    v_mfma_f32_16x16x32_bf16 v[24:27], a[116:119], a[4:7], v[24:27]
    v_mfma_f32_16x16x32_bf16 v[28:31], a[124:127], a[4:7], v[28:31]
    s_add_u32 m0, s33, 0xffffff80
    ds_read_b128 a[68:71], v5 offset:32768
    v_mfma_f32_16x16x32_bf16 v[28:31], a[120:123], a[0:3], v[28:31]
    s_waitcnt lgkmcnt(10)
    buffer_load_dwordx4 v15, s[20:23], 0 offen offset:1152 lds
    v_mfma_f32_16x16x32_bf16 a[228:231], a[120:123], a[8:11], a[228:231]
    ds_read_b128 a[76:79], v5 offset:34816
    v_mfma_f32_16x16x32_bf16 a[228:231], a[124:127], a[12:15], a[228:231]
    v_mfma_f32_16x16x32_bf16 a[224:227], a[116:119], a[12:15], a[224:227]
    s_add_u32 m0, s33, 0x700
    ds_read_b128 a[72:75], v4 offset:34816
    v_mfma_f32_16x16x32_bf16 a[224:227], a[112:115], a[8:11], a[224:227]
    buffer_load_dwordx4 v15, s[20:23], s57 offen offset:256 lds
    v_mfma_f32_16x16x32_bf16 a[236:239], a[104:107], a[8:11], a[236:239]
    ds_read_b128 a[80:83], v4 offset:36864
    v_mfma_f32_16x16x32_bf16 a[236:239], a[108:111], a[12:15], a[236:239]
    v_mfma_f32_16x16x32_bf16 a[232:235], a[100:103], a[12:15], a[232:235]
    s_add_u32 m0, s33, 0x780
    ds_read_b128 a[84:87], v5 offset:36864
    v_mfma_f32_16x16x32_bf16 a[232:235], a[96:99], a[8:11], a[232:235]
    s_waitcnt lgkmcnt(10)
    buffer_load_dwordx4 v15, s[20:23], s57 offen offset:1152 lds
    v_mfma_f32_16x16x32_bf16 v[32:35], a[96:99], a[16:19], v[32:35]
    ds_read_b128 a[92:95], v5 offset:38912
    v_mfma_f32_16x16x32_bf16 v[32:35], a[100:103], a[20:23], v[32:35]
    v_mfma_f32_16x16x32_bf16 v[36:39], a[108:111], a[20:23], v[36:39]
    s_add_u32 m0, s33, 0xe80
    ds_read_b128 a[88:91], v4 offset:38912
    v_mfma_f32_16x16x32_bf16 v[36:39], a[104:107], a[16:19], v[36:39]
    buffer_load_dwordx4 v15, s[20:23], 0 offen offset:384 lds
    v_mfma_f32_16x16x32_bf16 v[40:43], a[112:115], a[16:19], v[40:43]
    ds_read_b64_tr_b16 a[32:33], v10 offset:32768
    v_mfma_f32_16x16x32_bf16 v[40:43], a[116:119], a[20:23], v[40:43]
    ds_read_b64_tr_b16 a[34:35], v10 offset:36864
    v_mfma_f32_16x16x32_bf16 v[44:47], a[124:127], a[20:23], v[44:47]
    s_add_u32 m0, s33, 0xf00
    ds_read_b64_tr_b16 a[36:37], v10 offset:49152
    v_mfma_f32_16x16x32_bf16 v[44:47], a[120:123], a[16:19], v[44:47]
    s_waitcnt lgkmcnt(11)
    ds_read_b64_tr_b16 a[38:39], v10 offset:53248
    buffer_load_dwordx4 v15, s[20:23], 0 offen offset:1280 lds
    v_mfma_f32_16x16x32_bf16 v[52:55], a[120:123], a[24:27], v[52:55]
    ds_read_b64_tr_b16 a[40:41], v11 offset:32768
    v_mfma_f32_16x16x32_bf16 v[52:55], a[124:127], a[28:31], v[52:55]
    ds_read_b64_tr_b16 a[42:43], v11 offset:36864
    v_mfma_f32_16x16x32_bf16 v[48:51], a[116:119], a[28:31], v[48:51]
    s_add_u32 m0, s33, 0x1680
    ds_read_b64_tr_b16 a[44:45], v11 offset:49152
    v_mfma_f32_16x16x32_bf16 v[48:51], a[112:115], a[24:27], v[48:51]
    ds_read_b64_tr_b16 a[46:47], v11 offset:53248
    buffer_load_dwordx4 v15, s[20:23], s57 offen offset:384 lds
    v_mfma_f32_16x16x32_bf16 v[60:63], a[104:107], a[24:27], v[60:63]
    ds_read_b64_tr_b16 a[48:49], v12 offset:32768
    v_mfma_f32_16x16x32_bf16 v[60:63], a[108:111], a[28:31], v[60:63]
    ds_read_b64_tr_b16 a[50:51], v12 offset:36864
    v_mfma_f32_16x16x32_bf16 v[56:59], a[100:103], a[28:31], v[56:59]
    s_add_u32 m0, s33, 0x1700
    ds_read_b64_tr_b16 a[52:53], v12 offset:49152
    v_mfma_f32_16x16x32_bf16 v[56:59], a[96:99], a[24:27], v[56:59]
    s_waitcnt lgkmcnt(15)
    ds_read_b64_tr_b16 a[54:55], v12 offset:53248
    buffer_load_dwordx4 v15, s[20:23], s57 offen offset:1280 lds
    v_mfma_f32_16x16x32_bf16 v[64:67], a[64:67], a[0:3], v[64:67]
    ds_read_b64_tr_b16 a[56:57], v13 offset:32768
    v_mfma_f32_16x16x32_bf16 v[64:67], a[68:71], a[4:7], v[64:67]
    ds_read_b64_tr_b16 a[58:59], v13 offset:36864
    v_mfma_f32_16x16x32_bf16 v[68:71], a[76:79], a[4:7], v[68:71]
    ds_read_b64_tr_b16 a[60:61], v13 offset:49152
    v_mfma_f32_16x16x32_bf16 v[68:71], a[72:75], a[0:3], v[68:71]
    s_waitcnt lgkmcnt(15)
    ds_read_b64_tr_b16 a[62:63], v13 offset:53248
    v_mfma_f32_16x16x32_bf16 v[72:75], a[80:83], a[0:3], v[72:75]
    v_mfma_f32_16x16x32_bf16 v[72:75], a[84:87], a[4:7], v[72:75]
    v_mfma_f32_16x16x32_bf16 v[76:79], a[92:95], a[4:7], v[76:79]
    v_mfma_f32_16x16x32_bf16 v[76:79], a[88:91], a[0:3], v[76:79]
    s_waitcnt lgkmcnt(0)
    v_mfma_f32_16x16x32_bf16 v[84:87], a[88:91], a[8:11], v[84:87]
    s_barrier
    v_mfma_f32_16x16x32_bf16 v[84:87], a[92:95], a[12:15], v[84:87]
    s_add_u32 m0, s29, 98304
    v_mfma_f32_16x16x32_bf16 v[80:83], a[84:87], a[12:15], v[80:83]
    buffer_load_dwordx4 v2, s[8:11], 0 offen lds
    v_mfma_f32_16x16x32_bf16 v[80:83], a[80:83], a[8:11], v[80:83]
    v_mfma_f32_16x16x32_bf16 v[92:95], a[72:75], a[8:11], v[92:95]
    v_mfma_f32_16x16x32_bf16 v[92:95], a[76:79], a[12:15], v[92:95]
    v_mfma_f32_16x16x32_bf16 v[88:91], a[68:71], a[12:15], v[88:91]
    s_add_u32 m0, s29, 32768
    v_mfma_f32_16x16x32_bf16 v[88:91], a[64:67], a[8:11], v[88:91]
    buffer_load_dwordx4 v1, s[4:7], 0 offen lds
    v_mfma_f32_16x16x32_bf16 v[96:99], a[64:67], a[16:19], v[96:99]
    v_mfma_f32_16x16x32_bf16 v[96:99], a[68:71], a[20:23], v[96:99]
    v_mfma_f32_16x16x32_bf16 v[100:103], a[76:79], a[20:23], v[100:103]
    v_mfma_f32_16x16x32_bf16 v[100:103], a[72:75], a[16:19], v[100:103]
    s_add_u32 m0, s29, 102400
    v_mfma_f32_16x16x32_bf16 v[104:107], a[80:83], a[16:19], v[104:107]
    buffer_load_dwordx4 v2, s[8:11], s48 offen lds
    v_mfma_f32_16x16x32_bf16 v[104:107], a[84:87], a[20:23], v[104:107]
    v_mfma_f32_16x16x32_bf16 v[108:111], a[92:95], a[20:23], v[108:111]
    v_mfma_f32_16x16x32_bf16 v[108:111], a[88:91], a[16:19], v[108:111]
    v_mfma_f32_16x16x32_bf16 v[116:119], a[88:91], a[24:27], v[116:119]
    s_add_u32 m0, s29, 36864
    v_mfma_f32_16x16x32_bf16 v[116:119], a[92:95], a[28:31], v[116:119]
    buffer_load_dwordx4 v1, s[4:7], s41 offen lds
    v_mfma_f32_16x16x32_bf16 v[112:115], a[84:87], a[28:31], v[112:115]
    v_mfma_f32_16x16x32_bf16 v[112:115], a[80:83], a[24:27], v[112:115]
    v_mfma_f32_16x16x32_bf16 v[124:127], a[72:75], a[24:27], v[124:127]
    v_mfma_f32_16x16x32_bf16 v[124:127], a[76:79], a[28:31], v[124:127]
    s_add_u32 m0, s29, 106496
    v_mfma_f32_16x16x32_bf16 v[120:123], a[68:71], a[28:31], v[120:123]
    buffer_load_dwordx4 v2, s[8:11], s49 offen lds
    v_mfma_f32_16x16x32_bf16 v[120:123], a[64:67], a[24:27], v[120:123]
    v_mfma_f32_16x16x32_bf16 v[128:131], a[64:67], a[32:35], v[128:131]
    v_mfma_f32_16x16x32_bf16 v[128:131], a[68:71], a[36:39], v[128:131]
    v_mfma_f32_16x16x32_bf16 v[132:135], a[76:79], a[36:39], v[132:135]
    s_add_u32 m0, s29, 40960
    v_mfma_f32_16x16x32_bf16 v[132:135], a[72:75], a[32:35], v[132:135]
    buffer_load_dwordx4 v1, s[4:7], s42 offen lds
    v_mfma_f32_16x16x32_bf16 v[136:139], a[80:83], a[32:35], v[136:139]
    v_mfma_f32_16x16x32_bf16 v[136:139], a[84:87], a[36:39], v[136:139]
    v_mfma_f32_16x16x32_bf16 v[140:143], a[92:95], a[36:39], v[140:143]
    v_mfma_f32_16x16x32_bf16 v[140:143], a[88:91], a[32:35], v[140:143]
    s_add_u32 m0, s29, 110592
    v_mfma_f32_16x16x32_bf16 v[148:151], a[88:91], a[40:43], v[148:151]
    buffer_load_dwordx4 v2, s[8:11], s50 offen lds
    v_mfma_f32_16x16x32_bf16 v[148:151], a[92:95], a[44:47], v[148:151]
    v_mfma_f32_16x16x32_bf16 v[144:147], a[84:87], a[44:47], v[144:147]
    v_mfma_f32_16x16x32_bf16 v[144:147], a[80:83], a[40:43], v[144:147]
    v_mfma_f32_16x16x32_bf16 v[156:159], a[72:75], a[40:43], v[156:159]
    s_add_u32 m0, s29, 45056
    v_mfma_f32_16x16x32_bf16 v[156:159], a[76:79], a[44:47], v[156:159]
    buffer_load_dwordx4 v1, s[4:7], s43 offen lds
    v_mfma_f32_16x16x32_bf16 v[152:155], a[68:71], a[44:47], v[152:155]
    v_mfma_f32_16x16x32_bf16 v[152:155], a[64:67], a[40:43], v[152:155]
    v_mfma_f32_16x16x32_bf16 v[160:163], a[64:67], a[48:51], v[160:163]
    v_mfma_f32_16x16x32_bf16 v[160:163], a[68:71], a[52:55], v[160:163]
    s_add_u32 m0, s29, 114688
    v_mfma_f32_16x16x32_bf16 v[164:167], a[76:79], a[52:55], v[164:167]
    buffer_load_dwordx4 v2, s[8:11], s51 offen lds
    v_mfma_f32_16x16x32_bf16 v[164:167], a[72:75], a[48:51], v[164:167]
    v_mfma_f32_16x16x32_bf16 v[168:171], a[80:83], a[48:51], v[168:171]
    v_mfma_f32_16x16x32_bf16 v[168:171], a[84:87], a[52:55], v[168:171]
    v_mfma_f32_16x16x32_bf16 v[172:175], a[92:95], a[52:55], v[172:175]
    s_add_u32 m0, s29, 49152
    v_mfma_f32_16x16x32_bf16 v[172:175], a[88:91], a[48:51], v[172:175]
    buffer_load_dwordx4 v1, s[4:7], s44 offen lds
    v_mfma_f32_16x16x32_bf16 v[180:183], a[88:91], a[56:59], v[180:183]
    v_mfma_f32_16x16x32_bf16 v[180:183], a[92:95], a[60:63], v[180:183]
    v_mfma_f32_16x16x32_bf16 v[176:179], a[84:87], a[60:63], v[176:179]
    v_mfma_f32_16x16x32_bf16 v[176:179], a[80:83], a[56:59], v[176:179]
    s_add_u32 m0, s29, 118784
    v_mfma_f32_16x16x32_bf16 v[188:191], a[72:75], a[56:59], v[188:191]
    s_waitcnt vmcnt(10)
    buffer_load_dwordx4 v2, s[8:11], s52 offen lds
    v_mfma_f32_16x16x32_bf16 v[188:191], a[76:79], a[60:63], v[188:191]
    s_barrier
    ds_read_b64_tr_b16 a[0:1], v6 offset:0
    v_mfma_f32_16x16x32_bf16 v[184:187], a[68:71], a[60:63], v[184:187]
    ds_read_b64_tr_b16 a[2:3], v6 offset:4096
    v_mfma_f32_16x16x32_bf16 v[184:187], a[64:67], a[56:59], v[184:187]
    ds_read_b128 a[64:67], v4 offset:0
    v_mfma_f32_16x16x32_bf16 v[192:195], a[96:99], a[32:35], v[192:195]
    s_add_u32 m0, s29, 53248
    ds_read_b128 a[160:163], v14 offset:0
    v_mfma_f32_16x16x32_bf16 v[192:195], a[100:103], a[36:39], v[192:195]
    buffer_load_dwordx4 v1, s[4:7], s45 offen lds
    v_mfma_f32_16x16x32_bf16 v[196:199], a[108:111], a[36:39], v[196:199]
    ds_read_b64_tr_b16 a[4:5], v6 offset:16384
    v_mfma_f32_16x16x32_bf16 v[196:199], a[104:107], a[32:35], v[196:199]
    ds_read_b64_tr_b16 a[6:7], v6 offset:20480
    v_mfma_f32_16x16x32_bf16 v[200:203], a[112:115], a[32:35], v[200:203]
    ds_read_b128 a[68:71], v5 offset:0
    v_mfma_f32_16x16x32_bf16 v[200:203], a[116:119], a[36:39], v[200:203]
    s_add_u32 m0, s29, 122880
    ds_read_b128 a[168:171], v3 offset:0
    v_mfma_f32_16x16x32_bf16 v[204:207], a[124:127], a[36:39], v[204:207]
    buffer_load_dwordx4 v2, s[8:11], s53 offen lds
    v_mfma_f32_16x16x32_bf16 v[204:207], a[120:123], a[32:35], v[204:207]
    ds_read_b128 a[76:79], v5 offset:2048
    v_mfma_f32_16x16x32_bf16 v[212:215], a[120:123], a[40:43], v[212:215]
    ds_read_b128 a[164:167], v14 offset:2048
    v_mfma_f32_16x16x32_bf16 v[212:215], a[124:127], a[44:47], v[212:215]
    ds_read_b128 a[72:75], v4 offset:2048
    v_mfma_f32_16x16x32_bf16 v[208:211], a[116:119], a[44:47], v[208:211]
    s_add_u32 m0, s29, 57344
    ds_read_b128 a[172:175], v3 offset:2048
    v_mfma_f32_16x16x32_bf16 v[208:211], a[112:115], a[40:43], v[208:211]
    buffer_load_dwordx4 v1, s[4:7], s46 offen lds
    v_mfma_f32_16x16x32_bf16 v[220:223], a[104:107], a[40:43], v[220:223]
    ds_read_b128 a[80:83], v4 offset:4096
    v_mfma_f32_16x16x32_bf16 v[220:223], a[108:111], a[44:47], v[220:223]
    ds_read_b128 a[176:179], v14 offset:4096
    v_mfma_f32_16x16x32_bf16 v[216:219], a[100:103], a[44:47], v[216:219]
    ds_read_b128 a[84:87], v5 offset:4096
    v_mfma_f32_16x16x32_bf16 v[216:219], a[96:99], a[40:43], v[216:219]
    s_add_u32 m0, s29, 126976
    ds_read_b128 a[184:187], v3 offset:4096
    v_mfma_f32_16x16x32_bf16 v[224:227], a[96:99], a[48:51], v[224:227]
    buffer_load_dwordx4 v2, s[8:11], s54 offen lds
    v_mfma_f32_16x16x32_bf16 v[224:227], a[100:103], a[52:55], v[224:227]
    ds_read_b128 a[92:95], v5 offset:6144
    v_mfma_f32_16x16x32_bf16 v[228:231], a[108:111], a[52:55], v[228:231]
    ds_read_b128 a[180:183], v14 offset:6144
    v_mfma_f32_16x16x32_bf16 v[228:231], a[104:107], a[48:51], v[228:231]
    ds_read_b128 a[88:91], v4 offset:6144
    v_mfma_f32_16x16x32_bf16 v[232:235], a[112:115], a[48:51], v[232:235]
    s_add_u32 m0, s29, 61440
    ds_read_b128 a[188:191], v3 offset:6144
    v_mfma_f32_16x16x32_bf16 v[232:235], a[116:119], a[52:55], v[232:235]
    buffer_load_dwordx4 v1, s[4:7], s47 offen lds
    v_mfma_f32_16x16x32_bf16 v[236:239], a[124:127], a[52:55], v[236:239]
    v_add_u32 v1, 128, v1
    v_add_u32 v2, 0x80000, v2
    v_mfma_f32_16x16x32_bf16 v[236:239], a[120:123], a[48:51], v[236:239]
    ds_read_b64_tr_b16 a[8:9], v7 offset:0
    v_mfma_f32_16x16x32_bf16 v[244:247], a[120:123], a[56:59], v[244:247]
    v_mfma_f32_16x16x32_bf16 v[244:247], a[124:127], a[60:63], v[244:247]
    ds_read_b64_tr_b16 a[10:11], v7 offset:4096
    v_mfma_f32_16x16x32_bf16 v[240:243], a[116:119], a[60:63], v[240:243]
    ds_read_b64_tr_b16 a[12:13], v7 offset:16384
    v_mfma_f32_16x16x32_bf16 v[240:243], a[112:115], a[56:59], v[240:243]
    ds_read_b64_tr_b16 a[14:15], v7 offset:20480
    v_mfma_f32_16x16x32_bf16 v[252:255], a[104:107], a[56:59], v[252:255]
    ds_read_b64_tr_b16 a[16:17], v8 offset:0
    v_mfma_f32_16x16x32_bf16 v[252:255], a[108:111], a[60:63], v[252:255]
    ds_read_b64_tr_b16 a[18:19], v8 offset:4096
    v_mfma_f32_16x16x32_bf16 v[248:251], a[100:103], a[60:63], v[248:251]
    ds_read_b64_tr_b16 a[20:21], v8 offset:16384
    v_mfma_f32_16x16x32_bf16 v[248:251], a[96:99], a[56:59], v[248:251]
    s_waitcnt lgkmcnt(15)
    ds_read_b64_tr_b16 a[22:23], v8 offset:20480
    v_mfma_f32_16x16x32_bf16 v[64:67], a[64:67], a[0:3], v[64:67]
    ds_read_b64_tr_b16 a[24:25], v9 offset:0
    v_lshlrev_b32 v1, 4, v0
    v_mfma_f32_16x16x32_bf16 v[64:67], a[68:71], a[4:7], v[64:67]
    s_add_u32 m0, s33, 0xfffffe00
    ds_read_b64_tr_b16 a[26:27], v9 offset:4096
    v_mfma_f32_16x16x32_bf16 v[68:71], a[76:79], a[4:7], v[68:71]
    s_waitcnt lgkmcnt(10)
    ds_read_b64_tr_b16 a[28:29], v9 offset:16384
    v_mfma_f32_16x16x32_bf16 v[68:71], a[72:75], a[0:3], v[68:71]
    ds_read_b64_tr_b16 a[30:31], v9 offset:20480
    buffer_load_dwordx4 v15, s[20:23], 0 offen offset:512 lds
    v_mfma_f32_16x16x32_bf16 v[72:75], a[80:83], a[0:3], v[72:75]
    ds_read_b128 a[96:99], v4 offset:8192
    v_mfma_f32_16x16x32_bf16 v[72:75], a[84:87], a[4:7], v[72:75]
    v_mfma_f32_16x16x32_bf16 v[76:79], a[92:95], a[4:7], v[76:79]
    s_add_u32 m0, s33, 0xfffffe80
    ds_read_b128 a[100:103], v5 offset:8192
    v_mfma_f32_16x16x32_bf16 v[76:79], a[88:91], a[0:3], v[76:79]
    s_waitcnt lgkmcnt(10)
    buffer_load_dwordx4 v15, s[20:23], 0 offen offset:1408 lds
    v_mfma_f32_16x16x32_bf16 v[84:87], a[88:91], a[8:11], v[84:87]
    ds_read_b128 a[108:111], v5 offset:10240
    v_mfma_f32_16x16x32_bf16 v[84:87], a[92:95], a[12:15], v[84:87]
    v_mfma_f32_16x16x32_bf16 v[80:83], a[84:87], a[12:15], v[80:83]
    s_add_u32 m0, s33, 0x600
    ds_read_b128 a[104:107], v4 offset:10240
    v_mfma_f32_16x16x32_bf16 v[80:83], a[80:83], a[8:11], v[80:83]
    buffer_load_dwordx4 v15, s[20:23], s57 offen offset:512 lds
    v_mfma_f32_16x16x32_bf16 v[92:95], a[72:75], a[8:11], v[92:95]
    ds_read_b128 a[112:115], v4 offset:12288
    v_mfma_f32_16x16x32_bf16 v[92:95], a[76:79], a[12:15], v[92:95]
    v_mfma_f32_16x16x32_bf16 v[88:91], a[68:71], a[12:15], v[88:91]
    s_add_u32 m0, s33, 0x680
    ds_read_b128 a[116:119], v5 offset:12288
    v_mfma_f32_16x16x32_bf16 v[88:91], a[64:67], a[8:11], v[88:91]
    s_waitcnt lgkmcnt(10)
    buffer_load_dwordx4 v15, s[20:23], s57 offen offset:1408 lds
    v_mfma_f32_16x16x32_bf16 v[96:99], a[64:67], a[16:19], v[96:99]
    ds_read_b128 a[124:127], v5 offset:14336
    v_mfma_f32_16x16x32_bf16 v[96:99], a[68:71], a[20:23], v[96:99]
    v_mfma_f32_16x16x32_bf16 v[100:103], a[76:79], a[20:23], v[100:103]
    s_add_u32 m0, s33, 0xd80
    ds_read_b128 a[120:123], v4 offset:14336
    v_mfma_f32_16x16x32_bf16 v[100:103], a[72:75], a[16:19], v[100:103]
    buffer_load_dwordx4 v15, s[20:23], 0 offen offset:640 lds
    v_mfma_f32_16x16x32_bf16 v[104:107], a[80:83], a[16:19], v[104:107]
    ds_read_b64_tr_b16 a[32:33], v10 offset:0
    v_mfma_f32_16x16x32_bf16 v[104:107], a[84:87], a[20:23], v[104:107]
    ds_read_b64_tr_b16 a[34:35], v10 offset:4096
    v_mfma_f32_16x16x32_bf16 v[108:111], a[92:95], a[20:23], v[108:111]
    s_add_u32 m0, s33, 0xe00
    ds_read_b64_tr_b16 a[36:37], v10 offset:16384
    v_mfma_f32_16x16x32_bf16 v[108:111], a[88:91], a[16:19], v[108:111]
    s_waitcnt lgkmcnt(11)
    ds_read_b64_tr_b16 a[38:39], v10 offset:20480
    buffer_load_dwordx4 v15, s[20:23], 0 offen offset:1536 lds
    v_mfma_f32_16x16x32_bf16 v[116:119], a[88:91], a[24:27], v[116:119]
    ds_read_b64_tr_b16 a[40:41], v11 offset:0
    v_mfma_f32_16x16x32_bf16 v[116:119], a[92:95], a[28:31], v[116:119]
    ds_read_b64_tr_b16 a[42:43], v11 offset:4096
    v_mfma_f32_16x16x32_bf16 v[112:115], a[84:87], a[28:31], v[112:115]
    s_add_u32 m0, s33, 0x1580
    ds_read_b64_tr_b16 a[44:45], v11 offset:16384
    v_mfma_f32_16x16x32_bf16 v[112:115], a[80:83], a[24:27], v[112:115]
    ds_read_b64_tr_b16 a[46:47], v11 offset:20480
    buffer_load_dwordx4 v15, s[20:23], s57 offen offset:640 lds
    v_mfma_f32_16x16x32_bf16 v[124:127], a[72:75], a[24:27], v[124:127]
    ds_read_b64_tr_b16 a[48:49], v12 offset:0
    v_mfma_f32_16x16x32_bf16 v[124:127], a[76:79], a[28:31], v[124:127]
    ds_read_b64_tr_b16 a[50:51], v12 offset:4096
    v_mfma_f32_16x16x32_bf16 v[120:123], a[68:71], a[28:31], v[120:123]
    s_add_u32 m0, s33, 0x1600
    ds_read_b64_tr_b16 a[52:53], v12 offset:16384
    v_mfma_f32_16x16x32_bf16 v[120:123], a[64:67], a[24:27], v[120:123]
    s_waitcnt lgkmcnt(15)
    ds_read_b64_tr_b16 a[54:55], v12 offset:20480
    buffer_load_dwordx4 v15, s[20:23], s57 offen offset:1536 lds
    v_mfma_f32_16x16x32_bf16 v[16:19], a[96:99], a[0:3], v[16:19]
    ds_read_b64_tr_b16 a[56:57], v13 offset:0
    v_mfma_f32_16x16x32_bf16 v[16:19], a[100:103], a[4:7], v[16:19]
    ds_read_b64_tr_b16 a[58:59], v13 offset:4096
    v_mfma_f32_16x16x32_bf16 v[20:23], a[108:111], a[4:7], v[20:23]
    ds_read_b64_tr_b16 a[60:61], v13 offset:16384
    v_mfma_f32_16x16x32_bf16 v[20:23], a[104:107], a[0:3], v[20:23]
    s_waitcnt lgkmcnt(15)
    ds_read_b64_tr_b16 a[62:63], v13 offset:20480
    v_mfma_f32_16x16x32_bf16 v[24:27], a[112:115], a[0:3], v[24:27]
    v_mfma_f32_16x16x32_bf16 v[24:27], a[116:119], a[4:7], v[24:27]
    v_mfma_f32_16x16x32_bf16 v[28:31], a[124:127], a[4:7], v[28:31]
    v_mfma_f32_16x16x32_bf16 v[28:31], a[120:123], a[0:3], v[28:31]
    s_waitcnt lgkmcnt(0)
    v_mfma_f32_16x16x32_bf16 a[228:231], a[120:123], a[8:11], a[228:231]
    s_barrier
    v_mfma_f32_16x16x32_bf16 a[228:231], a[124:127], a[12:15], a[228:231]
    s_add_u32 m0, s29, 0
    v_add_u32 v2, 0xff800000, v2
    v_mfma_f32_16x16x32_bf16 a[224:227], a[116:119], a[12:15], a[224:227]
    buffer_load_dwordx4 v2, s[16:19], 0 offen lds
    v_mfma_f32_16x16x32_bf16 a[224:227], a[112:115], a[8:11], a[224:227]
    v_mfma_f32_16x16x32_bf16 a[236:239], a[104:107], a[8:11], a[236:239]
    v_mfma_f32_16x16x32_bf16 a[236:239], a[108:111], a[12:15], a[236:239]
    v_mfma_f32_16x16x32_bf16 a[232:235], a[100:103], a[12:15], a[232:235]
    s_add_u32 m0, s29, 4096
    v_mfma_f32_16x16x32_bf16 a[232:235], a[96:99], a[8:11], a[232:235]
    buffer_load_dwordx4 v2, s[16:19], s48 offen lds
    v_mfma_f32_16x16x32_bf16 v[32:35], a[96:99], a[16:19], v[32:35]
    v_mfma_f32_16x16x32_bf16 v[32:35], a[100:103], a[20:23], v[32:35]
    v_mfma_f32_16x16x32_bf16 v[36:39], a[108:111], a[20:23], v[36:39]
    v_mfma_f32_16x16x32_bf16 v[36:39], a[104:107], a[16:19], v[36:39]
    s_add_u32 m0, s29, 8192
    v_mfma_f32_16x16x32_bf16 v[40:43], a[112:115], a[16:19], v[40:43]
    buffer_load_dwordx4 v2, s[16:19], s49 offen lds
    v_mfma_f32_16x16x32_bf16 v[40:43], a[116:119], a[20:23], v[40:43]
    v_mfma_f32_16x16x32_bf16 v[44:47], a[124:127], a[20:23], v[44:47]
    v_mfma_f32_16x16x32_bf16 v[44:47], a[120:123], a[16:19], v[44:47]
    v_mfma_f32_16x16x32_bf16 v[52:55], a[120:123], a[24:27], v[52:55]
    s_add_u32 m0, s29, 12288
    v_mfma_f32_16x16x32_bf16 v[52:55], a[124:127], a[28:31], v[52:55]
    buffer_load_dwordx4 v2, s[16:19], s50 offen lds
    v_mfma_f32_16x16x32_bf16 v[48:51], a[116:119], a[28:31], v[48:51]
    v_mfma_f32_16x16x32_bf16 v[48:51], a[112:115], a[24:27], v[48:51]
    v_mfma_f32_16x16x32_bf16 v[60:63], a[104:107], a[24:27], v[60:63]
    v_mfma_f32_16x16x32_bf16 v[60:63], a[108:111], a[28:31], v[60:63]
    s_add_u32 m0, s29, 16384
    v_mfma_f32_16x16x32_bf16 v[56:59], a[100:103], a[28:31], v[56:59]
    buffer_load_dwordx4 v2, s[16:19], s51 offen lds
    v_mfma_f32_16x16x32_bf16 v[56:59], a[96:99], a[24:27], v[56:59]
    v_mfma_f32_16x16x32_bf16 v[192:195], a[96:99], a[32:35], v[192:195]
    v_mfma_f32_16x16x32_bf16 v[192:195], a[100:103], a[36:39], v[192:195]
    v_mfma_f32_16x16x32_bf16 v[196:199], a[108:111], a[36:39], v[196:199]
    s_add_u32 m0, s29, 20480
    v_mfma_f32_16x16x32_bf16 v[196:199], a[104:107], a[32:35], v[196:199]
    buffer_load_dwordx4 v2, s[16:19], s52 offen lds
    v_mfma_f32_16x16x32_bf16 v[200:203], a[112:115], a[32:35], v[200:203]
    v_mfma_f32_16x16x32_bf16 v[200:203], a[116:119], a[36:39], v[200:203]
    v_mfma_f32_16x16x32_bf16 v[204:207], a[124:127], a[36:39], v[204:207]
    v_mfma_f32_16x16x32_bf16 v[204:207], a[120:123], a[32:35], v[204:207]
    s_add_u32 m0, s29, 24576
    v_mfma_f32_16x16x32_bf16 v[212:215], a[120:123], a[40:43], v[212:215]
    buffer_load_dwordx4 v2, s[16:19], s53 offen lds
    v_mfma_f32_16x16x32_bf16 v[212:215], a[124:127], a[44:47], v[212:215]
    v_mfma_f32_16x16x32_bf16 v[208:211], a[116:119], a[44:47], v[208:211]
    v_mfma_f32_16x16x32_bf16 v[208:211], a[112:115], a[40:43], v[208:211]
    v_mfma_f32_16x16x32_bf16 v[220:223], a[104:107], a[40:43], v[220:223]
    s_add_u32 m0, s29, 28672
    v_mfma_f32_16x16x32_bf16 v[220:223], a[108:111], a[44:47], v[220:223]
    buffer_load_dwordx4 v2, s[16:19], s54 offen lds
    v_mfma_f32_16x16x32_bf16 v[216:219], a[100:103], a[44:47], v[216:219]
    v_mfma_f32_16x16x32_bf16 v[216:219], a[96:99], a[40:43], v[216:219]
    v_mfma_f32_16x16x32_bf16 v[224:227], a[96:99], a[48:51], v[224:227]
    s_add_u32 m0, s29, 65536
    v_add_u32 v2, 0x80000, v2
    v_mfma_f32_16x16x32_bf16 v[224:227], a[100:103], a[52:55], v[224:227]
    buffer_load_dwordx4 v2, s[16:19], 0 offen lds
    v_mfma_f32_16x16x32_bf16 v[228:231], a[108:111], a[52:55], v[228:231]
    v_mfma_f32_16x16x32_bf16 v[228:231], a[104:107], a[48:51], v[228:231]
    v_mfma_f32_16x16x32_bf16 v[232:235], a[112:115], a[48:51], v[232:235]
    v_mfma_f32_16x16x32_bf16 v[232:235], a[116:119], a[52:55], v[232:235]
    s_add_u32 m0, s29, 69632
    v_mfma_f32_16x16x32_bf16 v[236:239], a[124:127], a[52:55], v[236:239]
    buffer_load_dwordx4 v2, s[16:19], s48 offen lds
    v_mfma_f32_16x16x32_bf16 v[236:239], a[120:123], a[48:51], v[236:239]
    v_mfma_f32_16x16x32_bf16 v[244:247], a[120:123], a[56:59], v[244:247]
    v_mfma_f32_16x16x32_bf16 v[244:247], a[124:127], a[60:63], v[244:247]
    v_mfma_f32_16x16x32_bf16 v[240:243], a[116:119], a[60:63], v[240:243]
    s_add_u32 m0, s29, 73728
    v_mfma_f32_16x16x32_bf16 v[240:243], a[112:115], a[56:59], v[240:243]
    buffer_load_dwordx4 v2, s[16:19], s49 offen lds
    v_mfma_f32_16x16x32_bf16 v[252:255], a[104:107], a[56:59], v[252:255]
    s_waitcnt vmcnt(11)
    v_mfma_f32_16x16x32_bf16 v[252:255], a[108:111], a[60:63], v[252:255]
    s_barrier
    ds_read_b64_tr_b16 a[0:1], v6 offset:32768
    v_mfma_f32_16x16x32_bf16 v[248:251], a[100:103], a[60:63], v[248:251]
    ds_read_b64_tr_b16 a[2:3], v6 offset:36864
    v_mfma_f32_16x16x32_bf16 v[248:251], a[96:99], a[56:59], v[248:251]
    s_add_u32 m0, s29, 77824
    ds_read_b128 a[96:99], v4 offset:40960
    v_mfma_f32_16x16x32_bf16 v[128:131], a[64:67], a[32:35], v[128:131]
    ds_read_b128 a[192:195], v14 offset:0
    buffer_load_dwordx4 v2, s[16:19], s50 offen lds
    v_mfma_f32_16x16x32_bf16 v[128:131], a[68:71], a[36:39], v[128:131]
    ds_read_b128 a[200:203], v3 offset:0
    v_mfma_f32_16x16x32_bf16 v[132:135], a[76:79], a[36:39], v[132:135]
    ds_read_b64_tr_b16 a[4:5], v6 offset:49152
    v_mfma_f32_16x16x32_bf16 v[132:135], a[72:75], a[32:35], v[132:135]
    ds_read_b64_tr_b16 a[6:7], v6 offset:53248
    v_mfma_f32_16x16x32_bf16 v[136:139], a[80:83], a[32:35], v[136:139]
    s_add_u32 m0, s29, 81920
    ds_read_b128 a[100:103], v5 offset:40960
    v_mfma_f32_16x16x32_bf16 v[136:139], a[84:87], a[36:39], v[136:139]
    ds_read_b128 a[196:199], v14 offset:2048
    buffer_load_dwordx4 v2, s[16:19], s51 offen lds
    v_mfma_f32_16x16x32_bf16 v[140:143], a[92:95], a[36:39], v[140:143]
    ds_read_b128 a[204:207], v3 offset:2048
    v_mfma_f32_16x16x32_bf16 v[140:143], a[88:91], a[32:35], v[140:143]
    ds_read_b128 a[108:111], v5 offset:43008
    v_mfma_f32_16x16x32_bf16 v[148:151], a[88:91], a[40:43], v[148:151]
    ds_read_b128 a[208:211], v14 offset:4096
    v_mfma_f32_16x16x32_bf16 v[148:151], a[92:95], a[44:47], v[148:151]
    s_add_u32 m0, s29, 86016
    ds_read_b128 a[104:107], v4 offset:43008
    v_mfma_f32_16x16x32_bf16 v[144:147], a[84:87], a[44:47], v[144:147]
    ds_read_b128 a[216:219], v3 offset:4096
    buffer_load_dwordx4 v2, s[16:19], s52 offen lds
    v_mfma_f32_16x16x32_bf16 v[144:147], a[80:83], a[40:43], v[144:147]
    ds_read_b128 a[212:215], v14 offset:6144
    v_mfma_f32_16x16x32_bf16 v[156:159], a[72:75], a[40:43], v[156:159]
    ds_read_b128 a[112:115], v4 offset:45056
    v_mfma_f32_16x16x32_bf16 v[156:159], a[76:79], a[44:47], v[156:159]
    ds_read_b128 a[220:223], v3 offset:6144
    v_mfma_f32_16x16x32_bf16 v[152:155], a[68:71], a[44:47], v[152:155]
    s_add_u32 m0, s29, 90112
    ds_read_b128 a[116:119], v5 offset:45056
    v_mfma_f32_16x16x32_bf16 v[152:155], a[64:67], a[40:43], v[152:155]
    buffer_load_dwordx4 v2, s[16:19], s53 offen lds
    v_mfma_f32_16x16x32_bf16 v[160:163], a[64:67], a[48:51], v[160:163]
    v_mfma_f32_16x16x32_bf16 v[160:163], a[68:71], a[52:55], v[160:163]
    ds_read_b128 a[124:127], v5 offset:47104
    v_mfma_f32_16x16x32_bf16 v[164:167], a[76:79], a[52:55], v[164:167]
    v_mfma_f32_16x16x32_bf16 v[164:167], a[72:75], a[48:51], v[164:167]
    s_add_u32 m0, s29, 94208
    ds_read_b128 a[120:123], v4 offset:47104
    v_mfma_f32_16x16x32_bf16 v[168:171], a[80:83], a[48:51], v[168:171]
    buffer_load_dwordx4 v2, s[16:19], s54 offen lds
    v_mfma_f32_16x16x32_bf16 v[168:171], a[84:87], a[52:55], v[168:171]
    v_mfma_f32_16x16x32_bf16 v[172:175], a[92:95], a[52:55], v[172:175]
    v_mfma_f32_16x16x32_bf16 v[172:175], a[88:91], a[48:51], v[172:175]
    ds_read_b64_tr_b16 a[8:9], v7 offset:32768
    v_mfma_f32_16x16x32_bf16 v[180:183], a[88:91], a[56:59], v[180:183]
    v_mfma_f32_16x16x32_bf16 v[180:183], a[92:95], a[60:63], v[180:183]
    ds_read_b64_tr_b16 a[10:11], v7 offset:36864
    v_mfma_f32_16x16x32_bf16 v[176:179], a[84:87], a[60:63], v[176:179]
    ds_read_b64_tr_b16 a[12:13], v7 offset:49152
    v_mfma_f32_16x16x32_bf16 v[176:179], a[80:83], a[56:59], v[176:179]
    ds_read_b64_tr_b16 a[14:15], v7 offset:53248
    v_mfma_f32_16x16x32_bf16 v[188:191], a[72:75], a[56:59], v[188:191]
    ds_read_b64_tr_b16 a[16:17], v8 offset:32768
    v_mfma_f32_16x16x32_bf16 v[188:191], a[76:79], a[60:63], v[188:191]
    ds_read_b64_tr_b16 a[18:19], v8 offset:36864
    v_mfma_f32_16x16x32_bf16 v[184:187], a[68:71], a[60:63], v[184:187]
    ds_read_b64_tr_b16 a[20:21], v8 offset:49152
    v_mfma_f32_16x16x32_bf16 v[184:187], a[64:67], a[56:59], v[184:187]
    s_waitcnt lgkmcnt(15)
    ds_read_b64_tr_b16 a[22:23], v8 offset:53248
    v_mfma_f32_16x16x32_bf16 v[16:19], a[96:99], a[0:3], v[16:19]
    ds_read_b64_tr_b16 a[24:25], v9 offset:32768
    v_mfma_f32_16x16x32_bf16 v[16:19], a[100:103], a[4:7], v[16:19]
    s_add_u32 m0, s33, 0xfffffd00
    ds_read_b64_tr_b16 a[26:27], v9 offset:36864
    v_mfma_f32_16x16x32_bf16 v[20:23], a[108:111], a[4:7], v[20:23]
    s_waitcnt lgkmcnt(13)
    ds_read_b64_tr_b16 a[28:29], v9 offset:49152
    v_mfma_f32_16x16x32_bf16 v[20:23], a[104:107], a[0:3], v[20:23]
    ds_read_b64_tr_b16 a[30:31], v9 offset:53248
    buffer_load_dwordx4 v15, s[20:23], 0 offen offset:768 lds
    v_mfma_f32_16x16x32_bf16 v[24:27], a[112:115], a[0:3], v[24:27]
    s_waitcnt lgkmcnt(12)
    ds_read_b128 a[64:67], v4 offset:32768
    v_mfma_f32_16x16x32_bf16 v[24:27], a[116:119], a[4:7], v[24:27]
    v_mfma_f32_16x16x32_bf16 v[28:31], a[124:127], a[4:7], v[28:31]
    s_add_u32 m0, s33, 0xfffffd80
    ds_read_b128 a[68:71], v5 offset:32768
    v_mfma_f32_16x16x32_bf16 v[28:31], a[120:123], a[0:3], v[28:31]
    s_waitcnt lgkmcnt(10)
    buffer_load_dwordx4 v15, s[20:23], 0 offen offset:1664 lds
    v_mfma_f32_16x16x32_bf16 a[228:231], a[120:123], a[8:11], a[228:231]
    ds_read_b128 a[76:79], v5 offset:34816
    v_mfma_f32_16x16x32_bf16 a[228:231], a[124:127], a[12:15], a[228:231]
    v_mfma_f32_16x16x32_bf16 a[224:227], a[116:119], a[12:15], a[224:227]
    s_add_u32 m0, s33, 0x500
    ds_read_b128 a[72:75], v4 offset:34816
    v_mfma_f32_16x16x32_bf16 a[224:227], a[112:115], a[8:11], a[224:227]
    buffer_load_dwordx4 v15, s[20:23], s57 offen offset:768 lds
    v_mfma_f32_16x16x32_bf16 a[236:239], a[104:107], a[8:11], a[236:239]
    ds_read_b128 a[80:83], v4 offset:36864
    v_cvt_pk_bf16_f32 v16, v16, v17
    v_mfma_f32_16x16x32_bf16 a[236:239], a[108:111], a[12:15], a[236:239]
    v_cvt_pk_bf16_f32 v17, v18, v19
    v_cvt_pk_bf16_f32 v18, v20, v21
    v_mfma_f32_16x16x32_bf16 a[232:235], a[100:103], a[12:15], a[232:235]
    s_add_u32 m0, s33, 0x580
    ds_read_b128 a[84:87], v5 offset:36864
    v_cvt_pk_bf16_f32 v19, v22, v23
    v_mfma_f32_16x16x32_bf16 a[232:235], a[96:99], a[8:11], a[232:235]
    s_waitcnt lgkmcnt(10)
    buffer_load_dwordx4 v15, s[20:23], s57 offen offset:1664 lds
    v_mfma_f32_16x16x32_bf16 v[32:35], a[96:99], a[16:19], v[32:35]
    ds_read_b128 a[92:95], v5 offset:38912
    v_cvt_pk_bf16_f32 v24, v24, v25
    v_mfma_f32_16x16x32_bf16 v[32:35], a[100:103], a[20:23], v[32:35]
    v_cvt_pk_bf16_f32 v25, v26, v27
    v_cvt_pk_bf16_f32 v26, v28, v29
    v_mfma_f32_16x16x32_bf16 v[36:39], a[108:111], a[20:23], v[36:39]
    ds_read_b128 a[88:91], v4 offset:38912
    v_cvt_pk_bf16_f32 v27, v30, v31
    v_mfma_f32_16x16x32_bf16 v[36:39], a[104:107], a[16:19], v[36:39]
    v_accvgpr_read_b32 v20, a224
    v_accvgpr_read_b32 v21, a225
    v_mfma_f32_16x16x32_bf16 v[40:43], a[112:115], a[16:19], v[40:43]
    ds_read_b64_tr_b16 a[32:33], v10 offset:32768
    v_accvgpr_read_b32 v22, a226
    v_mfma_f32_16x16x32_bf16 v[40:43], a[116:119], a[20:23], v[40:43]
    ds_read_b64_tr_b16 a[34:35], v10 offset:36864
    v_accvgpr_read_b32 v23, a227
    v_mfma_f32_16x16x32_bf16 v[44:47], a[124:127], a[20:23], v[44:47]
    ds_read_b64_tr_b16 a[36:37], v10 offset:49152
    v_accvgpr_read_b32 v28, a228
    v_mfma_f32_16x16x32_bf16 v[44:47], a[120:123], a[16:19], v[44:47]
    s_waitcnt lgkmcnt(11)
    ds_read_b64_tr_b16 a[38:39], v10 offset:53248
    v_accvgpr_read_b32 v29, a229
    v_mfma_f32_16x16x32_bf16 v[52:55], a[120:123], a[24:27], v[52:55]
    ds_read_b64_tr_b16 a[40:41], v11 offset:32768
    v_accvgpr_read_b32 v30, a230
    v_mfma_f32_16x16x32_bf16 v[52:55], a[124:127], a[28:31], v[52:55]
    ds_read_b64_tr_b16 a[42:43], v11 offset:36864
    v_accvgpr_read_b32 v31, a231
    v_mfma_f32_16x16x32_bf16 v[48:51], a[116:119], a[28:31], v[48:51]
    ds_read_b64_tr_b16 a[44:45], v11 offset:49152
    v_cvt_pk_bf16_f32 v20, v20, v21
    v_mfma_f32_16x16x32_bf16 v[48:51], a[112:115], a[24:27], v[48:51]
    ds_read_b64_tr_b16 a[46:47], v11 offset:53248
    v_cvt_pk_bf16_f32 v21, v22, v23
    v_mfma_f32_16x16x32_bf16 v[60:63], a[104:107], a[24:27], v[60:63]
    ds_read_b64_tr_b16 a[48:49], v12 offset:32768
    v_cvt_pk_bf16_f32 v22, v28, v29
    v_mfma_f32_16x16x32_bf16 v[60:63], a[108:111], a[28:31], v[60:63]
    ds_read_b64_tr_b16 a[50:51], v12 offset:36864
    v_cvt_pk_bf16_f32 v23, v30, v31
    v_mfma_f32_16x16x32_bf16 v[56:59], a[100:103], a[28:31], v[56:59]
    ds_read_b64_tr_b16 a[52:53], v12 offset:49152
    v_cvt_pk_bf16_f32 v32, v32, v33
    v_mfma_f32_16x16x32_bf16 v[56:59], a[96:99], a[24:27], v[56:59]
    s_waitcnt lgkmcnt(15)
    ds_read_b64_tr_b16 a[54:55], v12 offset:53248
    v_cvt_pk_bf16_f32 v33, v34, v35
    v_mfma_f32_16x16x32_bf16 v[64:67], a[64:67], a[0:3], v[64:67]
    ds_read_b64_tr_b16 a[56:57], v13 offset:32768
    v_cvt_pk_bf16_f32 v34, v36, v37
    v_mfma_f32_16x16x32_bf16 v[64:67], a[68:71], a[4:7], v[64:67]
    ds_read_b64_tr_b16 a[58:59], v13 offset:36864
    v_cvt_pk_bf16_f32 v35, v38, v39
    v_mfma_f32_16x16x32_bf16 v[68:71], a[76:79], a[4:7], v[68:71]
    ds_read_b64_tr_b16 a[60:61], v13 offset:49152
    v_cvt_pk_bf16_f32 v40, v40, v41
    v_mfma_f32_16x16x32_bf16 v[68:71], a[72:75], a[0:3], v[68:71]
    s_waitcnt lgkmcnt(15)
    ds_read_b64_tr_b16 a[62:63], v13 offset:53248
    v_cvt_pk_bf16_f32 v41, v42, v43
    v_mfma_f32_16x16x32_bf16 v[72:75], a[80:83], a[0:3], v[72:75]
    v_cvt_pk_bf16_f32 v42, v44, v45
    v_cvt_pk_bf16_f32 v43, v46, v47
    v_mfma_f32_16x16x32_bf16 v[72:75], a[84:87], a[4:7], v[72:75]
    v_accvgpr_read_b32 v36, a232
    v_accvgpr_read_b32 v37, a233
    v_mfma_f32_16x16x32_bf16 v[76:79], a[92:95], a[4:7], v[76:79]
    v_accvgpr_read_b32 v38, a234
    v_accvgpr_read_b32 v39, a235
    v_mfma_f32_16x16x32_bf16 v[76:79], a[88:91], a[0:3], v[76:79]
    s_waitcnt lgkmcnt(0)
    v_accvgpr_read_b32 v44, a236
    v_accvgpr_read_b32 v45, a237
    v_mfma_f32_16x16x32_bf16 v[84:87], a[88:91], a[8:11], v[84:87]
    s_barrier
    v_xor_b32 v6, s60, v6
    v_accvgpr_read_b32 v46, a238
    v_mfma_f32_16x16x32_bf16 v[84:87], a[92:95], a[12:15], v[84:87]
    s_add_u32 m0, s29, 32768
    v_add_u32 v2, 0x80000, v2
    v_accvgpr_read_b32 v47, a239
    v_mfma_f32_16x16x32_bf16 v[80:83], a[84:87], a[12:15], v[80:83]
    buffer_load_dwordx4 v2, s[16:19], 0 offen lds
    v_mfma_f32_16x16x32_bf16 v[80:83], a[80:83], a[8:11], v[80:83]
    s_add_u32 s59, s58, 49152
    v_cvt_pk_bf16_f32 v36, v36, v37
    v_cvt_pk_bf16_f32 v37, v38, v39
    v_mfma_f32_16x16x32_bf16 v[92:95], a[72:75], a[8:11], v[92:95]
    buffer_store_dwordx4 v[20:23], v1, s[12:15], s59 offen offset:1024 sc1
    v_mfma_f32_16x16x32_bf16 v[92:95], a[76:79], a[12:15], v[92:95]
    v_cvt_pk_bf16_f32 v38, v44, v45
    v_cvt_pk_bf16_f32 v39, v46, v47
    v_mfma_f32_16x16x32_bf16 v[88:91], a[68:71], a[12:15], v[88:91]
    s_add_u32 m0, s29, 36864
    v_cvt_pk_bf16_f32 v48, v48, v49
    v_cvt_pk_bf16_f32 v49, v50, v51
    v_mfma_f32_16x16x32_bf16 v[88:91], a[64:67], a[8:11], v[88:91]
    buffer_load_dwordx4 v2, s[16:19], s48 offen lds
    v_mfma_f32_16x16x32_bf16 v[96:99], a[64:67], a[16:19], v[96:99]
    v_cvt_pk_bf16_f32 v50, v52, v53
    v_cvt_pk_bf16_f32 v51, v54, v55
    v_mfma_f32_16x16x32_bf16 v[96:99], a[68:71], a[20:23], v[96:99]
    v_cvt_pk_bf16_f32 v56, v56, v57
    v_cvt_pk_bf16_f32 v57, v58, v59
    v_mfma_f32_16x16x32_bf16 v[100:103], a[76:79], a[20:23], v[100:103]
    v_cvt_pk_bf16_f32 v58, v60, v61
    v_cvt_pk_bf16_f32 v59, v62, v63
    v_mfma_f32_16x16x32_bf16 v[100:103], a[72:75], a[16:19], v[100:103]
    s_add_u32 m0, s29, 40960
    v_cvt_pk_bf16_f32 v64, v64, v65
    v_cvt_pk_bf16_f32 v65, v66, v67
    v_mfma_f32_16x16x32_bf16 v[104:107], a[80:83], a[16:19], v[104:107]
    buffer_load_dwordx4 v2, s[16:19], s49 offen lds
    v_mfma_f32_16x16x32_bf16 v[104:107], a[84:87], a[20:23], v[104:107]
    s_add_u32 s59, s58, 32768
    v_cvt_pk_bf16_f32 v66, v68, v69
    v_cvt_pk_bf16_f32 v67, v70, v71
    v_mfma_f32_16x16x32_bf16 v[108:111], a[92:95], a[20:23], v[108:111]
    buffer_store_dwordx4 v[36:39], v1, s[12:15], s59 offen offset:1024 sc1
    v_mfma_f32_16x16x32_bf16 v[108:111], a[88:91], a[16:19], v[108:111]
    v_cvt_pk_bf16_f32 v72, v72, v73
    v_cvt_pk_bf16_f32 v73, v74, v75
    v_mfma_f32_16x16x32_bf16 v[116:119], a[88:91], a[24:27], v[116:119]
    s_add_u32 m0, s29, 45056
    v_cvt_pk_bf16_f32 v74, v76, v77
    v_cvt_pk_bf16_f32 v75, v78, v79
    v_mfma_f32_16x16x32_bf16 v[116:119], a[92:95], a[28:31], v[116:119]
    buffer_load_dwordx4 v2, s[16:19], s50 offen lds
    v_mfma_f32_16x16x32_bf16 v[112:115], a[84:87], a[28:31], v[112:115]
    v_cvt_pk_bf16_f32 v80, v80, v81
    v_cvt_pk_bf16_f32 v81, v82, v83
    v_mfma_f32_16x16x32_bf16 v[112:115], a[80:83], a[24:27], v[112:115]
    v_cvt_pk_bf16_f32 v82, v84, v85
    v_cvt_pk_bf16_f32 v83, v86, v87
    v_mfma_f32_16x16x32_bf16 v[124:127], a[72:75], a[24:27], v[124:127]
    v_cvt_pk_bf16_f32 v88, v88, v89
    v_cvt_pk_bf16_f32 v89, v90, v91
    v_mfma_f32_16x16x32_bf16 v[124:127], a[76:79], a[28:31], v[124:127]
    s_add_u32 m0, s29, 49152
    v_cvt_pk_bf16_f32 v90, v92, v93
    v_cvt_pk_bf16_f32 v91, v94, v95
    v_mfma_f32_16x16x32_bf16 v[120:123], a[68:71], a[28:31], v[120:123]
    buffer_load_dwordx4 v2, s[16:19], s51 offen lds
    v_mfma_f32_16x16x32_bf16 v[120:123], a[64:67], a[24:27], v[120:123]
    s_add_u32 s59, s58, 32768
    v_cvt_pk_bf16_f32 v96, v96, v97
    v_cvt_pk_bf16_f32 v97, v98, v99
    v_mfma_f32_16x16x32_bf16 v[128:131], a[64:67], a[32:35], v[128:131]
    buffer_store_dwordx4 v[16:19], v1, s[12:15], s59 offen offset:0 sc1
    v_mfma_f32_16x16x32_bf16 v[128:131], a[68:71], a[36:39], v[128:131]
    v_cvt_pk_bf16_f32 v98, v100, v101
    v_cvt_pk_bf16_f32 v99, v102, v103
    v_mfma_f32_16x16x32_bf16 v[132:135], a[76:79], a[36:39], v[132:135]
    s_add_u32 m0, s29, 53248
    v_cvt_pk_bf16_f32 v104, v104, v105
    v_cvt_pk_bf16_f32 v105, v106, v107
    v_mfma_f32_16x16x32_bf16 v[132:135], a[72:75], a[32:35], v[132:135]
    buffer_load_dwordx4 v2, s[16:19], s52 offen lds
    v_mfma_f32_16x16x32_bf16 v[136:139], a[80:83], a[32:35], v[136:139]
    v_cvt_pk_bf16_f32 v106, v108, v109
    v_cvt_pk_bf16_f32 v107, v110, v111
    v_mfma_f32_16x16x32_bf16 v[136:139], a[84:87], a[36:39], v[136:139]
    v_cvt_pk_bf16_f32 v112, v112, v113
    v_cvt_pk_bf16_f32 v113, v114, v115
    v_mfma_f32_16x16x32_bf16 v[140:143], a[92:95], a[36:39], v[140:143]
    v_cvt_pk_bf16_f32 v114, v116, v117
    v_cvt_pk_bf16_f32 v115, v118, v119
    v_mfma_f32_16x16x32_bf16 v[140:143], a[88:91], a[32:35], v[140:143]
    s_add_u32 m0, s29, 57344
    v_cvt_pk_bf16_f32 v120, v120, v121
    v_cvt_pk_bf16_f32 v121, v122, v123
    v_mfma_f32_16x16x32_bf16 v[148:151], a[88:91], a[40:43], v[148:151]
    buffer_load_dwordx4 v2, s[16:19], s53 offen lds
    v_mfma_f32_16x16x32_bf16 v[148:151], a[92:95], a[44:47], v[148:151]
    s_add_u32 s59, s58, 49152
    v_cvt_pk_bf16_f32 v122, v124, v125
    v_cvt_pk_bf16_f32 v123, v126, v127
    v_mfma_f32_16x16x32_bf16 v[144:147], a[84:87], a[44:47], v[144:147]
    buffer_store_dwordx4 v[24:27], v1, s[12:15], s59 offen offset:0 sc1
    v_mfma_f32_16x16x32_bf16 v[144:147], a[80:83], a[40:43], v[144:147]
    v_cvt_pk_bf16_f32 v128, v128, v129
    v_cvt_pk_bf16_f32 v129, v130, v131
    v_mfma_f32_16x16x32_bf16 v[156:159], a[72:75], a[40:43], v[156:159]
    s_add_u32 m0, s29, 61440
    v_cvt_pk_bf16_f32 v130, v132, v133
    v_cvt_pk_bf16_f32 v131, v134, v135
    v_mfma_f32_16x16x32_bf16 v[156:159], a[76:79], a[44:47], v[156:159]
    buffer_load_dwordx4 v2, s[16:19], s54 offen lds
    v_mfma_f32_16x16x32_bf16 v[152:155], a[68:71], a[44:47], v[152:155]
    v_mfma_f32_16x16x32_bf16 v[152:155], a[64:67], a[40:43], v[152:155]
    v_cvt_pk_bf16_f32 v136, v136, v137
    v_cvt_pk_bf16_f32 v137, v138, v139
    v_mfma_f32_16x16x32_bf16 v[160:163], a[64:67], a[48:51], v[160:163]
    s_add_u32 m0, s29, 98304
    v_add_u32 v2, 0x80000, v2
    v_cvt_pk_bf16_f32 v138, v140, v141
    v_mfma_f32_16x16x32_bf16 v[160:163], a[68:71], a[52:55], v[160:163]
    buffer_load_dwordx4 v2, s[16:19], 0 offen lds
    v_mfma_f32_16x16x32_bf16 v[164:167], a[76:79], a[52:55], v[164:167]
    s_add_u32 s59, s58, 32768
    v_cvt_pk_bf16_f32 v139, v142, v143
    v_mfma_f32_16x16x32_bf16 v[164:167], a[72:75], a[48:51], v[164:167]
    buffer_store_dwordx4 v[32:35], v1, s[12:15], s59 offen offset:2048 sc1
    v_mfma_f32_16x16x32_bf16 v[168:171], a[80:83], a[48:51], v[168:171]
    v_cvt_pk_bf16_f32 v144, v144, v145
    v_cvt_pk_bf16_f32 v145, v146, v147
    v_mfma_f32_16x16x32_bf16 v[168:171], a[84:87], a[52:55], v[168:171]
    s_add_u32 m0, s29, 102400
    v_cvt_pk_bf16_f32 v146, v148, v149
    v_cvt_pk_bf16_f32 v147, v150, v151
    v_mfma_f32_16x16x32_bf16 v[172:175], a[92:95], a[52:55], v[172:175]
    buffer_load_dwordx4 v2, s[16:19], s48 offen lds
    v_mfma_f32_16x16x32_bf16 v[172:175], a[88:91], a[48:51], v[172:175]
    v_cvt_pk_bf16_f32 v152, v152, v153
    v_cvt_pk_bf16_f32 v153, v154, v155
    v_mfma_f32_16x16x32_bf16 v[180:183], a[88:91], a[56:59], v[180:183]
    v_cvt_pk_bf16_f32 v154, v156, v157
    v_cvt_pk_bf16_f32 v155, v158, v159
    v_mfma_f32_16x16x32_bf16 v[180:183], a[92:95], a[60:63], v[180:183]
    v_mfma_f32_16x16x32_bf16 v[176:179], a[84:87], a[60:63], v[176:179]
    s_add_u32 m0, s29, 106496
    v_mfma_f32_16x16x32_bf16 v[176:179], a[80:83], a[56:59], v[176:179]
    buffer_load_dwordx4 v2, s[16:19], s49 offen lds
    v_mfma_f32_16x16x32_bf16 v[188:191], a[72:75], a[56:59], v[188:191]
    s_add_u32 s59, s58, 49152
    v_cvt_pk_bf16_f32 v160, v160, v161
    v_cvt_pk_bf16_f32 v161, v162, v163
    v_mfma_f32_16x16x32_bf16 v[188:191], a[76:79], a[60:63], v[188:191]
    buffer_store_dwordx4 v[40:43], v1, s[12:15], s59 offen offset:2048 sc1
    v_mfma_f32_16x16x32_bf16 v[184:187], a[68:71], a[60:63], v[184:187]
    v_cvt_pk_bf16_f32 v162, v164, v165
    v_cvt_pk_bf16_f32 v163, v166, v167
    v_mfma_f32_16x16x32_bf16 v[184:187], a[64:67], a[56:59], v[184:187]
    s_add_u32 m0, s29, 110592
    v_cvt_pk_bf16_f32 v168, v168, v169
    v_cvt_pk_bf16_f32 v169, v170, v171
    v_mfma_f32_16x16x32_bf16 v[192:195], a[96:99], a[32:35], v[192:195]
    buffer_load_dwordx4 v2, s[16:19], s50 offen lds
    v_mfma_f32_16x16x32_bf16 v[192:195], a[100:103], a[36:39], v[192:195]
    v_cvt_pk_bf16_f32 v170, v172, v173
    v_cvt_pk_bf16_f32 v171, v174, v175
    v_mfma_f32_16x16x32_bf16 v[196:199], a[108:111], a[36:39], v[196:199]
    v_mfma_f32_16x16x32_bf16 v[196:199], a[104:107], a[32:35], v[196:199]
    v_cvt_pk_bf16_f32 v176, v176, v177
    v_cvt_pk_bf16_f32 v177, v178, v179
    v_mfma_f32_16x16x32_bf16 v[200:203], a[112:115], a[32:35], v[200:203]
    s_add_u32 m0, s29, 114688
    v_cvt_pk_bf16_f32 v178, v180, v181
    v_cvt_pk_bf16_f32 v179, v182, v183
    v_mfma_f32_16x16x32_bf16 v[200:203], a[116:119], a[36:39], v[200:203]
    buffer_load_dwordx4 v2, s[16:19], s51 offen lds
    v_mfma_f32_16x16x32_bf16 v[204:207], a[124:127], a[36:39], v[204:207]
    s_add_u32 s59, s58, 49152
    v_mfma_f32_16x16x32_bf16 v[204:207], a[120:123], a[32:35], v[204:207]
    buffer_store_dwordx4 v[48:51], v1, s[12:15], s59 offen offset:3072 sc1
    v_mfma_f32_16x16x32_bf16 v[212:215], a[120:123], a[40:43], v[212:215]
    v_cvt_pk_bf16_f32 v184, v184, v185
    v_cvt_pk_bf16_f32 v185, v186, v187
    v_mfma_f32_16x16x32_bf16 v[212:215], a[124:127], a[44:47], v[212:215]
    s_add_u32 m0, s29, 118784
    v_cvt_pk_bf16_f32 v186, v188, v189
    v_cvt_pk_bf16_f32 v187, v190, v191
    v_mfma_f32_16x16x32_bf16 v[208:211], a[116:119], a[44:47], v[208:211]
    buffer_load_dwordx4 v2, s[16:19], s52 offen lds
    v_mfma_f32_16x16x32_bf16 v[208:211], a[112:115], a[40:43], v[208:211]
    v_cvt_pk_bf16_f32 v192, v192, v193
    v_cvt_pk_bf16_f32 v193, v194, v195
    v_mfma_f32_16x16x32_bf16 v[220:223], a[104:107], a[40:43], v[220:223]
    v_cvt_pk_bf16_f32 v194, v196, v197
    v_cvt_pk_bf16_f32 v195, v198, v199
    v_mfma_f32_16x16x32_bf16 v[220:223], a[108:111], a[44:47], v[220:223]
    v_mfma_f32_16x16x32_bf16 v[216:219], a[100:103], a[44:47], v[216:219]
    s_add_u32 m0, s29, 122880
    v_mfma_f32_16x16x32_bf16 v[216:219], a[96:99], a[40:43], v[216:219]
    buffer_load_dwordx4 v2, s[16:19], s53 offen lds
    v_mfma_f32_16x16x32_bf16 v[224:227], a[96:99], a[48:51], v[224:227]
    s_add_u32 s59, s58, 32768
    v_cvt_pk_bf16_f32 v200, v200, v201
    v_cvt_pk_bf16_f32 v201, v202, v203
    v_mfma_f32_16x16x32_bf16 v[224:227], a[100:103], a[52:55], v[224:227]
    s_waitcnt vmcnt(22)
    buffer_store_dwordx4 v[56:59], v1, s[12:15], s59 offen offset:3072 sc1
    v_mfma_f32_16x16x32_bf16 v[228:231], a[108:111], a[52:55], v[228:231]
    s_barrier
    v_xor_b32 v7, 0, v6
    v_cvt_pk_bf16_f32 v202, v204, v205
    v_mfma_f32_16x16x32_bf16 v[228:231], a[104:107], a[48:51], v[228:231]
    s_add_u32 m0, s29, 126976
    ds_read_b64_tr_b16 a[64:65], v7 offset:0
    v_cvt_pk_bf16_f32 v203, v206, v207
    v_mfma_f32_16x16x32_bf16 v[232:235], a[112:115], a[48:51], v[232:235]
    ds_read_b64_tr_b16 a[66:67], v7 offset:4096
    buffer_load_dwordx4 v2, s[16:19], s54 offen lds
    v_mfma_f32_16x16x32_bf16 v[232:235], a[116:119], a[52:55], v[232:235]
    ds_read_b64_tr_b16 a[68:69], v7 offset:16384
    v_cvt_pk_bf16_f32 v208, v208, v209
    v_mfma_f32_16x16x32_bf16 v[236:239], a[124:127], a[52:55], v[236:239]
    ds_read_b64_tr_b16 a[70:71], v7 offset:20480
    v_xor_b32 v8, 65536, v6
    v_mfma_f32_16x16x32_bf16 v[236:239], a[120:123], a[48:51], v[236:239]
    ds_read_b64_tr_b16 a[72:73], v8 offset:0
    v_cvt_pk_bf16_f32 v209, v210, v211
    v_mfma_f32_16x16x32_bf16 v[244:247], a[120:123], a[56:59], v[244:247]
    s_add_u32 s59, s58, 0
    ds_read_b64_tr_b16 a[74:75], v8 offset:4096
    v_cvt_pk_bf16_f32 v210, v212, v213
    v_mfma_f32_16x16x32_bf16 v[244:247], a[124:127], a[60:63], v[244:247]
    ds_read_b64_tr_b16 a[76:77], v8 offset:16384
    buffer_store_dwordx4 v[64:67], v1, s[12:15], s59 offen offset:0 sc1
    v_mfma_f32_16x16x32_bf16 v[240:243], a[116:119], a[60:63], v[240:243]
    ds_read_b64_tr_b16 a[78:79], v8 offset:20480
    v_xor_b32 v9, 32, v6
    v_mfma_f32_16x16x32_bf16 v[240:243], a[112:115], a[56:59], v[240:243]
    ds_read_b64_tr_b16 a[80:81], v9 offset:0
    v_cvt_pk_bf16_f32 v211, v214, v215
    v_mfma_f32_16x16x32_bf16 v[252:255], a[104:107], a[56:59], v[252:255]
    ds_read_b64_tr_b16 a[82:83], v9 offset:4096
    v_cvt_pk_bf16_f32 v216, v216, v217
    v_mfma_f32_16x16x32_bf16 v[252:255], a[108:111], a[60:63], v[252:255]
    ds_read_b64_tr_b16 a[84:85], v9 offset:16384
    v_cvt_pk_bf16_f32 v217, v218, v219
    v_mfma_f32_16x16x32_bf16 v[248:251], a[100:103], a[60:63], v[248:251]
    ds_read_b64_tr_b16 a[86:87], v9 offset:20480
    v_xor_b32 v10, 65568, v6
    v_mfma_f32_16x16x32_bf16 v[248:251], a[96:99], a[56:59], v[248:251]
    s_waitcnt lgkmcnt(6)
    ds_read_b64_tr_b16 a[88:89], v10 offset:0
    v_cvt_pk_bf16_f32 v218, v220, v221
    v_mfma_f32_16x16x32_bf16 v[28:31], a[64:67], a[128:131], 0
    ds_read_b64_tr_b16 a[90:91], v10 offset:4096
    v_cvt_pk_bf16_f32 v219, v222, v223
    v_mfma_f32_16x16x32_bf16 v[28:31], a[68:71], a[136:139], v[28:31]
    s_add_u32 s59, s58, 16384
    ds_read_b64_tr_b16 a[92:93], v10 offset:16384
    v_xor_b32 v7, 64, v6
    v_mfma_f32_16x16x32_bf16 v[28:31], a[72:75], a[144:147], v[28:31]
    s_waitcnt lgkmcnt(7)
    ds_read_b128 a[112:115], v14 offset:0
    ds_read_b64_tr_b16 a[94:95], v10 offset:20480
    buffer_store_dwordx4 v[72:75], v1, s[12:15], s59 offen offset:0 sc1
    v_mfma_f32_16x16x32_bf16 v[28:31], a[76:79], a[152:155], v[28:31]
    ds_read_b64_tr_b16 a[96:97], v7 offset:0
    v_cvt_pk_bf16_f32 v224, v224, v225
    v_mfma_f32_16x16x32_bf16 v[44:47], a[64:67], a[132:135], 0
    ds_read_b128 a[120:123], v3 offset:0
    ds_read_b64_tr_b16 a[98:99], v7 offset:4096
    v_mfma_f32_16x16x32_bf16 v[44:47], a[68:71], a[140:143], v[44:47]
    ds_read_b64_tr_b16 a[100:101], v7 offset:16384
    v_xor_b32 v8, 65600, v6
    v_mfma_f32_16x16x32_bf16 v[44:47], a[72:75], a[148:151], v[44:47]
    ds_read_b128 a[116:119], v14 offset:2048
    ds_read_b64_tr_b16 a[102:103], v7 offset:20480
    v_mfma_f32_16x16x32_bf16 v[44:47], a[76:79], a[156:159], v[44:47]
    s_waitcnt lgkmcnt(9)
    ds_read_b64_tr_b16 a[104:105], v8 offset:0
    v_cvt_pk_bf16_f32 v225, v226, v227
    v_mfma_f32_16x16x32_bf16 v[52:55], a[80:83], a[128:131], 0
    ds_read_b128 a[124:127], v3 offset:2048
    ds_read_b64_tr_b16 a[106:107], v8 offset:4096
    v_mfma_f32_16x16x32_bf16 v[52:55], a[84:87], a[136:139], v[52:55]
    s_add_u32 s59, s58, 16384
    ds_read_b64_tr_b16 a[108:109], v8 offset:16384
    v_cvt_pk_bf16_f32 v226, v228, v229
    v_mfma_f32_16x16x32_bf16 v[52:55], a[88:91], a[144:147], v[52:55]
    s_waitcnt lgkmcnt(10)
    ds_read_b64_tr_b16 a[110:111], v8 offset:20480
    v_xor_b32 v9, 96, v6
    v_mfma_f32_16x16x32_bf16 v[52:55], a[92:95], a[152:155], v[52:55]
    ds_read_b64_tr_b16 a[64:65], v9 offset:0
    buffer_store_dwordx4 v[80:83], v1, s[12:15], s59 offen offset:1024 sc1
    v_mfma_f32_16x16x32_bf16 v[60:63], a[80:83], a[132:135], 0
    ds_read_b64_tr_b16 a[66:67], v9 offset:4096
    v_cvt_pk_bf16_f32 v227, v230, v231
    v_mfma_f32_16x16x32_bf16 v[60:63], a[84:87], a[140:143], v[60:63]
    ds_read_b64_tr_b16 a[68:69], v9 offset:16384
    v_cvt_pk_bf16_f32 v232, v232, v233
    v_mfma_f32_16x16x32_bf16 v[60:63], a[88:91], a[148:151], v[60:63]
    ds_read_b64_tr_b16 a[70:71], v9 offset:20480
    v_xor_b32 v10, 65632, v6
    v_mfma_f32_16x16x32_bf16 v[60:63], a[92:95], a[156:159], v[60:63]
    s_waitcnt lgkmcnt(6)
    ds_read_b64_tr_b16 a[72:73], v10 offset:0
    v_cvt_pk_bf16_f32 v233, v234, v235
    v_mfma_f32_16x16x32_bf16 v[20:23], a[96:99], a[128:131], 0
    ds_read_b64_tr_b16 a[74:75], v10 offset:4096
    v_cvt_pk_bf16_f32 v234, v236, v237
    v_mfma_f32_16x16x32_bf16 v[20:23], a[100:103], a[136:139], v[20:23]
    s_waitcnt lgkmcnt(8)
    ds_read_b64_tr_b16 a[76:77], v10 offset:16384
    v_xor_b32 v7, 128, v6
    v_mfma_f32_16x16x32_bf16 v[20:23], a[104:107], a[144:147], v[20:23]
    s_waitcnt lgkmcnt(7)
    s_barrier
    ds_read_b64_tr_b16 a[78:79], v10 offset:20480
    v_mfma_f32_16x16x32_bf16 v[20:23], a[108:111], a[152:155], v[20:23]
    s_add_u32 m0, s29, 131072
    ds_read_b64_tr_b16 a[80:81], v7 offset:0
    v_add_u32 v2, 0x80000, v2
    v_mfma_f32_16x16x32_bf16 v[36:39], a[96:99], a[132:135], 0
    ds_read_b64_tr_b16 a[82:83], v7 offset:4096
    buffer_load_dwordx4 v2, s[16:19], 0 offen lds
    v_mfma_f32_16x16x32_bf16 v[36:39], a[100:103], a[140:143], v[36:39]
    ds_read_b64_tr_b16 a[84:85], v7 offset:16384
    v_cvt_pk_bf16_f32 v235, v238, v239
    v_mfma_f32_16x16x32_bf16 v[36:39], a[104:107], a[148:151], v[36:39]
    s_add_u32 s59, s58, 0
    ds_read_b64_tr_b16 a[86:87], v7 offset:20480
    v_xor_b32 v8, 65664, v6
    v_mfma_f32_16x16x32_bf16 v[36:39], a[108:111], a[156:159], v[36:39]
    s_waitcnt lgkmcnt(6)
    ds_read_b64_tr_b16 a[88:89], v8 offset:0
    buffer_store_dwordx4 v[88:91], v1, s[12:15], s59 offen offset:1024 sc1
    v_mfma_f32_16x16x32_bf16 v[68:71], a[64:67], a[128:131], 0
    ds_read_b64_tr_b16 a[90:91], v8 offset:4096
    v_cvt_pk_bf16_f32 v240, v240, v241
    v_mfma_f32_16x16x32_bf16 v[68:71], a[68:71], a[136:139], v[68:71]
    s_add_u32 m0, s29, 135168
    ds_read_b64_tr_b16 a[92:93], v8 offset:16384
    v_cvt_pk_bf16_f32 v241, v242, v243
    v_mfma_f32_16x16x32_bf16 v[68:71], a[72:75], a[144:147], v[68:71]
    s_waitcnt lgkmcnt(7)
    ds_read_b64_tr_b16 a[94:95], v8 offset:20480
    v_xor_b32 v9, 160, v6
    v_mfma_f32_16x16x32_bf16 v[68:71], a[76:79], a[152:155], v[68:71]
    ds_read_b64_tr_b16 a[96:97], v9 offset:0
    buffer_load_dwordx4 v2, s[16:19], s48 offen lds
    v_mfma_f32_16x16x32_bf16 v[76:79], a[64:67], a[132:135], 0
    ds_read_b64_tr_b16 a[98:99], v9 offset:4096
    v_cvt_pk_bf16_f32 v242, v244, v245
    v_mfma_f32_16x16x32_bf16 v[76:79], a[68:71], a[140:143], v[76:79]
    ds_read_b64_tr_b16 a[100:101], v9 offset:16384
    v_cvt_pk_bf16_f32 v243, v246, v247
    v_mfma_f32_16x16x32_bf16 v[76:79], a[72:75], a[148:151], v[76:79]
    s_add_u32 s59, s58, 0
    ds_read_b64_tr_b16 a[102:103], v9 offset:20480
    v_xor_b32 v10, 65696, v6
    v_mfma_f32_16x16x32_bf16 v[76:79], a[76:79], a[156:159], v[76:79]
    s_waitcnt lgkmcnt(6)
    ds_read_b64_tr_b16 a[104:105], v10 offset:0
    buffer_store_dwordx4 v[96:99], v1, s[12:15], s59 offen offset:2048 sc1
    v_mfma_f32_16x16x32_bf16 v[84:87], a[80:83], a[128:131], 0
    s_add_u32 m0, s29, 139264
    ds_read_b64_tr_b16 a[106:107], v10 offset:4096
    v_cvt_pk_bf16_f32 v248, v248, v249
    v_mfma_f32_16x16x32_bf16 v[84:87], a[84:87], a[136:139], v[84:87]
    ds_read_b64_tr_b16 a[108:109], v10 offset:16384
    buffer_load_dwordx4 v2, s[16:19], s49 offen lds
    v_mfma_f32_16x16x32_bf16 v[84:87], a[88:91], a[144:147], v[84:87]
    s_waitcnt lgkmcnt(7)
    ds_read_b64_tr_b16 a[110:111], v10 offset:20480
    v_xor_b32 v7, 192, v6
    v_mfma_f32_16x16x32_bf16 v[84:87], a[92:95], a[152:155], v[84:87]
    ds_read_b64_tr_b16 a[64:65], v7 offset:0
    v_cvt_pk_bf16_f32 v249, v250, v251
    v_mfma_f32_16x16x32_bf16 v[92:95], a[80:83], a[132:135], 0
    ds_read_b64_tr_b16 a[66:67], v7 offset:4096
    v_cvt_pk_bf16_f32 v250, v252, v253
    v_mfma_f32_16x16x32_bf16 v[92:95], a[84:87], a[140:143], v[92:95]
    ds_read_b64_tr_b16 a[68:69], v7 offset:16384
    v_cvt_pk_bf16_f32 v251, v254, v255
    v_mfma_f32_16x16x32_bf16 v[92:95], a[88:91], a[148:151], v[92:95]
    s_add_u32 m0, s29, 143360
    ds_read_b64_tr_b16 a[70:71], v7 offset:20480
    v_xor_b32 v8, 65728, v6
    v_mfma_f32_16x16x32_bf16 v[92:95], a[92:95], a[156:159], v[92:95]
    s_waitcnt lgkmcnt(6)
    ds_read_b64_tr_b16 a[72:73], v8 offset:0
    buffer_load_dwordx4 v2, s[16:19], s50 offen lds
    v_mfma_f32_16x16x32_bf16 v[100:103], a[96:99], a[128:131], 0
    s_add_u32 s59, s58, 16384
    ds_read_b64_tr_b16 a[74:75], v8 offset:4096
    v_accvgpr_read_b32 v11, a245
    v_mfma_f32_16x16x32_bf16 v[100:103], a[100:103], a[136:139], v[100:103]
    ds_read_b64_tr_b16 a[76:77], v8 offset:16384
    buffer_store_dwordx4 v[104:107], v1, s[12:15], s59 offen offset:2048 sc1
    v_mfma_f32_16x16x32_bf16 v[100:103], a[104:107], a[144:147], v[100:103]
    s_waitcnt lgkmcnt(7)
    ds_read_b64_tr_b16 a[78:79], v8 offset:20480
    v_xor_b32 v9, 224, v6
    v_mfma_f32_16x16x32_bf16 v[100:103], a[108:111], a[152:155], v[100:103]
    s_and_b32 s36, s95, 31
    ds_read_b64_tr_b16 a[80:81], v9 offset:0
    v_mov_b32 v12, 0
    v_mfma_f32_16x16x32_bf16 v[108:111], a[96:99], a[132:135], 0
    s_add_u32 m0, s29, 147456
    ds_read_b64_tr_b16 a[82:83], v9 offset:4096
    v_mfma_f32_16x16x32_bf16 v[108:111], a[100:103], a[140:143], v[108:111]
    ds_read_b64_tr_b16 a[84:85], v9 offset:16384
    buffer_load_dwordx4 v2, s[16:19], s51 offen lds
    v_mfma_f32_16x16x32_bf16 v[108:111], a[104:107], a[148:151], v[108:111]
    s_lshr_b32 s37, s95, 5
    ds_read_b64_tr_b16 a[86:87], v9 offset:20480
    v_xor_b32 v10, 65760, v6
    v_mfma_f32_16x16x32_bf16 v[108:111], a[108:111], a[156:159], v[108:111]
    s_waitcnt lgkmcnt(6)
    ds_read_b64_tr_b16 a[88:89], v10 offset:0
    global_load_dword a248, v12, s[90:91] offset:128 sc1
    v_mfma_f32_16x16x32_bf16 v[116:119], a[64:67], a[128:131], 0
    s_lshl_b32 s38, s3, 4
    ds_read_b64_tr_b16 a[90:91], v10 offset:4096
    v_and_b32 v12, 15, v0
    v_mfma_f32_16x16x32_bf16 v[116:119], a[68:71], a[136:139], v[116:119]
    s_add_u32 m0, s29, 151552
    ds_read_b64_tr_b16 a[92:93], v10 offset:16384
    v_lshlrev_b32 v12, 2, v12
    v_mfma_f32_16x16x32_bf16 v[116:119], a[72:75], a[144:147], v[116:119]
    s_waitcnt lgkmcnt(7)
    ds_read_b64_tr_b16 a[94:95], v10 offset:20480
    v_xor_b32 v7, 256, v6
    v_mfma_f32_16x16x32_bf16 v[116:119], a[76:79], a[152:155], v[116:119]
    ds_read_b64_tr_b16 a[96:97], v7 offset:0
    buffer_load_dwordx4 v2, s[16:19], s52 offen lds
    v_mfma_f32_16x16x32_bf16 v[124:127], a[64:67], a[132:135], 0
    s_add_u32 s59, s58, 16384
    ds_read_b64_tr_b16 a[98:99], v7 offset:4096
    v_mfma_f32_16x16x32_bf16 v[124:127], a[68:71], a[140:143], v[124:127]
    ds_read_b64_tr_b16 a[100:101], v7 offset:16384
    buffer_store_dwordx4 v[112:115], v1, s[12:15], s59 offen offset:3072 sc1
    v_mfma_f32_16x16x32_bf16 v[124:127], a[72:75], a[148:151], v[124:127]
    s_lshl_b32 s39, s36, 6
    ds_read_b64_tr_b16 a[102:103], v7 offset:20480
    v_xor_b32 v8, 65792, v6
    v_mfma_f32_16x16x32_bf16 v[124:127], a[76:79], a[156:159], v[124:127]
    s_waitcnt lgkmcnt(6)
    ds_read_b64_tr_b16 a[104:105], v8 offset:0
    v_mfma_f32_16x16x32_bf16 v[132:135], a[80:83], a[128:131], 0
    s_add_u32 m0, s29, 155648
    ds_read_b64_tr_b16 a[106:107], v8 offset:4096
    v_mfma_f32_16x16x32_bf16 v[132:135], a[84:87], a[136:139], v[132:135]
    ds_read_b64_tr_b16 a[108:109], v8 offset:16384
    buffer_load_dwordx4 v2, s[16:19], s53 offen lds
    v_mfma_f32_16x16x32_bf16 v[132:135], a[88:91], a[144:147], v[132:135]
    s_waitcnt lgkmcnt(7)
    ds_read_b64_tr_b16 a[110:111], v8 offset:20480
    v_xor_b32 v9, 288, v6
    v_mfma_f32_16x16x32_bf16 v[132:135], a[92:95], a[152:155], v[132:135]
    s_add_u32 s38, s38, s39
    ds_read_b64_tr_b16 a[64:65], v9 offset:0
    v_mfma_f32_16x16x32_bf16 v[140:143], a[80:83], a[132:135], 0
    s_add_u32 s59, s58, 0
    ds_read_b64_tr_b16 a[66:67], v9 offset:4096
    v_mfma_f32_16x16x32_bf16 v[140:143], a[84:87], a[140:143], v[140:143]
    ds_read_b64_tr_b16 a[68:69], v9 offset:16384
    buffer_store_dwordx4 v[120:123], v1, s[12:15], s59 offen offset:3072 sc1
    v_mfma_f32_16x16x32_bf16 v[140:143], a[88:91], a[148:151], v[140:143]
    s_add_u32 m0, s29, 159744
    ds_read_b64_tr_b16 a[70:71], v9 offset:20480
    v_xor_b32 v10, 65824, v6
    v_mfma_f32_16x16x32_bf16 v[140:143], a[92:95], a[156:159], v[140:143]
    s_waitcnt lgkmcnt(6)
    ds_read_b64_tr_b16 a[72:73], v10 offset:0
    buffer_load_dwordx4 v2, s[16:19], s54 offen lds
    v_mfma_f32_16x16x32_bf16 v[148:151], a[96:99], a[128:131], 0
    s_mul_i32 s38, s38, 896
    ds_read_b64_tr_b16 a[74:75], v10 offset:4096
    v_mfma_f32_16x16x32_bf16 v[148:151], a[100:103], a[136:139], v[148:151]
    s_lshl_b32 s39, s37, 7
    ds_read_b64_tr_b16 a[76:77], v10 offset:16384
    v_mfma_f32_16x16x32_bf16 v[148:151], a[104:107], a[144:147], v[148:151]
    s_waitcnt lgkmcnt(7)
    ds_read_b64_tr_b16 a[78:79], v10 offset:20480
    v_xor_b32 v7, 320, v6
    v_mfma_f32_16x16x32_bf16 v[148:151], a[108:111], a[152:155], v[148:151]
    s_add_u32 s38, s38, s39
    ds_read_b64_tr_b16 a[80:81], v7 offset:0
    v_mfma_f32_16x16x32_bf16 v[156:159], a[96:99], a[132:135], 0
    s_add_u32 s59, s58, 4096
    ds_read_b64_tr_b16 a[82:83], v7 offset:4096
    v_mfma_f32_16x16x32_bf16 v[156:159], a[100:103], a[140:143], v[156:159]
    ds_read_b64_tr_b16 a[84:85], v7 offset:16384
    buffer_store_dwordx4 v[128:131], v1, s[12:15], s59 offen offset:0 sc1
    v_mfma_f32_16x16x32_bf16 v[156:159], a[104:107], a[148:151], v[156:159]
    s_lshl_b32 s39, s37, 9
    ds_read_b64_tr_b16 a[86:87], v7 offset:20480
    v_xor_b32 v8, 65856, v6
    v_mfma_f32_16x16x32_bf16 v[156:159], a[108:111], a[156:159], v[156:159]
    s_waitcnt lgkmcnt(6)
    ds_read_b64_tr_b16 a[88:89], v8 offset:0
    v_mfma_f32_16x16x32_bf16 v[164:167], a[64:67], a[128:131], 0
    s_mov_b32 s4, s66
    ds_read_b64_tr_b16 a[90:91], v8 offset:4096
    v_mfma_f32_16x16x32_bf16 v[164:167], a[68:71], a[136:139], v[164:167]
    s_mov_b32 s5, s67
    ds_read_b64_tr_b16 a[92:93], v8 offset:16384
    v_mfma_f32_16x16x32_bf16 v[164:167], a[72:75], a[144:147], v[164:167]
    s_waitcnt lgkmcnt(7)
    ds_read_b64_tr_b16 a[94:95], v8 offset:20480
    v_xor_b32 v9, 352, v6
    v_mfma_f32_16x16x32_bf16 v[164:167], a[76:79], a[152:155], v[164:167]
    s_mov_b32 s6, 1835008
    ds_read_b64_tr_b16 a[96:97], v9 offset:0
    v_mfma_f32_16x16x32_bf16 v[172:175], a[64:67], a[132:135], 0
    s_add_u32 s59, s58, 20480
    ds_read_b64_tr_b16 a[98:99], v9 offset:4096
    v_mfma_f32_16x16x32_bf16 v[172:175], a[68:71], a[140:143], v[172:175]
    ds_read_b64_tr_b16 a[100:101], v9 offset:16384
    buffer_store_dwordx4 v[136:139], v1, s[12:15], s59 offen offset:0 sc1
    v_mfma_f32_16x16x32_bf16 v[172:175], a[72:75], a[148:151], v[172:175]
    s_mov_b32 s7, 0x20000
    ds_read_b64_tr_b16 a[102:103], v9 offset:20480
    v_xor_b32 v10, 65888, v6
    v_mfma_f32_16x16x32_bf16 v[172:175], a[76:79], a[156:159], v[172:175]
    s_waitcnt lgkmcnt(6)
    ds_read_b64_tr_b16 a[104:105], v10 offset:0
    v_mfma_f32_16x16x32_bf16 v[180:183], a[80:83], a[128:131], 0
    s_mov_b32 s8, s68
    ds_read_b64_tr_b16 a[106:107], v10 offset:4096
    v_mfma_f32_16x16x32_bf16 v[180:183], a[84:87], a[136:139], v[180:183]
    s_mov_b32 s9, s69
    ds_read_b64_tr_b16 a[108:109], v10 offset:16384
    v_mfma_f32_16x16x32_bf16 v[180:183], a[88:91], a[144:147], v[180:183]
    s_waitcnt lgkmcnt(7)
    ds_read_b64_tr_b16 a[110:111], v10 offset:20480
    v_xor_b32 v7, 384, v6
    v_mfma_f32_16x16x32_bf16 v[180:183], a[92:95], a[152:155], v[180:183]
    s_mov_b32 s10, 1835008
    ds_read_b64_tr_b16 a[64:65], v7 offset:0
    v_mfma_f32_16x16x32_bf16 v[188:191], a[80:83], a[132:135], 0
    s_add_u32 s59, s58, 20480
    ds_read_b64_tr_b16 a[66:67], v7 offset:4096
    v_mfma_f32_16x16x32_bf16 v[188:191], a[84:87], a[140:143], v[188:191]
    ds_read_b64_tr_b16 a[68:69], v7 offset:16384
    buffer_store_dwordx4 v[144:147], v1, s[12:15], s59 offen offset:1024 sc1
    v_mfma_f32_16x16x32_bf16 v[188:191], a[88:91], a[148:151], v[188:191]
    s_mov_b32 s11, 0x20000
    ds_read_b64_tr_b16 a[70:71], v7 offset:20480
    v_xor_b32 v8, 65920, v6
    v_mfma_f32_16x16x32_bf16 v[188:191], a[92:95], a[156:159], v[188:191]
    s_waitcnt lgkmcnt(6)
    ds_read_b64_tr_b16 a[72:73], v8 offset:0
    v_mfma_f32_16x16x32_bf16 v[196:199], a[96:99], a[128:131], 0
    s_mov_b32 s20, s70
    ds_read_b64_tr_b16 a[74:75], v8 offset:4096
    v_mfma_f32_16x16x32_bf16 v[196:199], a[100:103], a[136:139], v[196:199]
    s_mov_b32 s21, s71
    ds_read_b64_tr_b16 a[76:77], v8 offset:16384
    v_mfma_f32_16x16x32_bf16 v[196:199], a[104:107], a[144:147], v[196:199]
    s_waitcnt lgkmcnt(7)
    ds_read_b64_tr_b16 a[78:79], v8 offset:20480
    v_xor_b32 v9, 416, v6
    v_mfma_f32_16x16x32_bf16 v[196:199], a[108:111], a[152:155], v[196:199]
    s_mov_b32 s22, 3584
    ds_read_b64_tr_b16 a[80:81], v9 offset:0
    v_mfma_f32_16x16x32_bf16 v[204:207], a[96:99], a[132:135], 0
    s_add_u32 s59, s58, 4096
    ds_read_b64_tr_b16 a[82:83], v9 offset:4096
    v_mfma_f32_16x16x32_bf16 v[204:207], a[100:103], a[140:143], v[204:207]
    ds_read_b64_tr_b16 a[84:85], v9 offset:16384
    buffer_store_dwordx4 v[152:155], v1, s[12:15], s59 offen offset:1024 sc1
    v_mfma_f32_16x16x32_bf16 v[204:207], a[104:107], a[148:151], v[204:207]
    s_mov_b32 s23, 0x20000
    ds_read_b64_tr_b16 a[86:87], v9 offset:20480
    v_xor_b32 v10, 65952, v6
    v_mfma_f32_16x16x32_bf16 v[204:207], a[108:111], a[156:159], v[204:207]
    s_waitcnt lgkmcnt(6)
    ds_read_b64_tr_b16 a[88:89], v10 offset:0
    v_lshrrev_b32 v120, 3, v0
    v_mfma_f32_16x16x32_bf16 v[212:215], a[64:67], a[128:131], 0
    ds_read_b64_tr_b16 a[90:91], v10 offset:4096
    v_mul_u32_u24 v120, 1792, v120
    v_mfma_f32_16x16x32_bf16 v[212:215], a[68:71], a[136:139], v[212:215]
    ds_read_b64_tr_b16 a[92:93], v10 offset:16384
    v_and_b32 v121, 7, v0
    v_mfma_f32_16x16x32_bf16 v[212:215], a[72:75], a[144:147], v[212:215]
    s_waitcnt lgkmcnt(7)
    ds_read_b64_tr_b16 a[94:95], v10 offset:20480
    v_xor_b32 v7, 448, v6
    v_mfma_f32_16x16x32_bf16 v[212:215], a[76:79], a[152:155], v[212:215]
    ds_read_b64_tr_b16 a[96:97], v7 offset:0
    v_lshl_add_u32 v120, v121, 4, v120
    v_mfma_f32_16x16x32_bf16 v[220:223], a[64:67], a[132:135], 0
    s_add_u32 s59, s58, 4096
    ds_read_b64_tr_b16 a[98:99], v7 offset:4096
    v_add_u32 v120, s38, v120
    v_mfma_f32_16x16x32_bf16 v[220:223], a[68:71], a[140:143], v[220:223]
    ds_read_b64_tr_b16 a[100:101], v7 offset:16384
    buffer_store_dwordx4 v[160:163], v1, s[12:15], s59 offen offset:2048 sc1
    v_mfma_f32_16x16x32_bf16 v[220:223], a[72:75], a[148:151], v[220:223]
    ds_read_b64_tr_b16 a[102:103], v7 offset:20480
    v_xor_b32 v8, 65984, v6
    v_mfma_f32_16x16x32_bf16 v[220:223], a[76:79], a[156:159], v[220:223]
    s_waitcnt lgkmcnt(6)
    ds_read_b64_tr_b16 a[104:105], v8 offset:0
    v_lshlrev_b32 v121, 6, v121
    v_mfma_f32_16x16x32_bf16 v[228:231], a[80:83], a[128:131], 0
    ds_read_b64_tr_b16 a[106:107], v8 offset:4096
    v_subrev_u32 v122, 2688, v120
    v_mfma_f32_16x16x32_bf16 v[228:231], a[84:87], a[136:139], v[228:231]
    ds_read_b64_tr_b16 a[108:109], v8 offset:16384
    v_subrev_u32 v123, 1792, v120
    v_mfma_f32_16x16x32_bf16 v[228:231], a[88:91], a[144:147], v[228:231]
    s_waitcnt lgkmcnt(7)
    ds_read_b64_tr_b16 a[110:111], v8 offset:20480
    v_xor_b32 v9, 480, v6
    v_mfma_f32_16x16x32_bf16 v[228:231], a[92:95], a[152:155], v[228:231]
    ds_read_b64_tr_b16 a[64:65], v9 offset:0
    v_subrev_u32 v128, 896, v120
    v_mfma_f32_16x16x32_bf16 v[236:239], a[80:83], a[132:135], 0
    s_add_u32 s59, s58, 20480
    ds_read_b64_tr_b16 a[66:67], v9 offset:4096
    v_mfma_f32_16x16x32_bf16 v[236:239], a[84:87], a[140:143], v[236:239]
    ds_read_b64_tr_b16 a[68:69], v9 offset:16384
    buffer_store_dwordx4 v[168:171], v1, s[12:15], s59 offen offset:2048 sc1
    v_mfma_f32_16x16x32_bf16 v[236:239], a[88:91], a[148:151], v[236:239]
    ds_read_b64_tr_b16 a[70:71], v9 offset:20480
    v_xor_b32 v10, 66016, v6
    v_mfma_f32_16x16x32_bf16 v[236:239], a[92:95], a[156:159], v[236:239]
    s_waitcnt lgkmcnt(6)
    ds_read_b64_tr_b16 a[72:73], v10 offset:0
    v_mfma_f32_16x16x32_bf16 v[244:247], a[96:99], a[128:131], 0
    ds_read_b64_tr_b16 a[74:75], v10 offset:4096
    v_mfma_f32_16x16x32_bf16 v[244:247], a[100:103], a[136:139], v[244:247]
    s_waitcnt vmcnt(23)
    ds_read_b64_tr_b16 a[76:77], v10 offset:16384
    v_xor_b32 v7, 32768, v6
    v_mfma_f32_16x16x32_bf16 v[244:247], a[104:107], a[144:147], v[244:247]
    s_waitcnt lgkmcnt(7)
    s_barrier
    ds_read_b64_tr_b16 a[78:79], v10 offset:20480
    v_mfma_f32_16x16x32_bf16 v[244:247], a[108:111], a[152:155], v[244:247]
    ds_read_b64_tr_b16 a[80:81], v7 offset:0
    v_mfma_f32_16x16x32_bf16 v[252:255], a[96:99], a[132:135], 0
    s_add_u32 s59, s58, 20480
    ds_read_b64_tr_b16 a[82:83], v7 offset:4096
    v_mfma_f32_16x16x32_bf16 v[252:255], a[100:103], a[140:143], v[252:255]
    ds_read_b64_tr_b16 a[84:85], v7 offset:16384
    buffer_store_dwordx4 v[176:179], v1, s[12:15], s59 offen offset:3072 sc1
    v_mfma_f32_16x16x32_bf16 v[252:255], a[104:107], a[148:151], v[252:255]
    ds_read_b64_tr_b16 a[86:87], v7 offset:20480
    v_xor_b32 v8, 98304, v6
    v_mfma_f32_16x16x32_bf16 v[252:255], a[108:111], a[156:159], v[252:255]
    s_waitcnt lgkmcnt(6)
    ds_read_b64_tr_b16 a[88:89], v8 offset:0
    v_mfma_f32_16x16x32_bf16 v[16:19], a[64:67], a[128:131], 0
    ds_read_b64_tr_b16 a[90:91], v8 offset:4096
    v_mfma_f32_16x16x32_bf16 v[16:19], a[68:71], a[136:139], v[16:19]
    ds_read_b64_tr_b16 a[92:93], v8 offset:16384
    v_mfma_f32_16x16x32_bf16 v[16:19], a[72:75], a[144:147], v[16:19]
    s_waitcnt lgkmcnt(7)
    ds_read_b64_tr_b16 a[94:95], v8 offset:20480
    v_xor_b32 v9, 32800, v6
    v_mfma_f32_16x16x32_bf16 v[16:19], a[76:79], a[152:155], v[16:19]
    ds_read_b64_tr_b16 a[96:97], v9 offset:0
    v_mfma_f32_16x16x32_bf16 v[24:27], a[64:67], a[132:135], 0
    s_waitcnt lgkmcnt(9)
    ds_read_b64_tr_b16 a[98:99], v9 offset:4096
    v_mfma_f32_16x16x32_bf16 v[24:27], a[68:71], a[140:143], v[24:27]
    s_barrier
    ds_read_b64_tr_b16 a[100:101], v9 offset:16384
    v_mfma_f32_16x16x32_bf16 v[24:27], a[72:75], a[148:151], v[24:27]
    s_add_u32 m0, s29, 0
    ds_read_b64_tr_b16 a[102:103], v9 offset:20480
    v_xor_b32 v10, 98336, v6
    v_mfma_f32_16x16x32_bf16 v[24:27], a[76:79], a[156:159], v[24:27]
    s_waitcnt lgkmcnt(6)
    ds_read_b64_tr_b16 a[104:105], v10 offset:0
    v_add_u32 v2, 0x80000, v2
    v_mfma_f32_16x16x32_bf16 v[28:31], a[80:83], a[160:163], v[28:31]
    ds_read_b64_tr_b16 a[106:107], v10 offset:4096
    buffer_load_dwordx4 v2, s[16:19], 0 offen lds
    v_mfma_f32_16x16x32_bf16 v[28:31], a[84:87], a[168:171], v[28:31]
    s_add_u32 s59, s58, 4096
    ds_read_b64_tr_b16 a[108:109], v10 offset:16384
    v_mfma_f32_16x16x32_bf16 v[28:31], a[88:91], a[176:179], v[28:31]
    s_waitcnt lgkmcnt(7)
    ds_read_b64_tr_b16 a[110:111], v10 offset:20480
    v_xor_b32 v7, 32832, v6
    v_mfma_f32_16x16x32_bf16 v[28:31], a[92:95], a[184:187], v[28:31]
    ds_read_b64_tr_b16 a[64:65], v7 offset:0
    buffer_store_dwordx4 v[184:187], v1, s[12:15], s59 offen offset:3072 sc1
    v_mfma_f32_16x16x32_bf16 v[44:47], a[80:83], a[164:167], v[44:47]
    s_add_u32 m0, s29, 4096
    ds_read_b64_tr_b16 a[66:67], v7 offset:4096
    v_mfma_f32_16x16x32_bf16 v[44:47], a[84:87], a[172:175], v[44:47]
    ds_read_b64_tr_b16 a[68:69], v7 offset:16384
    buffer_load_dwordx4 v2, s[16:19], s48 offen lds
    v_mfma_f32_16x16x32_bf16 v[44:47], a[88:91], a[180:183], v[44:47]
    ds_read_b64_tr_b16 a[70:71], v7 offset:20480
    v_xor_b32 v8, 98368, v6
    v_mfma_f32_16x16x32_bf16 v[44:47], a[92:95], a[188:191], v[44:47]
    s_waitcnt lgkmcnt(6)
    ds_read_b64_tr_b16 a[72:73], v8 offset:0
    v_mfma_f32_16x16x32_bf16 v[52:55], a[96:99], a[160:163], v[52:55]
    ds_read_b64_tr_b16 a[74:75], v8 offset:4096
    v_mfma_f32_16x16x32_bf16 v[52:55], a[100:103], a[168:171], v[52:55]
    s_add_u32 m0, s29, 8192
    ds_read_b64_tr_b16 a[76:77], v8 offset:16384
    v_mfma_f32_16x16x32_bf16 v[52:55], a[104:107], a[176:179], v[52:55]
    s_waitcnt lgkmcnt(7)
    ds_read_b64_tr_b16 a[78:79], v8 offset:20480
    v_xor_b32 v9, 32864, v6
    v_mfma_f32_16x16x32_bf16 v[52:55], a[108:111], a[184:187], v[52:55]
    ds_read_b64_tr_b16 a[80:81], v9 offset:0
    buffer_load_dwordx4 v2, s[16:19], s49 offen lds
    v_mfma_f32_16x16x32_bf16 v[60:63], a[96:99], a[164:167], v[60:63]
    s_add_u32 s59, s58, 36864
    ds_read_b64_tr_b16 a[82:83], v9 offset:4096
    v_mfma_f32_16x16x32_bf16 v[60:63], a[100:103], a[172:175], v[60:63]
    ds_read_b64_tr_b16 a[84:85], v9 offset:16384
    buffer_store_dwordx4 v[192:195], v1, s[12:15], s59 offen offset:0 sc1
    v_mfma_f32_16x16x32_bf16 v[60:63], a[104:107], a[180:183], v[60:63]
    s_add_u32 m0, s29, 12288
    ds_read_b64_tr_b16 a[86:87], v9 offset:20480
    v_xor_b32 v10, 98400, v6
    v_mfma_f32_16x16x32_bf16 v[60:63], a[108:111], a[188:191], v[60:63]
    s_waitcnt lgkmcnt(6)
    ds_read_b64_tr_b16 a[88:89], v10 offset:0
    v_mfma_f32_16x16x32_bf16 v[20:23], a[64:67], a[160:163], v[20:23]
    ds_read_b64_tr_b16 a[90:91], v10 offset:4096
    buffer_load_dwordx4 v2, s[16:19], s50 offen lds
    v_mfma_f32_16x16x32_bf16 v[20:23], a[68:71], a[168:171], v[20:23]
    ds_read_b64_tr_b16 a[92:93], v10 offset:16384
    v_mfma_f32_16x16x32_bf16 v[20:23], a[72:75], a[176:179], v[20:23]
    s_waitcnt lgkmcnt(7)
    ds_read_b64_tr_b16 a[94:95], v10 offset:20480
    v_xor_b32 v7, 32896, v6
    v_mfma_f32_16x16x32_bf16 v[20:23], a[76:79], a[184:187], v[20:23]
    ds_read_b64_tr_b16 a[96:97], v7 offset:0
    v_mfma_f32_16x16x32_bf16 v[36:39], a[64:67], a[164:167], v[36:39]
    s_add_u32 m0, s29, 16384
    ds_read_b64_tr_b16 a[98:99], v7 offset:4096
    v_mfma_f32_16x16x32_bf16 v[36:39], a[68:71], a[172:175], v[36:39]
    ds_read_b64_tr_b16 a[100:101], v7 offset:16384
    buffer_load_dwordx4 v2, s[16:19], s51 offen lds
    v_mfma_f32_16x16x32_bf16 v[36:39], a[72:75], a[180:183], v[36:39]
    s_add_u32 s59, s58, 53248
    ds_read_b64_tr_b16 a[102:103], v7 offset:20480
    v_xor_b32 v8, 98432, v6
    v_mfma_f32_16x16x32_bf16 v[36:39], a[76:79], a[188:191], v[36:39]
    s_waitcnt lgkmcnt(6)
    ds_read_b64_tr_b16 a[104:105], v8 offset:0
    buffer_store_dwordx4 v[200:203], v1, s[12:15], s59 offen offset:0 sc1
    v_mfma_f32_16x16x32_bf16 v[68:71], a[80:83], a[160:163], v[68:71]
    ds_read_b64_tr_b16 a[106:107], v8 offset:4096
    v_mfma_f32_16x16x32_bf16 v[68:71], a[84:87], a[168:171], v[68:71]
    s_add_u32 m0, s29, 20480
    ds_read_b64_tr_b16 a[108:109], v8 offset:16384
    v_mfma_f32_16x16x32_bf16 v[68:71], a[88:91], a[176:179], v[68:71]
    s_waitcnt lgkmcnt(7)
    ds_read_b64_tr_b16 a[110:111], v8 offset:20480
    v_xor_b32 v9, 32928, v6
    v_mfma_f32_16x16x32_bf16 v[68:71], a[92:95], a[184:187], v[68:71]
    ds_read_b64_tr_b16 a[64:65], v9 offset:0
    buffer_load_dwordx4 v2, s[16:19], s52 offen lds
    v_mfma_f32_16x16x32_bf16 v[76:79], a[80:83], a[164:167], v[76:79]
    ds_read_b64_tr_b16 a[66:67], v9 offset:4096
    v_mfma_f32_16x16x32_bf16 v[76:79], a[84:87], a[172:175], v[76:79]
    ds_read_b64_tr_b16 a[68:69], v9 offset:16384
    v_mfma_f32_16x16x32_bf16 v[76:79], a[88:91], a[180:183], v[76:79]
    s_add_u32 m0, s29, 24576
    ds_read_b64_tr_b16 a[70:71], v9 offset:20480
    v_xor_b32 v10, 98464, v6
    v_mfma_f32_16x16x32_bf16 v[76:79], a[92:95], a[188:191], v[76:79]
    s_waitcnt lgkmcnt(6)
    ds_read_b64_tr_b16 a[72:73], v10 offset:0
    v_mfma_f32_16x16x32_bf16 v[84:87], a[96:99], a[160:163], v[84:87]
    ds_read_b64_tr_b16 a[74:75], v10 offset:4096
    buffer_load_dwordx4 v2, s[16:19], s53 offen lds
    v_mfma_f32_16x16x32_bf16 v[84:87], a[100:103], a[168:171], v[84:87]
    s_add_u32 s59, s58, 53248
    ds_read_b64_tr_b16 a[76:77], v10 offset:16384
    v_mfma_f32_16x16x32_bf16 v[84:87], a[104:107], a[176:179], v[84:87]
    s_waitcnt lgkmcnt(7)
    ds_read_b64_tr_b16 a[78:79], v10 offset:20480
    v_xor_b32 v7, 32960, v6
    v_mfma_f32_16x16x32_bf16 v[84:87], a[108:111], a[184:187], v[84:87]
    ds_read_b64_tr_b16 a[80:81], v7 offset:0
    buffer_store_dwordx4 v[208:211], v1, s[12:15], s59 offen offset:1024 sc1
    v_mfma_f32_16x16x32_bf16 v[92:95], a[96:99], a[164:167], v[92:95]
    s_add_u32 m0, s29, 28672
    ds_read_b64_tr_b16 a[82:83], v7 offset:4096
    v_mfma_f32_16x16x32_bf16 v[92:95], a[100:103], a[172:175], v[92:95]
    ds_read_b64_tr_b16 a[84:85], v7 offset:16384
    buffer_load_dwordx4 v2, s[16:19], s54 offen lds
    v_mfma_f32_16x16x32_bf16 v[92:95], a[104:107], a[180:183], v[92:95]
    ds_read_b64_tr_b16 a[86:87], v7 offset:20480
    v_xor_b32 v8, 98496, v6
    v_mfma_f32_16x16x32_bf16 v[92:95], a[108:111], a[188:191], v[92:95]
    s_waitcnt lgkmcnt(6)
    ds_read_b64_tr_b16 a[88:89], v8 offset:0
    v_mfma_f32_16x16x32_bf16 v[100:103], a[64:67], a[160:163], v[100:103]
    s_add_u32 m0, s29, 65536
    ds_read_b64_tr_b16 a[90:91], v8 offset:4096
    v_add_u32 v2, 0x80000, v2
    v_mfma_f32_16x16x32_bf16 v[100:103], a[68:71], a[168:171], v[100:103]
    ds_read_b64_tr_b16 a[92:93], v8 offset:16384
    buffer_load_dwordx4 v2, s[16:19], 0 offen lds
    v_mfma_f32_16x16x32_bf16 v[100:103], a[72:75], a[176:179], v[100:103]
    s_waitcnt lgkmcnt(7)
    ds_read_b64_tr_b16 a[94:95], v8 offset:20480
    v_xor_b32 v9, 32992, v6
    v_mfma_f32_16x16x32_bf16 v[100:103], a[76:79], a[184:187], v[100:103]
    s_add_u32 s59, s58, 36864
    ds_read_b64_tr_b16 a[96:97], v9 offset:0
    v_mfma_f32_16x16x32_bf16 v[108:111], a[64:67], a[164:167], v[108:111]
    ds_read_b64_tr_b16 a[98:99], v9 offset:4096
    buffer_store_dwordx4 v[216:219], v1, s[12:15], s59 offen offset:1024 sc1
    v_mfma_f32_16x16x32_bf16 v[108:111], a[68:71], a[172:175], v[108:111]
    ds_read_b64_tr_b16 a[100:101], v9 offset:16384
    v_mfma_f32_16x16x32_bf16 v[108:111], a[72:75], a[180:183], v[108:111]
    s_add_u32 m0, s29, 69632
    ds_read_b64_tr_b16 a[102:103], v9 offset:20480
    v_xor_b32 v10, 98528, v6
    v_mfma_f32_16x16x32_bf16 v[108:111], a[76:79], a[188:191], v[108:111]
    s_waitcnt lgkmcnt(6)
    ds_read_b64_tr_b16 a[104:105], v10 offset:0
    buffer_load_dwordx4 v2, s[16:19], s48 offen lds
    v_mfma_f32_16x16x32_bf16 v[116:119], a[80:83], a[160:163], v[116:119]
    ds_read_b64_tr_b16 a[106:107], v10 offset:4096
    v_mfma_f32_16x16x32_bf16 v[116:119], a[84:87], a[168:171], v[116:119]
    ds_read_b64_tr_b16 a[108:109], v10 offset:16384
    v_mfma_f32_16x16x32_bf16 v[116:119], a[88:91], a[176:179], v[116:119]
    s_waitcnt lgkmcnt(7)
    ds_read_b64_tr_b16 a[110:111], v10 offset:20480
    v_xor_b32 v7, 33024, v6
    v_mfma_f32_16x16x32_bf16 v[116:119], a[92:95], a[184:187], v[116:119]
    s_add_u32 m0, s29, 73728
    ds_read_b64_tr_b16 a[64:65], v7 offset:0
    v_mfma_f32_16x16x32_bf16 v[124:127], a[80:83], a[164:167], v[124:127]
    ds_read_b64_tr_b16 a[66:67], v7 offset:4096
    buffer_load_dwordx4 v2, s[16:19], s49 offen lds
    v_mfma_f32_16x16x32_bf16 v[124:127], a[84:87], a[172:175], v[124:127]
    ds_read_b64_tr_b16 a[68:69], v7 offset:16384
    v_mfma_f32_16x16x32_bf16 v[124:127], a[88:91], a[180:183], v[124:127]
    s_add_u32 s59, s58, 36864
    ds_read_b64_tr_b16 a[70:71], v7 offset:20480
    v_xor_b32 v8, 98560, v6
    v_mfma_f32_16x16x32_bf16 v[124:127], a[92:95], a[188:191], v[124:127]
    s_waitcnt lgkmcnt(6)
    ds_read_b64_tr_b16 a[72:73], v8 offset:0
    buffer_store_dwordx4 v[224:227], v1, s[12:15], s59 offen offset:2048 sc1
    v_mfma_f32_16x16x32_bf16 v[132:135], a[96:99], a[160:163], v[132:135]
    s_add_u32 m0, s29, 77824
    ds_read_b64_tr_b16 a[74:75], v8 offset:4096
    v_mfma_f32_16x16x32_bf16 v[132:135], a[100:103], a[168:171], v[132:135]
    ds_read_b64_tr_b16 a[76:77], v8 offset:16384
    buffer_load_dwordx4 v2, s[16:19], s50 offen lds
    v_mfma_f32_16x16x32_bf16 v[132:135], a[104:107], a[176:179], v[132:135]
    s_waitcnt lgkmcnt(7)
    ds_read_b64_tr_b16 a[78:79], v8 offset:20480
    v_xor_b32 v9, 33056, v6
    v_mfma_f32_16x16x32_bf16 v[132:135], a[108:111], a[184:187], v[132:135]
    ds_read_b64_tr_b16 a[80:81], v9 offset:0
    v_mfma_f32_16x16x32_bf16 v[140:143], a[96:99], a[164:167], v[140:143]
    ds_read_b64_tr_b16 a[82:83], v9 offset:4096
    v_mfma_f32_16x16x32_bf16 v[140:143], a[100:103], a[172:175], v[140:143]
    ds_read_b64_tr_b16 a[84:85], v9 offset:16384
    v_mfma_f32_16x16x32_bf16 v[140:143], a[104:107], a[180:183], v[140:143]
    s_add_u32 m0, s29, 81920
    ds_read_b64_tr_b16 a[86:87], v9 offset:20480
    v_xor_b32 v10, 98592, v6
    v_mfma_f32_16x16x32_bf16 v[140:143], a[108:111], a[188:191], v[140:143]
    s_waitcnt lgkmcnt(6)
    ds_read_b64_tr_b16 a[88:89], v10 offset:0
    buffer_load_dwordx4 v2, s[16:19], s51 offen lds
    v_mfma_f32_16x16x32_bf16 v[148:151], a[64:67], a[160:163], v[148:151]
    s_add_u32 s59, s58, 53248
    ds_read_b64_tr_b16 a[90:91], v10 offset:4096
    v_mfma_f32_16x16x32_bf16 v[148:151], a[68:71], a[168:171], v[148:151]
    ds_read_b64_tr_b16 a[92:93], v10 offset:16384
    buffer_store_dwordx4 v[232:235], v1, s[12:15], s59 offen offset:2048 sc1
    v_mfma_f32_16x16x32_bf16 v[148:151], a[72:75], a[176:179], v[148:151]
    s_waitcnt lgkmcnt(7)
    ds_read_b64_tr_b16 a[94:95], v10 offset:20480
    v_xor_b32 v7, 33088, v6
    v_mfma_f32_16x16x32_bf16 v[148:151], a[76:79], a[184:187], v[148:151]
    s_add_u32 m0, s29, 86016
    ds_read_b64_tr_b16 a[96:97], v7 offset:0
    v_mfma_f32_16x16x32_bf16 v[156:159], a[64:67], a[164:167], v[156:159]
    ds_read_b64_tr_b16 a[98:99], v7 offset:4096
    buffer_load_dwordx4 v2, s[16:19], s52 offen lds
    v_mfma_f32_16x16x32_bf16 v[156:159], a[68:71], a[172:175], v[156:159]
    ds_read_b64_tr_b16 a[100:101], v7 offset:16384
    v_mfma_f32_16x16x32_bf16 v[156:159], a[72:75], a[180:183], v[156:159]
    ds_read_b64_tr_b16 a[102:103], v7 offset:20480
    v_xor_b32 v8, 98624, v6
    v_mfma_f32_16x16x32_bf16 v[156:159], a[76:79], a[188:191], v[156:159]
    s_waitcnt lgkmcnt(6)
    ds_read_b64_tr_b16 a[104:105], v8 offset:0
    v_mfma_f32_16x16x32_bf16 v[164:167], a[80:83], a[160:163], v[164:167]
    s_add_u32 m0, s29, 90112
    ds_read_b64_tr_b16 a[106:107], v8 offset:4096
    v_mfma_f32_16x16x32_bf16 v[164:167], a[84:87], a[168:171], v[164:167]
    ds_read_b64_tr_b16 a[108:109], v8 offset:16384
    buffer_load_dwordx4 v2, s[16:19], s53 offen lds
    v_mfma_f32_16x16x32_bf16 v[164:167], a[88:91], a[176:179], v[164:167]
    s_waitcnt lgkmcnt(7)
    ds_read_b64_tr_b16 a[110:111], v8 offset:20480
    v_xor_b32 v9, 33120, v6
    v_mfma_f32_16x16x32_bf16 v[164:167], a[92:95], a[184:187], v[164:167]
    s_add_u32 s59, s58, 53248
    ds_read_b64_tr_b16 a[64:65], v9 offset:0
    v_mfma_f32_16x16x32_bf16 v[172:175], a[80:83], a[164:167], v[172:175]
    ds_read_b64_tr_b16 a[66:67], v9 offset:4096
    buffer_store_dwordx4 v[240:243], v1, s[12:15], s59 offen offset:3072 sc1
    v_mfma_f32_16x16x32_bf16 v[172:175], a[84:87], a[172:175], v[172:175]
    ds_read_b64_tr_b16 a[68:69], v9 offset:16384
    v_mfma_f32_16x16x32_bf16 v[172:175], a[88:91], a[180:183], v[172:175]
    s_add_u32 m0, s29, 94208
    ds_read_b64_tr_b16 a[70:71], v9 offset:20480
    v_xor_b32 v10, 98656, v6
    v_mfma_f32_16x16x32_bf16 v[172:175], a[92:95], a[188:191], v[172:175]
    s_waitcnt lgkmcnt(6)
    ds_read_b64_tr_b16 a[72:73], v10 offset:0
    buffer_load_dwordx4 v2, s[16:19], s54 offen lds
    v_mfma_f32_16x16x32_bf16 v[180:183], a[96:99], a[160:163], v[180:183]
    ds_read_b64_tr_b16 a[74:75], v10 offset:4096
    v_mfma_f32_16x16x32_bf16 v[180:183], a[100:103], a[168:171], v[180:183]
    ds_read_b64_tr_b16 a[76:77], v10 offset:16384
    v_mfma_f32_16x16x32_bf16 v[180:183], a[104:107], a[176:179], v[180:183]
    s_waitcnt lgkmcnt(7)
    ds_read_b64_tr_b16 a[78:79], v10 offset:20480
    v_xor_b32 v7, 33152, v6
    v_mfma_f32_16x16x32_bf16 v[180:183], a[108:111], a[184:187], v[180:183]
    s_add_u32 s59, s58, 36864
    ds_read_b64_tr_b16 a[80:81], v7 offset:0
    v_mfma_f32_16x16x32_bf16 v[188:191], a[96:99], a[164:167], v[188:191]
    ds_read_b64_tr_b16 a[82:83], v7 offset:4096
    buffer_store_dwordx4 v[248:251], v1, s[12:15], s59 offen offset:3072 sc1
    v_mfma_f32_16x16x32_bf16 v[188:191], a[100:103], a[172:175], v[188:191]
    ds_read_b64_tr_b16 a[84:85], v7 offset:16384
    v_mfma_f32_16x16x32_bf16 v[188:191], a[104:107], a[180:183], v[188:191]
    ds_read_b64_tr_b16 a[86:87], v7 offset:20480
    v_xor_b32 v8, 98688, v6
    v_mfma_f32_16x16x32_bf16 v[188:191], a[108:111], a[188:191], v[188:191]
    s_waitcnt lgkmcnt(6)
    ds_read_b64_tr_b16 a[88:89], v8 offset:0
    v_mfma_f32_16x16x32_bf16 v[196:199], a[64:67], a[160:163], v[196:199]
    ds_read_b64_tr_b16 a[90:91], v8 offset:4096
    v_mfma_f32_16x16x32_bf16 v[196:199], a[68:71], a[168:171], v[196:199]
    ds_read_b64_tr_b16 a[92:93], v8 offset:16384
    v_mfma_f32_16x16x32_bf16 v[196:199], a[72:75], a[176:179], v[196:199]
    s_waitcnt lgkmcnt(7)
    ds_read_b64_tr_b16 a[94:95], v8 offset:20480
    v_xor_b32 v9, 33184, v6
    v_mfma_f32_16x16x32_bf16 v[196:199], a[76:79], a[184:187], v[196:199]
    ds_read_b64_tr_b16 a[96:97], v9 offset:0
    v_mfma_f32_16x16x32_bf16 v[204:207], a[64:67], a[164:167], v[204:207]
    ds_read_b64_tr_b16 a[98:99], v9 offset:4096
    v_mfma_f32_16x16x32_bf16 v[204:207], a[68:71], a[172:175], v[204:207]
    ds_read_b64_tr_b16 a[100:101], v9 offset:16384
    v_mfma_f32_16x16x32_bf16 v[204:207], a[72:75], a[180:183], v[204:207]
    ds_read_b64_tr_b16 a[102:103], v9 offset:20480
    v_xor_b32 v10, 98720, v6
    v_mfma_f32_16x16x32_bf16 v[204:207], a[76:79], a[188:191], v[204:207]
    s_waitcnt lgkmcnt(6)
    ds_read_b64_tr_b16 a[104:105], v10 offset:0
    v_mfma_f32_16x16x32_bf16 v[212:215], a[80:83], a[160:163], v[212:215]
    ds_read_b64_tr_b16 a[106:107], v10 offset:4096
    v_mfma_f32_16x16x32_bf16 v[212:215], a[84:87], a[168:171], v[212:215]
    ds_read_b64_tr_b16 a[108:109], v10 offset:16384
    v_mfma_f32_16x16x32_bf16 v[212:215], a[88:91], a[176:179], v[212:215]
    s_waitcnt lgkmcnt(7)
    ds_read_b64_tr_b16 a[110:111], v10 offset:20480
    v_xor_b32 v7, 33216, v6
    v_mfma_f32_16x16x32_bf16 v[212:215], a[92:95], a[184:187], v[212:215]
    ds_read_b64_tr_b16 a[64:65], v7 offset:0
    v_mfma_f32_16x16x32_bf16 v[220:223], a[80:83], a[164:167], v[220:223]
    ds_read_b64_tr_b16 a[66:67], v7 offset:4096
    v_mfma_f32_16x16x32_bf16 v[220:223], a[84:87], a[172:175], v[220:223]
    ds_read_b64_tr_b16 a[68:69], v7 offset:16384
    v_mfma_f32_16x16x32_bf16 v[220:223], a[88:91], a[180:183], v[220:223]
    ds_read_b64_tr_b16 a[70:71], v7 offset:20480
    v_xor_b32 v8, 98752, v6
    v_mfma_f32_16x16x32_bf16 v[220:223], a[92:95], a[188:191], v[220:223]
    s_waitcnt lgkmcnt(6)
    ds_read_b64_tr_b16 a[72:73], v8 offset:0
    v_mfma_f32_16x16x32_bf16 v[228:231], a[96:99], a[160:163], v[228:231]
    ds_read_b64_tr_b16 a[74:75], v8 offset:4096
    v_mfma_f32_16x16x32_bf16 v[228:231], a[100:103], a[168:171], v[228:231]
    ds_read_b64_tr_b16 a[76:77], v8 offset:16384
    v_mfma_f32_16x16x32_bf16 v[228:231], a[104:107], a[176:179], v[228:231]
    s_waitcnt lgkmcnt(7)
    ds_read_b64_tr_b16 a[78:79], v8 offset:20480
    v_xor_b32 v9, 33248, v6
    v_mfma_f32_16x16x32_bf16 v[228:231], a[108:111], a[184:187], v[228:231]
    ds_read_b64_tr_b16 a[80:81], v9 offset:0
    v_mfma_f32_16x16x32_bf16 v[236:239], a[96:99], a[164:167], v[236:239]
    ds_read_b64_tr_b16 a[82:83], v9 offset:4096
    v_mfma_f32_16x16x32_bf16 v[236:239], a[100:103], a[172:175], v[236:239]
    ds_read_b64_tr_b16 a[84:85], v9 offset:16384
    v_mfma_f32_16x16x32_bf16 v[236:239], a[104:107], a[180:183], v[236:239]
    ds_read_b64_tr_b16 a[86:87], v9 offset:20480
    v_xor_b32 v10, 98784, v6
    v_mfma_f32_16x16x32_bf16 v[236:239], a[108:111], a[188:191], v[236:239]
    s_waitcnt lgkmcnt(6)
    ds_read_b64_tr_b16 a[88:89], v10 offset:0
    v_mfma_f32_16x16x32_bf16 v[244:247], a[64:67], a[160:163], v[244:247]
    ds_read_b64_tr_b16 a[90:91], v10 offset:4096
    v_mfma_f32_16x16x32_bf16 v[244:247], a[68:71], a[168:171], v[244:247]
    s_waitcnt vmcnt(1)
    ds_read_b64_tr_b16 a[92:93], v10 offset:16384
    v_xor_b32 v7, 131072, v6
    v_mfma_f32_16x16x32_bf16 v[244:247], a[72:75], a[176:179], v[244:247]
    s_waitcnt lgkmcnt(7)
    s_barrier
    ds_read_b64_tr_b16 a[94:95], v10 offset:20480
    v_mfma_f32_16x16x32_bf16 v[244:247], a[76:79], a[184:187], v[244:247]
    ds_read_b64_tr_b16 a[96:97], v7 offset:0
    v_mfma_f32_16x16x32_bf16 v[252:255], a[64:67], a[164:167], v[252:255]
    ds_read_b64_tr_b16 a[98:99], v7 offset:4096
    v_mfma_f32_16x16x32_bf16 v[252:255], a[68:71], a[172:175], v[252:255]
    ds_read_b64_tr_b16 a[100:101], v7 offset:16384
    v_mfma_f32_16x16x32_bf16 v[252:255], a[72:75], a[180:183], v[252:255]
    ds_read_b64_tr_b16 a[102:103], v7 offset:20480
    v_xor_b32 v8, 0, v6
    v_mfma_f32_16x16x32_bf16 v[252:255], a[76:79], a[188:191], v[252:255]
    s_waitcnt lgkmcnt(6)
    ds_read_b64_tr_b16 a[104:105], v8 offset:0
    v_mfma_f32_16x16x32_bf16 v[16:19], a[80:83], a[160:163], v[16:19]
    ds_read_b64_tr_b16 a[106:107], v8 offset:4096
    v_mfma_f32_16x16x32_bf16 v[16:19], a[84:87], a[168:171], v[16:19]
    ds_read_b64_tr_b16 a[108:109], v8 offset:16384
    v_mfma_f32_16x16x32_bf16 v[16:19], a[88:91], a[176:179], v[16:19]
    s_waitcnt lgkmcnt(7)
    ds_read_b64_tr_b16 a[110:111], v8 offset:20480
    v_xor_b32 v9, 65536, v6
    v_mfma_f32_16x16x32_bf16 v[16:19], a[92:95], a[184:187], v[16:19]
    ds_read_b64_tr_b16 a[64:65], v9 offset:0
    v_mfma_f32_16x16x32_bf16 v[24:27], a[80:83], a[164:167], v[24:27]
    ds_read_b64_tr_b16 a[66:67], v9 offset:4096
    v_mfma_f32_16x16x32_bf16 v[24:27], a[84:87], a[172:175], v[24:27]
    ds_read_b64_tr_b16 a[68:69], v9 offset:16384
    v_mfma_f32_16x16x32_bf16 v[24:27], a[88:91], a[180:183], v[24:27]
    ds_read_b64_tr_b16 a[70:71], v9 offset:20480
    v_xor_b32 v10, 131104, v6
    v_mfma_f32_16x16x32_bf16 v[24:27], a[92:95], a[188:191], v[24:27]
    s_waitcnt lgkmcnt(6)
    ds_read_b64_tr_b16 a[72:73], v10 offset:0
    v_mfma_f32_16x16x32_bf16 v[28:31], a[96:99], a[192:195], v[28:31]
    ds_read_b64_tr_b16 a[74:75], v10 offset:4096
    v_mfma_f32_16x16x32_bf16 v[28:31], a[100:103], a[200:203], v[28:31]
    ds_read_b64_tr_b16 a[76:77], v10 offset:16384
    v_mfma_f32_16x16x32_bf16 v[28:31], a[104:107], a[208:211], v[28:31]
    s_waitcnt lgkmcnt(3)
    ds_read_b64_tr_b16 a[78:79], v10 offset:20480
    v_xor_b32 v7, 32, v6
    v_mfma_f32_16x16x32_bf16 v[28:31], a[108:111], a[216:219], v[28:31]
    ds_read_b64_tr_b16 a[80:81], v7 offset:0
    v_mfma_f32_16x16x32_bf16 v[28:31], a[64:67], a[112:115], v[28:31]
    ds_read_b64_tr_b16 a[82:83], v7 offset:4096
    v_mfma_f32_16x16x32_bf16 v[28:31], a[68:71], a[120:123], v[28:31]
    ds_read_b64_tr_b16 a[84:85], v7 offset:16384
    v_mfma_f32_16x16x32_bf16 v[44:47], a[96:99], a[196:199], v[44:47]
    ds_read_b64_tr_b16 a[86:87], v7 offset:20480
    v_xor_b32 v8, 65568, v6
    v_mfma_f32_16x16x32_bf16 v[44:47], a[100:103], a[204:207], v[44:47]
    ds_read_b64_tr_b16 a[88:89], v8 offset:0
    v_mfma_f32_16x16x32_bf16 v[44:47], a[104:107], a[212:215], v[44:47]
    ds_read_b64_tr_b16 a[90:91], v8 offset:4096
    v_mfma_f32_16x16x32_bf16 v[44:47], a[108:111], a[220:223], v[44:47]
    ds_read_b64_tr_b16 a[92:93], v8 offset:16384
    v_mfma_f32_16x16x32_bf16 v[44:47], a[64:67], a[116:119], v[44:47]
    ds_read_b64_tr_b16 a[94:95], v8 offset:20480
    v_xor_b32 v9, 131136, v6
    v_mfma_f32_16x16x32_bf16 v[44:47], a[68:71], a[124:127], v[44:47]
    s_waitcnt lgkmcnt(6)
    ds_read_b64_tr_b16 a[96:97], v9 offset:0
    v_mfma_f32_16x16x32_bf16 v[52:55], a[72:75], a[192:195], v[52:55]
    ds_read_b64_tr_b16 a[98:99], v9 offset:4096
    v_mfma_f32_16x16x32_bf16 v[52:55], a[76:79], a[200:203], v[52:55]
    ds_read_b64_tr_b16 a[100:101], v9 offset:16384
    v_mfma_f32_16x16x32_bf16 v[52:55], a[80:83], a[208:211], v[52:55]
    s_waitcnt lgkmcnt(3)
    ds_read_b64_tr_b16 a[102:103], v9 offset:20480
    v_xor_b32 v10, 64, v6
    v_mfma_f32_16x16x32_bf16 v[52:55], a[84:87], a[216:219], v[52:55]
    ds_read_b64_tr_b16 a[104:105], v10 offset:0
    v_mfma_f32_16x16x32_bf16 v[52:55], a[88:91], a[112:115], v[52:55]
    ds_read_b64_tr_b16 a[106:107], v10 offset:4096
    v_mfma_f32_16x16x32_bf16 v[52:55], a[92:95], a[120:123], v[52:55]
    ds_read_b64_tr_b16 a[108:109], v10 offset:16384
    v_mfma_f32_16x16x32_bf16 v[60:63], a[72:75], a[196:199], v[60:63]
    ds_read_b64_tr_b16 a[110:111], v10 offset:20480
    v_xor_b32 v7, 65600, v6
    v_mfma_f32_16x16x32_bf16 v[60:63], a[76:79], a[204:207], v[60:63]
    ds_read_b64_tr_b16 a[64:65], v7 offset:0
    v_mfma_f32_16x16x32_bf16 v[60:63], a[80:83], a[212:215], v[60:63]
    ds_read_b64_tr_b16 a[66:67], v7 offset:4096
    v_mfma_f32_16x16x32_bf16 v[60:63], a[84:87], a[220:223], v[60:63]
    ds_read_b64_tr_b16 a[68:69], v7 offset:16384
    v_mfma_f32_16x16x32_bf16 v[60:63], a[88:91], a[116:119], v[60:63]
    ds_read_b64_tr_b16 a[70:71], v7 offset:20480
    v_xor_b32 v8, 131168, v6
    v_mfma_f32_16x16x32_bf16 v[60:63], a[92:95], a[124:127], v[60:63]
    s_waitcnt lgkmcnt(6)
    ds_read_b64_tr_b16 a[72:73], v8 offset:0
    v_mfma_f32_16x16x32_bf16 v[20:23], a[96:99], a[192:195], v[20:23]
    ds_read_b64_tr_b16 a[74:75], v8 offset:4096
    v_mfma_f32_16x16x32_bf16 v[20:23], a[100:103], a[200:203], v[20:23]
    ds_read_b64_tr_b16 a[76:77], v8 offset:16384
    v_mul_f32 v28, s34, v28
    v_mfma_f32_16x16x32_bf16 v[20:23], a[104:107], a[208:211], v[20:23]
    s_waitcnt lgkmcnt(3)
    ds_read_b64_tr_b16 a[78:79], v8 offset:20480
    v_xor_b32 v9, 96, v6
    v_mfma_f32_16x16x32_bf16 v[20:23], a[108:111], a[216:219], v[20:23]
    ds_read_b64_tr_b16 a[80:81], v9 offset:0
    v_mul_f32 v29, s34, v29
    v_mfma_f32_16x16x32_bf16 v[20:23], a[64:67], a[112:115], v[20:23]
    ds_read_b64_tr_b16 a[82:83], v9 offset:4096
    v_mul_f32 v30, s34, v30
    v_mfma_f32_16x16x32_bf16 v[20:23], a[68:71], a[120:123], v[20:23]
    ds_read_b64_tr_b16 a[84:85], v9 offset:16384
    v_mul_f32 v31, s34, v31
    v_mfma_f32_16x16x32_bf16 v[36:39], a[96:99], a[196:199], v[36:39]
    ds_read_b64_tr_b16 a[86:87], v9 offset:20480
    v_xor_b32 v10, 65632, v6
    v_mfma_f32_16x16x32_bf16 v[36:39], a[100:103], a[204:207], v[36:39]
    ds_read_b64_tr_b16 a[88:89], v10 offset:0
    v_mul_f32 v52, s34, v52
    v_mfma_f32_16x16x32_bf16 v[36:39], a[104:107], a[212:215], v[36:39]
    ds_read_b64_tr_b16 a[90:91], v10 offset:4096
    v_mul_f32 v53, s34, v53
    v_mfma_f32_16x16x32_bf16 v[36:39], a[108:111], a[220:223], v[36:39]
    ds_read_b64_tr_b16 a[92:93], v10 offset:16384
    v_mul_f32 v54, s34, v54
    v_mfma_f32_16x16x32_bf16 v[36:39], a[64:67], a[116:119], v[36:39]
    ds_read_b64_tr_b16 a[94:95], v10 offset:20480
    v_xor_b32 v7, 131200, v6
    v_mfma_f32_16x16x32_bf16 v[36:39], a[68:71], a[124:127], v[36:39]
    s_waitcnt lgkmcnt(6)
    ds_read_b64_tr_b16 a[96:97], v7 offset:0
    v_mul_f32 v55, s34, v55
    v_mfma_f32_16x16x32_bf16 v[68:71], a[72:75], a[192:195], v[68:71]
    ds_read_b64_tr_b16 a[98:99], v7 offset:4096
    v_cvt_pk_bf16_f32 v28, v28, v29
    v_mfma_f32_16x16x32_bf16 v[68:71], a[76:79], a[200:203], v[68:71]
    ds_read_b64_tr_b16 a[100:101], v7 offset:16384
    v_cvt_pk_bf16_f32 v29, v30, v31
    v_mfma_f32_16x16x32_bf16 v[68:71], a[80:83], a[208:211], v[68:71]
    s_waitcnt lgkmcnt(3)
    ds_read_b64_tr_b16 a[102:103], v7 offset:20480
    v_xor_b32 v8, 128, v6
    v_mfma_f32_16x16x32_bf16 v[68:71], a[84:87], a[216:219], v[68:71]
    ds_read_b64_tr_b16 a[104:105], v8 offset:0
    v_cvt_pk_bf16_f32 v30, v52, v53
    v_mfma_f32_16x16x32_bf16 v[68:71], a[88:91], a[112:115], v[68:71]
    s_add_u32 s59, s62, 0
    ds_read_b64_tr_b16 a[106:107], v8 offset:4096
    v_cvt_pk_bf16_f32 v31, v54, v55
    v_mfma_f32_16x16x32_bf16 v[68:71], a[92:95], a[120:123], v[68:71]
    ds_read_b64_tr_b16 a[108:109], v8 offset:16384
    buffer_store_dwordx4 v[28:31], v1, s[12:15], s59 offen offset:0 sc1
    v_mfma_f32_16x16x32_bf16 v[76:79], a[72:75], a[196:199], v[76:79]
    ds_read_b64_tr_b16 a[110:111], v8 offset:20480
    v_xor_b32 v9, 65664, v6
    v_mfma_f32_16x16x32_bf16 v[76:79], a[76:79], a[204:207], v[76:79]
    ds_read_b64_tr_b16 a[64:65], v9 offset:0
    v_accvgpr_write_b32 a0, v28
    v_mfma_f32_16x16x32_bf16 v[76:79], a[80:83], a[212:215], v[76:79]
    ds_read_b64_tr_b16 a[66:67], v9 offset:4096
    v_accvgpr_write_b32 a1, v29
    v_mfma_f32_16x16x32_bf16 v[76:79], a[84:87], a[220:223], v[76:79]
    s_waitcnt vmcnt(1)
    ds_read_b64_tr_b16 a[68:69], v9 offset:16384
    v_accvgpr_write_b32 a2, v30
    v_mfma_f32_16x16x32_bf16 v[76:79], a[88:91], a[116:119], v[76:79]
    s_barrier
    ds_read_b64_tr_b16 a[70:71], v9 offset:20480
    v_xor_b32 v10, 131232, v6
    v_mfma_f32_16x16x32_bf16 v[76:79], a[92:95], a[124:127], v[76:79]
    s_waitcnt lgkmcnt(6)
    ds_read_b64_tr_b16 a[72:73], v10 offset:0
    buffer_store_dword v11, v11, s[12:15], s92 offen sc1
    v_mfma_f32_16x16x32_bf16 v[84:87], a[96:99], a[192:195], v[84:87]
    ds_read_b64_tr_b16 a[74:75], v10 offset:4096
    v_accvgpr_write_b32 a3, v31
    v_mfma_f32_16x16x32_bf16 v[84:87], a[100:103], a[200:203], v[84:87]
    ds_read_b64_tr_b16 a[76:77], v10 offset:16384
    v_mul_f32 v44, s34, v44
    v_mfma_f32_16x16x32_bf16 v[84:87], a[104:107], a[208:211], v[84:87]
    s_waitcnt lgkmcnt(3)
    ds_read_b64_tr_b16 a[78:79], v10 offset:20480
    v_xor_b32 v7, 160, v6
    v_mfma_f32_16x16x32_bf16 v[84:87], a[108:111], a[216:219], v[84:87]
    ds_read_b64_tr_b16 a[80:81], v7 offset:0
    v_mul_f32 v45, s34, v45
    v_mfma_f32_16x16x32_bf16 v[84:87], a[64:67], a[112:115], v[84:87]
    ds_read_b64_tr_b16 a[82:83], v7 offset:4096
    v_mul_f32 v46, s34, v46
    v_mfma_f32_16x16x32_bf16 v[84:87], a[68:71], a[120:123], v[84:87]
    ds_read_b64_tr_b16 a[84:85], v7 offset:16384
    v_mul_f32 v47, s34, v47
    v_mfma_f32_16x16x32_bf16 v[92:95], a[96:99], a[196:199], v[92:95]
    ds_read_b64_tr_b16 a[86:87], v7 offset:20480
    v_xor_b32 v8, 65696, v6
    v_mfma_f32_16x16x32_bf16 v[92:95], a[100:103], a[204:207], v[92:95]
    ds_read_b64_tr_b16 a[88:89], v8 offset:0
    v_mul_f32 v60, s34, v60
    v_mfma_f32_16x16x32_bf16 v[92:95], a[104:107], a[212:215], v[92:95]
    ds_read_b64_tr_b16 a[90:91], v8 offset:4096
    v_mul_f32 v61, s34, v61
    v_mfma_f32_16x16x32_bf16 v[92:95], a[108:111], a[220:223], v[92:95]
    ds_read_b64_tr_b16 a[92:93], v8 offset:16384
    v_mul_f32 v62, s34, v62
    v_mfma_f32_16x16x32_bf16 v[92:95], a[64:67], a[116:119], v[92:95]
    ds_read_b64_tr_b16 a[94:95], v8 offset:20480
    v_xor_b32 v9, 131264, v6
    v_mfma_f32_16x16x32_bf16 v[92:95], a[68:71], a[124:127], v[92:95]
    s_waitcnt lgkmcnt(6)
    ds_read_b64_tr_b16 a[96:97], v9 offset:0
    v_mul_f32 v63, s34, v63
    v_mfma_f32_16x16x32_bf16 v[100:103], a[72:75], a[192:195], v[100:103]
    ds_read_b64_tr_b16 a[98:99], v9 offset:4096
    v_cvt_pk_bf16_f32 v44, v44, v45
    v_mfma_f32_16x16x32_bf16 v[100:103], a[76:79], a[200:203], v[100:103]
    ds_read_b64_tr_b16 a[100:101], v9 offset:16384
    v_cvt_pk_bf16_f32 v45, v46, v47
    v_mfma_f32_16x16x32_bf16 v[100:103], a[80:83], a[208:211], v[100:103]
    s_waitcnt lgkmcnt(3)
    ds_read_b64_tr_b16 a[102:103], v9 offset:20480
    v_xor_b32 v10, 192, v6
    v_mfma_f32_16x16x32_bf16 v[100:103], a[84:87], a[216:219], v[100:103]
    ds_read_b64_tr_b16 a[104:105], v10 offset:0
    v_cvt_pk_bf16_f32 v46, v60, v61
    v_mfma_f32_16x16x32_bf16 v[100:103], a[88:91], a[112:115], v[100:103]
    s_add_u32 s59, s62, 32768
    ds_read_b64_tr_b16 a[106:107], v10 offset:4096
    v_cvt_pk_bf16_f32 v47, v62, v63
    v_mfma_f32_16x16x32_bf16 v[100:103], a[92:95], a[120:123], v[100:103]
    ds_read_b64_tr_b16 a[108:109], v10 offset:16384
    buffer_store_dwordx4 v[44:47], v1, s[12:15], s59 offen offset:0 sc1
    v_mfma_f32_16x16x32_bf16 v[108:111], a[72:75], a[196:199], v[108:111]
    ds_read_b64_tr_b16 a[110:111], v10 offset:20480
    v_xor_b32 v7, 65728, v6
    v_mfma_f32_16x16x32_bf16 v[108:111], a[76:79], a[204:207], v[108:111]
    ds_read_b64_tr_b16 a[64:65], v7 offset:0
    v_accvgpr_write_b32 a32, v44
    v_mfma_f32_16x16x32_bf16 v[108:111], a[80:83], a[212:215], v[108:111]
    ds_read_b64_tr_b16 a[66:67], v7 offset:4096
    v_accvgpr_write_b32 a33, v45
    v_mfma_f32_16x16x32_bf16 v[108:111], a[84:87], a[220:223], v[108:111]
    ds_read_b64_tr_b16 a[68:69], v7 offset:16384
    v_accvgpr_write_b32 a34, v46
    v_mfma_f32_16x16x32_bf16 v[108:111], a[88:91], a[116:119], v[108:111]
    ds_read_b64_tr_b16 a[70:71], v7 offset:20480
    v_xor_b32 v8, 131296, v6
    v_mfma_f32_16x16x32_bf16 v[108:111], a[92:95], a[124:127], v[108:111]
    s_waitcnt lgkmcnt(6)
    ds_read_b64_tr_b16 a[72:73], v8 offset:0
    v_accvgpr_write_b32 a35, v47
    v_mfma_f32_16x16x32_bf16 v[116:119], a[96:99], a[192:195], v[116:119]
    ds_read_b64_tr_b16 a[74:75], v8 offset:4096
    v_mul_f32 v20, s34, v20
    v_mfma_f32_16x16x32_bf16 v[116:119], a[100:103], a[200:203], v[116:119]
    ds_read_b64_tr_b16 a[76:77], v8 offset:16384
    v_mul_f32 v21, s34, v21
    v_mfma_f32_16x16x32_bf16 v[116:119], a[104:107], a[208:211], v[116:119]
    s_waitcnt lgkmcnt(3)
    ds_read_b64_tr_b16 a[78:79], v8 offset:20480
    v_xor_b32 v9, 224, v6
    v_mfma_f32_16x16x32_bf16 v[116:119], a[108:111], a[216:219], v[116:119]
    ds_read_b64_tr_b16 a[80:81], v9 offset:0
    v_mul_f32 v22, s34, v22
    v_mfma_f32_16x16x32_bf16 v[116:119], a[64:67], a[112:115], v[116:119]
    ds_read_b64_tr_b16 a[82:83], v9 offset:4096
    v_mul_f32 v23, s34, v23
    v_mfma_f32_16x16x32_bf16 v[116:119], a[68:71], a[120:123], v[116:119]
    ds_read_b64_tr_b16 a[84:85], v9 offset:16384
    v_mul_f32 v68, s34, v68
    v_mfma_f32_16x16x32_bf16 v[124:127], a[96:99], a[196:199], v[124:127]
    ds_read_b64_tr_b16 a[86:87], v9 offset:20480
    v_xor_b32 v10, 65760, v6
    v_mfma_f32_16x16x32_bf16 v[124:127], a[100:103], a[204:207], v[124:127]
    ds_read_b64_tr_b16 a[88:89], v10 offset:0
    v_mul_f32 v69, s34, v69
    v_mfma_f32_16x16x32_bf16 v[124:127], a[104:107], a[212:215], v[124:127]
    ds_read_b64_tr_b16 a[90:91], v10 offset:4096
    v_mul_f32 v70, s34, v70
    v_mfma_f32_16x16x32_bf16 v[124:127], a[108:111], a[220:223], v[124:127]
    ds_read_b64_tr_b16 a[92:93], v10 offset:16384
    v_mul_f32 v71, s34, v71
    v_mfma_f32_16x16x32_bf16 v[124:127], a[64:67], a[116:119], v[124:127]
    ds_read_b64_tr_b16 a[94:95], v10 offset:20480
    v_xor_b32 v7, 131328, v6
    v_mfma_f32_16x16x32_bf16 v[124:127], a[68:71], a[124:127], v[124:127]
    s_waitcnt lgkmcnt(6)
    ds_read_b64_tr_b16 a[96:97], v7 offset:0
    v_cvt_pk_bf16_f32 v20, v20, v21
    v_mfma_f32_16x16x32_bf16 v[132:135], a[72:75], a[192:195], v[132:135]
    ds_read_b64_tr_b16 a[98:99], v7 offset:4096
    buffer_load_dwordx4 v[32:35], v122, s[4:7], 0 offen
    v_mfma_f32_16x16x32_bf16 v[132:135], a[76:79], a[200:203], v[132:135]
    ds_read_b64_tr_b16 a[100:101], v7 offset:16384
    v_cvt_pk_bf16_f32 v21, v22, v23
    v_mfma_f32_16x16x32_bf16 v[132:135], a[80:83], a[208:211], v[132:135]
    s_waitcnt lgkmcnt(3)
    ds_read_b64_tr_b16 a[102:103], v7 offset:20480
    v_xor_b32 v8, 256, v6
    v_mfma_f32_16x16x32_bf16 v[132:135], a[84:87], a[216:219], v[132:135]
    ds_read_b64_tr_b16 a[104:105], v8 offset:0
    v_cvt_pk_bf16_f32 v22, v68, v69
    v_mfma_f32_16x16x32_bf16 v[132:135], a[88:91], a[112:115], v[132:135]
    ds_read_b64_tr_b16 a[106:107], v8 offset:4096
    buffer_load_dwordx4 v[40:43], v123, s[4:7], 0 offen
    v_mfma_f32_16x16x32_bf16 v[132:135], a[92:95], a[120:123], v[132:135]
    ds_read_b64_tr_b16 a[108:109], v8 offset:16384
    v_cvt_pk_bf16_f32 v23, v70, v71
    v_mfma_f32_16x16x32_bf16 v[140:143], a[72:75], a[196:199], v[140:143]
    ds_read_b64_tr_b16 a[110:111], v8 offset:20480
    v_xor_b32 v9, 65792, v6
    v_mfma_f32_16x16x32_bf16 v[140:143], a[76:79], a[204:207], v[140:143]
    ds_read_b64_tr_b16 a[64:65], v9 offset:0
    v_accvgpr_write_b32 a4, v20
    v_mfma_f32_16x16x32_bf16 v[140:143], a[80:83], a[212:215], v[140:143]
    ds_read_b64_tr_b16 a[66:67], v9 offset:4096
    buffer_load_dwordx4 v[48:51], v128, s[4:7], 0 offen
    v_mfma_f32_16x16x32_bf16 v[140:143], a[84:87], a[220:223], v[140:143]
    ds_read_b64_tr_b16 a[68:69], v9 offset:16384
    v_accvgpr_write_b32 a5, v21
    v_mfma_f32_16x16x32_bf16 v[140:143], a[88:91], a[116:119], v[140:143]
    ds_read_b64_tr_b16 a[70:71], v9 offset:20480
    v_xor_b32 v10, 131360, v6
    v_mfma_f32_16x16x32_bf16 v[140:143], a[92:95], a[124:127], v[140:143]
    s_waitcnt lgkmcnt(6)
    ds_read_b64_tr_b16 a[72:73], v10 offset:0
    v_accvgpr_write_b32 a6, v22
    v_mfma_f32_16x16x32_bf16 v[148:151], a[96:99], a[192:195], v[148:151]
    ds_read_b64_tr_b16 a[74:75], v10 offset:4096
    buffer_load_dwordx4 v[56:59], v120, s[4:7], 0 offen offset:0
    v_mfma_f32_16x16x32_bf16 v[148:151], a[100:103], a[200:203], v[148:151]
    ds_read_b64_tr_b16 a[76:77], v10 offset:16384
    v_accvgpr_write_b32 a7, v23
    v_mfma_f32_16x16x32_bf16 v[148:151], a[104:107], a[208:211], v[148:151]
    s_waitcnt lgkmcnt(3)
    ds_read_b64_tr_b16 a[78:79], v10 offset:20480
    v_xor_b32 v7, 288, v6
    v_mfma_f32_16x16x32_bf16 v[148:151], a[108:111], a[216:219], v[148:151]
    ds_read_b64_tr_b16 a[80:81], v7 offset:0
    v_mul_f32 v36, s34, v36
    v_mfma_f32_16x16x32_bf16 v[148:151], a[64:67], a[112:115], v[148:151]
    ds_read_b64_tr_b16 a[82:83], v7 offset:4096
    buffer_load_dwordx4 v[64:67], v120, s[4:7], 0 offen offset:896
    v_mfma_f32_16x16x32_bf16 v[148:151], a[68:71], a[120:123], v[148:151]
    ds_read_b64_tr_b16 a[84:85], v7 offset:16384
    v_mul_f32 v37, s34, v37
    v_mfma_f32_16x16x32_bf16 v[156:159], a[96:99], a[196:199], v[156:159]
    ds_read_b64_tr_b16 a[86:87], v7 offset:20480
    v_xor_b32 v8, 65824, v6
    v_mfma_f32_16x16x32_bf16 v[156:159], a[100:103], a[204:207], v[156:159]
    ds_read_b64_tr_b16 a[88:89], v8 offset:0
    v_mul_f32 v38, s34, v38
    v_mfma_f32_16x16x32_bf16 v[156:159], a[104:107], a[212:215], v[156:159]
    ds_read_b64_tr_b16 a[90:91], v8 offset:4096
    buffer_load_dwordx4 v[72:75], v120, s[8:11], 0 offen offset:0
    v_mfma_f32_16x16x32_bf16 v[156:159], a[108:111], a[220:223], v[156:159]
    ds_read_b64_tr_b16 a[92:93], v8 offset:16384
    v_mul_f32 v39, s34, v39
    v_mfma_f32_16x16x32_bf16 v[156:159], a[64:67], a[116:119], v[156:159]
    ds_read_b64_tr_b16 a[94:95], v8 offset:20480
    v_xor_b32 v9, 131392, v6
    v_mfma_f32_16x16x32_bf16 v[156:159], a[68:71], a[124:127], v[156:159]
    s_waitcnt lgkmcnt(6)
    ds_read_b64_tr_b16 a[96:97], v9 offset:0
    v_mul_f32 v76, s34, v76
    v_mfma_f32_16x16x32_bf16 v[164:167], a[72:75], a[192:195], v[164:167]
    ds_read_b64_tr_b16 a[98:99], v9 offset:4096
    buffer_load_dwordx4 v[80:83], v120, s[8:11], 0 offen offset:896
    v_mfma_f32_16x16x32_bf16 v[164:167], a[76:79], a[200:203], v[164:167]
    ds_read_b64_tr_b16 a[100:101], v9 offset:16384
    v_mul_f32 v77, s34, v77
    v_mfma_f32_16x16x32_bf16 v[164:167], a[80:83], a[208:211], v[164:167]
    s_waitcnt lgkmcnt(3)
    ds_read_b64_tr_b16 a[102:103], v9 offset:20480
    v_xor_b32 v10, 320, v6
    v_mfma_f32_16x16x32_bf16 v[164:167], a[84:87], a[216:219], v[164:167]
    ds_read_b64_tr_b16 a[104:105], v10 offset:0
    v_mul_f32 v78, s34, v78
    v_mfma_f32_16x16x32_bf16 v[164:167], a[88:91], a[112:115], v[164:167]
    ds_read_b64_tr_b16 a[106:107], v10 offset:4096
    buffer_load_dwordx4 v[88:91], v121, s[20:23], s39 offen offset:0
    v_mfma_f32_16x16x32_bf16 v[164:167], a[92:95], a[120:123], v[164:167]
    ds_read_b64_tr_b16 a[108:109], v10 offset:16384
    v_mul_f32 v79, s34, v79
    v_mfma_f32_16x16x32_bf16 v[172:175], a[72:75], a[196:199], v[172:175]
    ds_read_b64_tr_b16 a[110:111], v10 offset:20480
    v_xor_b32 v7, 65856, v6
    v_mfma_f32_16x16x32_bf16 v[172:175], a[76:79], a[204:207], v[172:175]
    ds_read_b64_tr_b16 a[64:65], v7 offset:0
    v_cvt_pk_bf16_f32 v36, v36, v37
    v_mfma_f32_16x16x32_bf16 v[172:175], a[80:83], a[212:215], v[172:175]
    ds_read_b64_tr_b16 a[66:67], v7 offset:4096
    buffer_load_dwordx4 v[96:99], v121, s[20:23], s39 offen offset:16
    v_mfma_f32_16x16x32_bf16 v[172:175], a[84:87], a[220:223], v[172:175]
    ds_read_b64_tr_b16 a[68:69], v7 offset:16384
    v_cvt_pk_bf16_f32 v37, v38, v39
    v_mfma_f32_16x16x32_bf16 v[172:175], a[88:91], a[116:119], v[172:175]
    ds_read_b64_tr_b16 a[70:71], v7 offset:20480
    v_xor_b32 v8, 131424, v6
    v_mfma_f32_16x16x32_bf16 v[172:175], a[92:95], a[124:127], v[172:175]
    s_waitcnt lgkmcnt(6)
    ds_read_b64_tr_b16 a[72:73], v8 offset:0
    v_cvt_pk_bf16_f32 v38, v76, v77
    v_mfma_f32_16x16x32_bf16 v[180:183], a[96:99], a[192:195], v[180:183]
    ds_read_b64_tr_b16 a[74:75], v8 offset:4096
    buffer_load_dwordx4 v[104:107], v121, s[20:23], s39 offen offset:32
    v_mfma_f32_16x16x32_bf16 v[180:183], a[100:103], a[200:203], v[180:183]
    ds_read_b64_tr_b16 a[76:77], v8 offset:16384
    v_cvt_pk_bf16_f32 v39, v78, v79
    v_mfma_f32_16x16x32_bf16 v[180:183], a[104:107], a[208:211], v[180:183]
    s_waitcnt lgkmcnt(3)
    ds_read_b64_tr_b16 a[78:79], v8 offset:20480
    v_xor_b32 v9, 352, v6
    v_mfma_f32_16x16x32_bf16 v[180:183], a[108:111], a[216:219], v[180:183]
    ds_read_b64_tr_b16 a[80:81], v9 offset:0
    v_accvgpr_write_b32 a36, v36
    v_mfma_f32_16x16x32_bf16 v[180:183], a[64:67], a[112:115], v[180:183]
    ds_read_b64_tr_b16 a[82:83], v9 offset:4096
    buffer_load_dwordx4 v[112:115], v121, s[20:23], s39 offen offset:48
    v_mfma_f32_16x16x32_bf16 v[180:183], a[68:71], a[120:123], v[180:183]
    ds_read_b64_tr_b16 a[84:85], v9 offset:16384
    v_accvgpr_write_b32 a37, v37
    v_mfma_f32_16x16x32_bf16 v[188:191], a[96:99], a[196:199], v[188:191]
    s_add_u32 s59, s62, 0
    ds_read_b64_tr_b16 a[86:87], v9 offset:20480
    v_xor_b32 v10, 65888, v6
    v_mfma_f32_16x16x32_bf16 v[188:191], a[100:103], a[204:207], v[188:191]
    ds_read_b64_tr_b16 a[88:89], v10 offset:0
    buffer_store_dwordx4 v[20:23], v1, s[12:15], s59 offen offset:1024 sc1
    v_mfma_f32_16x16x32_bf16 v[188:191], a[104:107], a[212:215], v[188:191]
    s_add_u32 s59, s62, 32768
    ds_read_b64_tr_b16 a[90:91], v10 offset:4096
    v_accvgpr_write_b32 a38, v38
    v_mfma_f32_16x16x32_bf16 v[188:191], a[108:111], a[220:223], v[188:191]
    ds_read_b64_tr_b16 a[92:93], v10 offset:16384
    buffer_store_dwordx4 v[36:39], v1, s[12:15], s59 offen offset:1024 sc1
    v_mfma_f32_16x16x32_bf16 v[188:191], a[64:67], a[116:119], v[188:191]
    ds_read_b64_tr_b16 a[94:95], v10 offset:20480
    v_xor_b32 v7, 131456, v6
    v_mfma_f32_16x16x32_bf16 v[188:191], a[68:71], a[124:127], v[188:191]
    s_waitcnt lgkmcnt(6)
    ds_read_b64_tr_b16 a[96:97], v7 offset:0
    v_accvgpr_write_b32 a39, v39
    v_mfma_f32_16x16x32_bf16 v[196:199], a[72:75], a[192:195], v[196:199]
    ds_read_b64_tr_b16 a[98:99], v7 offset:4096
    v_mul_f32 v84, s34, v84
    v_mfma_f32_16x16x32_bf16 v[196:199], a[76:79], a[200:203], v[196:199]
    ds_read_b64_tr_b16 a[100:101], v7 offset:16384
    v_mul_f32 v85, s34, v85
    v_mfma_f32_16x16x32_bf16 v[196:199], a[80:83], a[208:211], v[196:199]
    s_waitcnt lgkmcnt(3)
    ds_read_b64_tr_b16 a[102:103], v7 offset:20480
    v_xor_b32 v8, 384, v6
    v_mfma_f32_16x16x32_bf16 v[196:199], a[84:87], a[216:219], v[196:199]
    ds_read_b64_tr_b16 a[104:105], v8 offset:0
    v_mul_f32 v86, s34, v86
    v_mfma_f32_16x16x32_bf16 v[196:199], a[88:91], a[112:115], v[196:199]
    ds_read_b64_tr_b16 a[106:107], v8 offset:4096
    v_mul_f32 v87, s34, v87
    v_mfma_f32_16x16x32_bf16 v[196:199], a[92:95], a[120:123], v[196:199]
    ds_read_b64_tr_b16 a[108:109], v8 offset:16384
    v_mul_f32 v100, s34, v100
    v_mfma_f32_16x16x32_bf16 v[204:207], a[72:75], a[196:199], v[204:207]
    ds_read_b64_tr_b16 a[110:111], v8 offset:20480
    v_xor_b32 v9, 65920, v6
    v_mfma_f32_16x16x32_bf16 v[204:207], a[76:79], a[204:207], v[204:207]
    ds_read_b64_tr_b16 a[64:65], v9 offset:0
    v_mul_f32 v101, s34, v101
    v_mfma_f32_16x16x32_bf16 v[204:207], a[80:83], a[212:215], v[204:207]
    ds_read_b64_tr_b16 a[66:67], v9 offset:4096
    v_mul_f32 v102, s34, v102
    v_mfma_f32_16x16x32_bf16 v[204:207], a[84:87], a[220:223], v[204:207]
    ds_read_b64_tr_b16 a[68:69], v9 offset:16384
    v_mul_f32 v103, s34, v103
    v_mfma_f32_16x16x32_bf16 v[204:207], a[88:91], a[116:119], v[204:207]
    ds_read_b64_tr_b16 a[70:71], v9 offset:20480
    v_xor_b32 v10, 131488, v6
    v_mfma_f32_16x16x32_bf16 v[204:207], a[92:95], a[124:127], v[204:207]
    s_waitcnt lgkmcnt(6)
    ds_read_b64_tr_b16 a[72:73], v10 offset:0
    v_cvt_pk_bf16_f32 v84, v84, v85
    v_mfma_f32_16x16x32_bf16 v[212:215], a[96:99], a[192:195], v[212:215]
    ds_read_b64_tr_b16 a[74:75], v10 offset:4096
    v_cvt_pk_bf16_f32 v85, v86, v87
    v_mfma_f32_16x16x32_bf16 v[212:215], a[100:103], a[200:203], v[212:215]
    ds_read_b64_tr_b16 a[76:77], v10 offset:16384
    v_cvt_pk_bf16_f32 v86, v100, v101
    v_mfma_f32_16x16x32_bf16 v[212:215], a[104:107], a[208:211], v[212:215]
    s_waitcnt lgkmcnt(3)
    ds_read_b64_tr_b16 a[78:79], v10 offset:20480
    v_xor_b32 v7, 416, v6
    v_mfma_f32_16x16x32_bf16 v[212:215], a[108:111], a[216:219], v[212:215]
    s_add_u32 s59, s62, 0
    ds_read_b64_tr_b16 a[80:81], v7 offset:0
    v_cvt_pk_bf16_f32 v87, v102, v103
    v_mfma_f32_16x16x32_bf16 v[212:215], a[64:67], a[112:115], v[212:215]
    ds_read_b64_tr_b16 a[82:83], v7 offset:4096
    buffer_store_dwordx4 v[84:87], v1, s[12:15], s59 offen offset:2048 sc1
    v_mfma_f32_16x16x32_bf16 v[212:215], a[68:71], a[120:123], v[212:215]
    ds_read_b64_tr_b16 a[84:85], v7 offset:16384
    v_accvgpr_write_b32 a8, v84
    v_mfma_f32_16x16x32_bf16 v[220:223], a[96:99], a[196:199], v[220:223]
    ds_read_b64_tr_b16 a[86:87], v7 offset:20480
    v_xor_b32 v8, 65952, v6
    v_mfma_f32_16x16x32_bf16 v[220:223], a[100:103], a[204:207], v[220:223]
    ds_read_b64_tr_b16 a[88:89], v8 offset:0
    v_accvgpr_write_b32 a9, v85
    v_mfma_f32_16x16x32_bf16 v[220:223], a[104:107], a[212:215], v[220:223]
    ds_read_b64_tr_b16 a[90:91], v8 offset:4096
    v_accvgpr_write_b32 a10, v86
    v_mfma_f32_16x16x32_bf16 v[220:223], a[108:111], a[220:223], v[220:223]
    ds_read_b64_tr_b16 a[92:93], v8 offset:16384
    v_accvgpr_write_b32 a11, v87
    v_mfma_f32_16x16x32_bf16 v[220:223], a[64:67], a[116:119], v[220:223]
    ds_read_b64_tr_b16 a[94:95], v8 offset:20480
    v_xor_b32 v9, 131520, v6
    v_mfma_f32_16x16x32_bf16 v[220:223], a[68:71], a[124:127], v[220:223]
    s_waitcnt lgkmcnt(6)
    ds_read_b64_tr_b16 a[96:97], v9 offset:0
    v_mul_f32 v92, s34, v92
    v_mfma_f32_16x16x32_bf16 v[228:231], a[72:75], a[192:195], v[228:231]
    ds_read_b64_tr_b16 a[98:99], v9 offset:4096
    v_mul_f32 v93, s34, v93
    v_mfma_f32_16x16x32_bf16 v[228:231], a[76:79], a[200:203], v[228:231]
    ds_read_b64_tr_b16 a[100:101], v9 offset:16384
    v_mul_f32 v94, s34, v94
    v_mfma_f32_16x16x32_bf16 v[228:231], a[80:83], a[208:211], v[228:231]
    s_waitcnt lgkmcnt(3)
    ds_read_b64_tr_b16 a[102:103], v9 offset:20480
    v_xor_b32 v10, 448, v6
    v_mfma_f32_16x16x32_bf16 v[228:231], a[84:87], a[216:219], v[228:231]
    ds_read_b64_tr_b16 a[104:105], v10 offset:0
    v_mul_f32 v95, s34, v95
    v_mfma_f32_16x16x32_bf16 v[228:231], a[88:91], a[112:115], v[228:231]
    ds_read_b64_tr_b16 a[106:107], v10 offset:4096
    v_mul_f32 v108, s34, v108
    v_mfma_f32_16x16x32_bf16 v[228:231], a[92:95], a[120:123], v[228:231]
    ds_read_b64_tr_b16 a[108:109], v10 offset:16384
    v_mul_f32 v109, s34, v109
    v_mfma_f32_16x16x32_bf16 v[236:239], a[72:75], a[196:199], v[236:239]
    ds_read_b64_tr_b16 a[110:111], v10 offset:20480
    v_xor_b32 v7, 65984, v6
    v_mfma_f32_16x16x32_bf16 v[236:239], a[76:79], a[204:207], v[236:239]
    ds_read_b64_tr_b16 a[64:65], v7 offset:0
    v_mul_f32 v110, s34, v110
    v_mfma_f32_16x16x32_bf16 v[236:239], a[80:83], a[212:215], v[236:239]
    ds_read_b64_tr_b16 a[66:67], v7 offset:4096
    v_mul_f32 v111, s34, v111
    v_mfma_f32_16x16x32_bf16 v[236:239], a[84:87], a[220:223], v[236:239]
    ds_read_b64_tr_b16 a[68:69], v7 offset:16384
    v_cvt_pk_bf16_f32 v92, v92, v93
    v_mfma_f32_16x16x32_bf16 v[236:239], a[88:91], a[116:119], v[236:239]
    ds_read_b64_tr_b16 a[70:71], v7 offset:20480
    v_xor_b32 v8, 131552, v6
    v_mfma_f32_16x16x32_bf16 v[236:239], a[92:95], a[124:127], v[236:239]
    s_waitcnt lgkmcnt(6)
    ds_read_b64_tr_b16 a[72:73], v8 offset:0
    v_cvt_pk_bf16_f32 v93, v94, v95
    v_mfma_f32_16x16x32_bf16 v[244:247], a[96:99], a[192:195], v[244:247]
    ds_read_b64_tr_b16 a[74:75], v8 offset:4096
    v_cvt_pk_bf16_f32 v94, v108, v109
    v_mfma_f32_16x16x32_bf16 v[244:247], a[100:103], a[200:203], v[244:247]
    s_add_u32 s59, s62, 32768
    ds_read_b64_tr_b16 a[76:77], v8 offset:16384
    v_cvt_pk_bf16_f32 v95, v110, v111
    v_mfma_f32_16x16x32_bf16 v[244:247], a[104:107], a[208:211], v[244:247]
    s_waitcnt lgkmcnt(3)
    ds_read_b64_tr_b16 a[78:79], v8 offset:20480
    v_xor_b32 v9, 480, v6
    v_mfma_f32_16x16x32_bf16 v[244:247], a[108:111], a[216:219], v[244:247]
    ds_read_b64_tr_b16 a[80:81], v9 offset:0
    buffer_store_dwordx4 v[92:95], v1, s[12:15], s59 offen offset:2048 sc1
    v_mfma_f32_16x16x32_bf16 v[244:247], a[64:67], a[112:115], v[244:247]
    ds_read_b64_tr_b16 a[82:83], v9 offset:4096
    v_accvgpr_write_b32 a40, v92
    v_mfma_f32_16x16x32_bf16 v[244:247], a[68:71], a[120:123], v[244:247]
    ds_read_b64_tr_b16 a[84:85], v9 offset:16384
    v_accvgpr_write_b32 a41, v93
    v_mfma_f32_16x16x32_bf16 v[252:255], a[96:99], a[196:199], v[252:255]
    ds_read_b64_tr_b16 a[86:87], v9 offset:20480
    v_xor_b32 v10, 66016, v6
    v_mfma_f32_16x16x32_bf16 v[252:255], a[100:103], a[204:207], v[252:255]
    ds_read_b64_tr_b16 a[88:89], v10 offset:0
    v_accvgpr_write_b32 a42, v94
    v_mfma_f32_16x16x32_bf16 v[252:255], a[104:107], a[212:215], v[252:255]
    ds_read_b64_tr_b16 a[90:91], v10 offset:4096
    v_accvgpr_write_b32 a43, v95
    v_mfma_f32_16x16x32_bf16 v[252:255], a[108:111], a[220:223], v[252:255]
    ds_read_b64_tr_b16 a[92:93], v10 offset:16384
    v_mfma_f32_16x16x32_bf16 v[252:255], a[64:67], a[116:119], v[252:255]
    ds_read_b64_tr_b16 a[94:95], v10 offset:20480
    v_mfma_f32_16x16x32_bf16 v[252:255], a[68:71], a[124:127], v[252:255]
    s_waitcnt lgkmcnt(6)
    v_mfma_f32_16x16x32_bf16 v[16:19], a[72:75], a[192:195], v[16:19]
    v_mfma_f32_16x16x32_bf16 v[16:19], a[76:79], a[200:203], v[16:19]
    v_mfma_f32_16x16x32_bf16 v[16:19], a[80:83], a[208:211], v[16:19]
    s_waitcnt lgkmcnt(0)
    v_mfma_f32_16x16x32_bf16 v[16:19], a[84:87], a[216:219], v[16:19]
    v_mfma_f32_16x16x32_bf16 v[16:19], a[88:91], a[112:115], v[16:19]
    v_mfma_f32_16x16x32_bf16 v[16:19], a[92:95], a[120:123], v[16:19]
    v_mfma_f32_16x16x32_bf16 v[24:27], a[72:75], a[196:199], v[24:27]
    v_mfma_f32_16x16x32_bf16 v[24:27], a[76:79], a[204:207], v[24:27]
    v_mfma_f32_16x16x32_bf16 v[24:27], a[80:83], a[212:215], v[24:27]
    v_mfma_f32_16x16x32_bf16 v[24:27], a[84:87], a[220:223], v[24:27]
    s_waitcnt lgkmcnt(0)
    v_mfma_f32_16x16x32_bf16 v[24:27], a[88:91], a[116:119], v[24:27]
    s_barrier
    v_mfma_f32_16x16x32_bf16 v[24:27], a[92:95], a[124:127], v[24:27]
    s_nop 3
    v_pk_mul_f32 v[116:117], v[116:117], s[34:35]
    v_pk_mul_f32 v[118:119], v[118:119], s[34:35]
    v_pk_mul_f32 v[132:133], v[132:133], s[34:35]
    v_pk_mul_f32 v[134:135], v[134:135], s[34:35]
    v_cvt_pk_bf16_f32 v116, v116, v117
    v_cvt_pk_bf16_f32 v117, v118, v119
    v_cvt_pk_bf16_f32 v118, v132, v133
    v_cvt_pk_bf16_f32 v119, v134, v135
    s_add_u32 s59, s62, 0
    buffer_store_dwordx4 v[116:119], v1, s[12:15], s59 offen offset:3072 sc1
    v_accvgpr_write_b32 a12, v116
    v_accvgpr_write_b32 a13, v117
    v_accvgpr_write_b32 a14, v118
    v_accvgpr_write_b32 a15, v119
    v_pk_mul_f32 v[124:125], v[124:125], s[34:35]
    v_pk_mul_f32 v[126:127], v[126:127], s[34:35]
    v_pk_mul_f32 v[140:141], v[140:141], s[34:35]
    v_pk_mul_f32 v[142:143], v[142:143], s[34:35]
    v_cvt_pk_bf16_f32 v124, v124, v125
    v_cvt_pk_bf16_f32 v125, v126, v127
    v_cvt_pk_bf16_f32 v126, v140, v141
    v_cvt_pk_bf16_f32 v127, v142, v143
    s_add_u32 s59, s62, 32768
    buffer_store_dwordx4 v[124:127], v1, s[12:15], s59 offen offset:3072 sc1
    v_accvgpr_write_b32 a44, v124
    v_accvgpr_write_b32 a45, v125
    v_accvgpr_write_b32 a46, v126
    v_accvgpr_write_b32 a47, v127
    v_pk_mul_f32 v[148:149], v[148:149], s[34:35]
    v_pk_mul_f32 v[150:151], v[150:151], s[34:35]
    v_pk_mul_f32 v[164:165], v[164:165], s[34:35]
    v_pk_mul_f32 v[166:167], v[166:167], s[34:35]
    v_cvt_pk_bf16_f32 v148, v148, v149
    v_cvt_pk_bf16_f32 v149, v150, v151
    v_cvt_pk_bf16_f32 v150, v164, v165
    v_cvt_pk_bf16_f32 v151, v166, v167
    s_add_u32 s59, s62, 4096
    buffer_store_dwordx4 v[148:151], v1, s[12:15], s59 offen offset:0 sc1
    v_accvgpr_write_b32 a16, v148
    v_accvgpr_write_b32 a17, v149
    v_accvgpr_write_b32 a18, v150
    v_accvgpr_write_b32 a19, v151
    v_pk_mul_f32 v[156:157], v[156:157], s[34:35]
    v_pk_mul_f32 v[158:159], v[158:159], s[34:35]
    v_pk_mul_f32 v[172:173], v[172:173], s[34:35]
    v_pk_mul_f32 v[174:175], v[174:175], s[34:35]
    v_cvt_pk_bf16_f32 v156, v156, v157
    v_cvt_pk_bf16_f32 v157, v158, v159
    v_cvt_pk_bf16_f32 v158, v172, v173
    v_cvt_pk_bf16_f32 v159, v174, v175
    s_add_u32 s59, s62, 36864
    buffer_store_dwordx4 v[156:159], v1, s[12:15], s59 offen offset:0 sc1
    v_accvgpr_write_b32 a48, v156
    v_accvgpr_write_b32 a49, v157
    v_accvgpr_write_b32 a50, v158
    v_accvgpr_write_b32 a51, v159
    v_pk_mul_f32 v[180:181], v[180:181], s[34:35]
    v_pk_mul_f32 v[182:183], v[182:183], s[34:35]
    v_pk_mul_f32 v[196:197], v[196:197], s[34:35]
    v_pk_mul_f32 v[198:199], v[198:199], s[34:35]
    v_cvt_pk_bf16_f32 v180, v180, v181
    v_cvt_pk_bf16_f32 v181, v182, v183
    v_cvt_pk_bf16_f32 v182, v196, v197
    v_cvt_pk_bf16_f32 v183, v198, v199
    s_add_u32 s59, s62, 4096
    buffer_store_dwordx4 v[180:183], v1, s[12:15], s59 offen offset:1024 sc1
    v_accvgpr_write_b32 a20, v180
    v_accvgpr_write_b32 a21, v181
    v_accvgpr_write_b32 a22, v182
    v_accvgpr_write_b32 a23, v183
    v_pk_mul_f32 v[188:189], v[188:189], s[34:35]
    v_pk_mul_f32 v[190:191], v[190:191], s[34:35]
    v_pk_mul_f32 v[204:205], v[204:205], s[34:35]
    v_pk_mul_f32 v[206:207], v[206:207], s[34:35]
    v_cvt_pk_bf16_f32 v188, v188, v189
    v_cvt_pk_bf16_f32 v189, v190, v191
    v_cvt_pk_bf16_f32 v190, v204, v205
    v_cvt_pk_bf16_f32 v191, v206, v207
    s_add_u32 s59, s62, 36864
    buffer_store_dwordx4 v[188:191], v1, s[12:15], s59 offen offset:1024 sc1
    v_accvgpr_write_b32 a52, v188
    v_accvgpr_write_b32 a53, v189
    v_accvgpr_write_b32 a54, v190
    v_accvgpr_write_b32 a55, v191
    v_pk_mul_f32 v[212:213], v[212:213], s[34:35]
    v_pk_mul_f32 v[214:215], v[214:215], s[34:35]
    v_pk_mul_f32 v[228:229], v[228:229], s[34:35]
    v_pk_mul_f32 v[230:231], v[230:231], s[34:35]
    v_cvt_pk_bf16_f32 v212, v212, v213
    v_cvt_pk_bf16_f32 v213, v214, v215
    v_cvt_pk_bf16_f32 v214, v228, v229
    v_cvt_pk_bf16_f32 v215, v230, v231
    s_add_u32 s59, s62, 4096
    buffer_store_dwordx4 v[212:215], v1, s[12:15], s59 offen offset:2048 sc1
    v_accvgpr_write_b32 a24, v212
    v_accvgpr_write_b32 a25, v213
    v_accvgpr_write_b32 a26, v214
    v_accvgpr_write_b32 a27, v215
    v_pk_mul_f32 v[220:221], v[220:221], s[34:35]
    v_pk_mul_f32 v[222:223], v[222:223], s[34:35]
    v_pk_mul_f32 v[236:237], v[236:237], s[34:35]
    v_pk_mul_f32 v[238:239], v[238:239], s[34:35]
    v_cvt_pk_bf16_f32 v220, v220, v221
    v_cvt_pk_bf16_f32 v221, v222, v223
    v_cvt_pk_bf16_f32 v222, v236, v237
    v_cvt_pk_bf16_f32 v223, v238, v239
    s_add_u32 s59, s62, 36864
    buffer_store_dwordx4 v[220:223], v1, s[12:15], s59 offen offset:2048 sc1
    v_accvgpr_write_b32 a56, v220
    v_accvgpr_write_b32 a57, v221
    v_accvgpr_write_b32 a58, v222
    v_accvgpr_write_b32 a59, v223
    v_pk_mul_f32 v[244:245], v[244:245], s[34:35]
    v_pk_mul_f32 v[246:247], v[246:247], s[34:35]
    v_pk_mul_f32 v[16:17], v[16:17], s[34:35]
    v_pk_mul_f32 v[18:19], v[18:19], s[34:35]
    v_cvt_pk_bf16_f32 v244, v244, v245
    v_cvt_pk_bf16_f32 v245, v246, v247
    v_cvt_pk_bf16_f32 v246, v16, v17
    v_cvt_pk_bf16_f32 v247, v18, v19
    s_add_u32 s59, s62, 4096
    buffer_store_dwordx4 v[244:247], v1, s[12:15], s59 offen offset:3072 sc1
    v_accvgpr_write_b32 a28, v244
    v_accvgpr_write_b32 a29, v245
    v_accvgpr_write_b32 a30, v246
    v_accvgpr_write_b32 a31, v247
    v_pk_mul_f32 v[252:253], v[252:253], s[34:35]
    v_pk_mul_f32 v[254:255], v[254:255], s[34:35]
    v_pk_mul_f32 v[24:25], v[24:25], s[34:35]
    v_pk_mul_f32 v[26:27], v[26:27], s[34:35]
    v_cvt_pk_bf16_f32 v252, v252, v253
    v_cvt_pk_bf16_f32 v253, v254, v255
    v_cvt_pk_bf16_f32 v254, v24, v25
    v_cvt_pk_bf16_f32 v255, v26, v27
    s_add_u32 s59, s62, 36864
    buffer_store_dwordx4 v[252:255], v1, s[12:15], s59 offen offset:3072 sc1
    v_accvgpr_write_b32 a60, v252
    v_accvgpr_write_b32 a61, v253
    v_accvgpr_write_b32 a62, v254
    v_accvgpr_write_b32 a63, v255
    s_waitcnt vmcnt(14)
L_kvdone:
    s_cmp_ge_u32 s28, 14
    s_cbranch_scc1 L_s1b
    s_mov_b32 s36, 0xffff0000
    s_and_b32 s33, s95, 31
    s_lshr_b32 s34, s95, 5
    v_lshlrev_b32 v128, 16, v32
    v_and_b32 v129, s36, v32
    v_lshlrev_b32 v130, 16, v40
    v_and_b32 v131, s36, v40
    v_lshlrev_b32 v132, 16, v48
    v_and_b32 v133, s36, v48
    v_lshlrev_b32 v134, 16, v56
    v_and_b32 v135, s36, v56
    v_lshlrev_b32 v136, 16, v64
    v_and_b32 v137, s36, v64
    v_lshlrev_b32 v138, 16, v72
    v_and_b32 v139, s36, v72
    v_lshlrev_b32 v140, 16, v80
    v_and_b32 v141, s36, v80
    v_lshlrev_b32 v142, 16, v88
    v_lshlrev_b32 v143, 16, v90
    v_and_b32 v144, s36, v88
    v_and_b32 v145, s36, v90
    v_lshlrev_b32 v146, 16, v89
    v_lshlrev_b32 v147, 16, v91
    v_and_b32 v148, s36, v89
    v_and_b32 v149, s36, v91
    v_pk_mul_f32 v[150:151], v[128:129], v[148:149]
    v_pk_fma_f32 v[150:151], v[130:131], v[146:147], v[150:151]
    v_pk_fma_f32 v[150:151], v[132:133], v[144:145], v[150:151]
    v_pk_fma_f32 v[150:151], v[134:135], v[142:143], v[150:151]
    v_pk_mul_f32 v[150:151], v[150:151], v[138:139]
    v_cvt_pk_bf16_f32 v16, v150, v151
    v_pk_mul_f32 v[152:153], v[130:131], v[148:149]
    v_pk_fma_f32 v[152:153], v[132:133], v[146:147], v[152:153]
    v_pk_fma_f32 v[152:153], v[134:135], v[144:145], v[152:153]
    v_pk_fma_f32 v[152:153], v[136:137], v[142:143], v[152:153]
    v_pk_mul_f32 v[152:153], v[152:153], v[140:141]
    v_cvt_pk_bf16_f32 v20, v152, v153
    v_lshlrev_b32 v128, 16, v33
    v_and_b32 v129, s36, v33
    v_lshlrev_b32 v130, 16, v41
    v_and_b32 v131, s36, v41
    v_lshlrev_b32 v132, 16, v49
    v_and_b32 v133, s36, v49
    v_lshlrev_b32 v134, 16, v57
    v_and_b32 v135, s36, v57
    v_lshlrev_b32 v136, 16, v65
    v_and_b32 v137, s36, v65
    v_lshlrev_b32 v138, 16, v73
    v_and_b32 v139, s36, v73
    v_lshlrev_b32 v140, 16, v81
    v_and_b32 v141, s36, v81
    v_lshlrev_b32 v142, 16, v96
    v_lshlrev_b32 v143, 16, v98
    v_and_b32 v144, s36, v96
    v_and_b32 v145, s36, v98
    v_lshlrev_b32 v146, 16, v97
    v_lshlrev_b32 v147, 16, v99
    v_and_b32 v148, s36, v97
    v_and_b32 v149, s36, v99
    v_pk_mul_f32 v[150:151], v[128:129], v[148:149]
    v_pk_fma_f32 v[150:151], v[130:131], v[146:147], v[150:151]
    v_pk_fma_f32 v[150:151], v[132:133], v[144:145], v[150:151]
    v_pk_fma_f32 v[150:151], v[134:135], v[142:143], v[150:151]
    v_pk_mul_f32 v[150:151], v[150:151], v[138:139]
    v_cvt_pk_bf16_f32 v17, v150, v151
    v_pk_mul_f32 v[152:153], v[130:131], v[148:149]
    v_pk_fma_f32 v[152:153], v[132:133], v[146:147], v[152:153]
    v_pk_fma_f32 v[152:153], v[134:135], v[144:145], v[152:153]
    v_pk_fma_f32 v[152:153], v[136:137], v[142:143], v[152:153]
    v_pk_mul_f32 v[152:153], v[152:153], v[140:141]
    v_cvt_pk_bf16_f32 v21, v152, v153
    v_lshlrev_b32 v128, 16, v34
    v_and_b32 v129, s36, v34
    v_lshlrev_b32 v130, 16, v42
    v_and_b32 v131, s36, v42
    v_lshlrev_b32 v132, 16, v50
    v_and_b32 v133, s36, v50
    v_lshlrev_b32 v134, 16, v58
    v_and_b32 v135, s36, v58
    v_lshlrev_b32 v136, 16, v66
    v_and_b32 v137, s36, v66
    v_lshlrev_b32 v138, 16, v74
    v_and_b32 v139, s36, v74
    v_lshlrev_b32 v140, 16, v82
    v_and_b32 v141, s36, v82
    v_lshlrev_b32 v142, 16, v104
    v_lshlrev_b32 v143, 16, v106
    v_and_b32 v144, s36, v104
    v_and_b32 v145, s36, v106
    v_lshlrev_b32 v146, 16, v105
    v_lshlrev_b32 v147, 16, v107
    v_and_b32 v148, s36, v105
    v_and_b32 v149, s36, v107
    v_pk_mul_f32 v[150:151], v[128:129], v[148:149]
    v_pk_fma_f32 v[150:151], v[130:131], v[146:147], v[150:151]
    v_pk_fma_f32 v[150:151], v[132:133], v[144:145], v[150:151]
    v_pk_fma_f32 v[150:151], v[134:135], v[142:143], v[150:151]
    v_pk_mul_f32 v[150:151], v[150:151], v[138:139]
    v_cvt_pk_bf16_f32 v18, v150, v151
    v_pk_mul_f32 v[152:153], v[130:131], v[148:149]
    v_pk_fma_f32 v[152:153], v[132:133], v[146:147], v[152:153]
    v_pk_fma_f32 v[152:153], v[134:135], v[144:145], v[152:153]
    v_pk_fma_f32 v[152:153], v[136:137], v[142:143], v[152:153]
    v_pk_mul_f32 v[152:153], v[152:153], v[140:141]
    v_cvt_pk_bf16_f32 v22, v152, v153
    v_lshlrev_b32 v128, 16, v35
    v_and_b32 v129, s36, v35
    v_lshlrev_b32 v130, 16, v43
    v_and_b32 v131, s36, v43
    v_lshlrev_b32 v132, 16, v51
    v_and_b32 v133, s36, v51
    v_lshlrev_b32 v134, 16, v59
    v_and_b32 v135, s36, v59
    v_lshlrev_b32 v136, 16, v67
    v_and_b32 v137, s36, v67
    v_lshlrev_b32 v138, 16, v75
    v_and_b32 v139, s36, v75
    v_lshlrev_b32 v140, 16, v83
    v_and_b32 v141, s36, v83
    v_lshlrev_b32 v142, 16, v112
    v_lshlrev_b32 v143, 16, v114
    v_and_b32 v144, s36, v112
    v_and_b32 v145, s36, v114
    v_lshlrev_b32 v146, 16, v113
    v_lshlrev_b32 v147, 16, v115
    v_and_b32 v148, s36, v113
    v_and_b32 v149, s36, v115
    v_pk_mul_f32 v[150:151], v[128:129], v[148:149]
    v_pk_fma_f32 v[150:151], v[130:131], v[146:147], v[150:151]
    v_pk_fma_f32 v[150:151], v[132:133], v[144:145], v[150:151]
    v_pk_fma_f32 v[150:151], v[134:135], v[142:143], v[150:151]
    v_pk_mul_f32 v[150:151], v[150:151], v[138:139]
    v_cvt_pk_bf16_f32 v19, v150, v151
    v_pk_mul_f32 v[152:153], v[130:131], v[148:149]
    v_pk_fma_f32 v[152:153], v[132:133], v[146:147], v[152:153]
    v_pk_fma_f32 v[152:153], v[134:135], v[144:145], v[152:153]
    v_pk_fma_f32 v[152:153], v[136:137], v[142:143], v[152:153]
    v_pk_mul_f32 v[152:153], v[152:153], v[140:141]
    v_cvt_pk_bf16_f32 v23, v152, v153
    v_lshrrev_b32 v26, 3, v0
    v_lshlrev_b32 v26, 8, v26
    v_and_b32 v25, 7, v0
    v_lshl_add_u32 v26, v25, 4, v26
    s_lshl_b32 s35, s3, 11
    s_add_u32 s35, s35, 0x20000
    v_add_u32 v26, s35, v26
    ds_write_b128 v26, v[16:19] offset:0
    ds_write_b128 v26, v[20:23] offset:128
    v_bfe_u32 v24, v0, 2, 2
    v_bfe_u32 v28, v0, 4, 1
    v_lshl_add_u32 v24, v28, 3, v24
    v_lshlrev_b32 v24, 2, v24
    v_lshrrev_b32 v28, 5, v0
    v_add_u32 v24, v24, v28
    v_lshlrev_b32 v24, 7, v24
    v_and_b32 v28, 3, v0
    v_lshl_add_u32 v24, v28, 3, v24
    s_lshl_b32 s35, s3, 5
    s_add_u32 s35, s35, 0x20000
    v_add_u32 v24, s35, v24
    v_and_b32 v25, 15, v0
    v_lshlrev_b32 v25, 12, v25
    v_lshrrev_b32 v28, 4, v0
    v_lshl_add_u32 v25, v28, 4, v25
    s_lshl_b32 s35, s34, 2
    s_add_u32 s35, s35, s3
    s_lshl_b32 s35, s35, 16
    s_lshl_b32 s36, s33, 7
    s_add_u32 s35, s35, s36
    s_add_u32 s35, s35, 85983232
L_s1b:
    s_and_b32 s59, s92, ~127
    s_mov_b32 s58, s62
    buffer_load_dword a249, v12, s[12:15], s59 offen sc1
    s_lshl_b32 s37, s25, 1
    s_sub_i32 s38, 13, s37
    s_max_i32 s38, s38, 0
    s_lshl_b32 s49, s26, 20
    s_lshl_b32 s50, s3, 13
    s_add_u32 s49, s49, s50
    s_mov_b32 s51, s63
    s_add_u32 s53, s37, 2
    s_sub_u32 s55, 32, s37
    s_sub_u32 s55, s55, s38
    s_cmp_eq_u32 s27, 0
    s_cselect_b32 s53, s53, s55
    s_cselect_b32 s52, 0, s38
    s_cselect_b32 s54, 0, 2
    v_lshlrev_b32 v1, 4, v0
    v_add_u32 v4, 4096, v1
    s_lshl_b32 s55, s52, 15
    s_add_u32 s42, s55, s49
    s_add_u32 s43, s42, 16777216
    s_mov_b32 s40, s50
    s_add_u32 s41, s50, 0x10000
    v_and_b32 v14, 15, v0
    v_lshrrev_b32 v11, 4, v0
    v_lshlrev_b32 v11, 2, v11
    v_sub_u32 v14, v14, v11
    s_lshl_b32 s48, s3, 4
    v_add_u32 v14, s48, v14
    v_mov_b32 v2, v1
    v_add_u32 v3, 0x10000, v1
    v_mov_b64 v[96:97], 0
    v_mov_b64 v[98:99], 0
    v_mov_b64 v[100:101], 0
    v_mov_b64 v[102:103], 0
    v_mov_b64 v[104:105], 0
    v_mov_b64 v[106:107], 0
    v_mov_b64 v[108:109], 0
    v_mov_b64 v[110:111], 0
    v_mov_b64 v[112:113], 0
    v_mov_b64 v[114:115], 0
    v_mov_b64 v[116:117], 0
    v_mov_b64 v[118:119], 0
    v_mov_b64 v[120:121], 0
    v_mov_b64 v[122:123], 0
    v_mov_b64 v[124:125], 0
    v_mov_b64 v[126:127], 0
    v_mov_b64 v[128:129], 0
    v_mov_b64 v[130:131], 0
    v_mov_b64 v[132:133], 0
    v_mov_b64 v[134:135], 0
    v_mov_b64 v[136:137], 0
    v_mov_b64 v[138:139], 0
    v_mov_b64 v[140:141], 0
    v_mov_b64 v[142:143], 0
    v_mov_b64 v[144:145], 0
    v_mov_b64 v[146:147], 0
    v_mov_b64 v[148:149], 0
    v_mov_b64 v[150:151], 0
    v_mov_b64 v[152:153], 0
    v_mov_b64 v[154:155], 0
    v_mov_b64 v[156:157], 0
    v_mov_b64 v[158:159], 0
    v_mov_b64 v[160:161], 0
    v_mov_b64 v[162:163], 0
    v_mov_b64 v[164:165], 0
    v_mov_b64 v[166:167], 0
    v_mov_b64 v[168:169], 0
    v_mov_b64 v[170:171], 0
    v_mov_b64 v[172:173], 0
    v_mov_b64 v[174:175], 0
    v_mov_b64 v[176:177], 0
    v_mov_b64 v[178:179], 0
    v_mov_b64 v[180:181], 0
    v_mov_b64 v[182:183], 0
    v_mov_b64 v[184:185], 0
    v_mov_b64 v[186:187], 0
    v_mov_b64 v[188:189], 0
    v_mov_b64 v[190:191], 0
    v_mov_b64 v[192:193], 0
    v_mov_b64 v[194:195], 0
    v_mov_b64 v[196:197], 0
    v_mov_b64 v[198:199], 0
    v_mov_b64 v[200:201], 0
    v_mov_b64 v[202:203], 0
    v_mov_b64 v[204:205], 0
    v_mov_b64 v[206:207], 0
    v_mov_b64 v[208:209], 0
    v_mov_b64 v[210:211], 0
    v_mov_b64 v[212:213], 0
    v_mov_b64 v[214:215], 0
    v_mov_b64 v[216:217], 0
    v_mov_b64 v[218:219], 0
    v_mov_b64 v[220:221], 0
    v_mov_b64 v[222:223], 0
    v_mov_b64 v[224:225], 0
    v_mov_b64 v[226:227], 0
    v_mov_b64 v[228:229], 0
    v_mov_b64 v[230:231], 0
    v_mov_b64 v[232:233], 0
    v_mov_b64 v[234:235], 0
    v_mov_b64 v[236:237], 0
    v_mov_b64 v[238:239], 0
    v_mov_b64 v[240:241], 0
    v_mov_b64 v[242:243], 0
    v_mov_b64 v[244:245], 0
    v_mov_b64 v[246:247], 0
    v_mov_b64 v[248:249], 0
    v_mov_b64 v[250:251], 0
    v_mov_b64 v[252:253], 0
    v_mov_b64 v[254:255], 0
    v_mov_b32 v7, 0
    v_mov_b32 v8, 0
    v_mov_b32 v9, 0
    v_mov_b32 v10, 0
    v_accvgpr_write_b32 a246, 1
    v_accvgpr_write_b32 a247, 1
    s_xor_b32 s60, s27, 1
    s_lshl_b32 s60, s60, 2
    s_add_u32 s60, s60, s94
    s_lshr_b32 s61, s95, 4
    s_lshl_b32 s61, s61, 7
    s_add_u32 s61, s61, 84959232
    s_cmp_lt_u32 s28, 14
    s_cselect_b32 s62, 1, 0
    s_andn2_b32 s62, s62, s27
    s_lshl_b32 s30, s95, 1
    s_lshr_b32 s31, s3, 1
    s_add_u32 s30, s30, s31
    s_min_u32 s30, s30, 223
    s_lshl_b32 s30, s30, 2
    s_load_dword s31, s[74:75], s30
    s_mov_b32 s47, 0x4b800000
    s_mov_b32 s45, 2
    s_sub_u32 s44, s53, 1
    s_cmp_ge_u32 s44, 2
    s_cbranch_scc1 L_nomask0
    v_mov_b32 v11, 0xf149f2ca
    v_cmp_gt_i32 s[16:17], 0, v14
    v_cmp_gt_i32 s[18:19], 1, v14
    v_cmp_gt_i32 s[20:21], 2, v14
    v_cmp_gt_i32 s[22:23], 3, v14
    v_cndmask_b32 v96, v9, v11, s[16:17]
    v_cndmask_b32 v97, v9, v11, s[18:19]
    v_cndmask_b32 v98, v9, v11, s[20:21]
    v_cndmask_b32 v99, v9, v11, s[22:23]
    v_cmp_gt_i32 s[16:17], 16, v14
    v_cmp_gt_i32 s[18:19], 17, v14
    v_cmp_gt_i32 s[20:21], 18, v14
    v_cmp_gt_i32 s[22:23], 19, v14
    v_cndmask_b32 v104, v9, v11, s[16:17]
    v_cndmask_b32 v105, v9, v11, s[18:19]
    v_cndmask_b32 v106, v9, v11, s[20:21]
    v_cndmask_b32 v107, v9, v11, s[22:23]
    v_cmp_gt_i32 s[16:17], 32, v14
    v_cmp_gt_i32 s[18:19], 33, v14
    v_cmp_gt_i32 s[20:21], 34, v14
    v_cmp_gt_i32 s[22:23], 35, v14
    v_cndmask_b32 v112, v9, v11, s[16:17]
    v_cndmask_b32 v113, v9, v11, s[18:19]
    v_cndmask_b32 v114, v9, v11, s[20:21]
    v_cndmask_b32 v115, v9, v11, s[22:23]
    v_cmp_gt_i32 s[16:17], 48, v14
    v_cmp_gt_i32 s[18:19], 49, v14
    v_cmp_gt_i32 s[20:21], 50, v14
    v_cmp_gt_i32 s[22:23], 51, v14
    v_cndmask_b32 v120, v9, v11, s[16:17]
    v_cndmask_b32 v121, v9, v11, s[18:19]
    v_cndmask_b32 v122, v9, v11, s[20:21]
    v_cndmask_b32 v123, v9, v11, s[22:23]
L_nomask0:
    v_accvgpr_read_b32 v27, a245
    s_lshl_b32 s36, s95, 2
    s_add_u32 s36, s36, 84959232
    s_cmp_lt_u32 s28, 14
    s_cselect_b32 s36, s36, 2.0
    s_add_u32 s33, s94, 4
    s_cmp_eq_u32 s27, 1
    s_cselect_b32 s33, s33, 2.0
    s_waitcnt vmcnt(0)
    v_accvgpr_read_b32 v28, a248
    v_mov_b32 v29, 0
    v_cmp_gt_u32 vcc, 256, v28
    s_cbranch_vccz L_armed
    s_mov_b32 s32, 0
    v_accvgpr_write_b32 a249, 1
L_pollA:
    global_load_dword v28, v29, s[90:91] offset:128 sc1
    s_add_u32 s32, s32, 1
    s_waitcnt vmcnt(0)
    v_cmp_gt_u32 vcc, 256, v28
    s_cmp_lt_u32 s32, 0x80000
    s_cselect_b64 vcc, vcc, 0
    s_cbranch_vccnz L_pollA
L_armed:
    v_accvgpr_read_b32 v29, a249
    v_cmp_ne_u32 vcc, 0, v29
    s_cbranch_vccz L_poll0_ok
    v_and_b32 v28, 15, v0
    v_lshlrev_b32 v28, 2, v28
    s_mov_b32 s32, 0
L_poll0:
    buffer_load_dword v29, v28, s[12:15], s59 offen sc1
    s_waitcnt vmcnt(0)
    v_cmp_ne_u32 vcc, 0, v29
    s_cbranch_vccz L_poll0_ok
    s_sleep 8
    s_add_u32 s32, s32, 1
    s_cmp_lt_u32 s32, 0x80000
    s_cbranch_scc1 L_poll0
L_poll0_ok:
    s_mov_b32 m0, s40
    s_nop 0
    buffer_load_dwordx4 v1, s[12:15], s42 offen offset:0 sc1 lds
    buffer_load_dwordx4 v1, s[12:15], s42 offen offset:1024 sc1 lds
    buffer_load_dwordx4 v1, s[12:15], s42 offen offset:2048 sc1 lds
    buffer_load_dwordx4 v1, s[12:15], s42 offen offset:3072 sc1 lds
    s_bitset1_b32 m0, 12
    s_nop 0
    buffer_load_dwordx4 v4, s[12:15], s42 offen offset:0 sc1 lds
    buffer_load_dwordx4 v4, s[12:15], s42 offen offset:1024 sc1 lds
    buffer_load_dwordx4 v4, s[12:15], s42 offen offset:2048 sc1 lds
    buffer_load_dwordx4 v4, s[12:15], s42 offen offset:3072 sc1 lds
    s_add_u32 s42, s42, 0x8000
    s_xor_b32 s40, s40, 0x8000
    s_mov_b32 m0, s40
    s_nop 0
    buffer_load_dwordx4 v1, s[12:15], s42 offen offset:0 sc1 lds
    buffer_load_dwordx4 v1, s[12:15], s42 offen offset:1024 sc1 lds
    buffer_load_dwordx4 v1, s[12:15], s42 offen offset:2048 sc1 lds
    buffer_load_dwordx4 v1, s[12:15], s42 offen offset:3072 sc1 lds
    s_bitset1_b32 m0, 12
    s_nop 0
    buffer_load_dwordx4 v4, s[12:15], s42 offen offset:0 sc1 lds
    buffer_load_dwordx4 v4, s[12:15], s42 offen offset:1024 sc1 lds
    buffer_load_dwordx4 v4, s[12:15], s42 offen offset:2048 sc1 lds
    buffer_load_dwordx4 v4, s[12:15], s42 offen offset:3072 sc1 lds
    s_add_u32 s42, s42, 0x8000
    s_xor_b32 s40, s40, 0x8000
    s_waitcnt vmcnt(8) lgkmcnt(0)
    s_barrier
    ds_read_b128 a[64:67], v2 offset:0
    ds_read_b128 a[68:71], v2 offset:1024
    ds_read_b128 a[72:75], v2 offset:2048
    ds_read_b128 a[76:79], v2 offset:3072
    ds_read_b128 a[80:83], v2 offset:4096
    ds_read_b128 a[84:87], v2 offset:5120
    ds_read_b128 a[88:91], v2 offset:6144
    ds_read_b128 a[92:95], v2 offset:7168
    buffer_store_dword v27, v27, s[12:15], s33 offen sc1
    s_cmp_ge_u32 s28, 14
    s_cbranch_scc1 L_s1c
    ds_read_b64_tr_b16 v[16:17], v24 offset:0
    ds_read_b64_tr_b16 v[18:19], v24 offset:2048
    ds_read_b64_tr_b16 v[20:21], v24 offset:256
    ds_read_b64_tr_b16 v[22:23], v24 offset:2304
    s_waitcnt lgkmcnt(0)
    buffer_store_dwordx4 v[16:19], v25, s[12:15], s35 offen offset:0 sc1
    buffer_store_dwordx4 v[20:23], v25, s[12:15], s35 offen offset:64 sc1
L_s1c:
    s_mov_b32 m0, s41
    s_waitcnt lgkmcnt(0)
    v_mfma_f32_16x16x32_bf16 v[32:35], a[64:67], a[0:3], v[96:99]
    ds_read_b128 a[96:99], v2 offset:8192
    v_mfma_f32_16x16x32_bf16 v[32:35], a[68:71], a[4:7], v[32:35]
    buffer_load_dwordx4 v1, s[12:15], s43 offen offset:0 sc1 lds
    v_mfma_f32_16x16x32_bf16 v[32:35], a[72:75], a[8:11], v[32:35]
    ds_read_b128 a[100:103], v2 offset:9216
    v_mfma_f32_16x16x32_bf16 v[32:35], a[76:79], a[12:15], v[32:35]
    v_mfma_f32_16x16x32_bf16 v[32:35], a[80:83], a[16:19], v[32:35]
    ds_read_b128 a[104:107], v2 offset:10240
    v_mfma_f32_16x16x32_bf16 v[32:35], a[84:87], a[20:23], v[32:35]
    buffer_load_dwordx4 v1, s[12:15], s43 offen offset:1024 sc1 lds
    v_mfma_f32_16x16x32_bf16 v[32:35], a[88:91], a[24:27], v[32:35]
    ds_read_b128 a[108:111], v2 offset:11264
    v_mfma_f32_16x16x32_bf16 v[32:35], a[92:95], a[28:31], v[32:35]
    v_mfma_f32_16x16x32_bf16 v[36:39], a[64:67], a[32:35], v[100:103]
    ds_read_b128 a[112:115], v2 offset:12288
    v_mfma_f32_16x16x32_bf16 v[36:39], a[68:71], a[36:39], v[36:39]
    buffer_load_dwordx4 v1, s[12:15], s43 offen offset:2048 sc1 lds
    v_mfma_f32_16x16x32_bf16 v[36:39], a[72:75], a[40:43], v[36:39]
    ds_read_b128 a[116:119], v2 offset:13312
    v_mfma_f32_16x16x32_bf16 v[36:39], a[76:79], a[44:47], v[36:39]
    v_mfma_f32_16x16x32_bf16 v[36:39], a[80:83], a[48:51], v[36:39]
    ds_read_b128 a[120:123], v2 offset:14336
    v_mfma_f32_16x16x32_bf16 v[36:39], a[84:87], a[52:55], v[36:39]
    buffer_load_dwordx4 v1, s[12:15], s43 offen offset:3072 sc1 lds
    v_mfma_f32_16x16x32_bf16 v[36:39], a[88:91], a[56:59], v[36:39]
    ds_read_b128 a[124:127], v2 offset:15360
    v_mfma_f32_16x16x32_bf16 v[36:39], a[92:95], a[60:63], v[36:39]
    s_waitcnt lgkmcnt(6)
    v_exp_f32 v64, v32
    v_mfma_f32_16x16x32_bf16 v[40:43], a[96:99], a[0:3], v[104:107]
    s_bitset1_b32 m0, 12
    ds_read_b128 a[64:67], v2 offset:16384
    v_mfma_f32_16x16x32_bf16 v[40:43], a[100:103], a[4:7], v[40:43]
    s_waitcnt lgkmcnt(5)
    buffer_load_dwordx4 v4, s[12:15], s43 offen offset:0 sc1 lds
    v_mfma_f32_16x16x32_bf16 v[40:43], a[104:107], a[8:11], v[40:43]
    ds_read_b128 a[68:71], v2 offset:17408
    v_mfma_f32_16x16x32_bf16 v[40:43], a[108:111], a[12:15], v[40:43]
    s_waitcnt lgkmcnt(4)
    v_exp_f32 v65, v33
    v_mfma_f32_16x16x32_bf16 v[40:43], a[112:115], a[16:19], v[40:43]
    ds_read_b128 a[72:75], v2 offset:18432
    v_add_f32 v5, v64, v65
    v_mfma_f32_16x16x32_bf16 v[40:43], a[116:119], a[20:23], v[40:43]
    s_waitcnt lgkmcnt(3)
    buffer_load_dwordx4 v4, s[12:15], s43 offen offset:1024 sc1 lds
    v_mfma_f32_16x16x32_bf16 v[40:43], a[120:123], a[24:27], v[40:43]
    ds_read_b128 a[76:79], v2 offset:19456
    v_mfma_f32_16x16x32_bf16 v[40:43], a[124:127], a[28:31], v[40:43]
    v_exp_f32 v66, v34
    v_mfma_f32_16x16x32_bf16 v[44:47], a[96:99], a[32:35], v[108:111]
    ds_read_b128 a[80:83], v2 offset:20480
    v_add_f32 v5, v5, v66
    v_mfma_f32_16x16x32_bf16 v[44:47], a[100:103], a[36:39], v[44:47]
    buffer_load_dwordx4 v4, s[12:15], s43 offen offset:2048 sc1 lds
    v_mfma_f32_16x16x32_bf16 v[44:47], a[104:107], a[40:43], v[44:47]
    ds_read_b128 a[84:87], v2 offset:21504
    v_mfma_f32_16x16x32_bf16 v[44:47], a[108:111], a[44:47], v[44:47]
    v_exp_f32 v67, v35
    v_mfma_f32_16x16x32_bf16 v[44:47], a[112:115], a[48:51], v[44:47]
    ds_read_b128 a[88:91], v2 offset:22528
    v_add_f32 v5, v5, v67
    v_mfma_f32_16x16x32_bf16 v[44:47], a[116:119], a[52:55], v[44:47]
    buffer_load_dwordx4 v4, s[12:15], s43 offen offset:3072 sc1 lds
    v_mfma_f32_16x16x32_bf16 v[44:47], a[120:123], a[56:59], v[44:47]
    ds_read_b128 a[92:95], v2 offset:23552
    v_mfma_f32_16x16x32_bf16 v[44:47], a[124:127], a[60:63], v[44:47]
    s_waitcnt lgkmcnt(6)
    v_exp_f32 v68, v36
    v_mfma_f32_16x16x32_bf16 v[48:51], a[64:67], a[0:3], v[112:115]
    s_add_u32 s43, s43, 0x8000
    ds_read_b128 a[96:99], v2 offset:24576
    v_mfma_f32_16x16x32_bf16 v[48:51], a[68:71], a[4:7], v[48:51]
    s_waitcnt lgkmcnt(5)
    v_exp_f32 v69, v37
    v_mfma_f32_16x16x32_bf16 v[48:51], a[72:75], a[8:11], v[48:51]
    s_xor_b32 s41, s41, 0x8000
    ds_read_b128 a[100:103], v2 offset:25600
    v_add_f32 v6, v68, v69
    v_mfma_f32_16x16x32_bf16 v[48:51], a[76:79], a[12:15], v[48:51]
    s_waitcnt lgkmcnt(4)
    v_exp_f32 v70, v38
    v_mfma_f32_16x16x32_bf16 v[48:51], a[80:83], a[16:19], v[48:51]
    ds_read_b128 a[104:107], v2 offset:26624
    v_add_f32 v6, v6, v70
    v_mfma_f32_16x16x32_bf16 v[48:51], a[84:87], a[20:23], v[48:51]
    s_waitcnt lgkmcnt(3)
    v_exp_f32 v71, v39
    v_mfma_f32_16x16x32_bf16 v[48:51], a[88:91], a[24:27], v[48:51]
    ds_read_b128 a[108:111], v2 offset:27648
    v_add_f32 v6, v6, v71
    v_mfma_f32_16x16x32_bf16 v[48:51], a[92:95], a[28:31], v[48:51]
    v_exp_f32 v72, v40
    v_mfma_f32_16x16x32_bf16 v[52:55], a[64:67], a[32:35], v[116:119]
    ds_read_b128 a[112:115], v2 offset:28672
    v_add_f32 v5, v5, v72
    v_mfma_f32_16x16x32_bf16 v[52:55], a[68:71], a[36:39], v[52:55]
    v_exp_f32 v73, v41
    v_mfma_f32_16x16x32_bf16 v[52:55], a[72:75], a[40:43], v[52:55]
    ds_read_b128 a[116:119], v2 offset:29696
    v_add_f32 v5, v5, v73
    v_mfma_f32_16x16x32_bf16 v[52:55], a[76:79], a[44:47], v[52:55]
    v_exp_f32 v74, v42
    v_mfma_f32_16x16x32_bf16 v[52:55], a[80:83], a[48:51], v[52:55]
    ds_read_b128 a[120:123], v2 offset:30720
    v_add_f32 v5, v5, v74
    v_mfma_f32_16x16x32_bf16 v[52:55], a[84:87], a[52:55], v[52:55]
    v_exp_f32 v75, v43
    v_mfma_f32_16x16x32_bf16 v[52:55], a[88:91], a[56:59], v[52:55]
    ds_read_b128 a[124:127], v2 offset:31744
    v_add_f32 v5, v5, v75
    v_mfma_f32_16x16x32_bf16 v[52:55], a[92:95], a[60:63], v[52:55]
    s_waitcnt lgkmcnt(6)
    v_exp_f32 v76, v44
    v_mfma_f32_16x16x32_bf16 v[56:59], a[96:99], a[0:3], v[120:123]
    v_exp_f32 v77, v45
    v_mfma_f32_16x16x32_bf16 v[56:59], a[100:103], a[4:7], v[56:59]
    s_waitcnt lgkmcnt(4)
    v_exp_f32 v78, v46
    v_mfma_f32_16x16x32_bf16 v[56:59], a[104:107], a[8:11], v[56:59]
    v_exp_f32 v79, v47
    v_mfma_f32_16x16x32_bf16 v[56:59], a[108:111], a[12:15], v[56:59]
    s_waitcnt lgkmcnt(2)
    v_exp_f32 v80, v48
    v_mfma_f32_16x16x32_bf16 v[56:59], a[112:115], a[16:19], v[56:59]
    v_exp_f32 v81, v49
    v_mfma_f32_16x16x32_bf16 v[56:59], a[116:119], a[20:23], v[56:59]
    s_waitcnt lgkmcnt(0)
    v_exp_f32 v82, v50
    v_mfma_f32_16x16x32_bf16 v[56:59], a[120:123], a[24:27], v[56:59]
    v_exp_f32 v83, v51
    v_mfma_f32_16x16x32_bf16 v[56:59], a[124:127], a[28:31], v[56:59]
    v_exp_f32 v84, v52
    v_mfma_f32_16x16x32_bf16 v[60:63], a[96:99], a[32:35], v[124:127]
    v_exp_f32 v85, v53
    v_mfma_f32_16x16x32_bf16 v[60:63], a[100:103], a[36:39], v[60:63]
    v_exp_f32 v86, v54
    v_mfma_f32_16x16x32_bf16 v[60:63], a[104:107], a[40:43], v[60:63]
    v_exp_f32 v87, v55
    v_mfma_f32_16x16x32_bf16 v[60:63], a[108:111], a[44:47], v[60:63]
    v_add_f32 v6, v6, v76
    v_mfma_f32_16x16x32_bf16 v[60:63], a[112:115], a[48:51], v[60:63]
    v_add_f32 v6, v6, v77
    v_mfma_f32_16x16x32_bf16 v[60:63], a[116:119], a[52:55], v[60:63]
    v_exp_f32 v88, v56
    v_mfma_f32_16x16x32_bf16 v[60:63], a[120:123], a[56:59], v[60:63]
    v_exp_f32 v89, v57
    v_mfma_f32_16x16x32_bf16 v[60:63], a[124:127], a[60:63], v[60:63]
    v_exp_f32 v90, v58
    v_xor_b32 v2, 0x8000, v2
    s_waitcnt vmcnt(8)
    s_barrier
    ds_read_b128 a[64:67], v2 offset:0
    ds_read_b128 a[68:71], v2 offset:1024
    ds_read_b128 a[72:75], v2 offset:2048
    ds_read_b128 a[76:79], v2 offset:3072
    ds_read_b128 a[80:83], v2 offset:4096
    ds_read_b128 a[84:87], v2 offset:5120
    ds_read_b128 a[88:91], v2 offset:6144
    ds_read_b128 a[92:95], v2 offset:7168
    buffer_store_dword v27, v27, s[12:15], s36 offen sc1
    v_exp_f32 v91, v59
    v_exp_f32 v92, v60
    v_exp_f32 v93, v61
    v_exp_f32 v94, v62
    v_exp_f32 v95, v63
    v_add_f32 v6, v6, v78
    v_add_f32 v6, v6, v79
    v_add_f32 v5, v5, v80
    v_add_f32 v5, v5, v81
    v_add_f32 v5, v5, v82
    v_add_f32 v5, v5, v83
    v_add_f32 v6, v6, v84
    v_add_f32 v6, v6, v85
    v_add_f32 v6, v6, v86
    v_add_f32 v6, v6, v87
    v_add_f32 v5, v5, v88
    v_add_f32 v5, v5, v89
    v_add_f32 v5, v5, v90
    v_add_f32 v5, v5, v91
    v_add_f32 v6, v6, v92
    v_add_f32 v6, v6, v93
    v_add_f32 v6, v6, v94
    v_add_f32 v6, v6, v95
L_first:
    v_add_f32 v11, v5, v6
    v_min_f32 v12, v5, v6
    v_cmp_nge_f32 vcc, s47, v11
    s_mov_b32 s46, 0xff800000
    s_cbranch_vccnz L_slow2
    v_cmp_gt_f32 vcc, 0x33800000, v12
    s_cbranch_vccnz L_rowchk
L_firstok:
    s_mov_b32 s46, 0
    s_waitcnt lgkmcnt(0)
    s_branch L_ret
L_rowchk:
    v_mov_b32 v16, v5
    v_mov_b32 v17, v6
    v_mov_b32 v18, v16
    v_mov_b32 v19, v17
    s_nop 0
    v_permlane32_swap_b32 v16, v18
    v_permlane32_swap_b32 v17, v19
    s_nop 0
    v_add_f32 v16, v16, v18
    v_add_f32 v17, v17, v19
    v_mov_b32 v18, v16
    v_mov_b32 v19, v17
    s_nop 0
    v_permlane16_swap_b32 v16, v18
    v_permlane16_swap_b32 v17, v19
    s_nop 0
    v_add_f32 v16, v16, v18
    v_add_f32 v17, v17, v19
    v_min_f32 v16, v16, v17
    v_cmp_gt_f32 vcc, 0x33800000, v16
    s_cbranch_vccz L_firstok
    s_branch L_slow2
L_slow:
    s_cmp_lg_u32 s47, 0x4b800000
    s_cbranch_scc1 L_switched
    s_nop 5
L_slow2:
    v_max3_f32 v11, v32, v33, v34
    v_max3_f32 v11, v11, v35, v40
    v_max3_f32 v11, v11, v41, v42
    v_max3_f32 v11, v11, v43, v48
    v_max3_f32 v11, v11, v49, v50
    v_max3_f32 v11, v11, v51, v56
    v_max3_f32 v11, v11, v57, v58
    v_max_f32 v11, v11, v59
    v_mov_b32 v13, v11
    s_nop 1
    v_permlane32_swap_b32 v11, v13
    s_nop 1
    v_max_f32 v11, v11, v13
    v_mov_b32 v13, v11
    s_nop 1
    v_permlane16_swap_b32 v11, v13
    s_nop 1
    v_max_f32 v11, v11, v13
    v_max_f32 v11, s46, v11
    v_sub_f32 v9, v9, v11
    v_sub_f32 v32, v32, v11
    v_sub_f32 v33, v33, v11
    v_sub_f32 v34, v34, v11
    v_sub_f32 v35, v35, v11
    v_sub_f32 v40, v40, v11
    v_sub_f32 v41, v41, v11
    v_sub_f32 v42, v42, v11
    v_sub_f32 v43, v43, v11
    v_sub_f32 v48, v48, v11
    v_sub_f32 v49, v49, v11
    v_sub_f32 v50, v50, v11
    v_sub_f32 v51, v51, v11
    v_sub_f32 v56, v56, v11
    v_sub_f32 v57, v57, v11
    v_sub_f32 v58, v58, v11
    v_sub_f32 v59, v59, v11
    v_exp_f32 v64, v32
    v_mov_b32 v96, v9
    v_exp_f32 v65, v33
    v_mov_b32 v97, v9
    v_exp_f32 v66, v34
    v_mov_b32 v98, v9
    v_exp_f32 v67, v35
    v_mov_b32 v99, v9
    v_exp_f32 v72, v40
    v_mov_b32 v104, v9
    v_exp_f32 v73, v41
    v_mov_b32 v105, v9
    v_exp_f32 v74, v42
    v_mov_b32 v106, v9
    v_exp_f32 v75, v43
    v_mov_b32 v107, v9
    v_exp_f32 v80, v48
    v_mov_b32 v112, v9
    v_exp_f32 v81, v49
    v_mov_b32 v113, v9
    v_exp_f32 v82, v50
    v_mov_b32 v114, v9
    v_exp_f32 v83, v51
    v_mov_b32 v115, v9
    v_exp_f32 v88, v56
    v_mov_b32 v120, v9
    v_exp_f32 v89, v57
    v_mov_b32 v121, v9
    v_exp_f32 v90, v58
    v_mov_b32 v122, v9
    v_exp_f32 v91, v59
    v_mov_b32 v123, v9
    v_add_f32 v5, v64, v65
    v_add_f32 v5, v5, v66
    v_add_f32 v5, v5, v67
    v_add_f32 v5, v5, v72
    v_add_f32 v5, v5, v73
    v_add_f32 v5, v5, v74
    v_add_f32 v5, v5, v75
    v_add_f32 v5, v5, v80
    v_add_f32 v5, v5, v81
    v_add_f32 v5, v5, v82
    v_add_f32 v5, v5, v83
    v_add_f32 v5, v5, v88
    v_add_f32 v5, v5, v89
    v_add_f32 v5, v5, v90
    v_add_f32 v5, v5, v91
    v_max3_f32 v12, v36, v37, v38
    v_max3_f32 v12, v12, v39, v44
    v_max3_f32 v12, v12, v45, v46
    v_max3_f32 v12, v12, v47, v52
    v_max3_f32 v12, v12, v53, v54
    v_max3_f32 v12, v12, v55, v60
    v_max3_f32 v12, v12, v61, v62
    v_max_f32 v12, v12, v63
    v_mov_b32 v13, v12
    s_nop 1
    v_permlane32_swap_b32 v12, v13
    s_nop 1
    v_max_f32 v12, v12, v13
    v_mov_b32 v13, v12
    s_nop 1
    v_permlane16_swap_b32 v12, v13
    s_nop 1
    v_max_f32 v12, v12, v13
    v_max_f32 v12, s46, v12
    v_sub_f32 v10, v10, v12
    v_sub_f32 v36, v36, v12
    v_sub_f32 v37, v37, v12
    v_sub_f32 v38, v38, v12
    v_sub_f32 v39, v39, v12
    v_sub_f32 v44, v44, v12
    v_sub_f32 v45, v45, v12
    v_sub_f32 v46, v46, v12
    v_sub_f32 v47, v47, v12
    v_sub_f32 v52, v52, v12
    v_sub_f32 v53, v53, v12
    v_sub_f32 v54, v54, v12
    v_sub_f32 v55, v55, v12
    v_sub_f32 v60, v60, v12
    v_sub_f32 v61, v61, v12
    v_sub_f32 v62, v62, v12
    v_sub_f32 v63, v63, v12
    v_exp_f32 v68, v36
    v_mov_b32 v100, v10
    v_exp_f32 v69, v37
    v_mov_b32 v101, v10
    v_exp_f32 v70, v38
    v_mov_b32 v102, v10
    v_exp_f32 v71, v39
    v_mov_b32 v103, v10
    v_exp_f32 v76, v44
    v_mov_b32 v108, v10
    v_exp_f32 v77, v45
    v_mov_b32 v109, v10
    v_exp_f32 v78, v46
    v_mov_b32 v110, v10
    v_exp_f32 v79, v47
    v_mov_b32 v111, v10
    v_exp_f32 v84, v52
    v_mov_b32 v116, v10
    v_exp_f32 v85, v53
    v_mov_b32 v117, v10
    v_exp_f32 v86, v54
    v_mov_b32 v118, v10
    v_exp_f32 v87, v55
    v_mov_b32 v119, v10
    v_exp_f32 v92, v60
    v_mov_b32 v124, v10
    v_exp_f32 v93, v61
    v_mov_b32 v125, v10
    v_exp_f32 v94, v62
    v_mov_b32 v126, v10
    v_exp_f32 v95, v63
    v_mov_b32 v127, v10
    v_add_f32 v6, v68, v69
    v_add_f32 v6, v6, v70
    v_add_f32 v6, v6, v71
    v_add_f32 v6, v6, v76
    v_add_f32 v6, v6, v77
    v_add_f32 v6, v6, v78
    v_add_f32 v6, v6, v79
    v_add_f32 v6, v6, v84
    v_add_f32 v6, v6, v85
    v_add_f32 v6, v6, v86
    v_add_f32 v6, v6, v87
    v_add_f32 v6, v6, v92
    v_add_f32 v6, v6, v93
    v_add_f32 v6, v6, v94
    v_add_f32 v6, v6, v95
    s_waitcnt lgkmcnt(0)
    s_cmp_lg_u32 s46, 0
    s_mov_b32 s46, 0
    s_cbranch_scc1 L_ret
    v_exp_f32 v11, -v11
    s_nop 0
    v_mul_f32 v7, v7, v11
    v_mul_f32 v128, v128, v11
    v_mul_f32 v129, v129, v11
    v_mul_f32 v130, v130, v11
    v_mul_f32 v131, v131, v11
    v_mul_f32 v132, v132, v11
    v_mul_f32 v133, v133, v11
    v_mul_f32 v134, v134, v11
    v_mul_f32 v135, v135, v11
    v_mul_f32 v136, v136, v11
    v_mul_f32 v137, v137, v11
    v_mul_f32 v138, v138, v11
    v_mul_f32 v139, v139, v11
    v_mul_f32 v140, v140, v11
    v_mul_f32 v141, v141, v11
    v_mul_f32 v142, v142, v11
    v_mul_f32 v143, v143, v11
    v_mul_f32 v144, v144, v11
    v_mul_f32 v145, v145, v11
    v_mul_f32 v146, v146, v11
    v_mul_f32 v147, v147, v11
    v_mul_f32 v148, v148, v11
    v_mul_f32 v149, v149, v11
    v_mul_f32 v150, v150, v11
    v_mul_f32 v151, v151, v11
    v_mul_f32 v152, v152, v11
    v_mul_f32 v153, v153, v11
    v_mul_f32 v154, v154, v11
    v_mul_f32 v155, v155, v11
    v_mul_f32 v156, v156, v11
    v_mul_f32 v157, v157, v11
    v_mul_f32 v158, v158, v11
    v_mul_f32 v159, v159, v11
    v_mul_f32 v160, v160, v11
    v_mul_f32 v161, v161, v11
    v_mul_f32 v162, v162, v11
    v_mul_f32 v163, v163, v11
    v_mul_f32 v164, v164, v11
    v_mul_f32 v165, v165, v11
    v_mul_f32 v166, v166, v11
    v_mul_f32 v167, v167, v11
    v_mul_f32 v168, v168, v11
    v_mul_f32 v169, v169, v11
    v_mul_f32 v170, v170, v11
    v_mul_f32 v171, v171, v11
    v_mul_f32 v172, v172, v11
    v_mul_f32 v173, v173, v11
    v_mul_f32 v174, v174, v11
    v_mul_f32 v175, v175, v11
    v_mul_f32 v176, v176, v11
    v_mul_f32 v177, v177, v11
    v_mul_f32 v178, v178, v11
    v_mul_f32 v179, v179, v11
    v_mul_f32 v180, v180, v11
    v_mul_f32 v181, v181, v11
    v_mul_f32 v182, v182, v11
    v_mul_f32 v183, v183, v11
    v_mul_f32 v184, v184, v11
    v_mul_f32 v185, v185, v11
    v_mul_f32 v186, v186, v11
    v_mul_f32 v187, v187, v11
    v_mul_f32 v188, v188, v11
    v_mul_f32 v189, v189, v11
    v_mul_f32 v190, v190, v11
    v_mul_f32 v191, v191, v11
    v_exp_f32 v12, -v12
    s_nop 0
    v_mul_f32 v8, v8, v12
    v_mul_f32 v192, v192, v12
    v_mul_f32 v193, v193, v12
    v_mul_f32 v194, v194, v12
    v_mul_f32 v195, v195, v12
    v_mul_f32 v196, v196, v12
    v_mul_f32 v197, v197, v12
    v_mul_f32 v198, v198, v12
    v_mul_f32 v199, v199, v12
    v_mul_f32 v200, v200, v12
    v_mul_f32 v201, v201, v12
    v_mul_f32 v202, v202, v12
    v_mul_f32 v203, v203, v12
    v_mul_f32 v204, v204, v12
    v_mul_f32 v205, v205, v12
    v_mul_f32 v206, v206, v12
    v_mul_f32 v207, v207, v12
    v_mul_f32 v208, v208, v12
    v_mul_f32 v209, v209, v12
    v_mul_f32 v210, v210, v12
    v_mul_f32 v211, v211, v12
    v_mul_f32 v212, v212, v12
    v_mul_f32 v213, v213, v12
    v_mul_f32 v214, v214, v12
    v_mul_f32 v215, v215, v12
    v_mul_f32 v216, v216, v12
    v_mul_f32 v217, v217, v12
    v_mul_f32 v218, v218, v12
    v_mul_f32 v219, v219, v12
    v_mul_f32 v220, v220, v12
    v_mul_f32 v221, v221, v12
    v_mul_f32 v222, v222, v12
    v_mul_f32 v223, v223, v12
    v_mul_f32 v224, v224, v12
    v_mul_f32 v225, v225, v12
    v_mul_f32 v226, v226, v12
    v_mul_f32 v227, v227, v12
    v_mul_f32 v228, v228, v12
    v_mul_f32 v229, v229, v12
    v_mul_f32 v230, v230, v12
    v_mul_f32 v231, v231, v12
    v_mul_f32 v232, v232, v12
    v_mul_f32 v233, v233, v12
    v_mul_f32 v234, v234, v12
    v_mul_f32 v235, v235, v12
    v_mul_f32 v236, v236, v12
    v_mul_f32 v237, v237, v12
    v_mul_f32 v238, v238, v12
    v_mul_f32 v239, v239, v12
    v_mul_f32 v240, v240, v12
    v_mul_f32 v241, v241, v12
    v_mul_f32 v242, v242, v12
    v_mul_f32 v243, v243, v12
    v_mul_f32 v244, v244, v12
    v_mul_f32 v245, v245, v12
    v_mul_f32 v246, v246, v12
    v_mul_f32 v247, v247, v12
    v_mul_f32 v248, v248, v12
    v_mul_f32 v249, v249, v12
    v_mul_f32 v250, v250, v12
    v_mul_f32 v251, v251, v12
    v_mul_f32 v252, v252, v12
    v_mul_f32 v253, v253, v12
    v_mul_f32 v254, v254, v12
    v_mul_f32 v255, v255, v12
    s_branch L_ret
.p2align 6
L_loop:
    v_mfma_f32_16x16x32_bf16 v[32:35], a[64:67], a[0:3], v[96:99]
    s_mov_b32 m0, s40
    ds_read_b128 a[96:99], v2 offset:8192
    v_cvt_pk_bf16_f32 v16, v64, v65
    v_mfma_f32_16x16x32_bf16 v[32:35], a[68:71], a[4:7], v[32:35]
    s_waitcnt lgkmcnt(5)
    buffer_load_dwordx4 v1, s[12:15], s42 offen offset:0 sc1 lds
    v_mfma_f32_16x16x32_bf16 v[32:35], a[72:75], a[8:11], v[32:35]
    ds_read_b128 a[100:103], v2 offset:9216
    v_cvt_pk_bf16_f32 v17, v66, v67
    v_mfma_f32_16x16x32_bf16 v[32:35], a[76:79], a[12:15], v[32:35]
    s_waitcnt lgkmcnt(4)
    v_cvt_pk_bf16_f32 v20, v68, v69
    v_cvt_pk_bf16_f32 v21, v70, v71
    v_mfma_f32_16x16x32_bf16 v[32:35], a[80:83], a[16:19], v[32:35]
    ds_read_b128 a[104:107], v2 offset:10240
    v_add_f32 v7, v7, v5
    v_mfma_f32_16x16x32_bf16 v[32:35], a[84:87], a[20:23], v[32:35]
    s_waitcnt lgkmcnt(3)
    v_add_f32 v8, v8, v6
    v_cvt_pk_bf16_f32 v18, v72, v73
    v_mfma_f32_16x16x32_bf16 v[32:35], a[88:91], a[24:27], v[32:35]
    ds_read_b128 a[108:111], v2 offset:11264
    v_cvt_pk_bf16_f32 v19, v74, v75
    v_mfma_f32_16x16x32_bf16 v[32:35], a[92:95], a[28:31], v[32:35]
    buffer_load_dwordx4 v1, s[12:15], s42 offen offset:1024 sc1 lds
    v_mfma_f32_16x16x32_bf16 v[36:39], a[64:67], a[32:35], v[100:103]
    ds_read_b128 a[112:115], v2 offset:12288
    v_cvt_pk_bf16_f32 v22, v76, v77
    v_mfma_f32_16x16x32_bf16 v[36:39], a[68:71], a[36:39], v[36:39]
    v_cvt_pk_bf16_f32 v23, v78, v79
    v_cvt_pk_bf16_f32 v24, v80, v81
    v_mfma_f32_16x16x32_bf16 v[36:39], a[72:75], a[40:43], v[36:39]
    ds_read_b128 a[116:119], v2 offset:13312
    v_cvt_pk_bf16_f32 v25, v82, v83
    v_mfma_f32_16x16x32_bf16 v[36:39], a[76:79], a[44:47], v[36:39]
    v_cvt_pk_bf16_f32 v28, v84, v85
    v_cvt_pk_bf16_f32 v29, v86, v87
    v_mfma_f32_16x16x32_bf16 v[36:39], a[80:83], a[48:51], v[36:39]
    ds_read_b128 a[120:123], v2 offset:14336
    v_cvt_pk_bf16_f32 v26, v88, v89
    v_mfma_f32_16x16x32_bf16 v[36:39], a[84:87], a[52:55], v[36:39]
    buffer_load_dwordx4 v1, s[12:15], s42 offen offset:2048 sc1 lds
    v_mfma_f32_16x16x32_bf16 v[36:39], a[88:91], a[56:59], v[36:39]
    ds_read_b128 a[124:127], v2 offset:15360
    v_cvt_pk_bf16_f32 v27, v90, v91
    v_mfma_f32_16x16x32_bf16 v[36:39], a[92:95], a[60:63], v[36:39]
    s_waitcnt lgkmcnt(6)
    v_exp_f32 v64, v32
    v_mfma_f32_16x16x32_bf16 v[40:43], a[96:99], a[0:3], v[104:107]
    ds_read_b128 a[64:67], v2 offset:16384
    v_cvt_pk_bf16_f32 v30, v92, v93
    v_mfma_f32_16x16x32_bf16 v[40:43], a[100:103], a[4:7], v[40:43]
    s_waitcnt lgkmcnt(5)
    v_exp_f32 v65, v33
    v_mfma_f32_16x16x32_bf16 v[40:43], a[104:107], a[8:11], v[40:43]
    ds_read_b128 a[68:71], v2 offset:17408
    v_cvt_pk_bf16_f32 v31, v94, v95
    v_mfma_f32_16x16x32_bf16 v[40:43], a[108:111], a[12:15], v[40:43]
    s_waitcnt lgkmcnt(4)
    buffer_load_dwordx4 v1, s[12:15], s42 offen offset:3072 sc1 lds
    v_mfma_f32_16x16x32_bf16 v[40:43], a[112:115], a[16:19], v[40:43]
    ds_read_b128 a[72:75], v2 offset:18432
    v_add_f32 v5, v64, v65
    v_mfma_f32_16x16x32_bf16 v[40:43], a[116:119], a[20:23], v[40:43]
    s_waitcnt lgkmcnt(3)
    v_exp_f32 v66, v34
    v_mfma_f32_16x16x32_bf16 v[40:43], a[120:123], a[24:27], v[40:43]
    ds_read_b128 a[76:79], v2 offset:19456
    v_add_f32 v5, v5, v66
    v_mfma_f32_16x16x32_bf16 v[40:43], a[124:127], a[28:31], v[40:43]
    v_exp_f32 v67, v35
    v_mfma_f32_16x16x32_bf16 v[44:47], a[96:99], a[32:35], v[108:111]
    s_bitset1_b32 m0, 12
    ds_read_b128 a[80:83], v2 offset:20480
    v_add_f32 v5, v5, v67
    v_mfma_f32_16x16x32_bf16 v[44:47], a[100:103], a[36:39], v[44:47]
    buffer_load_dwordx4 v4, s[12:15], s42 offen offset:0 sc1 lds
    v_mfma_f32_16x16x32_bf16 v[44:47], a[104:107], a[40:43], v[44:47]
    ds_read_b128 a[84:87], v2 offset:21504
    v_mfma_f32_16x16x32_bf16 v[44:47], a[108:111], a[44:47], v[44:47]
    v_exp_f32 v68, v36
    v_mfma_f32_16x16x32_bf16 v[44:47], a[112:115], a[48:51], v[44:47]
    ds_read_b128 a[88:91], v2 offset:22528
    v_mfma_f32_16x16x32_bf16 v[44:47], a[116:119], a[52:55], v[44:47]
    v_exp_f32 v69, v37
    v_mfma_f32_16x16x32_bf16 v[44:47], a[120:123], a[56:59], v[44:47]
    ds_read_b128 a[92:95], v2 offset:23552
    v_add_f32 v6, v68, v69
    v_mfma_f32_16x16x32_bf16 v[44:47], a[124:127], a[60:63], v[44:47]
    s_waitcnt lgkmcnt(6)
    buffer_load_dwordx4 v4, s[12:15], s42 offen offset:1024 sc1 lds
    v_mfma_f32_16x16x32_bf16 v[48:51], a[64:67], a[0:3], v[112:115]
    ds_read_b128 a[96:99], v2 offset:24576
    v_mfma_f32_16x16x32_bf16 v[48:51], a[68:71], a[4:7], v[48:51]
    s_waitcnt lgkmcnt(5)
    v_exp_f32 v70, v38
    v_mfma_f32_16x16x32_bf16 v[48:51], a[72:75], a[8:11], v[48:51]
    ds_read_b128 a[100:103], v2 offset:25600
    v_add_f32 v6, v6, v70
    v_mfma_f32_16x16x32_bf16 v[48:51], a[76:79], a[12:15], v[48:51]
    s_waitcnt lgkmcnt(4)
    v_exp_f32 v71, v39
    v_mfma_f32_16x16x32_bf16 v[48:51], a[80:83], a[16:19], v[48:51]
    ds_read_b128 a[104:107], v2 offset:26624
    v_add_f32 v6, v6, v71
    v_mfma_f32_16x16x32_bf16 v[48:51], a[84:87], a[20:23], v[48:51]
    s_waitcnt lgkmcnt(3)
    buffer_load_dwordx4 v4, s[12:15], s42 offen offset:2048 sc1 lds
    v_mfma_f32_16x16x32_bf16 v[48:51], a[88:91], a[24:27], v[48:51]
    ds_read_b128 a[108:111], v2 offset:27648
    v_mfma_f32_16x16x32_bf16 v[48:51], a[92:95], a[28:31], v[48:51]
    v_exp_f32 v72, v40
    v_mfma_f32_16x16x32_bf16 v[52:55], a[64:67], a[32:35], v[116:119]
    ds_read_b128 a[112:115], v2 offset:28672
    v_add_f32 v5, v5, v72
    v_mfma_f32_16x16x32_bf16 v[52:55], a[68:71], a[36:39], v[52:55]
    v_exp_f32 v73, v41
    v_mfma_f32_16x16x32_bf16 v[52:55], a[72:75], a[40:43], v[52:55]
    ds_read_b128 a[116:119], v2 offset:29696
    v_add_f32 v5, v5, v73
    v_mfma_f32_16x16x32_bf16 v[52:55], a[76:79], a[44:47], v[52:55]
    buffer_load_dwordx4 v4, s[12:15], s42 offen offset:3072 sc1 lds
    v_mfma_f32_16x16x32_bf16 v[52:55], a[80:83], a[48:51], v[52:55]
    s_add_u32 s42, s42, 0x8000
    ds_read_b128 a[120:123], v2 offset:30720
    v_mfma_f32_16x16x32_bf16 v[52:55], a[84:87], a[52:55], v[52:55]
    s_xor_b32 s40, s40, 0x8000
    v_exp_f32 v74, v42
    v_mfma_f32_16x16x32_bf16 v[52:55], a[88:91], a[56:59], v[52:55]
    s_waitcnt vmcnt(8)
    ds_read_b128 a[124:127], v2 offset:31744
    v_add_f32 v5, v5, v74
    v_mfma_f32_16x16x32_bf16 v[52:55], a[92:95], a[60:63], v[52:55]
    s_waitcnt lgkmcnt(6)
    s_barrier
    v_mfma_f32_16x16x32_bf16 v[56:59], a[96:99], a[0:3], v[120:123]
    s_mov_b32 m0, s41
    ds_read_b128 a[64:67], v3 offset:0
    v_xor_b32 v2, 0x8000, v2
    v_mfma_f32_16x16x32_bf16 v[56:59], a[100:103], a[4:7], v[56:59]
    s_waitcnt lgkmcnt(5)
    buffer_load_dwordx4 v1, s[12:15], s43 offen offset:0 sc1 lds
    v_mfma_f32_16x16x32_bf16 v[56:59], a[104:107], a[8:11], v[56:59]
    ds_read_b128 a[68:71], v3 offset:16384
    v_mfma_f32_16x16x32_bf16 v[56:59], a[108:111], a[12:15], v[56:59]
    s_waitcnt lgkmcnt(4)
    v_exp_f32 v75, v43
    v_mfma_f32_16x16x32_bf16 v[56:59], a[112:115], a[16:19], v[56:59]
    ds_read_b128 a[72:75], v3 offset:1024
    v_add_f32 v5, v5, v75
    v_mfma_f32_16x16x32_bf16 v[56:59], a[116:119], a[20:23], v[56:59]
    s_waitcnt lgkmcnt(3)
    v_exp_f32 v76, v44
    v_mfma_f32_16x16x32_bf16 v[56:59], a[120:123], a[24:27], v[56:59]
    ds_read_b128 a[76:79], v3 offset:17408
    v_add_f32 v6, v6, v76
    v_mfma_f32_16x16x32_bf16 v[56:59], a[124:127], a[28:31], v[56:59]
    buffer_load_dwordx4 v1, s[12:15], s43 offen offset:1024 sc1 lds
    v_mfma_f32_16x16x32_bf16 v[60:63], a[96:99], a[32:35], v[124:127]
    ds_read_b128 a[80:83], v3 offset:2048
    v_mfma_f32_16x16x32_bf16 v[60:63], a[100:103], a[36:39], v[60:63]
    v_exp_f32 v77, v45
    v_mfma_f32_16x16x32_bf16 v[60:63], a[104:107], a[40:43], v[60:63]
    ds_read_b128 a[84:87], v3 offset:18432
    v_add_f32 v6, v6, v77
    v_mfma_f32_16x16x32_bf16 v[60:63], a[108:111], a[44:47], v[60:63]
    v_exp_f32 v78, v46
    v_mfma_f32_16x16x32_bf16 v[60:63], a[112:115], a[48:51], v[60:63]
    ds_read_b128 a[88:91], v3 offset:3072
    v_add_f32 v6, v6, v78
    v_mfma_f32_16x16x32_bf16 v[60:63], a[116:119], a[52:55], v[60:63]
    buffer_load_dwordx4 v1, s[12:15], s43 offen offset:2048 sc1 lds
    v_mfma_f32_16x16x32_bf16 v[60:63], a[120:123], a[56:59], v[60:63]
    ds_read_b128 a[92:95], v3 offset:19456
    v_mfma_f32_16x16x32_bf16 v[60:63], a[124:127], a[60:63], v[60:63]
    s_waitcnt lgkmcnt(6)
    v_exp_f32 v79, v47
    v_mfma_f32_16x16x32_bf16 v[128:131], a[64:67], v[16:19], v[128:131]
    ds_read_b128 a[96:99], v3 offset:4096
    v_add_f32 v6, v6, v79
    v_mfma_f32_16x16x32_bf16 v[128:131], a[68:71], v[24:27], v[128:131]
    v_exp_f32 v80, v48
    v_mfma_f32_16x16x32_bf16 v[192:195], a[68:71], v[28:31], v[192:195]
    ds_read_b128 a[100:103], v3 offset:20480
    v_add_f32 v5, v5, v80
    v_mfma_f32_16x16x32_bf16 v[192:195], a[64:67], v[20:23], v[192:195]
    s_waitcnt lgkmcnt(6)
    buffer_load_dwordx4 v1, s[12:15], s43 offen offset:3072 sc1 lds
    v_mfma_f32_16x16x32_bf16 v[132:135], a[72:75], v[16:19], v[132:135]
    ds_read_b128 a[104:107], v3 offset:5120
    v_mfma_f32_16x16x32_bf16 v[132:135], a[76:79], v[24:27], v[132:135]
    v_exp_f32 v81, v49
    v_mfma_f32_16x16x32_bf16 v[196:199], a[76:79], v[28:31], v[196:199]
    ds_read_b128 a[108:111], v3 offset:21504
    v_add_f32 v5, v5, v81
    v_mfma_f32_16x16x32_bf16 v[196:199], a[72:75], v[20:23], v[196:199]
    s_waitcnt lgkmcnt(6)
    v_exp_f32 v82, v50
    v_mfma_f32_16x16x32_bf16 v[136:139], a[80:83], v[16:19], v[136:139]
    s_bitset1_b32 m0, 12
    ds_read_b128 a[112:115], v3 offset:6144
    v_add_f32 v5, v5, v82
    v_mfma_f32_16x16x32_bf16 v[136:139], a[84:87], v[24:27], v[136:139]
    buffer_load_dwordx4 v4, s[12:15], s43 offen offset:0 sc1 lds
    v_mfma_f32_16x16x32_bf16 v[200:203], a[84:87], v[28:31], v[200:203]
    ds_read_b128 a[116:119], v3 offset:22528
    v_mfma_f32_16x16x32_bf16 v[200:203], a[80:83], v[20:23], v[200:203]
    s_waitcnt lgkmcnt(6)
    v_exp_f32 v83, v51
    v_mfma_f32_16x16x32_bf16 v[140:143], a[88:91], v[16:19], v[140:143]
    ds_read_b128 a[120:123], v3 offset:7168
    v_add_f32 v5, v5, v83
    v_mfma_f32_16x16x32_bf16 v[140:143], a[92:95], v[24:27], v[140:143]
    v_exp_f32 v84, v52
    v_mfma_f32_16x16x32_bf16 v[204:207], a[92:95], v[28:31], v[204:207]
    ds_read_b128 a[124:127], v3 offset:23552
    v_add_f32 v6, v6, v84
    v_mfma_f32_16x16x32_bf16 v[204:207], a[88:91], v[20:23], v[204:207]
    s_waitcnt lgkmcnt(6)
    buffer_load_dwordx4 v4, s[12:15], s43 offen offset:1024 sc1 lds
    v_mfma_f32_16x16x32_bf16 v[144:147], a[96:99], v[16:19], v[144:147]
    ds_read_b128 a[64:67], v3 offset:8192
    v_mfma_f32_16x16x32_bf16 v[144:147], a[100:103], v[24:27], v[144:147]
    v_exp_f32 v85, v53
    v_mfma_f32_16x16x32_bf16 v[208:211], a[100:103], v[28:31], v[208:211]
    ds_read_b128 a[68:71], v3 offset:24576
    v_add_f32 v6, v6, v85
    v_mfma_f32_16x16x32_bf16 v[208:211], a[96:99], v[20:23], v[208:211]
    s_waitcnt lgkmcnt(6)
    v_exp_f32 v86, v54
    v_mfma_f32_16x16x32_bf16 v[148:151], a[104:107], v[16:19], v[148:151]
    ds_read_b128 a[72:75], v3 offset:9216
    v_add_f32 v6, v6, v86
    v_mfma_f32_16x16x32_bf16 v[148:151], a[108:111], v[24:27], v[148:151]
    buffer_load_dwordx4 v4, s[12:15], s43 offen offset:2048 sc1 lds
    v_mfma_f32_16x16x32_bf16 v[212:215], a[108:111], v[28:31], v[212:215]
    ds_read_b128 a[76:79], v3 offset:25600
    v_mfma_f32_16x16x32_bf16 v[212:215], a[104:107], v[20:23], v[212:215]
    s_waitcnt lgkmcnt(6)
    v_exp_f32 v87, v55
    v_mfma_f32_16x16x32_bf16 v[152:155], a[112:115], v[16:19], v[152:155]
    ds_read_b128 a[80:83], v3 offset:10240
    v_add_f32 v6, v6, v87
    v_mfma_f32_16x16x32_bf16 v[152:155], a[116:119], v[24:27], v[152:155]
    v_exp_f32 v88, v56
    v_mfma_f32_16x16x32_bf16 v[216:219], a[116:119], v[28:31], v[216:219]
    ds_read_b128 a[84:87], v3 offset:26624
    v_add_f32 v5, v5, v88
    v_mfma_f32_16x16x32_bf16 v[216:219], a[112:115], v[20:23], v[216:219]
    s_waitcnt lgkmcnt(6)
    buffer_load_dwordx4 v4, s[12:15], s43 offen offset:3072 sc1 lds
    v_mfma_f32_16x16x32_bf16 v[156:159], a[120:123], v[16:19], v[156:159]
    s_add_u32 s43, s43, 0x8000
    ds_read_b128 a[88:91], v3 offset:11264
    v_mfma_f32_16x16x32_bf16 v[156:159], a[124:127], v[24:27], v[156:159]
    s_xor_b32 s41, s41, 0x8000
    v_exp_f32 v89, v57
    v_mfma_f32_16x16x32_bf16 v[220:223], a[124:127], v[28:31], v[220:223]
    ds_read_b128 a[92:95], v3 offset:27648
    v_add_f32 v5, v5, v89
    v_mfma_f32_16x16x32_bf16 v[220:223], a[120:123], v[20:23], v[220:223]
    s_waitcnt lgkmcnt(6)
    v_exp_f32 v90, v58
    v_mfma_f32_16x16x32_bf16 v[160:163], a[64:67], v[16:19], v[160:163]
    ds_read_b128 a[96:99], v3 offset:12288
    v_add_f32 v5, v5, v90
    v_mfma_f32_16x16x32_bf16 v[160:163], a[68:71], v[24:27], v[160:163]
    v_exp_f32 v91, v59
    v_mfma_f32_16x16x32_bf16 v[224:227], a[68:71], v[28:31], v[224:227]
    ds_read_b128 a[100:103], v3 offset:28672
    v_add_f32 v5, v5, v91
    v_mfma_f32_16x16x32_bf16 v[224:227], a[64:67], v[20:23], v[224:227]
    s_waitcnt lgkmcnt(6)
    v_exp_f32 v92, v60
    v_mfma_f32_16x16x32_bf16 v[164:167], a[72:75], v[16:19], v[164:167]
    ds_read_b128 a[104:107], v3 offset:13312
    v_add_f32 v6, v6, v92
    v_mfma_f32_16x16x32_bf16 v[164:167], a[76:79], v[24:27], v[164:167]
    v_exp_f32 v93, v61
    v_mfma_f32_16x16x32_bf16 v[228:231], a[76:79], v[28:31], v[228:231]
    ds_read_b128 a[108:111], v3 offset:29696
    v_add_f32 v6, v6, v93
    v_mfma_f32_16x16x32_bf16 v[228:231], a[72:75], v[20:23], v[228:231]
    s_waitcnt lgkmcnt(6)
    v_exp_f32 v94, v62
    v_mfma_f32_16x16x32_bf16 v[168:171], a[80:83], v[16:19], v[168:171]
    ds_read_b128 a[112:115], v3 offset:14336
    v_add_f32 v6, v6, v94
    v_mfma_f32_16x16x32_bf16 v[168:171], a[84:87], v[24:27], v[168:171]
    v_exp_f32 v95, v63
    v_mfma_f32_16x16x32_bf16 v[232:235], a[84:87], v[28:31], v[232:235]
    ds_read_b128 a[116:119], v3 offset:30720
    v_add_f32 v6, v6, v95
    v_mfma_f32_16x16x32_bf16 v[232:235], a[80:83], v[20:23], v[232:235]
    s_waitcnt lgkmcnt(6)
    v_add_f32 v11, v5, v6
    v_mfma_f32_16x16x32_bf16 v[172:175], a[88:91], v[16:19], v[172:175]
    ds_read_b128 a[120:123], v3 offset:15360
    v_cmp_nge_f32 vcc, s47, v11
    v_mfma_f32_16x16x32_bf16 v[172:175], a[92:95], v[24:27], v[172:175]
    buffer_load_dword a246, off, s[12:15], s60 sc1
    v_mfma_f32_16x16x32_bf16 v[236:239], a[92:95], v[28:31], v[236:239]
    s_waitcnt vmcnt(9)
    ds_read_b128 a[124:127], v3 offset:31744
    v_mfma_f32_16x16x32_bf16 v[236:239], a[88:91], v[20:23], v[236:239]
    s_waitcnt lgkmcnt(6)
    s_barrier
    v_mfma_f32_16x16x32_bf16 v[176:179], a[96:99], v[16:19], v[176:179]
    ds_read_b128 a[64:67], v2 offset:0
    v_xor_b32 v3, 0x8000, v3
    v_mfma_f32_16x16x32_bf16 v[176:179], a[100:103], v[24:27], v[176:179]
    v_mfma_f32_16x16x32_bf16 v[240:243], a[100:103], v[28:31], v[240:243]
    ds_read_b128 a[68:71], v2 offset:1024
    v_mfma_f32_16x16x32_bf16 v[240:243], a[96:99], v[20:23], v[240:243]
    s_waitcnt lgkmcnt(6)
    v_mfma_f32_16x16x32_bf16 v[180:183], a[104:107], v[16:19], v[180:183]
    ds_read_b128 a[72:75], v2 offset:2048
    v_mfma_f32_16x16x32_bf16 v[180:183], a[108:111], v[24:27], v[180:183]
    v_mfma_f32_16x16x32_bf16 v[244:247], a[108:111], v[28:31], v[244:247]
    ds_read_b128 a[76:79], v2 offset:3072
    v_mfma_f32_16x16x32_bf16 v[244:247], a[104:107], v[20:23], v[244:247]
    s_waitcnt lgkmcnt(6)
    v_mfma_f32_16x16x32_bf16 v[184:187], a[112:115], v[16:19], v[184:187]
    s_sub_u32 s44, s44, 1
    ds_read_b128 a[80:83], v2 offset:4096
    v_mfma_f32_16x16x32_bf16 v[184:187], a[116:119], v[24:27], v[184:187]
    v_mfma_f32_16x16x32_bf16 v[248:251], a[116:119], v[28:31], v[248:251]
    ds_read_b128 a[84:87], v2 offset:5120
    v_mfma_f32_16x16x32_bf16 v[248:251], a[112:115], v[20:23], v[248:251]
    s_waitcnt lgkmcnt(6)
    v_mfma_f32_16x16x32_bf16 v[188:191], a[120:123], v[16:19], v[188:191]
    ds_read_b128 a[88:91], v2 offset:6144
    v_mfma_f32_16x16x32_bf16 v[188:191], a[124:127], v[24:27], v[188:191]
    v_mfma_f32_16x16x32_bf16 v[252:255], a[124:127], v[28:31], v[252:255]
    ds_read_b128 a[92:95], v2 offset:7168
    v_mfma_f32_16x16x32_bf16 v[252:255], a[120:123], v[20:23], v[252:255]
    s_waitcnt lgkmcnt(6)
    s_cbranch_vccnz L_slow
L_ret:
    s_cmp_gt_u32 s44, s45
    s_cbranch_scc1 L_loop
    s_cmp_eq_u32 s44, 0
    s_cbranch_scc1 L_segend
    s_cmp_eq_u32 s44, 1
    s_cbranch_scc1 L_d1
    v_mov_b32 v11, 0xf149f2ca
    v_cmp_gt_i32 s[16:17], 0, v14
    v_cmp_gt_i32 s[18:19], 1, v14
    v_cmp_gt_i32 s[20:21], 2, v14
    v_cmp_gt_i32 s[22:23], 3, v14
    v_cndmask_b32 v96, v9, v11, s[16:17]
    v_cndmask_b32 v97, v9, v11, s[18:19]
    v_cndmask_b32 v98, v9, v11, s[20:21]
    v_cndmask_b32 v99, v9, v11, s[22:23]
    v_cmp_gt_i32 s[16:17], 16, v14
    v_cmp_gt_i32 s[18:19], 17, v14
    v_cmp_gt_i32 s[20:21], 18, v14
    v_cmp_gt_i32 s[22:23], 19, v14
    v_cndmask_b32 v104, v9, v11, s[16:17]
    v_cndmask_b32 v105, v9, v11, s[18:19]
    v_cndmask_b32 v106, v9, v11, s[20:21]
    v_cndmask_b32 v107, v9, v11, s[22:23]
    v_cmp_gt_i32 s[16:17], 32, v14
    v_cmp_gt_i32 s[18:19], 33, v14
    v_cmp_gt_i32 s[20:21], 34, v14
    v_cmp_gt_i32 s[22:23], 35, v14
    v_cndmask_b32 v112, v9, v11, s[16:17]
    v_cndmask_b32 v113, v9, v11, s[18:19]
    v_cndmask_b32 v114, v9, v11, s[20:21]
    v_cndmask_b32 v115, v9, v11, s[22:23]
    v_cmp_gt_i32 s[16:17], 48, v14
    v_cmp_gt_i32 s[18:19], 49, v14
    v_cmp_gt_i32 s[20:21], 50, v14
    v_cmp_gt_i32 s[22:23], 51, v14
    v_cndmask_b32 v120, v9, v11, s[16:17]
    v_cndmask_b32 v121, v9, v11, s[18:19]
    v_cndmask_b32 v122, v9, v11, s[20:21]
    v_cndmask_b32 v123, v9, v11, s[22:23]
    s_nop 0
    s_branch L_loop
L_d1:
    s_cmp_eq_u32 s54, 0
    s_cselect_b32 s57, s38, 0
    s_cmp_lg_u32 s57, 0
    s_cselect_b32 s42, s49, 0xf0000000
    s_cbranch_scc0 L_d1b
    s_sub_u32 s58, 15, s25
    s_waitcnt vmcnt(0)
    v_accvgpr_read_b32 v12, a246
    v_cmp_ne_u32 vcc, 0, v12
    s_cbranch_vccz L_poll1_ok
    v_and_b32 v11, 0, v0
    v_lshlrev_b32 v11, 2, v11
    s_mov_b32 s32, 0
L_poll1:
    buffer_load_dword v12, v11, s[12:15], s60 offen sc1
    s_waitcnt vmcnt(0)
    v_cmp_ne_u32 vcc, 0, v12
    s_cbranch_vccz L_poll1_ok
    s_sleep 8
    s_add_u32 s32, s32, 1
    s_cmp_lt_u32 s32, 0x80000
    s_cbranch_scc1 L_poll1
L_poll1_ok:
    s_lshl_b32 s55, s58, 16
    s_add_u32 s55, s55, s49
    s_add_u32 s55, s55, 33554432
    s_add_u32 s56, s55, 0x8000
    buffer_load_dwordx4 a[128:131], v1, s[12:15], s55 offen offset:0 sc1
    buffer_load_dwordx4 a[132:135], v1, s[12:15], s55 offen offset:1024 sc1
    buffer_load_dwordx4 a[136:139], v1, s[12:15], s55 offen offset:2048 sc1
    buffer_load_dwordx4 a[140:143], v1, s[12:15], s55 offen offset:3072 sc1
    buffer_load_dwordx4 a[144:147], v4, s[12:15], s55 offen offset:0 sc1
    buffer_load_dwordx4 a[148:151], v4, s[12:15], s55 offen offset:1024 sc1
    buffer_load_dwordx4 a[152:155], v4, s[12:15], s55 offen offset:2048 sc1
    buffer_load_dwordx4 a[156:159], v4, s[12:15], s55 offen offset:3072 sc1
    buffer_load_dwordx4 a[160:163], v1, s[12:15], s56 offen offset:0 sc1
    buffer_load_dwordx4 a[164:167], v1, s[12:15], s56 offen offset:1024 sc1
    buffer_load_dwordx4 a[168:171], v1, s[12:15], s56 offen offset:2048 sc1
    buffer_load_dwordx4 a[172:175], v1, s[12:15], s56 offen offset:3072 sc1
    buffer_load_dwordx4 a[176:179], v4, s[12:15], s56 offen offset:0 sc1
    buffer_load_dwordx4 a[180:183], v4, s[12:15], s56 offen offset:1024 sc1
    buffer_load_dwordx4 a[184:187], v4, s[12:15], s56 offen offset:2048 sc1
    buffer_load_dwordx4 a[188:191], v4, s[12:15], s56 offen offset:3072 sc1
L_d1b:
    v_and_b32 v11, 31, v0
    v_lshlrev_b32 v11, 2, v11
    buffer_load_dword a247, v11, s[12:15], s61 offen sc1
    v_accvgpr_read_b32 v12, a244
    global_load_dword a243, v12, s[100:101]
    v_lshrrev_b32 v12, 3, v0
    s_lshl_b32 s78, s3, 3
    v_add_u32 v13, s78, v12
    v_mul_u32_u24 v13, 896, v13
    v_and_b32 v12, 6, v12
    v_xor_b32 v12, v12, v0
    v_and_b32 v12, 7, v12
    v_lshl_add_u32 v13, v12, 4, v13
    s_mul_i32 s78, s26, 229376
    s_add_u32 s79, s78, 28672
    s_add_u32 s80, s78, 57344
    s_add_u32 s81, s78, 86016
    s_add_u32 s82, s78, 114688
    s_add_u32 s83, s78, 143360
    s_add_u32 s84, s78, 172032
    s_add_u32 s85, s78, 200704
    s_mov_b32 s8, s86
    s_mov_b32 s9, s87
    s_mov_b32 s10, 3670016
    s_mov_b32 s11, 0x20000
    s_add_u32 m0, s29, 131072
    s_nop 0
    buffer_load_dwordx4 v13, s[8:11], s78 offen lds
    v_mov_b32 v11, 0xf149f2ca
    v_cmp_gt_i32 s[16:17], 0, v14
    v_cmp_gt_i32 s[18:19], 1, v14
    v_cmp_gt_i32 s[20:21], 2, v14
    v_cmp_gt_i32 s[22:23], 3, v14
    v_cndmask_b32 v100, v10, v11, s[16:17]
    v_cndmask_b32 v101, v10, v11, s[18:19]
    s_add_u32 m0, s29, 135168
    s_nop 0
    buffer_load_dwordx4 v13, s[8:11], s79 offen lds
    v_cndmask_b32 v102, v10, v11, s[20:21]
    v_cndmask_b32 v103, v10, v11, s[22:23]
    v_cmp_gt_i32 s[16:17], 16, v14
    v_cmp_gt_i32 s[18:19], 17, v14
    v_cmp_gt_i32 s[20:21], 18, v14
    v_cmp_gt_i32 s[22:23], 19, v14
    s_add_u32 m0, s29, 139264
    s_nop 0
    buffer_load_dwordx4 v13, s[8:11], s80 offen lds
    v_cndmask_b32 v108, v10, v11, s[16:17]
    v_cndmask_b32 v109, v10, v11, s[18:19]
    v_cndmask_b32 v110, v10, v11, s[20:21]
    v_cndmask_b32 v111, v10, v11, s[22:23]
    v_cmp_gt_i32 s[16:17], 32, v14
    v_cmp_gt_i32 s[18:19], 33, v14
    s_add_u32 m0, s29, 143360
    s_nop 0
    buffer_load_dwordx4 v13, s[8:11], s81 offen lds
    v_cmp_gt_i32 s[20:21], 34, v14
    v_cmp_gt_i32 s[22:23], 35, v14
    v_cndmask_b32 v116, v10, v11, s[16:17]
    v_cndmask_b32 v117, v10, v11, s[18:19]
    v_cndmask_b32 v118, v10, v11, s[20:21]
    v_cndmask_b32 v119, v10, v11, s[22:23]
    s_add_u32 m0, s29, 147456
    s_nop 0
    buffer_load_dwordx4 v13, s[8:11], s82 offen lds
    v_cmp_gt_i32 s[16:17], 48, v14
    v_cmp_gt_i32 s[18:19], 49, v14
    v_cmp_gt_i32 s[20:21], 50, v14
    v_cmp_gt_i32 s[22:23], 51, v14
    v_cndmask_b32 v124, v10, v11, s[16:17]
    v_cndmask_b32 v125, v10, v11, s[18:19]
    s_add_u32 m0, s29, 151552
    s_nop 0
    buffer_load_dwordx4 v13, s[8:11], s83 offen lds
    v_cndmask_b32 v126, v10, v11, s[20:21]
    v_cndmask_b32 v127, v10, v11, s[22:23]
    v_mov_b32 v96, v11
    v_mov_b32 v97, v11
    v_mov_b32 v98, v11
    v_mov_b32 v99, v11
    s_add_u32 m0, s29, 155648
    s_nop 0
    buffer_load_dwordx4 v13, s[8:11], s84 offen lds
    v_mov_b32 v104, v11
    v_mov_b32 v105, v11
    v_mov_b32 v106, v11
    v_mov_b32 v107, v11
    v_mov_b32 v112, v11
    v_mov_b32 v113, v11
    s_add_u32 m0, s29, 159744
    s_nop 0
    buffer_load_dwordx4 v13, s[8:11], s85 offen lds
    v_mov_b32 v114, v11
    v_mov_b32 v115, v11
    v_mov_b32 v120, v11
    v_mov_b32 v121, v11
    v_mov_b32 v122, v11
    v_mov_b32 v123, v11
    v_add_u32 v13, 128, v13
    v_accvgpr_write_b32 a252, v13
    s_branch L_loop
L_segend:
    s_cmp_eq_u32 s54, 0
    s_cselect_b32 s57, s38, 0
    s_cmp_eq_u32 s57, 0
    s_cbranch_scc1 L_tail
    v_accvgpr_mov_b32 a0, a128
    v_accvgpr_mov_b32 a1, a129
    v_accvgpr_mov_b32 a2, a130
    v_accvgpr_mov_b32 a3, a131
    v_accvgpr_mov_b32 a4, a132
    v_accvgpr_mov_b32 a5, a133
    v_accvgpr_mov_b32 a6, a134
    v_accvgpr_mov_b32 a7, a135
    v_accvgpr_mov_b32 a8, a136
    v_accvgpr_mov_b32 a9, a137
    v_accvgpr_mov_b32 a10, a138
    v_accvgpr_mov_b32 a11, a139
    v_accvgpr_mov_b32 a12, a140
    v_accvgpr_mov_b32 a13, a141
    v_accvgpr_mov_b32 a14, a142
    v_accvgpr_mov_b32 a15, a143
    v_accvgpr_mov_b32 a16, a144
    v_accvgpr_mov_b32 a17, a145
    v_accvgpr_mov_b32 a18, a146
    v_accvgpr_mov_b32 a19, a147
    v_accvgpr_mov_b32 a20, a148
    v_accvgpr_mov_b32 a21, a149
    v_accvgpr_mov_b32 a22, a150
    v_accvgpr_mov_b32 a23, a151
    v_accvgpr_mov_b32 a24, a152
    v_accvgpr_mov_b32 a25, a153
    v_accvgpr_mov_b32 a26, a154
    v_accvgpr_mov_b32 a27, a155
    v_accvgpr_mov_b32 a28, a156
    v_accvgpr_mov_b32 a29, a157
    v_accvgpr_mov_b32 a30, a158
    v_accvgpr_mov_b32 a31, a159
    v_accvgpr_mov_b32 a32, a160
    v_accvgpr_mov_b32 a33, a161
    v_accvgpr_mov_b32 a34, a162
    v_accvgpr_mov_b32 a35, a163
    v_accvgpr_mov_b32 a36, a164
    v_accvgpr_mov_b32 a37, a165
    v_accvgpr_mov_b32 a38, a166
    v_accvgpr_mov_b32 a39, a167
    v_accvgpr_mov_b32 a40, a168
    v_accvgpr_mov_b32 a41, a169
    v_accvgpr_mov_b32 a42, a170
    v_accvgpr_mov_b32 a43, a171
    v_accvgpr_mov_b32 a44, a172
    v_accvgpr_mov_b32 a45, a173
    v_accvgpr_mov_b32 a46, a174
    v_accvgpr_mov_b32 a47, a175
    v_accvgpr_mov_b32 a48, a176
    v_accvgpr_mov_b32 a49, a177
    v_accvgpr_mov_b32 a50, a178
    v_accvgpr_mov_b32 a51, a179
    v_accvgpr_mov_b32 a52, a180
    v_accvgpr_mov_b32 a53, a181
    v_accvgpr_mov_b32 a54, a182
    v_accvgpr_mov_b32 a55, a183
    v_accvgpr_mov_b32 a56, a184
    v_accvgpr_mov_b32 a57, a185
    v_accvgpr_mov_b32 a58, a186
    v_accvgpr_mov_b32 a59, a187
    v_accvgpr_mov_b32 a60, a188
    v_accvgpr_mov_b32 a61, a189
    v_accvgpr_mov_b32 a62, a190
    v_accvgpr_mov_b32 a63, a191
    v_mov_b64 v[96:97], 0
    v_mov_b64 v[98:99], 0
    v_mov_b64 v[100:101], 0
    v_mov_b64 v[102:103], 0
    v_mov_b64 v[104:105], 0
    v_mov_b64 v[106:107], 0
    v_mov_b64 v[108:109], 0
    v_mov_b64 v[110:111], 0
    v_mov_b64 v[112:113], 0
    v_mov_b64 v[114:115], 0
    v_mov_b64 v[116:117], 0
    v_mov_b64 v[118:119], 0
    v_mov_b64 v[120:121], 0
    v_mov_b64 v[122:123], 0
    v_mov_b64 v[124:125], 0
    v_mov_b64 v[126:127], 0
    s_add_u32 s43, s49, 16777216
    s_mov_b32 s44, s38
    s_mov_b32 s45, 0
    s_mov_b32 s47, -1.0
    s_branch L_loop
L_switched:
    v_mov_b32 v18, v7
    v_mov_b32 v19, v8
    s_nop 0
    v_permlane32_swap_b32 v7, v18
    v_permlane32_swap_b32 v8, v19
    s_nop 0
    v_add_f32 v7, v7, v18
    v_add_f32 v8, v8, v19
    s_nop 0
    v_mov_b32 v18, v7
    v_mov_b32 v19, v8
    s_nop 0
    v_permlane16_swap_b32 v7, v18
    v_permlane16_swap_b32 v8, v19
    s_nop 0
    v_add_f32 v7, v7, v18
    v_add_f32 v8, v8, v19
    s_nop 0
    v_rcp_f32 v16, v7
    v_rcp_f32 v17, v8
    s_mov_b32 s47, 0x4b800000
    s_mov_b32 s54, 1
    v_accvgpr_write_b32 a250, v16
    v_cvt_pk_bf16_f32 v128, v128, v129
    v_cvt_pk_bf16_f32 v129, v130, v131
    v_cvt_pk_bf16_f32 v130, v132, v133
    v_cvt_pk_bf16_f32 v131, v134, v135
    v_accvgpr_write_b32 a128, v128
    v_accvgpr_write_b32 a129, v129
    v_accvgpr_write_b32 a130, v130
    v_accvgpr_write_b32 a131, v131
    v_cvt_pk_bf16_f32 v136, v136, v137
    v_cvt_pk_bf16_f32 v137, v138, v139
    v_cvt_pk_bf16_f32 v138, v140, v141
    v_cvt_pk_bf16_f32 v139, v142, v143
    v_accvgpr_write_b32 a132, v136
    v_accvgpr_write_b32 a133, v137
    v_accvgpr_write_b32 a134, v138
    v_accvgpr_write_b32 a135, v139
    v_cvt_pk_bf16_f32 v144, v144, v145
    v_cvt_pk_bf16_f32 v145, v146, v147
    v_cvt_pk_bf16_f32 v146, v148, v149
    v_cvt_pk_bf16_f32 v147, v150, v151
    v_accvgpr_write_b32 a136, v144
    v_accvgpr_write_b32 a137, v145
    v_accvgpr_write_b32 a138, v146
    v_accvgpr_write_b32 a139, v147
    v_cvt_pk_bf16_f32 v152, v152, v153
    v_cvt_pk_bf16_f32 v153, v154, v155
    v_cvt_pk_bf16_f32 v154, v156, v157
    v_cvt_pk_bf16_f32 v155, v158, v159
    v_accvgpr_write_b32 a140, v152
    v_accvgpr_write_b32 a141, v153
    v_accvgpr_write_b32 a142, v154
    v_accvgpr_write_b32 a143, v155
    v_cvt_pk_bf16_f32 v160, v160, v161
    v_cvt_pk_bf16_f32 v161, v162, v163
    v_cvt_pk_bf16_f32 v162, v164, v165
    v_cvt_pk_bf16_f32 v163, v166, v167
    v_accvgpr_write_b32 a144, v160
    v_accvgpr_write_b32 a145, v161
    v_accvgpr_write_b32 a146, v162
    v_accvgpr_write_b32 a147, v163
    v_cvt_pk_bf16_f32 v168, v168, v169
    v_cvt_pk_bf16_f32 v169, v170, v171
    v_cvt_pk_bf16_f32 v170, v172, v173
    v_cvt_pk_bf16_f32 v171, v174, v175
    v_accvgpr_write_b32 a148, v168
    v_accvgpr_write_b32 a149, v169
    v_accvgpr_write_b32 a150, v170
    v_accvgpr_write_b32 a151, v171
    v_cvt_pk_bf16_f32 v176, v176, v177
    v_cvt_pk_bf16_f32 v177, v178, v179
    v_cvt_pk_bf16_f32 v178, v180, v181
    v_cvt_pk_bf16_f32 v179, v182, v183
    v_accvgpr_write_b32 a152, v176
    v_accvgpr_write_b32 a153, v177
    v_accvgpr_write_b32 a154, v178
    v_accvgpr_write_b32 a155, v179
    v_cvt_pk_bf16_f32 v184, v184, v185
    v_cvt_pk_bf16_f32 v185, v186, v187
    v_cvt_pk_bf16_f32 v186, v188, v189
    v_cvt_pk_bf16_f32 v187, v190, v191
    v_accvgpr_write_b32 a156, v184
    v_accvgpr_write_b32 a157, v185
    v_accvgpr_write_b32 a158, v186
    v_accvgpr_write_b32 a159, v187
    v_accvgpr_write_b32 a251, v17
    v_cvt_pk_bf16_f32 v192, v192, v193
    v_cvt_pk_bf16_f32 v193, v194, v195
    v_cvt_pk_bf16_f32 v194, v196, v197
    v_cvt_pk_bf16_f32 v195, v198, v199
    v_accvgpr_write_b32 a160, v192
    v_accvgpr_write_b32 a161, v193
    v_accvgpr_write_b32 a162, v194
    v_accvgpr_write_b32 a163, v195
    v_cvt_pk_bf16_f32 v200, v200, v201
    v_cvt_pk_bf16_f32 v201, v202, v203
    v_cvt_pk_bf16_f32 v202, v204, v205
    v_cvt_pk_bf16_f32 v203, v206, v207
    v_accvgpr_write_b32 a164, v200
    v_accvgpr_write_b32 a165, v201
    v_accvgpr_write_b32 a166, v202
    v_accvgpr_write_b32 a167, v203
    v_cvt_pk_bf16_f32 v208, v208, v209
    v_cvt_pk_bf16_f32 v209, v210, v211
    v_cvt_pk_bf16_f32 v210, v212, v213
    v_cvt_pk_bf16_f32 v211, v214, v215
    v_accvgpr_write_b32 a168, v208
    v_accvgpr_write_b32 a169, v209
    v_accvgpr_write_b32 a170, v210
    v_accvgpr_write_b32 a171, v211
    v_cvt_pk_bf16_f32 v216, v216, v217
    v_cvt_pk_bf16_f32 v217, v218, v219
    v_cvt_pk_bf16_f32 v218, v220, v221
    v_cvt_pk_bf16_f32 v219, v222, v223
    v_accvgpr_write_b32 a172, v216
    v_accvgpr_write_b32 a173, v217
    v_accvgpr_write_b32 a174, v218
    v_accvgpr_write_b32 a175, v219
    v_cvt_pk_bf16_f32 v224, v224, v225
    v_cvt_pk_bf16_f32 v225, v226, v227
    v_cvt_pk_bf16_f32 v226, v228, v229
    v_cvt_pk_bf16_f32 v227, v230, v231
    v_accvgpr_write_b32 a176, v224
    v_accvgpr_write_b32 a177, v225
    v_accvgpr_write_b32 a178, v226
    v_accvgpr_write_b32 a179, v227
    v_cvt_pk_bf16_f32 v232, v232, v233
    v_cvt_pk_bf16_f32 v233, v234, v235
    v_cvt_pk_bf16_f32 v234, v236, v237
    v_cvt_pk_bf16_f32 v235, v238, v239
    v_accvgpr_write_b32 a180, v232
    v_accvgpr_write_b32 a181, v233
    v_accvgpr_write_b32 a182, v234
    v_accvgpr_write_b32 a183, v235
    v_cvt_pk_bf16_f32 v240, v240, v241
    v_cvt_pk_bf16_f32 v241, v242, v243
    v_cvt_pk_bf16_f32 v242, v244, v245
    v_cvt_pk_bf16_f32 v243, v246, v247
    v_accvgpr_write_b32 a184, v240
    v_accvgpr_write_b32 a185, v241
    v_accvgpr_write_b32 a186, v242
    v_accvgpr_write_b32 a187, v243
    v_cvt_pk_bf16_f32 v248, v248, v249
    v_cvt_pk_bf16_f32 v249, v250, v251
    v_cvt_pk_bf16_f32 v250, v252, v253
    v_cvt_pk_bf16_f32 v251, v254, v255
    v_accvgpr_write_b32 a188, v248
    v_accvgpr_write_b32 a189, v249
    v_accvgpr_write_b32 a190, v250
    v_accvgpr_write_b32 a191, v251
    v_mov_b64 v[128:129], 0
    v_mov_b64 v[130:131], 0
    v_mov_b64 v[132:133], 0
    v_mov_b64 v[134:135], 0
    v_mov_b64 v[136:137], 0
    v_mov_b64 v[138:139], 0
    v_mov_b64 v[140:141], 0
    v_mov_b64 v[142:143], 0
    v_mov_b64 v[144:145], 0
    v_mov_b64 v[146:147], 0
    v_mov_b64 v[148:149], 0
    v_mov_b64 v[150:151], 0
    v_mov_b64 v[152:153], 0
    v_mov_b64 v[154:155], 0
    v_mov_b64 v[156:157], 0
    v_mov_b64 v[158:159], 0
    v_mov_b64 v[160:161], 0
    v_mov_b64 v[162:163], 0
    v_mov_b64 v[164:165], 0
    v_mov_b64 v[166:167], 0
    v_mov_b64 v[168:169], 0
    v_mov_b64 v[170:171], 0
    v_mov_b64 v[172:173], 0
    v_mov_b64 v[174:175], 0
    v_mov_b64 v[176:177], 0
    v_mov_b64 v[178:179], 0
    v_mov_b64 v[180:181], 0
    v_mov_b64 v[182:183], 0
    v_mov_b64 v[184:185], 0
    v_mov_b64 v[186:187], 0
    v_mov_b64 v[188:189], 0
    v_mov_b64 v[190:191], 0
    v_mov_b64 v[192:193], 0
    v_mov_b64 v[194:195], 0
    v_mov_b64 v[196:197], 0
    v_mov_b64 v[198:199], 0
    v_mov_b64 v[200:201], 0
    v_mov_b64 v[202:203], 0
    v_mov_b64 v[204:205], 0
    v_mov_b64 v[206:207], 0
    v_mov_b64 v[208:209], 0
    v_mov_b64 v[210:211], 0
    v_mov_b64 v[212:213], 0
    v_mov_b64 v[214:215], 0
    v_mov_b64 v[216:217], 0
    v_mov_b64 v[218:219], 0
    v_mov_b64 v[220:221], 0
    v_mov_b64 v[222:223], 0
    v_mov_b64 v[224:225], 0
    v_mov_b64 v[226:227], 0
    v_mov_b64 v[228:229], 0
    v_mov_b64 v[230:231], 0
    v_mov_b64 v[232:233], 0
    v_mov_b64 v[234:235], 0
    v_mov_b64 v[236:237], 0
    v_mov_b64 v[238:239], 0
    v_mov_b64 v[240:241], 0
    v_mov_b64 v[242:243], 0
    v_mov_b64 v[244:245], 0
    v_mov_b64 v[246:247], 0
    v_mov_b64 v[248:249], 0
    v_mov_b64 v[250:251], 0
    v_mov_b64 v[252:253], 0
    v_mov_b64 v[254:255], 0
    v_mov_b32 v7, 0
    v_mov_b32 v8, 0
    v_mov_b32 v9, 0
    v_mov_b32 v10, 0
    v_and_b32 v11, 31, v0
    v_lshlrev_b32 v11, 2, v11
    buffer_load_dword a247, v11, s[12:15], s61 offen sc1
    s_branch L_first
L_tail:
    s_and_b32 s39, s2, 127
    s_lshl_b32 s57, s39, 2
    s_add_u32 s57, s57, s3
    s_lshl_b32 s55, s57, 14
    s_add_u32 s55, s55, 67108864
    s_lshl_b32 s57, s57, 10
    s_add_u32 s57, s57, 83886080
    v_accvgpr_read_b32 v2, a252
    v_cvt_pk_bf16_f32 v16, v64, v65
    v_cvt_pk_bf16_f32 v17, v66, v67
    v_cvt_pk_bf16_f32 v20, v68, v69
    v_cvt_pk_bf16_f32 v21, v70, v71
    v_cvt_pk_bf16_f32 v18, v72, v73
    v_cvt_pk_bf16_f32 v19, v74, v75
    v_cvt_pk_bf16_f32 v22, v76, v77
    v_cvt_pk_bf16_f32 v23, v78, v79
    v_cvt_pk_bf16_f32 v24, v80, v81
    v_cvt_pk_bf16_f32 v25, v82, v83
    v_cvt_pk_bf16_f32 v28, v84, v85
    v_cvt_pk_bf16_f32 v29, v86, v87
    v_cvt_pk_bf16_f32 v26, v88, v89
    v_cvt_pk_bf16_f32 v27, v90, v91
    v_cvt_pk_bf16_f32 v30, v92, v93
    v_cvt_pk_bf16_f32 v31, v94, v95
    v_add_f32 v7, v7, v5
    v_add_f32 v8, v8, v6
    s_waitcnt vmcnt(0) lgkmcnt(0)
    s_barrier
    ds_read_b128 a[64:67], v3 offset:0
    ds_read_b128 a[68:71], v3 offset:16384
    ds_read_b128 a[72:75], v3 offset:1024
    ds_read_b128 a[76:79], v3 offset:17408
    ds_read_b128 a[80:83], v3 offset:2048
    ds_read_b128 a[84:87], v3 offset:18432
    ds_read_b128 a[88:91], v3 offset:3072
    ds_read_b128 a[92:95], v3 offset:19456
    s_cmp_lg_u32 s38, 0
    s_cselect_b32 s58, s54, 0
    s_cmp_eq_u32 s58, 2
    s_cbranch_scc1 L_tail2
    s_cmp_eq_u32 s62, 0
    s_cbranch_scc1 L_nou
    v_accvgpr_read_b32 v12, a247
    v_cmp_ne_u32 vcc, 0, v12
    s_cbranch_vccz L_poll2_ok
    v_and_b32 v11, 31, v0
    v_lshlrev_b32 v11, 2, v11
    s_mov_b32 s32, 0
L_poll2:
    buffer_load_dword v12, v11, s[12:15], s61 offen sc1
    s_waitcnt vmcnt(0)
    v_cmp_ne_u32 vcc, 0, v12
    s_cbranch_vccz L_poll2_ok
    s_sleep 8
    s_add_u32 s32, s32, 1
    s_cmp_lt_u32 s32, 0x80000
    s_cbranch_scc1 L_poll2
L_poll2_ok:
L_nou:
    s_cmp_eq_u32 s54, 1
    s_cselect_b32 s55, s55, 2.0
    s_cselect_b32 s57, s57, 2.0
    s_cselect_b32 s59, s94, 2.0
    s_add_u32 s56, s55, 0x2000
    s_waitcnt lgkmcnt(0)
    v_mfma_f32_16x16x32_bf16 v[128:131], a[64:67], v[16:19], v[128:131]
    s_add_u32 m0, s29, 0
    ds_read_b128 a[96:99], v3 offset:4096
    v_mov_b32 v72, v7
    v_mfma_f32_16x16x32_bf16 v[128:131], a[68:71], v[24:27], v[128:131]
    buffer_load_dwordx4 v2, s[8:11], s78 offen lds
    v_mfma_f32_16x16x32_bf16 v[192:195], a[68:71], v[28:31], v[192:195]
    ds_read_b128 a[100:103], v3 offset:20480
    v_mov_b32 v73, v8
    v_mfma_f32_16x16x32_bf16 v[192:195], a[64:67], v[20:23], v[192:195]
    v_permlane32_swap_b32 v7, v72
    v_permlane32_swap_b32 v8, v73
    v_mfma_f32_16x16x32_bf16 v[132:135], a[72:75], v[16:19], v[132:135]
    s_add_u32 m0, s29, 4096
    ds_read_b128 a[104:107], v3 offset:5120
    v_mfma_f32_16x16x32_bf16 v[132:135], a[76:79], v[24:27], v[132:135]
    buffer_load_dwordx4 v2, s[8:11], s79 offen lds
    v_mfma_f32_16x16x32_bf16 v[196:199], a[76:79], v[28:31], v[196:199]
    ds_read_b128 a[108:111], v3 offset:21504
    v_add_f32 v7, v7, v72
    v_mfma_f32_16x16x32_bf16 v[196:199], a[72:75], v[20:23], v[196:199]
    v_add_f32 v8, v8, v73
    v_mfma_f32_16x16x32_bf16 v[136:139], a[80:83], v[16:19], v[136:139]
    s_add_u32 m0, s29, 8192
    ds_read_b128 a[112:115], v3 offset:6144
    v_mov_b32 v72, v7
    v_mfma_f32_16x16x32_bf16 v[136:139], a[84:87], v[24:27], v[136:139]
    buffer_load_dwordx4 v2, s[8:11], s80 offen lds
    v_mfma_f32_16x16x32_bf16 v[200:203], a[84:87], v[28:31], v[200:203]
    s_add_u32 m0, s29, 12288
    ds_read_b128 a[116:119], v3 offset:22528
    v_mov_b32 v73, v8
    v_mfma_f32_16x16x32_bf16 v[200:203], a[80:83], v[20:23], v[200:203]
    buffer_load_dwordx4 v2, s[8:11], s81 offen lds
    v_mfma_f32_16x16x32_bf16 v[140:143], a[88:91], v[16:19], v[140:143]
    s_add_u32 m0, s29, 16384
    ds_read_b128 a[120:123], v3 offset:7168
    v_mfma_f32_16x16x32_bf16 v[140:143], a[92:95], v[24:27], v[140:143]
    buffer_load_dwordx4 v2, s[8:11], s82 offen lds
    v_mfma_f32_16x16x32_bf16 v[204:207], a[92:95], v[28:31], v[204:207]
    ds_read_b128 a[124:127], v3 offset:23552
    v_permlane16_swap_b32 v7, v72
    v_mfma_f32_16x16x32_bf16 v[204:207], a[88:91], v[20:23], v[204:207]
    s_waitcnt lgkmcnt(6)
    v_permlane16_swap_b32 v8, v73
    v_cvt_pk_bf16_f32 v128, v128, v129
    v_mfma_f32_16x16x32_bf16 v[144:147], a[96:99], v[16:19], v[144:147]
    s_add_u32 m0, s29, 20480
    ds_read_b128 a[64:67], v3 offset:8192
    v_cvt_pk_bf16_f32 v129, v130, v131
    v_mfma_f32_16x16x32_bf16 v[144:147], a[100:103], v[24:27], v[144:147]
    buffer_load_dwordx4 v2, s[8:11], s83 offen lds
    v_mfma_f32_16x16x32_bf16 v[208:211], a[100:103], v[28:31], v[208:211]
    s_add_u32 m0, s29, 24576
    ds_read_b128 a[68:71], v3 offset:24576
    v_add_f32 v7, v7, v72
    v_mfma_f32_16x16x32_bf16 v[208:211], a[96:99], v[20:23], v[208:211]
    s_waitcnt lgkmcnt(6)
    buffer_load_dwordx4 v2, s[8:11], s84 offen lds
    v_mfma_f32_16x16x32_bf16 v[148:151], a[104:107], v[16:19], v[148:151]
    s_add_u32 m0, s29, 28672
    ds_read_b128 a[72:75], v3 offset:9216
    v_add_f32 v8, v8, v73
    v_mfma_f32_16x16x32_bf16 v[148:151], a[108:111], v[24:27], v[148:151]
    buffer_load_dwordx4 v2, s[8:11], s85 offen lds
    v_mfma_f32_16x16x32_bf16 v[212:215], a[108:111], v[28:31], v[212:215]
    ds_read_b128 a[76:79], v3 offset:25600
    v_add_u32 v2, 128, v2
    v_mfma_f32_16x16x32_bf16 v[212:215], a[104:107], v[20:23], v[212:215]
    s_waitcnt lgkmcnt(6)
    v_cvt_pk_bf16_f32 v130, v132, v133
    v_cvt_pk_bf16_f32 v131, v134, v135
    v_mfma_f32_16x16x32_bf16 v[152:155], a[112:115], v[16:19], v[152:155]
    ds_read_b128 a[80:83], v3 offset:10240
    v_cvt_pk_bf16_f32 v192, v192, v193
    v_mfma_f32_16x16x32_bf16 v[152:155], a[116:119], v[24:27], v[152:155]
    buffer_store_dwordx4 v[128:131], v1, s[12:15], s55 offen offset:0 sc1
    v_mfma_f32_16x16x32_bf16 v[216:219], a[116:119], v[28:31], v[216:219]
    ds_read_b128 a[84:87], v3 offset:26624
    v_cvt_pk_bf16_f32 v193, v194, v195
    v_mfma_f32_16x16x32_bf16 v[216:219], a[112:115], v[20:23], v[216:219]
    s_waitcnt lgkmcnt(6)
    v_cvt_pk_bf16_f32 v194, v196, v197
    v_cvt_pk_bf16_f32 v195, v198, v199
    v_mfma_f32_16x16x32_bf16 v[156:159], a[120:123], v[16:19], v[156:159]
    ds_read_b128 a[88:91], v3 offset:11264
    v_cvt_pk_bf16_f32 v136, v136, v137
    v_mfma_f32_16x16x32_bf16 v[156:159], a[124:127], v[24:27], v[156:159]
    buffer_store_dwordx4 v[192:195], v1, s[12:15], s56 offen offset:0 sc1
    v_mfma_f32_16x16x32_bf16 v[220:223], a[124:127], v[28:31], v[220:223]
    ds_read_b128 a[92:95], v3 offset:27648
    v_cvt_pk_bf16_f32 v137, v138, v139
    v_mfma_f32_16x16x32_bf16 v[220:223], a[120:123], v[20:23], v[220:223]
    s_waitcnt lgkmcnt(6)
    v_cvt_pk_bf16_f32 v138, v140, v141
    v_cvt_pk_bf16_f32 v139, v142, v143
    v_mfma_f32_16x16x32_bf16 v[160:163], a[64:67], v[16:19], v[160:163]
    ds_read_b128 a[96:99], v3 offset:12288
    v_cvt_pk_bf16_f32 v200, v200, v201
    v_mfma_f32_16x16x32_bf16 v[160:163], a[68:71], v[24:27], v[160:163]
    buffer_store_dwordx4 v[136:139], v1, s[12:15], s55 offen offset:1024 sc1
    v_mfma_f32_16x16x32_bf16 v[224:227], a[68:71], v[28:31], v[224:227]
    ds_read_b128 a[100:103], v3 offset:28672
    v_cvt_pk_bf16_f32 v201, v202, v203
    v_mfma_f32_16x16x32_bf16 v[224:227], a[64:67], v[20:23], v[224:227]
    s_waitcnt lgkmcnt(6)
    v_cvt_pk_bf16_f32 v202, v204, v205
    v_cvt_pk_bf16_f32 v203, v206, v207
    v_mfma_f32_16x16x32_bf16 v[164:167], a[72:75], v[16:19], v[164:167]
    ds_read_b128 a[104:107], v3 offset:13312
    v_cvt_pk_bf16_f32 v144, v144, v145
    v_mfma_f32_16x16x32_bf16 v[164:167], a[76:79], v[24:27], v[164:167]
    buffer_store_dwordx4 v[200:203], v1, s[12:15], s56 offen offset:1024 sc1
    v_mfma_f32_16x16x32_bf16 v[228:231], a[76:79], v[28:31], v[228:231]
    ds_read_b128 a[108:111], v3 offset:29696
    v_cvt_pk_bf16_f32 v145, v146, v147
    v_mfma_f32_16x16x32_bf16 v[228:231], a[72:75], v[20:23], v[228:231]
    s_waitcnt lgkmcnt(6)
    v_cvt_pk_bf16_f32 v146, v148, v149
    v_cvt_pk_bf16_f32 v147, v150, v151
    v_mfma_f32_16x16x32_bf16 v[168:171], a[80:83], v[16:19], v[168:171]
    ds_read_b128 a[112:115], v3 offset:14336
    v_cvt_pk_bf16_f32 v208, v208, v209
    v_mfma_f32_16x16x32_bf16 v[168:171], a[84:87], v[24:27], v[168:171]
    buffer_store_dwordx4 v[144:147], v1, s[12:15], s55 offen offset:2048 sc1
    v_mfma_f32_16x16x32_bf16 v[232:235], a[84:87], v[28:31], v[232:235]
    ds_read_b128 a[116:119], v3 offset:30720
    v_cvt_pk_bf16_f32 v209, v210, v211
    v_mfma_f32_16x16x32_bf16 v[232:235], a[80:83], v[20:23], v[232:235]
    s_waitcnt lgkmcnt(6)
    v_cvt_pk_bf16_f32 v210, v212, v213
    v_cvt_pk_bf16_f32 v211, v214, v215
    v_mfma_f32_16x16x32_bf16 v[172:175], a[88:91], v[16:19], v[172:175]
    ds_read_b128 a[120:123], v3 offset:15360
    v_cvt_pk_bf16_f32 v152, v152, v153
    v_mfma_f32_16x16x32_bf16 v[172:175], a[92:95], v[24:27], v[172:175]
    buffer_store_dwordx4 v[208:211], v1, s[12:15], s56 offen offset:2048 sc1
    v_mfma_f32_16x16x32_bf16 v[236:239], a[92:95], v[28:31], v[236:239]
    ds_read_b128 a[124:127], v3 offset:31744
    v_cvt_pk_bf16_f32 v153, v154, v155
    v_mfma_f32_16x16x32_bf16 v[236:239], a[88:91], v[20:23], v[236:239]
    s_waitcnt lgkmcnt(6)
    v_cvt_pk_bf16_f32 v154, v156, v157
    v_cvt_pk_bf16_f32 v155, v158, v159
    v_mfma_f32_16x16x32_bf16 v[176:179], a[96:99], v[16:19], v[176:179]
    v_cvt_pk_bf16_f32 v216, v216, v217
    v_cvt_pk_bf16_f32 v217, v218, v219
    v_mfma_f32_16x16x32_bf16 v[176:179], a[100:103], v[24:27], v[176:179]
    buffer_store_dwordx4 v[152:155], v1, s[12:15], s55 offen offset:3072 sc1
    v_mfma_f32_16x16x32_bf16 v[240:243], a[100:103], v[28:31], v[240:243]
    v_cvt_pk_bf16_f32 v218, v220, v221
    v_cvt_pk_bf16_f32 v219, v222, v223
    v_mfma_f32_16x16x32_bf16 v[240:243], a[96:99], v[20:23], v[240:243]
    s_waitcnt lgkmcnt(4)
    v_cvt_pk_bf16_f32 v160, v160, v161
    v_cvt_pk_bf16_f32 v161, v162, v163
    v_mfma_f32_16x16x32_bf16 v[180:183], a[104:107], v[16:19], v[180:183]
    v_cvt_pk_bf16_f32 v162, v164, v165
    v_cvt_pk_bf16_f32 v163, v166, v167
    v_mfma_f32_16x16x32_bf16 v[180:183], a[108:111], v[24:27], v[180:183]
    buffer_store_dwordx4 v[216:219], v1, s[12:15], s56 offen offset:3072 sc1
    v_mfma_f32_16x16x32_bf16 v[244:247], a[108:111], v[28:31], v[244:247]
    v_cvt_pk_bf16_f32 v224, v224, v225
    v_cvt_pk_bf16_f32 v225, v226, v227
    v_mfma_f32_16x16x32_bf16 v[244:247], a[104:107], v[20:23], v[244:247]
    s_waitcnt lgkmcnt(2)
    v_cvt_pk_bf16_f32 v226, v228, v229
    v_cvt_pk_bf16_f32 v227, v230, v231
    v_mfma_f32_16x16x32_bf16 v[184:187], a[112:115], v[16:19], v[184:187]
    v_cvt_pk_bf16_f32 v168, v168, v169
    v_cvt_pk_bf16_f32 v169, v170, v171
    v_mfma_f32_16x16x32_bf16 v[184:187], a[116:119], v[24:27], v[184:187]
    buffer_store_dwordx4 v[160:163], v4, s[12:15], s55 offen offset:0 sc1
    v_mfma_f32_16x16x32_bf16 v[248:251], a[116:119], v[28:31], v[248:251]
    v_cvt_pk_bf16_f32 v170, v172, v173
    v_cvt_pk_bf16_f32 v171, v174, v175
    v_mfma_f32_16x16x32_bf16 v[248:251], a[112:115], v[20:23], v[248:251]
    s_waitcnt lgkmcnt(0)
    v_cvt_pk_bf16_f32 v232, v232, v233
    v_cvt_pk_bf16_f32 v233, v234, v235
    v_mfma_f32_16x16x32_bf16 v[188:191], a[120:123], v[16:19], v[188:191]
    v_cvt_pk_bf16_f32 v234, v236, v237
    v_cvt_pk_bf16_f32 v235, v238, v239
    v_mfma_f32_16x16x32_bf16 v[188:191], a[124:127], v[24:27], v[188:191]
    buffer_store_dwordx4 v[224:227], v4, s[12:15], s56 offen offset:0 sc1
    v_mfma_f32_16x16x32_bf16 v[252:255], a[124:127], v[28:31], v[252:255]
    v_mfma_f32_16x16x32_bf16 v[252:255], a[120:123], v[20:23], v[252:255]
    v_mov_b32 v68, v7
    v_mov_b32 v69, v8
    v_mov_b32 v70, v9
    v_mov_b32 v71, v10
    v_rcp_f32 v64, v7
    v_rcp_f32 v65, v8
    v_cvt_pk_bf16_f32 v176, v176, v177
    v_cvt_pk_bf16_f32 v177, v178, v179
    v_cvt_pk_bf16_f32 v178, v180, v181
    v_cvt_pk_bf16_f32 v179, v182, v183
    v_cvt_pk_bf16_f32 v240, v240, v241
    v_cvt_pk_bf16_f32 v241, v242, v243
    v_cvt_pk_bf16_f32 v242, v244, v245
    v_cvt_pk_bf16_f32 v243, v246, v247
    v_cvt_pk_bf16_f32 v184, v184, v185
    v_cvt_pk_bf16_f32 v185, v186, v187
    v_cvt_pk_bf16_f32 v186, v188, v189
    v_cvt_pk_bf16_f32 v187, v190, v191
    v_cvt_pk_bf16_f32 v248, v248, v249
    v_cvt_pk_bf16_f32 v249, v250, v251
    v_cvt_pk_bf16_f32 v250, v252, v253
    v_cvt_pk_bf16_f32 v251, v254, v255
    s_waitcnt vmcnt(10)
    s_cmp_lg_u32 s27, 0
    s_cbranch_scc1 L_attdone
    v_mov_b32 v3, v4
    s_cmp_eq_u32 s54, 1
    s_cbranch_scc0 L_t1park
    v_accvgpr_read_b32 v64, a250
    v_accvgpr_read_b32 v65, a251
    s_branch L_opB
L_t1park:
    v_accvgpr_write_b32 a128, v128
    v_accvgpr_write_b32 a129, v129
    v_accvgpr_write_b32 a130, v130
    v_accvgpr_write_b32 a131, v131
    v_accvgpr_write_b32 a160, v192
    v_accvgpr_write_b32 a161, v193
    v_accvgpr_write_b32 a162, v194
    v_accvgpr_write_b32 a163, v195
    v_accvgpr_write_b32 a132, v136
    v_accvgpr_write_b32 a133, v137
    v_accvgpr_write_b32 a134, v138
    v_accvgpr_write_b32 a135, v139
    v_accvgpr_write_b32 a164, v200
    v_accvgpr_write_b32 a165, v201
    v_accvgpr_write_b32 a166, v202
    v_accvgpr_write_b32 a167, v203
    v_accvgpr_write_b32 a136, v144
    v_accvgpr_write_b32 a137, v145
    v_accvgpr_write_b32 a138, v146
    v_accvgpr_write_b32 a139, v147
    v_accvgpr_write_b32 a168, v208
    v_accvgpr_write_b32 a169, v209
    v_accvgpr_write_b32 a170, v210
    v_accvgpr_write_b32 a171, v211
    v_accvgpr_write_b32 a140, v152
    v_accvgpr_write_b32 a141, v153
    v_accvgpr_write_b32 a142, v154
    v_accvgpr_write_b32 a143, v155
    v_accvgpr_write_b32 a172, v216
    v_accvgpr_write_b32 a173, v217
    v_accvgpr_write_b32 a174, v218
    v_accvgpr_write_b32 a175, v219
    v_accvgpr_write_b32 a144, v160
    v_accvgpr_write_b32 a145, v161
    v_accvgpr_write_b32 a146, v162
    v_accvgpr_write_b32 a147, v163
    v_accvgpr_write_b32 a176, v224
    v_accvgpr_write_b32 a177, v225
    v_accvgpr_write_b32 a178, v226
    v_accvgpr_write_b32 a179, v227
    v_accvgpr_write_b32 a148, v168
    v_accvgpr_write_b32 a149, v169
    v_accvgpr_write_b32 a150, v170
    v_accvgpr_write_b32 a151, v171
    v_accvgpr_write_b32 a180, v232
    v_accvgpr_write_b32 a181, v233
    v_accvgpr_write_b32 a182, v234
    v_accvgpr_write_b32 a183, v235
    v_accvgpr_write_b32 a152, v176
    v_accvgpr_write_b32 a153, v177
    v_accvgpr_write_b32 a154, v178
    v_accvgpr_write_b32 a155, v179
    v_accvgpr_write_b32 a184, v240
    v_accvgpr_write_b32 a185, v241
    v_accvgpr_write_b32 a186, v242
    v_accvgpr_write_b32 a187, v243
    v_accvgpr_write_b32 a156, v184
    v_accvgpr_write_b32 a157, v185
    v_accvgpr_write_b32 a158, v186
    v_accvgpr_write_b32 a159, v187
    v_accvgpr_write_b32 a188, v248
    v_accvgpr_write_b32 a189, v249
    v_accvgpr_write_b32 a190, v250
    v_accvgpr_write_b32 a191, v251
    s_branch L_opB
L_tail2:
    v_accvgpr_read_b32 v11, a246
    s_mov_b32 s52, s55
    s_mov_b32 s53, s57
    v_readfirstlane_b32 s58, v11
    s_mov_b32 s59, 2.0
    s_nop 1
    s_cmp_eq_u32 s58, 0
    s_cselect_b32 s55, s55, 2.0
    s_cselect_b32 s57, s57, 2.0
    s_add_u32 s56, s55, 0x2000
    buffer_load_dwordx4 v[68:71], v1, s[12:15], s57 offen sc1
    s_waitcnt lgkmcnt(0)
    v_mfma_f32_16x16x32_bf16 v[128:131], a[64:67], v[16:19], v[128:131]
    ds_read_b128 a[96:99], v3 offset:4096
    v_mfma_f32_16x16x32_bf16 v[128:131], a[68:71], v[24:27], v[128:131]
    buffer_load_dwordx4 v[32:35], v1, s[12:15], s55 offen offset:0 sc1
    v_mfma_f32_16x16x32_bf16 v[192:195], a[68:71], v[28:31], v[192:195]
    ds_read_b128 a[100:103], v3 offset:20480
    v_mfma_f32_16x16x32_bf16 v[192:195], a[64:67], v[20:23], v[192:195]
    v_mov_b32 v72, v7
    v_mov_b32 v73, v8
    v_mfma_f32_16x16x32_bf16 v[132:135], a[72:75], v[16:19], v[132:135]
    ds_read_b128 a[104:107], v3 offset:5120
    v_mfma_f32_16x16x32_bf16 v[132:135], a[76:79], v[24:27], v[132:135]
    buffer_load_dwordx4 v[96:99], v1, s[12:15], s56 offen offset:0 sc1
    v_mfma_f32_16x16x32_bf16 v[196:199], a[76:79], v[28:31], v[196:199]
    ds_read_b128 a[108:111], v3 offset:21504
    v_mfma_f32_16x16x32_bf16 v[196:199], a[72:75], v[20:23], v[196:199]
    v_permlane32_swap_b32 v7, v72
    v_permlane32_swap_b32 v8, v73
    v_mfma_f32_16x16x32_bf16 v[136:139], a[80:83], v[16:19], v[136:139]
    ds_read_b128 a[112:115], v3 offset:6144
    v_mfma_f32_16x16x32_bf16 v[136:139], a[84:87], v[24:27], v[136:139]
    buffer_load_dwordx4 v[36:39], v1, s[12:15], s55 offen offset:1024 sc1
    v_mfma_f32_16x16x32_bf16 v[200:203], a[84:87], v[28:31], v[200:203]
    ds_read_b128 a[116:119], v3 offset:22528
    v_mfma_f32_16x16x32_bf16 v[200:203], a[80:83], v[20:23], v[200:203]
    v_add_f32 v7, v7, v72
    v_add_f32 v8, v8, v73
    v_mfma_f32_16x16x32_bf16 v[140:143], a[88:91], v[16:19], v[140:143]
    ds_read_b128 a[120:123], v3 offset:7168
    v_mfma_f32_16x16x32_bf16 v[140:143], a[92:95], v[24:27], v[140:143]
    buffer_load_dwordx4 v[100:103], v1, s[12:15], s56 offen offset:1024 sc1
    v_mfma_f32_16x16x32_bf16 v[204:207], a[92:95], v[28:31], v[204:207]
    ds_read_b128 a[124:127], v3 offset:23552
    v_mfma_f32_16x16x32_bf16 v[204:207], a[88:91], v[20:23], v[204:207]
    s_waitcnt lgkmcnt(6)
    v_mov_b32 v72, v7
    v_mov_b32 v73, v8
    v_mfma_f32_16x16x32_bf16 v[144:147], a[96:99], v[16:19], v[144:147]
    ds_read_b128 a[64:67], v3 offset:8192
    v_mfma_f32_16x16x32_bf16 v[144:147], a[100:103], v[24:27], v[144:147]
    buffer_load_dwordx4 v[40:43], v1, s[12:15], s55 offen offset:2048 sc1
    v_mfma_f32_16x16x32_bf16 v[208:211], a[100:103], v[28:31], v[208:211]
    ds_read_b128 a[68:71], v3 offset:24576
    v_mfma_f32_16x16x32_bf16 v[208:211], a[96:99], v[20:23], v[208:211]
    s_waitcnt lgkmcnt(6)
    v_permlane16_swap_b32 v7, v72
    v_permlane16_swap_b32 v8, v73
    v_mfma_f32_16x16x32_bf16 v[148:151], a[104:107], v[16:19], v[148:151]
    ds_read_b128 a[72:75], v3 offset:9216
    v_mfma_f32_16x16x32_bf16 v[148:151], a[108:111], v[24:27], v[148:151]
    buffer_load_dwordx4 v[104:107], v1, s[12:15], s56 offen offset:2048 sc1
    v_mfma_f32_16x16x32_bf16 v[212:215], a[108:111], v[28:31], v[212:215]
    ds_read_b128 a[76:79], v3 offset:25600
    v_mfma_f32_16x16x32_bf16 v[212:215], a[104:107], v[20:23], v[212:215]
    s_waitcnt lgkmcnt(6)
    v_add_f32 v7, v7, v72
    v_add_f32 v8, v8, v73
    v_mfma_f32_16x16x32_bf16 v[152:155], a[112:115], v[16:19], v[152:155]
    ds_read_b128 a[80:83], v3 offset:10240
    v_mfma_f32_16x16x32_bf16 v[152:155], a[116:119], v[24:27], v[152:155]
    buffer_load_dwordx4 v[44:47], v1, s[12:15], s55 offen offset:3072 sc1
    v_mfma_f32_16x16x32_bf16 v[216:219], a[116:119], v[28:31], v[216:219]
    ds_read_b128 a[84:87], v3 offset:26624
    v_mfma_f32_16x16x32_bf16 v[216:219], a[112:115], v[20:23], v[216:219]
    s_waitcnt lgkmcnt(6)
    v_mov_b32 v76, 0
    v_mov_b32 v77, 0
    v_mfma_f32_16x16x32_bf16 v[156:159], a[120:123], v[16:19], v[156:159]
    ds_read_b128 a[88:91], v3 offset:11264
    v_mov_b32 v80, 0
    v_mfma_f32_16x16x32_bf16 v[156:159], a[124:127], v[24:27], v[156:159]
    buffer_load_dwordx4 v[108:111], v1, s[12:15], s56 offen offset:3072 sc1
    v_mfma_f32_16x16x32_bf16 v[220:223], a[124:127], v[28:31], v[220:223]
    ds_read_b128 a[92:95], v3 offset:27648
    v_mov_b32 v81, 0
    v_mfma_f32_16x16x32_bf16 v[220:223], a[120:123], v[20:23], v[220:223]
    s_waitcnt lgkmcnt(6)
    v_and_b32 v82, 1, v0
    v_lshlrev_b32 v82, 4, v82
    v_mfma_f32_16x16x32_bf16 v[160:163], a[64:67], v[16:19], v[160:163]
    ds_read_b128 a[96:99], v3 offset:12288
    v_mov_b32 v83, 0x3f80
    v_mfma_f32_16x16x32_bf16 v[160:163], a[68:71], v[24:27], v[160:163]
    buffer_load_dwordx4 v[48:51], v4, s[12:15], s55 offen offset:0 sc1
    v_mfma_f32_16x16x32_bf16 v[224:227], a[68:71], v[28:31], v[224:227]
    ds_read_b128 a[100:103], v3 offset:28672
    v_lshlrev_b32 v82, v82, v83
    v_mfma_f32_16x16x32_bf16 v[224:227], a[64:67], v[20:23], v[224:227]
    s_waitcnt lgkmcnt(6)
    v_bfe_u32 v83, v0, 1, 3
    v_lshrrev_b32 v84, 4, v0
    v_mfma_f32_16x16x32_bf16 v[164:167], a[72:75], v[16:19], v[164:167]
    ds_read_b128 a[104:107], v3 offset:13312
    v_lshlrev_b32 v84, 1, v84
    v_mfma_f32_16x16x32_bf16 v[164:167], a[76:79], v[24:27], v[164:167]
    buffer_load_dwordx4 v[112:115], v4, s[12:15], s56 offen offset:0 sc1
    v_mfma_f32_16x16x32_bf16 v[228:231], a[76:79], v[28:31], v[228:231]
    ds_read_b128 a[108:111], v3 offset:29696
    v_sub_u32 v83, v83, v84
    v_mfma_f32_16x16x32_bf16 v[228:231], a[72:75], v[20:23], v[228:231]
    s_waitcnt lgkmcnt(6)
    v_cmp_eq_u32 s[20:21], 0, v83
    v_cmp_eq_u32 s[22:23], 1, v83
    v_mfma_f32_16x16x32_bf16 v[168:171], a[80:83], v[16:19], v[168:171]
    ds_read_b128 a[112:115], v3 offset:14336
    v_mfma_f32_16x16x32_bf16 v[168:171], a[84:87], v[24:27], v[168:171]
    buffer_load_dwordx4 v[52:55], v4, s[12:15], s55 offen offset:1024 sc1
    v_mfma_f32_16x16x32_bf16 v[232:235], a[84:87], v[28:31], v[232:235]
    ds_read_b128 a[116:119], v3 offset:30720
    v_cndmask_b32 v78, 0, v82, s[20:21]
    v_mfma_f32_16x16x32_bf16 v[232:235], a[80:83], v[20:23], v[232:235]
    s_waitcnt lgkmcnt(6)
    v_mfma_f32_16x16x32_bf16 v[172:175], a[88:91], v[16:19], v[172:175]
    ds_read_b128 a[120:123], v3 offset:15360
    v_cndmask_b32 v79, 0, v82, s[22:23]
    v_mfma_f32_16x16x32_bf16 v[172:175], a[92:95], v[24:27], v[172:175]
    buffer_load_dwordx4 v[116:119], v4, s[12:15], s56 offen offset:1024 sc1
    v_mfma_f32_16x16x32_bf16 v[236:239], a[92:95], v[28:31], v[236:239]
    ds_read_b128 a[124:127], v3 offset:31744
    v_mfma_f32_16x16x32_bf16 v[236:239], a[88:91], v[20:23], v[236:239]
    s_waitcnt lgkmcnt(6)
    v_mfma_f32_16x16x32_bf16 v[176:179], a[96:99], v[16:19], v[176:179]
    v_mfma_f32_16x16x32_bf16 v[176:179], a[100:103], v[24:27], v[176:179]
    buffer_load_dwordx4 v[56:59], v4, s[12:15], s55 offen offset:2048 sc1
    v_mfma_f32_16x16x32_bf16 v[240:243], a[100:103], v[28:31], v[240:243]
    v_mfma_f32_16x16x32_bf16 v[240:243], a[96:99], v[20:23], v[240:243]
    s_waitcnt lgkmcnt(4)
    v_mfma_f32_16x16x32_bf16 v[180:183], a[104:107], v[16:19], v[180:183]
    v_mfma_f32_16x16x32_bf16 v[180:183], a[108:111], v[24:27], v[180:183]
    buffer_load_dwordx4 v[120:123], v4, s[12:15], s56 offen offset:2048 sc1
    v_mfma_f32_16x16x32_bf16 v[244:247], a[108:111], v[28:31], v[244:247]
    v_mfma_f32_16x16x32_bf16 v[244:247], a[104:107], v[20:23], v[244:247]
    s_waitcnt lgkmcnt(2)
    v_mfma_f32_16x16x32_bf16 v[184:187], a[112:115], v[16:19], v[184:187]
    v_mfma_f32_16x16x32_bf16 v[184:187], a[116:119], v[24:27], v[184:187]
    buffer_load_dwordx4 v[60:63], v4, s[12:15], s55 offen offset:3072 sc1
    v_mfma_f32_16x16x32_bf16 v[248:251], a[116:119], v[28:31], v[248:251]
    v_mfma_f32_16x16x32_bf16 v[248:251], a[112:115], v[20:23], v[248:251]
    s_waitcnt lgkmcnt(0)
    v_mfma_f32_16x16x32_bf16 v[188:191], a[120:123], v[16:19], v[188:191]
    v_mfma_f32_16x16x32_bf16 v[188:191], a[124:127], v[24:27], v[188:191]
    v_mfma_f32_16x16x32_bf16 v[252:255], a[124:127], v[28:31], v[252:255]
    v_mfma_f32_16x16x32_bf16 v[252:255], a[120:123], v[20:23], v[252:255]
    buffer_load_dwordx4 v[124:127], v4, s[12:15], s56 offen offset:3072 sc1
    s_cmp_eq_u32 s58, 0
    s_cbranch_scc1 L_merge2
    v_and_b32 v11, 0, v0
    v_lshlrev_b32 v11, 2, v11
    s_mov_b32 s32, 0
L_poll3:
    buffer_load_dword v12, v11, s[12:15], s94 offen sc1
    s_waitcnt vmcnt(0)
    v_cmp_ne_u32 vcc, 0, v12
    s_cbranch_vccz L_poll3_ok
    s_sleep 8
    s_add_u32 s32, s32, 1
    s_cmp_lt_u32 s32, 0x80000
    s_cbranch_scc1 L_poll3
L_poll3_ok:
    s_mov_b32 s55, s52
    s_mov_b32 s57, s53
    s_add_u32 s56, s55, 0x2000
    buffer_load_dwordx4 v[68:71], v1, s[12:15], s57 offen sc1
    buffer_load_dwordx4 v[32:35], v1, s[12:15], s55 offen offset:0 sc1
    buffer_load_dwordx4 v[96:99], v1, s[12:15], s56 offen offset:0 sc1
    buffer_load_dwordx4 v[36:39], v1, s[12:15], s55 offen offset:1024 sc1
    buffer_load_dwordx4 v[100:103], v1, s[12:15], s56 offen offset:1024 sc1
    buffer_load_dwordx4 v[40:43], v1, s[12:15], s55 offen offset:2048 sc1
    buffer_load_dwordx4 v[104:107], v1, s[12:15], s56 offen offset:2048 sc1
    buffer_load_dwordx4 v[44:47], v1, s[12:15], s55 offen offset:3072 sc1
    buffer_load_dwordx4 v[108:111], v1, s[12:15], s56 offen offset:3072 sc1
    buffer_load_dwordx4 v[48:51], v4, s[12:15], s55 offen offset:0 sc1
    buffer_load_dwordx4 v[112:115], v4, s[12:15], s56 offen offset:0 sc1
    buffer_load_dwordx4 v[52:55], v4, s[12:15], s55 offen offset:1024 sc1
    buffer_load_dwordx4 v[116:119], v4, s[12:15], s56 offen offset:1024 sc1
    buffer_load_dwordx4 v[56:59], v4, s[12:15], s55 offen offset:2048 sc1
    buffer_load_dwordx4 v[120:123], v4, s[12:15], s56 offen offset:2048 sc1
    buffer_load_dwordx4 v[60:63], v4, s[12:15], s55 offen offset:3072 sc1
    buffer_load_dwordx4 v[124:127], v4, s[12:15], s56 offen offset:3072 sc1
L_merge2:
    s_waitcnt vmcnt(14)
    v_cmp_neq_f32 vcc, v70, v9
    v_cmp_neq_f32 s[20:21], v71, v10
    s_or_b64 vcc, vcc, s[20:21]
    s_cbranch_vccnz L_mslow
    v_mfma_f32_16x16x32_bf16 v[128:131], v[78:81], v[32:35], v[128:131]
    s_add_u32 m0, s29, 0
    v_add_f32 v7, v7, v68
    v_add_f32 v8, v8, v69
    v_mfma_f32_16x16x32_bf16 v[132:135], v[76:79], v[32:35], v[132:135]
    buffer_load_dwordx4 v2, s[8:11], s78 offen lds
    v_mfma_f32_16x16x32_bf16 v[192:195], v[78:81], v[96:99], v[192:195]
    v_rcp_f32 v64, v7
    v_mfma_f32_16x16x32_bf16 v[196:199], v[76:79], v[96:99], v[196:199]
    s_waitcnt vmcnt(13)
    v_rcp_f32 v65, v8
    v_mfma_f32_16x16x32_bf16 v[136:139], v[78:81], v[36:39], v[136:139]
    s_add_u32 m0, s29, 4096
    v_mfma_f32_16x16x32_bf16 v[140:143], v[76:79], v[36:39], v[140:143]
    buffer_load_dwordx4 v2, s[8:11], s79 offen lds
    v_mfma_f32_16x16x32_bf16 v[200:203], v[78:81], v[100:103], v[200:203]
    v_cvt_pk_bf16_f32 v128, v128, v129
    v_cvt_pk_bf16_f32 v129, v130, v131
    v_mfma_f32_16x16x32_bf16 v[204:207], v[76:79], v[100:103], v[204:207]
    s_waitcnt vmcnt(12)
    v_cvt_pk_bf16_f32 v130, v132, v133
    v_cvt_pk_bf16_f32 v131, v134, v135
    v_mfma_f32_16x16x32_bf16 v[144:147], v[78:81], v[40:43], v[144:147]
    s_add_u32 m0, s29, 8192
    v_cvt_pk_bf16_f32 v192, v192, v193
    v_cvt_pk_bf16_f32 v193, v194, v195
    v_mfma_f32_16x16x32_bf16 v[148:151], v[76:79], v[40:43], v[148:151]
    buffer_load_dwordx4 v2, s[8:11], s80 offen lds
    v_mfma_f32_16x16x32_bf16 v[208:211], v[78:81], v[104:107], v[208:211]
    v_cvt_pk_bf16_f32 v194, v196, v197
    v_cvt_pk_bf16_f32 v195, v198, v199
    v_mfma_f32_16x16x32_bf16 v[212:215], v[76:79], v[104:107], v[212:215]
    s_waitcnt vmcnt(11)
    v_cvt_pk_bf16_f32 v136, v136, v137
    v_cvt_pk_bf16_f32 v137, v138, v139
    v_mfma_f32_16x16x32_bf16 v[152:155], v[78:81], v[44:47], v[152:155]
    s_add_u32 m0, s29, 12288
    v_cvt_pk_bf16_f32 v138, v140, v141
    v_cvt_pk_bf16_f32 v139, v142, v143
    v_mfma_f32_16x16x32_bf16 v[156:159], v[76:79], v[44:47], v[156:159]
    buffer_load_dwordx4 v2, s[8:11], s81 offen lds
    v_mfma_f32_16x16x32_bf16 v[216:219], v[78:81], v[108:111], v[216:219]
    v_cvt_pk_bf16_f32 v200, v200, v201
    v_cvt_pk_bf16_f32 v201, v202, v203
    v_mfma_f32_16x16x32_bf16 v[220:223], v[76:79], v[108:111], v[220:223]
    s_waitcnt vmcnt(10)
    v_cvt_pk_bf16_f32 v202, v204, v205
    v_cvt_pk_bf16_f32 v203, v206, v207
    v_mfma_f32_16x16x32_bf16 v[160:163], v[78:81], v[48:51], v[160:163]
    s_add_u32 m0, s29, 16384
    v_cvt_pk_bf16_f32 v144, v144, v145
    v_cvt_pk_bf16_f32 v145, v146, v147
    v_mfma_f32_16x16x32_bf16 v[164:167], v[76:79], v[48:51], v[164:167]
    buffer_load_dwordx4 v2, s[8:11], s82 offen lds
    v_mfma_f32_16x16x32_bf16 v[224:227], v[78:81], v[112:115], v[224:227]
    v_cvt_pk_bf16_f32 v146, v148, v149
    v_cvt_pk_bf16_f32 v147, v150, v151
    v_mfma_f32_16x16x32_bf16 v[228:231], v[76:79], v[112:115], v[228:231]
    s_waitcnt vmcnt(9)
    v_cvt_pk_bf16_f32 v208, v208, v209
    v_cvt_pk_bf16_f32 v209, v210, v211
    v_mfma_f32_16x16x32_bf16 v[168:171], v[78:81], v[52:55], v[168:171]
    s_add_u32 m0, s29, 20480
    v_cvt_pk_bf16_f32 v210, v212, v213
    v_cvt_pk_bf16_f32 v211, v214, v215
    v_mfma_f32_16x16x32_bf16 v[172:175], v[76:79], v[52:55], v[172:175]
    buffer_load_dwordx4 v2, s[8:11], s83 offen lds
    v_mfma_f32_16x16x32_bf16 v[232:235], v[78:81], v[116:119], v[232:235]
    v_cvt_pk_bf16_f32 v152, v152, v153
    v_cvt_pk_bf16_f32 v153, v154, v155
    v_mfma_f32_16x16x32_bf16 v[236:239], v[76:79], v[116:119], v[236:239]
    s_waitcnt vmcnt(8)
    v_cvt_pk_bf16_f32 v154, v156, v157
    v_cvt_pk_bf16_f32 v155, v158, v159
    v_mfma_f32_16x16x32_bf16 v[176:179], v[78:81], v[56:59], v[176:179]
    s_add_u32 m0, s29, 24576
    v_cvt_pk_bf16_f32 v216, v216, v217
    v_cvt_pk_bf16_f32 v217, v218, v219
    v_mfma_f32_16x16x32_bf16 v[180:183], v[76:79], v[56:59], v[180:183]
    buffer_load_dwordx4 v2, s[8:11], s84 offen lds
    v_mfma_f32_16x16x32_bf16 v[240:243], v[78:81], v[120:123], v[240:243]
    v_cvt_pk_bf16_f32 v218, v220, v221
    v_cvt_pk_bf16_f32 v219, v222, v223
    v_mfma_f32_16x16x32_bf16 v[244:247], v[76:79], v[120:123], v[244:247]
    s_waitcnt vmcnt(7)
    v_cvt_pk_bf16_f32 v160, v160, v161
    v_cvt_pk_bf16_f32 v161, v162, v163
    v_mfma_f32_16x16x32_bf16 v[184:187], v[78:81], v[60:63], v[184:187]
    s_add_u32 m0, s29, 28672
    v_cvt_pk_bf16_f32 v162, v164, v165
    v_cvt_pk_bf16_f32 v163, v166, v167
    v_mfma_f32_16x16x32_bf16 v[188:191], v[76:79], v[60:63], v[188:191]
    buffer_load_dwordx4 v2, s[8:11], s85 offen lds
    v_mfma_f32_16x16x32_bf16 v[248:251], v[78:81], v[124:127], v[248:251]
    v_cvt_pk_bf16_f32 v224, v224, v225
    v_cvt_pk_bf16_f32 v225, v226, v227
    v_mfma_f32_16x16x32_bf16 v[252:255], v[76:79], v[124:127], v[252:255]
    v_cvt_pk_bf16_f32 v226, v228, v229
    v_cvt_pk_bf16_f32 v227, v230, v231
    v_add_u32 v2, 128, v2
    v_cvt_pk_bf16_f32 v168, v168, v169
    v_cvt_pk_bf16_f32 v169, v170, v171
    v_cvt_pk_bf16_f32 v170, v172, v173
    v_cvt_pk_bf16_f32 v171, v174, v175
    v_cvt_pk_bf16_f32 v232, v232, v233
    v_cvt_pk_bf16_f32 v233, v234, v235
    v_cvt_pk_bf16_f32 v234, v236, v237
    v_cvt_pk_bf16_f32 v235, v238, v239
    v_cvt_pk_bf16_f32 v176, v176, v177
    v_cvt_pk_bf16_f32 v177, v178, v179
    v_cvt_pk_bf16_f32 v178, v180, v181
    v_cvt_pk_bf16_f32 v179, v182, v183
    v_cvt_pk_bf16_f32 v240, v240, v241
    v_cvt_pk_bf16_f32 v241, v242, v243
    v_cvt_pk_bf16_f32 v242, v244, v245
    v_cvt_pk_bf16_f32 v243, v246, v247
    v_cvt_pk_bf16_f32 v184, v184, v185
    v_cvt_pk_bf16_f32 v185, v186, v187
    v_cvt_pk_bf16_f32 v186, v188, v189
    v_cvt_pk_bf16_f32 v187, v190, v191
    v_cvt_pk_bf16_f32 v248, v248, v249
    v_cvt_pk_bf16_f32 v249, v250, v251
    v_cvt_pk_bf16_f32 v250, v252, v253
    v_cvt_pk_bf16_f32 v251, v254, v255
    s_waitcnt vmcnt(0)
    s_branch L_attdone
L_mslow:
    s_add_u32 m0, s29, 0
    s_nop 0
    buffer_load_dwordx4 v2, s[8:11], s78 offen lds
    s_add_u32 m0, s29, 4096
    s_nop 0
    buffer_load_dwordx4 v2, s[8:11], s79 offen lds
    s_add_u32 m0, s29, 8192
    s_nop 0
    buffer_load_dwordx4 v2, s[8:11], s80 offen lds
    s_add_u32 m0, s29, 12288
    s_nop 0
    buffer_load_dwordx4 v2, s[8:11], s81 offen lds
    s_add_u32 m0, s29, 16384
    s_nop 0
    buffer_load_dwordx4 v2, s[8:11], s82 offen lds
    s_add_u32 m0, s29, 20480
    s_nop 0
    buffer_load_dwordx4 v2, s[8:11], s83 offen lds
    s_add_u32 m0, s29, 24576
    s_nop 0
    buffer_load_dwordx4 v2, s[8:11], s84 offen lds
    s_add_u32 m0, s29, 28672
    s_nop 0
    buffer_load_dwordx4 v2, s[8:11], s85 offen lds
    v_add_u32 v2, 128, v2
    s_mov_b32 s58, 0xffff0000
    s_waitcnt vmcnt(0)
    v_min_f32 v20, v70, v9
    v_sub_f32 v21, v20, v9
    v_sub_f32 v22, v20, v70
    v_exp_f32 v16, v21
    v_exp_f32 v18, v22
    s_nop 0
    v_mul_f32 v7, v7, v16
    v_fmac_f32 v7, v68, v18
    v_rcp_f32 v64, v7
    v_min_f32 v20, v71, v10
    v_sub_f32 v21, v20, v10
    v_sub_f32 v22, v20, v71
    v_exp_f32 v17, v21
    v_exp_f32 v19, v22
    s_nop 0
    v_mul_f32 v8, v8, v17
    v_fmac_f32 v8, v69, v19
    v_rcp_f32 v65, v8
    v_lshlrev_b32 v24, 16, v32
    v_and_b32 v25, s58, v32
    v_pk_mul_f32 v[24:25], v[24:25], v[18:19] op_sel:[0,0] op_sel_hi:[1,0]
    v_pk_fma_f32 v[128:129], v[128:129], v[16:17], v[24:25] op_sel:[0,0,0] op_sel_hi:[1,0,1]
    v_lshlrev_b32 v26, 16, v33
    v_and_b32 v27, s58, v33
    v_pk_mul_f32 v[26:27], v[26:27], v[18:19] op_sel:[0,0] op_sel_hi:[1,0]
    v_pk_fma_f32 v[130:131], v[130:131], v[16:17], v[26:27] op_sel:[0,0,0] op_sel_hi:[1,0,1]
    v_lshlrev_b32 v28, 16, v34
    v_and_b32 v29, s58, v34
    v_pk_mul_f32 v[28:29], v[28:29], v[18:19] op_sel:[0,0] op_sel_hi:[1,0]
    v_pk_fma_f32 v[132:133], v[132:133], v[16:17], v[28:29] op_sel:[0,0,0] op_sel_hi:[1,0,1]
    v_lshlrev_b32 v30, 16, v35
    v_and_b32 v31, s58, v35
    v_pk_mul_f32 v[30:31], v[30:31], v[18:19] op_sel:[0,0] op_sel_hi:[1,0]
    v_pk_fma_f32 v[134:135], v[134:135], v[16:17], v[30:31] op_sel:[0,0,0] op_sel_hi:[1,0,1]
    v_cvt_pk_bf16_f32 v128, v128, v129
    v_cvt_pk_bf16_f32 v129, v130, v131
    v_cvt_pk_bf16_f32 v130, v132, v133
    v_cvt_pk_bf16_f32 v131, v134, v135
    v_lshlrev_b32 v24, 16, v36
    v_and_b32 v25, s58, v36
    v_pk_mul_f32 v[24:25], v[24:25], v[18:19] op_sel:[0,0] op_sel_hi:[1,0]
    v_pk_fma_f32 v[136:137], v[136:137], v[16:17], v[24:25] op_sel:[0,0,0] op_sel_hi:[1,0,1]
    v_lshlrev_b32 v26, 16, v37
    v_and_b32 v27, s58, v37
    v_pk_mul_f32 v[26:27], v[26:27], v[18:19] op_sel:[0,0] op_sel_hi:[1,0]
    v_pk_fma_f32 v[138:139], v[138:139], v[16:17], v[26:27] op_sel:[0,0,0] op_sel_hi:[1,0,1]
    v_lshlrev_b32 v28, 16, v38
    v_and_b32 v29, s58, v38
    v_pk_mul_f32 v[28:29], v[28:29], v[18:19] op_sel:[0,0] op_sel_hi:[1,0]
    v_pk_fma_f32 v[140:141], v[140:141], v[16:17], v[28:29] op_sel:[0,0,0] op_sel_hi:[1,0,1]
    v_lshlrev_b32 v30, 16, v39
    v_and_b32 v31, s58, v39
    v_pk_mul_f32 v[30:31], v[30:31], v[18:19] op_sel:[0,0] op_sel_hi:[1,0]
    v_pk_fma_f32 v[142:143], v[142:143], v[16:17], v[30:31] op_sel:[0,0,0] op_sel_hi:[1,0,1]
    v_cvt_pk_bf16_f32 v136, v136, v137
    v_cvt_pk_bf16_f32 v137, v138, v139
    v_cvt_pk_bf16_f32 v138, v140, v141
    v_cvt_pk_bf16_f32 v139, v142, v143
    v_lshlrev_b32 v24, 16, v40
    v_and_b32 v25, s58, v40
    v_pk_mul_f32 v[24:25], v[24:25], v[18:19] op_sel:[0,0] op_sel_hi:[1,0]
    v_pk_fma_f32 v[144:145], v[144:145], v[16:17], v[24:25] op_sel:[0,0,0] op_sel_hi:[1,0,1]
    v_lshlrev_b32 v26, 16, v41
    v_and_b32 v27, s58, v41
    v_pk_mul_f32 v[26:27], v[26:27], v[18:19] op_sel:[0,0] op_sel_hi:[1,0]
    v_pk_fma_f32 v[146:147], v[146:147], v[16:17], v[26:27] op_sel:[0,0,0] op_sel_hi:[1,0,1]
    v_lshlrev_b32 v28, 16, v42
    v_and_b32 v29, s58, v42
    v_pk_mul_f32 v[28:29], v[28:29], v[18:19] op_sel:[0,0] op_sel_hi:[1,0]
    v_pk_fma_f32 v[148:149], v[148:149], v[16:17], v[28:29] op_sel:[0,0,0] op_sel_hi:[1,0,1]
    v_lshlrev_b32 v30, 16, v43
    v_and_b32 v31, s58, v43
    v_pk_mul_f32 v[30:31], v[30:31], v[18:19] op_sel:[0,0] op_sel_hi:[1,0]
    v_pk_fma_f32 v[150:151], v[150:151], v[16:17], v[30:31] op_sel:[0,0,0] op_sel_hi:[1,0,1]
    v_cvt_pk_bf16_f32 v144, v144, v145
    v_cvt_pk_bf16_f32 v145, v146, v147
    v_cvt_pk_bf16_f32 v146, v148, v149
    v_cvt_pk_bf16_f32 v147, v150, v151
    v_lshlrev_b32 v24, 16, v44
    v_and_b32 v25, s58, v44
    v_pk_mul_f32 v[24:25], v[24:25], v[18:19] op_sel:[0,0] op_sel_hi:[1,0]
    v_pk_fma_f32 v[152:153], v[152:153], v[16:17], v[24:25] op_sel:[0,0,0] op_sel_hi:[1,0,1]
    v_lshlrev_b32 v26, 16, v45
    v_and_b32 v27, s58, v45
    v_pk_mul_f32 v[26:27], v[26:27], v[18:19] op_sel:[0,0] op_sel_hi:[1,0]
    v_pk_fma_f32 v[154:155], v[154:155], v[16:17], v[26:27] op_sel:[0,0,0] op_sel_hi:[1,0,1]
    v_lshlrev_b32 v28, 16, v46
    v_and_b32 v29, s58, v46
    v_pk_mul_f32 v[28:29], v[28:29], v[18:19] op_sel:[0,0] op_sel_hi:[1,0]
    v_pk_fma_f32 v[156:157], v[156:157], v[16:17], v[28:29] op_sel:[0,0,0] op_sel_hi:[1,0,1]
    v_lshlrev_b32 v30, 16, v47
    v_and_b32 v31, s58, v47
    v_pk_mul_f32 v[30:31], v[30:31], v[18:19] op_sel:[0,0] op_sel_hi:[1,0]
    v_pk_fma_f32 v[158:159], v[158:159], v[16:17], v[30:31] op_sel:[0,0,0] op_sel_hi:[1,0,1]
    v_cvt_pk_bf16_f32 v152, v152, v153
    v_cvt_pk_bf16_f32 v153, v154, v155
    v_cvt_pk_bf16_f32 v154, v156, v157
    v_cvt_pk_bf16_f32 v155, v158, v159
    v_lshlrev_b32 v24, 16, v48
    v_and_b32 v25, s58, v48
    v_pk_mul_f32 v[24:25], v[24:25], v[18:19] op_sel:[0,0] op_sel_hi:[1,0]
    v_pk_fma_f32 v[160:161], v[160:161], v[16:17], v[24:25] op_sel:[0,0,0] op_sel_hi:[1,0,1]
    v_lshlrev_b32 v26, 16, v49
    v_and_b32 v27, s58, v49
    v_pk_mul_f32 v[26:27], v[26:27], v[18:19] op_sel:[0,0] op_sel_hi:[1,0]
    v_pk_fma_f32 v[162:163], v[162:163], v[16:17], v[26:27] op_sel:[0,0,0] op_sel_hi:[1,0,1]
    v_lshlrev_b32 v28, 16, v50
    v_and_b32 v29, s58, v50
    v_pk_mul_f32 v[28:29], v[28:29], v[18:19] op_sel:[0,0] op_sel_hi:[1,0]
    v_pk_fma_f32 v[164:165], v[164:165], v[16:17], v[28:29] op_sel:[0,0,0] op_sel_hi:[1,0,1]
    v_lshlrev_b32 v30, 16, v51
    v_and_b32 v31, s58, v51
    v_pk_mul_f32 v[30:31], v[30:31], v[18:19] op_sel:[0,0] op_sel_hi:[1,0]
    v_pk_fma_f32 v[166:167], v[166:167], v[16:17], v[30:31] op_sel:[0,0,0] op_sel_hi:[1,0,1]
    v_cvt_pk_bf16_f32 v160, v160, v161
    v_cvt_pk_bf16_f32 v161, v162, v163
    v_cvt_pk_bf16_f32 v162, v164, v165
    v_cvt_pk_bf16_f32 v163, v166, v167
    v_lshlrev_b32 v24, 16, v52
    v_and_b32 v25, s58, v52
    v_pk_mul_f32 v[24:25], v[24:25], v[18:19] op_sel:[0,0] op_sel_hi:[1,0]
    v_pk_fma_f32 v[168:169], v[168:169], v[16:17], v[24:25] op_sel:[0,0,0] op_sel_hi:[1,0,1]
    v_lshlrev_b32 v26, 16, v53
    v_and_b32 v27, s58, v53
    v_pk_mul_f32 v[26:27], v[26:27], v[18:19] op_sel:[0,0] op_sel_hi:[1,0]
    v_pk_fma_f32 v[170:171], v[170:171], v[16:17], v[26:27] op_sel:[0,0,0] op_sel_hi:[1,0,1]
    v_lshlrev_b32 v28, 16, v54
    v_and_b32 v29, s58, v54
    v_pk_mul_f32 v[28:29], v[28:29], v[18:19] op_sel:[0,0] op_sel_hi:[1,0]
    v_pk_fma_f32 v[172:173], v[172:173], v[16:17], v[28:29] op_sel:[0,0,0] op_sel_hi:[1,0,1]
    v_lshlrev_b32 v30, 16, v55
    v_and_b32 v31, s58, v55
    v_pk_mul_f32 v[30:31], v[30:31], v[18:19] op_sel:[0,0] op_sel_hi:[1,0]
    v_pk_fma_f32 v[174:175], v[174:175], v[16:17], v[30:31] op_sel:[0,0,0] op_sel_hi:[1,0,1]
    v_cvt_pk_bf16_f32 v168, v168, v169
    v_cvt_pk_bf16_f32 v169, v170, v171
    v_cvt_pk_bf16_f32 v170, v172, v173
    v_cvt_pk_bf16_f32 v171, v174, v175
    v_lshlrev_b32 v24, 16, v56
    v_and_b32 v25, s58, v56
    v_pk_mul_f32 v[24:25], v[24:25], v[18:19] op_sel:[0,0] op_sel_hi:[1,0]
    v_pk_fma_f32 v[176:177], v[176:177], v[16:17], v[24:25] op_sel:[0,0,0] op_sel_hi:[1,0,1]
    v_lshlrev_b32 v26, 16, v57
    v_and_b32 v27, s58, v57
    v_pk_mul_f32 v[26:27], v[26:27], v[18:19] op_sel:[0,0] op_sel_hi:[1,0]
    v_pk_fma_f32 v[178:179], v[178:179], v[16:17], v[26:27] op_sel:[0,0,0] op_sel_hi:[1,0,1]
    v_lshlrev_b32 v28, 16, v58
    v_and_b32 v29, s58, v58
    v_pk_mul_f32 v[28:29], v[28:29], v[18:19] op_sel:[0,0] op_sel_hi:[1,0]
    v_pk_fma_f32 v[180:181], v[180:181], v[16:17], v[28:29] op_sel:[0,0,0] op_sel_hi:[1,0,1]
    v_lshlrev_b32 v30, 16, v59
    v_and_b32 v31, s58, v59
    v_pk_mul_f32 v[30:31], v[30:31], v[18:19] op_sel:[0,0] op_sel_hi:[1,0]
    v_pk_fma_f32 v[182:183], v[182:183], v[16:17], v[30:31] op_sel:[0,0,0] op_sel_hi:[1,0,1]
    v_cvt_pk_bf16_f32 v176, v176, v177
    v_cvt_pk_bf16_f32 v177, v178, v179
    v_cvt_pk_bf16_f32 v178, v180, v181
    v_cvt_pk_bf16_f32 v179, v182, v183
    v_lshlrev_b32 v24, 16, v60
    v_and_b32 v25, s58, v60
    v_pk_mul_f32 v[24:25], v[24:25], v[18:19] op_sel:[0,0] op_sel_hi:[1,0]
    v_pk_fma_f32 v[184:185], v[184:185], v[16:17], v[24:25] op_sel:[0,0,0] op_sel_hi:[1,0,1]
    v_lshlrev_b32 v26, 16, v61
    v_and_b32 v27, s58, v61
    v_pk_mul_f32 v[26:27], v[26:27], v[18:19] op_sel:[0,0] op_sel_hi:[1,0]
    v_pk_fma_f32 v[186:187], v[186:187], v[16:17], v[26:27] op_sel:[0,0,0] op_sel_hi:[1,0,1]
    v_lshlrev_b32 v28, 16, v62
    v_and_b32 v29, s58, v62
    v_pk_mul_f32 v[28:29], v[28:29], v[18:19] op_sel:[0,0] op_sel_hi:[1,0]
    v_pk_fma_f32 v[188:189], v[188:189], v[16:17], v[28:29] op_sel:[0,0,0] op_sel_hi:[1,0,1]
    v_lshlrev_b32 v30, 16, v63
    v_and_b32 v31, s58, v63
    v_pk_mul_f32 v[30:31], v[30:31], v[18:19] op_sel:[0,0] op_sel_hi:[1,0]
    v_pk_fma_f32 v[190:191], v[190:191], v[16:17], v[30:31] op_sel:[0,0,0] op_sel_hi:[1,0,1]
    v_cvt_pk_bf16_f32 v184, v184, v185
    v_cvt_pk_bf16_f32 v185, v186, v187
    v_cvt_pk_bf16_f32 v186, v188, v189
    v_cvt_pk_bf16_f32 v187, v190, v191
    v_lshlrev_b32 v24, 16, v96
    v_and_b32 v25, s58, v96
    v_pk_mul_f32 v[24:25], v[24:25], v[18:19] op_sel:[0,1] op_sel_hi:[1,1]
    v_pk_fma_f32 v[192:193], v[192:193], v[16:17], v[24:25] op_sel:[0,1,0] op_sel_hi:[1,1,1]
    v_lshlrev_b32 v26, 16, v97
    v_and_b32 v27, s58, v97
    v_pk_mul_f32 v[26:27], v[26:27], v[18:19] op_sel:[0,1] op_sel_hi:[1,1]
    v_pk_fma_f32 v[194:195], v[194:195], v[16:17], v[26:27] op_sel:[0,1,0] op_sel_hi:[1,1,1]
    v_lshlrev_b32 v28, 16, v98
    v_and_b32 v29, s58, v98
    v_pk_mul_f32 v[28:29], v[28:29], v[18:19] op_sel:[0,1] op_sel_hi:[1,1]
    v_pk_fma_f32 v[196:197], v[196:197], v[16:17], v[28:29] op_sel:[0,1,0] op_sel_hi:[1,1,1]
    v_lshlrev_b32 v30, 16, v99
    v_and_b32 v31, s58, v99
    v_pk_mul_f32 v[30:31], v[30:31], v[18:19] op_sel:[0,1] op_sel_hi:[1,1]
    v_pk_fma_f32 v[198:199], v[198:199], v[16:17], v[30:31] op_sel:[0,1,0] op_sel_hi:[1,1,1]
    v_cvt_pk_bf16_f32 v192, v192, v193
    v_cvt_pk_bf16_f32 v193, v194, v195
    v_cvt_pk_bf16_f32 v194, v196, v197
    v_cvt_pk_bf16_f32 v195, v198, v199
    v_lshlrev_b32 v24, 16, v100
    v_and_b32 v25, s58, v100
    v_pk_mul_f32 v[24:25], v[24:25], v[18:19] op_sel:[0,1] op_sel_hi:[1,1]
    v_pk_fma_f32 v[200:201], v[200:201], v[16:17], v[24:25] op_sel:[0,1,0] op_sel_hi:[1,1,1]
    v_lshlrev_b32 v26, 16, v101
    v_and_b32 v27, s58, v101
    v_pk_mul_f32 v[26:27], v[26:27], v[18:19] op_sel:[0,1] op_sel_hi:[1,1]
    v_pk_fma_f32 v[202:203], v[202:203], v[16:17], v[26:27] op_sel:[0,1,0] op_sel_hi:[1,1,1]
    v_lshlrev_b32 v28, 16, v102
    v_and_b32 v29, s58, v102
    v_pk_mul_f32 v[28:29], v[28:29], v[18:19] op_sel:[0,1] op_sel_hi:[1,1]
    v_pk_fma_f32 v[204:205], v[204:205], v[16:17], v[28:29] op_sel:[0,1,0] op_sel_hi:[1,1,1]
    v_lshlrev_b32 v30, 16, v103
    v_and_b32 v31, s58, v103
    v_pk_mul_f32 v[30:31], v[30:31], v[18:19] op_sel:[0,1] op_sel_hi:[1,1]
    v_pk_fma_f32 v[206:207], v[206:207], v[16:17], v[30:31] op_sel:[0,1,0] op_sel_hi:[1,1,1]
    v_cvt_pk_bf16_f32 v200, v200, v201
    v_cvt_pk_bf16_f32 v201, v202, v203
    v_cvt_pk_bf16_f32 v202, v204, v205
    v_cvt_pk_bf16_f32 v203, v206, v207
    v_lshlrev_b32 v24, 16, v104
    v_and_b32 v25, s58, v104
    v_pk_mul_f32 v[24:25], v[24:25], v[18:19] op_sel:[0,1] op_sel_hi:[1,1]
    v_pk_fma_f32 v[208:209], v[208:209], v[16:17], v[24:25] op_sel:[0,1,0] op_sel_hi:[1,1,1]
    v_lshlrev_b32 v26, 16, v105
    v_and_b32 v27, s58, v105
    v_pk_mul_f32 v[26:27], v[26:27], v[18:19] op_sel:[0,1] op_sel_hi:[1,1]
    v_pk_fma_f32 v[210:211], v[210:211], v[16:17], v[26:27] op_sel:[0,1,0] op_sel_hi:[1,1,1]
    v_lshlrev_b32 v28, 16, v106
    v_and_b32 v29, s58, v106
    v_pk_mul_f32 v[28:29], v[28:29], v[18:19] op_sel:[0,1] op_sel_hi:[1,1]
    v_pk_fma_f32 v[212:213], v[212:213], v[16:17], v[28:29] op_sel:[0,1,0] op_sel_hi:[1,1,1]
    v_lshlrev_b32 v30, 16, v107
    v_and_b32 v31, s58, v107
    v_pk_mul_f32 v[30:31], v[30:31], v[18:19] op_sel:[0,1] op_sel_hi:[1,1]
    v_pk_fma_f32 v[214:215], v[214:215], v[16:17], v[30:31] op_sel:[0,1,0] op_sel_hi:[1,1,1]
    v_cvt_pk_bf16_f32 v208, v208, v209
    v_cvt_pk_bf16_f32 v209, v210, v211
    v_cvt_pk_bf16_f32 v210, v212, v213
    v_cvt_pk_bf16_f32 v211, v214, v215
    v_lshlrev_b32 v24, 16, v108
    v_and_b32 v25, s58, v108
    v_pk_mul_f32 v[24:25], v[24:25], v[18:19] op_sel:[0,1] op_sel_hi:[1,1]
    v_pk_fma_f32 v[216:217], v[216:217], v[16:17], v[24:25] op_sel:[0,1,0] op_sel_hi:[1,1,1]
    v_lshlrev_b32 v26, 16, v109
    v_and_b32 v27, s58, v109
    v_pk_mul_f32 v[26:27], v[26:27], v[18:19] op_sel:[0,1] op_sel_hi:[1,1]
    v_pk_fma_f32 v[218:219], v[218:219], v[16:17], v[26:27] op_sel:[0,1,0] op_sel_hi:[1,1,1]
    v_lshlrev_b32 v28, 16, v110
    v_and_b32 v29, s58, v110
    v_pk_mul_f32 v[28:29], v[28:29], v[18:19] op_sel:[0,1] op_sel_hi:[1,1]
    v_pk_fma_f32 v[220:221], v[220:221], v[16:17], v[28:29] op_sel:[0,1,0] op_sel_hi:[1,1,1]
    v_lshlrev_b32 v30, 16, v111
    v_and_b32 v31, s58, v111
    v_pk_mul_f32 v[30:31], v[30:31], v[18:19] op_sel:[0,1] op_sel_hi:[1,1]
    v_pk_fma_f32 v[222:223], v[222:223], v[16:17], v[30:31] op_sel:[0,1,0] op_sel_hi:[1,1,1]
    v_cvt_pk_bf16_f32 v216, v216, v217
    v_cvt_pk_bf16_f32 v217, v218, v219
    v_cvt_pk_bf16_f32 v218, v220, v221
    v_cvt_pk_bf16_f32 v219, v222, v223
    v_lshlrev_b32 v24, 16, v112
    v_and_b32 v25, s58, v112
    v_pk_mul_f32 v[24:25], v[24:25], v[18:19] op_sel:[0,1] op_sel_hi:[1,1]
    v_pk_fma_f32 v[224:225], v[224:225], v[16:17], v[24:25] op_sel:[0,1,0] op_sel_hi:[1,1,1]
    v_lshlrev_b32 v26, 16, v113
    v_and_b32 v27, s58, v113
    v_pk_mul_f32 v[26:27], v[26:27], v[18:19] op_sel:[0,1] op_sel_hi:[1,1]
    v_pk_fma_f32 v[226:227], v[226:227], v[16:17], v[26:27] op_sel:[0,1,0] op_sel_hi:[1,1,1]
    v_lshlrev_b32 v28, 16, v114
    v_and_b32 v29, s58, v114
    v_pk_mul_f32 v[28:29], v[28:29], v[18:19] op_sel:[0,1] op_sel_hi:[1,1]
    v_pk_fma_f32 v[228:229], v[228:229], v[16:17], v[28:29] op_sel:[0,1,0] op_sel_hi:[1,1,1]
    v_lshlrev_b32 v30, 16, v115
    v_and_b32 v31, s58, v115
    v_pk_mul_f32 v[30:31], v[30:31], v[18:19] op_sel:[0,1] op_sel_hi:[1,1]
    v_pk_fma_f32 v[230:231], v[230:231], v[16:17], v[30:31] op_sel:[0,1,0] op_sel_hi:[1,1,1]
    v_cvt_pk_bf16_f32 v224, v224, v225
    v_cvt_pk_bf16_f32 v225, v226, v227
    v_cvt_pk_bf16_f32 v226, v228, v229
    v_cvt_pk_bf16_f32 v227, v230, v231
    v_lshlrev_b32 v24, 16, v116
    v_and_b32 v25, s58, v116
    v_pk_mul_f32 v[24:25], v[24:25], v[18:19] op_sel:[0,1] op_sel_hi:[1,1]
    v_pk_fma_f32 v[232:233], v[232:233], v[16:17], v[24:25] op_sel:[0,1,0] op_sel_hi:[1,1,1]
    v_lshlrev_b32 v26, 16, v117
    v_and_b32 v27, s58, v117
    v_pk_mul_f32 v[26:27], v[26:27], v[18:19] op_sel:[0,1] op_sel_hi:[1,1]
    v_pk_fma_f32 v[234:235], v[234:235], v[16:17], v[26:27] op_sel:[0,1,0] op_sel_hi:[1,1,1]
    v_lshlrev_b32 v28, 16, v118
    v_and_b32 v29, s58, v118
    v_pk_mul_f32 v[28:29], v[28:29], v[18:19] op_sel:[0,1] op_sel_hi:[1,1]
    v_pk_fma_f32 v[236:237], v[236:237], v[16:17], v[28:29] op_sel:[0,1,0] op_sel_hi:[1,1,1]
    v_lshlrev_b32 v30, 16, v119
    v_and_b32 v31, s58, v119
    v_pk_mul_f32 v[30:31], v[30:31], v[18:19] op_sel:[0,1] op_sel_hi:[1,1]
    v_pk_fma_f32 v[238:239], v[238:239], v[16:17], v[30:31] op_sel:[0,1,0] op_sel_hi:[1,1,1]
    v_cvt_pk_bf16_f32 v232, v232, v233
    v_cvt_pk_bf16_f32 v233, v234, v235
    v_cvt_pk_bf16_f32 v234, v236, v237
    v_cvt_pk_bf16_f32 v235, v238, v239
    v_lshlrev_b32 v24, 16, v120
    v_and_b32 v25, s58, v120
    v_pk_mul_f32 v[24:25], v[24:25], v[18:19] op_sel:[0,1] op_sel_hi:[1,1]
    v_pk_fma_f32 v[240:241], v[240:241], v[16:17], v[24:25] op_sel:[0,1,0] op_sel_hi:[1,1,1]
    v_lshlrev_b32 v26, 16, v121
    v_and_b32 v27, s58, v121
    v_pk_mul_f32 v[26:27], v[26:27], v[18:19] op_sel:[0,1] op_sel_hi:[1,1]
    v_pk_fma_f32 v[242:243], v[242:243], v[16:17], v[26:27] op_sel:[0,1,0] op_sel_hi:[1,1,1]
    v_lshlrev_b32 v28, 16, v122
    v_and_b32 v29, s58, v122
    v_pk_mul_f32 v[28:29], v[28:29], v[18:19] op_sel:[0,1] op_sel_hi:[1,1]
    v_pk_fma_f32 v[244:245], v[244:245], v[16:17], v[28:29] op_sel:[0,1,0] op_sel_hi:[1,1,1]
    v_lshlrev_b32 v30, 16, v123
    v_and_b32 v31, s58, v123
    v_pk_mul_f32 v[30:31], v[30:31], v[18:19] op_sel:[0,1] op_sel_hi:[1,1]
    v_pk_fma_f32 v[246:247], v[246:247], v[16:17], v[30:31] op_sel:[0,1,0] op_sel_hi:[1,1,1]
    v_cvt_pk_bf16_f32 v240, v240, v241
    v_cvt_pk_bf16_f32 v241, v242, v243
    v_cvt_pk_bf16_f32 v242, v244, v245
    v_cvt_pk_bf16_f32 v243, v246, v247
    v_lshlrev_b32 v24, 16, v124
    v_and_b32 v25, s58, v124
    v_pk_mul_f32 v[24:25], v[24:25], v[18:19] op_sel:[0,1] op_sel_hi:[1,1]
    v_pk_fma_f32 v[248:249], v[248:249], v[16:17], v[24:25] op_sel:[0,1,0] op_sel_hi:[1,1,1]
    v_lshlrev_b32 v26, 16, v125
    v_and_b32 v27, s58, v125
    v_pk_mul_f32 v[26:27], v[26:27], v[18:19] op_sel:[0,1] op_sel_hi:[1,1]
    v_pk_fma_f32 v[250:251], v[250:251], v[16:17], v[26:27] op_sel:[0,1,0] op_sel_hi:[1,1,1]
    v_lshlrev_b32 v28, 16, v126
    v_and_b32 v29, s58, v126
    v_pk_mul_f32 v[28:29], v[28:29], v[18:19] op_sel:[0,1] op_sel_hi:[1,1]
    v_pk_fma_f32 v[252:253], v[252:253], v[16:17], v[28:29] op_sel:[0,1,0] op_sel_hi:[1,1,1]
    v_lshlrev_b32 v30, 16, v127
    v_and_b32 v31, s58, v127
    v_pk_mul_f32 v[30:31], v[30:31], v[18:19] op_sel:[0,1] op_sel_hi:[1,1]
    v_pk_fma_f32 v[254:255], v[254:255], v[16:17], v[30:31] op_sel:[0,1,0] op_sel_hi:[1,1,1]
    v_cvt_pk_bf16_f32 v248, v248, v249
    v_cvt_pk_bf16_f32 v249, v250, v251
    v_cvt_pk_bf16_f32 v250, v252, v253
    v_cvt_pk_bf16_f32 v251, v254, v255
L_attdone:
    v_lshrrev_b32 v8, 2, v0
    v_lshlrev_b32 v4, 7, v8
    v_bfe_u32 v8, v8, 1, 2
    v_lshl_add_u32 v4, v8, 5, v4
    v_and_b32 v8, 3, v0
    v_lshl_add_u32 v4, v8, 3, v4
    v_add_u32 v4, 131072, v4
    s_barrier
    ds_read_b64_tr_b16 a[0:1], v4 offset:0
    ds_read_b64_tr_b16 a[2:3], v4 offset:2048
    ds_read_b64_tr_b16 a[4:5], v4 offset:4096
    ds_read_b64_tr_b16 a[6:7], v4 offset:6144
    ds_read_b64_tr_b16 a[8:9], v4 offset:8192
    ds_read_b64_tr_b16 a[10:11], v4 offset:10240
    ds_read_b64_tr_b16 a[12:13], v4 offset:12288
    ds_read_b64_tr_b16 a[14:15], v4 offset:14336
    ds_read_b64_tr_b16 a[16:17], v4 offset:16384
    ds_read_b64_tr_b16 a[18:19], v4 offset:18432
    ds_read_b64_tr_b16 a[20:21], v4 offset:20480
    ds_read_b64_tr_b16 a[22:23], v4 offset:22528
    ds_read_b64_tr_b16 a[24:25], v4 offset:24576
    ds_read_b64_tr_b16 a[26:27], v4 offset:26624
    v_xor_b32 v5, 32, v4
    v_xor_b32 v6, 64, v4
    v_xor_b32 v7, 96, v4
    v_and_b32 v10, 15, v0
    v_lshlrev_b32 v10, 2, v10
    s_cmp_lt_u32 s28, 14
    s_cselect_b32 s52, 0, 1
    s_mov_b32 s53, 0
    v_accvgpr_read_b32 v9, a245
    s_lshl_b32 s48, s63, 3
    s_add_u32 s48, s48, s3
    s_mul_i32 s48, s48, 229376
    s_lshl_b32 s58, s26, 10
    s_add_u32 s48, s48, s58
    s_add_u32 s48, s48, 117440512
    s_waitcnt lgkmcnt(7)
    v_mfma_f32_16x16x32_bf16 v[72:75], a[0:3], v[128:131], 0
    s_add_u32 m0, s29, 32768
    ds_read_b64_tr_b16 a[28:29], v4 offset:28672
    v_mfma_f32_16x16x32_bf16 v[72:75], a[4:7], v[136:139], v[72:75]
    ds_read_b64_tr_b16 a[30:31], v4 offset:30720
    buffer_load_dwordx4 v2, s[8:11], s78 offen lds
    v_mfma_f32_16x16x32_bf16 v[72:75], a[8:11], v[144:147], v[72:75]
    s_waitcnt lgkmcnt(4)
    ds_read_b64_tr_b16 a[32:33], v5 offset:0
    v_mfma_f32_16x16x32_bf16 v[72:75], a[12:15], v[152:155], v[72:75]
    ds_read_b64_tr_b16 a[34:35], v5 offset:2048
    v_mfma_f32_16x16x32_bf16 v[72:75], a[16:19], v[160:163], v[72:75]
    s_add_u32 m0, s29, 36864
    ds_read_b64_tr_b16 a[36:37], v5 offset:4096
    v_mfma_f32_16x16x32_bf16 v[72:75], a[20:23], v[168:171], v[72:75]
    s_waitcnt lgkmcnt(3)
    ds_read_b64_tr_b16 a[38:39], v5 offset:6144
    v_mfma_f32_16x16x32_bf16 v[72:75], a[24:27], v[176:179], v[72:75]
    ds_read_b64_tr_b16 a[40:41], v5 offset:8192
    buffer_load_dwordx4 v2, s[8:11], s79 offen lds
    v_mfma_f32_16x16x32_bf16 v[72:75], a[28:31], v[184:187], v[72:75]
    ds_read_b64_tr_b16 a[42:43], v5 offset:10240
    v_mfma_f32_16x16x32_bf16 v[80:83], a[0:3], v[192:195], 0
    ds_read_b64_tr_b16 a[44:45], v5 offset:12288
    v_mfma_f32_16x16x32_bf16 v[80:83], a[4:7], v[200:203], v[80:83]
    ds_read_b64_tr_b16 a[46:47], v5 offset:14336
    v_mfma_f32_16x16x32_bf16 v[80:83], a[8:11], v[208:211], v[80:83]
    s_add_u32 m0, s29, 40960
    ds_read_b64_tr_b16 a[48:49], v5 offset:16384
    v_mfma_f32_16x16x32_bf16 v[80:83], a[12:15], v[216:219], v[80:83]
    ds_read_b64_tr_b16 a[50:51], v5 offset:18432
    buffer_load_dwordx4 v2, s[8:11], s80 offen lds
    v_mfma_f32_16x16x32_bf16 v[80:83], a[16:19], v[224:227], v[80:83]
    ds_read_b64_tr_b16 a[52:53], v5 offset:20480
    v_mul_f32 v72, v72, v64
    v_mfma_f32_16x16x32_bf16 v[80:83], a[20:23], v[232:235], v[80:83]
    ds_read_b64_tr_b16 a[54:55], v5 offset:22528
    v_mul_f32 v73, v73, v64
    v_mfma_f32_16x16x32_bf16 v[80:83], a[24:27], v[240:243], v[80:83]
    s_add_u32 m0, s29, 45056
    ds_read_b64_tr_b16 a[56:57], v5 offset:24576
    v_mul_f32 v74, v74, v64
    v_mfma_f32_16x16x32_bf16 v[80:83], a[28:31], v[248:251], v[80:83]
    s_waitcnt lgkmcnt(7)
    ds_read_b64_tr_b16 a[58:59], v5 offset:26624
    v_mul_f32 v75, v75, v64
    v_mfma_f32_16x16x32_bf16 v[76:79], a[32:35], v[128:131], 0
    ds_read_b64_tr_b16 a[60:61], v5 offset:28672
    buffer_load_dwordx4 v2, s[8:11], s81 offen lds
    v_mfma_f32_16x16x32_bf16 v[76:79], a[36:39], v[136:139], v[76:79]
    ds_read_b64_tr_b16 a[62:63], v5 offset:30720
    v_mfma_f32_16x16x32_bf16 v[76:79], a[40:43], v[144:147], v[76:79]
    s_waitcnt lgkmcnt(4)
    ds_read_b64_tr_b16 a[0:1], v6 offset:0
    v_mfma_f32_16x16x32_bf16 v[76:79], a[44:47], v[152:155], v[76:79]
    ds_read_b64_tr_b16 a[2:3], v6 offset:2048
    v_mfma_f32_16x16x32_bf16 v[76:79], a[48:51], v[160:163], v[76:79]
    s_add_u32 m0, s29, 49152
    ds_read_b64_tr_b16 a[4:5], v6 offset:4096
    v_mul_f32 v80, v80, v65
    v_mfma_f32_16x16x32_bf16 v[76:79], a[52:55], v[168:171], v[76:79]
    s_waitcnt lgkmcnt(3)
    ds_read_b64_tr_b16 a[6:7], v6 offset:6144
    buffer_load_dwordx4 v2, s[8:11], s82 offen lds
    v_mfma_f32_16x16x32_bf16 v[76:79], a[56:59], v[176:179], v[76:79]
    ds_read_b64_tr_b16 a[8:9], v6 offset:8192
    v_mul_f32 v81, v81, v65
    v_mfma_f32_16x16x32_bf16 v[76:79], a[60:63], v[184:187], v[76:79]
    ds_read_b64_tr_b16 a[10:11], v6 offset:10240
    v_mul_f32 v82, v82, v65
    v_mfma_f32_16x16x32_bf16 v[84:87], a[32:35], v[192:195], 0
    ds_read_b64_tr_b16 a[12:13], v6 offset:12288
    v_mul_f32 v83, v83, v65
    v_mfma_f32_16x16x32_bf16 v[84:87], a[36:39], v[200:203], v[84:87]
    s_add_u32 m0, s29, 53248
    ds_read_b64_tr_b16 a[14:15], v6 offset:14336
    v_mfma_f32_16x16x32_bf16 v[84:87], a[40:43], v[208:211], v[84:87]
    ds_read_b64_tr_b16 a[16:17], v6 offset:16384
    buffer_load_dwordx4 v2, s[8:11], s83 offen lds
    v_mfma_f32_16x16x32_bf16 v[84:87], a[44:47], v[216:219], v[84:87]
    ds_read_b64_tr_b16 a[18:19], v6 offset:18432
    v_mfma_f32_16x16x32_bf16 v[84:87], a[48:51], v[224:227], v[84:87]
    ds_read_b64_tr_b16 a[20:21], v6 offset:20480
    v_mul_f32 v76, v76, v64
    v_mfma_f32_16x16x32_bf16 v[84:87], a[52:55], v[232:235], v[84:87]
    ds_read_b64_tr_b16 a[22:23], v6 offset:22528
    v_mul_f32 v77, v77, v64
    v_mfma_f32_16x16x32_bf16 v[84:87], a[56:59], v[240:243], v[84:87]
    s_add_u32 m0, s29, 57344
    ds_read_b64_tr_b16 a[24:25], v6 offset:24576
    v_mul_f32 v78, v78, v64
    v_mfma_f32_16x16x32_bf16 v[84:87], a[60:63], v[248:251], v[84:87]
    s_waitcnt lgkmcnt(7)
    ds_read_b64_tr_b16 a[26:27], v6 offset:26624
    buffer_load_dwordx4 v2, s[8:11], s84 offen lds
    v_mfma_f32_16x16x32_bf16 v[88:91], a[0:3], v[128:131], 0
    s_lshl_b32 s44, s24, 7
    ds_read_b64_tr_b16 a[28:29], v6 offset:28672
    v_mul_f32 v79, v79, v64
    v_mfma_f32_16x16x32_bf16 v[88:91], a[4:7], v[136:139], v[88:91]
    s_add_u32 s44, s44, 84938752
    ds_read_b64_tr_b16 a[30:31], v6 offset:30720
    v_cvt_pk_bf16_f32 v72, v72, v73
    v_mfma_f32_16x16x32_bf16 v[88:91], a[8:11], v[144:147], v[88:91]
    s_waitcnt lgkmcnt(4)
    ds_read_b64_tr_b16 a[32:33], v7 offset:0
    v_cvt_pk_bf16_f32 v73, v74, v75
    v_mfma_f32_16x16x32_bf16 v[88:91], a[12:15], v[152:155], v[88:91]
    s_add_u32 m0, s29, 61440
    ds_read_b64_tr_b16 a[34:35], v7 offset:2048
    v_cvt_pk_bf16_f32 v74, v76, v77
    v_mfma_f32_16x16x32_bf16 v[88:91], a[16:19], v[160:163], v[88:91]
    ds_read_b64_tr_b16 a[36:37], v7 offset:4096
    buffer_load_dwordx4 v2, s[8:11], s85 offen lds
    v_mfma_f32_16x16x32_bf16 v[88:91], a[20:23], v[168:171], v[88:91]
    s_waitcnt lgkmcnt(3)
    ds_read_b64_tr_b16 a[38:39], v7 offset:6144
    v_add_u32 v2, 128, v2
    v_mfma_f32_16x16x32_bf16 v[88:91], a[24:27], v[176:179], v[88:91]
    s_add_u32 s58, s48, 0
    ds_read_b64_tr_b16 a[40:41], v7 offset:8192
    v_cvt_pk_bf16_f32 v75, v78, v79
    v_mfma_f32_16x16x32_bf16 v[88:91], a[28:31], v[184:187], v[88:91]
    ds_read_b64_tr_b16 a[42:43], v7 offset:10240
    buffer_store_dwordx4 v[72:75], v1, s[12:15], s58 offen sc1
    v_mfma_f32_16x16x32_bf16 v[96:99], a[0:3], v[192:195], 0
    s_add_u32 m0, s29, 65536
    ds_read_b64_tr_b16 a[44:45], v7 offset:12288
    v_mul_f32 v84, v84, v65
    v_mfma_f32_16x16x32_bf16 v[96:99], a[4:7], v[200:203], v[96:99]
    ds_read_b64_tr_b16 a[46:47], v7 offset:14336
    buffer_load_dwordx4 v2, s[8:11], s78 offen lds
    v_mfma_f32_16x16x32_bf16 v[96:99], a[8:11], v[208:211], v[96:99]
    s_lshl_b32 s40, s24, 1
    ds_read_b64_tr_b16 a[48:49], v7 offset:16384
    v_mul_f32 v85, v85, v65
    v_mfma_f32_16x16x32_bf16 v[96:99], a[12:15], v[216:219], v[96:99]
    s_and_b32 s41, s28, 1
    ds_read_b64_tr_b16 a[50:51], v7 offset:18432
    v_mul_f32 v86, v86, v65
    v_mfma_f32_16x16x32_bf16 v[96:99], a[16:19], v[224:227], v[96:99]
    s_add_u32 s40, s40, s41
    ds_read_b64_tr_b16 a[52:53], v7 offset:20480
    v_mul_f32 v87, v87, v65
    v_mfma_f32_16x16x32_bf16 v[96:99], a[20:23], v[232:235], v[96:99]
    s_add_u32 m0, s29, 69632
    ds_read_b64_tr_b16 a[54:55], v7 offset:22528
    v_cvt_pk_bf16_f32 v80, v80, v81
    v_mfma_f32_16x16x32_bf16 v[96:99], a[24:27], v[240:243], v[96:99]
    ds_read_b64_tr_b16 a[56:57], v7 offset:24576
    buffer_load_dwordx4 v2, s[8:11], s79 offen lds
    v_mfma_f32_16x16x32_bf16 v[96:99], a[28:31], v[248:251], v[96:99]
    s_waitcnt lgkmcnt(7)
    ds_read_b64_tr_b16 a[58:59], v7 offset:26624
    v_cvt_pk_bf16_f32 v81, v82, v83
    v_mfma_f32_16x16x32_bf16 v[92:95], a[32:35], v[128:131], 0
    s_lshr_b32 s41, s28, 1
    ds_read_b64_tr_b16 a[60:61], v7 offset:28672
    v_cvt_pk_bf16_f32 v82, v84, v85
    v_mfma_f32_16x16x32_bf16 v[92:95], a[36:39], v[136:139], v[92:95]
    s_add_u32 m0, s29, 73728
    ds_read_b64_tr_b16 a[62:63], v7 offset:30720
    v_xor_b32 v4, 0x20000, v4
    v_mfma_f32_16x16x32_bf16 v[92:95], a[40:43], v[144:147], v[92:95]
    s_waitcnt lgkmcnt(4)
    ds_read_b64_tr_b16 a[0:1], v4 offset:0
    v_cvt_pk_bf16_f32 v83, v86, v87
    v_mfma_f32_16x16x32_bf16 v[92:95], a[44:47], v[152:155], v[92:95]
    ds_read_b64_tr_b16 a[2:3], v4 offset:2048
    buffer_load_dwordx4 v2, s[8:11], s80 offen lds
    v_mfma_f32_16x16x32_bf16 v[92:95], a[48:51], v[160:163], v[92:95]
    s_add_u32 s58, s48, 917504
    ds_read_b64_tr_b16 a[4:5], v4 offset:4096
    v_mul_f32 v88, v88, v64
    v_mfma_f32_16x16x32_bf16 v[92:95], a[52:55], v[168:171], v[92:95]
    s_waitcnt lgkmcnt(3)
    ds_read_b64_tr_b16 a[6:7], v4 offset:6144
    buffer_store_dwordx4 v[80:83], v1, s[12:15], s58 offen sc1
    v_mfma_f32_16x16x32_bf16 v[92:95], a[56:59], v[176:179], v[92:95]
    s_lshl_b32 s42, s40, 2
    ds_read_b64_tr_b16 a[8:9], v4 offset:8192
    v_mul_f32 v89, v89, v64
    v_mfma_f32_16x16x32_bf16 v[92:95], a[60:63], v[184:187], v[92:95]
    s_add_u32 m0, s29, 77824
    ds_read_b64_tr_b16 a[10:11], v4 offset:10240
    v_mul_f32 v90, v90, v64
    v_mfma_f32_16x16x32_bf16 v[100:103], a[32:35], v[192:195], 0
    ds_read_b64_tr_b16 a[12:13], v4 offset:12288
    buffer_load_dwordx4 v2, s[8:11], s81 offen lds
    v_mfma_f32_16x16x32_bf16 v[100:103], a[36:39], v[200:203], v[100:103]
    s_add_u32 s42, s42, s3
    ds_read_b64_tr_b16 a[14:15], v4 offset:14336
    v_mul_f32 v91, v91, v64
    v_mfma_f32_16x16x32_bf16 v[100:103], a[40:43], v[208:211], v[100:103]
    s_mul_i32 s37, s42, 229376
    ds_read_b64_tr_b16 a[16:17], v4 offset:16384
    v_mul_f32 v96, v96, v65
    v_mfma_f32_16x16x32_bf16 v[100:103], a[44:47], v[216:219], v[100:103]
    s_lshl_b32 s43, s41, 14
    ds_read_b64_tr_b16 a[18:19], v4 offset:18432
    v_mul_f32 v97, v97, v65
    v_mfma_f32_16x16x32_bf16 v[100:103], a[48:51], v[224:227], v[100:103]
    s_add_u32 m0, s29, 81920
    ds_read_b64_tr_b16 a[20:21], v4 offset:20480
    v_mul_f32 v92, v92, v64
    v_mfma_f32_16x16x32_bf16 v[100:103], a[52:55], v[232:235], v[100:103]
    ds_read_b64_tr_b16 a[22:23], v4 offset:22528
    buffer_load_dwordx4 v2, s[8:11], s82 offen lds
    v_mfma_f32_16x16x32_bf16 v[100:103], a[56:59], v[240:243], v[100:103]
    s_add_u32 s37, s37, s43
    ds_read_b64_tr_b16 a[24:25], v4 offset:24576
    v_mul_f32 v93, v93, v64
    v_mfma_f32_16x16x32_bf16 v[100:103], a[60:63], v[248:251], v[100:103]
    s_waitcnt lgkmcnt(7)
    ds_read_b64_tr_b16 a[26:27], v4 offset:26624
    v_mul_f32 v94, v94, v64
    v_mfma_f32_16x16x32_bf16 v[104:107], a[0:3], v[128:131], 0
    s_add_u32 s37, s37, 117440512
    ds_read_b64_tr_b16 a[28:29], v4 offset:28672
    v_mul_f32 v95, v95, v64
    v_mfma_f32_16x16x32_bf16 v[104:107], a[4:7], v[136:139], v[104:107]
    s_add_u32 m0, s29, 86016
    ds_read_b64_tr_b16 a[30:31], v4 offset:30720
    v_xor_b32 v5, 0x20000, v5
    v_mfma_f32_16x16x32_bf16 v[104:107], a[8:11], v[144:147], v[104:107]
    s_waitcnt lgkmcnt(4)
    ds_read_b64_tr_b16 a[32:33], v5 offset:0
    buffer_load_dwordx4 v2, s[8:11], s83 offen lds
    v_mfma_f32_16x16x32_bf16 v[104:107], a[12:15], v[152:155], v[104:107]
    s_add_u32 s38, s37, 114688
    ds_read_b64_tr_b16 a[34:35], v5 offset:2048
    v_cvt_pk_bf16_f32 v88, v88, v89
    v_mfma_f32_16x16x32_bf16 v[104:107], a[16:19], v[160:163], v[104:107]
    ds_read_b64_tr_b16 a[36:37], v5 offset:4096
    v_cvt_pk_bf16_f32 v89, v90, v91
    v_mfma_f32_16x16x32_bf16 v[104:107], a[20:23], v[168:171], v[104:107]
    s_waitcnt lgkmcnt(3)
    ds_read_b64_tr_b16 a[38:39], v5 offset:6144
    v_cvt_pk_bf16_f32 v90, v92, v93
    v_mfma_f32_16x16x32_bf16 v[104:107], a[24:27], v[176:179], v[104:107]
    s_add_u32 m0, s29, 90112
    ds_read_b64_tr_b16 a[40:41], v5 offset:8192
    v_cvt_pk_bf16_f32 v91, v94, v95
    v_mfma_f32_16x16x32_bf16 v[104:107], a[28:31], v[184:187], v[104:107]
    ds_read_b64_tr_b16 a[42:43], v5 offset:10240
    buffer_load_dwordx4 v2, s[8:11], s84 offen lds
    v_mfma_f32_16x16x32_bf16 v[112:115], a[0:3], v[192:195], 0
    s_add_u32 s58, s48, 16384
    ds_read_b64_tr_b16 a[44:45], v5 offset:12288
    v_mul_f32 v98, v98, v65
    v_mfma_f32_16x16x32_bf16 v[112:115], a[4:7], v[200:203], v[112:115]
    ds_read_b64_tr_b16 a[46:47], v5 offset:14336
    buffer_store_dwordx4 v[88:91], v1, s[12:15], s58 offen sc1
    v_mfma_f32_16x16x32_bf16 v[112:115], a[8:11], v[208:211], v[112:115]
    ds_read_b64_tr_b16 a[48:49], v5 offset:16384
    v_mul_f32 v99, v99, v65
    v_mfma_f32_16x16x32_bf16 v[112:115], a[12:15], v[216:219], v[112:115]
    s_add_u32 m0, s29, 94208
    ds_read_b64_tr_b16 a[50:51], v5 offset:18432
    v_mul_f32 v100, v100, v65
    v_mfma_f32_16x16x32_bf16 v[112:115], a[16:19], v[224:227], v[112:115]
    ds_read_b64_tr_b16 a[52:53], v5 offset:20480
    buffer_load_dwordx4 v2, s[8:11], s85 offen lds
    v_mfma_f32_16x16x32_bf16 v[112:115], a[20:23], v[232:235], v[112:115]
    ds_read_b64_tr_b16 a[54:55], v5 offset:22528
    v_add_u32 v2, 128, v2
    v_mfma_f32_16x16x32_bf16 v[112:115], a[24:27], v[240:243], v[112:115]
    ds_read_b64_tr_b16 a[56:57], v5 offset:24576
    v_mul_f32 v101, v101, v65
    v_mfma_f32_16x16x32_bf16 v[112:115], a[28:31], v[248:251], v[112:115]
    s_waitcnt lgkmcnt(7)
    ds_read_b64_tr_b16 a[58:59], v5 offset:26624
    v_mul_f32 v102, v102, v65
    v_mfma_f32_16x16x32_bf16 v[108:111], a[32:35], v[128:131], 0
    ds_read_b64_tr_b16 a[60:61], v5 offset:28672
    v_mul_f32 v103, v103, v65
    v_mfma_f32_16x16x32_bf16 v[108:111], a[36:39], v[136:139], v[108:111]
    s_add_u32 m0, s29, 98304
    ds_read_b64_tr_b16 a[62:63], v5 offset:30720
    v_xor_b32 v6, 0x20000, v6
    v_mfma_f32_16x16x32_bf16 v[108:111], a[40:43], v[144:147], v[108:111]
    s_waitcnt lgkmcnt(4)
    ds_read_b64_tr_b16 a[0:1], v6 offset:0
    buffer_load_dwordx4 v2, s[8:11], s78 offen lds
    v_mfma_f32_16x16x32_bf16 v[108:111], a[44:47], v[152:155], v[108:111]
    ds_read_b64_tr_b16 a[2:3], v6 offset:2048
    v_cvt_pk_bf16_f32 v96, v96, v97
    v_mfma_f32_16x16x32_bf16 v[108:111], a[48:51], v[160:163], v[108:111]
    ds_read_b64_tr_b16 a[4:5], v6 offset:4096
    v_cvt_pk_bf16_f32 v97, v98, v99
    v_mfma_f32_16x16x32_bf16 v[108:111], a[52:55], v[168:171], v[108:111]
    s_waitcnt lgkmcnt(3)
    ds_read_b64_tr_b16 a[6:7], v6 offset:6144
    v_cvt_pk_bf16_f32 v98, v100, v101
    v_mfma_f32_16x16x32_bf16 v[108:111], a[56:59], v[176:179], v[108:111]
    s_add_u32 m0, s29, 102400
    ds_read_b64_tr_b16 a[8:9], v6 offset:8192
    v_cvt_pk_bf16_f32 v99, v102, v103
    v_mfma_f32_16x16x32_bf16 v[108:111], a[60:63], v[184:187], v[108:111]
    ds_read_b64_tr_b16 a[10:11], v6 offset:10240
    buffer_load_dwordx4 v2, s[8:11], s79 offen lds
    v_mfma_f32_16x16x32_bf16 v[116:119], a[32:35], v[192:195], 0
    s_add_u32 s58, s48, 933888
    ds_read_b64_tr_b16 a[12:13], v6 offset:12288
    v_mul_f32 v104, v104, v64
    v_mfma_f32_16x16x32_bf16 v[116:119], a[36:39], v[200:203], v[116:119]
    ds_read_b64_tr_b16 a[14:15], v6 offset:14336
    buffer_store_dwordx4 v[96:99], v1, s[12:15], s58 offen sc1
    v_mfma_f32_16x16x32_bf16 v[116:119], a[40:43], v[208:211], v[116:119]
    ds_read_b64_tr_b16 a[16:17], v6 offset:16384
    v_mul_f32 v105, v105, v64
    v_mfma_f32_16x16x32_bf16 v[116:119], a[44:47], v[216:219], v[116:119]
    s_add_u32 m0, s29, 106496
    ds_read_b64_tr_b16 a[18:19], v6 offset:18432
    v_mul_f32 v106, v106, v64
    v_mfma_f32_16x16x32_bf16 v[116:119], a[48:51], v[224:227], v[116:119]
    ds_read_b64_tr_b16 a[20:21], v6 offset:20480
    buffer_load_dwordx4 v2, s[8:11], s80 offen lds
    v_mfma_f32_16x16x32_bf16 v[116:119], a[52:55], v[232:235], v[116:119]
    ds_read_b64_tr_b16 a[22:23], v6 offset:22528
    v_mul_f32 v107, v107, v64
    v_mfma_f32_16x16x32_bf16 v[116:119], a[56:59], v[240:243], v[116:119]
    ds_read_b64_tr_b16 a[24:25], v6 offset:24576
    v_mul_f32 v108, v108, v64
    v_mfma_f32_16x16x32_bf16 v[116:119], a[60:63], v[248:251], v[116:119]
    s_waitcnt lgkmcnt(7)
    ds_read_b64_tr_b16 a[26:27], v6 offset:26624
    v_mul_f32 v109, v109, v64
    v_mfma_f32_16x16x32_bf16 v[72:75], a[0:3], v[128:131], 0
    ds_read_b64_tr_b16 a[28:29], v6 offset:28672
    v_mul_f32 v110, v110, v64
    v_mfma_f32_16x16x32_bf16 v[72:75], a[4:7], v[136:139], v[72:75]
    s_add_u32 m0, s29, 110592
    ds_read_b64_tr_b16 a[30:31], v6 offset:30720
    v_xor_b32 v7, 0x20000, v7
    v_mfma_f32_16x16x32_bf16 v[72:75], a[8:11], v[144:147], v[72:75]
    s_waitcnt lgkmcnt(4)
    ds_read_b64_tr_b16 a[32:33], v7 offset:0
    buffer_load_dwordx4 v2, s[8:11], s81 offen lds
    v_mfma_f32_16x16x32_bf16 v[72:75], a[12:15], v[152:155], v[72:75]
    ds_read_b64_tr_b16 a[34:35], v7 offset:2048
    v_mul_f32 v111, v111, v64
    v_mfma_f32_16x16x32_bf16 v[72:75], a[16:19], v[160:163], v[72:75]
    ds_read_b64_tr_b16 a[36:37], v7 offset:4096
    v_cvt_pk_bf16_f32 v104, v104, v105
    v_mfma_f32_16x16x32_bf16 v[72:75], a[20:23], v[168:171], v[72:75]
    s_waitcnt lgkmcnt(3)
    ds_read_b64_tr_b16 a[38:39], v7 offset:6144
    v_cvt_pk_bf16_f32 v105, v106, v107
    v_mfma_f32_16x16x32_bf16 v[72:75], a[24:27], v[176:179], v[72:75]
    s_add_u32 m0, s29, 114688
    ds_read_b64_tr_b16 a[40:41], v7 offset:8192
    v_cvt_pk_bf16_f32 v106, v108, v109
    v_mfma_f32_16x16x32_bf16 v[72:75], a[28:31], v[184:187], v[72:75]
    ds_read_b64_tr_b16 a[42:43], v7 offset:10240
    buffer_load_dwordx4 v2, s[8:11], s82 offen lds
    v_mfma_f32_16x16x32_bf16 v[80:83], a[0:3], v[192:195], 0
    s_add_u32 s58, s48, 32768
    ds_read_b64_tr_b16 a[44:45], v7 offset:12288
    v_cvt_pk_bf16_f32 v107, v110, v111
    v_mfma_f32_16x16x32_bf16 v[80:83], a[4:7], v[200:203], v[80:83]
    ds_read_b64_tr_b16 a[46:47], v7 offset:14336
    buffer_store_dwordx4 v[104:107], v1, s[12:15], s58 offen sc1
    v_mfma_f32_16x16x32_bf16 v[80:83], a[8:11], v[208:211], v[80:83]
    ds_read_b64_tr_b16 a[48:49], v7 offset:16384
    v_mul_f32 v112, v112, v65
    v_mfma_f32_16x16x32_bf16 v[80:83], a[12:15], v[216:219], v[80:83]
    s_add_u32 m0, s29, 118784
    ds_read_b64_tr_b16 a[50:51], v7 offset:18432
    v_mul_f32 v113, v113, v65
    v_mfma_f32_16x16x32_bf16 v[80:83], a[16:19], v[224:227], v[80:83]
    ds_read_b64_tr_b16 a[52:53], v7 offset:20480
    buffer_load_dwordx4 v2, s[8:11], s83 offen lds
    v_mfma_f32_16x16x32_bf16 v[80:83], a[20:23], v[232:235], v[80:83]
    ds_read_b64_tr_b16 a[54:55], v7 offset:22528
    v_mul_f32 v114, v114, v65
    v_mfma_f32_16x16x32_bf16 v[80:83], a[24:27], v[240:243], v[80:83]
    ds_read_b64_tr_b16 a[56:57], v7 offset:24576
    v_mul_f32 v115, v115, v65
    v_mfma_f32_16x16x32_bf16 v[80:83], a[28:31], v[248:251], v[80:83]
    s_waitcnt lgkmcnt(7)
    ds_read_b64_tr_b16 a[58:59], v7 offset:26624
    v_mul_f32 v116, v116, v65
    v_mfma_f32_16x16x32_bf16 v[76:79], a[32:35], v[128:131], 0
    s_waitcnt vmcnt(19)
    ds_read_b64_tr_b16 a[60:61], v7 offset:28672
    v_mul_f32 v117, v117, v65
    v_mfma_f32_16x16x32_bf16 v[76:79], a[36:39], v[136:139], v[76:79]
    s_barrier
    ds_read_b64_tr_b16 a[62:63], v7 offset:30720
    v_mul_f32 v118, v118, v65
    v_mfma_f32_16x16x32_bf16 v[76:79], a[40:43], v[144:147], v[76:79]
    s_waitcnt lgkmcnt(4)
    ds_read_b64_tr_b16 a[0:1], v4 offset:32768
    v_mul_f32 v119, v119, v65
    v_mfma_f32_16x16x32_bf16 v[76:79], a[44:47], v[152:155], v[76:79]
    s_add_u32 m0, s29, 122880
    ds_read_b64_tr_b16 a[2:3], v4 offset:34816
    v_cvt_pk_bf16_f32 v112, v112, v113
    v_mfma_f32_16x16x32_bf16 v[76:79], a[48:51], v[160:163], v[76:79]
    ds_read_b64_tr_b16 a[4:5], v4 offset:36864
    buffer_load_dwordx4 v2, s[8:11], s84 offen lds
    v_mfma_f32_16x16x32_bf16 v[76:79], a[52:55], v[168:171], v[76:79]
    s_waitcnt lgkmcnt(3)
    ds_read_b64_tr_b16 a[6:7], v4 offset:38912
    v_cvt_pk_bf16_f32 v113, v114, v115
    v_mfma_f32_16x16x32_bf16 v[76:79], a[56:59], v[176:179], v[76:79]
    ds_read_b64_tr_b16 a[8:9], v4 offset:40960
    v_cvt_pk_bf16_f32 v114, v116, v117
    v_mfma_f32_16x16x32_bf16 v[76:79], a[60:63], v[184:187], v[76:79]
    ds_read_b64_tr_b16 a[10:11], v4 offset:43008
    v_cvt_pk_bf16_f32 v115, v118, v119
    v_mfma_f32_16x16x32_bf16 v[84:87], a[32:35], v[192:195], 0
    s_add_u32 m0, s29, 126976
    ds_read_b64_tr_b16 a[12:13], v4 offset:45056
    v_mul_f32 v72, v72, v64
    v_mfma_f32_16x16x32_bf16 v[84:87], a[36:39], v[200:203], v[84:87]
    ds_read_b64_tr_b16 a[14:15], v4 offset:47104
    buffer_load_dwordx4 v2, s[8:11], s85 offen lds
    v_mfma_f32_16x16x32_bf16 v[84:87], a[40:43], v[208:211], v[84:87]
    s_add_u32 s58, s48, 950272
    ds_read_b64_tr_b16 a[16:17], v4 offset:49152
    v_add_u32 v2, 128, v2
    v_mfma_f32_16x16x32_bf16 v[84:87], a[44:47], v[216:219], v[84:87]
    s_waitcnt lgkmcnt(9)
    ds_read_b64_tr_b16 a[18:19], v4 offset:51200
    buffer_store_dwordx4 v[112:115], v1, s[12:15], s58 offen sc1
    v_mfma_f32_16x16x32_bf16 v[84:87], a[48:51], v[224:227], v[84:87]
    s_barrier
    ds_read_b64_tr_b16 a[20:21], v4 offset:53248
    v_mul_f32 v73, v73, v64
    v_mfma_f32_16x16x32_bf16 v[84:87], a[52:55], v[232:235], v[84:87]
    s_add_u32 m0, s29, 131072
    ds_read_b64_tr_b16 a[22:23], v4 offset:55296
    v_mul_f32 v74, v74, v64
    v_mfma_f32_16x16x32_bf16 v[84:87], a[56:59], v[240:243], v[84:87]
    ds_read_b64_tr_b16 a[24:25], v4 offset:57344
    buffer_load_dwordx4 v2, s[8:11], s78 offen lds
    v_mfma_f32_16x16x32_bf16 v[84:87], a[60:63], v[248:251], v[84:87]
    s_waitcnt lgkmcnt(7)
    ds_read_b64_tr_b16 a[26:27], v4 offset:59392
    v_mul_f32 v75, v75, v64
    v_mfma_f32_16x16x32_bf16 v[88:91], a[0:3], v[128:131], 0
    ds_read_b64_tr_b16 a[28:29], v4 offset:61440
    v_mul_f32 v76, v76, v64
    v_mfma_f32_16x16x32_bf16 v[88:91], a[4:7], v[136:139], v[88:91]
    s_add_u32 m0, s29, 135168
    ds_read_b64_tr_b16 a[30:31], v4 offset:63488
    v_mul_f32 v77, v77, v64
    v_mfma_f32_16x16x32_bf16 v[88:91], a[8:11], v[144:147], v[88:91]
    s_waitcnt lgkmcnt(4)
    ds_read_b64_tr_b16 a[32:33], v5 offset:32768
    v_mul_f32 v78, v78, v64
    v_mfma_f32_16x16x32_bf16 v[88:91], a[12:15], v[152:155], v[88:91]
    ds_read_b64_tr_b16 a[34:35], v5 offset:34816
    buffer_load_dwordx4 v2, s[8:11], s79 offen lds
    v_mfma_f32_16x16x32_bf16 v[88:91], a[16:19], v[160:163], v[88:91]
    ds_read_b64_tr_b16 a[36:37], v5 offset:36864
    v_mul_f32 v79, v79, v64
    v_mfma_f32_16x16x32_bf16 v[88:91], a[20:23], v[168:171], v[88:91]
    s_waitcnt lgkmcnt(3)
    ds_read_b64_tr_b16 a[38:39], v5 offset:38912
    v_cvt_pk_bf16_f32 v72, v72, v73
    v_mfma_f32_16x16x32_bf16 v[88:91], a[24:27], v[176:179], v[88:91]
    ds_read_b64_tr_b16 a[40:41], v5 offset:40960
    v_cvt_pk_bf16_f32 v73, v74, v75
    v_mfma_f32_16x16x32_bf16 v[88:91], a[28:31], v[184:187], v[88:91]
    s_add_u32 m0, s29, 139264
    ds_read_b64_tr_b16 a[42:43], v5 offset:43008
    v_cvt_pk_bf16_f32 v74, v76, v77
    v_mfma_f32_16x16x32_bf16 v[96:99], a[0:3], v[192:195], 0
    ds_read_b64_tr_b16 a[44:45], v5 offset:45056
    buffer_load_dwordx4 v2, s[8:11], s80 offen lds
    v_mfma_f32_16x16x32_bf16 v[96:99], a[4:7], v[200:203], v[96:99]
    ds_read_b64_tr_b16 a[46:47], v5 offset:47104
    v_cvt_pk_bf16_f32 v75, v78, v79
    v_mfma_f32_16x16x32_bf16 v[96:99], a[8:11], v[208:211], v[96:99]
    ds_read_b64_tr_b16 a[48:49], v5 offset:49152
    buffer_load_dword v11, v10, s[12:15], s44 offen offset:64 sc1
    v_mfma_f32_16x16x32_bf16 v[96:99], a[12:15], v[216:219], v[96:99]
    ds_read_b64_tr_b16 a[50:51], v5 offset:51200
    v_mul_f32 v80, v80, v65
    v_mfma_f32_16x16x32_bf16 v[96:99], a[16:19], v[224:227], v[96:99]
    s_add_u32 m0, s29, 143360
    ds_read_b64_tr_b16 a[52:53], v5 offset:53248
    v_mul_f32 v81, v81, v65
    v_mfma_f32_16x16x32_bf16 v[96:99], a[20:23], v[232:235], v[96:99]
    ds_read_b64_tr_b16 a[54:55], v5 offset:55296
    buffer_load_dwordx4 v2, s[8:11], s81 offen lds
    v_mfma_f32_16x16x32_bf16 v[96:99], a[24:27], v[240:243], v[96:99]
    s_add_u32 s58, s48, 49152
    ds_read_b64_tr_b16 a[56:57], v5 offset:57344
    v_mul_f32 v82, v82, v65
    v_mfma_f32_16x16x32_bf16 v[96:99], a[28:31], v[248:251], v[96:99]
    s_waitcnt lgkmcnt(7)
    ds_read_b64_tr_b16 a[58:59], v5 offset:59392
    buffer_store_dwordx4 v[72:75], v1, s[12:15], s58 offen sc1
    v_mfma_f32_16x16x32_bf16 v[92:95], a[32:35], v[128:131], 0
    ds_read_b64_tr_b16 a[60:61], v5 offset:61440
    v_mul_f32 v83, v83, v65
    v_mfma_f32_16x16x32_bf16 v[92:95], a[36:39], v[136:139], v[92:95]
    s_add_u32 m0, s29, 147456
    ds_read_b64_tr_b16 a[62:63], v5 offset:63488
    v_mul_f32 v84, v84, v65
    v_mfma_f32_16x16x32_bf16 v[92:95], a[40:43], v[144:147], v[92:95]
    s_waitcnt lgkmcnt(4)
    ds_read_b64_tr_b16 a[0:1], v6 offset:32768
    buffer_load_dwordx4 v2, s[8:11], s82 offen lds
    v_mfma_f32_16x16x32_bf16 v[92:95], a[44:47], v[152:155], v[92:95]
    ds_read_b64_tr_b16 a[2:3], v6 offset:34816
    v_mul_f32 v85, v85, v65
    v_mfma_f32_16x16x32_bf16 v[92:95], a[48:51], v[160:163], v[92:95]
    ds_read_b64_tr_b16 a[4:5], v6 offset:36864
    v_mul_f32 v86, v86, v65
    v_mfma_f32_16x16x32_bf16 v[92:95], a[52:55], v[168:171], v[92:95]
    s_waitcnt lgkmcnt(3)
    ds_read_b64_tr_b16 a[6:7], v6 offset:38912
    v_mul_f32 v87, v87, v65
    v_mfma_f32_16x16x32_bf16 v[92:95], a[56:59], v[176:179], v[92:95]
    s_add_u32 m0, s29, 151552
    ds_read_b64_tr_b16 a[8:9], v6 offset:40960
    v_cvt_pk_bf16_f32 v80, v80, v81
    v_mfma_f32_16x16x32_bf16 v[92:95], a[60:63], v[184:187], v[92:95]
    ds_read_b64_tr_b16 a[10:11], v6 offset:43008
    buffer_load_dwordx4 v2, s[8:11], s83 offen lds
    v_mfma_f32_16x16x32_bf16 v[100:103], a[32:35], v[192:195], 0
    ds_read_b64_tr_b16 a[12:13], v6 offset:45056
    v_cvt_pk_bf16_f32 v81, v82, v83
    v_mfma_f32_16x16x32_bf16 v[100:103], a[36:39], v[200:203], v[100:103]
    ds_read_b64_tr_b16 a[14:15], v6 offset:47104
    v_cvt_pk_bf16_f32 v82, v84, v85
    v_mfma_f32_16x16x32_bf16 v[100:103], a[40:43], v[208:211], v[100:103]
    ds_read_b64_tr_b16 a[16:17], v6 offset:49152
    v_cvt_pk_bf16_f32 v83, v86, v87
    v_mfma_f32_16x16x32_bf16 v[100:103], a[44:47], v[216:219], v[100:103]
    s_add_u32 m0, s29, 155648
    ds_read_b64_tr_b16 a[18:19], v6 offset:51200
    v_mul_f32 v88, v88, v64
    v_mfma_f32_16x16x32_bf16 v[100:103], a[48:51], v[224:227], v[100:103]
    ds_read_b64_tr_b16 a[20:21], v6 offset:53248
    buffer_load_dwordx4 v2, s[8:11], s84 offen lds
    v_mfma_f32_16x16x32_bf16 v[100:103], a[52:55], v[232:235], v[100:103]
    s_add_u32 s58, s48, 966656
    ds_read_b64_tr_b16 a[22:23], v6 offset:55296
    v_mul_f32 v89, v89, v64
    v_mfma_f32_16x16x32_bf16 v[100:103], a[56:59], v[240:243], v[100:103]
    ds_read_b64_tr_b16 a[24:25], v6 offset:57344
    buffer_store_dwordx4 v[80:83], v1, s[12:15], s58 offen sc1
    v_mfma_f32_16x16x32_bf16 v[100:103], a[60:63], v[248:251], v[100:103]
    s_waitcnt lgkmcnt(7)
    ds_read_b64_tr_b16 a[26:27], v6 offset:59392
    v_mul_f32 v90, v90, v64
    v_mfma_f32_16x16x32_bf16 v[104:107], a[0:3], v[128:131], 0
    s_add_u32 m0, s29, 159744
    ds_read_b64_tr_b16 a[28:29], v6 offset:61440
    v_mul_f32 v91, v91, v64
    v_mfma_f32_16x16x32_bf16 v[104:107], a[4:7], v[136:139], v[104:107]
    ds_read_b64_tr_b16 a[30:31], v6 offset:63488
    buffer_load_dwordx4 v2, s[8:11], s85 offen lds
    v_mfma_f32_16x16x32_bf16 v[104:107], a[8:11], v[144:147], v[104:107]
    s_waitcnt lgkmcnt(4)
    ds_read_b64_tr_b16 a[32:33], v7 offset:32768
    v_add_u32 v2, 128, v2
    v_mfma_f32_16x16x32_bf16 v[104:107], a[12:15], v[152:155], v[104:107]
    ds_read_b64_tr_b16 a[34:35], v7 offset:34816
    v_mul_f32 v92, v92, v64
    v_mfma_f32_16x16x32_bf16 v[104:107], a[16:19], v[160:163], v[104:107]
    s_add_u32 m0, s29, 0
    ds_read_b64_tr_b16 a[36:37], v7 offset:36864
    v_mul_f32 v93, v93, v64
    v_mfma_f32_16x16x32_bf16 v[104:107], a[20:23], v[168:171], v[104:107]
    s_waitcnt lgkmcnt(3)
    ds_read_b64_tr_b16 a[38:39], v7 offset:38912
    v_mul_f32 v94, v94, v64
    v_mfma_f32_16x16x32_bf16 v[104:107], a[24:27], v[176:179], v[104:107]
    ds_read_b64_tr_b16 a[40:41], v7 offset:40960
    buffer_load_dwordx4 v2, s[8:11], s78 offen lds
    v_mfma_f32_16x16x32_bf16 v[104:107], a[28:31], v[184:187], v[104:107]
    ds_read_b64_tr_b16 a[42:43], v7 offset:43008
    v_mul_f32 v95, v95, v64
    v_mfma_f32_16x16x32_bf16 v[112:115], a[0:3], v[192:195], 0
    ds_read_b64_tr_b16 a[44:45], v7 offset:45056
    v_cvt_pk_bf16_f32 v88, v88, v89
    v_mfma_f32_16x16x32_bf16 v[112:115], a[4:7], v[200:203], v[112:115]
    ds_read_b64_tr_b16 a[46:47], v7 offset:47104
    v_cvt_pk_bf16_f32 v89, v90, v91
    v_mfma_f32_16x16x32_bf16 v[112:115], a[8:11], v[208:211], v[112:115]
    s_add_u32 m0, s29, 4096
    ds_read_b64_tr_b16 a[48:49], v7 offset:49152
    v_cvt_pk_bf16_f32 v90, v92, v93
    v_mfma_f32_16x16x32_bf16 v[112:115], a[12:15], v[216:219], v[112:115]
    ds_read_b64_tr_b16 a[50:51], v7 offset:51200
    buffer_load_dwordx4 v2, s[8:11], s79 offen lds
    v_mfma_f32_16x16x32_bf16 v[112:115], a[16:19], v[224:227], v[112:115]
    s_add_u32 s58, s48, 65536
    ds_read_b64_tr_b16 a[52:53], v7 offset:53248
    v_cvt_pk_bf16_f32 v91, v94, v95
    v_mfma_f32_16x16x32_bf16 v[112:115], a[20:23], v[232:235], v[112:115]
    ds_read_b64_tr_b16 a[54:55], v7 offset:55296
    buffer_store_dwordx4 v[88:91], v1, s[12:15], s58 offen sc1
    v_mfma_f32_16x16x32_bf16 v[112:115], a[24:27], v[240:243], v[112:115]
    s_add_u32 m0, s29, 8192
    ds_read_b64_tr_b16 a[56:57], v7 offset:57344
    v_mul_f32 v96, v96, v65
    v_mfma_f32_16x16x32_bf16 v[112:115], a[28:31], v[248:251], v[112:115]
    s_waitcnt lgkmcnt(7)
    ds_read_b64_tr_b16 a[58:59], v7 offset:59392
    v_mul_f32 v97, v97, v65
    v_mfma_f32_16x16x32_bf16 v[108:111], a[32:35], v[128:131], 0
    s_waitcnt vmcnt(10)
    ds_read_b64_tr_b16 a[60:61], v7 offset:61440
    buffer_load_dwordx4 v2, s[8:11], s80 offen lds
    v_mfma_f32_16x16x32_bf16 v[108:111], a[36:39], v[136:139], v[108:111]
    s_barrier
    ds_read_b64_tr_b16 a[62:63], v7 offset:63488
    v_xor_b32 v4, 0x10000, v4
    v_mfma_f32_16x16x32_bf16 v[108:111], a[40:43], v[144:147], v[108:111]
    s_waitcnt lgkmcnt(4)
    ds_read_b64_tr_b16 a[0:1], v4 offset:0
    v_cmp_ne_u32 vcc, 0, v11
    v_mfma_f32_16x16x32_bf16 v[108:111], a[44:47], v[152:155], v[108:111]
    s_cmp_eq_u64 vcc, s[52:53]
    s_cselect_b32 s49, 1, 0
    s_cselect_b32 s51, s37, 2.0
    ds_read_b64_tr_b16 a[2:3], v4 offset:2048
    v_mfma_f32_16x16x32_bf16 v[108:111], a[48:51], v[160:163], v[108:111]
    ds_read_b64_tr_b16 a[4:5], v4 offset:4096
    buffer_load_dwordx4 a[64:67], v1, s[12:15], s51 offen offset:0 sc1
    v_mfma_f32_16x16x32_bf16 v[108:111], a[52:55], v[168:171], v[108:111]
    s_waitcnt lgkmcnt(3)
    ds_read_b64_tr_b16 a[6:7], v4 offset:6144
    v_mul_f32 v98, v98, v65
    v_mfma_f32_16x16x32_bf16 v[108:111], a[56:59], v[176:179], v[108:111]
    s_add_u32 m0, s29, 12288
    ds_read_b64_tr_b16 a[8:9], v4 offset:8192
    v_mul_f32 v99, v99, v65
    v_mfma_f32_16x16x32_bf16 v[108:111], a[60:63], v[184:187], v[108:111]
    ds_read_b64_tr_b16 a[10:11], v4 offset:10240
    buffer_load_dwordx4 v2, s[8:11], s81 offen lds
    v_mfma_f32_16x16x32_bf16 v[116:119], a[32:35], v[192:195], 0
    ds_read_b64_tr_b16 a[12:13], v4 offset:12288
    v_mul_f32 v100, v100, v65
    v_mfma_f32_16x16x32_bf16 v[116:119], a[36:39], v[200:203], v[116:119]
    ds_read_b64_tr_b16 a[14:15], v4 offset:14336
    v_mul_f32 v101, v101, v65
    v_mfma_f32_16x16x32_bf16 v[116:119], a[40:43], v[208:211], v[116:119]
    ds_read_b64_tr_b16 a[16:17], v4 offset:16384
    buffer_load_dwordx4 a[68:71], v1, s[12:15], s51 offen offset:1024 sc1
    v_mfma_f32_16x16x32_bf16 v[116:119], a[44:47], v[216:219], v[116:119]
    s_add_u32 m0, s29, 16384
    ds_read_b64_tr_b16 a[18:19], v4 offset:18432
    v_mul_f32 v102, v102, v65
    v_mfma_f32_16x16x32_bf16 v[116:119], a[48:51], v[224:227], v[116:119]
    ds_read_b64_tr_b16 a[20:21], v4 offset:20480
    buffer_load_dwordx4 v2, s[8:11], s82 offen lds
    v_mfma_f32_16x16x32_bf16 v[116:119], a[52:55], v[232:235], v[116:119]
    ds_read_b64_tr_b16 a[22:23], v4 offset:22528
    v_mul_f32 v103, v103, v65
    v_mfma_f32_16x16x32_bf16 v[116:119], a[56:59], v[240:243], v[116:119]
    ds_read_b64_tr_b16 a[24:25], v4 offset:24576
    v_cvt_pk_bf16_f32 v96, v96, v97
    v_mfma_f32_16x16x32_bf16 v[116:119], a[60:63], v[248:251], v[116:119]
    s_waitcnt lgkmcnt(7)
    ds_read_b64_tr_b16 a[26:27], v4 offset:26624
    v_cvt_pk_bf16_f32 v97, v98, v99
    v_mfma_f32_16x16x32_bf16 v[72:75], a[0:3], v[128:131], 0
    ds_read_b64_tr_b16 a[28:29], v4 offset:28672
    buffer_load_dwordx4 a[72:75], v1, s[12:15], s51 offen offset:2048 sc1
    v_mfma_f32_16x16x32_bf16 v[72:75], a[4:7], v[136:139], v[72:75]
    s_add_u32 m0, s29, 20480
    ds_read_b64_tr_b16 a[30:31], v4 offset:30720
    v_xor_b32 v5, 0x10000, v5
    v_mfma_f32_16x16x32_bf16 v[72:75], a[8:11], v[144:147], v[72:75]
    s_waitcnt lgkmcnt(4)
    ds_read_b64_tr_b16 a[32:33], v5 offset:0
    buffer_load_dwordx4 v2, s[8:11], s83 offen lds
    v_mfma_f32_16x16x32_bf16 v[72:75], a[12:15], v[152:155], v[72:75]
    ds_read_b64_tr_b16 a[34:35], v5 offset:2048
    v_cvt_pk_bf16_f32 v98, v100, v101
    v_mfma_f32_16x16x32_bf16 v[72:75], a[16:19], v[160:163], v[72:75]
    ds_read_b64_tr_b16 a[36:37], v5 offset:4096
    v_cvt_pk_bf16_f32 v99, v102, v103
    v_mfma_f32_16x16x32_bf16 v[72:75], a[20:23], v[168:171], v[72:75]
    s_waitcnt lgkmcnt(3)
    ds_read_b64_tr_b16 a[38:39], v5 offset:6144
    v_mul_f32 v104, v104, v64
    v_mfma_f32_16x16x32_bf16 v[72:75], a[24:27], v[176:179], v[72:75]
    ds_read_b64_tr_b16 a[40:41], v5 offset:8192
    buffer_load_dwordx4 a[76:79], v1, s[12:15], s51 offen offset:3072 sc1
    v_mfma_f32_16x16x32_bf16 v[72:75], a[28:31], v[184:187], v[72:75]
    s_add_u32 m0, s29, 24576
    ds_read_b64_tr_b16 a[42:43], v5 offset:10240
    v_mul_f32 v105, v105, v64
    v_mfma_f32_16x16x32_bf16 v[80:83], a[0:3], v[192:195], 0
    ds_read_b64_tr_b16 a[44:45], v5 offset:12288
    buffer_load_dwordx4 v2, s[8:11], s84 offen lds
    v_mfma_f32_16x16x32_bf16 v[80:83], a[4:7], v[200:203], v[80:83]
    s_add_u32 s58, s48, 983040
    ds_read_b64_tr_b16 a[46:47], v5 offset:14336
    v_mul_f32 v106, v106, v64
    v_mfma_f32_16x16x32_bf16 v[80:83], a[8:11], v[208:211], v[80:83]
    ds_read_b64_tr_b16 a[48:49], v5 offset:16384
    buffer_store_dwordx4 v[96:99], v1, s[12:15], s58 offen sc1
    v_mfma_f32_16x16x32_bf16 v[80:83], a[12:15], v[216:219], v[80:83]
    s_add_u32 s51, s51, 4096
    ds_read_b64_tr_b16 a[50:51], v5 offset:18432
    v_mul_f32 v107, v107, v64
    v_mfma_f32_16x16x32_bf16 v[80:83], a[16:19], v[224:227], v[80:83]
    ds_read_b64_tr_b16 a[52:53], v5 offset:20480
    buffer_load_dwordx4 a[80:83], v1, s[12:15], s51 offen offset:0 sc1
    v_mfma_f32_16x16x32_bf16 v[80:83], a[20:23], v[232:235], v[80:83]
    s_add_u32 m0, s29, 28672
    ds_read_b64_tr_b16 a[54:55], v5 offset:22528
    v_mul_f32 v108, v108, v64
    v_mfma_f32_16x16x32_bf16 v[80:83], a[24:27], v[240:243], v[80:83]
    ds_read_b64_tr_b16 a[56:57], v5 offset:24576
    buffer_load_dwordx4 v2, s[8:11], s85 offen lds
    v_mfma_f32_16x16x32_bf16 v[80:83], a[28:31], v[248:251], v[80:83]
    s_waitcnt lgkmcnt(7)
    ds_read_b64_tr_b16 a[58:59], v5 offset:26624
    v_add_u32 v2, 128, v2
    v_mfma_f32_16x16x32_bf16 v[76:79], a[32:35], v[128:131], 0
    ds_read_b64_tr_b16 a[60:61], v5 offset:28672
    v_mul_f32 v109, v109, v64
    v_mfma_f32_16x16x32_bf16 v[76:79], a[36:39], v[136:139], v[76:79]
    ds_read_b64_tr_b16 a[62:63], v5 offset:30720
    v_xor_b32 v6, 0x10000, v6
    v_mfma_f32_16x16x32_bf16 v[76:79], a[40:43], v[144:147], v[76:79]
    s_waitcnt lgkmcnt(4)
    ds_read_b64_tr_b16 a[0:1], v6 offset:0
    buffer_load_dwordx4 a[84:87], v1, s[12:15], s51 offen offset:1024 sc1
    v_mfma_f32_16x16x32_bf16 v[76:79], a[44:47], v[152:155], v[76:79]
    ds_read_b64_tr_b16 a[2:3], v6 offset:2048
    v_mul_f32 v110, v110, v64
    v_mfma_f32_16x16x32_bf16 v[76:79], a[48:51], v[160:163], v[76:79]
    ds_read_b64_tr_b16 a[4:5], v6 offset:4096
    v_mul_f32 v111, v111, v64
    v_mfma_f32_16x16x32_bf16 v[76:79], a[52:55], v[168:171], v[76:79]
    s_waitcnt lgkmcnt(3)
    ds_read_b64_tr_b16 a[6:7], v6 offset:6144
    v_cvt_pk_bf16_f32 v104, v104, v105
    v_mfma_f32_16x16x32_bf16 v[76:79], a[56:59], v[176:179], v[76:79]
    ds_read_b64_tr_b16 a[8:9], v6 offset:8192
    v_cvt_pk_bf16_f32 v105, v106, v107
    v_mfma_f32_16x16x32_bf16 v[76:79], a[60:63], v[184:187], v[76:79]
    ds_read_b64_tr_b16 a[10:11], v6 offset:10240
    v_cvt_pk_bf16_f32 v106, v108, v109
    v_mfma_f32_16x16x32_bf16 v[84:87], a[32:35], v[192:195], 0
    ds_read_b64_tr_b16 a[12:13], v6 offset:12288
    buffer_load_dwordx4 a[88:91], v1, s[12:15], s51 offen offset:2048 sc1
    v_mfma_f32_16x16x32_bf16 v[84:87], a[36:39], v[200:203], v[84:87]
    s_add_u32 s58, s48, 81920
    ds_read_b64_tr_b16 a[14:15], v6 offset:14336
    v_cvt_pk_bf16_f32 v107, v110, v111
    v_mfma_f32_16x16x32_bf16 v[84:87], a[40:43], v[208:211], v[84:87]
    ds_read_b64_tr_b16 a[16:17], v6 offset:16384
    buffer_store_dwordx4 v[104:107], v1, s[12:15], s58 offen sc1
    v_mfma_f32_16x16x32_bf16 v[84:87], a[44:47], v[216:219], v[84:87]
    ds_read_b64_tr_b16 a[18:19], v6 offset:18432
    v_mul_f32 v112, v112, v65
    v_mfma_f32_16x16x32_bf16 v[84:87], a[48:51], v[224:227], v[84:87]
    ds_read_b64_tr_b16 a[20:21], v6 offset:20480
    v_mul_f32 v113, v113, v65
    v_mfma_f32_16x16x32_bf16 v[84:87], a[52:55], v[232:235], v[84:87]
    ds_read_b64_tr_b16 a[22:23], v6 offset:22528
    v_mul_f32 v114, v114, v65
    v_mfma_f32_16x16x32_bf16 v[84:87], a[56:59], v[240:243], v[84:87]
    ds_read_b64_tr_b16 a[24:25], v6 offset:24576
    buffer_load_dwordx4 a[92:95], v1, s[12:15], s51 offen offset:3072 sc1
    v_mfma_f32_16x16x32_bf16 v[84:87], a[60:63], v[248:251], v[84:87]
    s_waitcnt lgkmcnt(7)
    ds_read_b64_tr_b16 a[26:27], v6 offset:26624
    v_mul_f32 v115, v115, v65
    v_mfma_f32_16x16x32_bf16 v[88:91], a[0:3], v[128:131], 0
    ds_read_b64_tr_b16 a[28:29], v6 offset:28672
    v_mul_f32 v116, v116, v65
    v_mfma_f32_16x16x32_bf16 v[88:91], a[4:7], v[136:139], v[88:91]
    ds_read_b64_tr_b16 a[30:31], v6 offset:30720
    v_xor_b32 v7, 0x10000, v7
    v_mfma_f32_16x16x32_bf16 v[88:91], a[8:11], v[144:147], v[88:91]
    s_waitcnt lgkmcnt(4)
    ds_read_b64_tr_b16 a[32:33], v7 offset:0
    v_mul_f32 v117, v117, v65
    v_mfma_f32_16x16x32_bf16 v[88:91], a[12:15], v[152:155], v[88:91]
    s_add_u32 s51, s51, 4096
    ds_read_b64_tr_b16 a[34:35], v7 offset:2048
    v_mul_f32 v118, v118, v65
    v_mfma_f32_16x16x32_bf16 v[88:91], a[16:19], v[160:163], v[88:91]
    ds_read_b64_tr_b16 a[36:37], v7 offset:4096
    buffer_load_dwordx4 a[96:99], v1, s[12:15], s51 offen offset:0 sc1
    v_mfma_f32_16x16x32_bf16 v[88:91], a[20:23], v[168:171], v[88:91]
    s_waitcnt lgkmcnt(3)
    ds_read_b64_tr_b16 a[38:39], v7 offset:6144
    v_mul_f32 v119, v119, v65
    v_mfma_f32_16x16x32_bf16 v[88:91], a[24:27], v[176:179], v[88:91]
    ds_read_b64_tr_b16 a[40:41], v7 offset:8192
    v_cvt_pk_bf16_f32 v112, v112, v113
    v_mfma_f32_16x16x32_bf16 v[88:91], a[28:31], v[184:187], v[88:91]
    ds_read_b64_tr_b16 a[42:43], v7 offset:10240
    v_cvt_pk_bf16_f32 v113, v114, v115
    v_mfma_f32_16x16x32_bf16 v[96:99], a[0:3], v[192:195], 0
    ds_read_b64_tr_b16 a[44:45], v7 offset:12288
    v_cvt_pk_bf16_f32 v114, v116, v117
    v_mfma_f32_16x16x32_bf16 v[96:99], a[4:7], v[200:203], v[96:99]
    ds_read_b64_tr_b16 a[46:47], v7 offset:14336
    v_cvt_pk_bf16_f32 v115, v118, v119
    v_mfma_f32_16x16x32_bf16 v[96:99], a[8:11], v[208:211], v[96:99]
    ds_read_b64_tr_b16 a[48:49], v7 offset:16384
    buffer_load_dwordx4 a[100:103], v1, s[12:15], s51 offen offset:1024 sc1
    v_mfma_f32_16x16x32_bf16 v[96:99], a[12:15], v[216:219], v[96:99]
    s_add_u32 s58, s48, 999424
    ds_read_b64_tr_b16 a[50:51], v7 offset:18432
    v_mul_f32 v72, v72, v64
    v_mfma_f32_16x16x32_bf16 v[96:99], a[16:19], v[224:227], v[96:99]
    ds_read_b64_tr_b16 a[52:53], v7 offset:20480
    buffer_store_dwordx4 v[112:115], v1, s[12:15], s58 offen sc1
    v_mfma_f32_16x16x32_bf16 v[96:99], a[20:23], v[232:235], v[96:99]
    ds_read_b64_tr_b16 a[54:55], v7 offset:22528
    v_mul_f32 v73, v73, v64
    v_mfma_f32_16x16x32_bf16 v[96:99], a[24:27], v[240:243], v[96:99]
    ds_read_b64_tr_b16 a[56:57], v7 offset:24576
    v_mul_f32 v74, v74, v64
    v_mfma_f32_16x16x32_bf16 v[96:99], a[28:31], v[248:251], v[96:99]
    s_waitcnt lgkmcnt(7)
    ds_read_b64_tr_b16 a[58:59], v7 offset:26624
    v_mul_f32 v75, v75, v64
    v_mfma_f32_16x16x32_bf16 v[92:95], a[32:35], v[128:131], 0
    ds_read_b64_tr_b16 a[60:61], v7 offset:28672
    buffer_load_dwordx4 a[104:107], v1, s[12:15], s51 offen offset:2048 sc1
    v_mfma_f32_16x16x32_bf16 v[92:95], a[36:39], v[136:139], v[92:95]
    ds_read_b64_tr_b16 a[62:63], v7 offset:30720
    v_mul_f32 v76, v76, v64
    v_mfma_f32_16x16x32_bf16 v[92:95], a[40:43], v[144:147], v[92:95]
    s_waitcnt lgkmcnt(4)
    ds_read_b64_tr_b16 a[0:1], v4 offset:32768
    v_mul_f32 v77, v77, v64
    v_mfma_f32_16x16x32_bf16 v[92:95], a[44:47], v[152:155], v[92:95]
    ds_read_b64_tr_b16 a[2:3], v4 offset:34816
    v_mul_f32 v78, v78, v64
    v_mfma_f32_16x16x32_bf16 v[92:95], a[48:51], v[160:163], v[92:95]
    ds_read_b64_tr_b16 a[4:5], v4 offset:36864
    v_mul_f32 v79, v79, v64
    v_mfma_f32_16x16x32_bf16 v[92:95], a[52:55], v[168:171], v[92:95]
    s_waitcnt lgkmcnt(3)
    ds_read_b64_tr_b16 a[6:7], v4 offset:38912
    v_cvt_pk_bf16_f32 v72, v72, v73
    v_mfma_f32_16x16x32_bf16 v[92:95], a[56:59], v[176:179], v[92:95]
    ds_read_b64_tr_b16 a[8:9], v4 offset:40960
    buffer_load_dwordx4 a[108:111], v1, s[12:15], s51 offen offset:3072 sc1
    v_mfma_f32_16x16x32_bf16 v[92:95], a[60:63], v[184:187], v[92:95]
    ds_read_b64_tr_b16 a[10:11], v4 offset:43008
    v_cvt_pk_bf16_f32 v73, v74, v75
    v_mfma_f32_16x16x32_bf16 v[100:103], a[32:35], v[192:195], 0
    ds_read_b64_tr_b16 a[12:13], v4 offset:45056
    v_cvt_pk_bf16_f32 v74, v76, v77
    v_mfma_f32_16x16x32_bf16 v[100:103], a[36:39], v[200:203], v[100:103]
    s_add_u32 s58, s48, 98304
    ds_read_b64_tr_b16 a[14:15], v4 offset:47104
    v_cvt_pk_bf16_f32 v75, v78, v79
    v_mfma_f32_16x16x32_bf16 v[100:103], a[40:43], v[208:211], v[100:103]
    ds_read_b64_tr_b16 a[16:17], v4 offset:49152
    buffer_store_dwordx4 v[72:75], v1, s[12:15], s58 offen sc1
    v_mfma_f32_16x16x32_bf16 v[100:103], a[44:47], v[216:219], v[100:103]
    s_add_u32 s51, s51, 4096
    ds_read_b64_tr_b16 a[18:19], v4 offset:51200
    v_mul_f32 v80, v80, v65
    v_mfma_f32_16x16x32_bf16 v[100:103], a[48:51], v[224:227], v[100:103]
    ds_read_b64_tr_b16 a[20:21], v4 offset:53248
    buffer_load_dwordx4 a[112:115], v1, s[12:15], s51 offen offset:0 sc1
    v_mfma_f32_16x16x32_bf16 v[100:103], a[52:55], v[232:235], v[100:103]
    ds_read_b64_tr_b16 a[22:23], v4 offset:55296
    v_mul_f32 v81, v81, v65
    v_mfma_f32_16x16x32_bf16 v[100:103], a[56:59], v[240:243], v[100:103]
    ds_read_b64_tr_b16 a[24:25], v4 offset:57344
    v_mul_f32 v82, v82, v65
    v_mfma_f32_16x16x32_bf16 v[100:103], a[60:63], v[248:251], v[100:103]
    s_waitcnt lgkmcnt(7)
    ds_read_b64_tr_b16 a[26:27], v4 offset:59392
    v_mul_f32 v83, v83, v65
    v_mfma_f32_16x16x32_bf16 v[104:107], a[0:3], v[128:131], 0
    ds_read_b64_tr_b16 a[28:29], v4 offset:61440
    v_mul_f32 v84, v84, v65
    v_mfma_f32_16x16x32_bf16 v[104:107], a[4:7], v[136:139], v[104:107]
    ds_read_b64_tr_b16 a[30:31], v4 offset:63488
    v_mul_f32 v85, v85, v65
    v_mfma_f32_16x16x32_bf16 v[104:107], a[8:11], v[144:147], v[104:107]
    s_waitcnt lgkmcnt(4)
    ds_read_b64_tr_b16 a[32:33], v5 offset:32768
    buffer_load_dwordx4 a[116:119], v1, s[12:15], s51 offen offset:1024 sc1
    v_mfma_f32_16x16x32_bf16 v[104:107], a[12:15], v[152:155], v[104:107]
    ds_read_b64_tr_b16 a[34:35], v5 offset:34816
    v_mul_f32 v86, v86, v65
    v_mfma_f32_16x16x32_bf16 v[104:107], a[16:19], v[160:163], v[104:107]
    ds_read_b64_tr_b16 a[36:37], v5 offset:36864
    v_mul_f32 v87, v87, v65
    v_mfma_f32_16x16x32_bf16 v[104:107], a[20:23], v[168:171], v[104:107]
    s_waitcnt lgkmcnt(3)
    ds_read_b64_tr_b16 a[38:39], v5 offset:38912
    v_cvt_pk_bf16_f32 v80, v80, v81
    v_mfma_f32_16x16x32_bf16 v[104:107], a[24:27], v[176:179], v[104:107]
    ds_read_b64_tr_b16 a[40:41], v5 offset:40960
    v_cvt_pk_bf16_f32 v81, v82, v83
    v_mfma_f32_16x16x32_bf16 v[104:107], a[28:31], v[184:187], v[104:107]
    ds_read_b64_tr_b16 a[42:43], v5 offset:43008
    v_cvt_pk_bf16_f32 v82, v84, v85
    v_mfma_f32_16x16x32_bf16 v[112:115], a[0:3], v[192:195], 0
    ds_read_b64_tr_b16 a[44:45], v5 offset:45056
    buffer_load_dwordx4 a[120:123], v1, s[12:15], s51 offen offset:2048 sc1
    v_mfma_f32_16x16x32_bf16 v[112:115], a[4:7], v[200:203], v[112:115]
    s_add_u32 s58, s48, 1015808
    ds_read_b64_tr_b16 a[46:47], v5 offset:47104
    v_cvt_pk_bf16_f32 v83, v86, v87
    v_mfma_f32_16x16x32_bf16 v[112:115], a[8:11], v[208:211], v[112:115]
    ds_read_b64_tr_b16 a[48:49], v5 offset:49152
    buffer_store_dwordx4 v[80:83], v1, s[12:15], s58 offen sc1
    v_mfma_f32_16x16x32_bf16 v[112:115], a[12:15], v[216:219], v[112:115]
    ds_read_b64_tr_b16 a[50:51], v5 offset:51200
    v_mul_f32 v88, v88, v64
    v_mfma_f32_16x16x32_bf16 v[112:115], a[16:19], v[224:227], v[112:115]
    ds_read_b64_tr_b16 a[52:53], v5 offset:53248
    v_mul_f32 v89, v89, v64
    v_mfma_f32_16x16x32_bf16 v[112:115], a[20:23], v[232:235], v[112:115]
    ds_read_b64_tr_b16 a[54:55], v5 offset:55296
    v_mul_f32 v90, v90, v64
    v_mfma_f32_16x16x32_bf16 v[112:115], a[24:27], v[240:243], v[112:115]
    ds_read_b64_tr_b16 a[56:57], v5 offset:57344
    buffer_load_dwordx4 a[124:127], v1, s[12:15], s51 offen offset:3072 sc1
    v_mfma_f32_16x16x32_bf16 v[112:115], a[28:31], v[248:251], v[112:115]
    s_waitcnt lgkmcnt(7)
    ds_read_b64_tr_b16 a[58:59], v5 offset:59392
    v_mul_f32 v91, v91, v64
    v_mfma_f32_16x16x32_bf16 v[108:111], a[32:35], v[128:131], 0
    ds_read_b64_tr_b16 a[60:61], v5 offset:61440
    v_mul_f32 v92, v92, v64
    v_mfma_f32_16x16x32_bf16 v[108:111], a[36:39], v[136:139], v[108:111]
    ds_read_b64_tr_b16 a[62:63], v5 offset:63488
    v_mul_f32 v93, v93, v64
    v_mfma_f32_16x16x32_bf16 v[108:111], a[40:43], v[144:147], v[108:111]
    s_waitcnt lgkmcnt(4)
    ds_read_b64_tr_b16 a[0:1], v6 offset:32768
    v_mul_f32 v94, v94, v64
    v_mfma_f32_16x16x32_bf16 v[108:111], a[44:47], v[152:155], v[108:111]
    ds_read_b64_tr_b16 a[2:3], v6 offset:34816
    v_mul_f32 v95, v95, v64
    v_mfma_f32_16x16x32_bf16 v[108:111], a[48:51], v[160:163], v[108:111]
    ds_read_b64_tr_b16 a[4:5], v6 offset:36864
    v_cvt_pk_bf16_f32 v88, v88, v89
    v_mfma_f32_16x16x32_bf16 v[108:111], a[52:55], v[168:171], v[108:111]
    s_waitcnt lgkmcnt(3)
    ds_read_b64_tr_b16 a[6:7], v6 offset:38912
    v_cvt_pk_bf16_f32 v89, v90, v91
    v_mfma_f32_16x16x32_bf16 v[108:111], a[56:59], v[176:179], v[108:111]
    ds_read_b64_tr_b16 a[8:9], v6 offset:40960
    v_cvt_pk_bf16_f32 v90, v92, v93
    v_mfma_f32_16x16x32_bf16 v[108:111], a[60:63], v[184:187], v[108:111]
    s_add_u32 s58, s48, 114688
    ds_read_b64_tr_b16 a[10:11], v6 offset:43008
    v_cvt_pk_bf16_f32 v91, v94, v95
    v_mfma_f32_16x16x32_bf16 v[116:119], a[32:35], v[192:195], 0
    ds_read_b64_tr_b16 a[12:13], v6 offset:45056
    buffer_store_dwordx4 v[88:91], v1, s[12:15], s58 offen sc1
    v_mfma_f32_16x16x32_bf16 v[116:119], a[36:39], v[200:203], v[116:119]
    ds_read_b64_tr_b16 a[14:15], v6 offset:47104
    v_mul_f32 v96, v96, v65
    v_mfma_f32_16x16x32_bf16 v[116:119], a[40:43], v[208:211], v[116:119]
    ds_read_b64_tr_b16 a[16:17], v6 offset:49152
    v_mul_f32 v97, v97, v65
    v_mfma_f32_16x16x32_bf16 v[116:119], a[44:47], v[216:219], v[116:119]
    ds_read_b64_tr_b16 a[18:19], v6 offset:51200
    v_mul_f32 v98, v98, v65
    v_mfma_f32_16x16x32_bf16 v[116:119], a[48:51], v[224:227], v[116:119]
    ds_read_b64_tr_b16 a[20:21], v6 offset:53248
    v_mul_f32 v99, v99, v65
    v_mfma_f32_16x16x32_bf16 v[116:119], a[52:55], v[232:235], v[116:119]
    ds_read_b64_tr_b16 a[22:23], v6 offset:55296
    v_mul_f32 v100, v100, v65
    v_mfma_f32_16x16x32_bf16 v[116:119], a[56:59], v[240:243], v[116:119]
    ds_read_b64_tr_b16 a[24:25], v6 offset:57344
    v_mul_f32 v101, v101, v65
    v_mfma_f32_16x16x32_bf16 v[116:119], a[60:63], v[248:251], v[116:119]
    s_waitcnt lgkmcnt(7)
    ds_read_b64_tr_b16 a[26:27], v6 offset:59392
    v_mul_f32 v102, v102, v65
    v_mfma_f32_16x16x32_bf16 v[72:75], a[0:3], v[128:131], 0
    ds_read_b64_tr_b16 a[28:29], v6 offset:61440
    v_mul_f32 v103, v103, v65
    v_mfma_f32_16x16x32_bf16 v[72:75], a[4:7], v[136:139], v[72:75]
    ds_read_b64_tr_b16 a[30:31], v6 offset:63488
    v_cvt_pk_bf16_f32 v96, v96, v97
    v_mfma_f32_16x16x32_bf16 v[72:75], a[8:11], v[144:147], v[72:75]
    s_waitcnt lgkmcnt(4)
    ds_read_b64_tr_b16 a[32:33], v7 offset:32768
    v_cvt_pk_bf16_f32 v97, v98, v99
    v_mfma_f32_16x16x32_bf16 v[72:75], a[12:15], v[152:155], v[72:75]
    ds_read_b64_tr_b16 a[34:35], v7 offset:34816
    v_cvt_pk_bf16_f32 v98, v100, v101
    v_mfma_f32_16x16x32_bf16 v[72:75], a[16:19], v[160:163], v[72:75]
    s_add_u32 s58, s48, 1032192
    ds_read_b64_tr_b16 a[36:37], v7 offset:36864
    v_cvt_pk_bf16_f32 v99, v102, v103
    v_mfma_f32_16x16x32_bf16 v[72:75], a[20:23], v[168:171], v[72:75]
    s_waitcnt lgkmcnt(3)
    ds_read_b64_tr_b16 a[38:39], v7 offset:38912
    buffer_store_dwordx4 v[96:99], v1, s[12:15], s58 offen sc1
    v_mfma_f32_16x16x32_bf16 v[72:75], a[24:27], v[176:179], v[72:75]
    ds_read_b64_tr_b16 a[40:41], v7 offset:40960
    v_mul_f32 v104, v104, v64
    v_mfma_f32_16x16x32_bf16 v[72:75], a[28:31], v[184:187], v[72:75]
    ds_read_b64_tr_b16 a[42:43], v7 offset:43008
    v_mul_f32 v105, v105, v64
    v_mfma_f32_16x16x32_bf16 v[80:83], a[0:3], v[192:195], 0
    ds_read_b64_tr_b16 a[44:45], v7 offset:45056
    v_mul_f32 v106, v106, v64
    v_mfma_f32_16x16x32_bf16 v[80:83], a[4:7], v[200:203], v[80:83]
    ds_read_b64_tr_b16 a[46:47], v7 offset:47104
    v_mul_f32 v107, v107, v64
    v_mfma_f32_16x16x32_bf16 v[80:83], a[8:11], v[208:211], v[80:83]
    ds_read_b64_tr_b16 a[48:49], v7 offset:49152
    v_mul_f32 v108, v108, v64
    v_mfma_f32_16x16x32_bf16 v[80:83], a[12:15], v[216:219], v[80:83]
    ds_read_b64_tr_b16 a[50:51], v7 offset:51200
    v_mul_f32 v109, v109, v64
    v_mfma_f32_16x16x32_bf16 v[80:83], a[16:19], v[224:227], v[80:83]
    ds_read_b64_tr_b16 a[52:53], v7 offset:53248
    v_mul_f32 v110, v110, v64
    v_mfma_f32_16x16x32_bf16 v[80:83], a[20:23], v[232:235], v[80:83]
    ds_read_b64_tr_b16 a[54:55], v7 offset:55296
    v_mul_f32 v111, v111, v64
    v_mfma_f32_16x16x32_bf16 v[80:83], a[24:27], v[240:243], v[80:83]
    ds_read_b64_tr_b16 a[56:57], v7 offset:57344
    v_cvt_pk_bf16_f32 v104, v104, v105
    v_mfma_f32_16x16x32_bf16 v[80:83], a[28:31], v[248:251], v[80:83]
    s_waitcnt lgkmcnt(7)
    ds_read_b64_tr_b16 a[58:59], v7 offset:59392
    v_cvt_pk_bf16_f32 v105, v106, v107
    v_mfma_f32_16x16x32_bf16 v[76:79], a[32:35], v[128:131], 0
    s_waitcnt vmcnt(3)
    ds_read_b64_tr_b16 a[60:61], v7 offset:61440
    v_cvt_pk_bf16_f32 v106, v108, v109
    v_mfma_f32_16x16x32_bf16 v[76:79], a[36:39], v[136:139], v[76:79]
    s_barrier
    ds_read_b64_tr_b16 a[62:63], v7 offset:63488
    v_xor_b32 v4, 0x30000, v4
    v_mfma_f32_16x16x32_bf16 v[76:79], a[40:43], v[144:147], v[76:79]
    s_waitcnt lgkmcnt(4)
    ds_read_b64_tr_b16 a[0:1], v4 offset:0
    buffer_store_dword v9, v9, s[12:15], s93 offen offset:64 sc1
    v_mfma_f32_16x16x32_bf16 v[76:79], a[44:47], v[152:155], v[76:79]
    s_add_u32 s58, s48, 131072
    ds_read_b64_tr_b16 a[2:3], v4 offset:2048
    v_cvt_pk_bf16_f32 v107, v110, v111
    v_mfma_f32_16x16x32_bf16 v[76:79], a[48:51], v[160:163], v[76:79]
    ds_read_b64_tr_b16 a[4:5], v4 offset:4096
    buffer_store_dwordx4 v[104:107], v1, s[12:15], s58 offen sc1
    v_mfma_f32_16x16x32_bf16 v[76:79], a[52:55], v[168:171], v[76:79]
    s_waitcnt lgkmcnt(3)
    ds_read_b64_tr_b16 a[6:7], v4 offset:6144
    v_mul_f32 v112, v112, v65
    v_mfma_f32_16x16x32_bf16 v[76:79], a[56:59], v[176:179], v[76:79]
    ds_read_b64_tr_b16 a[8:9], v4 offset:8192
    v_mul_f32 v113, v113, v65
    v_mfma_f32_16x16x32_bf16 v[76:79], a[60:63], v[184:187], v[76:79]
    ds_read_b64_tr_b16 a[10:11], v4 offset:10240
    v_mul_f32 v114, v114, v65
    v_mfma_f32_16x16x32_bf16 v[84:87], a[32:35], v[192:195], 0
    ds_read_b64_tr_b16 a[12:13], v4 offset:12288
    v_mul_f32 v115, v115, v65
    v_mfma_f32_16x16x32_bf16 v[84:87], a[36:39], v[200:203], v[84:87]
    ds_read_b64_tr_b16 a[14:15], v4 offset:14336
    v_mul_f32 v116, v116, v65
    v_mfma_f32_16x16x32_bf16 v[84:87], a[40:43], v[208:211], v[84:87]
    ds_read_b64_tr_b16 a[16:17], v4 offset:16384
    v_mul_f32 v117, v117, v65
    v_mfma_f32_16x16x32_bf16 v[84:87], a[44:47], v[216:219], v[84:87]
    ds_read_b64_tr_b16 a[18:19], v4 offset:18432
    v_mul_f32 v118, v118, v65
    v_mfma_f32_16x16x32_bf16 v[84:87], a[48:51], v[224:227], v[84:87]
    ds_read_b64_tr_b16 a[20:21], v4 offset:20480
    v_mul_f32 v119, v119, v65
    v_mfma_f32_16x16x32_bf16 v[84:87], a[52:55], v[232:235], v[84:87]
    ds_read_b64_tr_b16 a[22:23], v4 offset:22528
    v_cvt_pk_bf16_f32 v112, v112, v113
    v_mfma_f32_16x16x32_bf16 v[84:87], a[56:59], v[240:243], v[84:87]
    ds_read_b64_tr_b16 a[24:25], v4 offset:24576
    v_cvt_pk_bf16_f32 v113, v114, v115
    v_mfma_f32_16x16x32_bf16 v[84:87], a[60:63], v[248:251], v[84:87]
    s_waitcnt lgkmcnt(7)
    ds_read_b64_tr_b16 a[26:27], v4 offset:26624
    v_cvt_pk_bf16_f32 v114, v116, v117
    v_mfma_f32_16x16x32_bf16 v[88:91], a[0:3], v[128:131], 0
    ds_read_b64_tr_b16 a[28:29], v4 offset:28672
    v_cvt_pk_bf16_f32 v115, v118, v119
    v_mfma_f32_16x16x32_bf16 v[88:91], a[4:7], v[136:139], v[88:91]
    s_add_u32 s58, s48, 1048576
    ds_read_b64_tr_b16 a[30:31], v4 offset:30720
    v_xor_b32 v5, 0x30000, v5
    v_mfma_f32_16x16x32_bf16 v[88:91], a[8:11], v[144:147], v[88:91]
    s_waitcnt lgkmcnt(4)
    ds_read_b64_tr_b16 a[32:33], v5 offset:0
    buffer_store_dwordx4 v[112:115], v1, s[12:15], s58 offen sc1
    v_mfma_f32_16x16x32_bf16 v[88:91], a[12:15], v[152:155], v[88:91]
    ds_read_b64_tr_b16 a[34:35], v5 offset:2048
    v_mul_f32 v72, v72, v64
    v_mfma_f32_16x16x32_bf16 v[88:91], a[16:19], v[160:163], v[88:91]
    ds_read_b64_tr_b16 a[36:37], v5 offset:4096
    v_mul_f32 v73, v73, v64
    v_mfma_f32_16x16x32_bf16 v[88:91], a[20:23], v[168:171], v[88:91]
    s_waitcnt lgkmcnt(3)
    ds_read_b64_tr_b16 a[38:39], v5 offset:6144
    v_mul_f32 v74, v74, v64
    v_mfma_f32_16x16x32_bf16 v[88:91], a[24:27], v[176:179], v[88:91]
    ds_read_b64_tr_b16 a[40:41], v5 offset:8192
    v_mul_f32 v75, v75, v64
    v_mfma_f32_16x16x32_bf16 v[88:91], a[28:31], v[184:187], v[88:91]
    ds_read_b64_tr_b16 a[42:43], v5 offset:10240
    v_mul_f32 v76, v76, v64
    v_mfma_f32_16x16x32_bf16 v[96:99], a[0:3], v[192:195], 0
    ds_read_b64_tr_b16 a[44:45], v5 offset:12288
    v_mul_f32 v77, v77, v64
    v_mfma_f32_16x16x32_bf16 v[96:99], a[4:7], v[200:203], v[96:99]
    ds_read_b64_tr_b16 a[46:47], v5 offset:14336
    v_mul_f32 v78, v78, v64
    v_mfma_f32_16x16x32_bf16 v[96:99], a[8:11], v[208:211], v[96:99]
    ds_read_b64_tr_b16 a[48:49], v5 offset:16384
    v_mul_f32 v79, v79, v64
    v_mfma_f32_16x16x32_bf16 v[96:99], a[12:15], v[216:219], v[96:99]
    ds_read_b64_tr_b16 a[50:51], v5 offset:18432
    v_cvt_pk_bf16_f32 v72, v72, v73
    v_mfma_f32_16x16x32_bf16 v[96:99], a[16:19], v[224:227], v[96:99]
    ds_read_b64_tr_b16 a[52:53], v5 offset:20480
    v_cvt_pk_bf16_f32 v73, v74, v75
    v_mfma_f32_16x16x32_bf16 v[96:99], a[20:23], v[232:235], v[96:99]
    ds_read_b64_tr_b16 a[54:55], v5 offset:22528
    v_cvt_pk_bf16_f32 v74, v76, v77
    v_mfma_f32_16x16x32_bf16 v[96:99], a[24:27], v[240:243], v[96:99]
    s_add_u32 s58, s48, 147456
    ds_read_b64_tr_b16 a[56:57], v5 offset:24576
    v_cvt_pk_bf16_f32 v75, v78, v79
    v_mfma_f32_16x16x32_bf16 v[96:99], a[28:31], v[248:251], v[96:99]
    s_waitcnt lgkmcnt(7)
    ds_read_b64_tr_b16 a[58:59], v5 offset:26624
    buffer_store_dwordx4 v[72:75], v1, s[12:15], s58 offen sc1
    v_mfma_f32_16x16x32_bf16 v[92:95], a[32:35], v[128:131], 0
    ds_read_b64_tr_b16 a[60:61], v5 offset:28672
    v_mul_f32 v80, v80, v65
    v_mfma_f32_16x16x32_bf16 v[92:95], a[36:39], v[136:139], v[92:95]
    ds_read_b64_tr_b16 a[62:63], v5 offset:30720
    v_xor_b32 v6, 0x30000, v6
    v_mfma_f32_16x16x32_bf16 v[92:95], a[40:43], v[144:147], v[92:95]
    s_waitcnt lgkmcnt(4)
    ds_read_b64_tr_b16 a[0:1], v6 offset:0
    v_mul_f32 v81, v81, v65
    v_mfma_f32_16x16x32_bf16 v[92:95], a[44:47], v[152:155], v[92:95]
    ds_read_b64_tr_b16 a[2:3], v6 offset:2048
    v_mul_f32 v82, v82, v65
    v_mfma_f32_16x16x32_bf16 v[92:95], a[48:51], v[160:163], v[92:95]
    ds_read_b64_tr_b16 a[4:5], v6 offset:4096
    v_mul_f32 v83, v83, v65
    v_mfma_f32_16x16x32_bf16 v[92:95], a[52:55], v[168:171], v[92:95]
    s_waitcnt lgkmcnt(3)
    ds_read_b64_tr_b16 a[6:7], v6 offset:6144
    v_mul_f32 v84, v84, v65
    v_mfma_f32_16x16x32_bf16 v[92:95], a[56:59], v[176:179], v[92:95]
    ds_read_b64_tr_b16 a[8:9], v6 offset:8192
    v_mul_f32 v85, v85, v65
    v_mfma_f32_16x16x32_bf16 v[92:95], a[60:63], v[184:187], v[92:95]
    ds_read_b64_tr_b16 a[10:11], v6 offset:10240
    v_mul_f32 v86, v86, v65
    v_mfma_f32_16x16x32_bf16 v[100:103], a[32:35], v[192:195], 0
    ds_read_b64_tr_b16 a[12:13], v6 offset:12288
    v_mul_f32 v87, v87, v65
    v_mfma_f32_16x16x32_bf16 v[100:103], a[36:39], v[200:203], v[100:103]
    ds_read_b64_tr_b16 a[14:15], v6 offset:14336
    v_cvt_pk_bf16_f32 v80, v80, v81
    v_mfma_f32_16x16x32_bf16 v[100:103], a[40:43], v[208:211], v[100:103]
    ds_read_b64_tr_b16 a[16:17], v6 offset:16384
    v_cvt_pk_bf16_f32 v81, v82, v83
    v_mfma_f32_16x16x32_bf16 v[100:103], a[44:47], v[216:219], v[100:103]
    ds_read_b64_tr_b16 a[18:19], v6 offset:18432
    v_cvt_pk_bf16_f32 v82, v84, v85
    v_mfma_f32_16x16x32_bf16 v[100:103], a[48:51], v[224:227], v[100:103]
    s_add_u32 s58, s48, 1064960
    ds_read_b64_tr_b16 a[20:21], v6 offset:20480
    v_cvt_pk_bf16_f32 v83, v86, v87
    v_mfma_f32_16x16x32_bf16 v[100:103], a[52:55], v[232:235], v[100:103]
    ds_read_b64_tr_b16 a[22:23], v6 offset:22528
    buffer_store_dwordx4 v[80:83], v1, s[12:15], s58 offen sc1
    v_mfma_f32_16x16x32_bf16 v[100:103], a[56:59], v[240:243], v[100:103]
    ds_read_b64_tr_b16 a[24:25], v6 offset:24576
    v_mul_f32 v88, v88, v64
    v_mfma_f32_16x16x32_bf16 v[100:103], a[60:63], v[248:251], v[100:103]
    s_waitcnt lgkmcnt(7)
    ds_read_b64_tr_b16 a[26:27], v6 offset:26624
    v_mul_f32 v89, v89, v64
    v_mfma_f32_16x16x32_bf16 v[104:107], a[0:3], v[128:131], 0
    ds_read_b64_tr_b16 a[28:29], v6 offset:28672
    v_mul_f32 v90, v90, v64
    v_mfma_f32_16x16x32_bf16 v[104:107], a[4:7], v[136:139], v[104:107]
    ds_read_b64_tr_b16 a[30:31], v6 offset:30720
    v_xor_b32 v7, 0x30000, v7
    v_mfma_f32_16x16x32_bf16 v[104:107], a[8:11], v[144:147], v[104:107]
    s_waitcnt lgkmcnt(4)
    ds_read_b64_tr_b16 a[32:33], v7 offset:0
    v_mul_f32 v91, v91, v64
    v_mfma_f32_16x16x32_bf16 v[104:107], a[12:15], v[152:155], v[104:107]
    ds_read_b64_tr_b16 a[34:35], v7 offset:2048
    v_mul_f32 v92, v92, v64
    v_mfma_f32_16x16x32_bf16 v[104:107], a[16:19], v[160:163], v[104:107]
    ds_read_b64_tr_b16 a[36:37], v7 offset:4096
    v_mul_f32 v93, v93, v64
    v_mfma_f32_16x16x32_bf16 v[104:107], a[20:23], v[168:171], v[104:107]
    s_waitcnt lgkmcnt(3)
    ds_read_b64_tr_b16 a[38:39], v7 offset:6144
    v_mul_f32 v94, v94, v64
    v_mfma_f32_16x16x32_bf16 v[104:107], a[24:27], v[176:179], v[104:107]
    ds_read_b64_tr_b16 a[40:41], v7 offset:8192
    v_mul_f32 v95, v95, v64
    v_mfma_f32_16x16x32_bf16 v[104:107], a[28:31], v[184:187], v[104:107]
    ds_read_b64_tr_b16 a[42:43], v7 offset:10240
    v_cvt_pk_bf16_f32 v88, v88, v89
    v_mfma_f32_16x16x32_bf16 v[112:115], a[0:3], v[192:195], 0
    ds_read_b64_tr_b16 a[44:45], v7 offset:12288
    v_cvt_pk_bf16_f32 v89, v90, v91
    v_mfma_f32_16x16x32_bf16 v[112:115], a[4:7], v[200:203], v[112:115]
    ds_read_b64_tr_b16 a[46:47], v7 offset:14336
    v_cvt_pk_bf16_f32 v90, v92, v93
    v_mfma_f32_16x16x32_bf16 v[112:115], a[8:11], v[208:211], v[112:115]
    s_add_u32 s58, s48, 163840
    ds_read_b64_tr_b16 a[48:49], v7 offset:16384
    v_cvt_pk_bf16_f32 v91, v94, v95
    v_mfma_f32_16x16x32_bf16 v[112:115], a[12:15], v[216:219], v[112:115]
    ds_read_b64_tr_b16 a[50:51], v7 offset:18432
    buffer_store_dwordx4 v[88:91], v1, s[12:15], s58 offen sc1
    v_mfma_f32_16x16x32_bf16 v[112:115], a[16:19], v[224:227], v[112:115]
    ds_read_b64_tr_b16 a[52:53], v7 offset:20480
    v_mul_f32 v96, v96, v65
    v_mfma_f32_16x16x32_bf16 v[112:115], a[20:23], v[232:235], v[112:115]
    ds_read_b64_tr_b16 a[54:55], v7 offset:22528
    v_mul_f32 v97, v97, v65
    v_mfma_f32_16x16x32_bf16 v[112:115], a[24:27], v[240:243], v[112:115]
    ds_read_b64_tr_b16 a[56:57], v7 offset:24576
    v_mul_f32 v98, v98, v65
    v_mfma_f32_16x16x32_bf16 v[112:115], a[28:31], v[248:251], v[112:115]
    s_waitcnt lgkmcnt(7)
    ds_read_b64_tr_b16 a[58:59], v7 offset:26624
    v_mul_f32 v99, v99, v65
    v_mfma_f32_16x16x32_bf16 v[108:111], a[32:35], v[128:131], 0
    ds_read_b64_tr_b16 a[60:61], v7 offset:28672
    v_mul_f32 v100, v100, v65
    v_mfma_f32_16x16x32_bf16 v[108:111], a[36:39], v[136:139], v[108:111]
    ds_read_b64_tr_b16 a[62:63], v7 offset:30720
    v_xor_b32 v4, 0x20000, v4
    v_mfma_f32_16x16x32_bf16 v[108:111], a[40:43], v[144:147], v[108:111]
    s_waitcnt lgkmcnt(4)
    ds_read_b64_tr_b16 a[0:1], v4 offset:0
    v_mul_f32 v101, v101, v65
    v_mfma_f32_16x16x32_bf16 v[108:111], a[44:47], v[152:155], v[108:111]
    ds_read_b64_tr_b16 a[2:3], v4 offset:2048
    v_mul_f32 v102, v102, v65
    v_mfma_f32_16x16x32_bf16 v[108:111], a[48:51], v[160:163], v[108:111]
    ds_read_b64_tr_b16 a[4:5], v4 offset:4096
    v_mul_f32 v103, v103, v65
    v_mfma_f32_16x16x32_bf16 v[108:111], a[52:55], v[168:171], v[108:111]
    s_waitcnt lgkmcnt(3)
    ds_read_b64_tr_b16 a[6:7], v4 offset:6144
    v_cvt_pk_bf16_f32 v96, v96, v97
    v_mfma_f32_16x16x32_bf16 v[108:111], a[56:59], v[176:179], v[108:111]
    ds_read_b64_tr_b16 a[8:9], v4 offset:8192
    v_cvt_pk_bf16_f32 v97, v98, v99
    v_mfma_f32_16x16x32_bf16 v[108:111], a[60:63], v[184:187], v[108:111]
    ds_read_b64_tr_b16 a[10:11], v4 offset:10240
    v_cvt_pk_bf16_f32 v98, v100, v101
    v_mfma_f32_16x16x32_bf16 v[116:119], a[32:35], v[192:195], 0
    s_add_u32 s58, s48, 1081344
    ds_read_b64_tr_b16 a[12:13], v4 offset:12288
    v_cvt_pk_bf16_f32 v99, v102, v103
    v_mfma_f32_16x16x32_bf16 v[116:119], a[36:39], v[200:203], v[116:119]
    ds_read_b64_tr_b16 a[14:15], v4 offset:14336
    buffer_store_dwordx4 v[96:99], v1, s[12:15], s58 offen sc1
    v_mfma_f32_16x16x32_bf16 v[116:119], a[40:43], v[208:211], v[116:119]
    ds_read_b64_tr_b16 a[16:17], v4 offset:16384
    v_mul_f32 v104, v104, v64
    v_mfma_f32_16x16x32_bf16 v[116:119], a[44:47], v[216:219], v[116:119]
    ds_read_b64_tr_b16 a[18:19], v4 offset:18432
    v_mul_f32 v105, v105, v64
    v_mfma_f32_16x16x32_bf16 v[116:119], a[48:51], v[224:227], v[116:119]
    ds_read_b64_tr_b16 a[20:21], v4 offset:20480
    v_mul_f32 v106, v106, v64
    v_mfma_f32_16x16x32_bf16 v[116:119], a[52:55], v[232:235], v[116:119]
    ds_read_b64_tr_b16 a[22:23], v4 offset:22528
    v_mul_f32 v107, v107, v64
    v_mfma_f32_16x16x32_bf16 v[116:119], a[56:59], v[240:243], v[116:119]
    ds_read_b64_tr_b16 a[24:25], v4 offset:24576
    v_mul_f32 v108, v108, v64
    v_mfma_f32_16x16x32_bf16 v[116:119], a[60:63], v[248:251], v[116:119]
    s_waitcnt lgkmcnt(7)
    ds_read_b64_tr_b16 a[26:27], v4 offset:26624
    v_mul_f32 v109, v109, v64
    v_mfma_f32_16x16x32_bf16 v[72:75], a[0:3], v[128:131], 0
    ds_read_b64_tr_b16 a[28:29], v4 offset:28672
    v_mul_f32 v110, v110, v64
    v_mfma_f32_16x16x32_bf16 v[72:75], a[4:7], v[136:139], v[72:75]
    ds_read_b64_tr_b16 a[30:31], v4 offset:30720
    v_xor_b32 v5, 0x20000, v5
    v_mfma_f32_16x16x32_bf16 v[72:75], a[8:11], v[144:147], v[72:75]
    s_waitcnt lgkmcnt(4)
    ds_read_b64_tr_b16 a[32:33], v5 offset:0
    v_mul_f32 v111, v111, v64
    v_mfma_f32_16x16x32_bf16 v[72:75], a[12:15], v[152:155], v[72:75]
    ds_read_b64_tr_b16 a[34:35], v5 offset:2048
    v_cvt_pk_bf16_f32 v104, v104, v105
    v_mfma_f32_16x16x32_bf16 v[72:75], a[16:19], v[160:163], v[72:75]
    ds_read_b64_tr_b16 a[36:37], v5 offset:4096
    v_cvt_pk_bf16_f32 v105, v106, v107
    v_mfma_f32_16x16x32_bf16 v[72:75], a[20:23], v[168:171], v[72:75]
    s_waitcnt lgkmcnt(3)
    ds_read_b64_tr_b16 a[38:39], v5 offset:6144
    v_cvt_pk_bf16_f32 v106, v108, v109
    v_mfma_f32_16x16x32_bf16 v[72:75], a[24:27], v[176:179], v[72:75]
    s_add_u32 s58, s48, 180224
    ds_read_b64_tr_b16 a[40:41], v5 offset:8192
    v_cvt_pk_bf16_f32 v107, v110, v111
    v_mfma_f32_16x16x32_bf16 v[72:75], a[28:31], v[184:187], v[72:75]
    ds_read_b64_tr_b16 a[42:43], v5 offset:10240
    buffer_store_dwordx4 v[104:107], v1, s[12:15], s58 offen sc1
    v_mfma_f32_16x16x32_bf16 v[80:83], a[0:3], v[192:195], 0
    ds_read_b64_tr_b16 a[44:45], v5 offset:12288
    v_mul_f32 v112, v112, v65
    v_mfma_f32_16x16x32_bf16 v[80:83], a[4:7], v[200:203], v[80:83]
    ds_read_b64_tr_b16 a[46:47], v5 offset:14336
    v_mul_f32 v113, v113, v65
    v_mfma_f32_16x16x32_bf16 v[80:83], a[8:11], v[208:211], v[80:83]
    ds_read_b64_tr_b16 a[48:49], v5 offset:16384
    v_mul_f32 v114, v114, v65
    v_mfma_f32_16x16x32_bf16 v[80:83], a[12:15], v[216:219], v[80:83]
    ds_read_b64_tr_b16 a[50:51], v5 offset:18432
    v_mul_f32 v115, v115, v65
    v_mfma_f32_16x16x32_bf16 v[80:83], a[16:19], v[224:227], v[80:83]
    ds_read_b64_tr_b16 a[52:53], v5 offset:20480
    v_mul_f32 v116, v116, v65
    v_mfma_f32_16x16x32_bf16 v[80:83], a[20:23], v[232:235], v[80:83]
    ds_read_b64_tr_b16 a[54:55], v5 offset:22528
    v_mul_f32 v117, v117, v65
    v_mfma_f32_16x16x32_bf16 v[80:83], a[24:27], v[240:243], v[80:83]
    ds_read_b64_tr_b16 a[56:57], v5 offset:24576
    v_mul_f32 v118, v118, v65
    v_mfma_f32_16x16x32_bf16 v[80:83], a[28:31], v[248:251], v[80:83]
    s_waitcnt lgkmcnt(7)
    ds_read_b64_tr_b16 a[58:59], v5 offset:26624
    v_mul_f32 v119, v119, v65
    v_mfma_f32_16x16x32_bf16 v[76:79], a[32:35], v[128:131], 0
    ds_read_b64_tr_b16 a[60:61], v5 offset:28672
    v_cvt_pk_bf16_f32 v112, v112, v113
    v_mfma_f32_16x16x32_bf16 v[76:79], a[36:39], v[136:139], v[76:79]
    ds_read_b64_tr_b16 a[62:63], v5 offset:30720
    v_xor_b32 v6, 0x20000, v6
    v_mfma_f32_16x16x32_bf16 v[76:79], a[40:43], v[144:147], v[76:79]
    s_waitcnt lgkmcnt(4)
    ds_read_b64_tr_b16 a[0:1], v6 offset:0
    v_cvt_pk_bf16_f32 v113, v114, v115
    v_mfma_f32_16x16x32_bf16 v[76:79], a[44:47], v[152:155], v[76:79]
    ds_read_b64_tr_b16 a[2:3], v6 offset:2048
    v_cvt_pk_bf16_f32 v114, v116, v117
    v_mfma_f32_16x16x32_bf16 v[76:79], a[48:51], v[160:163], v[76:79]
    s_add_u32 s58, s48, 1097728
    ds_read_b64_tr_b16 a[4:5], v6 offset:4096
    v_cvt_pk_bf16_f32 v115, v118, v119
    v_mfma_f32_16x16x32_bf16 v[76:79], a[52:55], v[168:171], v[76:79]
    s_waitcnt lgkmcnt(3)
    ds_read_b64_tr_b16 a[6:7], v6 offset:6144
    buffer_store_dwordx4 v[112:115], v1, s[12:15], s58 offen sc1
    v_mfma_f32_16x16x32_bf16 v[76:79], a[56:59], v[176:179], v[76:79]
    ds_read_b64_tr_b16 a[8:9], v6 offset:8192
    v_mul_f32 v72, v72, v64
    v_mfma_f32_16x16x32_bf16 v[76:79], a[60:63], v[184:187], v[76:79]
    ds_read_b64_tr_b16 a[10:11], v6 offset:10240
    v_mul_f32 v73, v73, v64
    v_mfma_f32_16x16x32_bf16 v[84:87], a[32:35], v[192:195], 0
    ds_read_b64_tr_b16 a[12:13], v6 offset:12288
    buffer_load_dword v12, v10, s[12:15], s44 offen sc1
    v_mfma_f32_16x16x32_bf16 v[84:87], a[36:39], v[200:203], v[84:87]
    ds_read_b64_tr_b16 a[14:15], v6 offset:14336
    v_mul_f32 v74, v74, v64
    v_mfma_f32_16x16x32_bf16 v[84:87], a[40:43], v[208:211], v[84:87]
    ds_read_b64_tr_b16 a[16:17], v6 offset:16384
    v_mul_f32 v75, v75, v64
    v_mfma_f32_16x16x32_bf16 v[84:87], a[44:47], v[216:219], v[84:87]
    ds_read_b64_tr_b16 a[18:19], v6 offset:18432
    v_mul_f32 v80, v80, v65
    v_mfma_f32_16x16x32_bf16 v[84:87], a[48:51], v[224:227], v[84:87]
    ds_read_b64_tr_b16 a[20:21], v6 offset:20480
    v_mul_f32 v76, v76, v64
    v_mfma_f32_16x16x32_bf16 v[84:87], a[52:55], v[232:235], v[84:87]
    ds_read_b64_tr_b16 a[22:23], v6 offset:22528
    v_mul_f32 v77, v77, v64
    v_mfma_f32_16x16x32_bf16 v[84:87], a[56:59], v[240:243], v[84:87]
    ds_read_b64_tr_b16 a[24:25], v6 offset:24576
    v_mul_f32 v78, v78, v64
    v_mfma_f32_16x16x32_bf16 v[84:87], a[60:63], v[248:251], v[84:87]
    s_waitcnt lgkmcnt(7)
    ds_read_b64_tr_b16 a[26:27], v6 offset:26624
    v_mul_f32 v79, v79, v64
    v_mfma_f32_16x16x32_bf16 v[88:91], a[0:3], v[128:131], 0
    ds_read_b64_tr_b16 a[28:29], v6 offset:28672
    v_cvt_pk_bf16_f32 v72, v72, v73
    v_mfma_f32_16x16x32_bf16 v[88:91], a[4:7], v[136:139], v[88:91]
    ds_read_b64_tr_b16 a[30:31], v6 offset:30720
    v_xor_b32 v7, 0x20000, v7
    v_mfma_f32_16x16x32_bf16 v[88:91], a[8:11], v[144:147], v[88:91]
    s_waitcnt lgkmcnt(4)
    ds_read_b64_tr_b16 a[32:33], v7 offset:0
    v_cvt_pk_bf16_f32 v73, v74, v75
    v_mfma_f32_16x16x32_bf16 v[88:91], a[12:15], v[152:155], v[88:91]
    ds_read_b64_tr_b16 a[34:35], v7 offset:2048
    v_cvt_pk_bf16_f32 v74, v76, v77
    v_mfma_f32_16x16x32_bf16 v[88:91], a[16:19], v[160:163], v[88:91]
    s_add_u32 s58, s48, 196608
    ds_read_b64_tr_b16 a[36:37], v7 offset:4096
    v_cvt_pk_bf16_f32 v75, v78, v79
    v_mfma_f32_16x16x32_bf16 v[88:91], a[20:23], v[168:171], v[88:91]
    s_waitcnt lgkmcnt(3)
    ds_read_b64_tr_b16 a[38:39], v7 offset:6144
    buffer_store_dwordx4 v[72:75], v1, s[12:15], s58 offen sc1
    v_mfma_f32_16x16x32_bf16 v[88:91], a[24:27], v[176:179], v[88:91]
    ds_read_b64_tr_b16 a[40:41], v7 offset:8192
    v_mul_f32 v81, v81, v65
    v_mfma_f32_16x16x32_bf16 v[88:91], a[28:31], v[184:187], v[88:91]
    ds_read_b64_tr_b16 a[42:43], v7 offset:10240
    v_mul_f32 v82, v82, v65
    v_mfma_f32_16x16x32_bf16 v[96:99], a[0:3], v[192:195], 0
    ds_read_b64_tr_b16 a[44:45], v7 offset:12288
    v_mul_f32 v83, v83, v65
    v_mfma_f32_16x16x32_bf16 v[96:99], a[4:7], v[200:203], v[96:99]
    ds_read_b64_tr_b16 a[46:47], v7 offset:14336
    v_mul_f32 v84, v84, v65
    v_mfma_f32_16x16x32_bf16 v[96:99], a[8:11], v[208:211], v[96:99]
    ds_read_b64_tr_b16 a[48:49], v7 offset:16384
    v_mul_f32 v85, v85, v65
    v_mfma_f32_16x16x32_bf16 v[96:99], a[12:15], v[216:219], v[96:99]
    ds_read_b64_tr_b16 a[50:51], v7 offset:18432
    v_mul_f32 v86, v86, v65
    v_mfma_f32_16x16x32_bf16 v[96:99], a[16:19], v[224:227], v[96:99]
    ds_read_b64_tr_b16 a[52:53], v7 offset:20480
    v_mul_f32 v87, v87, v65
    v_mfma_f32_16x16x32_bf16 v[96:99], a[20:23], v[232:235], v[96:99]
    ds_read_b64_tr_b16 a[54:55], v7 offset:22528
    v_cvt_pk_bf16_f32 v80, v80, v81
    v_mfma_f32_16x16x32_bf16 v[96:99], a[24:27], v[240:243], v[96:99]
    ds_read_b64_tr_b16 a[56:57], v7 offset:24576
    v_cvt_pk_bf16_f32 v81, v82, v83
    v_mfma_f32_16x16x32_bf16 v[96:99], a[28:31], v[248:251], v[96:99]
    s_waitcnt lgkmcnt(7)
    ds_read_b64_tr_b16 a[58:59], v7 offset:26624
    v_cvt_pk_bf16_f32 v82, v84, v85
    v_mfma_f32_16x16x32_bf16 v[92:95], a[32:35], v[128:131], 0
    s_add_u32 s58, s48, 1114112
    ds_read_b64_tr_b16 a[60:61], v7 offset:28672
    v_cvt_pk_bf16_f32 v83, v86, v87
    v_mfma_f32_16x16x32_bf16 v[92:95], a[36:39], v[136:139], v[92:95]
    ds_read_b64_tr_b16 a[62:63], v7 offset:30720
    buffer_store_dwordx4 v[80:83], v1, s[12:15], s58 offen sc1
    v_mfma_f32_16x16x32_bf16 v[92:95], a[40:43], v[144:147], v[92:95]
    s_waitcnt lgkmcnt(4)
    v_mul_f32 v88, v88, v64
    v_mul_f32 v89, v89, v64
    v_mfma_f32_16x16x32_bf16 v[92:95], a[44:47], v[152:155], v[92:95]
    v_mul_f32 v90, v90, v64
    v_mul_f32 v91, v91, v64
    v_mfma_f32_16x16x32_bf16 v[92:95], a[48:51], v[160:163], v[92:95]
    v_mul_f32 v96, v96, v65
    v_mul_f32 v97, v97, v65
    v_mfma_f32_16x16x32_bf16 v[92:95], a[52:55], v[168:171], v[92:95]
    s_waitcnt lgkmcnt(0)
    v_mul_f32 v98, v98, v65
    v_mul_f32 v99, v99, v65
    v_mfma_f32_16x16x32_bf16 v[92:95], a[56:59], v[176:179], v[92:95]
    v_mfma_f32_16x16x32_bf16 v[92:95], a[60:63], v[184:187], v[92:95]
    v_mfma_f32_16x16x32_bf16 v[100:103], a[32:35], v[192:195], 0
    v_mfma_f32_16x16x32_bf16 v[100:103], a[36:39], v[200:203], v[100:103]
    v_mfma_f32_16x16x32_bf16 v[100:103], a[40:43], v[208:211], v[100:103]
    v_mfma_f32_16x16x32_bf16 v[100:103], a[44:47], v[216:219], v[100:103]
    v_mfma_f32_16x16x32_bf16 v[100:103], a[48:51], v[224:227], v[100:103]
    v_mfma_f32_16x16x32_bf16 v[100:103], a[52:55], v[232:235], v[100:103]
    v_mfma_f32_16x16x32_bf16 v[100:103], a[56:59], v[240:243], v[100:103]
    v_mfma_f32_16x16x32_bf16 v[100:103], a[60:63], v[248:251], v[100:103]
    s_nop 4
    v_mul_f32 v92, v92, v64
    v_mul_f32 v93, v93, v64
    v_mul_f32 v94, v94, v64
    v_mul_f32 v95, v95, v64
    v_cvt_pk_bf16_f32 v88, v88, v89
    v_cvt_pk_bf16_f32 v89, v90, v91
    v_cvt_pk_bf16_f32 v90, v92, v93
    v_cvt_pk_bf16_f32 v91, v94, v95
    s_add_u32 s58, s48, 212992
    buffer_store_dwordx4 v[88:91], v1, s[12:15], s58 offen sc1
    v_mul_f32 v100, v100, v65
    v_mul_f32 v101, v101, v65
    v_mul_f32 v102, v102, v65
    v_mul_f32 v103, v103, v65
    v_cvt_pk_bf16_f32 v96, v96, v97
    v_cvt_pk_bf16_f32 v97, v98, v99
    v_cvt_pk_bf16_f32 v98, v100, v101
    v_cvt_pk_bf16_f32 v99, v102, v103
    s_add_u32 s58, s48, 1130496
    buffer_store_dwordx4 v[96:99], v1, s[12:15], s58 offen sc1
    s_cmp_ge_u32 s28, 14
    s_cbranch_scc1 L_idle
    s_waitcnt vmcnt(4)
    v_cmp_ne_u32 vcc, 0, v12
    s_cmp_eq_u64 vcc, 0
    s_cselect_b32 s50, 1, 0
    s_cselect_b32 s51, s38, 2.0
    buffer_load_dwordx4 a[128:131], v1, s[12:15], s51 offen offset:0 sc1
    s_lshl_b32 s42, s42, 4
    s_lshl_b32 s36, s41, 6
    s_add_u32 s36, s36, 896
    s_add_u32 s35, s36, 1835008
    s_add_u32 s39, s37, 14680064
    buffer_load_dwordx4 a[132:135], v1, s[12:15], s51 offen offset:1024 sc1
    s_mov_b32 s8, s88
    s_mov_b32 s9, s89
    s_mov_b32 s10, 3670016
    s_mov_b32 s11, 0x20000
    buffer_load_dwordx4 a[136:139], v1, s[12:15], s51 offen offset:2048 sc1
    v_and_b32 v2, 15, v0
    v_add_u32 v2, s42, v2
    v_mul_u32_u24 v7, 896, v2
    v_lshrrev_b32 v3, 4, v0
    buffer_load_dwordx4 a[140:143], v1, s[12:15], s51 offen offset:3072 sc1
    v_lshlrev_b32 v8, 4, v3
    v_lshl_add_u32 v2, v7, 1, v8
    v_add_u32 v7, v7, v8
    v_and_b32 v4, 1, v0
    v_lshlrev_b32 v4, 4, v4
    s_add_u32 s51, s51, 4096
    v_mov_b32 v5, 0x3f80
    v_lshlrev_b32 v4, v4, v5
    v_bfe_u32 v5, v0, 3, 1
    v_bfe_u32 v6, v0, 1, 1
    buffer_load_dwordx4 a[144:147], v1, s[12:15], s51 offen offset:0 sc1
    v_lshl_add_u32 v5, v5, 1, v6
    v_bfe_u32 v6, v0, 2, 1
    v_lshlrev_b32 v6, 1, v6
    v_sub_u32 v6, v3, v6
    buffer_load_dwordx4 a[148:151], v1, s[12:15], s51 offen offset:1024 sc1
    v_lshl_add_u32 v5, v6, 2, v5
    v_cmp_eq_u32 s[16:17], 0, v5
    v_cmp_eq_u32 s[18:19], 1, v5
    v_cmp_eq_u32 s[20:21], 2, v5
    v_cmp_eq_u32 s[22:23], 3, v5
    buffer_load_dwordx4 a[152:155], v1, s[12:15], s51 offen offset:2048 sc1
    v_cndmask_b32 v24, 0, v4, s[16:17]
    v_cndmask_b32 v25, 0, v4, s[18:19]
    v_cndmask_b32 v26, 0, v4, s[20:21]
    v_cndmask_b32 v27, 0, v4, s[22:23]
    buffer_load_dwordx4 a[156:159], v1, s[12:15], s51 offen offset:3072 sc1
    v_cmp_eq_u32 s[16:17], 4, v5
    v_cmp_eq_u32 s[18:19], 5, v5
    v_cmp_eq_u32 s[20:21], 6, v5
    v_cmp_eq_u32 s[22:23], 7, v5
    s_add_u32 s51, s51, 4096
    v_cndmask_b32 v28, 0, v4, s[16:17]
    v_cndmask_b32 v29, 0, v4, s[18:19]
    v_cndmask_b32 v30, 0, v4, s[20:21]
    v_cndmask_b32 v31, 0, v4, s[22:23]
    s_add_u32 s45, s44, 1024
    s_add_u32 s39, s39, 114688
    s_waitcnt vmcnt(8)
    s_barrier
    buffer_store_dword v9, v9, s[12:15], s93 offen sc1
    buffer_load_dwordx4 a[160:163], v1, s[12:15], s51 offen offset:0 sc1
    buffer_load_dwordx4 a[164:167], v1, s[12:15], s51 offen offset:1024 sc1
    buffer_load_dwordx4 a[168:171], v1, s[12:15], s51 offen offset:2048 sc1
    buffer_load_dwordx4 a[172:175], v1, s[12:15], s51 offen offset:3072 sc1
    s_add_u32 s51, s51, 4096
    buffer_load_dwordx4 a[176:179], v1, s[12:15], s51 offen offset:0 sc1
    buffer_load_dwordx4 a[180:183], v1, s[12:15], s51 offen offset:1024 sc1
    buffer_load_dwordx4 a[184:187], v1, s[12:15], s51 offen offset:2048 sc1
    buffer_load_dwordx4 a[188:191], v1, s[12:15], s51 offen offset:3072 sc1
    s_add_u32 s51, s51, 4096
    s_and_b32 s51, s49, s50
    s_cbranch_scc1 L_haveshort
    v_and_b32 v16, 15, v0
    v_lshlrev_b32 v16, 2, v16
    s_mov_b32 s32, 0
L_poll4:
    buffer_load_dword v17, v16, s[12:15], s44 offen sc1
    s_waitcnt vmcnt(0)
    v_cmp_ne_u32 vcc, 0, v17
    s_cbranch_vccz L_poll4_ok
    s_sleep 8
    s_add_u32 s32, s32, 1
    s_cmp_lt_u32 s32, 0x80000
    s_cbranch_scc1 L_poll4
L_poll4_ok:
    s_cmp_eq_u32 s49, 1
    s_cbranch_scc1 L_have1
    buffer_load_dwordx4 a[64:67], v1, s[12:15], s37 offen offset:0 sc1
    buffer_load_dwordx4 a[68:71], v1, s[12:15], s37 offen offset:1024 sc1
    buffer_load_dwordx4 a[72:75], v1, s[12:15], s37 offen offset:2048 sc1
    buffer_load_dwordx4 a[76:79], v1, s[12:15], s37 offen offset:3072 sc1
    s_add_u32 s37, s37, 4096
    buffer_load_dwordx4 a[80:83], v1, s[12:15], s37 offen offset:0 sc1
    buffer_load_dwordx4 a[84:87], v1, s[12:15], s37 offen offset:1024 sc1
    buffer_load_dwordx4 a[88:91], v1, s[12:15], s37 offen offset:2048 sc1
    buffer_load_dwordx4 a[92:95], v1, s[12:15], s37 offen offset:3072 sc1
    s_add_u32 s37, s37, 4096
    buffer_load_dwordx4 a[96:99], v1, s[12:15], s37 offen offset:0 sc1
    buffer_load_dwordx4 a[100:103], v1, s[12:15], s37 offen offset:1024 sc1
    buffer_load_dwordx4 a[104:107], v1, s[12:15], s37 offen offset:2048 sc1
    buffer_load_dwordx4 a[108:111], v1, s[12:15], s37 offen offset:3072 sc1
    s_add_u32 s37, s37, 4096
    buffer_load_dwordx4 a[112:115], v1, s[12:15], s37 offen offset:0 sc1
    buffer_load_dwordx4 a[116:119], v1, s[12:15], s37 offen offset:1024 sc1
    buffer_load_dwordx4 a[120:123], v1, s[12:15], s37 offen offset:2048 sc1
    buffer_load_dwordx4 a[124:127], v1, s[12:15], s37 offen offset:3072 sc1
    s_add_u32 s37, s37, 4096
L_have1:
    s_cmp_eq_u32 s50, 1
    s_cbranch_scc1 L_have2
    buffer_load_dwordx4 a[128:131], v1, s[12:15], s38 offen offset:0 sc1
    buffer_load_dwordx4 a[132:135], v1, s[12:15], s38 offen offset:1024 sc1
    buffer_load_dwordx4 a[136:139], v1, s[12:15], s38 offen offset:2048 sc1
    buffer_load_dwordx4 a[140:143], v1, s[12:15], s38 offen offset:3072 sc1
    s_add_u32 s38, s38, 4096
    buffer_load_dwordx4 a[144:147], v1, s[12:15], s38 offen offset:0 sc1
    buffer_load_dwordx4 a[148:151], v1, s[12:15], s38 offen offset:1024 sc1
    buffer_load_dwordx4 a[152:155], v1, s[12:15], s38 offen offset:2048 sc1
    buffer_load_dwordx4 a[156:159], v1, s[12:15], s38 offen offset:3072 sc1
    s_add_u32 s38, s38, 4096
    buffer_load_dwordx4 a[160:163], v1, s[12:15], s38 offen offset:0 sc1
    buffer_load_dwordx4 a[164:167], v1, s[12:15], s38 offen offset:1024 sc1
    buffer_load_dwordx4 a[168:171], v1, s[12:15], s38 offen offset:2048 sc1
    buffer_load_dwordx4 a[172:175], v1, s[12:15], s38 offen offset:3072 sc1
    s_add_u32 s38, s38, 4096
    buffer_load_dwordx4 a[176:179], v1, s[12:15], s38 offen offset:0 sc1
    buffer_load_dwordx4 a[180:183], v1, s[12:15], s38 offen offset:1024 sc1
    buffer_load_dwordx4 a[184:187], v1, s[12:15], s38 offen offset:2048 sc1
    buffer_load_dwordx4 a[188:191], v1, s[12:15], s38 offen offset:3072 sc1
    s_add_u32 s38, s38, 4096
L_have2:
    s_waitcnt vmcnt(0)
L_haveshort:
    v_mfma_f32_16x16x32_bf16 v[32:35], v[24:27], a[64:67], 0
    v_mfma_f32_16x16x32_bf16 v[36:39], v[28:31], a[64:67], 0
    v_mfma_f32_16x16x32_bf16 v[32:35], v[24:27], a[68:71], v[32:35]
    v_mfma_f32_16x16x32_bf16 v[36:39], v[28:31], a[68:71], v[36:39]
    v_mfma_f32_16x16x32_bf16 v[32:35], v[24:27], a[72:75], v[32:35]
    v_mfma_f32_16x16x32_bf16 v[36:39], v[28:31], a[72:75], v[36:39]
    v_mfma_f32_16x16x32_bf16 v[32:35], v[24:27], a[76:79], v[32:35]
    v_mfma_f32_16x16x32_bf16 v[36:39], v[28:31], a[76:79], v[36:39]
    v_mfma_f32_16x16x32_bf16 v[32:35], v[24:27], a[80:83], v[32:35]
    v_mfma_f32_16x16x32_bf16 v[36:39], v[28:31], a[80:83], v[36:39]
    v_mfma_f32_16x16x32_bf16 v[32:35], v[24:27], a[84:87], v[32:35]
    v_mfma_f32_16x16x32_bf16 v[36:39], v[28:31], a[84:87], v[36:39]
    v_mfma_f32_16x16x32_bf16 v[32:35], v[24:27], a[88:91], v[32:35]
    v_mfma_f32_16x16x32_bf16 v[36:39], v[28:31], a[88:91], v[36:39]
    v_mfma_f32_16x16x32_bf16 v[32:35], v[24:27], a[92:95], v[32:35]
    v_mfma_f32_16x16x32_bf16 v[36:39], v[28:31], a[92:95], v[36:39]
    v_mfma_f32_16x16x32_bf16 v[32:35], v[24:27], a[96:99], v[32:35]
    v_mfma_f32_16x16x32_bf16 v[36:39], v[28:31], a[96:99], v[36:39]
    v_mfma_f32_16x16x32_bf16 v[32:35], v[24:27], a[100:103], v[32:35]
    v_mfma_f32_16x16x32_bf16 v[36:39], v[28:31], a[100:103], v[36:39]
    v_mfma_f32_16x16x32_bf16 v[32:35], v[24:27], a[104:107], v[32:35]
    v_mfma_f32_16x16x32_bf16 v[36:39], v[28:31], a[104:107], v[36:39]
    v_mfma_f32_16x16x32_bf16 v[32:35], v[24:27], a[108:111], v[32:35]
    v_mfma_f32_16x16x32_bf16 v[36:39], v[28:31], a[108:111], v[36:39]
    v_mfma_f32_16x16x32_bf16 v[32:35], v[24:27], a[112:115], v[32:35]
    v_mfma_f32_16x16x32_bf16 v[36:39], v[28:31], a[112:115], v[36:39]
    v_mfma_f32_16x16x32_bf16 v[32:35], v[24:27], a[116:119], v[32:35]
    v_mfma_f32_16x16x32_bf16 v[36:39], v[28:31], a[116:119], v[36:39]
    v_mfma_f32_16x16x32_bf16 v[32:35], v[24:27], a[120:123], v[32:35]
    v_mfma_f32_16x16x32_bf16 v[36:39], v[28:31], a[120:123], v[36:39]
    v_mfma_f32_16x16x32_bf16 v[32:35], v[24:27], a[124:127], v[32:35]
    v_mfma_f32_16x16x32_bf16 v[36:39], v[28:31], a[124:127], v[36:39]
    v_and_b32 v17, 15, v0
    v_lshlrev_b32 v17, 2, v17
    buffer_load_dword a246, v17, s[12:15], s45 offen sc1
    s_waitcnt vmcnt(16)
    v_mfma_f32_16x16x32_bf16 v[40:43], v[24:27], a[128:131], 0
    v_mfma_f32_16x16x32_bf16 v[44:47], v[28:31], a[128:131], 0
    s_waitcnt vmcnt(15)
    v_mfma_f32_16x16x32_bf16 v[40:43], v[24:27], a[132:135], v[40:43]
    v_mfma_f32_16x16x32_bf16 v[44:47], v[28:31], a[132:135], v[44:47]
    s_waitcnt vmcnt(14)
    v_mfma_f32_16x16x32_bf16 v[40:43], v[24:27], a[136:139], v[40:43]
    v_mfma_f32_16x16x32_bf16 v[44:47], v[28:31], a[136:139], v[44:47]
    s_waitcnt vmcnt(13)
    v_mfma_f32_16x16x32_bf16 v[40:43], v[24:27], a[140:143], v[40:43]
    v_mfma_f32_16x16x32_bf16 v[44:47], v[28:31], a[140:143], v[44:47]
    s_waitcnt vmcnt(12)
    v_mfma_f32_16x16x32_bf16 v[40:43], v[24:27], a[144:147], v[40:43]
    v_mfma_f32_16x16x32_bf16 v[44:47], v[28:31], a[144:147], v[44:47]
    s_waitcnt vmcnt(11)
    v_mfma_f32_16x16x32_bf16 v[40:43], v[24:27], a[148:151], v[40:43]
    v_mfma_f32_16x16x32_bf16 v[44:47], v[28:31], a[148:151], v[44:47]
    s_waitcnt vmcnt(10)
    v_mfma_f32_16x16x32_bf16 v[40:43], v[24:27], a[152:155], v[40:43]
    v_mfma_f32_16x16x32_bf16 v[44:47], v[28:31], a[152:155], v[44:47]
    s_waitcnt vmcnt(9)
    v_mfma_f32_16x16x32_bf16 v[40:43], v[24:27], a[156:159], v[40:43]
    v_mfma_f32_16x16x32_bf16 v[44:47], v[28:31], a[156:159], v[44:47]
    s_waitcnt vmcnt(8)
    v_mfma_f32_16x16x32_bf16 v[40:43], v[24:27], a[160:163], v[40:43]
    v_mfma_f32_16x16x32_bf16 v[44:47], v[28:31], a[160:163], v[44:47]
    s_waitcnt vmcnt(7)
    v_mfma_f32_16x16x32_bf16 v[40:43], v[24:27], a[164:167], v[40:43]
    v_mfma_f32_16x16x32_bf16 v[44:47], v[28:31], a[164:167], v[44:47]
    s_waitcnt vmcnt(6)
    v_mfma_f32_16x16x32_bf16 v[40:43], v[24:27], a[168:171], v[40:43]
    v_mfma_f32_16x16x32_bf16 v[44:47], v[28:31], a[168:171], v[44:47]
    s_waitcnt vmcnt(5)
    v_mfma_f32_16x16x32_bf16 v[40:43], v[24:27], a[172:175], v[40:43]
    v_mfma_f32_16x16x32_bf16 v[44:47], v[28:31], a[172:175], v[44:47]
    s_waitcnt vmcnt(4)
    v_mfma_f32_16x16x32_bf16 v[40:43], v[24:27], a[176:179], v[40:43]
    v_mfma_f32_16x16x32_bf16 v[44:47], v[28:31], a[176:179], v[44:47]
    s_waitcnt vmcnt(3)
    v_mfma_f32_16x16x32_bf16 v[40:43], v[24:27], a[180:183], v[40:43]
    v_mfma_f32_16x16x32_bf16 v[44:47], v[28:31], a[180:183], v[44:47]
    s_waitcnt vmcnt(2)
    v_mfma_f32_16x16x32_bf16 v[40:43], v[24:27], a[184:187], v[40:43]
    v_mfma_f32_16x16x32_bf16 v[44:47], v[28:31], a[184:187], v[44:47]
    s_waitcnt vmcnt(1)
    v_mfma_f32_16x16x32_bf16 v[40:43], v[24:27], a[188:191], v[40:43]
    v_mfma_f32_16x16x32_bf16 v[44:47], v[28:31], a[188:191], v[44:47]
    v_cvt_pk_bf16_f32 v32, v32, v33
    v_cvt_pk_bf16_f32 v33, v34, v35
    v_cvt_pk_bf16_f32 v34, v36, v37
    v_cvt_pk_bf16_f32 v35, v38, v39
    buffer_store_dwordx4 v[32:35], v2, s[8:11], s36 offen offset:0
    s_nop 2
    v_cvt_pk_bf16_f32 v40, v40, v41
    v_cvt_pk_bf16_f32 v41, v42, v43
    v_cvt_pk_bf16_f32 v42, v44, v45
    v_cvt_pk_bf16_f32 v43, v46, v47
    buffer_store_dwordx4 v[40:43], v2, s[8:11], s36 offen offset:448
    s_waitcnt vmcnt(2)
    v_accvgpr_read_b32 v17, a246
    v_cmp_ne_u32 vcc, 0, v17
    s_cbranch_vccz L_poll5_ok
    v_and_b32 v16, 15, v0
    v_lshlrev_b32 v16, 2, v16
    s_mov_b32 s32, 0
L_poll5:
    buffer_load_dword v17, v16, s[12:15], s45 offen sc1
    s_waitcnt vmcnt(0)
    v_cmp_ne_u32 vcc, 0, v17
    s_cbranch_vccz L_poll5_ok
    s_sleep 8
    s_add_u32 s32, s32, 1
    s_cmp_lt_u32 s32, 0x80000
    s_cbranch_scc1 L_poll5
L_poll5_ok:
    buffer_load_dwordx4 a[0:3], v1, s[12:15], s39 offen offset:0 sc1
    buffer_load_dwordx4 a[4:7], v1, s[12:15], s39 offen offset:1024 sc1
    buffer_load_dwordx4 a[8:11], v1, s[12:15], s39 offen offset:2048 sc1
    buffer_load_dwordx4 a[12:15], v1, s[12:15], s39 offen offset:3072 sc1
    s_add_u32 s39, s39, 4096
    buffer_load_dwordx4 a[16:19], v1, s[12:15], s39 offen offset:0 sc1
    buffer_load_dwordx4 a[20:23], v1, s[12:15], s39 offen offset:1024 sc1
    buffer_load_dwordx4 a[24:27], v1, s[12:15], s39 offen offset:2048 sc1
    buffer_load_dwordx4 a[28:31], v1, s[12:15], s39 offen offset:3072 sc1
    s_add_u32 s39, s39, 4096
    buffer_load_dwordx4 a[32:35], v1, s[12:15], s39 offen offset:0 sc1
    buffer_load_dwordx4 a[36:39], v1, s[12:15], s39 offen offset:1024 sc1
    buffer_load_dwordx4 a[40:43], v1, s[12:15], s39 offen offset:2048 sc1
    buffer_load_dwordx4 a[44:47], v1, s[12:15], s39 offen offset:3072 sc1
    s_add_u32 s39, s39, 4096
    buffer_load_dwordx4 a[48:51], v1, s[12:15], s39 offen offset:0 sc1
    buffer_load_dwordx4 a[52:55], v1, s[12:15], s39 offen offset:1024 sc1
    buffer_load_dwordx4 a[56:59], v1, s[12:15], s39 offen offset:2048 sc1
    buffer_load_dwordx4 a[60:63], v1, s[12:15], s39 offen offset:3072 sc1
    s_add_u32 s39, s39, 4096
    s_waitcnt vmcnt(15)
    v_mfma_f32_16x16x32_bf16 v[48:51], v[24:27], a[0:3], 0
    v_mfma_f32_16x16x32_bf16 v[52:55], v[28:31], a[0:3], 0
    s_waitcnt vmcnt(14)
    v_mfma_f32_16x16x32_bf16 v[48:51], v[24:27], a[4:7], v[48:51]
    v_mfma_f32_16x16x32_bf16 v[52:55], v[28:31], a[4:7], v[52:55]
    s_waitcnt vmcnt(13)
    v_mfma_f32_16x16x32_bf16 v[48:51], v[24:27], a[8:11], v[48:51]
    v_mfma_f32_16x16x32_bf16 v[52:55], v[28:31], a[8:11], v[52:55]
    s_waitcnt vmcnt(12)
    v_mfma_f32_16x16x32_bf16 v[48:51], v[24:27], a[12:15], v[48:51]
    v_mfma_f32_16x16x32_bf16 v[52:55], v[28:31], a[12:15], v[52:55]
    s_waitcnt vmcnt(11)
    v_mfma_f32_16x16x32_bf16 v[48:51], v[24:27], a[16:19], v[48:51]
    v_mfma_f32_16x16x32_bf16 v[52:55], v[28:31], a[16:19], v[52:55]
    s_waitcnt vmcnt(10)
    v_mfma_f32_16x16x32_bf16 v[48:51], v[24:27], a[20:23], v[48:51]
    v_mfma_f32_16x16x32_bf16 v[52:55], v[28:31], a[20:23], v[52:55]
    s_waitcnt vmcnt(9)
    v_mfma_f32_16x16x32_bf16 v[48:51], v[24:27], a[24:27], v[48:51]
    v_mfma_f32_16x16x32_bf16 v[52:55], v[28:31], a[24:27], v[52:55]
    s_waitcnt vmcnt(8)
    v_mfma_f32_16x16x32_bf16 v[48:51], v[24:27], a[28:31], v[48:51]
    v_mfma_f32_16x16x32_bf16 v[52:55], v[28:31], a[28:31], v[52:55]
    s_waitcnt vmcnt(7)
    v_mfma_f32_16x16x32_bf16 v[48:51], v[24:27], a[32:35], v[48:51]
    v_mfma_f32_16x16x32_bf16 v[52:55], v[28:31], a[32:35], v[52:55]
    s_waitcnt vmcnt(6)
    v_mfma_f32_16x16x32_bf16 v[48:51], v[24:27], a[36:39], v[48:51]
    v_mfma_f32_16x16x32_bf16 v[52:55], v[28:31], a[36:39], v[52:55]
    s_waitcnt vmcnt(5)
    v_mfma_f32_16x16x32_bf16 v[48:51], v[24:27], a[40:43], v[48:51]
    v_mfma_f32_16x16x32_bf16 v[52:55], v[28:31], a[40:43], v[52:55]
    s_waitcnt vmcnt(4)
    v_mfma_f32_16x16x32_bf16 v[48:51], v[24:27], a[44:47], v[48:51]
    v_mfma_f32_16x16x32_bf16 v[52:55], v[28:31], a[44:47], v[52:55]
    s_waitcnt vmcnt(3)
    v_mfma_f32_16x16x32_bf16 v[48:51], v[24:27], a[48:51], v[48:51]
    v_mfma_f32_16x16x32_bf16 v[52:55], v[28:31], a[48:51], v[52:55]
    s_waitcnt vmcnt(2)
    v_mfma_f32_16x16x32_bf16 v[48:51], v[24:27], a[52:55], v[48:51]
    v_mfma_f32_16x16x32_bf16 v[52:55], v[28:31], a[52:55], v[52:55]
    s_waitcnt vmcnt(1)
    v_mfma_f32_16x16x32_bf16 v[48:51], v[24:27], a[56:59], v[48:51]
    v_mfma_f32_16x16x32_bf16 v[52:55], v[28:31], a[56:59], v[52:55]
    s_waitcnt vmcnt(0)
    v_mfma_f32_16x16x32_bf16 v[48:51], v[24:27], a[60:63], v[48:51]
    v_mfma_f32_16x16x32_bf16 v[52:55], v[28:31], a[60:63], v[52:55]
    s_nop 7
    v_cvt_pk_bf16_f32 v48, v48, v49
    v_cvt_pk_bf16_f32 v49, v50, v51
    v_cvt_pk_bf16_f32 v50, v52, v53
    v_cvt_pk_bf16_f32 v51, v54, v55
    buffer_store_dwordx4 v[48:51], v2, s[8:11], s35 offen offset:448
    s_branch L_fin
L_idle:
    s_waitcnt vmcnt(0)
    s_barrier
    s_cmp_lg_u32 s3, 0
    s_cbranch_scc1 L_pub6
    v_mov_b32 v11, 0
    s_mov_b64 exec, 1
    buffer_store_dword v11, v11, s[12:15], s93 offen sc1
    s_mov_b64 exec, -1
L_pub6:
    s_branch L_fin
L_opB:
    v_lshrrev_b32 v8, 2, v0
    v_lshlrev_b32 v4, 7, v8
    v_bfe_u32 v8, v8, 1, 2
    v_lshl_add_u32 v4, v8, 5, v4
    v_and_b32 v8, 3, v0
    v_lshl_add_u32 v4, v8, 3, v4
    v_add_u32 v4, 131072, v4
    s_barrier
    ds_read_b64_tr_b16 a[0:1], v4 offset:0
    ds_read_b64_tr_b16 a[2:3], v4 offset:2048
    ds_read_b64_tr_b16 a[4:5], v4 offset:4096
    ds_read_b64_tr_b16 a[6:7], v4 offset:6144
    ds_read_b64_tr_b16 a[8:9], v4 offset:8192
    ds_read_b64_tr_b16 a[10:11], v4 offset:10240
    ds_read_b64_tr_b16 a[12:13], v4 offset:12288
    ds_read_b64_tr_b16 a[14:15], v4 offset:14336
    ds_read_b64_tr_b16 a[16:17], v4 offset:16384
    ds_read_b64_tr_b16 a[18:19], v4 offset:18432
    ds_read_b64_tr_b16 a[20:21], v4 offset:20480
    ds_read_b64_tr_b16 a[22:23], v4 offset:22528
    ds_read_b64_tr_b16 a[24:25], v4 offset:24576
    ds_read_b64_tr_b16 a[26:27], v4 offset:26624
    v_xor_b32 v5, 32, v4
    v_xor_b32 v6, 64, v4
    v_xor_b32 v7, 96, v4
    s_lshl_b32 s34, s95, 2
    s_add_u32 s34, s34, s3
    s_lshl_b32 s34, s34, 12
    s_cmp_eq_u32 s62, 0
    s_cmov_b32 s34, 2.0
    s_add_u32 s35, s34, 85983232
    s_mul_i32 s33, s3, 8736
    s_add_u32 s33, s33, 0x10000
    s_mov_b32 s4, s72
    s_mov_b32 s5, s73
    s_mov_b32 s6, 1835008
    s_mov_b32 s7, 0x20000
    v_lshrrev_b32 v10, 1, v0
    v_lshlrev_b32 v10, 7, v10
    v_and_b32 v11, 1, v0
    v_lshl_add_u32 v10, v11, 4, v10
    v_and_b32 v11, 31, v0
    v_lshl_add_u32 v11, v11, 2, s33
    v_and_b32 v12, 7, v0
    v_lshl_add_u32 v12, v12, 2, s33
    v_mov_b32 v13, 0
    v_accvgpr_read_b32 v9, a245
    s_lshl_b32 s48, s63, 3
    s_add_u32 s48, s48, s3
    s_mul_i32 s48, s48, 229376
    s_lshl_b32 s58, s26, 10
    s_add_u32 s48, s48, s58
    s_add_u32 s48, s48, 117440512
    s_waitcnt lgkmcnt(7)
    v_mfma_f32_16x16x32_bf16 v[72:75], a[0:3], a[128:131], 0
    ds_read_b64_tr_b16 a[28:29], v4 offset:28672
    buffer_store_dwordx4 v[68:71], v1, s[12:15], s57 offen sc1
    v_mfma_f32_16x16x32_bf16 v[72:75], a[4:7], a[132:135], v[72:75]
    ds_read_b64_tr_b16 a[30:31], v4 offset:30720
    v_mfma_f32_16x16x32_bf16 v[72:75], a[8:11], a[136:139], v[72:75]
    s_waitcnt lgkmcnt(4)
    ds_read_b64_tr_b16 a[32:33], v5 offset:0
    v_mfma_f32_16x16x32_bf16 v[72:75], a[12:15], a[140:143], v[72:75]
    ds_read_b64_tr_b16 a[34:35], v5 offset:2048
    buffer_store_dwordx4 v[168:171], v3, s[12:15], s55 offen offset:1024 sc1
    v_mfma_f32_16x16x32_bf16 v[72:75], a[16:19], a[144:147], v[72:75]
    ds_read_b64_tr_b16 a[36:37], v5 offset:4096
    v_mfma_f32_16x16x32_bf16 v[72:75], a[20:23], a[148:151], v[72:75]
    s_waitcnt lgkmcnt(3)
    ds_read_b64_tr_b16 a[38:39], v5 offset:6144
    v_mfma_f32_16x16x32_bf16 v[72:75], a[24:27], a[152:155], v[72:75]
    ds_read_b64_tr_b16 a[40:41], v5 offset:8192
    buffer_store_dwordx4 v[232:235], v3, s[12:15], s56 offen offset:1024 sc1
    v_mfma_f32_16x16x32_bf16 v[72:75], a[28:31], a[156:159], v[72:75]
    ds_read_b64_tr_b16 a[42:43], v5 offset:10240
    v_mfma_f32_16x16x32_bf16 v[80:83], a[0:3], a[160:163], 0
    ds_read_b64_tr_b16 a[44:45], v5 offset:12288
    v_mfma_f32_16x16x32_bf16 v[80:83], a[4:7], a[164:167], v[80:83]
    ds_read_b64_tr_b16 a[46:47], v5 offset:14336
    buffer_store_dwordx4 v[176:179], v3, s[12:15], s55 offen offset:2048 sc1
    v_mfma_f32_16x16x32_bf16 v[80:83], a[8:11], a[168:171], v[80:83]
    ds_read_b64_tr_b16 a[48:49], v5 offset:16384
    v_mfma_f32_16x16x32_bf16 v[80:83], a[12:15], a[172:175], v[80:83]
    ds_read_b64_tr_b16 a[50:51], v5 offset:18432
    v_mfma_f32_16x16x32_bf16 v[80:83], a[16:19], a[176:179], v[80:83]
    ds_read_b64_tr_b16 a[52:53], v5 offset:20480
    buffer_store_dwordx4 v[240:243], v3, s[12:15], s56 offen offset:2048 sc1
    v_mfma_f32_16x16x32_bf16 v[80:83], a[20:23], a[180:183], v[80:83]
    ds_read_b64_tr_b16 a[54:55], v5 offset:22528
    v_mul_f32 v72, v72, v64
    v_mfma_f32_16x16x32_bf16 v[80:83], a[24:27], a[184:187], v[80:83]
    ds_read_b64_tr_b16 a[56:57], v5 offset:24576
    v_mul_f32 v73, v73, v64
    v_mfma_f32_16x16x32_bf16 v[80:83], a[28:31], a[188:191], v[80:83]
    s_waitcnt lgkmcnt(7)
    ds_read_b64_tr_b16 a[58:59], v5 offset:26624
    buffer_store_dwordx4 v[184:187], v3, s[12:15], s55 offen offset:3072 sc1
    v_mfma_f32_16x16x32_bf16 v[76:79], a[32:35], a[128:131], 0
    ds_read_b64_tr_b16 a[60:61], v5 offset:28672
    v_mul_f32 v74, v74, v64
    v_mfma_f32_16x16x32_bf16 v[76:79], a[36:39], a[132:135], v[76:79]
    ds_read_b64_tr_b16 a[62:63], v5 offset:30720
    v_mul_f32 v75, v75, v64
    v_mfma_f32_16x16x32_bf16 v[76:79], a[40:43], a[136:139], v[76:79]
    s_waitcnt lgkmcnt(4)
    ds_read_b64_tr_b16 a[0:1], v6 offset:0
    buffer_store_dwordx4 v[248:251], v3, s[12:15], s56 offen offset:3072 sc1
    v_mfma_f32_16x16x32_bf16 v[76:79], a[44:47], a[140:143], v[76:79]
    ds_read_b64_tr_b16 a[2:3], v6 offset:2048
    v_mfma_f32_16x16x32_bf16 v[76:79], a[48:51], a[144:147], v[76:79]
    s_add_u32 m0, s29, 32768
    ds_read_b64_tr_b16 a[4:5], v6 offset:4096
    v_mul_f32 v80, v80, v65
    v_mfma_f32_16x16x32_bf16 v[76:79], a[52:55], a[148:151], v[76:79]
    s_waitcnt lgkmcnt(3)
    ds_read_b64_tr_b16 a[6:7], v6 offset:6144
    buffer_load_dwordx4 v2, s[8:11], s78 offen lds
    v_mfma_f32_16x16x32_bf16 v[76:79], a[56:59], a[152:155], v[76:79]
    ds_read_b64_tr_b16 a[8:9], v6 offset:8192
    v_mul_f32 v81, v81, v65
    v_mfma_f32_16x16x32_bf16 v[76:79], a[60:63], a[156:159], v[76:79]
    ds_read_b64_tr_b16 a[10:11], v6 offset:10240
    v_mul_f32 v82, v82, v65
    v_mfma_f32_16x16x32_bf16 v[84:87], a[32:35], a[160:163], 0
    ds_read_b64_tr_b16 a[12:13], v6 offset:12288
    v_mul_f32 v83, v83, v65
    v_mfma_f32_16x16x32_bf16 v[84:87], a[36:39], a[164:167], v[84:87]
    s_add_u32 m0, s29, 36864
    ds_read_b64_tr_b16 a[14:15], v6 offset:14336
    v_mfma_f32_16x16x32_bf16 v[84:87], a[40:43], a[168:171], v[84:87]
    ds_read_b64_tr_b16 a[16:17], v6 offset:16384
    buffer_load_dwordx4 v2, s[8:11], s79 offen lds
    v_mfma_f32_16x16x32_bf16 v[84:87], a[44:47], a[172:175], v[84:87]
    ds_read_b64_tr_b16 a[18:19], v6 offset:18432
    v_mfma_f32_16x16x32_bf16 v[84:87], a[48:51], a[176:179], v[84:87]
    ds_read_b64_tr_b16 a[20:21], v6 offset:20480
    v_mul_f32 v76, v76, v64
    v_mfma_f32_16x16x32_bf16 v[84:87], a[52:55], a[180:183], v[84:87]
    ds_read_b64_tr_b16 a[22:23], v6 offset:22528
    v_mul_f32 v77, v77, v64
    v_mfma_f32_16x16x32_bf16 v[84:87], a[56:59], a[184:187], v[84:87]
    s_add_u32 m0, s29, 40960
    ds_read_b64_tr_b16 a[24:25], v6 offset:24576
    v_mul_f32 v78, v78, v64
    v_mfma_f32_16x16x32_bf16 v[84:87], a[60:63], a[188:191], v[84:87]
    s_waitcnt lgkmcnt(7)
    ds_read_b64_tr_b16 a[26:27], v6 offset:26624
    buffer_load_dwordx4 v2, s[8:11], s80 offen lds
    v_mfma_f32_16x16x32_bf16 v[88:91], a[0:3], a[128:131], 0
    s_lshl_b32 s44, s24, 7
    ds_read_b64_tr_b16 a[28:29], v6 offset:28672
    v_mul_f32 v79, v79, v64
    v_mfma_f32_16x16x32_bf16 v[88:91], a[4:7], a[132:135], v[88:91]
    s_add_u32 s44, s44, 84938752
    ds_read_b64_tr_b16 a[30:31], v6 offset:30720
    v_cvt_pk_bf16_f32 v72, v72, v73
    v_mfma_f32_16x16x32_bf16 v[88:91], a[8:11], a[136:139], v[88:91]
    s_waitcnt lgkmcnt(4)
    ds_read_b64_tr_b16 a[32:33], v7 offset:0
    v_cvt_pk_bf16_f32 v73, v74, v75
    v_mfma_f32_16x16x32_bf16 v[88:91], a[12:15], a[140:143], v[88:91]
    s_add_u32 m0, s29, 45056
    ds_read_b64_tr_b16 a[34:35], v7 offset:2048
    v_cvt_pk_bf16_f32 v74, v76, v77
    v_mfma_f32_16x16x32_bf16 v[88:91], a[16:19], a[144:147], v[88:91]
    ds_read_b64_tr_b16 a[36:37], v7 offset:4096
    buffer_load_dwordx4 v2, s[8:11], s81 offen lds
    v_mfma_f32_16x16x32_bf16 v[88:91], a[20:23], a[148:151], v[88:91]
    s_waitcnt lgkmcnt(3)
    ds_read_b64_tr_b16 a[38:39], v7 offset:6144
    v_cvt_pk_bf16_f32 v75, v78, v79
    v_mfma_f32_16x16x32_bf16 v[88:91], a[24:27], a[152:155], v[88:91]
    s_add_u32 s58, s48, 0
    ds_read_b64_tr_b16 a[40:41], v7 offset:8192
    v_mul_f32 v84, v84, v65
    v_mfma_f32_16x16x32_bf16 v[88:91], a[28:31], a[156:159], v[88:91]
    s_waitcnt vmcnt(4)
    ds_read_b64_tr_b16 a[42:43], v7 offset:10240
    buffer_store_dwordx4 v[72:75], v1, s[12:15], s58 offen sc1
    v_mfma_f32_16x16x32_bf16 v[96:99], a[0:3], a[160:163], 0
    s_barrier
    ds_read_b64_tr_b16 a[44:45], v7 offset:12288
    v_mul_f32 v85, v85, v65
    v_mfma_f32_16x16x32_bf16 v[96:99], a[4:7], a[164:167], v[96:99]
    ds_read_b64_tr_b16 a[46:47], v7 offset:14336
    buffer_store_dword v9, v9, s[12:15], s59 offen sc1
    v_mfma_f32_16x16x32_bf16 v[96:99], a[8:11], a[168:171], v[96:99]
    s_add_u32 m0, s29, 49152
    ds_read_b64_tr_b16 a[48:49], v7 offset:16384
    v_mul_f32 v86, v86, v65
    v_mfma_f32_16x16x32_bf16 v[96:99], a[12:15], a[172:175], v[96:99]
    ds_read_b64_tr_b16 a[50:51], v7 offset:18432
    buffer_load_dwordx4 v2, s[8:11], s82 offen lds
    v_mfma_f32_16x16x32_bf16 v[96:99], a[16:19], a[176:179], v[96:99]
    s_lshl_b32 s40, s24, 1
    ds_read_b64_tr_b16 a[52:53], v7 offset:20480
    v_mul_f32 v87, v87, v65
    v_mfma_f32_16x16x32_bf16 v[96:99], a[20:23], a[180:183], v[96:99]
    s_and_b32 s41, s28, 1
    ds_read_b64_tr_b16 a[54:55], v7 offset:22528
    v_cvt_pk_bf16_f32 v80, v80, v81
    v_mfma_f32_16x16x32_bf16 v[96:99], a[24:27], a[184:187], v[96:99]
    s_add_u32 m0, s29, 53248
    ds_read_b64_tr_b16 a[56:57], v7 offset:24576
    v_cvt_pk_bf16_f32 v81, v82, v83
    v_mfma_f32_16x16x32_bf16 v[96:99], a[28:31], a[188:191], v[96:99]
    s_waitcnt lgkmcnt(7)
    ds_read_b64_tr_b16 a[58:59], v7 offset:26624
    v_cvt_pk_bf16_f32 v82, v84, v85
    v_mfma_f32_16x16x32_bf16 v[92:95], a[32:35], a[128:131], 0
    ds_read_b64_tr_b16 a[60:61], v7 offset:28672
    buffer_load_dwordx4 v2, s[8:11], s83 offen lds
    v_mfma_f32_16x16x32_bf16 v[92:95], a[36:39], a[132:135], v[92:95]
    s_add_u32 s58, s48, 917504
    ds_read_b64_tr_b16 a[62:63], v7 offset:30720
    v_xor_b32 v4, 0x20000, v4
    v_mfma_f32_16x16x32_bf16 v[92:95], a[40:43], a[136:139], v[92:95]
    s_waitcnt lgkmcnt(4)
    ds_read_b64_tr_b16 a[0:1], v4 offset:0
    v_cvt_pk_bf16_f32 v83, v86, v87
    v_mfma_f32_16x16x32_bf16 v[92:95], a[44:47], a[140:143], v[92:95]
    ds_read_b64_tr_b16 a[2:3], v4 offset:2048
    buffer_store_dwordx4 v[80:83], v1, s[12:15], s58 offen sc1
    v_mfma_f32_16x16x32_bf16 v[92:95], a[48:51], a[144:147], v[92:95]
    s_add_u32 m0, s29, 57344
    ds_read_b64_tr_b16 a[4:5], v4 offset:4096
    v_mul_f32 v88, v88, v64
    v_mfma_f32_16x16x32_bf16 v[92:95], a[52:55], a[148:151], v[92:95]
    s_waitcnt lgkmcnt(3)
    ds_read_b64_tr_b16 a[6:7], v4 offset:6144
    buffer_load_dwordx4 v2, s[8:11], s84 offen lds
    v_mfma_f32_16x16x32_bf16 v[92:95], a[56:59], a[152:155], v[92:95]
    s_add_u32 s40, s40, s41
    ds_read_b64_tr_b16 a[8:9], v4 offset:8192
    v_mul_f32 v89, v89, v64
    v_mfma_f32_16x16x32_bf16 v[92:95], a[60:63], a[156:159], v[92:95]
    s_lshr_b32 s41, s28, 1
    ds_read_b64_tr_b16 a[10:11], v4 offset:10240
    v_mul_f32 v90, v90, v64
    v_mfma_f32_16x16x32_bf16 v[100:103], a[32:35], a[160:163], 0
    s_lshl_b32 s42, s40, 2
    ds_read_b64_tr_b16 a[12:13], v4 offset:12288
    v_mul_f32 v91, v91, v64
    v_mfma_f32_16x16x32_bf16 v[100:103], a[36:39], a[164:167], v[100:103]
    s_add_u32 m0, s29, 61440
    ds_read_b64_tr_b16 a[14:15], v4 offset:14336
    v_mul_f32 v96, v96, v65
    v_mfma_f32_16x16x32_bf16 v[100:103], a[40:43], a[168:171], v[100:103]
    ds_read_b64_tr_b16 a[16:17], v4 offset:16384
    buffer_load_dwordx4 v2, s[8:11], s85 offen lds
    v_mfma_f32_16x16x32_bf16 v[100:103], a[44:47], a[172:175], v[100:103]
    s_add_u32 s42, s42, s3
    ds_read_b64_tr_b16 a[18:19], v4 offset:18432
    v_add_u32 v2, 128, v2
    v_mfma_f32_16x16x32_bf16 v[100:103], a[48:51], a[176:179], v[100:103]
    s_mul_i32 s37, s42, 229376
    ds_read_b64_tr_b16 a[20:21], v4 offset:20480
    v_mul_f32 v92, v92, v64
    v_mfma_f32_16x16x32_bf16 v[100:103], a[52:55], a[180:183], v[100:103]
    s_lshl_b32 s43, s41, 14
    ds_read_b64_tr_b16 a[22:23], v4 offset:22528
    v_mul_f32 v93, v93, v64
    v_mfma_f32_16x16x32_bf16 v[100:103], a[56:59], a[184:187], v[100:103]
    s_add_u32 m0, s29, 65536
    ds_read_b64_tr_b16 a[24:25], v4 offset:24576
    v_mul_f32 v94, v94, v64
    v_mfma_f32_16x16x32_bf16 v[100:103], a[60:63], a[188:191], v[100:103]
    s_waitcnt lgkmcnt(7)
    ds_read_b64_tr_b16 a[26:27], v4 offset:26624
    buffer_load_dwordx4 v2, s[8:11], s78 offen lds
    v_mfma_f32_16x16x32_bf16 v[104:107], a[0:3], a[128:131], 0
    s_add_u32 s37, s37, s43
    ds_read_b64_tr_b16 a[28:29], v4 offset:28672
    v_mul_f32 v95, v95, v64
    v_mfma_f32_16x16x32_bf16 v[104:107], a[4:7], a[132:135], v[104:107]
    s_add_u32 s37, s37, 117440512
    ds_read_b64_tr_b16 a[30:31], v4 offset:30720
    v_xor_b32 v5, 0x20000, v5
    v_mfma_f32_16x16x32_bf16 v[104:107], a[8:11], a[136:139], v[104:107]
    s_waitcnt lgkmcnt(4)
    ds_read_b64_tr_b16 a[32:33], v5 offset:0
    v_cvt_pk_bf16_f32 v88, v88, v89
    v_mfma_f32_16x16x32_bf16 v[104:107], a[12:15], a[140:143], v[104:107]
    s_add_u32 m0, s29, 69632
    ds_read_b64_tr_b16 a[34:35], v5 offset:2048
    v_cvt_pk_bf16_f32 v89, v90, v91
    v_mfma_f32_16x16x32_bf16 v[104:107], a[16:19], a[144:147], v[104:107]
    ds_read_b64_tr_b16 a[36:37], v5 offset:4096
    buffer_load_dwordx4 v2, s[8:11], s79 offen lds
    v_mfma_f32_16x16x32_bf16 v[104:107], a[20:23], a[148:151], v[104:107]
    s_waitcnt lgkmcnt(3)
    ds_read_b64_tr_b16 a[38:39], v5 offset:6144
    v_cvt_pk_bf16_f32 v90, v92, v93
    v_mfma_f32_16x16x32_bf16 v[104:107], a[24:27], a[152:155], v[104:107]
    s_add_u32 s58, s48, 16384
    ds_read_b64_tr_b16 a[40:41], v5 offset:8192
    v_cvt_pk_bf16_f32 v91, v94, v95
    v_mfma_f32_16x16x32_bf16 v[104:107], a[28:31], a[156:159], v[104:107]
    ds_read_b64_tr_b16 a[42:43], v5 offset:10240
    buffer_store_dwordx4 v[88:91], v1, s[12:15], s58 offen sc1
    v_mfma_f32_16x16x32_bf16 v[112:115], a[0:3], a[160:163], 0
    s_add_u32 m0, s29, 73728
    ds_read_b64_tr_b16 a[44:45], v5 offset:12288
    v_mul_f32 v97, v97, v65
    v_mfma_f32_16x16x32_bf16 v[112:115], a[4:7], a[164:167], v[112:115]
    ds_read_b64_tr_b16 a[46:47], v5 offset:14336
    buffer_load_dwordx4 v2, s[8:11], s80 offen lds
    v_mfma_f32_16x16x32_bf16 v[112:115], a[8:11], a[168:171], v[112:115]
    s_add_u32 s38, s37, 114688
    ds_read_b64_tr_b16 a[48:49], v5 offset:16384
    v_mul_f32 v98, v98, v65
    v_mfma_f32_16x16x32_bf16 v[112:115], a[12:15], a[172:175], v[112:115]
    ds_read_b64_tr_b16 a[50:51], v5 offset:18432
    v_mul_f32 v99, v99, v65
    v_mfma_f32_16x16x32_bf16 v[112:115], a[16:19], a[176:179], v[112:115]
    ds_read_b64_tr_b16 a[52:53], v5 offset:20480
    v_mul_f32 v100, v100, v65
    v_mfma_f32_16x16x32_bf16 v[112:115], a[20:23], a[180:183], v[112:115]
    s_add_u32 m0, s29, 77824
    ds_read_b64_tr_b16 a[54:55], v5 offset:22528
    v_mul_f32 v101, v101, v65
    v_mfma_f32_16x16x32_bf16 v[112:115], a[24:27], a[184:187], v[112:115]
    ds_read_b64_tr_b16 a[56:57], v5 offset:24576
    buffer_load_dwordx4 v2, s[8:11], s81 offen lds
    v_mfma_f32_16x16x32_bf16 v[112:115], a[28:31], a[188:191], v[112:115]
    s_waitcnt lgkmcnt(7)
    ds_read_b64_tr_b16 a[58:59], v5 offset:26624
    v_mul_f32 v102, v102, v65
    v_mfma_f32_16x16x32_bf16 v[108:111], a[32:35], a[128:131], 0
    ds_read_b64_tr_b16 a[60:61], v5 offset:28672
    v_mul_f32 v103, v103, v65
    v_mfma_f32_16x16x32_bf16 v[108:111], a[36:39], a[132:135], v[108:111]
    s_add_u32 m0, s29, 81920
    ds_read_b64_tr_b16 a[62:63], v5 offset:30720
    v_xor_b32 v6, 0x20000, v6
    v_mfma_f32_16x16x32_bf16 v[108:111], a[40:43], a[136:139], v[108:111]
    s_waitcnt lgkmcnt(4)
    ds_read_b64_tr_b16 a[0:1], v6 offset:0
    v_cvt_pk_bf16_f32 v96, v96, v97
    v_mfma_f32_16x16x32_bf16 v[108:111], a[44:47], a[140:143], v[108:111]
    ds_read_b64_tr_b16 a[2:3], v6 offset:2048
    buffer_load_dwordx4 v2, s[8:11], s82 offen lds
    v_mfma_f32_16x16x32_bf16 v[108:111], a[48:51], a[144:147], v[108:111]
    ds_read_b64_tr_b16 a[4:5], v6 offset:4096
    v_cvt_pk_bf16_f32 v97, v98, v99
    v_mfma_f32_16x16x32_bf16 v[108:111], a[52:55], a[148:151], v[108:111]
    s_waitcnt lgkmcnt(3)
    ds_read_b64_tr_b16 a[6:7], v6 offset:6144
    v_cvt_pk_bf16_f32 v98, v100, v101
    v_mfma_f32_16x16x32_bf16 v[108:111], a[56:59], a[152:155], v[108:111]
    ds_read_b64_tr_b16 a[8:9], v6 offset:8192
    v_cvt_pk_bf16_f32 v99, v102, v103
    v_mfma_f32_16x16x32_bf16 v[108:111], a[60:63], a[156:159], v[108:111]
    s_add_u32 m0, s29, 86016
    ds_read_b64_tr_b16 a[10:11], v6 offset:10240
    v_mul_f32 v104, v104, v64
    v_mfma_f32_16x16x32_bf16 v[116:119], a[32:35], a[160:163], 0
    ds_read_b64_tr_b16 a[12:13], v6 offset:12288
    buffer_load_dwordx4 v2, s[8:11], s83 offen lds
    v_mfma_f32_16x16x32_bf16 v[116:119], a[36:39], a[164:167], v[116:119]
    s_add_u32 s58, s48, 933888
    ds_read_b64_tr_b16 a[14:15], v6 offset:14336
    v_mul_f32 v105, v105, v64
    v_mfma_f32_16x16x32_bf16 v[116:119], a[40:43], a[168:171], v[116:119]
    ds_read_b64_tr_b16 a[16:17], v6 offset:16384
    buffer_store_dwordx4 v[96:99], v1, s[12:15], s58 offen sc1
    v_mfma_f32_16x16x32_bf16 v[116:119], a[44:47], a[172:175], v[116:119]
    ds_read_b64_tr_b16 a[18:19], v6 offset:18432
    v_mul_f32 v106, v106, v64
    v_mfma_f32_16x16x32_bf16 v[116:119], a[48:51], a[176:179], v[116:119]
    s_add_u32 m0, s29, 90112
    ds_read_b64_tr_b16 a[20:21], v6 offset:20480
    v_mul_f32 v107, v107, v64
    v_mfma_f32_16x16x32_bf16 v[116:119], a[52:55], a[180:183], v[116:119]
    ds_read_b64_tr_b16 a[22:23], v6 offset:22528
    buffer_load_dwordx4 v2, s[8:11], s84 offen lds
    v_mfma_f32_16x16x32_bf16 v[116:119], a[56:59], a[184:187], v[116:119]
    ds_read_b64_tr_b16 a[24:25], v6 offset:24576
    v_mul_f32 v108, v108, v64
    v_mfma_f32_16x16x32_bf16 v[116:119], a[60:63], a[188:191], v[116:119]
    s_waitcnt lgkmcnt(7)
    ds_read_b64_tr_b16 a[26:27], v6 offset:26624
    v_mul_f32 v109, v109, v64
    v_mfma_f32_16x16x32_bf16 v[72:75], a[0:3], a[128:131], 0
    ds_read_b64_tr_b16 a[28:29], v6 offset:28672
    v_mul_f32 v110, v110, v64
    v_mfma_f32_16x16x32_bf16 v[72:75], a[4:7], a[132:135], v[72:75]
    s_add_u32 m0, s29, 94208
    ds_read_b64_tr_b16 a[30:31], v6 offset:30720
    v_xor_b32 v7, 0x20000, v7
    v_mfma_f32_16x16x32_bf16 v[72:75], a[8:11], a[136:139], v[72:75]
    s_waitcnt lgkmcnt(4)
    ds_read_b64_tr_b16 a[32:33], v7 offset:0
    buffer_load_dwordx4 v2, s[8:11], s85 offen lds
    v_mfma_f32_16x16x32_bf16 v[72:75], a[12:15], a[140:143], v[72:75]
    ds_read_b64_tr_b16 a[34:35], v7 offset:2048
    v_add_u32 v2, 128, v2
    v_mfma_f32_16x16x32_bf16 v[72:75], a[16:19], a[144:147], v[72:75]
    ds_read_b64_tr_b16 a[36:37], v7 offset:4096
    v_mul_f32 v111, v111, v64
    v_mfma_f32_16x16x32_bf16 v[72:75], a[20:23], a[148:151], v[72:75]
    s_waitcnt lgkmcnt(3)
    ds_read_b64_tr_b16 a[38:39], v7 offset:6144
    v_cvt_pk_bf16_f32 v104, v104, v105
    v_mfma_f32_16x16x32_bf16 v[72:75], a[24:27], a[152:155], v[72:75]
    s_add_u32 m0, s29, 98304
    ds_read_b64_tr_b16 a[40:41], v7 offset:8192
    v_cvt_pk_bf16_f32 v105, v106, v107
    v_mfma_f32_16x16x32_bf16 v[72:75], a[28:31], a[156:159], v[72:75]
    ds_read_b64_tr_b16 a[42:43], v7 offset:10240
    buffer_load_dwordx4 v2, s[8:11], s78 offen lds
    v_mfma_f32_16x16x32_bf16 v[80:83], a[0:3], a[160:163], 0
    ds_read_b64_tr_b16 a[44:45], v7 offset:12288
    v_cvt_pk_bf16_f32 v106, v108, v109
    v_mfma_f32_16x16x32_bf16 v[80:83], a[4:7], a[164:167], v[80:83]
    s_add_u32 s58, s48, 32768
    ds_read_b64_tr_b16 a[46:47], v7 offset:14336
    v_cvt_pk_bf16_f32 v107, v110, v111
    v_mfma_f32_16x16x32_bf16 v[80:83], a[8:11], a[168:171], v[80:83]
    ds_read_b64_tr_b16 a[48:49], v7 offset:16384
    buffer_store_dwordx4 v[104:107], v1, s[12:15], s58 offen sc1
    v_mfma_f32_16x16x32_bf16 v[80:83], a[12:15], a[172:175], v[80:83]
    s_add_u32 m0, s29, 102400
    ds_read_b64_tr_b16 a[50:51], v7 offset:18432
    v_mul_f32 v112, v112, v65
    v_mfma_f32_16x16x32_bf16 v[80:83], a[16:19], a[176:179], v[80:83]
    ds_read_b64_tr_b16 a[52:53], v7 offset:20480
    buffer_load_dwordx4 v2, s[8:11], s79 offen lds
    v_mfma_f32_16x16x32_bf16 v[80:83], a[20:23], a[180:183], v[80:83]
    ds_read_b64_tr_b16 a[54:55], v7 offset:22528
    v_mul_f32 v113, v113, v65
    v_mfma_f32_16x16x32_bf16 v[80:83], a[24:27], a[184:187], v[80:83]
    ds_read_b64_tr_b16 a[56:57], v7 offset:24576
    v_mul_f32 v114, v114, v65
    v_mfma_f32_16x16x32_bf16 v[80:83], a[28:31], a[188:191], v[80:83]
    s_waitcnt lgkmcnt(7)
    ds_read_b64_tr_b16 a[58:59], v7 offset:26624
    v_mul_f32 v115, v115, v65
    v_mfma_f32_16x16x32_bf16 v[76:79], a[32:35], a[128:131], 0
    s_waitcnt vmcnt(13)
    ds_read_b64_tr_b16 a[60:61], v7 offset:28672
    v_mul_f32 v116, v116, v65
    v_mfma_f32_16x16x32_bf16 v[76:79], a[36:39], a[132:135], v[76:79]
    s_barrier
    ds_read_b64_tr_b16 a[62:63], v7 offset:30720
    v_mul_f32 v117, v117, v65
    v_mfma_f32_16x16x32_bf16 v[76:79], a[40:43], a[136:139], v[76:79]
    s_waitcnt lgkmcnt(4)
    ds_read_b64_tr_b16 a[0:1], v4 offset:32768
    v_mul_f32 v118, v118, v65
    v_mfma_f32_16x16x32_bf16 v[76:79], a[44:47], a[140:143], v[76:79]
    s_add_u32 m0, s29, 106496
    ds_read_b64_tr_b16 a[2:3], v4 offset:34816
    v_mul_f32 v119, v119, v65
    v_mfma_f32_16x16x32_bf16 v[76:79], a[48:51], a[144:147], v[76:79]
    ds_read_b64_tr_b16 a[4:5], v4 offset:36864
    buffer_load_dwordx4 v2, s[8:11], s80 offen lds
    v_mfma_f32_16x16x32_bf16 v[76:79], a[52:55], a[148:151], v[76:79]
    s_waitcnt lgkmcnt(3)
    ds_read_b64_tr_b16 a[6:7], v4 offset:38912
    v_cvt_pk_bf16_f32 v112, v112, v113
    v_mfma_f32_16x16x32_bf16 v[76:79], a[56:59], a[152:155], v[76:79]
    ds_read_b64_tr_b16 a[8:9], v4 offset:40960
    v_cvt_pk_bf16_f32 v113, v114, v115
    v_mfma_f32_16x16x32_bf16 v[76:79], a[60:63], a[156:159], v[76:79]
    ds_read_b64_tr_b16 a[10:11], v4 offset:43008
    v_cvt_pk_bf16_f32 v114, v116, v117
    v_mfma_f32_16x16x32_bf16 v[84:87], a[32:35], a[160:163], 0
    s_add_u32 m0, s29, 110592
    ds_read_b64_tr_b16 a[12:13], v4 offset:45056
    v_cvt_pk_bf16_f32 v115, v118, v119
    v_mfma_f32_16x16x32_bf16 v[84:87], a[36:39], a[164:167], v[84:87]
    ds_read_b64_tr_b16 a[14:15], v4 offset:47104
    buffer_load_dwordx4 v2, s[8:11], s81 offen lds
    v_mfma_f32_16x16x32_bf16 v[84:87], a[40:43], a[168:171], v[84:87]
    s_add_u32 s58, s48, 950272
    ds_read_b64_tr_b16 a[16:17], v4 offset:49152
    v_mul_f32 v72, v72, v64
    v_mfma_f32_16x16x32_bf16 v[84:87], a[44:47], a[172:175], v[84:87]
    s_waitcnt lgkmcnt(9)
    ds_read_b64_tr_b16 a[18:19], v4 offset:51200
    buffer_store_dwordx4 v[112:115], v1, s[12:15], s58 offen sc1
    v_mfma_f32_16x16x32_bf16 v[84:87], a[48:51], a[176:179], v[84:87]
    s_barrier
    ds_read_b64_tr_b16 a[20:21], v4 offset:53248
    v_mul_f32 v73, v73, v64
    v_mfma_f32_16x16x32_bf16 v[84:87], a[52:55], a[180:183], v[84:87]
    s_add_u32 m0, s29, 114688
    ds_read_b64_tr_b16 a[22:23], v4 offset:55296
    v_mul_f32 v74, v74, v64
    v_mfma_f32_16x16x32_bf16 v[84:87], a[56:59], a[184:187], v[84:87]
    ds_read_b64_tr_b16 a[24:25], v4 offset:57344
    buffer_load_dwordx4 v2, s[8:11], s82 offen lds
    v_mfma_f32_16x16x32_bf16 v[84:87], a[60:63], a[188:191], v[84:87]
    s_waitcnt lgkmcnt(7)
    ds_read_b64_tr_b16 a[26:27], v4 offset:59392
    v_mul_f32 v75, v75, v64
    v_mfma_f32_16x16x32_bf16 v[88:91], a[0:3], a[128:131], 0
    ds_read_b64_tr_b16 a[28:29], v4 offset:61440
    v_mul_f32 v76, v76, v64
    v_mfma_f32_16x16x32_bf16 v[88:91], a[4:7], a[132:135], v[88:91]
    s_add_u32 m0, s29, 118784
    ds_read_b64_tr_b16 a[30:31], v4 offset:63488
    v_mul_f32 v77, v77, v64
    v_mfma_f32_16x16x32_bf16 v[88:91], a[8:11], a[136:139], v[88:91]
    s_waitcnt lgkmcnt(4)
    ds_read_b64_tr_b16 a[32:33], v5 offset:32768
    v_mul_f32 v78, v78, v64
    v_mfma_f32_16x16x32_bf16 v[88:91], a[12:15], a[140:143], v[88:91]
    ds_read_b64_tr_b16 a[34:35], v5 offset:34816
    buffer_load_dwordx4 v2, s[8:11], s83 offen lds
    v_mfma_f32_16x16x32_bf16 v[88:91], a[16:19], a[144:147], v[88:91]
    ds_read_b64_tr_b16 a[36:37], v5 offset:36864
    v_mul_f32 v79, v79, v64
    v_mfma_f32_16x16x32_bf16 v[88:91], a[20:23], a[148:151], v[88:91]
    s_waitcnt lgkmcnt(3)
    ds_read_b64_tr_b16 a[38:39], v5 offset:38912
    v_cvt_pk_bf16_f32 v72, v72, v73
    v_mfma_f32_16x16x32_bf16 v[88:91], a[24:27], a[152:155], v[88:91]
    ds_read_b64_tr_b16 a[40:41], v5 offset:40960
    v_cvt_pk_bf16_f32 v73, v74, v75
    v_mfma_f32_16x16x32_bf16 v[88:91], a[28:31], a[156:159], v[88:91]
    s_add_u32 m0, s29, 122880
    ds_read_b64_tr_b16 a[42:43], v5 offset:43008
    v_cvt_pk_bf16_f32 v74, v76, v77
    v_mfma_f32_16x16x32_bf16 v[96:99], a[0:3], a[160:163], 0
    ds_read_b64_tr_b16 a[44:45], v5 offset:45056
    buffer_load_dwordx4 v2, s[8:11], s84 offen lds
    v_mfma_f32_16x16x32_bf16 v[96:99], a[4:7], a[164:167], v[96:99]
    s_add_u32 s58, s48, 49152
    ds_read_b64_tr_b16 a[46:47], v5 offset:47104
    v_cvt_pk_bf16_f32 v75, v78, v79
    v_mfma_f32_16x16x32_bf16 v[96:99], a[8:11], a[168:171], v[96:99]
    ds_read_b64_tr_b16 a[48:49], v5 offset:49152
    buffer_store_dwordx4 v[72:75], v1, s[12:15], s58 offen sc1
    v_mfma_f32_16x16x32_bf16 v[96:99], a[12:15], a[172:175], v[96:99]
    ds_read_b64_tr_b16 a[50:51], v5 offset:51200
    v_mul_f32 v80, v80, v65
    v_mfma_f32_16x16x32_bf16 v[96:99], a[16:19], a[176:179], v[96:99]
    s_add_u32 m0, s29, 126976
    ds_read_b64_tr_b16 a[52:53], v5 offset:53248
    v_mul_f32 v81, v81, v65
    v_mfma_f32_16x16x32_bf16 v[96:99], a[20:23], a[180:183], v[96:99]
    ds_read_b64_tr_b16 a[54:55], v5 offset:55296
    buffer_load_dwordx4 v2, s[8:11], s85 offen lds
    v_mfma_f32_16x16x32_bf16 v[96:99], a[24:27], a[184:187], v[96:99]
    ds_read_b64_tr_b16 a[56:57], v5 offset:57344
    v_add_u32 v2, 128, v2
    v_mfma_f32_16x16x32_bf16 v[96:99], a[28:31], a[188:191], v[96:99]
    s_waitcnt lgkmcnt(7)
    ds_read_b64_tr_b16 a[58:59], v5 offset:59392
    v_mul_f32 v82, v82, v65
    v_mfma_f32_16x16x32_bf16 v[92:95], a[32:35], a[128:131], 0
    ds_read_b64_tr_b16 a[60:61], v5 offset:61440
    v_mul_f32 v83, v83, v65
    v_mfma_f32_16x16x32_bf16 v[92:95], a[36:39], a[132:135], v[92:95]
    s_add_u32 m0, s29, 131072
    ds_read_b64_tr_b16 a[62:63], v5 offset:63488
    v_mul_f32 v84, v84, v65
    v_mfma_f32_16x16x32_bf16 v[92:95], a[40:43], a[136:139], v[92:95]
    s_waitcnt lgkmcnt(4)
    ds_read_b64_tr_b16 a[0:1], v6 offset:32768
    buffer_load_dwordx4 v2, s[8:11], s78 offen lds
    v_mfma_f32_16x16x32_bf16 v[92:95], a[44:47], a[140:143], v[92:95]
    ds_read_b64_tr_b16 a[2:3], v6 offset:34816
    v_mul_f32 v85, v85, v65
    v_mfma_f32_16x16x32_bf16 v[92:95], a[48:51], a[144:147], v[92:95]
    ds_read_b64_tr_b16 a[4:5], v6 offset:36864
    v_mul_f32 v86, v86, v65
    v_mfma_f32_16x16x32_bf16 v[92:95], a[52:55], a[148:151], v[92:95]
    s_waitcnt lgkmcnt(3)
    ds_read_b64_tr_b16 a[6:7], v6 offset:38912
    v_mul_f32 v87, v87, v65
    v_mfma_f32_16x16x32_bf16 v[92:95], a[56:59], a[152:155], v[92:95]
    s_add_u32 m0, s29, 135168
    ds_read_b64_tr_b16 a[8:9], v6 offset:40960
    v_cvt_pk_bf16_f32 v80, v80, v81
    v_mfma_f32_16x16x32_bf16 v[92:95], a[60:63], a[156:159], v[92:95]
    ds_read_b64_tr_b16 a[10:11], v6 offset:43008
    buffer_load_dwordx4 v2, s[8:11], s79 offen lds
    v_mfma_f32_16x16x32_bf16 v[100:103], a[32:35], a[160:163], 0
    ds_read_b64_tr_b16 a[12:13], v6 offset:45056
    v_cvt_pk_bf16_f32 v81, v82, v83
    v_mfma_f32_16x16x32_bf16 v[100:103], a[36:39], a[164:167], v[100:103]
    ds_read_b64_tr_b16 a[14:15], v6 offset:47104
    v_cvt_pk_bf16_f32 v82, v84, v85
    v_mfma_f32_16x16x32_bf16 v[100:103], a[40:43], a[168:171], v[100:103]
    ds_read_b64_tr_b16 a[16:17], v6 offset:49152
    v_cvt_pk_bf16_f32 v83, v86, v87
    v_mfma_f32_16x16x32_bf16 v[100:103], a[44:47], a[172:175], v[100:103]
    s_add_u32 m0, s29, 139264
    ds_read_b64_tr_b16 a[18:19], v6 offset:51200
    v_mul_f32 v88, v88, v64
    v_mfma_f32_16x16x32_bf16 v[100:103], a[48:51], a[176:179], v[100:103]
    ds_read_b64_tr_b16 a[20:21], v6 offset:53248
    buffer_load_dwordx4 v2, s[8:11], s80 offen lds
    v_mfma_f32_16x16x32_bf16 v[100:103], a[52:55], a[180:183], v[100:103]
    s_add_u32 s58, s48, 966656
    ds_read_b64_tr_b16 a[22:23], v6 offset:55296
    v_mul_f32 v89, v89, v64
    v_mfma_f32_16x16x32_bf16 v[100:103], a[56:59], a[184:187], v[100:103]
    ds_read_b64_tr_b16 a[24:25], v6 offset:57344
    buffer_store_dwordx4 v[80:83], v1, s[12:15], s58 offen sc1
    v_mfma_f32_16x16x32_bf16 v[100:103], a[60:63], a[188:191], v[100:103]
    s_waitcnt lgkmcnt(7)
    ds_read_b64_tr_b16 a[26:27], v6 offset:59392
    v_mul_f32 v90, v90, v64
    v_mfma_f32_16x16x32_bf16 v[104:107], a[0:3], a[128:131], 0
    s_add_u32 m0, s29, 143360
    ds_read_b64_tr_b16 a[28:29], v6 offset:61440
    v_mul_f32 v91, v91, v64
    v_mfma_f32_16x16x32_bf16 v[104:107], a[4:7], a[132:135], v[104:107]
    ds_read_b64_tr_b16 a[30:31], v6 offset:63488
    buffer_load_dwordx4 v2, s[8:11], s81 offen lds
    v_mfma_f32_16x16x32_bf16 v[104:107], a[8:11], a[136:139], v[104:107]
    s_waitcnt lgkmcnt(4)
    ds_read_b64_tr_b16 a[32:33], v7 offset:32768
    v_mul_f32 v92, v92, v64
    v_mfma_f32_16x16x32_bf16 v[104:107], a[12:15], a[140:143], v[104:107]
    ds_read_b64_tr_b16 a[34:35], v7 offset:34816
    v_mul_f32 v93, v93, v64
    v_mfma_f32_16x16x32_bf16 v[104:107], a[16:19], a[144:147], v[104:107]
    s_add_u32 m0, s29, 147456
    ds_read_b64_tr_b16 a[36:37], v7 offset:36864
    v_mul_f32 v94, v94, v64
    v_mfma_f32_16x16x32_bf16 v[104:107], a[20:23], a[148:151], v[104:107]
    s_waitcnt lgkmcnt(3)
    ds_read_b64_tr_b16 a[38:39], v7 offset:38912
    v_mul_f32 v95, v95, v64
    v_mfma_f32_16x16x32_bf16 v[104:107], a[24:27], a[152:155], v[104:107]
    ds_read_b64_tr_b16 a[40:41], v7 offset:40960
    buffer_load_dwordx4 v2, s[8:11], s82 offen lds
    v_mfma_f32_16x16x32_bf16 v[104:107], a[28:31], a[156:159], v[104:107]
    ds_read_b64_tr_b16 a[42:43], v7 offset:43008
    v_cvt_pk_bf16_f32 v88, v88, v89
    v_mfma_f32_16x16x32_bf16 v[112:115], a[0:3], a[160:163], 0
    ds_read_b64_tr_b16 a[44:45], v7 offset:45056
    v_cvt_pk_bf16_f32 v89, v90, v91
    v_mfma_f32_16x16x32_bf16 v[112:115], a[4:7], a[164:167], v[112:115]
    ds_read_b64_tr_b16 a[46:47], v7 offset:47104
    v_cvt_pk_bf16_f32 v90, v92, v93
    v_mfma_f32_16x16x32_bf16 v[112:115], a[8:11], a[168:171], v[112:115]
    s_add_u32 m0, s29, 151552
    ds_read_b64_tr_b16 a[48:49], v7 offset:49152
    v_cvt_pk_bf16_f32 v91, v94, v95
    v_mfma_f32_16x16x32_bf16 v[112:115], a[12:15], a[172:175], v[112:115]
    ds_read_b64_tr_b16 a[50:51], v7 offset:51200
    buffer_load_dwordx4 v2, s[8:11], s83 offen lds
    v_mfma_f32_16x16x32_bf16 v[112:115], a[16:19], a[176:179], v[112:115]
    s_add_u32 s58, s48, 65536
    ds_read_b64_tr_b16 a[52:53], v7 offset:53248
    v_mul_f32 v96, v96, v65
    v_mfma_f32_16x16x32_bf16 v[112:115], a[20:23], a[180:183], v[112:115]
    ds_read_b64_tr_b16 a[54:55], v7 offset:55296
    buffer_store_dwordx4 v[88:91], v1, s[12:15], s58 offen sc1
    v_mfma_f32_16x16x32_bf16 v[112:115], a[24:27], a[184:187], v[112:115]
    s_add_u32 m0, s29, 155648
    ds_read_b64_tr_b16 a[56:57], v7 offset:57344
    v_mul_f32 v97, v97, v65
    v_mfma_f32_16x16x32_bf16 v[112:115], a[28:31], a[188:191], v[112:115]
    s_waitcnt lgkmcnt(7)
    ds_read_b64_tr_b16 a[58:59], v7 offset:59392
    v_mul_f32 v98, v98, v65
    v_mfma_f32_16x16x32_bf16 v[108:111], a[32:35], a[128:131], 0
    s_waitcnt vmcnt(8)
    ds_read_b64_tr_b16 a[60:61], v7 offset:61440
    buffer_load_dwordx4 v2, s[8:11], s84 offen lds
    v_mfma_f32_16x16x32_bf16 v[108:111], a[36:39], a[132:135], v[108:111]
    s_barrier
    ds_read_b64_tr_b16 a[62:63], v7 offset:63488
    v_xor_b32 v4, 0x10000, v4
    v_mfma_f32_16x16x32_bf16 v[108:111], a[40:43], a[136:139], v[108:111]
    s_waitcnt lgkmcnt(4)
    ds_read_b64_tr_b16 a[0:1], v4 offset:0
    v_mul_f32 v99, v99, v65
    v_mfma_f32_16x16x32_bf16 v[108:111], a[44:47], a[140:143], v[108:111]
    ds_read_b64_tr_b16 a[2:3], v4 offset:2048
    v_mul_f32 v100, v100, v65
    v_mfma_f32_16x16x32_bf16 v[108:111], a[48:51], a[144:147], v[108:111]
    s_add_u32 m0, s29, 159744
    ds_read_b64_tr_b16 a[4:5], v4 offset:4096
    v_mul_f32 v101, v101, v65
    v_mfma_f32_16x16x32_bf16 v[108:111], a[52:55], a[148:151], v[108:111]
    s_waitcnt lgkmcnt(3)
    ds_read_b64_tr_b16 a[6:7], v4 offset:6144
    buffer_load_dwordx4 v2, s[8:11], s85 offen lds
    v_mfma_f32_16x16x32_bf16 v[108:111], a[56:59], a[152:155], v[108:111]
    ds_read_b64_tr_b16 a[8:9], v4 offset:8192
    v_add_u32 v2, 128, v2
    v_mfma_f32_16x16x32_bf16 v[108:111], a[60:63], a[156:159], v[108:111]
    ds_read_b64_tr_b16 a[10:11], v4 offset:10240
    v_mul_f32 v102, v102, v65
    v_mfma_f32_16x16x32_bf16 v[116:119], a[32:35], a[160:163], 0
    ds_read_b64_tr_b16 a[12:13], v4 offset:12288
    v_mul_f32 v103, v103, v65
    v_mfma_f32_16x16x32_bf16 v[116:119], a[36:39], a[164:167], v[116:119]
    s_add_u32 m0, s29, 0
    ds_read_b64_tr_b16 a[14:15], v4 offset:14336
    v_cvt_pk_bf16_f32 v96, v96, v97
    v_mfma_f32_16x16x32_bf16 v[116:119], a[40:43], a[168:171], v[116:119]
    ds_read_b64_tr_b16 a[16:17], v4 offset:16384
    buffer_load_dwordx4 v2, s[8:11], s78 offen lds
    v_mfma_f32_16x16x32_bf16 v[116:119], a[44:47], a[172:175], v[116:119]
    ds_read_b64_tr_b16 a[18:19], v4 offset:18432
    v_cvt_pk_bf16_f32 v97, v98, v99
    v_mfma_f32_16x16x32_bf16 v[116:119], a[48:51], a[176:179], v[116:119]
    ds_read_b64_tr_b16 a[20:21], v4 offset:20480
    v_cvt_pk_bf16_f32 v98, v100, v101
    v_mfma_f32_16x16x32_bf16 v[116:119], a[52:55], a[180:183], v[116:119]
    ds_read_b64_tr_b16 a[22:23], v4 offset:22528
    v_cvt_pk_bf16_f32 v99, v102, v103
    v_mfma_f32_16x16x32_bf16 v[116:119], a[56:59], a[184:187], v[116:119]
    s_add_u32 m0, s29, 4096
    ds_read_b64_tr_b16 a[24:25], v4 offset:24576
    v_mul_f32 v104, v104, v64
    v_mfma_f32_16x16x32_bf16 v[116:119], a[60:63], a[188:191], v[116:119]
    s_waitcnt lgkmcnt(7)
    ds_read_b64_tr_b16 a[26:27], v4 offset:26624
    buffer_load_dwordx4 v2, s[8:11], s79 offen lds
    v_mfma_f32_16x16x32_bf16 v[72:75], a[0:3], a[128:131], 0
    ds_read_b64_tr_b16 a[28:29], v4 offset:28672
    v_mul_f32 v105, v105, v64
    v_mfma_f32_16x16x32_bf16 v[72:75], a[4:7], a[132:135], v[72:75]
    s_add_u32 s58, s48, 983040
    ds_read_b64_tr_b16 a[30:31], v4 offset:30720
    v_xor_b32 v5, 0x10000, v5
    v_mfma_f32_16x16x32_bf16 v[72:75], a[8:11], a[136:139], v[72:75]
    s_waitcnt lgkmcnt(4)
    ds_read_b64_tr_b16 a[32:33], v5 offset:0
    buffer_store_dwordx4 v[96:99], v1, s[12:15], s58 offen sc1
    v_mfma_f32_16x16x32_bf16 v[72:75], a[12:15], a[140:143], v[72:75]
    s_add_u32 m0, s29, 8192
    ds_read_b64_tr_b16 a[34:35], v5 offset:2048
    v_mul_f32 v106, v106, v64
    v_mfma_f32_16x16x32_bf16 v[72:75], a[16:19], a[144:147], v[72:75]
    ds_read_b64_tr_b16 a[36:37], v5 offset:4096
    buffer_load_dwordx4 v2, s[8:11], s80 offen lds
    v_mfma_f32_16x16x32_bf16 v[72:75], a[20:23], a[148:151], v[72:75]
    s_waitcnt lgkmcnt(3)
    ds_read_b64_tr_b16 a[38:39], v5 offset:6144
    v_mul_f32 v107, v107, v64
    v_mfma_f32_16x16x32_bf16 v[72:75], a[24:27], a[152:155], v[72:75]
    ds_read_b64_tr_b16 a[40:41], v5 offset:8192
    v_mul_f32 v108, v108, v64
    v_mfma_f32_16x16x32_bf16 v[72:75], a[28:31], a[156:159], v[72:75]
    ds_read_b64_tr_b16 a[42:43], v5 offset:10240
    v_mul_f32 v109, v109, v64
    v_mfma_f32_16x16x32_bf16 v[80:83], a[0:3], a[160:163], 0
    s_add_u32 m0, s29, 12288
    ds_read_b64_tr_b16 a[44:45], v5 offset:12288
    v_mul_f32 v110, v110, v64
    v_mfma_f32_16x16x32_bf16 v[80:83], a[4:7], a[164:167], v[80:83]
    ds_read_b64_tr_b16 a[46:47], v5 offset:14336
    buffer_load_dwordx4 v2, s[8:11], s81 offen lds
    v_mfma_f32_16x16x32_bf16 v[80:83], a[8:11], a[168:171], v[80:83]
    ds_read_b64_tr_b16 a[48:49], v5 offset:16384
    v_mul_f32 v111, v111, v64
    v_mfma_f32_16x16x32_bf16 v[80:83], a[12:15], a[172:175], v[80:83]
    ds_read_b64_tr_b16 a[50:51], v5 offset:18432
    v_cvt_pk_bf16_f32 v104, v104, v105
    v_mfma_f32_16x16x32_bf16 v[80:83], a[16:19], a[176:179], v[80:83]
    ds_read_b64_tr_b16 a[52:53], v5 offset:20480
    v_cvt_pk_bf16_f32 v105, v106, v107
    v_mfma_f32_16x16x32_bf16 v[80:83], a[20:23], a[180:183], v[80:83]
    s_add_u32 m0, s29, 16384
    ds_read_b64_tr_b16 a[54:55], v5 offset:22528
    v_cvt_pk_bf16_f32 v106, v108, v109
    v_mfma_f32_16x16x32_bf16 v[80:83], a[24:27], a[184:187], v[80:83]
    ds_read_b64_tr_b16 a[56:57], v5 offset:24576
    buffer_load_dwordx4 v2, s[8:11], s82 offen lds
    v_mfma_f32_16x16x32_bf16 v[80:83], a[28:31], a[188:191], v[80:83]
    s_waitcnt lgkmcnt(7)
    ds_read_b64_tr_b16 a[58:59], v5 offset:26624
    v_cvt_pk_bf16_f32 v107, v110, v111
    v_mfma_f32_16x16x32_bf16 v[76:79], a[32:35], a[128:131], 0
    ds_read_b64_tr_b16 a[60:61], v5 offset:28672
    v_mul_f32 v112, v112, v65
    v_mfma_f32_16x16x32_bf16 v[76:79], a[36:39], a[132:135], v[76:79]
    s_add_u32 m0, s29, 20480
    ds_read_b64_tr_b16 a[62:63], v5 offset:30720
    v_xor_b32 v6, 0x10000, v6
    v_mfma_f32_16x16x32_bf16 v[76:79], a[40:43], a[136:139], v[76:79]
    s_waitcnt lgkmcnt(4)
    ds_read_b64_tr_b16 a[0:1], v6 offset:0
    v_mul_f32 v113, v113, v65
    v_mfma_f32_16x16x32_bf16 v[76:79], a[44:47], a[140:143], v[76:79]
    ds_read_b64_tr_b16 a[2:3], v6 offset:2048
    buffer_load_dwordx4 v2, s[8:11], s83 offen lds
    v_mfma_f32_16x16x32_bf16 v[76:79], a[48:51], a[144:147], v[76:79]
    s_add_u32 s58, s48, 81920
    ds_read_b64_tr_b16 a[4:5], v6 offset:4096
    v_mul_f32 v114, v114, v65
    v_mfma_f32_16x16x32_bf16 v[76:79], a[52:55], a[148:151], v[76:79]
    s_waitcnt lgkmcnt(3)
    ds_read_b64_tr_b16 a[6:7], v6 offset:6144
    buffer_store_dwordx4 v[104:107], v1, s[12:15], s58 offen sc1
    v_mfma_f32_16x16x32_bf16 v[76:79], a[56:59], a[152:155], v[76:79]
    ds_read_b64_tr_b16 a[8:9], v6 offset:8192
    v_mul_f32 v115, v115, v65
    v_mfma_f32_16x16x32_bf16 v[76:79], a[60:63], a[156:159], v[76:79]
    s_add_u32 m0, s29, 24576
    ds_read_b64_tr_b16 a[10:11], v6 offset:10240
    v_mul_f32 v116, v116, v65
    v_mfma_f32_16x16x32_bf16 v[84:87], a[32:35], a[160:163], 0
    ds_read_b64_tr_b16 a[12:13], v6 offset:12288
    buffer_load_dwordx4 v2, s[8:11], s84 offen lds
    v_mfma_f32_16x16x32_bf16 v[84:87], a[36:39], a[164:167], v[84:87]
    ds_read_b64_tr_b16 a[14:15], v6 offset:14336
    v_mul_f32 v117, v117, v65
    v_mfma_f32_16x16x32_bf16 v[84:87], a[40:43], a[168:171], v[84:87]
    ds_read_b64_tr_b16 a[16:17], v6 offset:16384
    v_mul_f32 v118, v118, v65
    v_mfma_f32_16x16x32_bf16 v[84:87], a[44:47], a[172:175], v[84:87]
    ds_read_b64_tr_b16 a[18:19], v6 offset:18432
    v_mul_f32 v119, v119, v65
    v_mfma_f32_16x16x32_bf16 v[84:87], a[48:51], a[176:179], v[84:87]
    s_add_u32 m0, s29, 28672
    ds_read_b64_tr_b16 a[20:21], v6 offset:20480
    v_cvt_pk_bf16_f32 v112, v112, v113
    v_mfma_f32_16x16x32_bf16 v[84:87], a[52:55], a[180:183], v[84:87]
    ds_read_b64_tr_b16 a[22:23], v6 offset:22528
    buffer_load_dwordx4 v2, s[8:11], s85 offen lds
    v_mfma_f32_16x16x32_bf16 v[84:87], a[56:59], a[184:187], v[84:87]
    ds_read_b64_tr_b16 a[24:25], v6 offset:24576
    v_add_u32 v2, 128, v2
    v_mfma_f32_16x16x32_bf16 v[84:87], a[60:63], a[188:191], v[84:87]
    s_waitcnt lgkmcnt(7)
    ds_read_b64_tr_b16 a[26:27], v6 offset:26624
    v_cvt_pk_bf16_f32 v113, v114, v115
    v_mfma_f32_16x16x32_bf16 v[88:91], a[0:3], a[128:131], 0
    ds_read_b64_tr_b16 a[28:29], v6 offset:28672
    v_cvt_pk_bf16_f32 v114, v116, v117
    v_mfma_f32_16x16x32_bf16 v[88:91], a[4:7], a[132:135], v[88:91]
    s_add_u32 s58, s48, 999424
    ds_read_b64_tr_b16 a[30:31], v6 offset:30720
    v_xor_b32 v7, 0x10000, v7
    v_mfma_f32_16x16x32_bf16 v[88:91], a[8:11], a[136:139], v[88:91]
    s_waitcnt lgkmcnt(4)
    ds_read_b64_tr_b16 a[32:33], v7 offset:0
    v_cvt_pk_bf16_f32 v115, v118, v119
    v_mfma_f32_16x16x32_bf16 v[88:91], a[12:15], a[140:143], v[88:91]
    ds_read_b64_tr_b16 a[34:35], v7 offset:2048
    buffer_store_dwordx4 v[112:115], v1, s[12:15], s58 offen sc1
    v_mfma_f32_16x16x32_bf16 v[88:91], a[16:19], a[144:147], v[88:91]
    ds_read_b64_tr_b16 a[36:37], v7 offset:4096
    v_mul_f32 v72, v72, v64
    v_mfma_f32_16x16x32_bf16 v[88:91], a[20:23], a[148:151], v[88:91]
    s_waitcnt lgkmcnt(3)
    ds_read_b64_tr_b16 a[38:39], v7 offset:6144
    v_mul_f32 v73, v73, v64
    v_mfma_f32_16x16x32_bf16 v[88:91], a[24:27], a[152:155], v[88:91]
    ds_read_b64_tr_b16 a[40:41], v7 offset:8192
    v_mul_f32 v74, v74, v64
    v_mfma_f32_16x16x32_bf16 v[88:91], a[28:31], a[156:159], v[88:91]
    ds_read_b64_tr_b16 a[42:43], v7 offset:10240
    v_mul_f32 v75, v75, v64
    v_mfma_f32_16x16x32_bf16 v[96:99], a[0:3], a[160:163], 0
    ds_read_b64_tr_b16 a[44:45], v7 offset:12288
    v_mul_f32 v76, v76, v64
    v_mfma_f32_16x16x32_bf16 v[96:99], a[4:7], a[164:167], v[96:99]
    ds_read_b64_tr_b16 a[46:47], v7 offset:14336
    v_mul_f32 v77, v77, v64
    v_mfma_f32_16x16x32_bf16 v[96:99], a[8:11], a[168:171], v[96:99]
    ds_read_b64_tr_b16 a[48:49], v7 offset:16384
    v_mul_f32 v78, v78, v64
    v_mfma_f32_16x16x32_bf16 v[96:99], a[12:15], a[172:175], v[96:99]
    ds_read_b64_tr_b16 a[50:51], v7 offset:18432
    v_mul_f32 v79, v79, v64
    v_mfma_f32_16x16x32_bf16 v[96:99], a[16:19], a[176:179], v[96:99]
    ds_read_b64_tr_b16 a[52:53], v7 offset:20480
    v_cvt_pk_bf16_f32 v72, v72, v73
    v_mfma_f32_16x16x32_bf16 v[96:99], a[20:23], a[180:183], v[96:99]
    ds_read_b64_tr_b16 a[54:55], v7 offset:22528
    v_cvt_pk_bf16_f32 v73, v74, v75
    v_mfma_f32_16x16x32_bf16 v[96:99], a[24:27], a[184:187], v[96:99]
    s_add_u32 s58, s48, 98304
    ds_read_b64_tr_b16 a[56:57], v7 offset:24576
    v_cvt_pk_bf16_f32 v74, v76, v77
    v_mfma_f32_16x16x32_bf16 v[96:99], a[28:31], a[188:191], v[96:99]
    s_waitcnt lgkmcnt(7)
    ds_read_b64_tr_b16 a[58:59], v7 offset:26624
    v_cvt_pk_bf16_f32 v75, v78, v79
    v_mfma_f32_16x16x32_bf16 v[92:95], a[32:35], a[128:131], 0
    ds_read_b64_tr_b16 a[60:61], v7 offset:28672
    buffer_store_dwordx4 v[72:75], v1, s[12:15], s58 offen sc1
    v_mfma_f32_16x16x32_bf16 v[92:95], a[36:39], a[132:135], v[92:95]
    ds_read_b64_tr_b16 a[62:63], v7 offset:30720
    v_mul_f32 v80, v80, v65
    v_mfma_f32_16x16x32_bf16 v[92:95], a[40:43], a[136:139], v[92:95]
    s_waitcnt lgkmcnt(4)
    ds_read_b64_tr_b16 a[0:1], v4 offset:32768
    v_mul_f32 v81, v81, v65
    v_mfma_f32_16x16x32_bf16 v[92:95], a[44:47], a[140:143], v[92:95]
    ds_read_b64_tr_b16 a[2:3], v4 offset:34816
    v_mul_f32 v82, v82, v65
    v_mfma_f32_16x16x32_bf16 v[92:95], a[48:51], a[144:147], v[92:95]
    ds_read_b64_tr_b16 a[4:5], v4 offset:36864
    v_mul_f32 v83, v83, v65
    v_mfma_f32_16x16x32_bf16 v[92:95], a[52:55], a[148:151], v[92:95]
    s_waitcnt lgkmcnt(3)
    ds_read_b64_tr_b16 a[6:7], v4 offset:38912
    v_mul_f32 v84, v84, v65
    v_mfma_f32_16x16x32_bf16 v[92:95], a[56:59], a[152:155], v[92:95]
    ds_read_b64_tr_b16 a[8:9], v4 offset:40960
    v_mul_f32 v85, v85, v65
    v_mfma_f32_16x16x32_bf16 v[92:95], a[60:63], a[156:159], v[92:95]
    ds_read_b64_tr_b16 a[10:11], v4 offset:43008
    v_mul_f32 v86, v86, v65
    v_mfma_f32_16x16x32_bf16 v[100:103], a[32:35], a[160:163], 0
    ds_read_b64_tr_b16 a[12:13], v4 offset:45056
    v_mul_f32 v87, v87, v65
    v_mfma_f32_16x16x32_bf16 v[100:103], a[36:39], a[164:167], v[100:103]
    ds_read_b64_tr_b16 a[14:15], v4 offset:47104
    v_cvt_pk_bf16_f32 v80, v80, v81
    v_mfma_f32_16x16x32_bf16 v[100:103], a[40:43], a[168:171], v[100:103]
    ds_read_b64_tr_b16 a[16:17], v4 offset:49152
    v_cvt_pk_bf16_f32 v81, v82, v83
    v_mfma_f32_16x16x32_bf16 v[100:103], a[44:47], a[172:175], v[100:103]
    ds_read_b64_tr_b16 a[18:19], v4 offset:51200
    v_cvt_pk_bf16_f32 v82, v84, v85
    v_mfma_f32_16x16x32_bf16 v[100:103], a[48:51], a[176:179], v[100:103]
    s_add_u32 s58, s48, 1015808
    ds_read_b64_tr_b16 a[20:21], v4 offset:53248
    v_cvt_pk_bf16_f32 v83, v86, v87
    v_mfma_f32_16x16x32_bf16 v[100:103], a[52:55], a[180:183], v[100:103]
    ds_read_b64_tr_b16 a[22:23], v4 offset:55296
    buffer_store_dwordx4 v[80:83], v1, s[12:15], s58 offen sc1
    v_mfma_f32_16x16x32_bf16 v[100:103], a[56:59], a[184:187], v[100:103]
    ds_read_b64_tr_b16 a[24:25], v4 offset:57344
    v_mul_f32 v88, v88, v64
    v_mfma_f32_16x16x32_bf16 v[100:103], a[60:63], a[188:191], v[100:103]
    s_waitcnt lgkmcnt(7)
    ds_read_b64_tr_b16 a[26:27], v4 offset:59392
    v_mul_f32 v89, v89, v64
    v_mfma_f32_16x16x32_bf16 v[104:107], a[0:3], a[128:131], 0
    ds_read_b64_tr_b16 a[28:29], v4 offset:61440
    v_mul_f32 v90, v90, v64
    v_mfma_f32_16x16x32_bf16 v[104:107], a[4:7], a[132:135], v[104:107]
    ds_read_b64_tr_b16 a[30:31], v4 offset:63488
    v_mul_f32 v91, v91, v64
    v_mfma_f32_16x16x32_bf16 v[104:107], a[8:11], a[136:139], v[104:107]
    s_waitcnt lgkmcnt(4)
    ds_read_b64_tr_b16 a[32:33], v5 offset:32768
    v_mul_f32 v92, v92, v64
    v_mfma_f32_16x16x32_bf16 v[104:107], a[12:15], a[140:143], v[104:107]
    ds_read_b64_tr_b16 a[34:35], v5 offset:34816
    v_mul_f32 v93, v93, v64
    v_mfma_f32_16x16x32_bf16 v[104:107], a[16:19], a[144:147], v[104:107]
    ds_read_b64_tr_b16 a[36:37], v5 offset:36864
    v_mul_f32 v94, v94, v64
    v_mfma_f32_16x16x32_bf16 v[104:107], a[20:23], a[148:151], v[104:107]
    s_waitcnt lgkmcnt(3)
    ds_read_b64_tr_b16 a[38:39], v5 offset:38912
    v_mul_f32 v95, v95, v64
    v_mfma_f32_16x16x32_bf16 v[104:107], a[24:27], a[152:155], v[104:107]
    ds_read_b64_tr_b16 a[40:41], v5 offset:40960
    v_cvt_pk_bf16_f32 v88, v88, v89
    v_mfma_f32_16x16x32_bf16 v[104:107], a[28:31], a[156:159], v[104:107]
    ds_read_b64_tr_b16 a[42:43], v5 offset:43008
    v_cvt_pk_bf16_f32 v89, v90, v91
    v_mfma_f32_16x16x32_bf16 v[112:115], a[0:3], a[160:163], 0
    ds_read_b64_tr_b16 a[44:45], v5 offset:45056
    v_cvt_pk_bf16_f32 v90, v92, v93
    v_mfma_f32_16x16x32_bf16 v[112:115], a[4:7], a[164:167], v[112:115]
    s_add_u32 s58, s48, 114688
    ds_read_b64_tr_b16 a[46:47], v5 offset:47104
    v_cvt_pk_bf16_f32 v91, v94, v95
    v_mfma_f32_16x16x32_bf16 v[112:115], a[8:11], a[168:171], v[112:115]
    ds_read_b64_tr_b16 a[48:49], v5 offset:49152
    buffer_store_dwordx4 v[88:91], v1, s[12:15], s58 offen sc1
    v_mfma_f32_16x16x32_bf16 v[112:115], a[12:15], a[172:175], v[112:115]
    ds_read_b64_tr_b16 a[50:51], v5 offset:51200
    v_mul_f32 v96, v96, v65
    v_mfma_f32_16x16x32_bf16 v[112:115], a[16:19], a[176:179], v[112:115]
    ds_read_b64_tr_b16 a[52:53], v5 offset:53248
    v_mul_f32 v97, v97, v65
    v_mfma_f32_16x16x32_bf16 v[112:115], a[20:23], a[180:183], v[112:115]
    ds_read_b64_tr_b16 a[54:55], v5 offset:55296
    v_mul_f32 v98, v98, v65
    v_mfma_f32_16x16x32_bf16 v[112:115], a[24:27], a[184:187], v[112:115]
    ds_read_b64_tr_b16 a[56:57], v5 offset:57344
    v_mul_f32 v99, v99, v65
    v_mfma_f32_16x16x32_bf16 v[112:115], a[28:31], a[188:191], v[112:115]
    s_waitcnt lgkmcnt(7)
    ds_read_b64_tr_b16 a[58:59], v5 offset:59392
    v_mul_f32 v100, v100, v65
    v_mfma_f32_16x16x32_bf16 v[108:111], a[32:35], a[128:131], 0
    ds_read_b64_tr_b16 a[60:61], v5 offset:61440
    v_mul_f32 v101, v101, v65
    v_mfma_f32_16x16x32_bf16 v[108:111], a[36:39], a[132:135], v[108:111]
    ds_read_b64_tr_b16 a[62:63], v5 offset:63488
    v_mul_f32 v102, v102, v65
    v_mfma_f32_16x16x32_bf16 v[108:111], a[40:43], a[136:139], v[108:111]
    s_waitcnt lgkmcnt(4)
    ds_read_b64_tr_b16 a[0:1], v6 offset:32768
    v_mul_f32 v103, v103, v65
    v_mfma_f32_16x16x32_bf16 v[108:111], a[44:47], a[140:143], v[108:111]
    ds_read_b64_tr_b16 a[2:3], v6 offset:34816
    v_cvt_pk_bf16_f32 v96, v96, v97
    v_mfma_f32_16x16x32_bf16 v[108:111], a[48:51], a[144:147], v[108:111]
    ds_read_b64_tr_b16 a[4:5], v6 offset:36864
    v_cvt_pk_bf16_f32 v97, v98, v99
    v_mfma_f32_16x16x32_bf16 v[108:111], a[52:55], a[148:151], v[108:111]
    s_waitcnt lgkmcnt(3)
    ds_read_b64_tr_b16 a[6:7], v6 offset:38912
    v_cvt_pk_bf16_f32 v98, v100, v101
    v_mfma_f32_16x16x32_bf16 v[108:111], a[56:59], a[152:155], v[108:111]
    s_add_u32 s58, s48, 1032192
    ds_read_b64_tr_b16 a[8:9], v6 offset:40960
    v_cvt_pk_bf16_f32 v99, v102, v103
    v_mfma_f32_16x16x32_bf16 v[108:111], a[60:63], a[156:159], v[108:111]
    ds_read_b64_tr_b16 a[10:11], v6 offset:43008
    buffer_store_dwordx4 v[96:99], v1, s[12:15], s58 offen sc1
    v_mfma_f32_16x16x32_bf16 v[116:119], a[32:35], a[160:163], 0
    ds_read_b64_tr_b16 a[12:13], v6 offset:45056
    v_mul_f32 v104, v104, v64
    v_mfma_f32_16x16x32_bf16 v[116:119], a[36:39], a[164:167], v[116:119]
    ds_read_b64_tr_b16 a[14:15], v6 offset:47104
    v_mul_f32 v105, v105, v64
    v_mfma_f32_16x16x32_bf16 v[116:119], a[40:43], a[168:171], v[116:119]
    ds_read_b64_tr_b16 a[16:17], v6 offset:49152
    v_mul_f32 v106, v106, v64
    v_mfma_f32_16x16x32_bf16 v[116:119], a[44:47], a[172:175], v[116:119]
    ds_read_b64_tr_b16 a[18:19], v6 offset:51200
    v_mul_f32 v107, v107, v64
    v_mfma_f32_16x16x32_bf16 v[116:119], a[48:51], a[176:179], v[116:119]
    ds_read_b64_tr_b16 a[20:21], v6 offset:53248
    v_mul_f32 v108, v108, v64
    v_mfma_f32_16x16x32_bf16 v[116:119], a[52:55], a[180:183], v[116:119]
    ds_read_b64_tr_b16 a[22:23], v6 offset:55296
    v_mul_f32 v109, v109, v64
    v_mfma_f32_16x16x32_bf16 v[116:119], a[56:59], a[184:187], v[116:119]
    ds_read_b64_tr_b16 a[24:25], v6 offset:57344
    v_mul_f32 v110, v110, v64
    v_mfma_f32_16x16x32_bf16 v[116:119], a[60:63], a[188:191], v[116:119]
    s_waitcnt lgkmcnt(7)
    ds_read_b64_tr_b16 a[26:27], v6 offset:59392
    v_mul_f32 v111, v111, v64
    v_mfma_f32_16x16x32_bf16 v[72:75], a[0:3], a[128:131], 0
    ds_read_b64_tr_b16 a[28:29], v6 offset:61440
    v_cvt_pk_bf16_f32 v104, v104, v105
    v_mfma_f32_16x16x32_bf16 v[72:75], a[4:7], a[132:135], v[72:75]
    ds_read_b64_tr_b16 a[30:31], v6 offset:63488
    v_cvt_pk_bf16_f32 v105, v106, v107
    v_mfma_f32_16x16x32_bf16 v[72:75], a[8:11], a[136:139], v[72:75]
    s_waitcnt lgkmcnt(4)
    ds_read_b64_tr_b16 a[32:33], v7 offset:32768
    v_cvt_pk_bf16_f32 v106, v108, v109
    v_mfma_f32_16x16x32_bf16 v[72:75], a[12:15], a[140:143], v[72:75]
    s_add_u32 s58, s48, 131072
    ds_read_b64_tr_b16 a[34:35], v7 offset:34816
    v_cvt_pk_bf16_f32 v107, v110, v111
    v_mfma_f32_16x16x32_bf16 v[72:75], a[16:19], a[144:147], v[72:75]
    ds_read_b64_tr_b16 a[36:37], v7 offset:36864
    buffer_store_dwordx4 v[104:107], v1, s[12:15], s58 offen sc1
    v_mfma_f32_16x16x32_bf16 v[72:75], a[20:23], a[148:151], v[72:75]
    s_waitcnt lgkmcnt(3)
    ds_read_b64_tr_b16 a[38:39], v7 offset:38912
    v_mul_f32 v112, v112, v65
    v_mfma_f32_16x16x32_bf16 v[72:75], a[24:27], a[152:155], v[72:75]
    ds_read_b64_tr_b16 a[40:41], v7 offset:40960
    v_mul_f32 v113, v113, v65
    v_mfma_f32_16x16x32_bf16 v[72:75], a[28:31], a[156:159], v[72:75]
    ds_read_b64_tr_b16 a[42:43], v7 offset:43008
    v_mul_f32 v114, v114, v65
    v_mfma_f32_16x16x32_bf16 v[80:83], a[0:3], a[160:163], 0
    ds_read_b64_tr_b16 a[44:45], v7 offset:45056
    v_mul_f32 v115, v115, v65
    v_mfma_f32_16x16x32_bf16 v[80:83], a[4:7], a[164:167], v[80:83]
    ds_read_b64_tr_b16 a[46:47], v7 offset:47104
    v_mul_f32 v116, v116, v65
    v_mfma_f32_16x16x32_bf16 v[80:83], a[8:11], a[168:171], v[80:83]
    ds_read_b64_tr_b16 a[48:49], v7 offset:49152
    v_mul_f32 v117, v117, v65
    v_mfma_f32_16x16x32_bf16 v[80:83], a[12:15], a[172:175], v[80:83]
    ds_read_b64_tr_b16 a[50:51], v7 offset:51200
    v_mul_f32 v118, v118, v65
    v_mfma_f32_16x16x32_bf16 v[80:83], a[16:19], a[176:179], v[80:83]
    ds_read_b64_tr_b16 a[52:53], v7 offset:53248
    v_mul_f32 v119, v119, v65
    v_mfma_f32_16x16x32_bf16 v[80:83], a[20:23], a[180:183], v[80:83]
    ds_read_b64_tr_b16 a[54:55], v7 offset:55296
    v_cvt_pk_bf16_f32 v112, v112, v113
    v_mfma_f32_16x16x32_bf16 v[80:83], a[24:27], a[184:187], v[80:83]
    ds_read_b64_tr_b16 a[56:57], v7 offset:57344
    v_cvt_pk_bf16_f32 v113, v114, v115
    v_mfma_f32_16x16x32_bf16 v[80:83], a[28:31], a[188:191], v[80:83]
    s_waitcnt lgkmcnt(7)
    ds_read_b64_tr_b16 a[58:59], v7 offset:59392
    v_cvt_pk_bf16_f32 v114, v116, v117
    v_mfma_f32_16x16x32_bf16 v[76:79], a[32:35], a[128:131], 0
    s_waitcnt vmcnt(3)
    ds_read_b64_tr_b16 a[60:61], v7 offset:61440
    v_cvt_pk_bf16_f32 v115, v118, v119
    v_mfma_f32_16x16x32_bf16 v[76:79], a[36:39], a[132:135], v[76:79]
    s_barrier
    ds_read_b64_tr_b16 a[62:63], v7 offset:63488
    v_xor_b32 v4, 0x30000, v4
    v_mfma_f32_16x16x32_bf16 v[76:79], a[40:43], a[136:139], v[76:79]
    s_waitcnt lgkmcnt(4)
    ds_read_b64_tr_b16 a[0:1], v4 offset:0
    buffer_store_dword v9, v9, s[12:15], s93 offen offset:64 sc1
    v_mfma_f32_16x16x32_bf16 v[76:79], a[44:47], a[140:143], v[76:79]
    s_add_u32 s58, s48, 1048576
    ds_read_b64_tr_b16 a[2:3], v4 offset:2048
    v_mul_f32 v72, v72, v64
    v_mfma_f32_16x16x32_bf16 v[76:79], a[48:51], a[144:147], v[76:79]
    ds_read_b64_tr_b16 a[4:5], v4 offset:4096
    buffer_store_dwordx4 v[112:115], v1, s[12:15], s58 offen sc1
    v_mfma_f32_16x16x32_bf16 v[76:79], a[52:55], a[148:151], v[76:79]
    s_waitcnt lgkmcnt(3)
    ds_read_b64_tr_b16 a[6:7], v4 offset:6144
    v_mul_f32 v73, v73, v64
    v_mfma_f32_16x16x32_bf16 v[76:79], a[56:59], a[152:155], v[76:79]
    ds_read_b64_tr_b16 a[8:9], v4 offset:8192
    v_mul_f32 v74, v74, v64
    v_mfma_f32_16x16x32_bf16 v[76:79], a[60:63], a[156:159], v[76:79]
    ds_read_b64_tr_b16 a[10:11], v4 offset:10240
    v_mul_f32 v75, v75, v64
    v_mfma_f32_16x16x32_bf16 v[84:87], a[32:35], a[160:163], 0
    ds_read_b64_tr_b16 a[12:13], v4 offset:12288
    v_mul_f32 v80, v80, v65
    v_mfma_f32_16x16x32_bf16 v[84:87], a[36:39], a[164:167], v[84:87]
    ds_read_b64_tr_b16 a[14:15], v4 offset:14336
    v_mul_f32 v81, v81, v65
    v_mfma_f32_16x16x32_bf16 v[84:87], a[40:43], a[168:171], v[84:87]
    ds_read_b64_tr_b16 a[16:17], v4 offset:16384
    v_mul_f32 v82, v82, v65
    v_mfma_f32_16x16x32_bf16 v[84:87], a[44:47], a[172:175], v[84:87]
    s_waitcnt lgkmcnt(9)
    ds_read_b64_tr_b16 a[18:19], v4 offset:18432
    v_mul_f32 v83, v83, v65
    v_mfma_f32_16x16x32_bf16 v[84:87], a[48:51], a[176:179], v[84:87]
    s_barrier
    ds_read_b64_tr_b16 a[20:21], v4 offset:20480
    v_mul_f32 v76, v76, v64
    v_mfma_f32_16x16x32_bf16 v[84:87], a[52:55], a[180:183], v[84:87]
    s_add_u32 m0, s33, 4640
    ds_read_b64_tr_b16 a[22:23], v4 offset:22528
    v_mul_f32 v77, v77, v64
    v_mfma_f32_16x16x32_bf16 v[84:87], a[56:59], a[184:187], v[84:87]
    ds_read_b64_tr_b16 a[24:25], v4 offset:24576
    buffer_load_dwordx4 v1, s[4:7], s34 offen offset:0 lds
    v_mfma_f32_16x16x32_bf16 v[84:87], a[60:63], a[188:191], v[84:87]
    s_waitcnt lgkmcnt(7)
    ds_read_b64_tr_b16 a[26:27], v4 offset:26624
    v_mul_f32 v78, v78, v64
    v_mfma_f32_16x16x32_bf16 v[88:91], a[0:3], a[128:131], 0
    ds_read_b64_tr_b16 a[28:29], v4 offset:28672
    v_mul_f32 v79, v79, v64
    v_mfma_f32_16x16x32_bf16 v[88:91], a[4:7], a[132:135], v[88:91]
    ds_read_b64_tr_b16 a[30:31], v4 offset:30720
    v_xor_b32 v5, 0x30000, v5
    v_mfma_f32_16x16x32_bf16 v[88:91], a[8:11], a[136:139], v[88:91]
    s_waitcnt lgkmcnt(4)
    ds_read_b64_tr_b16 a[32:33], v5 offset:0
    v_cvt_pk_bf16_f32 v72, v72, v73
    v_mfma_f32_16x16x32_bf16 v[88:91], a[12:15], a[140:143], v[88:91]
    ds_read_b64_tr_b16 a[34:35], v5 offset:2048
    buffer_load_dwordx4 v1, s[4:7], s34 offen offset:1024 lds
    v_mfma_f32_16x16x32_bf16 v[88:91], a[16:19], a[144:147], v[88:91]
    ds_read_b64_tr_b16 a[36:37], v5 offset:4096
    v_cvt_pk_bf16_f32 v73, v74, v75
    v_mfma_f32_16x16x32_bf16 v[88:91], a[20:23], a[148:151], v[88:91]
    s_waitcnt lgkmcnt(3)
    ds_read_b64_tr_b16 a[38:39], v5 offset:6144
    v_cvt_pk_bf16_f32 v74, v76, v77
    v_mfma_f32_16x16x32_bf16 v[88:91], a[24:27], a[152:155], v[88:91]
    ds_read_b64_tr_b16 a[40:41], v5 offset:8192
    v_cvt_pk_bf16_f32 v75, v78, v79
    v_mfma_f32_16x16x32_bf16 v[88:91], a[28:31], a[156:159], v[88:91]
    ds_read_b64_tr_b16 a[42:43], v5 offset:10240
    v_mul_f32 v84, v84, v65
    v_mfma_f32_16x16x32_bf16 v[96:99], a[0:3], a[160:163], 0
    ds_read_b64_tr_b16 a[44:45], v5 offset:12288
    buffer_load_dwordx4 v1, s[4:7], s34 offen offset:2048 lds
    v_mfma_f32_16x16x32_bf16 v[96:99], a[4:7], a[164:167], v[96:99]
    s_add_u32 s58, s48, 147456
    ds_read_b64_tr_b16 a[46:47], v5 offset:14336
    v_mul_f32 v85, v85, v65
    v_mfma_f32_16x16x32_bf16 v[96:99], a[8:11], a[168:171], v[96:99]
    ds_read_b64_tr_b16 a[48:49], v5 offset:16384
    buffer_store_dwordx4 v[72:75], v1, s[12:15], s58 offen sc1
    v_mfma_f32_16x16x32_bf16 v[96:99], a[12:15], a[172:175], v[96:99]
    ds_read_b64_tr_b16 a[50:51], v5 offset:18432
    v_mul_f32 v86, v86, v65
    v_mfma_f32_16x16x32_bf16 v[96:99], a[16:19], a[176:179], v[96:99]
    ds_read_b64_tr_b16 a[52:53], v5 offset:20480
    v_mul_f32 v87, v87, v65
    v_mfma_f32_16x16x32_bf16 v[96:99], a[20:23], a[180:183], v[96:99]
    ds_read_b64_tr_b16 a[54:55], v5 offset:22528
    buffer_load_dwordx4 v1, s[4:7], s34 offen offset:3072 lds
    v_mfma_f32_16x16x32_bf16 v[96:99], a[24:27], a[184:187], v[96:99]
    ds_read_b64_tr_b16 a[56:57], v5 offset:24576
    v_cvt_pk_bf16_f32 v80, v80, v81
    v_mfma_f32_16x16x32_bf16 v[96:99], a[28:31], a[188:191], v[96:99]
    s_waitcnt lgkmcnt(7)
    ds_read_b64_tr_b16 a[58:59], v5 offset:26624
    v_cvt_pk_bf16_f32 v81, v82, v83
    v_mfma_f32_16x16x32_bf16 v[92:95], a[32:35], a[128:131], 0
    ds_read_b64_tr_b16 a[60:61], v5 offset:28672
    v_cvt_pk_bf16_f32 v82, v84, v85
    v_mfma_f32_16x16x32_bf16 v[92:95], a[36:39], a[132:135], v[92:95]
    s_add_u32 m0, s33, 128
    ds_read_b64_tr_b16 a[62:63], v5 offset:30720
    v_xor_b32 v6, 0x30000, v6
    v_mfma_f32_16x16x32_bf16 v[92:95], a[40:43], a[136:139], v[92:95]
    s_waitcnt lgkmcnt(4)
    ds_read_b64_tr_b16 a[0:1], v6 offset:0
    buffer_load_dwordx4 v10, s[12:15], s35 offen offset:0 sc1 lds
    v_mfma_f32_16x16x32_bf16 v[92:95], a[44:47], a[140:143], v[92:95]
    s_add_u32 s58, s48, 1064960
    ds_read_b64_tr_b16 a[2:3], v6 offset:2048
    v_cvt_pk_bf16_f32 v83, v86, v87
    v_mfma_f32_16x16x32_bf16 v[92:95], a[48:51], a[144:147], v[92:95]
    ds_read_b64_tr_b16 a[4:5], v6 offset:4096
    buffer_store_dwordx4 v[80:83], v1, s[12:15], s58 offen sc1
    v_mfma_f32_16x16x32_bf16 v[92:95], a[52:55], a[148:151], v[92:95]
    s_waitcnt lgkmcnt(3)
    ds_read_b64_tr_b16 a[6:7], v6 offset:6144
    v_mul_f32 v88, v88, v64
    v_mfma_f32_16x16x32_bf16 v[92:95], a[56:59], a[152:155], v[92:95]
    s_add_u32 m0, s33, 1248
    ds_read_b64_tr_b16 a[8:9], v6 offset:8192
    v_mul_f32 v89, v89, v64
    v_mfma_f32_16x16x32_bf16 v[92:95], a[60:63], a[156:159], v[92:95]
    ds_read_b64_tr_b16 a[10:11], v6 offset:10240
    buffer_load_dwordx4 v10, s[12:15], s35 offen offset:32 sc1 lds
    v_mfma_f32_16x16x32_bf16 v[100:103], a[32:35], a[160:163], 0
    ds_read_b64_tr_b16 a[12:13], v6 offset:12288
    v_mul_f32 v90, v90, v64
    v_mfma_f32_16x16x32_bf16 v[100:103], a[36:39], a[164:167], v[100:103]
    ds_read_b64_tr_b16 a[14:15], v6 offset:14336
    v_mul_f32 v91, v91, v64
    v_mfma_f32_16x16x32_bf16 v[100:103], a[40:43], a[168:171], v[100:103]
    ds_read_b64_tr_b16 a[16:17], v6 offset:16384
    v_mul_f32 v96, v96, v65
    v_mfma_f32_16x16x32_bf16 v[100:103], a[44:47], a[172:175], v[100:103]
    s_add_u32 m0, s33, 2368
    ds_read_b64_tr_b16 a[18:19], v6 offset:18432
    v_mul_f32 v97, v97, v65
    v_mfma_f32_16x16x32_bf16 v[100:103], a[48:51], a[176:179], v[100:103]
    ds_read_b64_tr_b16 a[20:21], v6 offset:20480
    buffer_load_dwordx4 v10, s[12:15], s35 offen offset:64 sc1 lds
    v_mfma_f32_16x16x32_bf16 v[100:103], a[52:55], a[180:183], v[100:103]
    ds_read_b64_tr_b16 a[22:23], v6 offset:22528
    v_mul_f32 v92, v92, v64
    v_mfma_f32_16x16x32_bf16 v[100:103], a[56:59], a[184:187], v[100:103]
    ds_read_b64_tr_b16 a[24:25], v6 offset:24576
    v_mul_f32 v93, v93, v64
    v_mfma_f32_16x16x32_bf16 v[100:103], a[60:63], a[188:191], v[100:103]
    s_waitcnt lgkmcnt(7)
    ds_read_b64_tr_b16 a[26:27], v6 offset:26624
    v_mul_f32 v94, v94, v64
    v_mfma_f32_16x16x32_bf16 v[104:107], a[0:3], a[128:131], 0
    ds_read_b64_tr_b16 a[28:29], v6 offset:28672
    v_mul_f32 v95, v95, v64
    v_mfma_f32_16x16x32_bf16 v[104:107], a[4:7], a[132:135], v[104:107]
    s_add_u32 m0, s33, 3488
    ds_read_b64_tr_b16 a[30:31], v6 offset:30720
    v_xor_b32 v7, 0x30000, v7
    v_mfma_f32_16x16x32_bf16 v[104:107], a[8:11], a[136:139], v[104:107]
    s_waitcnt lgkmcnt(4)
    ds_read_b64_tr_b16 a[32:33], v7 offset:0
    buffer_load_dwordx4 v10, s[12:15], s35 offen offset:96 sc1 lds
    v_mfma_f32_16x16x32_bf16 v[104:107], a[12:15], a[140:143], v[104:107]
    ds_read_b64_tr_b16 a[34:35], v7 offset:2048
    v_cvt_pk_bf16_f32 v88, v88, v89
    v_mfma_f32_16x16x32_bf16 v[104:107], a[16:19], a[144:147], v[104:107]
    ds_read_b64_tr_b16 a[36:37], v7 offset:4096
    v_cvt_pk_bf16_f32 v89, v90, v91
    v_mfma_f32_16x16x32_bf16 v[104:107], a[20:23], a[148:151], v[104:107]
    s_waitcnt lgkmcnt(3)
    ds_read_b64_tr_b16 a[38:39], v7 offset:6144
    v_cvt_pk_bf16_f32 v90, v92, v93
    v_mfma_f32_16x16x32_bf16 v[104:107], a[24:27], a[152:155], v[104:107]
    s_add_u32 s58, s48, 163840
    ds_read_b64_tr_b16 a[40:41], v7 offset:8192
    v_cvt_pk_bf16_f32 v91, v94, v95
    v_mfma_f32_16x16x32_bf16 v[104:107], a[28:31], a[156:159], v[104:107]
    ds_read_b64_tr_b16 a[42:43], v7 offset:10240
    buffer_store_dwordx4 v[88:91], v1, s[12:15], s58 offen sc1
    v_mfma_f32_16x16x32_bf16 v[112:115], a[0:3], a[160:163], 0
    ds_read_b64_tr_b16 a[44:45], v7 offset:12288
    v_mul_f32 v98, v98, v65
    v_mfma_f32_16x16x32_bf16 v[112:115], a[4:7], a[164:167], v[112:115]
    ds_read_b64_tr_b16 a[46:47], v7 offset:14336
    v_mul_f32 v99, v99, v65
    v_mfma_f32_16x16x32_bf16 v[112:115], a[8:11], a[168:171], v[112:115]
    ds_read_b64_tr_b16 a[48:49], v7 offset:16384
    v_mul_f32 v100, v100, v65
    v_mfma_f32_16x16x32_bf16 v[112:115], a[12:15], a[172:175], v[112:115]
    ds_read_b64_tr_b16 a[50:51], v7 offset:18432
    v_mul_f32 v101, v101, v65
    v_mfma_f32_16x16x32_bf16 v[112:115], a[16:19], a[176:179], v[112:115]
    ds_read_b64_tr_b16 a[52:53], v7 offset:20480
    v_mul_f32 v102, v102, v65
    v_mfma_f32_16x16x32_bf16 v[112:115], a[20:23], a[180:183], v[112:115]
    ds_read_b64_tr_b16 a[54:55], v7 offset:22528
    v_mul_f32 v103, v103, v65
    v_mfma_f32_16x16x32_bf16 v[112:115], a[24:27], a[184:187], v[112:115]
    ds_read_b64_tr_b16 a[56:57], v7 offset:24576
    v_cvt_pk_bf16_f32 v96, v96, v97
    v_mfma_f32_16x16x32_bf16 v[112:115], a[28:31], a[188:191], v[112:115]
    s_waitcnt lgkmcnt(7)
    ds_read_b64_tr_b16 a[58:59], v7 offset:26624
    v_cvt_pk_bf16_f32 v97, v98, v99
    v_mfma_f32_16x16x32_bf16 v[108:111], a[32:35], a[128:131], 0
    ds_read_b64_tr_b16 a[60:61], v7 offset:28672
    v_cvt_pk_bf16_f32 v98, v100, v101
    v_mfma_f32_16x16x32_bf16 v[108:111], a[36:39], a[132:135], v[108:111]
    s_add_u32 s58, s48, 1081344
    ds_read_b64_tr_b16 a[62:63], v7 offset:30720
    v_xor_b32 v4, 0x20000, v4
    v_mfma_f32_16x16x32_bf16 v[108:111], a[40:43], a[136:139], v[108:111]
    s_waitcnt lgkmcnt(4)
    ds_read_b64_tr_b16 a[0:1], v4 offset:0
    v_cvt_pk_bf16_f32 v99, v102, v103
    v_mfma_f32_16x16x32_bf16 v[108:111], a[44:47], a[140:143], v[108:111]
    ds_read_b64_tr_b16 a[2:3], v4 offset:2048
    buffer_store_dwordx4 v[96:99], v1, s[12:15], s58 offen sc1
    v_mfma_f32_16x16x32_bf16 v[108:111], a[48:51], a[144:147], v[108:111]
    ds_read_b64_tr_b16 a[4:5], v4 offset:4096
    v_mul_f32 v104, v104, v64
    v_mfma_f32_16x16x32_bf16 v[108:111], a[52:55], a[148:151], v[108:111]
    s_waitcnt lgkmcnt(3)
    ds_read_b64_tr_b16 a[6:7], v4 offset:6144
    v_mul_f32 v105, v105, v64
    v_mfma_f32_16x16x32_bf16 v[108:111], a[56:59], a[152:155], v[108:111]
    ds_read_b64_tr_b16 a[8:9], v4 offset:8192
    v_mul_f32 v106, v106, v64
    v_mfma_f32_16x16x32_bf16 v[108:111], a[60:63], a[156:159], v[108:111]
    ds_read_b64_tr_b16 a[10:11], v4 offset:10240
    v_mul_f32 v107, v107, v64
    v_mfma_f32_16x16x32_bf16 v[116:119], a[32:35], a[160:163], 0
    ds_read_b64_tr_b16 a[12:13], v4 offset:12288
    v_mul_f32 v112, v112, v65
    v_mfma_f32_16x16x32_bf16 v[116:119], a[36:39], a[164:167], v[116:119]
    ds_read_b64_tr_b16 a[14:15], v4 offset:14336
    v_mul_f32 v113, v113, v65
    v_mfma_f32_16x16x32_bf16 v[116:119], a[40:43], a[168:171], v[116:119]
    ds_read_b64_tr_b16 a[16:17], v4 offset:16384
    v_mul_f32 v114, v114, v65
    v_mfma_f32_16x16x32_bf16 v[116:119], a[44:47], a[172:175], v[116:119]
    ds_read_b64_tr_b16 a[18:19], v4 offset:18432
    v_mul_f32 v115, v115, v65
    v_mfma_f32_16x16x32_bf16 v[116:119], a[48:51], a[176:179], v[116:119]
    ds_read_b64_tr_b16 a[20:21], v4 offset:20480
    v_mul_f32 v108, v108, v64
    v_mfma_f32_16x16x32_bf16 v[116:119], a[52:55], a[180:183], v[116:119]
    ds_read_b64_tr_b16 a[22:23], v4 offset:22528
    v_mul_f32 v109, v109, v64
    v_mfma_f32_16x16x32_bf16 v[116:119], a[56:59], a[184:187], v[116:119]
    ds_read_b64_tr_b16 a[24:25], v4 offset:24576
    v_mul_f32 v110, v110, v64
    v_mfma_f32_16x16x32_bf16 v[116:119], a[60:63], a[188:191], v[116:119]
    s_waitcnt lgkmcnt(7)
    ds_read_b64_tr_b16 a[26:27], v4 offset:26624
    v_mul_f32 v111, v111, v64
    v_mfma_f32_16x16x32_bf16 v[72:75], a[0:3], a[128:131], 0
    ds_read_b64_tr_b16 a[28:29], v4 offset:28672
    v_cvt_pk_bf16_f32 v104, v104, v105
    v_mfma_f32_16x16x32_bf16 v[72:75], a[4:7], a[132:135], v[72:75]
    ds_read_b64_tr_b16 a[30:31], v4 offset:30720
    v_xor_b32 v5, 0x20000, v5
    v_mfma_f32_16x16x32_bf16 v[72:75], a[8:11], a[136:139], v[72:75]
    s_waitcnt lgkmcnt(4)
    ds_read_b64_tr_b16 a[32:33], v5 offset:0
    v_cvt_pk_bf16_f32 v105, v106, v107
    v_mfma_f32_16x16x32_bf16 v[72:75], a[12:15], a[140:143], v[72:75]
    ds_read_b64_tr_b16 a[34:35], v5 offset:2048
    v_cvt_pk_bf16_f32 v106, v108, v109
    v_mfma_f32_16x16x32_bf16 v[72:75], a[16:19], a[144:147], v[72:75]
    s_add_u32 s58, s48, 180224
    ds_read_b64_tr_b16 a[36:37], v5 offset:4096
    v_cvt_pk_bf16_f32 v107, v110, v111
    v_mfma_f32_16x16x32_bf16 v[72:75], a[20:23], a[148:151], v[72:75]
    s_waitcnt lgkmcnt(3)
    ds_read_b64_tr_b16 a[38:39], v5 offset:6144
    buffer_store_dwordx4 v[104:107], v1, s[12:15], s58 offen sc1
    v_mfma_f32_16x16x32_bf16 v[72:75], a[24:27], a[152:155], v[72:75]
    ds_read_b64_tr_b16 a[40:41], v5 offset:8192
    v_mul_f32 v116, v116, v65
    v_mfma_f32_16x16x32_bf16 v[72:75], a[28:31], a[156:159], v[72:75]
    ds_read_b64_tr_b16 a[42:43], v5 offset:10240
    v_mul_f32 v117, v117, v65
    v_mfma_f32_16x16x32_bf16 v[80:83], a[0:3], a[160:163], 0
    ds_read_b64_tr_b16 a[44:45], v5 offset:12288
    v_mul_f32 v118, v118, v65
    v_mfma_f32_16x16x32_bf16 v[80:83], a[4:7], a[164:167], v[80:83]
    ds_read_b64_tr_b16 a[46:47], v5 offset:14336
    v_mul_f32 v119, v119, v65
    v_mfma_f32_16x16x32_bf16 v[80:83], a[8:11], a[168:171], v[80:83]
    ds_read_b64_tr_b16 a[48:49], v5 offset:16384
    v_cvt_pk_bf16_f32 v112, v112, v113
    v_mfma_f32_16x16x32_bf16 v[80:83], a[12:15], a[172:175], v[80:83]
    ds_read_b64_tr_b16 a[50:51], v5 offset:18432
    v_cvt_pk_bf16_f32 v113, v114, v115
    v_mfma_f32_16x16x32_bf16 v[80:83], a[16:19], a[176:179], v[80:83]
    ds_read_b64_tr_b16 a[52:53], v5 offset:20480
    v_cvt_pk_bf16_f32 v114, v116, v117
    v_mfma_f32_16x16x32_bf16 v[80:83], a[20:23], a[180:183], v[80:83]
    s_add_u32 s58, s48, 1097728
    ds_read_b64_tr_b16 a[54:55], v5 offset:22528
    v_cvt_pk_bf16_f32 v115, v118, v119
    v_mfma_f32_16x16x32_bf16 v[80:83], a[24:27], a[184:187], v[80:83]
    ds_read_b64_tr_b16 a[56:57], v5 offset:24576
    buffer_store_dwordx4 v[112:115], v1, s[12:15], s58 offen sc1
    v_mfma_f32_16x16x32_bf16 v[80:83], a[28:31], a[188:191], v[80:83]
    s_waitcnt lgkmcnt(7)
    ds_read_b64_tr_b16 a[58:59], v5 offset:26624
    v_mul_f32 v72, v72, v64
    v_mfma_f32_16x16x32_bf16 v[76:79], a[32:35], a[128:131], 0
    ds_read_b64_tr_b16 a[60:61], v5 offset:28672
    v_mul_f32 v73, v73, v64
    v_mfma_f32_16x16x32_bf16 v[76:79], a[36:39], a[132:135], v[76:79]
    ds_read_b64_tr_b16 a[62:63], v5 offset:30720
    v_xor_b32 v6, 0x20000, v6
    v_mfma_f32_16x16x32_bf16 v[76:79], a[40:43], a[136:139], v[76:79]
    s_waitcnt lgkmcnt(4)
    ds_read_b64_tr_b16 a[0:1], v6 offset:0
    v_mul_f32 v74, v74, v64
    v_mfma_f32_16x16x32_bf16 v[76:79], a[44:47], a[140:143], v[76:79]
    ds_read_b64_tr_b16 a[2:3], v6 offset:2048
    v_mul_f32 v75, v75, v64
    v_mfma_f32_16x16x32_bf16 v[76:79], a[48:51], a[144:147], v[76:79]
    ds_read_b64_tr_b16 a[4:5], v6 offset:4096
    v_mul_f32 v80, v80, v65
    v_mfma_f32_16x16x32_bf16 v[76:79], a[52:55], a[148:151], v[76:79]
    s_waitcnt lgkmcnt(3)
    ds_read_b64_tr_b16 a[6:7], v6 offset:6144
    v_mul_f32 v81, v81, v65
    v_mfma_f32_16x16x32_bf16 v[76:79], a[56:59], a[152:155], v[76:79]
    ds_read_b64_tr_b16 a[8:9], v6 offset:8192
    v_mul_f32 v82, v82, v65
    v_mfma_f32_16x16x32_bf16 v[76:79], a[60:63], a[156:159], v[76:79]
    ds_read_b64_tr_b16 a[10:11], v6 offset:10240
    v_mul_f32 v83, v83, v65
    v_mfma_f32_16x16x32_bf16 v[84:87], a[32:35], a[160:163], 0
    ds_read_b64_tr_b16 a[12:13], v6 offset:12288
    v_mfma_f32_16x16x32_bf16 v[84:87], a[36:39], a[164:167], v[84:87]
    ds_read_b64_tr_b16 a[14:15], v6 offset:14336
    v_mfma_f32_16x16x32_bf16 v[84:87], a[40:43], a[168:171], v[84:87]
    ds_read_b64_tr_b16 a[16:17], v6 offset:16384
    v_mfma_f32_16x16x32_bf16 v[84:87], a[44:47], a[172:175], v[84:87]
    ds_read_b64_tr_b16 a[18:19], v6 offset:18432
    v_mfma_f32_16x16x32_bf16 v[84:87], a[48:51], a[176:179], v[84:87]
    ds_read_b64_tr_b16 a[20:21], v6 offset:20480
    v_mul_f32 v76, v76, v64
    v_mfma_f32_16x16x32_bf16 v[84:87], a[52:55], a[180:183], v[84:87]
    ds_read_b64_tr_b16 a[22:23], v6 offset:22528
    v_mul_f32 v77, v77, v64
    v_mfma_f32_16x16x32_bf16 v[84:87], a[56:59], a[184:187], v[84:87]
    ds_read_b64_tr_b16 a[24:25], v6 offset:24576
    v_mul_f32 v78, v78, v64
    v_mfma_f32_16x16x32_bf16 v[84:87], a[60:63], a[188:191], v[84:87]
    s_waitcnt lgkmcnt(7)
    ds_read_b64_tr_b16 a[26:27], v6 offset:26624
    v_mul_f32 v79, v79, v64
    v_mfma_f32_16x16x32_bf16 v[88:91], a[0:3], a[128:131], 0
    ds_read_b64_tr_b16 a[28:29], v6 offset:28672
    v_cvt_pk_bf16_f32 v72, v72, v73
    v_mfma_f32_16x16x32_bf16 v[88:91], a[4:7], a[132:135], v[88:91]
    ds_read_b64_tr_b16 a[30:31], v6 offset:30720
    v_xor_b32 v7, 0x20000, v7
    v_mfma_f32_16x16x32_bf16 v[88:91], a[8:11], a[136:139], v[88:91]
    s_waitcnt lgkmcnt(4)
    ds_read_b64_tr_b16 a[32:33], v7 offset:0
    v_cvt_pk_bf16_f32 v73, v74, v75
    v_mfma_f32_16x16x32_bf16 v[88:91], a[12:15], a[140:143], v[88:91]
    ds_read_b64_tr_b16 a[34:35], v7 offset:2048
    v_cvt_pk_bf16_f32 v74, v76, v77
    v_mfma_f32_16x16x32_bf16 v[88:91], a[16:19], a[144:147], v[88:91]
    s_add_u32 s58, s48, 196608
    ds_read_b64_tr_b16 a[36:37], v7 offset:4096
    v_cvt_pk_bf16_f32 v75, v78, v79
    v_mfma_f32_16x16x32_bf16 v[88:91], a[20:23], a[148:151], v[88:91]
    s_waitcnt lgkmcnt(3)
    ds_read_b64_tr_b16 a[38:39], v7 offset:6144
    buffer_store_dwordx4 v[72:75], v1, s[12:15], s58 offen sc1
    v_mfma_f32_16x16x32_bf16 v[88:91], a[24:27], a[152:155], v[88:91]
    ds_read_b64_tr_b16 a[40:41], v7 offset:8192
    v_mul_f32 v84, v84, v65
    v_mfma_f32_16x16x32_bf16 v[88:91], a[28:31], a[156:159], v[88:91]
    ds_read_b64_tr_b16 a[42:43], v7 offset:10240
    v_mul_f32 v85, v85, v65
    v_mfma_f32_16x16x32_bf16 v[96:99], a[0:3], a[160:163], 0
    ds_read_b64_tr_b16 a[44:45], v7 offset:12288
    v_mul_f32 v86, v86, v65
    v_mfma_f32_16x16x32_bf16 v[96:99], a[4:7], a[164:167], v[96:99]
    ds_read_b64_tr_b16 a[46:47], v7 offset:14336
    v_mul_f32 v87, v87, v65
    v_mfma_f32_16x16x32_bf16 v[96:99], a[8:11], a[168:171], v[96:99]
    ds_read_b64_tr_b16 a[48:49], v7 offset:16384
    v_cvt_pk_bf16_f32 v80, v80, v81
    v_mfma_f32_16x16x32_bf16 v[96:99], a[12:15], a[172:175], v[96:99]
    ds_read_b64_tr_b16 a[50:51], v7 offset:18432
    v_cvt_pk_bf16_f32 v81, v82, v83
    v_mfma_f32_16x16x32_bf16 v[96:99], a[16:19], a[176:179], v[96:99]
    ds_read_b64_tr_b16 a[52:53], v7 offset:20480
    v_cvt_pk_bf16_f32 v82, v84, v85
    v_mfma_f32_16x16x32_bf16 v[96:99], a[20:23], a[180:183], v[96:99]
    s_add_u32 s58, s48, 1114112
    ds_read_b64_tr_b16 a[54:55], v7 offset:22528
    v_cvt_pk_bf16_f32 v83, v86, v87
    v_mfma_f32_16x16x32_bf16 v[96:99], a[24:27], a[184:187], v[96:99]
    ds_read_b64_tr_b16 a[56:57], v7 offset:24576
    buffer_store_dwordx4 v[80:83], v1, s[12:15], s58 offen sc1
    v_mfma_f32_16x16x32_bf16 v[96:99], a[28:31], a[188:191], v[96:99]
    s_waitcnt lgkmcnt(7)
    ds_read_b64_tr_b16 a[58:59], v7 offset:26624
    v_mul_f32 v88, v88, v64
    v_mfma_f32_16x16x32_bf16 v[92:95], a[32:35], a[128:131], 0
    ds_read_b64_tr_b16 a[60:61], v7 offset:28672
    v_mul_f32 v89, v89, v64
    v_mfma_f32_16x16x32_bf16 v[92:95], a[36:39], a[132:135], v[92:95]
    ds_read_b64_tr_b16 a[62:63], v7 offset:30720
    v_mul_f32 v90, v90, v64
    v_mfma_f32_16x16x32_bf16 v[92:95], a[40:43], a[136:139], v[92:95]
    s_waitcnt lgkmcnt(4)
    v_mul_f32 v91, v91, v64
    v_mfma_f32_16x16x32_bf16 v[92:95], a[44:47], a[140:143], v[92:95]
    ds_write_b32 v11, v13 offset:0
    v_mfma_f32_16x16x32_bf16 v[92:95], a[48:51], a[144:147], v[92:95]
    ds_write_b32 v11, v13 offset:1152
    v_mul_f32 v96, v96, v65
    v_mul_f32 v97, v97, v65
    v_mfma_f32_16x16x32_bf16 v[92:95], a[52:55], a[148:151], v[92:95]
    s_waitcnt lgkmcnt(0)
    ds_write_b32 v11, v13 offset:2304
    v_mul_f32 v98, v98, v65
    v_mul_f32 v99, v99, v65
    v_mfma_f32_16x16x32_bf16 v[92:95], a[56:59], a[152:155], v[92:95]
    ds_write_b32 v11, v13 offset:3456
    v_mfma_f32_16x16x32_bf16 v[92:95], a[60:63], a[156:159], v[92:95]
    ds_write_b32 v12, v13 offset:4608
    v_mfma_f32_16x16x32_bf16 v[100:103], a[32:35], a[160:163], 0
    v_mfma_f32_16x16x32_bf16 v[100:103], a[36:39], a[164:167], v[100:103]
    v_mfma_f32_16x16x32_bf16 v[100:103], a[40:43], a[168:171], v[100:103]
    v_mfma_f32_16x16x32_bf16 v[100:103], a[44:47], a[172:175], v[100:103]
    v_mfma_f32_16x16x32_bf16 v[100:103], a[48:51], a[176:179], v[100:103]
    v_mfma_f32_16x16x32_bf16 v[100:103], a[52:55], a[180:183], v[100:103]
    v_mfma_f32_16x16x32_bf16 v[100:103], a[56:59], a[184:187], v[100:103]
    v_mfma_f32_16x16x32_bf16 v[100:103], a[60:63], a[188:191], v[100:103]
    s_nop 4
    v_mul_f32 v92, v92, v64
    v_mul_f32 v93, v93, v64
    v_mul_f32 v94, v94, v64
    v_mul_f32 v95, v95, v64
    v_cvt_pk_bf16_f32 v88, v88, v89
    v_cvt_pk_bf16_f32 v89, v90, v91
    v_cvt_pk_bf16_f32 v90, v92, v93
    v_cvt_pk_bf16_f32 v91, v94, v95
    s_add_u32 s58, s48, 212992
    buffer_store_dwordx4 v[88:91], v1, s[12:15], s58 offen sc1
    v_mul_f32 v100, v100, v65
    v_mul_f32 v101, v101, v65
    v_mul_f32 v102, v102, v65
    v_mul_f32 v103, v103, v65
    v_cvt_pk_bf16_f32 v96, v96, v97
    v_cvt_pk_bf16_f32 v97, v98, v99
    v_cvt_pk_bf16_f32 v98, v100, v101
    v_cvt_pk_bf16_f32 v99, v102, v103
    s_add_u32 s58, s48, 1130496
    buffer_store_dwordx4 v[96:99], v1, s[12:15], s58 offen sc1
    s_cmp_ge_u32 s28, 14
    s_cbranch_scc1 L_idle
    v_and_b32 v22, 15, v0
    v_lshrrev_b32 v23, 4, v0
    v_lshl_add_u32 v18, v22, 3, s33
    v_lshl_add_u32 v16, v23, 4, v18
    v_lshl_add_u32 v18, v23, 1, v18
    v_and_b32 v17, 3, v0
    v_bfe_u32 v24, v0, 2, 2
    v_sub_u32 v17, v17, v24
    v_lshlrev_b32 v24, 3, v23
    v_sub_u32 v17, v17, v24
    v_add_u32 v17, 32, v17
    v_lshl_add_u32 v17, v17, 3, s33
    v_lshlrev_b32 v20, 5, v22
    v_lshl_add_u32 v20, v23, 3, v20
    v_add_u32 v24, -1, v0
    v_and_b32 v24, 15, v24
    v_add_u32 v24, 48, v24
    v_add_u32 v19, -16, v0
    v_cmp_gt_u32 vcc, 16, v0
    v_accvgpr_read_b32 v21, a245
    s_add_u32 s34, s34, 90177536
    v_cndmask_b32 v19, v19, v24, vcc
    v_lshlrev_b32 v19, 2, v19
    v_cmp_eq_u32 vcc, 63, v0
    s_lshl_b32 s30, s31, 16
    s_and_b32 s31, s31, 0xffff0000
    s_bitcmp1_b32 s3, 0
    s_cselect_b32 s31, s31, s30
    v_mov_b64 v[224:225], 0
    v_mov_b64 v[226:227], 0
    v_mov_b64 v[228:229], 0
    v_mov_b64 v[230:231], 0
    v_mov_b64 v[232:233], 0
    v_mov_b64 v[234:235], 0
    v_mov_b64 v[236:237], 0
    v_mov_b64 v[238:239], 0
    v_mov_b64 v[240:241], 0
    v_mov_b64 v[242:243], 0
    v_mov_b64 v[244:245], 0
    v_mov_b64 v[246:247], 0
    v_mov_b64 v[248:249], 0
    v_mov_b64 v[250:251], 0
    v_mov_b64 v[252:253], 0
    v_mov_b64 v[254:255], 0
    s_waitcnt vmcnt(8) lgkmcnt(0)
    ds_read_b64_tr_b16 v[160:161], v17 offset:4608
    ds_read_b64_tr_b16 v[162:163], v17 offset:4576
    ds_read_b64_tr_b16 v[164:165], v17 offset:4864
    ds_read_b64_tr_b16 v[166:167], v17 offset:4832
    ds_read_b64 a[4:5], v16 offset:72
    ds_read_b64 a[6:7], v16 offset:80
    ds_read_b64 a[0:1], v16 offset:8
    ds_read_b64 a[2:3], v16 offset:16
    s_waitcnt lgkmcnt(6)
    ds_read_b64 a[68:69], v16 offset:1224
    ds_read_b64 a[70:71], v16 offset:1232
    ds_read_b64 a[64:65], v16 offset:1160
    ds_read_b64 a[66:67], v16 offset:1168
    ds_read_b64 a[132:133], v16 offset:2376
    ds_read_b64 a[134:135], v16 offset:2384
    ds_read_b64 a[128:129], v16 offset:2312
    ds_read_b64 a[130:131], v16 offset:2320
    s_waitcnt lgkmcnt(6)
    ds_read_b64 a[196:197], v16 offset:3528
    ds_read_b64 a[198:199], v16 offset:3536
    ds_read_b64 a[192:193], v16 offset:3464
    ds_read_b64 a[194:195], v16 offset:3472
    ds_read_b64_tr_b16 v[168:169], v17 offset:5120
    ds_read_b64_tr_b16 v[170:171], v17 offset:5088
    ds_read_b64_tr_b16 v[172:173], v17 offset:5376
    ds_read_b64_tr_b16 v[174:175], v17 offset:5344
    s_waitcnt lgkmcnt(6)
    ds_read_b64 a[12:13], v16 offset:200
    ds_read_b64 a[14:15], v16 offset:208
    ds_read_b64 a[8:9], v16 offset:136
    ds_read_b64 a[10:11], v16 offset:144
    ds_read_b64 a[76:77], v16 offset:1352
    ds_read_b64 a[78:79], v16 offset:1360
    ds_read_b64 a[72:73], v16 offset:1288
    ds_read_b64 a[74:75], v16 offset:1296
    s_waitcnt lgkmcnt(6)
    ds_read_b64 a[140:141], v16 offset:2504
    ds_read_b64 a[142:143], v16 offset:2512
    ds_read_b64 a[136:137], v16 offset:2440
    ds_read_b64 a[138:139], v16 offset:2448
    ds_read_b64 a[204:205], v16 offset:3656
    ds_read_b64 a[206:207], v16 offset:3664
    ds_read_b64 a[200:201], v16 offset:3592
    ds_read_b64 a[202:203], v16 offset:3600
    s_waitcnt lgkmcnt(6)
    ds_read_b64_tr_b16 v[176:177], v17 offset:5632
    ds_read_b64_tr_b16 v[178:179], v17 offset:5600
    ds_read_b64_tr_b16 v[180:181], v17 offset:5888
    ds_read_b64_tr_b16 v[182:183], v17 offset:5856
    s_waitcnt lgkmcnt(0)
    v_lshlrev_b32 v25, 2, v22
    s_add_u32 s45, s44, 1088
    v_mfma_f32_16x16x32_bf16 v[32:35], v[160:163], a[4:7], 0
    ds_read_b64 a[20:21], v16 offset:328
    v_mfma_f32_16x16x32_bf16 v[32:35], v[164:167], a[0:3], v[32:35]
    ds_read_b64 a[22:23], v16 offset:336
    v_mfma_f32_16x16x32_bf16 v[36:39], v[160:163], a[68:71], 0
    ds_read_b64 a[16:17], v16 offset:264
    v_mfma_f32_16x16x32_bf16 v[36:39], v[164:167], a[64:67], v[36:39]
    ds_read_b64 a[18:19], v16 offset:272
    v_mfma_f32_16x16x32_bf16 v[40:43], v[160:163], a[132:135], 0
    ds_read_b64 a[84:85], v16 offset:1480
    v_mfma_f32_16x16x32_bf16 v[40:43], v[164:167], a[128:131], v[40:43]
    ds_read_b64 a[86:87], v16 offset:1488
    v_mfma_f32_16x16x32_bf16 v[44:47], v[160:163], a[196:199], 0
    ds_read_b64 a[80:81], v16 offset:1416
    v_mfma_f32_16x16x32_bf16 v[44:47], v[164:167], a[192:195], v[44:47]
    ds_read_b64 a[82:83], v16 offset:1424
    v_mfma_f32_16x16x32_bf16 v[48:51], v[160:163], a[12:15], 0
    ds_read_b64 a[148:149], v16 offset:2632
    v_mfma_f32_16x16x32_bf16 v[48:51], v[164:167], a[8:11], v[48:51]
    ds_read_b64 a[150:151], v16 offset:2640
    v_mfma_f32_16x16x32_bf16 v[48:51], v[168:171], a[4:7], v[48:51]
    ds_read_b64 a[144:145], v16 offset:2568
    v_mfma_f32_16x16x32_bf16 v[48:51], v[172:175], a[0:3], v[48:51]
    ds_read_b64 a[146:147], v16 offset:2576
    v_mfma_f32_16x16x32_bf16 v[52:55], v[160:163], a[76:79], 0
    ds_read_b64 a[212:213], v16 offset:3784
    v_mfma_f32_16x16x32_bf16 v[52:55], v[164:167], a[72:75], v[52:55]
    ds_read_b64 a[214:215], v16 offset:3792
    v_mfma_f32_16x16x32_bf16 v[52:55], v[168:171], a[68:71], v[52:55]
    ds_read_b64 a[208:209], v16 offset:3720
    v_mfma_f32_16x16x32_bf16 v[52:55], v[172:175], a[64:67], v[52:55]
    s_waitcnt vmcnt(0)
    ds_read_b64 a[210:211], v16 offset:3728
    v_mfma_f32_16x16x32_bf16 v[56:59], v[160:163], a[140:143], 0
    s_barrier
    ds_read_b64_tr_b16 v[184:185], v17 offset:6144
    v_mfma_f32_16x16x32_bf16 v[56:59], v[164:167], a[136:139], v[56:59]
    ds_read_b64_tr_b16 v[186:187], v17 offset:6112
    buffer_store_dword v21, v21, s[12:15], s93 offen sc1
    v_mfma_f32_16x16x32_bf16 v[56:59], v[168:171], a[132:135], v[56:59]
    ds_read_b64_tr_b16 v[188:189], v17 offset:6400
    v_mfma_f32_16x16x32_bf16 v[56:59], v[172:175], a[128:131], v[56:59]
    ds_read_b64_tr_b16 v[190:191], v17 offset:6368
    v_mfma_f32_16x16x32_bf16 v[60:63], v[160:163], a[204:207], 0
    ds_read_b64 a[28:29], v16 offset:456
    v_mfma_f32_16x16x32_bf16 v[60:63], v[164:167], a[200:203], v[60:63]
    ds_read_b64 a[30:31], v16 offset:464
    v_mfma_f32_16x16x32_bf16 v[60:63], v[168:171], a[196:199], v[60:63]
    ds_read_b64 a[24:25], v16 offset:392
    v_mfma_f32_16x16x32_bf16 v[60:63], v[172:175], a[192:195], v[60:63]
    s_waitcnt lgkmcnt(15)
    ds_read_b64 a[26:27], v16 offset:400
    v_mfma_f32_16x16x32_bf16 v[64:67], v[160:163], a[20:23], 0
    ds_read_b64 a[92:93], v16 offset:1608
    v_mfma_f32_16x16x32_bf16 v[64:67], v[164:167], a[16:19], v[64:67]
    ds_read_b64 a[94:95], v16 offset:1616
    v_mfma_f32_16x16x32_bf16 v[64:67], v[168:171], a[12:15], v[64:67]
    ds_read_b64 a[88:89], v16 offset:1544
    v_mfma_f32_16x16x32_bf16 v[64:67], v[172:175], a[8:11], v[64:67]
    ds_read_b64 a[90:91], v16 offset:1552
    v_mfma_f32_16x16x32_bf16 v[64:67], v[176:179], a[4:7], v[64:67]
    ds_read_b64 a[156:157], v16 offset:2760
    v_mfma_f32_16x16x32_bf16 v[64:67], v[180:183], a[0:3], v[64:67]
    ds_read_b64 a[158:159], v16 offset:2768
    v_mfma_f32_16x16x32_bf16 v[68:71], v[160:163], a[84:87], 0
    ds_read_b64 a[152:153], v16 offset:2696
    v_mfma_f32_16x16x32_bf16 v[68:71], v[164:167], a[80:83], v[68:71]
    ds_read_b64 a[154:155], v16 offset:2704
    v_mfma_f32_16x16x32_bf16 v[68:71], v[168:171], a[76:79], v[68:71]
    ds_read_b64 a[220:221], v16 offset:3912
    v_mfma_f32_16x16x32_bf16 v[68:71], v[172:175], a[72:75], v[68:71]
    ds_read_b64 a[222:223], v16 offset:3920
    v_mfma_f32_16x16x32_bf16 v[68:71], v[176:179], a[68:71], v[68:71]
    ds_read_b64 a[216:217], v16 offset:3848
    v_mfma_f32_16x16x32_bf16 v[68:71], v[180:183], a[64:67], v[68:71]
    s_waitcnt lgkmcnt(15)
    ds_read_b64 a[218:219], v16 offset:3856
    v_mfma_f32_16x16x32_bf16 v[72:75], v[160:163], a[148:151], 0
    ds_read_b64_tr_b16 v[192:193], v17 offset:6656
    v_mfma_f32_16x16x32_bf16 v[72:75], v[164:167], a[144:147], v[72:75]
    ds_read_b64_tr_b16 v[194:195], v17 offset:6624
    v_mfma_f32_16x16x32_bf16 v[72:75], v[168:171], a[140:143], v[72:75]
    ds_read_b64_tr_b16 v[196:197], v17 offset:6912
    v_mfma_f32_16x16x32_bf16 v[72:75], v[172:175], a[136:139], v[72:75]
    ds_read_b64_tr_b16 v[198:199], v17 offset:6880
    v_mfma_f32_16x16x32_bf16 v[72:75], v[176:179], a[132:135], v[72:75]
    ds_read_b64 a[36:37], v16 offset:584
    v_mfma_f32_16x16x32_bf16 v[72:75], v[180:183], a[128:131], v[72:75]
    ds_read_b64 a[38:39], v16 offset:592
    v_mfma_f32_16x16x32_bf16 v[76:79], v[160:163], a[212:215], 0
    ds_read_b64 a[32:33], v16 offset:520
    v_mfma_f32_16x16x32_bf16 v[76:79], v[164:167], a[208:211], v[76:79]
    ds_read_b64 a[34:35], v16 offset:528
    v_mfma_f32_16x16x32_bf16 v[76:79], v[168:171], a[204:207], v[76:79]
    ds_read_b64 a[100:101], v16 offset:1736
    v_mfma_f32_16x16x32_bf16 v[76:79], v[172:175], a[200:203], v[76:79]
    ds_read_b64 a[102:103], v16 offset:1744
    v_mfma_f32_16x16x32_bf16 v[76:79], v[176:179], a[196:199], v[76:79]
    ds_read_b64 a[96:97], v16 offset:1672
    v_mfma_f32_16x16x32_bf16 v[76:79], v[180:183], a[192:195], v[76:79]
    s_waitcnt lgkmcnt(15)
    ds_read_b64 a[98:99], v16 offset:1680
    v_mfma_f32_16x16x32_bf16 v[80:83], v[160:163], a[28:31], 0
    ds_read_b64 a[164:165], v16 offset:2888
    v_mfma_f32_16x16x32_bf16 v[80:83], v[164:167], a[24:27], v[80:83]
    ds_read_b64 a[166:167], v16 offset:2896
    v_mfma_f32_16x16x32_bf16 v[80:83], v[168:171], a[20:23], v[80:83]
    ds_read_b64 a[160:161], v16 offset:2824
    v_mfma_f32_16x16x32_bf16 v[80:83], v[172:175], a[16:19], v[80:83]
    ds_read_b64 a[162:163], v16 offset:2832
    v_mfma_f32_16x16x32_bf16 v[80:83], v[176:179], a[12:15], v[80:83]
    ds_read_b64 a[228:229], v16 offset:4040
    v_mfma_f32_16x16x32_bf16 v[80:83], v[180:183], a[8:11], v[80:83]
    ds_read_b64 a[230:231], v16 offset:4048
    v_mfma_f32_16x16x32_bf16 v[80:83], v[184:187], a[4:7], v[80:83]
    ds_read_b64 a[224:225], v16 offset:3976
    v_mfma_f32_16x16x32_bf16 v[80:83], v[188:191], a[0:3], v[80:83]
    ds_read_b64 a[226:227], v16 offset:3984
    v_mfma_f32_16x16x32_bf16 v[84:87], v[160:163], a[92:95], 0
    ds_read_b64_tr_b16 v[200:201], v17 offset:7168
    v_mfma_f32_16x16x32_bf16 v[84:87], v[164:167], a[88:91], v[84:87]
    ds_read_b64_tr_b16 v[202:203], v17 offset:7136
    v_mfma_f32_16x16x32_bf16 v[84:87], v[168:171], a[84:87], v[84:87]
    ds_read_b64_tr_b16 v[204:205], v17 offset:7424
    v_mfma_f32_16x16x32_bf16 v[84:87], v[172:175], a[80:83], v[84:87]
    ds_read_b64_tr_b16 v[206:207], v17 offset:7392
    v_mfma_f32_16x16x32_bf16 v[84:87], v[176:179], a[76:79], v[84:87]
    ds_read_b64 a[44:45], v16 offset:712
    v_mfma_f32_16x16x32_bf16 v[84:87], v[180:183], a[72:75], v[84:87]
    ds_read_b64 a[46:47], v16 offset:720
    v_mfma_f32_16x16x32_bf16 v[84:87], v[184:187], a[68:71], v[84:87]
    ds_read_b64 a[40:41], v16 offset:648
    v_mfma_f32_16x16x32_bf16 v[84:87], v[188:191], a[64:67], v[84:87]
    ds_read_b64 a[42:43], v16 offset:656
    v_mfma_f32_16x16x32_bf16 v[88:91], v[160:163], a[156:159], 0
    ds_read_b64 a[108:109], v16 offset:1864
    v_mfma_f32_16x16x32_bf16 v[88:91], v[164:167], a[152:155], v[88:91]
    ds_read_b64 a[110:111], v16 offset:1872
    v_mfma_f32_16x16x32_bf16 v[88:91], v[168:171], a[148:151], v[88:91]
    ds_read_b64 a[104:105], v16 offset:1800
    v_mfma_f32_16x16x32_bf16 v[88:91], v[172:175], a[144:147], v[88:91]
    ds_read_b64 a[106:107], v16 offset:1808
    v_mfma_f32_16x16x32_bf16 v[88:91], v[176:179], a[140:143], v[88:91]
    ds_read_b64 a[172:173], v16 offset:3016
    v_mfma_f32_16x16x32_bf16 v[88:91], v[180:183], a[136:139], v[88:91]
    ds_read_b64 a[174:175], v16 offset:3024
    v_mfma_f32_16x16x32_bf16 v[88:91], v[184:187], a[132:135], v[88:91]
    ds_read_b64 a[168:169], v16 offset:2952
    v_mfma_f32_16x16x32_bf16 v[88:91], v[188:191], a[128:131], v[88:91]
    s_waitcnt lgkmcnt(15)
    ds_read_b64 a[170:171], v16 offset:2960
    v_mfma_f32_16x16x32_bf16 v[92:95], v[160:163], a[220:223], 0
    ds_read_b64 a[236:237], v16 offset:4168
    v_mfma_f32_16x16x32_bf16 v[92:95], v[164:167], a[216:219], v[92:95]
    ds_read_b64 a[238:239], v16 offset:4176
    v_mfma_f32_16x16x32_bf16 v[92:95], v[168:171], a[212:215], v[92:95]
    ds_read_b64 a[232:233], v16 offset:4104
    v_mfma_f32_16x16x32_bf16 v[92:95], v[172:175], a[208:211], v[92:95]
    ds_read_b64 a[234:235], v16 offset:4112
    v_mfma_f32_16x16x32_bf16 v[92:95], v[176:179], a[204:207], v[92:95]
    ds_read_b64_tr_b16 v[208:209], v17 offset:7680
    v_mfma_f32_16x16x32_bf16 v[92:95], v[180:183], a[200:203], v[92:95]
    ds_read_b64_tr_b16 v[210:211], v17 offset:7648
    v_mfma_f32_16x16x32_bf16 v[92:95], v[184:187], a[196:199], v[92:95]
    ds_read_b64_tr_b16 v[212:213], v17 offset:7936
    v_mfma_f32_16x16x32_bf16 v[92:95], v[188:191], a[192:195], v[92:95]
    ds_read_b64_tr_b16 v[214:215], v17 offset:7904
    v_mfma_f32_16x16x32_bf16 v[96:99], v[160:163], a[36:39], 0
    ds_read_b64 a[52:53], v16 offset:840
    v_mfma_f32_16x16x32_bf16 v[96:99], v[164:167], a[32:35], v[96:99]
    ds_read_b64 a[54:55], v16 offset:848
    v_mfma_f32_16x16x32_bf16 v[96:99], v[168:171], a[28:31], v[96:99]
    ds_read_b64 a[48:49], v16 offset:776
    v_mfma_f32_16x16x32_bf16 v[96:99], v[172:175], a[24:27], v[96:99]
    ds_read_b64 a[50:51], v16 offset:784
    v_mfma_f32_16x16x32_bf16 v[96:99], v[176:179], a[20:23], v[96:99]
    ds_read_b64 a[116:117], v16 offset:1992
    v_mfma_f32_16x16x32_bf16 v[96:99], v[180:183], a[16:19], v[96:99]
    ds_read_b64 a[118:119], v16 offset:2000
    v_mfma_f32_16x16x32_bf16 v[96:99], v[184:187], a[12:15], v[96:99]
    ds_read_b64 a[112:113], v16 offset:1928
    v_add_f32 v39, v39, v42
    v_mfma_f32_16x16x32_bf16 v[96:99], v[188:191], a[8:11], v[96:99]
    ds_read_b64 a[114:115], v16 offset:1936
    v_add_f32 v43, v43, v46
    v_mfma_f32_16x16x32_bf16 v[96:99], v[192:195], a[4:7], v[96:99]
    ds_read_b64 a[180:181], v16 offset:3144
    v_add_f32 v39, v39, v45
    v_mfma_f32_16x16x32_bf16 v[96:99], v[196:199], a[0:3], v[96:99]
    ds_read_b64 a[182:183], v16 offset:3152
    v_cndmask_b32_e64 v224, v39, 0, vcc
    v_mfma_f32_16x16x32_bf16 v[100:103], v[160:163], a[100:103], 0
    ds_read_b64 a[176:177], v16 offset:3080
    v_cndmask_b32_e64 v225, v43, 0, vcc
    v_mfma_f32_16x16x32_bf16 v[100:103], v[164:167], a[96:99], v[100:103]
    ds_read_b64 a[178:179], v16 offset:3088
    v_cndmask_b32_e64 v226, v47, 0, vcc
    v_mfma_f32_16x16x32_bf16 v[100:103], v[168:171], a[92:95], v[100:103]
    ds_read_b64 a[244:245], v16 offset:4296
    v_add_f32 v33, v33, v36
    v_mfma_f32_16x16x32_bf16 v[100:103], v[172:175], a[88:91], v[100:103]
    ds_read_b64 a[246:247], v16 offset:4304
    v_add_f32 v34, v34, v37
    v_mfma_f32_16x16x32_bf16 v[100:103], v[176:179], a[84:87], v[100:103]
    ds_read_b64 a[240:241], v16 offset:4232
    v_add_f32 v35, v35, v38
    v_mfma_f32_16x16x32_bf16 v[100:103], v[180:183], a[80:83], v[100:103]
    ds_read_b64 a[242:243], v16 offset:4240
    v_add_f32 v34, v34, v40
    v_mfma_f32_16x16x32_bf16 v[100:103], v[184:187], a[76:79], v[100:103]
    ds_read_b64_tr_b16 v[216:217], v17 offset:8192
    v_add_f32 v35, v35, v41
    v_mfma_f32_16x16x32_bf16 v[100:103], v[188:191], a[72:75], v[100:103]
    ds_read_b64_tr_b16 v[218:219], v17 offset:8160
    v_add_f32 v35, v35, v44
    v_mfma_f32_16x16x32_bf16 v[100:103], v[192:195], a[68:71], v[100:103]
    ds_read_b64_tr_b16 v[220:221], v17 offset:8448
    v_add_f32 v55, v55, v58
    v_mfma_f32_16x16x32_bf16 v[100:103], v[196:199], a[64:67], v[100:103]
    ds_read_b64_tr_b16 v[222:223], v17 offset:8416
    v_add_f32 v59, v59, v62
    v_mfma_f32_16x16x32_bf16 v[104:107], v[160:163], a[164:167], 0
    ds_read_b64 a[60:61], v16 offset:968
    v_add_f32 v55, v55, v61
    v_mfma_f32_16x16x32_bf16 v[104:107], v[164:167], a[160:163], v[104:107]
    ds_read_b64 a[62:63], v16 offset:976
    v_cndmask_b32_e64 v232, v55, v39, vcc
    v_mfma_f32_16x16x32_bf16 v[104:107], v[168:171], a[156:159], v[104:107]
    ds_read_b64 a[56:57], v16 offset:904
    v_cndmask_b32_e64 v233, v59, v43, vcc
    v_mfma_f32_16x16x32_bf16 v[104:107], v[172:175], a[152:155], v[104:107]
    ds_read_b64 a[58:59], v16 offset:912
    v_cndmask_b32_e64 v234, v63, v47, vcc
    v_mfma_f32_16x16x32_bf16 v[104:107], v[176:179], a[148:151], v[104:107]
    ds_read_b64 a[124:125], v16 offset:2120
    v_add_f32 v49, v49, v52
    v_mfma_f32_16x16x32_bf16 v[104:107], v[180:183], a[144:147], v[104:107]
    ds_read_b64 a[126:127], v16 offset:2128
    v_add_f32 v50, v50, v53
    v_mfma_f32_16x16x32_bf16 v[104:107], v[184:187], a[140:143], v[104:107]
    ds_read_b64 a[120:121], v16 offset:2056
    v_add_f32 v51, v51, v54
    v_mfma_f32_16x16x32_bf16 v[104:107], v[188:191], a[136:139], v[104:107]
    ds_read_b64 a[122:123], v16 offset:2064
    v_add_f32 v50, v50, v56
    v_mfma_f32_16x16x32_bf16 v[104:107], v[192:195], a[132:135], v[104:107]
    ds_read_b64 a[188:189], v16 offset:3272
    v_add_f32 v51, v51, v57
    v_mfma_f32_16x16x32_bf16 v[104:107], v[196:199], a[128:131], v[104:107]
    ds_read_b64 a[190:191], v16 offset:3280
    v_add_f32 v51, v51, v60
    v_mfma_f32_16x16x32_bf16 v[108:111], v[160:163], a[228:231], 0
    ds_read_b64 a[184:185], v16 offset:3208
    v_add_f32 v71, v71, v74
    v_mfma_f32_16x16x32_bf16 v[108:111], v[164:167], a[224:227], v[108:111]
    ds_read_b64 a[186:187], v16 offset:3216
    v_add_f32 v75, v75, v78
    v_mfma_f32_16x16x32_bf16 v[108:111], v[168:171], a[220:223], v[108:111]
    ds_read_b64 v[28:29], v16 offset:4424
    v_add_f32 v71, v71, v77
    v_mfma_f32_16x16x32_bf16 v[108:111], v[172:175], a[216:219], v[108:111]
    ds_read_b64 v[30:31], v16 offset:4432
    v_cndmask_b32_e64 v240, v71, v55, vcc
    v_mfma_f32_16x16x32_bf16 v[108:111], v[176:179], a[212:215], v[108:111]
    ds_read_b64 a[248:249], v16 offset:4360
    v_cndmask_b32_e64 v241, v75, v59, vcc
    v_mfma_f32_16x16x32_bf16 v[108:111], v[180:183], a[208:211], v[108:111]
    ds_read_b64 a[250:251], v16 offset:4368
    v_cndmask_b32_e64 v242, v79, v63, vcc
    v_mfma_f32_16x16x32_bf16 v[108:111], v[184:187], a[204:207], v[108:111]
    ds_bpermute_b32 v224, v19, v224
    v_add_f32 v65, v65, v68
    v_mfma_f32_16x16x32_bf16 v[108:111], v[188:191], a[200:203], v[108:111]
    ds_bpermute_b32 v225, v19, v225
    v_add_f32 v66, v66, v69
    v_mfma_f32_16x16x32_bf16 v[108:111], v[192:195], a[196:199], v[108:111]
    ds_bpermute_b32 v226, v19, v226
    v_add_f32 v67, v67, v70
    v_mfma_f32_16x16x32_bf16 v[108:111], v[196:199], a[192:195], v[108:111]
    s_waitcnt lgkmcnt(15)
    ds_read_u16_d16_hi v228, v18 offset:128
    v_add_f32 v66, v66, v72
    v_mfma_f32_16x16x32_bf16 v[112:115], v[160:163], a[44:47], 0
    ds_read_u16_d16_hi v229, v18 offset:1280
    v_add_f32 v67, v67, v73
    v_mfma_f32_16x16x32_bf16 v[112:115], v[164:167], a[40:43], v[112:115]
    ds_read_u16_d16_hi v230, v18 offset:2432
    v_add_f32 v67, v67, v76
    v_mfma_f32_16x16x32_bf16 v[112:115], v[168:171], a[36:39], v[112:115]
    ds_read_u16_d16_hi v231, v18 offset:3584
    v_add_f32 v87, v87, v90
    v_mfma_f32_16x16x32_bf16 v[112:115], v[172:175], a[32:35], v[112:115]
    ds_bpermute_b32 v232, v19, v232
    v_add_f32 v91, v91, v94
    v_mfma_f32_16x16x32_bf16 v[112:115], v[176:179], a[28:31], v[112:115]
    ds_bpermute_b32 v233, v19, v233
    v_add_f32 v87, v87, v93
    v_mfma_f32_16x16x32_bf16 v[112:115], v[180:183], a[24:27], v[112:115]
    ds_bpermute_b32 v234, v19, v234
    v_cndmask_b32_e64 v248, v87, v71, vcc
    v_mfma_f32_16x16x32_bf16 v[112:115], v[184:187], a[20:23], v[112:115]
    ds_read_u16_d16_hi v236, v18 offset:256
    v_cndmask_b32_e64 v249, v91, v75, vcc
    v_mfma_f32_16x16x32_bf16 v[112:115], v[188:191], a[16:19], v[112:115]
    ds_read_u16_d16_hi v237, v18 offset:1408
    v_cndmask_b32_e64 v250, v95, v79, vcc
    v_mfma_f32_16x16x32_bf16 v[112:115], v[192:195], a[12:15], v[112:115]
    s_waitcnt lgkmcnt(10)
    v_add_f32 v32, v32, v224
    v_add_f32 v33, v33, v225
    v_mfma_f32_16x16x32_bf16 v[112:115], v[196:199], a[8:11], v[112:115]
    s_waitcnt lgkmcnt(8)
    v_add_f32 v34, v34, v226
    v_fmac_f32 v32, s31, v228
    v_mfma_f32_16x16x32_bf16 v[112:115], v[200:203], a[4:7], v[112:115]
    s_waitcnt lgkmcnt(6)
    v_fmac_f32 v33, s31, v229
    v_fmac_f32 v34, s31, v230
    v_mfma_f32_16x16x32_bf16 v[112:115], v[204:207], a[0:3], v[112:115]
    s_waitcnt lgkmcnt(5)
    v_fmac_f32 v35, s31, v231
    v_cvt_pk_bf16_f32 v32, v32, v33
    v_mfma_f32_16x16x32_bf16 v[116:119], v[160:163], a[108:111], 0
    ds_read_u16_d16_hi v238, v18 offset:2560
    v_cvt_pk_bf16_f32 v33, v34, v35
    v_mfma_f32_16x16x32_bf16 v[116:119], v[164:167], a[104:107], v[116:119]
    buffer_store_dwordx2 v[32:33], v20, s[12:15], s34 offen offset:0 sc1
    v_mfma_f32_16x16x32_bf16 v[116:119], v[168:171], a[100:103], v[116:119]
    ds_read_u16_d16_hi v239, v18 offset:3712
    v_add_f32 v81, v81, v84
    v_mfma_f32_16x16x32_bf16 v[116:119], v[172:175], a[96:99], v[116:119]
    ds_bpermute_b32 v240, v19, v240
    v_add_f32 v82, v82, v85
    v_mfma_f32_16x16x32_bf16 v[116:119], v[176:179], a[92:95], v[116:119]
    ds_bpermute_b32 v241, v19, v241
    v_add_f32 v83, v83, v86
    v_mfma_f32_16x16x32_bf16 v[116:119], v[180:183], a[88:91], v[116:119]
    ds_bpermute_b32 v242, v19, v242
    v_add_f32 v82, v82, v88
    v_mfma_f32_16x16x32_bf16 v[116:119], v[184:187], a[84:87], v[116:119]
    ds_read_u16_d16_hi v244, v18 offset:384
    v_add_f32 v83, v83, v89
    v_mfma_f32_16x16x32_bf16 v[116:119], v[188:191], a[80:83], v[116:119]
    ds_read_u16_d16_hi v245, v18 offset:1536
    v_add_f32 v83, v83, v92
    v_mfma_f32_16x16x32_bf16 v[116:119], v[192:195], a[76:79], v[116:119]
    s_waitcnt lgkmcnt(10)
    v_add_f32 v48, v48, v232
    v_add_f32 v49, v49, v233
    v_mfma_f32_16x16x32_bf16 v[116:119], v[196:199], a[72:75], v[116:119]
    s_waitcnt lgkmcnt(8)
    v_add_f32 v50, v50, v234
    v_fmac_f32 v48, s31, v236
    v_mfma_f32_16x16x32_bf16 v[116:119], v[200:203], a[68:71], v[116:119]
    s_waitcnt lgkmcnt(6)
    v_fmac_f32 v49, s31, v237
    v_fmac_f32 v50, s31, v238
    v_mfma_f32_16x16x32_bf16 v[116:119], v[204:207], a[64:67], v[116:119]
    s_waitcnt lgkmcnt(5)
    v_fmac_f32 v51, s31, v239
    v_cvt_pk_bf16_f32 v48, v48, v49
    v_mfma_f32_16x16x32_bf16 v[120:123], v[160:163], a[172:175], 0
    ds_read_u16_d16_hi v246, v18 offset:2688
    v_cvt_pk_bf16_f32 v49, v50, v51
    v_mfma_f32_16x16x32_bf16 v[120:123], v[164:167], a[168:171], v[120:123]
    buffer_store_dwordx2 v[48:49], v20, s[12:15], s34 offen offset:512 sc1
    v_mfma_f32_16x16x32_bf16 v[120:123], v[168:171], a[164:167], v[120:123]
    ds_read_u16_d16_hi v247, v18 offset:3840
    v_add_f32 v103, v103, v106
    v_mfma_f32_16x16x32_bf16 v[120:123], v[172:175], a[160:163], v[120:123]
    ds_bpermute_b32 v248, v19, v248
    v_add_f32 v107, v107, v110
    v_mfma_f32_16x16x32_bf16 v[120:123], v[176:179], a[156:159], v[120:123]
    ds_bpermute_b32 v249, v19, v249
    v_add_f32 v103, v103, v109
    v_mfma_f32_16x16x32_bf16 v[120:123], v[180:183], a[152:155], v[120:123]
    ds_bpermute_b32 v250, v19, v250
    v_cndmask_b32_e64 v224, v103, v87, vcc
    v_mfma_f32_16x16x32_bf16 v[120:123], v[184:187], a[148:151], v[120:123]
    ds_read_u16_d16_hi v252, v18 offset:512
    v_cndmask_b32_e64 v225, v107, v91, vcc
    v_mfma_f32_16x16x32_bf16 v[120:123], v[188:191], a[144:147], v[120:123]
    ds_read_u16_d16_hi v253, v18 offset:1664
    v_cndmask_b32_e64 v226, v111, v95, vcc
    v_mfma_f32_16x16x32_bf16 v[120:123], v[192:195], a[140:143], v[120:123]
    s_waitcnt lgkmcnt(10)
    v_add_f32 v64, v64, v240
    v_add_f32 v65, v65, v241
    v_mfma_f32_16x16x32_bf16 v[120:123], v[196:199], a[136:139], v[120:123]
    s_waitcnt lgkmcnt(8)
    v_add_f32 v66, v66, v242
    v_fmac_f32 v64, s31, v244
    v_mfma_f32_16x16x32_bf16 v[120:123], v[200:203], a[132:135], v[120:123]
    s_waitcnt lgkmcnt(6)
    v_fmac_f32 v65, s31, v245
    v_fmac_f32 v66, s31, v246
    v_mfma_f32_16x16x32_bf16 v[120:123], v[204:207], a[128:131], v[120:123]
    s_waitcnt lgkmcnt(5)
    v_fmac_f32 v67, s31, v247
    v_cvt_pk_bf16_f32 v64, v64, v65
    v_mfma_f32_16x16x32_bf16 v[124:127], v[160:163], a[236:239], 0
    ds_read_u16_d16_hi v254, v18 offset:2816
    v_cvt_pk_bf16_f32 v65, v66, v67
    v_mfma_f32_16x16x32_bf16 v[124:127], v[164:167], a[232:235], v[124:127]
    buffer_store_dwordx2 v[64:65], v20, s[12:15], s34 offen offset:1024 sc1
    v_mfma_f32_16x16x32_bf16 v[124:127], v[168:171], a[228:231], v[124:127]
    ds_read_u16_d16_hi v255, v18 offset:3968
    v_add_f32 v97, v97, v100
    v_mfma_f32_16x16x32_bf16 v[124:127], v[172:175], a[224:227], v[124:127]
    ds_bpermute_b32 v224, v19, v224
    v_add_f32 v98, v98, v101
    v_mfma_f32_16x16x32_bf16 v[124:127], v[176:179], a[220:223], v[124:127]
    ds_bpermute_b32 v225, v19, v225
    v_add_f32 v99, v99, v102
    v_mfma_f32_16x16x32_bf16 v[124:127], v[180:183], a[216:219], v[124:127]
    ds_bpermute_b32 v226, v19, v226
    v_add_f32 v98, v98, v104
    v_mfma_f32_16x16x32_bf16 v[124:127], v[184:187], a[212:215], v[124:127]
    ds_read_u16_d16_hi v228, v18 offset:640
    v_add_f32 v99, v99, v105
    v_mfma_f32_16x16x32_bf16 v[124:127], v[188:191], a[208:211], v[124:127]
    ds_read_u16_d16_hi v229, v18 offset:1792
    v_add_f32 v99, v99, v108
    v_mfma_f32_16x16x32_bf16 v[124:127], v[192:195], a[204:207], v[124:127]
    s_waitcnt lgkmcnt(10)
    v_add_f32 v80, v80, v248
    v_add_f32 v81, v81, v249
    v_mfma_f32_16x16x32_bf16 v[124:127], v[196:199], a[200:203], v[124:127]
    s_waitcnt lgkmcnt(8)
    v_add_f32 v82, v82, v250
    v_fmac_f32 v80, s31, v252
    v_mfma_f32_16x16x32_bf16 v[124:127], v[200:203], a[196:199], v[124:127]
    s_waitcnt lgkmcnt(6)
    v_fmac_f32 v81, s31, v253
    v_fmac_f32 v82, s31, v254
    v_mfma_f32_16x16x32_bf16 v[124:127], v[204:207], a[192:195], v[124:127]
    s_waitcnt lgkmcnt(5)
    v_fmac_f32 v83, s31, v255
    v_cvt_pk_bf16_f32 v80, v80, v81
    v_mfma_f32_16x16x32_bf16 v[128:131], v[160:163], a[52:55], 0
    ds_read_u16_d16_hi v230, v18 offset:2944
    v_cvt_pk_bf16_f32 v81, v82, v83
    v_mfma_f32_16x16x32_bf16 v[128:131], v[164:167], a[48:51], v[128:131]
    buffer_store_dwordx2 v[80:81], v20, s[12:15], s34 offen offset:1536 sc1
    v_mfma_f32_16x16x32_bf16 v[128:131], v[168:171], a[44:47], v[128:131]
    ds_read_u16_d16_hi v231, v18 offset:4096
    v_mfma_f32_16x16x32_bf16 v[128:131], v[172:175], a[40:43], v[128:131]
    v_mfma_f32_16x16x32_bf16 v[128:131], v[176:179], a[36:39], v[128:131]
    v_mfma_f32_16x16x32_bf16 v[128:131], v[180:183], a[32:35], v[128:131]
    v_mfma_f32_16x16x32_bf16 v[128:131], v[184:187], a[28:31], v[128:131]
    v_mfma_f32_16x16x32_bf16 v[128:131], v[188:191], a[24:27], v[128:131]
    v_add_f32 v119, v119, v122
    v_add_f32 v123, v123, v126
    v_mfma_f32_16x16x32_bf16 v[128:131], v[192:195], a[20:23], v[128:131]
    s_waitcnt lgkmcnt(5)
    v_add_f32 v96, v96, v224
    v_add_f32 v97, v97, v225
    v_mfma_f32_16x16x32_bf16 v[128:131], v[196:199], a[16:19], v[128:131]
    s_waitcnt lgkmcnt(3)
    v_add_f32 v98, v98, v226
    v_fmac_f32 v96, s31, v228
    v_mfma_f32_16x16x32_bf16 v[128:131], v[200:203], a[12:15], v[128:131]
    s_waitcnt lgkmcnt(1)
    v_fmac_f32 v97, s31, v229
    v_fmac_f32 v98, s31, v230
    v_mfma_f32_16x16x32_bf16 v[128:131], v[204:207], a[8:11], v[128:131]
    s_waitcnt lgkmcnt(0)
    v_fmac_f32 v99, s31, v231
    v_cvt_pk_bf16_f32 v96, v96, v97
    v_mfma_f32_16x16x32_bf16 v[128:131], v[208:211], a[4:7], v[128:131]
    v_cvt_pk_bf16_f32 v97, v98, v99
    v_add_f32 v119, v119, v125
    v_mfma_f32_16x16x32_bf16 v[128:131], v[212:215], a[0:3], v[128:131]
    buffer_store_dwordx2 v[96:97], v20, s[12:15], s34 offen offset:2048 sc1
    v_mfma_f32_16x16x32_bf16 v[132:135], v[160:163], a[116:119], 0
    v_cndmask_b32_e64 v232, v119, v103, vcc
    v_cndmask_b32_e64 v233, v123, v107, vcc
    v_mfma_f32_16x16x32_bf16 v[132:135], v[164:167], a[112:115], v[132:135]
    v_cndmask_b32_e64 v234, v127, v111, vcc
    v_add_f32 v113, v113, v116
    v_mfma_f32_16x16x32_bf16 v[132:135], v[168:171], a[108:111], v[132:135]
    ds_bpermute_b32 v232, v19, v232
    v_add_f32 v114, v114, v117
    v_mfma_f32_16x16x32_bf16 v[132:135], v[172:175], a[104:107], v[132:135]
    ds_bpermute_b32 v233, v19, v233
    v_add_f32 v115, v115, v118
    v_mfma_f32_16x16x32_bf16 v[132:135], v[176:179], a[100:103], v[132:135]
    ds_bpermute_b32 v234, v19, v234
    v_add_f32 v114, v114, v120
    v_mfma_f32_16x16x32_bf16 v[132:135], v[180:183], a[96:99], v[132:135]
    ds_read_u16_d16_hi v236, v18 offset:768
    v_add_f32 v115, v115, v121
    v_mfma_f32_16x16x32_bf16 v[132:135], v[184:187], a[92:95], v[132:135]
    ds_read_u16_d16_hi v237, v18 offset:1920
    v_add_f32 v115, v115, v124
    v_mfma_f32_16x16x32_bf16 v[132:135], v[188:191], a[88:91], v[132:135]
    ds_read_u16_d16_hi v238, v18 offset:3072
    v_mfma_f32_16x16x32_bf16 v[132:135], v[192:195], a[84:87], v[132:135]
    ds_read_u16_d16_hi v239, v18 offset:4224
    v_mfma_f32_16x16x32_bf16 v[132:135], v[196:199], a[80:83], v[132:135]
    v_mfma_f32_16x16x32_bf16 v[132:135], v[200:203], a[76:79], v[132:135]
    v_mfma_f32_16x16x32_bf16 v[132:135], v[204:207], a[72:75], v[132:135]
    v_mfma_f32_16x16x32_bf16 v[132:135], v[208:211], a[68:71], v[132:135]
    v_mfma_f32_16x16x32_bf16 v[132:135], v[212:215], a[64:67], v[132:135]
    v_mfma_f32_16x16x32_bf16 v[136:139], v[160:163], a[180:183], 0
    s_waitcnt lgkmcnt(5)
    v_add_f32 v112, v112, v232
    v_add_f32 v113, v113, v233
    v_mfma_f32_16x16x32_bf16 v[136:139], v[164:167], a[176:179], v[136:139]
    s_waitcnt lgkmcnt(3)
    v_add_f32 v114, v114, v234
    v_fmac_f32 v112, s31, v236
    v_mfma_f32_16x16x32_bf16 v[136:139], v[168:171], a[172:175], v[136:139]
    s_waitcnt lgkmcnt(1)
    v_fmac_f32 v113, s31, v237
    v_fmac_f32 v114, s31, v238
    v_mfma_f32_16x16x32_bf16 v[136:139], v[172:175], a[168:171], v[136:139]
    s_waitcnt lgkmcnt(0)
    v_fmac_f32 v115, s31, v239
    v_cvt_pk_bf16_f32 v112, v112, v113
    v_mfma_f32_16x16x32_bf16 v[136:139], v[176:179], a[164:167], v[136:139]
    v_cvt_pk_bf16_f32 v113, v114, v115
    v_mfma_f32_16x16x32_bf16 v[136:139], v[180:183], a[160:163], v[136:139]
    buffer_store_dwordx2 v[112:113], v20, s[12:15], s34 offen offset:2560 sc1
    v_mfma_f32_16x16x32_bf16 v[136:139], v[184:187], a[156:159], v[136:139]
    v_mfma_f32_16x16x32_bf16 v[136:139], v[188:191], a[152:155], v[136:139]
    v_mfma_f32_16x16x32_bf16 v[136:139], v[192:195], a[148:151], v[136:139]
    v_mfma_f32_16x16x32_bf16 v[136:139], v[196:199], a[144:147], v[136:139]
    v_mfma_f32_16x16x32_bf16 v[136:139], v[200:203], a[140:143], v[136:139]
    v_mfma_f32_16x16x32_bf16 v[136:139], v[204:207], a[136:139], v[136:139]
    v_mfma_f32_16x16x32_bf16 v[136:139], v[208:211], a[132:135], v[136:139]
    v_mfma_f32_16x16x32_bf16 v[136:139], v[212:215], a[128:131], v[136:139]
    v_mfma_f32_16x16x32_bf16 v[140:143], v[160:163], a[244:247], 0
    v_mfma_f32_16x16x32_bf16 v[140:143], v[164:167], a[240:243], v[140:143]
    v_mfma_f32_16x16x32_bf16 v[140:143], v[168:171], a[236:239], v[140:143]
    v_mfma_f32_16x16x32_bf16 v[140:143], v[172:175], a[232:235], v[140:143]
    v_mfma_f32_16x16x32_bf16 v[140:143], v[176:179], a[228:231], v[140:143]
    v_mfma_f32_16x16x32_bf16 v[140:143], v[180:183], a[224:227], v[140:143]
    v_mfma_f32_16x16x32_bf16 v[140:143], v[184:187], a[220:223], v[140:143]
    v_mfma_f32_16x16x32_bf16 v[140:143], v[188:191], a[216:219], v[140:143]
    v_mfma_f32_16x16x32_bf16 v[140:143], v[192:195], a[212:215], v[140:143]
    v_mfma_f32_16x16x32_bf16 v[140:143], v[196:199], a[208:211], v[140:143]
    v_mfma_f32_16x16x32_bf16 v[140:143], v[200:203], a[204:207], v[140:143]
    v_mfma_f32_16x16x32_bf16 v[140:143], v[204:207], a[200:203], v[140:143]
    v_mfma_f32_16x16x32_bf16 v[140:143], v[208:211], a[196:199], v[140:143]
    v_mfma_f32_16x16x32_bf16 v[140:143], v[212:215], a[192:195], v[140:143]
    v_mfma_f32_16x16x32_bf16 v[144:147], v[160:163], a[60:63], 0
    v_mfma_f32_16x16x32_bf16 v[144:147], v[164:167], a[56:59], v[144:147]
    v_mfma_f32_16x16x32_bf16 v[144:147], v[168:171], a[52:55], v[144:147]
    v_mfma_f32_16x16x32_bf16 v[144:147], v[172:175], a[48:51], v[144:147]
    v_mfma_f32_16x16x32_bf16 v[144:147], v[176:179], a[44:47], v[144:147]
    v_mfma_f32_16x16x32_bf16 v[144:147], v[180:183], a[40:43], v[144:147]
    v_mfma_f32_16x16x32_bf16 v[144:147], v[184:187], a[36:39], v[144:147]
    v_mfma_f32_16x16x32_bf16 v[144:147], v[188:191], a[32:35], v[144:147]
    v_add_f32 v135, v135, v138
    v_add_f32 v139, v139, v142
    v_mfma_f32_16x16x32_bf16 v[144:147], v[192:195], a[28:31], v[144:147]
    v_add_f32 v135, v135, v141
    v_cndmask_b32_e64 v240, v135, v119, vcc
    v_mfma_f32_16x16x32_bf16 v[144:147], v[196:199], a[24:27], v[144:147]
    v_cndmask_b32_e64 v241, v139, v123, vcc
    v_cndmask_b32_e64 v242, v143, v127, vcc
    v_mfma_f32_16x16x32_bf16 v[144:147], v[200:203], a[20:23], v[144:147]
    ds_bpermute_b32 v240, v19, v240
    v_add_f32 v129, v129, v132
    v_mfma_f32_16x16x32_bf16 v[144:147], v[204:207], a[16:19], v[144:147]
    ds_bpermute_b32 v241, v19, v241
    v_add_f32 v130, v130, v133
    v_mfma_f32_16x16x32_bf16 v[144:147], v[208:211], a[12:15], v[144:147]
    ds_bpermute_b32 v242, v19, v242
    v_add_f32 v131, v131, v134
    v_mfma_f32_16x16x32_bf16 v[144:147], v[212:215], a[8:11], v[144:147]
    ds_read_u16_d16_hi v244, v18 offset:896
    v_add_f32 v130, v130, v136
    v_mfma_f32_16x16x32_bf16 v[144:147], v[216:219], a[4:7], v[144:147]
    ds_read_u16_d16_hi v245, v18 offset:2048
    v_add_f32 v131, v131, v137
    v_mfma_f32_16x16x32_bf16 v[144:147], v[220:223], a[0:3], v[144:147]
    ds_read_u16_d16_hi v246, v18 offset:3200
    v_add_f32 v131, v131, v140
    v_mfma_f32_16x16x32_bf16 v[148:151], v[160:163], a[124:127], 0
    ds_read_u16_d16_hi v247, v18 offset:4352
    v_mfma_f32_16x16x32_bf16 v[148:151], v[164:167], a[120:123], v[148:151]
    v_mfma_f32_16x16x32_bf16 v[148:151], v[168:171], a[116:119], v[148:151]
    v_mfma_f32_16x16x32_bf16 v[148:151], v[172:175], a[112:115], v[148:151]
    v_mfma_f32_16x16x32_bf16 v[148:151], v[176:179], a[108:111], v[148:151]
    v_mfma_f32_16x16x32_bf16 v[148:151], v[180:183], a[104:107], v[148:151]
    v_mfma_f32_16x16x32_bf16 v[148:151], v[184:187], a[100:103], v[148:151]
    s_waitcnt lgkmcnt(5)
    v_add_f32 v128, v128, v240
    v_add_f32 v129, v129, v241
    v_mfma_f32_16x16x32_bf16 v[148:151], v[188:191], a[96:99], v[148:151]
    s_waitcnt lgkmcnt(3)
    v_add_f32 v130, v130, v242
    v_fmac_f32 v128, s31, v244
    v_mfma_f32_16x16x32_bf16 v[148:151], v[192:195], a[92:95], v[148:151]
    buffer_load_dword v26, v25, s[12:15], s45 offen sc1
    v_mfma_f32_16x16x32_bf16 v[148:151], v[196:199], a[88:91], v[148:151]
    s_waitcnt lgkmcnt(1)
    v_fmac_f32 v129, s31, v245
    v_fmac_f32 v130, s31, v246
    v_mfma_f32_16x16x32_bf16 v[148:151], v[200:203], a[84:87], v[148:151]
    s_waitcnt lgkmcnt(0)
    v_fmac_f32 v131, s31, v247
    v_cvt_pk_bf16_f32 v128, v128, v129
    v_mfma_f32_16x16x32_bf16 v[148:151], v[204:207], a[80:83], v[148:151]
    v_cvt_pk_bf16_f32 v129, v130, v131
    v_mfma_f32_16x16x32_bf16 v[148:151], v[208:211], a[76:79], v[148:151]
    buffer_store_dwordx2 v[128:129], v20, s[12:15], s34 offen offset:3072 sc1
    v_mfma_f32_16x16x32_bf16 v[148:151], v[212:215], a[72:75], v[148:151]
    v_mfma_f32_16x16x32_bf16 v[148:151], v[216:219], a[68:71], v[148:151]
    v_mfma_f32_16x16x32_bf16 v[148:151], v[220:223], a[64:67], v[148:151]
    v_mfma_f32_16x16x32_bf16 v[152:155], v[160:163], a[188:191], 0
    v_mfma_f32_16x16x32_bf16 v[152:155], v[164:167], a[184:187], v[152:155]
    v_mfma_f32_16x16x32_bf16 v[152:155], v[168:171], a[180:183], v[152:155]
    v_mfma_f32_16x16x32_bf16 v[152:155], v[172:175], a[176:179], v[152:155]
    v_mfma_f32_16x16x32_bf16 v[152:155], v[176:179], a[172:175], v[152:155]
    v_mfma_f32_16x16x32_bf16 v[152:155], v[180:183], a[168:171], v[152:155]
    v_mfma_f32_16x16x32_bf16 v[152:155], v[184:187], a[164:167], v[152:155]
    v_mfma_f32_16x16x32_bf16 v[152:155], v[188:191], a[160:163], v[152:155]
    v_mfma_f32_16x16x32_bf16 v[152:155], v[192:195], a[156:159], v[152:155]
    v_mfma_f32_16x16x32_bf16 v[152:155], v[196:199], a[152:155], v[152:155]
    v_mfma_f32_16x16x32_bf16 v[152:155], v[200:203], a[148:151], v[152:155]
    v_mfma_f32_16x16x32_bf16 v[152:155], v[204:207], a[144:147], v[152:155]
    v_mfma_f32_16x16x32_bf16 v[152:155], v[208:211], a[140:143], v[152:155]
    v_mfma_f32_16x16x32_bf16 v[152:155], v[212:215], a[136:139], v[152:155]
    v_mfma_f32_16x16x32_bf16 v[152:155], v[216:219], a[132:135], v[152:155]
    v_mfma_f32_16x16x32_bf16 v[152:155], v[220:223], a[128:131], v[152:155]
    v_mfma_f32_16x16x32_bf16 v[156:159], v[160:163], v[28:31], 0
    v_mfma_f32_16x16x32_bf16 v[156:159], v[164:167], a[248:251], v[156:159]
    v_mfma_f32_16x16x32_bf16 v[156:159], v[168:171], a[244:247], v[156:159]
    v_mfma_f32_16x16x32_bf16 v[156:159], v[172:175], a[240:243], v[156:159]
    v_mfma_f32_16x16x32_bf16 v[156:159], v[176:179], a[236:239], v[156:159]
    v_mfma_f32_16x16x32_bf16 v[156:159], v[180:183], a[232:235], v[156:159]
    v_mfma_f32_16x16x32_bf16 v[156:159], v[184:187], a[228:231], v[156:159]
    v_mfma_f32_16x16x32_bf16 v[156:159], v[188:191], a[224:227], v[156:159]
    v_mfma_f32_16x16x32_bf16 v[156:159], v[192:195], a[220:223], v[156:159]
    v_mfma_f32_16x16x32_bf16 v[156:159], v[196:199], a[216:219], v[156:159]
    v_mfma_f32_16x16x32_bf16 v[156:159], v[200:203], a[212:215], v[156:159]
    v_mfma_f32_16x16x32_bf16 v[156:159], v[204:207], a[208:211], v[156:159]
    v_mfma_f32_16x16x32_bf16 v[156:159], v[208:211], a[204:207], v[156:159]
    v_mfma_f32_16x16x32_bf16 v[156:159], v[212:215], a[200:203], v[156:159]
    v_mfma_f32_16x16x32_bf16 v[156:159], v[216:219], a[196:199], v[156:159]
    v_mfma_f32_16x16x32_bf16 v[156:159], v[220:223], a[192:195], v[156:159]
    s_nop 7
    v_add_f32 v151, v151, v154
    v_add_f32 v155, v155, v158
    v_add_f32 v151, v151, v157
    v_cndmask_b32_e64 v248, v151, v135, vcc
    v_cndmask_b32_e64 v249, v155, v139, vcc
    v_cndmask_b32_e64 v250, v159, v143, vcc
    ds_bpermute_b32 v248, v19, v248
    ds_bpermute_b32 v249, v19, v249
    ds_bpermute_b32 v250, v19, v250
    ds_read_u16_d16_hi v252, v18 offset:1024
    ds_read_u16_d16_hi v253, v18 offset:2176
    ds_read_u16_d16_hi v254, v18 offset:3328
    ds_read_u16_d16_hi v255, v18 offset:4480
    v_add_f32 v145, v145, v148
    v_add_f32 v146, v146, v149
    v_add_f32 v147, v147, v150
    v_add_f32 v146, v146, v152
    v_add_f32 v147, v147, v153
    v_add_f32 v147, v147, v156
    s_waitcnt lgkmcnt(0)
    v_add_f32 v144, v144, v248
    v_add_f32 v145, v145, v249
    v_add_f32 v146, v146, v250
    v_fmac_f32 v144, s31, v252
    v_fmac_f32 v145, s31, v253
    v_fmac_f32 v146, s31, v254
    v_fmac_f32 v147, s31, v255
    v_cvt_pk_bf16_f32 v144, v144, v145
    v_cvt_pk_bf16_f32 v145, v146, v147
    buffer_store_dwordx2 v[144:145], v20, s[12:15], s34 offen offset:3584 sc1
    s_add_u32 s47, s37, 14680064
    s_waitcnt vmcnt(2)
    v_cmp_ne_u32 vcc, 0, v26
    s_cmp_eq_u64 vcc, 0
    s_cselect_b32 s50, 1, 0
    s_cselect_b32 s51, s47, 2.0
    buffer_load_dwordx4 a[0:3], v1, s[12:15], s51 offen offset:0 sc1
    s_lshl_b32 s42, s42, 4
    s_lshl_b32 s36, s41, 6
    s_add_u32 s36, s36, 896
    s_add_u32 s35, s36, 1835008
    s_add_u32 s39, s37, 14680064
    s_mov_b32 s8, s88
    s_mov_b32 s9, s89
    s_mov_b32 s10, 3670016
    buffer_load_dwordx4 a[4:7], v1, s[12:15], s51 offen offset:1024 sc1
    s_mov_b32 s11, 0x20000
    v_and_b32 v2, 15, v0
    v_add_u32 v2, s42, v2
    v_mul_u32_u24 v7, 896, v2
    v_lshrrev_b32 v3, 4, v0
    v_lshlrev_b32 v8, 4, v3
    v_lshl_add_u32 v2, v7, 1, v8
    buffer_load_dwordx4 a[8:11], v1, s[12:15], s51 offen offset:2048 sc1
    v_add_u32 v7, v7, v8
    v_and_b32 v4, 1, v0
    v_lshlrev_b32 v4, 4, v4
    v_mov_b32 v5, 0x3f80
    v_lshlrev_b32 v4, v4, v5
    v_bfe_u32 v5, v0, 3, 1
    v_bfe_u32 v6, v0, 1, 1
    buffer_load_dwordx4 a[12:15], v1, s[12:15], s51 offen offset:3072 sc1
    v_lshl_add_u32 v5, v5, 1, v6
    v_bfe_u32 v6, v0, 2, 1
    v_lshlrev_b32 v6, 1, v6
    v_sub_u32 v6, v3, v6
    v_lshl_add_u32 v5, v6, 2, v5
    v_cmp_eq_u32 s[16:17], 0, v5
    v_cmp_eq_u32 s[18:19], 1, v5
    s_add_u32 s51, s51, 4096
    v_cmp_eq_u32 s[20:21], 2, v5
    v_cmp_eq_u32 s[22:23], 3, v5
    v_cndmask_b32 v24, 0, v4, s[16:17]
    v_cndmask_b32 v25, 0, v4, s[18:19]
    v_cndmask_b32 v26, 0, v4, s[20:21]
    v_cndmask_b32 v27, 0, v4, s[22:23]
    v_cmp_eq_u32 s[16:17], 4, v5
    buffer_load_dwordx4 a[16:19], v1, s[12:15], s51 offen offset:0 sc1
    v_cmp_eq_u32 s[18:19], 5, v5
    v_cmp_eq_u32 s[20:21], 6, v5
    v_cmp_eq_u32 s[22:23], 7, v5
    v_cndmask_b32 v28, 0, v4, s[16:17]
    v_cndmask_b32 v29, 0, v4, s[18:19]
    v_cndmask_b32 v30, 0, v4, s[20:21]
    v_cndmask_b32 v31, 0, v4, s[22:23]
    s_mov_b32 s16, s64
    buffer_load_dwordx4 a[20:23], v1, s[12:15], s51 offen offset:1024 sc1
    s_mov_b32 s17, s65
    s_mov_b32 s18, 1835008
    s_mov_b32 s19, 0x20000
    s_lshl_b32 s93, s95, 2
    s_add_u32 s93, s93, 84963328
    s_lshl_b32 s43, s41, 6
    s_add_u32 s43, s43, 84963328
    buffer_load_dwordx4 a[24:27], v1, s[12:15], s51 offen offset:2048 sc1
    s_lshl_b32 s46, s41, 7
    s_add_u32 s54, s46, 917504
    s_add_u32 s55, s46, 1835008
    v_lshrrev_b32 v8, 1, v0
    v_lshlrev_b32 v8, 12, v8
    v_and_b32 v9, 1, v0
    v_lshl_add_u32 v8, v9, 4, v8
    buffer_load_dwordx4 a[28:31], v1, s[12:15], s51 offen offset:3072 sc1
    s_lshl_b32 s56, s42, 1
    s_lshl_b32 s57, s41, 18
    s_add_u32 s56, s56, s57
    s_add_u32 s56, s56, 90177536
    s_add_u32 s57, s56, 0x20000
    s_lshl_b32 s58, s3, 12
    v_lshlrev_b32 v10, 3, v3
    s_add_u32 s51, s51, 4096
    v_bfe_u32 v15, v0, 2, 2
    v_add_u32 v10, v10, v15
    v_lshlrev_b32 v10, 5, v10
    v_and_b32 v15, 3, v0
    v_lshl_add_u32 v10, v15, 3, v10
    v_add_u32 v10, s58, v10
    s_mov_b32 s59, 0xffff0000
    s_waitcnt vmcnt(8)
    s_barrier
    buffer_store_dword v21, v21, s[12:15], s93 offen sc1
    buffer_load_dwordx4 a[32:35], v1, s[12:15], s51 offen offset:0 sc1
    buffer_load_dwordx4 a[36:39], v1, s[12:15], s51 offen offset:1024 sc1
    buffer_load_dwordx4 a[40:43], v1, s[12:15], s51 offen offset:2048 sc1
    buffer_load_dwordx4 a[44:47], v1, s[12:15], s51 offen offset:3072 sc1
    s_add_u32 s51, s51, 4096
    buffer_load_dwordx4 a[48:51], v1, s[12:15], s51 offen offset:0 sc1
    buffer_load_dwordx4 a[52:55], v1, s[12:15], s51 offen offset:1024 sc1
    buffer_load_dwordx4 a[56:59], v1, s[12:15], s51 offen offset:2048 sc1
    buffer_load_dwordx4 a[60:63], v1, s[12:15], s51 offen offset:3072 sc1
    s_add_u32 s51, s51, 4096
    s_cmp_eq_u32 s50, 1
    s_cbranch_scc1 L_havelong
    v_and_b32 v16, 15, v0
    v_lshlrev_b32 v16, 2, v16
    s_mov_b32 s32, 0
L_poll7:
    buffer_load_dword v17, v16, s[12:15], s45 offen sc1
    s_waitcnt vmcnt(0)
    v_cmp_ne_u32 vcc, 0, v17
    s_cbranch_vccz L_poll7_ok
    s_sleep 8
    s_add_u32 s32, s32, 1
    s_cmp_lt_u32 s32, 0x80000
    s_cbranch_scc1 L_poll7
L_poll7_ok:
    buffer_load_dwordx4 a[0:3], v1, s[12:15], s39 offen offset:0 sc1
    buffer_load_dwordx4 a[4:7], v1, s[12:15], s39 offen offset:1024 sc1
    buffer_load_dwordx4 a[8:11], v1, s[12:15], s39 offen offset:2048 sc1
    buffer_load_dwordx4 a[12:15], v1, s[12:15], s39 offen offset:3072 sc1
    s_add_u32 s39, s39, 4096
    buffer_load_dwordx4 a[16:19], v1, s[12:15], s39 offen offset:0 sc1
    buffer_load_dwordx4 a[20:23], v1, s[12:15], s39 offen offset:1024 sc1
    buffer_load_dwordx4 a[24:27], v1, s[12:15], s39 offen offset:2048 sc1
    buffer_load_dwordx4 a[28:31], v1, s[12:15], s39 offen offset:3072 sc1
    s_add_u32 s39, s39, 4096
    buffer_load_dwordx4 a[32:35], v1, s[12:15], s39 offen offset:0 sc1
    buffer_load_dwordx4 a[36:39], v1, s[12:15], s39 offen offset:1024 sc1
    buffer_load_dwordx4 a[40:43], v1, s[12:15], s39 offen offset:2048 sc1
    buffer_load_dwordx4 a[44:47], v1, s[12:15], s39 offen offset:3072 sc1
    s_add_u32 s39, s39, 4096
    buffer_load_dwordx4 a[48:51], v1, s[12:15], s39 offen offset:0 sc1
    buffer_load_dwordx4 a[52:55], v1, s[12:15], s39 offen offset:1024 sc1
    buffer_load_dwordx4 a[56:59], v1, s[12:15], s39 offen offset:2048 sc1
    buffer_load_dwordx4 a[60:63], v1, s[12:15], s39 offen offset:3072 sc1
    s_add_u32 s39, s39, 4096
L_havelong:
    buffer_load_dwordx4 v[48:51], v7, s[16:19], s46 offen offset:0
    buffer_load_dwordx4 v[52:55], v7, s[16:19], s46 offen offset:64
    buffer_load_dwordx4 v[56:59], v7, s[16:19], s54 offen offset:0
    buffer_load_dwordx4 v[60:63], v7, s[16:19], s54 offen offset:64
    v_and_b32 v17, 15, v0
    v_lshlrev_b32 v17, 2, v17
    buffer_load_dword a246, v17, s[12:15], s43 offen sc1
    s_waitcnt vmcnt(20)
    v_mfma_f32_16x16x32_bf16 v[32:35], v[24:27], a[0:3], 0
    v_mfma_f32_16x16x32_bf16 v[36:39], v[28:31], a[0:3], 0
    s_waitcnt vmcnt(19)
    v_mfma_f32_16x16x32_bf16 v[32:35], v[24:27], a[4:7], v[32:35]
    v_mfma_f32_16x16x32_bf16 v[36:39], v[28:31], a[4:7], v[36:39]
    s_waitcnt vmcnt(18)
    v_mfma_f32_16x16x32_bf16 v[32:35], v[24:27], a[8:11], v[32:35]
    v_mfma_f32_16x16x32_bf16 v[36:39], v[28:31], a[8:11], v[36:39]
    s_waitcnt vmcnt(17)
    v_mfma_f32_16x16x32_bf16 v[32:35], v[24:27], a[12:15], v[32:35]
    v_mfma_f32_16x16x32_bf16 v[36:39], v[28:31], a[12:15], v[36:39]
    s_waitcnt vmcnt(16)
    v_mfma_f32_16x16x32_bf16 v[32:35], v[24:27], a[16:19], v[32:35]
    v_mfma_f32_16x16x32_bf16 v[36:39], v[28:31], a[16:19], v[36:39]
    s_waitcnt vmcnt(15)
    v_mfma_f32_16x16x32_bf16 v[32:35], v[24:27], a[20:23], v[32:35]
    v_mfma_f32_16x16x32_bf16 v[36:39], v[28:31], a[20:23], v[36:39]
    s_waitcnt vmcnt(14)
    v_mfma_f32_16x16x32_bf16 v[32:35], v[24:27], a[24:27], v[32:35]
    v_mfma_f32_16x16x32_bf16 v[36:39], v[28:31], a[24:27], v[36:39]
    s_waitcnt vmcnt(13)
    v_mfma_f32_16x16x32_bf16 v[32:35], v[24:27], a[28:31], v[32:35]
    v_mfma_f32_16x16x32_bf16 v[36:39], v[28:31], a[28:31], v[36:39]
    s_waitcnt vmcnt(12)
    v_mfma_f32_16x16x32_bf16 v[32:35], v[24:27], a[32:35], v[32:35]
    v_mfma_f32_16x16x32_bf16 v[36:39], v[28:31], a[32:35], v[36:39]
    s_waitcnt vmcnt(11)
    v_mfma_f32_16x16x32_bf16 v[32:35], v[24:27], a[36:39], v[32:35]
    v_mfma_f32_16x16x32_bf16 v[36:39], v[28:31], a[36:39], v[36:39]
    s_waitcnt vmcnt(10)
    v_mfma_f32_16x16x32_bf16 v[32:35], v[24:27], a[40:43], v[32:35]
    v_mfma_f32_16x16x32_bf16 v[36:39], v[28:31], a[40:43], v[36:39]
    s_waitcnt vmcnt(9)
    v_mfma_f32_16x16x32_bf16 v[32:35], v[24:27], a[44:47], v[32:35]
    v_mfma_f32_16x16x32_bf16 v[36:39], v[28:31], a[44:47], v[36:39]
    s_waitcnt vmcnt(8)
    v_mfma_f32_16x16x32_bf16 v[32:35], v[24:27], a[48:51], v[32:35]
    v_mfma_f32_16x16x32_bf16 v[36:39], v[28:31], a[48:51], v[36:39]
    s_waitcnt vmcnt(7)
    v_mfma_f32_16x16x32_bf16 v[32:35], v[24:27], a[52:55], v[32:35]
    v_mfma_f32_16x16x32_bf16 v[36:39], v[28:31], a[52:55], v[36:39]
    s_waitcnt vmcnt(6)
    v_mfma_f32_16x16x32_bf16 v[32:35], v[24:27], a[56:59], v[32:35]
    v_mfma_f32_16x16x32_bf16 v[36:39], v[28:31], a[56:59], v[36:39]
    s_waitcnt vmcnt(5)
    v_mfma_f32_16x16x32_bf16 v[32:35], v[24:27], a[60:63], v[32:35]
    v_mfma_f32_16x16x32_bf16 v[36:39], v[28:31], a[60:63], v[36:39]
    s_nop 7
    v_cvt_pk_bf16_f32 v32, v32, v33
    v_cvt_pk_bf16_f32 v33, v34, v35
    v_cvt_pk_bf16_f32 v34, v36, v37
    v_cvt_pk_bf16_f32 v35, v38, v39
    buffer_store_dwordx4 v[32:35], v2, s[8:11], s35 offen offset:0
    s_waitcnt vmcnt(1)
    v_accvgpr_read_b32 v17, a246
    v_cmp_ne_u32 vcc, 0, v17
    s_cbranch_vccz L_poll8_ok
    v_and_b32 v16, 15, v0
    v_lshlrev_b32 v16, 2, v16
    s_mov_b32 s32, 0
L_poll8:
    buffer_load_dword v17, v16, s[12:15], s43 offen sc1
    s_waitcnt vmcnt(0)
    v_cmp_ne_u32 vcc, 0, v17
    s_cbranch_vccz L_poll8_ok
    s_sleep 8
    s_add_u32 s32, s32, 1
    s_cmp_lt_u32 s32, 0x80000
    s_cbranch_scc1 L_poll8
L_poll8_ok:
    s_add_u32 m0, s58, 0
    s_nop 0
    buffer_load_dwordx4 v8, s[12:15], s56 offen offset:0 sc1 lds
    s_add_u32 m0, s58, 1024
    s_nop 0
    buffer_load_dwordx4 v8, s[12:15], s57 offen offset:0 sc1 lds
    s_add_u32 m0, s58, 0
    s_nop 0
    buffer_load_dwordx4 v8, s[12:15], s56 offen offset:2048 sc1 lds
    s_add_u32 m0, s58, 1024
    s_nop 0
    buffer_load_dwordx4 v8, s[12:15], s57 offen offset:2048 sc1 lds
    s_waitcnt vmcnt(3)
    ds_read_b64_tr_b16 v[12:13], v10 offset:0
    ds_read_b64_tr_b16 v[14:15], v10 offset:128
    s_waitcnt lgkmcnt(0)
    v_lshlrev_b32 v16, 16, v48
    v_and_b32 v17, s59, v48
    v_lshlrev_b32 v18, 16, v12
    v_and_b32 v19, s59, v12
    v_pk_mul_f32 v[16:17], v[16:17], v[18:19]
    v_cvt_pk_bf16_f32 v48, v16, v17
    v_lshlrev_b32 v16, 16, v49
    v_and_b32 v17, s59, v49
    v_lshlrev_b32 v18, 16, v13
    v_and_b32 v19, s59, v13
    v_pk_mul_f32 v[16:17], v[16:17], v[18:19]
    v_cvt_pk_bf16_f32 v49, v16, v17
    v_lshlrev_b32 v16, 16, v50
    v_and_b32 v17, s59, v50
    v_lshlrev_b32 v18, 16, v14
    v_and_b32 v19, s59, v14
    v_pk_mul_f32 v[16:17], v[16:17], v[18:19]
    v_cvt_pk_bf16_f32 v50, v16, v17
    v_lshlrev_b32 v16, 16, v51
    v_and_b32 v17, s59, v51
    v_lshlrev_b32 v18, 16, v15
    v_and_b32 v19, s59, v15
    v_pk_mul_f32 v[16:17], v[16:17], v[18:19]
    v_cvt_pk_bf16_f32 v51, v16, v17
    buffer_store_dwordx4 v[48:51], v2, s[8:11], s46 offen offset:0
    s_waitcnt vmcnt(3)
    ds_read_b64_tr_b16 v[12:13], v10 offset:1024
    ds_read_b64_tr_b16 v[14:15], v10 offset:1152
    s_waitcnt lgkmcnt(0)
    v_lshlrev_b32 v16, 16, v52
    v_and_b32 v17, s59, v52
    v_lshlrev_b32 v18, 16, v12
    v_and_b32 v19, s59, v12
    v_pk_mul_f32 v[16:17], v[16:17], v[18:19]
    v_cvt_pk_bf16_f32 v52, v16, v17
    v_lshlrev_b32 v16, 16, v53
    v_and_b32 v17, s59, v53
    v_lshlrev_b32 v18, 16, v13
    v_and_b32 v19, s59, v13
    v_pk_mul_f32 v[16:17], v[16:17], v[18:19]
    v_cvt_pk_bf16_f32 v53, v16, v17
    v_lshlrev_b32 v16, 16, v54
    v_and_b32 v17, s59, v54
    v_lshlrev_b32 v18, 16, v14
    v_and_b32 v19, s59, v14
    v_pk_mul_f32 v[16:17], v[16:17], v[18:19]
    v_cvt_pk_bf16_f32 v54, v16, v17
    v_lshlrev_b32 v16, 16, v55
    v_and_b32 v17, s59, v55
    v_lshlrev_b32 v18, 16, v15
    v_and_b32 v19, s59, v15
    v_pk_mul_f32 v[16:17], v[16:17], v[18:19]
    v_cvt_pk_bf16_f32 v55, v16, v17
    buffer_store_dwordx4 v[52:55], v2, s[8:11], s46 offen offset:64
    s_waitcnt vmcnt(3)
    ds_read_b64_tr_b16 v[12:13], v10 offset:2048
    ds_read_b64_tr_b16 v[14:15], v10 offset:2176
    s_waitcnt lgkmcnt(0)
    v_lshlrev_b32 v16, 16, v56
    v_and_b32 v17, s59, v56
    v_lshlrev_b32 v18, 16, v12
    v_and_b32 v19, s59, v12
    v_pk_mul_f32 v[16:17], v[16:17], v[18:19]
    v_cvt_pk_bf16_f32 v56, v16, v17
    v_lshlrev_b32 v16, 16, v57
    v_and_b32 v17, s59, v57
    v_lshlrev_b32 v18, 16, v13
    v_and_b32 v19, s59, v13
    v_pk_mul_f32 v[16:17], v[16:17], v[18:19]
    v_cvt_pk_bf16_f32 v57, v16, v17
    v_lshlrev_b32 v16, 16, v58
    v_and_b32 v17, s59, v58
    v_lshlrev_b32 v18, 16, v14
    v_and_b32 v19, s59, v14
    v_pk_mul_f32 v[16:17], v[16:17], v[18:19]
    v_cvt_pk_bf16_f32 v58, v16, v17
    v_lshlrev_b32 v16, 16, v59
    v_and_b32 v17, s59, v59
    v_lshlrev_b32 v18, 16, v15
    v_and_b32 v19, s59, v15
    v_pk_mul_f32 v[16:17], v[16:17], v[18:19]
    v_cvt_pk_bf16_f32 v59, v16, v17
    buffer_store_dwordx4 v[56:59], v2, s[8:11], s55 offen offset:0
    s_waitcnt vmcnt(3)
    ds_read_b64_tr_b16 v[12:13], v10 offset:3072
    ds_read_b64_tr_b16 v[14:15], v10 offset:3200
    s_waitcnt lgkmcnt(0)
    v_lshlrev_b32 v16, 16, v60
    v_and_b32 v17, s59, v60
    v_lshlrev_b32 v18, 16, v12
    v_and_b32 v19, s59, v12
    v_pk_mul_f32 v[16:17], v[16:17], v[18:19]
    v_cvt_pk_bf16_f32 v60, v16, v17
    v_lshlrev_b32 v16, 16, v61
    v_and_b32 v17, s59, v61
    v_lshlrev_b32 v18, 16, v13
    v_and_b32 v19, s59, v13
    v_pk_mul_f32 v[16:17], v[16:17], v[18:19]
    v_cvt_pk_bf16_f32 v61, v16, v17
    v_lshlrev_b32 v16, 16, v62
    v_and_b32 v17, s59, v62
    v_lshlrev_b32 v18, 16, v14
    v_and_b32 v19, s59, v14
    v_pk_mul_f32 v[16:17], v[16:17], v[18:19]
    v_cvt_pk_bf16_f32 v62, v16, v17
    v_lshlrev_b32 v16, 16, v63
    v_and_b32 v17, s59, v63
    v_lshlrev_b32 v18, 16, v15
    v_and_b32 v19, s59, v15
    v_pk_mul_f32 v[16:17], v[16:17], v[18:19]
    v_cvt_pk_bf16_f32 v63, v16, v17
    buffer_store_dwordx4 v[60:63], v2, s[8:11], s55 offen offset:64
L_fin:
    s_endpgm
L_codeend:
.section .rodata,"a"
.p2align 6
.amdhsa_kernel concat_heads__ssm_conv_h3__compressed_kv_cla__prompt_kernel
  .amdhsa_next_free_vgpr 512
  .amdhsa_next_free_sgpr 102
  .amdhsa_accum_offset 256
  .amdhsa_group_segment_fixed_size 0
  .amdhsa_kernarg_size 120
  .amdhsa_user_sgpr_count 2
  .amdhsa_user_sgpr_kernarg_segment_ptr 1
  .amdhsa_system_sgpr_workgroup_id_x 1
.end_amdhsa_kernel
```

```asm
; @launch grid=(256,1,1) block=(256,1,1) lds=163840
.amdgcn_target "amdgcn-amd-amdhsa--gfx950"
.text
.globl concat_heads__ssm_conv_h3__compressed_kv_cla__prompt_kernel
.p2align 8
.type concat_heads__ssm_conv_h3__compressed_kv_cla__prompt_kernel,@function
concat_heads__ssm_conv_h3__compressed_kv_cla__prompt_kernel:
 s_cmp_lt_u32 s2, 256
 s_cbranch_scc1 L_go
 s_endpgm
L_go:
 s_load_dwordx16 s[64:79], s[0:1], 0
 s_load_dwordx8 s[80:87], s[0:1], 64
 s_load_dwordx4 s[88:91], s[0:1], 96
 s_load_dwordx2 s[12:13], s[0:1], 112
 v_lshrrev_b32 v1, 6, v0
 v_and_b32 v0, 63, v0
 v_readfirstlane_b32 s3, v1
 s_and_b32 s24, s2, 7
 s_bfe_u32 s25, s2, 0x30003
 s_bfe_u32 s26, s2, 0x10006
 s_lshl_b32 s37, s24, 1
 s_add_u32 s26, s26, s37
 s_lshr_b32 s27, s2, 7
 s_bfe_u32 s28, s2, 0x40003
 s_lshl_b32 s29, s3, 10
 s_and_b32 s39, s3, 1
 s_lshr_b32 s40, s3, 1
 s_getpc_b64 s[100:101]
L_pc:
 s_sub_u32 s100, s100, L_pc-L_go
 s_subb_u32 s101, s101, 0
 s_lshr_b32 s32, s2, 1
 s_and_b32 s32, s32, 12
 s_add_u32 s32, s32, s3
 s_lshl_b32 s32, s32, 13
 s_add_u32 s32, s32, 0x1000
 v_lshlrev_b32 v14, 7, v0
 v_add_u32 v14, s32, v14
 v_min_u32 v14, L_codeend-L_go-4, v14
 v_accvgpr_write_b32 a244, v14
 global_load_dword a243, v14, s[100:101]
 s_mov_b32 s41, 65536
 s_mov_b32 s48, 32768
 s_mov_b32 s42, 131072
 s_mov_b32 s49, 131072
 s_mov_b32 s43, 196608
 s_mov_b32 s50, 163840
 s_mov_b32 s44, 262144
 s_mov_b32 s51, 262144
 s_mov_b32 s45, 327680
 s_mov_b32 s52, 294912
 s_mov_b32 s46, 393216
 s_mov_b32 s53, 393216
 s_mov_b32 s47, 458752
 s_mov_b32 s54, 425984
 s_lshl_b32 s56, s39, 1
 s_lshl_b32 s57, s40, 3
 s_add_u32 s56, s56, s57
 s_lshl_b32 s60, s25, 8
 s_lshl_b32 s58, s3, 3
 s_add_u32 s58, s58, s60
 v_lshrrev_b32 v14, 3, v0
 v_add_u32 v14, s58, v14
 v_lshlrev_b32 v14, 11, v14
 s_lshl_b32 s58, s39, 2
 v_lshrrev_b32 v15, 4, v0
 v_add_u32 v15, s58, v15
 v_xor_b32 v15, v0, v15
 v_and_b32 v15, 7, v15
 v_lshl_add_u32 v1, v15, 4, v14
 v_lshrrev_b32 v14, 5, v0
 s_lshl_b32 s58, s3, 1
 v_add_u32 v15, s58, v14
 v_lshlrev_b32 v15, 1, v15
 v_xor_b32 v15, v0, v15
 v_and_b32 v15, 31, v15
 v_lshlrev_b32 v15, 4, v15
 v_add_u32 v14, s56, v14
 v_lshl_add_u32 v14, v14, 13, v15
 s_lshl_b32 s58, s26, 9
 v_add_u32 v2, s58, v14
 s_waitcnt lgkmcnt(0)
 s_cmp_eq_u32 s27, 0
 s_cselect_b32 s8, s82, s84
 s_cselect_b32 s9, s83, s85
 s_mov_b32 s10, 8388608
 s_mov_b32 s11, 0x20000
 s_mov_b32 s4, s78
 s_mov_b32 s5, s79
 s_mov_b32 s6, 4194304
 s_mov_b32 s7, 0x20000
 s_mov_b32 s14, 268435456
 s_mov_b32 s15, 0x20000
 s_add_u32 m0, s29, 65536
 s_nop 0
 buffer_load_dwordx4 v2, s[8:11], 0 offen  lds
 s_lshl_b32 s58, s27, 3
 s_add_u32 s59, s58, s25
 s_lshl_b32 s59, s59, 2
 s_lshl_b32 s92, s26, 7
 s_add_u32 s92, s92, s59
 s_add_u32 s92, s92, 84934656
 s_add_u32 s58, s58, s24
 s_mul_i32 s95, s58, 14
 s_add_u32 m0, s29, 0
 s_nop 0
 buffer_load_dwordx4 v1, s[4:7], 0 offen  lds
 s_add_u32 s95, s95, s28
 s_sub_u32 s63, 15, s25
 s_cmp_eq_u32 s27, 0
 s_cselect_b32 s63, s25, s63
 s_lshl_b32 s93, s63, 7
 s_lshl_b32 s59, s26, 2
 s_add_u32 s93, s93, s59
 s_add_u32 s93, s93, 84938752
 s_add_u32 m0, s29, 69632
 s_nop 0
 buffer_load_dwordx4 v2, s[8:11], s48 offen  lds
 s_and_b32 s94, s2, 127
 s_lshl_b32 s94, s94, 7
 s_add_u32 s94, s94, 84942848
 s_cmp_lg_u32 s3, 0
 s_cbranch_scc1 L_noclr
 s_lshl_b32 s58, s95, 2
 s_add_u32 s59, s58, 84963328
 s_add_u32 s58, s58, 84959232
 s_lshl_b32 s61, s27, 2
 s_add_u32 s61, s61, s94
 s_cmp_lt_u32 s28, 14
 s_cselect_b32 s58, s58, s92
 s_cselect_b32 s59, s59, s92
 v_mov_b32 v14, s92
 v_writelane_b32 v14, s93, 1
 v_writelane_b32 v14, s61, 2
 v_writelane_b32 v14, s58, 3
 v_writelane_b32 v14, s59, 4
 s_add_u32 s58, s93, 64
 v_writelane_b32 v14, s58, 5
 v_mov_b32 v15, 1
 s_mov_b64 exec, 63
 buffer_store_dword v15, v14, s[12:15], 0 offen sc1
 s_mov_b64 exec, -1
L_noclr:
 s_add_u32 m0, s29, 4096
 s_nop 0
 buffer_load_dwordx4 v1, s[4:7], s41 offen  lds
 s_add_u32 m0, s29, 73728
 s_nop 0
 buffer_load_dwordx4 v2, s[8:11], s49 offen  lds
 s_add_u32 m0, s29, 8192
 s_nop 0
 buffer_load_dwordx4 v1, s[4:7], s42 offen  lds
 s_cmp_eq_u32 s3, 0
 s_cselect_b32 s58, 0, 0x80000000
 v_bfrev_b32 v14, 1
 v_writelane_b32 v14, s58, 0
 v_accvgpr_write_b32 a245, v14
 s_add_u32 m0, s29, 77824
 s_nop 0
 buffer_load_dwordx4 v2, s[8:11], s50 offen  lds
 s_lshl_b32 s58, s39, 7
 s_lshl_b32 s59, s40, 3
 v_and_b32 v14, 15, v0
 v_lshrrev_b32 v15, 4, v0
 s_lshl_b32 s60, s63, 7
 s_lshl_b32 s62, s3, 4
 s_add_u32 s60, s60, s62
 v_lshrrev_b32 v13, 3, v0
 s_add_u32 m0, s29, 12288
 s_nop 0
 buffer_load_dwordx4 v1, s[4:7], s43 offen  lds
 v_lshlrev_b32 v13, 1, v13
 v_add_u32 v12, s60, v13
 v_mul_u32_u24 v12, 896, v12
 v_lshrrev_b32 v13, 1, v13
 v_xor_b32 v13, v0, v13
 v_and_b32 v13, 7, v13
 v_lshl_add_u32 v13, v13, 4, v12
 s_add_u32 m0, s29, 81920
 s_nop 0
 buffer_load_dwordx4 v2, s[8:11], s51 offen  lds
 v_accvgpr_write_b32 a240, v13
 v_lshrrev_b32 v13, 1, v14
 v_xor_b32 v12, v13, v15
 v_lshlrev_b32 v12, 4, v12
 v_lshl_add_u32 v12, v13, 7, v12
 v_and_b32 v13, 1, v14
 v_lshl_add_u32 v12, v13, 10, v12
 s_lshl_b32 s33, s3, 13
 s_add_u32 m0, s29, 16384
 s_nop 0
 buffer_load_dwordx4 v1, s[4:7], s44 offen  lds
 s_add_u32 s33, s33, 0x20000
 v_add_u32 v12, s33, v12
 v_accvgpr_write_b32 a242, v12
 v_lshrrev_b32 v5, 1, v14
 v_xor_b32 v5, v5, v15
 v_add_u32 v14, s58, v14
 v_lshlrev_b32 v14, 7, v14
 s_add_u32 m0, s29, 86016
 s_nop 0
 buffer_load_dwordx4 v2, s[8:11], s52 offen  lds
 v_lshl_add_u32 v4, v5, 4, v14
 v_xor_b32 v5, 64, v4
 v_bfe_u32 v14, v0, 2, 3
 v_lshrrev_b32 v15, 5, v0
 v_lshl_add_u32 v13, v15, 4, v14
 v_lshlrev_b32 v13, 9, v13
 v_xor_b32 v14, s59, v14
 v_lshl_add_u32 v13, v14, 5, v13
 s_add_u32 m0, s29, 20480
 s_nop 0
 buffer_load_dwordx4 v1, s[4:7], s45 offen  lds
 v_and_b32 v14, 3, v0
 v_lshl_add_u32 v13, v14, 3, v13
 v_add_u32 v6, 0x10000, v13
 v_xor_b32 v7, 32, v6
 v_xor_b32 v8, 64, v6
 v_xor_b32 v9, 96, v6
 v_xor_b32 v10, 128, v6
 s_add_u32 m0, s29, 90112
 s_nop 0
 buffer_load_dwordx4 v2, s[8:11], s53 offen  lds
 v_xor_b32 v11, 160, v6
 v_xor_b32 v12, 192, v6
 v_xor_b32 v13, 224, v6
 s_mov_b32 s16, s80
 s_mov_b32 s17, s81
 s_mov_b32 s18, 3670016
 s_mov_b32 s19, 0x20000
 s_mov_b32 s20, s76
 s_add_u32 m0, s29, 24576
 s_nop 0
 buffer_load_dwordx4 v1, s[4:7], s46 offen  lds
 s_mov_b32 s21, s77
 s_mov_b32 s22, 1835008
 s_mov_b32 s23, 0x20000
 s_lshl_b32 s58, s26, 20
 s_lshl_b32 s62, s63, 16
 s_add_u32 s62, s62, s58
 s_lshl_b32 s59, s3, 13
 s_add_u32 s62, s62, s59
 s_add_u32 m0, s29, 94208
 s_nop 0
 buffer_load_dwordx4 v2, s[8:11], s54 offen  lds
 s_add_u32 s62, s62, 33554432
 s_lshl_b32 s59, s25, 17
 s_add_u32 s58, s58, s59
 s_lshl_b32 s59, s39, 16
 s_add_u32 s58, s58, s59
 s_lshl_b32 s59, s40, 12
 s_lshl_b32 s59, s59, s27
 s_add_u32 m0, s29, 28672
 s_nop 0
 buffer_load_dwordx4 v1, s[4:7], s47 offen  lds
 v_add_u32 v1, 128, v1
 v_add_u32 v2, 0x80000, v2
 s_add_u32 s58, s58, s59
 s_lshl_b32 s59, s27, 24
 s_add_u32 s58, s58, s59
 s_mov_b32 s57, 57344
 s_lshl_b32 s60, s40, 8
 s_add_u32 s60, s60, 0x10000
 s_mov_b32 s34, 0x3db8aa3b
 s_mov_b32 s35, 0x3db8aa3b
 s_add_u32 m0, s29, 98304
 s_nop 0
 buffer_load_dwordx4 v2, s[8:11], 0 offen  lds
 s_mul_i32 s55, s25, 5
 s_lshr_b32 s55, s55, 3
 s_add_u32 s55, s55, 1
 s_cmp_lg_u32 s3, 0
 s_cmov_b32 s55, 64
 v_mov_b32 v15, 1
 s_cmp_ge_u32 s25, 7
 s_cmov_b32 s62, 2.0
 s_add_u32 m0, s29, 32768
 s_nop 0
 buffer_load_dwordx4 v1, s[4:7], 0 offen  lds
 s_lshl_b32 s31, s25, 16
 s_lshl_b32 s32, s26, 9
 s_add_u32 s31, s31, s32
 v_lshrrev_b32 v15, 3, v0
 v_lshlrev_b32 v15, 13, v15
 v_and_b32 v14, 7, v0
 v_lshlrev_b32 v14, 6, v14
 s_add_u32 m0, s29, 102400
 s_nop 0
 buffer_load_dwordx4 v2, s[8:11], s48 offen  lds
 v_add3_u32 v16, v14, v15, s31
 s_lshl_b32 s31, s25, 2
 s_lshr_b32 s32, s2, 6
 s_add_u32 s31, s31, s32
 s_lshl_b32 s31, s31, 17
 v_lshlrev_b32 v17, 11, v0
 v_add_u32 v17, s31, v17
 s_add_u32 m0, s29, 36864
 s_nop 0
 buffer_load_dwordx4 v1, s[4:7], s41 offen  lds
 s_mul_i32 s36, s2, 7282
 s_lshr_b32 s36, s36, 16
 s_mul_i32 s37, s36, 9
 s_sub_u32 s37, s2, s37
 s_lshl_b32 s38, s36, 16
 s_mov_b64 s[30:31], s[80:81]
 s_cmp_eq_u32 s37, 2
 s_cmov_b64 s[30:31], s[76:77]
 s_add_u32 m0, s29, 106496
 s_nop 0
 buffer_load_dwordx4 v2, s[8:11], s49 offen  lds
 s_cmp_eq_u32 s37, 3
 s_cmov_b64 s[30:31], s[66:67]
 s_cmp_eq_u32 s37, 4
 s_cmov_b64 s[30:31], s[68:69]
 s_cmp_eq_u32 s37, 5
 s_cmov_b64 s[30:31], s[86:87]
 s_cmp_eq_u32 s37, 6
 s_cmov_b64 s[30:31], s[86:87]
 s_add_u32 m0, s29, 40960
 s_nop 0
 buffer_load_dwordx4 v1, s[4:7], s42 offen  lds
 s_cmp_eq_u32 s37, 7
 s_cmov_b64 s[30:31], s[72:73]
 s_cmp_eq_u32 s37, 8
 s_cmov_b64 s[30:31], s[64:65]
 s_add_u32 s32, s38, 1835008
 s_cmp_eq_u32 s37, 1
 s_cmov_b32 s38, s32
 s_add_u32 m0, s29, 110592
 s_nop 0
 buffer_load_dwordx4 v2, s[8:11], s50 offen  lds
 s_cmp_eq_u32 s37, 6
 s_cmov_b32 s38, s32
 s_lshl_b32 s32, s39, 15
 s_add_u32 s38, s38, s32
 s_cmp_ge_u32 s37, 9
 s_cmov_b32 s36, 28
 s_cmp_lt_u32 s36, 28
 s_cselect_b32 s32, 0x8000, 0
 s_cselect_b32 s38, s38, 0
 s_add_u32 m0, s29, 45056
 s_nop 0
 buffer_load_dwordx4 v1, s[4:7], s43 offen  lds
 s_add_u32 s36, s30, s38
 s_addc_u32 s37, s31, 0
 s_mov_b32 s38, s32
 s_mov_b32 s39, 0x20000
 v_lshlrev_b32 v14, 6, v0
 s_mov_b32 s56, 0xffffd000
 s_add_u32 m0, s29, 114688
 s_nop 0
 buffer_load_dwordx4 v2, s[8:11], s51 offen  lds
 s_movk_i32 s30, 0x1000
 s_cmp_ge_u32 s3, 2
 s_cbranch_scc1 L_pfset
 s_mov_b32 s38, 0
 s_cmp_eq_u32 s3, 0
 s_cselect_b64 s[36:37], s[8:9], s[4:5]
 s_cselect_b32 s38, s10, s6
 s_movk_i32 s30, 128
 s_cmov_b32 s30, 0x80000
 s_cselect_b64 vcc, -1, 0
 s_lshl_b32 s56, s30, 1
 v_cndmask_b32 v14, v17, v16, vcc
L_pfset:
 s_add_u32 m0, s29, 49152
 s_nop 0
 buffer_load_dwordx4 v1, s[4:7], s44 offen  lds
 v_mov_b32 v15, 1
 v_mov_b32 v3, 0
 s_mov_b32 s61, 0
 s_waitcnt vmcnt(10)
 s_barrier
 ds_read_b64_tr_b16 a[0:1], v6 offset:0
 ds_read_b64_tr_b16 a[2:3], v6 offset:4096
 ds_read_b128 a[64:67], v4 offset:0
 ds_read_b64_tr_b16 a[4:5], v6 offset:16384
 ds_read_b64_tr_b16 a[6:7], v6 offset:20480
 ds_read_b128 a[68:71], v5 offset:0
 ds_read_b128 a[76:79], v5 offset:2048
 ds_read_b128 a[72:75], v4 offset:2048
 ds_read_b128 a[80:83], v4 offset:4096
 ds_read_b128 a[84:87], v5 offset:4096
 ds_read_b128 a[92:95], v5 offset:6144
 ds_read_b128 a[88:91], v4 offset:6144
 ds_read_b64_tr_b16 a[8:9], v7 offset:0
 ds_read_b64_tr_b16 a[10:11], v7 offset:4096
 ds_read_b64_tr_b16 a[12:13], v7 offset:16384
 ds_read_b64_tr_b16 a[14:15], v7 offset:20480
 ds_read_b64_tr_b16 a[16:17], v8 offset:0
 ds_read_b64_tr_b16 a[18:19], v8 offset:4096
 ds_read_b64_tr_b16 a[20:21], v8 offset:16384
 ds_read_b64_tr_b16 a[22:23], v8 offset:20480
 s_cmp_eq_u32 s27, 0
 s_waitcnt lgkmcnt(0)
 s_cbranch_scc0 L_vloop_head
L_kloop_head:
 v_mfma_f32_16x16x32_bf16 v[88:91], a[0:3], a[64:67], 0
 s_add_u32 m0, s29, 118784
 ds_read_b64_tr_b16 a[24:25], v9 offset:0
 v_mfma_f32_16x16x32_bf16 v[88:91], a[4:7], a[68:71], v[88:91]
 ds_read_b64_tr_b16 a[26:27], v9 offset:4096
 buffer_load_dwordx4 v2, s[8:11], s52 offen  lds
 v_mfma_f32_16x16x32_bf16 v[80:83], a[4:7], a[76:79], 0
 ds_read_b64_tr_b16 a[28:29], v9 offset:16384
 v_mfma_f32_16x16x32_bf16 v[80:83], a[0:3], a[72:75], v[80:83]
 ds_read_b64_tr_b16 a[30:31], v9 offset:20480
 v_mfma_f32_16x16x32_bf16 v[72:75], a[0:3], a[80:83], 0
 s_add_u32 m0, s29, 53248
 ds_read_b128 a[96:99], v4 offset:8192
 v_mfma_f32_16x16x32_bf16 v[72:75], a[4:7], a[84:87], v[72:75]
 buffer_load_dwordx4 v1, s[4:7], s45 offen  lds
 v_mfma_f32_16x16x32_bf16 v[64:67], a[4:7], a[92:95], 0
 ds_read_b128 a[100:103], v5 offset:8192
 v_mfma_f32_16x16x32_bf16 v[64:67], a[0:3], a[88:91], v[64:67]
 v_mfma_f32_16x16x32_bf16 v[68:71], a[8:11], a[88:91], 0
 s_add_u32 m0, s29, 122880
 ds_read_b128 a[108:111], v5 offset:10240
 v_mfma_f32_16x16x32_bf16 v[68:71], a[12:15], a[92:95], v[68:71]
 buffer_load_dwordx4 v2, s[8:11], s53 offen  lds
 v_mfma_f32_16x16x32_bf16 v[76:79], a[12:15], a[84:87], 0
 ds_read_b128 a[104:107], v4 offset:10240
 v_mfma_f32_16x16x32_bf16 v[76:79], a[8:11], a[80:83], v[76:79]
 v_mfma_f32_16x16x32_bf16 v[84:87], a[8:11], a[72:75], 0
 s_add_u32 m0, s29, 57344
 ds_read_b128 a[112:115], v4 offset:12288
 v_mfma_f32_16x16x32_bf16 v[84:87], a[12:15], a[76:79], v[84:87]
 buffer_load_dwordx4 v1, s[4:7], s46 offen  lds
 v_mfma_f32_16x16x32_bf16 v[92:95], a[12:15], a[68:71], 0
 ds_read_b128 a[116:119], v5 offset:12288
 v_mfma_f32_16x16x32_bf16 v[92:95], a[8:11], a[64:67], v[92:95]
 v_mfma_f32_16x16x32_bf16 v[120:123], a[16:19], a[64:67], 0
 s_add_u32 m0, s29, 126976
 ds_read_b128 a[124:127], v5 offset:14336
 v_mfma_f32_16x16x32_bf16 v[120:123], a[20:23], a[68:71], v[120:123]
 buffer_load_dwordx4 v2, s[8:11], s54 offen  lds
 v_mfma_f32_16x16x32_bf16 v[112:115], a[20:23], a[76:79], 0
 ds_read_b128 a[120:123], v4 offset:14336
 v_mfma_f32_16x16x32_bf16 v[112:115], a[16:19], a[72:75], v[112:115]
 v_mfma_f32_16x16x32_bf16 v[104:107], a[16:19], a[80:83], 0
 s_add_u32 m0, s29, 61440
 ds_read_b64_tr_b16 a[32:33], v10 offset:0
 v_mfma_f32_16x16x32_bf16 v[104:107], a[20:23], a[84:87], v[104:107]
 ds_read_b64_tr_b16 a[34:35], v10 offset:4096
 buffer_load_dwordx4 v1, s[4:7], s47 offen  lds
 v_mfma_f32_16x16x32_bf16 v[96:99], a[20:23], a[92:95], 0
 ds_read_b64_tr_b16 a[36:37], v10 offset:16384
 v_add_u32 v1, 128, v1
 v_mfma_f32_16x16x32_bf16 v[96:99], a[16:19], a[88:91], v[96:99]
 s_waitcnt lgkmcnt(8)
 ds_read_b64_tr_b16 a[38:39], v10 offset:20480
 v_add_u32 v2, 0x80000, v2
 v_mfma_f32_16x16x32_bf16 v[100:103], a[24:27], a[88:91], 0
 ds_read_b64_tr_b16 a[40:41], v11 offset:0
 v_mfma_f32_16x16x32_bf16 v[100:103], a[28:31], a[92:95], v[100:103]
 ds_read_b64_tr_b16 a[42:43], v11 offset:4096
 v_mfma_f32_16x16x32_bf16 v[108:111], a[28:31], a[84:87], 0
 ds_read_b64_tr_b16 a[44:45], v11 offset:16384
 v_mfma_f32_16x16x32_bf16 v[108:111], a[24:27], a[80:83], v[108:111]
 ds_read_b64_tr_b16 a[46:47], v11 offset:20480
 v_mfma_f32_16x16x32_bf16 v[116:119], a[24:27], a[72:75], 0
 ds_read_b64_tr_b16 a[48:49], v12 offset:0
 v_mfma_f32_16x16x32_bf16 v[116:119], a[28:31], a[76:79], v[116:119]
 ds_read_b64_tr_b16 a[50:51], v12 offset:4096
 v_mfma_f32_16x16x32_bf16 v[124:127], a[28:31], a[68:71], 0
 ds_read_b64_tr_b16 a[52:53], v12 offset:16384
 v_mfma_f32_16x16x32_bf16 v[124:127], a[24:27], a[64:67], v[124:127]
 ds_read_b64_tr_b16 a[54:55], v12 offset:20480
 v_mfma_f32_16x16x32_bf16 a[232:235], a[0:3], a[96:99], 0
 ds_read_b64_tr_b16 a[56:57], v13 offset:0
 v_mfma_f32_16x16x32_bf16 a[232:235], a[4:7], a[100:103], a[232:235]
 ds_read_b64_tr_b16 a[58:59], v13 offset:4096
 v_mfma_f32_16x16x32_bf16 a[224:227], a[4:7], a[108:111], 0
 s_waitcnt lgkmcnt(8)
 ds_read_b64_tr_b16 a[60:61], v13 offset:16384
 v_mfma_f32_16x16x32_bf16 a[224:227], a[0:3], a[104:107], a[224:227]
 ds_read_b64_tr_b16 a[62:63], v13 offset:20480
 v_mfma_f32_16x16x32_bf16 v[24:27], a[0:3], a[112:115], 0
 v_mfma_f32_16x16x32_bf16 v[24:27], a[4:7], a[116:119], v[24:27]
 v_mfma_f32_16x16x32_bf16 v[16:19], a[4:7], a[124:127], 0
 v_mfma_f32_16x16x32_bf16 v[16:19], a[0:3], a[120:123], v[16:19]
 s_waitcnt lgkmcnt(0)
 v_mfma_f32_16x16x32_bf16 v[20:23], a[8:11], a[120:123], 0
 s_barrier
 v_mfma_f32_16x16x32_bf16 v[20:23], a[12:15], a[124:127], v[20:23]
 s_add_u32 m0, s29, 65536
 v_mfma_f32_16x16x32_bf16 v[28:31], a[12:15], a[116:119], 0
 buffer_load_dwordx4 v2, s[8:11], 0 offen  lds
 v_mfma_f32_16x16x32_bf16 v[28:31], a[8:11], a[112:115], v[28:31]
 v_mfma_f32_16x16x32_bf16 a[228:231], a[8:11], a[104:107], 0
 v_mfma_f32_16x16x32_bf16 a[228:231], a[12:15], a[108:111], a[228:231]
 v_mfma_f32_16x16x32_bf16 a[236:239], a[12:15], a[100:103], 0
 s_add_u32 m0, s29, 0
 v_mfma_f32_16x16x32_bf16 a[236:239], a[8:11], a[96:99], a[236:239]
 buffer_load_dwordx4 v1, s[4:7], 0 offen  lds
 v_mfma_f32_16x16x32_bf16 v[56:59], a[16:19], a[96:99], 0
 v_mfma_f32_16x16x32_bf16 v[56:59], a[20:23], a[100:103], v[56:59]
 v_mfma_f32_16x16x32_bf16 v[48:51], a[20:23], a[108:111], 0
 v_mfma_f32_16x16x32_bf16 v[48:51], a[16:19], a[104:107], v[48:51]
 s_add_u32 m0, s29, 69632
 v_mfma_f32_16x16x32_bf16 v[40:43], a[16:19], a[112:115], 0
 buffer_load_dwordx4 v2, s[8:11], s48 offen  lds
 v_mfma_f32_16x16x32_bf16 v[40:43], a[20:23], a[116:119], v[40:43]
 v_mfma_f32_16x16x32_bf16 v[32:35], a[20:23], a[124:127], 0
 v_mfma_f32_16x16x32_bf16 v[32:35], a[16:19], a[120:123], v[32:35]
 v_mfma_f32_16x16x32_bf16 v[36:39], a[24:27], a[120:123], 0
 s_add_u32 m0, s29, 4096
 v_mfma_f32_16x16x32_bf16 v[36:39], a[28:31], a[124:127], v[36:39]
 buffer_load_dwordx4 v1, s[4:7], s41 offen  lds
 v_mfma_f32_16x16x32_bf16 v[44:47], a[28:31], a[116:119], 0
 v_mfma_f32_16x16x32_bf16 v[44:47], a[24:27], a[112:115], v[44:47]
 v_mfma_f32_16x16x32_bf16 v[52:55], a[24:27], a[104:107], 0
 v_mfma_f32_16x16x32_bf16 v[52:55], a[28:31], a[108:111], v[52:55]
 s_add_u32 m0, s29, 73728
 v_mfma_f32_16x16x32_bf16 v[60:63], a[28:31], a[100:103], 0
 buffer_load_dwordx4 v2, s[8:11], s49 offen  lds
 v_mfma_f32_16x16x32_bf16 v[60:63], a[24:27], a[96:99], v[60:63]
 v_mfma_f32_16x16x32_bf16 v[216:219], a[32:35], a[96:99], 0
 v_mfma_f32_16x16x32_bf16 v[216:219], a[36:39], a[100:103], v[216:219]
 v_mfma_f32_16x16x32_bf16 v[208:211], a[36:39], a[108:111], 0
 s_add_u32 m0, s29, 8192
 v_mfma_f32_16x16x32_bf16 v[208:211], a[32:35], a[104:107], v[208:211]
 buffer_load_dwordx4 v1, s[4:7], s42 offen  lds
 v_mfma_f32_16x16x32_bf16 v[200:203], a[32:35], a[112:115], 0
 v_mfma_f32_16x16x32_bf16 v[200:203], a[36:39], a[116:119], v[200:203]
 v_mfma_f32_16x16x32_bf16 v[192:195], a[36:39], a[124:127], 0
 v_mfma_f32_16x16x32_bf16 v[192:195], a[32:35], a[120:123], v[192:195]
 s_add_u32 m0, s29, 77824
 v_mfma_f32_16x16x32_bf16 v[196:199], a[40:43], a[120:123], 0
 buffer_load_dwordx4 v2, s[8:11], s50 offen  lds
 v_mfma_f32_16x16x32_bf16 v[196:199], a[44:47], a[124:127], v[196:199]
 v_mfma_f32_16x16x32_bf16 v[204:207], a[44:47], a[116:119], 0
 v_mfma_f32_16x16x32_bf16 v[204:207], a[40:43], a[112:115], v[204:207]
 v_mfma_f32_16x16x32_bf16 v[212:215], a[40:43], a[104:107], 0
 s_add_u32 m0, s29, 12288
 v_mfma_f32_16x16x32_bf16 v[212:215], a[44:47], a[108:111], v[212:215]
 buffer_load_dwordx4 v1, s[4:7], s43 offen  lds
 v_mfma_f32_16x16x32_bf16 v[220:223], a[44:47], a[100:103], 0
 v_mfma_f32_16x16x32_bf16 v[220:223], a[40:43], a[96:99], v[220:223]
 v_mfma_f32_16x16x32_bf16 v[248:251], a[48:51], a[96:99], 0
 v_mfma_f32_16x16x32_bf16 v[248:251], a[52:55], a[100:103], v[248:251]
 s_add_u32 m0, s29, 81920
 v_mfma_f32_16x16x32_bf16 v[240:243], a[52:55], a[108:111], 0
 buffer_load_dwordx4 v2, s[8:11], s51 offen  lds
 v_mfma_f32_16x16x32_bf16 v[240:243], a[48:51], a[104:107], v[240:243]
 v_mfma_f32_16x16x32_bf16 v[232:235], a[48:51], a[112:115], 0
 v_mfma_f32_16x16x32_bf16 v[232:235], a[52:55], a[116:119], v[232:235]
 v_mfma_f32_16x16x32_bf16 v[224:227], a[52:55], a[124:127], 0
 s_add_u32 m0, s29, 16384
 v_mfma_f32_16x16x32_bf16 v[224:227], a[48:51], a[120:123], v[224:227]
 buffer_load_dwordx4 v1, s[4:7], s44 offen  lds
 v_mfma_f32_16x16x32_bf16 v[228:231], a[56:59], a[120:123], 0
 v_mfma_f32_16x16x32_bf16 v[228:231], a[60:63], a[124:127], v[228:231]
 v_mfma_f32_16x16x32_bf16 v[236:239], a[60:63], a[116:119], 0
 v_mfma_f32_16x16x32_bf16 v[236:239], a[56:59], a[112:115], v[236:239]
 s_add_u32 m0, s29, 86016
 v_mfma_f32_16x16x32_bf16 v[244:247], a[56:59], a[104:107], 0
 s_waitcnt vmcnt(10)
 buffer_load_dwordx4 v2, s[8:11], s52 offen  lds
 v_mfma_f32_16x16x32_bf16 v[244:247], a[60:63], a[108:111], v[244:247]
 s_barrier
 ds_read_b64_tr_b16 a[0:1], v6 offset:32768
 v_mfma_f32_16x16x32_bf16 v[252:255], a[60:63], a[100:103], 0
 ds_read_b64_tr_b16 a[2:3], v6 offset:36864
 v_mfma_f32_16x16x32_bf16 v[252:255], a[56:59], a[96:99], v[252:255]
 ds_read_b128 a[96:99], v4 offset:40960
 v_mfma_f32_16x16x32_bf16 v[152:155], a[32:35], a[64:67], 0
 s_add_u32 m0, s29, 20480
 v_mfma_f32_16x16x32_bf16 v[152:155], a[36:39], a[68:71], v[152:155]
 buffer_load_dwordx4 v1, s[4:7], s45 offen  lds
 v_mfma_f32_16x16x32_bf16 v[144:147], a[36:39], a[76:79], 0
 ds_read_b64_tr_b16 a[4:5], v6 offset:49152
 v_mfma_f32_16x16x32_bf16 v[144:147], a[32:35], a[72:75], v[144:147]
 ds_read_b64_tr_b16 a[6:7], v6 offset:53248
 v_mfma_f32_16x16x32_bf16 v[136:139], a[32:35], a[80:83], 0
 ds_read_b128 a[100:103], v5 offset:40960
 v_mfma_f32_16x16x32_bf16 v[136:139], a[36:39], a[84:87], v[136:139]
 s_add_u32 m0, s29, 90112
 v_mfma_f32_16x16x32_bf16 v[128:131], a[36:39], a[92:95], 0
 buffer_load_dwordx4 v2, s[8:11], s53 offen  lds
 v_mfma_f32_16x16x32_bf16 v[128:131], a[32:35], a[88:91], v[128:131]
 ds_read_b128 a[108:111], v5 offset:43008
 v_mfma_f32_16x16x32_bf16 v[132:135], a[40:43], a[88:91], 0
 v_mfma_f32_16x16x32_bf16 v[132:135], a[44:47], a[92:95], v[132:135]
 ds_read_b128 a[104:107], v4 offset:43008
 v_mfma_f32_16x16x32_bf16 v[140:143], a[44:47], a[84:87], 0
 s_add_u32 m0, s29, 24576
 v_mfma_f32_16x16x32_bf16 v[140:143], a[40:43], a[80:83], v[140:143]
 buffer_load_dwordx4 v1, s[4:7], s46 offen  lds
 v_mfma_f32_16x16x32_bf16 v[148:151], a[40:43], a[72:75], 0
 ds_read_b128 a[112:115], v4 offset:45056
 v_mfma_f32_16x16x32_bf16 v[148:151], a[44:47], a[76:79], v[148:151]
 v_mfma_f32_16x16x32_bf16 v[156:159], a[44:47], a[68:71], 0
 ds_read_b128 a[116:119], v5 offset:45056
 v_mfma_f32_16x16x32_bf16 v[156:159], a[40:43], a[64:67], v[156:159]
 s_add_u32 m0, s29, 94208
 v_mfma_f32_16x16x32_bf16 v[184:187], a[48:51], a[64:67], 0
 buffer_load_dwordx4 v2, s[8:11], s54 offen  lds
 v_mfma_f32_16x16x32_bf16 v[184:187], a[52:55], a[68:71], v[184:187]
 ds_read_b128 a[124:127], v5 offset:47104
 v_mfma_f32_16x16x32_bf16 v[176:179], a[52:55], a[76:79], 0
 v_mfma_f32_16x16x32_bf16 v[176:179], a[48:51], a[72:75], v[176:179]
 ds_read_b128 a[120:123], v4 offset:47104
 v_mfma_f32_16x16x32_bf16 v[168:171], a[48:51], a[80:83], 0
 s_add_u32 m0, s29, 28672
 v_mfma_f32_16x16x32_bf16 v[168:171], a[52:55], a[84:87], v[168:171]
 buffer_load_dwordx4 v1, s[4:7], s47 offen  lds
 v_mfma_f32_16x16x32_bf16 v[160:163], a[52:55], a[92:95], 0
 v_mfma_f32_16x16x32_bf16 v[160:163], a[48:51], a[88:91], v[160:163]
 ds_read_b64_tr_b16 a[8:9], v7 offset:32768
 v_mfma_f32_16x16x32_bf16 v[164:167], a[56:59], a[88:91], 0
 v_mfma_f32_16x16x32_bf16 v[164:167], a[60:63], a[92:95], v[164:167]
 ds_read_b64_tr_b16 a[10:11], v7 offset:36864
 v_mfma_f32_16x16x32_bf16 v[172:175], a[60:63], a[84:87], 0
 ds_read_b64_tr_b16 a[12:13], v7 offset:49152
 v_mfma_f32_16x16x32_bf16 v[172:175], a[56:59], a[80:83], v[172:175]
 ds_read_b64_tr_b16 a[14:15], v7 offset:53248
 v_mfma_f32_16x16x32_bf16 v[180:183], a[56:59], a[72:75], 0
 ds_read_b64_tr_b16 a[16:17], v8 offset:32768
 v_mfma_f32_16x16x32_bf16 v[180:183], a[60:63], a[76:79], v[180:183]
 ds_read_b64_tr_b16 a[18:19], v8 offset:36864
 v_mfma_f32_16x16x32_bf16 v[188:191], a[60:63], a[68:71], 0
 ds_read_b64_tr_b16 a[20:21], v8 offset:49152
 v_mfma_f32_16x16x32_bf16 v[188:191], a[56:59], a[64:67], v[188:191]
 s_waitcnt lgkmcnt(8)
 ds_read_b64_tr_b16 a[22:23], v8 offset:53248
 v_add_u32 v1, 128, v1
 v_add_u32 v2, 0x80000, v2
 s_add_u32 s56, s56, s30
 buffer_load_dword a243, v14, s[36:39], s56 offen
 s_add_u32 s56, s56, s30
 buffer_load_dword a243, v14, s[36:39], s56 offen
 s_add_u32 s56, s56, s30
 s_branch L_kloop_mid
.p2align 6
L_kloop:
 v_mfma_f32_16x16x32_bf16 v[88:91], a[0:3], a[64:67], v[88:91]
 ds_read_b64_tr_b16 a[24:25], v9 offset:0
 v_mfma_f32_16x16x32_bf16 v[88:91], a[4:7], a[68:71], v[88:91]
 ds_read_b64_tr_b16 a[26:27], v9 offset:4096
 v_mfma_f32_16x16x32_bf16 v[80:83], a[4:7], a[76:79], v[80:83]
 ds_read_b64_tr_b16 a[28:29], v9 offset:16384
 v_mfma_f32_16x16x32_bf16 v[80:83], a[0:3], a[72:75], v[80:83]
 ds_read_b64_tr_b16 a[30:31], v9 offset:20480
 v_mfma_f32_16x16x32_bf16 v[72:75], a[0:3], a[80:83], v[72:75]
 ds_read_b128 a[96:99], v4 offset:8192
 v_mfma_f32_16x16x32_bf16 v[72:75], a[4:7], a[84:87], v[72:75]
 s_cmp_eq_u32 s61, s55
 s_cbranch_scc1 L_kloop_side
L_kloop_back:
 v_mfma_f32_16x16x32_bf16 v[64:67], a[4:7], a[92:95], v[64:67]
 s_waitcnt lgkmcnt(8)
 ds_read_b128 a[100:103], v5 offset:8192
 v_mfma_f32_16x16x32_bf16 v[64:67], a[0:3], a[88:91], v[64:67]
 v_mfma_f32_16x16x32_bf16 v[68:71], a[8:11], a[88:91], v[68:71]
 ds_read_b128 a[108:111], v5 offset:10240
 v_mfma_f32_16x16x32_bf16 v[68:71], a[12:15], a[92:95], v[68:71]
 v_mfma_f32_16x16x32_bf16 v[76:79], a[12:15], a[84:87], v[76:79]
 ds_read_b128 a[104:107], v4 offset:10240
 v_mfma_f32_16x16x32_bf16 v[76:79], a[8:11], a[80:83], v[76:79]
 v_mfma_f32_16x16x32_bf16 v[84:87], a[8:11], a[72:75], v[84:87]
 ds_read_b128 a[112:115], v4 offset:12288
 v_mfma_f32_16x16x32_bf16 v[84:87], a[12:15], a[76:79], v[84:87]
 v_mfma_f32_16x16x32_bf16 v[92:95], a[12:15], a[68:71], v[92:95]
 ds_read_b128 a[116:119], v5 offset:12288
 v_mfma_f32_16x16x32_bf16 v[92:95], a[8:11], a[64:67], v[92:95]
 s_waitcnt lgkmcnt(8)
 v_mfma_f32_16x16x32_bf16 v[120:123], a[16:19], a[64:67], v[120:123]
 ds_read_b128 a[124:127], v5 offset:14336
 v_mfma_f32_16x16x32_bf16 v[120:123], a[20:23], a[68:71], v[120:123]
 v_mfma_f32_16x16x32_bf16 v[112:115], a[20:23], a[76:79], v[112:115]
 ds_read_b128 a[120:123], v4 offset:14336
 v_mfma_f32_16x16x32_bf16 v[112:115], a[16:19], a[72:75], v[112:115]
 v_mfma_f32_16x16x32_bf16 v[104:107], a[16:19], a[80:83], v[104:107]
 ds_read_b64_tr_b16 a[32:33], v10 offset:0
 v_mfma_f32_16x16x32_bf16 v[104:107], a[20:23], a[84:87], v[104:107]
 ds_read_b64_tr_b16 a[34:35], v10 offset:4096
 v_mfma_f32_16x16x32_bf16 v[96:99], a[20:23], a[92:95], v[96:99]
 ds_read_b64_tr_b16 a[36:37], v10 offset:16384
 v_mfma_f32_16x16x32_bf16 v[96:99], a[16:19], a[88:91], v[96:99]
 ds_read_b64_tr_b16 a[38:39], v10 offset:20480
 v_mfma_f32_16x16x32_bf16 v[100:103], a[24:27], a[88:91], v[100:103]
 s_waitcnt lgkmcnt(8)
 ds_read_b64_tr_b16 a[40:41], v11 offset:0
 v_mfma_f32_16x16x32_bf16 v[100:103], a[28:31], a[92:95], v[100:103]
 ds_read_b64_tr_b16 a[42:43], v11 offset:4096
 v_mfma_f32_16x16x32_bf16 v[108:111], a[28:31], a[84:87], v[108:111]
 ds_read_b64_tr_b16 a[44:45], v11 offset:16384
 v_mfma_f32_16x16x32_bf16 v[108:111], a[24:27], a[80:83], v[108:111]
 ds_read_b64_tr_b16 a[46:47], v11 offset:20480
 v_mfma_f32_16x16x32_bf16 v[116:119], a[24:27], a[72:75], v[116:119]
 ds_read_b64_tr_b16 a[48:49], v12 offset:0
 v_mfma_f32_16x16x32_bf16 v[116:119], a[28:31], a[76:79], v[116:119]
 ds_read_b64_tr_b16 a[50:51], v12 offset:4096
 v_mfma_f32_16x16x32_bf16 v[124:127], a[28:31], a[68:71], v[124:127]
 ds_read_b64_tr_b16 a[52:53], v12 offset:16384
 v_mfma_f32_16x16x32_bf16 v[124:127], a[24:27], a[64:67], v[124:127]
 ds_read_b64_tr_b16 a[54:55], v12 offset:20480
 v_mfma_f32_16x16x32_bf16 a[232:235], a[0:3], a[96:99], a[232:235]
 ds_read_b64_tr_b16 a[56:57], v13 offset:0
 v_mfma_f32_16x16x32_bf16 a[232:235], a[4:7], a[100:103], a[232:235]
 ds_read_b64_tr_b16 a[58:59], v13 offset:4096
 v_mfma_f32_16x16x32_bf16 a[224:227], a[4:7], a[108:111], a[224:227]
 ds_read_b64_tr_b16 a[60:61], v13 offset:16384
 v_mfma_f32_16x16x32_bf16 a[224:227], a[0:3], a[104:107], a[224:227]
 s_waitcnt lgkmcnt(8)
 ds_read_b64_tr_b16 a[62:63], v13 offset:20480
 v_mfma_f32_16x16x32_bf16 v[24:27], a[0:3], a[112:115], v[24:27]
 v_mfma_f32_16x16x32_bf16 v[24:27], a[4:7], a[116:119], v[24:27]
 v_mfma_f32_16x16x32_bf16 v[16:19], a[4:7], a[124:127], v[16:19]
 v_mfma_f32_16x16x32_bf16 v[16:19], a[0:3], a[120:123], v[16:19]
 s_waitcnt lgkmcnt(0)
 v_mfma_f32_16x16x32_bf16 v[20:23], a[8:11], a[120:123], v[20:23]
 s_barrier
 v_mfma_f32_16x16x32_bf16 v[20:23], a[12:15], a[124:127], v[20:23]
 s_add_u32 m0, s29, 65536
 v_mfma_f32_16x16x32_bf16 v[28:31], a[12:15], a[116:119], v[28:31]
 buffer_load_dwordx4 v2, s[8:11], 0 offen  lds
 v_mfma_f32_16x16x32_bf16 v[28:31], a[8:11], a[112:115], v[28:31]
 v_mfma_f32_16x16x32_bf16 a[228:231], a[8:11], a[104:107], a[228:231]
 v_mfma_f32_16x16x32_bf16 a[228:231], a[12:15], a[108:111], a[228:231]
 v_mfma_f32_16x16x32_bf16 a[236:239], a[12:15], a[100:103], a[236:239]
 s_add_u32 m0, s29, 0
 v_mfma_f32_16x16x32_bf16 a[236:239], a[8:11], a[96:99], a[236:239]
 buffer_load_dwordx4 v1, s[4:7], 0 offen  lds
 v_mfma_f32_16x16x32_bf16 v[56:59], a[16:19], a[96:99], v[56:59]
 v_mfma_f32_16x16x32_bf16 v[56:59], a[20:23], a[100:103], v[56:59]
 v_mfma_f32_16x16x32_bf16 v[48:51], a[20:23], a[108:111], v[48:51]
 v_mfma_f32_16x16x32_bf16 v[48:51], a[16:19], a[104:107], v[48:51]
 s_add_u32 m0, s29, 69632
 v_mfma_f32_16x16x32_bf16 v[40:43], a[16:19], a[112:115], v[40:43]
 buffer_load_dwordx4 v2, s[8:11], s48 offen  lds
 v_mfma_f32_16x16x32_bf16 v[40:43], a[20:23], a[116:119], v[40:43]
 v_mfma_f32_16x16x32_bf16 v[32:35], a[20:23], a[124:127], v[32:35]
 v_mfma_f32_16x16x32_bf16 v[32:35], a[16:19], a[120:123], v[32:35]
 v_mfma_f32_16x16x32_bf16 v[36:39], a[24:27], a[120:123], v[36:39]
 s_add_u32 m0, s29, 4096
 v_mfma_f32_16x16x32_bf16 v[36:39], a[28:31], a[124:127], v[36:39]
 buffer_load_dwordx4 v1, s[4:7], s41 offen  lds
 v_mfma_f32_16x16x32_bf16 v[44:47], a[28:31], a[116:119], v[44:47]
 v_mfma_f32_16x16x32_bf16 v[44:47], a[24:27], a[112:115], v[44:47]
 v_mfma_f32_16x16x32_bf16 v[52:55], a[24:27], a[104:107], v[52:55]
 v_mfma_f32_16x16x32_bf16 v[52:55], a[28:31], a[108:111], v[52:55]
 s_add_u32 m0, s29, 73728
 v_mfma_f32_16x16x32_bf16 v[60:63], a[28:31], a[100:103], v[60:63]
 buffer_load_dwordx4 v2, s[8:11], s49 offen  lds
 v_mfma_f32_16x16x32_bf16 v[60:63], a[24:27], a[96:99], v[60:63]
 v_mfma_f32_16x16x32_bf16 v[216:219], a[32:35], a[96:99], v[216:219]
 v_mfma_f32_16x16x32_bf16 v[216:219], a[36:39], a[100:103], v[216:219]
 v_mfma_f32_16x16x32_bf16 v[208:211], a[36:39], a[108:111], v[208:211]
 s_add_u32 m0, s29, 8192
 v_mfma_f32_16x16x32_bf16 v[208:211], a[32:35], a[104:107], v[208:211]
 buffer_load_dwordx4 v1, s[4:7], s42 offen  lds
 v_mfma_f32_16x16x32_bf16 v[200:203], a[32:35], a[112:115], v[200:203]
 v_mfma_f32_16x16x32_bf16 v[200:203], a[36:39], a[116:119], v[200:203]
 v_mfma_f32_16x16x32_bf16 v[192:195], a[36:39], a[124:127], v[192:195]
 v_mfma_f32_16x16x32_bf16 v[192:195], a[32:35], a[120:123], v[192:195]
 s_add_u32 m0, s29, 77824
 v_mfma_f32_16x16x32_bf16 v[196:199], a[40:43], a[120:123], v[196:199]
 buffer_load_dwordx4 v2, s[8:11], s50 offen  lds
 v_mfma_f32_16x16x32_bf16 v[196:199], a[44:47], a[124:127], v[196:199]
 v_mfma_f32_16x16x32_bf16 v[204:207], a[44:47], a[116:119], v[204:207]
 v_mfma_f32_16x16x32_bf16 v[204:207], a[40:43], a[112:115], v[204:207]
 v_mfma_f32_16x16x32_bf16 v[212:215], a[40:43], a[104:107], v[212:215]
 s_add_u32 m0, s29, 12288
 v_mfma_f32_16x16x32_bf16 v[212:215], a[44:47], a[108:111], v[212:215]
 buffer_load_dwordx4 v1, s[4:7], s43 offen  lds
 v_mfma_f32_16x16x32_bf16 v[220:223], a[44:47], a[100:103], v[220:223]
 v_mfma_f32_16x16x32_bf16 v[220:223], a[40:43], a[96:99], v[220:223]
 v_mfma_f32_16x16x32_bf16 v[248:251], a[48:51], a[96:99], v[248:251]
 v_mfma_f32_16x16x32_bf16 v[248:251], a[52:55], a[100:103], v[248:251]
 s_add_u32 m0, s29, 81920
 v_mfma_f32_16x16x32_bf16 v[240:243], a[52:55], a[108:111], v[240:243]
 buffer_load_dwordx4 v2, s[8:11], s51 offen  lds
 v_mfma_f32_16x16x32_bf16 v[240:243], a[48:51], a[104:107], v[240:243]
 v_mfma_f32_16x16x32_bf16 v[232:235], a[48:51], a[112:115], v[232:235]
 v_mfma_f32_16x16x32_bf16 v[232:235], a[52:55], a[116:119], v[232:235]
 v_mfma_f32_16x16x32_bf16 v[224:227], a[52:55], a[124:127], v[224:227]
 s_add_u32 m0, s29, 16384
 v_mfma_f32_16x16x32_bf16 v[224:227], a[48:51], a[120:123], v[224:227]
 buffer_load_dwordx4 v1, s[4:7], s44 offen  lds
 v_mfma_f32_16x16x32_bf16 v[228:231], a[56:59], a[120:123], v[228:231]
 v_mfma_f32_16x16x32_bf16 v[228:231], a[60:63], a[124:127], v[228:231]
 v_mfma_f32_16x16x32_bf16 v[236:239], a[60:63], a[116:119], v[236:239]
 v_mfma_f32_16x16x32_bf16 v[236:239], a[56:59], a[112:115], v[236:239]
 s_add_u32 m0, s29, 86016
 v_mfma_f32_16x16x32_bf16 v[244:247], a[56:59], a[104:107], v[244:247]
 s_waitcnt vmcnt(11)
 buffer_load_dwordx4 v2, s[8:11], s52 offen  lds
 v_mfma_f32_16x16x32_bf16 v[244:247], a[60:63], a[108:111], v[244:247]
 s_barrier
 ds_read_b64_tr_b16 a[0:1], v6 offset:32768
 v_mfma_f32_16x16x32_bf16 v[252:255], a[60:63], a[100:103], v[252:255]
 ds_read_b64_tr_b16 a[2:3], v6 offset:36864
 v_mfma_f32_16x16x32_bf16 v[252:255], a[56:59], a[96:99], v[252:255]
 ds_read_b128 a[96:99], v4 offset:40960
 v_mfma_f32_16x16x32_bf16 v[152:155], a[32:35], a[64:67], v[152:155]
 s_add_u32 m0, s29, 20480
 v_mfma_f32_16x16x32_bf16 v[152:155], a[36:39], a[68:71], v[152:155]
 buffer_load_dwordx4 v1, s[4:7], s45 offen  lds
 v_mfma_f32_16x16x32_bf16 v[144:147], a[36:39], a[76:79], v[144:147]
 ds_read_b64_tr_b16 a[4:5], v6 offset:49152
 v_mfma_f32_16x16x32_bf16 v[144:147], a[32:35], a[72:75], v[144:147]
 ds_read_b64_tr_b16 a[6:7], v6 offset:53248
 v_mfma_f32_16x16x32_bf16 v[136:139], a[32:35], a[80:83], v[136:139]
 ds_read_b128 a[100:103], v5 offset:40960
 v_mfma_f32_16x16x32_bf16 v[136:139], a[36:39], a[84:87], v[136:139]
 s_add_u32 m0, s29, 90112
 v_mfma_f32_16x16x32_bf16 v[128:131], a[36:39], a[92:95], v[128:131]
 buffer_load_dwordx4 v2, s[8:11], s53 offen  lds
 v_mfma_f32_16x16x32_bf16 v[128:131], a[32:35], a[88:91], v[128:131]
 ds_read_b128 a[108:111], v5 offset:43008
 v_mfma_f32_16x16x32_bf16 v[132:135], a[40:43], a[88:91], v[132:135]
 v_mfma_f32_16x16x32_bf16 v[132:135], a[44:47], a[92:95], v[132:135]
 ds_read_b128 a[104:107], v4 offset:43008
 v_mfma_f32_16x16x32_bf16 v[140:143], a[44:47], a[84:87], v[140:143]
 s_add_u32 m0, s29, 24576
 v_mfma_f32_16x16x32_bf16 v[140:143], a[40:43], a[80:83], v[140:143]
 buffer_load_dwordx4 v1, s[4:7], s46 offen  lds
 v_mfma_f32_16x16x32_bf16 v[148:151], a[40:43], a[72:75], v[148:151]
 ds_read_b128 a[112:115], v4 offset:45056
 v_mfma_f32_16x16x32_bf16 v[148:151], a[44:47], a[76:79], v[148:151]
 v_mfma_f32_16x16x32_bf16 v[156:159], a[44:47], a[68:71], v[156:159]
 ds_read_b128 a[116:119], v5 offset:45056
 v_mfma_f32_16x16x32_bf16 v[156:159], a[40:43], a[64:67], v[156:159]
 s_add_u32 m0, s29, 94208
 v_mfma_f32_16x16x32_bf16 v[184:187], a[48:51], a[64:67], v[184:187]
 buffer_load_dwordx4 v2, s[8:11], s54 offen  lds
 v_mfma_f32_16x16x32_bf16 v[184:187], a[52:55], a[68:71], v[184:187]
 ds_read_b128 a[124:127], v5 offset:47104
 v_mfma_f32_16x16x32_bf16 v[176:179], a[52:55], a[76:79], v[176:179]
 v_mfma_f32_16x16x32_bf16 v[176:179], a[48:51], a[72:75], v[176:179]
 ds_read_b128 a[120:123], v4 offset:47104
 v_mfma_f32_16x16x32_bf16 v[168:171], a[48:51], a[80:83], v[168:171]
 s_add_u32 m0, s29, 28672
 v_mfma_f32_16x16x32_bf16 v[168:171], a[52:55], a[84:87], v[168:171]
 buffer_load_dwordx4 v1, s[4:7], s47 offen  lds
 v_mfma_f32_16x16x32_bf16 v[160:163], a[52:55], a[92:95], v[160:163]
 v_add_u32 v1, 128, v1
 v_add_u32 v2, 0x80000, v2
 v_mfma_f32_16x16x32_bf16 v[160:163], a[48:51], a[88:91], v[160:163]
 ds_read_b64_tr_b16 a[8:9], v7 offset:32768
 v_mfma_f32_16x16x32_bf16 v[164:167], a[56:59], a[88:91], v[164:167]
 buffer_load_dword a243, v14, s[36:39], s56 offen
 v_mfma_f32_16x16x32_bf16 v[164:167], a[60:63], a[92:95], v[164:167]
 s_add_u32 s56, s56, s30
 ds_read_b64_tr_b16 a[10:11], v7 offset:36864
 v_mfma_f32_16x16x32_bf16 v[172:175], a[60:63], a[84:87], v[172:175]
 ds_read_b64_tr_b16 a[12:13], v7 offset:49152
 v_mfma_f32_16x16x32_bf16 v[172:175], a[56:59], a[80:83], v[172:175]
 ds_read_b64_tr_b16 a[14:15], v7 offset:53248
 v_mfma_f32_16x16x32_bf16 v[180:183], a[56:59], a[72:75], v[180:183]
 ds_read_b64_tr_b16 a[16:17], v8 offset:32768
 v_mfma_f32_16x16x32_bf16 v[180:183], a[60:63], a[76:79], v[180:183]
 ds_read_b64_tr_b16 a[18:19], v8 offset:36864
 v_mfma_f32_16x16x32_bf16 v[188:191], a[60:63], a[68:71], v[188:191]
 ds_read_b64_tr_b16 a[20:21], v8 offset:49152
 v_mfma_f32_16x16x32_bf16 v[188:191], a[56:59], a[64:67], v[188:191]
 s_waitcnt lgkmcnt(8)
 ds_read_b64_tr_b16 a[22:23], v8 offset:53248
L_kloop_mid:
 v_mfma_f32_16x16x32_bf16 a[232:235], a[0:3], a[96:99], a[232:235]
 ds_read_b64_tr_b16 a[24:25], v9 offset:32768
 v_mfma_f32_16x16x32_bf16 a[232:235], a[4:7], a[100:103], a[232:235]
 ds_read_b64_tr_b16 a[26:27], v9 offset:36864
 v_mfma_f32_16x16x32_bf16 a[224:227], a[4:7], a[108:111], a[224:227]
 ds_read_b64_tr_b16 a[28:29], v9 offset:49152
 v_mfma_f32_16x16x32_bf16 a[224:227], a[0:3], a[104:107], a[224:227]
 ds_read_b64_tr_b16 a[30:31], v9 offset:53248
 v_mfma_f32_16x16x32_bf16 v[24:27], a[0:3], a[112:115], v[24:27]
 ds_read_b128 a[64:67], v4 offset:32768
 v_mfma_f32_16x16x32_bf16 v[24:27], a[4:7], a[116:119], v[24:27]
 v_mfma_f32_16x16x32_bf16 v[16:19], a[4:7], a[124:127], v[16:19]
 s_waitcnt lgkmcnt(8)
 ds_read_b128 a[68:71], v5 offset:32768
 v_mfma_f32_16x16x32_bf16 v[16:19], a[0:3], a[120:123], v[16:19]
 v_mfma_f32_16x16x32_bf16 v[20:23], a[8:11], a[120:123], v[20:23]
 ds_read_b128 a[76:79], v5 offset:34816
 v_mfma_f32_16x16x32_bf16 v[20:23], a[12:15], a[124:127], v[20:23]
 v_mfma_f32_16x16x32_bf16 v[28:31], a[12:15], a[116:119], v[28:31]
 ds_read_b128 a[72:75], v4 offset:34816
 v_mfma_f32_16x16x32_bf16 v[28:31], a[8:11], a[112:115], v[28:31]
 v_mfma_f32_16x16x32_bf16 a[228:231], a[8:11], a[104:107], a[228:231]
 ds_read_b128 a[80:83], v4 offset:36864
 v_mfma_f32_16x16x32_bf16 a[228:231], a[12:15], a[108:111], a[228:231]
 v_mfma_f32_16x16x32_bf16 a[236:239], a[12:15], a[100:103], a[236:239]
 ds_read_b128 a[84:87], v5 offset:36864
 v_mfma_f32_16x16x32_bf16 a[236:239], a[8:11], a[96:99], a[236:239]
 s_waitcnt lgkmcnt(8)
 v_mfma_f32_16x16x32_bf16 v[56:59], a[16:19], a[96:99], v[56:59]
 ds_read_b128 a[92:95], v5 offset:38912
 v_mfma_f32_16x16x32_bf16 v[56:59], a[20:23], a[100:103], v[56:59]
 v_mfma_f32_16x16x32_bf16 v[48:51], a[20:23], a[108:111], v[48:51]
 ds_read_b128 a[88:91], v4 offset:38912
 v_mfma_f32_16x16x32_bf16 v[48:51], a[16:19], a[104:107], v[48:51]
 v_mfma_f32_16x16x32_bf16 v[40:43], a[16:19], a[112:115], v[40:43]
 ds_read_b64_tr_b16 a[32:33], v10 offset:32768
 v_mfma_f32_16x16x32_bf16 v[40:43], a[20:23], a[116:119], v[40:43]
 ds_read_b64_tr_b16 a[34:35], v10 offset:36864
 v_mfma_f32_16x16x32_bf16 v[32:35], a[20:23], a[124:127], v[32:35]
 ds_read_b64_tr_b16 a[36:37], v10 offset:49152
 v_mfma_f32_16x16x32_bf16 v[32:35], a[16:19], a[120:123], v[32:35]
 ds_read_b64_tr_b16 a[38:39], v10 offset:53248
 v_mfma_f32_16x16x32_bf16 v[36:39], a[24:27], a[120:123], v[36:39]
 s_waitcnt lgkmcnt(8)
 ds_read_b64_tr_b16 a[40:41], v11 offset:32768
 v_mfma_f32_16x16x32_bf16 v[36:39], a[28:31], a[124:127], v[36:39]
 ds_read_b64_tr_b16 a[42:43], v11 offset:36864
 v_mfma_f32_16x16x32_bf16 v[44:47], a[28:31], a[116:119], v[44:47]
 ds_read_b64_tr_b16 a[44:45], v11 offset:49152
 v_mfma_f32_16x16x32_bf16 v[44:47], a[24:27], a[112:115], v[44:47]
 ds_read_b64_tr_b16 a[46:47], v11 offset:53248
 v_mfma_f32_16x16x32_bf16 v[52:55], a[24:27], a[104:107], v[52:55]
 ds_read_b64_tr_b16 a[48:49], v12 offset:32768
 v_mfma_f32_16x16x32_bf16 v[52:55], a[28:31], a[108:111], v[52:55]
 ds_read_b64_tr_b16 a[50:51], v12 offset:36864
 v_mfma_f32_16x16x32_bf16 v[60:63], a[28:31], a[100:103], v[60:63]
 ds_read_b64_tr_b16 a[52:53], v12 offset:49152
 v_mfma_f32_16x16x32_bf16 v[60:63], a[24:27], a[96:99], v[60:63]
 ds_read_b64_tr_b16 a[54:55], v12 offset:53248
 v_mfma_f32_16x16x32_bf16 v[88:91], a[0:3], a[64:67], v[88:91]
 ds_read_b64_tr_b16 a[56:57], v13 offset:32768
 v_mfma_f32_16x16x32_bf16 v[88:91], a[4:7], a[68:71], v[88:91]
 ds_read_b64_tr_b16 a[58:59], v13 offset:36864
 v_mfma_f32_16x16x32_bf16 v[80:83], a[4:7], a[76:79], v[80:83]
 ds_read_b64_tr_b16 a[60:61], v13 offset:49152
 v_mfma_f32_16x16x32_bf16 v[80:83], a[0:3], a[72:75], v[80:83]
 s_waitcnt lgkmcnt(8)
 ds_read_b64_tr_b16 a[62:63], v13 offset:53248
 v_mfma_f32_16x16x32_bf16 v[72:75], a[0:3], a[80:83], v[72:75]
 v_mfma_f32_16x16x32_bf16 v[72:75], a[4:7], a[84:87], v[72:75]
 v_mfma_f32_16x16x32_bf16 v[64:67], a[4:7], a[92:95], v[64:67]
 v_mfma_f32_16x16x32_bf16 v[64:67], a[0:3], a[88:91], v[64:67]
 s_waitcnt lgkmcnt(0)
 v_mfma_f32_16x16x32_bf16 v[68:71], a[8:11], a[88:91], v[68:71]
 s_barrier
 v_mfma_f32_16x16x32_bf16 v[68:71], a[12:15], a[92:95], v[68:71]
 s_add_u32 m0, s29, 98304
 v_mfma_f32_16x16x32_bf16 v[76:79], a[12:15], a[84:87], v[76:79]
 buffer_load_dwordx4 v2, s[8:11], 0 offen  lds
 v_mfma_f32_16x16x32_bf16 v[76:79], a[8:11], a[80:83], v[76:79]
 v_mfma_f32_16x16x32_bf16 v[84:87], a[8:11], a[72:75], v[84:87]
 v_mfma_f32_16x16x32_bf16 v[84:87], a[12:15], a[76:79], v[84:87]
 v_mfma_f32_16x16x32_bf16 v[92:95], a[12:15], a[68:71], v[92:95]
 s_add_u32 m0, s29, 32768
 v_mfma_f32_16x16x32_bf16 v[92:95], a[8:11], a[64:67], v[92:95]
 buffer_load_dwordx4 v1, s[4:7], 0 offen  lds
 v_mfma_f32_16x16x32_bf16 v[120:123], a[16:19], a[64:67], v[120:123]
 v_mfma_f32_16x16x32_bf16 v[120:123], a[20:23], a[68:71], v[120:123]
 v_mfma_f32_16x16x32_bf16 v[112:115], a[20:23], a[76:79], v[112:115]
 v_mfma_f32_16x16x32_bf16 v[112:115], a[16:19], a[72:75], v[112:115]
 s_add_u32 m0, s29, 102400
 v_mfma_f32_16x16x32_bf16 v[104:107], a[16:19], a[80:83], v[104:107]
 buffer_load_dwordx4 v2, s[8:11], s48 offen  lds
 v_mfma_f32_16x16x32_bf16 v[104:107], a[20:23], a[84:87], v[104:107]
 v_mfma_f32_16x16x32_bf16 v[96:99], a[20:23], a[92:95], v[96:99]
 v_mfma_f32_16x16x32_bf16 v[96:99], a[16:19], a[88:91], v[96:99]
 v_mfma_f32_16x16x32_bf16 v[100:103], a[24:27], a[88:91], v[100:103]
 s_add_u32 m0, s29, 36864
 v_mfma_f32_16x16x32_bf16 v[100:103], a[28:31], a[92:95], v[100:103]
 buffer_load_dwordx4 v1, s[4:7], s41 offen  lds
 v_mfma_f32_16x16x32_bf16 v[108:111], a[28:31], a[84:87], v[108:111]
 v_mfma_f32_16x16x32_bf16 v[108:111], a[24:27], a[80:83], v[108:111]
 v_mfma_f32_16x16x32_bf16 v[116:119], a[24:27], a[72:75], v[116:119]
 v_mfma_f32_16x16x32_bf16 v[116:119], a[28:31], a[76:79], v[116:119]
 s_add_u32 m0, s29, 106496
 v_mfma_f32_16x16x32_bf16 v[124:127], a[28:31], a[68:71], v[124:127]
 buffer_load_dwordx4 v2, s[8:11], s49 offen  lds
 v_mfma_f32_16x16x32_bf16 v[124:127], a[24:27], a[64:67], v[124:127]
 v_mfma_f32_16x16x32_bf16 v[152:155], a[32:35], a[64:67], v[152:155]
 v_mfma_f32_16x16x32_bf16 v[152:155], a[36:39], a[68:71], v[152:155]
 v_mfma_f32_16x16x32_bf16 v[144:147], a[36:39], a[76:79], v[144:147]
 s_add_u32 m0, s29, 40960
 v_mfma_f32_16x16x32_bf16 v[144:147], a[32:35], a[72:75], v[144:147]
 buffer_load_dwordx4 v1, s[4:7], s42 offen  lds
 v_mfma_f32_16x16x32_bf16 v[136:139], a[32:35], a[80:83], v[136:139]
 v_mfma_f32_16x16x32_bf16 v[136:139], a[36:39], a[84:87], v[136:139]
 v_mfma_f32_16x16x32_bf16 v[128:131], a[36:39], a[92:95], v[128:131]
 v_mfma_f32_16x16x32_bf16 v[128:131], a[32:35], a[88:91], v[128:131]
 s_add_u32 m0, s29, 110592
 v_mfma_f32_16x16x32_bf16 v[132:135], a[40:43], a[88:91], v[132:135]
 buffer_load_dwordx4 v2, s[8:11], s50 offen  lds
 v_mfma_f32_16x16x32_bf16 v[132:135], a[44:47], a[92:95], v[132:135]
 v_mfma_f32_16x16x32_bf16 v[140:143], a[44:47], a[84:87], v[140:143]
 v_mfma_f32_16x16x32_bf16 v[140:143], a[40:43], a[80:83], v[140:143]
 v_mfma_f32_16x16x32_bf16 v[148:151], a[40:43], a[72:75], v[148:151]
 s_add_u32 m0, s29, 45056
 v_mfma_f32_16x16x32_bf16 v[148:151], a[44:47], a[76:79], v[148:151]
 buffer_load_dwordx4 v1, s[4:7], s43 offen  lds
 v_mfma_f32_16x16x32_bf16 v[156:159], a[44:47], a[68:71], v[156:159]
 v_mfma_f32_16x16x32_bf16 v[156:159], a[40:43], a[64:67], v[156:159]
 v_mfma_f32_16x16x32_bf16 v[184:187], a[48:51], a[64:67], v[184:187]
 v_mfma_f32_16x16x32_bf16 v[184:187], a[52:55], a[68:71], v[184:187]
 s_add_u32 m0, s29, 114688
 v_mfma_f32_16x16x32_bf16 v[176:179], a[52:55], a[76:79], v[176:179]
 buffer_load_dwordx4 v2, s[8:11], s51 offen  lds
 v_mfma_f32_16x16x32_bf16 v[176:179], a[48:51], a[72:75], v[176:179]
 v_mfma_f32_16x16x32_bf16 v[168:171], a[48:51], a[80:83], v[168:171]
 v_mfma_f32_16x16x32_bf16 v[168:171], a[52:55], a[84:87], v[168:171]
 v_mfma_f32_16x16x32_bf16 v[160:163], a[52:55], a[92:95], v[160:163]
 s_add_u32 m0, s29, 49152
 v_mfma_f32_16x16x32_bf16 v[160:163], a[48:51], a[88:91], v[160:163]
 buffer_load_dwordx4 v1, s[4:7], s44 offen  lds
 v_mfma_f32_16x16x32_bf16 v[164:167], a[56:59], a[88:91], v[164:167]
 v_mfma_f32_16x16x32_bf16 v[164:167], a[60:63], a[92:95], v[164:167]
 v_mfma_f32_16x16x32_bf16 v[172:175], a[60:63], a[84:87], v[172:175]
 v_mfma_f32_16x16x32_bf16 v[172:175], a[56:59], a[80:83], v[172:175]
 s_add_u32 m0, s29, 118784
 v_mfma_f32_16x16x32_bf16 v[180:183], a[56:59], a[72:75], v[180:183]
 s_waitcnt vmcnt(11)
 buffer_load_dwordx4 v2, s[8:11], s52 offen  lds
 v_mfma_f32_16x16x32_bf16 v[180:183], a[60:63], a[76:79], v[180:183]
 s_barrier
 ds_read_b64_tr_b16 a[0:1], v6 offset:0
 v_mfma_f32_16x16x32_bf16 v[188:191], a[60:63], a[68:71], v[188:191]
 ds_read_b64_tr_b16 a[2:3], v6 offset:4096
 v_mfma_f32_16x16x32_bf16 v[188:191], a[56:59], a[64:67], v[188:191]
 ds_read_b128 a[64:67], v4 offset:0
 v_mfma_f32_16x16x32_bf16 v[216:219], a[32:35], a[96:99], v[216:219]
 s_add_u32 m0, s29, 53248
 v_mfma_f32_16x16x32_bf16 v[216:219], a[36:39], a[100:103], v[216:219]
 buffer_load_dwordx4 v1, s[4:7], s45 offen  lds
 v_mfma_f32_16x16x32_bf16 v[208:211], a[36:39], a[108:111], v[208:211]
 ds_read_b64_tr_b16 a[4:5], v6 offset:16384
 v_mfma_f32_16x16x32_bf16 v[208:211], a[32:35], a[104:107], v[208:211]
 ds_read_b64_tr_b16 a[6:7], v6 offset:20480
 v_mfma_f32_16x16x32_bf16 v[200:203], a[32:35], a[112:115], v[200:203]
 ds_read_b128 a[68:71], v5 offset:0
 v_mfma_f32_16x16x32_bf16 v[200:203], a[36:39], a[116:119], v[200:203]
 s_add_u32 m0, s29, 122880
 v_mfma_f32_16x16x32_bf16 v[192:195], a[36:39], a[124:127], v[192:195]
 buffer_load_dwordx4 v2, s[8:11], s53 offen  lds
 v_mfma_f32_16x16x32_bf16 v[192:195], a[32:35], a[120:123], v[192:195]
 ds_read_b128 a[76:79], v5 offset:2048
 v_mfma_f32_16x16x32_bf16 v[196:199], a[40:43], a[120:123], v[196:199]
 v_mfma_f32_16x16x32_bf16 v[196:199], a[44:47], a[124:127], v[196:199]
 ds_read_b128 a[72:75], v4 offset:2048
 v_mfma_f32_16x16x32_bf16 v[204:207], a[44:47], a[116:119], v[204:207]
 s_add_u32 m0, s29, 57344
 v_mfma_f32_16x16x32_bf16 v[204:207], a[40:43], a[112:115], v[204:207]
 buffer_load_dwordx4 v1, s[4:7], s46 offen  lds
 v_mfma_f32_16x16x32_bf16 v[212:215], a[40:43], a[104:107], v[212:215]
 ds_read_b128 a[80:83], v4 offset:4096
 v_mfma_f32_16x16x32_bf16 v[212:215], a[44:47], a[108:111], v[212:215]
 v_mfma_f32_16x16x32_bf16 v[220:223], a[44:47], a[100:103], v[220:223]
 ds_read_b128 a[84:87], v5 offset:4096
 v_mfma_f32_16x16x32_bf16 v[220:223], a[40:43], a[96:99], v[220:223]
 s_add_u32 m0, s29, 126976
 v_mfma_f32_16x16x32_bf16 v[248:251], a[48:51], a[96:99], v[248:251]
 buffer_load_dwordx4 v2, s[8:11], s54 offen  lds
 v_mfma_f32_16x16x32_bf16 v[248:251], a[52:55], a[100:103], v[248:251]
 ds_read_b128 a[92:95], v5 offset:6144
 v_mfma_f32_16x16x32_bf16 v[240:243], a[52:55], a[108:111], v[240:243]
 v_mfma_f32_16x16x32_bf16 v[240:243], a[48:51], a[104:107], v[240:243]
 ds_read_b128 a[88:91], v4 offset:6144
 v_mfma_f32_16x16x32_bf16 v[232:235], a[48:51], a[112:115], v[232:235]
 s_add_u32 m0, s29, 61440
 v_mfma_f32_16x16x32_bf16 v[232:235], a[52:55], a[116:119], v[232:235]
 buffer_load_dwordx4 v1, s[4:7], s47 offen  lds
 v_mfma_f32_16x16x32_bf16 v[224:227], a[52:55], a[124:127], v[224:227]
 v_add_u32 v1, 128, v1
 v_add_u32 v2, 0x80000, v2
 v_mfma_f32_16x16x32_bf16 v[224:227], a[48:51], a[120:123], v[224:227]
 ds_read_b64_tr_b16 a[8:9], v7 offset:0
 v_mfma_f32_16x16x32_bf16 v[228:231], a[56:59], a[120:123], v[228:231]
 buffer_load_dword a243, v14, s[36:39], s56 offen
 v_mfma_f32_16x16x32_bf16 v[228:231], a[60:63], a[124:127], v[228:231]
 s_add_u32 s56, s56, s30
 ds_read_b64_tr_b16 a[10:11], v7 offset:4096
 v_mfma_f32_16x16x32_bf16 v[236:239], a[60:63], a[116:119], v[236:239]
 ds_read_b64_tr_b16 a[12:13], v7 offset:16384
 v_mfma_f32_16x16x32_bf16 v[236:239], a[56:59], a[112:115], v[236:239]
 ds_read_b64_tr_b16 a[14:15], v7 offset:20480
 v_mfma_f32_16x16x32_bf16 v[244:247], a[56:59], a[104:107], v[244:247]
 ds_read_b64_tr_b16 a[16:17], v8 offset:0
 v_mfma_f32_16x16x32_bf16 v[244:247], a[60:63], a[108:111], v[244:247]
 ds_read_b64_tr_b16 a[18:19], v8 offset:4096
 v_mfma_f32_16x16x32_bf16 v[252:255], a[60:63], a[100:103], v[252:255]
 s_add_u32 s61, s61, 1
 ds_read_b64_tr_b16 a[20:21], v8 offset:16384
 v_mfma_f32_16x16x32_bf16 v[252:255], a[56:59], a[96:99], v[252:255]
 s_waitcnt lgkmcnt(8)
 ds_read_b64_tr_b16 a[22:23], v8 offset:20480
 s_cmp_lt_u32 s61, 6
 s_cbranch_scc1 L_kloop
 v_mfma_f32_16x16x32_bf16 v[88:91], a[0:3], a[64:67], v[88:91]
 ds_read_b64_tr_b16 a[24:25], v9 offset:0
 v_accvgpr_read_b32 v15, a240
 v_mfma_f32_16x16x32_bf16 v[88:91], a[4:7], a[68:71], v[88:91]
 ds_read_b64_tr_b16 a[26:27], v9 offset:4096
 v_accvgpr_read_b32 v14, a244
 v_mfma_f32_16x16x32_bf16 v[80:83], a[4:7], a[76:79], v[80:83]
 s_waitcnt lgkmcnt(12)
 ds_read_b64_tr_b16 a[28:29], v9 offset:16384
 global_load_dword a243, v14, s[100:101]
 v_mfma_f32_16x16x32_bf16 v[80:83], a[0:3], a[72:75], v[80:83]
 ds_read_b64_tr_b16 a[30:31], v9 offset:20480
 v_accvgpr_read_b32 v14, a242
 v_mfma_f32_16x16x32_bf16 v[72:75], a[0:3], a[80:83], v[72:75]
 s_add_u32 m0, s33, 0x0
 ds_read_b128 a[96:99], v4 offset:8192
 v_xor_b32 v3, 64, v14
 v_mfma_f32_16x16x32_bf16 v[72:75], a[4:7], a[84:87], v[72:75]
 s_waitcnt lgkmcnt(11)
 v_mfma_f32_16x16x32_bf16 v[64:67], a[4:7], a[92:95], v[64:67]
 ds_read_b128 a[100:103], v5 offset:8192
 buffer_load_dwordx4 v15, s[20:23], 0 offen offset:0 lds
 v_mfma_f32_16x16x32_bf16 v[64:67], a[0:3], a[88:91], v[64:67]
 v_mfma_f32_16x16x32_bf16 v[68:71], a[8:11], a[88:91], v[68:71]
 s_waitcnt lgkmcnt(10)
 ds_read_b128 a[108:111], v5 offset:10240
 v_mfma_f32_16x16x32_bf16 v[68:71], a[12:15], a[92:95], v[68:71]
 s_add_u32 m0, s33, 0x80
 v_mfma_f32_16x16x32_bf16 v[76:79], a[12:15], a[84:87], v[76:79]
 ds_read_b128 a[104:107], v4 offset:10240
 buffer_load_dwordx4 v15, s[20:23], 0 offen offset:896 lds
 v_mfma_f32_16x16x32_bf16 v[76:79], a[8:11], a[80:83], v[76:79]
 v_mfma_f32_16x16x32_bf16 v[84:87], a[8:11], a[72:75], v[84:87]
 ds_read_b128 a[112:115], v4 offset:12288
 v_mfma_f32_16x16x32_bf16 v[84:87], a[12:15], a[76:79], v[84:87]
 s_add_u32 m0, s33, 0x800
 v_mfma_f32_16x16x32_bf16 v[92:95], a[12:15], a[68:71], v[92:95]
 ds_read_b128 a[116:119], v5 offset:12288
 buffer_load_dwordx4 v15, s[20:23], s57 offen offset:0 lds
 v_mfma_f32_16x16x32_bf16 v[92:95], a[8:11], a[64:67], v[92:95]
 s_waitcnt lgkmcnt(10)
 v_mfma_f32_16x16x32_bf16 v[120:123], a[16:19], a[64:67], v[120:123]
 ds_read_b128 a[124:127], v5 offset:14336
 v_mfma_f32_16x16x32_bf16 v[120:123], a[20:23], a[68:71], v[120:123]
 s_add_u32 m0, s33, 0x880
 v_mfma_f32_16x16x32_bf16 v[112:115], a[20:23], a[76:79], v[112:115]
 ds_read_b128 a[120:123], v4 offset:14336
 buffer_load_dwordx4 v15, s[20:23], s57 offen offset:896 lds
 v_mfma_f32_16x16x32_bf16 v[112:115], a[16:19], a[72:75], v[112:115]
 v_mfma_f32_16x16x32_bf16 v[104:107], a[16:19], a[80:83], v[104:107]
 ds_read_b64_tr_b16 a[32:33], v10 offset:0
 v_mfma_f32_16x16x32_bf16 v[104:107], a[20:23], a[84:87], v[104:107]
 s_add_u32 m0, s33, 0xf80
 ds_read_b64_tr_b16 a[34:35], v10 offset:4096
 v_mfma_f32_16x16x32_bf16 v[96:99], a[20:23], a[92:95], v[96:99]
 ds_read_b64_tr_b16 a[36:37], v10 offset:16384
 buffer_load_dwordx4 v15, s[20:23], 0 offen offset:128 lds
 v_mfma_f32_16x16x32_bf16 v[96:99], a[16:19], a[88:91], v[96:99]
 s_waitcnt lgkmcnt(11)
 ds_read_b64_tr_b16 a[38:39], v10 offset:20480
 v_mfma_f32_16x16x32_bf16 v[100:103], a[24:27], a[88:91], v[100:103]
 ds_read_b64_tr_b16 a[40:41], v11 offset:0
 v_mfma_f32_16x16x32_bf16 v[100:103], a[28:31], a[92:95], v[100:103]
 s_add_u32 m0, s33, 0x1000
 ds_read_b64_tr_b16 a[42:43], v11 offset:4096
 v_mfma_f32_16x16x32_bf16 v[108:111], a[28:31], a[84:87], v[108:111]
 ds_read_b64_tr_b16 a[44:45], v11 offset:16384
 buffer_load_dwordx4 v15, s[20:23], 0 offen offset:1024 lds
 v_mfma_f32_16x16x32_bf16 v[108:111], a[24:27], a[80:83], v[108:111]
 ds_read_b64_tr_b16 a[46:47], v11 offset:20480
 v_mfma_f32_16x16x32_bf16 v[116:119], a[24:27], a[72:75], v[116:119]
 ds_read_b64_tr_b16 a[48:49], v12 offset:0
 v_mfma_f32_16x16x32_bf16 v[116:119], a[28:31], a[76:79], v[116:119]
 s_add_u32 m0, s33, 0x1780
 ds_read_b64_tr_b16 a[50:51], v12 offset:4096
 v_mfma_f32_16x16x32_bf16 v[124:127], a[28:31], a[68:71], v[124:127]
 ds_read_b64_tr_b16 a[52:53], v12 offset:16384
 buffer_load_dwordx4 v15, s[20:23], s57 offen offset:128 lds
 v_mfma_f32_16x16x32_bf16 v[124:127], a[24:27], a[64:67], v[124:127]
 s_waitcnt lgkmcnt(15)
 ds_read_b64_tr_b16 a[54:55], v12 offset:20480
 v_mfma_f32_16x16x32_bf16 a[232:235], a[0:3], a[96:99], a[232:235]
 ds_read_b64_tr_b16 a[56:57], v13 offset:0
 v_mfma_f32_16x16x32_bf16 a[232:235], a[4:7], a[100:103], a[232:235]
 s_add_u32 m0, s33, 0x1800
 ds_read_b64_tr_b16 a[58:59], v13 offset:4096
 v_mfma_f32_16x16x32_bf16 a[224:227], a[4:7], a[108:111], a[224:227]
 ds_read_b64_tr_b16 a[60:61], v13 offset:16384
 buffer_load_dwordx4 v15, s[20:23], s57 offen offset:1024 lds
 v_mfma_f32_16x16x32_bf16 a[224:227], a[0:3], a[104:107], a[224:227]
 s_waitcnt lgkmcnt(15)
 ds_read_b64_tr_b16 a[62:63], v13 offset:20480
 v_mfma_f32_16x16x32_bf16 v[24:27], a[0:3], a[112:115], v[24:27]
 v_mfma_f32_16x16x32_bf16 v[24:27], a[4:7], a[116:119], v[24:27]
 v_mfma_f32_16x16x32_bf16 v[16:19], a[4:7], a[124:127], v[16:19]
 v_mfma_f32_16x16x32_bf16 v[16:19], a[0:3], a[120:123], v[16:19]
 s_waitcnt lgkmcnt(0)
 v_mfma_f32_16x16x32_bf16 v[20:23], a[8:11], a[120:123], v[20:23]
 s_barrier
 v_mfma_f32_16x16x32_bf16 v[20:23], a[12:15], a[124:127], v[20:23]
 s_add_u32 m0, s29, 65536
 v_mfma_f32_16x16x32_bf16 v[28:31], a[12:15], a[116:119], v[28:31]
 buffer_load_dwordx4 v2, s[8:11], 0 offen  lds
 v_mfma_f32_16x16x32_bf16 v[28:31], a[8:11], a[112:115], v[28:31]
 v_mfma_f32_16x16x32_bf16 a[228:231], a[8:11], a[104:107], a[228:231]
 v_mfma_f32_16x16x32_bf16 a[228:231], a[12:15], a[108:111], a[228:231]
 v_mfma_f32_16x16x32_bf16 a[236:239], a[12:15], a[100:103], a[236:239]
 s_add_u32 m0, s29, 0
 v_mfma_f32_16x16x32_bf16 a[236:239], a[8:11], a[96:99], a[236:239]
 buffer_load_dwordx4 v1, s[4:7], 0 offen  lds
 v_mfma_f32_16x16x32_bf16 v[56:59], a[16:19], a[96:99], v[56:59]
 v_mfma_f32_16x16x32_bf16 v[56:59], a[20:23], a[100:103], v[56:59]
 v_mfma_f32_16x16x32_bf16 v[48:51], a[20:23], a[108:111], v[48:51]
 v_mfma_f32_16x16x32_bf16 v[48:51], a[16:19], a[104:107], v[48:51]
 s_add_u32 m0, s29, 69632
 v_mfma_f32_16x16x32_bf16 v[40:43], a[16:19], a[112:115], v[40:43]
 buffer_load_dwordx4 v2, s[8:11], s48 offen  lds
 v_mfma_f32_16x16x32_bf16 v[40:43], a[20:23], a[116:119], v[40:43]
 v_mfma_f32_16x16x32_bf16 v[32:35], a[20:23], a[124:127], v[32:35]
 v_mfma_f32_16x16x32_bf16 v[32:35], a[16:19], a[120:123], v[32:35]
 v_mfma_f32_16x16x32_bf16 v[36:39], a[24:27], a[120:123], v[36:39]
 s_add_u32 m0, s29, 4096
 v_mfma_f32_16x16x32_bf16 v[36:39], a[28:31], a[124:127], v[36:39]
 buffer_load_dwordx4 v1, s[4:7], s41 offen  lds
 v_mfma_f32_16x16x32_bf16 v[44:47], a[28:31], a[116:119], v[44:47]
 v_mfma_f32_16x16x32_bf16 v[44:47], a[24:27], a[112:115], v[44:47]
 v_mfma_f32_16x16x32_bf16 v[52:55], a[24:27], a[104:107], v[52:55]
 v_mfma_f32_16x16x32_bf16 v[52:55], a[28:31], a[108:111], v[52:55]
 s_add_u32 m0, s29, 73728
 v_mfma_f32_16x16x32_bf16 v[60:63], a[28:31], a[100:103], v[60:63]
 buffer_load_dwordx4 v2, s[8:11], s49 offen  lds
 v_mfma_f32_16x16x32_bf16 v[60:63], a[24:27], a[96:99], v[60:63]
 v_mfma_f32_16x16x32_bf16 v[216:219], a[32:35], a[96:99], v[216:219]
 v_mfma_f32_16x16x32_bf16 v[216:219], a[36:39], a[100:103], v[216:219]
 v_mfma_f32_16x16x32_bf16 v[208:211], a[36:39], a[108:111], v[208:211]
 s_add_u32 m0, s29, 8192
 v_mfma_f32_16x16x32_bf16 v[208:211], a[32:35], a[104:107], v[208:211]
 buffer_load_dwordx4 v1, s[4:7], s42 offen  lds
 v_mfma_f32_16x16x32_bf16 v[200:203], a[32:35], a[112:115], v[200:203]
 v_mfma_f32_16x16x32_bf16 v[200:203], a[36:39], a[116:119], v[200:203]
 v_mfma_f32_16x16x32_bf16 v[192:195], a[36:39], a[124:127], v[192:195]
 v_mfma_f32_16x16x32_bf16 v[192:195], a[32:35], a[120:123], v[192:195]
 s_add_u32 m0, s29, 77824
 v_mfma_f32_16x16x32_bf16 v[196:199], a[40:43], a[120:123], v[196:199]
 buffer_load_dwordx4 v2, s[8:11], s50 offen  lds
 v_mfma_f32_16x16x32_bf16 v[196:199], a[44:47], a[124:127], v[196:199]
 v_mfma_f32_16x16x32_bf16 v[204:207], a[44:47], a[116:119], v[204:207]
 v_mfma_f32_16x16x32_bf16 v[204:207], a[40:43], a[112:115], v[204:207]
 v_mfma_f32_16x16x32_bf16 v[212:215], a[40:43], a[104:107], v[212:215]
 s_add_u32 m0, s29, 12288
 v_mfma_f32_16x16x32_bf16 v[212:215], a[44:47], a[108:111], v[212:215]
 buffer_load_dwordx4 v1, s[4:7], s43 offen  lds
 v_mfma_f32_16x16x32_bf16 v[220:223], a[44:47], a[100:103], v[220:223]
 v_mfma_f32_16x16x32_bf16 v[220:223], a[40:43], a[96:99], v[220:223]
 v_mfma_f32_16x16x32_bf16 v[248:251], a[48:51], a[96:99], v[248:251]
 v_mfma_f32_16x16x32_bf16 v[248:251], a[52:55], a[100:103], v[248:251]
 s_add_u32 m0, s29, 81920
 v_mfma_f32_16x16x32_bf16 v[240:243], a[52:55], a[108:111], v[240:243]
 buffer_load_dwordx4 v2, s[8:11], s51 offen  lds
 v_mfma_f32_16x16x32_bf16 v[240:243], a[48:51], a[104:107], v[240:243]
 v_mfma_f32_16x16x32_bf16 v[232:235], a[48:51], a[112:115], v[232:235]
 v_mfma_f32_16x16x32_bf16 v[232:235], a[52:55], a[116:119], v[232:235]
 v_mfma_f32_16x16x32_bf16 v[224:227], a[52:55], a[124:127], v[224:227]
 s_add_u32 m0, s29, 16384
 v_mfma_f32_16x16x32_bf16 v[224:227], a[48:51], a[120:123], v[224:227]
 buffer_load_dwordx4 v1, s[4:7], s44 offen  lds
 v_mfma_f32_16x16x32_bf16 v[228:231], a[56:59], a[120:123], v[228:231]
 v_mfma_f32_16x16x32_bf16 v[228:231], a[60:63], a[124:127], v[228:231]
 v_mfma_f32_16x16x32_bf16 v[236:239], a[60:63], a[116:119], v[236:239]
 v_mfma_f32_16x16x32_bf16 v[236:239], a[56:59], a[112:115], v[236:239]
 s_add_u32 m0, s29, 86016
 v_mfma_f32_16x16x32_bf16 v[244:247], a[56:59], a[104:107], v[244:247]
 s_waitcnt vmcnt(10)
 buffer_load_dwordx4 v2, s[8:11], s52 offen  lds
 v_mfma_f32_16x16x32_bf16 v[244:247], a[60:63], a[108:111], v[244:247]
 s_barrier
 ds_read_b64_tr_b16 a[0:1], v6 offset:32768
 v_mfma_f32_16x16x32_bf16 v[252:255], a[60:63], a[100:103], v[252:255]
 ds_read_b64_tr_b16 a[2:3], v6 offset:36864
 v_mfma_f32_16x16x32_bf16 v[252:255], a[56:59], a[96:99], v[252:255]
 ds_read_b128 a[96:99], v4 offset:40960
 v_mfma_f32_16x16x32_bf16 v[152:155], a[32:35], a[64:67], v[152:155]
 s_add_u32 m0, s29, 20480
 ds_read_b128 a[128:131], v14 offset:0
 v_mfma_f32_16x16x32_bf16 v[152:155], a[36:39], a[68:71], v[152:155]
 buffer_load_dwordx4 v1, s[4:7], s45 offen  lds
 v_mfma_f32_16x16x32_bf16 v[144:147], a[36:39], a[76:79], v[144:147]
 ds_read_b64_tr_b16 a[4:5], v6 offset:49152
 v_mfma_f32_16x16x32_bf16 v[144:147], a[32:35], a[72:75], v[144:147]
 ds_read_b64_tr_b16 a[6:7], v6 offset:53248
 v_mfma_f32_16x16x32_bf16 v[136:139], a[32:35], a[80:83], v[136:139]
 ds_read_b128 a[100:103], v5 offset:40960
 v_mfma_f32_16x16x32_bf16 v[136:139], a[36:39], a[84:87], v[136:139]
 s_add_u32 m0, s29, 90112
 ds_read_b128 a[136:139], v3 offset:0
 v_mfma_f32_16x16x32_bf16 v[128:131], a[36:39], a[92:95], v[128:131]
 buffer_load_dwordx4 v2, s[8:11], s53 offen  lds
 v_mfma_f32_16x16x32_bf16 v[128:131], a[32:35], a[88:91], v[128:131]
 ds_read_b128 a[108:111], v5 offset:43008
 v_mfma_f32_16x16x32_bf16 v[132:135], a[40:43], a[88:91], v[132:135]
 ds_read_b128 a[132:135], v14 offset:2048
 v_mfma_f32_16x16x32_bf16 v[132:135], a[44:47], a[92:95], v[132:135]
 ds_read_b128 a[104:107], v4 offset:43008
 v_mfma_f32_16x16x32_bf16 v[140:143], a[44:47], a[84:87], v[140:143]
 s_add_u32 m0, s29, 24576
 ds_read_b128 a[140:143], v3 offset:2048
 v_mfma_f32_16x16x32_bf16 v[140:143], a[40:43], a[80:83], v[140:143]
 buffer_load_dwordx4 v1, s[4:7], s46 offen  lds
 v_mfma_f32_16x16x32_bf16 v[148:151], a[40:43], a[72:75], v[148:151]
 ds_read_b128 a[112:115], v4 offset:45056
 v_mfma_f32_16x16x32_bf16 v[148:151], a[44:47], a[76:79], v[148:151]
 ds_read_b128 a[144:147], v14 offset:4096
 v_mfma_f32_16x16x32_bf16 v[156:159], a[44:47], a[68:71], v[156:159]
 ds_read_b128 a[116:119], v5 offset:45056
 v_mfma_f32_16x16x32_bf16 v[156:159], a[40:43], a[64:67], v[156:159]
 s_add_u32 m0, s29, 94208
 ds_read_b128 a[152:155], v3 offset:4096
 v_mfma_f32_16x16x32_bf16 v[184:187], a[48:51], a[64:67], v[184:187]
 buffer_load_dwordx4 v2, s[8:11], s54 offen  lds
 v_mfma_f32_16x16x32_bf16 v[184:187], a[52:55], a[68:71], v[184:187]
 ds_read_b128 a[124:127], v5 offset:47104
 v_mfma_f32_16x16x32_bf16 v[176:179], a[52:55], a[76:79], v[176:179]
 ds_read_b128 a[148:151], v14 offset:6144
 v_mfma_f32_16x16x32_bf16 v[176:179], a[48:51], a[72:75], v[176:179]
 ds_read_b128 a[120:123], v4 offset:47104
 v_mfma_f32_16x16x32_bf16 v[168:171], a[48:51], a[80:83], v[168:171]
 s_add_u32 m0, s29, 28672
 ds_read_b128 a[156:159], v3 offset:6144
 v_mfma_f32_16x16x32_bf16 v[168:171], a[52:55], a[84:87], v[168:171]
 buffer_load_dwordx4 v1, s[4:7], s47 offen  lds
 v_mfma_f32_16x16x32_bf16 v[160:163], a[52:55], a[92:95], v[160:163]
 v_add_u32 v1, 128, v1
 v_add_u32 v2, 0x80000, v2
 v_mfma_f32_16x16x32_bf16 v[160:163], a[48:51], a[88:91], v[160:163]
 ds_read_b64_tr_b16 a[8:9], v7 offset:32768
 v_mfma_f32_16x16x32_bf16 v[164:167], a[56:59], a[88:91], v[164:167]
 v_mfma_f32_16x16x32_bf16 v[164:167], a[60:63], a[92:95], v[164:167]
 ds_read_b64_tr_b16 a[10:11], v7 offset:36864
 v_mfma_f32_16x16x32_bf16 v[172:175], a[60:63], a[84:87], v[172:175]
 ds_read_b64_tr_b16 a[12:13], v7 offset:49152
 v_mfma_f32_16x16x32_bf16 v[172:175], a[56:59], a[80:83], v[172:175]
 ds_read_b64_tr_b16 a[14:15], v7 offset:53248
 v_mfma_f32_16x16x32_bf16 v[180:183], a[56:59], a[72:75], v[180:183]
 ds_read_b64_tr_b16 a[16:17], v8 offset:32768
 v_mfma_f32_16x16x32_bf16 v[180:183], a[60:63], a[76:79], v[180:183]
 ds_read_b64_tr_b16 a[18:19], v8 offset:36864
 v_mfma_f32_16x16x32_bf16 v[188:191], a[60:63], a[68:71], v[188:191]
 ds_read_b64_tr_b16 a[20:21], v8 offset:49152
 v_mfma_f32_16x16x32_bf16 v[188:191], a[56:59], a[64:67], v[188:191]
 s_waitcnt lgkmcnt(15)
 ds_read_b64_tr_b16 a[22:23], v8 offset:53248
 v_mfma_f32_16x16x32_bf16 a[232:235], a[0:3], a[96:99], a[232:235]
 ds_read_b64_tr_b16 a[24:25], v9 offset:32768
 v_mfma_f32_16x16x32_bf16 a[232:235], a[4:7], a[100:103], a[232:235]
 s_add_u32 m0, s33, 0xffffff00
 ds_read_b64_tr_b16 a[26:27], v9 offset:36864
 v_mfma_f32_16x16x32_bf16 a[224:227], a[4:7], a[108:111], a[224:227]
 s_waitcnt lgkmcnt(10)
 ds_read_b64_tr_b16 a[28:29], v9 offset:49152
 v_mfma_f32_16x16x32_bf16 a[224:227], a[0:3], a[104:107], a[224:227]
 ds_read_b64_tr_b16 a[30:31], v9 offset:53248
 buffer_load_dwordx4 v15, s[20:23], 0 offen offset:256 lds
 v_mfma_f32_16x16x32_bf16 v[24:27], a[0:3], a[112:115], v[24:27]
 ds_read_b128 a[64:67], v4 offset:32768
 v_mfma_f32_16x16x32_bf16 v[24:27], a[4:7], a[116:119], v[24:27]
 v_mfma_f32_16x16x32_bf16 v[16:19], a[4:7], a[124:127], v[16:19]
 s_add_u32 m0, s33, 0xffffff80
 ds_read_b128 a[68:71], v5 offset:32768
 v_mfma_f32_16x16x32_bf16 v[16:19], a[0:3], a[120:123], v[16:19]
 s_waitcnt lgkmcnt(10)
 buffer_load_dwordx4 v15, s[20:23], 0 offen offset:1152 lds
 v_mfma_f32_16x16x32_bf16 v[20:23], a[8:11], a[120:123], v[20:23]
 ds_read_b128 a[76:79], v5 offset:34816
 v_mfma_f32_16x16x32_bf16 v[20:23], a[12:15], a[124:127], v[20:23]
 v_mfma_f32_16x16x32_bf16 v[28:31], a[12:15], a[116:119], v[28:31]
 s_add_u32 m0, s33, 0x700
 ds_read_b128 a[72:75], v4 offset:34816
 v_mfma_f32_16x16x32_bf16 v[28:31], a[8:11], a[112:115], v[28:31]
 buffer_load_dwordx4 v15, s[20:23], s57 offen offset:256 lds
 v_mfma_f32_16x16x32_bf16 a[228:231], a[8:11], a[104:107], a[228:231]
 ds_read_b128 a[80:83], v4 offset:36864
 v_mfma_f32_16x16x32_bf16 a[228:231], a[12:15], a[108:111], a[228:231]
 v_mfma_f32_16x16x32_bf16 a[236:239], a[12:15], a[100:103], a[236:239]
 s_add_u32 m0, s33, 0x780
 ds_read_b128 a[84:87], v5 offset:36864
 v_mfma_f32_16x16x32_bf16 a[236:239], a[8:11], a[96:99], a[236:239]
 s_waitcnt lgkmcnt(10)
 buffer_load_dwordx4 v15, s[20:23], s57 offen offset:1152 lds
 v_mfma_f32_16x16x32_bf16 v[56:59], a[16:19], a[96:99], v[56:59]
 ds_read_b128 a[92:95], v5 offset:38912
 v_mfma_f32_16x16x32_bf16 v[56:59], a[20:23], a[100:103], v[56:59]
 v_mfma_f32_16x16x32_bf16 v[48:51], a[20:23], a[108:111], v[48:51]
 s_add_u32 m0, s33, 0xe80
 ds_read_b128 a[88:91], v4 offset:38912
 v_mfma_f32_16x16x32_bf16 v[48:51], a[16:19], a[104:107], v[48:51]
 buffer_load_dwordx4 v15, s[20:23], 0 offen offset:384 lds
 v_mfma_f32_16x16x32_bf16 v[40:43], a[16:19], a[112:115], v[40:43]
 ds_read_b64_tr_b16 a[32:33], v10 offset:32768
 v_mfma_f32_16x16x32_bf16 v[40:43], a[20:23], a[116:119], v[40:43]
 ds_read_b64_tr_b16 a[34:35], v10 offset:36864
 v_mfma_f32_16x16x32_bf16 v[32:35], a[20:23], a[124:127], v[32:35]
 s_add_u32 m0, s33, 0xf00
 ds_read_b64_tr_b16 a[36:37], v10 offset:49152
 v_mfma_f32_16x16x32_bf16 v[32:35], a[16:19], a[120:123], v[32:35]
 s_waitcnt lgkmcnt(11)
 ds_read_b64_tr_b16 a[38:39], v10 offset:53248
 buffer_load_dwordx4 v15, s[20:23], 0 offen offset:1280 lds
 v_mfma_f32_16x16x32_bf16 v[36:39], a[24:27], a[120:123], v[36:39]
 ds_read_b64_tr_b16 a[40:41], v11 offset:32768
 v_mfma_f32_16x16x32_bf16 v[36:39], a[28:31], a[124:127], v[36:39]
 ds_read_b64_tr_b16 a[42:43], v11 offset:36864
 v_mfma_f32_16x16x32_bf16 v[44:47], a[28:31], a[116:119], v[44:47]
 s_add_u32 m0, s33, 0x1680
 ds_read_b64_tr_b16 a[44:45], v11 offset:49152
 v_mfma_f32_16x16x32_bf16 v[44:47], a[24:27], a[112:115], v[44:47]
 ds_read_b64_tr_b16 a[46:47], v11 offset:53248
 buffer_load_dwordx4 v15, s[20:23], s57 offen offset:384 lds
 v_mfma_f32_16x16x32_bf16 v[52:55], a[24:27], a[104:107], v[52:55]
 ds_read_b64_tr_b16 a[48:49], v12 offset:32768
 v_mfma_f32_16x16x32_bf16 v[52:55], a[28:31], a[108:111], v[52:55]
 ds_read_b64_tr_b16 a[50:51], v12 offset:36864
 v_mfma_f32_16x16x32_bf16 v[60:63], a[28:31], a[100:103], v[60:63]
 s_add_u32 m0, s33, 0x1700
 ds_read_b64_tr_b16 a[52:53], v12 offset:49152
 v_mfma_f32_16x16x32_bf16 v[60:63], a[24:27], a[96:99], v[60:63]
 s_waitcnt lgkmcnt(15)
 ds_read_b64_tr_b16 a[54:55], v12 offset:53248
 buffer_load_dwordx4 v15, s[20:23], s57 offen offset:1280 lds
 v_mfma_f32_16x16x32_bf16 v[88:91], a[0:3], a[64:67], v[88:91]
 ds_read_b64_tr_b16 a[56:57], v13 offset:32768
 v_mfma_f32_16x16x32_bf16 v[88:91], a[4:7], a[68:71], v[88:91]
 ds_read_b64_tr_b16 a[58:59], v13 offset:36864
 v_mfma_f32_16x16x32_bf16 v[80:83], a[4:7], a[76:79], v[80:83]
 ds_read_b64_tr_b16 a[60:61], v13 offset:49152
 v_mfma_f32_16x16x32_bf16 v[80:83], a[0:3], a[72:75], v[80:83]
 s_waitcnt lgkmcnt(15)
 ds_read_b64_tr_b16 a[62:63], v13 offset:53248
 v_mfma_f32_16x16x32_bf16 v[72:75], a[0:3], a[80:83], v[72:75]
 v_mfma_f32_16x16x32_bf16 v[72:75], a[4:7], a[84:87], v[72:75]
 v_mfma_f32_16x16x32_bf16 v[64:67], a[4:7], a[92:95], v[64:67]
 v_mfma_f32_16x16x32_bf16 v[64:67], a[0:3], a[88:91], v[64:67]
 s_waitcnt lgkmcnt(0)
 v_mfma_f32_16x16x32_bf16 v[68:71], a[8:11], a[88:91], v[68:71]
 s_barrier
 v_mfma_f32_16x16x32_bf16 v[68:71], a[12:15], a[92:95], v[68:71]
 s_add_u32 m0, s29, 98304
 v_mfma_f32_16x16x32_bf16 v[76:79], a[12:15], a[84:87], v[76:79]
 buffer_load_dwordx4 v2, s[8:11], 0 offen  lds
 v_mfma_f32_16x16x32_bf16 v[76:79], a[8:11], a[80:83], v[76:79]
 v_mfma_f32_16x16x32_bf16 v[84:87], a[8:11], a[72:75], v[84:87]
 v_mfma_f32_16x16x32_bf16 v[84:87], a[12:15], a[76:79], v[84:87]
 v_mfma_f32_16x16x32_bf16 v[92:95], a[12:15], a[68:71], v[92:95]
 s_add_u32 m0, s29, 32768
 v_mfma_f32_16x16x32_bf16 v[92:95], a[8:11], a[64:67], v[92:95]
 buffer_load_dwordx4 v1, s[4:7], 0 offen  lds
 v_mfma_f32_16x16x32_bf16 v[120:123], a[16:19], a[64:67], v[120:123]
 v_mfma_f32_16x16x32_bf16 v[120:123], a[20:23], a[68:71], v[120:123]
 v_mfma_f32_16x16x32_bf16 v[112:115], a[20:23], a[76:79], v[112:115]
 v_mfma_f32_16x16x32_bf16 v[112:115], a[16:19], a[72:75], v[112:115]
 s_add_u32 m0, s29, 102400
 v_mfma_f32_16x16x32_bf16 v[104:107], a[16:19], a[80:83], v[104:107]
 buffer_load_dwordx4 v2, s[8:11], s48 offen  lds
 v_mfma_f32_16x16x32_bf16 v[104:107], a[20:23], a[84:87], v[104:107]
 v_mfma_f32_16x16x32_bf16 v[96:99], a[20:23], a[92:95], v[96:99]
 v_mfma_f32_16x16x32_bf16 v[96:99], a[16:19], a[88:91], v[96:99]
 v_mfma_f32_16x16x32_bf16 v[100:103], a[24:27], a[88:91], v[100:103]
 s_add_u32 m0, s29, 36864
 v_mfma_f32_16x16x32_bf16 v[100:103], a[28:31], a[92:95], v[100:103]
 buffer_load_dwordx4 v1, s[4:7], s41 offen  lds
 v_mfma_f32_16x16x32_bf16 v[108:111], a[28:31], a[84:87], v[108:111]
 v_mfma_f32_16x16x32_bf16 v[108:111], a[24:27], a[80:83], v[108:111]
 v_mfma_f32_16x16x32_bf16 v[116:119], a[24:27], a[72:75], v[116:119]
 v_mfma_f32_16x16x32_bf16 v[116:119], a[28:31], a[76:79], v[116:119]
 s_add_u32 m0, s29, 106496
 v_mfma_f32_16x16x32_bf16 v[124:127], a[28:31], a[68:71], v[124:127]
 buffer_load_dwordx4 v2, s[8:11], s49 offen  lds
 v_mfma_f32_16x16x32_bf16 v[124:127], a[24:27], a[64:67], v[124:127]
 v_mfma_f32_16x16x32_bf16 v[152:155], a[32:35], a[64:67], v[152:155]
 v_mfma_f32_16x16x32_bf16 v[152:155], a[36:39], a[68:71], v[152:155]
 v_mfma_f32_16x16x32_bf16 v[144:147], a[36:39], a[76:79], v[144:147]
 s_add_u32 m0, s29, 40960
 v_mfma_f32_16x16x32_bf16 v[144:147], a[32:35], a[72:75], v[144:147]
 buffer_load_dwordx4 v1, s[4:7], s42 offen  lds
 v_mfma_f32_16x16x32_bf16 v[136:139], a[32:35], a[80:83], v[136:139]
 v_mfma_f32_16x16x32_bf16 v[136:139], a[36:39], a[84:87], v[136:139]
 v_mfma_f32_16x16x32_bf16 v[128:131], a[36:39], a[92:95], v[128:131]
 v_mfma_f32_16x16x32_bf16 v[128:131], a[32:35], a[88:91], v[128:131]
 s_add_u32 m0, s29, 110592
 v_mfma_f32_16x16x32_bf16 v[132:135], a[40:43], a[88:91], v[132:135]
 buffer_load_dwordx4 v2, s[8:11], s50 offen  lds
 v_mfma_f32_16x16x32_bf16 v[132:135], a[44:47], a[92:95], v[132:135]
 v_mfma_f32_16x16x32_bf16 v[140:143], a[44:47], a[84:87], v[140:143]
 v_mfma_f32_16x16x32_bf16 v[140:143], a[40:43], a[80:83], v[140:143]
 v_mfma_f32_16x16x32_bf16 v[148:151], a[40:43], a[72:75], v[148:151]
 s_add_u32 m0, s29, 45056
 v_mfma_f32_16x16x32_bf16 v[148:151], a[44:47], a[76:79], v[148:151]
 buffer_load_dwordx4 v1, s[4:7], s43 offen  lds
 v_mfma_f32_16x16x32_bf16 v[156:159], a[44:47], a[68:71], v[156:159]
 v_mfma_f32_16x16x32_bf16 v[156:159], a[40:43], a[64:67], v[156:159]
 v_mfma_f32_16x16x32_bf16 v[184:187], a[48:51], a[64:67], v[184:187]
 v_mfma_f32_16x16x32_bf16 v[184:187], a[52:55], a[68:71], v[184:187]
 s_add_u32 m0, s29, 114688
 v_mfma_f32_16x16x32_bf16 v[176:179], a[52:55], a[76:79], v[176:179]
 buffer_load_dwordx4 v2, s[8:11], s51 offen  lds
 v_mfma_f32_16x16x32_bf16 v[176:179], a[48:51], a[72:75], v[176:179]
 v_mfma_f32_16x16x32_bf16 v[168:171], a[48:51], a[80:83], v[168:171]
 v_mfma_f32_16x16x32_bf16 v[168:171], a[52:55], a[84:87], v[168:171]
 v_mfma_f32_16x16x32_bf16 v[160:163], a[52:55], a[92:95], v[160:163]
 s_add_u32 m0, s29, 49152
 v_mfma_f32_16x16x32_bf16 v[160:163], a[48:51], a[88:91], v[160:163]
 buffer_load_dwordx4 v1, s[4:7], s44 offen  lds
 v_mfma_f32_16x16x32_bf16 v[164:167], a[56:59], a[88:91], v[164:167]
 v_mfma_f32_16x16x32_bf16 v[164:167], a[60:63], a[92:95], v[164:167]
 v_mfma_f32_16x16x32_bf16 v[172:175], a[60:63], a[84:87], v[172:175]
 v_mfma_f32_16x16x32_bf16 v[172:175], a[56:59], a[80:83], v[172:175]
 s_add_u32 m0, s29, 118784
 v_mfma_f32_16x16x32_bf16 v[180:183], a[56:59], a[72:75], v[180:183]
 s_waitcnt vmcnt(10)
 buffer_load_dwordx4 v2, s[8:11], s52 offen  lds
 v_mfma_f32_16x16x32_bf16 v[180:183], a[60:63], a[76:79], v[180:183]
 s_barrier
 ds_read_b64_tr_b16 a[0:1], v6 offset:0
 v_mfma_f32_16x16x32_bf16 v[188:191], a[60:63], a[68:71], v[188:191]
 ds_read_b64_tr_b16 a[2:3], v6 offset:4096
 v_mfma_f32_16x16x32_bf16 v[188:191], a[56:59], a[64:67], v[188:191]
 ds_read_b128 a[64:67], v4 offset:0
 v_mfma_f32_16x16x32_bf16 v[216:219], a[32:35], a[96:99], v[216:219]
 s_add_u32 m0, s29, 53248
 ds_read_b128 a[160:163], v14 offset:0
 v_mfma_f32_16x16x32_bf16 v[216:219], a[36:39], a[100:103], v[216:219]
 buffer_load_dwordx4 v1, s[4:7], s45 offen  lds
 v_mfma_f32_16x16x32_bf16 v[208:211], a[36:39], a[108:111], v[208:211]
 ds_read_b64_tr_b16 a[4:5], v6 offset:16384
 v_mfma_f32_16x16x32_bf16 v[208:211], a[32:35], a[104:107], v[208:211]
 ds_read_b64_tr_b16 a[6:7], v6 offset:20480
 v_mfma_f32_16x16x32_bf16 v[200:203], a[32:35], a[112:115], v[200:203]
 ds_read_b128 a[68:71], v5 offset:0
 v_mfma_f32_16x16x32_bf16 v[200:203], a[36:39], a[116:119], v[200:203]
 s_add_u32 m0, s29, 122880
 ds_read_b128 a[168:171], v3 offset:0
 v_mfma_f32_16x16x32_bf16 v[192:195], a[36:39], a[124:127], v[192:195]
 buffer_load_dwordx4 v2, s[8:11], s53 offen  lds
 v_mfma_f32_16x16x32_bf16 v[192:195], a[32:35], a[120:123], v[192:195]
 ds_read_b128 a[76:79], v5 offset:2048
 v_mfma_f32_16x16x32_bf16 v[196:199], a[40:43], a[120:123], v[196:199]
 ds_read_b128 a[164:167], v14 offset:2048
 v_mfma_f32_16x16x32_bf16 v[196:199], a[44:47], a[124:127], v[196:199]
 ds_read_b128 a[72:75], v4 offset:2048
 v_mfma_f32_16x16x32_bf16 v[204:207], a[44:47], a[116:119], v[204:207]
 s_add_u32 m0, s29, 57344
 ds_read_b128 a[172:175], v3 offset:2048
 v_mfma_f32_16x16x32_bf16 v[204:207], a[40:43], a[112:115], v[204:207]
 buffer_load_dwordx4 v1, s[4:7], s46 offen  lds
 v_mfma_f32_16x16x32_bf16 v[212:215], a[40:43], a[104:107], v[212:215]
 ds_read_b128 a[80:83], v4 offset:4096
 v_mfma_f32_16x16x32_bf16 v[212:215], a[44:47], a[108:111], v[212:215]
 ds_read_b128 a[176:179], v14 offset:4096
 v_mfma_f32_16x16x32_bf16 v[220:223], a[44:47], a[100:103], v[220:223]
 ds_read_b128 a[84:87], v5 offset:4096
 v_mfma_f32_16x16x32_bf16 v[220:223], a[40:43], a[96:99], v[220:223]
 s_add_u32 m0, s29, 126976
 ds_read_b128 a[184:187], v3 offset:4096
 v_mfma_f32_16x16x32_bf16 v[248:251], a[48:51], a[96:99], v[248:251]
 buffer_load_dwordx4 v2, s[8:11], s54 offen  lds
 v_mfma_f32_16x16x32_bf16 v[248:251], a[52:55], a[100:103], v[248:251]
 ds_read_b128 a[92:95], v5 offset:6144
 v_mfma_f32_16x16x32_bf16 v[240:243], a[52:55], a[108:111], v[240:243]
 ds_read_b128 a[180:183], v14 offset:6144
 v_mfma_f32_16x16x32_bf16 v[240:243], a[48:51], a[104:107], v[240:243]
 ds_read_b128 a[88:91], v4 offset:6144
 v_mfma_f32_16x16x32_bf16 v[232:235], a[48:51], a[112:115], v[232:235]
 s_add_u32 m0, s29, 61440
 ds_read_b128 a[188:191], v3 offset:6144
 v_mfma_f32_16x16x32_bf16 v[232:235], a[52:55], a[116:119], v[232:235]
 buffer_load_dwordx4 v1, s[4:7], s47 offen  lds
 v_mfma_f32_16x16x32_bf16 v[224:227], a[52:55], a[124:127], v[224:227]
 v_add_u32 v1, 128, v1
 v_add_u32 v2, 0x80000, v2
 v_mfma_f32_16x16x32_bf16 v[224:227], a[48:51], a[120:123], v[224:227]
 ds_read_b64_tr_b16 a[8:9], v7 offset:0
 v_mfma_f32_16x16x32_bf16 v[228:231], a[56:59], a[120:123], v[228:231]
 v_mfma_f32_16x16x32_bf16 v[228:231], a[60:63], a[124:127], v[228:231]
 ds_read_b64_tr_b16 a[10:11], v7 offset:4096
 v_mfma_f32_16x16x32_bf16 v[236:239], a[60:63], a[116:119], v[236:239]
 ds_read_b64_tr_b16 a[12:13], v7 offset:16384
 v_mfma_f32_16x16x32_bf16 v[236:239], a[56:59], a[112:115], v[236:239]
 ds_read_b64_tr_b16 a[14:15], v7 offset:20480
 v_mfma_f32_16x16x32_bf16 v[244:247], a[56:59], a[104:107], v[244:247]
 ds_read_b64_tr_b16 a[16:17], v8 offset:0
 v_mfma_f32_16x16x32_bf16 v[244:247], a[60:63], a[108:111], v[244:247]
 ds_read_b64_tr_b16 a[18:19], v8 offset:4096
 v_mfma_f32_16x16x32_bf16 v[252:255], a[60:63], a[100:103], v[252:255]
 ds_read_b64_tr_b16 a[20:21], v8 offset:16384
 v_mfma_f32_16x16x32_bf16 v[252:255], a[56:59], a[96:99], v[252:255]
 s_waitcnt lgkmcnt(15)
 ds_read_b64_tr_b16 a[22:23], v8 offset:20480
 v_mfma_f32_16x16x32_bf16 v[88:91], a[0:3], a[64:67], v[88:91]
 ds_read_b64_tr_b16 a[24:25], v9 offset:0
 v_lshlrev_b32 v1, 4, v0
 v_mfma_f32_16x16x32_bf16 v[88:91], a[4:7], a[68:71], v[88:91]
 s_add_u32 m0, s33, 0xfffffe00
 ds_read_b64_tr_b16 a[26:27], v9 offset:4096
 v_mfma_f32_16x16x32_bf16 v[80:83], a[4:7], a[76:79], v[80:83]
 s_waitcnt lgkmcnt(10)
 ds_read_b64_tr_b16 a[28:29], v9 offset:16384
 v_mfma_f32_16x16x32_bf16 v[80:83], a[0:3], a[72:75], v[80:83]
 ds_read_b64_tr_b16 a[30:31], v9 offset:20480
 buffer_load_dwordx4 v15, s[20:23], 0 offen offset:512 lds
 v_mfma_f32_16x16x32_bf16 v[72:75], a[0:3], a[80:83], v[72:75]
 ds_read_b128 a[96:99], v4 offset:8192
 v_mfma_f32_16x16x32_bf16 v[72:75], a[4:7], a[84:87], v[72:75]
 v_mfma_f32_16x16x32_bf16 v[64:67], a[4:7], a[92:95], v[64:67]
 s_add_u32 m0, s33, 0xfffffe80
 ds_read_b128 a[100:103], v5 offset:8192
 v_mfma_f32_16x16x32_bf16 v[64:67], a[0:3], a[88:91], v[64:67]
 s_waitcnt lgkmcnt(10)
 buffer_load_dwordx4 v15, s[20:23], 0 offen offset:1408 lds
 v_mfma_f32_16x16x32_bf16 v[68:71], a[8:11], a[88:91], v[68:71]
 ds_read_b128 a[108:111], v5 offset:10240
 v_mfma_f32_16x16x32_bf16 v[68:71], a[12:15], a[92:95], v[68:71]
 v_mfma_f32_16x16x32_bf16 v[76:79], a[12:15], a[84:87], v[76:79]
 s_add_u32 m0, s33, 0x600
 ds_read_b128 a[104:107], v4 offset:10240
 v_mfma_f32_16x16x32_bf16 v[76:79], a[8:11], a[80:83], v[76:79]
 buffer_load_dwordx4 v15, s[20:23], s57 offen offset:512 lds
 v_mfma_f32_16x16x32_bf16 v[84:87], a[8:11], a[72:75], v[84:87]
 ds_read_b128 a[112:115], v4 offset:12288
 v_mfma_f32_16x16x32_bf16 v[84:87], a[12:15], a[76:79], v[84:87]
 v_mfma_f32_16x16x32_bf16 v[92:95], a[12:15], a[68:71], v[92:95]
 s_add_u32 m0, s33, 0x680
 ds_read_b128 a[116:119], v5 offset:12288
 v_mfma_f32_16x16x32_bf16 v[92:95], a[8:11], a[64:67], v[92:95]
 s_waitcnt lgkmcnt(10)
 buffer_load_dwordx4 v15, s[20:23], s57 offen offset:1408 lds
 v_mfma_f32_16x16x32_bf16 v[120:123], a[16:19], a[64:67], v[120:123]
 ds_read_b128 a[124:127], v5 offset:14336
 v_mfma_f32_16x16x32_bf16 v[120:123], a[20:23], a[68:71], v[120:123]
 v_mfma_f32_16x16x32_bf16 v[112:115], a[20:23], a[76:79], v[112:115]
 s_add_u32 m0, s33, 0xd80
 ds_read_b128 a[120:123], v4 offset:14336
 v_mfma_f32_16x16x32_bf16 v[112:115], a[16:19], a[72:75], v[112:115]
 buffer_load_dwordx4 v15, s[20:23], 0 offen offset:640 lds
 v_mfma_f32_16x16x32_bf16 v[104:107], a[16:19], a[80:83], v[104:107]
 ds_read_b64_tr_b16 a[32:33], v10 offset:0
 v_mfma_f32_16x16x32_bf16 v[104:107], a[20:23], a[84:87], v[104:107]
 ds_read_b64_tr_b16 a[34:35], v10 offset:4096
 v_mfma_f32_16x16x32_bf16 v[96:99], a[20:23], a[92:95], v[96:99]
 s_add_u32 m0, s33, 0xe00
 ds_read_b64_tr_b16 a[36:37], v10 offset:16384
 v_mfma_f32_16x16x32_bf16 v[96:99], a[16:19], a[88:91], v[96:99]
 s_waitcnt lgkmcnt(11)
 ds_read_b64_tr_b16 a[38:39], v10 offset:20480
 buffer_load_dwordx4 v15, s[20:23], 0 offen offset:1536 lds
 v_mfma_f32_16x16x32_bf16 v[100:103], a[24:27], a[88:91], v[100:103]
 ds_read_b64_tr_b16 a[40:41], v11 offset:0
 v_mfma_f32_16x16x32_bf16 v[100:103], a[28:31], a[92:95], v[100:103]
 ds_read_b64_tr_b16 a[42:43], v11 offset:4096
 v_mfma_f32_16x16x32_bf16 v[108:111], a[28:31], a[84:87], v[108:111]
 s_add_u32 m0, s33, 0x1580
 ds_read_b64_tr_b16 a[44:45], v11 offset:16384
 v_mfma_f32_16x16x32_bf16 v[108:111], a[24:27], a[80:83], v[108:111]
 ds_read_b64_tr_b16 a[46:47], v11 offset:20480
 buffer_load_dwordx4 v15, s[20:23], s57 offen offset:640 lds
 v_mfma_f32_16x16x32_bf16 v[116:119], a[24:27], a[72:75], v[116:119]
 ds_read_b64_tr_b16 a[48:49], v12 offset:0
 v_mfma_f32_16x16x32_bf16 v[116:119], a[28:31], a[76:79], v[116:119]
 ds_read_b64_tr_b16 a[50:51], v12 offset:4096
 v_mfma_f32_16x16x32_bf16 v[124:127], a[28:31], a[68:71], v[124:127]
 s_add_u32 m0, s33, 0x1600
 ds_read_b64_tr_b16 a[52:53], v12 offset:16384
 v_mfma_f32_16x16x32_bf16 v[124:127], a[24:27], a[64:67], v[124:127]
 s_waitcnt lgkmcnt(15)
 ds_read_b64_tr_b16 a[54:55], v12 offset:20480
 buffer_load_dwordx4 v15, s[20:23], s57 offen offset:1536 lds
 v_mfma_f32_16x16x32_bf16 a[232:235], a[0:3], a[96:99], a[232:235]
 ds_read_b64_tr_b16 a[56:57], v13 offset:0
 v_mfma_f32_16x16x32_bf16 a[232:235], a[4:7], a[100:103], a[232:235]
 ds_read_b64_tr_b16 a[58:59], v13 offset:4096
 v_mfma_f32_16x16x32_bf16 a[224:227], a[4:7], a[108:111], a[224:227]
 ds_read_b64_tr_b16 a[60:61], v13 offset:16384
 v_mfma_f32_16x16x32_bf16 a[224:227], a[0:3], a[104:107], a[224:227]
 s_waitcnt lgkmcnt(15)
 ds_read_b64_tr_b16 a[62:63], v13 offset:20480
 v_mfma_f32_16x16x32_bf16 v[24:27], a[0:3], a[112:115], v[24:27]
 v_mfma_f32_16x16x32_bf16 v[24:27], a[4:7], a[116:119], v[24:27]
 v_mfma_f32_16x16x32_bf16 v[16:19], a[4:7], a[124:127], v[16:19]
 v_mfma_f32_16x16x32_bf16 v[16:19], a[0:3], a[120:123], v[16:19]
 s_waitcnt lgkmcnt(0)
 v_mfma_f32_16x16x32_bf16 v[20:23], a[8:11], a[120:123], v[20:23]
 s_barrier
 v_mfma_f32_16x16x32_bf16 v[20:23], a[12:15], a[124:127], v[20:23]
 s_add_u32 m0, s29, 0
 v_add_u32 v2, 0xff800000, v2
 v_mfma_f32_16x16x32_bf16 v[28:31], a[12:15], a[116:119], v[28:31]
 buffer_load_dwordx4 v2, s[16:19], 0 offen lds
 v_mfma_f32_16x16x32_bf16 v[28:31], a[8:11], a[112:115], v[28:31]
 v_mfma_f32_16x16x32_bf16 a[228:231], a[8:11], a[104:107], a[228:231]
 v_mfma_f32_16x16x32_bf16 a[228:231], a[12:15], a[108:111], a[228:231]
 v_mfma_f32_16x16x32_bf16 a[236:239], a[12:15], a[100:103], a[236:239]
 s_add_u32 m0, s29, 4096
 v_mfma_f32_16x16x32_bf16 a[236:239], a[8:11], a[96:99], a[236:239]
 buffer_load_dwordx4 v2, s[16:19], s48 offen lds
 v_mfma_f32_16x16x32_bf16 v[56:59], a[16:19], a[96:99], v[56:59]
 v_mfma_f32_16x16x32_bf16 v[56:59], a[20:23], a[100:103], v[56:59]
 v_mfma_f32_16x16x32_bf16 v[48:51], a[20:23], a[108:111], v[48:51]
 v_mfma_f32_16x16x32_bf16 v[48:51], a[16:19], a[104:107], v[48:51]
 s_add_u32 m0, s29, 8192
 v_mfma_f32_16x16x32_bf16 v[40:43], a[16:19], a[112:115], v[40:43]
 buffer_load_dwordx4 v2, s[16:19], s49 offen lds
 v_mfma_f32_16x16x32_bf16 v[40:43], a[20:23], a[116:119], v[40:43]
 v_mfma_f32_16x16x32_bf16 v[32:35], a[20:23], a[124:127], v[32:35]
 v_mfma_f32_16x16x32_bf16 v[32:35], a[16:19], a[120:123], v[32:35]
 v_mfma_f32_16x16x32_bf16 v[36:39], a[24:27], a[120:123], v[36:39]
 s_add_u32 m0, s29, 12288
 v_mfma_f32_16x16x32_bf16 v[36:39], a[28:31], a[124:127], v[36:39]
 buffer_load_dwordx4 v2, s[16:19], s50 offen lds
 v_mfma_f32_16x16x32_bf16 v[44:47], a[28:31], a[116:119], v[44:47]
 v_mfma_f32_16x16x32_bf16 v[44:47], a[24:27], a[112:115], v[44:47]
 v_mfma_f32_16x16x32_bf16 v[52:55], a[24:27], a[104:107], v[52:55]
 v_mfma_f32_16x16x32_bf16 v[52:55], a[28:31], a[108:111], v[52:55]
 s_add_u32 m0, s29, 16384
 v_mfma_f32_16x16x32_bf16 v[60:63], a[28:31], a[100:103], v[60:63]
 buffer_load_dwordx4 v2, s[16:19], s51 offen lds
 v_mfma_f32_16x16x32_bf16 v[60:63], a[24:27], a[96:99], v[60:63]
 v_mfma_f32_16x16x32_bf16 v[216:219], a[32:35], a[96:99], v[216:219]
 v_mfma_f32_16x16x32_bf16 v[216:219], a[36:39], a[100:103], v[216:219]
 v_mfma_f32_16x16x32_bf16 v[208:211], a[36:39], a[108:111], v[208:211]
 s_add_u32 m0, s29, 20480
 v_mfma_f32_16x16x32_bf16 v[208:211], a[32:35], a[104:107], v[208:211]
 buffer_load_dwordx4 v2, s[16:19], s52 offen lds
 v_mfma_f32_16x16x32_bf16 v[200:203], a[32:35], a[112:115], v[200:203]
 v_mfma_f32_16x16x32_bf16 v[200:203], a[36:39], a[116:119], v[200:203]
 v_mfma_f32_16x16x32_bf16 v[192:195], a[36:39], a[124:127], v[192:195]
 v_mfma_f32_16x16x32_bf16 v[192:195], a[32:35], a[120:123], v[192:195]
 s_add_u32 m0, s29, 24576
 v_mfma_f32_16x16x32_bf16 v[196:199], a[40:43], a[120:123], v[196:199]
 buffer_load_dwordx4 v2, s[16:19], s53 offen lds
 v_mfma_f32_16x16x32_bf16 v[196:199], a[44:47], a[124:127], v[196:199]
 v_mfma_f32_16x16x32_bf16 v[204:207], a[44:47], a[116:119], v[204:207]
 v_mfma_f32_16x16x32_bf16 v[204:207], a[40:43], a[112:115], v[204:207]
 v_mfma_f32_16x16x32_bf16 v[212:215], a[40:43], a[104:107], v[212:215]
 s_add_u32 m0, s29, 28672
 v_mfma_f32_16x16x32_bf16 v[212:215], a[44:47], a[108:111], v[212:215]
 buffer_load_dwordx4 v2, s[16:19], s54 offen lds
 v_mfma_f32_16x16x32_bf16 v[220:223], a[44:47], a[100:103], v[220:223]
 v_mfma_f32_16x16x32_bf16 v[220:223], a[40:43], a[96:99], v[220:223]
 v_mfma_f32_16x16x32_bf16 v[248:251], a[48:51], a[96:99], v[248:251]
 s_add_u32 m0, s29, 65536
 v_add_u32 v2, 0x80000, v2
 v_mfma_f32_16x16x32_bf16 v[248:251], a[52:55], a[100:103], v[248:251]
 buffer_load_dwordx4 v2, s[16:19], 0 offen lds
 v_mfma_f32_16x16x32_bf16 v[240:243], a[52:55], a[108:111], v[240:243]
 v_mfma_f32_16x16x32_bf16 v[240:243], a[48:51], a[104:107], v[240:243]
 v_mfma_f32_16x16x32_bf16 v[232:235], a[48:51], a[112:115], v[232:235]
 v_mfma_f32_16x16x32_bf16 v[232:235], a[52:55], a[116:119], v[232:235]
 s_add_u32 m0, s29, 69632
 v_mfma_f32_16x16x32_bf16 v[224:227], a[52:55], a[124:127], v[224:227]
 buffer_load_dwordx4 v2, s[16:19], s48 offen lds
 v_mfma_f32_16x16x32_bf16 v[224:227], a[48:51], a[120:123], v[224:227]
 v_mfma_f32_16x16x32_bf16 v[228:231], a[56:59], a[120:123], v[228:231]
 v_mfma_f32_16x16x32_bf16 v[228:231], a[60:63], a[124:127], v[228:231]
 v_mfma_f32_16x16x32_bf16 v[236:239], a[60:63], a[116:119], v[236:239]
 s_add_u32 m0, s29, 73728
 v_mfma_f32_16x16x32_bf16 v[236:239], a[56:59], a[112:115], v[236:239]
 buffer_load_dwordx4 v2, s[16:19], s49 offen lds
 v_mfma_f32_16x16x32_bf16 v[244:247], a[56:59], a[104:107], v[244:247]
 s_waitcnt vmcnt(11)
 v_mfma_f32_16x16x32_bf16 v[244:247], a[60:63], a[108:111], v[244:247]
 s_barrier
 ds_read_b64_tr_b16 a[0:1], v6 offset:32768
 v_mfma_f32_16x16x32_bf16 v[252:255], a[60:63], a[100:103], v[252:255]
 ds_read_b64_tr_b16 a[2:3], v6 offset:36864
 v_mfma_f32_16x16x32_bf16 v[252:255], a[56:59], a[96:99], v[252:255]
 s_add_u32 m0, s29, 77824
 ds_read_b128 a[96:99], v4 offset:40960
 v_mfma_f32_16x16x32_bf16 v[152:155], a[32:35], a[64:67], v[152:155]
 ds_read_b128 a[192:195], v14 offset:0
 buffer_load_dwordx4 v2, s[16:19], s50 offen lds
 v_mfma_f32_16x16x32_bf16 v[152:155], a[36:39], a[68:71], v[152:155]
 ds_read_b128 a[200:203], v3 offset:0
 v_mfma_f32_16x16x32_bf16 v[144:147], a[36:39], a[76:79], v[144:147]
 s_mov_b32 s56, s58
 ds_read_b64_tr_b16 a[4:5], v6 offset:49152
 v_mfma_f32_16x16x32_bf16 v[144:147], a[32:35], a[72:75], v[144:147]
 ds_read_b64_tr_b16 a[6:7], v6 offset:53248
 v_mfma_f32_16x16x32_bf16 v[136:139], a[32:35], a[80:83], v[136:139]
 s_add_u32 m0, s29, 81920
 ds_read_b128 a[100:103], v5 offset:40960
 v_mfma_f32_16x16x32_bf16 v[136:139], a[36:39], a[84:87], v[136:139]
 ds_read_b128 a[196:199], v14 offset:2048
 buffer_load_dwordx4 v2, s[16:19], s51 offen lds
 v_mfma_f32_16x16x32_bf16 v[128:131], a[36:39], a[92:95], v[128:131]
 ds_read_b128 a[204:207], v3 offset:2048
 v_mfma_f32_16x16x32_bf16 v[128:131], a[32:35], a[88:91], v[128:131]
 ds_read_b128 a[108:111], v5 offset:43008
 v_mfma_f32_16x16x32_bf16 v[132:135], a[40:43], a[88:91], v[132:135]
 ds_read_b128 a[208:211], v14 offset:4096
 v_mfma_f32_16x16x32_bf16 v[132:135], a[44:47], a[92:95], v[132:135]
 s_add_u32 m0, s29, 86016
 ds_read_b128 a[104:107], v4 offset:43008
 v_mfma_f32_16x16x32_bf16 v[140:143], a[44:47], a[84:87], v[140:143]
 ds_read_b128 a[216:219], v3 offset:4096
 buffer_load_dwordx4 v2, s[16:19], s52 offen lds
 v_mfma_f32_16x16x32_bf16 v[140:143], a[40:43], a[80:83], v[140:143]
 ds_read_b128 a[212:215], v14 offset:6144
 v_mfma_f32_16x16x32_bf16 v[148:151], a[40:43], a[72:75], v[148:151]
 s_cmp_lt_u32 s25, 4
 s_cselect_b32 s1, 2.0, s92
 ds_read_b128 a[112:115], v4 offset:45056
 v_mfma_f32_16x16x32_bf16 v[148:151], a[44:47], a[76:79], v[148:151]
 ds_read_b128 a[220:223], v3 offset:6144
 v_mfma_f32_16x16x32_bf16 v[156:159], a[44:47], a[68:71], v[156:159]
 s_add_u32 m0, s29, 90112
 ds_read_b128 a[116:119], v5 offset:45056
 v_mfma_f32_16x16x32_bf16 v[156:159], a[40:43], a[64:67], v[156:159]
 buffer_load_dwordx4 v2, s[16:19], s53 offen lds
 v_mfma_f32_16x16x32_bf16 v[184:187], a[48:51], a[64:67], v[184:187]
 v_mfma_f32_16x16x32_bf16 v[184:187], a[52:55], a[68:71], v[184:187]
 ds_read_b128 a[124:127], v5 offset:47104
 v_mfma_f32_16x16x32_bf16 v[176:179], a[52:55], a[76:79], v[176:179]
 v_mfma_f32_16x16x32_bf16 v[176:179], a[48:51], a[72:75], v[176:179]
 s_add_u32 m0, s29, 94208
 ds_read_b128 a[120:123], v4 offset:47104
 v_mfma_f32_16x16x32_bf16 v[168:171], a[48:51], a[80:83], v[168:171]
 buffer_load_dwordx4 v2, s[16:19], s54 offen lds
 v_mfma_f32_16x16x32_bf16 v[168:171], a[52:55], a[84:87], v[168:171]
 v_mfma_f32_16x16x32_bf16 v[160:163], a[52:55], a[92:95], v[160:163]
 v_mfma_f32_16x16x32_bf16 v[160:163], a[48:51], a[88:91], v[160:163]
 ds_read_b64_tr_b16 a[8:9], v7 offset:32768
 v_mfma_f32_16x16x32_bf16 v[164:167], a[56:59], a[88:91], v[164:167]
 v_mfma_f32_16x16x32_bf16 v[164:167], a[60:63], a[92:95], v[164:167]
 ds_read_b64_tr_b16 a[10:11], v7 offset:36864
 v_mfma_f32_16x16x32_bf16 v[172:175], a[60:63], a[84:87], v[172:175]
 ds_read_b64_tr_b16 a[12:13], v7 offset:49152
 v_mfma_f32_16x16x32_bf16 v[172:175], a[56:59], a[80:83], v[172:175]
 ds_read_b64_tr_b16 a[14:15], v7 offset:53248
 v_mfma_f32_16x16x32_bf16 v[180:183], a[56:59], a[72:75], v[180:183]
 ds_read_b64_tr_b16 a[16:17], v8 offset:32768
 v_mfma_f32_16x16x32_bf16 v[180:183], a[60:63], a[76:79], v[180:183]
 ds_read_b64_tr_b16 a[18:19], v8 offset:36864
 v_mfma_f32_16x16x32_bf16 v[188:191], a[60:63], a[68:71], v[188:191]
 ds_read_b64_tr_b16 a[20:21], v8 offset:49152
 v_mfma_f32_16x16x32_bf16 v[188:191], a[56:59], a[64:67], v[188:191]
 s_waitcnt lgkmcnt(15)
 ds_read_b64_tr_b16 a[22:23], v8 offset:53248
 s_cmp_ge_u32 s25, 4
 s_cbranch_scc1 L_late0
 v_mfma_f32_16x16x32_bf16 a[232:235], a[0:3], a[96:99], a[232:235]
 ds_read_b64_tr_b16 a[24:25], v9 offset:32768
 v_mfma_f32_16x16x32_bf16 a[232:235], a[4:7], a[100:103], a[232:235]
 s_add_u32 m0, s33, 0xfffffd00
 ds_read_b64_tr_b16 a[26:27], v9 offset:36864
 v_mfma_f32_16x16x32_bf16 a[224:227], a[4:7], a[108:111], a[224:227]
 s_waitcnt lgkmcnt(13)
 ds_read_b64_tr_b16 a[28:29], v9 offset:49152
 v_mfma_f32_16x16x32_bf16 a[224:227], a[0:3], a[104:107], a[224:227]
 ds_read_b64_tr_b16 a[30:31], v9 offset:53248
 buffer_load_dwordx4 v15, s[20:23], 0 offen offset:768 lds
 v_mfma_f32_16x16x32_bf16 v[24:27], a[0:3], a[112:115], v[24:27]
 s_waitcnt lgkmcnt(12)
 ds_read_b128 a[64:67], v4 offset:32768
 v_mfma_f32_16x16x32_bf16 v[24:27], a[4:7], a[116:119], v[24:27]
 v_mfma_f32_16x16x32_bf16 v[16:19], a[4:7], a[124:127], v[16:19]
 s_add_u32 m0, s33, 0xfffffd80
 ds_read_b128 a[68:71], v5 offset:32768
 v_mfma_f32_16x16x32_bf16 v[16:19], a[0:3], a[120:123], v[16:19]
 s_waitcnt lgkmcnt(10)
 buffer_load_dwordx4 v15, s[20:23], 0 offen offset:1664 lds
 v_mfma_f32_16x16x32_bf16 v[20:23], a[8:11], a[120:123], v[20:23]
 ds_read_b128 a[76:79], v5 offset:34816
 v_mfma_f32_16x16x32_bf16 v[20:23], a[12:15], a[124:127], v[20:23]
 v_mfma_f32_16x16x32_bf16 v[28:31], a[12:15], a[116:119], v[28:31]
 s_add_u32 m0, s33, 0x500
 ds_read_b128 a[72:75], v4 offset:34816
 v_mfma_f32_16x16x32_bf16 v[28:31], a[8:11], a[112:115], v[28:31]
 buffer_load_dwordx4 v15, s[20:23], s57 offen offset:768 lds
 v_mfma_f32_16x16x32_bf16 a[228:231], a[8:11], a[104:107], a[228:231]
 ds_read_b128 a[80:83], v4 offset:36864
 v_mfma_f32_16x16x32_bf16 a[228:231], a[12:15], a[108:111], a[228:231]
 v_mfma_f32_16x16x32_bf16 a[236:239], a[12:15], a[100:103], a[236:239]
 s_add_u32 m0, s33, 0x580
 ds_read_b128 a[84:87], v5 offset:36864
 v_mfma_f32_16x16x32_bf16 a[236:239], a[8:11], a[96:99], a[236:239]
 s_waitcnt lgkmcnt(10)
 buffer_load_dwordx4 v15, s[20:23], s57 offen offset:1664 lds
 v_mfma_f32_16x16x32_bf16 v[56:59], a[16:19], a[96:99], v[56:59]
 ds_read_b128 a[92:95], v5 offset:38912
 v_mfma_f32_16x16x32_bf16 v[56:59], a[20:23], a[100:103], v[56:59]
 v_cvt_pk_bf16_f32 v16, v16, v17
 v_cvt_pk_bf16_f32 v17, v18, v19
 v_mfma_f32_16x16x32_bf16 v[48:51], a[20:23], a[108:111], v[48:51]
 ds_read_b128 a[88:91], v4 offset:38912
 v_cvt_pk_bf16_f32 v18, v20, v21
 v_mfma_f32_16x16x32_bf16 v[48:51], a[16:19], a[104:107], v[48:51]
 v_cvt_pk_bf16_f32 v19, v22, v23
 v_cvt_pk_bf16_f32 v24, v24, v25
 v_mfma_f32_16x16x32_bf16 v[40:43], a[16:19], a[112:115], v[40:43]
 ds_read_b64_tr_b16 a[32:33], v10 offset:32768
 v_cvt_pk_bf16_f32 v25, v26, v27
 v_mfma_f32_16x16x32_bf16 v[40:43], a[20:23], a[116:119], v[40:43]
 ds_read_b64_tr_b16 a[34:35], v10 offset:36864
 v_cvt_pk_bf16_f32 v26, v28, v29
 v_mfma_f32_16x16x32_bf16 v[32:35], a[20:23], a[124:127], v[32:35]
 s_add_u32 s59, s56, 57344
 ds_read_b64_tr_b16 a[36:37], v10 offset:49152
 v_cvt_pk_bf16_f32 v27, v30, v31
 v_mfma_f32_16x16x32_bf16 v[32:35], a[16:19], a[120:123], v[32:35]
 s_waitcnt lgkmcnt(11)
 ds_read_b64_tr_b16 a[38:39], v10 offset:53248
 v_accvgpr_read_b32 v20, a224
 v_mfma_f32_16x16x32_bf16 v[36:39], a[24:27], a[120:123], v[36:39]
 ds_read_b64_tr_b16 a[40:41], v11 offset:32768
 buffer_store_dwordx4 v[16:19], v1, s[12:15], s59 offen offset:0 sc1
 v_mfma_f32_16x16x32_bf16 v[36:39], a[28:31], a[124:127], v[36:39]
 ds_read_b64_tr_b16 a[42:43], v11 offset:36864
 v_accvgpr_read_b32 v21, a225
 v_mfma_f32_16x16x32_bf16 v[44:47], a[28:31], a[116:119], v[44:47]
 ds_read_b64_tr_b16 a[44:45], v11 offset:49152
 v_accvgpr_read_b32 v22, a226
 v_mfma_f32_16x16x32_bf16 v[44:47], a[24:27], a[112:115], v[44:47]
 ds_read_b64_tr_b16 a[46:47], v11 offset:53248
 v_accvgpr_read_b32 v23, a227
 v_mfma_f32_16x16x32_bf16 v[52:55], a[24:27], a[104:107], v[52:55]
 ds_read_b64_tr_b16 a[48:49], v12 offset:32768
 v_accvgpr_read_b32 v28, a228
 v_mfma_f32_16x16x32_bf16 v[52:55], a[28:31], a[108:111], v[52:55]
 ds_read_b64_tr_b16 a[50:51], v12 offset:36864
 v_accvgpr_read_b32 v29, a229
 v_mfma_f32_16x16x32_bf16 v[60:63], a[28:31], a[100:103], v[60:63]
 s_add_u32 s59, s56, 49152
 ds_read_b64_tr_b16 a[52:53], v12 offset:49152
 v_accvgpr_read_b32 v30, a230
 v_mfma_f32_16x16x32_bf16 v[60:63], a[24:27], a[96:99], v[60:63]
 s_waitcnt lgkmcnt(15)
 ds_read_b64_tr_b16 a[54:55], v12 offset:53248
 buffer_store_dwordx4 v[24:27], v1, s[12:15], s59 offen offset:0 sc1
 v_mfma_f32_16x16x32_bf16 v[88:91], a[0:3], a[64:67], v[88:91]
 ds_read_b64_tr_b16 a[56:57], v13 offset:32768
 v_accvgpr_read_b32 v31, a231
 v_mfma_f32_16x16x32_bf16 v[88:91], a[4:7], a[68:71], v[88:91]
 ds_read_b64_tr_b16 a[58:59], v13 offset:36864
 v_cvt_pk_bf16_f32 v20, v20, v21
 v_mfma_f32_16x16x32_bf16 v[80:83], a[4:7], a[76:79], v[80:83]
 ds_read_b64_tr_b16 a[60:61], v13 offset:49152
 v_cvt_pk_bf16_f32 v21, v22, v23
 v_mfma_f32_16x16x32_bf16 v[80:83], a[0:3], a[72:75], v[80:83]
 s_waitcnt lgkmcnt(15)
 ds_read_b64_tr_b16 a[62:63], v13 offset:53248
 v_cvt_pk_bf16_f32 v22, v28, v29
 v_mfma_f32_16x16x32_bf16 v[72:75], a[0:3], a[80:83], v[72:75]
 v_cvt_pk_bf16_f32 v23, v30, v31
 v_cvt_pk_bf16_f32 v32, v32, v33
 v_mfma_f32_16x16x32_bf16 v[72:75], a[4:7], a[84:87], v[72:75]
 s_add_u32 s59, s56, 40960
 v_cvt_pk_bf16_f32 v33, v34, v35
 v_cvt_pk_bf16_f32 v34, v36, v37
 v_mfma_f32_16x16x32_bf16 v[64:67], a[4:7], a[92:95], v[64:67]
 buffer_store_dwordx4 v[20:23], v1, s[12:15], s59 offen offset:0 sc1
 v_mfma_f32_16x16x32_bf16 v[64:67], a[0:3], a[88:91], v[64:67]
 s_waitcnt lgkmcnt(0)
 v_cvt_pk_bf16_f32 v35, v38, v39
 v_cvt_pk_bf16_f32 v40, v40, v41
 v_mfma_f32_16x16x32_bf16 v[68:71], a[8:11], a[88:91], v[68:71]
 s_barrier
 v_xor_b32 v6, s60, v6
 v_cvt_pk_bf16_f32 v41, v42, v43
 v_mfma_f32_16x16x32_bf16 v[68:71], a[12:15], a[92:95], v[68:71]
 s_add_u32 m0, s29, 32768
 v_add_u32 v2, 0x80000, v2
 v_cvt_pk_bf16_f32 v42, v44, v45
 v_mfma_f32_16x16x32_bf16 v[76:79], a[12:15], a[84:87], v[76:79]
 buffer_load_dwordx4 v2, s[16:19], 0 offen lds
 v_mfma_f32_16x16x32_bf16 v[76:79], a[8:11], a[80:83], v[76:79]
 v_cvt_pk_bf16_f32 v43, v46, v47
 v_accvgpr_read_b32 v36, a232
 v_mfma_f32_16x16x32_bf16 v[84:87], a[8:11], a[72:75], v[84:87]
 s_add_u32 s59, s56, 57344
 v_accvgpr_read_b32 v37, a233
 v_accvgpr_read_b32 v38, a234
 v_mfma_f32_16x16x32_bf16 v[84:87], a[12:15], a[76:79], v[84:87]
 buffer_store_dwordx4 v[32:35], v1, s[12:15], s59 offen offset:1024 sc1
 v_mfma_f32_16x16x32_bf16 v[92:95], a[12:15], a[68:71], v[92:95]
 s_add_u32 m0, s29, 36864
 v_accvgpr_read_b32 v39, a235
 v_accvgpr_read_b32 v44, a236
 v_mfma_f32_16x16x32_bf16 v[92:95], a[8:11], a[64:67], v[92:95]
 buffer_load_dwordx4 v2, s[16:19], s48 offen lds
 v_mfma_f32_16x16x32_bf16 v[120:123], a[16:19], a[64:67], v[120:123]
 v_accvgpr_read_b32 v45, a237
 v_accvgpr_read_b32 v46, a238
 v_mfma_f32_16x16x32_bf16 v[120:123], a[20:23], a[68:71], v[120:123]
 v_accvgpr_read_b32 v47, a239
 v_cvt_pk_bf16_f32 v36, v36, v37
 v_mfma_f32_16x16x32_bf16 v[112:115], a[20:23], a[76:79], v[112:115]
 v_cvt_pk_bf16_f32 v37, v38, v39
 v_cvt_pk_bf16_f32 v38, v44, v45
 v_mfma_f32_16x16x32_bf16 v[112:115], a[16:19], a[72:75], v[112:115]
 s_add_u32 m0, s29, 40960
 v_cvt_pk_bf16_f32 v39, v46, v47
 v_cvt_pk_bf16_f32 v48, v48, v49
 v_mfma_f32_16x16x32_bf16 v[104:107], a[16:19], a[80:83], v[104:107]
 buffer_load_dwordx4 v2, s[16:19], s49 offen lds
 v_mfma_f32_16x16x32_bf16 v[104:107], a[20:23], a[84:87], v[104:107]
 s_add_u32 s59, s56, 49152
 v_cvt_pk_bf16_f32 v49, v50, v51
 v_cvt_pk_bf16_f32 v50, v52, v53
 v_mfma_f32_16x16x32_bf16 v[96:99], a[20:23], a[92:95], v[96:99]
 buffer_store_dwordx4 v[40:43], v1, s[12:15], s59 offen offset:1024 sc1
 v_mfma_f32_16x16x32_bf16 v[96:99], a[16:19], a[88:91], v[96:99]
 v_cvt_pk_bf16_f32 v51, v54, v55
 v_cvt_pk_bf16_f32 v56, v56, v57
 v_mfma_f32_16x16x32_bf16 v[100:103], a[24:27], a[88:91], v[100:103]
 s_add_u32 m0, s29, 45056
 v_cvt_pk_bf16_f32 v57, v58, v59
 v_cvt_pk_bf16_f32 v58, v60, v61
 v_mfma_f32_16x16x32_bf16 v[100:103], a[28:31], a[92:95], v[100:103]
 buffer_load_dwordx4 v2, s[16:19], s50 offen lds
 v_mfma_f32_16x16x32_bf16 v[108:111], a[28:31], a[84:87], v[108:111]
 v_cvt_pk_bf16_f32 v59, v62, v63
 v_cvt_pk_bf16_f32 v64, v64, v65
 v_mfma_f32_16x16x32_bf16 v[108:111], a[24:27], a[80:83], v[108:111]
 v_cvt_pk_bf16_f32 v65, v66, v67
 v_cvt_pk_bf16_f32 v66, v68, v69
 v_mfma_f32_16x16x32_bf16 v[116:119], a[24:27], a[72:75], v[116:119]
 v_cvt_pk_bf16_f32 v67, v70, v71
 v_cvt_pk_bf16_f32 v72, v72, v73
 v_mfma_f32_16x16x32_bf16 v[116:119], a[28:31], a[76:79], v[116:119]
 s_add_u32 m0, s29, 49152
 v_cvt_pk_bf16_f32 v73, v74, v75
 v_cvt_pk_bf16_f32 v74, v76, v77
 v_mfma_f32_16x16x32_bf16 v[124:127], a[28:31], a[68:71], v[124:127]
 buffer_load_dwordx4 v2, s[16:19], s51 offen lds
 v_mfma_f32_16x16x32_bf16 v[124:127], a[24:27], a[64:67], v[124:127]
 s_add_u32 s59, s56, 32768
 v_cvt_pk_bf16_f32 v75, v78, v79
 v_cvt_pk_bf16_f32 v80, v80, v81
 v_mfma_f32_16x16x32_bf16 v[152:155], a[32:35], a[64:67], v[152:155]
 buffer_store_dwordx4 v[36:39], v1, s[12:15], s59 offen offset:0 sc1
 v_mfma_f32_16x16x32_bf16 v[152:155], a[36:39], a[68:71], v[152:155]
 v_cvt_pk_bf16_f32 v81, v82, v83
 v_cvt_pk_bf16_f32 v82, v84, v85
 v_mfma_f32_16x16x32_bf16 v[144:147], a[36:39], a[76:79], v[144:147]
 s_add_u32 m0, s29, 53248
 v_cvt_pk_bf16_f32 v83, v86, v87
 v_cvt_pk_bf16_f32 v88, v88, v89
 v_mfma_f32_16x16x32_bf16 v[144:147], a[32:35], a[72:75], v[144:147]
 buffer_load_dwordx4 v2, s[16:19], s52 offen lds
 v_mfma_f32_16x16x32_bf16 v[136:139], a[32:35], a[80:83], v[136:139]
 v_cvt_pk_bf16_f32 v89, v90, v91
 v_cvt_pk_bf16_f32 v90, v92, v93
 v_mfma_f32_16x16x32_bf16 v[136:139], a[36:39], a[84:87], v[136:139]
 v_cvt_pk_bf16_f32 v91, v94, v95
 v_cvt_pk_bf16_f32 v96, v96, v97
 v_mfma_f32_16x16x32_bf16 v[128:131], a[36:39], a[92:95], v[128:131]
 v_cvt_pk_bf16_f32 v97, v98, v99
 v_cvt_pk_bf16_f32 v98, v100, v101
 v_mfma_f32_16x16x32_bf16 v[128:131], a[32:35], a[88:91], v[128:131]
 s_add_u32 m0, s29, 57344
 v_cvt_pk_bf16_f32 v99, v102, v103
 v_cvt_pk_bf16_f32 v104, v104, v105
 v_mfma_f32_16x16x32_bf16 v[132:135], a[40:43], a[88:91], v[132:135]
 buffer_load_dwordx4 v2, s[16:19], s53 offen lds
 v_mfma_f32_16x16x32_bf16 v[132:135], a[44:47], a[92:95], v[132:135]
 s_add_u32 s59, s56, 40960
 v_cvt_pk_bf16_f32 v105, v106, v107
 v_cvt_pk_bf16_f32 v106, v108, v109
 v_mfma_f32_16x16x32_bf16 v[140:143], a[44:47], a[84:87], v[140:143]
 buffer_store_dwordx4 v[48:51], v1, s[12:15], s59 offen offset:1024 sc1
 v_mfma_f32_16x16x32_bf16 v[140:143], a[40:43], a[80:83], v[140:143]
 v_cvt_pk_bf16_f32 v107, v110, v111
 v_cvt_pk_bf16_f32 v112, v112, v113
 v_mfma_f32_16x16x32_bf16 v[148:151], a[40:43], a[72:75], v[148:151]
 s_add_u32 m0, s29, 61440
 v_cvt_pk_bf16_f32 v113, v114, v115
 v_cvt_pk_bf16_f32 v114, v116, v117
 v_mfma_f32_16x16x32_bf16 v[148:151], a[44:47], a[76:79], v[148:151]
 buffer_load_dwordx4 v2, s[16:19], s54 offen lds
 v_mfma_f32_16x16x32_bf16 v[156:159], a[44:47], a[68:71], v[156:159]
 v_cvt_pk_bf16_f32 v115, v118, v119
 v_cvt_pk_bf16_f32 v120, v120, v121
 v_mfma_f32_16x16x32_bf16 v[156:159], a[40:43], a[64:67], v[156:159]
 v_cvt_pk_bf16_f32 v121, v122, v123
 v_cvt_pk_bf16_f32 v122, v124, v125
 v_mfma_f32_16x16x32_bf16 v[184:187], a[48:51], a[64:67], v[184:187]
 s_add_u32 m0, s29, 98304
 v_add_u32 v2, 0x80000, v2
 v_cvt_pk_bf16_f32 v123, v126, v127
 v_mfma_f32_16x16x32_bf16 v[184:187], a[52:55], a[68:71], v[184:187]
 buffer_load_dwordx4 v2, s[16:19], 0 offen lds
 v_mfma_f32_16x16x32_bf16 v[176:179], a[52:55], a[76:79], v[176:179]
 s_add_u32 s59, s56, 32768
 v_cvt_pk_bf16_f32 v128, v128, v129
 v_cvt_pk_bf16_f32 v129, v130, v131
 v_mfma_f32_16x16x32_bf16 v[176:179], a[48:51], a[72:75], v[176:179]
 buffer_store_dwordx4 v[56:59], v1, s[12:15], s59 offen offset:1024 sc1
 v_mfma_f32_16x16x32_bf16 v[168:171], a[48:51], a[80:83], v[168:171]
 v_cvt_pk_bf16_f32 v130, v132, v133
 v_cvt_pk_bf16_f32 v131, v134, v135
 v_mfma_f32_16x16x32_bf16 v[168:171], a[52:55], a[84:87], v[168:171]
 s_add_u32 m0, s29, 102400
 v_cvt_pk_bf16_f32 v136, v136, v137
 v_cvt_pk_bf16_f32 v137, v138, v139
 v_mfma_f32_16x16x32_bf16 v[160:163], a[52:55], a[92:95], v[160:163]
 buffer_load_dwordx4 v2, s[16:19], s48 offen lds
 v_mfma_f32_16x16x32_bf16 v[160:163], a[48:51], a[88:91], v[160:163]
 v_cvt_pk_bf16_f32 v138, v140, v141
 v_cvt_pk_bf16_f32 v139, v142, v143
 v_mfma_f32_16x16x32_bf16 v[164:167], a[56:59], a[88:91], v[164:167]
 v_cvt_pk_bf16_f32 v144, v144, v145
 v_cvt_pk_bf16_f32 v145, v146, v147
 v_mfma_f32_16x16x32_bf16 v[164:167], a[60:63], a[92:95], v[164:167]
 v_cvt_pk_bf16_f32 v146, v148, v149
 v_cvt_pk_bf16_f32 v147, v150, v151
 v_mfma_f32_16x16x32_bf16 v[172:175], a[60:63], a[84:87], v[172:175]
 s_add_u32 m0, s29, 106496
 v_cvt_pk_bf16_f32 v152, v152, v153
 v_cvt_pk_bf16_f32 v153, v154, v155
 v_mfma_f32_16x16x32_bf16 v[172:175], a[56:59], a[80:83], v[172:175]
 buffer_load_dwordx4 v2, s[16:19], s49 offen lds
 v_mfma_f32_16x16x32_bf16 v[180:183], a[56:59], a[72:75], v[180:183]
 s_add_u32 s59, s56, 24576
 v_cvt_pk_bf16_f32 v154, v156, v157
 v_cvt_pk_bf16_f32 v155, v158, v159
 v_mfma_f32_16x16x32_bf16 v[180:183], a[60:63], a[76:79], v[180:183]
 buffer_store_dwordx4 v[64:67], v1, s[12:15], s59 offen offset:0 sc1
 v_mfma_f32_16x16x32_bf16 v[188:191], a[60:63], a[68:71], v[188:191]
 v_mfma_f32_16x16x32_bf16 v[188:191], a[56:59], a[64:67], v[188:191]
 s_add_u32 m0, s29, 110592
 v_mfma_f32_16x16x32_bf16 v[216:219], a[32:35], a[96:99], v[216:219]
 buffer_load_dwordx4 v2, s[16:19], s50 offen lds
 v_mfma_f32_16x16x32_bf16 v[216:219], a[36:39], a[100:103], v[216:219]
 v_cvt_pk_bf16_f32 v160, v160, v161
 v_cvt_pk_bf16_f32 v161, v162, v163
 v_mfma_f32_16x16x32_bf16 v[208:211], a[36:39], a[108:111], v[208:211]
 v_cvt_pk_bf16_f32 v162, v164, v165
 v_cvt_pk_bf16_f32 v163, v166, v167
 v_mfma_f32_16x16x32_bf16 v[208:211], a[32:35], a[104:107], v[208:211]
 v_cvt_pk_bf16_f32 v168, v168, v169
 v_cvt_pk_bf16_f32 v169, v170, v171
 v_mfma_f32_16x16x32_bf16 v[200:203], a[32:35], a[112:115], v[200:203]
 s_add_u32 m0, s29, 114688
 v_cvt_pk_bf16_f32 v170, v172, v173
 v_cvt_pk_bf16_f32 v171, v174, v175
 v_mfma_f32_16x16x32_bf16 v[200:203], a[36:39], a[116:119], v[200:203]
 buffer_load_dwordx4 v2, s[16:19], s51 offen lds
 v_mfma_f32_16x16x32_bf16 v[192:195], a[36:39], a[124:127], v[192:195]
 s_add_u32 s59, s56, 16384
 v_cvt_pk_bf16_f32 v176, v176, v177
 v_cvt_pk_bf16_f32 v177, v178, v179
 v_mfma_f32_16x16x32_bf16 v[192:195], a[32:35], a[120:123], v[192:195]
 buffer_store_dwordx4 v[72:75], v1, s[12:15], s59 offen offset:0 sc1
 v_mfma_f32_16x16x32_bf16 v[196:199], a[40:43], a[120:123], v[196:199]
 v_cvt_pk_bf16_f32 v178, v180, v181
 v_cvt_pk_bf16_f32 v179, v182, v183
 v_mfma_f32_16x16x32_bf16 v[196:199], a[44:47], a[124:127], v[196:199]
 s_add_u32 m0, s29, 118784
 v_cvt_pk_bf16_f32 v184, v184, v185
 v_cvt_pk_bf16_f32 v185, v186, v187
 v_mfma_f32_16x16x32_bf16 v[204:207], a[44:47], a[116:119], v[204:207]
 buffer_load_dwordx4 v2, s[16:19], s52 offen lds
 v_mfma_f32_16x16x32_bf16 v[204:207], a[40:43], a[112:115], v[204:207]
 v_cvt_pk_bf16_f32 v186, v188, v189
 v_cvt_pk_bf16_f32 v187, v190, v191
 v_mfma_f32_16x16x32_bf16 v[212:215], a[40:43], a[104:107], v[212:215]
 v_mfma_f32_16x16x32_bf16 v[212:215], a[44:47], a[108:111], v[212:215]
 v_mfma_f32_16x16x32_bf16 v[220:223], a[44:47], a[100:103], v[220:223]
 s_add_u32 m0, s29, 122880
 v_mfma_f32_16x16x32_bf16 v[220:223], a[40:43], a[96:99], v[220:223]
 buffer_load_dwordx4 v2, s[16:19], s53 offen lds
 v_mfma_f32_16x16x32_bf16 v[248:251], a[48:51], a[96:99], v[248:251]
 s_add_u32 s59, s56, 8192
 v_mfma_f32_16x16x32_bf16 v[248:251], a[52:55], a[100:103], v[248:251]
 s_waitcnt vmcnt(25)
 buffer_store_dwordx4 v[80:83], v1, s[12:15], s59 offen offset:0 sc1
 v_mfma_f32_16x16x32_bf16 v[240:243], a[52:55], a[108:111], v[240:243]
 s_barrier
 v_xor_b32 v7, 0, v6
 v_cvt_pk_bf16_f32 v192, v192, v193
 v_mfma_f32_16x16x32_bf16 v[240:243], a[48:51], a[104:107], v[240:243]
 s_add_u32 m0, s29, 126976
 ds_read_b64_tr_b16 a[64:65], v7 offset:0
 v_cvt_pk_bf16_f32 v193, v194, v195
 v_mfma_f32_16x16x32_bf16 v[232:235], a[48:51], a[112:115], v[232:235]
 ds_read_b64_tr_b16 a[66:67], v7 offset:4096
 buffer_load_dwordx4 v2, s[16:19], s54 offen lds
 v_mfma_f32_16x16x32_bf16 v[232:235], a[52:55], a[116:119], v[232:235]
 ds_read_b64_tr_b16 a[68:69], v7 offset:16384
 v_cvt_pk_bf16_f32 v194, v196, v197
 v_mfma_f32_16x16x32_bf16 v[224:227], a[52:55], a[124:127], v[224:227]
 ds_read_b64_tr_b16 a[70:71], v7 offset:20480
 v_xor_b32 v8, 65536, v6
 v_mfma_f32_16x16x32_bf16 v[224:227], a[48:51], a[120:123], v[224:227]
 s_add_u32 s59, s56, 0
 ds_read_b64_tr_b16 a[72:73], v8 offset:0
 v_cvt_pk_bf16_f32 v195, v198, v199
 v_mfma_f32_16x16x32_bf16 v[228:231], a[56:59], a[120:123], v[228:231]
 ds_read_b64_tr_b16 a[74:75], v8 offset:4096
 buffer_store_dwordx4 v[88:91], v1, s[12:15], s59 offen offset:0 sc1
 v_mfma_f32_16x16x32_bf16 v[228:231], a[60:63], a[124:127], v[228:231]
 ds_read_b64_tr_b16 a[76:77], v8 offset:16384
 v_cvt_pk_bf16_f32 v200, v200, v201
 v_mfma_f32_16x16x32_bf16 v[236:239], a[60:63], a[116:119], v[236:239]
 ds_read_b64_tr_b16 a[78:79], v8 offset:20480
 v_xor_b32 v9, 32, v6
 v_mfma_f32_16x16x32_bf16 v[236:239], a[56:59], a[112:115], v[236:239]
 ds_read_b64_tr_b16 a[80:81], v9 offset:0
 v_cvt_pk_bf16_f32 v201, v202, v203
 v_mfma_f32_16x16x32_bf16 v[244:247], a[56:59], a[104:107], v[244:247]
 ds_read_b64_tr_b16 a[82:83], v9 offset:4096
 v_cvt_pk_bf16_f32 v202, v204, v205
 v_mfma_f32_16x16x32_bf16 v[244:247], a[60:63], a[108:111], v[244:247]
 ds_read_b64_tr_b16 a[84:85], v9 offset:16384
 v_cvt_pk_bf16_f32 v203, v206, v207
 v_mfma_f32_16x16x32_bf16 v[252:255], a[60:63], a[100:103], v[252:255]
 s_add_u32 s59, s56, 24576
 ds_read_b64_tr_b16 a[86:87], v9 offset:20480
 v_xor_b32 v10, 65568, v6
 v_mfma_f32_16x16x32_bf16 v[252:255], a[56:59], a[96:99], v[252:255]
 s_waitcnt lgkmcnt(6)
 ds_read_b64_tr_b16 a[88:89], v10 offset:0
 buffer_store_dwordx4 v[96:99], v1, s[12:15], s59 offen offset:1024 sc1
 v_mfma_f32_16x16x32_bf16 v[28:31], a[64:67], a[128:131], 0
 ds_read_b64_tr_b16 a[90:91], v10 offset:4096
 v_cvt_pk_bf16_f32 v208, v208, v209
 v_mfma_f32_16x16x32_bf16 v[28:31], a[68:71], a[136:139], v[28:31]
 ds_read_b64_tr_b16 a[92:93], v10 offset:16384
 v_xor_b32 v7, 64, v6
 v_mfma_f32_16x16x32_bf16 v[28:31], a[72:75], a[144:147], v[28:31]
 s_waitcnt lgkmcnt(7)
 ds_read_b128 a[112:115], v14 offset:0
 ds_read_b64_tr_b16 a[94:95], v10 offset:20480
 v_mfma_f32_16x16x32_bf16 v[28:31], a[76:79], a[152:155], v[28:31]
 ds_read_b64_tr_b16 a[96:97], v7 offset:0
 v_cvt_pk_bf16_f32 v209, v210, v211
 v_mfma_f32_16x16x32_bf16 v[44:47], a[64:67], a[132:135], 0
 ds_read_b128 a[120:123], v3 offset:0
 ds_read_b64_tr_b16 a[98:99], v7 offset:4096
 v_mfma_f32_16x16x32_bf16 v[44:47], a[68:71], a[140:143], v[44:47]
 s_add_u32 s59, s56, 16384
 ds_read_b64_tr_b16 a[100:101], v7 offset:16384
 v_xor_b32 v8, 65600, v6
 v_mfma_f32_16x16x32_bf16 v[44:47], a[72:75], a[148:151], v[44:47]
 ds_read_b128 a[116:119], v14 offset:2048
 ds_read_b64_tr_b16 a[102:103], v7 offset:20480
 buffer_store_dwordx4 v[104:107], v1, s[12:15], s59 offen offset:1024 sc1
 v_mfma_f32_16x16x32_bf16 v[44:47], a[76:79], a[156:159], v[44:47]
 s_waitcnt lgkmcnt(9)
 ds_read_b64_tr_b16 a[104:105], v8 offset:0
 v_cvt_pk_bf16_f32 v210, v212, v213
 v_mfma_f32_16x16x32_bf16 v[52:55], a[80:83], a[128:131], 0
 ds_read_b128 a[124:127], v3 offset:2048
 ds_read_b64_tr_b16 a[106:107], v8 offset:4096
 v_mfma_f32_16x16x32_bf16 v[52:55], a[84:87], a[136:139], v[52:55]
 ds_read_b64_tr_b16 a[108:109], v8 offset:16384
 v_cvt_pk_bf16_f32 v211, v214, v215
 v_mfma_f32_16x16x32_bf16 v[52:55], a[88:91], a[144:147], v[52:55]
 s_waitcnt lgkmcnt(10)
 ds_read_b64_tr_b16 a[110:111], v8 offset:20480
 v_xor_b32 v9, 96, v6
 v_mfma_f32_16x16x32_bf16 v[52:55], a[92:95], a[152:155], v[52:55]
 ds_read_b64_tr_b16 a[64:65], v9 offset:0
 v_cvt_pk_bf16_f32 v216, v216, v217
 v_mfma_f32_16x16x32_bf16 v[60:63], a[80:83], a[132:135], 0
 s_add_u32 s59, s56, 8192
 ds_read_b64_tr_b16 a[66:67], v9 offset:4096
 v_cvt_pk_bf16_f32 v217, v218, v219
 v_mfma_f32_16x16x32_bf16 v[60:63], a[84:87], a[140:143], v[60:63]
 ds_read_b64_tr_b16 a[68:69], v9 offset:16384
 buffer_store_dwordx4 v[112:115], v1, s[12:15], s59 offen offset:1024 sc1
 v_mfma_f32_16x16x32_bf16 v[60:63], a[88:91], a[148:151], v[60:63]
 ds_read_b64_tr_b16 a[70:71], v9 offset:20480
 v_xor_b32 v10, 65632, v6
 v_mfma_f32_16x16x32_bf16 v[60:63], a[92:95], a[156:159], v[60:63]
 s_waitcnt lgkmcnt(6)
 ds_read_b64_tr_b16 a[72:73], v10 offset:0
 v_cvt_pk_bf16_f32 v218, v220, v221
 v_mfma_f32_16x16x32_bf16 v[20:23], a[96:99], a[128:131], 0
 ds_read_b64_tr_b16 a[74:75], v10 offset:4096
 v_cvt_pk_bf16_f32 v219, v222, v223
 v_mfma_f32_16x16x32_bf16 v[20:23], a[100:103], a[136:139], v[20:23]
 s_waitcnt lgkmcnt(8)
 ds_read_b64_tr_b16 a[76:77], v10 offset:16384
 v_xor_b32 v7, 128, v6
 v_mfma_f32_16x16x32_bf16 v[20:23], a[104:107], a[144:147], v[20:23]
 s_waitcnt lgkmcnt(7)
 s_barrier
 ds_read_b64_tr_b16 a[78:79], v10 offset:20480
 v_mfma_f32_16x16x32_bf16 v[20:23], a[108:111], a[152:155], v[20:23]
 s_add_u32 m0, s29, 131072
 ds_read_b64_tr_b16 a[80:81], v7 offset:0
 v_add_u32 v2, 0x80000, v2
 v_mfma_f32_16x16x32_bf16 v[36:39], a[96:99], a[132:135], 0
 ds_read_b64_tr_b16 a[82:83], v7 offset:4096
 buffer_load_dwordx4 v2, s[16:19], 0 offen lds
 v_mfma_f32_16x16x32_bf16 v[36:39], a[100:103], a[140:143], v[36:39]
 ds_read_b64_tr_b16 a[84:85], v7 offset:16384
 v_cvt_pk_bf16_f32 v224, v224, v225
 v_mfma_f32_16x16x32_bf16 v[36:39], a[104:107], a[148:151], v[36:39]
 s_add_u32 s59, s56, 0
 ds_read_b64_tr_b16 a[86:87], v7 offset:20480
 v_xor_b32 v8, 65664, v6
 v_mfma_f32_16x16x32_bf16 v[36:39], a[108:111], a[156:159], v[36:39]
 s_waitcnt lgkmcnt(6)
 ds_read_b64_tr_b16 a[88:89], v8 offset:0
 buffer_store_dwordx4 v[120:123], v1, s[12:15], s59 offen offset:1024 sc1
 v_mfma_f32_16x16x32_bf16 v[68:71], a[64:67], a[128:131], 0
 ds_read_b64_tr_b16 a[90:91], v8 offset:4096
 v_cvt_pk_bf16_f32 v225, v226, v227
 v_mfma_f32_16x16x32_bf16 v[68:71], a[68:71], a[136:139], v[68:71]
 s_add_u32 m0, s29, 135168
 ds_read_b64_tr_b16 a[92:93], v8 offset:16384
 v_cvt_pk_bf16_f32 v226, v228, v229
 v_mfma_f32_16x16x32_bf16 v[68:71], a[72:75], a[144:147], v[68:71]
 s_waitcnt lgkmcnt(7)
 ds_read_b64_tr_b16 a[94:95], v8 offset:20480
 v_xor_b32 v9, 160, v6
 v_mfma_f32_16x16x32_bf16 v[68:71], a[76:79], a[152:155], v[68:71]
 ds_read_b64_tr_b16 a[96:97], v9 offset:0
 buffer_load_dwordx4 v2, s[16:19], s48 offen lds
 v_mfma_f32_16x16x32_bf16 v[76:79], a[64:67], a[132:135], 0
 ds_read_b64_tr_b16 a[98:99], v9 offset:4096
 v_cvt_pk_bf16_f32 v227, v230, v231
 v_mfma_f32_16x16x32_bf16 v[76:79], a[68:71], a[140:143], v[76:79]
 ds_read_b64_tr_b16 a[100:101], v9 offset:16384
 v_cvt_pk_bf16_f32 v232, v232, v233
 v_mfma_f32_16x16x32_bf16 v[76:79], a[72:75], a[148:151], v[76:79]
 s_add_u32 s59, s56, 24576
 ds_read_b64_tr_b16 a[102:103], v9 offset:20480
 v_xor_b32 v10, 65696, v6
 v_mfma_f32_16x16x32_bf16 v[76:79], a[76:79], a[156:159], v[76:79]
 s_waitcnt lgkmcnt(6)
 ds_read_b64_tr_b16 a[104:105], v10 offset:0
 buffer_store_dwordx4 v[128:131], v1, s[12:15], s59 offen offset:2048 sc1
 v_mfma_f32_16x16x32_bf16 v[84:87], a[80:83], a[128:131], 0
 s_add_u32 m0, s29, 139264
 ds_read_b64_tr_b16 a[106:107], v10 offset:4096
 v_cvt_pk_bf16_f32 v233, v234, v235
 v_mfma_f32_16x16x32_bf16 v[84:87], a[84:87], a[136:139], v[84:87]
 ds_read_b64_tr_b16 a[108:109], v10 offset:16384
 buffer_load_dwordx4 v2, s[16:19], s49 offen lds
 v_mfma_f32_16x16x32_bf16 v[84:87], a[88:91], a[144:147], v[84:87]
 s_waitcnt lgkmcnt(7)
 ds_read_b64_tr_b16 a[110:111], v10 offset:20480
 v_xor_b32 v7, 192, v6
 v_mfma_f32_16x16x32_bf16 v[84:87], a[92:95], a[152:155], v[84:87]
 ds_read_b64_tr_b16 a[64:65], v7 offset:0
 v_cvt_pk_bf16_f32 v234, v236, v237
 v_mfma_f32_16x16x32_bf16 v[92:95], a[80:83], a[132:135], 0
 ds_read_b64_tr_b16 a[66:67], v7 offset:4096
 v_cvt_pk_bf16_f32 v235, v238, v239
 v_mfma_f32_16x16x32_bf16 v[92:95], a[84:87], a[140:143], v[92:95]
 ds_read_b64_tr_b16 a[68:69], v7 offset:16384
 v_cvt_pk_bf16_f32 v240, v240, v241
 v_mfma_f32_16x16x32_bf16 v[92:95], a[88:91], a[148:151], v[92:95]
 s_add_u32 m0, s29, 143360
 ds_read_b64_tr_b16 a[70:71], v7 offset:20480
 v_xor_b32 v8, 65728, v6
 v_mfma_f32_16x16x32_bf16 v[92:95], a[92:95], a[156:159], v[92:95]
 s_waitcnt lgkmcnt(6)
 ds_read_b64_tr_b16 a[72:73], v8 offset:0
 buffer_load_dwordx4 v2, s[16:19], s50 offen lds
 v_mfma_f32_16x16x32_bf16 v[100:103], a[96:99], a[128:131], 0
 s_add_u32 s59, s56, 16384
 ds_read_b64_tr_b16 a[74:75], v8 offset:4096
 v_cvt_pk_bf16_f32 v241, v242, v243
 v_mfma_f32_16x16x32_bf16 v[100:103], a[100:103], a[136:139], v[100:103]
 ds_read_b64_tr_b16 a[76:77], v8 offset:16384
 buffer_store_dwordx4 v[136:139], v1, s[12:15], s59 offen offset:2048 sc1
 v_mfma_f32_16x16x32_bf16 v[100:103], a[104:107], a[144:147], v[100:103]
 s_waitcnt lgkmcnt(7)
 ds_read_b64_tr_b16 a[78:79], v8 offset:20480
 v_xor_b32 v9, 224, v6
 v_mfma_f32_16x16x32_bf16 v[100:103], a[108:111], a[152:155], v[100:103]
 s_and_b32 s36, s95, 31
 ds_read_b64_tr_b16 a[80:81], v9 offset:0
 v_cvt_pk_bf16_f32 v242, v244, v245
 v_mfma_f32_16x16x32_bf16 v[108:111], a[96:99], a[132:135], 0
 s_add_u32 m0, s29, 147456
 ds_read_b64_tr_b16 a[82:83], v9 offset:4096
 v_cvt_pk_bf16_f32 v243, v246, v247
 v_mfma_f32_16x16x32_bf16 v[108:111], a[100:103], a[140:143], v[108:111]
 ds_read_b64_tr_b16 a[84:85], v9 offset:16384
 buffer_load_dwordx4 v2, s[16:19], s51 offen lds
 v_mfma_f32_16x16x32_bf16 v[108:111], a[104:107], a[148:151], v[108:111]
 s_add_u32 s59, s56, 8192
 ds_read_b64_tr_b16 a[86:87], v9 offset:20480
 v_xor_b32 v10, 65760, v6
 v_mfma_f32_16x16x32_bf16 v[108:111], a[108:111], a[156:159], v[108:111]
 s_waitcnt lgkmcnt(6)
 ds_read_b64_tr_b16 a[88:89], v10 offset:0
 v_cvt_pk_bf16_f32 v248, v248, v249
 v_mfma_f32_16x16x32_bf16 v[116:119], a[64:67], a[128:131], 0
 ds_read_b64_tr_b16 a[90:91], v10 offset:4096
 buffer_store_dwordx4 v[144:147], v1, s[12:15], s59 offen offset:2048 sc1
 v_mfma_f32_16x16x32_bf16 v[116:119], a[68:71], a[136:139], v[116:119]
 s_add_u32 m0, s29, 151552
 ds_read_b64_tr_b16 a[92:93], v10 offset:16384
 v_cvt_pk_bf16_f32 v249, v250, v251
 v_mfma_f32_16x16x32_bf16 v[116:119], a[72:75], a[144:147], v[116:119]
 s_waitcnt lgkmcnt(7)
 ds_read_b64_tr_b16 a[94:95], v10 offset:20480
 v_xor_b32 v7, 256, v6
 v_mfma_f32_16x16x32_bf16 v[116:119], a[76:79], a[152:155], v[116:119]
 ds_read_b64_tr_b16 a[96:97], v7 offset:0
 buffer_load_dwordx4 v2, s[16:19], s52 offen lds
 v_mfma_f32_16x16x32_bf16 v[124:127], a[64:67], a[132:135], 0
 s_lshr_b32 s37, s95, 5
 ds_read_b64_tr_b16 a[98:99], v7 offset:4096
 v_cvt_pk_bf16_f32 v250, v252, v253
 v_mfma_f32_16x16x32_bf16 v[124:127], a[68:71], a[140:143], v[124:127]
 s_lshl_b32 s38, s3, 4
 ds_read_b64_tr_b16 a[100:101], v7 offset:16384
 v_cvt_pk_bf16_f32 v251, v254, v255
 v_mfma_f32_16x16x32_bf16 v[124:127], a[72:75], a[148:151], v[124:127]
 s_add_u32 s59, s56, 0
 ds_read_b64_tr_b16 a[102:103], v7 offset:20480
 v_xor_b32 v8, 65792, v6
 v_mfma_f32_16x16x32_bf16 v[124:127], a[76:79], a[156:159], v[124:127]
 s_waitcnt lgkmcnt(6)
 ds_read_b64_tr_b16 a[104:105], v8 offset:0
 buffer_store_dwordx4 v[152:155], v1, s[12:15], s59 offen offset:2048 sc1
 v_mfma_f32_16x16x32_bf16 v[132:135], a[80:83], a[128:131], 0
 s_add_u32 m0, s29, 155648
 ds_read_b64_tr_b16 a[106:107], v8 offset:4096
 v_accvgpr_read_b32 v11, a245
 v_mfma_f32_16x16x32_bf16 v[132:135], a[84:87], a[136:139], v[132:135]
 ds_read_b64_tr_b16 a[108:109], v8 offset:16384
 buffer_load_dwordx4 v2, s[16:19], s53 offen lds
 v_mfma_f32_16x16x32_bf16 v[132:135], a[88:91], a[144:147], v[132:135]
 s_waitcnt lgkmcnt(7)
 ds_read_b64_tr_b16 a[110:111], v8 offset:20480
 v_xor_b32 v9, 288, v6
 v_mfma_f32_16x16x32_bf16 v[132:135], a[92:95], a[152:155], v[132:135]
 s_lshl_b32 s39, s36, 6
 ds_read_b64_tr_b16 a[64:65], v9 offset:0
 v_mov_b32 v12, 0
 v_mfma_f32_16x16x32_bf16 v[140:143], a[80:83], a[132:135], 0
 ds_read_b64_tr_b16 a[66:67], v9 offset:4096
 global_load_dword a248, v12, s[90:91] offset:128 sc1
 v_mfma_f32_16x16x32_bf16 v[140:143], a[84:87], a[140:143], v[140:143]
 s_add_u32 s38, s38, s39
 ds_read_b64_tr_b16 a[68:69], v9 offset:16384
 v_and_b32 v12, 11, v0
 v_mfma_f32_16x16x32_bf16 v[140:143], a[88:91], a[148:151], v[140:143]
 s_add_u32 m0, s29, 159744
 ds_read_b64_tr_b16 a[70:71], v9 offset:20480
 v_xor_b32 v10, 65824, v6
 v_mfma_f32_16x16x32_bf16 v[140:143], a[92:95], a[156:159], v[140:143]
 s_waitcnt lgkmcnt(6)
 ds_read_b64_tr_b16 a[72:73], v10 offset:0
 buffer_load_dwordx4 v2, s[16:19], s54 offen lds
 v_mfma_f32_16x16x32_bf16 v[148:151], a[96:99], a[128:131], 0
 s_add_u32 s59, s56, 24576
 ds_read_b64_tr_b16 a[74:75], v10 offset:4096
 v_lshlrev_b32 v12, 2, v12
 v_mfma_f32_16x16x32_bf16 v[148:151], a[100:103], a[136:139], v[148:151]
 ds_read_b64_tr_b16 a[76:77], v10 offset:16384
 buffer_store_dwordx4 v[160:163], v1, s[12:15], s59 offen offset:3072 sc1
 v_mfma_f32_16x16x32_bf16 v[148:151], a[104:107], a[144:147], v[148:151]
 s_waitcnt lgkmcnt(7)
 ds_read_b64_tr_b16 a[78:79], v10 offset:20480
 v_xor_b32 v7, 320, v6
 v_mfma_f32_16x16x32_bf16 v[148:151], a[108:111], a[152:155], v[148:151]
 s_mul_i32 s38, s38, 896
 ds_read_b64_tr_b16 a[80:81], v7 offset:0
 v_mfma_f32_16x16x32_bf16 v[156:159], a[96:99], a[132:135], 0
 s_lshl_b32 s39, s37, 7
 ds_read_b64_tr_b16 a[82:83], v7 offset:4096
 v_mfma_f32_16x16x32_bf16 v[156:159], a[100:103], a[140:143], v[156:159]
 s_add_u32 s38, s38, s39
 ds_read_b64_tr_b16 a[84:85], v7 offset:16384
 v_mfma_f32_16x16x32_bf16 v[156:159], a[104:107], a[148:151], v[156:159]
 s_add_u32 s59, s56, 16384
 ds_read_b64_tr_b16 a[86:87], v7 offset:20480
 v_xor_b32 v8, 65856, v6
 v_mfma_f32_16x16x32_bf16 v[156:159], a[108:111], a[156:159], v[156:159]
 s_waitcnt lgkmcnt(6)
 ds_read_b64_tr_b16 a[88:89], v8 offset:0
 v_mfma_f32_16x16x32_bf16 v[164:167], a[64:67], a[128:131], 0
 ds_read_b64_tr_b16 a[90:91], v8 offset:4096
 buffer_store_dwordx4 v[168:171], v1, s[12:15], s59 offen offset:3072 sc1
 v_mfma_f32_16x16x32_bf16 v[164:167], a[68:71], a[136:139], v[164:167]
 s_lshl_b32 s39, s37, 9
 ds_read_b64_tr_b16 a[92:93], v8 offset:16384
 v_mfma_f32_16x16x32_bf16 v[164:167], a[72:75], a[144:147], v[164:167]
 s_waitcnt lgkmcnt(7)
 ds_read_b64_tr_b16 a[94:95], v8 offset:20480
 v_xor_b32 v9, 352, v6
 v_mfma_f32_16x16x32_bf16 v[164:167], a[76:79], a[152:155], v[164:167]
 s_mov_b32 s4, s66
 ds_read_b64_tr_b16 a[96:97], v9 offset:0
 v_mfma_f32_16x16x32_bf16 v[172:175], a[64:67], a[132:135], 0
 s_mov_b32 s5, s67
 ds_read_b64_tr_b16 a[98:99], v9 offset:4096
 v_mfma_f32_16x16x32_bf16 v[172:175], a[68:71], a[140:143], v[172:175]
 s_mov_b32 s6, 1835008
 ds_read_b64_tr_b16 a[100:101], v9 offset:16384
 v_mfma_f32_16x16x32_bf16 v[172:175], a[72:75], a[148:151], v[172:175]
 s_add_u32 s59, s56, 8192
 ds_read_b64_tr_b16 a[102:103], v9 offset:20480
 v_xor_b32 v10, 65888, v6
 v_mfma_f32_16x16x32_bf16 v[172:175], a[76:79], a[156:159], v[172:175]
 s_waitcnt lgkmcnt(6)
 ds_read_b64_tr_b16 a[104:105], v10 offset:0
 buffer_store_dwordx4 v[176:179], v1, s[12:15], s59 offen offset:3072 sc1
 v_mfma_f32_16x16x32_bf16 v[180:183], a[80:83], a[128:131], 0
 s_mov_b32 s7, 0x20000
 ds_read_b64_tr_b16 a[106:107], v10 offset:4096
 v_mfma_f32_16x16x32_bf16 v[180:183], a[84:87], a[136:139], v[180:183]
 s_mov_b32 s8, s68
 ds_read_b64_tr_b16 a[108:109], v10 offset:16384
 v_mfma_f32_16x16x32_bf16 v[180:183], a[88:91], a[144:147], v[180:183]
 s_waitcnt lgkmcnt(7)
 ds_read_b64_tr_b16 a[110:111], v10 offset:20480
 v_xor_b32 v7, 384, v6
 v_mfma_f32_16x16x32_bf16 v[180:183], a[92:95], a[152:155], v[180:183]
 s_mov_b32 s9, s69
 ds_read_b64_tr_b16 a[64:65], v7 offset:0
 v_mfma_f32_16x16x32_bf16 v[188:191], a[80:83], a[132:135], 0
 s_mov_b32 s10, 1835008
 ds_read_b64_tr_b16 a[66:67], v7 offset:4096
 v_mfma_f32_16x16x32_bf16 v[188:191], a[84:87], a[140:143], v[188:191]
 s_mov_b32 s11, 0x20000
 ds_read_b64_tr_b16 a[68:69], v7 offset:16384
 v_mfma_f32_16x16x32_bf16 v[188:191], a[88:91], a[148:151], v[188:191]
 s_add_u32 s59, s56, 0
 ds_read_b64_tr_b16 a[70:71], v7 offset:20480
 v_xor_b32 v8, 65920, v6
 v_mfma_f32_16x16x32_bf16 v[188:191], a[92:95], a[156:159], v[188:191]
 s_waitcnt lgkmcnt(6)
 ds_read_b64_tr_b16 a[72:73], v8 offset:0
 buffer_store_dwordx4 v[184:187], v1, s[12:15], s59 offen offset:3072 sc1
 v_mfma_f32_16x16x32_bf16 v[196:199], a[96:99], a[128:131], 0
 s_mov_b32 s20, s70
 ds_read_b64_tr_b16 a[74:75], v8 offset:4096
 v_mfma_f32_16x16x32_bf16 v[196:199], a[100:103], a[136:139], v[196:199]
 s_mov_b32 s21, s71
 ds_read_b64_tr_b16 a[76:77], v8 offset:16384
 v_mfma_f32_16x16x32_bf16 v[196:199], a[104:107], a[144:147], v[196:199]
 s_waitcnt lgkmcnt(7)
 ds_read_b64_tr_b16 a[78:79], v8 offset:20480
 v_xor_b32 v9, 416, v6
 v_mfma_f32_16x16x32_bf16 v[196:199], a[108:111], a[152:155], v[196:199]
 s_mov_b32 s22, 3584
 ds_read_b64_tr_b16 a[80:81], v9 offset:0
 v_mfma_f32_16x16x32_bf16 v[204:207], a[96:99], a[132:135], 0
 s_mov_b32 s23, 0x20000
 ds_read_b64_tr_b16 a[82:83], v9 offset:4096
 v_mfma_f32_16x16x32_bf16 v[204:207], a[100:103], a[140:143], v[204:207]
 ds_read_b64_tr_b16 a[84:85], v9 offset:16384
 v_lshrrev_b32 v120, 3, v0
 v_mfma_f32_16x16x32_bf16 v[204:207], a[104:107], a[148:151], v[204:207]
 s_add_u32 s59, s56, 57344
 ds_read_b64_tr_b16 a[86:87], v9 offset:20480
 v_xor_b32 v10, 65952, v6
 v_mfma_f32_16x16x32_bf16 v[204:207], a[108:111], a[156:159], v[204:207]
 s_waitcnt lgkmcnt(6)
 ds_read_b64_tr_b16 a[88:89], v10 offset:0
 buffer_store_dwordx4 v[192:195], v1, s[12:15], s59 offen offset:2048 sc1
 v_mfma_f32_16x16x32_bf16 v[212:215], a[64:67], a[128:131], 0
 ds_read_b64_tr_b16 a[90:91], v10 offset:4096
 v_mul_u32_u24 v120, 1792, v120
 v_mfma_f32_16x16x32_bf16 v[212:215], a[68:71], a[136:139], v[212:215]
 ds_read_b64_tr_b16 a[92:93], v10 offset:16384
 v_and_b32 v121, 7, v0
 v_mfma_f32_16x16x32_bf16 v[212:215], a[72:75], a[144:147], v[212:215]
 s_waitcnt lgkmcnt(7)
 ds_read_b64_tr_b16 a[94:95], v10 offset:20480
 v_xor_b32 v7, 448, v6
 v_mfma_f32_16x16x32_bf16 v[212:215], a[76:79], a[152:155], v[212:215]
 ds_read_b64_tr_b16 a[96:97], v7 offset:0
 v_lshl_add_u32 v120, v121, 4, v120
 v_mfma_f32_16x16x32_bf16 v[220:223], a[64:67], a[132:135], 0
 ds_read_b64_tr_b16 a[98:99], v7 offset:4096
 v_add_u32 v120, s38, v120
 v_mfma_f32_16x16x32_bf16 v[220:223], a[68:71], a[140:143], v[220:223]
 ds_read_b64_tr_b16 a[100:101], v7 offset:16384
 v_lshlrev_b32 v121, 6, v121
 v_mfma_f32_16x16x32_bf16 v[220:223], a[72:75], a[148:151], v[220:223]
 s_add_u32 s59, s56, 49152
 ds_read_b64_tr_b16 a[102:103], v7 offset:20480
 v_xor_b32 v8, 65984, v6
 v_mfma_f32_16x16x32_bf16 v[220:223], a[76:79], a[156:159], v[220:223]
 s_waitcnt lgkmcnt(6)
 ds_read_b64_tr_b16 a[104:105], v8 offset:0
 buffer_store_dwordx4 v[200:203], v1, s[12:15], s59 offen offset:2048 sc1
 v_mfma_f32_16x16x32_bf16 v[228:231], a[80:83], a[128:131], 0
 ds_read_b64_tr_b16 a[106:107], v8 offset:4096
 v_subrev_u32 v122, 2688, v120
 v_mfma_f32_16x16x32_bf16 v[228:231], a[84:87], a[136:139], v[228:231]
 ds_read_b64_tr_b16 a[108:109], v8 offset:16384
 v_subrev_u32 v123, 1792, v120
 v_mfma_f32_16x16x32_bf16 v[228:231], a[88:91], a[144:147], v[228:231]
 s_waitcnt lgkmcnt(7)
 ds_read_b64_tr_b16 a[110:111], v8 offset:20480
 v_xor_b32 v9, 480, v6
 v_mfma_f32_16x16x32_bf16 v[228:231], a[92:95], a[152:155], v[228:231]
 ds_read_b64_tr_b16 a[64:65], v9 offset:0
 v_subrev_u32 v128, 896, v120
 v_mfma_f32_16x16x32_bf16 v[236:239], a[80:83], a[132:135], 0
 ds_read_b64_tr_b16 a[66:67], v9 offset:4096
 v_mfma_f32_16x16x32_bf16 v[236:239], a[84:87], a[140:143], v[236:239]
 ds_read_b64_tr_b16 a[68:69], v9 offset:16384
 v_mfma_f32_16x16x32_bf16 v[236:239], a[88:91], a[148:151], v[236:239]
 s_add_u32 s59, s56, 40960
 ds_read_b64_tr_b16 a[70:71], v9 offset:20480
 v_xor_b32 v10, 66016, v6
 v_mfma_f32_16x16x32_bf16 v[236:239], a[92:95], a[156:159], v[236:239]
 s_waitcnt lgkmcnt(6)
 ds_read_b64_tr_b16 a[72:73], v10 offset:0
 buffer_store_dwordx4 v[208:211], v1, s[12:15], s59 offen offset:2048 sc1
 v_mfma_f32_16x16x32_bf16 v[244:247], a[96:99], a[128:131], 0
 ds_read_b64_tr_b16 a[74:75], v10 offset:4096
 v_mfma_f32_16x16x32_bf16 v[244:247], a[100:103], a[136:139], v[244:247]
 s_waitcnt vmcnt(25)
 ds_read_b64_tr_b16 a[76:77], v10 offset:16384
 v_xor_b32 v7, 32768, v6
 v_mfma_f32_16x16x32_bf16 v[244:247], a[104:107], a[144:147], v[244:247]
 s_waitcnt lgkmcnt(7)
 s_barrier
 ds_read_b64_tr_b16 a[78:79], v10 offset:20480
 v_mfma_f32_16x16x32_bf16 v[244:247], a[108:111], a[152:155], v[244:247]
 ds_read_b64_tr_b16 a[80:81], v7 offset:0
 v_mfma_f32_16x16x32_bf16 v[252:255], a[96:99], a[132:135], 0
 ds_read_b64_tr_b16 a[82:83], v7 offset:4096
 v_mfma_f32_16x16x32_bf16 v[252:255], a[100:103], a[140:143], v[252:255]
 ds_read_b64_tr_b16 a[84:85], v7 offset:16384
 v_mfma_f32_16x16x32_bf16 v[252:255], a[104:107], a[148:151], v[252:255]
 s_add_u32 s59, s56, 32768
 ds_read_b64_tr_b16 a[86:87], v7 offset:20480
 v_xor_b32 v8, 98304, v6
 v_mfma_f32_16x16x32_bf16 v[252:255], a[108:111], a[156:159], v[252:255]
 s_waitcnt lgkmcnt(6)
 ds_read_b64_tr_b16 a[88:89], v8 offset:0
 buffer_store_dwordx4 v[216:219], v1, s[12:15], s59 offen offset:2048 sc1
 v_mfma_f32_16x16x32_bf16 v[16:19], a[64:67], a[128:131], 0
 ds_read_b64_tr_b16 a[90:91], v8 offset:4096
 v_mfma_f32_16x16x32_bf16 v[16:19], a[68:71], a[136:139], v[16:19]
 ds_read_b64_tr_b16 a[92:93], v8 offset:16384
 v_mfma_f32_16x16x32_bf16 v[16:19], a[72:75], a[144:147], v[16:19]
 s_waitcnt lgkmcnt(7)
 ds_read_b64_tr_b16 a[94:95], v8 offset:20480
 v_xor_b32 v9, 32800, v6
 v_mfma_f32_16x16x32_bf16 v[16:19], a[76:79], a[152:155], v[16:19]
 ds_read_b64_tr_b16 a[96:97], v9 offset:0
 v_mfma_f32_16x16x32_bf16 v[24:27], a[64:67], a[132:135], 0
 s_waitcnt lgkmcnt(9)
 ds_read_b64_tr_b16 a[98:99], v9 offset:4096
 v_mfma_f32_16x16x32_bf16 v[24:27], a[68:71], a[140:143], v[24:27]
 s_barrier
 ds_read_b64_tr_b16 a[100:101], v9 offset:16384
 v_mfma_f32_16x16x32_bf16 v[24:27], a[72:75], a[148:151], v[24:27]
 s_add_u32 m0, s29, 0
 ds_read_b64_tr_b16 a[102:103], v9 offset:20480
 v_xor_b32 v10, 98336, v6
 v_mfma_f32_16x16x32_bf16 v[24:27], a[76:79], a[156:159], v[24:27]
 s_waitcnt lgkmcnt(6)
 ds_read_b64_tr_b16 a[104:105], v10 offset:0
 v_add_u32 v2, 0x80000, v2
 v_mfma_f32_16x16x32_bf16 v[28:31], a[80:83], a[160:163], v[28:31]
 ds_read_b64_tr_b16 a[106:107], v10 offset:4096
 buffer_load_dwordx4 v2, s[16:19], 0 offen lds
 v_mfma_f32_16x16x32_bf16 v[28:31], a[84:87], a[168:171], v[28:31]
 s_add_u32 s59, s56, 57344
 ds_read_b64_tr_b16 a[108:109], v10 offset:16384
 v_mfma_f32_16x16x32_bf16 v[28:31], a[88:91], a[176:179], v[28:31]
 s_waitcnt lgkmcnt(7)
 ds_read_b64_tr_b16 a[110:111], v10 offset:20480
 v_xor_b32 v7, 32832, v6
 v_mfma_f32_16x16x32_bf16 v[28:31], a[92:95], a[184:187], v[28:31]
 ds_read_b64_tr_b16 a[64:65], v7 offset:0
 buffer_store_dwordx4 v[224:227], v1, s[12:15], s59 offen offset:3072 sc1
 v_mfma_f32_16x16x32_bf16 v[44:47], a[80:83], a[164:167], v[44:47]
 s_add_u32 m0, s29, 4096
 ds_read_b64_tr_b16 a[66:67], v7 offset:4096
 v_add_u32 v4, 4096, v1
 v_mfma_f32_16x16x32_bf16 v[44:47], a[84:87], a[172:175], v[44:47]
 ds_read_b64_tr_b16 a[68:69], v7 offset:16384
 buffer_load_dwordx4 v2, s[16:19], s48 offen lds
 v_mfma_f32_16x16x32_bf16 v[44:47], a[88:91], a[180:183], v[44:47]
 ds_read_b64_tr_b16 a[70:71], v7 offset:20480
 v_xor_b32 v8, 98368, v6
 v_mfma_f32_16x16x32_bf16 v[44:47], a[92:95], a[188:191], v[44:47]
 s_waitcnt lgkmcnt(6)
 ds_read_b64_tr_b16 a[72:73], v8 offset:0
 v_mfma_f32_16x16x32_bf16 v[52:55], a[96:99], a[160:163], v[52:55]
 ds_read_b64_tr_b16 a[74:75], v8 offset:4096
 v_mfma_f32_16x16x32_bf16 v[52:55], a[100:103], a[168:171], v[52:55]
 s_add_u32 m0, s29, 8192
 ds_read_b64_tr_b16 a[76:77], v8 offset:16384
 v_mfma_f32_16x16x32_bf16 v[52:55], a[104:107], a[176:179], v[52:55]
 s_waitcnt lgkmcnt(7)
 ds_read_b64_tr_b16 a[78:79], v8 offset:20480
 v_xor_b32 v9, 32864, v6
 v_mfma_f32_16x16x32_bf16 v[52:55], a[108:111], a[184:187], v[52:55]
 ds_read_b64_tr_b16 a[80:81], v9 offset:0
 buffer_load_dwordx4 v2, s[16:19], s49 offen lds
 v_mfma_f32_16x16x32_bf16 v[60:63], a[96:99], a[164:167], v[60:63]
 s_add_u32 s59, s56, 49152
 ds_read_b64_tr_b16 a[82:83], v9 offset:4096
 v_mfma_f32_16x16x32_bf16 v[60:63], a[100:103], a[172:175], v[60:63]
 ds_read_b64_tr_b16 a[84:85], v9 offset:16384
 buffer_store_dwordx4 v[232:235], v1, s[12:15], s59 offen offset:3072 sc1
 v_mfma_f32_16x16x32_bf16 v[60:63], a[104:107], a[180:183], v[60:63]
 s_add_u32 m0, s29, 12288
 ds_read_b64_tr_b16 a[86:87], v9 offset:20480
 v_xor_b32 v10, 98400, v6
 v_mfma_f32_16x16x32_bf16 v[60:63], a[108:111], a[188:191], v[60:63]
 s_waitcnt lgkmcnt(6)
 ds_read_b64_tr_b16 a[88:89], v10 offset:0
 v_mfma_f32_16x16x32_bf16 v[20:23], a[64:67], a[160:163], v[20:23]
 ds_read_b64_tr_b16 a[90:91], v10 offset:4096
 buffer_load_dwordx4 v2, s[16:19], s50 offen lds
 v_mfma_f32_16x16x32_bf16 v[20:23], a[68:71], a[168:171], v[20:23]
 ds_read_b64_tr_b16 a[92:93], v10 offset:16384
 v_mfma_f32_16x16x32_bf16 v[20:23], a[72:75], a[176:179], v[20:23]
 s_waitcnt lgkmcnt(7)
 ds_read_b64_tr_b16 a[94:95], v10 offset:20480
 v_xor_b32 v7, 32896, v6
 v_mfma_f32_16x16x32_bf16 v[20:23], a[76:79], a[184:187], v[20:23]
 ds_read_b64_tr_b16 a[96:97], v7 offset:0
 v_mfma_f32_16x16x32_bf16 v[36:39], a[64:67], a[164:167], v[36:39]
 s_add_u32 m0, s29, 16384
 ds_read_b64_tr_b16 a[98:99], v7 offset:4096
 v_mfma_f32_16x16x32_bf16 v[36:39], a[68:71], a[172:175], v[36:39]
 ds_read_b64_tr_b16 a[100:101], v7 offset:16384
 buffer_load_dwordx4 v2, s[16:19], s51 offen lds
 v_mfma_f32_16x16x32_bf16 v[36:39], a[72:75], a[180:183], v[36:39]
 s_add_u32 s59, s56, 40960
 ds_read_b64_tr_b16 a[102:103], v7 offset:20480
 v_xor_b32 v8, 98432, v6
 v_mfma_f32_16x16x32_bf16 v[36:39], a[76:79], a[188:191], v[36:39]
 s_waitcnt lgkmcnt(6)
 ds_read_b64_tr_b16 a[104:105], v8 offset:0
 buffer_store_dwordx4 v[240:243], v1, s[12:15], s59 offen offset:3072 sc1
 v_mfma_f32_16x16x32_bf16 v[68:71], a[80:83], a[160:163], v[68:71]
 ds_read_b64_tr_b16 a[106:107], v8 offset:4096
 v_mfma_f32_16x16x32_bf16 v[68:71], a[84:87], a[168:171], v[68:71]
 s_add_u32 m0, s29, 20480
 ds_read_b64_tr_b16 a[108:109], v8 offset:16384
 v_mfma_f32_16x16x32_bf16 v[68:71], a[88:91], a[176:179], v[68:71]
 s_waitcnt lgkmcnt(7)
 ds_read_b64_tr_b16 a[110:111], v8 offset:20480
 v_xor_b32 v9, 32928, v6
 v_mfma_f32_16x16x32_bf16 v[68:71], a[92:95], a[184:187], v[68:71]
 ds_read_b64_tr_b16 a[64:65], v9 offset:0
 buffer_load_dwordx4 v2, s[16:19], s52 offen lds
 v_mfma_f32_16x16x32_bf16 v[76:79], a[80:83], a[164:167], v[76:79]
 ds_read_b64_tr_b16 a[66:67], v9 offset:4096
 v_mfma_f32_16x16x32_bf16 v[76:79], a[84:87], a[172:175], v[76:79]
 ds_read_b64_tr_b16 a[68:69], v9 offset:16384
 v_mfma_f32_16x16x32_bf16 v[76:79], a[88:91], a[180:183], v[76:79]
 s_add_u32 m0, s29, 24576
 ds_read_b64_tr_b16 a[70:71], v9 offset:20480
 v_xor_b32 v10, 98464, v6
 v_mfma_f32_16x16x32_bf16 v[76:79], a[92:95], a[188:191], v[76:79]
 s_waitcnt lgkmcnt(6)
 ds_read_b64_tr_b16 a[72:73], v10 offset:0
 v_mfma_f32_16x16x32_bf16 v[84:87], a[96:99], a[160:163], v[84:87]
 ds_read_b64_tr_b16 a[74:75], v10 offset:4096
 buffer_load_dwordx4 v2, s[16:19], s53 offen lds
 v_mfma_f32_16x16x32_bf16 v[84:87], a[100:103], a[168:171], v[84:87]
 s_add_u32 s59, s56, 32768
 ds_read_b64_tr_b16 a[76:77], v10 offset:16384
 v_mfma_f32_16x16x32_bf16 v[84:87], a[104:107], a[176:179], v[84:87]
 s_waitcnt lgkmcnt(7)
 ds_read_b64_tr_b16 a[78:79], v10 offset:20480
 v_xor_b32 v7, 32960, v6
 v_mfma_f32_16x16x32_bf16 v[84:87], a[108:111], a[184:187], v[84:87]
 ds_read_b64_tr_b16 a[80:81], v7 offset:0
 buffer_store_dwordx4 v[248:251], v1, s[12:15], s59 offen offset:3072 sc1
 v_mfma_f32_16x16x32_bf16 v[92:95], a[96:99], a[164:167], v[92:95]
 s_add_u32 m0, s29, 28672
 ds_read_b64_tr_b16 a[82:83], v7 offset:4096
 v_mfma_f32_16x16x32_bf16 v[92:95], a[100:103], a[172:175], v[92:95]
 ds_read_b64_tr_b16 a[84:85], v7 offset:16384
 buffer_load_dwordx4 v2, s[16:19], s54 offen lds
 v_mfma_f32_16x16x32_bf16 v[92:95], a[104:107], a[180:183], v[92:95]
 ds_read_b64_tr_b16 a[86:87], v7 offset:20480
 v_xor_b32 v8, 98496, v6
 v_mfma_f32_16x16x32_bf16 v[92:95], a[108:111], a[188:191], v[92:95]
 s_waitcnt lgkmcnt(6)
 ds_read_b64_tr_b16 a[88:89], v8 offset:0
 v_mfma_f32_16x16x32_bf16 v[100:103], a[64:67], a[160:163], v[100:103]
 s_add_u32 m0, s29, 65536
 ds_read_b64_tr_b16 a[90:91], v8 offset:4096
 v_add_u32 v2, 0x80000, v2
 v_mfma_f32_16x16x32_bf16 v[100:103], a[68:71], a[168:171], v[100:103]
 ds_read_b64_tr_b16 a[92:93], v8 offset:16384
 buffer_load_dwordx4 v2, s[16:19], 0 offen lds
 v_mfma_f32_16x16x32_bf16 v[100:103], a[72:75], a[176:179], v[100:103]
 s_waitcnt lgkmcnt(7)
 ds_read_b64_tr_b16 a[94:95], v8 offset:20480
 v_xor_b32 v9, 32992, v6
 v_mfma_f32_16x16x32_bf16 v[100:103], a[76:79], a[184:187], v[100:103]
 ds_read_b64_tr_b16 a[96:97], v9 offset:0
 v_mfma_f32_16x16x32_bf16 v[108:111], a[64:67], a[164:167], v[108:111]
 ds_read_b64_tr_b16 a[98:99], v9 offset:4096
 v_mfma_f32_16x16x32_bf16 v[108:111], a[68:71], a[172:175], v[108:111]
 ds_read_b64_tr_b16 a[100:101], v9 offset:16384
 v_mfma_f32_16x16x32_bf16 v[108:111], a[72:75], a[180:183], v[108:111]
 s_add_u32 m0, s29, 69632
 ds_read_b64_tr_b16 a[102:103], v9 offset:20480
 v_xor_b32 v10, 98528, v6
 v_mfma_f32_16x16x32_bf16 v[108:111], a[76:79], a[188:191], v[108:111]
 s_waitcnt lgkmcnt(6)
 ds_read_b64_tr_b16 a[104:105], v10 offset:0
 buffer_load_dwordx4 v2, s[16:19], s48 offen lds
 v_mfma_f32_16x16x32_bf16 v[116:119], a[80:83], a[160:163], v[116:119]
 ds_read_b64_tr_b16 a[106:107], v10 offset:4096
 v_mfma_f32_16x16x32_bf16 v[116:119], a[84:87], a[168:171], v[116:119]
 ds_read_b64_tr_b16 a[108:109], v10 offset:16384
 v_mfma_f32_16x16x32_bf16 v[116:119], a[88:91], a[176:179], v[116:119]
 s_waitcnt lgkmcnt(7)
 ds_read_b64_tr_b16 a[110:111], v10 offset:20480
 v_xor_b32 v7, 33024, v6
 v_mfma_f32_16x16x32_bf16 v[116:119], a[92:95], a[184:187], v[116:119]
 s_add_u32 m0, s29, 73728
 ds_read_b64_tr_b16 a[64:65], v7 offset:0
 v_mfma_f32_16x16x32_bf16 v[124:127], a[80:83], a[164:167], v[124:127]
 ds_read_b64_tr_b16 a[66:67], v7 offset:4096
 buffer_load_dwordx4 v2, s[16:19], s49 offen lds
 v_mfma_f32_16x16x32_bf16 v[124:127], a[84:87], a[172:175], v[124:127]
 ds_read_b64_tr_b16 a[68:69], v7 offset:16384
 v_mfma_f32_16x16x32_bf16 v[124:127], a[88:91], a[180:183], v[124:127]
 ds_read_b64_tr_b16 a[70:71], v7 offset:20480
 v_xor_b32 v8, 98560, v6
 v_mfma_f32_16x16x32_bf16 v[124:127], a[92:95], a[188:191], v[124:127]
 s_waitcnt lgkmcnt(6)
 ds_read_b64_tr_b16 a[72:73], v8 offset:0
 v_mfma_f32_16x16x32_bf16 v[132:135], a[96:99], a[160:163], v[132:135]
 s_add_u32 m0, s29, 77824
 ds_read_b64_tr_b16 a[74:75], v8 offset:4096
 v_mfma_f32_16x16x32_bf16 v[132:135], a[100:103], a[168:171], v[132:135]
 ds_read_b64_tr_b16 a[76:77], v8 offset:16384
 buffer_load_dwordx4 v2, s[16:19], s50 offen lds
 v_mfma_f32_16x16x32_bf16 v[132:135], a[104:107], a[176:179], v[132:135]
 s_waitcnt lgkmcnt(7)
 ds_read_b64_tr_b16 a[78:79], v8 offset:20480
 v_xor_b32 v9, 33056, v6
 v_mfma_f32_16x16x32_bf16 v[132:135], a[108:111], a[184:187], v[132:135]
 ds_read_b64_tr_b16 a[80:81], v9 offset:0
 v_mfma_f32_16x16x32_bf16 v[140:143], a[96:99], a[164:167], v[140:143]
 ds_read_b64_tr_b16 a[82:83], v9 offset:4096
 v_mfma_f32_16x16x32_bf16 v[140:143], a[100:103], a[172:175], v[140:143]
 ds_read_b64_tr_b16 a[84:85], v9 offset:16384
 v_mfma_f32_16x16x32_bf16 v[140:143], a[104:107], a[180:183], v[140:143]
 s_add_u32 m0, s29, 81920
 ds_read_b64_tr_b16 a[86:87], v9 offset:20480
 v_xor_b32 v10, 98592, v6
 v_mfma_f32_16x16x32_bf16 v[140:143], a[108:111], a[188:191], v[140:143]
 s_waitcnt lgkmcnt(6)
 ds_read_b64_tr_b16 a[88:89], v10 offset:0
 buffer_load_dwordx4 v2, s[16:19], s51 offen lds
 v_mfma_f32_16x16x32_bf16 v[148:151], a[64:67], a[160:163], v[148:151]
 ds_read_b64_tr_b16 a[90:91], v10 offset:4096
 v_mfma_f32_16x16x32_bf16 v[148:151], a[68:71], a[168:171], v[148:151]
 ds_read_b64_tr_b16 a[92:93], v10 offset:16384
 v_mfma_f32_16x16x32_bf16 v[148:151], a[72:75], a[176:179], v[148:151]
 s_waitcnt lgkmcnt(7)
 ds_read_b64_tr_b16 a[94:95], v10 offset:20480
 v_xor_b32 v7, 33088, v6
 v_mfma_f32_16x16x32_bf16 v[148:151], a[76:79], a[184:187], v[148:151]
 s_add_u32 m0, s29, 86016
 ds_read_b64_tr_b16 a[96:97], v7 offset:0
 v_mfma_f32_16x16x32_bf16 v[156:159], a[64:67], a[164:167], v[156:159]
 ds_read_b64_tr_b16 a[98:99], v7 offset:4096
 buffer_load_dwordx4 v2, s[16:19], s52 offen lds
 v_mfma_f32_16x16x32_bf16 v[156:159], a[68:71], a[172:175], v[156:159]
 ds_read_b64_tr_b16 a[100:101], v7 offset:16384
 v_mfma_f32_16x16x32_bf16 v[156:159], a[72:75], a[180:183], v[156:159]
 ds_read_b64_tr_b16 a[102:103], v7 offset:20480
 v_xor_b32 v8, 98624, v6
 v_mfma_f32_16x16x32_bf16 v[156:159], a[76:79], a[188:191], v[156:159]
 s_waitcnt lgkmcnt(6)
 ds_read_b64_tr_b16 a[104:105], v8 offset:0
 v_mfma_f32_16x16x32_bf16 v[164:167], a[80:83], a[160:163], v[164:167]
 s_add_u32 m0, s29, 90112
 ds_read_b64_tr_b16 a[106:107], v8 offset:4096
 v_mfma_f32_16x16x32_bf16 v[164:167], a[84:87], a[168:171], v[164:167]
 ds_read_b64_tr_b16 a[108:109], v8 offset:16384
 buffer_load_dwordx4 v2, s[16:19], s53 offen lds
 v_mfma_f32_16x16x32_bf16 v[164:167], a[88:91], a[176:179], v[164:167]
 s_waitcnt lgkmcnt(7)
 ds_read_b64_tr_b16 a[110:111], v8 offset:20480
 v_xor_b32 v9, 33120, v6
 v_mfma_f32_16x16x32_bf16 v[164:167], a[92:95], a[184:187], v[164:167]
 s_waitcnt vmcnt(8)
 ds_read_b64_tr_b16 a[64:65], v9 offset:0
 v_mfma_f32_16x16x32_bf16 v[172:175], a[80:83], a[164:167], v[172:175]
 s_barrier
 ds_read_b64_tr_b16 a[66:67], v9 offset:4096
 v_mfma_f32_16x16x32_bf16 v[172:175], a[84:87], a[172:175], v[172:175]
 ds_read_b64_tr_b16 a[68:69], v9 offset:16384
 buffer_store_dword v11, v11, s[12:15], s92 offen sc1
 v_mfma_f32_16x16x32_bf16 v[172:175], a[88:91], a[180:183], v[172:175]
 s_add_u32 m0, s29, 94208
 ds_read_b64_tr_b16 a[70:71], v9 offset:20480
 v_xor_b32 v10, 98656, v6
 v_mfma_f32_16x16x32_bf16 v[172:175], a[92:95], a[188:191], v[172:175]
 s_waitcnt lgkmcnt(6)
 ds_read_b64_tr_b16 a[72:73], v10 offset:0
 buffer_load_dwordx4 v2, s[16:19], s54 offen lds
 v_mfma_f32_16x16x32_bf16 v[180:183], a[96:99], a[160:163], v[180:183]
 ds_read_b64_tr_b16 a[74:75], v10 offset:4096
 v_mfma_f32_16x16x32_bf16 v[180:183], a[100:103], a[168:171], v[180:183]
 ds_read_b64_tr_b16 a[76:77], v10 offset:16384
 v_mfma_f32_16x16x32_bf16 v[180:183], a[104:107], a[176:179], v[180:183]
 s_waitcnt lgkmcnt(7)
 ds_read_b64_tr_b16 a[78:79], v10 offset:20480
 v_xor_b32 v7, 33152, v6
 v_mfma_f32_16x16x32_bf16 v[180:183], a[108:111], a[184:187], v[180:183]
 ds_read_b64_tr_b16 a[80:81], v7 offset:0
 v_mfma_f32_16x16x32_bf16 v[188:191], a[96:99], a[164:167], v[188:191]
 ds_read_b64_tr_b16 a[82:83], v7 offset:4096
 v_mfma_f32_16x16x32_bf16 v[188:191], a[100:103], a[172:175], v[188:191]
 ds_read_b64_tr_b16 a[84:85], v7 offset:16384
 v_mfma_f32_16x16x32_bf16 v[188:191], a[104:107], a[180:183], v[188:191]
 ds_read_b64_tr_b16 a[86:87], v7 offset:20480
 v_xor_b32 v8, 98688, v6
 v_mfma_f32_16x16x32_bf16 v[188:191], a[108:111], a[188:191], v[188:191]
 s_waitcnt lgkmcnt(6)
 ds_read_b64_tr_b16 a[88:89], v8 offset:0
 v_mfma_f32_16x16x32_bf16 v[196:199], a[64:67], a[160:163], v[196:199]
 s_and_b32 s58, s92, ~127
 ds_read_b64_tr_b16 a[90:91], v8 offset:4096
 v_mfma_f32_16x16x32_bf16 v[196:199], a[68:71], a[168:171], v[196:199]
 s_lshl_b32 s37, s25, 1
 ds_read_b64_tr_b16 a[92:93], v8 offset:16384
 v_mfma_f32_16x16x32_bf16 v[196:199], a[72:75], a[176:179], v[196:199]
 s_waitcnt lgkmcnt(7)
 ds_read_b64_tr_b16 a[94:95], v8 offset:20480
 v_xor_b32 v9, 33184, v6
 v_mfma_f32_16x16x32_bf16 v[196:199], a[76:79], a[184:187], v[196:199]
 s_sub_i32 s38, 13, s37
 ds_read_b64_tr_b16 a[96:97], v9 offset:0
 v_mfma_f32_16x16x32_bf16 v[204:207], a[64:67], a[164:167], v[204:207]
 s_max_i32 s38, s38, 0
 ds_read_b64_tr_b16 a[98:99], v9 offset:4096
 v_mfma_f32_16x16x32_bf16 v[204:207], a[68:71], a[172:175], v[204:207]
 s_lshl_b32 s49, s26, 20
 ds_read_b64_tr_b16 a[100:101], v9 offset:16384
 v_mfma_f32_16x16x32_bf16 v[204:207], a[72:75], a[180:183], v[204:207]
 s_lshl_b32 s50, s3, 13
 ds_read_b64_tr_b16 a[102:103], v9 offset:20480
 v_xor_b32 v10, 98720, v6
 v_mfma_f32_16x16x32_bf16 v[204:207], a[76:79], a[188:191], v[204:207]
 s_waitcnt lgkmcnt(6)
 ds_read_b64_tr_b16 a[104:105], v10 offset:0
 v_mfma_f32_16x16x32_bf16 v[212:215], a[80:83], a[160:163], v[212:215]
 s_add_u32 s49, s49, s50
 ds_read_b64_tr_b16 a[106:107], v10 offset:4096
 v_mfma_f32_16x16x32_bf16 v[212:215], a[84:87], a[168:171], v[212:215]
 s_mov_b32 s54, 0
 ds_read_b64_tr_b16 a[108:109], v10 offset:16384
 v_mfma_f32_16x16x32_bf16 v[212:215], a[88:91], a[176:179], v[212:215]
 s_waitcnt lgkmcnt(7)
 ds_read_b64_tr_b16 a[110:111], v10 offset:20480
 v_xor_b32 v7, 33216, v6
 v_mfma_f32_16x16x32_bf16 v[212:215], a[92:95], a[184:187], v[212:215]
 s_add_u32 s44, s37, 1
 ds_read_b64_tr_b16 a[64:65], v7 offset:0
 v_mfma_f32_16x16x32_bf16 v[220:223], a[80:83], a[164:167], v[220:223]
 s_mov_b32 s42, s49
 ds_read_b64_tr_b16 a[66:67], v7 offset:4096
 v_mfma_f32_16x16x32_bf16 v[220:223], a[84:87], a[172:175], v[220:223]
 s_add_u32 s60, s94, 4
 ds_read_b64_tr_b16 a[68:69], v7 offset:16384
 v_mfma_f32_16x16x32_bf16 v[220:223], a[88:91], a[180:183], v[220:223]
 s_mov_b32 s45, 2
 ds_read_b64_tr_b16 a[70:71], v7 offset:20480
 v_xor_b32 v8, 98752, v6
 v_mfma_f32_16x16x32_bf16 v[220:223], a[92:95], a[188:191], v[220:223]
 s_waitcnt lgkmcnt(6)
 ds_read_b64_tr_b16 a[72:73], v8 offset:0
 buffer_load_dwordx4 v[32:35], v122, s[4:7], 0 offen
 v_mfma_f32_16x16x32_bf16 v[228:231], a[96:99], a[160:163], v[228:231]
 s_mov_b32 s66, 1
 ds_read_b64_tr_b16 a[74:75], v8 offset:4096
 v_mfma_f32_16x16x32_bf16 v[228:231], a[100:103], a[168:171], v[228:231]
 s_mov_b32 s68, 1
 ds_read_b64_tr_b16 a[76:77], v8 offset:16384
 v_mfma_f32_16x16x32_bf16 v[228:231], a[104:107], a[176:179], v[228:231]
 s_waitcnt lgkmcnt(7)
 ds_read_b64_tr_b16 a[78:79], v8 offset:20480
 v_xor_b32 v9, 33248, v6
 v_mfma_f32_16x16x32_bf16 v[228:231], a[108:111], a[184:187], v[228:231]
 ds_read_b64_tr_b16 a[80:81], v9 offset:0
 buffer_load_dwordx4 v[40:43], v123, s[4:7], 0 offen
 v_mfma_f32_16x16x32_bf16 v[236:239], a[96:99], a[164:167], v[236:239]
 s_mov_b32 s70, 0x8000
 ds_read_b64_tr_b16 a[82:83], v9 offset:4096
 v_mfma_f32_16x16x32_bf16 v[236:239], a[100:103], a[172:175], v[236:239]
 s_mov_b32 s71, s70
 ds_read_b64_tr_b16 a[84:85], v9 offset:16384
 v_mfma_f32_16x16x32_bf16 v[236:239], a[104:107], a[180:183], v[236:239]
 s_add_u32 s43, s42, 16777216
 ds_read_b64_tr_b16 a[86:87], v9 offset:20480
 v_xor_b32 v10, 98784, v6
 v_mfma_f32_16x16x32_bf16 v[236:239], a[108:111], a[188:191], v[236:239]
 s_waitcnt lgkmcnt(6)
 ds_read_b64_tr_b16 a[88:89], v10 offset:0
 buffer_load_dwordx4 v[48:51], v128, s[4:7], 0 offen
 v_mfma_f32_16x16x32_bf16 v[244:247], a[64:67], a[160:163], v[244:247]
 s_mov_b32 s40, s50
 ds_read_b64_tr_b16 a[90:91], v10 offset:4096
 v_mfma_f32_16x16x32_bf16 v[244:247], a[68:71], a[168:171], v[244:247]
 s_waitcnt vmcnt(3)
 ds_read_b64_tr_b16 a[92:93], v10 offset:16384
 v_xor_b32 v7, 131072, v6
 v_mfma_f32_16x16x32_bf16 v[244:247], a[72:75], a[176:179], v[244:247]
 s_waitcnt lgkmcnt(7)
 s_barrier
 ds_read_b64_tr_b16 a[94:95], v10 offset:20480
 v_mfma_f32_16x16x32_bf16 v[244:247], a[76:79], a[184:187], v[244:247]
 ds_read_b64_tr_b16 a[96:97], v7 offset:0
 buffer_load_dwordx4 v[56:59], v120, s[4:7], 0 offen offset:0
 v_mfma_f32_16x16x32_bf16 v[252:255], a[64:67], a[164:167], v[252:255]
 s_add_u32 s41, s50, 0x10000
 ds_read_b64_tr_b16 a[98:99], v7 offset:4096
 v_mfma_f32_16x16x32_bf16 v[252:255], a[68:71], a[172:175], v[252:255]
 s_lshr_b32 s61, s95, 4
 ds_read_b64_tr_b16 a[100:101], v7 offset:16384
 v_accvgpr_read_b32 v5, a248
 v_mfma_f32_16x16x32_bf16 v[252:255], a[72:75], a[180:183], v[252:255]
 s_lshl_b32 s61, s61, 7
 ds_read_b64_tr_b16 a[102:103], v7 offset:20480
 v_xor_b32 v8, 0, v6
 v_mfma_f32_16x16x32_bf16 v[252:255], a[76:79], a[188:191], v[252:255]
 s_waitcnt lgkmcnt(6)
 ds_read_b64_tr_b16 a[104:105], v8 offset:0
 buffer_load_dwordx4 v[64:67], v120, s[4:7], 0 offen offset:896
 v_mfma_f32_16x16x32_bf16 v[16:19], a[80:83], a[160:163], v[16:19]
 s_add_u32 s61, s61, 84959232
 ds_read_b64_tr_b16 a[106:107], v8 offset:4096
 v_mfma_f32_16x16x32_bf16 v[16:19], a[84:87], a[168:171], v[16:19]
 s_mov_b32 s47, 0x4b800000
 ds_read_b64_tr_b16 a[108:109], v8 offset:16384
 v_mfma_f32_16x16x32_bf16 v[16:19], a[88:91], a[176:179], v[16:19]
 s_waitcnt lgkmcnt(7)
 ds_read_b64_tr_b16 a[110:111], v8 offset:20480
 v_xor_b32 v9, 65536, v6
 v_mfma_f32_16x16x32_bf16 v[16:19], a[92:95], a[184:187], v[16:19]
 ds_read_b64_tr_b16 a[64:65], v9 offset:0
 buffer_load_dwordx4 v[72:75], v120, s[8:11], 0 offen offset:0
 v_mfma_f32_16x16x32_bf16 v[24:27], a[80:83], a[164:167], v[24:27]
 s_lshl_b32 s30, s95, 1
 ds_read_b64_tr_b16 a[66:67], v9 offset:4096
 v_mfma_f32_16x16x32_bf16 v[24:27], a[84:87], a[172:175], v[24:27]
 s_lshr_b32 s31, s3, 1
 ds_read_b64_tr_b16 a[68:69], v9 offset:16384
 v_mfma_f32_16x16x32_bf16 v[24:27], a[88:91], a[180:183], v[24:27]
 s_add_u32 s30, s30, s31
 ds_read_b64_tr_b16 a[70:71], v9 offset:20480
 v_xor_b32 v10, 131104, v6
 v_mfma_f32_16x16x32_bf16 v[24:27], a[92:95], a[188:191], v[24:27]
 s_waitcnt lgkmcnt(6)
 ds_read_b64_tr_b16 a[72:73], v10 offset:0
 buffer_load_dwordx4 v[80:83], v120, s[8:11], 0 offen offset:896
 v_mfma_f32_16x16x32_bf16 v[28:31], a[96:99], a[192:195], v[28:31]
 s_min_u32 s30, s30, 223
 ds_read_b64_tr_b16 a[74:75], v10 offset:4096
 v_mfma_f32_16x16x32_bf16 v[28:31], a[100:103], a[200:203], v[28:31]
 s_lshl_b32 s30, s30, 2
 ds_read_b64_tr_b16 a[76:77], v10 offset:16384
 v_mfma_f32_16x16x32_bf16 v[28:31], a[104:107], a[208:211], v[28:31]
 s_waitcnt lgkmcnt(3)
 ds_read_b64_tr_b16 a[78:79], v10 offset:20480
 v_xor_b32 v7, 32, v6
 v_mfma_f32_16x16x32_bf16 v[28:31], a[108:111], a[216:219], v[28:31]
 ds_read_b64_tr_b16 a[80:81], v7 offset:0
 buffer_load_dwordx4 v[88:91], v121, s[20:23], s39 offen offset:0
 v_mfma_f32_16x16x32_bf16 v[28:31], a[64:67], a[112:115], v[28:31]
 s_lshl_b32 s53, s3, 4
 ds_read_b64_tr_b16 a[82:83], v7 offset:4096
 v_mfma_f32_16x16x32_bf16 v[28:31], a[68:71], a[120:123], v[28:31]
 ds_read_b64_tr_b16 a[84:85], v7 offset:16384
 v_mfma_f32_16x16x32_bf16 v[44:47], a[96:99], a[196:199], v[44:47]
 ds_read_b64_tr_b16 a[86:87], v7 offset:20480
 v_xor_b32 v8, 65568, v6
 v_mfma_f32_16x16x32_bf16 v[44:47], a[100:103], a[204:207], v[44:47]
 ds_read_b64_tr_b16 a[88:89], v8 offset:0
 buffer_load_dwordx4 v[96:99], v121, s[20:23], s39 offen offset:16
 v_mfma_f32_16x16x32_bf16 v[44:47], a[104:107], a[212:215], v[44:47]
 ds_read_b64_tr_b16 a[90:91], v8 offset:4096
 v_mfma_f32_16x16x32_bf16 v[44:47], a[108:111], a[220:223], v[44:47]
 ds_read_b64_tr_b16 a[92:93], v8 offset:16384
 v_mfma_f32_16x16x32_bf16 v[44:47], a[64:67], a[116:119], v[44:47]
 ds_read_b64_tr_b16 a[94:95], v8 offset:20480
 v_xor_b32 v9, 131136, v6
 v_mfma_f32_16x16x32_bf16 v[44:47], a[68:71], a[124:127], v[44:47]
 s_waitcnt lgkmcnt(6)
 ds_read_b64_tr_b16 a[96:97], v9 offset:0
 buffer_load_dwordx4 v[104:107], v121, s[20:23], s39 offen offset:32
 v_mfma_f32_16x16x32_bf16 v[52:55], a[72:75], a[192:195], v[52:55]
 ds_read_b64_tr_b16 a[98:99], v9 offset:4096
 v_mfma_f32_16x16x32_bf16 v[52:55], a[76:79], a[200:203], v[52:55]
 ds_read_b64_tr_b16 a[100:101], v9 offset:16384
 v_mfma_f32_16x16x32_bf16 v[52:55], a[80:83], a[208:211], v[52:55]
 s_waitcnt lgkmcnt(3)
 ds_read_b64_tr_b16 a[102:103], v9 offset:20480
 v_xor_b32 v10, 64, v6
 v_mfma_f32_16x16x32_bf16 v[52:55], a[84:87], a[216:219], v[52:55]
 ds_read_b64_tr_b16 a[104:105], v10 offset:0
 buffer_load_dwordx4 v[112:115], v121, s[20:23], s39 offen offset:48
 v_mfma_f32_16x16x32_bf16 v[52:55], a[88:91], a[112:115], v[52:55]
 ds_read_b64_tr_b16 a[106:107], v10 offset:4096
 v_mfma_f32_16x16x32_bf16 v[52:55], a[92:95], a[120:123], v[52:55]
 ds_read_b64_tr_b16 a[108:109], v10 offset:16384
 v_mfma_f32_16x16x32_bf16 v[60:63], a[72:75], a[196:199], v[60:63]
 ds_read_b64_tr_b16 a[110:111], v10 offset:20480
 v_xor_b32 v7, 65600, v6
 v_mfma_f32_16x16x32_bf16 v[60:63], a[76:79], a[204:207], v[60:63]
 ds_read_b64_tr_b16 a[64:65], v7 offset:0
 v_mfma_f32_16x16x32_bf16 v[60:63], a[80:83], a[212:215], v[60:63]
 ds_read_b64_tr_b16 a[66:67], v7 offset:4096
 v_mfma_f32_16x16x32_bf16 v[60:63], a[84:87], a[220:223], v[60:63]
 ds_read_b64_tr_b16 a[68:69], v7 offset:16384
 v_mfma_f32_16x16x32_bf16 v[60:63], a[88:91], a[116:119], v[60:63]
 ds_read_b64_tr_b16 a[70:71], v7 offset:20480
 v_xor_b32 v8, 131168, v6
 v_mfma_f32_16x16x32_bf16 v[60:63], a[92:95], a[124:127], v[60:63]
 s_waitcnt lgkmcnt(6)
 ds_read_b64_tr_b16 a[72:73], v8 offset:0
 v_mfma_f32_16x16x32_bf16 v[20:23], a[96:99], a[192:195], v[20:23]
 ds_read_b64_tr_b16 a[74:75], v8 offset:4096
 v_mfma_f32_16x16x32_bf16 v[20:23], a[100:103], a[200:203], v[20:23]
 ds_read_b64_tr_b16 a[76:77], v8 offset:16384
 v_mul_f32 v28, s34, v28
 v_mfma_f32_16x16x32_bf16 v[20:23], a[104:107], a[208:211], v[20:23]
 s_waitcnt lgkmcnt(3)
 ds_read_b64_tr_b16 a[78:79], v8 offset:20480
 v_xor_b32 v9, 96, v6
 v_mfma_f32_16x16x32_bf16 v[20:23], a[108:111], a[216:219], v[20:23]
 ds_read_b64_tr_b16 a[80:81], v9 offset:0
 v_mul_f32 v29, s34, v29
 v_mfma_f32_16x16x32_bf16 v[20:23], a[64:67], a[112:115], v[20:23]
 ds_read_b64_tr_b16 a[82:83], v9 offset:4096
 v_mul_f32 v30, s34, v30
 v_mfma_f32_16x16x32_bf16 v[20:23], a[68:71], a[120:123], v[20:23]
 ds_read_b64_tr_b16 a[84:85], v9 offset:16384
 v_mul_f32 v31, s34, v31
 v_mfma_f32_16x16x32_bf16 v[36:39], a[96:99], a[196:199], v[36:39]
 ds_read_b64_tr_b16 a[86:87], v9 offset:20480
 v_xor_b32 v10, 65632, v6
 v_mfma_f32_16x16x32_bf16 v[36:39], a[100:103], a[204:207], v[36:39]
 ds_read_b64_tr_b16 a[88:89], v10 offset:0
 v_mul_f32 v52, s34, v52
 v_mfma_f32_16x16x32_bf16 v[36:39], a[104:107], a[212:215], v[36:39]
 ds_read_b64_tr_b16 a[90:91], v10 offset:4096
 v_mul_f32 v53, s34, v53
 v_mfma_f32_16x16x32_bf16 v[36:39], a[108:111], a[220:223], v[36:39]
 ds_read_b64_tr_b16 a[92:93], v10 offset:16384
 v_mul_f32 v54, s34, v54
 v_mfma_f32_16x16x32_bf16 v[36:39], a[64:67], a[116:119], v[36:39]
 ds_read_b64_tr_b16 a[94:95], v10 offset:20480
 v_xor_b32 v7, 131200, v6
 v_mfma_f32_16x16x32_bf16 v[36:39], a[68:71], a[124:127], v[36:39]
 s_waitcnt lgkmcnt(6)
 ds_read_b64_tr_b16 a[96:97], v7 offset:0
 v_mul_f32 v55, s34, v55
 v_mfma_f32_16x16x32_bf16 v[68:71], a[72:75], a[192:195], v[68:71]
 ds_read_b64_tr_b16 a[98:99], v7 offset:4096
 v_cvt_pk_bf16_f32 v28, v28, v29
 v_mfma_f32_16x16x32_bf16 v[68:71], a[76:79], a[200:203], v[68:71]
 ds_read_b64_tr_b16 a[100:101], v7 offset:16384
 v_cvt_pk_bf16_f32 v29, v30, v31
 v_mfma_f32_16x16x32_bf16 v[68:71], a[80:83], a[208:211], v[68:71]
 s_waitcnt lgkmcnt(3)
 ds_read_b64_tr_b16 a[102:103], v7 offset:20480
 v_xor_b32 v8, 128, v6
 v_mfma_f32_16x16x32_bf16 v[68:71], a[84:87], a[216:219], v[68:71]
 ds_read_b64_tr_b16 a[104:105], v8 offset:0
 v_cvt_pk_bf16_f32 v30, v52, v53
 v_mfma_f32_16x16x32_bf16 v[68:71], a[88:91], a[112:115], v[68:71]
 ds_read_b64_tr_b16 a[106:107], v8 offset:4096
 v_cvt_pk_bf16_f32 v31, v54, v55
 v_mfma_f32_16x16x32_bf16 v[68:71], a[92:95], a[120:123], v[68:71]
 ds_read_b64_tr_b16 a[108:109], v8 offset:16384
 v_accvgpr_write_b32 a0, v28
 v_mfma_f32_16x16x32_bf16 v[76:79], a[72:75], a[196:199], v[76:79]
 ds_read_b64_tr_b16 a[110:111], v8 offset:20480
 v_xor_b32 v9, 65664, v6
 v_mfma_f32_16x16x32_bf16 v[76:79], a[76:79], a[204:207], v[76:79]
 ds_read_b64_tr_b16 a[64:65], v9 offset:0
 v_accvgpr_write_b32 a1, v29
 v_mfma_f32_16x16x32_bf16 v[76:79], a[80:83], a[212:215], v[76:79]
 ds_read_b64_tr_b16 a[66:67], v9 offset:4096
 v_accvgpr_write_b32 a2, v30
 v_mfma_f32_16x16x32_bf16 v[76:79], a[84:87], a[220:223], v[76:79]
 ds_read_b64_tr_b16 a[68:69], v9 offset:16384
 v_accvgpr_write_b32 a3, v31
 v_mfma_f32_16x16x32_bf16 v[76:79], a[88:91], a[116:119], v[76:79]
 ds_read_b64_tr_b16 a[70:71], v9 offset:20480
 v_xor_b32 v10, 131232, v6
 v_mfma_f32_16x16x32_bf16 v[76:79], a[92:95], a[124:127], v[76:79]
 s_waitcnt lgkmcnt(6)
 ds_read_b64_tr_b16 a[72:73], v10 offset:0
 v_mul_f32 v44, s34, v44
 v_mfma_f32_16x16x32_bf16 v[84:87], a[96:99], a[192:195], v[84:87]
 ds_read_b64_tr_b16 a[74:75], v10 offset:4096
 v_mul_f32 v45, s34, v45
 v_mfma_f32_16x16x32_bf16 v[84:87], a[100:103], a[200:203], v[84:87]
 ds_read_b64_tr_b16 a[76:77], v10 offset:16384
 v_mul_f32 v46, s34, v46
 v_mfma_f32_16x16x32_bf16 v[84:87], a[104:107], a[208:211], v[84:87]
 s_waitcnt lgkmcnt(3)
 ds_read_b64_tr_b16 a[78:79], v10 offset:20480
 v_xor_b32 v7, 160, v6
 v_mfma_f32_16x16x32_bf16 v[84:87], a[108:111], a[216:219], v[84:87]
 ds_read_b64_tr_b16 a[80:81], v7 offset:0
 v_mul_f32 v47, s34, v47
 v_mfma_f32_16x16x32_bf16 v[84:87], a[64:67], a[112:115], v[84:87]
 ds_read_b64_tr_b16 a[82:83], v7 offset:4096
 v_mul_f32 v60, s34, v60
 v_mfma_f32_16x16x32_bf16 v[84:87], a[68:71], a[120:123], v[84:87]
 ds_read_b64_tr_b16 a[84:85], v7 offset:16384
 v_mul_f32 v61, s34, v61
 v_mfma_f32_16x16x32_bf16 v[92:95], a[96:99], a[196:199], v[92:95]
 ds_read_b64_tr_b16 a[86:87], v7 offset:20480
 v_xor_b32 v8, 65696, v6
 v_mfma_f32_16x16x32_bf16 v[92:95], a[100:103], a[204:207], v[92:95]
 ds_read_b64_tr_b16 a[88:89], v8 offset:0
 v_mul_f32 v62, s34, v62
 v_mfma_f32_16x16x32_bf16 v[92:95], a[104:107], a[212:215], v[92:95]
 ds_read_b64_tr_b16 a[90:91], v8 offset:4096
 v_mul_f32 v63, s34, v63
 v_mfma_f32_16x16x32_bf16 v[92:95], a[108:111], a[220:223], v[92:95]
 ds_read_b64_tr_b16 a[92:93], v8 offset:16384
 v_cvt_pk_bf16_f32 v44, v44, v45
 v_mfma_f32_16x16x32_bf16 v[92:95], a[64:67], a[116:119], v[92:95]
 ds_read_b64_tr_b16 a[94:95], v8 offset:20480
 v_xor_b32 v9, 131264, v6
 v_mfma_f32_16x16x32_bf16 v[92:95], a[68:71], a[124:127], v[92:95]
 s_waitcnt lgkmcnt(6)
 ds_read_b64_tr_b16 a[96:97], v9 offset:0
 v_cvt_pk_bf16_f32 v45, v46, v47
 v_mfma_f32_16x16x32_bf16 v[100:103], a[72:75], a[192:195], v[100:103]
 ds_read_b64_tr_b16 a[98:99], v9 offset:4096
 v_cvt_pk_bf16_f32 v46, v60, v61
 v_mfma_f32_16x16x32_bf16 v[100:103], a[76:79], a[200:203], v[100:103]
 ds_read_b64_tr_b16 a[100:101], v9 offset:16384
 v_cvt_pk_bf16_f32 v47, v62, v63
 v_mfma_f32_16x16x32_bf16 v[100:103], a[80:83], a[208:211], v[100:103]
 s_waitcnt lgkmcnt(3)
 ds_read_b64_tr_b16 a[102:103], v9 offset:20480
 v_xor_b32 v10, 192, v6
 v_mfma_f32_16x16x32_bf16 v[100:103], a[84:87], a[216:219], v[100:103]
 ds_read_b64_tr_b16 a[104:105], v10 offset:0
 v_accvgpr_write_b32 a32, v44
 v_mfma_f32_16x16x32_bf16 v[100:103], a[88:91], a[112:115], v[100:103]
 ds_read_b64_tr_b16 a[106:107], v10 offset:4096
 v_accvgpr_write_b32 a33, v45
 v_mfma_f32_16x16x32_bf16 v[100:103], a[92:95], a[120:123], v[100:103]
 ds_read_b64_tr_b16 a[108:109], v10 offset:16384
 v_accvgpr_write_b32 a34, v46
 v_mfma_f32_16x16x32_bf16 v[108:111], a[72:75], a[196:199], v[108:111]
 ds_read_b64_tr_b16 a[110:111], v10 offset:20480
 v_xor_b32 v7, 65728, v6
 v_mfma_f32_16x16x32_bf16 v[108:111], a[76:79], a[204:207], v[108:111]
 ds_read_b64_tr_b16 a[64:65], v7 offset:0
 v_accvgpr_write_b32 a35, v47
 v_mfma_f32_16x16x32_bf16 v[108:111], a[80:83], a[212:215], v[108:111]
 ds_read_b64_tr_b16 a[66:67], v7 offset:4096
 v_mul_f32 v20, s34, v20
 v_mfma_f32_16x16x32_bf16 v[108:111], a[84:87], a[220:223], v[108:111]
 ds_read_b64_tr_b16 a[68:69], v7 offset:16384
 v_mul_f32 v21, s34, v21
 v_mfma_f32_16x16x32_bf16 v[108:111], a[88:91], a[116:119], v[108:111]
 ds_read_b64_tr_b16 a[70:71], v7 offset:20480
 v_xor_b32 v8, 131296, v6
 v_mfma_f32_16x16x32_bf16 v[108:111], a[92:95], a[124:127], v[108:111]
 s_waitcnt lgkmcnt(6)
 ds_read_b64_tr_b16 a[72:73], v8 offset:0
 v_mul_f32 v22, s34, v22
 v_mfma_f32_16x16x32_bf16 v[116:119], a[96:99], a[192:195], v[116:119]
 ds_read_b64_tr_b16 a[74:75], v8 offset:4096
 v_mul_f32 v23, s34, v23
 v_mfma_f32_16x16x32_bf16 v[116:119], a[100:103], a[200:203], v[116:119]
 ds_read_b64_tr_b16 a[76:77], v8 offset:16384
 v_mul_f32 v68, s34, v68
 v_mfma_f32_16x16x32_bf16 v[116:119], a[104:107], a[208:211], v[116:119]
 s_waitcnt lgkmcnt(3)
 ds_read_b64_tr_b16 a[78:79], v8 offset:20480
 v_xor_b32 v9, 224, v6
 v_mfma_f32_16x16x32_bf16 v[116:119], a[108:111], a[216:219], v[116:119]
 ds_read_b64_tr_b16 a[80:81], v9 offset:0
 v_mul_f32 v69, s34, v69
 v_mfma_f32_16x16x32_bf16 v[116:119], a[64:67], a[112:115], v[116:119]
 ds_read_b64_tr_b16 a[82:83], v9 offset:4096
 v_mul_f32 v70, s34, v70
 v_mfma_f32_16x16x32_bf16 v[116:119], a[68:71], a[120:123], v[116:119]
 ds_read_b64_tr_b16 a[84:85], v9 offset:16384
 v_mul_f32 v71, s34, v71
 v_mfma_f32_16x16x32_bf16 v[124:127], a[96:99], a[196:199], v[124:127]
 ds_read_b64_tr_b16 a[86:87], v9 offset:20480
 v_xor_b32 v10, 65760, v6
 v_mfma_f32_16x16x32_bf16 v[124:127], a[100:103], a[204:207], v[124:127]
 ds_read_b64_tr_b16 a[88:89], v10 offset:0
 v_cvt_pk_bf16_f32 v20, v20, v21
 v_mfma_f32_16x16x32_bf16 v[124:127], a[104:107], a[212:215], v[124:127]
 ds_read_b64_tr_b16 a[90:91], v10 offset:4096
 v_cvt_pk_bf16_f32 v21, v22, v23
 v_mfma_f32_16x16x32_bf16 v[124:127], a[108:111], a[220:223], v[124:127]
 ds_read_b64_tr_b16 a[92:93], v10 offset:16384
 v_cvt_pk_bf16_f32 v22, v68, v69
 v_mfma_f32_16x16x32_bf16 v[124:127], a[64:67], a[116:119], v[124:127]
 ds_read_b64_tr_b16 a[94:95], v10 offset:20480
 v_xor_b32 v7, 131328, v6
 v_mfma_f32_16x16x32_bf16 v[124:127], a[68:71], a[124:127], v[124:127]
 s_waitcnt lgkmcnt(6)
 ds_read_b64_tr_b16 a[96:97], v7 offset:0
 v_cvt_pk_bf16_f32 v23, v70, v71
 v_mfma_f32_16x16x32_bf16 v[132:135], a[72:75], a[192:195], v[132:135]
 ds_read_b64_tr_b16 a[98:99], v7 offset:4096
 v_accvgpr_write_b32 a4, v20
 v_mfma_f32_16x16x32_bf16 v[132:135], a[76:79], a[200:203], v[132:135]
 ds_read_b64_tr_b16 a[100:101], v7 offset:16384
 v_accvgpr_write_b32 a5, v21
 v_mfma_f32_16x16x32_bf16 v[132:135], a[80:83], a[208:211], v[132:135]
 s_waitcnt lgkmcnt(3)
 ds_read_b64_tr_b16 a[102:103], v7 offset:20480
 v_xor_b32 v8, 256, v6
 v_mfma_f32_16x16x32_bf16 v[132:135], a[84:87], a[216:219], v[132:135]
 ds_read_b64_tr_b16 a[104:105], v8 offset:0
 v_accvgpr_write_b32 a6, v22
 v_mfma_f32_16x16x32_bf16 v[132:135], a[88:91], a[112:115], v[132:135]
 ds_read_b64_tr_b16 a[106:107], v8 offset:4096
 v_accvgpr_write_b32 a7, v23
 v_mfma_f32_16x16x32_bf16 v[132:135], a[92:95], a[120:123], v[132:135]
 ds_read_b64_tr_b16 a[108:109], v8 offset:16384
 v_mul_f32 v36, s34, v36
 v_mfma_f32_16x16x32_bf16 v[140:143], a[72:75], a[196:199], v[140:143]
 ds_read_b64_tr_b16 a[110:111], v8 offset:20480
 v_xor_b32 v9, 65792, v6
 v_mfma_f32_16x16x32_bf16 v[140:143], a[76:79], a[204:207], v[140:143]
 ds_read_b64_tr_b16 a[64:65], v9 offset:0
 v_mul_f32 v37, s34, v37
 v_mfma_f32_16x16x32_bf16 v[140:143], a[80:83], a[212:215], v[140:143]
 ds_read_b64_tr_b16 a[66:67], v9 offset:4096
 v_mul_f32 v38, s34, v38
 v_mfma_f32_16x16x32_bf16 v[140:143], a[84:87], a[220:223], v[140:143]
 ds_read_b64_tr_b16 a[68:69], v9 offset:16384
 v_mul_f32 v39, s34, v39
 v_mfma_f32_16x16x32_bf16 v[140:143], a[88:91], a[116:119], v[140:143]
 ds_read_b64_tr_b16 a[70:71], v9 offset:20480
 v_xor_b32 v10, 131360, v6
 v_mfma_f32_16x16x32_bf16 v[140:143], a[92:95], a[124:127], v[140:143]
 s_waitcnt lgkmcnt(6)
 ds_read_b64_tr_b16 a[72:73], v10 offset:0
 v_mul_f32 v76, s34, v76
 v_mfma_f32_16x16x32_bf16 v[148:151], a[96:99], a[192:195], v[148:151]
 ds_read_b64_tr_b16 a[74:75], v10 offset:4096
 v_mul_f32 v77, s34, v77
 v_mfma_f32_16x16x32_bf16 v[148:151], a[100:103], a[200:203], v[148:151]
 ds_read_b64_tr_b16 a[76:77], v10 offset:16384
 v_mul_f32 v78, s34, v78
 v_mfma_f32_16x16x32_bf16 v[148:151], a[104:107], a[208:211], v[148:151]
 s_waitcnt lgkmcnt(3)
 ds_read_b64_tr_b16 a[78:79], v10 offset:20480
 v_xor_b32 v7, 288, v6
 v_mfma_f32_16x16x32_bf16 v[148:151], a[108:111], a[216:219], v[148:151]
 ds_read_b64_tr_b16 a[80:81], v7 offset:0
 v_mul_f32 v79, s34, v79
 v_mfma_f32_16x16x32_bf16 v[148:151], a[64:67], a[112:115], v[148:151]
 ds_read_b64_tr_b16 a[82:83], v7 offset:4096
 v_cvt_pk_bf16_f32 v36, v36, v37
 v_mfma_f32_16x16x32_bf16 v[148:151], a[68:71], a[120:123], v[148:151]
 ds_read_b64_tr_b16 a[84:85], v7 offset:16384
 v_cvt_pk_bf16_f32 v37, v38, v39
 v_mfma_f32_16x16x32_bf16 v[156:159], a[96:99], a[196:199], v[156:159]
 ds_read_b64_tr_b16 a[86:87], v7 offset:20480
 v_xor_b32 v8, 65824, v6
 v_mfma_f32_16x16x32_bf16 v[156:159], a[100:103], a[204:207], v[156:159]
 ds_read_b64_tr_b16 a[88:89], v8 offset:0
 v_cvt_pk_bf16_f32 v38, v76, v77
 v_mfma_f32_16x16x32_bf16 v[156:159], a[104:107], a[212:215], v[156:159]
 ds_read_b64_tr_b16 a[90:91], v8 offset:4096
 v_cvt_pk_bf16_f32 v39, v78, v79
 v_mfma_f32_16x16x32_bf16 v[156:159], a[108:111], a[220:223], v[156:159]
 ds_read_b64_tr_b16 a[92:93], v8 offset:16384
 v_accvgpr_write_b32 a36, v36
 v_mfma_f32_16x16x32_bf16 v[156:159], a[64:67], a[116:119], v[156:159]
 ds_read_b64_tr_b16 a[94:95], v8 offset:20480
 v_xor_b32 v9, 131392, v6
 v_mfma_f32_16x16x32_bf16 v[156:159], a[68:71], a[124:127], v[156:159]
 s_waitcnt lgkmcnt(6)
 ds_read_b64_tr_b16 a[96:97], v9 offset:0
 v_accvgpr_write_b32 a37, v37
 v_mfma_f32_16x16x32_bf16 v[164:167], a[72:75], a[192:195], v[164:167]
 ds_read_b64_tr_b16 a[98:99], v9 offset:4096
 v_accvgpr_write_b32 a38, v38
 v_mfma_f32_16x16x32_bf16 v[164:167], a[76:79], a[200:203], v[164:167]
 ds_read_b64_tr_b16 a[100:101], v9 offset:16384
 v_accvgpr_write_b32 a39, v39
 v_mfma_f32_16x16x32_bf16 v[164:167], a[80:83], a[208:211], v[164:167]
 s_waitcnt lgkmcnt(3)
 ds_read_b64_tr_b16 a[102:103], v9 offset:20480
 v_xor_b32 v10, 320, v6
 v_mfma_f32_16x16x32_bf16 v[164:167], a[84:87], a[216:219], v[164:167]
 ds_read_b64_tr_b16 a[104:105], v10 offset:0
 v_mul_f32 v84, s34, v84
 v_mfma_f32_16x16x32_bf16 v[164:167], a[88:91], a[112:115], v[164:167]
 ds_read_b64_tr_b16 a[106:107], v10 offset:4096
 v_mul_f32 v85, s34, v85
 v_mfma_f32_16x16x32_bf16 v[164:167], a[92:95], a[120:123], v[164:167]
 ds_read_b64_tr_b16 a[108:109], v10 offset:16384
 v_mul_f32 v86, s34, v86
 v_mfma_f32_16x16x32_bf16 v[172:175], a[72:75], a[196:199], v[172:175]
 ds_read_b64_tr_b16 a[110:111], v10 offset:20480
 v_xor_b32 v7, 65856, v6
 v_mfma_f32_16x16x32_bf16 v[172:175], a[76:79], a[204:207], v[172:175]
 ds_read_b64_tr_b16 a[64:65], v7 offset:0
 v_mul_f32 v87, s34, v87
 v_mfma_f32_16x16x32_bf16 v[172:175], a[80:83], a[212:215], v[172:175]
 ds_read_b64_tr_b16 a[66:67], v7 offset:4096
 v_mul_f32 v100, s34, v100
 v_mfma_f32_16x16x32_bf16 v[172:175], a[84:87], a[220:223], v[172:175]
 ds_read_b64_tr_b16 a[68:69], v7 offset:16384
 v_mul_f32 v101, s34, v101
 v_mfma_f32_16x16x32_bf16 v[172:175], a[88:91], a[116:119], v[172:175]
 ds_read_b64_tr_b16 a[70:71], v7 offset:20480
 v_xor_b32 v8, 131424, v6
 v_mfma_f32_16x16x32_bf16 v[172:175], a[92:95], a[124:127], v[172:175]
 s_waitcnt lgkmcnt(6)
 ds_read_b64_tr_b16 a[72:73], v8 offset:0
 v_mul_f32 v102, s34, v102
 v_mfma_f32_16x16x32_bf16 v[180:183], a[96:99], a[192:195], v[180:183]
 ds_read_b64_tr_b16 a[74:75], v8 offset:4096
 v_mul_f32 v103, s34, v103
 v_mfma_f32_16x16x32_bf16 v[180:183], a[100:103], a[200:203], v[180:183]
 ds_read_b64_tr_b16 a[76:77], v8 offset:16384
 v_cvt_pk_bf16_f32 v84, v84, v85
 v_mfma_f32_16x16x32_bf16 v[180:183], a[104:107], a[208:211], v[180:183]
 s_waitcnt lgkmcnt(3)
 ds_read_b64_tr_b16 a[78:79], v8 offset:20480
 v_xor_b32 v9, 352, v6
 v_mfma_f32_16x16x32_bf16 v[180:183], a[108:111], a[216:219], v[180:183]
 ds_read_b64_tr_b16 a[80:81], v9 offset:0
 v_cvt_pk_bf16_f32 v85, v86, v87
 v_mfma_f32_16x16x32_bf16 v[180:183], a[64:67], a[112:115], v[180:183]
 ds_read_b64_tr_b16 a[82:83], v9 offset:4096
 v_cvt_pk_bf16_f32 v86, v100, v101
 v_mfma_f32_16x16x32_bf16 v[180:183], a[68:71], a[120:123], v[180:183]
 ds_read_b64_tr_b16 a[84:85], v9 offset:16384
 v_cvt_pk_bf16_f32 v87, v102, v103
 v_mfma_f32_16x16x32_bf16 v[188:191], a[96:99], a[196:199], v[188:191]
 ds_read_b64_tr_b16 a[86:87], v9 offset:20480
 v_xor_b32 v10, 65888, v6
 v_mfma_f32_16x16x32_bf16 v[188:191], a[100:103], a[204:207], v[188:191]
 ds_read_b64_tr_b16 a[88:89], v10 offset:0
 v_accvgpr_write_b32 a8, v84
 v_mfma_f32_16x16x32_bf16 v[188:191], a[104:107], a[212:215], v[188:191]
 ds_read_b64_tr_b16 a[90:91], v10 offset:4096
 v_accvgpr_write_b32 a9, v85
 v_mfma_f32_16x16x32_bf16 v[188:191], a[108:111], a[220:223], v[188:191]
 ds_read_b64_tr_b16 a[92:93], v10 offset:16384
 v_accvgpr_write_b32 a10, v86
 v_mfma_f32_16x16x32_bf16 v[188:191], a[64:67], a[116:119], v[188:191]
 ds_read_b64_tr_b16 a[94:95], v10 offset:20480
 v_xor_b32 v7, 131456, v6
 v_mfma_f32_16x16x32_bf16 v[188:191], a[68:71], a[124:127], v[188:191]
 s_waitcnt lgkmcnt(6)
 ds_read_b64_tr_b16 a[96:97], v7 offset:0
 v_accvgpr_write_b32 a11, v87
 v_mfma_f32_16x16x32_bf16 v[196:199], a[72:75], a[192:195], v[196:199]
 ds_read_b64_tr_b16 a[98:99], v7 offset:4096
 v_mul_f32 v92, s34, v92
 v_mfma_f32_16x16x32_bf16 v[196:199], a[76:79], a[200:203], v[196:199]
 ds_read_b64_tr_b16 a[100:101], v7 offset:16384
 v_mul_f32 v93, s34, v93
 v_mfma_f32_16x16x32_bf16 v[196:199], a[80:83], a[208:211], v[196:199]
 s_waitcnt lgkmcnt(3)
 ds_read_b64_tr_b16 a[102:103], v7 offset:20480
 v_xor_b32 v8, 384, v6
 v_mfma_f32_16x16x32_bf16 v[196:199], a[84:87], a[216:219], v[196:199]
 ds_read_b64_tr_b16 a[104:105], v8 offset:0
 v_mul_f32 v94, s34, v94
 v_mfma_f32_16x16x32_bf16 v[196:199], a[88:91], a[112:115], v[196:199]
 ds_read_b64_tr_b16 a[106:107], v8 offset:4096
 v_mul_f32 v95, s34, v95
 v_mfma_f32_16x16x32_bf16 v[196:199], a[92:95], a[120:123], v[196:199]
 ds_read_b64_tr_b16 a[108:109], v8 offset:16384
 v_mul_f32 v108, s34, v108
 v_mfma_f32_16x16x32_bf16 v[204:207], a[72:75], a[196:199], v[204:207]
 ds_read_b64_tr_b16 a[110:111], v8 offset:20480
 v_xor_b32 v9, 65920, v6
 v_mfma_f32_16x16x32_bf16 v[204:207], a[76:79], a[204:207], v[204:207]
 ds_read_b64_tr_b16 a[64:65], v9 offset:0
 v_mul_f32 v109, s34, v109
 v_mfma_f32_16x16x32_bf16 v[204:207], a[80:83], a[212:215], v[204:207]
 ds_read_b64_tr_b16 a[66:67], v9 offset:4096
 v_mul_f32 v110, s34, v110
 v_mfma_f32_16x16x32_bf16 v[204:207], a[84:87], a[220:223], v[204:207]
 ds_read_b64_tr_b16 a[68:69], v9 offset:16384
 v_mul_f32 v111, s34, v111
 v_mfma_f32_16x16x32_bf16 v[204:207], a[88:91], a[116:119], v[204:207]
 ds_read_b64_tr_b16 a[70:71], v9 offset:20480
 v_xor_b32 v10, 131488, v6
 v_mfma_f32_16x16x32_bf16 v[204:207], a[92:95], a[124:127], v[204:207]
 s_waitcnt lgkmcnt(6)
 ds_read_b64_tr_b16 a[72:73], v10 offset:0
 v_cvt_pk_bf16_f32 v92, v92, v93
 v_mfma_f32_16x16x32_bf16 v[212:215], a[96:99], a[192:195], v[212:215]
 ds_read_b64_tr_b16 a[74:75], v10 offset:4096
 v_cvt_pk_bf16_f32 v93, v94, v95
 v_mfma_f32_16x16x32_bf16 v[212:215], a[100:103], a[200:203], v[212:215]
 ds_read_b64_tr_b16 a[76:77], v10 offset:16384
 v_cvt_pk_bf16_f32 v94, v108, v109
 v_mfma_f32_16x16x32_bf16 v[212:215], a[104:107], a[208:211], v[212:215]
 s_waitcnt lgkmcnt(3)
 ds_read_b64_tr_b16 a[78:79], v10 offset:20480
 v_xor_b32 v7, 416, v6
 v_mfma_f32_16x16x32_bf16 v[212:215], a[108:111], a[216:219], v[212:215]
 ds_read_b64_tr_b16 a[80:81], v7 offset:0
 v_cvt_pk_bf16_f32 v95, v110, v111
 v_mfma_f32_16x16x32_bf16 v[212:215], a[64:67], a[112:115], v[212:215]
 ds_read_b64_tr_b16 a[82:83], v7 offset:4096
 v_accvgpr_write_b32 a40, v92
 v_mfma_f32_16x16x32_bf16 v[212:215], a[68:71], a[120:123], v[212:215]
 ds_read_b64_tr_b16 a[84:85], v7 offset:16384
 v_accvgpr_write_b32 a41, v93
 v_mfma_f32_16x16x32_bf16 v[220:223], a[96:99], a[196:199], v[220:223]
 ds_read_b64_tr_b16 a[86:87], v7 offset:20480
 v_xor_b32 v8, 65952, v6
 v_mfma_f32_16x16x32_bf16 v[220:223], a[100:103], a[204:207], v[220:223]
 ds_read_b64_tr_b16 a[88:89], v8 offset:0
 v_accvgpr_write_b32 a42, v94
 v_mfma_f32_16x16x32_bf16 v[220:223], a[104:107], a[212:215], v[220:223]
 ds_read_b64_tr_b16 a[90:91], v8 offset:4096
 v_accvgpr_write_b32 a43, v95
 v_mfma_f32_16x16x32_bf16 v[220:223], a[108:111], a[220:223], v[220:223]
 ds_read_b64_tr_b16 a[92:93], v8 offset:16384
 v_mul_f32 v116, s34, v116
 v_mfma_f32_16x16x32_bf16 v[220:223], a[64:67], a[116:119], v[220:223]
 ds_read_b64_tr_b16 a[94:95], v8 offset:20480
 v_xor_b32 v9, 131520, v6
 v_mfma_f32_16x16x32_bf16 v[220:223], a[68:71], a[124:127], v[220:223]
 s_waitcnt lgkmcnt(6)
 ds_read_b64_tr_b16 a[96:97], v9 offset:0
 v_mul_f32 v117, s34, v117
 v_mfma_f32_16x16x32_bf16 v[228:231], a[72:75], a[192:195], v[228:231]
 ds_read_b64_tr_b16 a[98:99], v9 offset:4096
 v_mul_f32 v118, s34, v118
 v_mfma_f32_16x16x32_bf16 v[228:231], a[76:79], a[200:203], v[228:231]
 ds_read_b64_tr_b16 a[100:101], v9 offset:16384
 v_mul_f32 v119, s34, v119
 v_mfma_f32_16x16x32_bf16 v[228:231], a[80:83], a[208:211], v[228:231]
 s_waitcnt lgkmcnt(3)
 ds_read_b64_tr_b16 a[102:103], v9 offset:20480
 v_xor_b32 v10, 448, v6
 v_mfma_f32_16x16x32_bf16 v[228:231], a[84:87], a[216:219], v[228:231]
 ds_read_b64_tr_b16 a[104:105], v10 offset:0
 v_mul_f32 v132, s34, v132
 v_mfma_f32_16x16x32_bf16 v[228:231], a[88:91], a[112:115], v[228:231]
 ds_read_b64_tr_b16 a[106:107], v10 offset:4096
 v_mul_f32 v133, s34, v133
 v_mfma_f32_16x16x32_bf16 v[228:231], a[92:95], a[120:123], v[228:231]
 ds_read_b64_tr_b16 a[108:109], v10 offset:16384
 v_mul_f32 v134, s34, v134
 v_mfma_f32_16x16x32_bf16 v[236:239], a[72:75], a[196:199], v[236:239]
 ds_read_b64_tr_b16 a[110:111], v10 offset:20480
 v_xor_b32 v7, 65984, v6
 v_mfma_f32_16x16x32_bf16 v[236:239], a[76:79], a[204:207], v[236:239]
 ds_read_b64_tr_b16 a[64:65], v7 offset:0
 buffer_load_dword v13, v12, s[12:15], s58 offen sc1
 v_mfma_f32_16x16x32_bf16 v[236:239], a[80:83], a[212:215], v[236:239]
 ds_read_b64_tr_b16 a[66:67], v7 offset:4096
 v_mul_f32 v135, s34, v135
 v_mfma_f32_16x16x32_bf16 v[236:239], a[84:87], a[220:223], v[236:239]
 ds_read_b64_tr_b16 a[68:69], v7 offset:16384
 v_cvt_pk_bf16_f32 v116, v116, v117
 v_mfma_f32_16x16x32_bf16 v[236:239], a[88:91], a[116:119], v[236:239]
 ds_read_b64_tr_b16 a[70:71], v7 offset:20480
 v_xor_b32 v8, 131552, v6
 v_mfma_f32_16x16x32_bf16 v[236:239], a[92:95], a[124:127], v[236:239]
 s_waitcnt lgkmcnt(6)
 ds_read_b64_tr_b16 a[72:73], v8 offset:0
 v_cvt_pk_bf16_f32 v117, v118, v119
 v_mfma_f32_16x16x32_bf16 v[244:247], a[96:99], a[192:195], v[244:247]
 ds_read_b64_tr_b16 a[74:75], v8 offset:4096
 v_cvt_pk_bf16_f32 v118, v132, v133
 v_mfma_f32_16x16x32_bf16 v[244:247], a[100:103], a[200:203], v[244:247]
 ds_read_b64_tr_b16 a[76:77], v8 offset:16384
 v_cvt_pk_bf16_f32 v119, v134, v135
 v_mfma_f32_16x16x32_bf16 v[244:247], a[104:107], a[208:211], v[244:247]
 s_waitcnt lgkmcnt(3)
 ds_read_b64_tr_b16 a[78:79], v8 offset:20480
 v_xor_b32 v9, 480, v6
 v_mfma_f32_16x16x32_bf16 v[244:247], a[108:111], a[216:219], v[244:247]
 ds_read_b64_tr_b16 a[80:81], v9 offset:0
 v_accvgpr_write_b32 a12, v116
 v_mfma_f32_16x16x32_bf16 v[244:247], a[64:67], a[112:115], v[244:247]
 ds_read_b64_tr_b16 a[82:83], v9 offset:4096
 v_accvgpr_write_b32 a13, v117
 v_mfma_f32_16x16x32_bf16 v[244:247], a[68:71], a[120:123], v[244:247]
 ds_read_b64_tr_b16 a[84:85], v9 offset:16384
 v_accvgpr_write_b32 a14, v118
 v_mfma_f32_16x16x32_bf16 v[252:255], a[96:99], a[196:199], v[252:255]
 ds_read_b64_tr_b16 a[86:87], v9 offset:20480
 v_xor_b32 v10, 66016, v6
 v_mfma_f32_16x16x32_bf16 v[252:255], a[100:103], a[204:207], v[252:255]
 ds_read_b64_tr_b16 a[88:89], v10 offset:0
 v_accvgpr_write_b32 a15, v119
 v_mfma_f32_16x16x32_bf16 v[252:255], a[104:107], a[212:215], v[252:255]
 ds_read_b64_tr_b16 a[90:91], v10 offset:4096
 v_mfma_f32_16x16x32_bf16 v[252:255], a[108:111], a[220:223], v[252:255]
 ds_read_b64_tr_b16 a[92:93], v10 offset:16384
 v_mfma_f32_16x16x32_bf16 v[252:255], a[64:67], a[116:119], v[252:255]
 ds_read_b64_tr_b16 a[94:95], v10 offset:20480
 v_mfma_f32_16x16x32_bf16 v[252:255], a[68:71], a[124:127], v[252:255]
 s_waitcnt lgkmcnt(6)
 v_mfma_f32_16x16x32_bf16 v[16:19], a[72:75], a[192:195], v[16:19]
 v_mfma_f32_16x16x32_bf16 v[16:19], a[76:79], a[200:203], v[16:19]
 v_mfma_f32_16x16x32_bf16 v[16:19], a[80:83], a[208:211], v[16:19]
 s_waitcnt lgkmcnt(0)
 v_mfma_f32_16x16x32_bf16 v[16:19], a[84:87], a[216:219], v[16:19]
 v_mfma_f32_16x16x32_bf16 v[16:19], a[88:91], a[112:115], v[16:19]
 v_mfma_f32_16x16x32_bf16 v[16:19], a[92:95], a[120:123], v[16:19]
 v_mfma_f32_16x16x32_bf16 v[24:27], a[72:75], a[196:199], v[24:27]
 v_mfma_f32_16x16x32_bf16 v[24:27], a[76:79], a[204:207], v[24:27]
 v_mfma_f32_16x16x32_bf16 v[24:27], a[80:83], a[212:215], v[24:27]
 v_mfma_f32_16x16x32_bf16 v[24:27], a[84:87], a[220:223], v[24:27]
 s_waitcnt lgkmcnt(0)
 v_mfma_f32_16x16x32_bf16 v[24:27], a[88:91], a[116:119], v[24:27]
 s_barrier
 v_mfma_f32_16x16x32_bf16 v[24:27], a[92:95], a[124:127], v[24:27]
 s_waitcnt vmcnt(0)
 v_cmp_ne_u32 s[16:17], 0, v13
 v_cmp_gt_u32 vcc, 256, v5
 s_or_b64 vcc, vcc, s[16:17]
 s_mov_b32 m0, s40
 s_cselect_b32 s48, 0, 1
 s_cselect_b32 s52, 2.0, s42
 buffer_load_dwordx4 v1, s[12:15], s52 offen offset:0 sc1 lds
 v_pk_mul_f32 v[124:125], v[124:125], s[34:35]
 v_pk_mul_f32 v[126:127], v[126:127], s[34:35]
 v_pk_mul_f32 v[140:141], v[140:141], s[34:35]
 v_pk_mul_f32 v[142:143], v[142:143], s[34:35]
 v_cvt_pk_bf16_f32 v124, v124, v125
 v_cvt_pk_bf16_f32 v125, v126, v127
 v_cvt_pk_bf16_f32 v126, v140, v141
 v_cvt_pk_bf16_f32 v127, v142, v143
 v_accvgpr_write_b32 a44, v124
 v_accvgpr_write_b32 a45, v125
 v_accvgpr_write_b32 a46, v126
 v_accvgpr_write_b32 a47, v127
 v_pk_mul_f32 v[148:149], v[148:149], s[34:35]
 v_pk_mul_f32 v[150:151], v[150:151], s[34:35]
 buffer_load_dwordx4 v1, s[12:15], s52 offen offset:1024 sc1 lds
 v_pk_mul_f32 v[164:165], v[164:165], s[34:35]
 v_pk_mul_f32 v[166:167], v[166:167], s[34:35]
 v_cvt_pk_bf16_f32 v148, v148, v149
 v_cvt_pk_bf16_f32 v149, v150, v151
 v_cvt_pk_bf16_f32 v150, v164, v165
 v_cvt_pk_bf16_f32 v151, v166, v167
 v_accvgpr_write_b32 a16, v148
 v_accvgpr_write_b32 a17, v149
 v_accvgpr_write_b32 a18, v150
 v_accvgpr_write_b32 a19, v151
 v_pk_mul_f32 v[156:157], v[156:157], s[34:35]
 v_pk_mul_f32 v[158:159], v[158:159], s[34:35]
 v_pk_mul_f32 v[172:173], v[172:173], s[34:35]
 buffer_load_dwordx4 v1, s[12:15], s52 offen offset:2048 sc1 lds
 v_pk_mul_f32 v[174:175], v[174:175], s[34:35]
 v_cvt_pk_bf16_f32 v156, v156, v157
 v_cvt_pk_bf16_f32 v157, v158, v159
 v_cvt_pk_bf16_f32 v158, v172, v173
 v_cvt_pk_bf16_f32 v159, v174, v175
 v_accvgpr_write_b32 a48, v156
 v_accvgpr_write_b32 a49, v157
 v_accvgpr_write_b32 a50, v158
 v_accvgpr_write_b32 a51, v159
 v_pk_mul_f32 v[180:181], v[180:181], s[34:35]
 v_pk_mul_f32 v[182:183], v[182:183], s[34:35]
 v_pk_mul_f32 v[196:197], v[196:197], s[34:35]
 v_pk_mul_f32 v[198:199], v[198:199], s[34:35]
 v_cvt_pk_bf16_f32 v180, v180, v181
 buffer_load_dwordx4 v1, s[12:15], s52 offen offset:3072 sc1 lds
 v_cvt_pk_bf16_f32 v181, v182, v183
 v_cvt_pk_bf16_f32 v182, v196, v197
 v_cvt_pk_bf16_f32 v183, v198, v199
 v_accvgpr_write_b32 a20, v180
 v_accvgpr_write_b32 a21, v181
 v_accvgpr_write_b32 a22, v182
 v_accvgpr_write_b32 a23, v183
 v_pk_mul_f32 v[188:189], v[188:189], s[34:35]
 v_pk_mul_f32 v[190:191], v[190:191], s[34:35]
 v_pk_mul_f32 v[204:205], v[204:205], s[34:35]
 v_pk_mul_f32 v[206:207], v[206:207], s[34:35]
 v_cvt_pk_bf16_f32 v188, v188, v189
 v_cvt_pk_bf16_f32 v189, v190, v191
 s_bitset1_b32 m0, 12
 s_nop 0
 buffer_load_dwordx4 v4, s[12:15], s52 offen offset:0 sc1 lds
 v_cvt_pk_bf16_f32 v190, v204, v205
 v_cvt_pk_bf16_f32 v191, v206, v207
 v_accvgpr_write_b32 a52, v188
 v_accvgpr_write_b32 a53, v189
 v_accvgpr_write_b32 a54, v190
 v_accvgpr_write_b32 a55, v191
 v_pk_mul_f32 v[212:213], v[212:213], s[34:35]
 v_pk_mul_f32 v[214:215], v[214:215], s[34:35]
 v_pk_mul_f32 v[228:229], v[228:229], s[34:35]
 v_pk_mul_f32 v[230:231], v[230:231], s[34:35]
 v_cvt_pk_bf16_f32 v212, v212, v213
 v_cvt_pk_bf16_f32 v213, v214, v215
 v_cvt_pk_bf16_f32 v214, v228, v229
 v_cvt_pk_bf16_f32 v215, v230, v231
 buffer_load_dwordx4 v4, s[12:15], s52 offen offset:1024 sc1 lds
 v_accvgpr_write_b32 a24, v212
 v_accvgpr_write_b32 a25, v213
 v_accvgpr_write_b32 a26, v214
 v_accvgpr_write_b32 a27, v215
 v_pk_mul_f32 v[220:221], v[220:221], s[34:35]
 v_pk_mul_f32 v[222:223], v[222:223], s[34:35]
 v_pk_mul_f32 v[236:237], v[236:237], s[34:35]
 v_pk_mul_f32 v[238:239], v[238:239], s[34:35]
 v_cvt_pk_bf16_f32 v220, v220, v221
 v_cvt_pk_bf16_f32 v221, v222, v223
 v_cvt_pk_bf16_f32 v222, v236, v237
 v_cvt_pk_bf16_f32 v223, v238, v239
 v_accvgpr_write_b32 a56, v220
 buffer_load_dwordx4 v4, s[12:15], s52 offen offset:2048 sc1 lds
 v_accvgpr_write_b32 a57, v221
 v_accvgpr_write_b32 a58, v222
 v_accvgpr_write_b32 a59, v223
 v_pk_mul_f32 v[244:245], v[244:245], s[34:35]
 v_pk_mul_f32 v[246:247], v[246:247], s[34:35]
 v_pk_mul_f32 v[16:17], v[16:17], s[34:35]
 v_pk_mul_f32 v[18:19], v[18:19], s[34:35]
 v_cvt_pk_bf16_f32 v244, v244, v245
 v_cvt_pk_bf16_f32 v245, v246, v247
 v_cvt_pk_bf16_f32 v246, v16, v17
 v_cvt_pk_bf16_f32 v247, v18, v19
 v_accvgpr_write_b32 a28, v244
 v_accvgpr_write_b32 a29, v245
 v_accvgpr_write_b32 a30, v246
 buffer_load_dwordx4 v4, s[12:15], s52 offen offset:3072 sc1 lds
 v_accvgpr_write_b32 a31, v247
 v_pk_mul_f32 v[252:253], v[252:253], s[34:35]
 v_pk_mul_f32 v[254:255], v[254:255], s[34:35]
 v_pk_mul_f32 v[24:25], v[24:25], s[34:35]
 v_pk_mul_f32 v[26:27], v[26:27], s[34:35]
 v_cvt_pk_bf16_f32 v252, v252, v253
 v_cvt_pk_bf16_f32 v253, v254, v255
 v_cvt_pk_bf16_f32 v254, v24, v25
 v_cvt_pk_bf16_f32 v255, v26, v27
 v_accvgpr_write_b32 a60, v252
 v_accvgpr_write_b32 a61, v253
 v_accvgpr_write_b32 a62, v254
 v_accvgpr_write_b32 a63, v255
 s_branch L_kvdone
L_late0:
 v_mfma_f32_16x16x32_bf16 a[232:235], a[0:3], a[96:99], a[232:235]
 ds_read_b64_tr_b16 a[24:25], v9 offset:32768
 v_mfma_f32_16x16x32_bf16 a[232:235], a[4:7], a[100:103], a[232:235]
 s_add_u32 m0, s33, 0xfffffd00
 ds_read_b64_tr_b16 a[26:27], v9 offset:36864
 v_mfma_f32_16x16x32_bf16 a[224:227], a[4:7], a[108:111], a[224:227]
 s_waitcnt lgkmcnt(13)
 ds_read_b64_tr_b16 a[28:29], v9 offset:49152
 v_mfma_f32_16x16x32_bf16 a[224:227], a[0:3], a[104:107], a[224:227]
 ds_read_b64_tr_b16 a[30:31], v9 offset:53248
 buffer_load_dwordx4 v15, s[20:23], 0 offen offset:768 lds
 v_mfma_f32_16x16x32_bf16 v[24:27], a[0:3], a[112:115], v[24:27]
 s_waitcnt lgkmcnt(12)
 ds_read_b128 a[64:67], v4 offset:32768
 v_mfma_f32_16x16x32_bf16 v[24:27], a[4:7], a[116:119], v[24:27]
 v_mfma_f32_16x16x32_bf16 v[16:19], a[4:7], a[124:127], v[16:19]
 s_add_u32 m0, s33, 0xfffffd80
 ds_read_b128 a[68:71], v5 offset:32768
 v_mfma_f32_16x16x32_bf16 v[16:19], a[0:3], a[120:123], v[16:19]
 s_waitcnt lgkmcnt(10)
 buffer_load_dwordx4 v15, s[20:23], 0 offen offset:1664 lds
 v_mfma_f32_16x16x32_bf16 v[20:23], a[8:11], a[120:123], v[20:23]
 ds_read_b128 a[76:79], v5 offset:34816
 v_mfma_f32_16x16x32_bf16 v[20:23], a[12:15], a[124:127], v[20:23]
 v_mfma_f32_16x16x32_bf16 v[28:31], a[12:15], a[116:119], v[28:31]
 s_add_u32 m0, s33, 0x500
 ds_read_b128 a[72:75], v4 offset:34816
 v_mfma_f32_16x16x32_bf16 v[28:31], a[8:11], a[112:115], v[28:31]
 buffer_load_dwordx4 v15, s[20:23], s57 offen offset:768 lds
 v_mfma_f32_16x16x32_bf16 a[228:231], a[8:11], a[104:107], a[228:231]
 ds_read_b128 a[80:83], v4 offset:36864
 v_mfma_f32_16x16x32_bf16 a[228:231], a[12:15], a[108:111], a[228:231]
 v_mfma_f32_16x16x32_bf16 a[236:239], a[12:15], a[100:103], a[236:239]
 s_add_u32 m0, s33, 0x580
 ds_read_b128 a[84:87], v5 offset:36864
 v_mfma_f32_16x16x32_bf16 a[236:239], a[8:11], a[96:99], a[236:239]
 s_waitcnt lgkmcnt(10)
 buffer_load_dwordx4 v15, s[20:23], s57 offen offset:1664 lds
 v_mfma_f32_16x16x32_bf16 v[56:59], a[16:19], a[96:99], v[56:59]
 ds_read_b128 a[92:95], v5 offset:38912
 v_mfma_f32_16x16x32_bf16 v[56:59], a[20:23], a[100:103], v[56:59]
 v_cvt_pk_bf16_f32 v16, v16, v17
 v_cvt_pk_bf16_f32 v17, v18, v19
 v_mfma_f32_16x16x32_bf16 v[48:51], a[20:23], a[108:111], v[48:51]
 ds_read_b128 a[88:91], v4 offset:38912
 v_cvt_pk_bf16_f32 v18, v20, v21
 v_mfma_f32_16x16x32_bf16 v[48:51], a[16:19], a[104:107], v[48:51]
 v_cvt_pk_bf16_f32 v19, v22, v23
 v_cvt_pk_bf16_f32 v24, v24, v25
 v_mfma_f32_16x16x32_bf16 v[40:43], a[16:19], a[112:115], v[40:43]
 ds_read_b64_tr_b16 a[32:33], v10 offset:32768
 v_cvt_pk_bf16_f32 v25, v26, v27
 v_mfma_f32_16x16x32_bf16 v[40:43], a[20:23], a[116:119], v[40:43]
 ds_read_b64_tr_b16 a[34:35], v10 offset:36864
 v_cvt_pk_bf16_f32 v26, v28, v29
 v_mfma_f32_16x16x32_bf16 v[32:35], a[20:23], a[124:127], v[32:35]
 s_add_u32 s59, s56, 57344
 ds_read_b64_tr_b16 a[36:37], v10 offset:49152
 v_cvt_pk_bf16_f32 v27, v30, v31
 v_mfma_f32_16x16x32_bf16 v[32:35], a[16:19], a[120:123], v[32:35]
 s_waitcnt lgkmcnt(11)
 ds_read_b64_tr_b16 a[38:39], v10 offset:53248
 v_accvgpr_read_b32 v20, a224
 v_mfma_f32_16x16x32_bf16 v[36:39], a[24:27], a[120:123], v[36:39]
 ds_read_b64_tr_b16 a[40:41], v11 offset:32768
 buffer_store_dwordx4 v[16:19], v1, s[12:15], s59 offen offset:0 sc1
 v_mfma_f32_16x16x32_bf16 v[36:39], a[28:31], a[124:127], v[36:39]
 ds_read_b64_tr_b16 a[42:43], v11 offset:36864
 v_accvgpr_read_b32 v21, a225
 v_mfma_f32_16x16x32_bf16 v[44:47], a[28:31], a[116:119], v[44:47]
 ds_read_b64_tr_b16 a[44:45], v11 offset:49152
 v_accvgpr_read_b32 v22, a226
 v_mfma_f32_16x16x32_bf16 v[44:47], a[24:27], a[112:115], v[44:47]
 ds_read_b64_tr_b16 a[46:47], v11 offset:53248
 v_accvgpr_read_b32 v23, a227
 v_mfma_f32_16x16x32_bf16 v[52:55], a[24:27], a[104:107], v[52:55]
 ds_read_b64_tr_b16 a[48:49], v12 offset:32768
 v_accvgpr_read_b32 v28, a228
 v_mfma_f32_16x16x32_bf16 v[52:55], a[28:31], a[108:111], v[52:55]
 ds_read_b64_tr_b16 a[50:51], v12 offset:36864
 v_accvgpr_read_b32 v29, a229
 v_mfma_f32_16x16x32_bf16 v[60:63], a[28:31], a[100:103], v[60:63]
 s_add_u32 s59, s56, 49152
 ds_read_b64_tr_b16 a[52:53], v12 offset:49152
 v_accvgpr_read_b32 v30, a230
 v_mfma_f32_16x16x32_bf16 v[60:63], a[24:27], a[96:99], v[60:63]
 s_waitcnt lgkmcnt(15)
 ds_read_b64_tr_b16 a[54:55], v12 offset:53248
 buffer_store_dwordx4 v[24:27], v1, s[12:15], s59 offen offset:0 sc1
 v_mfma_f32_16x16x32_bf16 v[88:91], a[0:3], a[64:67], v[88:91]
 ds_read_b64_tr_b16 a[56:57], v13 offset:32768
 v_accvgpr_read_b32 v31, a231
 v_mfma_f32_16x16x32_bf16 v[88:91], a[4:7], a[68:71], v[88:91]
 ds_read_b64_tr_b16 a[58:59], v13 offset:36864
 v_cvt_pk_bf16_f32 v20, v20, v21
 v_mfma_f32_16x16x32_bf16 v[80:83], a[4:7], a[76:79], v[80:83]
 ds_read_b64_tr_b16 a[60:61], v13 offset:49152
 v_cvt_pk_bf16_f32 v21, v22, v23
 v_mfma_f32_16x16x32_bf16 v[80:83], a[0:3], a[72:75], v[80:83]
 s_waitcnt lgkmcnt(15)
 ds_read_b64_tr_b16 a[62:63], v13 offset:53248
 v_cvt_pk_bf16_f32 v22, v28, v29
 v_mfma_f32_16x16x32_bf16 v[72:75], a[0:3], a[80:83], v[72:75]
 v_cvt_pk_bf16_f32 v23, v30, v31
 v_cvt_pk_bf16_f32 v32, v32, v33
 v_mfma_f32_16x16x32_bf16 v[72:75], a[4:7], a[84:87], v[72:75]
 s_add_u32 s59, s56, 40960
 v_cvt_pk_bf16_f32 v33, v34, v35
 v_cvt_pk_bf16_f32 v34, v36, v37
 v_mfma_f32_16x16x32_bf16 v[64:67], a[4:7], a[92:95], v[64:67]
 buffer_store_dwordx4 v[20:23], v1, s[12:15], s59 offen offset:0 sc1
 v_mfma_f32_16x16x32_bf16 v[64:67], a[0:3], a[88:91], v[64:67]
 s_waitcnt lgkmcnt(0)
 v_cvt_pk_bf16_f32 v35, v38, v39
 v_cvt_pk_bf16_f32 v40, v40, v41
 v_mfma_f32_16x16x32_bf16 v[68:71], a[8:11], a[88:91], v[68:71]
 s_barrier
 v_xor_b32 v6, s60, v6
 v_cvt_pk_bf16_f32 v41, v42, v43
 v_mfma_f32_16x16x32_bf16 v[68:71], a[12:15], a[92:95], v[68:71]
 s_add_u32 m0, s29, 32768
 v_add_u32 v2, 0x80000, v2
 v_cvt_pk_bf16_f32 v42, v44, v45
 v_mfma_f32_16x16x32_bf16 v[76:79], a[12:15], a[84:87], v[76:79]
 buffer_load_dwordx4 v2, s[16:19], 0 offen lds
 v_mfma_f32_16x16x32_bf16 v[76:79], a[8:11], a[80:83], v[76:79]
 v_cvt_pk_bf16_f32 v43, v46, v47
 v_accvgpr_read_b32 v36, a232
 v_mfma_f32_16x16x32_bf16 v[84:87], a[8:11], a[72:75], v[84:87]
 v_accvgpr_read_b32 v37, a233
 v_accvgpr_read_b32 v38, a234
 v_mfma_f32_16x16x32_bf16 v[84:87], a[12:15], a[76:79], v[84:87]
 v_accvgpr_read_b32 v39, a235
 v_accvgpr_read_b32 v44, a236
 v_mfma_f32_16x16x32_bf16 v[92:95], a[12:15], a[68:71], v[92:95]
 s_add_u32 m0, s29, 36864
 v_accvgpr_read_b32 v45, a237
 v_accvgpr_read_b32 v46, a238
 v_mfma_f32_16x16x32_bf16 v[92:95], a[8:11], a[64:67], v[92:95]
 buffer_load_dwordx4 v2, s[16:19], s48 offen lds
 v_mfma_f32_16x16x32_bf16 v[120:123], a[16:19], a[64:67], v[120:123]
 v_accvgpr_read_b32 v47, a239
 v_cvt_pk_bf16_f32 v36, v36, v37
 v_mfma_f32_16x16x32_bf16 v[120:123], a[20:23], a[68:71], v[120:123]
 v_cvt_pk_bf16_f32 v37, v38, v39
 v_cvt_pk_bf16_f32 v38, v44, v45
 v_mfma_f32_16x16x32_bf16 v[112:115], a[20:23], a[76:79], v[112:115]
 v_cvt_pk_bf16_f32 v39, v46, v47
 v_cvt_pk_bf16_f32 v48, v48, v49
 v_mfma_f32_16x16x32_bf16 v[112:115], a[16:19], a[72:75], v[112:115]
 s_add_u32 m0, s29, 40960
 v_cvt_pk_bf16_f32 v49, v50, v51
 v_cvt_pk_bf16_f32 v50, v52, v53
 v_mfma_f32_16x16x32_bf16 v[104:107], a[16:19], a[80:83], v[104:107]
 buffer_load_dwordx4 v2, s[16:19], s49 offen lds
 v_mfma_f32_16x16x32_bf16 v[104:107], a[20:23], a[84:87], v[104:107]
 v_cvt_pk_bf16_f32 v51, v54, v55
 v_cvt_pk_bf16_f32 v56, v56, v57
 v_mfma_f32_16x16x32_bf16 v[96:99], a[20:23], a[92:95], v[96:99]
 v_cvt_pk_bf16_f32 v57, v58, v59
 v_cvt_pk_bf16_f32 v58, v60, v61
 v_mfma_f32_16x16x32_bf16 v[96:99], a[16:19], a[88:91], v[96:99]
 v_cvt_pk_bf16_f32 v59, v62, v63
 v_cvt_pk_bf16_f32 v64, v64, v65
 v_mfma_f32_16x16x32_bf16 v[100:103], a[24:27], a[88:91], v[100:103]
 s_add_u32 m0, s29, 45056
 v_cvt_pk_bf16_f32 v65, v66, v67
 v_cvt_pk_bf16_f32 v66, v68, v69
 v_mfma_f32_16x16x32_bf16 v[100:103], a[28:31], a[92:95], v[100:103]
 buffer_load_dwordx4 v2, s[16:19], s50 offen lds
 v_mfma_f32_16x16x32_bf16 v[108:111], a[28:31], a[84:87], v[108:111]
 s_add_u32 s59, s56, 32768
 v_cvt_pk_bf16_f32 v67, v70, v71
 v_cvt_pk_bf16_f32 v72, v72, v73
 v_mfma_f32_16x16x32_bf16 v[108:111], a[24:27], a[80:83], v[108:111]
 buffer_store_dwordx4 v[36:39], v1, s[12:15], s59 offen offset:0 sc1
 v_mfma_f32_16x16x32_bf16 v[116:119], a[24:27], a[72:75], v[116:119]
 v_cvt_pk_bf16_f32 v73, v74, v75
 v_cvt_pk_bf16_f32 v74, v76, v77
 v_mfma_f32_16x16x32_bf16 v[116:119], a[28:31], a[76:79], v[116:119]
 s_add_u32 m0, s29, 49152
 v_cvt_pk_bf16_f32 v75, v78, v79
 v_cvt_pk_bf16_f32 v80, v80, v81
 v_mfma_f32_16x16x32_bf16 v[124:127], a[28:31], a[68:71], v[124:127]
 buffer_load_dwordx4 v2, s[16:19], s51 offen lds
 v_mfma_f32_16x16x32_bf16 v[124:127], a[24:27], a[64:67], v[124:127]
 v_cvt_pk_bf16_f32 v81, v82, v83
 v_cvt_pk_bf16_f32 v82, v84, v85
 v_mfma_f32_16x16x32_bf16 v[152:155], a[32:35], a[64:67], v[152:155]
 v_cvt_pk_bf16_f32 v83, v86, v87
 v_cvt_pk_bf16_f32 v88, v88, v89
 v_mfma_f32_16x16x32_bf16 v[152:155], a[36:39], a[68:71], v[152:155]
 v_cvt_pk_bf16_f32 v89, v90, v91
 v_cvt_pk_bf16_f32 v90, v92, v93
 v_mfma_f32_16x16x32_bf16 v[144:147], a[36:39], a[76:79], v[144:147]
 s_add_u32 m0, s29, 53248
 v_cvt_pk_bf16_f32 v91, v94, v95
 v_cvt_pk_bf16_f32 v96, v96, v97
 v_mfma_f32_16x16x32_bf16 v[144:147], a[32:35], a[72:75], v[144:147]
 buffer_load_dwordx4 v2, s[16:19], s52 offen lds
 v_mfma_f32_16x16x32_bf16 v[136:139], a[32:35], a[80:83], v[136:139]
 v_cvt_pk_bf16_f32 v97, v98, v99
 v_cvt_pk_bf16_f32 v98, v100, v101
 v_mfma_f32_16x16x32_bf16 v[136:139], a[36:39], a[84:87], v[136:139]
 v_cvt_pk_bf16_f32 v99, v102, v103
 v_cvt_pk_bf16_f32 v104, v104, v105
 v_mfma_f32_16x16x32_bf16 v[128:131], a[36:39], a[92:95], v[128:131]
 v_cvt_pk_bf16_f32 v105, v106, v107
 v_cvt_pk_bf16_f32 v106, v108, v109
 v_mfma_f32_16x16x32_bf16 v[128:131], a[32:35], a[88:91], v[128:131]
 s_add_u32 m0, s29, 57344
 v_cvt_pk_bf16_f32 v107, v110, v111
 v_cvt_pk_bf16_f32 v112, v112, v113
 v_mfma_f32_16x16x32_bf16 v[132:135], a[40:43], a[88:91], v[132:135]
 buffer_load_dwordx4 v2, s[16:19], s53 offen lds
 v_mfma_f32_16x16x32_bf16 v[132:135], a[44:47], a[92:95], v[132:135]
 v_cvt_pk_bf16_f32 v113, v114, v115
 v_cvt_pk_bf16_f32 v114, v116, v117
 v_mfma_f32_16x16x32_bf16 v[140:143], a[44:47], a[84:87], v[140:143]
 v_cvt_pk_bf16_f32 v115, v118, v119
 v_cvt_pk_bf16_f32 v120, v120, v121
 v_mfma_f32_16x16x32_bf16 v[140:143], a[40:43], a[80:83], v[140:143]
 v_cvt_pk_bf16_f32 v121, v122, v123
 v_cvt_pk_bf16_f32 v122, v124, v125
 v_mfma_f32_16x16x32_bf16 v[148:151], a[40:43], a[72:75], v[148:151]
 s_add_u32 m0, s29, 61440
 v_cvt_pk_bf16_f32 v123, v126, v127
 v_mfma_f32_16x16x32_bf16 v[148:151], a[44:47], a[76:79], v[148:151]
 buffer_load_dwordx4 v2, s[16:19], s54 offen lds
 v_mfma_f32_16x16x32_bf16 v[156:159], a[44:47], a[68:71], v[156:159]
 v_mfma_f32_16x16x32_bf16 v[156:159], a[40:43], a[64:67], v[156:159]
 v_mfma_f32_16x16x32_bf16 v[184:187], a[48:51], a[64:67], v[184:187]
 s_add_u32 m0, s29, 98304
 v_add_u32 v2, 0x80000, v2
 v_mfma_f32_16x16x32_bf16 v[184:187], a[52:55], a[68:71], v[184:187]
 buffer_load_dwordx4 v2, s[16:19], 0 offen lds
 v_mfma_f32_16x16x32_bf16 v[176:179], a[52:55], a[76:79], v[176:179]
 v_cvt_pk_bf16_f32 v128, v128, v129
 v_cvt_pk_bf16_f32 v129, v130, v131
 v_mfma_f32_16x16x32_bf16 v[176:179], a[48:51], a[72:75], v[176:179]
 v_cvt_pk_bf16_f32 v130, v132, v133
 v_cvt_pk_bf16_f32 v131, v134, v135
 v_mfma_f32_16x16x32_bf16 v[168:171], a[48:51], a[80:83], v[168:171]
 v_cvt_pk_bf16_f32 v136, v136, v137
 v_cvt_pk_bf16_f32 v137, v138, v139
 v_mfma_f32_16x16x32_bf16 v[168:171], a[52:55], a[84:87], v[168:171]
 s_add_u32 m0, s29, 102400
 v_cvt_pk_bf16_f32 v138, v140, v141
 v_cvt_pk_bf16_f32 v139, v142, v143
 v_mfma_f32_16x16x32_bf16 v[160:163], a[52:55], a[92:95], v[160:163]
 buffer_load_dwordx4 v2, s[16:19], s48 offen lds
 v_mfma_f32_16x16x32_bf16 v[160:163], a[48:51], a[88:91], v[160:163]
 v_cvt_pk_bf16_f32 v144, v144, v145
 v_cvt_pk_bf16_f32 v145, v146, v147
 v_mfma_f32_16x16x32_bf16 v[164:167], a[56:59], a[88:91], v[164:167]
 v_cvt_pk_bf16_f32 v146, v148, v149
 v_cvt_pk_bf16_f32 v147, v150, v151
 v_mfma_f32_16x16x32_bf16 v[164:167], a[60:63], a[92:95], v[164:167]
 v_cvt_pk_bf16_f32 v152, v152, v153
 v_cvt_pk_bf16_f32 v153, v154, v155
 v_mfma_f32_16x16x32_bf16 v[172:175], a[60:63], a[84:87], v[172:175]
 s_add_u32 m0, s29, 106496
 v_cvt_pk_bf16_f32 v154, v156, v157
 v_cvt_pk_bf16_f32 v155, v158, v159
 v_mfma_f32_16x16x32_bf16 v[172:175], a[56:59], a[80:83], v[172:175]
 buffer_load_dwordx4 v2, s[16:19], s49 offen lds
 v_mfma_f32_16x16x32_bf16 v[180:183], a[56:59], a[72:75], v[180:183]
 v_mfma_f32_16x16x32_bf16 v[180:183], a[60:63], a[76:79], v[180:183]
 v_mfma_f32_16x16x32_bf16 v[188:191], a[60:63], a[68:71], v[188:191]
 v_mfma_f32_16x16x32_bf16 v[188:191], a[56:59], a[64:67], v[188:191]
 s_add_u32 m0, s29, 110592
 v_mfma_f32_16x16x32_bf16 v[216:219], a[32:35], a[96:99], v[216:219]
 buffer_load_dwordx4 v2, s[16:19], s50 offen lds
 v_mfma_f32_16x16x32_bf16 v[216:219], a[36:39], a[100:103], v[216:219]
 v_cvt_pk_bf16_f32 v160, v160, v161
 v_cvt_pk_bf16_f32 v161, v162, v163
 v_mfma_f32_16x16x32_bf16 v[208:211], a[36:39], a[108:111], v[208:211]
 v_cvt_pk_bf16_f32 v162, v164, v165
 v_cvt_pk_bf16_f32 v163, v166, v167
 v_mfma_f32_16x16x32_bf16 v[208:211], a[32:35], a[104:107], v[208:211]
 v_cvt_pk_bf16_f32 v168, v168, v169
 v_cvt_pk_bf16_f32 v169, v170, v171
 v_mfma_f32_16x16x32_bf16 v[200:203], a[32:35], a[112:115], v[200:203]
 s_add_u32 m0, s29, 114688
 v_cvt_pk_bf16_f32 v170, v172, v173
 v_cvt_pk_bf16_f32 v171, v174, v175
 v_mfma_f32_16x16x32_bf16 v[200:203], a[36:39], a[116:119], v[200:203]
 buffer_load_dwordx4 v2, s[16:19], s51 offen lds
 v_mfma_f32_16x16x32_bf16 v[192:195], a[36:39], a[124:127], v[192:195]
 v_cvt_pk_bf16_f32 v176, v176, v177
 v_cvt_pk_bf16_f32 v177, v178, v179
 v_mfma_f32_16x16x32_bf16 v[192:195], a[32:35], a[120:123], v[192:195]
 v_cvt_pk_bf16_f32 v178, v180, v181
 v_cvt_pk_bf16_f32 v179, v182, v183
 v_mfma_f32_16x16x32_bf16 v[196:199], a[40:43], a[120:123], v[196:199]
 v_cvt_pk_bf16_f32 v184, v184, v185
 v_cvt_pk_bf16_f32 v185, v186, v187
 v_mfma_f32_16x16x32_bf16 v[196:199], a[44:47], a[124:127], v[196:199]
 s_add_u32 m0, s29, 118784
 v_cvt_pk_bf16_f32 v186, v188, v189
 v_cvt_pk_bf16_f32 v187, v190, v191
 v_mfma_f32_16x16x32_bf16 v[204:207], a[44:47], a[116:119], v[204:207]
 buffer_load_dwordx4 v2, s[16:19], s52 offen lds
 v_mfma_f32_16x16x32_bf16 v[204:207], a[40:43], a[112:115], v[204:207]
 v_mfma_f32_16x16x32_bf16 v[212:215], a[40:43], a[104:107], v[212:215]
 v_mfma_f32_16x16x32_bf16 v[212:215], a[44:47], a[108:111], v[212:215]
 v_mfma_f32_16x16x32_bf16 v[220:223], a[44:47], a[100:103], v[220:223]
 s_add_u32 m0, s29, 122880
 v_mfma_f32_16x16x32_bf16 v[220:223], a[40:43], a[96:99], v[220:223]
 buffer_load_dwordx4 v2, s[16:19], s53 offen lds
 v_mfma_f32_16x16x32_bf16 v[248:251], a[48:51], a[96:99], v[248:251]
 v_mfma_f32_16x16x32_bf16 v[248:251], a[52:55], a[100:103], v[248:251]
 s_waitcnt vmcnt(19)
 v_cvt_pk_bf16_f32 v192, v192, v193
 v_cvt_pk_bf16_f32 v193, v194, v195
 v_mfma_f32_16x16x32_bf16 v[240:243], a[52:55], a[108:111], v[240:243]
 s_barrier
 v_xor_b32 v7, 0, v6
 v_cvt_pk_bf16_f32 v194, v196, v197
 v_mfma_f32_16x16x32_bf16 v[240:243], a[48:51], a[104:107], v[240:243]
 s_add_u32 m0, s29, 126976
 ds_read_b64_tr_b16 a[64:65], v7 offset:0
 v_cvt_pk_bf16_f32 v195, v198, v199
 v_mfma_f32_16x16x32_bf16 v[232:235], a[48:51], a[112:115], v[232:235]
 ds_read_b64_tr_b16 a[66:67], v7 offset:4096
 buffer_load_dwordx4 v2, s[16:19], s54 offen lds
 v_mfma_f32_16x16x32_bf16 v[232:235], a[52:55], a[116:119], v[232:235]
 ds_read_b64_tr_b16 a[68:69], v7 offset:16384
 v_cvt_pk_bf16_f32 v200, v200, v201
 v_mfma_f32_16x16x32_bf16 v[224:227], a[52:55], a[124:127], v[224:227]
 ds_read_b64_tr_b16 a[70:71], v7 offset:20480
 v_xor_b32 v8, 65536, v6
 v_mfma_f32_16x16x32_bf16 v[224:227], a[48:51], a[120:123], v[224:227]
 ds_read_b64_tr_b16 a[72:73], v8 offset:0
 v_cvt_pk_bf16_f32 v201, v202, v203
 v_mfma_f32_16x16x32_bf16 v[228:231], a[56:59], a[120:123], v[228:231]
 ds_read_b64_tr_b16 a[74:75], v8 offset:4096
 v_cvt_pk_bf16_f32 v202, v204, v205
 v_mfma_f32_16x16x32_bf16 v[228:231], a[60:63], a[124:127], v[228:231]
 ds_read_b64_tr_b16 a[76:77], v8 offset:16384
 v_cvt_pk_bf16_f32 v203, v206, v207
 v_mfma_f32_16x16x32_bf16 v[236:239], a[60:63], a[116:119], v[236:239]
 ds_read_b64_tr_b16 a[78:79], v8 offset:20480
 v_xor_b32 v9, 32, v6
 v_mfma_f32_16x16x32_bf16 v[236:239], a[56:59], a[112:115], v[236:239]
 ds_read_b64_tr_b16 a[80:81], v9 offset:0
 v_cvt_pk_bf16_f32 v208, v208, v209
 v_mfma_f32_16x16x32_bf16 v[244:247], a[56:59], a[104:107], v[244:247]
 ds_read_b64_tr_b16 a[82:83], v9 offset:4096
 v_cvt_pk_bf16_f32 v209, v210, v211
 v_mfma_f32_16x16x32_bf16 v[244:247], a[60:63], a[108:111], v[244:247]
 ds_read_b64_tr_b16 a[84:85], v9 offset:16384
 v_cvt_pk_bf16_f32 v210, v212, v213
 v_mfma_f32_16x16x32_bf16 v[252:255], a[60:63], a[100:103], v[252:255]
 ds_read_b64_tr_b16 a[86:87], v9 offset:20480
 v_xor_b32 v10, 65568, v6
 v_mfma_f32_16x16x32_bf16 v[252:255], a[56:59], a[96:99], v[252:255]
 s_waitcnt lgkmcnt(6)
 ds_read_b64_tr_b16 a[88:89], v10 offset:0
 v_cvt_pk_bf16_f32 v211, v214, v215
 v_mfma_f32_16x16x32_bf16 v[28:31], a[64:67], a[128:131], 0
 ds_read_b64_tr_b16 a[90:91], v10 offset:4096
 v_cvt_pk_bf16_f32 v216, v216, v217
 v_mfma_f32_16x16x32_bf16 v[28:31], a[68:71], a[136:139], v[28:31]
 ds_read_b64_tr_b16 a[92:93], v10 offset:16384
 v_xor_b32 v7, 64, v6
 v_mfma_f32_16x16x32_bf16 v[28:31], a[72:75], a[144:147], v[28:31]
 s_waitcnt lgkmcnt(7)
 ds_read_b128 a[112:115], v14 offset:0
 ds_read_b64_tr_b16 a[94:95], v10 offset:20480
 v_mfma_f32_16x16x32_bf16 v[28:31], a[76:79], a[152:155], v[28:31]
 ds_read_b64_tr_b16 a[96:97], v7 offset:0
 v_cvt_pk_bf16_f32 v217, v218, v219
 v_mfma_f32_16x16x32_bf16 v[44:47], a[64:67], a[132:135], 0
 ds_read_b128 a[120:123], v3 offset:0
 ds_read_b64_tr_b16 a[98:99], v7 offset:4096
 v_mfma_f32_16x16x32_bf16 v[44:47], a[68:71], a[140:143], v[44:47]
 ds_read_b64_tr_b16 a[100:101], v7 offset:16384
 v_xor_b32 v8, 65600, v6
 v_mfma_f32_16x16x32_bf16 v[44:47], a[72:75], a[148:151], v[44:47]
 ds_read_b128 a[116:119], v14 offset:2048
 ds_read_b64_tr_b16 a[102:103], v7 offset:20480
 v_mfma_f32_16x16x32_bf16 v[44:47], a[76:79], a[156:159], v[44:47]
 s_waitcnt lgkmcnt(9)
 ds_read_b64_tr_b16 a[104:105], v8 offset:0
 v_cvt_pk_bf16_f32 v218, v220, v221
 v_mfma_f32_16x16x32_bf16 v[52:55], a[80:83], a[128:131], 0
 ds_read_b128 a[124:127], v3 offset:2048
 ds_read_b64_tr_b16 a[106:107], v8 offset:4096
 v_mfma_f32_16x16x32_bf16 v[52:55], a[84:87], a[136:139], v[52:55]
 ds_read_b64_tr_b16 a[108:109], v8 offset:16384
 v_cvt_pk_bf16_f32 v219, v222, v223
 v_mfma_f32_16x16x32_bf16 v[52:55], a[88:91], a[144:147], v[52:55]
 s_waitcnt lgkmcnt(10)
 ds_read_b64_tr_b16 a[110:111], v8 offset:20480
 v_xor_b32 v9, 96, v6
 v_mfma_f32_16x16x32_bf16 v[52:55], a[92:95], a[152:155], v[52:55]
 ds_read_b64_tr_b16 a[64:65], v9 offset:0
 v_cvt_pk_bf16_f32 v224, v224, v225
 v_mfma_f32_16x16x32_bf16 v[60:63], a[80:83], a[132:135], 0
 ds_read_b64_tr_b16 a[66:67], v9 offset:4096
 v_cvt_pk_bf16_f32 v225, v226, v227
 v_mfma_f32_16x16x32_bf16 v[60:63], a[84:87], a[140:143], v[60:63]
 ds_read_b64_tr_b16 a[68:69], v9 offset:16384
 v_cvt_pk_bf16_f32 v226, v228, v229
 v_mfma_f32_16x16x32_bf16 v[60:63], a[88:91], a[148:151], v[60:63]
 ds_read_b64_tr_b16 a[70:71], v9 offset:20480
 v_xor_b32 v10, 65632, v6
 v_mfma_f32_16x16x32_bf16 v[60:63], a[92:95], a[156:159], v[60:63]
 s_waitcnt lgkmcnt(6)
 ds_read_b64_tr_b16 a[72:73], v10 offset:0
 v_cvt_pk_bf16_f32 v227, v230, v231
 v_mfma_f32_16x16x32_bf16 v[20:23], a[96:99], a[128:131], 0
 ds_read_b64_tr_b16 a[74:75], v10 offset:4096
 v_cvt_pk_bf16_f32 v232, v232, v233
 v_mfma_f32_16x16x32_bf16 v[20:23], a[100:103], a[136:139], v[20:23]
 s_waitcnt lgkmcnt(8)
 ds_read_b64_tr_b16 a[76:77], v10 offset:16384
 v_xor_b32 v7, 128, v6
 v_mfma_f32_16x16x32_bf16 v[20:23], a[104:107], a[144:147], v[20:23]
 s_waitcnt lgkmcnt(7)
 s_barrier
 ds_read_b64_tr_b16 a[78:79], v10 offset:20480
 v_mfma_f32_16x16x32_bf16 v[20:23], a[108:111], a[152:155], v[20:23]
 s_add_u32 m0, s29, 131072
 ds_read_b64_tr_b16 a[80:81], v7 offset:0
 v_add_u32 v2, 0x80000, v2
 v_mfma_f32_16x16x32_bf16 v[36:39], a[96:99], a[132:135], 0
 ds_read_b64_tr_b16 a[82:83], v7 offset:4096
 buffer_load_dwordx4 v2, s[16:19], 0 offen lds
 v_mfma_f32_16x16x32_bf16 v[36:39], a[100:103], a[140:143], v[36:39]
 ds_read_b64_tr_b16 a[84:85], v7 offset:16384
 v_cvt_pk_bf16_f32 v233, v234, v235
 v_mfma_f32_16x16x32_bf16 v[36:39], a[104:107], a[148:151], v[36:39]
 ds_read_b64_tr_b16 a[86:87], v7 offset:20480
 v_xor_b32 v8, 65664, v6
 v_mfma_f32_16x16x32_bf16 v[36:39], a[108:111], a[156:159], v[36:39]
 s_waitcnt lgkmcnt(6)
 ds_read_b64_tr_b16 a[88:89], v8 offset:0
 v_cvt_pk_bf16_f32 v234, v236, v237
 v_mfma_f32_16x16x32_bf16 v[68:71], a[64:67], a[128:131], 0
 ds_read_b64_tr_b16 a[90:91], v8 offset:4096
 v_cvt_pk_bf16_f32 v235, v238, v239
 v_mfma_f32_16x16x32_bf16 v[68:71], a[68:71], a[136:139], v[68:71]
 s_add_u32 m0, s29, 135168
 ds_read_b64_tr_b16 a[92:93], v8 offset:16384
 v_cvt_pk_bf16_f32 v240, v240, v241
 v_mfma_f32_16x16x32_bf16 v[68:71], a[72:75], a[144:147], v[68:71]
 s_waitcnt lgkmcnt(7)
 ds_read_b64_tr_b16 a[94:95], v8 offset:20480
 v_xor_b32 v9, 160, v6
 v_mfma_f32_16x16x32_bf16 v[68:71], a[76:79], a[152:155], v[68:71]
 ds_read_b64_tr_b16 a[96:97], v9 offset:0
 buffer_load_dwordx4 v2, s[16:19], s48 offen lds
 v_mfma_f32_16x16x32_bf16 v[76:79], a[64:67], a[132:135], 0
 ds_read_b64_tr_b16 a[98:99], v9 offset:4096
 v_cvt_pk_bf16_f32 v241, v242, v243
 v_mfma_f32_16x16x32_bf16 v[76:79], a[68:71], a[140:143], v[76:79]
 ds_read_b64_tr_b16 a[100:101], v9 offset:16384
 v_cvt_pk_bf16_f32 v242, v244, v245
 v_mfma_f32_16x16x32_bf16 v[76:79], a[72:75], a[148:151], v[76:79]
 ds_read_b64_tr_b16 a[102:103], v9 offset:20480
 v_xor_b32 v10, 65696, v6
 v_mfma_f32_16x16x32_bf16 v[76:79], a[76:79], a[156:159], v[76:79]
 s_waitcnt lgkmcnt(6)
 ds_read_b64_tr_b16 a[104:105], v10 offset:0
 v_cvt_pk_bf16_f32 v243, v246, v247
 v_mfma_f32_16x16x32_bf16 v[84:87], a[80:83], a[128:131], 0
 s_add_u32 m0, s29, 139264
 ds_read_b64_tr_b16 a[106:107], v10 offset:4096
 v_cvt_pk_bf16_f32 v248, v248, v249
 v_mfma_f32_16x16x32_bf16 v[84:87], a[84:87], a[136:139], v[84:87]
 ds_read_b64_tr_b16 a[108:109], v10 offset:16384
 buffer_load_dwordx4 v2, s[16:19], s49 offen lds
 v_mfma_f32_16x16x32_bf16 v[84:87], a[88:91], a[144:147], v[84:87]
 s_waitcnt lgkmcnt(7)
 ds_read_b64_tr_b16 a[110:111], v10 offset:20480
 v_xor_b32 v7, 192, v6
 v_mfma_f32_16x16x32_bf16 v[84:87], a[92:95], a[152:155], v[84:87]
 ds_read_b64_tr_b16 a[64:65], v7 offset:0
 v_cvt_pk_bf16_f32 v249, v250, v251
 v_mfma_f32_16x16x32_bf16 v[92:95], a[80:83], a[132:135], 0
 ds_read_b64_tr_b16 a[66:67], v7 offset:4096
 v_cvt_pk_bf16_f32 v250, v252, v253
 v_mfma_f32_16x16x32_bf16 v[92:95], a[84:87], a[140:143], v[92:95]
 ds_read_b64_tr_b16 a[68:69], v7 offset:16384
 v_cvt_pk_bf16_f32 v251, v254, v255
 v_mfma_f32_16x16x32_bf16 v[92:95], a[88:91], a[148:151], v[92:95]
 s_add_u32 m0, s29, 143360
 ds_read_b64_tr_b16 a[70:71], v7 offset:20480
 v_xor_b32 v8, 65728, v6
 v_mfma_f32_16x16x32_bf16 v[92:95], a[92:95], a[156:159], v[92:95]
 s_waitcnt lgkmcnt(6)
 ds_read_b64_tr_b16 a[72:73], v8 offset:0
 buffer_load_dwordx4 v2, s[16:19], s50 offen lds
 v_mfma_f32_16x16x32_bf16 v[100:103], a[96:99], a[128:131], 0
 ds_read_b64_tr_b16 a[74:75], v8 offset:4096
 v_mov_b32 v12, 0
 v_mfma_f32_16x16x32_bf16 v[100:103], a[100:103], a[136:139], v[100:103]
 ds_read_b64_tr_b16 a[76:77], v8 offset:16384
 global_load_dword a248, v12, s[90:91] offset:128 sc1
 v_mfma_f32_16x16x32_bf16 v[100:103], a[104:107], a[144:147], v[100:103]
 s_waitcnt lgkmcnt(7)
 ds_read_b64_tr_b16 a[78:79], v8 offset:20480
 v_xor_b32 v9, 224, v6
 v_mfma_f32_16x16x32_bf16 v[100:103], a[108:111], a[152:155], v[100:103]
 s_and_b32 s36, s95, 31
 ds_read_b64_tr_b16 a[80:81], v9 offset:0
 v_and_b32 v12, 11, v0
 v_mfma_f32_16x16x32_bf16 v[108:111], a[96:99], a[132:135], 0
 s_add_u32 m0, s29, 147456
 ds_read_b64_tr_b16 a[82:83], v9 offset:4096
 v_lshlrev_b32 v12, 2, v12
 v_mfma_f32_16x16x32_bf16 v[108:111], a[100:103], a[140:143], v[108:111]
 ds_read_b64_tr_b16 a[84:85], v9 offset:16384
 buffer_load_dwordx4 v2, s[16:19], s51 offen lds
 v_mfma_f32_16x16x32_bf16 v[108:111], a[104:107], a[148:151], v[108:111]
 s_lshr_b32 s37, s95, 5
 ds_read_b64_tr_b16 a[86:87], v9 offset:20480
 v_xor_b32 v10, 65760, v6
 v_mfma_f32_16x16x32_bf16 v[108:111], a[108:111], a[156:159], v[108:111]
 s_waitcnt lgkmcnt(6)
 ds_read_b64_tr_b16 a[88:89], v10 offset:0
 v_mfma_f32_16x16x32_bf16 v[116:119], a[64:67], a[128:131], 0
 s_lshl_b32 s38, s3, 4
 ds_read_b64_tr_b16 a[90:91], v10 offset:4096
 v_mfma_f32_16x16x32_bf16 v[116:119], a[68:71], a[136:139], v[116:119]
 s_add_u32 m0, s29, 151552
 ds_read_b64_tr_b16 a[92:93], v10 offset:16384
 v_mfma_f32_16x16x32_bf16 v[116:119], a[72:75], a[144:147], v[116:119]
 s_waitcnt lgkmcnt(7)
 ds_read_b64_tr_b16 a[94:95], v10 offset:20480
 v_xor_b32 v7, 256, v6
 v_mfma_f32_16x16x32_bf16 v[116:119], a[76:79], a[152:155], v[116:119]
 ds_read_b64_tr_b16 a[96:97], v7 offset:0
 buffer_load_dwordx4 v2, s[16:19], s52 offen lds
 v_mfma_f32_16x16x32_bf16 v[124:127], a[64:67], a[132:135], 0
 s_lshl_b32 s39, s36, 6
 ds_read_b64_tr_b16 a[98:99], v7 offset:4096
 v_mfma_f32_16x16x32_bf16 v[124:127], a[68:71], a[140:143], v[124:127]
 s_add_u32 s38, s38, s39
 ds_read_b64_tr_b16 a[100:101], v7 offset:16384
 v_mfma_f32_16x16x32_bf16 v[124:127], a[72:75], a[148:151], v[124:127]
 s_mul_i32 s38, s38, 896
 ds_read_b64_tr_b16 a[102:103], v7 offset:20480
 v_xor_b32 v8, 65792, v6
 v_mfma_f32_16x16x32_bf16 v[124:127], a[76:79], a[156:159], v[124:127]
 s_waitcnt lgkmcnt(6)
 ds_read_b64_tr_b16 a[104:105], v8 offset:0
 v_mfma_f32_16x16x32_bf16 v[132:135], a[80:83], a[128:131], 0
 s_add_u32 m0, s29, 155648
 ds_read_b64_tr_b16 a[106:107], v8 offset:4096
 v_mfma_f32_16x16x32_bf16 v[132:135], a[84:87], a[136:139], v[132:135]
 ds_read_b64_tr_b16 a[108:109], v8 offset:16384
 buffer_load_dwordx4 v2, s[16:19], s53 offen lds
 v_mfma_f32_16x16x32_bf16 v[132:135], a[88:91], a[144:147], v[132:135]
 s_waitcnt lgkmcnt(7)
 ds_read_b64_tr_b16 a[110:111], v8 offset:20480
 v_xor_b32 v9, 288, v6
 v_mfma_f32_16x16x32_bf16 v[132:135], a[92:95], a[152:155], v[132:135]
 s_lshl_b32 s39, s37, 7
 ds_read_b64_tr_b16 a[64:65], v9 offset:0
 v_mfma_f32_16x16x32_bf16 v[140:143], a[80:83], a[132:135], 0
 s_add_u32 s38, s38, s39
 ds_read_b64_tr_b16 a[66:67], v9 offset:4096
 v_mfma_f32_16x16x32_bf16 v[140:143], a[84:87], a[140:143], v[140:143]
 s_lshl_b32 s39, s37, 9
 ds_read_b64_tr_b16 a[68:69], v9 offset:16384
 v_mfma_f32_16x16x32_bf16 v[140:143], a[88:91], a[148:151], v[140:143]
 s_add_u32 m0, s29, 159744
 ds_read_b64_tr_b16 a[70:71], v9 offset:20480
 v_xor_b32 v10, 65824, v6
 v_mfma_f32_16x16x32_bf16 v[140:143], a[92:95], a[156:159], v[140:143]
 s_waitcnt lgkmcnt(6)
 ds_read_b64_tr_b16 a[72:73], v10 offset:0
 buffer_load_dwordx4 v2, s[16:19], s54 offen lds
 v_mfma_f32_16x16x32_bf16 v[148:151], a[96:99], a[128:131], 0
 s_mov_b32 s4, s66
 ds_read_b64_tr_b16 a[74:75], v10 offset:4096
 v_mfma_f32_16x16x32_bf16 v[148:151], a[100:103], a[136:139], v[148:151]
 s_mov_b32 s5, s67
 ds_read_b64_tr_b16 a[76:77], v10 offset:16384
 v_mfma_f32_16x16x32_bf16 v[148:151], a[104:107], a[144:147], v[148:151]
 s_waitcnt lgkmcnt(7)
 ds_read_b64_tr_b16 a[78:79], v10 offset:20480
 v_xor_b32 v7, 320, v6
 v_mfma_f32_16x16x32_bf16 v[148:151], a[108:111], a[152:155], v[148:151]
 s_mov_b32 s6, 1835008
 ds_read_b64_tr_b16 a[80:81], v7 offset:0
 v_mfma_f32_16x16x32_bf16 v[156:159], a[96:99], a[132:135], 0
 s_mov_b32 s7, 0x20000
 ds_read_b64_tr_b16 a[82:83], v7 offset:4096
 v_mfma_f32_16x16x32_bf16 v[156:159], a[100:103], a[140:143], v[156:159]
 s_mov_b32 s8, s68
 ds_read_b64_tr_b16 a[84:85], v7 offset:16384
 v_mfma_f32_16x16x32_bf16 v[156:159], a[104:107], a[148:151], v[156:159]
 s_mov_b32 s9, s69
 ds_read_b64_tr_b16 a[86:87], v7 offset:20480
 v_xor_b32 v8, 65856, v6
 v_mfma_f32_16x16x32_bf16 v[156:159], a[108:111], a[156:159], v[156:159]
 s_waitcnt lgkmcnt(6)
 ds_read_b64_tr_b16 a[88:89], v8 offset:0
 v_mfma_f32_16x16x32_bf16 v[164:167], a[64:67], a[128:131], 0
 s_mov_b32 s10, 1835008
 ds_read_b64_tr_b16 a[90:91], v8 offset:4096
 v_mfma_f32_16x16x32_bf16 v[164:167], a[68:71], a[136:139], v[164:167]
 s_mov_b32 s11, 0x20000
 ds_read_b64_tr_b16 a[92:93], v8 offset:16384
 v_mfma_f32_16x16x32_bf16 v[164:167], a[72:75], a[144:147], v[164:167]
 s_waitcnt lgkmcnt(7)
 ds_read_b64_tr_b16 a[94:95], v8 offset:20480
 v_xor_b32 v9, 352, v6
 v_mfma_f32_16x16x32_bf16 v[164:167], a[76:79], a[152:155], v[164:167]
 s_mov_b32 s20, s70
 ds_read_b64_tr_b16 a[96:97], v9 offset:0
 v_mfma_f32_16x16x32_bf16 v[172:175], a[64:67], a[132:135], 0
 s_mov_b32 s21, s71
 ds_read_b64_tr_b16 a[98:99], v9 offset:4096
 v_mfma_f32_16x16x32_bf16 v[172:175], a[68:71], a[140:143], v[172:175]
 s_mov_b32 s22, 3584
 ds_read_b64_tr_b16 a[100:101], v9 offset:16384
 v_mfma_f32_16x16x32_bf16 v[172:175], a[72:75], a[148:151], v[172:175]
 s_mov_b32 s23, 0x20000
 ds_read_b64_tr_b16 a[102:103], v9 offset:20480
 v_xor_b32 v10, 65888, v6
 v_mfma_f32_16x16x32_bf16 v[172:175], a[76:79], a[156:159], v[172:175]
 s_waitcnt lgkmcnt(6)
 ds_read_b64_tr_b16 a[104:105], v10 offset:0
 v_mfma_f32_16x16x32_bf16 v[180:183], a[80:83], a[128:131], 0
 ds_read_b64_tr_b16 a[106:107], v10 offset:4096
 v_mfma_f32_16x16x32_bf16 v[180:183], a[84:87], a[136:139], v[180:183]
 ds_read_b64_tr_b16 a[108:109], v10 offset:16384
 v_mfma_f32_16x16x32_bf16 v[180:183], a[88:91], a[144:147], v[180:183]
 s_waitcnt lgkmcnt(7)
 ds_read_b64_tr_b16 a[110:111], v10 offset:20480
 v_xor_b32 v7, 384, v6
 v_mfma_f32_16x16x32_bf16 v[180:183], a[92:95], a[152:155], v[180:183]
 ds_read_b64_tr_b16 a[64:65], v7 offset:0
 v_mfma_f32_16x16x32_bf16 v[188:191], a[80:83], a[132:135], 0
 ds_read_b64_tr_b16 a[66:67], v7 offset:4096
 v_mfma_f32_16x16x32_bf16 v[188:191], a[84:87], a[140:143], v[188:191]
 ds_read_b64_tr_b16 a[68:69], v7 offset:16384
 v_mfma_f32_16x16x32_bf16 v[188:191], a[88:91], a[148:151], v[188:191]
 ds_read_b64_tr_b16 a[70:71], v7 offset:20480
 v_xor_b32 v8, 65920, v6
 v_mfma_f32_16x16x32_bf16 v[188:191], a[92:95], a[156:159], v[188:191]
 s_waitcnt lgkmcnt(6)
 ds_read_b64_tr_b16 a[72:73], v8 offset:0
 v_mfma_f32_16x16x32_bf16 v[196:199], a[96:99], a[128:131], 0
 ds_read_b64_tr_b16 a[74:75], v8 offset:4096
 v_mfma_f32_16x16x32_bf16 v[196:199], a[100:103], a[136:139], v[196:199]
 ds_read_b64_tr_b16 a[76:77], v8 offset:16384
 v_mfma_f32_16x16x32_bf16 v[196:199], a[104:107], a[144:147], v[196:199]
 s_waitcnt lgkmcnt(7)
 ds_read_b64_tr_b16 a[78:79], v8 offset:20480
 v_xor_b32 v9, 416, v6
 v_mfma_f32_16x16x32_bf16 v[196:199], a[108:111], a[152:155], v[196:199]
 ds_read_b64_tr_b16 a[80:81], v9 offset:0
 v_mfma_f32_16x16x32_bf16 v[204:207], a[96:99], a[132:135], 0
 ds_read_b64_tr_b16 a[82:83], v9 offset:4096
 v_mfma_f32_16x16x32_bf16 v[204:207], a[100:103], a[140:143], v[204:207]
 ds_read_b64_tr_b16 a[84:85], v9 offset:16384
 v_mfma_f32_16x16x32_bf16 v[204:207], a[104:107], a[148:151], v[204:207]
 ds_read_b64_tr_b16 a[86:87], v9 offset:20480
 v_xor_b32 v10, 65952, v6
 v_mfma_f32_16x16x32_bf16 v[204:207], a[108:111], a[156:159], v[204:207]
 s_waitcnt lgkmcnt(6)
 ds_read_b64_tr_b16 a[88:89], v10 offset:0
 v_mfma_f32_16x16x32_bf16 v[212:215], a[64:67], a[128:131], 0
 ds_read_b64_tr_b16 a[90:91], v10 offset:4096
 v_mfma_f32_16x16x32_bf16 v[212:215], a[68:71], a[136:139], v[212:215]
 ds_read_b64_tr_b16 a[92:93], v10 offset:16384
 v_mfma_f32_16x16x32_bf16 v[212:215], a[72:75], a[144:147], v[212:215]
 s_waitcnt lgkmcnt(7)
 ds_read_b64_tr_b16 a[94:95], v10 offset:20480
 v_xor_b32 v7, 448, v6
 v_mfma_f32_16x16x32_bf16 v[212:215], a[76:79], a[152:155], v[212:215]
 s_add_u32 s59, s56, 57344
 ds_read_b64_tr_b16 a[96:97], v7 offset:0
 v_mfma_f32_16x16x32_bf16 v[220:223], a[64:67], a[132:135], 0
 ds_read_b64_tr_b16 a[98:99], v7 offset:4096
 buffer_store_dwordx4 v[32:35], v1, s[12:15], s59 offen offset:1024 sc1
 v_mfma_f32_16x16x32_bf16 v[220:223], a[68:71], a[140:143], v[220:223]
 ds_read_b64_tr_b16 a[100:101], v7 offset:16384
 v_mfma_f32_16x16x32_bf16 v[220:223], a[72:75], a[148:151], v[220:223]
 ds_read_b64_tr_b16 a[102:103], v7 offset:20480
 v_xor_b32 v8, 65984, v6
 v_mfma_f32_16x16x32_bf16 v[220:223], a[76:79], a[156:159], v[220:223]
 s_waitcnt lgkmcnt(6)
 ds_read_b64_tr_b16 a[104:105], v8 offset:0
 v_mfma_f32_16x16x32_bf16 v[228:231], a[80:83], a[128:131], 0
 ds_read_b64_tr_b16 a[106:107], v8 offset:4096
 v_mfma_f32_16x16x32_bf16 v[228:231], a[84:87], a[136:139], v[228:231]
 ds_read_b64_tr_b16 a[108:109], v8 offset:16384
 v_mfma_f32_16x16x32_bf16 v[228:231], a[88:91], a[144:147], v[228:231]
 s_waitcnt lgkmcnt(7)
 ds_read_b64_tr_b16 a[110:111], v8 offset:20480
 v_xor_b32 v9, 480, v6
 v_mfma_f32_16x16x32_bf16 v[228:231], a[92:95], a[152:155], v[228:231]
 ds_read_b64_tr_b16 a[64:65], v9 offset:0
 v_mfma_f32_16x16x32_bf16 v[236:239], a[80:83], a[132:135], 0
 ds_read_b64_tr_b16 a[66:67], v9 offset:4096
 v_mfma_f32_16x16x32_bf16 v[236:239], a[84:87], a[140:143], v[236:239]
 ds_read_b64_tr_b16 a[68:69], v9 offset:16384
 v_mfma_f32_16x16x32_bf16 v[236:239], a[88:91], a[148:151], v[236:239]
 s_add_u32 s59, s56, 49152
 ds_read_b64_tr_b16 a[70:71], v9 offset:20480
 v_xor_b32 v10, 66016, v6
 v_mfma_f32_16x16x32_bf16 v[236:239], a[92:95], a[156:159], v[236:239]
 s_waitcnt lgkmcnt(6)
 ds_read_b64_tr_b16 a[72:73], v10 offset:0
 buffer_store_dwordx4 v[40:43], v1, s[12:15], s59 offen offset:1024 sc1
 v_mfma_f32_16x16x32_bf16 v[244:247], a[96:99], a[128:131], 0
 ds_read_b64_tr_b16 a[74:75], v10 offset:4096
 v_mfma_f32_16x16x32_bf16 v[244:247], a[100:103], a[136:139], v[244:247]
 s_waitcnt vmcnt(11)
 ds_read_b64_tr_b16 a[76:77], v10 offset:16384
 v_xor_b32 v7, 32768, v6
 v_mfma_f32_16x16x32_bf16 v[244:247], a[104:107], a[144:147], v[244:247]
 s_waitcnt lgkmcnt(7)
 s_barrier
 ds_read_b64_tr_b16 a[78:79], v10 offset:20480
 v_mfma_f32_16x16x32_bf16 v[244:247], a[108:111], a[152:155], v[244:247]
 ds_read_b64_tr_b16 a[80:81], v7 offset:0
 v_mfma_f32_16x16x32_bf16 v[252:255], a[96:99], a[132:135], 0
 ds_read_b64_tr_b16 a[82:83], v7 offset:4096
 v_mfma_f32_16x16x32_bf16 v[252:255], a[100:103], a[140:143], v[252:255]
 ds_read_b64_tr_b16 a[84:85], v7 offset:16384
 v_mfma_f32_16x16x32_bf16 v[252:255], a[104:107], a[148:151], v[252:255]
 ds_read_b64_tr_b16 a[86:87], v7 offset:20480
 v_xor_b32 v8, 98304, v6
 v_mfma_f32_16x16x32_bf16 v[252:255], a[108:111], a[156:159], v[252:255]
 s_waitcnt lgkmcnt(6)
 ds_read_b64_tr_b16 a[88:89], v8 offset:0
 v_mfma_f32_16x16x32_bf16 v[16:19], a[64:67], a[128:131], 0
 s_add_u32 s59, s56, 40960
 ds_read_b64_tr_b16 a[90:91], v8 offset:4096
 v_mfma_f32_16x16x32_bf16 v[16:19], a[68:71], a[136:139], v[16:19]
 ds_read_b64_tr_b16 a[92:93], v8 offset:16384
 buffer_store_dwordx4 v[48:51], v1, s[12:15], s59 offen offset:1024 sc1
 v_mfma_f32_16x16x32_bf16 v[16:19], a[72:75], a[144:147], v[16:19]
 s_waitcnt lgkmcnt(7)
 ds_read_b64_tr_b16 a[94:95], v8 offset:20480
 v_xor_b32 v9, 32800, v6
 v_mfma_f32_16x16x32_bf16 v[16:19], a[76:79], a[152:155], v[16:19]
 ds_read_b64_tr_b16 a[96:97], v9 offset:0
 v_mfma_f32_16x16x32_bf16 v[24:27], a[64:67], a[132:135], 0
 s_waitcnt lgkmcnt(9)
 ds_read_b64_tr_b16 a[98:99], v9 offset:4096
 v_mfma_f32_16x16x32_bf16 v[24:27], a[68:71], a[140:143], v[24:27]
 s_barrier
 ds_read_b64_tr_b16 a[100:101], v9 offset:16384
 v_mfma_f32_16x16x32_bf16 v[24:27], a[72:75], a[148:151], v[24:27]
 s_add_u32 m0, s29, 0
 ds_read_b64_tr_b16 a[102:103], v9 offset:20480
 v_xor_b32 v10, 98336, v6
 v_mfma_f32_16x16x32_bf16 v[24:27], a[76:79], a[156:159], v[24:27]
 s_waitcnt lgkmcnt(6)
 ds_read_b64_tr_b16 a[104:105], v10 offset:0
 v_add_u32 v2, 0x80000, v2
 v_mfma_f32_16x16x32_bf16 v[28:31], a[80:83], a[160:163], v[28:31]
 ds_read_b64_tr_b16 a[106:107], v10 offset:4096
 buffer_load_dwordx4 v2, s[16:19], 0 offen lds
 v_mfma_f32_16x16x32_bf16 v[28:31], a[84:87], a[168:171], v[28:31]
 s_add_u32 s59, s56, 32768
 ds_read_b64_tr_b16 a[108:109], v10 offset:16384
 v_mfma_f32_16x16x32_bf16 v[28:31], a[88:91], a[176:179], v[28:31]
 s_waitcnt lgkmcnt(7)
 ds_read_b64_tr_b16 a[110:111], v10 offset:20480
 v_xor_b32 v7, 32832, v6
 v_mfma_f32_16x16x32_bf16 v[28:31], a[92:95], a[184:187], v[28:31]
 ds_read_b64_tr_b16 a[64:65], v7 offset:0
 buffer_store_dwordx4 v[56:59], v1, s[12:15], s59 offen offset:1024 sc1
 v_mfma_f32_16x16x32_bf16 v[44:47], a[80:83], a[164:167], v[44:47]
 s_add_u32 m0, s29, 4096
 ds_read_b64_tr_b16 a[66:67], v7 offset:4096
 v_add_u32 v4, 4096, v1
 v_mfma_f32_16x16x32_bf16 v[44:47], a[84:87], a[172:175], v[44:47]
 ds_read_b64_tr_b16 a[68:69], v7 offset:16384
 buffer_load_dwordx4 v2, s[16:19], s48 offen lds
 v_mfma_f32_16x16x32_bf16 v[44:47], a[88:91], a[180:183], v[44:47]
 ds_read_b64_tr_b16 a[70:71], v7 offset:20480
 v_xor_b32 v8, 98368, v6
 v_mfma_f32_16x16x32_bf16 v[44:47], a[92:95], a[188:191], v[44:47]
 s_waitcnt lgkmcnt(6)
 ds_read_b64_tr_b16 a[72:73], v8 offset:0
 v_mfma_f32_16x16x32_bf16 v[52:55], a[96:99], a[160:163], v[52:55]
 ds_read_b64_tr_b16 a[74:75], v8 offset:4096
 v_mfma_f32_16x16x32_bf16 v[52:55], a[100:103], a[168:171], v[52:55]
 s_add_u32 m0, s29, 8192
 ds_read_b64_tr_b16 a[76:77], v8 offset:16384
 v_mfma_f32_16x16x32_bf16 v[52:55], a[104:107], a[176:179], v[52:55]
 s_waitcnt lgkmcnt(7)
 ds_read_b64_tr_b16 a[78:79], v8 offset:20480
 v_xor_b32 v9, 32864, v6
 v_mfma_f32_16x16x32_bf16 v[52:55], a[108:111], a[184:187], v[52:55]
 ds_read_b64_tr_b16 a[80:81], v9 offset:0
 buffer_load_dwordx4 v2, s[16:19], s49 offen lds
 v_mfma_f32_16x16x32_bf16 v[60:63], a[96:99], a[164:167], v[60:63]
 s_add_u32 s59, s56, 24576
 ds_read_b64_tr_b16 a[82:83], v9 offset:4096
 v_mfma_f32_16x16x32_bf16 v[60:63], a[100:103], a[172:175], v[60:63]
 ds_read_b64_tr_b16 a[84:85], v9 offset:16384
 buffer_store_dwordx4 v[64:67], v1, s[12:15], s59 offen offset:0 sc1
 v_mfma_f32_16x16x32_bf16 v[60:63], a[104:107], a[180:183], v[60:63]
 s_add_u32 m0, s29, 12288
 ds_read_b64_tr_b16 a[86:87], v9 offset:20480
 v_xor_b32 v10, 98400, v6
 v_mfma_f32_16x16x32_bf16 v[60:63], a[108:111], a[188:191], v[60:63]
 s_waitcnt lgkmcnt(6)
 ds_read_b64_tr_b16 a[88:89], v10 offset:0
 v_mfma_f32_16x16x32_bf16 v[20:23], a[64:67], a[160:163], v[20:23]
 ds_read_b64_tr_b16 a[90:91], v10 offset:4096
 buffer_load_dwordx4 v2, s[16:19], s50 offen lds
 v_mfma_f32_16x16x32_bf16 v[20:23], a[68:71], a[168:171], v[20:23]
 ds_read_b64_tr_b16 a[92:93], v10 offset:16384
 v_mfma_f32_16x16x32_bf16 v[20:23], a[72:75], a[176:179], v[20:23]
 s_waitcnt lgkmcnt(7)
 ds_read_b64_tr_b16 a[94:95], v10 offset:20480
 v_xor_b32 v7, 32896, v6
 v_mfma_f32_16x16x32_bf16 v[20:23], a[76:79], a[184:187], v[20:23]
 ds_read_b64_tr_b16 a[96:97], v7 offset:0
 v_mfma_f32_16x16x32_bf16 v[36:39], a[64:67], a[164:167], v[36:39]
 s_add_u32 m0, s29, 16384
 ds_read_b64_tr_b16 a[98:99], v7 offset:4096
 v_mfma_f32_16x16x32_bf16 v[36:39], a[68:71], a[172:175], v[36:39]
 ds_read_b64_tr_b16 a[100:101], v7 offset:16384
 buffer_load_dwordx4 v2, s[16:19], s51 offen lds
 v_mfma_f32_16x16x32_bf16 v[36:39], a[72:75], a[180:183], v[36:39]
 s_add_u32 s59, s56, 16384
 ds_read_b64_tr_b16 a[102:103], v7 offset:20480
 v_xor_b32 v8, 98432, v6
 v_mfma_f32_16x16x32_bf16 v[36:39], a[76:79], a[188:191], v[36:39]
 s_waitcnt lgkmcnt(6)
 ds_read_b64_tr_b16 a[104:105], v8 offset:0
 buffer_store_dwordx4 v[72:75], v1, s[12:15], s59 offen offset:0 sc1
 v_mfma_f32_16x16x32_bf16 v[68:71], a[80:83], a[160:163], v[68:71]
 ds_read_b64_tr_b16 a[106:107], v8 offset:4096
 v_mfma_f32_16x16x32_bf16 v[68:71], a[84:87], a[168:171], v[68:71]
 s_add_u32 m0, s29, 20480
 ds_read_b64_tr_b16 a[108:109], v8 offset:16384
 v_mfma_f32_16x16x32_bf16 v[68:71], a[88:91], a[176:179], v[68:71]
 s_waitcnt lgkmcnt(7)
 ds_read_b64_tr_b16 a[110:111], v8 offset:20480
 v_xor_b32 v9, 32928, v6
 v_mfma_f32_16x16x32_bf16 v[68:71], a[92:95], a[184:187], v[68:71]
 ds_read_b64_tr_b16 a[64:65], v9 offset:0
 buffer_load_dwordx4 v2, s[16:19], s52 offen lds
 v_mfma_f32_16x16x32_bf16 v[76:79], a[80:83], a[164:167], v[76:79]
 ds_read_b64_tr_b16 a[66:67], v9 offset:4096
 v_mfma_f32_16x16x32_bf16 v[76:79], a[84:87], a[172:175], v[76:79]
 ds_read_b64_tr_b16 a[68:69], v9 offset:16384
 v_mfma_f32_16x16x32_bf16 v[76:79], a[88:91], a[180:183], v[76:79]
 s_add_u32 m0, s29, 24576
 ds_read_b64_tr_b16 a[70:71], v9 offset:20480
 v_xor_b32 v10, 98464, v6
 v_mfma_f32_16x16x32_bf16 v[76:79], a[92:95], a[188:191], v[76:79]
 s_waitcnt lgkmcnt(6)
 ds_read_b64_tr_b16 a[72:73], v10 offset:0
 v_mfma_f32_16x16x32_bf16 v[84:87], a[96:99], a[160:163], v[84:87]
 ds_read_b64_tr_b16 a[74:75], v10 offset:4096
 buffer_load_dwordx4 v2, s[16:19], s53 offen lds
 v_mfma_f32_16x16x32_bf16 v[84:87], a[100:103], a[168:171], v[84:87]
 s_add_u32 s59, s56, 8192
 ds_read_b64_tr_b16 a[76:77], v10 offset:16384
 v_mfma_f32_16x16x32_bf16 v[84:87], a[104:107], a[176:179], v[84:87]
 s_waitcnt lgkmcnt(7)
 ds_read_b64_tr_b16 a[78:79], v10 offset:20480
 v_xor_b32 v7, 32960, v6
 v_mfma_f32_16x16x32_bf16 v[84:87], a[108:111], a[184:187], v[84:87]
 ds_read_b64_tr_b16 a[80:81], v7 offset:0
 buffer_store_dwordx4 v[80:83], v1, s[12:15], s59 offen offset:0 sc1
 v_mfma_f32_16x16x32_bf16 v[92:95], a[96:99], a[164:167], v[92:95]
 s_add_u32 m0, s29, 28672
 ds_read_b64_tr_b16 a[82:83], v7 offset:4096
 v_mfma_f32_16x16x32_bf16 v[92:95], a[100:103], a[172:175], v[92:95]
 ds_read_b64_tr_b16 a[84:85], v7 offset:16384
 buffer_load_dwordx4 v2, s[16:19], s54 offen lds
 v_mfma_f32_16x16x32_bf16 v[92:95], a[104:107], a[180:183], v[92:95]
 ds_read_b64_tr_b16 a[86:87], v7 offset:20480
 v_xor_b32 v8, 98496, v6
 v_mfma_f32_16x16x32_bf16 v[92:95], a[108:111], a[188:191], v[92:95]
 s_waitcnt lgkmcnt(6)
 ds_read_b64_tr_b16 a[88:89], v8 offset:0
 v_mfma_f32_16x16x32_bf16 v[100:103], a[64:67], a[160:163], v[100:103]
 s_add_u32 m0, s29, 65536
 ds_read_b64_tr_b16 a[90:91], v8 offset:4096
 v_add_u32 v2, 0x80000, v2
 v_mfma_f32_16x16x32_bf16 v[100:103], a[68:71], a[168:171], v[100:103]
 ds_read_b64_tr_b16 a[92:93], v8 offset:16384
 buffer_load_dwordx4 v2, s[16:19], 0 offen lds
 v_mfma_f32_16x16x32_bf16 v[100:103], a[72:75], a[176:179], v[100:103]
 s_waitcnt lgkmcnt(7)
 ds_read_b64_tr_b16 a[94:95], v8 offset:20480
 v_xor_b32 v9, 32992, v6
 v_mfma_f32_16x16x32_bf16 v[100:103], a[76:79], a[184:187], v[100:103]
 ds_read_b64_tr_b16 a[96:97], v9 offset:0
 v_mfma_f32_16x16x32_bf16 v[108:111], a[64:67], a[164:167], v[108:111]
 s_add_u32 s59, s56, 0
 ds_read_b64_tr_b16 a[98:99], v9 offset:4096
 v_mfma_f32_16x16x32_bf16 v[108:111], a[68:71], a[172:175], v[108:111]
 ds_read_b64_tr_b16 a[100:101], v9 offset:16384
 buffer_store_dwordx4 v[88:91], v1, s[12:15], s59 offen offset:0 sc1
 v_mfma_f32_16x16x32_bf16 v[108:111], a[72:75], a[180:183], v[108:111]
 s_add_u32 m0, s29, 69632
 ds_read_b64_tr_b16 a[102:103], v9 offset:20480
 v_xor_b32 v10, 98528, v6
 v_mfma_f32_16x16x32_bf16 v[108:111], a[76:79], a[188:191], v[108:111]
 s_waitcnt lgkmcnt(6)
 ds_read_b64_tr_b16 a[104:105], v10 offset:0
 buffer_load_dwordx4 v2, s[16:19], s48 offen lds
 v_mfma_f32_16x16x32_bf16 v[116:119], a[80:83], a[160:163], v[116:119]
 ds_read_b64_tr_b16 a[106:107], v10 offset:4096
 v_mfma_f32_16x16x32_bf16 v[116:119], a[84:87], a[168:171], v[116:119]
 ds_read_b64_tr_b16 a[108:109], v10 offset:16384
 v_mfma_f32_16x16x32_bf16 v[116:119], a[88:91], a[176:179], v[116:119]
 s_waitcnt lgkmcnt(7)
 ds_read_b64_tr_b16 a[110:111], v10 offset:20480
 v_xor_b32 v7, 33024, v6
 v_mfma_f32_16x16x32_bf16 v[116:119], a[92:95], a[184:187], v[116:119]
 s_add_u32 m0, s29, 73728
 ds_read_b64_tr_b16 a[64:65], v7 offset:0
 v_mfma_f32_16x16x32_bf16 v[124:127], a[80:83], a[164:167], v[124:127]
 ds_read_b64_tr_b16 a[66:67], v7 offset:4096
 buffer_load_dwordx4 v2, s[16:19], s49 offen lds
 v_mfma_f32_16x16x32_bf16 v[124:127], a[84:87], a[172:175], v[124:127]
 ds_read_b64_tr_b16 a[68:69], v7 offset:16384
 v_mfma_f32_16x16x32_bf16 v[124:127], a[88:91], a[180:183], v[124:127]
 s_add_u32 s59, s56, 24576
 ds_read_b64_tr_b16 a[70:71], v7 offset:20480
 v_xor_b32 v8, 98560, v6
 v_mfma_f32_16x16x32_bf16 v[124:127], a[92:95], a[188:191], v[124:127]
 s_waitcnt lgkmcnt(6)
 ds_read_b64_tr_b16 a[72:73], v8 offset:0
 buffer_store_dwordx4 v[96:99], v1, s[12:15], s59 offen offset:1024 sc1
 v_mfma_f32_16x16x32_bf16 v[132:135], a[96:99], a[160:163], v[132:135]
 s_add_u32 m0, s29, 77824
 ds_read_b64_tr_b16 a[74:75], v8 offset:4096
 v_mfma_f32_16x16x32_bf16 v[132:135], a[100:103], a[168:171], v[132:135]
 ds_read_b64_tr_b16 a[76:77], v8 offset:16384
 buffer_load_dwordx4 v2, s[16:19], s50 offen lds
 v_mfma_f32_16x16x32_bf16 v[132:135], a[104:107], a[176:179], v[132:135]
 s_waitcnt lgkmcnt(7)
 ds_read_b64_tr_b16 a[78:79], v8 offset:20480
 v_xor_b32 v9, 33056, v6
 v_mfma_f32_16x16x32_bf16 v[132:135], a[108:111], a[184:187], v[132:135]
 ds_read_b64_tr_b16 a[80:81], v9 offset:0
 v_mfma_f32_16x16x32_bf16 v[140:143], a[96:99], a[164:167], v[140:143]
 ds_read_b64_tr_b16 a[82:83], v9 offset:4096
 v_mfma_f32_16x16x32_bf16 v[140:143], a[100:103], a[172:175], v[140:143]
 ds_read_b64_tr_b16 a[84:85], v9 offset:16384
 v_mfma_f32_16x16x32_bf16 v[140:143], a[104:107], a[180:183], v[140:143]
 s_add_u32 m0, s29, 81920
 ds_read_b64_tr_b16 a[86:87], v9 offset:20480
 v_xor_b32 v10, 98592, v6
 v_mfma_f32_16x16x32_bf16 v[140:143], a[108:111], a[188:191], v[140:143]
 s_waitcnt lgkmcnt(6)
 ds_read_b64_tr_b16 a[88:89], v10 offset:0
 buffer_load_dwordx4 v2, s[16:19], s51 offen lds
 v_mfma_f32_16x16x32_bf16 v[148:151], a[64:67], a[160:163], v[148:151]
 s_add_u32 s59, s56, 16384
 ds_read_b64_tr_b16 a[90:91], v10 offset:4096
 v_mfma_f32_16x16x32_bf16 v[148:151], a[68:71], a[168:171], v[148:151]
 ds_read_b64_tr_b16 a[92:93], v10 offset:16384
 buffer_store_dwordx4 v[104:107], v1, s[12:15], s59 offen offset:1024 sc1
 v_mfma_f32_16x16x32_bf16 v[148:151], a[72:75], a[176:179], v[148:151]
 s_waitcnt lgkmcnt(7)
 ds_read_b64_tr_b16 a[94:95], v10 offset:20480
 v_xor_b32 v7, 33088, v6
 v_mfma_f32_16x16x32_bf16 v[148:151], a[76:79], a[184:187], v[148:151]
 s_add_u32 m0, s29, 86016
 ds_read_b64_tr_b16 a[96:97], v7 offset:0
 v_mfma_f32_16x16x32_bf16 v[156:159], a[64:67], a[164:167], v[156:159]
 ds_read_b64_tr_b16 a[98:99], v7 offset:4096
 buffer_load_dwordx4 v2, s[16:19], s52 offen lds
 v_mfma_f32_16x16x32_bf16 v[156:159], a[68:71], a[172:175], v[156:159]
 ds_read_b64_tr_b16 a[100:101], v7 offset:16384
 v_mfma_f32_16x16x32_bf16 v[156:159], a[72:75], a[180:183], v[156:159]
 ds_read_b64_tr_b16 a[102:103], v7 offset:20480
 v_xor_b32 v8, 98624, v6
 v_mfma_f32_16x16x32_bf16 v[156:159], a[76:79], a[188:191], v[156:159]
 s_waitcnt lgkmcnt(6)
 ds_read_b64_tr_b16 a[104:105], v8 offset:0
 v_mfma_f32_16x16x32_bf16 v[164:167], a[80:83], a[160:163], v[164:167]
 s_add_u32 m0, s29, 90112
 ds_read_b64_tr_b16 a[106:107], v8 offset:4096
 v_mfma_f32_16x16x32_bf16 v[164:167], a[84:87], a[168:171], v[164:167]
 ds_read_b64_tr_b16 a[108:109], v8 offset:16384
 buffer_load_dwordx4 v2, s[16:19], s53 offen lds
 v_mfma_f32_16x16x32_bf16 v[164:167], a[88:91], a[176:179], v[164:167]
 s_waitcnt lgkmcnt(7)
 ds_read_b64_tr_b16 a[110:111], v8 offset:20480
 v_xor_b32 v9, 33120, v6
 v_mfma_f32_16x16x32_bf16 v[164:167], a[92:95], a[184:187], v[164:167]
 s_add_u32 s59, s56, 8192
 ds_read_b64_tr_b16 a[64:65], v9 offset:0
 v_mfma_f32_16x16x32_bf16 v[172:175], a[80:83], a[164:167], v[172:175]
 ds_read_b64_tr_b16 a[66:67], v9 offset:4096
 buffer_store_dwordx4 v[112:115], v1, s[12:15], s59 offen offset:1024 sc1
 v_mfma_f32_16x16x32_bf16 v[172:175], a[84:87], a[172:175], v[172:175]
 ds_read_b64_tr_b16 a[68:69], v9 offset:16384
 v_mfma_f32_16x16x32_bf16 v[172:175], a[88:91], a[180:183], v[172:175]
 s_add_u32 m0, s29, 94208
 ds_read_b64_tr_b16 a[70:71], v9 offset:20480
 v_xor_b32 v10, 98656, v6
 v_mfma_f32_16x16x32_bf16 v[172:175], a[92:95], a[188:191], v[172:175]
 s_waitcnt lgkmcnt(6)
 ds_read_b64_tr_b16 a[72:73], v10 offset:0
 buffer_load_dwordx4 v2, s[16:19], s54 offen lds
 v_mfma_f32_16x16x32_bf16 v[180:183], a[96:99], a[160:163], v[180:183]
 ds_read_b64_tr_b16 a[74:75], v10 offset:4096
 v_mfma_f32_16x16x32_bf16 v[180:183], a[100:103], a[168:171], v[180:183]
 ds_read_b64_tr_b16 a[76:77], v10 offset:16384
 v_mfma_f32_16x16x32_bf16 v[180:183], a[104:107], a[176:179], v[180:183]
 s_waitcnt lgkmcnt(7)
 ds_read_b64_tr_b16 a[78:79], v10 offset:20480
 v_xor_b32 v7, 33152, v6
 v_mfma_f32_16x16x32_bf16 v[180:183], a[108:111], a[184:187], v[180:183]
 ds_read_b64_tr_b16 a[80:81], v7 offset:0
 v_mfma_f32_16x16x32_bf16 v[188:191], a[96:99], a[164:167], v[188:191]
 ds_read_b64_tr_b16 a[82:83], v7 offset:4096
 v_mfma_f32_16x16x32_bf16 v[188:191], a[100:103], a[172:175], v[188:191]
 ds_read_b64_tr_b16 a[84:85], v7 offset:16384
 v_mfma_f32_16x16x32_bf16 v[188:191], a[104:107], a[180:183], v[188:191]
 s_add_u32 s59, s56, 0
 ds_read_b64_tr_b16 a[86:87], v7 offset:20480
 v_xor_b32 v8, 98688, v6
 v_mfma_f32_16x16x32_bf16 v[188:191], a[108:111], a[188:191], v[188:191]
 s_waitcnt lgkmcnt(6)
 ds_read_b64_tr_b16 a[88:89], v8 offset:0
 buffer_store_dwordx4 v[120:123], v1, s[12:15], s59 offen offset:1024 sc1
 v_mfma_f32_16x16x32_bf16 v[196:199], a[64:67], a[160:163], v[196:199]
 ds_read_b64_tr_b16 a[90:91], v8 offset:4096
 v_mfma_f32_16x16x32_bf16 v[196:199], a[68:71], a[168:171], v[196:199]
 ds_read_b64_tr_b16 a[92:93], v8 offset:16384
 v_mfma_f32_16x16x32_bf16 v[196:199], a[72:75], a[176:179], v[196:199]
 s_waitcnt lgkmcnt(7)
 ds_read_b64_tr_b16 a[94:95], v8 offset:20480
 v_xor_b32 v9, 33184, v6
 v_mfma_f32_16x16x32_bf16 v[196:199], a[76:79], a[184:187], v[196:199]
 ds_read_b64_tr_b16 a[96:97], v9 offset:0
 v_mfma_f32_16x16x32_bf16 v[204:207], a[64:67], a[164:167], v[204:207]
 ds_read_b64_tr_b16 a[98:99], v9 offset:4096
 v_mfma_f32_16x16x32_bf16 v[204:207], a[68:71], a[172:175], v[204:207]
 ds_read_b64_tr_b16 a[100:101], v9 offset:16384
 v_mfma_f32_16x16x32_bf16 v[204:207], a[72:75], a[180:183], v[204:207]
 ds_read_b64_tr_b16 a[102:103], v9 offset:20480
 v_xor_b32 v10, 98720, v6
 v_mfma_f32_16x16x32_bf16 v[204:207], a[76:79], a[188:191], v[204:207]
 s_waitcnt lgkmcnt(6)
 ds_read_b64_tr_b16 a[104:105], v10 offset:0
 v_mfma_f32_16x16x32_bf16 v[212:215], a[80:83], a[160:163], v[212:215]
 s_add_u32 s59, s56, 24576
 ds_read_b64_tr_b16 a[106:107], v10 offset:4096
 v_mfma_f32_16x16x32_bf16 v[212:215], a[84:87], a[168:171], v[212:215]
 ds_read_b64_tr_b16 a[108:109], v10 offset:16384
 buffer_store_dwordx4 v[128:131], v1, s[12:15], s59 offen offset:2048 sc1
 v_mfma_f32_16x16x32_bf16 v[212:215], a[88:91], a[176:179], v[212:215]
 s_waitcnt lgkmcnt(7)
 ds_read_b64_tr_b16 a[110:111], v10 offset:20480
 v_xor_b32 v7, 33216, v6
 v_mfma_f32_16x16x32_bf16 v[212:215], a[92:95], a[184:187], v[212:215]
 ds_read_b64_tr_b16 a[64:65], v7 offset:0
 v_lshrrev_b32 v120, 3, v0
 v_mfma_f32_16x16x32_bf16 v[220:223], a[80:83], a[164:167], v[220:223]
 ds_read_b64_tr_b16 a[66:67], v7 offset:4096
 v_mul_u32_u24 v120, 1792, v120
 v_mfma_f32_16x16x32_bf16 v[220:223], a[84:87], a[172:175], v[220:223]
 ds_read_b64_tr_b16 a[68:69], v7 offset:16384
 v_and_b32 v121, 7, v0
 v_mfma_f32_16x16x32_bf16 v[220:223], a[88:91], a[180:183], v[220:223]
 ds_read_b64_tr_b16 a[70:71], v7 offset:20480
 v_xor_b32 v8, 98752, v6
 v_mfma_f32_16x16x32_bf16 v[220:223], a[92:95], a[188:191], v[220:223]
 s_waitcnt lgkmcnt(6)
 ds_read_b64_tr_b16 a[72:73], v8 offset:0
 v_lshl_add_u32 v120, v121, 4, v120
 v_mfma_f32_16x16x32_bf16 v[228:231], a[96:99], a[160:163], v[228:231]
 ds_read_b64_tr_b16 a[74:75], v8 offset:4096
 v_add_u32 v120, s38, v120
 v_mfma_f32_16x16x32_bf16 v[228:231], a[100:103], a[168:171], v[228:231]
 s_add_u32 s59, s56, 16384
 ds_read_b64_tr_b16 a[76:77], v8 offset:16384
 v_lshlrev_b32 v121, 6, v121
 v_mfma_f32_16x16x32_bf16 v[228:231], a[104:107], a[176:179], v[228:231]
 s_waitcnt lgkmcnt(7)
 ds_read_b64_tr_b16 a[78:79], v8 offset:20480
 v_xor_b32 v9, 33248, v6
 v_mfma_f32_16x16x32_bf16 v[228:231], a[108:111], a[184:187], v[228:231]
 ds_read_b64_tr_b16 a[80:81], v9 offset:0
 buffer_store_dwordx4 v[136:139], v1, s[12:15], s59 offen offset:2048 sc1
 v_mfma_f32_16x16x32_bf16 v[236:239], a[96:99], a[164:167], v[236:239]
 ds_read_b64_tr_b16 a[82:83], v9 offset:4096
 v_subrev_u32 v122, 2688, v120
 v_mfma_f32_16x16x32_bf16 v[236:239], a[100:103], a[172:175], v[236:239]
 ds_read_b64_tr_b16 a[84:85], v9 offset:16384
 v_subrev_u32 v123, 1792, v120
 v_mfma_f32_16x16x32_bf16 v[236:239], a[104:107], a[180:183], v[236:239]
 ds_read_b64_tr_b16 a[86:87], v9 offset:20480
 v_xor_b32 v10, 98784, v6
 v_mfma_f32_16x16x32_bf16 v[236:239], a[108:111], a[188:191], v[236:239]
 s_waitcnt lgkmcnt(6)
 ds_read_b64_tr_b16 a[88:89], v10 offset:0
 v_subrev_u32 v128, 896, v120
 v_mfma_f32_16x16x32_bf16 v[244:247], a[64:67], a[160:163], v[244:247]
 ds_read_b64_tr_b16 a[90:91], v10 offset:4096
 buffer_load_dwordx4 v[32:35], v122, s[4:7], 0 offen
 v_mfma_f32_16x16x32_bf16 v[244:247], a[68:71], a[168:171], v[244:247]
 s_waitcnt vmcnt(4)
 ds_read_b64_tr_b16 a[92:93], v10 offset:16384
 v_xor_b32 v7, 131072, v6
 v_mfma_f32_16x16x32_bf16 v[244:247], a[72:75], a[176:179], v[244:247]
 s_waitcnt lgkmcnt(7)
 s_barrier
 ds_read_b64_tr_b16 a[94:95], v10 offset:20480
 v_mfma_f32_16x16x32_bf16 v[244:247], a[76:79], a[184:187], v[244:247]
 s_and_b32 s58, s92, ~127
 ds_read_b64_tr_b16 a[96:97], v7 offset:0
 v_mfma_f32_16x16x32_bf16 v[252:255], a[64:67], a[164:167], v[252:255]
 s_add_u32 s59, s56, 8192
 ds_read_b64_tr_b16 a[98:99], v7 offset:4096
 v_mfma_f32_16x16x32_bf16 v[252:255], a[68:71], a[172:175], v[252:255]
 ds_read_b64_tr_b16 a[100:101], v7 offset:16384
 buffer_store_dwordx4 v[144:147], v1, s[12:15], s59 offen offset:2048 sc1
 v_mfma_f32_16x16x32_bf16 v[252:255], a[72:75], a[180:183], v[252:255]
 s_lshl_b32 s37, s25, 1
 ds_read_b64_tr_b16 a[102:103], v7 offset:20480
 v_xor_b32 v8, 0, v6
 v_mfma_f32_16x16x32_bf16 v[252:255], a[76:79], a[188:191], v[252:255]
 s_waitcnt lgkmcnt(6)
 ds_read_b64_tr_b16 a[104:105], v8 offset:0
 buffer_load_dwordx4 v[40:43], v123, s[4:7], 0 offen
 v_mfma_f32_16x16x32_bf16 v[16:19], a[80:83], a[160:163], v[16:19]
 s_sub_i32 s38, 13, s37
 ds_read_b64_tr_b16 a[106:107], v8 offset:4096
 v_accvgpr_read_b32 v5, a248
 v_mfma_f32_16x16x32_bf16 v[16:19], a[84:87], a[168:171], v[16:19]
 s_max_i32 s38, s38, 0
 ds_read_b64_tr_b16 a[108:109], v8 offset:16384
 v_mfma_f32_16x16x32_bf16 v[16:19], a[88:91], a[176:179], v[16:19]
 s_waitcnt lgkmcnt(7)
 ds_read_b64_tr_b16 a[110:111], v8 offset:20480
 v_xor_b32 v9, 65536, v6
 v_mfma_f32_16x16x32_bf16 v[16:19], a[92:95], a[184:187], v[16:19]
 ds_read_b64_tr_b16 a[64:65], v9 offset:0
 buffer_load_dwordx4 v[48:51], v128, s[4:7], 0 offen
 v_mfma_f32_16x16x32_bf16 v[24:27], a[80:83], a[164:167], v[24:27]
 s_lshl_b32 s49, s26, 20
 ds_read_b64_tr_b16 a[66:67], v9 offset:4096
 v_mfma_f32_16x16x32_bf16 v[24:27], a[84:87], a[172:175], v[24:27]
 s_lshl_b32 s50, s3, 13
 ds_read_b64_tr_b16 a[68:69], v9 offset:16384
 v_mfma_f32_16x16x32_bf16 v[24:27], a[88:91], a[180:183], v[24:27]
 s_add_u32 s59, s56, 0
 ds_read_b64_tr_b16 a[70:71], v9 offset:20480
 v_xor_b32 v10, 131104, v6
 v_mfma_f32_16x16x32_bf16 v[24:27], a[92:95], a[188:191], v[24:27]
 s_waitcnt lgkmcnt(6)
 ds_read_b64_tr_b16 a[72:73], v10 offset:0
 buffer_store_dwordx4 v[152:155], v1, s[12:15], s59 offen offset:2048 sc1
 v_mfma_f32_16x16x32_bf16 v[28:31], a[96:99], a[192:195], v[28:31]
 s_add_u32 s49, s49, s50
 ds_read_b64_tr_b16 a[74:75], v10 offset:4096
 v_mfma_f32_16x16x32_bf16 v[28:31], a[100:103], a[200:203], v[28:31]
 ds_read_b64_tr_b16 a[76:77], v10 offset:16384
 buffer_load_dwordx4 v[56:59], v120, s[4:7], 0 offen offset:0
 v_mfma_f32_16x16x32_bf16 v[28:31], a[104:107], a[208:211], v[28:31]
 s_waitcnt lgkmcnt(3)
 ds_read_b64_tr_b16 a[78:79], v10 offset:20480
 v_xor_b32 v7, 32, v6
 v_mfma_f32_16x16x32_bf16 v[28:31], a[108:111], a[216:219], v[28:31]
 s_mov_b32 s54, 0
 ds_read_b64_tr_b16 a[80:81], v7 offset:0
 v_mfma_f32_16x16x32_bf16 v[28:31], a[64:67], a[112:115], v[28:31]
 s_add_u32 s44, s37, 1
 ds_read_b64_tr_b16 a[82:83], v7 offset:4096
 v_mfma_f32_16x16x32_bf16 v[28:31], a[68:71], a[120:123], v[28:31]
 ds_read_b64_tr_b16 a[84:85], v7 offset:16384
 buffer_load_dwordx4 v[64:67], v120, s[4:7], 0 offen offset:896
 v_mfma_f32_16x16x32_bf16 v[44:47], a[96:99], a[196:199], v[44:47]
 s_mov_b32 s42, s49
 ds_read_b64_tr_b16 a[86:87], v7 offset:20480
 v_xor_b32 v8, 65568, v6
 v_mfma_f32_16x16x32_bf16 v[44:47], a[100:103], a[204:207], v[44:47]
 s_add_u32 s60, s94, 4
 ds_read_b64_tr_b16 a[88:89], v8 offset:0
 v_mfma_f32_16x16x32_bf16 v[44:47], a[104:107], a[212:215], v[44:47]
 s_add_u32 s59, s56, 24576
 ds_read_b64_tr_b16 a[90:91], v8 offset:4096
 v_mfma_f32_16x16x32_bf16 v[44:47], a[108:111], a[220:223], v[44:47]
 ds_read_b64_tr_b16 a[92:93], v8 offset:16384
 buffer_store_dwordx4 v[160:163], v1, s[12:15], s59 offen offset:3072 sc1
 v_mfma_f32_16x16x32_bf16 v[44:47], a[64:67], a[116:119], v[44:47]
 s_mov_b32 s45, 2
 ds_read_b64_tr_b16 a[94:95], v8 offset:20480
 v_xor_b32 v9, 131136, v6
 v_mfma_f32_16x16x32_bf16 v[44:47], a[68:71], a[124:127], v[44:47]
 s_waitcnt lgkmcnt(6)
 ds_read_b64_tr_b16 a[96:97], v9 offset:0
 buffer_load_dwordx4 v[72:75], v120, s[8:11], 0 offen offset:0
 v_mfma_f32_16x16x32_bf16 v[52:55], a[72:75], a[192:195], v[52:55]
 s_mov_b32 s66, 1
 ds_read_b64_tr_b16 a[98:99], v9 offset:4096
 v_mfma_f32_16x16x32_bf16 v[52:55], a[76:79], a[200:203], v[52:55]
 s_mov_b32 s68, 1
 ds_read_b64_tr_b16 a[100:101], v9 offset:16384
 v_mfma_f32_16x16x32_bf16 v[52:55], a[80:83], a[208:211], v[52:55]
 s_waitcnt lgkmcnt(3)
 ds_read_b64_tr_b16 a[102:103], v9 offset:20480
 v_xor_b32 v10, 64, v6
 v_mfma_f32_16x16x32_bf16 v[52:55], a[84:87], a[216:219], v[52:55]
 ds_read_b64_tr_b16 a[104:105], v10 offset:0
 buffer_load_dwordx4 v[80:83], v120, s[8:11], 0 offen offset:896
 v_mfma_f32_16x16x32_bf16 v[52:55], a[88:91], a[112:115], v[52:55]
 s_mov_b32 s70, 0x8000
 ds_read_b64_tr_b16 a[106:107], v10 offset:4096
 v_mfma_f32_16x16x32_bf16 v[52:55], a[92:95], a[120:123], v[52:55]
 s_mov_b32 s71, s70
 ds_read_b64_tr_b16 a[108:109], v10 offset:16384
 v_mfma_f32_16x16x32_bf16 v[60:63], a[72:75], a[196:199], v[60:63]
 s_add_u32 s59, s56, 16384
 ds_read_b64_tr_b16 a[110:111], v10 offset:20480
 v_xor_b32 v7, 65600, v6
 v_mfma_f32_16x16x32_bf16 v[60:63], a[76:79], a[204:207], v[60:63]
 ds_read_b64_tr_b16 a[64:65], v7 offset:0
 buffer_store_dwordx4 v[168:171], v1, s[12:15], s59 offen offset:3072 sc1
 v_mfma_f32_16x16x32_bf16 v[60:63], a[80:83], a[212:215], v[60:63]
 s_add_u32 s43, s42, 16777216
 ds_read_b64_tr_b16 a[66:67], v7 offset:4096
 v_mfma_f32_16x16x32_bf16 v[60:63], a[84:87], a[220:223], v[60:63]
 ds_read_b64_tr_b16 a[68:69], v7 offset:16384
 buffer_load_dwordx4 v[88:91], v121, s[20:23], s39 offen offset:0
 v_mfma_f32_16x16x32_bf16 v[60:63], a[88:91], a[116:119], v[60:63]
 s_mov_b32 s40, s50
 ds_read_b64_tr_b16 a[70:71], v7 offset:20480
 v_xor_b32 v8, 131168, v6
 v_mfma_f32_16x16x32_bf16 v[60:63], a[92:95], a[124:127], v[60:63]
 s_waitcnt lgkmcnt(6)
 ds_read_b64_tr_b16 a[72:73], v8 offset:0
 v_mfma_f32_16x16x32_bf16 v[20:23], a[96:99], a[192:195], v[20:23]
 s_add_u32 s41, s50, 0x10000
 ds_read_b64_tr_b16 a[74:75], v8 offset:4096
 v_mfma_f32_16x16x32_bf16 v[20:23], a[100:103], a[200:203], v[20:23]
 ds_read_b64_tr_b16 a[76:77], v8 offset:16384
 buffer_load_dwordx4 v[96:99], v121, s[20:23], s39 offen offset:16
 v_mfma_f32_16x16x32_bf16 v[20:23], a[104:107], a[208:211], v[20:23]
 s_waitcnt lgkmcnt(3)
 ds_read_b64_tr_b16 a[78:79], v8 offset:20480
 v_xor_b32 v9, 96, v6
 v_mfma_f32_16x16x32_bf16 v[20:23], a[108:111], a[216:219], v[20:23]
 s_lshr_b32 s61, s95, 4
 ds_read_b64_tr_b16 a[80:81], v9 offset:0
 v_mul_f32 v28, s34, v28
 v_mfma_f32_16x16x32_bf16 v[20:23], a[64:67], a[112:115], v[20:23]
 s_add_u32 s59, s56, 8192
 ds_read_b64_tr_b16 a[82:83], v9 offset:4096
 v_mul_f32 v29, s34, v29
 v_mfma_f32_16x16x32_bf16 v[20:23], a[68:71], a[120:123], v[20:23]
 ds_read_b64_tr_b16 a[84:85], v9 offset:16384
 buffer_store_dwordx4 v[176:179], v1, s[12:15], s59 offen offset:3072 sc1
 v_mfma_f32_16x16x32_bf16 v[36:39], a[96:99], a[196:199], v[36:39]
 s_lshl_b32 s61, s61, 7
 ds_read_b64_tr_b16 a[86:87], v9 offset:20480
 v_xor_b32 v10, 65632, v6
 v_mfma_f32_16x16x32_bf16 v[36:39], a[100:103], a[204:207], v[36:39]
 ds_read_b64_tr_b16 a[88:89], v10 offset:0
 buffer_load_dwordx4 v[104:107], v121, s[20:23], s39 offen offset:32
 v_mfma_f32_16x16x32_bf16 v[36:39], a[104:107], a[212:215], v[36:39]
 s_add_u32 s61, s61, 84959232
 ds_read_b64_tr_b16 a[90:91], v10 offset:4096
 v_mul_f32 v30, s34, v30
 v_mfma_f32_16x16x32_bf16 v[36:39], a[108:111], a[220:223], v[36:39]
 s_mov_b32 s47, 0x4b800000
 ds_read_b64_tr_b16 a[92:93], v10 offset:16384
 v_mul_f32 v31, s34, v31
 v_mfma_f32_16x16x32_bf16 v[36:39], a[64:67], a[116:119], v[36:39]
 s_lshl_b32 s30, s95, 1
 ds_read_b64_tr_b16 a[94:95], v10 offset:20480
 v_xor_b32 v7, 131200, v6
 v_mfma_f32_16x16x32_bf16 v[36:39], a[68:71], a[124:127], v[36:39]
 s_waitcnt lgkmcnt(6)
 ds_read_b64_tr_b16 a[96:97], v7 offset:0
 buffer_load_dwordx4 v[112:115], v121, s[20:23], s39 offen offset:48
 v_mfma_f32_16x16x32_bf16 v[68:71], a[72:75], a[192:195], v[68:71]
 s_lshr_b32 s31, s3, 1
 ds_read_b64_tr_b16 a[98:99], v7 offset:4096
 v_mul_f32 v52, s34, v52
 v_mfma_f32_16x16x32_bf16 v[68:71], a[76:79], a[200:203], v[68:71]
 s_add_u32 s59, s56, 0
 ds_read_b64_tr_b16 a[100:101], v7 offset:16384
 v_mul_f32 v53, s34, v53
 v_mfma_f32_16x16x32_bf16 v[68:71], a[80:83], a[208:211], v[68:71]
 s_waitcnt lgkmcnt(3)
 ds_read_b64_tr_b16 a[102:103], v7 offset:20480
 v_xor_b32 v8, 128, v6
 v_mfma_f32_16x16x32_bf16 v[68:71], a[84:87], a[216:219], v[68:71]
 ds_read_b64_tr_b16 a[104:105], v8 offset:0
 buffer_store_dwordx4 v[184:187], v1, s[12:15], s59 offen offset:3072 sc1
 v_mfma_f32_16x16x32_bf16 v[68:71], a[88:91], a[112:115], v[68:71]
 s_add_u32 s30, s30, s31
 ds_read_b64_tr_b16 a[106:107], v8 offset:4096
 v_mul_f32 v54, s34, v54
 v_mfma_f32_16x16x32_bf16 v[68:71], a[92:95], a[120:123], v[68:71]
 s_min_u32 s30, s30, 223
 ds_read_b64_tr_b16 a[108:109], v8 offset:16384
 v_mul_f32 v55, s34, v55
 v_mfma_f32_16x16x32_bf16 v[76:79], a[72:75], a[196:199], v[76:79]
 s_lshl_b32 s30, s30, 2
 ds_read_b64_tr_b16 a[110:111], v8 offset:20480
 v_xor_b32 v9, 65664, v6
 v_mfma_f32_16x16x32_bf16 v[76:79], a[76:79], a[204:207], v[76:79]
 s_lshl_b32 s53, s3, 4
 ds_read_b64_tr_b16 a[64:65], v9 offset:0
 v_cvt_pk_bf16_f32 v28, v28, v29
 v_mfma_f32_16x16x32_bf16 v[76:79], a[80:83], a[212:215], v[76:79]
 ds_read_b64_tr_b16 a[66:67], v9 offset:4096
 v_cvt_pk_bf16_f32 v29, v30, v31
 v_mfma_f32_16x16x32_bf16 v[76:79], a[84:87], a[220:223], v[76:79]
 ds_read_b64_tr_b16 a[68:69], v9 offset:16384
 v_cvt_pk_bf16_f32 v30, v52, v53
 v_mfma_f32_16x16x32_bf16 v[76:79], a[88:91], a[116:119], v[76:79]
 ds_read_b64_tr_b16 a[70:71], v9 offset:20480
 v_xor_b32 v10, 131232, v6
 v_mfma_f32_16x16x32_bf16 v[76:79], a[92:95], a[124:127], v[76:79]
 s_waitcnt lgkmcnt(6)
 ds_read_b64_tr_b16 a[72:73], v10 offset:0
 v_cvt_pk_bf16_f32 v31, v54, v55
 v_mfma_f32_16x16x32_bf16 v[84:87], a[96:99], a[192:195], v[84:87]
 s_add_u32 s59, s56, 57344
 ds_read_b64_tr_b16 a[74:75], v10 offset:4096
 v_accvgpr_write_b32 a0, v28
 v_mfma_f32_16x16x32_bf16 v[84:87], a[100:103], a[200:203], v[84:87]
 ds_read_b64_tr_b16 a[76:77], v10 offset:16384
 buffer_store_dwordx4 v[192:195], v1, s[12:15], s59 offen offset:2048 sc1
 v_mfma_f32_16x16x32_bf16 v[84:87], a[104:107], a[208:211], v[84:87]
 s_waitcnt lgkmcnt(3)
 ds_read_b64_tr_b16 a[78:79], v10 offset:20480
 v_xor_b32 v7, 160, v6
 v_mfma_f32_16x16x32_bf16 v[84:87], a[108:111], a[216:219], v[84:87]
 ds_read_b64_tr_b16 a[80:81], v7 offset:0
 v_accvgpr_write_b32 a1, v29
 v_mfma_f32_16x16x32_bf16 v[84:87], a[64:67], a[112:115], v[84:87]
 ds_read_b64_tr_b16 a[82:83], v7 offset:4096
 v_accvgpr_write_b32 a2, v30
 v_mfma_f32_16x16x32_bf16 v[84:87], a[68:71], a[120:123], v[84:87]
 ds_read_b64_tr_b16 a[84:85], v7 offset:16384
 v_accvgpr_write_b32 a3, v31
 v_mfma_f32_16x16x32_bf16 v[92:95], a[96:99], a[196:199], v[92:95]
 ds_read_b64_tr_b16 a[86:87], v7 offset:20480
 v_xor_b32 v8, 65696, v6
 v_mfma_f32_16x16x32_bf16 v[92:95], a[100:103], a[204:207], v[92:95]
 ds_read_b64_tr_b16 a[88:89], v8 offset:0
 v_mul_f32 v44, s34, v44
 v_mfma_f32_16x16x32_bf16 v[92:95], a[104:107], a[212:215], v[92:95]
 ds_read_b64_tr_b16 a[90:91], v8 offset:4096
 v_mul_f32 v45, s34, v45
 v_mfma_f32_16x16x32_bf16 v[92:95], a[108:111], a[220:223], v[92:95]
 ds_read_b64_tr_b16 a[92:93], v8 offset:16384
 v_mul_f32 v46, s34, v46
 v_mfma_f32_16x16x32_bf16 v[92:95], a[64:67], a[116:119], v[92:95]
 s_add_u32 s59, s56, 49152
 ds_read_b64_tr_b16 a[94:95], v8 offset:20480
 v_xor_b32 v9, 131264, v6
 v_mfma_f32_16x16x32_bf16 v[92:95], a[68:71], a[124:127], v[92:95]
 s_waitcnt lgkmcnt(6)
 ds_read_b64_tr_b16 a[96:97], v9 offset:0
 buffer_store_dwordx4 v[200:203], v1, s[12:15], s59 offen offset:2048 sc1
 v_mfma_f32_16x16x32_bf16 v[100:103], a[72:75], a[192:195], v[100:103]
 ds_read_b64_tr_b16 a[98:99], v9 offset:4096
 v_mul_f32 v47, s34, v47
 v_mfma_f32_16x16x32_bf16 v[100:103], a[76:79], a[200:203], v[100:103]
 ds_read_b64_tr_b16 a[100:101], v9 offset:16384
 v_mul_f32 v60, s34, v60
 v_mfma_f32_16x16x32_bf16 v[100:103], a[80:83], a[208:211], v[100:103]
 s_waitcnt lgkmcnt(3)
 ds_read_b64_tr_b16 a[102:103], v9 offset:20480
 v_xor_b32 v10, 192, v6
 v_mfma_f32_16x16x32_bf16 v[100:103], a[84:87], a[216:219], v[100:103]
 ds_read_b64_tr_b16 a[104:105], v10 offset:0
 v_mul_f32 v61, s34, v61
 v_mfma_f32_16x16x32_bf16 v[100:103], a[88:91], a[112:115], v[100:103]
 ds_read_b64_tr_b16 a[106:107], v10 offset:4096
 v_mul_f32 v62, s34, v62
 v_mfma_f32_16x16x32_bf16 v[100:103], a[92:95], a[120:123], v[100:103]
 ds_read_b64_tr_b16 a[108:109], v10 offset:16384
 v_mul_f32 v63, s34, v63
 v_mfma_f32_16x16x32_bf16 v[108:111], a[72:75], a[196:199], v[108:111]
 ds_read_b64_tr_b16 a[110:111], v10 offset:20480
 v_xor_b32 v7, 65728, v6
 v_mfma_f32_16x16x32_bf16 v[108:111], a[76:79], a[204:207], v[108:111]
 ds_read_b64_tr_b16 a[64:65], v7 offset:0
 v_cvt_pk_bf16_f32 v44, v44, v45
 v_mfma_f32_16x16x32_bf16 v[108:111], a[80:83], a[212:215], v[108:111]
 s_add_u32 s59, s56, 40960
 ds_read_b64_tr_b16 a[66:67], v7 offset:4096
 v_cvt_pk_bf16_f32 v45, v46, v47
 v_mfma_f32_16x16x32_bf16 v[108:111], a[84:87], a[220:223], v[108:111]
 ds_read_b64_tr_b16 a[68:69], v7 offset:16384
 buffer_store_dwordx4 v[208:211], v1, s[12:15], s59 offen offset:2048 sc1
 v_mfma_f32_16x16x32_bf16 v[108:111], a[88:91], a[116:119], v[108:111]
 ds_read_b64_tr_b16 a[70:71], v7 offset:20480
 v_xor_b32 v8, 131296, v6
 v_mfma_f32_16x16x32_bf16 v[108:111], a[92:95], a[124:127], v[108:111]
 s_waitcnt lgkmcnt(6)
 ds_read_b64_tr_b16 a[72:73], v8 offset:0
 v_cvt_pk_bf16_f32 v46, v60, v61
 v_mfma_f32_16x16x32_bf16 v[116:119], a[96:99], a[192:195], v[116:119]
 ds_read_b64_tr_b16 a[74:75], v8 offset:4096
 v_cvt_pk_bf16_f32 v47, v62, v63
 v_mfma_f32_16x16x32_bf16 v[116:119], a[100:103], a[200:203], v[116:119]
 ds_read_b64_tr_b16 a[76:77], v8 offset:16384
 v_accvgpr_write_b32 a32, v44
 v_mfma_f32_16x16x32_bf16 v[116:119], a[104:107], a[208:211], v[116:119]
 s_waitcnt lgkmcnt(3)
 ds_read_b64_tr_b16 a[78:79], v8 offset:20480
 v_xor_b32 v9, 224, v6
 v_mfma_f32_16x16x32_bf16 v[116:119], a[108:111], a[216:219], v[116:119]
 ds_read_b64_tr_b16 a[80:81], v9 offset:0
 v_accvgpr_write_b32 a33, v45
 v_mfma_f32_16x16x32_bf16 v[116:119], a[64:67], a[112:115], v[116:119]
 ds_read_b64_tr_b16 a[82:83], v9 offset:4096
 v_accvgpr_write_b32 a34, v46
 v_mfma_f32_16x16x32_bf16 v[116:119], a[68:71], a[120:123], v[116:119]
 ds_read_b64_tr_b16 a[84:85], v9 offset:16384
 v_accvgpr_write_b32 a35, v47
 v_mfma_f32_16x16x32_bf16 v[124:127], a[96:99], a[196:199], v[124:127]
 s_add_u32 s59, s56, 32768
 ds_read_b64_tr_b16 a[86:87], v9 offset:20480
 v_xor_b32 v10, 65760, v6
 v_mfma_f32_16x16x32_bf16 v[124:127], a[100:103], a[204:207], v[124:127]
 ds_read_b64_tr_b16 a[88:89], v10 offset:0
 buffer_store_dwordx4 v[216:219], v1, s[12:15], s59 offen offset:2048 sc1
 v_mfma_f32_16x16x32_bf16 v[124:127], a[104:107], a[212:215], v[124:127]
 ds_read_b64_tr_b16 a[90:91], v10 offset:4096
 v_mul_f32 v20, s34, v20
 v_mfma_f32_16x16x32_bf16 v[124:127], a[108:111], a[220:223], v[124:127]
 ds_read_b64_tr_b16 a[92:93], v10 offset:16384
 v_mul_f32 v21, s34, v21
 v_mfma_f32_16x16x32_bf16 v[124:127], a[64:67], a[116:119], v[124:127]
 ds_read_b64_tr_b16 a[94:95], v10 offset:20480
 v_xor_b32 v7, 131328, v6
 v_mfma_f32_16x16x32_bf16 v[124:127], a[68:71], a[124:127], v[124:127]
 s_waitcnt lgkmcnt(6)
 ds_read_b64_tr_b16 a[96:97], v7 offset:0
 v_mul_f32 v22, s34, v22
 v_mfma_f32_16x16x32_bf16 v[132:135], a[72:75], a[192:195], v[132:135]
 ds_read_b64_tr_b16 a[98:99], v7 offset:4096
 v_mul_f32 v23, s34, v23
 v_mfma_f32_16x16x32_bf16 v[132:135], a[76:79], a[200:203], v[132:135]
 ds_read_b64_tr_b16 a[100:101], v7 offset:16384
 v_mul_f32 v68, s34, v68
 v_mfma_f32_16x16x32_bf16 v[132:135], a[80:83], a[208:211], v[132:135]
 s_waitcnt lgkmcnt(3)
 ds_read_b64_tr_b16 a[102:103], v7 offset:20480
 v_xor_b32 v8, 256, v6
 v_mfma_f32_16x16x32_bf16 v[132:135], a[84:87], a[216:219], v[132:135]
 ds_read_b64_tr_b16 a[104:105], v8 offset:0
 v_mul_f32 v69, s34, v69
 v_mfma_f32_16x16x32_bf16 v[132:135], a[88:91], a[112:115], v[132:135]
 s_add_u32 s59, s56, 57344
 ds_read_b64_tr_b16 a[106:107], v8 offset:4096
 v_mul_f32 v70, s34, v70
 v_mfma_f32_16x16x32_bf16 v[132:135], a[92:95], a[120:123], v[132:135]
 ds_read_b64_tr_b16 a[108:109], v8 offset:16384
 buffer_store_dwordx4 v[224:227], v1, s[12:15], s59 offen offset:3072 sc1
 v_mfma_f32_16x16x32_bf16 v[140:143], a[72:75], a[196:199], v[140:143]
 ds_read_b64_tr_b16 a[110:111], v8 offset:20480
 v_xor_b32 v9, 65792, v6
 v_mfma_f32_16x16x32_bf16 v[140:143], a[76:79], a[204:207], v[140:143]
 ds_read_b64_tr_b16 a[64:65], v9 offset:0
 v_mul_f32 v71, s34, v71
 v_mfma_f32_16x16x32_bf16 v[140:143], a[80:83], a[212:215], v[140:143]
 ds_read_b64_tr_b16 a[66:67], v9 offset:4096
 v_cvt_pk_bf16_f32 v20, v20, v21
 v_mfma_f32_16x16x32_bf16 v[140:143], a[84:87], a[220:223], v[140:143]
 ds_read_b64_tr_b16 a[68:69], v9 offset:16384
 v_cvt_pk_bf16_f32 v21, v22, v23
 v_mfma_f32_16x16x32_bf16 v[140:143], a[88:91], a[116:119], v[140:143]
 ds_read_b64_tr_b16 a[70:71], v9 offset:20480
 v_xor_b32 v10, 131360, v6
 v_mfma_f32_16x16x32_bf16 v[140:143], a[92:95], a[124:127], v[140:143]
 s_waitcnt lgkmcnt(6)
 ds_read_b64_tr_b16 a[72:73], v10 offset:0
 v_cvt_pk_bf16_f32 v22, v68, v69
 v_mfma_f32_16x16x32_bf16 v[148:151], a[96:99], a[192:195], v[148:151]
 ds_read_b64_tr_b16 a[74:75], v10 offset:4096
 v_cvt_pk_bf16_f32 v23, v70, v71
 v_mfma_f32_16x16x32_bf16 v[148:151], a[100:103], a[200:203], v[148:151]
 s_add_u32 s59, s56, 49152
 ds_read_b64_tr_b16 a[76:77], v10 offset:16384
 v_accvgpr_write_b32 a4, v20
 v_mfma_f32_16x16x32_bf16 v[148:151], a[104:107], a[208:211], v[148:151]
 s_waitcnt lgkmcnt(3)
 ds_read_b64_tr_b16 a[78:79], v10 offset:20480
 v_xor_b32 v7, 288, v6
 v_mfma_f32_16x16x32_bf16 v[148:151], a[108:111], a[216:219], v[148:151]
 ds_read_b64_tr_b16 a[80:81], v7 offset:0
 buffer_store_dwordx4 v[232:235], v1, s[12:15], s59 offen offset:3072 sc1
 v_mfma_f32_16x16x32_bf16 v[148:151], a[64:67], a[112:115], v[148:151]
 ds_read_b64_tr_b16 a[82:83], v7 offset:4096
 v_accvgpr_write_b32 a5, v21
 v_mfma_f32_16x16x32_bf16 v[148:151], a[68:71], a[120:123], v[148:151]
 ds_read_b64_tr_b16 a[84:85], v7 offset:16384
 v_accvgpr_write_b32 a6, v22
 v_mfma_f32_16x16x32_bf16 v[156:159], a[96:99], a[196:199], v[156:159]
 ds_read_b64_tr_b16 a[86:87], v7 offset:20480
 v_xor_b32 v8, 65824, v6
 v_mfma_f32_16x16x32_bf16 v[156:159], a[100:103], a[204:207], v[156:159]
 ds_read_b64_tr_b16 a[88:89], v8 offset:0
 v_accvgpr_write_b32 a7, v23
 v_mfma_f32_16x16x32_bf16 v[156:159], a[104:107], a[212:215], v[156:159]
 ds_read_b64_tr_b16 a[90:91], v8 offset:4096
 v_mul_f32 v36, s34, v36
 v_mfma_f32_16x16x32_bf16 v[156:159], a[108:111], a[220:223], v[156:159]
 ds_read_b64_tr_b16 a[92:93], v8 offset:16384
 v_mul_f32 v37, s34, v37
 v_mfma_f32_16x16x32_bf16 v[156:159], a[64:67], a[116:119], v[156:159]
 ds_read_b64_tr_b16 a[94:95], v8 offset:20480
 v_xor_b32 v9, 131392, v6
 v_mfma_f32_16x16x32_bf16 v[156:159], a[68:71], a[124:127], v[156:159]
 s_waitcnt lgkmcnt(6)
 ds_read_b64_tr_b16 a[96:97], v9 offset:0
 v_mul_f32 v38, s34, v38
 v_mfma_f32_16x16x32_bf16 v[164:167], a[72:75], a[192:195], v[164:167]
 s_add_u32 s59, s56, 40960
 ds_read_b64_tr_b16 a[98:99], v9 offset:4096
 v_mul_f32 v39, s34, v39
 v_mfma_f32_16x16x32_bf16 v[164:167], a[76:79], a[200:203], v[164:167]
 ds_read_b64_tr_b16 a[100:101], v9 offset:16384
 buffer_store_dwordx4 v[240:243], v1, s[12:15], s59 offen offset:3072 sc1
 v_mfma_f32_16x16x32_bf16 v[164:167], a[80:83], a[208:211], v[164:167]
 s_waitcnt lgkmcnt(3)
 ds_read_b64_tr_b16 a[102:103], v9 offset:20480
 v_xor_b32 v10, 320, v6
 v_mfma_f32_16x16x32_bf16 v[164:167], a[84:87], a[216:219], v[164:167]
 ds_read_b64_tr_b16 a[104:105], v10 offset:0
 v_mul_f32 v76, s34, v76
 v_mfma_f32_16x16x32_bf16 v[164:167], a[88:91], a[112:115], v[164:167]
 ds_read_b64_tr_b16 a[106:107], v10 offset:4096
 v_mul_f32 v77, s34, v77
 v_mfma_f32_16x16x32_bf16 v[164:167], a[92:95], a[120:123], v[164:167]
 ds_read_b64_tr_b16 a[108:109], v10 offset:16384
 v_mul_f32 v78, s34, v78
 v_mfma_f32_16x16x32_bf16 v[172:175], a[72:75], a[196:199], v[172:175]
 ds_read_b64_tr_b16 a[110:111], v10 offset:20480
 v_xor_b32 v7, 65856, v6
 v_mfma_f32_16x16x32_bf16 v[172:175], a[76:79], a[204:207], v[172:175]
 ds_read_b64_tr_b16 a[64:65], v7 offset:0
 v_mul_f32 v79, s34, v79
 v_mfma_f32_16x16x32_bf16 v[172:175], a[80:83], a[212:215], v[172:175]
 ds_read_b64_tr_b16 a[66:67], v7 offset:4096
 v_cvt_pk_bf16_f32 v36, v36, v37
 v_mfma_f32_16x16x32_bf16 v[172:175], a[84:87], a[220:223], v[172:175]
 ds_read_b64_tr_b16 a[68:69], v7 offset:16384
 v_cvt_pk_bf16_f32 v37, v38, v39
 v_mfma_f32_16x16x32_bf16 v[172:175], a[88:91], a[116:119], v[172:175]
 s_add_u32 s59, s56, 32768
 ds_read_b64_tr_b16 a[70:71], v7 offset:20480
 v_xor_b32 v8, 131424, v6
 v_mfma_f32_16x16x32_bf16 v[172:175], a[92:95], a[124:127], v[172:175]
 s_waitcnt lgkmcnt(6)
 ds_read_b64_tr_b16 a[72:73], v8 offset:0
 buffer_store_dwordx4 v[248:251], v1, s[12:15], s59 offen offset:3072 sc1
 v_mfma_f32_16x16x32_bf16 v[180:183], a[96:99], a[192:195], v[180:183]
 ds_read_b64_tr_b16 a[74:75], v8 offset:4096
 v_cvt_pk_bf16_f32 v38, v76, v77
 v_mfma_f32_16x16x32_bf16 v[180:183], a[100:103], a[200:203], v[180:183]
 ds_read_b64_tr_b16 a[76:77], v8 offset:16384
 v_cvt_pk_bf16_f32 v39, v78, v79
 v_mfma_f32_16x16x32_bf16 v[180:183], a[104:107], a[208:211], v[180:183]
 s_waitcnt lgkmcnt(3)
 ds_read_b64_tr_b16 a[78:79], v8 offset:20480
 v_xor_b32 v9, 352, v6
 v_mfma_f32_16x16x32_bf16 v[180:183], a[108:111], a[216:219], v[180:183]
 ds_read_b64_tr_b16 a[80:81], v9 offset:0
 v_accvgpr_write_b32 a36, v36
 v_mfma_f32_16x16x32_bf16 v[180:183], a[64:67], a[112:115], v[180:183]
 ds_read_b64_tr_b16 a[82:83], v9 offset:4096
 v_accvgpr_write_b32 a37, v37
 v_mfma_f32_16x16x32_bf16 v[180:183], a[68:71], a[120:123], v[180:183]
 ds_read_b64_tr_b16 a[84:85], v9 offset:16384
 v_accvgpr_write_b32 a38, v38
 v_mfma_f32_16x16x32_bf16 v[188:191], a[96:99], a[196:199], v[188:191]
 ds_read_b64_tr_b16 a[86:87], v9 offset:20480
 v_xor_b32 v10, 65888, v6
 v_mfma_f32_16x16x32_bf16 v[188:191], a[100:103], a[204:207], v[188:191]
 ds_read_b64_tr_b16 a[88:89], v10 offset:0
 v_accvgpr_write_b32 a39, v39
 v_mfma_f32_16x16x32_bf16 v[188:191], a[104:107], a[212:215], v[188:191]
 ds_read_b64_tr_b16 a[90:91], v10 offset:4096
 v_mul_f32 v84, s34, v84
 v_mfma_f32_16x16x32_bf16 v[188:191], a[108:111], a[220:223], v[188:191]
 ds_read_b64_tr_b16 a[92:93], v10 offset:16384
 v_mul_f32 v85, s34, v85
 v_mfma_f32_16x16x32_bf16 v[188:191], a[64:67], a[116:119], v[188:191]
 ds_read_b64_tr_b16 a[94:95], v10 offset:20480
 v_xor_b32 v7, 131456, v6
 v_mfma_f32_16x16x32_bf16 v[188:191], a[68:71], a[124:127], v[188:191]
 s_waitcnt lgkmcnt(6)
 ds_read_b64_tr_b16 a[96:97], v7 offset:0
 v_mul_f32 v86, s34, v86
 v_mfma_f32_16x16x32_bf16 v[196:199], a[72:75], a[192:195], v[196:199]
 ds_read_b64_tr_b16 a[98:99], v7 offset:4096
 v_mul_f32 v87, s34, v87
 v_mfma_f32_16x16x32_bf16 v[196:199], a[76:79], a[200:203], v[196:199]
 ds_read_b64_tr_b16 a[100:101], v7 offset:16384
 v_mul_f32 v100, s34, v100
 v_mfma_f32_16x16x32_bf16 v[196:199], a[80:83], a[208:211], v[196:199]
 s_waitcnt lgkmcnt(3)
 ds_read_b64_tr_b16 a[102:103], v7 offset:20480
 v_xor_b32 v8, 384, v6
 v_mfma_f32_16x16x32_bf16 v[196:199], a[84:87], a[216:219], v[196:199]
 ds_read_b64_tr_b16 a[104:105], v8 offset:0
 v_mul_f32 v101, s34, v101
 v_mfma_f32_16x16x32_bf16 v[196:199], a[88:91], a[112:115], v[196:199]
 ds_read_b64_tr_b16 a[106:107], v8 offset:4096
 v_mul_f32 v102, s34, v102
 v_mfma_f32_16x16x32_bf16 v[196:199], a[92:95], a[120:123], v[196:199]
 ds_read_b64_tr_b16 a[108:109], v8 offset:16384
 v_mul_f32 v103, s34, v103
 v_mfma_f32_16x16x32_bf16 v[204:207], a[72:75], a[196:199], v[204:207]
 ds_read_b64_tr_b16 a[110:111], v8 offset:20480
 v_xor_b32 v9, 65920, v6
 v_mfma_f32_16x16x32_bf16 v[204:207], a[76:79], a[204:207], v[204:207]
 ds_read_b64_tr_b16 a[64:65], v9 offset:0
 v_cvt_pk_bf16_f32 v84, v84, v85
 v_mfma_f32_16x16x32_bf16 v[204:207], a[80:83], a[212:215], v[204:207]
 ds_read_b64_tr_b16 a[66:67], v9 offset:4096
 v_cvt_pk_bf16_f32 v85, v86, v87
 v_mfma_f32_16x16x32_bf16 v[204:207], a[84:87], a[220:223], v[204:207]
 ds_read_b64_tr_b16 a[68:69], v9 offset:16384
 v_cvt_pk_bf16_f32 v86, v100, v101
 v_mfma_f32_16x16x32_bf16 v[204:207], a[88:91], a[116:119], v[204:207]
 ds_read_b64_tr_b16 a[70:71], v9 offset:20480
 v_xor_b32 v10, 131488, v6
 v_mfma_f32_16x16x32_bf16 v[204:207], a[92:95], a[124:127], v[204:207]
 s_waitcnt lgkmcnt(6)
 ds_read_b64_tr_b16 a[72:73], v10 offset:0
 v_cvt_pk_bf16_f32 v87, v102, v103
 v_mfma_f32_16x16x32_bf16 v[212:215], a[96:99], a[192:195], v[212:215]
 ds_read_b64_tr_b16 a[74:75], v10 offset:4096
 v_accvgpr_write_b32 a8, v84
 v_mfma_f32_16x16x32_bf16 v[212:215], a[100:103], a[200:203], v[212:215]
 ds_read_b64_tr_b16 a[76:77], v10 offset:16384
 v_accvgpr_write_b32 a9, v85
 v_mfma_f32_16x16x32_bf16 v[212:215], a[104:107], a[208:211], v[212:215]
 s_waitcnt lgkmcnt(3)
 ds_read_b64_tr_b16 a[78:79], v10 offset:20480
 v_xor_b32 v7, 416, v6
 v_mfma_f32_16x16x32_bf16 v[212:215], a[108:111], a[216:219], v[212:215]
 ds_read_b64_tr_b16 a[80:81], v7 offset:0
 v_accvgpr_write_b32 a10, v86
 v_mfma_f32_16x16x32_bf16 v[212:215], a[64:67], a[112:115], v[212:215]
 ds_read_b64_tr_b16 a[82:83], v7 offset:4096
 v_accvgpr_write_b32 a11, v87
 v_mfma_f32_16x16x32_bf16 v[212:215], a[68:71], a[120:123], v[212:215]
 ds_read_b64_tr_b16 a[84:85], v7 offset:16384
 v_mul_f32 v92, s34, v92
 v_mfma_f32_16x16x32_bf16 v[220:223], a[96:99], a[196:199], v[220:223]
 ds_read_b64_tr_b16 a[86:87], v7 offset:20480
 v_xor_b32 v8, 65952, v6
 v_mfma_f32_16x16x32_bf16 v[220:223], a[100:103], a[204:207], v[220:223]
 ds_read_b64_tr_b16 a[88:89], v8 offset:0
 v_mul_f32 v93, s34, v93
 v_mfma_f32_16x16x32_bf16 v[220:223], a[104:107], a[212:215], v[220:223]
 ds_read_b64_tr_b16 a[90:91], v8 offset:4096
 v_mul_f32 v94, s34, v94
 v_mfma_f32_16x16x32_bf16 v[220:223], a[108:111], a[220:223], v[220:223]
 ds_read_b64_tr_b16 a[92:93], v8 offset:16384
 v_mul_f32 v95, s34, v95
 v_mfma_f32_16x16x32_bf16 v[220:223], a[64:67], a[116:119], v[220:223]
 ds_read_b64_tr_b16 a[94:95], v8 offset:20480
 v_xor_b32 v9, 131520, v6
 v_mfma_f32_16x16x32_bf16 v[220:223], a[68:71], a[124:127], v[220:223]
 s_waitcnt lgkmcnt(6)
 ds_read_b64_tr_b16 a[96:97], v9 offset:0
 v_mul_f32 v108, s34, v108
 v_mfma_f32_16x16x32_bf16 v[228:231], a[72:75], a[192:195], v[228:231]
 ds_read_b64_tr_b16 a[98:99], v9 offset:4096
 v_mul_f32 v109, s34, v109
 v_mfma_f32_16x16x32_bf16 v[228:231], a[76:79], a[200:203], v[228:231]
 ds_read_b64_tr_b16 a[100:101], v9 offset:16384
 v_mul_f32 v110, s34, v110
 v_mfma_f32_16x16x32_bf16 v[228:231], a[80:83], a[208:211], v[228:231]
 s_waitcnt lgkmcnt(3)
 ds_read_b64_tr_b16 a[102:103], v9 offset:20480
 v_xor_b32 v10, 448, v6
 v_mfma_f32_16x16x32_bf16 v[228:231], a[84:87], a[216:219], v[228:231]
 ds_read_b64_tr_b16 a[104:105], v10 offset:0
 v_mul_f32 v111, s34, v111
 v_mfma_f32_16x16x32_bf16 v[228:231], a[88:91], a[112:115], v[228:231]
 ds_read_b64_tr_b16 a[106:107], v10 offset:4096
 v_cvt_pk_bf16_f32 v92, v92, v93
 v_mfma_f32_16x16x32_bf16 v[228:231], a[92:95], a[120:123], v[228:231]
 ds_read_b64_tr_b16 a[108:109], v10 offset:16384
 v_cvt_pk_bf16_f32 v93, v94, v95
 v_mfma_f32_16x16x32_bf16 v[236:239], a[72:75], a[196:199], v[236:239]
 ds_read_b64_tr_b16 a[110:111], v10 offset:20480
 v_xor_b32 v7, 65984, v6
 v_mfma_f32_16x16x32_bf16 v[236:239], a[76:79], a[204:207], v[236:239]
 ds_read_b64_tr_b16 a[64:65], v7 offset:0
 buffer_load_dword v13, v12, s[12:15], s58 offen sc1
 v_mfma_f32_16x16x32_bf16 v[236:239], a[80:83], a[212:215], v[236:239]
 ds_read_b64_tr_b16 a[66:67], v7 offset:4096
 v_cvt_pk_bf16_f32 v94, v108, v109
 v_mfma_f32_16x16x32_bf16 v[236:239], a[84:87], a[220:223], v[236:239]
 ds_read_b64_tr_b16 a[68:69], v7 offset:16384
 v_cvt_pk_bf16_f32 v95, v110, v111
 v_mfma_f32_16x16x32_bf16 v[236:239], a[88:91], a[116:119], v[236:239]
 ds_read_b64_tr_b16 a[70:71], v7 offset:20480
 v_xor_b32 v8, 131552, v6
 v_mfma_f32_16x16x32_bf16 v[236:239], a[92:95], a[124:127], v[236:239]
 s_waitcnt lgkmcnt(6)
 ds_read_b64_tr_b16 a[72:73], v8 offset:0
 v_accvgpr_write_b32 a40, v92
 v_mfma_f32_16x16x32_bf16 v[244:247], a[96:99], a[192:195], v[244:247]
 ds_read_b64_tr_b16 a[74:75], v8 offset:4096
 v_accvgpr_write_b32 a41, v93
 v_mfma_f32_16x16x32_bf16 v[244:247], a[100:103], a[200:203], v[244:247]
 ds_read_b64_tr_b16 a[76:77], v8 offset:16384
 v_accvgpr_write_b32 a42, v94
 v_mfma_f32_16x16x32_bf16 v[244:247], a[104:107], a[208:211], v[244:247]
 s_waitcnt lgkmcnt(3)
 ds_read_b64_tr_b16 a[78:79], v8 offset:20480
 v_xor_b32 v9, 480, v6
 v_mfma_f32_16x16x32_bf16 v[244:247], a[108:111], a[216:219], v[244:247]
 ds_read_b64_tr_b16 a[80:81], v9 offset:0
 v_accvgpr_write_b32 a43, v95
 v_mfma_f32_16x16x32_bf16 v[244:247], a[64:67], a[112:115], v[244:247]
 ds_read_b64_tr_b16 a[82:83], v9 offset:4096
 v_mfma_f32_16x16x32_bf16 v[244:247], a[68:71], a[120:123], v[244:247]
 ds_read_b64_tr_b16 a[84:85], v9 offset:16384
 v_mfma_f32_16x16x32_bf16 v[252:255], a[96:99], a[196:199], v[252:255]
 ds_read_b64_tr_b16 a[86:87], v9 offset:20480
 v_xor_b32 v10, 66016, v6
 v_mfma_f32_16x16x32_bf16 v[252:255], a[100:103], a[204:207], v[252:255]
 ds_read_b64_tr_b16 a[88:89], v10 offset:0
 v_mfma_f32_16x16x32_bf16 v[252:255], a[104:107], a[212:215], v[252:255]
 ds_read_b64_tr_b16 a[90:91], v10 offset:4096
 v_mfma_f32_16x16x32_bf16 v[252:255], a[108:111], a[220:223], v[252:255]
 ds_read_b64_tr_b16 a[92:93], v10 offset:16384
 v_mfma_f32_16x16x32_bf16 v[252:255], a[64:67], a[116:119], v[252:255]
 ds_read_b64_tr_b16 a[94:95], v10 offset:20480
 v_mfma_f32_16x16x32_bf16 v[252:255], a[68:71], a[124:127], v[252:255]
 s_waitcnt lgkmcnt(6)
 v_mfma_f32_16x16x32_bf16 v[16:19], a[72:75], a[192:195], v[16:19]
 v_mfma_f32_16x16x32_bf16 v[16:19], a[76:79], a[200:203], v[16:19]
 v_mfma_f32_16x16x32_bf16 v[16:19], a[80:83], a[208:211], v[16:19]
 s_waitcnt lgkmcnt(0)
 v_mfma_f32_16x16x32_bf16 v[16:19], a[84:87], a[216:219], v[16:19]
 v_mfma_f32_16x16x32_bf16 v[16:19], a[88:91], a[112:115], v[16:19]
 v_mfma_f32_16x16x32_bf16 v[16:19], a[92:95], a[120:123], v[16:19]
 v_mfma_f32_16x16x32_bf16 v[24:27], a[72:75], a[196:199], v[24:27]
 v_mfma_f32_16x16x32_bf16 v[24:27], a[76:79], a[204:207], v[24:27]
 v_mfma_f32_16x16x32_bf16 v[24:27], a[80:83], a[212:215], v[24:27]
 v_mfma_f32_16x16x32_bf16 v[24:27], a[84:87], a[220:223], v[24:27]
 s_waitcnt lgkmcnt(0)
 v_mfma_f32_16x16x32_bf16 v[24:27], a[88:91], a[116:119], v[24:27]
 s_barrier
 v_mfma_f32_16x16x32_bf16 v[24:27], a[92:95], a[124:127], v[24:27]
 s_waitcnt vmcnt(0)
 v_cmp_ne_u32 s[16:17], 0, v13
 v_cmp_gt_u32 vcc, 256, v5
 s_or_b64 vcc, vcc, s[16:17]
 s_mov_b32 m0, s40
 s_cselect_b32 s48, 0, 1
 s_cselect_b32 s52, 2.0, s42
 buffer_load_dwordx4 v1, s[12:15], s52 offen offset:0 sc1 lds
 v_pk_mul_f32 v[116:117], v[116:117], s[34:35]
 v_pk_mul_f32 v[118:119], v[118:119], s[34:35]
 v_pk_mul_f32 v[132:133], v[132:133], s[34:35]
 v_pk_mul_f32 v[134:135], v[134:135], s[34:35]
 v_cvt_pk_bf16_f32 v116, v116, v117
 v_cvt_pk_bf16_f32 v117, v118, v119
 v_cvt_pk_bf16_f32 v118, v132, v133
 v_cvt_pk_bf16_f32 v119, v134, v135
 v_accvgpr_write_b32 a12, v116
 v_accvgpr_write_b32 a13, v117
 v_accvgpr_write_b32 a14, v118
 v_accvgpr_write_b32 a15, v119
 v_pk_mul_f32 v[124:125], v[124:125], s[34:35]
 v_pk_mul_f32 v[126:127], v[126:127], s[34:35]
 v_pk_mul_f32 v[140:141], v[140:141], s[34:35]
 buffer_load_dwordx4 v1, s[12:15], s52 offen offset:1024 sc1 lds
 v_pk_mul_f32 v[142:143], v[142:143], s[34:35]
 v_cvt_pk_bf16_f32 v124, v124, v125
 v_cvt_pk_bf16_f32 v125, v126, v127
 v_cvt_pk_bf16_f32 v126, v140, v141
 v_cvt_pk_bf16_f32 v127, v142, v143
 v_accvgpr_write_b32 a44, v124
 v_accvgpr_write_b32 a45, v125
 v_accvgpr_write_b32 a46, v126
 v_accvgpr_write_b32 a47, v127
 v_pk_mul_f32 v[148:149], v[148:149], s[34:35]
 v_pk_mul_f32 v[150:151], v[150:151], s[34:35]
 v_pk_mul_f32 v[164:165], v[164:165], s[34:35]
 v_pk_mul_f32 v[166:167], v[166:167], s[34:35]
 v_cvt_pk_bf16_f32 v148, v148, v149
 v_cvt_pk_bf16_f32 v149, v150, v151
 buffer_load_dwordx4 v1, s[12:15], s52 offen offset:2048 sc1 lds
 v_cvt_pk_bf16_f32 v150, v164, v165
 v_cvt_pk_bf16_f32 v151, v166, v167
 v_accvgpr_write_b32 a16, v148
 v_accvgpr_write_b32 a17, v149
 v_accvgpr_write_b32 a18, v150
 v_accvgpr_write_b32 a19, v151
 v_pk_mul_f32 v[156:157], v[156:157], s[34:35]
 v_pk_mul_f32 v[158:159], v[158:159], s[34:35]
 v_pk_mul_f32 v[172:173], v[172:173], s[34:35]
 v_pk_mul_f32 v[174:175], v[174:175], s[34:35]
 v_cvt_pk_bf16_f32 v156, v156, v157
 v_cvt_pk_bf16_f32 v157, v158, v159
 v_cvt_pk_bf16_f32 v158, v172, v173
 v_cvt_pk_bf16_f32 v159, v174, v175
 v_accvgpr_write_b32 a48, v156
 buffer_load_dwordx4 v1, s[12:15], s52 offen offset:3072 sc1 lds
 v_accvgpr_write_b32 a49, v157
 v_accvgpr_write_b32 a50, v158
 v_accvgpr_write_b32 a51, v159
 v_pk_mul_f32 v[180:181], v[180:181], s[34:35]
 v_pk_mul_f32 v[182:183], v[182:183], s[34:35]
 v_pk_mul_f32 v[196:197], v[196:197], s[34:35]
 v_pk_mul_f32 v[198:199], v[198:199], s[34:35]
 v_cvt_pk_bf16_f32 v180, v180, v181
 v_cvt_pk_bf16_f32 v181, v182, v183
 v_cvt_pk_bf16_f32 v182, v196, v197
 v_cvt_pk_bf16_f32 v183, v198, v199
 v_accvgpr_write_b32 a20, v180
 v_accvgpr_write_b32 a21, v181
 v_accvgpr_write_b32 a22, v182
 v_accvgpr_write_b32 a23, v183
 s_bitset1_b32 m0, 12
 s_nop 0
 buffer_load_dwordx4 v4, s[12:15], s52 offen offset:0 sc1 lds
 v_pk_mul_f32 v[188:189], v[188:189], s[34:35]
 v_pk_mul_f32 v[190:191], v[190:191], s[34:35]
 v_pk_mul_f32 v[204:205], v[204:205], s[34:35]
 v_pk_mul_f32 v[206:207], v[206:207], s[34:35]
 v_cvt_pk_bf16_f32 v188, v188, v189
 v_cvt_pk_bf16_f32 v189, v190, v191
 v_cvt_pk_bf16_f32 v190, v204, v205
 v_cvt_pk_bf16_f32 v191, v206, v207
 v_accvgpr_write_b32 a52, v188
 v_accvgpr_write_b32 a53, v189
 v_accvgpr_write_b32 a54, v190
 v_accvgpr_write_b32 a55, v191
 v_pk_mul_f32 v[212:213], v[212:213], s[34:35]
 v_pk_mul_f32 v[214:215], v[214:215], s[34:35]
 v_pk_mul_f32 v[228:229], v[228:229], s[34:35]
 buffer_load_dwordx4 v4, s[12:15], s52 offen offset:1024 sc1 lds
 v_pk_mul_f32 v[230:231], v[230:231], s[34:35]
 v_cvt_pk_bf16_f32 v212, v212, v213
 v_cvt_pk_bf16_f32 v213, v214, v215
 v_cvt_pk_bf16_f32 v214, v228, v229
 v_cvt_pk_bf16_f32 v215, v230, v231
 v_accvgpr_write_b32 a24, v212
 v_accvgpr_write_b32 a25, v213
 v_accvgpr_write_b32 a26, v214
 v_accvgpr_write_b32 a27, v215
 v_pk_mul_f32 v[220:221], v[220:221], s[34:35]
 v_pk_mul_f32 v[222:223], v[222:223], s[34:35]
 v_pk_mul_f32 v[236:237], v[236:237], s[34:35]
 v_pk_mul_f32 v[238:239], v[238:239], s[34:35]
 v_cvt_pk_bf16_f32 v220, v220, v221
 v_cvt_pk_bf16_f32 v221, v222, v223
 buffer_load_dwordx4 v4, s[12:15], s52 offen offset:2048 sc1 lds
 v_cvt_pk_bf16_f32 v222, v236, v237
 v_cvt_pk_bf16_f32 v223, v238, v239
 v_accvgpr_write_b32 a56, v220
 v_accvgpr_write_b32 a57, v221
 v_accvgpr_write_b32 a58, v222
 v_accvgpr_write_b32 a59, v223
 v_pk_mul_f32 v[244:245], v[244:245], s[34:35]
 v_pk_mul_f32 v[246:247], v[246:247], s[34:35]
 v_pk_mul_f32 v[16:17], v[16:17], s[34:35]
 v_pk_mul_f32 v[18:19], v[18:19], s[34:35]
 v_cvt_pk_bf16_f32 v244, v244, v245
 v_cvt_pk_bf16_f32 v245, v246, v247
 v_cvt_pk_bf16_f32 v246, v16, v17
 v_cvt_pk_bf16_f32 v247, v18, v19
 v_accvgpr_write_b32 a28, v244
 buffer_load_dwordx4 v4, s[12:15], s52 offen offset:3072 sc1 lds
 v_accvgpr_write_b32 a29, v245
 v_accvgpr_write_b32 a30, v246
 v_accvgpr_write_b32 a31, v247
 v_pk_mul_f32 v[252:253], v[252:253], s[34:35]
 v_pk_mul_f32 v[254:255], v[254:255], s[34:35]
 v_pk_mul_f32 v[24:25], v[24:25], s[34:35]
 v_pk_mul_f32 v[26:27], v[26:27], s[34:35]
 v_cvt_pk_bf16_f32 v252, v252, v253
 v_cvt_pk_bf16_f32 v253, v254, v255
 v_cvt_pk_bf16_f32 v254, v24, v25
 v_cvt_pk_bf16_f32 v255, v26, v27
 v_accvgpr_write_b32 a60, v252
 v_accvgpr_write_b32 a61, v253
 v_accvgpr_write_b32 a62, v254
 v_accvgpr_write_b32 a63, v255
 s_branch L_kvdone
L_kloop_side:
 s_mov_b64 exec, 1
 global_atomic_add v3, v15, s[90:91] offset:128 sc1
 s_mov_b64 exec, -1
 s_branch L_kloop_back
L_vloop_side:
 s_mov_b64 exec, 1
 global_atomic_add v3, v15, s[90:91] offset:128 sc1
 s_mov_b64 exec, -1
 s_branch L_vloop_back
L_vloop_head:
 v_mfma_f32_16x16x32_bf16 v[64:67], a[64:67], a[0:3], 0
 s_add_u32 m0, s29, 118784
 ds_read_b64_tr_b16 a[24:25], v9 offset:0
 v_mfma_f32_16x16x32_bf16 v[64:67], a[68:71], a[4:7], v[64:67]
 ds_read_b64_tr_b16 a[26:27], v9 offset:4096
 buffer_load_dwordx4 v2, s[8:11], s52 offen  lds
 v_mfma_f32_16x16x32_bf16 v[68:71], a[76:79], a[4:7], 0
 ds_read_b64_tr_b16 a[28:29], v9 offset:16384
 v_mfma_f32_16x16x32_bf16 v[68:71], a[72:75], a[0:3], v[68:71]
 ds_read_b64_tr_b16 a[30:31], v9 offset:20480
 v_mfma_f32_16x16x32_bf16 v[72:75], a[80:83], a[0:3], 0
 s_add_u32 m0, s29, 53248
 ds_read_b128 a[96:99], v4 offset:8192
 v_mfma_f32_16x16x32_bf16 v[72:75], a[84:87], a[4:7], v[72:75]
 buffer_load_dwordx4 v1, s[4:7], s45 offen  lds
 v_mfma_f32_16x16x32_bf16 v[76:79], a[92:95], a[4:7], 0
 ds_read_b128 a[100:103], v5 offset:8192
 v_mfma_f32_16x16x32_bf16 v[76:79], a[88:91], a[0:3], v[76:79]
 v_mfma_f32_16x16x32_bf16 v[84:87], a[88:91], a[8:11], 0
 s_add_u32 m0, s29, 122880
 ds_read_b128 a[108:111], v5 offset:10240
 v_mfma_f32_16x16x32_bf16 v[84:87], a[92:95], a[12:15], v[84:87]
 buffer_load_dwordx4 v2, s[8:11], s53 offen  lds
 v_mfma_f32_16x16x32_bf16 v[80:83], a[84:87], a[12:15], 0
 ds_read_b128 a[104:107], v4 offset:10240
 v_mfma_f32_16x16x32_bf16 v[80:83], a[80:83], a[8:11], v[80:83]
 v_mfma_f32_16x16x32_bf16 v[92:95], a[72:75], a[8:11], 0
 s_add_u32 m0, s29, 57344
 ds_read_b128 a[112:115], v4 offset:12288
 v_mfma_f32_16x16x32_bf16 v[92:95], a[76:79], a[12:15], v[92:95]
 buffer_load_dwordx4 v1, s[4:7], s46 offen  lds
 v_mfma_f32_16x16x32_bf16 v[88:91], a[68:71], a[12:15], 0
 ds_read_b128 a[116:119], v5 offset:12288
 v_mfma_f32_16x16x32_bf16 v[88:91], a[64:67], a[8:11], v[88:91]
 v_mfma_f32_16x16x32_bf16 v[96:99], a[64:67], a[16:19], 0
 s_add_u32 m0, s29, 126976
 ds_read_b128 a[124:127], v5 offset:14336
 v_mfma_f32_16x16x32_bf16 v[96:99], a[68:71], a[20:23], v[96:99]
 buffer_load_dwordx4 v2, s[8:11], s54 offen  lds
 v_mfma_f32_16x16x32_bf16 v[100:103], a[76:79], a[20:23], 0
 ds_read_b128 a[120:123], v4 offset:14336
 v_mfma_f32_16x16x32_bf16 v[100:103], a[72:75], a[16:19], v[100:103]
 v_mfma_f32_16x16x32_bf16 v[104:107], a[80:83], a[16:19], 0
 s_add_u32 m0, s29, 61440
 ds_read_b64_tr_b16 a[32:33], v10 offset:0
 v_mfma_f32_16x16x32_bf16 v[104:107], a[84:87], a[20:23], v[104:107]
 ds_read_b64_tr_b16 a[34:35], v10 offset:4096
 buffer_load_dwordx4 v1, s[4:7], s47 offen  lds
 v_mfma_f32_16x16x32_bf16 v[108:111], a[92:95], a[20:23], 0
 ds_read_b64_tr_b16 a[36:37], v10 offset:16384
 v_add_u32 v1, 128, v1
 v_mfma_f32_16x16x32_bf16 v[108:111], a[88:91], a[16:19], v[108:111]
 s_waitcnt lgkmcnt(8)
 ds_read_b64_tr_b16 a[38:39], v10 offset:20480
 v_add_u32 v2, 0x80000, v2
 v_mfma_f32_16x16x32_bf16 v[116:119], a[88:91], a[24:27], 0
 ds_read_b64_tr_b16 a[40:41], v11 offset:0
 v_mfma_f32_16x16x32_bf16 v[116:119], a[92:95], a[28:31], v[116:119]
 ds_read_b64_tr_b16 a[42:43], v11 offset:4096
 v_mfma_f32_16x16x32_bf16 v[112:115], a[84:87], a[28:31], 0
 ds_read_b64_tr_b16 a[44:45], v11 offset:16384
 v_mfma_f32_16x16x32_bf16 v[112:115], a[80:83], a[24:27], v[112:115]
 ds_read_b64_tr_b16 a[46:47], v11 offset:20480
 v_mfma_f32_16x16x32_bf16 v[124:127], a[72:75], a[24:27], 0
 ds_read_b64_tr_b16 a[48:49], v12 offset:0
 v_mfma_f32_16x16x32_bf16 v[124:127], a[76:79], a[28:31], v[124:127]
 ds_read_b64_tr_b16 a[50:51], v12 offset:4096
 v_mfma_f32_16x16x32_bf16 v[120:123], a[68:71], a[28:31], 0
 ds_read_b64_tr_b16 a[52:53], v12 offset:16384
 v_mfma_f32_16x16x32_bf16 v[120:123], a[64:67], a[24:27], v[120:123]
 ds_read_b64_tr_b16 a[54:55], v12 offset:20480
 v_mfma_f32_16x16x32_bf16 v[16:19], a[96:99], a[0:3], 0
 ds_read_b64_tr_b16 a[56:57], v13 offset:0
 v_mfma_f32_16x16x32_bf16 v[16:19], a[100:103], a[4:7], v[16:19]
 ds_read_b64_tr_b16 a[58:59], v13 offset:4096
 v_mfma_f32_16x16x32_bf16 v[20:23], a[108:111], a[4:7], 0
 s_waitcnt lgkmcnt(8)
 ds_read_b64_tr_b16 a[60:61], v13 offset:16384
 v_mfma_f32_16x16x32_bf16 v[20:23], a[104:107], a[0:3], v[20:23]
 ds_read_b64_tr_b16 a[62:63], v13 offset:20480
 v_mfma_f32_16x16x32_bf16 v[24:27], a[112:115], a[0:3], 0
 v_mfma_f32_16x16x32_bf16 v[24:27], a[116:119], a[4:7], v[24:27]
 v_mfma_f32_16x16x32_bf16 v[28:31], a[124:127], a[4:7], 0
 v_mfma_f32_16x16x32_bf16 v[28:31], a[120:123], a[0:3], v[28:31]
 s_waitcnt lgkmcnt(0)
 v_mfma_f32_16x16x32_bf16 a[228:231], a[120:123], a[8:11], 0
 s_barrier
 v_mfma_f32_16x16x32_bf16 a[228:231], a[124:127], a[12:15], a[228:231]
 s_add_u32 m0, s29, 65536
 v_mfma_f32_16x16x32_bf16 a[224:227], a[116:119], a[12:15], 0
 buffer_load_dwordx4 v2, s[8:11], 0 offen  lds
 v_mfma_f32_16x16x32_bf16 a[224:227], a[112:115], a[8:11], a[224:227]
 v_mfma_f32_16x16x32_bf16 a[236:239], a[104:107], a[8:11], 0
 v_mfma_f32_16x16x32_bf16 a[236:239], a[108:111], a[12:15], a[236:239]
 v_mfma_f32_16x16x32_bf16 a[232:235], a[100:103], a[12:15], 0
 s_add_u32 m0, s29, 0
 v_mfma_f32_16x16x32_bf16 a[232:235], a[96:99], a[8:11], a[232:235]
 buffer_load_dwordx4 v1, s[4:7], 0 offen  lds
 v_mfma_f32_16x16x32_bf16 v[32:35], a[96:99], a[16:19], 0
 v_mfma_f32_16x16x32_bf16 v[32:35], a[100:103], a[20:23], v[32:35]
 v_mfma_f32_16x16x32_bf16 v[36:39], a[108:111], a[20:23], 0
 v_mfma_f32_16x16x32_bf16 v[36:39], a[104:107], a[16:19], v[36:39]
 s_add_u32 m0, s29, 69632
 v_mfma_f32_16x16x32_bf16 v[40:43], a[112:115], a[16:19], 0
 buffer_load_dwordx4 v2, s[8:11], s48 offen  lds
 v_mfma_f32_16x16x32_bf16 v[40:43], a[116:119], a[20:23], v[40:43]
 v_mfma_f32_16x16x32_bf16 v[44:47], a[124:127], a[20:23], 0
 v_mfma_f32_16x16x32_bf16 v[44:47], a[120:123], a[16:19], v[44:47]
 v_mfma_f32_16x16x32_bf16 v[52:55], a[120:123], a[24:27], 0
 s_add_u32 m0, s29, 4096
 v_mfma_f32_16x16x32_bf16 v[52:55], a[124:127], a[28:31], v[52:55]
 buffer_load_dwordx4 v1, s[4:7], s41 offen  lds
 v_mfma_f32_16x16x32_bf16 v[48:51], a[116:119], a[28:31], 0
 v_mfma_f32_16x16x32_bf16 v[48:51], a[112:115], a[24:27], v[48:51]
 v_mfma_f32_16x16x32_bf16 v[60:63], a[104:107], a[24:27], 0
 v_mfma_f32_16x16x32_bf16 v[60:63], a[108:111], a[28:31], v[60:63]
 s_add_u32 m0, s29, 73728
 v_mfma_f32_16x16x32_bf16 v[56:59], a[100:103], a[28:31], 0
 buffer_load_dwordx4 v2, s[8:11], s49 offen  lds
 v_mfma_f32_16x16x32_bf16 v[56:59], a[96:99], a[24:27], v[56:59]
 v_mfma_f32_16x16x32_bf16 v[192:195], a[96:99], a[32:35], 0
 v_mfma_f32_16x16x32_bf16 v[192:195], a[100:103], a[36:39], v[192:195]
 v_mfma_f32_16x16x32_bf16 v[196:199], a[108:111], a[36:39], 0
 s_add_u32 m0, s29, 8192
 v_mfma_f32_16x16x32_bf16 v[196:199], a[104:107], a[32:35], v[196:199]
 buffer_load_dwordx4 v1, s[4:7], s42 offen  lds
 v_mfma_f32_16x16x32_bf16 v[200:203], a[112:115], a[32:35], 0
 v_mfma_f32_16x16x32_bf16 v[200:203], a[116:119], a[36:39], v[200:203]
 v_mfma_f32_16x16x32_bf16 v[204:207], a[124:127], a[36:39], 0
 v_mfma_f32_16x16x32_bf16 v[204:207], a[120:123], a[32:35], v[204:207]
 s_add_u32 m0, s29, 77824
 v_mfma_f32_16x16x32_bf16 v[212:215], a[120:123], a[40:43], 0
 buffer_load_dwordx4 v2, s[8:11], s50 offen  lds
 v_mfma_f32_16x16x32_bf16 v[212:215], a[124:127], a[44:47], v[212:215]
 v_mfma_f32_16x16x32_bf16 v[208:211], a[116:119], a[44:47], 0
 v_mfma_f32_16x16x32_bf16 v[208:211], a[112:115], a[40:43], v[208:211]
 v_mfma_f32_16x16x32_bf16 v[220:223], a[104:107], a[40:43], 0
 s_add_u32 m0, s29, 12288
 v_mfma_f32_16x16x32_bf16 v[220:223], a[108:111], a[44:47], v[220:223]
 buffer_load_dwordx4 v1, s[4:7], s43 offen  lds
 v_mfma_f32_16x16x32_bf16 v[216:219], a[100:103], a[44:47], 0
 v_mfma_f32_16x16x32_bf16 v[216:219], a[96:99], a[40:43], v[216:219]
 v_mfma_f32_16x16x32_bf16 v[224:227], a[96:99], a[48:51], 0
 v_mfma_f32_16x16x32_bf16 v[224:227], a[100:103], a[52:55], v[224:227]
 s_add_u32 m0, s29, 81920
 v_mfma_f32_16x16x32_bf16 v[228:231], a[108:111], a[52:55], 0
 buffer_load_dwordx4 v2, s[8:11], s51 offen  lds
 v_mfma_f32_16x16x32_bf16 v[228:231], a[104:107], a[48:51], v[228:231]
 v_mfma_f32_16x16x32_bf16 v[232:235], a[112:115], a[48:51], 0
 v_mfma_f32_16x16x32_bf16 v[232:235], a[116:119], a[52:55], v[232:235]
 v_mfma_f32_16x16x32_bf16 v[236:239], a[124:127], a[52:55], 0
 s_add_u32 m0, s29, 16384
 v_mfma_f32_16x16x32_bf16 v[236:239], a[120:123], a[48:51], v[236:239]
 buffer_load_dwordx4 v1, s[4:7], s44 offen  lds
 v_mfma_f32_16x16x32_bf16 v[244:247], a[120:123], a[56:59], 0
 v_mfma_f32_16x16x32_bf16 v[244:247], a[124:127], a[60:63], v[244:247]
 v_mfma_f32_16x16x32_bf16 v[240:243], a[116:119], a[60:63], 0
 v_mfma_f32_16x16x32_bf16 v[240:243], a[112:115], a[56:59], v[240:243]
 s_add_u32 m0, s29, 86016
 v_mfma_f32_16x16x32_bf16 v[252:255], a[104:107], a[56:59], 0
 s_waitcnt vmcnt(10)
 buffer_load_dwordx4 v2, s[8:11], s52 offen  lds
 v_mfma_f32_16x16x32_bf16 v[252:255], a[108:111], a[60:63], v[252:255]
 s_barrier
 ds_read_b64_tr_b16 a[0:1], v6 offset:32768
 v_mfma_f32_16x16x32_bf16 v[248:251], a[100:103], a[60:63], 0
 ds_read_b64_tr_b16 a[2:3], v6 offset:36864
 v_mfma_f32_16x16x32_bf16 v[248:251], a[96:99], a[56:59], v[248:251]
 ds_read_b128 a[96:99], v4 offset:40960
 v_mfma_f32_16x16x32_bf16 v[128:131], a[64:67], a[32:35], 0
 s_add_u32 m0, s29, 20480
 v_mfma_f32_16x16x32_bf16 v[128:131], a[68:71], a[36:39], v[128:131]
 buffer_load_dwordx4 v1, s[4:7], s45 offen  lds
 v_mfma_f32_16x16x32_bf16 v[132:135], a[76:79], a[36:39], 0
 ds_read_b64_tr_b16 a[4:5], v6 offset:49152
 v_mfma_f32_16x16x32_bf16 v[132:135], a[72:75], a[32:35], v[132:135]
 ds_read_b64_tr_b16 a[6:7], v6 offset:53248
 v_mfma_f32_16x16x32_bf16 v[136:139], a[80:83], a[32:35], 0
 ds_read_b128 a[100:103], v5 offset:40960
 v_mfma_f32_16x16x32_bf16 v[136:139], a[84:87], a[36:39], v[136:139]
 s_add_u32 m0, s29, 90112
 v_mfma_f32_16x16x32_bf16 v[140:143], a[92:95], a[36:39], 0
 buffer_load_dwordx4 v2, s[8:11], s53 offen  lds
 v_mfma_f32_16x16x32_bf16 v[140:143], a[88:91], a[32:35], v[140:143]
 ds_read_b128 a[108:111], v5 offset:43008
 v_mfma_f32_16x16x32_bf16 v[148:151], a[88:91], a[40:43], 0
 v_mfma_f32_16x16x32_bf16 v[148:151], a[92:95], a[44:47], v[148:151]
 ds_read_b128 a[104:107], v4 offset:43008
 v_mfma_f32_16x16x32_bf16 v[144:147], a[84:87], a[44:47], 0
 s_add_u32 m0, s29, 24576
 v_mfma_f32_16x16x32_bf16 v[144:147], a[80:83], a[40:43], v[144:147]
 buffer_load_dwordx4 v1, s[4:7], s46 offen  lds
 v_mfma_f32_16x16x32_bf16 v[156:159], a[72:75], a[40:43], 0
 ds_read_b128 a[112:115], v4 offset:45056
 v_mfma_f32_16x16x32_bf16 v[156:159], a[76:79], a[44:47], v[156:159]
 v_mfma_f32_16x16x32_bf16 v[152:155], a[68:71], a[44:47], 0
 ds_read_b128 a[116:119], v5 offset:45056
 v_mfma_f32_16x16x32_bf16 v[152:155], a[64:67], a[40:43], v[152:155]
 s_add_u32 m0, s29, 94208
 v_mfma_f32_16x16x32_bf16 v[160:163], a[64:67], a[48:51], 0
 buffer_load_dwordx4 v2, s[8:11], s54 offen  lds
 v_mfma_f32_16x16x32_bf16 v[160:163], a[68:71], a[52:55], v[160:163]
 ds_read_b128 a[124:127], v5 offset:47104
 v_mfma_f32_16x16x32_bf16 v[164:167], a[76:79], a[52:55], 0
 v_mfma_f32_16x16x32_bf16 v[164:167], a[72:75], a[48:51], v[164:167]
 ds_read_b128 a[120:123], v4 offset:47104
 v_mfma_f32_16x16x32_bf16 v[168:171], a[80:83], a[48:51], 0
 s_add_u32 m0, s29, 28672
 v_mfma_f32_16x16x32_bf16 v[168:171], a[84:87], a[52:55], v[168:171]
 buffer_load_dwordx4 v1, s[4:7], s47 offen  lds
 v_mfma_f32_16x16x32_bf16 v[172:175], a[92:95], a[52:55], 0
 v_mfma_f32_16x16x32_bf16 v[172:175], a[88:91], a[48:51], v[172:175]
 ds_read_b64_tr_b16 a[8:9], v7 offset:32768
 v_mfma_f32_16x16x32_bf16 v[180:183], a[88:91], a[56:59], 0
 v_mfma_f32_16x16x32_bf16 v[180:183], a[92:95], a[60:63], v[180:183]
 ds_read_b64_tr_b16 a[10:11], v7 offset:36864
 v_mfma_f32_16x16x32_bf16 v[176:179], a[84:87], a[60:63], 0
 ds_read_b64_tr_b16 a[12:13], v7 offset:49152
 v_mfma_f32_16x16x32_bf16 v[176:179], a[80:83], a[56:59], v[176:179]
 ds_read_b64_tr_b16 a[14:15], v7 offset:53248
 v_mfma_f32_16x16x32_bf16 v[188:191], a[72:75], a[56:59], 0
 ds_read_b64_tr_b16 a[16:17], v8 offset:32768
 v_mfma_f32_16x16x32_bf16 v[188:191], a[76:79], a[60:63], v[188:191]
 ds_read_b64_tr_b16 a[18:19], v8 offset:36864
 v_mfma_f32_16x16x32_bf16 v[184:187], a[68:71], a[60:63], 0
 ds_read_b64_tr_b16 a[20:21], v8 offset:49152
 v_mfma_f32_16x16x32_bf16 v[184:187], a[64:67], a[56:59], v[184:187]
 s_waitcnt lgkmcnt(8)
 ds_read_b64_tr_b16 a[22:23], v8 offset:53248
 v_add_u32 v1, 128, v1
 v_add_u32 v2, 0x80000, v2
 s_add_u32 s56, s56, s30
 buffer_load_dword a243, v14, s[36:39], s56 offen
 s_add_u32 s56, s56, s30
 buffer_load_dword a243, v14, s[36:39], s56 offen
 s_add_u32 s56, s56, s30
 s_branch L_vloop_mid
.p2align 6
L_vloop:
 v_mfma_f32_16x16x32_bf16 v[64:67], a[64:67], a[0:3], v[64:67]
 ds_read_b64_tr_b16 a[24:25], v9 offset:0
 v_mfma_f32_16x16x32_bf16 v[64:67], a[68:71], a[4:7], v[64:67]
 ds_read_b64_tr_b16 a[26:27], v9 offset:4096
 v_mfma_f32_16x16x32_bf16 v[68:71], a[76:79], a[4:7], v[68:71]
 ds_read_b64_tr_b16 a[28:29], v9 offset:16384
 v_mfma_f32_16x16x32_bf16 v[68:71], a[72:75], a[0:3], v[68:71]
 ds_read_b64_tr_b16 a[30:31], v9 offset:20480
 v_mfma_f32_16x16x32_bf16 v[72:75], a[80:83], a[0:3], v[72:75]
 ds_read_b128 a[96:99], v4 offset:8192
 v_mfma_f32_16x16x32_bf16 v[72:75], a[84:87], a[4:7], v[72:75]
 s_cmp_eq_u32 s61, s55
 s_cbranch_scc1 L_vloop_side
L_vloop_back:
 v_mfma_f32_16x16x32_bf16 v[76:79], a[92:95], a[4:7], v[76:79]
 s_waitcnt lgkmcnt(8)
 ds_read_b128 a[100:103], v5 offset:8192
 v_mfma_f32_16x16x32_bf16 v[76:79], a[88:91], a[0:3], v[76:79]
 v_mfma_f32_16x16x32_bf16 v[84:87], a[88:91], a[8:11], v[84:87]
 ds_read_b128 a[108:111], v5 offset:10240
 v_mfma_f32_16x16x32_bf16 v[84:87], a[92:95], a[12:15], v[84:87]
 v_mfma_f32_16x16x32_bf16 v[80:83], a[84:87], a[12:15], v[80:83]
 ds_read_b128 a[104:107], v4 offset:10240
 v_mfma_f32_16x16x32_bf16 v[80:83], a[80:83], a[8:11], v[80:83]
 v_mfma_f32_16x16x32_bf16 v[92:95], a[72:75], a[8:11], v[92:95]
 ds_read_b128 a[112:115], v4 offset:12288
 v_mfma_f32_16x16x32_bf16 v[92:95], a[76:79], a[12:15], v[92:95]
 v_mfma_f32_16x16x32_bf16 v[88:91], a[68:71], a[12:15], v[88:91]
 ds_read_b128 a[116:119], v5 offset:12288
 v_mfma_f32_16x16x32_bf16 v[88:91], a[64:67], a[8:11], v[88:91]
 s_waitcnt lgkmcnt(8)
 v_mfma_f32_16x16x32_bf16 v[96:99], a[64:67], a[16:19], v[96:99]
 ds_read_b128 a[124:127], v5 offset:14336
 v_mfma_f32_16x16x32_bf16 v[96:99], a[68:71], a[20:23], v[96:99]
 v_mfma_f32_16x16x32_bf16 v[100:103], a[76:79], a[20:23], v[100:103]
 ds_read_b128 a[120:123], v4 offset:14336
 v_mfma_f32_16x16x32_bf16 v[100:103], a[72:75], a[16:19], v[100:103]
 v_mfma_f32_16x16x32_bf16 v[104:107], a[80:83], a[16:19], v[104:107]
 ds_read_b64_tr_b16 a[32:33], v10 offset:0
 v_mfma_f32_16x16x32_bf16 v[104:107], a[84:87], a[20:23], v[104:107]
 ds_read_b64_tr_b16 a[34:35], v10 offset:4096
 v_mfma_f32_16x16x32_bf16 v[108:111], a[92:95], a[20:23], v[108:111]
 ds_read_b64_tr_b16 a[36:37], v10 offset:16384
 v_mfma_f32_16x16x32_bf16 v[108:111], a[88:91], a[16:19], v[108:111]
 ds_read_b64_tr_b16 a[38:39], v10 offset:20480
 v_mfma_f32_16x16x32_bf16 v[116:119], a[88:91], a[24:27], v[116:119]
 s_waitcnt lgkmcnt(8)
 ds_read_b64_tr_b16 a[40:41], v11 offset:0
 v_mfma_f32_16x16x32_bf16 v[116:119], a[92:95], a[28:31], v[116:119]
 ds_read_b64_tr_b16 a[42:43], v11 offset:4096
 v_mfma_f32_16x16x32_bf16 v[112:115], a[84:87], a[28:31], v[112:115]
 ds_read_b64_tr_b16 a[44:45], v11 offset:16384
 v_mfma_f32_16x16x32_bf16 v[112:115], a[80:83], a[24:27], v[112:115]
 ds_read_b64_tr_b16 a[46:47], v11 offset:20480
 v_mfma_f32_16x16x32_bf16 v[124:127], a[72:75], a[24:27], v[124:127]
 ds_read_b64_tr_b16 a[48:49], v12 offset:0
 v_mfma_f32_16x16x32_bf16 v[124:127], a[76:79], a[28:31], v[124:127]
 ds_read_b64_tr_b16 a[50:51], v12 offset:4096
 v_mfma_f32_16x16x32_bf16 v[120:123], a[68:71], a[28:31], v[120:123]
 ds_read_b64_tr_b16 a[52:53], v12 offset:16384
 v_mfma_f32_16x16x32_bf16 v[120:123], a[64:67], a[24:27], v[120:123]
 ds_read_b64_tr_b16 a[54:55], v12 offset:20480
 v_mfma_f32_16x16x32_bf16 v[16:19], a[96:99], a[0:3], v[16:19]
 ds_read_b64_tr_b16 a[56:57], v13 offset:0
 v_mfma_f32_16x16x32_bf16 v[16:19], a[100:103], a[4:7], v[16:19]
 ds_read_b64_tr_b16 a[58:59], v13 offset:4096
 v_mfma_f32_16x16x32_bf16 v[20:23], a[108:111], a[4:7], v[20:23]
 ds_read_b64_tr_b16 a[60:61], v13 offset:16384
 v_mfma_f32_16x16x32_bf16 v[20:23], a[104:107], a[0:3], v[20:23]
 s_waitcnt lgkmcnt(8)
 ds_read_b64_tr_b16 a[62:63], v13 offset:20480
 v_mfma_f32_16x16x32_bf16 v[24:27], a[112:115], a[0:3], v[24:27]
 v_mfma_f32_16x16x32_bf16 v[24:27], a[116:119], a[4:7], v[24:27]
 v_mfma_f32_16x16x32_bf16 v[28:31], a[124:127], a[4:7], v[28:31]
 v_mfma_f32_16x16x32_bf16 v[28:31], a[120:123], a[0:3], v[28:31]
 s_waitcnt lgkmcnt(0)
 v_mfma_f32_16x16x32_bf16 a[228:231], a[120:123], a[8:11], a[228:231]
 s_barrier
 v_mfma_f32_16x16x32_bf16 a[228:231], a[124:127], a[12:15], a[228:231]
 s_add_u32 m0, s29, 65536
 v_mfma_f32_16x16x32_bf16 a[224:227], a[116:119], a[12:15], a[224:227]
 buffer_load_dwordx4 v2, s[8:11], 0 offen  lds
 v_mfma_f32_16x16x32_bf16 a[224:227], a[112:115], a[8:11], a[224:227]
 v_mfma_f32_16x16x32_bf16 a[236:239], a[104:107], a[8:11], a[236:239]
 v_mfma_f32_16x16x32_bf16 a[236:239], a[108:111], a[12:15], a[236:239]
 v_mfma_f32_16x16x32_bf16 a[232:235], a[100:103], a[12:15], a[232:235]
 s_add_u32 m0, s29, 0
 v_mfma_f32_16x16x32_bf16 a[232:235], a[96:99], a[8:11], a[232:235]
 buffer_load_dwordx4 v1, s[4:7], 0 offen  lds
 v_mfma_f32_16x16x32_bf16 v[32:35], a[96:99], a[16:19], v[32:35]
 v_mfma_f32_16x16x32_bf16 v[32:35], a[100:103], a[20:23], v[32:35]
 v_mfma_f32_16x16x32_bf16 v[36:39], a[108:111], a[20:23], v[36:39]
 v_mfma_f32_16x16x32_bf16 v[36:39], a[104:107], a[16:19], v[36:39]
 s_add_u32 m0, s29, 69632
 v_mfma_f32_16x16x32_bf16 v[40:43], a[112:115], a[16:19], v[40:43]
 buffer_load_dwordx4 v2, s[8:11], s48 offen  lds
 v_mfma_f32_16x16x32_bf16 v[40:43], a[116:119], a[20:23], v[40:43]
 v_mfma_f32_16x16x32_bf16 v[44:47], a[124:127], a[20:23], v[44:47]
 v_mfma_f32_16x16x32_bf16 v[44:47], a[120:123], a[16:19], v[44:47]
 v_mfma_f32_16x16x32_bf16 v[52:55], a[120:123], a[24:27], v[52:55]
 s_add_u32 m0, s29, 4096
 v_mfma_f32_16x16x32_bf16 v[52:55], a[124:127], a[28:31], v[52:55]
 buffer_load_dwordx4 v1, s[4:7], s41 offen  lds
 v_mfma_f32_16x16x32_bf16 v[48:51], a[116:119], a[28:31], v[48:51]
 v_mfma_f32_16x16x32_bf16 v[48:51], a[112:115], a[24:27], v[48:51]
 v_mfma_f32_16x16x32_bf16 v[60:63], a[104:107], a[24:27], v[60:63]
 v_mfma_f32_16x16x32_bf16 v[60:63], a[108:111], a[28:31], v[60:63]
 s_add_u32 m0, s29, 73728
 v_mfma_f32_16x16x32_bf16 v[56:59], a[100:103], a[28:31], v[56:59]
 buffer_load_dwordx4 v2, s[8:11], s49 offen  lds
 v_mfma_f32_16x16x32_bf16 v[56:59], a[96:99], a[24:27], v[56:59]
 v_mfma_f32_16x16x32_bf16 v[192:195], a[96:99], a[32:35], v[192:195]
 v_mfma_f32_16x16x32_bf16 v[192:195], a[100:103], a[36:39], v[192:195]
 v_mfma_f32_16x16x32_bf16 v[196:199], a[108:111], a[36:39], v[196:199]
 s_add_u32 m0, s29, 8192
 v_mfma_f32_16x16x32_bf16 v[196:199], a[104:107], a[32:35], v[196:199]
 buffer_load_dwordx4 v1, s[4:7], s42 offen  lds
 v_mfma_f32_16x16x32_bf16 v[200:203], a[112:115], a[32:35], v[200:203]
 v_mfma_f32_16x16x32_bf16 v[200:203], a[116:119], a[36:39], v[200:203]
 v_mfma_f32_16x16x32_bf16 v[204:207], a[124:127], a[36:39], v[204:207]
 v_mfma_f32_16x16x32_bf16 v[204:207], a[120:123], a[32:35], v[204:207]
 s_add_u32 m0, s29, 77824
 v_mfma_f32_16x16x32_bf16 v[212:215], a[120:123], a[40:43], v[212:215]
 buffer_load_dwordx4 v2, s[8:11], s50 offen  lds
 v_mfma_f32_16x16x32_bf16 v[212:215], a[124:127], a[44:47], v[212:215]
 v_mfma_f32_16x16x32_bf16 v[208:211], a[116:119], a[44:47], v[208:211]
 v_mfma_f32_16x16x32_bf16 v[208:211], a[112:115], a[40:43], v[208:211]
 v_mfma_f32_16x16x32_bf16 v[220:223], a[104:107], a[40:43], v[220:223]
 s_add_u32 m0, s29, 12288
 v_mfma_f32_16x16x32_bf16 v[220:223], a[108:111], a[44:47], v[220:223]
 buffer_load_dwordx4 v1, s[4:7], s43 offen  lds
 v_mfma_f32_16x16x32_bf16 v[216:219], a[100:103], a[44:47], v[216:219]
 v_mfma_f32_16x16x32_bf16 v[216:219], a[96:99], a[40:43], v[216:219]
 v_mfma_f32_16x16x32_bf16 v[224:227], a[96:99], a[48:51], v[224:227]
 v_mfma_f32_16x16x32_bf16 v[224:227], a[100:103], a[52:55], v[224:227]
 s_add_u32 m0, s29, 81920
 v_mfma_f32_16x16x32_bf16 v[228:231], a[108:111], a[52:55], v[228:231]
 buffer_load_dwordx4 v2, s[8:11], s51 offen  lds
 v_mfma_f32_16x16x32_bf16 v[228:231], a[104:107], a[48:51], v[228:231]
 v_mfma_f32_16x16x32_bf16 v[232:235], a[112:115], a[48:51], v[232:235]
 v_mfma_f32_16x16x32_bf16 v[232:235], a[116:119], a[52:55], v[232:235]
 v_mfma_f32_16x16x32_bf16 v[236:239], a[124:127], a[52:55], v[236:239]
 s_add_u32 m0, s29, 16384
 v_mfma_f32_16x16x32_bf16 v[236:239], a[120:123], a[48:51], v[236:239]
 buffer_load_dwordx4 v1, s[4:7], s44 offen  lds
 v_mfma_f32_16x16x32_bf16 v[244:247], a[120:123], a[56:59], v[244:247]
 v_mfma_f32_16x16x32_bf16 v[244:247], a[124:127], a[60:63], v[244:247]
 v_mfma_f32_16x16x32_bf16 v[240:243], a[116:119], a[60:63], v[240:243]
 v_mfma_f32_16x16x32_bf16 v[240:243], a[112:115], a[56:59], v[240:243]
 s_add_u32 m0, s29, 86016
 v_mfma_f32_16x16x32_bf16 v[252:255], a[104:107], a[56:59], v[252:255]
 s_waitcnt vmcnt(11)
 buffer_load_dwordx4 v2, s[8:11], s52 offen  lds
 v_mfma_f32_16x16x32_bf16 v[252:255], a[108:111], a[60:63], v[252:255]
 s_barrier
 ds_read_b64_tr_b16 a[0:1], v6 offset:32768
 v_mfma_f32_16x16x32_bf16 v[248:251], a[100:103], a[60:63], v[248:251]
 ds_read_b64_tr_b16 a[2:3], v6 offset:36864
 v_mfma_f32_16x16x32_bf16 v[248:251], a[96:99], a[56:59], v[248:251]
 ds_read_b128 a[96:99], v4 offset:40960
 v_mfma_f32_16x16x32_bf16 v[128:131], a[64:67], a[32:35], v[128:131]
 s_add_u32 m0, s29, 20480
 v_mfma_f32_16x16x32_bf16 v[128:131], a[68:71], a[36:39], v[128:131]
 buffer_load_dwordx4 v1, s[4:7], s45 offen  lds
 v_mfma_f32_16x16x32_bf16 v[132:135], a[76:79], a[36:39], v[132:135]
 ds_read_b64_tr_b16 a[4:5], v6 offset:49152
 v_mfma_f32_16x16x32_bf16 v[132:135], a[72:75], a[32:35], v[132:135]
 ds_read_b64_tr_b16 a[6:7], v6 offset:53248
 v_mfma_f32_16x16x32_bf16 v[136:139], a[80:83], a[32:35], v[136:139]
 ds_read_b128 a[100:103], v5 offset:40960
 v_mfma_f32_16x16x32_bf16 v[136:139], a[84:87], a[36:39], v[136:139]
 s_add_u32 m0, s29, 90112
 v_mfma_f32_16x16x32_bf16 v[140:143], a[92:95], a[36:39], v[140:143]
 buffer_load_dwordx4 v2, s[8:11], s53 offen  lds
 v_mfma_f32_16x16x32_bf16 v[140:143], a[88:91], a[32:35], v[140:143]
 ds_read_b128 a[108:111], v5 offset:43008
 v_mfma_f32_16x16x32_bf16 v[148:151], a[88:91], a[40:43], v[148:151]
 v_mfma_f32_16x16x32_bf16 v[148:151], a[92:95], a[44:47], v[148:151]
 ds_read_b128 a[104:107], v4 offset:43008
 v_mfma_f32_16x16x32_bf16 v[144:147], a[84:87], a[44:47], v[144:147]
 s_add_u32 m0, s29, 24576
 v_mfma_f32_16x16x32_bf16 v[144:147], a[80:83], a[40:43], v[144:147]
 buffer_load_dwordx4 v1, s[4:7], s46 offen  lds
 v_mfma_f32_16x16x32_bf16 v[156:159], a[72:75], a[40:43], v[156:159]
 ds_read_b128 a[112:115], v4 offset:45056
 v_mfma_f32_16x16x32_bf16 v[156:159], a[76:79], a[44:47], v[156:159]
 v_mfma_f32_16x16x32_bf16 v[152:155], a[68:71], a[44:47], v[152:155]
 ds_read_b128 a[116:119], v5 offset:45056
 v_mfma_f32_16x16x32_bf16 v[152:155], a[64:67], a[40:43], v[152:155]
 s_add_u32 m0, s29, 94208
 v_mfma_f32_16x16x32_bf16 v[160:163], a[64:67], a[48:51], v[160:163]
 buffer_load_dwordx4 v2, s[8:11], s54 offen  lds
 v_mfma_f32_16x16x32_bf16 v[160:163], a[68:71], a[52:55], v[160:163]
 ds_read_b128 a[124:127], v5 offset:47104
 v_mfma_f32_16x16x32_bf16 v[164:167], a[76:79], a[52:55], v[164:167]
 v_mfma_f32_16x16x32_bf16 v[164:167], a[72:75], a[48:51], v[164:167]
 ds_read_b128 a[120:123], v4 offset:47104
 v_mfma_f32_16x16x32_bf16 v[168:171], a[80:83], a[48:51], v[168:171]
 s_add_u32 m0, s29, 28672
 v_mfma_f32_16x16x32_bf16 v[168:171], a[84:87], a[52:55], v[168:171]
 buffer_load_dwordx4 v1, s[4:7], s47 offen  lds
 v_mfma_f32_16x16x32_bf16 v[172:175], a[92:95], a[52:55], v[172:175]
 v_add_u32 v1, 128, v1
 v_add_u32 v2, 0x80000, v2
 v_mfma_f32_16x16x32_bf16 v[172:175], a[88:91], a[48:51], v[172:175]
 ds_read_b64_tr_b16 a[8:9], v7 offset:32768
 v_mfma_f32_16x16x32_bf16 v[180:183], a[88:91], a[56:59], v[180:183]
 buffer_load_dword a243, v14, s[36:39], s56 offen
 v_mfma_f32_16x16x32_bf16 v[180:183], a[92:95], a[60:63], v[180:183]
 s_add_u32 s56, s56, s30
 ds_read_b64_tr_b16 a[10:11], v7 offset:36864
 v_mfma_f32_16x16x32_bf16 v[176:179], a[84:87], a[60:63], v[176:179]
 ds_read_b64_tr_b16 a[12:13], v7 offset:49152
 v_mfma_f32_16x16x32_bf16 v[176:179], a[80:83], a[56:59], v[176:179]
 ds_read_b64_tr_b16 a[14:15], v7 offset:53248
 v_mfma_f32_16x16x32_bf16 v[188:191], a[72:75], a[56:59], v[188:191]
 ds_read_b64_tr_b16 a[16:17], v8 offset:32768
 v_mfma_f32_16x16x32_bf16 v[188:191], a[76:79], a[60:63], v[188:191]
 ds_read_b64_tr_b16 a[18:19], v8 offset:36864
 v_mfma_f32_16x16x32_bf16 v[184:187], a[68:71], a[60:63], v[184:187]
 ds_read_b64_tr_b16 a[20:21], v8 offset:49152
 v_mfma_f32_16x16x32_bf16 v[184:187], a[64:67], a[56:59], v[184:187]
 s_waitcnt lgkmcnt(8)
 ds_read_b64_tr_b16 a[22:23], v8 offset:53248
L_vloop_mid:
 v_mfma_f32_16x16x32_bf16 v[16:19], a[96:99], a[0:3], v[16:19]
 ds_read_b64_tr_b16 a[24:25], v9 offset:32768
 v_mfma_f32_16x16x32_bf16 v[16:19], a[100:103], a[4:7], v[16:19]
 ds_read_b64_tr_b16 a[26:27], v9 offset:36864
 v_mfma_f32_16x16x32_bf16 v[20:23], a[108:111], a[4:7], v[20:23]
 ds_read_b64_tr_b16 a[28:29], v9 offset:49152
 v_mfma_f32_16x16x32_bf16 v[20:23], a[104:107], a[0:3], v[20:23]
 ds_read_b64_tr_b16 a[30:31], v9 offset:53248
 v_mfma_f32_16x16x32_bf16 v[24:27], a[112:115], a[0:3], v[24:27]
 ds_read_b128 a[64:67], v4 offset:32768
 v_mfma_f32_16x16x32_bf16 v[24:27], a[116:119], a[4:7], v[24:27]
 v_mfma_f32_16x16x32_bf16 v[28:31], a[124:127], a[4:7], v[28:31]
 s_waitcnt lgkmcnt(8)
 ds_read_b128 a[68:71], v5 offset:32768
 v_mfma_f32_16x16x32_bf16 v[28:31], a[120:123], a[0:3], v[28:31]
 v_mfma_f32_16x16x32_bf16 a[228:231], a[120:123], a[8:11], a[228:231]
 ds_read_b128 a[76:79], v5 offset:34816
 v_mfma_f32_16x16x32_bf16 a[228:231], a[124:127], a[12:15], a[228:231]
 v_mfma_f32_16x16x32_bf16 a[224:227], a[116:119], a[12:15], a[224:227]
 ds_read_b128 a[72:75], v4 offset:34816
 v_mfma_f32_16x16x32_bf16 a[224:227], a[112:115], a[8:11], a[224:227]
 v_mfma_f32_16x16x32_bf16 a[236:239], a[104:107], a[8:11], a[236:239]
 ds_read_b128 a[80:83], v4 offset:36864
 v_mfma_f32_16x16x32_bf16 a[236:239], a[108:111], a[12:15], a[236:239]
 v_mfma_f32_16x16x32_bf16 a[232:235], a[100:103], a[12:15], a[232:235]
 ds_read_b128 a[84:87], v5 offset:36864
 v_mfma_f32_16x16x32_bf16 a[232:235], a[96:99], a[8:11], a[232:235]
 s_waitcnt lgkmcnt(8)
 v_mfma_f32_16x16x32_bf16 v[32:35], a[96:99], a[16:19], v[32:35]
 ds_read_b128 a[92:95], v5 offset:38912
 v_mfma_f32_16x16x32_bf16 v[32:35], a[100:103], a[20:23], v[32:35]
 v_mfma_f32_16x16x32_bf16 v[36:39], a[108:111], a[20:23], v[36:39]
 ds_read_b128 a[88:91], v4 offset:38912
 v_mfma_f32_16x16x32_bf16 v[36:39], a[104:107], a[16:19], v[36:39]
 v_mfma_f32_16x16x32_bf16 v[40:43], a[112:115], a[16:19], v[40:43]
 ds_read_b64_tr_b16 a[32:33], v10 offset:32768
 v_mfma_f32_16x16x32_bf16 v[40:43], a[116:119], a[20:23], v[40:43]
 ds_read_b64_tr_b16 a[34:35], v10 offset:36864
 v_mfma_f32_16x16x32_bf16 v[44:47], a[124:127], a[20:23], v[44:47]
 ds_read_b64_tr_b16 a[36:37], v10 offset:49152
 v_mfma_f32_16x16x32_bf16 v[44:47], a[120:123], a[16:19], v[44:47]
 ds_read_b64_tr_b16 a[38:39], v10 offset:53248
 v_mfma_f32_16x16x32_bf16 v[52:55], a[120:123], a[24:27], v[52:55]
 s_waitcnt lgkmcnt(8)
 ds_read_b64_tr_b16 a[40:41], v11 offset:32768
 v_mfma_f32_16x16x32_bf16 v[52:55], a[124:127], a[28:31], v[52:55]
 ds_read_b64_tr_b16 a[42:43], v11 offset:36864
 v_mfma_f32_16x16x32_bf16 v[48:51], a[116:119], a[28:31], v[48:51]
 ds_read_b64_tr_b16 a[44:45], v11 offset:49152
 v_mfma_f32_16x16x32_bf16 v[48:51], a[112:115], a[24:27], v[48:51]
 ds_read_b64_tr_b16 a[46:47], v11 offset:53248
 v_mfma_f32_16x16x32_bf16 v[60:63], a[104:107], a[24:27], v[60:63]
 ds_read_b64_tr_b16 a[48:49], v12 offset:32768
 v_mfma_f32_16x16x32_bf16 v[60:63], a[108:111], a[28:31], v[60:63]
 ds_read_b64_tr_b16 a[50:51], v12 offset:36864
 v_mfma_f32_16x16x32_bf16 v[56:59], a[100:103], a[28:31], v[56:59]
 ds_read_b64_tr_b16 a[52:53], v12 offset:49152
 v_mfma_f32_16x16x32_bf16 v[56:59], a[96:99], a[24:27], v[56:59]
 ds_read_b64_tr_b16 a[54:55], v12 offset:53248
 v_mfma_f32_16x16x32_bf16 v[64:67], a[64:67], a[0:3], v[64:67]
 ds_read_b64_tr_b16 a[56:57], v13 offset:32768
 v_mfma_f32_16x16x32_bf16 v[64:67], a[68:71], a[4:7], v[64:67]
 ds_read_b64_tr_b16 a[58:59], v13 offset:36864
 v_mfma_f32_16x16x32_bf16 v[68:71], a[76:79], a[4:7], v[68:71]
 ds_read_b64_tr_b16 a[60:61], v13 offset:49152
 v_mfma_f32_16x16x32_bf16 v[68:71], a[72:75], a[0:3], v[68:71]
 s_waitcnt lgkmcnt(8)
 ds_read_b64_tr_b16 a[62:63], v13 offset:53248
 v_mfma_f32_16x16x32_bf16 v[72:75], a[80:83], a[0:3], v[72:75]
 v_mfma_f32_16x16x32_bf16 v[72:75], a[84:87], a[4:7], v[72:75]
 v_mfma_f32_16x16x32_bf16 v[76:79], a[92:95], a[4:7], v[76:79]
 v_mfma_f32_16x16x32_bf16 v[76:79], a[88:91], a[0:3], v[76:79]
 s_waitcnt lgkmcnt(0)
 v_mfma_f32_16x16x32_bf16 v[84:87], a[88:91], a[8:11], v[84:87]
 s_barrier
 v_mfma_f32_16x16x32_bf16 v[84:87], a[92:95], a[12:15], v[84:87]
 s_add_u32 m0, s29, 98304
 v_mfma_f32_16x16x32_bf16 v[80:83], a[84:87], a[12:15], v[80:83]
 buffer_load_dwordx4 v2, s[8:11], 0 offen  lds
 v_mfma_f32_16x16x32_bf16 v[80:83], a[80:83], a[8:11], v[80:83]
 v_mfma_f32_16x16x32_bf16 v[92:95], a[72:75], a[8:11], v[92:95]
 v_mfma_f32_16x16x32_bf16 v[92:95], a[76:79], a[12:15], v[92:95]
 v_mfma_f32_16x16x32_bf16 v[88:91], a[68:71], a[12:15], v[88:91]
 s_add_u32 m0, s29, 32768
 v_mfma_f32_16x16x32_bf16 v[88:91], a[64:67], a[8:11], v[88:91]
 buffer_load_dwordx4 v1, s[4:7], 0 offen  lds
 v_mfma_f32_16x16x32_bf16 v[96:99], a[64:67], a[16:19], v[96:99]
 v_mfma_f32_16x16x32_bf16 v[96:99], a[68:71], a[20:23], v[96:99]
 v_mfma_f32_16x16x32_bf16 v[100:103], a[76:79], a[20:23], v[100:103]
 v_mfma_f32_16x16x32_bf16 v[100:103], a[72:75], a[16:19], v[100:103]
 s_add_u32 m0, s29, 102400
 v_mfma_f32_16x16x32_bf16 v[104:107], a[80:83], a[16:19], v[104:107]
 buffer_load_dwordx4 v2, s[8:11], s48 offen  lds
 v_mfma_f32_16x16x32_bf16 v[104:107], a[84:87], a[20:23], v[104:107]
 v_mfma_f32_16x16x32_bf16 v[108:111], a[92:95], a[20:23], v[108:111]
 v_mfma_f32_16x16x32_bf16 v[108:111], a[88:91], a[16:19], v[108:111]
 v_mfma_f32_16x16x32_bf16 v[116:119], a[88:91], a[24:27], v[116:119]
 s_add_u32 m0, s29, 36864
 v_mfma_f32_16x16x32_bf16 v[116:119], a[92:95], a[28:31], v[116:119]
 buffer_load_dwordx4 v1, s[4:7], s41 offen  lds
 v_mfma_f32_16x16x32_bf16 v[112:115], a[84:87], a[28:31], v[112:115]
 v_mfma_f32_16x16x32_bf16 v[112:115], a[80:83], a[24:27], v[112:115]
 v_mfma_f32_16x16x32_bf16 v[124:127], a[72:75], a[24:27], v[124:127]
 v_mfma_f32_16x16x32_bf16 v[124:127], a[76:79], a[28:31], v[124:127]
 s_add_u32 m0, s29, 106496
 v_mfma_f32_16x16x32_bf16 v[120:123], a[68:71], a[28:31], v[120:123]
 buffer_load_dwordx4 v2, s[8:11], s49 offen  lds
 v_mfma_f32_16x16x32_bf16 v[120:123], a[64:67], a[24:27], v[120:123]
 v_mfma_f32_16x16x32_bf16 v[128:131], a[64:67], a[32:35], v[128:131]
 v_mfma_f32_16x16x32_bf16 v[128:131], a[68:71], a[36:39], v[128:131]
 v_mfma_f32_16x16x32_bf16 v[132:135], a[76:79], a[36:39], v[132:135]
 s_add_u32 m0, s29, 40960
 v_mfma_f32_16x16x32_bf16 v[132:135], a[72:75], a[32:35], v[132:135]
 buffer_load_dwordx4 v1, s[4:7], s42 offen  lds
 v_mfma_f32_16x16x32_bf16 v[136:139], a[80:83], a[32:35], v[136:139]
 v_mfma_f32_16x16x32_bf16 v[136:139], a[84:87], a[36:39], v[136:139]
 v_mfma_f32_16x16x32_bf16 v[140:143], a[92:95], a[36:39], v[140:143]
 v_mfma_f32_16x16x32_bf16 v[140:143], a[88:91], a[32:35], v[140:143]
 s_add_u32 m0, s29, 110592
 v_mfma_f32_16x16x32_bf16 v[148:151], a[88:91], a[40:43], v[148:151]
 buffer_load_dwordx4 v2, s[8:11], s50 offen  lds
 v_mfma_f32_16x16x32_bf16 v[148:151], a[92:95], a[44:47], v[148:151]
 v_mfma_f32_16x16x32_bf16 v[144:147], a[84:87], a[44:47], v[144:147]
 v_mfma_f32_16x16x32_bf16 v[144:147], a[80:83], a[40:43], v[144:147]
 v_mfma_f32_16x16x32_bf16 v[156:159], a[72:75], a[40:43], v[156:159]
 s_add_u32 m0, s29, 45056
 v_mfma_f32_16x16x32_bf16 v[156:159], a[76:79], a[44:47], v[156:159]
 buffer_load_dwordx4 v1, s[4:7], s43 offen  lds
 v_mfma_f32_16x16x32_bf16 v[152:155], a[68:71], a[44:47], v[152:155]
 v_mfma_f32_16x16x32_bf16 v[152:155], a[64:67], a[40:43], v[152:155]
 v_mfma_f32_16x16x32_bf16 v[160:163], a[64:67], a[48:51], v[160:163]
 v_mfma_f32_16x16x32_bf16 v[160:163], a[68:71], a[52:55], v[160:163]
 s_add_u32 m0, s29, 114688
 v_mfma_f32_16x16x32_bf16 v[164:167], a[76:79], a[52:55], v[164:167]
 buffer_load_dwordx4 v2, s[8:11], s51 offen  lds
 v_mfma_f32_16x16x32_bf16 v[164:167], a[72:75], a[48:51], v[164:167]
 v_mfma_f32_16x16x32_bf16 v[168:171], a[80:83], a[48:51], v[168:171]
 v_mfma_f32_16x16x32_bf16 v[168:171], a[84:87], a[52:55], v[168:171]
 v_mfma_f32_16x16x32_bf16 v[172:175], a[92:95], a[52:55], v[172:175]
 s_add_u32 m0, s29, 49152
 v_mfma_f32_16x16x32_bf16 v[172:175], a[88:91], a[48:51], v[172:175]
 buffer_load_dwordx4 v1, s[4:7], s44 offen  lds
 v_mfma_f32_16x16x32_bf16 v[180:183], a[88:91], a[56:59], v[180:183]
 v_mfma_f32_16x16x32_bf16 v[180:183], a[92:95], a[60:63], v[180:183]
 v_mfma_f32_16x16x32_bf16 v[176:179], a[84:87], a[60:63], v[176:179]
 v_mfma_f32_16x16x32_bf16 v[176:179], a[80:83], a[56:59], v[176:179]
 s_add_u32 m0, s29, 118784
 v_mfma_f32_16x16x32_bf16 v[188:191], a[72:75], a[56:59], v[188:191]
 s_waitcnt vmcnt(11)
 buffer_load_dwordx4 v2, s[8:11], s52 offen  lds
 v_mfma_f32_16x16x32_bf16 v[188:191], a[76:79], a[60:63], v[188:191]
 s_barrier
 ds_read_b64_tr_b16 a[0:1], v6 offset:0
 v_mfma_f32_16x16x32_bf16 v[184:187], a[68:71], a[60:63], v[184:187]
 ds_read_b64_tr_b16 a[2:3], v6 offset:4096
 v_mfma_f32_16x16x32_bf16 v[184:187], a[64:67], a[56:59], v[184:187]
 ds_read_b128 a[64:67], v4 offset:0
 v_mfma_f32_16x16x32_bf16 v[192:195], a[96:99], a[32:35], v[192:195]
 s_add_u32 m0, s29, 53248
 v_mfma_f32_16x16x32_bf16 v[192:195], a[100:103], a[36:39], v[192:195]
 buffer_load_dwordx4 v1, s[4:7], s45 offen  lds
 v_mfma_f32_16x16x32_bf16 v[196:199], a[108:111], a[36:39], v[196:199]
 ds_read_b64_tr_b16 a[4:5], v6 offset:16384
 v_mfma_f32_16x16x32_bf16 v[196:199], a[104:107], a[32:35], v[196:199]
 ds_read_b64_tr_b16 a[6:7], v6 offset:20480
 v_mfma_f32_16x16x32_bf16 v[200:203], a[112:115], a[32:35], v[200:203]
 ds_read_b128 a[68:71], v5 offset:0
 v_mfma_f32_16x16x32_bf16 v[200:203], a[116:119], a[36:39], v[200:203]
 s_add_u32 m0, s29, 122880
 v_mfma_f32_16x16x32_bf16 v[204:207], a[124:127], a[36:39], v[204:207]
 buffer_load_dwordx4 v2, s[8:11], s53 offen  lds
 v_mfma_f32_16x16x32_bf16 v[204:207], a[120:123], a[32:35], v[204:207]
 ds_read_b128 a[76:79], v5 offset:2048
 v_mfma_f32_16x16x32_bf16 v[212:215], a[120:123], a[40:43], v[212:215]
 v_mfma_f32_16x16x32_bf16 v[212:215], a[124:127], a[44:47], v[212:215]
 ds_read_b128 a[72:75], v4 offset:2048
 v_mfma_f32_16x16x32_bf16 v[208:211], a[116:119], a[44:47], v[208:211]
 s_add_u32 m0, s29, 57344
 v_mfma_f32_16x16x32_bf16 v[208:211], a[112:115], a[40:43], v[208:211]
 buffer_load_dwordx4 v1, s[4:7], s46 offen  lds
 v_mfma_f32_16x16x32_bf16 v[220:223], a[104:107], a[40:43], v[220:223]
 ds_read_b128 a[80:83], v4 offset:4096
 v_mfma_f32_16x16x32_bf16 v[220:223], a[108:111], a[44:47], v[220:223]
 v_mfma_f32_16x16x32_bf16 v[216:219], a[100:103], a[44:47], v[216:219]
 ds_read_b128 a[84:87], v5 offset:4096
 v_mfma_f32_16x16x32_bf16 v[216:219], a[96:99], a[40:43], v[216:219]
 s_add_u32 m0, s29, 126976
 v_mfma_f32_16x16x32_bf16 v[224:227], a[96:99], a[48:51], v[224:227]
 buffer_load_dwordx4 v2, s[8:11], s54 offen  lds
 v_mfma_f32_16x16x32_bf16 v[224:227], a[100:103], a[52:55], v[224:227]
 ds_read_b128 a[92:95], v5 offset:6144
 v_mfma_f32_16x16x32_bf16 v[228:231], a[108:111], a[52:55], v[228:231]
 v_mfma_f32_16x16x32_bf16 v[228:231], a[104:107], a[48:51], v[228:231]
 ds_read_b128 a[88:91], v4 offset:6144
 v_mfma_f32_16x16x32_bf16 v[232:235], a[112:115], a[48:51], v[232:235]
 s_add_u32 m0, s29, 61440
 v_mfma_f32_16x16x32_bf16 v[232:235], a[116:119], a[52:55], v[232:235]
 buffer_load_dwordx4 v1, s[4:7], s47 offen  lds
 v_mfma_f32_16x16x32_bf16 v[236:239], a[124:127], a[52:55], v[236:239]
 v_add_u32 v1, 128, v1
 v_add_u32 v2, 0x80000, v2
 v_mfma_f32_16x16x32_bf16 v[236:239], a[120:123], a[48:51], v[236:239]
 ds_read_b64_tr_b16 a[8:9], v7 offset:0
 v_mfma_f32_16x16x32_bf16 v[244:247], a[120:123], a[56:59], v[244:247]
 buffer_load_dword a243, v14, s[36:39], s56 offen
 v_mfma_f32_16x16x32_bf16 v[244:247], a[124:127], a[60:63], v[244:247]
 s_add_u32 s56, s56, s30
 ds_read_b64_tr_b16 a[10:11], v7 offset:4096
 v_mfma_f32_16x16x32_bf16 v[240:243], a[116:119], a[60:63], v[240:243]
 ds_read_b64_tr_b16 a[12:13], v7 offset:16384
 v_mfma_f32_16x16x32_bf16 v[240:243], a[112:115], a[56:59], v[240:243]
 ds_read_b64_tr_b16 a[14:15], v7 offset:20480
 v_mfma_f32_16x16x32_bf16 v[252:255], a[104:107], a[56:59], v[252:255]
 ds_read_b64_tr_b16 a[16:17], v8 offset:0
 v_mfma_f32_16x16x32_bf16 v[252:255], a[108:111], a[60:63], v[252:255]
 ds_read_b64_tr_b16 a[18:19], v8 offset:4096
 v_mfma_f32_16x16x32_bf16 v[248:251], a[100:103], a[60:63], v[248:251]
 s_add_u32 s61, s61, 1
 ds_read_b64_tr_b16 a[20:21], v8 offset:16384
 v_mfma_f32_16x16x32_bf16 v[248:251], a[96:99], a[56:59], v[248:251]
 s_waitcnt lgkmcnt(8)
 ds_read_b64_tr_b16 a[22:23], v8 offset:20480
 s_cmp_lt_u32 s61, 6
 s_cbranch_scc1 L_vloop
 v_mfma_f32_16x16x32_bf16 v[64:67], a[64:67], a[0:3], v[64:67]
 ds_read_b64_tr_b16 a[24:25], v9 offset:0
 v_accvgpr_read_b32 v15, a240
 v_mfma_f32_16x16x32_bf16 v[64:67], a[68:71], a[4:7], v[64:67]
 ds_read_b64_tr_b16 a[26:27], v9 offset:4096
 v_accvgpr_read_b32 v14, a244
 v_mfma_f32_16x16x32_bf16 v[68:71], a[76:79], a[4:7], v[68:71]
 s_waitcnt lgkmcnt(12)
 ds_read_b64_tr_b16 a[28:29], v9 offset:16384
 global_load_dword a243, v14, s[100:101]
 v_mfma_f32_16x16x32_bf16 v[68:71], a[72:75], a[0:3], v[68:71]
 ds_read_b64_tr_b16 a[30:31], v9 offset:20480
 v_accvgpr_read_b32 v14, a242
 v_mfma_f32_16x16x32_bf16 v[72:75], a[80:83], a[0:3], v[72:75]
 s_add_u32 m0, s33, 0x0
 ds_read_b128 a[96:99], v4 offset:8192
 v_xor_b32 v3, 64, v14
 v_mfma_f32_16x16x32_bf16 v[72:75], a[84:87], a[4:7], v[72:75]
 s_waitcnt lgkmcnt(11)
 v_mfma_f32_16x16x32_bf16 v[76:79], a[92:95], a[4:7], v[76:79]
 ds_read_b128 a[100:103], v5 offset:8192
 buffer_load_dwordx4 v15, s[20:23], 0 offen offset:0 lds
 v_mfma_f32_16x16x32_bf16 v[76:79], a[88:91], a[0:3], v[76:79]
 v_mfma_f32_16x16x32_bf16 v[84:87], a[88:91], a[8:11], v[84:87]
 s_waitcnt lgkmcnt(10)
 ds_read_b128 a[108:111], v5 offset:10240
 v_mfma_f32_16x16x32_bf16 v[84:87], a[92:95], a[12:15], v[84:87]
 s_add_u32 m0, s33, 0x80
 v_mfma_f32_16x16x32_bf16 v[80:83], a[84:87], a[12:15], v[80:83]
 ds_read_b128 a[104:107], v4 offset:10240
 buffer_load_dwordx4 v15, s[20:23], 0 offen offset:896 lds
 v_mfma_f32_16x16x32_bf16 v[80:83], a[80:83], a[8:11], v[80:83]
 v_mfma_f32_16x16x32_bf16 v[92:95], a[72:75], a[8:11], v[92:95]
 ds_read_b128 a[112:115], v4 offset:12288
 v_mfma_f32_16x16x32_bf16 v[92:95], a[76:79], a[12:15], v[92:95]
 s_add_u32 m0, s33, 0x800
 v_mfma_f32_16x16x32_bf16 v[88:91], a[68:71], a[12:15], v[88:91]
 ds_read_b128 a[116:119], v5 offset:12288
 buffer_load_dwordx4 v15, s[20:23], s57 offen offset:0 lds
 v_mfma_f32_16x16x32_bf16 v[88:91], a[64:67], a[8:11], v[88:91]
 s_waitcnt lgkmcnt(10)
 v_mfma_f32_16x16x32_bf16 v[96:99], a[64:67], a[16:19], v[96:99]
 ds_read_b128 a[124:127], v5 offset:14336
 v_mfma_f32_16x16x32_bf16 v[96:99], a[68:71], a[20:23], v[96:99]
 s_add_u32 m0, s33, 0x880
 v_mfma_f32_16x16x32_bf16 v[100:103], a[76:79], a[20:23], v[100:103]
 ds_read_b128 a[120:123], v4 offset:14336
 buffer_load_dwordx4 v15, s[20:23], s57 offen offset:896 lds
 v_mfma_f32_16x16x32_bf16 v[100:103], a[72:75], a[16:19], v[100:103]
 v_mfma_f32_16x16x32_bf16 v[104:107], a[80:83], a[16:19], v[104:107]
 ds_read_b64_tr_b16 a[32:33], v10 offset:0
 v_mfma_f32_16x16x32_bf16 v[104:107], a[84:87], a[20:23], v[104:107]
 s_add_u32 m0, s33, 0xf80
 ds_read_b64_tr_b16 a[34:35], v10 offset:4096
 v_mfma_f32_16x16x32_bf16 v[108:111], a[92:95], a[20:23], v[108:111]
 ds_read_b64_tr_b16 a[36:37], v10 offset:16384
 buffer_load_dwordx4 v15, s[20:23], 0 offen offset:128 lds
 v_mfma_f32_16x16x32_bf16 v[108:111], a[88:91], a[16:19], v[108:111]
 s_waitcnt lgkmcnt(11)
 ds_read_b64_tr_b16 a[38:39], v10 offset:20480
 v_mfma_f32_16x16x32_bf16 v[116:119], a[88:91], a[24:27], v[116:119]
 ds_read_b64_tr_b16 a[40:41], v11 offset:0
 v_mfma_f32_16x16x32_bf16 v[116:119], a[92:95], a[28:31], v[116:119]
 s_add_u32 m0, s33, 0x1000
 ds_read_b64_tr_b16 a[42:43], v11 offset:4096
 v_mfma_f32_16x16x32_bf16 v[112:115], a[84:87], a[28:31], v[112:115]
 ds_read_b64_tr_b16 a[44:45], v11 offset:16384
 buffer_load_dwordx4 v15, s[20:23], 0 offen offset:1024 lds
 v_mfma_f32_16x16x32_bf16 v[112:115], a[80:83], a[24:27], v[112:115]
 ds_read_b64_tr_b16 a[46:47], v11 offset:20480
 v_mfma_f32_16x16x32_bf16 v[124:127], a[72:75], a[24:27], v[124:127]
 ds_read_b64_tr_b16 a[48:49], v12 offset:0
 v_mfma_f32_16x16x32_bf16 v[124:127], a[76:79], a[28:31], v[124:127]
 s_add_u32 m0, s33, 0x1780
 ds_read_b64_tr_b16 a[50:51], v12 offset:4096
 v_mfma_f32_16x16x32_bf16 v[120:123], a[68:71], a[28:31], v[120:123]
 ds_read_b64_tr_b16 a[52:53], v12 offset:16384
 buffer_load_dwordx4 v15, s[20:23], s57 offen offset:128 lds
 v_mfma_f32_16x16x32_bf16 v[120:123], a[64:67], a[24:27], v[120:123]
 s_waitcnt lgkmcnt(15)
 ds_read_b64_tr_b16 a[54:55], v12 offset:20480
 v_mfma_f32_16x16x32_bf16 v[16:19], a[96:99], a[0:3], v[16:19]
 ds_read_b64_tr_b16 a[56:57], v13 offset:0
 v_mfma_f32_16x16x32_bf16 v[16:19], a[100:103], a[4:7], v[16:19]
 s_add_u32 m0, s33, 0x1800
 ds_read_b64_tr_b16 a[58:59], v13 offset:4096
 v_mfma_f32_16x16x32_bf16 v[20:23], a[108:111], a[4:7], v[20:23]
 ds_read_b64_tr_b16 a[60:61], v13 offset:16384
 buffer_load_dwordx4 v15, s[20:23], s57 offen offset:1024 lds
 v_mfma_f32_16x16x32_bf16 v[20:23], a[104:107], a[0:3], v[20:23]
 s_waitcnt lgkmcnt(15)
 ds_read_b64_tr_b16 a[62:63], v13 offset:20480
 v_mfma_f32_16x16x32_bf16 v[24:27], a[112:115], a[0:3], v[24:27]
 v_mfma_f32_16x16x32_bf16 v[24:27], a[116:119], a[4:7], v[24:27]
 v_mfma_f32_16x16x32_bf16 v[28:31], a[124:127], a[4:7], v[28:31]
 v_mfma_f32_16x16x32_bf16 v[28:31], a[120:123], a[0:3], v[28:31]
 s_waitcnt lgkmcnt(0)
 v_mfma_f32_16x16x32_bf16 a[228:231], a[120:123], a[8:11], a[228:231]
 s_barrier
 v_mfma_f32_16x16x32_bf16 a[228:231], a[124:127], a[12:15], a[228:231]
 s_add_u32 m0, s29, 65536
 v_mfma_f32_16x16x32_bf16 a[224:227], a[116:119], a[12:15], a[224:227]
 buffer_load_dwordx4 v2, s[8:11], 0 offen  lds
 v_mfma_f32_16x16x32_bf16 a[224:227], a[112:115], a[8:11], a[224:227]
 v_mfma_f32_16x16x32_bf16 a[236:239], a[104:107], a[8:11], a[236:239]
 v_mfma_f32_16x16x32_bf16 a[236:239], a[108:111], a[12:15], a[236:239]
 v_mfma_f32_16x16x32_bf16 a[232:235], a[100:103], a[12:15], a[232:235]
 s_add_u32 m0, s29, 0
 v_mfma_f32_16x16x32_bf16 a[232:235], a[96:99], a[8:11], a[232:235]
 buffer_load_dwordx4 v1, s[4:7], 0 offen  lds
 v_mfma_f32_16x16x32_bf16 v[32:35], a[96:99], a[16:19], v[32:35]
 v_mfma_f32_16x16x32_bf16 v[32:35], a[100:103], a[20:23], v[32:35]
 v_mfma_f32_16x16x32_bf16 v[36:39], a[108:111], a[20:23], v[36:39]
 v_mfma_f32_16x16x32_bf16 v[36:39], a[104:107], a[16:19], v[36:39]
 s_add_u32 m0, s29, 69632
 v_mfma_f32_16x16x32_bf16 v[40:43], a[112:115], a[16:19], v[40:43]
 buffer_load_dwordx4 v2, s[8:11], s48 offen  lds
 v_mfma_f32_16x16x32_bf16 v[40:43], a[116:119], a[20:23], v[40:43]
 v_mfma_f32_16x16x32_bf16 v[44:47], a[124:127], a[20:23], v[44:47]
 v_mfma_f32_16x16x32_bf16 v[44:47], a[120:123], a[16:19], v[44:47]
 v_mfma_f32_16x16x32_bf16 v[52:55], a[120:123], a[24:27], v[52:55]
 s_add_u32 m0, s29, 4096
 v_mfma_f32_16x16x32_bf16 v[52:55], a[124:127], a[28:31], v[52:55]
 buffer_load_dwordx4 v1, s[4:7], s41 offen  lds
 v_mfma_f32_16x16x32_bf16 v[48:51], a[116:119], a[28:31], v[48:51]
 v_mfma_f32_16x16x32_bf16 v[48:51], a[112:115], a[24:27], v[48:51]
 v_mfma_f32_16x16x32_bf16 v[60:63], a[104:107], a[24:27], v[60:63]
 v_mfma_f32_16x16x32_bf16 v[60:63], a[108:111], a[28:31], v[60:63]
 s_add_u32 m0, s29, 73728
 v_mfma_f32_16x16x32_bf16 v[56:59], a[100:103], a[28:31], v[56:59]
 buffer_load_dwordx4 v2, s[8:11], s49 offen  lds
 v_mfma_f32_16x16x32_bf16 v[56:59], a[96:99], a[24:27], v[56:59]
 v_mfma_f32_16x16x32_bf16 v[192:195], a[96:99], a[32:35], v[192:195]
 v_mfma_f32_16x16x32_bf16 v[192:195], a[100:103], a[36:39], v[192:195]
 v_mfma_f32_16x16x32_bf16 v[196:199], a[108:111], a[36:39], v[196:199]
 s_add_u32 m0, s29, 8192
 v_mfma_f32_16x16x32_bf16 v[196:199], a[104:107], a[32:35], v[196:199]
 buffer_load_dwordx4 v1, s[4:7], s42 offen  lds
 v_mfma_f32_16x16x32_bf16 v[200:203], a[112:115], a[32:35], v[200:203]
 v_mfma_f32_16x16x32_bf16 v[200:203], a[116:119], a[36:39], v[200:203]
 v_mfma_f32_16x16x32_bf16 v[204:207], a[124:127], a[36:39], v[204:207]
 v_mfma_f32_16x16x32_bf16 v[204:207], a[120:123], a[32:35], v[204:207]
 s_add_u32 m0, s29, 77824
 v_mfma_f32_16x16x32_bf16 v[212:215], a[120:123], a[40:43], v[212:215]
 buffer_load_dwordx4 v2, s[8:11], s50 offen  lds
 v_mfma_f32_16x16x32_bf16 v[212:215], a[124:127], a[44:47], v[212:215]
 v_mfma_f32_16x16x32_bf16 v[208:211], a[116:119], a[44:47], v[208:211]
 v_mfma_f32_16x16x32_bf16 v[208:211], a[112:115], a[40:43], v[208:211]
 v_mfma_f32_16x16x32_bf16 v[220:223], a[104:107], a[40:43], v[220:223]
 s_add_u32 m0, s29, 12288
 v_mfma_f32_16x16x32_bf16 v[220:223], a[108:111], a[44:47], v[220:223]
 buffer_load_dwordx4 v1, s[4:7], s43 offen  lds
 v_mfma_f32_16x16x32_bf16 v[216:219], a[100:103], a[44:47], v[216:219]
 v_mfma_f32_16x16x32_bf16 v[216:219], a[96:99], a[40:43], v[216:219]
 v_mfma_f32_16x16x32_bf16 v[224:227], a[96:99], a[48:51], v[224:227]
 v_mfma_f32_16x16x32_bf16 v[224:227], a[100:103], a[52:55], v[224:227]
 s_add_u32 m0, s29, 81920
 v_mfma_f32_16x16x32_bf16 v[228:231], a[108:111], a[52:55], v[228:231]
 buffer_load_dwordx4 v2, s[8:11], s51 offen  lds
 v_mfma_f32_16x16x32_bf16 v[228:231], a[104:107], a[48:51], v[228:231]
 v_mfma_f32_16x16x32_bf16 v[232:235], a[112:115], a[48:51], v[232:235]
 v_mfma_f32_16x16x32_bf16 v[232:235], a[116:119], a[52:55], v[232:235]
 v_mfma_f32_16x16x32_bf16 v[236:239], a[124:127], a[52:55], v[236:239]
 s_add_u32 m0, s29, 16384
 v_mfma_f32_16x16x32_bf16 v[236:239], a[120:123], a[48:51], v[236:239]
 buffer_load_dwordx4 v1, s[4:7], s44 offen  lds
 v_mfma_f32_16x16x32_bf16 v[244:247], a[120:123], a[56:59], v[244:247]
 v_mfma_f32_16x16x32_bf16 v[244:247], a[124:127], a[60:63], v[244:247]
 v_mfma_f32_16x16x32_bf16 v[240:243], a[116:119], a[60:63], v[240:243]
 v_mfma_f32_16x16x32_bf16 v[240:243], a[112:115], a[56:59], v[240:243]
 s_add_u32 m0, s29, 86016
 v_mfma_f32_16x16x32_bf16 v[252:255], a[104:107], a[56:59], v[252:255]
 s_waitcnt vmcnt(10)
 buffer_load_dwordx4 v2, s[8:11], s52 offen  lds
 v_mfma_f32_16x16x32_bf16 v[252:255], a[108:111], a[60:63], v[252:255]
 s_barrier
 ds_read_b64_tr_b16 a[0:1], v6 offset:32768
 v_mfma_f32_16x16x32_bf16 v[248:251], a[100:103], a[60:63], v[248:251]
 ds_read_b64_tr_b16 a[2:3], v6 offset:36864
 v_mfma_f32_16x16x32_bf16 v[248:251], a[96:99], a[56:59], v[248:251]
 ds_read_b128 a[96:99], v4 offset:40960
 v_mfma_f32_16x16x32_bf16 v[128:131], a[64:67], a[32:35], v[128:131]
 s_add_u32 m0, s29, 20480
 ds_read_b128 a[128:131], v14 offset:0
 v_mfma_f32_16x16x32_bf16 v[128:131], a[68:71], a[36:39], v[128:131]
 buffer_load_dwordx4 v1, s[4:7], s45 offen  lds
 v_mfma_f32_16x16x32_bf16 v[132:135], a[76:79], a[36:39], v[132:135]
 ds_read_b64_tr_b16 a[4:5], v6 offset:49152
 v_mfma_f32_16x16x32_bf16 v[132:135], a[72:75], a[32:35], v[132:135]
 ds_read_b64_tr_b16 a[6:7], v6 offset:53248
 v_mfma_f32_16x16x32_bf16 v[136:139], a[80:83], a[32:35], v[136:139]
 ds_read_b128 a[100:103], v5 offset:40960
 v_mfma_f32_16x16x32_bf16 v[136:139], a[84:87], a[36:39], v[136:139]
 s_add_u32 m0, s29, 90112
 ds_read_b128 a[136:139], v3 offset:0
 v_mfma_f32_16x16x32_bf16 v[140:143], a[92:95], a[36:39], v[140:143]
 buffer_load_dwordx4 v2, s[8:11], s53 offen  lds
 v_mfma_f32_16x16x32_bf16 v[140:143], a[88:91], a[32:35], v[140:143]
 ds_read_b128 a[108:111], v5 offset:43008
 v_mfma_f32_16x16x32_bf16 v[148:151], a[88:91], a[40:43], v[148:151]
 ds_read_b128 a[132:135], v14 offset:2048
 v_mfma_f32_16x16x32_bf16 v[148:151], a[92:95], a[44:47], v[148:151]
 ds_read_b128 a[104:107], v4 offset:43008
 v_mfma_f32_16x16x32_bf16 v[144:147], a[84:87], a[44:47], v[144:147]
 s_add_u32 m0, s29, 24576
 ds_read_b128 a[140:143], v3 offset:2048
 v_mfma_f32_16x16x32_bf16 v[144:147], a[80:83], a[40:43], v[144:147]
 buffer_load_dwordx4 v1, s[4:7], s46 offen  lds
 v_mfma_f32_16x16x32_bf16 v[156:159], a[72:75], a[40:43], v[156:159]
 ds_read_b128 a[112:115], v4 offset:45056
 v_mfma_f32_16x16x32_bf16 v[156:159], a[76:79], a[44:47], v[156:159]
 ds_read_b128 a[144:147], v14 offset:4096
 v_mfma_f32_16x16x32_bf16 v[152:155], a[68:71], a[44:47], v[152:155]
 ds_read_b128 a[116:119], v5 offset:45056
 v_mfma_f32_16x16x32_bf16 v[152:155], a[64:67], a[40:43], v[152:155]
 s_add_u32 m0, s29, 94208
 ds_read_b128 a[152:155], v3 offset:4096
 v_mfma_f32_16x16x32_bf16 v[160:163], a[64:67], a[48:51], v[160:163]
 buffer_load_dwordx4 v2, s[8:11], s54 offen  lds
 v_mfma_f32_16x16x32_bf16 v[160:163], a[68:71], a[52:55], v[160:163]
 ds_read_b128 a[124:127], v5 offset:47104
 v_mfma_f32_16x16x32_bf16 v[164:167], a[76:79], a[52:55], v[164:167]
 ds_read_b128 a[148:151], v14 offset:6144
 v_mfma_f32_16x16x32_bf16 v[164:167], a[72:75], a[48:51], v[164:167]
 ds_read_b128 a[120:123], v4 offset:47104
 v_mfma_f32_16x16x32_bf16 v[168:171], a[80:83], a[48:51], v[168:171]
 s_add_u32 m0, s29, 28672
 ds_read_b128 a[156:159], v3 offset:6144
 v_mfma_f32_16x16x32_bf16 v[168:171], a[84:87], a[52:55], v[168:171]
 buffer_load_dwordx4 v1, s[4:7], s47 offen  lds
 v_mfma_f32_16x16x32_bf16 v[172:175], a[92:95], a[52:55], v[172:175]
 v_add_u32 v1, 128, v1
 v_add_u32 v2, 0x80000, v2
 v_mfma_f32_16x16x32_bf16 v[172:175], a[88:91], a[48:51], v[172:175]
 ds_read_b64_tr_b16 a[8:9], v7 offset:32768
 v_mfma_f32_16x16x32_bf16 v[180:183], a[88:91], a[56:59], v[180:183]
 v_mfma_f32_16x16x32_bf16 v[180:183], a[92:95], a[60:63], v[180:183]
 ds_read_b64_tr_b16 a[10:11], v7 offset:36864
 v_mfma_f32_16x16x32_bf16 v[176:179], a[84:87], a[60:63], v[176:179]
 ds_read_b64_tr_b16 a[12:13], v7 offset:49152
 v_mfma_f32_16x16x32_bf16 v[176:179], a[80:83], a[56:59], v[176:179]
 ds_read_b64_tr_b16 a[14:15], v7 offset:53248
 v_mfma_f32_16x16x32_bf16 v[188:191], a[72:75], a[56:59], v[188:191]
 ds_read_b64_tr_b16 a[16:17], v8 offset:32768
 v_mfma_f32_16x16x32_bf16 v[188:191], a[76:79], a[60:63], v[188:191]
 ds_read_b64_tr_b16 a[18:19], v8 offset:36864
 v_mfma_f32_16x16x32_bf16 v[184:187], a[68:71], a[60:63], v[184:187]
 ds_read_b64_tr_b16 a[20:21], v8 offset:49152
 v_mfma_f32_16x16x32_bf16 v[184:187], a[64:67], a[56:59], v[184:187]
 s_waitcnt lgkmcnt(15)
 ds_read_b64_tr_b16 a[22:23], v8 offset:53248
 v_mfma_f32_16x16x32_bf16 v[16:19], a[96:99], a[0:3], v[16:19]
 ds_read_b64_tr_b16 a[24:25], v9 offset:32768
 v_mfma_f32_16x16x32_bf16 v[16:19], a[100:103], a[4:7], v[16:19]
 s_add_u32 m0, s33, 0xffffff00
 ds_read_b64_tr_b16 a[26:27], v9 offset:36864
 v_mfma_f32_16x16x32_bf16 v[20:23], a[108:111], a[4:7], v[20:23]
 s_waitcnt lgkmcnt(10)
 ds_read_b64_tr_b16 a[28:29], v9 offset:49152
 v_mfma_f32_16x16x32_bf16 v[20:23], a[104:107], a[0:3], v[20:23]
 ds_read_b64_tr_b16 a[30:31], v9 offset:53248
 buffer_load_dwordx4 v15, s[20:23], 0 offen offset:256 lds
 v_mfma_f32_16x16x32_bf16 v[24:27], a[112:115], a[0:3], v[24:27]
 ds_read_b128 a[64:67], v4 offset:32768
 v_mfma_f32_16x16x32_bf16 v[24:27], a[116:119], a[4:7], v[24:27]
 v_mfma_f32_16x16x32_bf16 v[28:31], a[124:127], a[4:7], v[28:31]
 s_add_u32 m0, s33, 0xffffff80
 ds_read_b128 a[68:71], v5 offset:32768
 v_mfma_f32_16x16x32_bf16 v[28:31], a[120:123], a[0:3], v[28:31]
 s_waitcnt lgkmcnt(10)
 buffer_load_dwordx4 v15, s[20:23], 0 offen offset:1152 lds
 v_mfma_f32_16x16x32_bf16 a[228:231], a[120:123], a[8:11], a[228:231]
 ds_read_b128 a[76:79], v5 offset:34816
 v_mfma_f32_16x16x32_bf16 a[228:231], a[124:127], a[12:15], a[228:231]
 v_mfma_f32_16x16x32_bf16 a[224:227], a[116:119], a[12:15], a[224:227]
 s_add_u32 m0, s33, 0x700
 ds_read_b128 a[72:75], v4 offset:34816
 v_mfma_f32_16x16x32_bf16 a[224:227], a[112:115], a[8:11], a[224:227]
 buffer_load_dwordx4 v15, s[20:23], s57 offen offset:256 lds
 v_mfma_f32_16x16x32_bf16 a[236:239], a[104:107], a[8:11], a[236:239]
 ds_read_b128 a[80:83], v4 offset:36864
 v_mfma_f32_16x16x32_bf16 a[236:239], a[108:111], a[12:15], a[236:239]
 v_mfma_f32_16x16x32_bf16 a[232:235], a[100:103], a[12:15], a[232:235]
 s_add_u32 m0, s33, 0x780
 ds_read_b128 a[84:87], v5 offset:36864
 v_mfma_f32_16x16x32_bf16 a[232:235], a[96:99], a[8:11], a[232:235]
 s_waitcnt lgkmcnt(10)
 buffer_load_dwordx4 v15, s[20:23], s57 offen offset:1152 lds
 v_mfma_f32_16x16x32_bf16 v[32:35], a[96:99], a[16:19], v[32:35]
 ds_read_b128 a[92:95], v5 offset:38912
 v_mfma_f32_16x16x32_bf16 v[32:35], a[100:103], a[20:23], v[32:35]
 v_mfma_f32_16x16x32_bf16 v[36:39], a[108:111], a[20:23], v[36:39]
 s_add_u32 m0, s33, 0xe80
 ds_read_b128 a[88:91], v4 offset:38912
 v_mfma_f32_16x16x32_bf16 v[36:39], a[104:107], a[16:19], v[36:39]
 buffer_load_dwordx4 v15, s[20:23], 0 offen offset:384 lds
 v_mfma_f32_16x16x32_bf16 v[40:43], a[112:115], a[16:19], v[40:43]
 ds_read_b64_tr_b16 a[32:33], v10 offset:32768
 v_mfma_f32_16x16x32_bf16 v[40:43], a[116:119], a[20:23], v[40:43]
 ds_read_b64_tr_b16 a[34:35], v10 offset:36864
 v_mfma_f32_16x16x32_bf16 v[44:47], a[124:127], a[20:23], v[44:47]
 s_add_u32 m0, s33, 0xf00
 ds_read_b64_tr_b16 a[36:37], v10 offset:49152
 v_mfma_f32_16x16x32_bf16 v[44:47], a[120:123], a[16:19], v[44:47]
 s_waitcnt lgkmcnt(11)
 ds_read_b64_tr_b16 a[38:39], v10 offset:53248
 buffer_load_dwordx4 v15, s[20:23], 0 offen offset:1280 lds
 v_mfma_f32_16x16x32_bf16 v[52:55], a[120:123], a[24:27], v[52:55]
 ds_read_b64_tr_b16 a[40:41], v11 offset:32768
 v_mfma_f32_16x16x32_bf16 v[52:55], a[124:127], a[28:31], v[52:55]
 ds_read_b64_tr_b16 a[42:43], v11 offset:36864
 v_mfma_f32_16x16x32_bf16 v[48:51], a[116:119], a[28:31], v[48:51]
 s_add_u32 m0, s33, 0x1680
 ds_read_b64_tr_b16 a[44:45], v11 offset:49152
 v_mfma_f32_16x16x32_bf16 v[48:51], a[112:115], a[24:27], v[48:51]
 ds_read_b64_tr_b16 a[46:47], v11 offset:53248
 buffer_load_dwordx4 v15, s[20:23], s57 offen offset:384 lds
 v_mfma_f32_16x16x32_bf16 v[60:63], a[104:107], a[24:27], v[60:63]
 ds_read_b64_tr_b16 a[48:49], v12 offset:32768
 v_mfma_f32_16x16x32_bf16 v[60:63], a[108:111], a[28:31], v[60:63]
 ds_read_b64_tr_b16 a[50:51], v12 offset:36864
 v_mfma_f32_16x16x32_bf16 v[56:59], a[100:103], a[28:31], v[56:59]
 s_add_u32 m0, s33, 0x1700
 ds_read_b64_tr_b16 a[52:53], v12 offset:49152
 v_mfma_f32_16x16x32_bf16 v[56:59], a[96:99], a[24:27], v[56:59]
 s_waitcnt lgkmcnt(15)
 ds_read_b64_tr_b16 a[54:55], v12 offset:53248
 buffer_load_dwordx4 v15, s[20:23], s57 offen offset:1280 lds
 v_mfma_f32_16x16x32_bf16 v[64:67], a[64:67], a[0:3], v[64:67]
 ds_read_b64_tr_b16 a[56:57], v13 offset:32768
 v_mfma_f32_16x16x32_bf16 v[64:67], a[68:71], a[4:7], v[64:67]
 ds_read_b64_tr_b16 a[58:59], v13 offset:36864
 v_mfma_f32_16x16x32_bf16 v[68:71], a[76:79], a[4:7], v[68:71]
 ds_read_b64_tr_b16 a[60:61], v13 offset:49152
 v_mfma_f32_16x16x32_bf16 v[68:71], a[72:75], a[0:3], v[68:71]
 s_waitcnt lgkmcnt(15)
 ds_read_b64_tr_b16 a[62:63], v13 offset:53248
 v_mfma_f32_16x16x32_bf16 v[72:75], a[80:83], a[0:3], v[72:75]
 v_mfma_f32_16x16x32_bf16 v[72:75], a[84:87], a[4:7], v[72:75]
 v_mfma_f32_16x16x32_bf16 v[76:79], a[92:95], a[4:7], v[76:79]
 v_mfma_f32_16x16x32_bf16 v[76:79], a[88:91], a[0:3], v[76:79]
 s_waitcnt lgkmcnt(0)
 v_mfma_f32_16x16x32_bf16 v[84:87], a[88:91], a[8:11], v[84:87]
 s_barrier
 v_mfma_f32_16x16x32_bf16 v[84:87], a[92:95], a[12:15], v[84:87]
 s_add_u32 m0, s29, 98304
 v_mfma_f32_16x16x32_bf16 v[80:83], a[84:87], a[12:15], v[80:83]
 buffer_load_dwordx4 v2, s[8:11], 0 offen  lds
 v_mfma_f32_16x16x32_bf16 v[80:83], a[80:83], a[8:11], v[80:83]
 v_mfma_f32_16x16x32_bf16 v[92:95], a[72:75], a[8:11], v[92:95]
 v_mfma_f32_16x16x32_bf16 v[92:95], a[76:79], a[12:15], v[92:95]
 v_mfma_f32_16x16x32_bf16 v[88:91], a[68:71], a[12:15], v[88:91]
 s_add_u32 m0, s29, 32768
 v_mfma_f32_16x16x32_bf16 v[88:91], a[64:67], a[8:11], v[88:91]
 buffer_load_dwordx4 v1, s[4:7], 0 offen  lds
 v_mfma_f32_16x16x32_bf16 v[96:99], a[64:67], a[16:19], v[96:99]
 v_mfma_f32_16x16x32_bf16 v[96:99], a[68:71], a[20:23], v[96:99]
 v_mfma_f32_16x16x32_bf16 v[100:103], a[76:79], a[20:23], v[100:103]
 v_mfma_f32_16x16x32_bf16 v[100:103], a[72:75], a[16:19], v[100:103]
 s_add_u32 m0, s29, 102400
 v_mfma_f32_16x16x32_bf16 v[104:107], a[80:83], a[16:19], v[104:107]
 buffer_load_dwordx4 v2, s[8:11], s48 offen  lds
 v_mfma_f32_16x16x32_bf16 v[104:107], a[84:87], a[20:23], v[104:107]
 v_mfma_f32_16x16x32_bf16 v[108:111], a[92:95], a[20:23], v[108:111]
 v_mfma_f32_16x16x32_bf16 v[108:111], a[88:91], a[16:19], v[108:111]
 v_mfma_f32_16x16x32_bf16 v[116:119], a[88:91], a[24:27], v[116:119]
 s_add_u32 m0, s29, 36864
 v_mfma_f32_16x16x32_bf16 v[116:119], a[92:95], a[28:31], v[116:119]
 buffer_load_dwordx4 v1, s[4:7], s41 offen  lds
 v_mfma_f32_16x16x32_bf16 v[112:115], a[84:87], a[28:31], v[112:115]
 v_mfma_f32_16x16x32_bf16 v[112:115], a[80:83], a[24:27], v[112:115]
 v_mfma_f32_16x16x32_bf16 v[124:127], a[72:75], a[24:27], v[124:127]
 v_mfma_f32_16x16x32_bf16 v[124:127], a[76:79], a[28:31], v[124:127]
 s_add_u32 m0, s29, 106496
 v_mfma_f32_16x16x32_bf16 v[120:123], a[68:71], a[28:31], v[120:123]
 buffer_load_dwordx4 v2, s[8:11], s49 offen  lds
 v_mfma_f32_16x16x32_bf16 v[120:123], a[64:67], a[24:27], v[120:123]
 v_mfma_f32_16x16x32_bf16 v[128:131], a[64:67], a[32:35], v[128:131]
 v_mfma_f32_16x16x32_bf16 v[128:131], a[68:71], a[36:39], v[128:131]
 v_mfma_f32_16x16x32_bf16 v[132:135], a[76:79], a[36:39], v[132:135]
 s_add_u32 m0, s29, 40960
 v_mfma_f32_16x16x32_bf16 v[132:135], a[72:75], a[32:35], v[132:135]
 buffer_load_dwordx4 v1, s[4:7], s42 offen  lds
 v_mfma_f32_16x16x32_bf16 v[136:139], a[80:83], a[32:35], v[136:139]
 v_mfma_f32_16x16x32_bf16 v[136:139], a[84:87], a[36:39], v[136:139]
 v_mfma_f32_16x16x32_bf16 v[140:143], a[92:95], a[36:39], v[140:143]
 v_mfma_f32_16x16x32_bf16 v[140:143], a[88:91], a[32:35], v[140:143]
 s_add_u32 m0, s29, 110592
 v_mfma_f32_16x16x32_bf16 v[148:151], a[88:91], a[40:43], v[148:151]
 buffer_load_dwordx4 v2, s[8:11], s50 offen  lds
 v_mfma_f32_16x16x32_bf16 v[148:151], a[92:95], a[44:47], v[148:151]
 v_mfma_f32_16x16x32_bf16 v[144:147], a[84:87], a[44:47], v[144:147]
 v_mfma_f32_16x16x32_bf16 v[144:147], a[80:83], a[40:43], v[144:147]
 v_mfma_f32_16x16x32_bf16 v[156:159], a[72:75], a[40:43], v[156:159]
 s_add_u32 m0, s29, 45056
 v_mfma_f32_16x16x32_bf16 v[156:159], a[76:79], a[44:47], v[156:159]
 buffer_load_dwordx4 v1, s[4:7], s43 offen  lds
 v_mfma_f32_16x16x32_bf16 v[152:155], a[68:71], a[44:47], v[152:155]
 v_mfma_f32_16x16x32_bf16 v[152:155], a[64:67], a[40:43], v[152:155]
 v_mfma_f32_16x16x32_bf16 v[160:163], a[64:67], a[48:51], v[160:163]
 v_mfma_f32_16x16x32_bf16 v[160:163], a[68:71], a[52:55], v[160:163]
 s_add_u32 m0, s29, 114688
 v_mfma_f32_16x16x32_bf16 v[164:167], a[76:79], a[52:55], v[164:167]
 buffer_load_dwordx4 v2, s[8:11], s51 offen  lds
 v_mfma_f32_16x16x32_bf16 v[164:167], a[72:75], a[48:51], v[164:167]
 v_mfma_f32_16x16x32_bf16 v[168:171], a[80:83], a[48:51], v[168:171]
 v_mfma_f32_16x16x32_bf16 v[168:171], a[84:87], a[52:55], v[168:171]
 v_mfma_f32_16x16x32_bf16 v[172:175], a[92:95], a[52:55], v[172:175]
 s_add_u32 m0, s29, 49152
 v_mfma_f32_16x16x32_bf16 v[172:175], a[88:91], a[48:51], v[172:175]
 buffer_load_dwordx4 v1, s[4:7], s44 offen  lds
 v_mfma_f32_16x16x32_bf16 v[180:183], a[88:91], a[56:59], v[180:183]
 v_mfma_f32_16x16x32_bf16 v[180:183], a[92:95], a[60:63], v[180:183]
 v_mfma_f32_16x16x32_bf16 v[176:179], a[84:87], a[60:63], v[176:179]
 v_mfma_f32_16x16x32_bf16 v[176:179], a[80:83], a[56:59], v[176:179]
 s_add_u32 m0, s29, 118784
 v_mfma_f32_16x16x32_bf16 v[188:191], a[72:75], a[56:59], v[188:191]
 s_waitcnt vmcnt(10)
 buffer_load_dwordx4 v2, s[8:11], s52 offen  lds
 v_mfma_f32_16x16x32_bf16 v[188:191], a[76:79], a[60:63], v[188:191]
 s_barrier
 ds_read_b64_tr_b16 a[0:1], v6 offset:0
 v_mfma_f32_16x16x32_bf16 v[184:187], a[68:71], a[60:63], v[184:187]
 ds_read_b64_tr_b16 a[2:3], v6 offset:4096
 v_mfma_f32_16x16x32_bf16 v[184:187], a[64:67], a[56:59], v[184:187]
 ds_read_b128 a[64:67], v4 offset:0
 v_mfma_f32_16x16x32_bf16 v[192:195], a[96:99], a[32:35], v[192:195]
 s_add_u32 m0, s29, 53248
 ds_read_b128 a[160:163], v14 offset:0
 v_mfma_f32_16x16x32_bf16 v[192:195], a[100:103], a[36:39], v[192:195]
 buffer_load_dwordx4 v1, s[4:7], s45 offen  lds
 v_mfma_f32_16x16x32_bf16 v[196:199], a[108:111], a[36:39], v[196:199]
 ds_read_b64_tr_b16 a[4:5], v6 offset:16384
 v_mfma_f32_16x16x32_bf16 v[196:199], a[104:107], a[32:35], v[196:199]
 ds_read_b64_tr_b16 a[6:7], v6 offset:20480
 v_mfma_f32_16x16x32_bf16 v[200:203], a[112:115], a[32:35], v[200:203]
 ds_read_b128 a[68:71], v5 offset:0
 v_mfma_f32_16x16x32_bf16 v[200:203], a[116:119], a[36:39], v[200:203]
 s_add_u32 m0, s29, 122880
 ds_read_b128 a[168:171], v3 offset:0
 v_mfma_f32_16x16x32_bf16 v[204:207], a[124:127], a[36:39], v[204:207]
 buffer_load_dwordx4 v2, s[8:11], s53 offen  lds
 v_mfma_f32_16x16x32_bf16 v[204:207], a[120:123], a[32:35], v[204:207]
 ds_read_b128 a[76:79], v5 offset:2048
 v_mfma_f32_16x16x32_bf16 v[212:215], a[120:123], a[40:43], v[212:215]
 ds_read_b128 a[164:167], v14 offset:2048
 v_mfma_f32_16x16x32_bf16 v[212:215], a[124:127], a[44:47], v[212:215]
 ds_read_b128 a[72:75], v4 offset:2048
 v_mfma_f32_16x16x32_bf16 v[208:211], a[116:119], a[44:47], v[208:211]
 s_add_u32 m0, s29, 57344
 ds_read_b128 a[172:175], v3 offset:2048
 v_mfma_f32_16x16x32_bf16 v[208:211], a[112:115], a[40:43], v[208:211]
 buffer_load_dwordx4 v1, s[4:7], s46 offen  lds
 v_mfma_f32_16x16x32_bf16 v[220:223], a[104:107], a[40:43], v[220:223]
 ds_read_b128 a[80:83], v4 offset:4096
 v_mfma_f32_16x16x32_bf16 v[220:223], a[108:111], a[44:47], v[220:223]
 ds_read_b128 a[176:179], v14 offset:4096
 v_mfma_f32_16x16x32_bf16 v[216:219], a[100:103], a[44:47], v[216:219]
 ds_read_b128 a[84:87], v5 offset:4096
 v_mfma_f32_16x16x32_bf16 v[216:219], a[96:99], a[40:43], v[216:219]
 s_add_u32 m0, s29, 126976
 ds_read_b128 a[184:187], v3 offset:4096
 v_mfma_f32_16x16x32_bf16 v[224:227], a[96:99], a[48:51], v[224:227]
 buffer_load_dwordx4 v2, s[8:11], s54 offen  lds
 v_mfma_f32_16x16x32_bf16 v[224:227], a[100:103], a[52:55], v[224:227]
 ds_read_b128 a[92:95], v5 offset:6144
 v_mfma_f32_16x16x32_bf16 v[228:231], a[108:111], a[52:55], v[228:231]
 ds_read_b128 a[180:183], v14 offset:6144
 v_mfma_f32_16x16x32_bf16 v[228:231], a[104:107], a[48:51], v[228:231]
 ds_read_b128 a[88:91], v4 offset:6144
 v_mfma_f32_16x16x32_bf16 v[232:235], a[112:115], a[48:51], v[232:235]
 s_add_u32 m0, s29, 61440
 ds_read_b128 a[188:191], v3 offset:6144
 v_mfma_f32_16x16x32_bf16 v[232:235], a[116:119], a[52:55], v[232:235]
 buffer_load_dwordx4 v1, s[4:7], s47 offen  lds
 v_mfma_f32_16x16x32_bf16 v[236:239], a[124:127], a[52:55], v[236:239]
 v_add_u32 v1, 128, v1
 v_add_u32 v2, 0x80000, v2
 v_mfma_f32_16x16x32_bf16 v[236:239], a[120:123], a[48:51], v[236:239]
 ds_read_b64_tr_b16 a[8:9], v7 offset:0
 v_mfma_f32_16x16x32_bf16 v[244:247], a[120:123], a[56:59], v[244:247]
 v_mfma_f32_16x16x32_bf16 v[244:247], a[124:127], a[60:63], v[244:247]
 ds_read_b64_tr_b16 a[10:11], v7 offset:4096
 v_mfma_f32_16x16x32_bf16 v[240:243], a[116:119], a[60:63], v[240:243]
 ds_read_b64_tr_b16 a[12:13], v7 offset:16384
 v_mfma_f32_16x16x32_bf16 v[240:243], a[112:115], a[56:59], v[240:243]
 ds_read_b64_tr_b16 a[14:15], v7 offset:20480
 v_mfma_f32_16x16x32_bf16 v[252:255], a[104:107], a[56:59], v[252:255]
 ds_read_b64_tr_b16 a[16:17], v8 offset:0
 v_mfma_f32_16x16x32_bf16 v[252:255], a[108:111], a[60:63], v[252:255]
 ds_read_b64_tr_b16 a[18:19], v8 offset:4096
 v_mfma_f32_16x16x32_bf16 v[248:251], a[100:103], a[60:63], v[248:251]
 ds_read_b64_tr_b16 a[20:21], v8 offset:16384
 v_mfma_f32_16x16x32_bf16 v[248:251], a[96:99], a[56:59], v[248:251]
 s_waitcnt lgkmcnt(15)
 ds_read_b64_tr_b16 a[22:23], v8 offset:20480
 v_mfma_f32_16x16x32_bf16 v[64:67], a[64:67], a[0:3], v[64:67]
 ds_read_b64_tr_b16 a[24:25], v9 offset:0
 v_lshlrev_b32 v1, 4, v0
 v_mfma_f32_16x16x32_bf16 v[64:67], a[68:71], a[4:7], v[64:67]
 s_add_u32 m0, s33, 0xfffffe00
 ds_read_b64_tr_b16 a[26:27], v9 offset:4096
 v_mfma_f32_16x16x32_bf16 v[68:71], a[76:79], a[4:7], v[68:71]
 s_waitcnt lgkmcnt(10)
 ds_read_b64_tr_b16 a[28:29], v9 offset:16384
 v_mfma_f32_16x16x32_bf16 v[68:71], a[72:75], a[0:3], v[68:71]
 ds_read_b64_tr_b16 a[30:31], v9 offset:20480
 buffer_load_dwordx4 v15, s[20:23], 0 offen offset:512 lds
 v_mfma_f32_16x16x32_bf16 v[72:75], a[80:83], a[0:3], v[72:75]
 ds_read_b128 a[96:99], v4 offset:8192
 v_mfma_f32_16x16x32_bf16 v[72:75], a[84:87], a[4:7], v[72:75]
 v_mfma_f32_16x16x32_bf16 v[76:79], a[92:95], a[4:7], v[76:79]
 s_add_u32 m0, s33, 0xfffffe80
 ds_read_b128 a[100:103], v5 offset:8192
 v_mfma_f32_16x16x32_bf16 v[76:79], a[88:91], a[0:3], v[76:79]
 s_waitcnt lgkmcnt(10)
 buffer_load_dwordx4 v15, s[20:23], 0 offen offset:1408 lds
 v_mfma_f32_16x16x32_bf16 v[84:87], a[88:91], a[8:11], v[84:87]
 ds_read_b128 a[108:111], v5 offset:10240
 v_mfma_f32_16x16x32_bf16 v[84:87], a[92:95], a[12:15], v[84:87]
 v_mfma_f32_16x16x32_bf16 v[80:83], a[84:87], a[12:15], v[80:83]
 s_add_u32 m0, s33, 0x600
 ds_read_b128 a[104:107], v4 offset:10240
 v_mfma_f32_16x16x32_bf16 v[80:83], a[80:83], a[8:11], v[80:83]
 buffer_load_dwordx4 v15, s[20:23], s57 offen offset:512 lds
 v_mfma_f32_16x16x32_bf16 v[92:95], a[72:75], a[8:11], v[92:95]
 ds_read_b128 a[112:115], v4 offset:12288
 v_mfma_f32_16x16x32_bf16 v[92:95], a[76:79], a[12:15], v[92:95]
 v_mfma_f32_16x16x32_bf16 v[88:91], a[68:71], a[12:15], v[88:91]
 s_add_u32 m0, s33, 0x680
 ds_read_b128 a[116:119], v5 offset:12288
 v_mfma_f32_16x16x32_bf16 v[88:91], a[64:67], a[8:11], v[88:91]
 s_waitcnt lgkmcnt(10)
 buffer_load_dwordx4 v15, s[20:23], s57 offen offset:1408 lds
 v_mfma_f32_16x16x32_bf16 v[96:99], a[64:67], a[16:19], v[96:99]
 ds_read_b128 a[124:127], v5 offset:14336
 v_mfma_f32_16x16x32_bf16 v[96:99], a[68:71], a[20:23], v[96:99]
 v_mfma_f32_16x16x32_bf16 v[100:103], a[76:79], a[20:23], v[100:103]
 s_add_u32 m0, s33, 0xd80
 ds_read_b128 a[120:123], v4 offset:14336
 v_mfma_f32_16x16x32_bf16 v[100:103], a[72:75], a[16:19], v[100:103]
 buffer_load_dwordx4 v15, s[20:23], 0 offen offset:640 lds
 v_mfma_f32_16x16x32_bf16 v[104:107], a[80:83], a[16:19], v[104:107]
 ds_read_b64_tr_b16 a[32:33], v10 offset:0
 v_mfma_f32_16x16x32_bf16 v[104:107], a[84:87], a[20:23], v[104:107]
 ds_read_b64_tr_b16 a[34:35], v10 offset:4096
 v_mfma_f32_16x16x32_bf16 v[108:111], a[92:95], a[20:23], v[108:111]
 s_add_u32 m0, s33, 0xe00
 ds_read_b64_tr_b16 a[36:37], v10 offset:16384
 v_mfma_f32_16x16x32_bf16 v[108:111], a[88:91], a[16:19], v[108:111]
 s_waitcnt lgkmcnt(11)
 ds_read_b64_tr_b16 a[38:39], v10 offset:20480
 buffer_load_dwordx4 v15, s[20:23], 0 offen offset:1536 lds
 v_mfma_f32_16x16x32_bf16 v[116:119], a[88:91], a[24:27], v[116:119]
 ds_read_b64_tr_b16 a[40:41], v11 offset:0
 v_mfma_f32_16x16x32_bf16 v[116:119], a[92:95], a[28:31], v[116:119]
 ds_read_b64_tr_b16 a[42:43], v11 offset:4096
 v_mfma_f32_16x16x32_bf16 v[112:115], a[84:87], a[28:31], v[112:115]
 s_add_u32 m0, s33, 0x1580
 ds_read_b64_tr_b16 a[44:45], v11 offset:16384
 v_mfma_f32_16x16x32_bf16 v[112:115], a[80:83], a[24:27], v[112:115]
 ds_read_b64_tr_b16 a[46:47], v11 offset:20480
 buffer_load_dwordx4 v15, s[20:23], s57 offen offset:640 lds
 v_mfma_f32_16x16x32_bf16 v[124:127], a[72:75], a[24:27], v[124:127]
 ds_read_b64_tr_b16 a[48:49], v12 offset:0
 v_mfma_f32_16x16x32_bf16 v[124:127], a[76:79], a[28:31], v[124:127]
 ds_read_b64_tr_b16 a[50:51], v12 offset:4096
 v_mfma_f32_16x16x32_bf16 v[120:123], a[68:71], a[28:31], v[120:123]
 s_add_u32 m0, s33, 0x1600
 ds_read_b64_tr_b16 a[52:53], v12 offset:16384
 v_mfma_f32_16x16x32_bf16 v[120:123], a[64:67], a[24:27], v[120:123]
 s_waitcnt lgkmcnt(15)
 ds_read_b64_tr_b16 a[54:55], v12 offset:20480
 buffer_load_dwordx4 v15, s[20:23], s57 offen offset:1536 lds
 v_mfma_f32_16x16x32_bf16 v[16:19], a[96:99], a[0:3], v[16:19]
 ds_read_b64_tr_b16 a[56:57], v13 offset:0
 v_mfma_f32_16x16x32_bf16 v[16:19], a[100:103], a[4:7], v[16:19]
 ds_read_b64_tr_b16 a[58:59], v13 offset:4096
 v_mfma_f32_16x16x32_bf16 v[20:23], a[108:111], a[4:7], v[20:23]
 ds_read_b64_tr_b16 a[60:61], v13 offset:16384
 v_mfma_f32_16x16x32_bf16 v[20:23], a[104:107], a[0:3], v[20:23]
 s_waitcnt lgkmcnt(15)
 ds_read_b64_tr_b16 a[62:63], v13 offset:20480
 v_mfma_f32_16x16x32_bf16 v[24:27], a[112:115], a[0:3], v[24:27]
 v_mfma_f32_16x16x32_bf16 v[24:27], a[116:119], a[4:7], v[24:27]
 v_mfma_f32_16x16x32_bf16 v[28:31], a[124:127], a[4:7], v[28:31]
 v_mfma_f32_16x16x32_bf16 v[28:31], a[120:123], a[0:3], v[28:31]
 s_waitcnt lgkmcnt(0)
 v_mfma_f32_16x16x32_bf16 a[228:231], a[120:123], a[8:11], a[228:231]
 s_barrier
 v_mfma_f32_16x16x32_bf16 a[228:231], a[124:127], a[12:15], a[228:231]
 s_add_u32 m0, s29, 0
 v_add_u32 v2, 0xff800000, v2
 v_mfma_f32_16x16x32_bf16 a[224:227], a[116:119], a[12:15], a[224:227]
 buffer_load_dwordx4 v2, s[16:19], 0 offen lds
 v_mfma_f32_16x16x32_bf16 a[224:227], a[112:115], a[8:11], a[224:227]
 v_mfma_f32_16x16x32_bf16 a[236:239], a[104:107], a[8:11], a[236:239]
 v_mfma_f32_16x16x32_bf16 a[236:239], a[108:111], a[12:15], a[236:239]
 v_mfma_f32_16x16x32_bf16 a[232:235], a[100:103], a[12:15], a[232:235]
 s_add_u32 m0, s29, 4096
 v_mfma_f32_16x16x32_bf16 a[232:235], a[96:99], a[8:11], a[232:235]
 buffer_load_dwordx4 v2, s[16:19], s48 offen lds
 v_mfma_f32_16x16x32_bf16 v[32:35], a[96:99], a[16:19], v[32:35]
 v_mfma_f32_16x16x32_bf16 v[32:35], a[100:103], a[20:23], v[32:35]
 v_mfma_f32_16x16x32_bf16 v[36:39], a[108:111], a[20:23], v[36:39]
 v_mfma_f32_16x16x32_bf16 v[36:39], a[104:107], a[16:19], v[36:39]
 s_add_u32 m0, s29, 8192
 v_mfma_f32_16x16x32_bf16 v[40:43], a[112:115], a[16:19], v[40:43]
 buffer_load_dwordx4 v2, s[16:19], s49 offen lds
 v_mfma_f32_16x16x32_bf16 v[40:43], a[116:119], a[20:23], v[40:43]
 v_mfma_f32_16x16x32_bf16 v[44:47], a[124:127], a[20:23], v[44:47]
 v_mfma_f32_16x16x32_bf16 v[44:47], a[120:123], a[16:19], v[44:47]
 v_mfma_f32_16x16x32_bf16 v[52:55], a[120:123], a[24:27], v[52:55]
 s_add_u32 m0, s29, 12288
 v_mfma_f32_16x16x32_bf16 v[52:55], a[124:127], a[28:31], v[52:55]
 buffer_load_dwordx4 v2, s[16:19], s50 offen lds
 v_mfma_f32_16x16x32_bf16 v[48:51], a[116:119], a[28:31], v[48:51]
 v_mfma_f32_16x16x32_bf16 v[48:51], a[112:115], a[24:27], v[48:51]
 v_mfma_f32_16x16x32_bf16 v[60:63], a[104:107], a[24:27], v[60:63]
 v_mfma_f32_16x16x32_bf16 v[60:63], a[108:111], a[28:31], v[60:63]
 s_add_u32 m0, s29, 16384
 v_mfma_f32_16x16x32_bf16 v[56:59], a[100:103], a[28:31], v[56:59]
 buffer_load_dwordx4 v2, s[16:19], s51 offen lds
 v_mfma_f32_16x16x32_bf16 v[56:59], a[96:99], a[24:27], v[56:59]
 v_mfma_f32_16x16x32_bf16 v[192:195], a[96:99], a[32:35], v[192:195]
 v_mfma_f32_16x16x32_bf16 v[192:195], a[100:103], a[36:39], v[192:195]
 v_mfma_f32_16x16x32_bf16 v[196:199], a[108:111], a[36:39], v[196:199]
 s_add_u32 m0, s29, 20480
 v_mfma_f32_16x16x32_bf16 v[196:199], a[104:107], a[32:35], v[196:199]
 buffer_load_dwordx4 v2, s[16:19], s52 offen lds
 v_mfma_f32_16x16x32_bf16 v[200:203], a[112:115], a[32:35], v[200:203]
 v_mfma_f32_16x16x32_bf16 v[200:203], a[116:119], a[36:39], v[200:203]
 v_mfma_f32_16x16x32_bf16 v[204:207], a[124:127], a[36:39], v[204:207]
 v_mfma_f32_16x16x32_bf16 v[204:207], a[120:123], a[32:35], v[204:207]
 s_add_u32 m0, s29, 24576
 v_mfma_f32_16x16x32_bf16 v[212:215], a[120:123], a[40:43], v[212:215]
 buffer_load_dwordx4 v2, s[16:19], s53 offen lds
 v_mfma_f32_16x16x32_bf16 v[212:215], a[124:127], a[44:47], v[212:215]
 v_mfma_f32_16x16x32_bf16 v[208:211], a[116:119], a[44:47], v[208:211]
 v_mfma_f32_16x16x32_bf16 v[208:211], a[112:115], a[40:43], v[208:211]
 v_mfma_f32_16x16x32_bf16 v[220:223], a[104:107], a[40:43], v[220:223]
 s_add_u32 m0, s29, 28672
 v_mfma_f32_16x16x32_bf16 v[220:223], a[108:111], a[44:47], v[220:223]
 buffer_load_dwordx4 v2, s[16:19], s54 offen lds
 v_mfma_f32_16x16x32_bf16 v[216:219], a[100:103], a[44:47], v[216:219]
 v_mfma_f32_16x16x32_bf16 v[216:219], a[96:99], a[40:43], v[216:219]
 v_mfma_f32_16x16x32_bf16 v[224:227], a[96:99], a[48:51], v[224:227]
 s_add_u32 m0, s29, 65536
 v_add_u32 v2, 0x80000, v2
 v_mfma_f32_16x16x32_bf16 v[224:227], a[100:103], a[52:55], v[224:227]
 buffer_load_dwordx4 v2, s[16:19], 0 offen lds
 v_mfma_f32_16x16x32_bf16 v[228:231], a[108:111], a[52:55], v[228:231]
 v_mfma_f32_16x16x32_bf16 v[228:231], a[104:107], a[48:51], v[228:231]
 v_mfma_f32_16x16x32_bf16 v[232:235], a[112:115], a[48:51], v[232:235]
 v_mfma_f32_16x16x32_bf16 v[232:235], a[116:119], a[52:55], v[232:235]
 s_add_u32 m0, s29, 69632
 v_mfma_f32_16x16x32_bf16 v[236:239], a[124:127], a[52:55], v[236:239]
 buffer_load_dwordx4 v2, s[16:19], s48 offen lds
 v_mfma_f32_16x16x32_bf16 v[236:239], a[120:123], a[48:51], v[236:239]
 v_mfma_f32_16x16x32_bf16 v[244:247], a[120:123], a[56:59], v[244:247]
 v_mfma_f32_16x16x32_bf16 v[244:247], a[124:127], a[60:63], v[244:247]
 v_mfma_f32_16x16x32_bf16 v[240:243], a[116:119], a[60:63], v[240:243]
 s_add_u32 m0, s29, 73728
 v_mfma_f32_16x16x32_bf16 v[240:243], a[112:115], a[56:59], v[240:243]
 buffer_load_dwordx4 v2, s[16:19], s49 offen lds
 v_mfma_f32_16x16x32_bf16 v[252:255], a[104:107], a[56:59], v[252:255]
 s_waitcnt vmcnt(11)
 v_mfma_f32_16x16x32_bf16 v[252:255], a[108:111], a[60:63], v[252:255]
 s_barrier
 ds_read_b64_tr_b16 a[0:1], v6 offset:32768
 v_mfma_f32_16x16x32_bf16 v[248:251], a[100:103], a[60:63], v[248:251]
 ds_read_b64_tr_b16 a[2:3], v6 offset:36864
 v_mfma_f32_16x16x32_bf16 v[248:251], a[96:99], a[56:59], v[248:251]
 s_add_u32 m0, s29, 77824
 ds_read_b128 a[96:99], v4 offset:40960
 v_mfma_f32_16x16x32_bf16 v[128:131], a[64:67], a[32:35], v[128:131]
 ds_read_b128 a[192:195], v14 offset:0
 buffer_load_dwordx4 v2, s[16:19], s50 offen lds
 v_mfma_f32_16x16x32_bf16 v[128:131], a[68:71], a[36:39], v[128:131]
 ds_read_b128 a[200:203], v3 offset:0
 v_mfma_f32_16x16x32_bf16 v[132:135], a[76:79], a[36:39], v[132:135]
 s_mov_b32 s56, s58
 ds_read_b64_tr_b16 a[4:5], v6 offset:49152
 v_mfma_f32_16x16x32_bf16 v[132:135], a[72:75], a[32:35], v[132:135]
 ds_read_b64_tr_b16 a[6:7], v6 offset:53248
 v_mfma_f32_16x16x32_bf16 v[136:139], a[80:83], a[32:35], v[136:139]
 s_add_u32 m0, s29, 81920
 ds_read_b128 a[100:103], v5 offset:40960
 v_mfma_f32_16x16x32_bf16 v[136:139], a[84:87], a[36:39], v[136:139]
 ds_read_b128 a[196:199], v14 offset:2048
 buffer_load_dwordx4 v2, s[16:19], s51 offen lds
 v_mfma_f32_16x16x32_bf16 v[140:143], a[92:95], a[36:39], v[140:143]
 ds_read_b128 a[204:207], v3 offset:2048
 v_mfma_f32_16x16x32_bf16 v[140:143], a[88:91], a[32:35], v[140:143]
 ds_read_b128 a[108:111], v5 offset:43008
 v_mfma_f32_16x16x32_bf16 v[148:151], a[88:91], a[40:43], v[148:151]
 ds_read_b128 a[208:211], v14 offset:4096
 v_mfma_f32_16x16x32_bf16 v[148:151], a[92:95], a[44:47], v[148:151]
 s_add_u32 m0, s29, 86016
 ds_read_b128 a[104:107], v4 offset:43008
 v_mfma_f32_16x16x32_bf16 v[144:147], a[84:87], a[44:47], v[144:147]
 ds_read_b128 a[216:219], v3 offset:4096
 buffer_load_dwordx4 v2, s[16:19], s52 offen lds
 v_mfma_f32_16x16x32_bf16 v[144:147], a[80:83], a[40:43], v[144:147]
 ds_read_b128 a[212:215], v14 offset:6144
 v_mfma_f32_16x16x32_bf16 v[156:159], a[72:75], a[40:43], v[156:159]
 s_cmp_lt_u32 s25, 4
 s_cselect_b32 s1, 2.0, s92
 ds_read_b128 a[112:115], v4 offset:45056
 v_mfma_f32_16x16x32_bf16 v[156:159], a[76:79], a[44:47], v[156:159]
 ds_read_b128 a[220:223], v3 offset:6144
 v_mfma_f32_16x16x32_bf16 v[152:155], a[68:71], a[44:47], v[152:155]
 s_add_u32 m0, s29, 90112
 ds_read_b128 a[116:119], v5 offset:45056
 v_mfma_f32_16x16x32_bf16 v[152:155], a[64:67], a[40:43], v[152:155]
 buffer_load_dwordx4 v2, s[16:19], s53 offen lds
 v_mfma_f32_16x16x32_bf16 v[160:163], a[64:67], a[48:51], v[160:163]
 v_mfma_f32_16x16x32_bf16 v[160:163], a[68:71], a[52:55], v[160:163]
 ds_read_b128 a[124:127], v5 offset:47104
 v_mfma_f32_16x16x32_bf16 v[164:167], a[76:79], a[52:55], v[164:167]
 v_mfma_f32_16x16x32_bf16 v[164:167], a[72:75], a[48:51], v[164:167]
 s_add_u32 m0, s29, 94208
 ds_read_b128 a[120:123], v4 offset:47104
 v_mfma_f32_16x16x32_bf16 v[168:171], a[80:83], a[48:51], v[168:171]
 buffer_load_dwordx4 v2, s[16:19], s54 offen lds
 v_mfma_f32_16x16x32_bf16 v[168:171], a[84:87], a[52:55], v[168:171]
 v_mfma_f32_16x16x32_bf16 v[172:175], a[92:95], a[52:55], v[172:175]
 v_mfma_f32_16x16x32_bf16 v[172:175], a[88:91], a[48:51], v[172:175]
 ds_read_b64_tr_b16 a[8:9], v7 offset:32768
 v_mfma_f32_16x16x32_bf16 v[180:183], a[88:91], a[56:59], v[180:183]
 v_mfma_f32_16x16x32_bf16 v[180:183], a[92:95], a[60:63], v[180:183]
 ds_read_b64_tr_b16 a[10:11], v7 offset:36864
 v_mfma_f32_16x16x32_bf16 v[176:179], a[84:87], a[60:63], v[176:179]
 ds_read_b64_tr_b16 a[12:13], v7 offset:49152
 v_mfma_f32_16x16x32_bf16 v[176:179], a[80:83], a[56:59], v[176:179]
 ds_read_b64_tr_b16 a[14:15], v7 offset:53248
 v_mfma_f32_16x16x32_bf16 v[188:191], a[72:75], a[56:59], v[188:191]
 ds_read_b64_tr_b16 a[16:17], v8 offset:32768
 v_mfma_f32_16x16x32_bf16 v[188:191], a[76:79], a[60:63], v[188:191]
 ds_read_b64_tr_b16 a[18:19], v8 offset:36864
 v_mfma_f32_16x16x32_bf16 v[184:187], a[68:71], a[60:63], v[184:187]
 ds_read_b64_tr_b16 a[20:21], v8 offset:49152
 v_mfma_f32_16x16x32_bf16 v[184:187], a[64:67], a[56:59], v[184:187]
 s_waitcnt lgkmcnt(15)
 ds_read_b64_tr_b16 a[22:23], v8 offset:53248
 s_cmp_ge_u32 s25, 4
 s_cbranch_scc1 L_late1
 v_mfma_f32_16x16x32_bf16 v[16:19], a[96:99], a[0:3], v[16:19]
 ds_read_b64_tr_b16 a[24:25], v9 offset:32768
 v_mfma_f32_16x16x32_bf16 v[16:19], a[100:103], a[4:7], v[16:19]
 s_add_u32 m0, s33, 0xfffffd00
 ds_read_b64_tr_b16 a[26:27], v9 offset:36864
 v_mfma_f32_16x16x32_bf16 v[20:23], a[108:111], a[4:7], v[20:23]
 s_waitcnt lgkmcnt(13)
 ds_read_b64_tr_b16 a[28:29], v9 offset:49152
 v_mfma_f32_16x16x32_bf16 v[20:23], a[104:107], a[0:3], v[20:23]
 ds_read_b64_tr_b16 a[30:31], v9 offset:53248
 buffer_load_dwordx4 v15, s[20:23], 0 offen offset:768 lds
 v_mfma_f32_16x16x32_bf16 v[24:27], a[112:115], a[0:3], v[24:27]
 s_waitcnt lgkmcnt(12)
 ds_read_b128 a[64:67], v4 offset:32768
 v_mfma_f32_16x16x32_bf16 v[24:27], a[116:119], a[4:7], v[24:27]
 v_mfma_f32_16x16x32_bf16 v[28:31], a[124:127], a[4:7], v[28:31]
 s_add_u32 m0, s33, 0xfffffd80
 ds_read_b128 a[68:71], v5 offset:32768
 v_mfma_f32_16x16x32_bf16 v[28:31], a[120:123], a[0:3], v[28:31]
 s_waitcnt lgkmcnt(10)
 buffer_load_dwordx4 v15, s[20:23], 0 offen offset:1664 lds
 v_mfma_f32_16x16x32_bf16 a[228:231], a[120:123], a[8:11], a[228:231]
 ds_read_b128 a[76:79], v5 offset:34816
 v_mfma_f32_16x16x32_bf16 a[228:231], a[124:127], a[12:15], a[228:231]
 v_mfma_f32_16x16x32_bf16 a[224:227], a[116:119], a[12:15], a[224:227]
 s_add_u32 m0, s33, 0x500
 ds_read_b128 a[72:75], v4 offset:34816
 v_mfma_f32_16x16x32_bf16 a[224:227], a[112:115], a[8:11], a[224:227]
 buffer_load_dwordx4 v15, s[20:23], s57 offen offset:768 lds
 v_mfma_f32_16x16x32_bf16 a[236:239], a[104:107], a[8:11], a[236:239]
 ds_read_b128 a[80:83], v4 offset:36864
 v_cvt_pk_bf16_f32 v16, v16, v17
 v_mfma_f32_16x16x32_bf16 a[236:239], a[108:111], a[12:15], a[236:239]
 v_cvt_pk_bf16_f32 v17, v18, v19
 v_cvt_pk_bf16_f32 v18, v20, v21
 v_mfma_f32_16x16x32_bf16 a[232:235], a[100:103], a[12:15], a[232:235]
 s_add_u32 m0, s33, 0x580
 ds_read_b128 a[84:87], v5 offset:36864
 v_cvt_pk_bf16_f32 v19, v22, v23
 v_mfma_f32_16x16x32_bf16 a[232:235], a[96:99], a[8:11], a[232:235]
 s_waitcnt lgkmcnt(10)
 buffer_load_dwordx4 v15, s[20:23], s57 offen offset:1664 lds
 v_mfma_f32_16x16x32_bf16 v[32:35], a[96:99], a[16:19], v[32:35]
 ds_read_b128 a[92:95], v5 offset:38912
 v_cvt_pk_bf16_f32 v24, v24, v25
 v_mfma_f32_16x16x32_bf16 v[32:35], a[100:103], a[20:23], v[32:35]
 v_cvt_pk_bf16_f32 v25, v26, v27
 v_cvt_pk_bf16_f32 v26, v28, v29
 v_mfma_f32_16x16x32_bf16 v[36:39], a[108:111], a[20:23], v[36:39]
 ds_read_b128 a[88:91], v4 offset:38912
 v_cvt_pk_bf16_f32 v27, v30, v31
 v_mfma_f32_16x16x32_bf16 v[36:39], a[104:107], a[16:19], v[36:39]
 v_accvgpr_read_b32 v20, a224
 v_accvgpr_read_b32 v21, a225
 v_mfma_f32_16x16x32_bf16 v[40:43], a[112:115], a[16:19], v[40:43]
 ds_read_b64_tr_b16 a[32:33], v10 offset:32768
 v_accvgpr_read_b32 v22, a226
 v_mfma_f32_16x16x32_bf16 v[40:43], a[116:119], a[20:23], v[40:43]
 ds_read_b64_tr_b16 a[34:35], v10 offset:36864
 v_accvgpr_read_b32 v23, a227
 v_mfma_f32_16x16x32_bf16 v[44:47], a[124:127], a[20:23], v[44:47]
 s_add_u32 s59, s56, 32768
 ds_read_b64_tr_b16 a[36:37], v10 offset:49152
 v_accvgpr_read_b32 v28, a228
 v_mfma_f32_16x16x32_bf16 v[44:47], a[120:123], a[16:19], v[44:47]
 s_waitcnt lgkmcnt(11)
 ds_read_b64_tr_b16 a[38:39], v10 offset:53248
 v_accvgpr_read_b32 v29, a229
 v_mfma_f32_16x16x32_bf16 v[52:55], a[120:123], a[24:27], v[52:55]
 ds_read_b64_tr_b16 a[40:41], v11 offset:32768
 buffer_store_dwordx4 v[16:19], v1, s[12:15], s59 offen offset:0 sc1
 v_mfma_f32_16x16x32_bf16 v[52:55], a[124:127], a[28:31], v[52:55]
 ds_read_b64_tr_b16 a[42:43], v11 offset:36864
 v_accvgpr_read_b32 v30, a230
 v_mfma_f32_16x16x32_bf16 v[48:51], a[116:119], a[28:31], v[48:51]
 ds_read_b64_tr_b16 a[44:45], v11 offset:49152
 v_accvgpr_read_b32 v31, a231
 v_mfma_f32_16x16x32_bf16 v[48:51], a[112:115], a[24:27], v[48:51]
 ds_read_b64_tr_b16 a[46:47], v11 offset:53248
 v_cvt_pk_bf16_f32 v20, v20, v21
 v_mfma_f32_16x16x32_bf16 v[60:63], a[104:107], a[24:27], v[60:63]
 ds_read_b64_tr_b16 a[48:49], v12 offset:32768
 v_cvt_pk_bf16_f32 v21, v22, v23
 v_mfma_f32_16x16x32_bf16 v[60:63], a[108:111], a[28:31], v[60:63]
 ds_read_b64_tr_b16 a[50:51], v12 offset:36864
 v_cvt_pk_bf16_f32 v22, v28, v29
 v_mfma_f32_16x16x32_bf16 v[56:59], a[100:103], a[28:31], v[56:59]
 s_add_u32 s59, s56, 49152
 ds_read_b64_tr_b16 a[52:53], v12 offset:49152
 v_cvt_pk_bf16_f32 v23, v30, v31
 v_mfma_f32_16x16x32_bf16 v[56:59], a[96:99], a[24:27], v[56:59]
 s_waitcnt lgkmcnt(15)
 ds_read_b64_tr_b16 a[54:55], v12 offset:53248
 buffer_store_dwordx4 v[24:27], v1, s[12:15], s59 offen offset:0 sc1
 v_mfma_f32_16x16x32_bf16 v[64:67], a[64:67], a[0:3], v[64:67]
 ds_read_b64_tr_b16 a[56:57], v13 offset:32768
 v_cvt_pk_bf16_f32 v32, v32, v33
 v_mfma_f32_16x16x32_bf16 v[64:67], a[68:71], a[4:7], v[64:67]
 ds_read_b64_tr_b16 a[58:59], v13 offset:36864
 v_cvt_pk_bf16_f32 v33, v34, v35
 v_mfma_f32_16x16x32_bf16 v[68:71], a[76:79], a[4:7], v[68:71]
 ds_read_b64_tr_b16 a[60:61], v13 offset:49152
 v_cvt_pk_bf16_f32 v34, v36, v37
 v_mfma_f32_16x16x32_bf16 v[68:71], a[72:75], a[0:3], v[68:71]
 s_waitcnt lgkmcnt(15)
 ds_read_b64_tr_b16 a[62:63], v13 offset:53248
 v_cvt_pk_bf16_f32 v35, v38, v39
 v_mfma_f32_16x16x32_bf16 v[72:75], a[80:83], a[0:3], v[72:75]
 v_cvt_pk_bf16_f32 v40, v40, v41
 v_cvt_pk_bf16_f32 v41, v42, v43
 v_mfma_f32_16x16x32_bf16 v[72:75], a[84:87], a[4:7], v[72:75]
 s_add_u32 s59, s56, 49152
 v_cvt_pk_bf16_f32 v42, v44, v45
 v_cvt_pk_bf16_f32 v43, v46, v47
 v_mfma_f32_16x16x32_bf16 v[76:79], a[92:95], a[4:7], v[76:79]
 buffer_store_dwordx4 v[20:23], v1, s[12:15], s59 offen offset:1024 sc1
 v_mfma_f32_16x16x32_bf16 v[76:79], a[88:91], a[0:3], v[76:79]
 s_waitcnt lgkmcnt(0)
 v_accvgpr_read_b32 v36, a232
 v_accvgpr_read_b32 v37, a233
 v_mfma_f32_16x16x32_bf16 v[84:87], a[88:91], a[8:11], v[84:87]
 s_barrier
 v_xor_b32 v6, s60, v6
 v_accvgpr_read_b32 v38, a234
 v_mfma_f32_16x16x32_bf16 v[84:87], a[92:95], a[12:15], v[84:87]
 s_add_u32 m0, s29, 32768
 v_add_u32 v2, 0x80000, v2
 v_accvgpr_read_b32 v39, a235
 v_mfma_f32_16x16x32_bf16 v[80:83], a[84:87], a[12:15], v[80:83]
 buffer_load_dwordx4 v2, s[16:19], 0 offen lds
 v_mfma_f32_16x16x32_bf16 v[80:83], a[80:83], a[8:11], v[80:83]
 v_accvgpr_read_b32 v44, a236
 v_accvgpr_read_b32 v45, a237
 v_mfma_f32_16x16x32_bf16 v[92:95], a[72:75], a[8:11], v[92:95]
 s_add_u32 s59, s56, 32768
 v_accvgpr_read_b32 v46, a238
 v_accvgpr_read_b32 v47, a239
 v_mfma_f32_16x16x32_bf16 v[92:95], a[76:79], a[12:15], v[92:95]
 buffer_store_dwordx4 v[32:35], v1, s[12:15], s59 offen offset:2048 sc1
 v_mfma_f32_16x16x32_bf16 v[88:91], a[68:71], a[12:15], v[88:91]
 s_add_u32 m0, s29, 36864
 v_cvt_pk_bf16_f32 v36, v36, v37
 v_cvt_pk_bf16_f32 v37, v38, v39
 v_mfma_f32_16x16x32_bf16 v[88:91], a[64:67], a[8:11], v[88:91]
 buffer_load_dwordx4 v2, s[16:19], s48 offen lds
 v_mfma_f32_16x16x32_bf16 v[96:99], a[64:67], a[16:19], v[96:99]
 v_cvt_pk_bf16_f32 v38, v44, v45
 v_cvt_pk_bf16_f32 v39, v46, v47
 v_mfma_f32_16x16x32_bf16 v[96:99], a[68:71], a[20:23], v[96:99]
 v_cvt_pk_bf16_f32 v48, v48, v49
 v_cvt_pk_bf16_f32 v49, v50, v51
 v_mfma_f32_16x16x32_bf16 v[100:103], a[76:79], a[20:23], v[100:103]
 v_cvt_pk_bf16_f32 v50, v52, v53
 v_cvt_pk_bf16_f32 v51, v54, v55
 v_mfma_f32_16x16x32_bf16 v[100:103], a[72:75], a[16:19], v[100:103]
 s_add_u32 m0, s29, 40960
 v_cvt_pk_bf16_f32 v56, v56, v57
 v_cvt_pk_bf16_f32 v57, v58, v59
 v_mfma_f32_16x16x32_bf16 v[104:107], a[80:83], a[16:19], v[104:107]
 buffer_load_dwordx4 v2, s[16:19], s49 offen lds
 v_mfma_f32_16x16x32_bf16 v[104:107], a[84:87], a[20:23], v[104:107]
 s_add_u32 s59, s56, 49152
 v_cvt_pk_bf16_f32 v58, v60, v61
 v_cvt_pk_bf16_f32 v59, v62, v63
 v_mfma_f32_16x16x32_bf16 v[108:111], a[92:95], a[20:23], v[108:111]
 buffer_store_dwordx4 v[40:43], v1, s[12:15], s59 offen offset:2048 sc1
 v_mfma_f32_16x16x32_bf16 v[108:111], a[88:91], a[16:19], v[108:111]
 v_cvt_pk_bf16_f32 v64, v64, v65
 v_cvt_pk_bf16_f32 v65, v66, v67
 v_mfma_f32_16x16x32_bf16 v[116:119], a[88:91], a[24:27], v[116:119]
 s_add_u32 m0, s29, 45056
 v_cvt_pk_bf16_f32 v66, v68, v69
 v_cvt_pk_bf16_f32 v67, v70, v71
 v_mfma_f32_16x16x32_bf16 v[116:119], a[92:95], a[28:31], v[116:119]
 buffer_load_dwordx4 v2, s[16:19], s50 offen lds
 v_mfma_f32_16x16x32_bf16 v[112:115], a[84:87], a[28:31], v[112:115]
 v_cvt_pk_bf16_f32 v72, v72, v73
 v_cvt_pk_bf16_f32 v73, v74, v75
 v_mfma_f32_16x16x32_bf16 v[112:115], a[80:83], a[24:27], v[112:115]
 v_cvt_pk_bf16_f32 v74, v76, v77
 v_cvt_pk_bf16_f32 v75, v78, v79
 v_mfma_f32_16x16x32_bf16 v[124:127], a[72:75], a[24:27], v[124:127]
 v_cvt_pk_bf16_f32 v80, v80, v81
 v_cvt_pk_bf16_f32 v81, v82, v83
 v_mfma_f32_16x16x32_bf16 v[124:127], a[76:79], a[28:31], v[124:127]
 s_add_u32 m0, s29, 49152
 v_cvt_pk_bf16_f32 v82, v84, v85
 v_cvt_pk_bf16_f32 v83, v86, v87
 v_mfma_f32_16x16x32_bf16 v[120:123], a[68:71], a[28:31], v[120:123]
 buffer_load_dwordx4 v2, s[16:19], s51 offen lds
 v_mfma_f32_16x16x32_bf16 v[120:123], a[64:67], a[24:27], v[120:123]
 s_add_u32 s59, s56, 32768
 v_cvt_pk_bf16_f32 v88, v88, v89
 v_cvt_pk_bf16_f32 v89, v90, v91
 v_mfma_f32_16x16x32_bf16 v[128:131], a[64:67], a[32:35], v[128:131]
 buffer_store_dwordx4 v[36:39], v1, s[12:15], s59 offen offset:1024 sc1
 v_mfma_f32_16x16x32_bf16 v[128:131], a[68:71], a[36:39], v[128:131]
 v_cvt_pk_bf16_f32 v90, v92, v93
 v_cvt_pk_bf16_f32 v91, v94, v95
 v_mfma_f32_16x16x32_bf16 v[132:135], a[76:79], a[36:39], v[132:135]
 s_add_u32 m0, s29, 53248
 v_cvt_pk_bf16_f32 v96, v96, v97
 v_cvt_pk_bf16_f32 v97, v98, v99
 v_mfma_f32_16x16x32_bf16 v[132:135], a[72:75], a[32:35], v[132:135]
 buffer_load_dwordx4 v2, s[16:19], s52 offen lds
 v_mfma_f32_16x16x32_bf16 v[136:139], a[80:83], a[32:35], v[136:139]
 v_cvt_pk_bf16_f32 v98, v100, v101
 v_cvt_pk_bf16_f32 v99, v102, v103
 v_mfma_f32_16x16x32_bf16 v[136:139], a[84:87], a[36:39], v[136:139]
 v_cvt_pk_bf16_f32 v104, v104, v105
 v_cvt_pk_bf16_f32 v105, v106, v107
 v_mfma_f32_16x16x32_bf16 v[140:143], a[92:95], a[36:39], v[140:143]
 v_cvt_pk_bf16_f32 v106, v108, v109
 v_cvt_pk_bf16_f32 v107, v110, v111
 v_mfma_f32_16x16x32_bf16 v[140:143], a[88:91], a[32:35], v[140:143]
 s_add_u32 m0, s29, 57344
 v_cvt_pk_bf16_f32 v112, v112, v113
 v_cvt_pk_bf16_f32 v113, v114, v115
 v_mfma_f32_16x16x32_bf16 v[148:151], a[88:91], a[40:43], v[148:151]
 buffer_load_dwordx4 v2, s[16:19], s53 offen lds
 v_mfma_f32_16x16x32_bf16 v[148:151], a[92:95], a[44:47], v[148:151]
 s_add_u32 s59, s56, 49152
 v_cvt_pk_bf16_f32 v114, v116, v117
 v_cvt_pk_bf16_f32 v115, v118, v119
 v_mfma_f32_16x16x32_bf16 v[144:147], a[84:87], a[44:47], v[144:147]
 buffer_store_dwordx4 v[48:51], v1, s[12:15], s59 offen offset:3072 sc1
 v_mfma_f32_16x16x32_bf16 v[144:147], a[80:83], a[40:43], v[144:147]
 v_cvt_pk_bf16_f32 v120, v120, v121
 v_cvt_pk_bf16_f32 v121, v122, v123
 v_mfma_f32_16x16x32_bf16 v[156:159], a[72:75], a[40:43], v[156:159]
 s_add_u32 m0, s29, 61440
 v_cvt_pk_bf16_f32 v122, v124, v125
 v_cvt_pk_bf16_f32 v123, v126, v127
 v_mfma_f32_16x16x32_bf16 v[156:159], a[76:79], a[44:47], v[156:159]
 buffer_load_dwordx4 v2, s[16:19], s54 offen lds
 v_mfma_f32_16x16x32_bf16 v[152:155], a[68:71], a[44:47], v[152:155]
 v_cvt_pk_bf16_f32 v128, v128, v129
 v_cvt_pk_bf16_f32 v129, v130, v131
 v_mfma_f32_16x16x32_bf16 v[152:155], a[64:67], a[40:43], v[152:155]
 v_cvt_pk_bf16_f32 v130, v132, v133
 v_cvt_pk_bf16_f32 v131, v134, v135
 v_mfma_f32_16x16x32_bf16 v[160:163], a[64:67], a[48:51], v[160:163]
 s_add_u32 m0, s29, 98304
 v_add_u32 v2, 0x80000, v2
 v_cvt_pk_bf16_f32 v136, v136, v137
 v_mfma_f32_16x16x32_bf16 v[160:163], a[68:71], a[52:55], v[160:163]
 buffer_load_dwordx4 v2, s[16:19], 0 offen lds
 v_mfma_f32_16x16x32_bf16 v[164:167], a[76:79], a[52:55], v[164:167]
 s_add_u32 s59, s56, 32768
 v_cvt_pk_bf16_f32 v137, v138, v139
 v_cvt_pk_bf16_f32 v138, v140, v141
 v_mfma_f32_16x16x32_bf16 v[164:167], a[72:75], a[48:51], v[164:167]
 buffer_store_dwordx4 v[56:59], v1, s[12:15], s59 offen offset:3072 sc1
 v_mfma_f32_16x16x32_bf16 v[168:171], a[80:83], a[48:51], v[168:171]
 v_cvt_pk_bf16_f32 v139, v142, v143
 v_cvt_pk_bf16_f32 v144, v144, v145
 v_mfma_f32_16x16x32_bf16 v[168:171], a[84:87], a[52:55], v[168:171]
 s_add_u32 m0, s29, 102400
 v_cvt_pk_bf16_f32 v145, v146, v147
 v_cvt_pk_bf16_f32 v146, v148, v149
 v_mfma_f32_16x16x32_bf16 v[172:175], a[92:95], a[52:55], v[172:175]
 buffer_load_dwordx4 v2, s[16:19], s48 offen lds
 v_mfma_f32_16x16x32_bf16 v[172:175], a[88:91], a[48:51], v[172:175]
 v_cvt_pk_bf16_f32 v147, v150, v151
 v_cvt_pk_bf16_f32 v152, v152, v153
 v_mfma_f32_16x16x32_bf16 v[180:183], a[88:91], a[56:59], v[180:183]
 v_cvt_pk_bf16_f32 v153, v154, v155
 v_cvt_pk_bf16_f32 v154, v156, v157
 v_mfma_f32_16x16x32_bf16 v[180:183], a[92:95], a[60:63], v[180:183]
 v_cvt_pk_bf16_f32 v155, v158, v159
 v_mfma_f32_16x16x32_bf16 v[176:179], a[84:87], a[60:63], v[176:179]
 s_add_u32 m0, s29, 106496
 v_mfma_f32_16x16x32_bf16 v[176:179], a[80:83], a[56:59], v[176:179]
 buffer_load_dwordx4 v2, s[16:19], s49 offen lds
 v_mfma_f32_16x16x32_bf16 v[188:191], a[72:75], a[56:59], v[188:191]
 s_add_u32 s59, s56, 0
 v_cvt_pk_bf16_f32 v160, v160, v161
 v_cvt_pk_bf16_f32 v161, v162, v163
 v_mfma_f32_16x16x32_bf16 v[188:191], a[76:79], a[60:63], v[188:191]
 buffer_store_dwordx4 v[64:67], v1, s[12:15], s59 offen offset:0 sc1
 v_mfma_f32_16x16x32_bf16 v[184:187], a[68:71], a[60:63], v[184:187]
 v_cvt_pk_bf16_f32 v162, v164, v165
 v_cvt_pk_bf16_f32 v163, v166, v167
 v_mfma_f32_16x16x32_bf16 v[184:187], a[64:67], a[56:59], v[184:187]
 s_add_u32 m0, s29, 110592
 v_cvt_pk_bf16_f32 v168, v168, v169
 v_cvt_pk_bf16_f32 v169, v170, v171
 v_mfma_f32_16x16x32_bf16 v[192:195], a[96:99], a[32:35], v[192:195]
 buffer_load_dwordx4 v2, s[16:19], s50 offen lds
 v_mfma_f32_16x16x32_bf16 v[192:195], a[100:103], a[36:39], v[192:195]
 v_cvt_pk_bf16_f32 v170, v172, v173
 v_cvt_pk_bf16_f32 v171, v174, v175
 v_mfma_f32_16x16x32_bf16 v[196:199], a[108:111], a[36:39], v[196:199]
 v_mfma_f32_16x16x32_bf16 v[196:199], a[104:107], a[32:35], v[196:199]
 v_cvt_pk_bf16_f32 v176, v176, v177
 v_cvt_pk_bf16_f32 v177, v178, v179
 v_mfma_f32_16x16x32_bf16 v[200:203], a[112:115], a[32:35], v[200:203]
 s_add_u32 m0, s29, 114688
 v_cvt_pk_bf16_f32 v178, v180, v181
 v_cvt_pk_bf16_f32 v179, v182, v183
 v_mfma_f32_16x16x32_bf16 v[200:203], a[116:119], a[36:39], v[200:203]
 buffer_load_dwordx4 v2, s[16:19], s51 offen lds
 v_mfma_f32_16x16x32_bf16 v[204:207], a[124:127], a[36:39], v[204:207]
 s_add_u32 s59, s56, 16384
 v_mfma_f32_16x16x32_bf16 v[204:207], a[120:123], a[32:35], v[204:207]
 buffer_store_dwordx4 v[72:75], v1, s[12:15], s59 offen offset:0 sc1
 v_mfma_f32_16x16x32_bf16 v[212:215], a[120:123], a[40:43], v[212:215]
 v_cvt_pk_bf16_f32 v184, v184, v185
 v_cvt_pk_bf16_f32 v185, v186, v187
 v_mfma_f32_16x16x32_bf16 v[212:215], a[124:127], a[44:47], v[212:215]
 s_add_u32 m0, s29, 118784
 v_cvt_pk_bf16_f32 v186, v188, v189
 v_cvt_pk_bf16_f32 v187, v190, v191
 v_mfma_f32_16x16x32_bf16 v[208:211], a[116:119], a[44:47], v[208:211]
 buffer_load_dwordx4 v2, s[16:19], s52 offen lds
 v_mfma_f32_16x16x32_bf16 v[208:211], a[112:115], a[40:43], v[208:211]
 v_cvt_pk_bf16_f32 v192, v192, v193
 v_cvt_pk_bf16_f32 v193, v194, v195
 v_mfma_f32_16x16x32_bf16 v[220:223], a[104:107], a[40:43], v[220:223]
 v_cvt_pk_bf16_f32 v194, v196, v197
 v_cvt_pk_bf16_f32 v195, v198, v199
 v_mfma_f32_16x16x32_bf16 v[220:223], a[108:111], a[44:47], v[220:223]
 v_mfma_f32_16x16x32_bf16 v[216:219], a[100:103], a[44:47], v[216:219]
 s_add_u32 m0, s29, 122880
 v_mfma_f32_16x16x32_bf16 v[216:219], a[96:99], a[40:43], v[216:219]
 buffer_load_dwordx4 v2, s[16:19], s53 offen lds
 v_mfma_f32_16x16x32_bf16 v[224:227], a[96:99], a[48:51], v[224:227]
 s_add_u32 s59, s56, 16384
 v_cvt_pk_bf16_f32 v200, v200, v201
 v_cvt_pk_bf16_f32 v201, v202, v203
 v_mfma_f32_16x16x32_bf16 v[224:227], a[100:103], a[52:55], v[224:227]
 s_waitcnt vmcnt(25)
 buffer_store_dwordx4 v[80:83], v1, s[12:15], s59 offen offset:1024 sc1
 v_mfma_f32_16x16x32_bf16 v[228:231], a[108:111], a[52:55], v[228:231]
 s_barrier
 v_xor_b32 v7, 0, v6
 v_cvt_pk_bf16_f32 v202, v204, v205
 v_mfma_f32_16x16x32_bf16 v[228:231], a[104:107], a[48:51], v[228:231]
 s_add_u32 m0, s29, 126976
 ds_read_b64_tr_b16 a[64:65], v7 offset:0
 v_cvt_pk_bf16_f32 v203, v206, v207
 v_mfma_f32_16x16x32_bf16 v[232:235], a[112:115], a[48:51], v[232:235]
 ds_read_b64_tr_b16 a[66:67], v7 offset:4096
 buffer_load_dwordx4 v2, s[16:19], s54 offen lds
 v_mfma_f32_16x16x32_bf16 v[232:235], a[116:119], a[52:55], v[232:235]
 ds_read_b64_tr_b16 a[68:69], v7 offset:16384
 v_cvt_pk_bf16_f32 v208, v208, v209
 v_mfma_f32_16x16x32_bf16 v[236:239], a[124:127], a[52:55], v[236:239]
 ds_read_b64_tr_b16 a[70:71], v7 offset:20480
 v_xor_b32 v8, 65536, v6
 v_mfma_f32_16x16x32_bf16 v[236:239], a[120:123], a[48:51], v[236:239]
 s_add_u32 s59, s56, 0
 ds_read_b64_tr_b16 a[72:73], v8 offset:0
 v_cvt_pk_bf16_f32 v209, v210, v211
 v_mfma_f32_16x16x32_bf16 v[244:247], a[120:123], a[56:59], v[244:247]
 ds_read_b64_tr_b16 a[74:75], v8 offset:4096
 buffer_store_dwordx4 v[88:91], v1, s[12:15], s59 offen offset:1024 sc1
 v_mfma_f32_16x16x32_bf16 v[244:247], a[124:127], a[60:63], v[244:247]
 ds_read_b64_tr_b16 a[76:77], v8 offset:16384
 v_cvt_pk_bf16_f32 v210, v212, v213
 v_mfma_f32_16x16x32_bf16 v[240:243], a[116:119], a[60:63], v[240:243]
 ds_read_b64_tr_b16 a[78:79], v8 offset:20480
 v_xor_b32 v9, 32, v6
 v_mfma_f32_16x16x32_bf16 v[240:243], a[112:115], a[56:59], v[240:243]
 ds_read_b64_tr_b16 a[80:81], v9 offset:0
 v_cvt_pk_bf16_f32 v211, v214, v215
 v_mfma_f32_16x16x32_bf16 v[252:255], a[104:107], a[56:59], v[252:255]
 ds_read_b64_tr_b16 a[82:83], v9 offset:4096
 v_cvt_pk_bf16_f32 v216, v216, v217
 v_mfma_f32_16x16x32_bf16 v[252:255], a[108:111], a[60:63], v[252:255]
 ds_read_b64_tr_b16 a[84:85], v9 offset:16384
 v_cvt_pk_bf16_f32 v217, v218, v219
 v_mfma_f32_16x16x32_bf16 v[248:251], a[100:103], a[60:63], v[248:251]
 s_add_u32 s59, s56, 0
 ds_read_b64_tr_b16 a[86:87], v9 offset:20480
 v_xor_b32 v10, 65568, v6
 v_mfma_f32_16x16x32_bf16 v[248:251], a[96:99], a[56:59], v[248:251]
 s_waitcnt lgkmcnt(6)
 ds_read_b64_tr_b16 a[88:89], v10 offset:0
 buffer_store_dwordx4 v[96:99], v1, s[12:15], s59 offen offset:2048 sc1
 v_mfma_f32_16x16x32_bf16 v[28:31], a[64:67], a[128:131], 0
 ds_read_b64_tr_b16 a[90:91], v10 offset:4096
 v_cvt_pk_bf16_f32 v218, v220, v221
 v_mfma_f32_16x16x32_bf16 v[28:31], a[68:71], a[136:139], v[28:31]
 ds_read_b64_tr_b16 a[92:93], v10 offset:16384
 v_xor_b32 v7, 64, v6
 v_mfma_f32_16x16x32_bf16 v[28:31], a[72:75], a[144:147], v[28:31]
 s_waitcnt lgkmcnt(7)
 ds_read_b128 a[112:115], v14 offset:0
 ds_read_b64_tr_b16 a[94:95], v10 offset:20480
 v_mfma_f32_16x16x32_bf16 v[28:31], a[76:79], a[152:155], v[28:31]
 ds_read_b64_tr_b16 a[96:97], v7 offset:0
 v_cvt_pk_bf16_f32 v219, v222, v223
 v_mfma_f32_16x16x32_bf16 v[44:47], a[64:67], a[132:135], 0
 ds_read_b128 a[120:123], v3 offset:0
 ds_read_b64_tr_b16 a[98:99], v7 offset:4096
 v_mfma_f32_16x16x32_bf16 v[44:47], a[68:71], a[140:143], v[44:47]
 s_add_u32 s59, s56, 16384
 ds_read_b64_tr_b16 a[100:101], v7 offset:16384
 v_xor_b32 v8, 65600, v6
 v_mfma_f32_16x16x32_bf16 v[44:47], a[72:75], a[148:151], v[44:47]
 ds_read_b128 a[116:119], v14 offset:2048
 ds_read_b64_tr_b16 a[102:103], v7 offset:20480
 buffer_store_dwordx4 v[104:107], v1, s[12:15], s59 offen offset:2048 sc1
 v_mfma_f32_16x16x32_bf16 v[44:47], a[76:79], a[156:159], v[44:47]
 s_waitcnt lgkmcnt(9)
 ds_read_b64_tr_b16 a[104:105], v8 offset:0
 v_cvt_pk_bf16_f32 v224, v224, v225
 v_mfma_f32_16x16x32_bf16 v[52:55], a[80:83], a[128:131], 0
 ds_read_b128 a[124:127], v3 offset:2048
 ds_read_b64_tr_b16 a[106:107], v8 offset:4096
 v_mfma_f32_16x16x32_bf16 v[52:55], a[84:87], a[136:139], v[52:55]
 ds_read_b64_tr_b16 a[108:109], v8 offset:16384
 v_cvt_pk_bf16_f32 v225, v226, v227
 v_mfma_f32_16x16x32_bf16 v[52:55], a[88:91], a[144:147], v[52:55]
 s_waitcnt lgkmcnt(10)
 ds_read_b64_tr_b16 a[110:111], v8 offset:20480
 v_xor_b32 v9, 96, v6
 v_mfma_f32_16x16x32_bf16 v[52:55], a[92:95], a[152:155], v[52:55]
 ds_read_b64_tr_b16 a[64:65], v9 offset:0
 v_cvt_pk_bf16_f32 v226, v228, v229
 v_mfma_f32_16x16x32_bf16 v[60:63], a[80:83], a[132:135], 0
 s_add_u32 s59, s56, 16384
 ds_read_b64_tr_b16 a[66:67], v9 offset:4096
 v_cvt_pk_bf16_f32 v227, v230, v231
 v_mfma_f32_16x16x32_bf16 v[60:63], a[84:87], a[140:143], v[60:63]
 ds_read_b64_tr_b16 a[68:69], v9 offset:16384
 buffer_store_dwordx4 v[112:115], v1, s[12:15], s59 offen offset:3072 sc1
 v_mfma_f32_16x16x32_bf16 v[60:63], a[88:91], a[148:151], v[60:63]
 ds_read_b64_tr_b16 a[70:71], v9 offset:20480
 v_xor_b32 v10, 65632, v6
 v_mfma_f32_16x16x32_bf16 v[60:63], a[92:95], a[156:159], v[60:63]
 s_waitcnt lgkmcnt(6)
 ds_read_b64_tr_b16 a[72:73], v10 offset:0
 v_cvt_pk_bf16_f32 v232, v232, v233
 v_mfma_f32_16x16x32_bf16 v[20:23], a[96:99], a[128:131], 0
 ds_read_b64_tr_b16 a[74:75], v10 offset:4096
 v_cvt_pk_bf16_f32 v233, v234, v235
 v_mfma_f32_16x16x32_bf16 v[20:23], a[100:103], a[136:139], v[20:23]
 s_waitcnt lgkmcnt(8)
 ds_read_b64_tr_b16 a[76:77], v10 offset:16384
 v_xor_b32 v7, 128, v6
 v_mfma_f32_16x16x32_bf16 v[20:23], a[104:107], a[144:147], v[20:23]
 s_waitcnt lgkmcnt(7)
 s_barrier
 ds_read_b64_tr_b16 a[78:79], v10 offset:20480
 v_mfma_f32_16x16x32_bf16 v[20:23], a[108:111], a[152:155], v[20:23]
 s_add_u32 m0, s29, 131072
 ds_read_b64_tr_b16 a[80:81], v7 offset:0
 v_add_u32 v2, 0x80000, v2
 v_mfma_f32_16x16x32_bf16 v[36:39], a[96:99], a[132:135], 0
 ds_read_b64_tr_b16 a[82:83], v7 offset:4096
 buffer_load_dwordx4 v2, s[16:19], 0 offen lds
 v_mfma_f32_16x16x32_bf16 v[36:39], a[100:103], a[140:143], v[36:39]
 ds_read_b64_tr_b16 a[84:85], v7 offset:16384
 v_cvt_pk_bf16_f32 v234, v236, v237
 v_mfma_f32_16x16x32_bf16 v[36:39], a[104:107], a[148:151], v[36:39]
 s_add_u32 s59, s56, 0
 ds_read_b64_tr_b16 a[86:87], v7 offset:20480
 v_xor_b32 v8, 65664, v6
 v_mfma_f32_16x16x32_bf16 v[36:39], a[108:111], a[156:159], v[36:39]
 s_waitcnt lgkmcnt(6)
 ds_read_b64_tr_b16 a[88:89], v8 offset:0
 buffer_store_dwordx4 v[120:123], v1, s[12:15], s59 offen offset:3072 sc1
 v_mfma_f32_16x16x32_bf16 v[68:71], a[64:67], a[128:131], 0
 ds_read_b64_tr_b16 a[90:91], v8 offset:4096
 v_cvt_pk_bf16_f32 v235, v238, v239
 v_mfma_f32_16x16x32_bf16 v[68:71], a[68:71], a[136:139], v[68:71]
 s_add_u32 m0, s29, 135168
 ds_read_b64_tr_b16 a[92:93], v8 offset:16384
 v_cvt_pk_bf16_f32 v240, v240, v241
 v_mfma_f32_16x16x32_bf16 v[68:71], a[72:75], a[144:147], v[68:71]
 s_waitcnt lgkmcnt(7)
 ds_read_b64_tr_b16 a[94:95], v8 offset:20480
 v_xor_b32 v9, 160, v6
 v_mfma_f32_16x16x32_bf16 v[68:71], a[76:79], a[152:155], v[68:71]
 ds_read_b64_tr_b16 a[96:97], v9 offset:0
 buffer_load_dwordx4 v2, s[16:19], s48 offen lds
 v_mfma_f32_16x16x32_bf16 v[76:79], a[64:67], a[132:135], 0
 ds_read_b64_tr_b16 a[98:99], v9 offset:4096
 v_cvt_pk_bf16_f32 v241, v242, v243
 v_mfma_f32_16x16x32_bf16 v[76:79], a[68:71], a[140:143], v[76:79]
 ds_read_b64_tr_b16 a[100:101], v9 offset:16384
 v_cvt_pk_bf16_f32 v242, v244, v245
 v_mfma_f32_16x16x32_bf16 v[76:79], a[72:75], a[148:151], v[76:79]
 s_add_u32 s59, s56, 4096
 ds_read_b64_tr_b16 a[102:103], v9 offset:20480
 v_xor_b32 v10, 65696, v6
 v_mfma_f32_16x16x32_bf16 v[76:79], a[76:79], a[156:159], v[76:79]
 s_waitcnt lgkmcnt(6)
 ds_read_b64_tr_b16 a[104:105], v10 offset:0
 buffer_store_dwordx4 v[128:131], v1, s[12:15], s59 offen offset:0 sc1
 v_mfma_f32_16x16x32_bf16 v[84:87], a[80:83], a[128:131], 0
 s_add_u32 m0, s29, 139264
 ds_read_b64_tr_b16 a[106:107], v10 offset:4096
 v_cvt_pk_bf16_f32 v243, v246, v247
 v_mfma_f32_16x16x32_bf16 v[84:87], a[84:87], a[136:139], v[84:87]
 ds_read_b64_tr_b16 a[108:109], v10 offset:16384
 buffer_load_dwordx4 v2, s[16:19], s49 offen lds
 v_mfma_f32_16x16x32_bf16 v[84:87], a[88:91], a[144:147], v[84:87]
 s_waitcnt lgkmcnt(7)
 ds_read_b64_tr_b16 a[110:111], v10 offset:20480
 v_xor_b32 v7, 192, v6
 v_mfma_f32_16x16x32_bf16 v[84:87], a[92:95], a[152:155], v[84:87]
 ds_read_b64_tr_b16 a[64:65], v7 offset:0
 v_cvt_pk_bf16_f32 v248, v248, v249
 v_mfma_f32_16x16x32_bf16 v[92:95], a[80:83], a[132:135], 0
 ds_read_b64_tr_b16 a[66:67], v7 offset:4096
 v_cvt_pk_bf16_f32 v249, v250, v251
 v_mfma_f32_16x16x32_bf16 v[92:95], a[84:87], a[140:143], v[92:95]
 ds_read_b64_tr_b16 a[68:69], v7 offset:16384
 v_cvt_pk_bf16_f32 v250, v252, v253
 v_mfma_f32_16x16x32_bf16 v[92:95], a[88:91], a[148:151], v[92:95]
 s_add_u32 m0, s29, 143360
 ds_read_b64_tr_b16 a[70:71], v7 offset:20480
 v_xor_b32 v8, 65728, v6
 v_mfma_f32_16x16x32_bf16 v[92:95], a[92:95], a[156:159], v[92:95]
 s_waitcnt lgkmcnt(6)
 ds_read_b64_tr_b16 a[72:73], v8 offset:0
 buffer_load_dwordx4 v2, s[16:19], s50 offen lds
 v_mfma_f32_16x16x32_bf16 v[100:103], a[96:99], a[128:131], 0
 s_add_u32 s59, s56, 20480
 ds_read_b64_tr_b16 a[74:75], v8 offset:4096
 v_cvt_pk_bf16_f32 v251, v254, v255
 v_mfma_f32_16x16x32_bf16 v[100:103], a[100:103], a[136:139], v[100:103]
 ds_read_b64_tr_b16 a[76:77], v8 offset:16384
 buffer_store_dwordx4 v[136:139], v1, s[12:15], s59 offen offset:0 sc1
 v_mfma_f32_16x16x32_bf16 v[100:103], a[104:107], a[144:147], v[100:103]
 s_waitcnt lgkmcnt(7)
 ds_read_b64_tr_b16 a[78:79], v8 offset:20480
 v_xor_b32 v9, 224, v6
 v_mfma_f32_16x16x32_bf16 v[100:103], a[108:111], a[152:155], v[100:103]
 s_and_b32 s36, s95, 31
 ds_read_b64_tr_b16 a[80:81], v9 offset:0
 v_accvgpr_read_b32 v11, a245
 v_mfma_f32_16x16x32_bf16 v[108:111], a[96:99], a[132:135], 0
 s_add_u32 m0, s29, 147456
 ds_read_b64_tr_b16 a[82:83], v9 offset:4096
 v_mov_b32 v12, 0
 v_mfma_f32_16x16x32_bf16 v[108:111], a[100:103], a[140:143], v[108:111]
 ds_read_b64_tr_b16 a[84:85], v9 offset:16384
 buffer_load_dwordx4 v2, s[16:19], s51 offen lds
 v_mfma_f32_16x16x32_bf16 v[108:111], a[104:107], a[148:151], v[108:111]
 s_add_u32 s59, s56, 20480
 ds_read_b64_tr_b16 a[86:87], v9 offset:20480
 v_xor_b32 v10, 65760, v6
 v_mfma_f32_16x16x32_bf16 v[108:111], a[108:111], a[156:159], v[108:111]
 s_waitcnt lgkmcnt(6)
 ds_read_b64_tr_b16 a[88:89], v10 offset:0
 v_mfma_f32_16x16x32_bf16 v[116:119], a[64:67], a[128:131], 0
 ds_read_b64_tr_b16 a[90:91], v10 offset:4096
 buffer_store_dwordx4 v[144:147], v1, s[12:15], s59 offen offset:1024 sc1
 v_mfma_f32_16x16x32_bf16 v[116:119], a[68:71], a[136:139], v[116:119]
 s_add_u32 m0, s29, 151552
 ds_read_b64_tr_b16 a[92:93], v10 offset:16384
 v_mfma_f32_16x16x32_bf16 v[116:119], a[72:75], a[144:147], v[116:119]
 s_waitcnt lgkmcnt(7)
 ds_read_b64_tr_b16 a[94:95], v10 offset:20480
 v_xor_b32 v7, 256, v6
 v_mfma_f32_16x16x32_bf16 v[116:119], a[76:79], a[152:155], v[116:119]
 ds_read_b64_tr_b16 a[96:97], v7 offset:0
 buffer_load_dwordx4 v2, s[16:19], s52 offen lds
 v_mfma_f32_16x16x32_bf16 v[124:127], a[64:67], a[132:135], 0
 s_lshr_b32 s37, s95, 5
 ds_read_b64_tr_b16 a[98:99], v7 offset:4096
 v_mfma_f32_16x16x32_bf16 v[124:127], a[68:71], a[140:143], v[124:127]
 ds_read_b64_tr_b16 a[100:101], v7 offset:16384
 global_load_dword a248, v12, s[90:91] offset:128 sc1
 v_mfma_f32_16x16x32_bf16 v[124:127], a[72:75], a[148:151], v[124:127]
 s_add_u32 s59, s56, 4096
 ds_read_b64_tr_b16 a[102:103], v7 offset:20480
 v_xor_b32 v8, 65792, v6
 v_mfma_f32_16x16x32_bf16 v[124:127], a[76:79], a[156:159], v[124:127]
 s_waitcnt lgkmcnt(6)
 ds_read_b64_tr_b16 a[104:105], v8 offset:0
 buffer_store_dwordx4 v[152:155], v1, s[12:15], s59 offen offset:1024 sc1
 v_mfma_f32_16x16x32_bf16 v[132:135], a[80:83], a[128:131], 0
 s_add_u32 m0, s29, 155648
 ds_read_b64_tr_b16 a[106:107], v8 offset:4096
 v_and_b32 v12, 11, v0
 v_mfma_f32_16x16x32_bf16 v[132:135], a[84:87], a[136:139], v[132:135]
 ds_read_b64_tr_b16 a[108:109], v8 offset:16384
 buffer_load_dwordx4 v2, s[16:19], s53 offen lds
 v_mfma_f32_16x16x32_bf16 v[132:135], a[88:91], a[144:147], v[132:135]
 s_waitcnt lgkmcnt(7)
 ds_read_b64_tr_b16 a[110:111], v8 offset:20480
 v_xor_b32 v9, 288, v6
 v_mfma_f32_16x16x32_bf16 v[132:135], a[92:95], a[152:155], v[132:135]
 s_lshl_b32 s38, s3, 4
 ds_read_b64_tr_b16 a[64:65], v9 offset:0
 v_lshlrev_b32 v12, 2, v12
 v_mfma_f32_16x16x32_bf16 v[140:143], a[80:83], a[132:135], 0
 s_lshl_b32 s39, s36, 6
 ds_read_b64_tr_b16 a[66:67], v9 offset:4096
 v_mfma_f32_16x16x32_bf16 v[140:143], a[84:87], a[140:143], v[140:143]
 s_add_u32 s38, s38, s39
 ds_read_b64_tr_b16 a[68:69], v9 offset:16384
 v_mfma_f32_16x16x32_bf16 v[140:143], a[88:91], a[148:151], v[140:143]
 s_add_u32 m0, s29, 159744
 ds_read_b64_tr_b16 a[70:71], v9 offset:20480
 v_xor_b32 v10, 65824, v6
 v_mfma_f32_16x16x32_bf16 v[140:143], a[92:95], a[156:159], v[140:143]
 s_waitcnt lgkmcnt(6)
 ds_read_b64_tr_b16 a[72:73], v10 offset:0
 buffer_load_dwordx4 v2, s[16:19], s54 offen lds
 v_mfma_f32_16x16x32_bf16 v[148:151], a[96:99], a[128:131], 0
 s_add_u32 s59, s56, 4096
 ds_read_b64_tr_b16 a[74:75], v10 offset:4096
 v_mfma_f32_16x16x32_bf16 v[148:151], a[100:103], a[136:139], v[148:151]
 ds_read_b64_tr_b16 a[76:77], v10 offset:16384
 buffer_store_dwordx4 v[160:163], v1, s[12:15], s59 offen offset:2048 sc1
 v_mfma_f32_16x16x32_bf16 v[148:151], a[104:107], a[144:147], v[148:151]
 s_waitcnt lgkmcnt(7)
 ds_read_b64_tr_b16 a[78:79], v10 offset:20480
 v_xor_b32 v7, 320, v6
 v_mfma_f32_16x16x32_bf16 v[148:151], a[108:111], a[152:155], v[148:151]
 s_mul_i32 s38, s38, 896
 ds_read_b64_tr_b16 a[80:81], v7 offset:0
 v_mfma_f32_16x16x32_bf16 v[156:159], a[96:99], a[132:135], 0
 s_lshl_b32 s39, s37, 7
 ds_read_b64_tr_b16 a[82:83], v7 offset:4096
 v_mfma_f32_16x16x32_bf16 v[156:159], a[100:103], a[140:143], v[156:159]
 s_add_u32 s38, s38, s39
 ds_read_b64_tr_b16 a[84:85], v7 offset:16384
 v_mfma_f32_16x16x32_bf16 v[156:159], a[104:107], a[148:151], v[156:159]
 s_add_u32 s59, s56, 20480
 ds_read_b64_tr_b16 a[86:87], v7 offset:20480
 v_xor_b32 v8, 65856, v6
 v_mfma_f32_16x16x32_bf16 v[156:159], a[108:111], a[156:159], v[156:159]
 s_waitcnt lgkmcnt(6)
 ds_read_b64_tr_b16 a[88:89], v8 offset:0
 v_mfma_f32_16x16x32_bf16 v[164:167], a[64:67], a[128:131], 0
 ds_read_b64_tr_b16 a[90:91], v8 offset:4096
 buffer_store_dwordx4 v[168:171], v1, s[12:15], s59 offen offset:2048 sc1
 v_mfma_f32_16x16x32_bf16 v[164:167], a[68:71], a[136:139], v[164:167]
 s_lshl_b32 s39, s37, 9
 ds_read_b64_tr_b16 a[92:93], v8 offset:16384
 v_mfma_f32_16x16x32_bf16 v[164:167], a[72:75], a[144:147], v[164:167]
 s_waitcnt lgkmcnt(7)
 ds_read_b64_tr_b16 a[94:95], v8 offset:20480
 v_xor_b32 v9, 352, v6
 v_mfma_f32_16x16x32_bf16 v[164:167], a[76:79], a[152:155], v[164:167]
 s_mov_b32 s4, s66
 ds_read_b64_tr_b16 a[96:97], v9 offset:0
 v_mfma_f32_16x16x32_bf16 v[172:175], a[64:67], a[132:135], 0
 s_mov_b32 s5, s67
 ds_read_b64_tr_b16 a[98:99], v9 offset:4096
 v_mfma_f32_16x16x32_bf16 v[172:175], a[68:71], a[140:143], v[172:175]
 s_mov_b32 s6, 1835008
 ds_read_b64_tr_b16 a[100:101], v9 offset:16384
 v_mfma_f32_16x16x32_bf16 v[172:175], a[72:75], a[148:151], v[172:175]
 s_add_u32 s59, s56, 20480
 ds_read_b64_tr_b16 a[102:103], v9 offset:20480
 v_xor_b32 v10, 65888, v6
 v_mfma_f32_16x16x32_bf16 v[172:175], a[76:79], a[156:159], v[172:175]
 s_waitcnt lgkmcnt(6)
 ds_read_b64_tr_b16 a[104:105], v10 offset:0
 buffer_store_dwordx4 v[176:179], v1, s[12:15], s59 offen offset:3072 sc1
 v_mfma_f32_16x16x32_bf16 v[180:183], a[80:83], a[128:131], 0
 s_mov_b32 s7, 0x20000
 ds_read_b64_tr_b16 a[106:107], v10 offset:4096
 v_mfma_f32_16x16x32_bf16 v[180:183], a[84:87], a[136:139], v[180:183]
 s_mov_b32 s8, s68
 ds_read_b64_tr_b16 a[108:109], v10 offset:16384
 v_mfma_f32_16x16x32_bf16 v[180:183], a[88:91], a[144:147], v[180:183]
 s_waitcnt lgkmcnt(7)
 ds_read_b64_tr_b16 a[110:111], v10 offset:20480
 v_xor_b32 v7, 384, v6
 v_mfma_f32_16x16x32_bf16 v[180:183], a[92:95], a[152:155], v[180:183]
 s_mov_b32 s9, s69
 ds_read_b64_tr_b16 a[64:65], v7 offset:0
 v_mfma_f32_16x16x32_bf16 v[188:191], a[80:83], a[132:135], 0
 s_mov_b32 s10, 1835008
 ds_read_b64_tr_b16 a[66:67], v7 offset:4096
 v_mfma_f32_16x16x32_bf16 v[188:191], a[84:87], a[140:143], v[188:191]
 s_mov_b32 s11, 0x20000
 ds_read_b64_tr_b16 a[68:69], v7 offset:16384
 v_mfma_f32_16x16x32_bf16 v[188:191], a[88:91], a[148:151], v[188:191]
 s_add_u32 s59, s56, 4096
 ds_read_b64_tr_b16 a[70:71], v7 offset:20480
 v_xor_b32 v8, 65920, v6
 v_mfma_f32_16x16x32_bf16 v[188:191], a[92:95], a[156:159], v[188:191]
 s_waitcnt lgkmcnt(6)
 ds_read_b64_tr_b16 a[72:73], v8 offset:0
 buffer_store_dwordx4 v[184:187], v1, s[12:15], s59 offen offset:3072 sc1
 v_mfma_f32_16x16x32_bf16 v[196:199], a[96:99], a[128:131], 0
 s_mov_b32 s20, s70
 ds_read_b64_tr_b16 a[74:75], v8 offset:4096
 v_mfma_f32_16x16x32_bf16 v[196:199], a[100:103], a[136:139], v[196:199]
 s_mov_b32 s21, s71
 ds_read_b64_tr_b16 a[76:77], v8 offset:16384
 v_mfma_f32_16x16x32_bf16 v[196:199], a[104:107], a[144:147], v[196:199]
 s_waitcnt lgkmcnt(7)
 ds_read_b64_tr_b16 a[78:79], v8 offset:20480
 v_xor_b32 v9, 416, v6
 v_mfma_f32_16x16x32_bf16 v[196:199], a[108:111], a[152:155], v[196:199]
 s_mov_b32 s22, 3584
 ds_read_b64_tr_b16 a[80:81], v9 offset:0
 v_mfma_f32_16x16x32_bf16 v[204:207], a[96:99], a[132:135], 0
 s_mov_b32 s23, 0x20000
 ds_read_b64_tr_b16 a[82:83], v9 offset:4096
 v_mfma_f32_16x16x32_bf16 v[204:207], a[100:103], a[140:143], v[204:207]
 ds_read_b64_tr_b16 a[84:85], v9 offset:16384
 v_lshrrev_b32 v120, 3, v0
 v_mfma_f32_16x16x32_bf16 v[204:207], a[104:107], a[148:151], v[204:207]
 s_add_u32 s59, s56, 36864
 ds_read_b64_tr_b16 a[86:87], v9 offset:20480
 v_xor_b32 v10, 65952, v6
 v_mfma_f32_16x16x32_bf16 v[204:207], a[108:111], a[156:159], v[204:207]
 s_waitcnt lgkmcnt(6)
 ds_read_b64_tr_b16 a[88:89], v10 offset:0
 buffer_store_dwordx4 v[192:195], v1, s[12:15], s59 offen offset:0 sc1
 v_mfma_f32_16x16x32_bf16 v[212:215], a[64:67], a[128:131], 0
 ds_read_b64_tr_b16 a[90:91], v10 offset:4096
 v_mul_u32_u24 v120, 1792, v120
 v_mfma_f32_16x16x32_bf16 v[212:215], a[68:71], a[136:139], v[212:215]
 ds_read_b64_tr_b16 a[92:93], v10 offset:16384
 v_and_b32 v121, 7, v0
 v_mfma_f32_16x16x32_bf16 v[212:215], a[72:75], a[144:147], v[212:215]
 s_waitcnt lgkmcnt(7)
 ds_read_b64_tr_b16 a[94:95], v10 offset:20480
 v_xor_b32 v7, 448, v6
 v_mfma_f32_16x16x32_bf16 v[212:215], a[76:79], a[152:155], v[212:215]
 ds_read_b64_tr_b16 a[96:97], v7 offset:0
 v_lshl_add_u32 v120, v121, 4, v120
 v_mfma_f32_16x16x32_bf16 v[220:223], a[64:67], a[132:135], 0
 ds_read_b64_tr_b16 a[98:99], v7 offset:4096
 v_add_u32 v120, s38, v120
 v_mfma_f32_16x16x32_bf16 v[220:223], a[68:71], a[140:143], v[220:223]
 ds_read_b64_tr_b16 a[100:101], v7 offset:16384
 v_lshlrev_b32 v121, 6, v121
 v_mfma_f32_16x16x32_bf16 v[220:223], a[72:75], a[148:151], v[220:223]
 s_add_u32 s59, s56, 53248
 ds_read_b64_tr_b16 a[102:103], v7 offset:20480
 v_xor_b32 v8, 65984, v6
 v_mfma_f32_16x16x32_bf16 v[220:223], a[76:79], a[156:159], v[220:223]
 s_waitcnt lgkmcnt(6)
 ds_read_b64_tr_b16 a[104:105], v8 offset:0
 buffer_store_dwordx4 v[200:203], v1, s[12:15], s59 offen offset:0 sc1
 v_mfma_f32_16x16x32_bf16 v[228:231], a[80:83], a[128:131], 0
 ds_read_b64_tr_b16 a[106:107], v8 offset:4096
 v_subrev_u32 v122, 2688, v120
 v_mfma_f32_16x16x32_bf16 v[228:231], a[84:87], a[136:139], v[228:231]
 ds_read_b64_tr_b16 a[108:109], v8 offset:16384
 v_subrev_u32 v123, 1792, v120
 v_mfma_f32_16x16x32_bf16 v[228:231], a[88:91], a[144:147], v[228:231]
 s_waitcnt lgkmcnt(7)
 ds_read_b64_tr_b16 a[110:111], v8 offset:20480
 v_xor_b32 v9, 480, v6
 v_mfma_f32_16x16x32_bf16 v[228:231], a[92:95], a[152:155], v[228:231]
 ds_read_b64_tr_b16 a[64:65], v9 offset:0
 v_subrev_u32 v128, 896, v120
 v_mfma_f32_16x16x32_bf16 v[236:239], a[80:83], a[132:135], 0
 ds_read_b64_tr_b16 a[66:67], v9 offset:4096
 v_mfma_f32_16x16x32_bf16 v[236:239], a[84:87], a[140:143], v[236:239]
 ds_read_b64_tr_b16 a[68:69], v9 offset:16384
 v_mfma_f32_16x16x32_bf16 v[236:239], a[88:91], a[148:151], v[236:239]
 s_add_u32 s59, s56, 53248
 ds_read_b64_tr_b16 a[70:71], v9 offset:20480
 v_xor_b32 v10, 66016, v6
 v_mfma_f32_16x16x32_bf16 v[236:239], a[92:95], a[156:159], v[236:239]
 s_waitcnt lgkmcnt(6)
 ds_read_b64_tr_b16 a[72:73], v10 offset:0
 buffer_store_dwordx4 v[208:211], v1, s[12:15], s59 offen offset:1024 sc1
 v_mfma_f32_16x16x32_bf16 v[244:247], a[96:99], a[128:131], 0
 ds_read_b64_tr_b16 a[74:75], v10 offset:4096
 v_mfma_f32_16x16x32_bf16 v[244:247], a[100:103], a[136:139], v[244:247]
 s_waitcnt vmcnt(25)
 ds_read_b64_tr_b16 a[76:77], v10 offset:16384
 v_xor_b32 v7, 32768, v6
 v_mfma_f32_16x16x32_bf16 v[244:247], a[104:107], a[144:147], v[244:247]
 s_waitcnt lgkmcnt(7)
 s_barrier
 ds_read_b64_tr_b16 a[78:79], v10 offset:20480
 v_mfma_f32_16x16x32_bf16 v[244:247], a[108:111], a[152:155], v[244:247]
 ds_read_b64_tr_b16 a[80:81], v7 offset:0
 v_mfma_f32_16x16x32_bf16 v[252:255], a[96:99], a[132:135], 0
 ds_read_b64_tr_b16 a[82:83], v7 offset:4096
 v_mfma_f32_16x16x32_bf16 v[252:255], a[100:103], a[140:143], v[252:255]
 ds_read_b64_tr_b16 a[84:85], v7 offset:16384
 v_mfma_f32_16x16x32_bf16 v[252:255], a[104:107], a[148:151], v[252:255]
 s_add_u32 s59, s56, 36864
 ds_read_b64_tr_b16 a[86:87], v7 offset:20480
 v_xor_b32 v8, 98304, v6
 v_mfma_f32_16x16x32_bf16 v[252:255], a[108:111], a[156:159], v[252:255]
 s_waitcnt lgkmcnt(6)
 ds_read_b64_tr_b16 a[88:89], v8 offset:0
 buffer_store_dwordx4 v[216:219], v1, s[12:15], s59 offen offset:1024 sc1
 v_mfma_f32_16x16x32_bf16 v[16:19], a[64:67], a[128:131], 0
 ds_read_b64_tr_b16 a[90:91], v8 offset:4096
 v_mfma_f32_16x16x32_bf16 v[16:19], a[68:71], a[136:139], v[16:19]
 ds_read_b64_tr_b16 a[92:93], v8 offset:16384
 v_mfma_f32_16x16x32_bf16 v[16:19], a[72:75], a[144:147], v[16:19]
 s_waitcnt lgkmcnt(7)
 ds_read_b64_tr_b16 a[94:95], v8 offset:20480
 v_xor_b32 v9, 32800, v6
 v_mfma_f32_16x16x32_bf16 v[16:19], a[76:79], a[152:155], v[16:19]
 ds_read_b64_tr_b16 a[96:97], v9 offset:0
 v_mfma_f32_16x16x32_bf16 v[24:27], a[64:67], a[132:135], 0
 s_waitcnt lgkmcnt(9)
 ds_read_b64_tr_b16 a[98:99], v9 offset:4096
 v_mfma_f32_16x16x32_bf16 v[24:27], a[68:71], a[140:143], v[24:27]
 s_barrier
 ds_read_b64_tr_b16 a[100:101], v9 offset:16384
 v_mfma_f32_16x16x32_bf16 v[24:27], a[72:75], a[148:151], v[24:27]
 s_add_u32 m0, s29, 0
 ds_read_b64_tr_b16 a[102:103], v9 offset:20480
 v_xor_b32 v10, 98336, v6
 v_mfma_f32_16x16x32_bf16 v[24:27], a[76:79], a[156:159], v[24:27]
 s_waitcnt lgkmcnt(6)
 ds_read_b64_tr_b16 a[104:105], v10 offset:0
 v_add_u32 v2, 0x80000, v2
 v_mfma_f32_16x16x32_bf16 v[28:31], a[80:83], a[160:163], v[28:31]
 ds_read_b64_tr_b16 a[106:107], v10 offset:4096
 buffer_load_dwordx4 v2, s[16:19], 0 offen lds
 v_mfma_f32_16x16x32_bf16 v[28:31], a[84:87], a[168:171], v[28:31]
 s_add_u32 s59, s56, 36864
 ds_read_b64_tr_b16 a[108:109], v10 offset:16384
 v_mfma_f32_16x16x32_bf16 v[28:31], a[88:91], a[176:179], v[28:31]
 s_waitcnt lgkmcnt(7)
 ds_read_b64_tr_b16 a[110:111], v10 offset:20480
 v_xor_b32 v7, 32832, v6
 v_mfma_f32_16x16x32_bf16 v[28:31], a[92:95], a[184:187], v[28:31]
 ds_read_b64_tr_b16 a[64:65], v7 offset:0
 buffer_store_dwordx4 v[224:227], v1, s[12:15], s59 offen offset:2048 sc1
 v_mfma_f32_16x16x32_bf16 v[44:47], a[80:83], a[164:167], v[44:47]
 s_add_u32 m0, s29, 4096
 ds_read_b64_tr_b16 a[66:67], v7 offset:4096
 v_add_u32 v4, 4096, v1
 v_mfma_f32_16x16x32_bf16 v[44:47], a[84:87], a[172:175], v[44:47]
 ds_read_b64_tr_b16 a[68:69], v7 offset:16384
 buffer_load_dwordx4 v2, s[16:19], s48 offen lds
 v_mfma_f32_16x16x32_bf16 v[44:47], a[88:91], a[180:183], v[44:47]
 ds_read_b64_tr_b16 a[70:71], v7 offset:20480
 v_xor_b32 v8, 98368, v6
 v_mfma_f32_16x16x32_bf16 v[44:47], a[92:95], a[188:191], v[44:47]
 s_waitcnt lgkmcnt(6)
 ds_read_b64_tr_b16 a[72:73], v8 offset:0
 v_mfma_f32_16x16x32_bf16 v[52:55], a[96:99], a[160:163], v[52:55]
 ds_read_b64_tr_b16 a[74:75], v8 offset:4096
 v_mfma_f32_16x16x32_bf16 v[52:55], a[100:103], a[168:171], v[52:55]
 s_add_u32 m0, s29, 8192
 ds_read_b64_tr_b16 a[76:77], v8 offset:16384
 v_mfma_f32_16x16x32_bf16 v[52:55], a[104:107], a[176:179], v[52:55]
 s_waitcnt lgkmcnt(7)
 ds_read_b64_tr_b16 a[78:79], v8 offset:20480
 v_xor_b32 v9, 32864, v6
 v_mfma_f32_16x16x32_bf16 v[52:55], a[108:111], a[184:187], v[52:55]
 ds_read_b64_tr_b16 a[80:81], v9 offset:0
 buffer_load_dwordx4 v2, s[16:19], s49 offen lds
 v_mfma_f32_16x16x32_bf16 v[60:63], a[96:99], a[164:167], v[60:63]
 s_add_u32 s59, s56, 53248
 ds_read_b64_tr_b16 a[82:83], v9 offset:4096
 v_mfma_f32_16x16x32_bf16 v[60:63], a[100:103], a[172:175], v[60:63]
 ds_read_b64_tr_b16 a[84:85], v9 offset:16384
 buffer_store_dwordx4 v[232:235], v1, s[12:15], s59 offen offset:2048 sc1
 v_mfma_f32_16x16x32_bf16 v[60:63], a[104:107], a[180:183], v[60:63]
 s_add_u32 m0, s29, 12288
 ds_read_b64_tr_b16 a[86:87], v9 offset:20480
 v_xor_b32 v10, 98400, v6
 v_mfma_f32_16x16x32_bf16 v[60:63], a[108:111], a[188:191], v[60:63]
 s_waitcnt lgkmcnt(6)
 ds_read_b64_tr_b16 a[88:89], v10 offset:0
 v_mfma_f32_16x16x32_bf16 v[20:23], a[64:67], a[160:163], v[20:23]
 ds_read_b64_tr_b16 a[90:91], v10 offset:4096
 buffer_load_dwordx4 v2, s[16:19], s50 offen lds
 v_mfma_f32_16x16x32_bf16 v[20:23], a[68:71], a[168:171], v[20:23]
 ds_read_b64_tr_b16 a[92:93], v10 offset:16384
 v_mfma_f32_16x16x32_bf16 v[20:23], a[72:75], a[176:179], v[20:23]
 s_waitcnt lgkmcnt(7)
 ds_read_b64_tr_b16 a[94:95], v10 offset:20480
 v_xor_b32 v7, 32896, v6
 v_mfma_f32_16x16x32_bf16 v[20:23], a[76:79], a[184:187], v[20:23]
 ds_read_b64_tr_b16 a[96:97], v7 offset:0
 v_mfma_f32_16x16x32_bf16 v[36:39], a[64:67], a[164:167], v[36:39]
 s_add_u32 m0, s29, 16384
 ds_read_b64_tr_b16 a[98:99], v7 offset:4096
 v_mfma_f32_16x16x32_bf16 v[36:39], a[68:71], a[172:175], v[36:39]
 ds_read_b64_tr_b16 a[100:101], v7 offset:16384
 buffer_load_dwordx4 v2, s[16:19], s51 offen lds
 v_mfma_f32_16x16x32_bf16 v[36:39], a[72:75], a[180:183], v[36:39]
 s_add_u32 s59, s56, 53248
 ds_read_b64_tr_b16 a[102:103], v7 offset:20480
 v_xor_b32 v8, 98432, v6
 v_mfma_f32_16x16x32_bf16 v[36:39], a[76:79], a[188:191], v[36:39]
 s_waitcnt lgkmcnt(6)
 ds_read_b64_tr_b16 a[104:105], v8 offset:0
 buffer_store_dwordx4 v[240:243], v1, s[12:15], s59 offen offset:3072 sc1
 v_mfma_f32_16x16x32_bf16 v[68:71], a[80:83], a[160:163], v[68:71]
 ds_read_b64_tr_b16 a[106:107], v8 offset:4096
 v_mfma_f32_16x16x32_bf16 v[68:71], a[84:87], a[168:171], v[68:71]
 s_add_u32 m0, s29, 20480
 ds_read_b64_tr_b16 a[108:109], v8 offset:16384
 v_mfma_f32_16x16x32_bf16 v[68:71], a[88:91], a[176:179], v[68:71]
 s_waitcnt lgkmcnt(7)
 ds_read_b64_tr_b16 a[110:111], v8 offset:20480
 v_xor_b32 v9, 32928, v6
 v_mfma_f32_16x16x32_bf16 v[68:71], a[92:95], a[184:187], v[68:71]
 ds_read_b64_tr_b16 a[64:65], v9 offset:0
 buffer_load_dwordx4 v2, s[16:19], s52 offen lds
 v_mfma_f32_16x16x32_bf16 v[76:79], a[80:83], a[164:167], v[76:79]
 ds_read_b64_tr_b16 a[66:67], v9 offset:4096
 v_mfma_f32_16x16x32_bf16 v[76:79], a[84:87], a[172:175], v[76:79]
 ds_read_b64_tr_b16 a[68:69], v9 offset:16384
 v_mfma_f32_16x16x32_bf16 v[76:79], a[88:91], a[180:183], v[76:79]
 s_add_u32 m0, s29, 24576
 ds_read_b64_tr_b16 a[70:71], v9 offset:20480
 v_xor_b32 v10, 98464, v6
 v_mfma_f32_16x16x32_bf16 v[76:79], a[92:95], a[188:191], v[76:79]
 s_waitcnt lgkmcnt(6)
 ds_read_b64_tr_b16 a[72:73], v10 offset:0
 v_mfma_f32_16x16x32_bf16 v[84:87], a[96:99], a[160:163], v[84:87]
 ds_read_b64_tr_b16 a[74:75], v10 offset:4096
 buffer_load_dwordx4 v2, s[16:19], s53 offen lds
 v_mfma_f32_16x16x32_bf16 v[84:87], a[100:103], a[168:171], v[84:87]
 s_add_u32 s59, s56, 36864
 ds_read_b64_tr_b16 a[76:77], v10 offset:16384
 v_mfma_f32_16x16x32_bf16 v[84:87], a[104:107], a[176:179], v[84:87]
 s_waitcnt lgkmcnt(7)
 ds_read_b64_tr_b16 a[78:79], v10 offset:20480
 v_xor_b32 v7, 32960, v6
 v_mfma_f32_16x16x32_bf16 v[84:87], a[108:111], a[184:187], v[84:87]
 ds_read_b64_tr_b16 a[80:81], v7 offset:0
 buffer_store_dwordx4 v[248:251], v1, s[12:15], s59 offen offset:3072 sc1
 v_mfma_f32_16x16x32_bf16 v[92:95], a[96:99], a[164:167], v[92:95]
 s_add_u32 m0, s29, 28672
 ds_read_b64_tr_b16 a[82:83], v7 offset:4096
 v_mfma_f32_16x16x32_bf16 v[92:95], a[100:103], a[172:175], v[92:95]
 ds_read_b64_tr_b16 a[84:85], v7 offset:16384
 buffer_load_dwordx4 v2, s[16:19], s54 offen lds
 v_mfma_f32_16x16x32_bf16 v[92:95], a[104:107], a[180:183], v[92:95]
 ds_read_b64_tr_b16 a[86:87], v7 offset:20480
 v_xor_b32 v8, 98496, v6
 v_mfma_f32_16x16x32_bf16 v[92:95], a[108:111], a[188:191], v[92:95]
 s_waitcnt lgkmcnt(6)
 ds_read_b64_tr_b16 a[88:89], v8 offset:0
 v_mfma_f32_16x16x32_bf16 v[100:103], a[64:67], a[160:163], v[100:103]
 s_add_u32 m0, s29, 65536
 ds_read_b64_tr_b16 a[90:91], v8 offset:4096
 v_add_u32 v2, 0x80000, v2
 v_mfma_f32_16x16x32_bf16 v[100:103], a[68:71], a[168:171], v[100:103]
 ds_read_b64_tr_b16 a[92:93], v8 offset:16384
 buffer_load_dwordx4 v2, s[16:19], 0 offen lds
 v_mfma_f32_16x16x32_bf16 v[100:103], a[72:75], a[176:179], v[100:103]
 s_waitcnt lgkmcnt(7)
 ds_read_b64_tr_b16 a[94:95], v8 offset:20480
 v_xor_b32 v9, 32992, v6
 v_mfma_f32_16x16x32_bf16 v[100:103], a[76:79], a[184:187], v[100:103]
 ds_read_b64_tr_b16 a[96:97], v9 offset:0
 v_mfma_f32_16x16x32_bf16 v[108:111], a[64:67], a[164:167], v[108:111]
 ds_read_b64_tr_b16 a[98:99], v9 offset:4096
 v_mfma_f32_16x16x32_bf16 v[108:111], a[68:71], a[172:175], v[108:111]
 ds_read_b64_tr_b16 a[100:101], v9 offset:16384
 v_mfma_f32_16x16x32_bf16 v[108:111], a[72:75], a[180:183], v[108:111]
 s_add_u32 m0, s29, 69632
 ds_read_b64_tr_b16 a[102:103], v9 offset:20480
 v_xor_b32 v10, 98528, v6
 v_mfma_f32_16x16x32_bf16 v[108:111], a[76:79], a[188:191], v[108:111]
 s_waitcnt lgkmcnt(6)
 ds_read_b64_tr_b16 a[104:105], v10 offset:0
 buffer_load_dwordx4 v2, s[16:19], s48 offen lds
 v_mfma_f32_16x16x32_bf16 v[116:119], a[80:83], a[160:163], v[116:119]
 ds_read_b64_tr_b16 a[106:107], v10 offset:4096
 v_mfma_f32_16x16x32_bf16 v[116:119], a[84:87], a[168:171], v[116:119]
 ds_read_b64_tr_b16 a[108:109], v10 offset:16384
 v_mfma_f32_16x16x32_bf16 v[116:119], a[88:91], a[176:179], v[116:119]
 s_waitcnt lgkmcnt(7)
 ds_read_b64_tr_b16 a[110:111], v10 offset:20480
 v_xor_b32 v7, 33024, v6
 v_mfma_f32_16x16x32_bf16 v[116:119], a[92:95], a[184:187], v[116:119]
 s_add_u32 m0, s29, 73728
 ds_read_b64_tr_b16 a[64:65], v7 offset:0
 v_mfma_f32_16x16x32_bf16 v[124:127], a[80:83], a[164:167], v[124:127]
 ds_read_b64_tr_b16 a[66:67], v7 offset:4096
 buffer_load_dwordx4 v2, s[16:19], s49 offen lds
 v_mfma_f32_16x16x32_bf16 v[124:127], a[84:87], a[172:175], v[124:127]
 ds_read_b64_tr_b16 a[68:69], v7 offset:16384
 v_mfma_f32_16x16x32_bf16 v[124:127], a[88:91], a[180:183], v[124:127]
 ds_read_b64_tr_b16 a[70:71], v7 offset:20480
 v_xor_b32 v8, 98560, v6
 v_mfma_f32_16x16x32_bf16 v[124:127], a[92:95], a[188:191], v[124:127]
 s_waitcnt lgkmcnt(6)
 ds_read_b64_tr_b16 a[72:73], v8 offset:0
 v_mfma_f32_16x16x32_bf16 v[132:135], a[96:99], a[160:163], v[132:135]
 s_add_u32 m0, s29, 77824
 ds_read_b64_tr_b16 a[74:75], v8 offset:4096
 v_mfma_f32_16x16x32_bf16 v[132:135], a[100:103], a[168:171], v[132:135]
 ds_read_b64_tr_b16 a[76:77], v8 offset:16384
 buffer_load_dwordx4 v2, s[16:19], s50 offen lds
 v_mfma_f32_16x16x32_bf16 v[132:135], a[104:107], a[176:179], v[132:135]
 s_waitcnt lgkmcnt(7)
 ds_read_b64_tr_b16 a[78:79], v8 offset:20480
 v_xor_b32 v9, 33056, v6
 v_mfma_f32_16x16x32_bf16 v[132:135], a[108:111], a[184:187], v[132:135]
 ds_read_b64_tr_b16 a[80:81], v9 offset:0
 v_mfma_f32_16x16x32_bf16 v[140:143], a[96:99], a[164:167], v[140:143]
 ds_read_b64_tr_b16 a[82:83], v9 offset:4096
 v_mfma_f32_16x16x32_bf16 v[140:143], a[100:103], a[172:175], v[140:143]
 ds_read_b64_tr_b16 a[84:85], v9 offset:16384
 v_mfma_f32_16x16x32_bf16 v[140:143], a[104:107], a[180:183], v[140:143]
 s_add_u32 m0, s29, 81920
 ds_read_b64_tr_b16 a[86:87], v9 offset:20480
 v_xor_b32 v10, 98592, v6
 v_mfma_f32_16x16x32_bf16 v[140:143], a[108:111], a[188:191], v[140:143]
 s_waitcnt lgkmcnt(6)
 ds_read_b64_tr_b16 a[88:89], v10 offset:0
 buffer_load_dwordx4 v2, s[16:19], s51 offen lds
 v_mfma_f32_16x16x32_bf16 v[148:151], a[64:67], a[160:163], v[148:151]
 ds_read_b64_tr_b16 a[90:91], v10 offset:4096
 v_mfma_f32_16x16x32_bf16 v[148:151], a[68:71], a[168:171], v[148:151]
 ds_read_b64_tr_b16 a[92:93], v10 offset:16384
 v_mfma_f32_16x16x32_bf16 v[148:151], a[72:75], a[176:179], v[148:151]
 s_waitcnt lgkmcnt(7)
 ds_read_b64_tr_b16 a[94:95], v10 offset:20480
 v_xor_b32 v7, 33088, v6
 v_mfma_f32_16x16x32_bf16 v[148:151], a[76:79], a[184:187], v[148:151]
 s_add_u32 m0, s29, 86016
 ds_read_b64_tr_b16 a[96:97], v7 offset:0
 v_mfma_f32_16x16x32_bf16 v[156:159], a[64:67], a[164:167], v[156:159]
 ds_read_b64_tr_b16 a[98:99], v7 offset:4096
 buffer_load_dwordx4 v2, s[16:19], s52 offen lds
 v_mfma_f32_16x16x32_bf16 v[156:159], a[68:71], a[172:175], v[156:159]
 ds_read_b64_tr_b16 a[100:101], v7 offset:16384
 v_mfma_f32_16x16x32_bf16 v[156:159], a[72:75], a[180:183], v[156:159]
 ds_read_b64_tr_b16 a[102:103], v7 offset:20480
 v_xor_b32 v8, 98624, v6
 v_mfma_f32_16x16x32_bf16 v[156:159], a[76:79], a[188:191], v[156:159]
 s_waitcnt lgkmcnt(6)
 ds_read_b64_tr_b16 a[104:105], v8 offset:0
 v_mfma_f32_16x16x32_bf16 v[164:167], a[80:83], a[160:163], v[164:167]
 s_add_u32 m0, s29, 90112
 ds_read_b64_tr_b16 a[106:107], v8 offset:4096
 v_mfma_f32_16x16x32_bf16 v[164:167], a[84:87], a[168:171], v[164:167]
 ds_read_b64_tr_b16 a[108:109], v8 offset:16384
 buffer_load_dwordx4 v2, s[16:19], s53 offen lds
 v_mfma_f32_16x16x32_bf16 v[164:167], a[88:91], a[176:179], v[164:167]
 s_waitcnt lgkmcnt(7)
 ds_read_b64_tr_b16 a[110:111], v8 offset:20480
 v_xor_b32 v9, 33120, v6
 v_mfma_f32_16x16x32_bf16 v[164:167], a[92:95], a[184:187], v[164:167]
 s_waitcnt vmcnt(8)
 ds_read_b64_tr_b16 a[64:65], v9 offset:0
 v_mfma_f32_16x16x32_bf16 v[172:175], a[80:83], a[164:167], v[172:175]
 s_barrier
 ds_read_b64_tr_b16 a[66:67], v9 offset:4096
 v_mfma_f32_16x16x32_bf16 v[172:175], a[84:87], a[172:175], v[172:175]
 ds_read_b64_tr_b16 a[68:69], v9 offset:16384
 buffer_store_dword v11, v11, s[12:15], s92 offen sc1
 v_mfma_f32_16x16x32_bf16 v[172:175], a[88:91], a[180:183], v[172:175]
 s_add_u32 m0, s29, 94208
 ds_read_b64_tr_b16 a[70:71], v9 offset:20480
 v_xor_b32 v10, 98656, v6
 v_mfma_f32_16x16x32_bf16 v[172:175], a[92:95], a[188:191], v[172:175]
 s_waitcnt lgkmcnt(6)
 ds_read_b64_tr_b16 a[72:73], v10 offset:0
 buffer_load_dwordx4 v2, s[16:19], s54 offen lds
 v_mfma_f32_16x16x32_bf16 v[180:183], a[96:99], a[160:163], v[180:183]
 ds_read_b64_tr_b16 a[74:75], v10 offset:4096
 v_mfma_f32_16x16x32_bf16 v[180:183], a[100:103], a[168:171], v[180:183]
 ds_read_b64_tr_b16 a[76:77], v10 offset:16384
 v_mfma_f32_16x16x32_bf16 v[180:183], a[104:107], a[176:179], v[180:183]
 s_waitcnt lgkmcnt(7)
 ds_read_b64_tr_b16 a[78:79], v10 offset:20480
 v_xor_b32 v7, 33152, v6
 v_mfma_f32_16x16x32_bf16 v[180:183], a[108:111], a[184:187], v[180:183]
 ds_read_b64_tr_b16 a[80:81], v7 offset:0
 v_mfma_f32_16x16x32_bf16 v[188:191], a[96:99], a[164:167], v[188:191]
 ds_read_b64_tr_b16 a[82:83], v7 offset:4096
 v_mfma_f32_16x16x32_bf16 v[188:191], a[100:103], a[172:175], v[188:191]
 ds_read_b64_tr_b16 a[84:85], v7 offset:16384
 v_mfma_f32_16x16x32_bf16 v[188:191], a[104:107], a[180:183], v[188:191]
 ds_read_b64_tr_b16 a[86:87], v7 offset:20480
 v_xor_b32 v8, 98688, v6
 v_mfma_f32_16x16x32_bf16 v[188:191], a[108:111], a[188:191], v[188:191]
 s_waitcnt lgkmcnt(6)
 ds_read_b64_tr_b16 a[88:89], v8 offset:0
 v_mfma_f32_16x16x32_bf16 v[196:199], a[64:67], a[160:163], v[196:199]
 s_and_b32 s58, s92, ~127
 ds_read_b64_tr_b16 a[90:91], v8 offset:4096
 v_mfma_f32_16x16x32_bf16 v[196:199], a[68:71], a[168:171], v[196:199]
 s_lshl_b32 s37, s25, 1
 ds_read_b64_tr_b16 a[92:93], v8 offset:16384
 v_mfma_f32_16x16x32_bf16 v[196:199], a[72:75], a[176:179], v[196:199]
 s_waitcnt lgkmcnt(7)
 ds_read_b64_tr_b16 a[94:95], v8 offset:20480
 v_xor_b32 v9, 33184, v6
 v_mfma_f32_16x16x32_bf16 v[196:199], a[76:79], a[184:187], v[196:199]
 s_sub_i32 s38, 13, s37
 ds_read_b64_tr_b16 a[96:97], v9 offset:0
 v_mfma_f32_16x16x32_bf16 v[204:207], a[64:67], a[164:167], v[204:207]
 s_max_i32 s38, s38, 0
 ds_read_b64_tr_b16 a[98:99], v9 offset:4096
 v_mfma_f32_16x16x32_bf16 v[204:207], a[68:71], a[172:175], v[204:207]
 s_lshl_b32 s49, s26, 20
 ds_read_b64_tr_b16 a[100:101], v9 offset:16384
 v_mfma_f32_16x16x32_bf16 v[204:207], a[72:75], a[180:183], v[204:207]
 s_lshl_b32 s50, s3, 13
 ds_read_b64_tr_b16 a[102:103], v9 offset:20480
 v_xor_b32 v10, 98720, v6
 v_mfma_f32_16x16x32_bf16 v[204:207], a[76:79], a[188:191], v[204:207]
 s_waitcnt lgkmcnt(6)
 ds_read_b64_tr_b16 a[104:105], v10 offset:0
 v_mfma_f32_16x16x32_bf16 v[212:215], a[80:83], a[160:163], v[212:215]
 s_add_u32 s49, s49, s50
 ds_read_b64_tr_b16 a[106:107], v10 offset:4096
 v_mfma_f32_16x16x32_bf16 v[212:215], a[84:87], a[168:171], v[212:215]
 s_mov_b32 s54, 2
 ds_read_b64_tr_b16 a[108:109], v10 offset:16384
 v_mfma_f32_16x16x32_bf16 v[212:215], a[88:91], a[176:179], v[212:215]
 s_waitcnt lgkmcnt(7)
 ds_read_b64_tr_b16 a[110:111], v10 offset:20480
 v_xor_b32 v7, 33216, v6
 v_mfma_f32_16x16x32_bf16 v[212:215], a[92:95], a[184:187], v[212:215]
 s_sub_u32 s44, 31, s37
 ds_read_b64_tr_b16 a[64:65], v7 offset:0
 v_mfma_f32_16x16x32_bf16 v[220:223], a[80:83], a[164:167], v[220:223]
 s_sub_u32 s44, s44, s38
 ds_read_b64_tr_b16 a[66:67], v7 offset:4096
 v_mfma_f32_16x16x32_bf16 v[220:223], a[84:87], a[172:175], v[220:223]
 s_lshl_b32 s55, s38, 15
 ds_read_b64_tr_b16 a[68:69], v7 offset:16384
 v_mfma_f32_16x16x32_bf16 v[220:223], a[88:91], a[180:183], v[220:223]
 s_add_u32 s42, s55, s49
 ds_read_b64_tr_b16 a[70:71], v7 offset:20480
 v_xor_b32 v8, 98752, v6
 v_mfma_f32_16x16x32_bf16 v[220:223], a[92:95], a[188:191], v[220:223]
 s_waitcnt lgkmcnt(6)
 ds_read_b64_tr_b16 a[72:73], v8 offset:0
 buffer_load_dwordx4 v[32:35], v122, s[4:7], 0 offen
 v_mfma_f32_16x16x32_bf16 v[228:231], a[96:99], a[160:163], v[228:231]
 s_add_u32 s60, s58, 16
 ds_read_b64_tr_b16 a[74:75], v8 offset:4096
 v_mfma_f32_16x16x32_bf16 v[228:231], a[100:103], a[168:171], v[228:231]
 s_sub_u32 s45, 17, s37
 ds_read_b64_tr_b16 a[76:77], v8 offset:16384
 v_mfma_f32_16x16x32_bf16 v[228:231], a[104:107], a[176:179], v[228:231]
 s_waitcnt lgkmcnt(7)
 ds_read_b64_tr_b16 a[78:79], v8 offset:20480
 v_xor_b32 v9, 33248, v6
 v_mfma_f32_16x16x32_bf16 v[228:231], a[108:111], a[184:187], v[228:231]
 ds_read_b64_tr_b16 a[80:81], v9 offset:0
 buffer_load_dwordx4 v[40:43], v123, s[4:7], 0 offen
 v_mfma_f32_16x16x32_bf16 v[236:239], a[96:99], a[164:167], v[236:239]
 s_sub_u32 s66, s42, 0x8000
 ds_read_b64_tr_b16 a[82:83], v9 offset:4096
 v_mfma_f32_16x16x32_bf16 v[236:239], a[100:103], a[172:175], v[236:239]
 s_add_u32 s42, s49, 491520
 ds_read_b64_tr_b16 a[84:85], v9 offset:16384
 v_mfma_f32_16x16x32_bf16 v[236:239], a[104:107], a[180:183], v[236:239]
 s_add_u32 s67, s49, 524288
 ds_read_b64_tr_b16 a[86:87], v9 offset:20480
 v_xor_b32 v10, 98784, v6
 v_mfma_f32_16x16x32_bf16 v[236:239], a[108:111], a[188:191], v[236:239]
 s_waitcnt lgkmcnt(6)
 ds_read_b64_tr_b16 a[88:89], v10 offset:0
 buffer_load_dwordx4 v[48:51], v128, s[4:7], 0 offen
 v_mfma_f32_16x16x32_bf16 v[244:247], a[64:67], a[160:163], v[244:247]
 s_add_u32 s68, s66, 16777216
 ds_read_b64_tr_b16 a[90:91], v10 offset:4096
 v_mfma_f32_16x16x32_bf16 v[244:247], a[68:71], a[168:171], v[244:247]
 s_waitcnt vmcnt(3)
 ds_read_b64_tr_b16 a[92:93], v10 offset:16384
 v_xor_b32 v7, 131072, v6
 v_mfma_f32_16x16x32_bf16 v[244:247], a[72:75], a[176:179], v[244:247]
 s_waitcnt lgkmcnt(7)
 s_barrier
 ds_read_b64_tr_b16 a[94:95], v10 offset:20480
 v_mfma_f32_16x16x32_bf16 v[244:247], a[76:79], a[184:187], v[244:247]
 ds_read_b64_tr_b16 a[96:97], v7 offset:0
 buffer_load_dwordx4 v[56:59], v120, s[4:7], 0 offen offset:0
 v_mfma_f32_16x16x32_bf16 v[252:255], a[64:67], a[164:167], v[252:255]
 s_add_u32 s69, s67, 16777216
 ds_read_b64_tr_b16 a[98:99], v7 offset:4096
 v_mfma_f32_16x16x32_bf16 v[252:255], a[68:71], a[172:175], v[252:255]
 s_mov_b32 s70, 0xffff8000
 ds_read_b64_tr_b16 a[100:101], v7 offset:16384
 v_accvgpr_read_b32 v5, a248
 v_mfma_f32_16x16x32_bf16 v[252:255], a[72:75], a[180:183], v[252:255]
 s_mov_b32 s71, s70
 ds_read_b64_tr_b16 a[102:103], v7 offset:20480
 v_xor_b32 v8, 0, v6
 v_mfma_f32_16x16x32_bf16 v[252:255], a[76:79], a[188:191], v[252:255]
 s_waitcnt lgkmcnt(6)
 ds_read_b64_tr_b16 a[104:105], v8 offset:0
 buffer_load_dwordx4 v[64:67], v120, s[4:7], 0 offen offset:896
 v_mfma_f32_16x16x32_bf16 v[16:19], a[80:83], a[160:163], v[16:19]
 s_add_u32 s43, s42, 16777216
 ds_read_b64_tr_b16 a[106:107], v8 offset:4096
 v_mfma_f32_16x16x32_bf16 v[16:19], a[84:87], a[168:171], v[16:19]
 s_mov_b32 s40, s50
 ds_read_b64_tr_b16 a[108:109], v8 offset:16384
 v_mfma_f32_16x16x32_bf16 v[16:19], a[88:91], a[176:179], v[16:19]
 s_waitcnt lgkmcnt(7)
 ds_read_b64_tr_b16 a[110:111], v8 offset:20480
 v_xor_b32 v9, 65536, v6
 v_mfma_f32_16x16x32_bf16 v[16:19], a[92:95], a[184:187], v[16:19]
 ds_read_b64_tr_b16 a[64:65], v9 offset:0
 buffer_load_dwordx4 v[72:75], v120, s[8:11], 0 offen offset:0
 v_mfma_f32_16x16x32_bf16 v[24:27], a[80:83], a[164:167], v[24:27]
 s_add_u32 s41, s50, 0x10000
 ds_read_b64_tr_b16 a[66:67], v9 offset:4096
 v_mfma_f32_16x16x32_bf16 v[24:27], a[84:87], a[172:175], v[24:27]
 s_lshr_b32 s61, s95, 4
 ds_read_b64_tr_b16 a[68:69], v9 offset:16384
 v_mfma_f32_16x16x32_bf16 v[24:27], a[88:91], a[180:183], v[24:27]
 s_lshl_b32 s61, s61, 7
 ds_read_b64_tr_b16 a[70:71], v9 offset:20480
 v_xor_b32 v10, 131104, v6
 v_mfma_f32_16x16x32_bf16 v[24:27], a[92:95], a[188:191], v[24:27]
 s_waitcnt lgkmcnt(6)
 ds_read_b64_tr_b16 a[72:73], v10 offset:0
 buffer_load_dwordx4 v[80:83], v120, s[8:11], 0 offen offset:896
 v_mfma_f32_16x16x32_bf16 v[28:31], a[96:99], a[192:195], v[28:31]
 s_add_u32 s61, s61, 84959232
 ds_read_b64_tr_b16 a[74:75], v10 offset:4096
 v_mfma_f32_16x16x32_bf16 v[28:31], a[100:103], a[200:203], v[28:31]
 s_mov_b32 s47, 0x4b800000
 ds_read_b64_tr_b16 a[76:77], v10 offset:16384
 v_mfma_f32_16x16x32_bf16 v[28:31], a[104:107], a[208:211], v[28:31]
 s_waitcnt lgkmcnt(3)
 ds_read_b64_tr_b16 a[78:79], v10 offset:20480
 v_xor_b32 v7, 32, v6
 v_mfma_f32_16x16x32_bf16 v[28:31], a[108:111], a[216:219], v[28:31]
 ds_read_b64_tr_b16 a[80:81], v7 offset:0
 buffer_load_dwordx4 v[88:91], v121, s[20:23], s39 offen offset:0
 v_mfma_f32_16x16x32_bf16 v[28:31], a[64:67], a[112:115], v[28:31]
 s_lshl_b32 s30, s95, 1
 ds_read_b64_tr_b16 a[82:83], v7 offset:4096
 v_mfma_f32_16x16x32_bf16 v[28:31], a[68:71], a[120:123], v[28:31]
 s_lshr_b32 s31, s3, 1
 ds_read_b64_tr_b16 a[84:85], v7 offset:16384
 v_mfma_f32_16x16x32_bf16 v[44:47], a[96:99], a[196:199], v[44:47]
 s_add_u32 s30, s30, s31
 ds_read_b64_tr_b16 a[86:87], v7 offset:20480
 v_xor_b32 v8, 65568, v6
 v_mfma_f32_16x16x32_bf16 v[44:47], a[100:103], a[204:207], v[44:47]
 ds_read_b64_tr_b16 a[88:89], v8 offset:0
 buffer_load_dwordx4 v[96:99], v121, s[20:23], s39 offen offset:16
 v_mfma_f32_16x16x32_bf16 v[44:47], a[104:107], a[212:215], v[44:47]
 s_min_u32 s30, s30, 223
 ds_read_b64_tr_b16 a[90:91], v8 offset:4096
 v_mfma_f32_16x16x32_bf16 v[44:47], a[108:111], a[220:223], v[44:47]
 s_lshl_b32 s30, s30, 2
 ds_read_b64_tr_b16 a[92:93], v8 offset:16384
 v_mfma_f32_16x16x32_bf16 v[44:47], a[64:67], a[116:119], v[44:47]
 s_lshl_b32 s53, s3, 4
 ds_read_b64_tr_b16 a[94:95], v8 offset:20480
 v_xor_b32 v9, 131136, v6
 v_mfma_f32_16x16x32_bf16 v[44:47], a[68:71], a[124:127], v[44:47]
 s_waitcnt lgkmcnt(6)
 ds_read_b64_tr_b16 a[96:97], v9 offset:0
 buffer_load_dwordx4 v[104:107], v121, s[20:23], s39 offen offset:32
 v_mfma_f32_16x16x32_bf16 v[52:55], a[72:75], a[192:195], v[52:55]
 ds_read_b64_tr_b16 a[98:99], v9 offset:4096
 v_mfma_f32_16x16x32_bf16 v[52:55], a[76:79], a[200:203], v[52:55]
 ds_read_b64_tr_b16 a[100:101], v9 offset:16384
 v_mfma_f32_16x16x32_bf16 v[52:55], a[80:83], a[208:211], v[52:55]
 s_waitcnt lgkmcnt(3)
 ds_read_b64_tr_b16 a[102:103], v9 offset:20480
 v_xor_b32 v10, 64, v6
 v_mfma_f32_16x16x32_bf16 v[52:55], a[84:87], a[216:219], v[52:55]
 ds_read_b64_tr_b16 a[104:105], v10 offset:0
 buffer_load_dwordx4 v[112:115], v121, s[20:23], s39 offen offset:48
 v_mfma_f32_16x16x32_bf16 v[52:55], a[88:91], a[112:115], v[52:55]
 ds_read_b64_tr_b16 a[106:107], v10 offset:4096
 v_mfma_f32_16x16x32_bf16 v[52:55], a[92:95], a[120:123], v[52:55]
 ds_read_b64_tr_b16 a[108:109], v10 offset:16384
 v_mfma_f32_16x16x32_bf16 v[60:63], a[72:75], a[196:199], v[60:63]
 ds_read_b64_tr_b16 a[110:111], v10 offset:20480
 v_xor_b32 v7, 65600, v6
 v_mfma_f32_16x16x32_bf16 v[60:63], a[76:79], a[204:207], v[60:63]
 ds_read_b64_tr_b16 a[64:65], v7 offset:0
 v_mfma_f32_16x16x32_bf16 v[60:63], a[80:83], a[212:215], v[60:63]
 ds_read_b64_tr_b16 a[66:67], v7 offset:4096
 v_mfma_f32_16x16x32_bf16 v[60:63], a[84:87], a[220:223], v[60:63]
 ds_read_b64_tr_b16 a[68:69], v7 offset:16384
 v_mfma_f32_16x16x32_bf16 v[60:63], a[88:91], a[116:119], v[60:63]
 ds_read_b64_tr_b16 a[70:71], v7 offset:20480
 v_xor_b32 v8, 131168, v6
 v_mfma_f32_16x16x32_bf16 v[60:63], a[92:95], a[124:127], v[60:63]
 s_waitcnt lgkmcnt(6)
 ds_read_b64_tr_b16 a[72:73], v8 offset:0
 v_mfma_f32_16x16x32_bf16 v[20:23], a[96:99], a[192:195], v[20:23]
 ds_read_b64_tr_b16 a[74:75], v8 offset:4096
 v_mfma_f32_16x16x32_bf16 v[20:23], a[100:103], a[200:203], v[20:23]
 ds_read_b64_tr_b16 a[76:77], v8 offset:16384
 v_mul_f32 v28, s34, v28
 v_mfma_f32_16x16x32_bf16 v[20:23], a[104:107], a[208:211], v[20:23]
 s_waitcnt lgkmcnt(3)
 ds_read_b64_tr_b16 a[78:79], v8 offset:20480
 v_xor_b32 v9, 96, v6
 v_mfma_f32_16x16x32_bf16 v[20:23], a[108:111], a[216:219], v[20:23]
 ds_read_b64_tr_b16 a[80:81], v9 offset:0
 v_mul_f32 v29, s34, v29
 v_mfma_f32_16x16x32_bf16 v[20:23], a[64:67], a[112:115], v[20:23]
 ds_read_b64_tr_b16 a[82:83], v9 offset:4096
 v_mul_f32 v30, s34, v30
 v_mfma_f32_16x16x32_bf16 v[20:23], a[68:71], a[120:123], v[20:23]
 ds_read_b64_tr_b16 a[84:85], v9 offset:16384
 v_mul_f32 v31, s34, v31
 v_mfma_f32_16x16x32_bf16 v[36:39], a[96:99], a[196:199], v[36:39]
 ds_read_b64_tr_b16 a[86:87], v9 offset:20480
 v_xor_b32 v10, 65632, v6
 v_mfma_f32_16x16x32_bf16 v[36:39], a[100:103], a[204:207], v[36:39]
 ds_read_b64_tr_b16 a[88:89], v10 offset:0
 v_mul_f32 v52, s34, v52
 v_mfma_f32_16x16x32_bf16 v[36:39], a[104:107], a[212:215], v[36:39]
 ds_read_b64_tr_b16 a[90:91], v10 offset:4096
 v_mul_f32 v53, s34, v53
 v_mfma_f32_16x16x32_bf16 v[36:39], a[108:111], a[220:223], v[36:39]
 ds_read_b64_tr_b16 a[92:93], v10 offset:16384
 v_mul_f32 v54, s34, v54
 v_mfma_f32_16x16x32_bf16 v[36:39], a[64:67], a[116:119], v[36:39]
 ds_read_b64_tr_b16 a[94:95], v10 offset:20480
 v_xor_b32 v7, 131200, v6
 v_mfma_f32_16x16x32_bf16 v[36:39], a[68:71], a[124:127], v[36:39]
 s_waitcnt lgkmcnt(6)
 ds_read_b64_tr_b16 a[96:97], v7 offset:0
 v_mul_f32 v55, s34, v55
 v_mfma_f32_16x16x32_bf16 v[68:71], a[72:75], a[192:195], v[68:71]
 ds_read_b64_tr_b16 a[98:99], v7 offset:4096
 v_cvt_pk_bf16_f32 v28, v28, v29
 v_mfma_f32_16x16x32_bf16 v[68:71], a[76:79], a[200:203], v[68:71]
 ds_read_b64_tr_b16 a[100:101], v7 offset:16384
 v_cvt_pk_bf16_f32 v29, v30, v31
 v_mfma_f32_16x16x32_bf16 v[68:71], a[80:83], a[208:211], v[68:71]
 s_waitcnt lgkmcnt(3)
 ds_read_b64_tr_b16 a[102:103], v7 offset:20480
 v_xor_b32 v8, 128, v6
 v_mfma_f32_16x16x32_bf16 v[68:71], a[84:87], a[216:219], v[68:71]
 ds_read_b64_tr_b16 a[104:105], v8 offset:0
 v_cvt_pk_bf16_f32 v30, v52, v53
 v_mfma_f32_16x16x32_bf16 v[68:71], a[88:91], a[112:115], v[68:71]
 s_add_u32 s59, s62, 0
 ds_read_b64_tr_b16 a[106:107], v8 offset:4096
 v_cvt_pk_bf16_f32 v31, v54, v55
 v_mfma_f32_16x16x32_bf16 v[68:71], a[92:95], a[120:123], v[68:71]
 ds_read_b64_tr_b16 a[108:109], v8 offset:16384
 buffer_store_dwordx4 v[28:31], v1, s[12:15], s59 offen offset:0 sc1
 v_mfma_f32_16x16x32_bf16 v[76:79], a[72:75], a[196:199], v[76:79]
 ds_read_b64_tr_b16 a[110:111], v8 offset:20480
 v_xor_b32 v9, 65664, v6
 v_mfma_f32_16x16x32_bf16 v[76:79], a[76:79], a[204:207], v[76:79]
 ds_read_b64_tr_b16 a[64:65], v9 offset:0
 v_accvgpr_write_b32 a0, v28
 v_mfma_f32_16x16x32_bf16 v[76:79], a[80:83], a[212:215], v[76:79]
 ds_read_b64_tr_b16 a[66:67], v9 offset:4096
 v_accvgpr_write_b32 a1, v29
 v_mfma_f32_16x16x32_bf16 v[76:79], a[84:87], a[220:223], v[76:79]
 ds_read_b64_tr_b16 a[68:69], v9 offset:16384
 v_accvgpr_write_b32 a2, v30
 v_mfma_f32_16x16x32_bf16 v[76:79], a[88:91], a[116:119], v[76:79]
 ds_read_b64_tr_b16 a[70:71], v9 offset:20480
 v_xor_b32 v10, 131232, v6
 v_mfma_f32_16x16x32_bf16 v[76:79], a[92:95], a[124:127], v[76:79]
 s_waitcnt lgkmcnt(6)
 ds_read_b64_tr_b16 a[72:73], v10 offset:0
 v_accvgpr_write_b32 a3, v31
 v_mfma_f32_16x16x32_bf16 v[84:87], a[96:99], a[192:195], v[84:87]
 ds_read_b64_tr_b16 a[74:75], v10 offset:4096
 v_mul_f32 v44, s34, v44
 v_mfma_f32_16x16x32_bf16 v[84:87], a[100:103], a[200:203], v[84:87]
 ds_read_b64_tr_b16 a[76:77], v10 offset:16384
 v_mul_f32 v45, s34, v45
 v_mfma_f32_16x16x32_bf16 v[84:87], a[104:107], a[208:211], v[84:87]
 s_waitcnt lgkmcnt(3)
 ds_read_b64_tr_b16 a[78:79], v10 offset:20480
 v_xor_b32 v7, 160, v6
 v_mfma_f32_16x16x32_bf16 v[84:87], a[108:111], a[216:219], v[84:87]
 ds_read_b64_tr_b16 a[80:81], v7 offset:0
 v_mul_f32 v46, s34, v46
 v_mfma_f32_16x16x32_bf16 v[84:87], a[64:67], a[112:115], v[84:87]
 ds_read_b64_tr_b16 a[82:83], v7 offset:4096
 v_mul_f32 v47, s34, v47
 v_mfma_f32_16x16x32_bf16 v[84:87], a[68:71], a[120:123], v[84:87]
 ds_read_b64_tr_b16 a[84:85], v7 offset:16384
 v_mul_f32 v60, s34, v60
 v_mfma_f32_16x16x32_bf16 v[92:95], a[96:99], a[196:199], v[92:95]
 ds_read_b64_tr_b16 a[86:87], v7 offset:20480
 v_xor_b32 v8, 65696, v6
 v_mfma_f32_16x16x32_bf16 v[92:95], a[100:103], a[204:207], v[92:95]
 ds_read_b64_tr_b16 a[88:89], v8 offset:0
 v_mul_f32 v61, s34, v61
 v_mfma_f32_16x16x32_bf16 v[92:95], a[104:107], a[212:215], v[92:95]
 ds_read_b64_tr_b16 a[90:91], v8 offset:4096
 v_mul_f32 v62, s34, v62
 v_mfma_f32_16x16x32_bf16 v[92:95], a[108:111], a[220:223], v[92:95]
 ds_read_b64_tr_b16 a[92:93], v8 offset:16384
 v_mul_f32 v63, s34, v63
 v_mfma_f32_16x16x32_bf16 v[92:95], a[64:67], a[116:119], v[92:95]
 ds_read_b64_tr_b16 a[94:95], v8 offset:20480
 v_xor_b32 v9, 131264, v6
 v_mfma_f32_16x16x32_bf16 v[92:95], a[68:71], a[124:127], v[92:95]
 s_waitcnt lgkmcnt(6)
 ds_read_b64_tr_b16 a[96:97], v9 offset:0
 v_cvt_pk_bf16_f32 v44, v44, v45
 v_mfma_f32_16x16x32_bf16 v[100:103], a[72:75], a[192:195], v[100:103]
 ds_read_b64_tr_b16 a[98:99], v9 offset:4096
 v_cvt_pk_bf16_f32 v45, v46, v47
 v_mfma_f32_16x16x32_bf16 v[100:103], a[76:79], a[200:203], v[100:103]
 ds_read_b64_tr_b16 a[100:101], v9 offset:16384
 v_cvt_pk_bf16_f32 v46, v60, v61
 v_mfma_f32_16x16x32_bf16 v[100:103], a[80:83], a[208:211], v[100:103]
 s_waitcnt lgkmcnt(3)
 ds_read_b64_tr_b16 a[102:103], v9 offset:20480
 v_xor_b32 v10, 192, v6
 v_mfma_f32_16x16x32_bf16 v[100:103], a[84:87], a[216:219], v[100:103]
 s_add_u32 s59, s62, 32768
 ds_read_b64_tr_b16 a[104:105], v10 offset:0
 v_cvt_pk_bf16_f32 v47, v62, v63
 v_mfma_f32_16x16x32_bf16 v[100:103], a[88:91], a[112:115], v[100:103]
 ds_read_b64_tr_b16 a[106:107], v10 offset:4096
 buffer_store_dwordx4 v[44:47], v1, s[12:15], s59 offen offset:0 sc1
 v_mfma_f32_16x16x32_bf16 v[100:103], a[92:95], a[120:123], v[100:103]
 ds_read_b64_tr_b16 a[108:109], v10 offset:16384
 v_accvgpr_write_b32 a32, v44
 v_mfma_f32_16x16x32_bf16 v[108:111], a[72:75], a[196:199], v[108:111]
 ds_read_b64_tr_b16 a[110:111], v10 offset:20480
 v_xor_b32 v7, 65728, v6
 v_mfma_f32_16x16x32_bf16 v[108:111], a[76:79], a[204:207], v[108:111]
 ds_read_b64_tr_b16 a[64:65], v7 offset:0
 v_accvgpr_write_b32 a33, v45
 v_mfma_f32_16x16x32_bf16 v[108:111], a[80:83], a[212:215], v[108:111]
 ds_read_b64_tr_b16 a[66:67], v7 offset:4096
 v_accvgpr_write_b32 a34, v46
 v_mfma_f32_16x16x32_bf16 v[108:111], a[84:87], a[220:223], v[108:111]
 ds_read_b64_tr_b16 a[68:69], v7 offset:16384
 v_accvgpr_write_b32 a35, v47
 v_mfma_f32_16x16x32_bf16 v[108:111], a[88:91], a[116:119], v[108:111]
 ds_read_b64_tr_b16 a[70:71], v7 offset:20480
 v_xor_b32 v8, 131296, v6
 v_mfma_f32_16x16x32_bf16 v[108:111], a[92:95], a[124:127], v[108:111]
 s_waitcnt lgkmcnt(6)
 ds_read_b64_tr_b16 a[72:73], v8 offset:0
 v_mul_f32 v20, s34, v20
 v_mfma_f32_16x16x32_bf16 v[116:119], a[96:99], a[192:195], v[116:119]
 ds_read_b64_tr_b16 a[74:75], v8 offset:4096
 v_mul_f32 v21, s34, v21
 v_mfma_f32_16x16x32_bf16 v[116:119], a[100:103], a[200:203], v[116:119]
 ds_read_b64_tr_b16 a[76:77], v8 offset:16384
 v_mul_f32 v22, s34, v22
 v_mfma_f32_16x16x32_bf16 v[116:119], a[104:107], a[208:211], v[116:119]
 s_waitcnt lgkmcnt(3)
 ds_read_b64_tr_b16 a[78:79], v8 offset:20480
 v_xor_b32 v9, 224, v6
 v_mfma_f32_16x16x32_bf16 v[116:119], a[108:111], a[216:219], v[116:119]
 ds_read_b64_tr_b16 a[80:81], v9 offset:0
 v_mul_f32 v23, s34, v23
 v_mfma_f32_16x16x32_bf16 v[116:119], a[64:67], a[112:115], v[116:119]
 ds_read_b64_tr_b16 a[82:83], v9 offset:4096
 v_mul_f32 v68, s34, v68
 v_mfma_f32_16x16x32_bf16 v[116:119], a[68:71], a[120:123], v[116:119]
 ds_read_b64_tr_b16 a[84:85], v9 offset:16384
 v_mul_f32 v69, s34, v69
 v_mfma_f32_16x16x32_bf16 v[124:127], a[96:99], a[196:199], v[124:127]
 ds_read_b64_tr_b16 a[86:87], v9 offset:20480
 v_xor_b32 v10, 65760, v6
 v_mfma_f32_16x16x32_bf16 v[124:127], a[100:103], a[204:207], v[124:127]
 ds_read_b64_tr_b16 a[88:89], v10 offset:0
 v_mul_f32 v70, s34, v70
 v_mfma_f32_16x16x32_bf16 v[124:127], a[104:107], a[212:215], v[124:127]
 ds_read_b64_tr_b16 a[90:91], v10 offset:4096
 v_mul_f32 v71, s34, v71
 v_mfma_f32_16x16x32_bf16 v[124:127], a[108:111], a[220:223], v[124:127]
 ds_read_b64_tr_b16 a[92:93], v10 offset:16384
 v_cvt_pk_bf16_f32 v20, v20, v21
 v_mfma_f32_16x16x32_bf16 v[124:127], a[64:67], a[116:119], v[124:127]
 ds_read_b64_tr_b16 a[94:95], v10 offset:20480
 v_xor_b32 v7, 131328, v6
 v_mfma_f32_16x16x32_bf16 v[124:127], a[68:71], a[124:127], v[124:127]
 s_waitcnt lgkmcnt(6)
 ds_read_b64_tr_b16 a[96:97], v7 offset:0
 v_cvt_pk_bf16_f32 v21, v22, v23
 v_mfma_f32_16x16x32_bf16 v[132:135], a[72:75], a[192:195], v[132:135]
 ds_read_b64_tr_b16 a[98:99], v7 offset:4096
 v_cvt_pk_bf16_f32 v22, v68, v69
 v_mfma_f32_16x16x32_bf16 v[132:135], a[76:79], a[200:203], v[132:135]
 s_add_u32 s59, s62, 0
 ds_read_b64_tr_b16 a[100:101], v7 offset:16384
 v_cvt_pk_bf16_f32 v23, v70, v71
 v_mfma_f32_16x16x32_bf16 v[132:135], a[80:83], a[208:211], v[132:135]
 s_waitcnt lgkmcnt(3)
 ds_read_b64_tr_b16 a[102:103], v7 offset:20480
 v_xor_b32 v8, 256, v6
 v_mfma_f32_16x16x32_bf16 v[132:135], a[84:87], a[216:219], v[132:135]
 ds_read_b64_tr_b16 a[104:105], v8 offset:0
 buffer_store_dwordx4 v[20:23], v1, s[12:15], s59 offen offset:1024 sc1
 v_mfma_f32_16x16x32_bf16 v[132:135], a[88:91], a[112:115], v[132:135]
 ds_read_b64_tr_b16 a[106:107], v8 offset:4096
 v_accvgpr_write_b32 a4, v20
 v_mfma_f32_16x16x32_bf16 v[132:135], a[92:95], a[120:123], v[132:135]
 ds_read_b64_tr_b16 a[108:109], v8 offset:16384
 v_accvgpr_write_b32 a5, v21
 v_mfma_f32_16x16x32_bf16 v[140:143], a[72:75], a[196:199], v[140:143]
 ds_read_b64_tr_b16 a[110:111], v8 offset:20480
 v_xor_b32 v9, 65792, v6
 v_mfma_f32_16x16x32_bf16 v[140:143], a[76:79], a[204:207], v[140:143]
 ds_read_b64_tr_b16 a[64:65], v9 offset:0
 v_accvgpr_write_b32 a6, v22
 v_mfma_f32_16x16x32_bf16 v[140:143], a[80:83], a[212:215], v[140:143]
 ds_read_b64_tr_b16 a[66:67], v9 offset:4096
 v_accvgpr_write_b32 a7, v23
 v_mfma_f32_16x16x32_bf16 v[140:143], a[84:87], a[220:223], v[140:143]
 ds_read_b64_tr_b16 a[68:69], v9 offset:16384
 v_mul_f32 v36, s34, v36
 v_mfma_f32_16x16x32_bf16 v[140:143], a[88:91], a[116:119], v[140:143]
 ds_read_b64_tr_b16 a[70:71], v9 offset:20480
 v_xor_b32 v10, 131360, v6
 v_mfma_f32_16x16x32_bf16 v[140:143], a[92:95], a[124:127], v[140:143]
 s_waitcnt lgkmcnt(6)
 ds_read_b64_tr_b16 a[72:73], v10 offset:0
 v_mul_f32 v37, s34, v37
 v_mfma_f32_16x16x32_bf16 v[148:151], a[96:99], a[192:195], v[148:151]
 ds_read_b64_tr_b16 a[74:75], v10 offset:4096
 v_mul_f32 v38, s34, v38
 v_mfma_f32_16x16x32_bf16 v[148:151], a[100:103], a[200:203], v[148:151]
 ds_read_b64_tr_b16 a[76:77], v10 offset:16384
 v_mul_f32 v39, s34, v39
 v_mfma_f32_16x16x32_bf16 v[148:151], a[104:107], a[208:211], v[148:151]
 s_waitcnt lgkmcnt(3)
 ds_read_b64_tr_b16 a[78:79], v10 offset:20480
 v_xor_b32 v7, 288, v6
 v_mfma_f32_16x16x32_bf16 v[148:151], a[108:111], a[216:219], v[148:151]
 ds_read_b64_tr_b16 a[80:81], v7 offset:0
 v_mul_f32 v76, s34, v76
 v_mfma_f32_16x16x32_bf16 v[148:151], a[64:67], a[112:115], v[148:151]
 ds_read_b64_tr_b16 a[82:83], v7 offset:4096
 v_mul_f32 v77, s34, v77
 v_mfma_f32_16x16x32_bf16 v[148:151], a[68:71], a[120:123], v[148:151]
 ds_read_b64_tr_b16 a[84:85], v7 offset:16384
 v_mul_f32 v78, s34, v78
 v_mfma_f32_16x16x32_bf16 v[156:159], a[96:99], a[196:199], v[156:159]
 ds_read_b64_tr_b16 a[86:87], v7 offset:20480
 v_xor_b32 v8, 65824, v6
 v_mfma_f32_16x16x32_bf16 v[156:159], a[100:103], a[204:207], v[156:159]
 ds_read_b64_tr_b16 a[88:89], v8 offset:0
 v_mul_f32 v79, s34, v79
 v_mfma_f32_16x16x32_bf16 v[156:159], a[104:107], a[212:215], v[156:159]
 ds_read_b64_tr_b16 a[90:91], v8 offset:4096
 v_cvt_pk_bf16_f32 v36, v36, v37
 v_mfma_f32_16x16x32_bf16 v[156:159], a[108:111], a[220:223], v[156:159]
 ds_read_b64_tr_b16 a[92:93], v8 offset:16384
 v_cvt_pk_bf16_f32 v37, v38, v39
 v_mfma_f32_16x16x32_bf16 v[156:159], a[64:67], a[116:119], v[156:159]
 ds_read_b64_tr_b16 a[94:95], v8 offset:20480
 v_xor_b32 v9, 131392, v6
 v_mfma_f32_16x16x32_bf16 v[156:159], a[68:71], a[124:127], v[156:159]
 s_waitcnt lgkmcnt(6)
 ds_read_b64_tr_b16 a[96:97], v9 offset:0
 v_cvt_pk_bf16_f32 v38, v76, v77
 v_mfma_f32_16x16x32_bf16 v[164:167], a[72:75], a[192:195], v[164:167]
 s_add_u32 s59, s62, 32768
 ds_read_b64_tr_b16 a[98:99], v9 offset:4096
 v_cvt_pk_bf16_f32 v39, v78, v79
 v_mfma_f32_16x16x32_bf16 v[164:167], a[76:79], a[200:203], v[164:167]
 ds_read_b64_tr_b16 a[100:101], v9 offset:16384
 buffer_store_dwordx4 v[36:39], v1, s[12:15], s59 offen offset:1024 sc1
 v_mfma_f32_16x16x32_bf16 v[164:167], a[80:83], a[208:211], v[164:167]
 s_waitcnt lgkmcnt(3)
 ds_read_b64_tr_b16 a[102:103], v9 offset:20480
 v_xor_b32 v10, 320, v6
 v_mfma_f32_16x16x32_bf16 v[164:167], a[84:87], a[216:219], v[164:167]
 ds_read_b64_tr_b16 a[104:105], v10 offset:0
 v_accvgpr_write_b32 a36, v36
 v_mfma_f32_16x16x32_bf16 v[164:167], a[88:91], a[112:115], v[164:167]
 ds_read_b64_tr_b16 a[106:107], v10 offset:4096
 v_accvgpr_write_b32 a37, v37
 v_mfma_f32_16x16x32_bf16 v[164:167], a[92:95], a[120:123], v[164:167]
 ds_read_b64_tr_b16 a[108:109], v10 offset:16384
 v_accvgpr_write_b32 a38, v38
 v_mfma_f32_16x16x32_bf16 v[172:175], a[72:75], a[196:199], v[172:175]
 ds_read_b64_tr_b16 a[110:111], v10 offset:20480
 v_xor_b32 v7, 65856, v6
 v_mfma_f32_16x16x32_bf16 v[172:175], a[76:79], a[204:207], v[172:175]
 ds_read_b64_tr_b16 a[64:65], v7 offset:0
 v_accvgpr_write_b32 a39, v39
 v_mfma_f32_16x16x32_bf16 v[172:175], a[80:83], a[212:215], v[172:175]
 ds_read_b64_tr_b16 a[66:67], v7 offset:4096
 v_mul_f32 v84, s34, v84
 v_mfma_f32_16x16x32_bf16 v[172:175], a[84:87], a[220:223], v[172:175]
 ds_read_b64_tr_b16 a[68:69], v7 offset:16384
 v_mul_f32 v85, s34, v85
 v_mfma_f32_16x16x32_bf16 v[172:175], a[88:91], a[116:119], v[172:175]
 ds_read_b64_tr_b16 a[70:71], v7 offset:20480
 v_xor_b32 v8, 131424, v6
 v_mfma_f32_16x16x32_bf16 v[172:175], a[92:95], a[124:127], v[172:175]
 s_waitcnt lgkmcnt(6)
 ds_read_b64_tr_b16 a[72:73], v8 offset:0
 v_mul_f32 v86, s34, v86
 v_mfma_f32_16x16x32_bf16 v[180:183], a[96:99], a[192:195], v[180:183]
 ds_read_b64_tr_b16 a[74:75], v8 offset:4096
 v_mul_f32 v87, s34, v87
 v_mfma_f32_16x16x32_bf16 v[180:183], a[100:103], a[200:203], v[180:183]
 ds_read_b64_tr_b16 a[76:77], v8 offset:16384
 v_mul_f32 v100, s34, v100
 v_mfma_f32_16x16x32_bf16 v[180:183], a[104:107], a[208:211], v[180:183]
 s_waitcnt lgkmcnt(3)
 ds_read_b64_tr_b16 a[78:79], v8 offset:20480
 v_xor_b32 v9, 352, v6
 v_mfma_f32_16x16x32_bf16 v[180:183], a[108:111], a[216:219], v[180:183]
 ds_read_b64_tr_b16 a[80:81], v9 offset:0
 v_mul_f32 v101, s34, v101
 v_mfma_f32_16x16x32_bf16 v[180:183], a[64:67], a[112:115], v[180:183]
 ds_read_b64_tr_b16 a[82:83], v9 offset:4096
 v_mul_f32 v102, s34, v102
 v_mfma_f32_16x16x32_bf16 v[180:183], a[68:71], a[120:123], v[180:183]
 ds_read_b64_tr_b16 a[84:85], v9 offset:16384
 v_mul_f32 v103, s34, v103
 v_mfma_f32_16x16x32_bf16 v[188:191], a[96:99], a[196:199], v[188:191]
 ds_read_b64_tr_b16 a[86:87], v9 offset:20480
 v_xor_b32 v10, 65888, v6
 v_mfma_f32_16x16x32_bf16 v[188:191], a[100:103], a[204:207], v[188:191]
 ds_read_b64_tr_b16 a[88:89], v10 offset:0
 v_cvt_pk_bf16_f32 v84, v84, v85
 v_mfma_f32_16x16x32_bf16 v[188:191], a[104:107], a[212:215], v[188:191]
 ds_read_b64_tr_b16 a[90:91], v10 offset:4096
 v_cvt_pk_bf16_f32 v85, v86, v87
 v_mfma_f32_16x16x32_bf16 v[188:191], a[108:111], a[220:223], v[188:191]
 ds_read_b64_tr_b16 a[92:93], v10 offset:16384
 v_cvt_pk_bf16_f32 v86, v100, v101
 v_mfma_f32_16x16x32_bf16 v[188:191], a[64:67], a[116:119], v[188:191]
 s_add_u32 s59, s62, 0
 ds_read_b64_tr_b16 a[94:95], v10 offset:20480
 v_xor_b32 v7, 131456, v6
 v_mfma_f32_16x16x32_bf16 v[188:191], a[68:71], a[124:127], v[188:191]
 s_waitcnt lgkmcnt(6)
 ds_read_b64_tr_b16 a[96:97], v7 offset:0
 v_cvt_pk_bf16_f32 v87, v102, v103
 v_mfma_f32_16x16x32_bf16 v[196:199], a[72:75], a[192:195], v[196:199]
 ds_read_b64_tr_b16 a[98:99], v7 offset:4096
 buffer_store_dwordx4 v[84:87], v1, s[12:15], s59 offen offset:2048 sc1
 v_mfma_f32_16x16x32_bf16 v[196:199], a[76:79], a[200:203], v[196:199]
 ds_read_b64_tr_b16 a[100:101], v7 offset:16384
 v_accvgpr_write_b32 a8, v84
 v_mfma_f32_16x16x32_bf16 v[196:199], a[80:83], a[208:211], v[196:199]
 s_waitcnt lgkmcnt(3)
 ds_read_b64_tr_b16 a[102:103], v7 offset:20480
 v_xor_b32 v8, 384, v6
 v_mfma_f32_16x16x32_bf16 v[196:199], a[84:87], a[216:219], v[196:199]
 ds_read_b64_tr_b16 a[104:105], v8 offset:0
 v_accvgpr_write_b32 a9, v85
 v_mfma_f32_16x16x32_bf16 v[196:199], a[88:91], a[112:115], v[196:199]
 ds_read_b64_tr_b16 a[106:107], v8 offset:4096
 v_accvgpr_write_b32 a10, v86
 v_mfma_f32_16x16x32_bf16 v[196:199], a[92:95], a[120:123], v[196:199]
 ds_read_b64_tr_b16 a[108:109], v8 offset:16384
 v_accvgpr_write_b32 a11, v87
 v_mfma_f32_16x16x32_bf16 v[204:207], a[72:75], a[196:199], v[204:207]
 ds_read_b64_tr_b16 a[110:111], v8 offset:20480
 v_xor_b32 v9, 65920, v6
 v_mfma_f32_16x16x32_bf16 v[204:207], a[76:79], a[204:207], v[204:207]
 ds_read_b64_tr_b16 a[64:65], v9 offset:0
 v_mul_f32 v92, s34, v92
 v_mfma_f32_16x16x32_bf16 v[204:207], a[80:83], a[212:215], v[204:207]
 ds_read_b64_tr_b16 a[66:67], v9 offset:4096
 v_mul_f32 v93, s34, v93
 v_mfma_f32_16x16x32_bf16 v[204:207], a[84:87], a[220:223], v[204:207]
 ds_read_b64_tr_b16 a[68:69], v9 offset:16384
 v_mul_f32 v94, s34, v94
 v_mfma_f32_16x16x32_bf16 v[204:207], a[88:91], a[116:119], v[204:207]
 ds_read_b64_tr_b16 a[70:71], v9 offset:20480
 v_xor_b32 v10, 131488, v6
 v_mfma_f32_16x16x32_bf16 v[204:207], a[92:95], a[124:127], v[204:207]
 s_waitcnt lgkmcnt(6)
 ds_read_b64_tr_b16 a[72:73], v10 offset:0
 v_mul_f32 v95, s34, v95
 v_mfma_f32_16x16x32_bf16 v[212:215], a[96:99], a[192:195], v[212:215]
 ds_read_b64_tr_b16 a[74:75], v10 offset:4096
 v_mul_f32 v108, s34, v108
 v_mfma_f32_16x16x32_bf16 v[212:215], a[100:103], a[200:203], v[212:215]
 ds_read_b64_tr_b16 a[76:77], v10 offset:16384
 v_mul_f32 v109, s34, v109
 v_mfma_f32_16x16x32_bf16 v[212:215], a[104:107], a[208:211], v[212:215]
 s_waitcnt lgkmcnt(3)
 ds_read_b64_tr_b16 a[78:79], v10 offset:20480
 v_xor_b32 v7, 416, v6
 v_mfma_f32_16x16x32_bf16 v[212:215], a[108:111], a[216:219], v[212:215]
 ds_read_b64_tr_b16 a[80:81], v7 offset:0
 v_mul_f32 v110, s34, v110
 v_mfma_f32_16x16x32_bf16 v[212:215], a[64:67], a[112:115], v[212:215]
 ds_read_b64_tr_b16 a[82:83], v7 offset:4096
 v_mul_f32 v111, s34, v111
 v_mfma_f32_16x16x32_bf16 v[212:215], a[68:71], a[120:123], v[212:215]
 ds_read_b64_tr_b16 a[84:85], v7 offset:16384
 v_cvt_pk_bf16_f32 v92, v92, v93
 v_mfma_f32_16x16x32_bf16 v[220:223], a[96:99], a[196:199], v[220:223]
 ds_read_b64_tr_b16 a[86:87], v7 offset:20480
 v_xor_b32 v8, 65952, v6
 v_mfma_f32_16x16x32_bf16 v[220:223], a[100:103], a[204:207], v[220:223]
 ds_read_b64_tr_b16 a[88:89], v8 offset:0
 v_cvt_pk_bf16_f32 v93, v94, v95
 v_mfma_f32_16x16x32_bf16 v[220:223], a[104:107], a[212:215], v[220:223]
 ds_read_b64_tr_b16 a[90:91], v8 offset:4096
 v_cvt_pk_bf16_f32 v94, v108, v109
 v_mfma_f32_16x16x32_bf16 v[220:223], a[108:111], a[220:223], v[220:223]
 ds_read_b64_tr_b16 a[92:93], v8 offset:16384
 v_cvt_pk_bf16_f32 v95, v110, v111
 v_mfma_f32_16x16x32_bf16 v[220:223], a[64:67], a[116:119], v[220:223]
 s_add_u32 s59, s62, 32768
 ds_read_b64_tr_b16 a[94:95], v8 offset:20480
 v_xor_b32 v9, 131520, v6
 v_mfma_f32_16x16x32_bf16 v[220:223], a[68:71], a[124:127], v[220:223]
 s_waitcnt lgkmcnt(6)
 ds_read_b64_tr_b16 a[96:97], v9 offset:0
 buffer_store_dwordx4 v[92:95], v1, s[12:15], s59 offen offset:2048 sc1
 v_mfma_f32_16x16x32_bf16 v[228:231], a[72:75], a[192:195], v[228:231]
 ds_read_b64_tr_b16 a[98:99], v9 offset:4096
 v_accvgpr_write_b32 a40, v92
 v_mfma_f32_16x16x32_bf16 v[228:231], a[76:79], a[200:203], v[228:231]
 ds_read_b64_tr_b16 a[100:101], v9 offset:16384
 v_accvgpr_write_b32 a41, v93
 v_mfma_f32_16x16x32_bf16 v[228:231], a[80:83], a[208:211], v[228:231]
 s_waitcnt lgkmcnt(3)
 ds_read_b64_tr_b16 a[102:103], v9 offset:20480
 v_xor_b32 v10, 448, v6
 v_mfma_f32_16x16x32_bf16 v[228:231], a[84:87], a[216:219], v[228:231]
 ds_read_b64_tr_b16 a[104:105], v10 offset:0
 v_accvgpr_write_b32 a42, v94
 v_mfma_f32_16x16x32_bf16 v[228:231], a[88:91], a[112:115], v[228:231]
 ds_read_b64_tr_b16 a[106:107], v10 offset:4096
 v_accvgpr_write_b32 a43, v95
 v_mfma_f32_16x16x32_bf16 v[228:231], a[92:95], a[120:123], v[228:231]
 ds_read_b64_tr_b16 a[108:109], v10 offset:16384
 v_mul_f32 v116, s34, v116
 v_mfma_f32_16x16x32_bf16 v[236:239], a[72:75], a[196:199], v[236:239]
 ds_read_b64_tr_b16 a[110:111], v10 offset:20480
 v_xor_b32 v7, 65984, v6
 v_mfma_f32_16x16x32_bf16 v[236:239], a[76:79], a[204:207], v[236:239]
 ds_read_b64_tr_b16 a[64:65], v7 offset:0
 buffer_load_dword v13, v12, s[12:15], s58 offen sc1
 v_mfma_f32_16x16x32_bf16 v[236:239], a[80:83], a[212:215], v[236:239]
 ds_read_b64_tr_b16 a[66:67], v7 offset:4096
 v_mul_f32 v117, s34, v117
 v_mfma_f32_16x16x32_bf16 v[236:239], a[84:87], a[220:223], v[236:239]
 ds_read_b64_tr_b16 a[68:69], v7 offset:16384
 v_mul_f32 v118, s34, v118
 v_mfma_f32_16x16x32_bf16 v[236:239], a[88:91], a[116:119], v[236:239]
 ds_read_b64_tr_b16 a[70:71], v7 offset:20480
 v_xor_b32 v8, 131552, v6
 v_mfma_f32_16x16x32_bf16 v[236:239], a[92:95], a[124:127], v[236:239]
 s_waitcnt lgkmcnt(6)
 ds_read_b64_tr_b16 a[72:73], v8 offset:0
 v_mul_f32 v119, s34, v119
 v_mfma_f32_16x16x32_bf16 v[244:247], a[96:99], a[192:195], v[244:247]
 ds_read_b64_tr_b16 a[74:75], v8 offset:4096
 v_mul_f32 v132, s34, v132
 v_mfma_f32_16x16x32_bf16 v[244:247], a[100:103], a[200:203], v[244:247]
 ds_read_b64_tr_b16 a[76:77], v8 offset:16384
 v_mul_f32 v133, s34, v133
 v_mfma_f32_16x16x32_bf16 v[244:247], a[104:107], a[208:211], v[244:247]
 s_waitcnt lgkmcnt(3)
 ds_read_b64_tr_b16 a[78:79], v8 offset:20480
 v_xor_b32 v9, 480, v6
 v_mfma_f32_16x16x32_bf16 v[244:247], a[108:111], a[216:219], v[244:247]
 ds_read_b64_tr_b16 a[80:81], v9 offset:0
 v_mul_f32 v134, s34, v134
 v_mfma_f32_16x16x32_bf16 v[244:247], a[64:67], a[112:115], v[244:247]
 ds_read_b64_tr_b16 a[82:83], v9 offset:4096
 v_mul_f32 v135, s34, v135
 v_mfma_f32_16x16x32_bf16 v[244:247], a[68:71], a[120:123], v[244:247]
 ds_read_b64_tr_b16 a[84:85], v9 offset:16384
 v_cvt_pk_bf16_f32 v116, v116, v117
 v_mfma_f32_16x16x32_bf16 v[252:255], a[96:99], a[196:199], v[252:255]
 ds_read_b64_tr_b16 a[86:87], v9 offset:20480
 v_xor_b32 v10, 66016, v6
 v_mfma_f32_16x16x32_bf16 v[252:255], a[100:103], a[204:207], v[252:255]
 ds_read_b64_tr_b16 a[88:89], v10 offset:0
 v_cvt_pk_bf16_f32 v117, v118, v119
 v_mfma_f32_16x16x32_bf16 v[252:255], a[104:107], a[212:215], v[252:255]
 ds_read_b64_tr_b16 a[90:91], v10 offset:4096
 v_cvt_pk_bf16_f32 v118, v132, v133
 v_mfma_f32_16x16x32_bf16 v[252:255], a[108:111], a[220:223], v[252:255]
 s_add_u32 s59, s62, 0
 ds_read_b64_tr_b16 a[92:93], v10 offset:16384
 v_cvt_pk_bf16_f32 v119, v134, v135
 v_mfma_f32_16x16x32_bf16 v[252:255], a[64:67], a[116:119], v[252:255]
 ds_read_b64_tr_b16 a[94:95], v10 offset:20480
 buffer_store_dwordx4 v[116:119], v1, s[12:15], s59 offen offset:3072 sc1
 v_mfma_f32_16x16x32_bf16 v[252:255], a[68:71], a[124:127], v[252:255]
 s_waitcnt lgkmcnt(6)
 v_accvgpr_write_b32 a12, v116
 v_accvgpr_write_b32 a13, v117
 v_mfma_f32_16x16x32_bf16 v[16:19], a[72:75], a[192:195], v[16:19]
 v_accvgpr_write_b32 a14, v118
 v_accvgpr_write_b32 a15, v119
 v_mfma_f32_16x16x32_bf16 v[16:19], a[76:79], a[200:203], v[16:19]
 v_mfma_f32_16x16x32_bf16 v[16:19], a[80:83], a[208:211], v[16:19]
 s_waitcnt lgkmcnt(0)
 v_mfma_f32_16x16x32_bf16 v[16:19], a[84:87], a[216:219], v[16:19]
 v_mfma_f32_16x16x32_bf16 v[16:19], a[88:91], a[112:115], v[16:19]
 v_mfma_f32_16x16x32_bf16 v[16:19], a[92:95], a[120:123], v[16:19]
 v_mfma_f32_16x16x32_bf16 v[24:27], a[72:75], a[196:199], v[24:27]
 v_mfma_f32_16x16x32_bf16 v[24:27], a[76:79], a[204:207], v[24:27]
 v_mfma_f32_16x16x32_bf16 v[24:27], a[80:83], a[212:215], v[24:27]
 v_mfma_f32_16x16x32_bf16 v[24:27], a[84:87], a[220:223], v[24:27]
 s_waitcnt lgkmcnt(0)
 v_mfma_f32_16x16x32_bf16 v[24:27], a[88:91], a[116:119], v[24:27]
 s_barrier
 v_mfma_f32_16x16x32_bf16 v[24:27], a[92:95], a[124:127], v[24:27]
 s_waitcnt vmcnt(1)
 v_cmp_ne_u32 s[16:17], 0, v13
 v_cmp_gt_u32 vcc, 256, v5
 s_or_b64 vcc, vcc, s[16:17]
 s_mov_b32 m0, s40
 s_cselect_b32 s48, 0, 1
 s_cselect_b32 s52, 2.0, s42
 buffer_load_dwordx4 v1, s[12:15], s52 offen offset:0 sc1 lds
 v_pk_mul_f32 v[124:125], v[124:125], s[34:35]
 v_pk_mul_f32 v[126:127], v[126:127], s[34:35]
 v_pk_mul_f32 v[140:141], v[140:141], s[34:35]
 v_pk_mul_f32 v[142:143], v[142:143], s[34:35]
 v_cvt_pk_bf16_f32 v124, v124, v125
 v_cvt_pk_bf16_f32 v125, v126, v127
 v_cvt_pk_bf16_f32 v126, v140, v141
 v_cvt_pk_bf16_f32 v127, v142, v143
 s_add_u32 s59, s62, 32768
 buffer_store_dwordx4 v[124:127], v1, s[12:15], s59 offen offset:3072 sc1
 v_accvgpr_write_b32 a44, v124
 v_accvgpr_write_b32 a45, v125
 v_accvgpr_write_b32 a46, v126
 v_accvgpr_write_b32 a47, v127
 v_pk_mul_f32 v[148:149], v[148:149], s[34:35]
 v_pk_mul_f32 v[150:151], v[150:151], s[34:35]
 buffer_load_dwordx4 v1, s[12:15], s52 offen offset:1024 sc1 lds
 v_pk_mul_f32 v[164:165], v[164:165], s[34:35]
 v_pk_mul_f32 v[166:167], v[166:167], s[34:35]
 v_cvt_pk_bf16_f32 v148, v148, v149
 v_cvt_pk_bf16_f32 v149, v150, v151
 v_cvt_pk_bf16_f32 v150, v164, v165
 v_cvt_pk_bf16_f32 v151, v166, v167
 s_add_u32 s59, s62, 4096
 buffer_store_dwordx4 v[148:151], v1, s[12:15], s59 offen offset:0 sc1
 v_accvgpr_write_b32 a16, v148
 v_accvgpr_write_b32 a17, v149
 v_accvgpr_write_b32 a18, v150
 v_accvgpr_write_b32 a19, v151
 v_pk_mul_f32 v[156:157], v[156:157], s[34:35]
 v_pk_mul_f32 v[158:159], v[158:159], s[34:35]
 v_pk_mul_f32 v[172:173], v[172:173], s[34:35]
 v_pk_mul_f32 v[174:175], v[174:175], s[34:35]
 buffer_load_dwordx4 v1, s[12:15], s52 offen offset:2048 sc1 lds
 v_cvt_pk_bf16_f32 v156, v156, v157
 v_cvt_pk_bf16_f32 v157, v158, v159
 v_cvt_pk_bf16_f32 v158, v172, v173
 v_cvt_pk_bf16_f32 v159, v174, v175
 s_add_u32 s59, s62, 36864
 buffer_store_dwordx4 v[156:159], v1, s[12:15], s59 offen offset:0 sc1
 v_accvgpr_write_b32 a48, v156
 v_accvgpr_write_b32 a49, v157
 v_accvgpr_write_b32 a50, v158
 v_accvgpr_write_b32 a51, v159
 v_pk_mul_f32 v[180:181], v[180:181], s[34:35]
 v_pk_mul_f32 v[182:183], v[182:183], s[34:35]
 v_pk_mul_f32 v[196:197], v[196:197], s[34:35]
 v_pk_mul_f32 v[198:199], v[198:199], s[34:35]
 v_cvt_pk_bf16_f32 v180, v180, v181
 v_cvt_pk_bf16_f32 v181, v182, v183
 buffer_load_dwordx4 v1, s[12:15], s52 offen offset:3072 sc1 lds
 v_cvt_pk_bf16_f32 v182, v196, v197
 v_cvt_pk_bf16_f32 v183, v198, v199
 s_add_u32 s59, s62, 4096
 buffer_store_dwordx4 v[180:183], v1, s[12:15], s59 offen offset:1024 sc1
 v_accvgpr_write_b32 a20, v180
 v_accvgpr_write_b32 a21, v181
 v_accvgpr_write_b32 a22, v182
 v_accvgpr_write_b32 a23, v183
 v_pk_mul_f32 v[188:189], v[188:189], s[34:35]
 v_pk_mul_f32 v[190:191], v[190:191], s[34:35]
 v_pk_mul_f32 v[204:205], v[204:205], s[34:35]
 v_pk_mul_f32 v[206:207], v[206:207], s[34:35]
 v_cvt_pk_bf16_f32 v188, v188, v189
 v_cvt_pk_bf16_f32 v189, v190, v191
 v_cvt_pk_bf16_f32 v190, v204, v205
 s_bitset1_b32 m0, 12
 s_nop 0
 buffer_load_dwordx4 v4, s[12:15], s52 offen offset:0 sc1 lds
 v_cvt_pk_bf16_f32 v191, v206, v207
 s_add_u32 s59, s62, 36864
 buffer_store_dwordx4 v[188:191], v1, s[12:15], s59 offen offset:1024 sc1
 v_accvgpr_write_b32 a52, v188
 v_accvgpr_write_b32 a53, v189
 v_accvgpr_write_b32 a54, v190
 v_accvgpr_write_b32 a55, v191
 v_pk_mul_f32 v[212:213], v[212:213], s[34:35]
 v_pk_mul_f32 v[214:215], v[214:215], s[34:35]
 v_pk_mul_f32 v[228:229], v[228:229], s[34:35]
 v_pk_mul_f32 v[230:231], v[230:231], s[34:35]
 v_cvt_pk_bf16_f32 v212, v212, v213
 v_cvt_pk_bf16_f32 v213, v214, v215
 v_cvt_pk_bf16_f32 v214, v228, v229
 v_cvt_pk_bf16_f32 v215, v230, v231
 s_add_u32 s59, s62, 4096
 buffer_load_dwordx4 v4, s[12:15], s52 offen offset:1024 sc1 lds
 buffer_store_dwordx4 v[212:215], v1, s[12:15], s59 offen offset:2048 sc1
 v_accvgpr_write_b32 a24, v212
 v_accvgpr_write_b32 a25, v213
 v_accvgpr_write_b32 a26, v214
 v_accvgpr_write_b32 a27, v215
 v_pk_mul_f32 v[220:221], v[220:221], s[34:35]
 v_pk_mul_f32 v[222:223], v[222:223], s[34:35]
 v_pk_mul_f32 v[236:237], v[236:237], s[34:35]
 v_pk_mul_f32 v[238:239], v[238:239], s[34:35]
 v_cvt_pk_bf16_f32 v220, v220, v221
 v_cvt_pk_bf16_f32 v221, v222, v223
 v_cvt_pk_bf16_f32 v222, v236, v237
 v_cvt_pk_bf16_f32 v223, v238, v239
 s_add_u32 s59, s62, 36864
 buffer_store_dwordx4 v[220:223], v1, s[12:15], s59 offen offset:2048 sc1
 v_accvgpr_write_b32 a56, v220
 buffer_load_dwordx4 v4, s[12:15], s52 offen offset:2048 sc1 lds
 v_accvgpr_write_b32 a57, v221
 v_accvgpr_write_b32 a58, v222
 v_accvgpr_write_b32 a59, v223
 v_pk_mul_f32 v[244:245], v[244:245], s[34:35]
 v_pk_mul_f32 v[246:247], v[246:247], s[34:35]
 v_pk_mul_f32 v[16:17], v[16:17], s[34:35]
 v_pk_mul_f32 v[18:19], v[18:19], s[34:35]
 v_cvt_pk_bf16_f32 v244, v244, v245
 v_cvt_pk_bf16_f32 v245, v246, v247
 v_cvt_pk_bf16_f32 v246, v16, v17
 v_cvt_pk_bf16_f32 v247, v18, v19
 s_add_u32 s59, s62, 4096
 buffer_store_dwordx4 v[244:247], v1, s[12:15], s59 offen offset:3072 sc1
 v_accvgpr_write_b32 a28, v244
 v_accvgpr_write_b32 a29, v245
 v_accvgpr_write_b32 a30, v246
 buffer_load_dwordx4 v4, s[12:15], s52 offen offset:3072 sc1 lds
 v_accvgpr_write_b32 a31, v247
 v_pk_mul_f32 v[252:253], v[252:253], s[34:35]
 v_pk_mul_f32 v[254:255], v[254:255], s[34:35]
 v_pk_mul_f32 v[24:25], v[24:25], s[34:35]
 v_pk_mul_f32 v[26:27], v[26:27], s[34:35]
 v_cvt_pk_bf16_f32 v252, v252, v253
 v_cvt_pk_bf16_f32 v253, v254, v255
 v_cvt_pk_bf16_f32 v254, v24, v25
 v_cvt_pk_bf16_f32 v255, v26, v27
 s_add_u32 s59, s62, 36864
 buffer_store_dwordx4 v[252:255], v1, s[12:15], s59 offen offset:3072 sc1
 v_accvgpr_write_b32 a60, v252
 v_accvgpr_write_b32 a61, v253
 v_accvgpr_write_b32 a62, v254
 v_accvgpr_write_b32 a63, v255
 s_branch L_kvdone
L_late1:
 v_mfma_f32_16x16x32_bf16 v[16:19], a[96:99], a[0:3], v[16:19]
 ds_read_b64_tr_b16 a[24:25], v9 offset:32768
 v_mfma_f32_16x16x32_bf16 v[16:19], a[100:103], a[4:7], v[16:19]
 s_add_u32 m0, s33, 0xfffffd00
 ds_read_b64_tr_b16 a[26:27], v9 offset:36864
 v_mfma_f32_16x16x32_bf16 v[20:23], a[108:111], a[4:7], v[20:23]
 s_waitcnt lgkmcnt(13)
 ds_read_b64_tr_b16 a[28:29], v9 offset:49152
 v_mfma_f32_16x16x32_bf16 v[20:23], a[104:107], a[0:3], v[20:23]
 ds_read_b64_tr_b16 a[30:31], v9 offset:53248
 buffer_load_dwordx4 v15, s[20:23], 0 offen offset:768 lds
 v_mfma_f32_16x16x32_bf16 v[24:27], a[112:115], a[0:3], v[24:27]
 s_waitcnt lgkmcnt(12)
 ds_read_b128 a[64:67], v4 offset:32768
 v_mfma_f32_16x16x32_bf16 v[24:27], a[116:119], a[4:7], v[24:27]
 v_mfma_f32_16x16x32_bf16 v[28:31], a[124:127], a[4:7], v[28:31]
 s_add_u32 m0, s33, 0xfffffd80
 ds_read_b128 a[68:71], v5 offset:32768
 v_mfma_f32_16x16x32_bf16 v[28:31], a[120:123], a[0:3], v[28:31]
 s_waitcnt lgkmcnt(10)
 buffer_load_dwordx4 v15, s[20:23], 0 offen offset:1664 lds
 v_mfma_f32_16x16x32_bf16 a[228:231], a[120:123], a[8:11], a[228:231]
 ds_read_b128 a[76:79], v5 offset:34816
 v_mfma_f32_16x16x32_bf16 a[228:231], a[124:127], a[12:15], a[228:231]
 v_mfma_f32_16x16x32_bf16 a[224:227], a[116:119], a[12:15], a[224:227]
 s_add_u32 m0, s33, 0x500
 ds_read_b128 a[72:75], v4 offset:34816
 v_mfma_f32_16x16x32_bf16 a[224:227], a[112:115], a[8:11], a[224:227]
 buffer_load_dwordx4 v15, s[20:23], s57 offen offset:768 lds
 v_mfma_f32_16x16x32_bf16 a[236:239], a[104:107], a[8:11], a[236:239]
 ds_read_b128 a[80:83], v4 offset:36864
 v_cvt_pk_bf16_f32 v16, v16, v17
 v_mfma_f32_16x16x32_bf16 a[236:239], a[108:111], a[12:15], a[236:239]
 v_cvt_pk_bf16_f32 v17, v18, v19
 v_cvt_pk_bf16_f32 v18, v20, v21
 v_mfma_f32_16x16x32_bf16 a[232:235], a[100:103], a[12:15], a[232:235]
 s_add_u32 m0, s33, 0x580
 ds_read_b128 a[84:87], v5 offset:36864
 v_cvt_pk_bf16_f32 v19, v22, v23
 v_mfma_f32_16x16x32_bf16 a[232:235], a[96:99], a[8:11], a[232:235]
 s_waitcnt lgkmcnt(10)
 buffer_load_dwordx4 v15, s[20:23], s57 offen offset:1664 lds
 v_mfma_f32_16x16x32_bf16 v[32:35], a[96:99], a[16:19], v[32:35]
 ds_read_b128 a[92:95], v5 offset:38912
 v_cvt_pk_bf16_f32 v24, v24, v25
 v_mfma_f32_16x16x32_bf16 v[32:35], a[100:103], a[20:23], v[32:35]
 v_cvt_pk_bf16_f32 v25, v26, v27
 v_cvt_pk_bf16_f32 v26, v28, v29
 v_mfma_f32_16x16x32_bf16 v[36:39], a[108:111], a[20:23], v[36:39]
 ds_read_b128 a[88:91], v4 offset:38912
 v_cvt_pk_bf16_f32 v27, v30, v31
 v_mfma_f32_16x16x32_bf16 v[36:39], a[104:107], a[16:19], v[36:39]
 v_accvgpr_read_b32 v20, a224
 v_accvgpr_read_b32 v21, a225
 v_mfma_f32_16x16x32_bf16 v[40:43], a[112:115], a[16:19], v[40:43]
 ds_read_b64_tr_b16 a[32:33], v10 offset:32768
 v_accvgpr_read_b32 v22, a226
 v_mfma_f32_16x16x32_bf16 v[40:43], a[116:119], a[20:23], v[40:43]
 ds_read_b64_tr_b16 a[34:35], v10 offset:36864
 v_accvgpr_read_b32 v23, a227
 v_mfma_f32_16x16x32_bf16 v[44:47], a[124:127], a[20:23], v[44:47]
 s_add_u32 s59, s56, 32768
 ds_read_b64_tr_b16 a[36:37], v10 offset:49152
 v_accvgpr_read_b32 v28, a228
 v_mfma_f32_16x16x32_bf16 v[44:47], a[120:123], a[16:19], v[44:47]
 s_waitcnt lgkmcnt(11)
 ds_read_b64_tr_b16 a[38:39], v10 offset:53248
 v_accvgpr_read_b32 v29, a229
 v_mfma_f32_16x16x32_bf16 v[52:55], a[120:123], a[24:27], v[52:55]
 ds_read_b64_tr_b16 a[40:41], v11 offset:32768
 buffer_store_dwordx4 v[16:19], v1, s[12:15], s59 offen offset:0 sc1
 v_mfma_f32_16x16x32_bf16 v[52:55], a[124:127], a[28:31], v[52:55]
 ds_read_b64_tr_b16 a[42:43], v11 offset:36864
 v_accvgpr_read_b32 v30, a230
 v_mfma_f32_16x16x32_bf16 v[48:51], a[116:119], a[28:31], v[48:51]
 ds_read_b64_tr_b16 a[44:45], v11 offset:49152
 v_accvgpr_read_b32 v31, a231
 v_mfma_f32_16x16x32_bf16 v[48:51], a[112:115], a[24:27], v[48:51]
 ds_read_b64_tr_b16 a[46:47], v11 offset:53248
 v_cvt_pk_bf16_f32 v20, v20, v21
 v_mfma_f32_16x16x32_bf16 v[60:63], a[104:107], a[24:27], v[60:63]
 ds_read_b64_tr_b16 a[48:49], v12 offset:32768
 v_cvt_pk_bf16_f32 v21, v22, v23
 v_mfma_f32_16x16x32_bf16 v[60:63], a[108:111], a[28:31], v[60:63]
 ds_read_b64_tr_b16 a[50:51], v12 offset:36864
 v_cvt_pk_bf16_f32 v22, v28, v29
 v_mfma_f32_16x16x32_bf16 v[56:59], a[100:103], a[28:31], v[56:59]
 s_add_u32 s59, s56, 49152
 ds_read_b64_tr_b16 a[52:53], v12 offset:49152
 v_cvt_pk_bf16_f32 v23, v30, v31
 v_mfma_f32_16x16x32_bf16 v[56:59], a[96:99], a[24:27], v[56:59]
 s_waitcnt lgkmcnt(15)
 ds_read_b64_tr_b16 a[54:55], v12 offset:53248
 buffer_store_dwordx4 v[24:27], v1, s[12:15], s59 offen offset:0 sc1
 v_mfma_f32_16x16x32_bf16 v[64:67], a[64:67], a[0:3], v[64:67]
 ds_read_b64_tr_b16 a[56:57], v13 offset:32768
 v_cvt_pk_bf16_f32 v32, v32, v33
 v_mfma_f32_16x16x32_bf16 v[64:67], a[68:71], a[4:7], v[64:67]
 ds_read_b64_tr_b16 a[58:59], v13 offset:36864
 v_cvt_pk_bf16_f32 v33, v34, v35
 v_mfma_f32_16x16x32_bf16 v[68:71], a[76:79], a[4:7], v[68:71]
 ds_read_b64_tr_b16 a[60:61], v13 offset:49152
 v_cvt_pk_bf16_f32 v34, v36, v37
 v_mfma_f32_16x16x32_bf16 v[68:71], a[72:75], a[0:3], v[68:71]
 s_waitcnt lgkmcnt(15)
 ds_read_b64_tr_b16 a[62:63], v13 offset:53248
 v_cvt_pk_bf16_f32 v35, v38, v39
 v_mfma_f32_16x16x32_bf16 v[72:75], a[80:83], a[0:3], v[72:75]
 v_cvt_pk_bf16_f32 v40, v40, v41
 v_cvt_pk_bf16_f32 v41, v42, v43
 v_mfma_f32_16x16x32_bf16 v[72:75], a[84:87], a[4:7], v[72:75]
 s_add_u32 s59, s56, 49152
 v_cvt_pk_bf16_f32 v42, v44, v45
 v_cvt_pk_bf16_f32 v43, v46, v47
 v_mfma_f32_16x16x32_bf16 v[76:79], a[92:95], a[4:7], v[76:79]
 buffer_store_dwordx4 v[20:23], v1, s[12:15], s59 offen offset:1024 sc1
 v_mfma_f32_16x16x32_bf16 v[76:79], a[88:91], a[0:3], v[76:79]
 s_waitcnt lgkmcnt(0)
 v_accvgpr_read_b32 v36, a232
 v_accvgpr_read_b32 v37, a233
 v_mfma_f32_16x16x32_bf16 v[84:87], a[88:91], a[8:11], v[84:87]
 s_barrier
 v_xor_b32 v6, s60, v6
 v_accvgpr_read_b32 v38, a234
 v_mfma_f32_16x16x32_bf16 v[84:87], a[92:95], a[12:15], v[84:87]
 s_add_u32 m0, s29, 32768
 v_add_u32 v2, 0x80000, v2
 v_accvgpr_read_b32 v39, a235
 v_mfma_f32_16x16x32_bf16 v[80:83], a[84:87], a[12:15], v[80:83]
 buffer_load_dwordx4 v2, s[16:19], 0 offen lds
 v_mfma_f32_16x16x32_bf16 v[80:83], a[80:83], a[8:11], v[80:83]
 v_accvgpr_read_b32 v44, a236
 v_accvgpr_read_b32 v45, a237
 v_mfma_f32_16x16x32_bf16 v[92:95], a[72:75], a[8:11], v[92:95]
 v_accvgpr_read_b32 v46, a238
 v_accvgpr_read_b32 v47, a239
 v_mfma_f32_16x16x32_bf16 v[92:95], a[76:79], a[12:15], v[92:95]
 v_cvt_pk_bf16_f32 v36, v36, v37
 v_cvt_pk_bf16_f32 v37, v38, v39
 v_mfma_f32_16x16x32_bf16 v[88:91], a[68:71], a[12:15], v[88:91]
 s_add_u32 m0, s29, 36864
 v_cvt_pk_bf16_f32 v38, v44, v45
 v_cvt_pk_bf16_f32 v39, v46, v47
 v_mfma_f32_16x16x32_bf16 v[88:91], a[64:67], a[8:11], v[88:91]
 buffer_load_dwordx4 v2, s[16:19], s48 offen lds
 v_mfma_f32_16x16x32_bf16 v[96:99], a[64:67], a[16:19], v[96:99]
 v_cvt_pk_bf16_f32 v48, v48, v49
 v_cvt_pk_bf16_f32 v49, v50, v51
 v_mfma_f32_16x16x32_bf16 v[96:99], a[68:71], a[20:23], v[96:99]
 v_cvt_pk_bf16_f32 v50, v52, v53
 v_cvt_pk_bf16_f32 v51, v54, v55
 v_mfma_f32_16x16x32_bf16 v[100:103], a[76:79], a[20:23], v[100:103]
 v_cvt_pk_bf16_f32 v56, v56, v57
 v_cvt_pk_bf16_f32 v57, v58, v59
 v_mfma_f32_16x16x32_bf16 v[100:103], a[72:75], a[16:19], v[100:103]
 s_add_u32 m0, s29, 40960
 v_cvt_pk_bf16_f32 v58, v60, v61
 v_cvt_pk_bf16_f32 v59, v62, v63
 v_mfma_f32_16x16x32_bf16 v[104:107], a[80:83], a[16:19], v[104:107]
 buffer_load_dwordx4 v2, s[16:19], s49 offen lds
 v_mfma_f32_16x16x32_bf16 v[104:107], a[84:87], a[20:23], v[104:107]
 v_cvt_pk_bf16_f32 v64, v64, v65
 v_cvt_pk_bf16_f32 v65, v66, v67
 v_mfma_f32_16x16x32_bf16 v[108:111], a[92:95], a[20:23], v[108:111]
 v_cvt_pk_bf16_f32 v66, v68, v69
 v_cvt_pk_bf16_f32 v67, v70, v71
 v_mfma_f32_16x16x32_bf16 v[108:111], a[88:91], a[16:19], v[108:111]
 v_cvt_pk_bf16_f32 v72, v72, v73
 v_cvt_pk_bf16_f32 v73, v74, v75
 v_mfma_f32_16x16x32_bf16 v[116:119], a[88:91], a[24:27], v[116:119]
 s_add_u32 m0, s29, 45056
 v_cvt_pk_bf16_f32 v74, v76, v77
 v_cvt_pk_bf16_f32 v75, v78, v79
 v_mfma_f32_16x16x32_bf16 v[116:119], a[92:95], a[28:31], v[116:119]
 buffer_load_dwordx4 v2, s[16:19], s50 offen lds
 v_mfma_f32_16x16x32_bf16 v[112:115], a[84:87], a[28:31], v[112:115]
 s_add_u32 s59, s56, 32768
 v_cvt_pk_bf16_f32 v80, v80, v81
 v_cvt_pk_bf16_f32 v81, v82, v83
 v_mfma_f32_16x16x32_bf16 v[112:115], a[80:83], a[24:27], v[112:115]
 buffer_store_dwordx4 v[36:39], v1, s[12:15], s59 offen offset:1024 sc1
 v_mfma_f32_16x16x32_bf16 v[124:127], a[72:75], a[24:27], v[124:127]
 v_cvt_pk_bf16_f32 v82, v84, v85
 v_cvt_pk_bf16_f32 v83, v86, v87
 v_mfma_f32_16x16x32_bf16 v[124:127], a[76:79], a[28:31], v[124:127]
 s_add_u32 m0, s29, 49152
 v_cvt_pk_bf16_f32 v88, v88, v89
 v_cvt_pk_bf16_f32 v89, v90, v91
 v_mfma_f32_16x16x32_bf16 v[120:123], a[68:71], a[28:31], v[120:123]
 buffer_load_dwordx4 v2, s[16:19], s51 offen lds
 v_mfma_f32_16x16x32_bf16 v[120:123], a[64:67], a[24:27], v[120:123]
 v_cvt_pk_bf16_f32 v90, v92, v93
 v_cvt_pk_bf16_f32 v91, v94, v95
 v_mfma_f32_16x16x32_bf16 v[128:131], a[64:67], a[32:35], v[128:131]
 v_cvt_pk_bf16_f32 v96, v96, v97
 v_cvt_pk_bf16_f32 v97, v98, v99
 v_mfma_f32_16x16x32_bf16 v[128:131], a[68:71], a[36:39], v[128:131]
 v_cvt_pk_bf16_f32 v98, v100, v101
 v_cvt_pk_bf16_f32 v99, v102, v103
 v_mfma_f32_16x16x32_bf16 v[132:135], a[76:79], a[36:39], v[132:135]
 s_add_u32 m0, s29, 53248
 v_cvt_pk_bf16_f32 v104, v104, v105
 v_cvt_pk_bf16_f32 v105, v106, v107
 v_mfma_f32_16x16x32_bf16 v[132:135], a[72:75], a[32:35], v[132:135]
 buffer_load_dwordx4 v2, s[16:19], s52 offen lds
 v_mfma_f32_16x16x32_bf16 v[136:139], a[80:83], a[32:35], v[136:139]
 v_cvt_pk_bf16_f32 v106, v108, v109
 v_cvt_pk_bf16_f32 v107, v110, v111
 v_mfma_f32_16x16x32_bf16 v[136:139], a[84:87], a[36:39], v[136:139]
 v_cvt_pk_bf16_f32 v112, v112, v113
 v_cvt_pk_bf16_f32 v113, v114, v115
 v_mfma_f32_16x16x32_bf16 v[140:143], a[92:95], a[36:39], v[140:143]
 v_cvt_pk_bf16_f32 v114, v116, v117
 v_cvt_pk_bf16_f32 v115, v118, v119
 v_mfma_f32_16x16x32_bf16 v[140:143], a[88:91], a[32:35], v[140:143]
 s_add_u32 m0, s29, 57344
 v_cvt_pk_bf16_f32 v120, v120, v121
 v_cvt_pk_bf16_f32 v121, v122, v123
 v_mfma_f32_16x16x32_bf16 v[148:151], a[88:91], a[40:43], v[148:151]
 buffer_load_dwordx4 v2, s[16:19], s53 offen lds
 v_mfma_f32_16x16x32_bf16 v[148:151], a[92:95], a[44:47], v[148:151]
 v_cvt_pk_bf16_f32 v122, v124, v125
 v_cvt_pk_bf16_f32 v123, v126, v127
 v_mfma_f32_16x16x32_bf16 v[144:147], a[84:87], a[44:47], v[144:147]
 v_mfma_f32_16x16x32_bf16 v[144:147], a[80:83], a[40:43], v[144:147]
 v_cvt_pk_bf16_f32 v128, v128, v129
 v_cvt_pk_bf16_f32 v129, v130, v131
 v_mfma_f32_16x16x32_bf16 v[156:159], a[72:75], a[40:43], v[156:159]
 s_add_u32 m0, s29, 61440
 v_cvt_pk_bf16_f32 v130, v132, v133
 v_cvt_pk_bf16_f32 v131, v134, v135
 v_mfma_f32_16x16x32_bf16 v[156:159], a[76:79], a[44:47], v[156:159]
 buffer_load_dwordx4 v2, s[16:19], s54 offen lds
 v_mfma_f32_16x16x32_bf16 v[152:155], a[68:71], a[44:47], v[152:155]
 v_mfma_f32_16x16x32_bf16 v[152:155], a[64:67], a[40:43], v[152:155]
 v_cvt_pk_bf16_f32 v136, v136, v137
 v_cvt_pk_bf16_f32 v137, v138, v139
 v_mfma_f32_16x16x32_bf16 v[160:163], a[64:67], a[48:51], v[160:163]
 s_add_u32 m0, s29, 98304
 v_add_u32 v2, 0x80000, v2
 v_cvt_pk_bf16_f32 v138, v140, v141
 v_mfma_f32_16x16x32_bf16 v[160:163], a[68:71], a[52:55], v[160:163]
 buffer_load_dwordx4 v2, s[16:19], 0 offen lds
 v_mfma_f32_16x16x32_bf16 v[164:167], a[76:79], a[52:55], v[164:167]
 v_cvt_pk_bf16_f32 v139, v142, v143
 v_mfma_f32_16x16x32_bf16 v[164:167], a[72:75], a[48:51], v[164:167]
 v_cvt_pk_bf16_f32 v144, v144, v145
 v_cvt_pk_bf16_f32 v145, v146, v147
 v_mfma_f32_16x16x32_bf16 v[168:171], a[80:83], a[48:51], v[168:171]
 v_cvt_pk_bf16_f32 v146, v148, v149
 v_cvt_pk_bf16_f32 v147, v150, v151
 v_mfma_f32_16x16x32_bf16 v[168:171], a[84:87], a[52:55], v[168:171]
 s_add_u32 m0, s29, 102400
 v_mfma_f32_16x16x32_bf16 v[172:175], a[92:95], a[52:55], v[172:175]
 buffer_load_dwordx4 v2, s[16:19], s48 offen lds
 v_mfma_f32_16x16x32_bf16 v[172:175], a[88:91], a[48:51], v[172:175]
 v_cvt_pk_bf16_f32 v152, v152, v153
 v_cvt_pk_bf16_f32 v153, v154, v155
 v_mfma_f32_16x16x32_bf16 v[180:183], a[88:91], a[56:59], v[180:183]
 v_cvt_pk_bf16_f32 v154, v156, v157
 v_cvt_pk_bf16_f32 v155, v158, v159
 v_mfma_f32_16x16x32_bf16 v[180:183], a[92:95], a[60:63], v[180:183]
 v_mfma_f32_16x16x32_bf16 v[176:179], a[84:87], a[60:63], v[176:179]
 s_add_u32 m0, s29, 106496
 v_mfma_f32_16x16x32_bf16 v[176:179], a[80:83], a[56:59], v[176:179]
 buffer_load_dwordx4 v2, s[16:19], s49 offen lds
 v_mfma_f32_16x16x32_bf16 v[188:191], a[72:75], a[56:59], v[188:191]
 v_cvt_pk_bf16_f32 v160, v160, v161
 v_cvt_pk_bf16_f32 v161, v162, v163
 v_mfma_f32_16x16x32_bf16 v[188:191], a[76:79], a[60:63], v[188:191]
 v_cvt_pk_bf16_f32 v162, v164, v165
 v_cvt_pk_bf16_f32 v163, v166, v167
 v_mfma_f32_16x16x32_bf16 v[184:187], a[68:71], a[60:63], v[184:187]
 v_mfma_f32_16x16x32_bf16 v[184:187], a[64:67], a[56:59], v[184:187]
 s_add_u32 m0, s29, 110592
 v_cvt_pk_bf16_f32 v168, v168, v169
 v_cvt_pk_bf16_f32 v169, v170, v171
 v_mfma_f32_16x16x32_bf16 v[192:195], a[96:99], a[32:35], v[192:195]
 buffer_load_dwordx4 v2, s[16:19], s50 offen lds
 v_mfma_f32_16x16x32_bf16 v[192:195], a[100:103], a[36:39], v[192:195]
 v_cvt_pk_bf16_f32 v170, v172, v173
 v_cvt_pk_bf16_f32 v171, v174, v175
 v_mfma_f32_16x16x32_bf16 v[196:199], a[108:111], a[36:39], v[196:199]
 v_mfma_f32_16x16x32_bf16 v[196:199], a[104:107], a[32:35], v[196:199]
 v_cvt_pk_bf16_f32 v176, v176, v177
 v_cvt_pk_bf16_f32 v177, v178, v179
 v_mfma_f32_16x16x32_bf16 v[200:203], a[112:115], a[32:35], v[200:203]
 s_add_u32 m0, s29, 114688
 v_cvt_pk_bf16_f32 v178, v180, v181
 v_cvt_pk_bf16_f32 v179, v182, v183
 v_mfma_f32_16x16x32_bf16 v[200:203], a[116:119], a[36:39], v[200:203]
 buffer_load_dwordx4 v2, s[16:19], s51 offen lds
 v_mfma_f32_16x16x32_bf16 v[204:207], a[124:127], a[36:39], v[204:207]
 v_mfma_f32_16x16x32_bf16 v[204:207], a[120:123], a[32:35], v[204:207]
 v_cvt_pk_bf16_f32 v184, v184, v185
 v_cvt_pk_bf16_f32 v185, v186, v187
 v_mfma_f32_16x16x32_bf16 v[212:215], a[120:123], a[40:43], v[212:215]
 v_cvt_pk_bf16_f32 v186, v188, v189
 v_cvt_pk_bf16_f32 v187, v190, v191
 v_mfma_f32_16x16x32_bf16 v[212:215], a[124:127], a[44:47], v[212:215]
 s_add_u32 m0, s29, 118784
 v_mfma_f32_16x16x32_bf16 v[208:211], a[116:119], a[44:47], v[208:211]
 buffer_load_dwordx4 v2, s[16:19], s52 offen lds
 v_mfma_f32_16x16x32_bf16 v[208:211], a[112:115], a[40:43], v[208:211]
 v_cvt_pk_bf16_f32 v192, v192, v193
 v_cvt_pk_bf16_f32 v193, v194, v195
 v_mfma_f32_16x16x32_bf16 v[220:223], a[104:107], a[40:43], v[220:223]
 v_cvt_pk_bf16_f32 v194, v196, v197
 v_cvt_pk_bf16_f32 v195, v198, v199
 v_mfma_f32_16x16x32_bf16 v[220:223], a[108:111], a[44:47], v[220:223]
 v_mfma_f32_16x16x32_bf16 v[216:219], a[100:103], a[44:47], v[216:219]
 s_add_u32 m0, s29, 122880
 v_mfma_f32_16x16x32_bf16 v[216:219], a[96:99], a[40:43], v[216:219]
 buffer_load_dwordx4 v2, s[16:19], s53 offen lds
 v_mfma_f32_16x16x32_bf16 v[224:227], a[96:99], a[48:51], v[224:227]
 v_cvt_pk_bf16_f32 v200, v200, v201
 v_cvt_pk_bf16_f32 v201, v202, v203
 v_mfma_f32_16x16x32_bf16 v[224:227], a[100:103], a[52:55], v[224:227]
 s_waitcnt vmcnt(19)
 v_cvt_pk_bf16_f32 v202, v204, v205
 v_cvt_pk_bf16_f32 v203, v206, v207
 v_mfma_f32_16x16x32_bf16 v[228:231], a[108:111], a[52:55], v[228:231]
 s_barrier
 v_xor_b32 v7, 0, v6
 v_mfma_f32_16x16x32_bf16 v[228:231], a[104:107], a[48:51], v[228:231]
 s_add_u32 m0, s29, 126976
 ds_read_b64_tr_b16 a[64:65], v7 offset:0
 v_cvt_pk_bf16_f32 v208, v208, v209
 v_mfma_f32_16x16x32_bf16 v[232:235], a[112:115], a[48:51], v[232:235]
 ds_read_b64_tr_b16 a[66:67], v7 offset:4096
 buffer_load_dwordx4 v2, s[16:19], s54 offen lds
 v_mfma_f32_16x16x32_bf16 v[232:235], a[116:119], a[52:55], v[232:235]
 ds_read_b64_tr_b16 a[68:69], v7 offset:16384
 v_cvt_pk_bf16_f32 v209, v210, v211
 v_mfma_f32_16x16x32_bf16 v[236:239], a[124:127], a[52:55], v[236:239]
 ds_read_b64_tr_b16 a[70:71], v7 offset:20480
 v_xor_b32 v8, 65536, v6
 v_mfma_f32_16x16x32_bf16 v[236:239], a[120:123], a[48:51], v[236:239]
 ds_read_b64_tr_b16 a[72:73], v8 offset:0
 v_cvt_pk_bf16_f32 v210, v212, v213
 v_mfma_f32_16x16x32_bf16 v[244:247], a[120:123], a[56:59], v[244:247]
 ds_read_b64_tr_b16 a[74:75], v8 offset:4096
 v_cvt_pk_bf16_f32 v211, v214, v215
 v_mfma_f32_16x16x32_bf16 v[244:247], a[124:127], a[60:63], v[244:247]
 ds_read_b64_tr_b16 a[76:77], v8 offset:16384
 v_cvt_pk_bf16_f32 v216, v216, v217
 v_mfma_f32_16x16x32_bf16 v[240:243], a[116:119], a[60:63], v[240:243]
 ds_read_b64_tr_b16 a[78:79], v8 offset:20480
 v_xor_b32 v9, 32, v6
 v_mfma_f32_16x16x32_bf16 v[240:243], a[112:115], a[56:59], v[240:243]
 ds_read_b64_tr_b16 a[80:81], v9 offset:0
 v_cvt_pk_bf16_f32 v217, v218, v219
 v_mfma_f32_16x16x32_bf16 v[252:255], a[104:107], a[56:59], v[252:255]
 ds_read_b64_tr_b16 a[82:83], v9 offset:4096
 v_cvt_pk_bf16_f32 v218, v220, v221
 v_mfma_f32_16x16x32_bf16 v[252:255], a[108:111], a[60:63], v[252:255]
 ds_read_b64_tr_b16 a[84:85], v9 offset:16384
 v_cvt_pk_bf16_f32 v219, v222, v223
 v_mfma_f32_16x16x32_bf16 v[248:251], a[100:103], a[60:63], v[248:251]
 ds_read_b64_tr_b16 a[86:87], v9 offset:20480
 v_xor_b32 v10, 65568, v6
 v_mfma_f32_16x16x32_bf16 v[248:251], a[96:99], a[56:59], v[248:251]
 s_waitcnt lgkmcnt(6)
 ds_read_b64_tr_b16 a[88:89], v10 offset:0
 v_cvt_pk_bf16_f32 v224, v224, v225
 v_mfma_f32_16x16x32_bf16 v[28:31], a[64:67], a[128:131], 0
 ds_read_b64_tr_b16 a[90:91], v10 offset:4096
 v_cvt_pk_bf16_f32 v225, v226, v227
 v_mfma_f32_16x16x32_bf16 v[28:31], a[68:71], a[136:139], v[28:31]
 ds_read_b64_tr_b16 a[92:93], v10 offset:16384
 v_xor_b32 v7, 64, v6
 v_mfma_f32_16x16x32_bf16 v[28:31], a[72:75], a[144:147], v[28:31]
 s_waitcnt lgkmcnt(7)
 ds_read_b128 a[112:115], v14 offset:0
 ds_read_b64_tr_b16 a[94:95], v10 offset:20480
 v_mfma_f32_16x16x32_bf16 v[28:31], a[76:79], a[152:155], v[28:31]
 ds_read_b64_tr_b16 a[96:97], v7 offset:0
 v_cvt_pk_bf16_f32 v226, v228, v229
 v_mfma_f32_16x16x32_bf16 v[44:47], a[64:67], a[132:135], 0
 ds_read_b128 a[120:123], v3 offset:0
 ds_read_b64_tr_b16 a[98:99], v7 offset:4096
 v_mfma_f32_16x16x32_bf16 v[44:47], a[68:71], a[140:143], v[44:47]
 ds_read_b64_tr_b16 a[100:101], v7 offset:16384
 v_xor_b32 v8, 65600, v6
 v_mfma_f32_16x16x32_bf16 v[44:47], a[72:75], a[148:151], v[44:47]
 ds_read_b128 a[116:119], v14 offset:2048
 ds_read_b64_tr_b16 a[102:103], v7 offset:20480
 v_mfma_f32_16x16x32_bf16 v[44:47], a[76:79], a[156:159], v[44:47]
 s_waitcnt lgkmcnt(9)
 ds_read_b64_tr_b16 a[104:105], v8 offset:0
 v_cvt_pk_bf16_f32 v227, v230, v231
 v_mfma_f32_16x16x32_bf16 v[52:55], a[80:83], a[128:131], 0
 ds_read_b128 a[124:127], v3 offset:2048
 ds_read_b64_tr_b16 a[106:107], v8 offset:4096
 v_mfma_f32_16x16x32_bf16 v[52:55], a[84:87], a[136:139], v[52:55]
 ds_read_b64_tr_b16 a[108:109], v8 offset:16384
 v_cvt_pk_bf16_f32 v232, v232, v233
 v_mfma_f32_16x16x32_bf16 v[52:55], a[88:91], a[144:147], v[52:55]
 s_waitcnt lgkmcnt(10)
 ds_read_b64_tr_b16 a[110:111], v8 offset:20480
 v_xor_b32 v9, 96, v6
 v_mfma_f32_16x16x32_bf16 v[52:55], a[92:95], a[152:155], v[52:55]
 ds_read_b64_tr_b16 a[64:65], v9 offset:0
 v_cvt_pk_bf16_f32 v233, v234, v235
 v_mfma_f32_16x16x32_bf16 v[60:63], a[80:83], a[132:135], 0
 ds_read_b64_tr_b16 a[66:67], v9 offset:4096
 v_cvt_pk_bf16_f32 v234, v236, v237
 v_mfma_f32_16x16x32_bf16 v[60:63], a[84:87], a[140:143], v[60:63]
 ds_read_b64_tr_b16 a[68:69], v9 offset:16384
 v_cvt_pk_bf16_f32 v235, v238, v239
 v_mfma_f32_16x16x32_bf16 v[60:63], a[88:91], a[148:151], v[60:63]
 ds_read_b64_tr_b16 a[70:71], v9 offset:20480
 v_xor_b32 v10, 65632, v6
 v_mfma_f32_16x16x32_bf16 v[60:63], a[92:95], a[156:159], v[60:63]
 s_waitcnt lgkmcnt(6)
 ds_read_b64_tr_b16 a[72:73], v10 offset:0
 v_cvt_pk_bf16_f32 v240, v240, v241
 v_mfma_f32_16x16x32_bf16 v[20:23], a[96:99], a[128:131], 0
 ds_read_b64_tr_b16 a[74:75], v10 offset:4096
 v_cvt_pk_bf16_f32 v241, v242, v243
 v_mfma_f32_16x16x32_bf16 v[20:23], a[100:103], a[136:139], v[20:23]
 s_waitcnt lgkmcnt(8)
 ds_read_b64_tr_b16 a[76:77], v10 offset:16384
 v_xor_b32 v7, 128, v6
 v_mfma_f32_16x16x32_bf16 v[20:23], a[104:107], a[144:147], v[20:23]
 s_waitcnt lgkmcnt(7)
 s_barrier
 ds_read_b64_tr_b16 a[78:79], v10 offset:20480
 v_mfma_f32_16x16x32_bf16 v[20:23], a[108:111], a[152:155], v[20:23]
 s_add_u32 m0, s29, 131072
 ds_read_b64_tr_b16 a[80:81], v7 offset:0
 v_add_u32 v2, 0x80000, v2
 v_mfma_f32_16x16x32_bf16 v[36:39], a[96:99], a[132:135], 0
 ds_read_b64_tr_b16 a[82:83], v7 offset:4096
 buffer_load_dwordx4 v2, s[16:19], 0 offen lds
 v_mfma_f32_16x16x32_bf16 v[36:39], a[100:103], a[140:143], v[36:39]
 ds_read_b64_tr_b16 a[84:85], v7 offset:16384
 v_cvt_pk_bf16_f32 v242, v244, v245
 v_mfma_f32_16x16x32_bf16 v[36:39], a[104:107], a[148:151], v[36:39]
 ds_read_b64_tr_b16 a[86:87], v7 offset:20480
 v_xor_b32 v8, 65664, v6
 v_mfma_f32_16x16x32_bf16 v[36:39], a[108:111], a[156:159], v[36:39]
 s_waitcnt lgkmcnt(6)
 ds_read_b64_tr_b16 a[88:89], v8 offset:0
 v_cvt_pk_bf16_f32 v243, v246, v247
 v_mfma_f32_16x16x32_bf16 v[68:71], a[64:67], a[128:131], 0
 ds_read_b64_tr_b16 a[90:91], v8 offset:4096
 v_cvt_pk_bf16_f32 v248, v248, v249
 v_mfma_f32_16x16x32_bf16 v[68:71], a[68:71], a[136:139], v[68:71]
 s_add_u32 m0, s29, 135168
 ds_read_b64_tr_b16 a[92:93], v8 offset:16384
 v_cvt_pk_bf16_f32 v249, v250, v251
 v_mfma_f32_16x16x32_bf16 v[68:71], a[72:75], a[144:147], v[68:71]
 s_waitcnt lgkmcnt(7)
 ds_read_b64_tr_b16 a[94:95], v8 offset:20480
 v_xor_b32 v9, 160, v6
 v_mfma_f32_16x16x32_bf16 v[68:71], a[76:79], a[152:155], v[68:71]
 ds_read_b64_tr_b16 a[96:97], v9 offset:0
 buffer_load_dwordx4 v2, s[16:19], s48 offen lds
 v_mfma_f32_16x16x32_bf16 v[76:79], a[64:67], a[132:135], 0
 ds_read_b64_tr_b16 a[98:99], v9 offset:4096
 v_cvt_pk_bf16_f32 v250, v252, v253
 v_mfma_f32_16x16x32_bf16 v[76:79], a[68:71], a[140:143], v[76:79]
 ds_read_b64_tr_b16 a[100:101], v9 offset:16384
 v_cvt_pk_bf16_f32 v251, v254, v255
 v_mfma_f32_16x16x32_bf16 v[76:79], a[72:75], a[148:151], v[76:79]
 ds_read_b64_tr_b16 a[102:103], v9 offset:20480
 v_xor_b32 v10, 65696, v6
 v_mfma_f32_16x16x32_bf16 v[76:79], a[76:79], a[156:159], v[76:79]
 s_waitcnt lgkmcnt(6)
 ds_read_b64_tr_b16 a[104:105], v10 offset:0
 v_mov_b32 v12, 0
 v_mfma_f32_16x16x32_bf16 v[84:87], a[80:83], a[128:131], 0
 s_add_u32 m0, s29, 139264
 ds_read_b64_tr_b16 a[106:107], v10 offset:4096
 v_mfma_f32_16x16x32_bf16 v[84:87], a[84:87], a[136:139], v[84:87]
 ds_read_b64_tr_b16 a[108:109], v10 offset:16384
 buffer_load_dwordx4 v2, s[16:19], s49 offen lds
 v_mfma_f32_16x16x32_bf16 v[84:87], a[88:91], a[144:147], v[84:87]
 s_waitcnt lgkmcnt(7)
 ds_read_b64_tr_b16 a[110:111], v10 offset:20480
 v_xor_b32 v7, 192, v6
 v_mfma_f32_16x16x32_bf16 v[84:87], a[92:95], a[152:155], v[84:87]
 ds_read_b64_tr_b16 a[64:65], v7 offset:0
 global_load_dword a248, v12, s[90:91] offset:128 sc1
 v_mfma_f32_16x16x32_bf16 v[92:95], a[80:83], a[132:135], 0
 ds_read_b64_tr_b16 a[66:67], v7 offset:4096
 v_and_b32 v12, 11, v0
 v_mfma_f32_16x16x32_bf16 v[92:95], a[84:87], a[140:143], v[92:95]
 ds_read_b64_tr_b16 a[68:69], v7 offset:16384
 v_lshlrev_b32 v12, 2, v12
 v_mfma_f32_16x16x32_bf16 v[92:95], a[88:91], a[148:151], v[92:95]
 s_add_u32 m0, s29, 143360
 ds_read_b64_tr_b16 a[70:71], v7 offset:20480
 v_xor_b32 v8, 65728, v6
 v_mfma_f32_16x16x32_bf16 v[92:95], a[92:95], a[156:159], v[92:95]
 s_waitcnt lgkmcnt(6)
 ds_read_b64_tr_b16 a[72:73], v8 offset:0
 buffer_load_dwordx4 v2, s[16:19], s50 offen lds
 v_mfma_f32_16x16x32_bf16 v[100:103], a[96:99], a[128:131], 0
 ds_read_b64_tr_b16 a[74:75], v8 offset:4096
 v_mfma_f32_16x16x32_bf16 v[100:103], a[100:103], a[136:139], v[100:103]
 s_and_b32 s36, s95, 31
 ds_read_b64_tr_b16 a[76:77], v8 offset:16384
 v_mfma_f32_16x16x32_bf16 v[100:103], a[104:107], a[144:147], v[100:103]
 s_waitcnt lgkmcnt(7)
 ds_read_b64_tr_b16 a[78:79], v8 offset:20480
 v_xor_b32 v9, 224, v6
 v_mfma_f32_16x16x32_bf16 v[100:103], a[108:111], a[152:155], v[100:103]
 s_lshr_b32 s37, s95, 5
 ds_read_b64_tr_b16 a[80:81], v9 offset:0
 v_mfma_f32_16x16x32_bf16 v[108:111], a[96:99], a[132:135], 0
 s_add_u32 m0, s29, 147456
 ds_read_b64_tr_b16 a[82:83], v9 offset:4096
 v_mfma_f32_16x16x32_bf16 v[108:111], a[100:103], a[140:143], v[108:111]
 ds_read_b64_tr_b16 a[84:85], v9 offset:16384
 buffer_load_dwordx4 v2, s[16:19], s51 offen lds
 v_mfma_f32_16x16x32_bf16 v[108:111], a[104:107], a[148:151], v[108:111]
 s_lshl_b32 s38, s3, 4
 ds_read_b64_tr_b16 a[86:87], v9 offset:20480
 v_xor_b32 v10, 65760, v6
 v_mfma_f32_16x16x32_bf16 v[108:111], a[108:111], a[156:159], v[108:111]
 s_waitcnt lgkmcnt(6)
 ds_read_b64_tr_b16 a[88:89], v10 offset:0
 v_mfma_f32_16x16x32_bf16 v[116:119], a[64:67], a[128:131], 0
 s_lshl_b32 s39, s36, 6
 ds_read_b64_tr_b16 a[90:91], v10 offset:4096
 v_mfma_f32_16x16x32_bf16 v[116:119], a[68:71], a[136:139], v[116:119]
 s_add_u32 m0, s29, 151552
 ds_read_b64_tr_b16 a[92:93], v10 offset:16384
 v_mfma_f32_16x16x32_bf16 v[116:119], a[72:75], a[144:147], v[116:119]
 s_waitcnt lgkmcnt(7)
 ds_read_b64_tr_b16 a[94:95], v10 offset:20480
 v_xor_b32 v7, 256, v6
 v_mfma_f32_16x16x32_bf16 v[116:119], a[76:79], a[152:155], v[116:119]
 ds_read_b64_tr_b16 a[96:97], v7 offset:0
 buffer_load_dwordx4 v2, s[16:19], s52 offen lds
 v_mfma_f32_16x16x32_bf16 v[124:127], a[64:67], a[132:135], 0
 s_add_u32 s38, s38, s39
 ds_read_b64_tr_b16 a[98:99], v7 offset:4096
 v_mfma_f32_16x16x32_bf16 v[124:127], a[68:71], a[140:143], v[124:127]
 s_mul_i32 s38, s38, 896
 ds_read_b64_tr_b16 a[100:101], v7 offset:16384
 v_mfma_f32_16x16x32_bf16 v[124:127], a[72:75], a[148:151], v[124:127]
 s_lshl_b32 s39, s37, 7
 ds_read_b64_tr_b16 a[102:103], v7 offset:20480
 v_xor_b32 v8, 65792, v6
 v_mfma_f32_16x16x32_bf16 v[124:127], a[76:79], a[156:159], v[124:127]
 s_waitcnt lgkmcnt(6)
 ds_read_b64_tr_b16 a[104:105], v8 offset:0
 v_mfma_f32_16x16x32_bf16 v[132:135], a[80:83], a[128:131], 0
 s_add_u32 m0, s29, 155648
 ds_read_b64_tr_b16 a[106:107], v8 offset:4096
 v_mfma_f32_16x16x32_bf16 v[132:135], a[84:87], a[136:139], v[132:135]
 ds_read_b64_tr_b16 a[108:109], v8 offset:16384
 buffer_load_dwordx4 v2, s[16:19], s53 offen lds
 v_mfma_f32_16x16x32_bf16 v[132:135], a[88:91], a[144:147], v[132:135]
 s_waitcnt lgkmcnt(7)
 ds_read_b64_tr_b16 a[110:111], v8 offset:20480
 v_xor_b32 v9, 288, v6
 v_mfma_f32_16x16x32_bf16 v[132:135], a[92:95], a[152:155], v[132:135]
 s_add_u32 s38, s38, s39
 ds_read_b64_tr_b16 a[64:65], v9 offset:0
 v_mfma_f32_16x16x32_bf16 v[140:143], a[80:83], a[132:135], 0
 s_lshl_b32 s39, s37, 9
 ds_read_b64_tr_b16 a[66:67], v9 offset:4096
 v_mfma_f32_16x16x32_bf16 v[140:143], a[84:87], a[140:143], v[140:143]
 s_mov_b32 s4, s66
 ds_read_b64_tr_b16 a[68:69], v9 offset:16384
 v_mfma_f32_16x16x32_bf16 v[140:143], a[88:91], a[148:151], v[140:143]
 s_add_u32 m0, s29, 159744
 ds_read_b64_tr_b16 a[70:71], v9 offset:20480
 v_xor_b32 v10, 65824, v6
 v_mfma_f32_16x16x32_bf16 v[140:143], a[92:95], a[156:159], v[140:143]
 s_waitcnt lgkmcnt(6)
 ds_read_b64_tr_b16 a[72:73], v10 offset:0
 buffer_load_dwordx4 v2, s[16:19], s54 offen lds
 v_mfma_f32_16x16x32_bf16 v[148:151], a[96:99], a[128:131], 0
 s_mov_b32 s5, s67
 ds_read_b64_tr_b16 a[74:75], v10 offset:4096
 v_mfma_f32_16x16x32_bf16 v[148:151], a[100:103], a[136:139], v[148:151]
 s_mov_b32 s6, 1835008
 ds_read_b64_tr_b16 a[76:77], v10 offset:16384
 v_mfma_f32_16x16x32_bf16 v[148:151], a[104:107], a[144:147], v[148:151]
 s_waitcnt lgkmcnt(7)
 ds_read_b64_tr_b16 a[78:79], v10 offset:20480
 v_xor_b32 v7, 320, v6
 v_mfma_f32_16x16x32_bf16 v[148:151], a[108:111], a[152:155], v[148:151]
 s_mov_b32 s7, 0x20000
 ds_read_b64_tr_b16 a[80:81], v7 offset:0
 v_mfma_f32_16x16x32_bf16 v[156:159], a[96:99], a[132:135], 0
 s_mov_b32 s8, s68
 ds_read_b64_tr_b16 a[82:83], v7 offset:4096
 v_mfma_f32_16x16x32_bf16 v[156:159], a[100:103], a[140:143], v[156:159]
 s_mov_b32 s9, s69
 ds_read_b64_tr_b16 a[84:85], v7 offset:16384
 v_mfma_f32_16x16x32_bf16 v[156:159], a[104:107], a[148:151], v[156:159]
 s_mov_b32 s10, 1835008
 ds_read_b64_tr_b16 a[86:87], v7 offset:20480
 v_xor_b32 v8, 65856, v6
 v_mfma_f32_16x16x32_bf16 v[156:159], a[108:111], a[156:159], v[156:159]
 s_waitcnt lgkmcnt(6)
 ds_read_b64_tr_b16 a[88:89], v8 offset:0
 v_mfma_f32_16x16x32_bf16 v[164:167], a[64:67], a[128:131], 0
 s_mov_b32 s11, 0x20000
 ds_read_b64_tr_b16 a[90:91], v8 offset:4096
 v_mfma_f32_16x16x32_bf16 v[164:167], a[68:71], a[136:139], v[164:167]
 s_mov_b32 s20, s70
 ds_read_b64_tr_b16 a[92:93], v8 offset:16384
 v_mfma_f32_16x16x32_bf16 v[164:167], a[72:75], a[144:147], v[164:167]
 s_waitcnt lgkmcnt(7)
 ds_read_b64_tr_b16 a[94:95], v8 offset:20480
 v_xor_b32 v9, 352, v6
 v_mfma_f32_16x16x32_bf16 v[164:167], a[76:79], a[152:155], v[164:167]
 s_mov_b32 s21, s71
 ds_read_b64_tr_b16 a[96:97], v9 offset:0
 v_mfma_f32_16x16x32_bf16 v[172:175], a[64:67], a[132:135], 0
 s_mov_b32 s22, 3584
 ds_read_b64_tr_b16 a[98:99], v9 offset:4096
 v_mfma_f32_16x16x32_bf16 v[172:175], a[68:71], a[140:143], v[172:175]
 s_mov_b32 s23, 0x20000
 ds_read_b64_tr_b16 a[100:101], v9 offset:16384
 v_mfma_f32_16x16x32_bf16 v[172:175], a[72:75], a[148:151], v[172:175]
 ds_read_b64_tr_b16 a[102:103], v9 offset:20480
 v_xor_b32 v10, 65888, v6
 v_mfma_f32_16x16x32_bf16 v[172:175], a[76:79], a[156:159], v[172:175]
 s_waitcnt lgkmcnt(6)
 ds_read_b64_tr_b16 a[104:105], v10 offset:0
 v_mfma_f32_16x16x32_bf16 v[180:183], a[80:83], a[128:131], 0
 ds_read_b64_tr_b16 a[106:107], v10 offset:4096
 v_mfma_f32_16x16x32_bf16 v[180:183], a[84:87], a[136:139], v[180:183]
 ds_read_b64_tr_b16 a[108:109], v10 offset:16384
 v_mfma_f32_16x16x32_bf16 v[180:183], a[88:91], a[144:147], v[180:183]
 s_waitcnt lgkmcnt(7)
 ds_read_b64_tr_b16 a[110:111], v10 offset:20480
 v_xor_b32 v7, 384, v6
 v_mfma_f32_16x16x32_bf16 v[180:183], a[92:95], a[152:155], v[180:183]
 ds_read_b64_tr_b16 a[64:65], v7 offset:0
 v_mfma_f32_16x16x32_bf16 v[188:191], a[80:83], a[132:135], 0
 ds_read_b64_tr_b16 a[66:67], v7 offset:4096
 v_mfma_f32_16x16x32_bf16 v[188:191], a[84:87], a[140:143], v[188:191]
 ds_read_b64_tr_b16 a[68:69], v7 offset:16384
 v_mfma_f32_16x16x32_bf16 v[188:191], a[88:91], a[148:151], v[188:191]
 ds_read_b64_tr_b16 a[70:71], v7 offset:20480
 v_xor_b32 v8, 65920, v6
 v_mfma_f32_16x16x32_bf16 v[188:191], a[92:95], a[156:159], v[188:191]
 s_waitcnt lgkmcnt(6)
 ds_read_b64_tr_b16 a[72:73], v8 offset:0
 v_mfma_f32_16x16x32_bf16 v[196:199], a[96:99], a[128:131], 0
 ds_read_b64_tr_b16 a[74:75], v8 offset:4096
 v_mfma_f32_16x16x32_bf16 v[196:199], a[100:103], a[136:139], v[196:199]
 ds_read_b64_tr_b16 a[76:77], v8 offset:16384
 v_mfma_f32_16x16x32_bf16 v[196:199], a[104:107], a[144:147], v[196:199]
 s_waitcnt lgkmcnt(7)
 ds_read_b64_tr_b16 a[78:79], v8 offset:20480
 v_xor_b32 v9, 416, v6
 v_mfma_f32_16x16x32_bf16 v[196:199], a[108:111], a[152:155], v[196:199]
 ds_read_b64_tr_b16 a[80:81], v9 offset:0
 v_mfma_f32_16x16x32_bf16 v[204:207], a[96:99], a[132:135], 0
 ds_read_b64_tr_b16 a[82:83], v9 offset:4096
 v_mfma_f32_16x16x32_bf16 v[204:207], a[100:103], a[140:143], v[204:207]
 ds_read_b64_tr_b16 a[84:85], v9 offset:16384
 v_mfma_f32_16x16x32_bf16 v[204:207], a[104:107], a[148:151], v[204:207]
 ds_read_b64_tr_b16 a[86:87], v9 offset:20480
 v_xor_b32 v10, 65952, v6
 v_mfma_f32_16x16x32_bf16 v[204:207], a[108:111], a[156:159], v[204:207]
 s_waitcnt lgkmcnt(6)
 ds_read_b64_tr_b16 a[88:89], v10 offset:0
 v_mfma_f32_16x16x32_bf16 v[212:215], a[64:67], a[128:131], 0
 ds_read_b64_tr_b16 a[90:91], v10 offset:4096
 v_mfma_f32_16x16x32_bf16 v[212:215], a[68:71], a[136:139], v[212:215]
 ds_read_b64_tr_b16 a[92:93], v10 offset:16384
 v_mfma_f32_16x16x32_bf16 v[212:215], a[72:75], a[144:147], v[212:215]
 s_waitcnt lgkmcnt(7)
 ds_read_b64_tr_b16 a[94:95], v10 offset:20480
 v_xor_b32 v7, 448, v6
 v_mfma_f32_16x16x32_bf16 v[212:215], a[76:79], a[152:155], v[212:215]
 s_add_u32 s59, s56, 32768
 ds_read_b64_tr_b16 a[96:97], v7 offset:0
 v_mfma_f32_16x16x32_bf16 v[220:223], a[64:67], a[132:135], 0
 ds_read_b64_tr_b16 a[98:99], v7 offset:4096
 buffer_store_dwordx4 v[32:35], v1, s[12:15], s59 offen offset:2048 sc1
 v_mfma_f32_16x16x32_bf16 v[220:223], a[68:71], a[140:143], v[220:223]
 ds_read_b64_tr_b16 a[100:101], v7 offset:16384
 v_mfma_f32_16x16x32_bf16 v[220:223], a[72:75], a[148:151], v[220:223]
 ds_read_b64_tr_b16 a[102:103], v7 offset:20480
 v_xor_b32 v8, 65984, v6
 v_mfma_f32_16x16x32_bf16 v[220:223], a[76:79], a[156:159], v[220:223]
 s_waitcnt lgkmcnt(6)
 ds_read_b64_tr_b16 a[104:105], v8 offset:0
 v_mfma_f32_16x16x32_bf16 v[228:231], a[80:83], a[128:131], 0
 ds_read_b64_tr_b16 a[106:107], v8 offset:4096
 v_mfma_f32_16x16x32_bf16 v[228:231], a[84:87], a[136:139], v[228:231]
 ds_read_b64_tr_b16 a[108:109], v8 offset:16384
 v_mfma_f32_16x16x32_bf16 v[228:231], a[88:91], a[144:147], v[228:231]
 s_waitcnt lgkmcnt(7)
 ds_read_b64_tr_b16 a[110:111], v8 offset:20480
 v_xor_b32 v9, 480, v6
 v_mfma_f32_16x16x32_bf16 v[228:231], a[92:95], a[152:155], v[228:231]
 ds_read_b64_tr_b16 a[64:65], v9 offset:0
 v_mfma_f32_16x16x32_bf16 v[236:239], a[80:83], a[132:135], 0
 ds_read_b64_tr_b16 a[66:67], v9 offset:4096
 v_mfma_f32_16x16x32_bf16 v[236:239], a[84:87], a[140:143], v[236:239]
 ds_read_b64_tr_b16 a[68:69], v9 offset:16384
 v_mfma_f32_16x16x32_bf16 v[236:239], a[88:91], a[148:151], v[236:239]
 s_add_u32 s59, s56, 49152
 ds_read_b64_tr_b16 a[70:71], v9 offset:20480
 v_xor_b32 v10, 66016, v6
 v_mfma_f32_16x16x32_bf16 v[236:239], a[92:95], a[156:159], v[236:239]
 s_waitcnt lgkmcnt(6)
 ds_read_b64_tr_b16 a[72:73], v10 offset:0
 buffer_store_dwordx4 v[40:43], v1, s[12:15], s59 offen offset:2048 sc1
 v_mfma_f32_16x16x32_bf16 v[244:247], a[96:99], a[128:131], 0
 ds_read_b64_tr_b16 a[74:75], v10 offset:4096
 v_mfma_f32_16x16x32_bf16 v[244:247], a[100:103], a[136:139], v[244:247]
 s_waitcnt vmcnt(11)
 ds_read_b64_tr_b16 a[76:77], v10 offset:16384
 v_xor_b32 v7, 32768, v6
 v_mfma_f32_16x16x32_bf16 v[244:247], a[104:107], a[144:147], v[244:247]
 s_waitcnt lgkmcnt(7)
 s_barrier
 ds_read_b64_tr_b16 a[78:79], v10 offset:20480
 v_mfma_f32_16x16x32_bf16 v[244:247], a[108:111], a[152:155], v[244:247]
 ds_read_b64_tr_b16 a[80:81], v7 offset:0
 v_mfma_f32_16x16x32_bf16 v[252:255], a[96:99], a[132:135], 0
 ds_read_b64_tr_b16 a[82:83], v7 offset:4096
 v_mfma_f32_16x16x32_bf16 v[252:255], a[100:103], a[140:143], v[252:255]
 ds_read_b64_tr_b16 a[84:85], v7 offset:16384
 v_mfma_f32_16x16x32_bf16 v[252:255], a[104:107], a[148:151], v[252:255]
 ds_read_b64_tr_b16 a[86:87], v7 offset:20480
 v_xor_b32 v8, 98304, v6
 v_mfma_f32_16x16x32_bf16 v[252:255], a[108:111], a[156:159], v[252:255]
 s_waitcnt lgkmcnt(6)
 ds_read_b64_tr_b16 a[88:89], v8 offset:0
 v_mfma_f32_16x16x32_bf16 v[16:19], a[64:67], a[128:131], 0
 s_add_u32 s59, s56, 49152
 ds_read_b64_tr_b16 a[90:91], v8 offset:4096
 v_mfma_f32_16x16x32_bf16 v[16:19], a[68:71], a[136:139], v[16:19]
 ds_read_b64_tr_b16 a[92:93], v8 offset:16384
 buffer_store_dwordx4 v[48:51], v1, s[12:15], s59 offen offset:3072 sc1
 v_mfma_f32_16x16x32_bf16 v[16:19], a[72:75], a[144:147], v[16:19]
 s_waitcnt lgkmcnt(7)
 ds_read_b64_tr_b16 a[94:95], v8 offset:20480
 v_xor_b32 v9, 32800, v6
 v_mfma_f32_16x16x32_bf16 v[16:19], a[76:79], a[152:155], v[16:19]
 ds_read_b64_tr_b16 a[96:97], v9 offset:0
 v_mfma_f32_16x16x32_bf16 v[24:27], a[64:67], a[132:135], 0
 s_waitcnt lgkmcnt(9)
 ds_read_b64_tr_b16 a[98:99], v9 offset:4096
 v_mfma_f32_16x16x32_bf16 v[24:27], a[68:71], a[140:143], v[24:27]
 s_barrier
 ds_read_b64_tr_b16 a[100:101], v9 offset:16384
 v_mfma_f32_16x16x32_bf16 v[24:27], a[72:75], a[148:151], v[24:27]
 s_add_u32 m0, s29, 0
 ds_read_b64_tr_b16 a[102:103], v9 offset:20480
 v_xor_b32 v10, 98336, v6
 v_mfma_f32_16x16x32_bf16 v[24:27], a[76:79], a[156:159], v[24:27]
 s_waitcnt lgkmcnt(6)
 ds_read_b64_tr_b16 a[104:105], v10 offset:0
 v_add_u32 v2, 0x80000, v2
 v_mfma_f32_16x16x32_bf16 v[28:31], a[80:83], a[160:163], v[28:31]
 ds_read_b64_tr_b16 a[106:107], v10 offset:4096
 buffer_load_dwordx4 v2, s[16:19], 0 offen lds
 v_mfma_f32_16x16x32_bf16 v[28:31], a[84:87], a[168:171], v[28:31]
 s_add_u32 s59, s56, 32768
 ds_read_b64_tr_b16 a[108:109], v10 offset:16384
 v_mfma_f32_16x16x32_bf16 v[28:31], a[88:91], a[176:179], v[28:31]
 s_waitcnt lgkmcnt(7)
 ds_read_b64_tr_b16 a[110:111], v10 offset:20480
 v_xor_b32 v7, 32832, v6
 v_mfma_f32_16x16x32_bf16 v[28:31], a[92:95], a[184:187], v[28:31]
 ds_read_b64_tr_b16 a[64:65], v7 offset:0
 buffer_store_dwordx4 v[56:59], v1, s[12:15], s59 offen offset:3072 sc1
 v_mfma_f32_16x16x32_bf16 v[44:47], a[80:83], a[164:167], v[44:47]
 s_add_u32 m0, s29, 4096
 ds_read_b64_tr_b16 a[66:67], v7 offset:4096
 v_add_u32 v4, 4096, v1
 v_mfma_f32_16x16x32_bf16 v[44:47], a[84:87], a[172:175], v[44:47]
 ds_read_b64_tr_b16 a[68:69], v7 offset:16384
 buffer_load_dwordx4 v2, s[16:19], s48 offen lds
 v_mfma_f32_16x16x32_bf16 v[44:47], a[88:91], a[180:183], v[44:47]
 ds_read_b64_tr_b16 a[70:71], v7 offset:20480
 v_xor_b32 v8, 98368, v6
 v_mfma_f32_16x16x32_bf16 v[44:47], a[92:95], a[188:191], v[44:47]
 s_waitcnt lgkmcnt(6)
 ds_read_b64_tr_b16 a[72:73], v8 offset:0
 v_mfma_f32_16x16x32_bf16 v[52:55], a[96:99], a[160:163], v[52:55]
 ds_read_b64_tr_b16 a[74:75], v8 offset:4096
 v_mfma_f32_16x16x32_bf16 v[52:55], a[100:103], a[168:171], v[52:55]
 s_add_u32 m0, s29, 8192
 ds_read_b64_tr_b16 a[76:77], v8 offset:16384
 v_mfma_f32_16x16x32_bf16 v[52:55], a[104:107], a[176:179], v[52:55]
 s_waitcnt lgkmcnt(7)
 ds_read_b64_tr_b16 a[78:79], v8 offset:20480
 v_xor_b32 v9, 32864, v6
 v_mfma_f32_16x16x32_bf16 v[52:55], a[108:111], a[184:187], v[52:55]
 ds_read_b64_tr_b16 a[80:81], v9 offset:0
 buffer_load_dwordx4 v2, s[16:19], s49 offen lds
 v_mfma_f32_16x16x32_bf16 v[60:63], a[96:99], a[164:167], v[60:63]
 s_add_u32 s59, s56, 0
 ds_read_b64_tr_b16 a[82:83], v9 offset:4096
 v_mfma_f32_16x16x32_bf16 v[60:63], a[100:103], a[172:175], v[60:63]
 ds_read_b64_tr_b16 a[84:85], v9 offset:16384
 buffer_store_dwordx4 v[64:67], v1, s[12:15], s59 offen offset:0 sc1
 v_mfma_f32_16x16x32_bf16 v[60:63], a[104:107], a[180:183], v[60:63]
 s_add_u32 m0, s29, 12288
 ds_read_b64_tr_b16 a[86:87], v9 offset:20480
 v_xor_b32 v10, 98400, v6
 v_mfma_f32_16x16x32_bf16 v[60:63], a[108:111], a[188:191], v[60:63]
 s_waitcnt lgkmcnt(6)
 ds_read_b64_tr_b16 a[88:89], v10 offset:0
 v_mfma_f32_16x16x32_bf16 v[20:23], a[64:67], a[160:163], v[20:23]
 ds_read_b64_tr_b16 a[90:91], v10 offset:4096
 buffer_load_dwordx4 v2, s[16:19], s50 offen lds
 v_mfma_f32_16x16x32_bf16 v[20:23], a[68:71], a[168:171], v[20:23]
 ds_read_b64_tr_b16 a[92:93], v10 offset:16384
 v_mfma_f32_16x16x32_bf16 v[20:23], a[72:75], a[176:179], v[20:23]
 s_waitcnt lgkmcnt(7)
 ds_read_b64_tr_b16 a[94:95], v10 offset:20480
 v_xor_b32 v7, 32896, v6
 v_mfma_f32_16x16x32_bf16 v[20:23], a[76:79], a[184:187], v[20:23]
 ds_read_b64_tr_b16 a[96:97], v7 offset:0
 v_mfma_f32_16x16x32_bf16 v[36:39], a[64:67], a[164:167], v[36:39]
 s_add_u32 m0, s29, 16384
 ds_read_b64_tr_b16 a[98:99], v7 offset:4096
 v_mfma_f32_16x16x32_bf16 v[36:39], a[68:71], a[172:175], v[36:39]
 ds_read_b64_tr_b16 a[100:101], v7 offset:16384
 buffer_load_dwordx4 v2, s[16:19], s51 offen lds
 v_mfma_f32_16x16x32_bf16 v[36:39], a[72:75], a[180:183], v[36:39]
 s_add_u32 s59, s56, 16384
 ds_read_b64_tr_b16 a[102:103], v7 offset:20480
 v_xor_b32 v8, 98432, v6
 v_mfma_f32_16x16x32_bf16 v[36:39], a[76:79], a[188:191], v[36:39]
 s_waitcnt lgkmcnt(6)
 ds_read_b64_tr_b16 a[104:105], v8 offset:0
 buffer_store_dwordx4 v[72:75], v1, s[12:15], s59 offen offset:0 sc1
 v_mfma_f32_16x16x32_bf16 v[68:71], a[80:83], a[160:163], v[68:71]
 ds_read_b64_tr_b16 a[106:107], v8 offset:4096
 v_mfma_f32_16x16x32_bf16 v[68:71], a[84:87], a[168:171], v[68:71]
 s_add_u32 m0, s29, 20480
 ds_read_b64_tr_b16 a[108:109], v8 offset:16384
 v_mfma_f32_16x16x32_bf16 v[68:71], a[88:91], a[176:179], v[68:71]
 s_waitcnt lgkmcnt(7)
 ds_read_b64_tr_b16 a[110:111], v8 offset:20480
 v_xor_b32 v9, 32928, v6
 v_mfma_f32_16x16x32_bf16 v[68:71], a[92:95], a[184:187], v[68:71]
 ds_read_b64_tr_b16 a[64:65], v9 offset:0
 buffer_load_dwordx4 v2, s[16:19], s52 offen lds
 v_mfma_f32_16x16x32_bf16 v[76:79], a[80:83], a[164:167], v[76:79]
 ds_read_b64_tr_b16 a[66:67], v9 offset:4096
 v_mfma_f32_16x16x32_bf16 v[76:79], a[84:87], a[172:175], v[76:79]
 ds_read_b64_tr_b16 a[68:69], v9 offset:16384
 v_mfma_f32_16x16x32_bf16 v[76:79], a[88:91], a[180:183], v[76:79]
 s_add_u32 m0, s29, 24576
 ds_read_b64_tr_b16 a[70:71], v9 offset:20480
 v_xor_b32 v10, 98464, v6
 v_mfma_f32_16x16x32_bf16 v[76:79], a[92:95], a[188:191], v[76:79]
 s_waitcnt lgkmcnt(6)
 ds_read_b64_tr_b16 a[72:73], v10 offset:0
 v_mfma_f32_16x16x32_bf16 v[84:87], a[96:99], a[160:163], v[84:87]
 ds_read_b64_tr_b16 a[74:75], v10 offset:4096
 buffer_load_dwordx4 v2, s[16:19], s53 offen lds
 v_mfma_f32_16x16x32_bf16 v[84:87], a[100:103], a[168:171], v[84:87]
 s_add_u32 s59, s56, 16384
 ds_read_b64_tr_b16 a[76:77], v10 offset:16384
 v_mfma_f32_16x16x32_bf16 v[84:87], a[104:107], a[176:179], v[84:87]
 s_waitcnt lgkmcnt(7)
 ds_read_b64_tr_b16 a[78:79], v10 offset:20480
 v_xor_b32 v7, 32960, v6
 v_mfma_f32_16x16x32_bf16 v[84:87], a[108:111], a[184:187], v[84:87]
 ds_read_b64_tr_b16 a[80:81], v7 offset:0
 buffer_store_dwordx4 v[80:83], v1, s[12:15], s59 offen offset:1024 sc1
 v_mfma_f32_16x16x32_bf16 v[92:95], a[96:99], a[164:167], v[92:95]
 s_add_u32 m0, s29, 28672
 ds_read_b64_tr_b16 a[82:83], v7 offset:4096
 v_mfma_f32_16x16x32_bf16 v[92:95], a[100:103], a[172:175], v[92:95]
 ds_read_b64_tr_b16 a[84:85], v7 offset:16384
 buffer_load_dwordx4 v2, s[16:19], s54 offen lds
 v_mfma_f32_16x16x32_bf16 v[92:95], a[104:107], a[180:183], v[92:95]
 ds_read_b64_tr_b16 a[86:87], v7 offset:20480
 v_xor_b32 v8, 98496, v6
 v_mfma_f32_16x16x32_bf16 v[92:95], a[108:111], a[188:191], v[92:95]
 s_waitcnt lgkmcnt(6)
 ds_read_b64_tr_b16 a[88:89], v8 offset:0
 v_mfma_f32_16x16x32_bf16 v[100:103], a[64:67], a[160:163], v[100:103]
 s_add_u32 m0, s29, 65536
 ds_read_b64_tr_b16 a[90:91], v8 offset:4096
 v_add_u32 v2, 0x80000, v2
 v_mfma_f32_16x16x32_bf16 v[100:103], a[68:71], a[168:171], v[100:103]
 ds_read_b64_tr_b16 a[92:93], v8 offset:16384
 buffer_load_dwordx4 v2, s[16:19], 0 offen lds
 v_mfma_f32_16x16x32_bf16 v[100:103], a[72:75], a[176:179], v[100:103]
 s_waitcnt lgkmcnt(7)
 ds_read_b64_tr_b16 a[94:95], v8 offset:20480
 v_xor_b32 v9, 32992, v6
 v_mfma_f32_16x16x32_bf16 v[100:103], a[76:79], a[184:187], v[100:103]
 ds_read_b64_tr_b16 a[96:97], v9 offset:0
 v_mfma_f32_16x16x32_bf16 v[108:111], a[64:67], a[164:167], v[108:111]
 s_add_u32 s59, s56, 0
 ds_read_b64_tr_b16 a[98:99], v9 offset:4096
 v_mfma_f32_16x16x32_bf16 v[108:111], a[68:71], a[172:175], v[108:111]
 ds_read_b64_tr_b16 a[100:101], v9 offset:16384
 buffer_store_dwordx4 v[88:91], v1, s[12:15], s59 offen offset:1024 sc1
 v_mfma_f32_16x16x32_bf16 v[108:111], a[72:75], a[180:183], v[108:111]
 s_add_u32 m0, s29, 69632
 ds_read_b64_tr_b16 a[102:103], v9 offset:20480
 v_xor_b32 v10, 98528, v6
 v_mfma_f32_16x16x32_bf16 v[108:111], a[76:79], a[188:191], v[108:111]
 s_waitcnt lgkmcnt(6)
 ds_read_b64_tr_b16 a[104:105], v10 offset:0
 buffer_load_dwordx4 v2, s[16:19], s48 offen lds
 v_mfma_f32_16x16x32_bf16 v[116:119], a[80:83], a[160:163], v[116:119]
 ds_read_b64_tr_b16 a[106:107], v10 offset:4096
 v_mfma_f32_16x16x32_bf16 v[116:119], a[84:87], a[168:171], v[116:119]
 ds_read_b64_tr_b16 a[108:109], v10 offset:16384
 v_mfma_f32_16x16x32_bf16 v[116:119], a[88:91], a[176:179], v[116:119]
 s_waitcnt lgkmcnt(7)
 ds_read_b64_tr_b16 a[110:111], v10 offset:20480
 v_xor_b32 v7, 33024, v6
 v_mfma_f32_16x16x32_bf16 v[116:119], a[92:95], a[184:187], v[116:119]
 s_add_u32 m0, s29, 73728
 ds_read_b64_tr_b16 a[64:65], v7 offset:0
 v_mfma_f32_16x16x32_bf16 v[124:127], a[80:83], a[164:167], v[124:127]
 ds_read_b64_tr_b16 a[66:67], v7 offset:4096
 buffer_load_dwordx4 v2, s[16:19], s49 offen lds
 v_mfma_f32_16x16x32_bf16 v[124:127], a[84:87], a[172:175], v[124:127]
 ds_read_b64_tr_b16 a[68:69], v7 offset:16384
 v_mfma_f32_16x16x32_bf16 v[124:127], a[88:91], a[180:183], v[124:127]
 s_add_u32 s59, s56, 0
 ds_read_b64_tr_b16 a[70:71], v7 offset:20480
 v_xor_b32 v8, 98560, v6
 v_mfma_f32_16x16x32_bf16 v[124:127], a[92:95], a[188:191], v[124:127]
 s_waitcnt lgkmcnt(6)
 ds_read_b64_tr_b16 a[72:73], v8 offset:0
 buffer_store_dwordx4 v[96:99], v1, s[12:15], s59 offen offset:2048 sc1
 v_mfma_f32_16x16x32_bf16 v[132:135], a[96:99], a[160:163], v[132:135]
 s_add_u32 m0, s29, 77824
 ds_read_b64_tr_b16 a[74:75], v8 offset:4096
 v_mfma_f32_16x16x32_bf16 v[132:135], a[100:103], a[168:171], v[132:135]
 ds_read_b64_tr_b16 a[76:77], v8 offset:16384
 buffer_load_dwordx4 v2, s[16:19], s50 offen lds
 v_mfma_f32_16x16x32_bf16 v[132:135], a[104:107], a[176:179], v[132:135]
 s_waitcnt lgkmcnt(7)
 ds_read_b64_tr_b16 a[78:79], v8 offset:20480
 v_xor_b32 v9, 33056, v6
 v_mfma_f32_16x16x32_bf16 v[132:135], a[108:111], a[184:187], v[132:135]
 ds_read_b64_tr_b16 a[80:81], v9 offset:0
 v_mfma_f32_16x16x32_bf16 v[140:143], a[96:99], a[164:167], v[140:143]
 ds_read_b64_tr_b16 a[82:83], v9 offset:4096
 v_mfma_f32_16x16x32_bf16 v[140:143], a[100:103], a[172:175], v[140:143]
 ds_read_b64_tr_b16 a[84:85], v9 offset:16384
 v_mfma_f32_16x16x32_bf16 v[140:143], a[104:107], a[180:183], v[140:143]
 s_add_u32 m0, s29, 81920
 ds_read_b64_tr_b16 a[86:87], v9 offset:20480
 v_xor_b32 v10, 98592, v6
 v_mfma_f32_16x16x32_bf16 v[140:143], a[108:111], a[188:191], v[140:143]
 s_waitcnt lgkmcnt(6)
 ds_read_b64_tr_b16 a[88:89], v10 offset:0
 buffer_load_dwordx4 v2, s[16:19], s51 offen lds
 v_mfma_f32_16x16x32_bf16 v[148:151], a[64:67], a[160:163], v[148:151]
 s_add_u32 s59, s56, 16384
 ds_read_b64_tr_b16 a[90:91], v10 offset:4096
 v_mfma_f32_16x16x32_bf16 v[148:151], a[68:71], a[168:171], v[148:151]
 ds_read_b64_tr_b16 a[92:93], v10 offset:16384
 buffer_store_dwordx4 v[104:107], v1, s[12:15], s59 offen offset:2048 sc1
 v_mfma_f32_16x16x32_bf16 v[148:151], a[72:75], a[176:179], v[148:151]
 s_waitcnt lgkmcnt(7)
 ds_read_b64_tr_b16 a[94:95], v10 offset:20480
 v_xor_b32 v7, 33088, v6
 v_mfma_f32_16x16x32_bf16 v[148:151], a[76:79], a[184:187], v[148:151]
 s_add_u32 m0, s29, 86016
 ds_read_b64_tr_b16 a[96:97], v7 offset:0
 v_mfma_f32_16x16x32_bf16 v[156:159], a[64:67], a[164:167], v[156:159]
 ds_read_b64_tr_b16 a[98:99], v7 offset:4096
 buffer_load_dwordx4 v2, s[16:19], s52 offen lds
 v_mfma_f32_16x16x32_bf16 v[156:159], a[68:71], a[172:175], v[156:159]
 ds_read_b64_tr_b16 a[100:101], v7 offset:16384
 v_mfma_f32_16x16x32_bf16 v[156:159], a[72:75], a[180:183], v[156:159]
 ds_read_b64_tr_b16 a[102:103], v7 offset:20480
 v_xor_b32 v8, 98624, v6
 v_mfma_f32_16x16x32_bf16 v[156:159], a[76:79], a[188:191], v[156:159]
 s_waitcnt lgkmcnt(6)
 ds_read_b64_tr_b16 a[104:105], v8 offset:0
 v_mfma_f32_16x16x32_bf16 v[164:167], a[80:83], a[160:163], v[164:167]
 s_add_u32 m0, s29, 90112
 ds_read_b64_tr_b16 a[106:107], v8 offset:4096
 v_mfma_f32_16x16x32_bf16 v[164:167], a[84:87], a[168:171], v[164:167]
 ds_read_b64_tr_b16 a[108:109], v8 offset:16384
 buffer_load_dwordx4 v2, s[16:19], s53 offen lds
 v_mfma_f32_16x16x32_bf16 v[164:167], a[88:91], a[176:179], v[164:167]
 s_waitcnt lgkmcnt(7)
 ds_read_b64_tr_b16 a[110:111], v8 offset:20480
 v_xor_b32 v9, 33120, v6
 v_mfma_f32_16x16x32_bf16 v[164:167], a[92:95], a[184:187], v[164:167]
 s_add_u32 s59, s56, 16384
 ds_read_b64_tr_b16 a[64:65], v9 offset:0
 v_mfma_f32_16x16x32_bf16 v[172:175], a[80:83], a[164:167], v[172:175]
 ds_read_b64_tr_b16 a[66:67], v9 offset:4096
 buffer_store_dwordx4 v[112:115], v1, s[12:15], s59 offen offset:3072 sc1
 v_mfma_f32_16x16x32_bf16 v[172:175], a[84:87], a[172:175], v[172:175]
 ds_read_b64_tr_b16 a[68:69], v9 offset:16384
 v_mfma_f32_16x16x32_bf16 v[172:175], a[88:91], a[180:183], v[172:175]
 s_add_u32 m0, s29, 94208
 ds_read_b64_tr_b16 a[70:71], v9 offset:20480
 v_xor_b32 v10, 98656, v6
 v_mfma_f32_16x16x32_bf16 v[172:175], a[92:95], a[188:191], v[172:175]
 s_waitcnt lgkmcnt(6)
 ds_read_b64_tr_b16 a[72:73], v10 offset:0
 buffer_load_dwordx4 v2, s[16:19], s54 offen lds
 v_mfma_f32_16x16x32_bf16 v[180:183], a[96:99], a[160:163], v[180:183]
 ds_read_b64_tr_b16 a[74:75], v10 offset:4096
 v_mfma_f32_16x16x32_bf16 v[180:183], a[100:103], a[168:171], v[180:183]
 ds_read_b64_tr_b16 a[76:77], v10 offset:16384
 v_mfma_f32_16x16x32_bf16 v[180:183], a[104:107], a[176:179], v[180:183]
 s_waitcnt lgkmcnt(7)
 ds_read_b64_tr_b16 a[78:79], v10 offset:20480
 v_xor_b32 v7, 33152, v6
 v_mfma_f32_16x16x32_bf16 v[180:183], a[108:111], a[184:187], v[180:183]
 ds_read_b64_tr_b16 a[80:81], v7 offset:0
 v_mfma_f32_16x16x32_bf16 v[188:191], a[96:99], a[164:167], v[188:191]
 ds_read_b64_tr_b16 a[82:83], v7 offset:4096
 v_mfma_f32_16x16x32_bf16 v[188:191], a[100:103], a[172:175], v[188:191]
 ds_read_b64_tr_b16 a[84:85], v7 offset:16384
 v_mfma_f32_16x16x32_bf16 v[188:191], a[104:107], a[180:183], v[188:191]
 s_add_u32 s59, s56, 0
 ds_read_b64_tr_b16 a[86:87], v7 offset:20480
 v_xor_b32 v8, 98688, v6
 v_mfma_f32_16x16x32_bf16 v[188:191], a[108:111], a[188:191], v[188:191]
 s_waitcnt lgkmcnt(6)
 ds_read_b64_tr_b16 a[88:89], v8 offset:0
 buffer_store_dwordx4 v[120:123], v1, s[12:15], s59 offen offset:3072 sc1
 v_mfma_f32_16x16x32_bf16 v[196:199], a[64:67], a[160:163], v[196:199]
 ds_read_b64_tr_b16 a[90:91], v8 offset:4096
 v_mfma_f32_16x16x32_bf16 v[196:199], a[68:71], a[168:171], v[196:199]
 ds_read_b64_tr_b16 a[92:93], v8 offset:16384
 v_mfma_f32_16x16x32_bf16 v[196:199], a[72:75], a[176:179], v[196:199]
 s_waitcnt lgkmcnt(7)
 ds_read_b64_tr_b16 a[94:95], v8 offset:20480
 v_xor_b32 v9, 33184, v6
 v_mfma_f32_16x16x32_bf16 v[196:199], a[76:79], a[184:187], v[196:199]
 ds_read_b64_tr_b16 a[96:97], v9 offset:0
 v_mfma_f32_16x16x32_bf16 v[204:207], a[64:67], a[164:167], v[204:207]
 ds_read_b64_tr_b16 a[98:99], v9 offset:4096
 v_mfma_f32_16x16x32_bf16 v[204:207], a[68:71], a[172:175], v[204:207]
 ds_read_b64_tr_b16 a[100:101], v9 offset:16384
 v_mfma_f32_16x16x32_bf16 v[204:207], a[72:75], a[180:183], v[204:207]
 ds_read_b64_tr_b16 a[102:103], v9 offset:20480
 v_xor_b32 v10, 98720, v6
 v_mfma_f32_16x16x32_bf16 v[204:207], a[76:79], a[188:191], v[204:207]
 s_waitcnt lgkmcnt(6)
 ds_read_b64_tr_b16 a[104:105], v10 offset:0
 v_mfma_f32_16x16x32_bf16 v[212:215], a[80:83], a[160:163], v[212:215]
 s_add_u32 s59, s56, 4096
 ds_read_b64_tr_b16 a[106:107], v10 offset:4096
 v_mfma_f32_16x16x32_bf16 v[212:215], a[84:87], a[168:171], v[212:215]
 ds_read_b64_tr_b16 a[108:109], v10 offset:16384
 buffer_store_dwordx4 v[128:131], v1, s[12:15], s59 offen offset:0 sc1
 v_mfma_f32_16x16x32_bf16 v[212:215], a[88:91], a[176:179], v[212:215]
 s_waitcnt lgkmcnt(7)
 ds_read_b64_tr_b16 a[110:111], v10 offset:20480
 v_xor_b32 v7, 33216, v6
 v_mfma_f32_16x16x32_bf16 v[212:215], a[92:95], a[184:187], v[212:215]
 ds_read_b64_tr_b16 a[64:65], v7 offset:0
 v_lshrrev_b32 v120, 3, v0
 v_mfma_f32_16x16x32_bf16 v[220:223], a[80:83], a[164:167], v[220:223]
 ds_read_b64_tr_b16 a[66:67], v7 offset:4096
 v_mul_u32_u24 v120, 1792, v120
 v_mfma_f32_16x16x32_bf16 v[220:223], a[84:87], a[172:175], v[220:223]
 ds_read_b64_tr_b16 a[68:69], v7 offset:16384
 v_and_b32 v121, 7, v0
 v_mfma_f32_16x16x32_bf16 v[220:223], a[88:91], a[180:183], v[220:223]
 ds_read_b64_tr_b16 a[70:71], v7 offset:20480
 v_xor_b32 v8, 98752, v6
 v_mfma_f32_16x16x32_bf16 v[220:223], a[92:95], a[188:191], v[220:223]
 s_waitcnt lgkmcnt(6)
 ds_read_b64_tr_b16 a[72:73], v8 offset:0
 v_lshl_add_u32 v120, v121, 4, v120
 v_mfma_f32_16x16x32_bf16 v[228:231], a[96:99], a[160:163], v[228:231]
 ds_read_b64_tr_b16 a[74:75], v8 offset:4096
 v_add_u32 v120, s38, v120
 v_mfma_f32_16x16x32_bf16 v[228:231], a[100:103], a[168:171], v[228:231]
 s_add_u32 s59, s56, 20480
 ds_read_b64_tr_b16 a[76:77], v8 offset:16384
 v_lshlrev_b32 v121, 6, v121
 v_mfma_f32_16x16x32_bf16 v[228:231], a[104:107], a[176:179], v[228:231]
 s_waitcnt lgkmcnt(7)
 ds_read_b64_tr_b16 a[78:79], v8 offset:20480
 v_xor_b32 v9, 33248, v6
 v_mfma_f32_16x16x32_bf16 v[228:231], a[108:111], a[184:187], v[228:231]
 ds_read_b64_tr_b16 a[80:81], v9 offset:0
 buffer_store_dwordx4 v[136:139], v1, s[12:15], s59 offen offset:0 sc1
 v_mfma_f32_16x16x32_bf16 v[236:239], a[96:99], a[164:167], v[236:239]
 ds_read_b64_tr_b16 a[82:83], v9 offset:4096
 v_subrev_u32 v122, 2688, v120
 v_mfma_f32_16x16x32_bf16 v[236:239], a[100:103], a[172:175], v[236:239]
 ds_read_b64_tr_b16 a[84:85], v9 offset:16384
 v_subrev_u32 v123, 1792, v120
 v_mfma_f32_16x16x32_bf16 v[236:239], a[104:107], a[180:183], v[236:239]
 ds_read_b64_tr_b16 a[86:87], v9 offset:20480
 v_xor_b32 v10, 98784, v6
 v_mfma_f32_16x16x32_bf16 v[236:239], a[108:111], a[188:191], v[236:239]
 s_waitcnt lgkmcnt(6)
 ds_read_b64_tr_b16 a[88:89], v10 offset:0
 v_subrev_u32 v128, 896, v120
 v_mfma_f32_16x16x32_bf16 v[244:247], a[64:67], a[160:163], v[244:247]
 ds_read_b64_tr_b16 a[90:91], v10 offset:4096
 buffer_load_dwordx4 v[32:35], v122, s[4:7], 0 offen
 v_mfma_f32_16x16x32_bf16 v[244:247], a[68:71], a[168:171], v[244:247]
 s_waitcnt vmcnt(4)
 ds_read_b64_tr_b16 a[92:93], v10 offset:16384
 v_xor_b32 v7, 131072, v6
 v_mfma_f32_16x16x32_bf16 v[244:247], a[72:75], a[176:179], v[244:247]
 s_waitcnt lgkmcnt(7)
 s_barrier
 ds_read_b64_tr_b16 a[94:95], v10 offset:20480
 v_mfma_f32_16x16x32_bf16 v[244:247], a[76:79], a[184:187], v[244:247]
 s_and_b32 s58, s92, ~127
 ds_read_b64_tr_b16 a[96:97], v7 offset:0
 v_mfma_f32_16x16x32_bf16 v[252:255], a[64:67], a[164:167], v[252:255]
 s_add_u32 s59, s56, 20480
 ds_read_b64_tr_b16 a[98:99], v7 offset:4096
 v_mfma_f32_16x16x32_bf16 v[252:255], a[68:71], a[172:175], v[252:255]
 ds_read_b64_tr_b16 a[100:101], v7 offset:16384
 buffer_store_dwordx4 v[144:147], v1, s[12:15], s59 offen offset:1024 sc1
 v_mfma_f32_16x16x32_bf16 v[252:255], a[72:75], a[180:183], v[252:255]
 s_lshl_b32 s37, s25, 1
 ds_read_b64_tr_b16 a[102:103], v7 offset:20480
 v_xor_b32 v8, 0, v6
 v_mfma_f32_16x16x32_bf16 v[252:255], a[76:79], a[188:191], v[252:255]
 s_waitcnt lgkmcnt(6)
 ds_read_b64_tr_b16 a[104:105], v8 offset:0
 buffer_load_dwordx4 v[40:43], v123, s[4:7], 0 offen
 v_mfma_f32_16x16x32_bf16 v[16:19], a[80:83], a[160:163], v[16:19]
 s_sub_i32 s38, 13, s37
 ds_read_b64_tr_b16 a[106:107], v8 offset:4096
 v_accvgpr_read_b32 v5, a248
 v_mfma_f32_16x16x32_bf16 v[16:19], a[84:87], a[168:171], v[16:19]
 s_max_i32 s38, s38, 0
 ds_read_b64_tr_b16 a[108:109], v8 offset:16384
 v_mfma_f32_16x16x32_bf16 v[16:19], a[88:91], a[176:179], v[16:19]
 s_waitcnt lgkmcnt(7)
 ds_read_b64_tr_b16 a[110:111], v8 offset:20480
 v_xor_b32 v9, 65536, v6
 v_mfma_f32_16x16x32_bf16 v[16:19], a[92:95], a[184:187], v[16:19]
 ds_read_b64_tr_b16 a[64:65], v9 offset:0
 buffer_load_dwordx4 v[48:51], v128, s[4:7], 0 offen
 v_mfma_f32_16x16x32_bf16 v[24:27], a[80:83], a[164:167], v[24:27]
 s_lshl_b32 s49, s26, 20
 ds_read_b64_tr_b16 a[66:67], v9 offset:4096
 v_mfma_f32_16x16x32_bf16 v[24:27], a[84:87], a[172:175], v[24:27]
 s_lshl_b32 s50, s3, 13
 ds_read_b64_tr_b16 a[68:69], v9 offset:16384
 v_mfma_f32_16x16x32_bf16 v[24:27], a[88:91], a[180:183], v[24:27]
 s_add_u32 s59, s56, 4096
 ds_read_b64_tr_b16 a[70:71], v9 offset:20480
 v_xor_b32 v10, 131104, v6
 v_mfma_f32_16x16x32_bf16 v[24:27], a[92:95], a[188:191], v[24:27]
 s_waitcnt lgkmcnt(6)
 ds_read_b64_tr_b16 a[72:73], v10 offset:0
 buffer_store_dwordx4 v[152:155], v1, s[12:15], s59 offen offset:1024 sc1
 v_mfma_f32_16x16x32_bf16 v[28:31], a[96:99], a[192:195], v[28:31]
 s_add_u32 s49, s49, s50
 ds_read_b64_tr_b16 a[74:75], v10 offset:4096
 v_mfma_f32_16x16x32_bf16 v[28:31], a[100:103], a[200:203], v[28:31]
 ds_read_b64_tr_b16 a[76:77], v10 offset:16384
 buffer_load_dwordx4 v[56:59], v120, s[4:7], 0 offen offset:0
 v_mfma_f32_16x16x32_bf16 v[28:31], a[104:107], a[208:211], v[28:31]
 s_waitcnt lgkmcnt(3)
 ds_read_b64_tr_b16 a[78:79], v10 offset:20480
 v_xor_b32 v7, 32, v6
 v_mfma_f32_16x16x32_bf16 v[28:31], a[108:111], a[216:219], v[28:31]
 s_mov_b32 s54, 2
 ds_read_b64_tr_b16 a[80:81], v7 offset:0
 v_mfma_f32_16x16x32_bf16 v[28:31], a[64:67], a[112:115], v[28:31]
 s_sub_u32 s44, 31, s37
 ds_read_b64_tr_b16 a[82:83], v7 offset:4096
 v_mfma_f32_16x16x32_bf16 v[28:31], a[68:71], a[120:123], v[28:31]
 ds_read_b64_tr_b16 a[84:85], v7 offset:16384
 buffer_load_dwordx4 v[64:67], v120, s[4:7], 0 offen offset:896
 v_mfma_f32_16x16x32_bf16 v[44:47], a[96:99], a[196:199], v[44:47]
 s_sub_u32 s44, s44, s38
 ds_read_b64_tr_b16 a[86:87], v7 offset:20480
 v_xor_b32 v8, 65568, v6
 v_mfma_f32_16x16x32_bf16 v[44:47], a[100:103], a[204:207], v[44:47]
 s_lshl_b32 s55, s38, 15
 ds_read_b64_tr_b16 a[88:89], v8 offset:0
 v_mfma_f32_16x16x32_bf16 v[44:47], a[104:107], a[212:215], v[44:47]
 s_add_u32 s59, s56, 4096
 ds_read_b64_tr_b16 a[90:91], v8 offset:4096
 v_mfma_f32_16x16x32_bf16 v[44:47], a[108:111], a[220:223], v[44:47]
 ds_read_b64_tr_b16 a[92:93], v8 offset:16384
 buffer_store_dwordx4 v[160:163], v1, s[12:15], s59 offen offset:2048 sc1
 v_mfma_f32_16x16x32_bf16 v[44:47], a[64:67], a[116:119], v[44:47]
 s_add_u32 s42, s55, s49
 ds_read_b64_tr_b16 a[94:95], v8 offset:20480
 v_xor_b32 v9, 131136, v6
 v_mfma_f32_16x16x32_bf16 v[44:47], a[68:71], a[124:127], v[44:47]
 s_waitcnt lgkmcnt(6)
 ds_read_b64_tr_b16 a[96:97], v9 offset:0
 buffer_load_dwordx4 v[72:75], v120, s[8:11], 0 offen offset:0
 v_mfma_f32_16x16x32_bf16 v[52:55], a[72:75], a[192:195], v[52:55]
 s_add_u32 s60, s58, 16
 ds_read_b64_tr_b16 a[98:99], v9 offset:4096
 v_mfma_f32_16x16x32_bf16 v[52:55], a[76:79], a[200:203], v[52:55]
 s_sub_u32 s45, 17, s37
 ds_read_b64_tr_b16 a[100:101], v9 offset:16384
 v_mfma_f32_16x16x32_bf16 v[52:55], a[80:83], a[208:211], v[52:55]
 s_waitcnt lgkmcnt(3)
 ds_read_b64_tr_b16 a[102:103], v9 offset:20480
 v_xor_b32 v10, 64, v6
 v_mfma_f32_16x16x32_bf16 v[52:55], a[84:87], a[216:219], v[52:55]
 ds_read_b64_tr_b16 a[104:105], v10 offset:0
 buffer_load_dwordx4 v[80:83], v120, s[8:11], 0 offen offset:896
 v_mfma_f32_16x16x32_bf16 v[52:55], a[88:91], a[112:115], v[52:55]
 s_sub_u32 s66, s42, 0x8000
 ds_read_b64_tr_b16 a[106:107], v10 offset:4096
 v_mfma_f32_16x16x32_bf16 v[52:55], a[92:95], a[120:123], v[52:55]
 s_add_u32 s42, s49, 491520
 ds_read_b64_tr_b16 a[108:109], v10 offset:16384
 v_mfma_f32_16x16x32_bf16 v[60:63], a[72:75], a[196:199], v[60:63]
 s_add_u32 s59, s56, 20480
 ds_read_b64_tr_b16 a[110:111], v10 offset:20480
 v_xor_b32 v7, 65600, v6
 v_mfma_f32_16x16x32_bf16 v[60:63], a[76:79], a[204:207], v[60:63]
 ds_read_b64_tr_b16 a[64:65], v7 offset:0
 buffer_store_dwordx4 v[168:171], v1, s[12:15], s59 offen offset:2048 sc1
 v_mfma_f32_16x16x32_bf16 v[60:63], a[80:83], a[212:215], v[60:63]
 s_add_u32 s67, s49, 524288
 ds_read_b64_tr_b16 a[66:67], v7 offset:4096
 v_mfma_f32_16x16x32_bf16 v[60:63], a[84:87], a[220:223], v[60:63]
 ds_read_b64_tr_b16 a[68:69], v7 offset:16384
 buffer_load_dwordx4 v[88:91], v121, s[20:23], s39 offen offset:0
 v_mfma_f32_16x16x32_bf16 v[60:63], a[88:91], a[116:119], v[60:63]
 s_add_u32 s68, s66, 16777216
 ds_read_b64_tr_b16 a[70:71], v7 offset:20480
 v_xor_b32 v8, 131168, v6
 v_mfma_f32_16x16x32_bf16 v[60:63], a[92:95], a[124:127], v[60:63]
 s_waitcnt lgkmcnt(6)
 ds_read_b64_tr_b16 a[72:73], v8 offset:0
 v_mfma_f32_16x16x32_bf16 v[20:23], a[96:99], a[192:195], v[20:23]
 s_add_u32 s69, s67, 16777216
 ds_read_b64_tr_b16 a[74:75], v8 offset:4096
 v_mfma_f32_16x16x32_bf16 v[20:23], a[100:103], a[200:203], v[20:23]
 ds_read_b64_tr_b16 a[76:77], v8 offset:16384
 buffer_load_dwordx4 v[96:99], v121, s[20:23], s39 offen offset:16
 v_mfma_f32_16x16x32_bf16 v[20:23], a[104:107], a[208:211], v[20:23]
 s_waitcnt lgkmcnt(3)
 ds_read_b64_tr_b16 a[78:79], v8 offset:20480
 v_xor_b32 v9, 96, v6
 v_mfma_f32_16x16x32_bf16 v[20:23], a[108:111], a[216:219], v[20:23]
 s_mov_b32 s70, 0xffff8000
 ds_read_b64_tr_b16 a[80:81], v9 offset:0
 v_mul_f32 v28, s34, v28
 v_mfma_f32_16x16x32_bf16 v[20:23], a[64:67], a[112:115], v[20:23]
 s_add_u32 s59, s56, 20480
 ds_read_b64_tr_b16 a[82:83], v9 offset:4096
 v_mul_f32 v29, s34, v29
 v_mfma_f32_16x16x32_bf16 v[20:23], a[68:71], a[120:123], v[20:23]
 ds_read_b64_tr_b16 a[84:85], v9 offset:16384
 buffer_store_dwordx4 v[176:179], v1, s[12:15], s59 offen offset:3072 sc1
 v_mfma_f32_16x16x32_bf16 v[36:39], a[96:99], a[196:199], v[36:39]
 s_mov_b32 s71, s70
 ds_read_b64_tr_b16 a[86:87], v9 offset:20480
 v_xor_b32 v10, 65632, v6
 v_mfma_f32_16x16x32_bf16 v[36:39], a[100:103], a[204:207], v[36:39]
 ds_read_b64_tr_b16 a[88:89], v10 offset:0
 buffer_load_dwordx4 v[104:107], v121, s[20:23], s39 offen offset:32
 v_mfma_f32_16x16x32_bf16 v[36:39], a[104:107], a[212:215], v[36:39]
 s_add_u32 s43, s42, 16777216
 ds_read_b64_tr_b16 a[90:91], v10 offset:4096
 v_mul_f32 v30, s34, v30
 v_mfma_f32_16x16x32_bf16 v[36:39], a[108:111], a[220:223], v[36:39]
 s_mov_b32 s40, s50
 ds_read_b64_tr_b16 a[92:93], v10 offset:16384
 v_mul_f32 v31, s34, v31
 v_mfma_f32_16x16x32_bf16 v[36:39], a[64:67], a[116:119], v[36:39]
 s_add_u32 s41, s50, 0x10000
 ds_read_b64_tr_b16 a[94:95], v10 offset:20480
 v_xor_b32 v7, 131200, v6
 v_mfma_f32_16x16x32_bf16 v[36:39], a[68:71], a[124:127], v[36:39]
 s_waitcnt lgkmcnt(6)
 ds_read_b64_tr_b16 a[96:97], v7 offset:0
 buffer_load_dwordx4 v[112:115], v121, s[20:23], s39 offen offset:48
 v_mfma_f32_16x16x32_bf16 v[68:71], a[72:75], a[192:195], v[68:71]
 s_lshr_b32 s61, s95, 4
 ds_read_b64_tr_b16 a[98:99], v7 offset:4096
 v_mul_f32 v52, s34, v52
 v_mfma_f32_16x16x32_bf16 v[68:71], a[76:79], a[200:203], v[68:71]
 s_add_u32 s59, s56, 4096
 ds_read_b64_tr_b16 a[100:101], v7 offset:16384
 v_mul_f32 v53, s34, v53
 v_mfma_f32_16x16x32_bf16 v[68:71], a[80:83], a[208:211], v[68:71]
 s_waitcnt lgkmcnt(3)
 ds_read_b64_tr_b16 a[102:103], v7 offset:20480
 v_xor_b32 v8, 128, v6
 v_mfma_f32_16x16x32_bf16 v[68:71], a[84:87], a[216:219], v[68:71]
 ds_read_b64_tr_b16 a[104:105], v8 offset:0
 buffer_store_dwordx4 v[184:187], v1, s[12:15], s59 offen offset:3072 sc1
 v_mfma_f32_16x16x32_bf16 v[68:71], a[88:91], a[112:115], v[68:71]
 s_lshl_b32 s61, s61, 7
 ds_read_b64_tr_b16 a[106:107], v8 offset:4096
 v_mul_f32 v54, s34, v54
 v_mfma_f32_16x16x32_bf16 v[68:71], a[92:95], a[120:123], v[68:71]
 s_add_u32 s61, s61, 84959232
 ds_read_b64_tr_b16 a[108:109], v8 offset:16384
 v_mul_f32 v55, s34, v55
 v_mfma_f32_16x16x32_bf16 v[76:79], a[72:75], a[196:199], v[76:79]
 s_mov_b32 s47, 0x4b800000
 ds_read_b64_tr_b16 a[110:111], v8 offset:20480
 v_xor_b32 v9, 65664, v6
 v_mfma_f32_16x16x32_bf16 v[76:79], a[76:79], a[204:207], v[76:79]
 s_lshl_b32 s30, s95, 1
 ds_read_b64_tr_b16 a[64:65], v9 offset:0
 v_cvt_pk_bf16_f32 v28, v28, v29
 v_mfma_f32_16x16x32_bf16 v[76:79], a[80:83], a[212:215], v[76:79]
 s_lshr_b32 s31, s3, 1
 ds_read_b64_tr_b16 a[66:67], v9 offset:4096
 v_cvt_pk_bf16_f32 v29, v30, v31
 v_mfma_f32_16x16x32_bf16 v[76:79], a[84:87], a[220:223], v[76:79]
 s_add_u32 s30, s30, s31
 ds_read_b64_tr_b16 a[68:69], v9 offset:16384
 v_cvt_pk_bf16_f32 v30, v52, v53
 v_mfma_f32_16x16x32_bf16 v[76:79], a[88:91], a[116:119], v[76:79]
 s_min_u32 s30, s30, 223
 ds_read_b64_tr_b16 a[70:71], v9 offset:20480
 v_xor_b32 v10, 131232, v6
 v_mfma_f32_16x16x32_bf16 v[76:79], a[92:95], a[124:127], v[76:79]
 s_waitcnt lgkmcnt(6)
 ds_read_b64_tr_b16 a[72:73], v10 offset:0
 v_cvt_pk_bf16_f32 v31, v54, v55
 v_mfma_f32_16x16x32_bf16 v[84:87], a[96:99], a[192:195], v[84:87]
 s_add_u32 s59, s56, 36864
 ds_read_b64_tr_b16 a[74:75], v10 offset:4096
 v_accvgpr_write_b32 a0, v28
 v_mfma_f32_16x16x32_bf16 v[84:87], a[100:103], a[200:203], v[84:87]
 ds_read_b64_tr_b16 a[76:77], v10 offset:16384
 buffer_store_dwordx4 v[192:195], v1, s[12:15], s59 offen offset:0 sc1
 v_mfma_f32_16x16x32_bf16 v[84:87], a[104:107], a[208:211], v[84:87]
 s_waitcnt lgkmcnt(3)
 ds_read_b64_tr_b16 a[78:79], v10 offset:20480
 v_xor_b32 v7, 160, v6
 v_mfma_f32_16x16x32_bf16 v[84:87], a[108:111], a[216:219], v[84:87]
 s_lshl_b32 s30, s30, 2
 ds_read_b64_tr_b16 a[80:81], v7 offset:0
 v_accvgpr_write_b32 a1, v29
 v_mfma_f32_16x16x32_bf16 v[84:87], a[64:67], a[112:115], v[84:87]
 s_lshl_b32 s53, s3, 4
 ds_read_b64_tr_b16 a[82:83], v7 offset:4096
 v_accvgpr_write_b32 a2, v30
 v_mfma_f32_16x16x32_bf16 v[84:87], a[68:71], a[120:123], v[84:87]
 ds_read_b64_tr_b16 a[84:85], v7 offset:16384
 v_accvgpr_write_b32 a3, v31
 v_mfma_f32_16x16x32_bf16 v[92:95], a[96:99], a[196:199], v[92:95]
 s_add_u32 s59, s62, 0
 ds_read_b64_tr_b16 a[86:87], v7 offset:20480
 v_xor_b32 v8, 65696, v6
 v_mfma_f32_16x16x32_bf16 v[92:95], a[100:103], a[204:207], v[92:95]
 ds_read_b64_tr_b16 a[88:89], v8 offset:0
 buffer_store_dwordx4 v[28:31], v1, s[12:15], s59 offen offset:0 sc1
 v_mfma_f32_16x16x32_bf16 v[92:95], a[104:107], a[212:215], v[92:95]
 ds_read_b64_tr_b16 a[90:91], v8 offset:4096
 v_mul_f32 v44, s34, v44
 v_mfma_f32_16x16x32_bf16 v[92:95], a[108:111], a[220:223], v[92:95]
 ds_read_b64_tr_b16 a[92:93], v8 offset:16384
 v_mul_f32 v45, s34, v45
 v_mfma_f32_16x16x32_bf16 v[92:95], a[64:67], a[116:119], v[92:95]
 s_add_u32 s59, s56, 53248
 ds_read_b64_tr_b16 a[94:95], v8 offset:20480
 v_xor_b32 v9, 131264, v6
 v_mfma_f32_16x16x32_bf16 v[92:95], a[68:71], a[124:127], v[92:95]
 s_waitcnt lgkmcnt(6)
 ds_read_b64_tr_b16 a[96:97], v9 offset:0
 buffer_store_dwordx4 v[200:203], v1, s[12:15], s59 offen offset:0 sc1
 v_mfma_f32_16x16x32_bf16 v[100:103], a[72:75], a[192:195], v[100:103]
 ds_read_b64_tr_b16 a[98:99], v9 offset:4096
 v_mul_f32 v46, s34, v46
 v_mfma_f32_16x16x32_bf16 v[100:103], a[76:79], a[200:203], v[100:103]
 ds_read_b64_tr_b16 a[100:101], v9 offset:16384
 v_mul_f32 v47, s34, v47
 v_mfma_f32_16x16x32_bf16 v[100:103], a[80:83], a[208:211], v[100:103]
 s_waitcnt lgkmcnt(3)
 ds_read_b64_tr_b16 a[102:103], v9 offset:20480
 v_xor_b32 v10, 192, v6
 v_mfma_f32_16x16x32_bf16 v[100:103], a[84:87], a[216:219], v[100:103]
 ds_read_b64_tr_b16 a[104:105], v10 offset:0
 v_mul_f32 v60, s34, v60
 v_mfma_f32_16x16x32_bf16 v[100:103], a[88:91], a[112:115], v[100:103]
 ds_read_b64_tr_b16 a[106:107], v10 offset:4096
 v_mul_f32 v61, s34, v61
 v_mfma_f32_16x16x32_bf16 v[100:103], a[92:95], a[120:123], v[100:103]
 ds_read_b64_tr_b16 a[108:109], v10 offset:16384
 v_mul_f32 v62, s34, v62
 v_mfma_f32_16x16x32_bf16 v[108:111], a[72:75], a[196:199], v[108:111]
 ds_read_b64_tr_b16 a[110:111], v10 offset:20480
 v_xor_b32 v7, 65728, v6
 v_mfma_f32_16x16x32_bf16 v[108:111], a[76:79], a[204:207], v[108:111]
 ds_read_b64_tr_b16 a[64:65], v7 offset:0
 v_mul_f32 v63, s34, v63
 v_mfma_f32_16x16x32_bf16 v[108:111], a[80:83], a[212:215], v[108:111]
 s_add_u32 s59, s56, 53248
 ds_read_b64_tr_b16 a[66:67], v7 offset:4096
 v_cvt_pk_bf16_f32 v44, v44, v45
 v_mfma_f32_16x16x32_bf16 v[108:111], a[84:87], a[220:223], v[108:111]
 ds_read_b64_tr_b16 a[68:69], v7 offset:16384
 buffer_store_dwordx4 v[208:211], v1, s[12:15], s59 offen offset:1024 sc1
 v_mfma_f32_16x16x32_bf16 v[108:111], a[88:91], a[116:119], v[108:111]
 ds_read_b64_tr_b16 a[70:71], v7 offset:20480
 v_xor_b32 v8, 131296, v6
 v_mfma_f32_16x16x32_bf16 v[108:111], a[92:95], a[124:127], v[108:111]
 s_waitcnt lgkmcnt(6)
 ds_read_b64_tr_b16 a[72:73], v8 offset:0
 v_cvt_pk_bf16_f32 v45, v46, v47
 v_mfma_f32_16x16x32_bf16 v[116:119], a[96:99], a[192:195], v[116:119]
 ds_read_b64_tr_b16 a[74:75], v8 offset:4096
 v_cvt_pk_bf16_f32 v46, v60, v61
 v_mfma_f32_16x16x32_bf16 v[116:119], a[100:103], a[200:203], v[116:119]
 s_add_u32 s59, s62, 32768
 ds_read_b64_tr_b16 a[76:77], v8 offset:16384
 v_cvt_pk_bf16_f32 v47, v62, v63
 v_mfma_f32_16x16x32_bf16 v[116:119], a[104:107], a[208:211], v[116:119]
 s_waitcnt lgkmcnt(3)
 ds_read_b64_tr_b16 a[78:79], v8 offset:20480
 v_xor_b32 v9, 224, v6
 v_mfma_f32_16x16x32_bf16 v[116:119], a[108:111], a[216:219], v[116:119]
 ds_read_b64_tr_b16 a[80:81], v9 offset:0
 buffer_store_dwordx4 v[44:47], v1, s[12:15], s59 offen offset:0 sc1
 v_mfma_f32_16x16x32_bf16 v[116:119], a[64:67], a[112:115], v[116:119]
 ds_read_b64_tr_b16 a[82:83], v9 offset:4096
 v_accvgpr_write_b32 a32, v44
 v_mfma_f32_16x16x32_bf16 v[116:119], a[68:71], a[120:123], v[116:119]
 ds_read_b64_tr_b16 a[84:85], v9 offset:16384
 v_accvgpr_write_b32 a33, v45
 v_mfma_f32_16x16x32_bf16 v[124:127], a[96:99], a[196:199], v[124:127]
 s_add_u32 s59, s56, 36864
 ds_read_b64_tr_b16 a[86:87], v9 offset:20480
 v_xor_b32 v10, 65760, v6
 v_mfma_f32_16x16x32_bf16 v[124:127], a[100:103], a[204:207], v[124:127]
 ds_read_b64_tr_b16 a[88:89], v10 offset:0
 buffer_store_dwordx4 v[216:219], v1, s[12:15], s59 offen offset:1024 sc1
 v_mfma_f32_16x16x32_bf16 v[124:127], a[104:107], a[212:215], v[124:127]
 ds_read_b64_tr_b16 a[90:91], v10 offset:4096
 v_accvgpr_write_b32 a34, v46
 v_mfma_f32_16x16x32_bf16 v[124:127], a[108:111], a[220:223], v[124:127]
 ds_read_b64_tr_b16 a[92:93], v10 offset:16384
 v_accvgpr_write_b32 a35, v47
 v_mfma_f32_16x16x32_bf16 v[124:127], a[64:67], a[116:119], v[124:127]
 ds_read_b64_tr_b16 a[94:95], v10 offset:20480
 v_xor_b32 v7, 131328, v6
 v_mfma_f32_16x16x32_bf16 v[124:127], a[68:71], a[124:127], v[124:127]
 s_waitcnt lgkmcnt(6)
 ds_read_b64_tr_b16 a[96:97], v7 offset:0
 v_mul_f32 v20, s34, v20
 v_mfma_f32_16x16x32_bf16 v[132:135], a[72:75], a[192:195], v[132:135]
 ds_read_b64_tr_b16 a[98:99], v7 offset:4096
 v_mul_f32 v21, s34, v21
 v_mfma_f32_16x16x32_bf16 v[132:135], a[76:79], a[200:203], v[132:135]
 ds_read_b64_tr_b16 a[100:101], v7 offset:16384
 v_mul_f32 v22, s34, v22
 v_mfma_f32_16x16x32_bf16 v[132:135], a[80:83], a[208:211], v[132:135]
 s_waitcnt lgkmcnt(3)
 ds_read_b64_tr_b16 a[102:103], v7 offset:20480
 v_xor_b32 v8, 256, v6
 v_mfma_f32_16x16x32_bf16 v[132:135], a[84:87], a[216:219], v[132:135]
 ds_read_b64_tr_b16 a[104:105], v8 offset:0
 v_mul_f32 v23, s34, v23
 v_mfma_f32_16x16x32_bf16 v[132:135], a[88:91], a[112:115], v[132:135]
 s_add_u32 s59, s56, 36864
 ds_read_b64_tr_b16 a[106:107], v8 offset:4096
 v_mul_f32 v68, s34, v68
 v_mfma_f32_16x16x32_bf16 v[132:135], a[92:95], a[120:123], v[132:135]
 ds_read_b64_tr_b16 a[108:109], v8 offset:16384
 buffer_store_dwordx4 v[224:227], v1, s[12:15], s59 offen offset:2048 sc1
 v_mfma_f32_16x16x32_bf16 v[140:143], a[72:75], a[196:199], v[140:143]
 ds_read_b64_tr_b16 a[110:111], v8 offset:20480
 v_xor_b32 v9, 65792, v6
 v_mfma_f32_16x16x32_bf16 v[140:143], a[76:79], a[204:207], v[140:143]
 ds_read_b64_tr_b16 a[64:65], v9 offset:0
 v_mul_f32 v69, s34, v69
 v_mfma_f32_16x16x32_bf16 v[140:143], a[80:83], a[212:215], v[140:143]
 ds_read_b64_tr_b16 a[66:67], v9 offset:4096
 v_mul_f32 v70, s34, v70
 v_mfma_f32_16x16x32_bf16 v[140:143], a[84:87], a[220:223], v[140:143]
 ds_read_b64_tr_b16 a[68:69], v9 offset:16384
 v_mul_f32 v71, s34, v71
 v_mfma_f32_16x16x32_bf16 v[140:143], a[88:91], a[116:119], v[140:143]
 ds_read_b64_tr_b16 a[70:71], v9 offset:20480
 v_xor_b32 v10, 131360, v6
 v_mfma_f32_16x16x32_bf16 v[140:143], a[92:95], a[124:127], v[140:143]
 s_waitcnt lgkmcnt(6)
 ds_read_b64_tr_b16 a[72:73], v10 offset:0
 v_cvt_pk_bf16_f32 v20, v20, v21
 v_mfma_f32_16x16x32_bf16 v[148:151], a[96:99], a[192:195], v[148:151]
 ds_read_b64_tr_b16 a[74:75], v10 offset:4096
 v_cvt_pk_bf16_f32 v21, v22, v23
 v_mfma_f32_16x16x32_bf16 v[148:151], a[100:103], a[200:203], v[148:151]
 s_add_u32 s59, s56, 53248
 ds_read_b64_tr_b16 a[76:77], v10 offset:16384
 v_cvt_pk_bf16_f32 v22, v68, v69
 v_mfma_f32_16x16x32_bf16 v[148:151], a[104:107], a[208:211], v[148:151]
 s_waitcnt lgkmcnt(3)
 ds_read_b64_tr_b16 a[78:79], v10 offset:20480
 v_xor_b32 v7, 288, v6
 v_mfma_f32_16x16x32_bf16 v[148:151], a[108:111], a[216:219], v[148:151]
 ds_read_b64_tr_b16 a[80:81], v7 offset:0
 buffer_store_dwordx4 v[232:235], v1, s[12:15], s59 offen offset:2048 sc1
 v_mfma_f32_16x16x32_bf16 v[148:151], a[64:67], a[112:115], v[148:151]
 s_add_u32 s59, s62, 0
 ds_read_b64_tr_b16 a[82:83], v7 offset:4096
 v_cvt_pk_bf16_f32 v23, v70, v71
 v_mfma_f32_16x16x32_bf16 v[148:151], a[68:71], a[120:123], v[148:151]
 ds_read_b64_tr_b16 a[84:85], v7 offset:16384
 buffer_store_dwordx4 v[20:23], v1, s[12:15], s59 offen offset:1024 sc1
 v_mfma_f32_16x16x32_bf16 v[156:159], a[96:99], a[196:199], v[156:159]
 ds_read_b64_tr_b16 a[86:87], v7 offset:20480
 v_xor_b32 v8, 65824, v6
 v_mfma_f32_16x16x32_bf16 v[156:159], a[100:103], a[204:207], v[156:159]
 ds_read_b64_tr_b16 a[88:89], v8 offset:0
 v_accvgpr_write_b32 a4, v20
 v_mfma_f32_16x16x32_bf16 v[156:159], a[104:107], a[212:215], v[156:159]
 ds_read_b64_tr_b16 a[90:91], v8 offset:4096
 v_accvgpr_write_b32 a5, v21
 v_mfma_f32_16x16x32_bf16 v[156:159], a[108:111], a[220:223], v[156:159]
 ds_read_b64_tr_b16 a[92:93], v8 offset:16384
 v_accvgpr_write_b32 a6, v22
 v_mfma_f32_16x16x32_bf16 v[156:159], a[64:67], a[116:119], v[156:159]
 ds_read_b64_tr_b16 a[94:95], v8 offset:20480
 v_xor_b32 v9, 131392, v6
 v_mfma_f32_16x16x32_bf16 v[156:159], a[68:71], a[124:127], v[156:159]
 s_waitcnt lgkmcnt(6)
 ds_read_b64_tr_b16 a[96:97], v9 offset:0
 v_accvgpr_write_b32 a7, v23
 v_mfma_f32_16x16x32_bf16 v[164:167], a[72:75], a[192:195], v[164:167]
 s_add_u32 s59, s56, 53248
 ds_read_b64_tr_b16 a[98:99], v9 offset:4096
 v_mul_f32 v36, s34, v36
 v_mfma_f32_16x16x32_bf16 v[164:167], a[76:79], a[200:203], v[164:167]
 ds_read_b64_tr_b16 a[100:101], v9 offset:16384
 buffer_store_dwordx4 v[240:243], v1, s[12:15], s59 offen offset:3072 sc1
 v_mfma_f32_16x16x32_bf16 v[164:167], a[80:83], a[208:211], v[164:167]
 s_waitcnt lgkmcnt(3)
 ds_read_b64_tr_b16 a[102:103], v9 offset:20480
 v_xor_b32 v10, 320, v6
 v_mfma_f32_16x16x32_bf16 v[164:167], a[84:87], a[216:219], v[164:167]
 ds_read_b64_tr_b16 a[104:105], v10 offset:0
 v_mul_f32 v37, s34, v37
 v_mfma_f32_16x16x32_bf16 v[164:167], a[88:91], a[112:115], v[164:167]
 ds_read_b64_tr_b16 a[106:107], v10 offset:4096
 v_mul_f32 v38, s34, v38
 v_mfma_f32_16x16x32_bf16 v[164:167], a[92:95], a[120:123], v[164:167]
 ds_read_b64_tr_b16 a[108:109], v10 offset:16384
 v_mul_f32 v39, s34, v39
 v_mfma_f32_16x16x32_bf16 v[172:175], a[72:75], a[196:199], v[172:175]
 ds_read_b64_tr_b16 a[110:111], v10 offset:20480
 v_xor_b32 v7, 65856, v6
 v_mfma_f32_16x16x32_bf16 v[172:175], a[76:79], a[204:207], v[172:175]
 ds_read_b64_tr_b16 a[64:65], v7 offset:0
 v_mul_f32 v76, s34, v76
 v_mfma_f32_16x16x32_bf16 v[172:175], a[80:83], a[212:215], v[172:175]
 ds_read_b64_tr_b16 a[66:67], v7 offset:4096
 v_mul_f32 v77, s34, v77
 v_mfma_f32_16x16x32_bf16 v[172:175], a[84:87], a[220:223], v[172:175]
 ds_read_b64_tr_b16 a[68:69], v7 offset:16384
 v_mul_f32 v78, s34, v78
 v_mfma_f32_16x16x32_bf16 v[172:175], a[88:91], a[116:119], v[172:175]
 s_add_u32 s59, s56, 36864
 ds_read_b64_tr_b16 a[70:71], v7 offset:20480
 v_xor_b32 v8, 131424, v6
 v_mfma_f32_16x16x32_bf16 v[172:175], a[92:95], a[124:127], v[172:175]
 s_waitcnt lgkmcnt(6)
 ds_read_b64_tr_b16 a[72:73], v8 offset:0
 buffer_store_dwordx4 v[248:251], v1, s[12:15], s59 offen offset:3072 sc1
 v_mfma_f32_16x16x32_bf16 v[180:183], a[96:99], a[192:195], v[180:183]
 ds_read_b64_tr_b16 a[74:75], v8 offset:4096
 v_mul_f32 v79, s34, v79
 v_mfma_f32_16x16x32_bf16 v[180:183], a[100:103], a[200:203], v[180:183]
 ds_read_b64_tr_b16 a[76:77], v8 offset:16384
 v_cvt_pk_bf16_f32 v36, v36, v37
 v_mfma_f32_16x16x32_bf16 v[180:183], a[104:107], a[208:211], v[180:183]
 s_waitcnt lgkmcnt(3)
 ds_read_b64_tr_b16 a[78:79], v8 offset:20480
 v_xor_b32 v9, 352, v6
 v_mfma_f32_16x16x32_bf16 v[180:183], a[108:111], a[216:219], v[180:183]
 ds_read_b64_tr_b16 a[80:81], v9 offset:0
 v_cvt_pk_bf16_f32 v37, v38, v39
 v_mfma_f32_16x16x32_bf16 v[180:183], a[64:67], a[112:115], v[180:183]
 ds_read_b64_tr_b16 a[82:83], v9 offset:4096
 v_cvt_pk_bf16_f32 v38, v76, v77
 v_mfma_f32_16x16x32_bf16 v[180:183], a[68:71], a[120:123], v[180:183]
 ds_read_b64_tr_b16 a[84:85], v9 offset:16384
 v_cvt_pk_bf16_f32 v39, v78, v79
 v_mfma_f32_16x16x32_bf16 v[188:191], a[96:99], a[196:199], v[188:191]
 s_add_u32 s59, s62, 32768
 ds_read_b64_tr_b16 a[86:87], v9 offset:20480
 v_xor_b32 v10, 65888, v6
 v_mfma_f32_16x16x32_bf16 v[188:191], a[100:103], a[204:207], v[188:191]
 ds_read_b64_tr_b16 a[88:89], v10 offset:0
 buffer_store_dwordx4 v[36:39], v1, s[12:15], s59 offen offset:1024 sc1
 v_mfma_f32_16x16x32_bf16 v[188:191], a[104:107], a[212:215], v[188:191]
 ds_read_b64_tr_b16 a[90:91], v10 offset:4096
 v_accvgpr_write_b32 a36, v36
 v_mfma_f32_16x16x32_bf16 v[188:191], a[108:111], a[220:223], v[188:191]
 ds_read_b64_tr_b16 a[92:93], v10 offset:16384
 v_accvgpr_write_b32 a37, v37
 v_mfma_f32_16x16x32_bf16 v[188:191], a[64:67], a[116:119], v[188:191]
 ds_read_b64_tr_b16 a[94:95], v10 offset:20480
 v_xor_b32 v7, 131456, v6
 v_mfma_f32_16x16x32_bf16 v[188:191], a[68:71], a[124:127], v[188:191]
 s_waitcnt lgkmcnt(6)
 ds_read_b64_tr_b16 a[96:97], v7 offset:0
 v_accvgpr_write_b32 a38, v38
 v_mfma_f32_16x16x32_bf16 v[196:199], a[72:75], a[192:195], v[196:199]
 ds_read_b64_tr_b16 a[98:99], v7 offset:4096
 v_accvgpr_write_b32 a39, v39
 v_mfma_f32_16x16x32_bf16 v[196:199], a[76:79], a[200:203], v[196:199]
 ds_read_b64_tr_b16 a[100:101], v7 offset:16384
 v_mul_f32 v84, s34, v84
 v_mfma_f32_16x16x32_bf16 v[196:199], a[80:83], a[208:211], v[196:199]
 s_waitcnt lgkmcnt(3)
 ds_read_b64_tr_b16 a[102:103], v7 offset:20480
 v_xor_b32 v8, 384, v6
 v_mfma_f32_16x16x32_bf16 v[196:199], a[84:87], a[216:219], v[196:199]
 ds_read_b64_tr_b16 a[104:105], v8 offset:0
 v_mul_f32 v85, s34, v85
 v_mfma_f32_16x16x32_bf16 v[196:199], a[88:91], a[112:115], v[196:199]
 ds_read_b64_tr_b16 a[106:107], v8 offset:4096
 v_mul_f32 v86, s34, v86
 v_mfma_f32_16x16x32_bf16 v[196:199], a[92:95], a[120:123], v[196:199]
 ds_read_b64_tr_b16 a[108:109], v8 offset:16384
 v_mul_f32 v87, s34, v87
 v_mfma_f32_16x16x32_bf16 v[204:207], a[72:75], a[196:199], v[204:207]
 ds_read_b64_tr_b16 a[110:111], v8 offset:20480
 v_xor_b32 v9, 65920, v6
 v_mfma_f32_16x16x32_bf16 v[204:207], a[76:79], a[204:207], v[204:207]
 ds_read_b64_tr_b16 a[64:65], v9 offset:0
 v_mul_f32 v100, s34, v100
 v_mfma_f32_16x16x32_bf16 v[204:207], a[80:83], a[212:215], v[204:207]
 ds_read_b64_tr_b16 a[66:67], v9 offset:4096
 v_mul_f32 v101, s34, v101
 v_mfma_f32_16x16x32_bf16 v[204:207], a[84:87], a[220:223], v[204:207]
 ds_read_b64_tr_b16 a[68:69], v9 offset:16384
 v_mul_f32 v102, s34, v102
 v_mfma_f32_16x16x32_bf16 v[204:207], a[88:91], a[116:119], v[204:207]
 ds_read_b64_tr_b16 a[70:71], v9 offset:20480
 v_xor_b32 v10, 131488, v6
 v_mfma_f32_16x16x32_bf16 v[204:207], a[92:95], a[124:127], v[204:207]
 s_waitcnt lgkmcnt(6)
 ds_read_b64_tr_b16 a[72:73], v10 offset:0
 v_mul_f32 v103, s34, v103
 v_mfma_f32_16x16x32_bf16 v[212:215], a[96:99], a[192:195], v[212:215]
 ds_read_b64_tr_b16 a[74:75], v10 offset:4096
 v_cvt_pk_bf16_f32 v84, v84, v85
 v_mfma_f32_16x16x32_bf16 v[212:215], a[100:103], a[200:203], v[212:215]
 ds_read_b64_tr_b16 a[76:77], v10 offset:16384
 v_cvt_pk_bf16_f32 v85, v86, v87
 v_mfma_f32_16x16x32_bf16 v[212:215], a[104:107], a[208:211], v[212:215]
 s_waitcnt lgkmcnt(3)
 ds_read_b64_tr_b16 a[78:79], v10 offset:20480
 v_xor_b32 v7, 416, v6
 v_mfma_f32_16x16x32_bf16 v[212:215], a[108:111], a[216:219], v[212:215]
 ds_read_b64_tr_b16 a[80:81], v7 offset:0
 v_cvt_pk_bf16_f32 v86, v100, v101
 v_mfma_f32_16x16x32_bf16 v[212:215], a[64:67], a[112:115], v[212:215]
 s_add_u32 s59, s62, 0
 ds_read_b64_tr_b16 a[82:83], v7 offset:4096
 v_cvt_pk_bf16_f32 v87, v102, v103
 v_mfma_f32_16x16x32_bf16 v[212:215], a[68:71], a[120:123], v[212:215]
 ds_read_b64_tr_b16 a[84:85], v7 offset:16384
 buffer_store_dwordx4 v[84:87], v1, s[12:15], s59 offen offset:2048 sc1
 v_mfma_f32_16x16x32_bf16 v[220:223], a[96:99], a[196:199], v[220:223]
 ds_read_b64_tr_b16 a[86:87], v7 offset:20480
 v_xor_b32 v8, 65952, v6
 v_mfma_f32_16x16x32_bf16 v[220:223], a[100:103], a[204:207], v[220:223]
 ds_read_b64_tr_b16 a[88:89], v8 offset:0
 v_accvgpr_write_b32 a8, v84
 v_mfma_f32_16x16x32_bf16 v[220:223], a[104:107], a[212:215], v[220:223]
 ds_read_b64_tr_b16 a[90:91], v8 offset:4096
 v_accvgpr_write_b32 a9, v85
 v_mfma_f32_16x16x32_bf16 v[220:223], a[108:111], a[220:223], v[220:223]
 ds_read_b64_tr_b16 a[92:93], v8 offset:16384
 v_accvgpr_write_b32 a10, v86
 v_mfma_f32_16x16x32_bf16 v[220:223], a[64:67], a[116:119], v[220:223]
 ds_read_b64_tr_b16 a[94:95], v8 offset:20480
 v_xor_b32 v9, 131520, v6
 v_mfma_f32_16x16x32_bf16 v[220:223], a[68:71], a[124:127], v[220:223]
 s_waitcnt lgkmcnt(6)
 ds_read_b64_tr_b16 a[96:97], v9 offset:0
 v_accvgpr_write_b32 a11, v87
 v_mfma_f32_16x16x32_bf16 v[228:231], a[72:75], a[192:195], v[228:231]
 ds_read_b64_tr_b16 a[98:99], v9 offset:4096
 v_mul_f32 v92, s34, v92
 v_mfma_f32_16x16x32_bf16 v[228:231], a[76:79], a[200:203], v[228:231]
 ds_read_b64_tr_b16 a[100:101], v9 offset:16384
 v_mul_f32 v93, s34, v93
 v_mfma_f32_16x16x32_bf16 v[228:231], a[80:83], a[208:211], v[228:231]
 s_waitcnt lgkmcnt(3)
 ds_read_b64_tr_b16 a[102:103], v9 offset:20480
 v_xor_b32 v10, 448, v6
 v_mfma_f32_16x16x32_bf16 v[228:231], a[84:87], a[216:219], v[228:231]
 ds_read_b64_tr_b16 a[104:105], v10 offset:0
 v_mul_f32 v94, s34, v94
 v_mfma_f32_16x16x32_bf16 v[228:231], a[88:91], a[112:115], v[228:231]
 ds_read_b64_tr_b16 a[106:107], v10 offset:4096
 v_mul_f32 v95, s34, v95
 v_mfma_f32_16x16x32_bf16 v[228:231], a[92:95], a[120:123], v[228:231]
 ds_read_b64_tr_b16 a[108:109], v10 offset:16384
 v_mul_f32 v108, s34, v108
 v_mfma_f32_16x16x32_bf16 v[236:239], a[72:75], a[196:199], v[236:239]
 ds_read_b64_tr_b16 a[110:111], v10 offset:20480
 v_xor_b32 v7, 65984, v6
 v_mfma_f32_16x16x32_bf16 v[236:239], a[76:79], a[204:207], v[236:239]
 ds_read_b64_tr_b16 a[64:65], v7 offset:0
 buffer_load_dword v13, v12, s[12:15], s58 offen sc1
 v_mfma_f32_16x16x32_bf16 v[236:239], a[80:83], a[212:215], v[236:239]
 ds_read_b64_tr_b16 a[66:67], v7 offset:4096
 v_mul_f32 v109, s34, v109
 v_mfma_f32_16x16x32_bf16 v[236:239], a[84:87], a[220:223], v[236:239]
 ds_read_b64_tr_b16 a[68:69], v7 offset:16384
 v_mul_f32 v110, s34, v110
 v_mfma_f32_16x16x32_bf16 v[236:239], a[88:91], a[116:119], v[236:239]
 ds_read_b64_tr_b16 a[70:71], v7 offset:20480
 v_xor_b32 v8, 131552, v6
 v_mfma_f32_16x16x32_bf16 v[236:239], a[92:95], a[124:127], v[236:239]
 s_waitcnt lgkmcnt(6)
 ds_read_b64_tr_b16 a[72:73], v8 offset:0
 v_mul_f32 v111, s34, v111
 v_mfma_f32_16x16x32_bf16 v[244:247], a[96:99], a[192:195], v[244:247]
 ds_read_b64_tr_b16 a[74:75], v8 offset:4096
 v_cvt_pk_bf16_f32 v92, v92, v93
 v_mfma_f32_16x16x32_bf16 v[244:247], a[100:103], a[200:203], v[244:247]
 ds_read_b64_tr_b16 a[76:77], v8 offset:16384
 v_cvt_pk_bf16_f32 v93, v94, v95
 v_mfma_f32_16x16x32_bf16 v[244:247], a[104:107], a[208:211], v[244:247]
 s_waitcnt lgkmcnt(3)
 ds_read_b64_tr_b16 a[78:79], v8 offset:20480
 v_xor_b32 v9, 480, v6
 v_mfma_f32_16x16x32_bf16 v[244:247], a[108:111], a[216:219], v[244:247]
 ds_read_b64_tr_b16 a[80:81], v9 offset:0
 v_cvt_pk_bf16_f32 v94, v108, v109
 v_mfma_f32_16x16x32_bf16 v[244:247], a[64:67], a[112:115], v[244:247]
 s_add_u32 s59, s62, 32768
 ds_read_b64_tr_b16 a[82:83], v9 offset:4096
 v_cvt_pk_bf16_f32 v95, v110, v111
 v_mfma_f32_16x16x32_bf16 v[244:247], a[68:71], a[120:123], v[244:247]
 ds_read_b64_tr_b16 a[84:85], v9 offset:16384
 buffer_store_dwordx4 v[92:95], v1, s[12:15], s59 offen offset:2048 sc1
 v_mfma_f32_16x16x32_bf16 v[252:255], a[96:99], a[196:199], v[252:255]
 ds_read_b64_tr_b16 a[86:87], v9 offset:20480
 v_xor_b32 v10, 66016, v6
 v_mfma_f32_16x16x32_bf16 v[252:255], a[100:103], a[204:207], v[252:255]
 ds_read_b64_tr_b16 a[88:89], v10 offset:0
 v_accvgpr_write_b32 a40, v92
 v_mfma_f32_16x16x32_bf16 v[252:255], a[104:107], a[212:215], v[252:255]
 ds_read_b64_tr_b16 a[90:91], v10 offset:4096
 v_accvgpr_write_b32 a41, v93
 v_mfma_f32_16x16x32_bf16 v[252:255], a[108:111], a[220:223], v[252:255]
 ds_read_b64_tr_b16 a[92:93], v10 offset:16384
 v_accvgpr_write_b32 a42, v94
 v_mfma_f32_16x16x32_bf16 v[252:255], a[64:67], a[116:119], v[252:255]
 ds_read_b64_tr_b16 a[94:95], v10 offset:20480
 v_accvgpr_write_b32 a43, v95
 v_mfma_f32_16x16x32_bf16 v[252:255], a[68:71], a[124:127], v[252:255]
 s_waitcnt lgkmcnt(6)
 v_mfma_f32_16x16x32_bf16 v[16:19], a[72:75], a[192:195], v[16:19]
 v_mfma_f32_16x16x32_bf16 v[16:19], a[76:79], a[200:203], v[16:19]
 v_mfma_f32_16x16x32_bf16 v[16:19], a[80:83], a[208:211], v[16:19]
 s_waitcnt lgkmcnt(0)
 v_mfma_f32_16x16x32_bf16 v[16:19], a[84:87], a[216:219], v[16:19]
 v_mfma_f32_16x16x32_bf16 v[16:19], a[88:91], a[112:115], v[16:19]
 v_mfma_f32_16x16x32_bf16 v[16:19], a[92:95], a[120:123], v[16:19]
 v_mfma_f32_16x16x32_bf16 v[24:27], a[72:75], a[196:199], v[24:27]
 v_mfma_f32_16x16x32_bf16 v[24:27], a[76:79], a[204:207], v[24:27]
 v_mfma_f32_16x16x32_bf16 v[24:27], a[80:83], a[212:215], v[24:27]
 v_mfma_f32_16x16x32_bf16 v[24:27], a[84:87], a[220:223], v[24:27]
 s_waitcnt lgkmcnt(0)
 v_mfma_f32_16x16x32_bf16 v[24:27], a[88:91], a[116:119], v[24:27]
 s_barrier
 v_mfma_f32_16x16x32_bf16 v[24:27], a[92:95], a[124:127], v[24:27]
 s_waitcnt vmcnt(1)
 v_cmp_ne_u32 s[16:17], 0, v13
 v_cmp_gt_u32 vcc, 256, v5
 s_or_b64 vcc, vcc, s[16:17]
 s_mov_b32 m0, s40
 s_cselect_b32 s48, 0, 1
 s_cselect_b32 s52, 2.0, s42
 buffer_load_dwordx4 v1, s[12:15], s52 offen offset:0 sc1 lds
 v_pk_mul_f32 v[116:117], v[116:117], s[34:35]
 v_pk_mul_f32 v[118:119], v[118:119], s[34:35]
 v_pk_mul_f32 v[132:133], v[132:133], s[34:35]
 v_pk_mul_f32 v[134:135], v[134:135], s[34:35]
 v_cvt_pk_bf16_f32 v116, v116, v117
 v_cvt_pk_bf16_f32 v117, v118, v119
 v_cvt_pk_bf16_f32 v118, v132, v133
 v_cvt_pk_bf16_f32 v119, v134, v135
 s_add_u32 s59, s62, 0
 buffer_store_dwordx4 v[116:119], v1, s[12:15], s59 offen offset:3072 sc1
 v_accvgpr_write_b32 a12, v116
 v_accvgpr_write_b32 a13, v117
 v_accvgpr_write_b32 a14, v118
 v_accvgpr_write_b32 a15, v119
 v_pk_mul_f32 v[124:125], v[124:125], s[34:35]
 v_pk_mul_f32 v[126:127], v[126:127], s[34:35]
 v_pk_mul_f32 v[140:141], v[140:141], s[34:35]
 v_pk_mul_f32 v[142:143], v[142:143], s[34:35]
 buffer_load_dwordx4 v1, s[12:15], s52 offen offset:1024 sc1 lds
 v_cvt_pk_bf16_f32 v124, v124, v125
 v_cvt_pk_bf16_f32 v125, v126, v127
 v_cvt_pk_bf16_f32 v126, v140, v141
 v_cvt_pk_bf16_f32 v127, v142, v143
 s_add_u32 s59, s62, 32768
 buffer_store_dwordx4 v[124:127], v1, s[12:15], s59 offen offset:3072 sc1
 v_accvgpr_write_b32 a44, v124
 v_accvgpr_write_b32 a45, v125
 v_accvgpr_write_b32 a46, v126
 v_accvgpr_write_b32 a47, v127
 v_pk_mul_f32 v[148:149], v[148:149], s[34:35]
 v_pk_mul_f32 v[150:151], v[150:151], s[34:35]
 v_pk_mul_f32 v[164:165], v[164:165], s[34:35]
 v_pk_mul_f32 v[166:167], v[166:167], s[34:35]
 v_cvt_pk_bf16_f32 v148, v148, v149
 v_cvt_pk_bf16_f32 v149, v150, v151
 v_cvt_pk_bf16_f32 v150, v164, v165
 buffer_load_dwordx4 v1, s[12:15], s52 offen offset:2048 sc1 lds
 v_cvt_pk_bf16_f32 v151, v166, v167
 s_add_u32 s59, s62, 4096
 buffer_store_dwordx4 v[148:151], v1, s[12:15], s59 offen offset:0 sc1
 v_accvgpr_write_b32 a16, v148
 v_accvgpr_write_b32 a17, v149
 v_accvgpr_write_b32 a18, v150
 v_accvgpr_write_b32 a19, v151
 v_pk_mul_f32 v[156:157], v[156:157], s[34:35]
 v_pk_mul_f32 v[158:159], v[158:159], s[34:35]
 v_pk_mul_f32 v[172:173], v[172:173], s[34:35]
 v_pk_mul_f32 v[174:175], v[174:175], s[34:35]
 v_cvt_pk_bf16_f32 v156, v156, v157
 v_cvt_pk_bf16_f32 v157, v158, v159
 v_cvt_pk_bf16_f32 v158, v172, v173
 v_cvt_pk_bf16_f32 v159, v174, v175
 s_add_u32 s59, s62, 36864
 buffer_store_dwordx4 v[156:159], v1, s[12:15], s59 offen offset:0 sc1
 v_accvgpr_write_b32 a48, v156
 buffer_load_dwordx4 v1, s[12:15], s52 offen offset:3072 sc1 lds
 v_accvgpr_write_b32 a49, v157
 v_accvgpr_write_b32 a50, v158
 v_accvgpr_write_b32 a51, v159
 v_pk_mul_f32 v[180:181], v[180:181], s[34:35]
 v_pk_mul_f32 v[182:183], v[182:183], s[34:35]
 v_pk_mul_f32 v[196:197], v[196:197], s[34:35]
 v_pk_mul_f32 v[198:199], v[198:199], s[34:35]
 v_cvt_pk_bf16_f32 v180, v180, v181
 v_cvt_pk_bf16_f32 v181, v182, v183
 v_cvt_pk_bf16_f32 v182, v196, v197
 v_cvt_pk_bf16_f32 v183, v198, v199
 s_add_u32 s59, s62, 4096
 buffer_store_dwordx4 v[180:183], v1, s[12:15], s59 offen offset:1024 sc1
 v_accvgpr_write_b32 a20, v180
 v_accvgpr_write_b32 a21, v181
 v_accvgpr_write_b32 a22, v182
 v_accvgpr_write_b32 a23, v183
 s_bitset1_b32 m0, 12
 s_nop 0
 buffer_load_dwordx4 v4, s[12:15], s52 offen offset:0 sc1 lds
 v_pk_mul_f32 v[188:189], v[188:189], s[34:35]
 v_pk_mul_f32 v[190:191], v[190:191], s[34:35]
 v_pk_mul_f32 v[204:205], v[204:205], s[34:35]
 v_pk_mul_f32 v[206:207], v[206:207], s[34:35]
 v_cvt_pk_bf16_f32 v188, v188, v189
 v_cvt_pk_bf16_f32 v189, v190, v191
 v_cvt_pk_bf16_f32 v190, v204, v205
 v_cvt_pk_bf16_f32 v191, v206, v207
 s_add_u32 s59, s62, 36864
 buffer_store_dwordx4 v[188:191], v1, s[12:15], s59 offen offset:1024 sc1
 v_accvgpr_write_b32 a52, v188
 v_accvgpr_write_b32 a53, v189
 v_accvgpr_write_b32 a54, v190
 v_accvgpr_write_b32 a55, v191
 v_pk_mul_f32 v[212:213], v[212:213], s[34:35]
 v_pk_mul_f32 v[214:215], v[214:215], s[34:35]
 v_pk_mul_f32 v[228:229], v[228:229], s[34:35]
 v_pk_mul_f32 v[230:231], v[230:231], s[34:35]
 buffer_load_dwordx4 v4, s[12:15], s52 offen offset:1024 sc1 lds
 v_cvt_pk_bf16_f32 v212, v212, v213
 v_cvt_pk_bf16_f32 v213, v214, v215
 v_cvt_pk_bf16_f32 v214, v228, v229
 v_cvt_pk_bf16_f32 v215, v230, v231
 s_add_u32 s59, s62, 4096
 buffer_store_dwordx4 v[212:215], v1, s[12:15], s59 offen offset:2048 sc1
 v_accvgpr_write_b32 a24, v212
 v_accvgpr_write_b32 a25, v213
 v_accvgpr_write_b32 a26, v214
 v_accvgpr_write_b32 a27, v215
 v_pk_mul_f32 v[220:221], v[220:221], s[34:35]
 v_pk_mul_f32 v[222:223], v[222:223], s[34:35]
 v_pk_mul_f32 v[236:237], v[236:237], s[34:35]
 v_pk_mul_f32 v[238:239], v[238:239], s[34:35]
 v_cvt_pk_bf16_f32 v220, v220, v221
 v_cvt_pk_bf16_f32 v221, v222, v223
 v_cvt_pk_bf16_f32 v222, v236, v237
 buffer_load_dwordx4 v4, s[12:15], s52 offen offset:2048 sc1 lds
 v_cvt_pk_bf16_f32 v223, v238, v239
 s_add_u32 s59, s62, 36864
 buffer_store_dwordx4 v[220:223], v1, s[12:15], s59 offen offset:2048 sc1
 v_accvgpr_write_b32 a56, v220
 v_accvgpr_write_b32 a57, v221
 v_accvgpr_write_b32 a58, v222
 v_accvgpr_write_b32 a59, v223
 v_pk_mul_f32 v[244:245], v[244:245], s[34:35]
 v_pk_mul_f32 v[246:247], v[246:247], s[34:35]
 v_pk_mul_f32 v[16:17], v[16:17], s[34:35]
 v_pk_mul_f32 v[18:19], v[18:19], s[34:35]
 v_cvt_pk_bf16_f32 v244, v244, v245
 v_cvt_pk_bf16_f32 v245, v246, v247
 v_cvt_pk_bf16_f32 v246, v16, v17
 v_cvt_pk_bf16_f32 v247, v18, v19
 s_add_u32 s59, s62, 4096
 buffer_store_dwordx4 v[244:247], v1, s[12:15], s59 offen offset:3072 sc1
 v_accvgpr_write_b32 a28, v244
 buffer_load_dwordx4 v4, s[12:15], s52 offen offset:3072 sc1 lds
 v_accvgpr_write_b32 a29, v245
 v_accvgpr_write_b32 a30, v246
 v_accvgpr_write_b32 a31, v247
 v_pk_mul_f32 v[252:253], v[252:253], s[34:35]
 v_pk_mul_f32 v[254:255], v[254:255], s[34:35]
 v_pk_mul_f32 v[24:25], v[24:25], s[34:35]
 v_pk_mul_f32 v[26:27], v[26:27], s[34:35]
 v_cvt_pk_bf16_f32 v252, v252, v253
 v_cvt_pk_bf16_f32 v253, v254, v255
 v_cvt_pk_bf16_f32 v254, v24, v25
 v_cvt_pk_bf16_f32 v255, v26, v27
 s_add_u32 s59, s62, 36864
 buffer_store_dwordx4 v[252:255], v1, s[12:15], s59 offen offset:3072 sc1
 v_accvgpr_write_b32 a60, v252
 v_accvgpr_write_b32 a61, v253
 v_accvgpr_write_b32 a62, v254
 v_accvgpr_write_b32 a63, v255
L_kvdone:
 s_load_dword s31, s[74:75], s30
 s_cmp_ge_u32 s28, 14
 s_cbranch_scc1 L_s1b
 s_mov_b32 s36, 0xffff0000
 s_and_b32 s33, s95, 31
 s_lshr_b32 s34, s95, 5
 v_lshlrev_b32 v128, 16, v32
 v_and_b32 v129, s36, v32
 v_lshlrev_b32 v130, 16, v40
 v_and_b32 v131, s36, v40
 v_lshlrev_b32 v132, 16, v48
 v_and_b32 v133, s36, v48
 v_lshlrev_b32 v134, 16, v56
 v_and_b32 v135, s36, v56
 v_lshlrev_b32 v136, 16, v64
 v_and_b32 v137, s36, v64
 v_lshlrev_b32 v138, 16, v72
 v_and_b32 v139, s36, v72
 v_lshlrev_b32 v140, 16, v80
 v_and_b32 v141, s36, v80
 v_lshlrev_b32 v142, 16, v88
 v_lshlrev_b32 v143, 16, v90
 v_and_b32 v144, s36, v88
 v_and_b32 v145, s36, v90
 v_lshlrev_b32 v146, 16, v89
 v_lshlrev_b32 v147, 16, v91
 v_and_b32 v148, s36, v89
 v_and_b32 v149, s36, v91
 v_pk_mul_f32 v[150:151], v[128:129], v[148:149]
 v_pk_fma_f32 v[150:151], v[130:131], v[146:147], v[150:151]
 v_pk_fma_f32 v[150:151], v[132:133], v[144:145], v[150:151]
 v_pk_fma_f32 v[150:151], v[134:135], v[142:143], v[150:151]
 v_pk_mul_f32 v[150:151], v[150:151], v[138:139]
 v_cvt_pk_bf16_f32 v16, v150, v151
 v_pk_mul_f32 v[152:153], v[130:131], v[148:149]
 v_pk_fma_f32 v[152:153], v[132:133], v[146:147], v[152:153]
 v_pk_fma_f32 v[152:153], v[134:135], v[144:145], v[152:153]
 v_pk_fma_f32 v[152:153], v[136:137], v[142:143], v[152:153]
 v_pk_mul_f32 v[152:153], v[152:153], v[140:141]
 v_cvt_pk_bf16_f32 v20, v152, v153
 v_lshlrev_b32 v128, 16, v33
 v_and_b32 v129, s36, v33
 v_lshlrev_b32 v130, 16, v41
 v_and_b32 v131, s36, v41
 v_lshlrev_b32 v132, 16, v49
 v_and_b32 v133, s36, v49
 v_lshlrev_b32 v134, 16, v57
 v_and_b32 v135, s36, v57
 v_lshlrev_b32 v136, 16, v65
 v_and_b32 v137, s36, v65
 v_lshlrev_b32 v138, 16, v73
 v_and_b32 v139, s36, v73
 v_lshlrev_b32 v140, 16, v81
 v_and_b32 v141, s36, v81
 v_lshlrev_b32 v142, 16, v96
 v_lshlrev_b32 v143, 16, v98
 v_and_b32 v144, s36, v96
 v_and_b32 v145, s36, v98
 v_lshlrev_b32 v146, 16, v97
 v_lshlrev_b32 v147, 16, v99
 v_and_b32 v148, s36, v97
 v_and_b32 v149, s36, v99
 v_pk_mul_f32 v[150:151], v[128:129], v[148:149]
 v_pk_fma_f32 v[150:151], v[130:131], v[146:147], v[150:151]
 v_pk_fma_f32 v[150:151], v[132:133], v[144:145], v[150:151]
 v_pk_fma_f32 v[150:151], v[134:135], v[142:143], v[150:151]
 v_pk_mul_f32 v[150:151], v[150:151], v[138:139]
 v_cvt_pk_bf16_f32 v17, v150, v151
 v_pk_mul_f32 v[152:153], v[130:131], v[148:149]
 v_pk_fma_f32 v[152:153], v[132:133], v[146:147], v[152:153]
 v_pk_fma_f32 v[152:153], v[134:135], v[144:145], v[152:153]
 v_pk_fma_f32 v[152:153], v[136:137], v[142:143], v[152:153]
 v_pk_mul_f32 v[152:153], v[152:153], v[140:141]
 v_cvt_pk_bf16_f32 v21, v152, v153
 v_lshlrev_b32 v128, 16, v34
 v_and_b32 v129, s36, v34
 v_lshlrev_b32 v130, 16, v42
 v_and_b32 v131, s36, v42
 v_lshlrev_b32 v132, 16, v50
 v_and_b32 v133, s36, v50
 v_lshlrev_b32 v134, 16, v58
 v_and_b32 v135, s36, v58
 v_lshlrev_b32 v136, 16, v66
 v_and_b32 v137, s36, v66
 v_lshlrev_b32 v138, 16, v74
 v_and_b32 v139, s36, v74
 v_lshlrev_b32 v140, 16, v82
 v_and_b32 v141, s36, v82
 v_lshlrev_b32 v142, 16, v104
 v_lshlrev_b32 v143, 16, v106
 v_and_b32 v144, s36, v104
 v_and_b32 v145, s36, v106
 v_lshlrev_b32 v146, 16, v105
 v_lshlrev_b32 v147, 16, v107
 v_and_b32 v148, s36, v105
 v_and_b32 v149, s36, v107
 v_pk_mul_f32 v[150:151], v[128:129], v[148:149]
 v_pk_fma_f32 v[150:151], v[130:131], v[146:147], v[150:151]
 v_pk_fma_f32 v[150:151], v[132:133], v[144:145], v[150:151]
 v_pk_fma_f32 v[150:151], v[134:135], v[142:143], v[150:151]
 v_pk_mul_f32 v[150:151], v[150:151], v[138:139]
 v_cvt_pk_bf16_f32 v18, v150, v151
 v_pk_mul_f32 v[152:153], v[130:131], v[148:149]
 v_pk_fma_f32 v[152:153], v[132:133], v[146:147], v[152:153]
 v_pk_fma_f32 v[152:153], v[134:135], v[144:145], v[152:153]
 v_pk_fma_f32 v[152:153], v[136:137], v[142:143], v[152:153]
 v_pk_mul_f32 v[152:153], v[152:153], v[140:141]
 v_cvt_pk_bf16_f32 v22, v152, v153
 v_lshlrev_b32 v128, 16, v35
 v_and_b32 v129, s36, v35
 v_lshlrev_b32 v130, 16, v43
 v_and_b32 v131, s36, v43
 v_lshlrev_b32 v132, 16, v51
 v_and_b32 v133, s36, v51
 v_lshlrev_b32 v134, 16, v59
 v_and_b32 v135, s36, v59
 v_lshlrev_b32 v136, 16, v67
 v_and_b32 v137, s36, v67
 v_lshlrev_b32 v138, 16, v75
 v_and_b32 v139, s36, v75
 v_lshlrev_b32 v140, 16, v83
 v_and_b32 v141, s36, v83
 v_lshlrev_b32 v142, 16, v112
 v_lshlrev_b32 v143, 16, v114
 v_and_b32 v144, s36, v112
 v_and_b32 v145, s36, v114
 v_lshlrev_b32 v146, 16, v113
 v_lshlrev_b32 v147, 16, v115
 v_and_b32 v148, s36, v113
 v_and_b32 v149, s36, v115
 v_pk_mul_f32 v[150:151], v[128:129], v[148:149]
 v_pk_fma_f32 v[150:151], v[130:131], v[146:147], v[150:151]
 v_pk_fma_f32 v[150:151], v[132:133], v[144:145], v[150:151]
 v_pk_fma_f32 v[150:151], v[134:135], v[142:143], v[150:151]
 v_pk_mul_f32 v[150:151], v[150:151], v[138:139]
 v_cvt_pk_bf16_f32 v19, v150, v151
 v_pk_mul_f32 v[152:153], v[130:131], v[148:149]
 v_pk_fma_f32 v[152:153], v[132:133], v[146:147], v[152:153]
 v_pk_fma_f32 v[152:153], v[134:135], v[144:145], v[152:153]
 v_pk_fma_f32 v[152:153], v[136:137], v[142:143], v[152:153]
 v_pk_mul_f32 v[152:153], v[152:153], v[140:141]
 v_cvt_pk_bf16_f32 v23, v152, v153
 v_lshrrev_b32 v26, 3, v0
 v_lshlrev_b32 v26, 8, v26
 v_and_b32 v25, 7, v0
 v_lshl_add_u32 v26, v25, 4, v26
 s_lshl_b32 s35, s3, 11
 s_add_u32 s35, s35, 0x20000
 v_add_u32 v26, s35, v26
 ds_write_b128 v26, v[16:19] offset:0
 ds_write_b128 v26, v[20:23] offset:128
 v_bfe_u32 v24, v0, 2, 2
 v_bfe_u32 v28, v0, 4, 1
 v_lshl_add_u32 v24, v28, 3, v24
 v_lshlrev_b32 v24, 2, v24
 v_lshrrev_b32 v28, 5, v0
 v_add_u32 v24, v24, v28
 v_lshlrev_b32 v24, 7, v24
 v_and_b32 v28, 3, v0
 v_lshl_add_u32 v24, v28, 3, v24
 s_lshl_b32 s35, s3, 5
 s_add_u32 s35, s35, 0x20000
 v_add_u32 v24, s35, v24
 v_and_b32 v25, 15, v0
 v_lshlrev_b32 v25, 12, v25
 v_lshrrev_b32 v28, 4, v0
 v_lshl_add_u32 v25, v28, 4, v25
 s_lshl_b32 s35, s34, 2
 s_add_u32 s35, s35, s3
 s_lshl_b32 s35, s35, 16
 s_lshl_b32 s36, s33, 7
 s_add_u32 s35, s35, s36
 s_add_u32 s35, s35, 85983232
L_s1b:
 s_add_u32 s52, s52, s70
 s_or_b32 m0, s40, 0x8000
 s_nop 0
 buffer_load_dwordx4 v1, s[12:15], s52 offen offset:0 sc1 lds
 v_and_b32 v14, 15, v0
 v_lshrrev_b32 v11, 4, v0
 v_lshlrev_b32 v11, 2, v11
 v_sub_u32 v14, v14, v11
 v_add_u32 v14, s53, v14
 v_mov_b32 v2, v1
 v_add_u32 v3, 0x10000, v1
 v_mov_b64 v[96:97], 0
 v_mov_b64 v[98:99], 0
 v_mov_b64 v[100:101], 0
 v_mov_b64 v[102:103], 0
 v_mov_b64 v[104:105], 0
 v_mov_b64 v[106:107], 0
 buffer_load_dwordx4 v1, s[12:15], s52 offen offset:1024 sc1 lds
 v_mov_b64 v[108:109], 0
 v_mov_b64 v[110:111], 0
 v_mov_b64 v[112:113], 0
 v_mov_b64 v[114:115], 0
 v_mov_b64 v[116:117], 0
 v_mov_b64 v[118:119], 0
 v_mov_b64 v[120:121], 0
 v_mov_b64 v[122:123], 0
 v_mov_b64 v[124:125], 0
 v_mov_b64 v[126:127], 0
 v_mov_b64 v[128:129], 0
 v_mov_b64 v[130:131], 0
 buffer_load_dwordx4 v1, s[12:15], s52 offen offset:2048 sc1 lds
 v_mov_b64 v[132:133], 0
 v_mov_b64 v[134:135], 0
 v_mov_b64 v[136:137], 0
 v_mov_b64 v[138:139], 0
 v_mov_b64 v[140:141], 0
 v_mov_b64 v[142:143], 0
 v_mov_b64 v[144:145], 0
 v_mov_b64 v[146:147], 0
 v_mov_b64 v[148:149], 0
 v_mov_b64 v[150:151], 0
 v_mov_b64 v[152:153], 0
 v_mov_b64 v[154:155], 0
 buffer_load_dwordx4 v1, s[12:15], s52 offen offset:3072 sc1 lds
 v_mov_b64 v[156:157], 0
 v_mov_b64 v[158:159], 0
 v_mov_b64 v[160:161], 0
 v_mov_b64 v[162:163], 0
 v_mov_b64 v[164:165], 0
 v_mov_b64 v[166:167], 0
 v_mov_b64 v[168:169], 0
 v_mov_b64 v[170:171], 0
 v_mov_b64 v[172:173], 0
 v_mov_b64 v[174:175], 0
 v_mov_b64 v[176:177], 0
 v_mov_b64 v[178:179], 0
 s_bitset1_b32 m0, 12
 s_nop 0
 buffer_load_dwordx4 v4, s[12:15], s52 offen offset:0 sc1 lds
 v_mov_b64 v[180:181], 0
 v_mov_b64 v[182:183], 0
 v_mov_b64 v[184:185], 0
 v_mov_b64 v[186:187], 0
 v_mov_b64 v[188:189], 0
 v_mov_b64 v[190:191], 0
 v_mov_b64 v[192:193], 0
 v_mov_b64 v[194:195], 0
 v_mov_b64 v[196:197], 0
 v_mov_b64 v[198:199], 0
 v_mov_b64 v[200:201], 0
 v_mov_b64 v[202:203], 0
 buffer_load_dwordx4 v4, s[12:15], s52 offen offset:1024 sc1 lds
 v_mov_b64 v[204:205], 0
 v_mov_b64 v[206:207], 0
 v_mov_b64 v[208:209], 0
 v_mov_b64 v[210:211], 0
 v_mov_b64 v[212:213], 0
 v_mov_b64 v[214:215], 0
 v_mov_b64 v[216:217], 0
 v_mov_b64 v[218:219], 0
 v_mov_b64 v[220:221], 0
 v_mov_b64 v[222:223], 0
 v_mov_b64 v[224:225], 0
 v_mov_b64 v[226:227], 0
 buffer_load_dwordx4 v4, s[12:15], s52 offen offset:2048 sc1 lds
 v_mov_b64 v[228:229], 0
 v_mov_b64 v[230:231], 0
 v_mov_b64 v[232:233], 0
 v_mov_b64 v[234:235], 0
 v_mov_b64 v[236:237], 0
 v_mov_b64 v[238:239], 0
 v_mov_b64 v[240:241], 0
 v_mov_b64 v[242:243], 0
 v_mov_b64 v[244:245], 0
 v_mov_b64 v[246:247], 0
 v_mov_b64 v[248:249], 0
 v_mov_b64 v[250:251], 0
 buffer_load_dwordx4 v4, s[12:15], s52 offen offset:3072 sc1 lds
 v_mov_b64 v[252:253], 0
 v_mov_b64 v[254:255], 0
 v_mov_b32 v7, 0
 v_mov_b32 v8, 0
 v_mov_b32 v9, 0
 v_mov_b32 v10, 0
 v_mul_u32_u24 v15, s27, v12
 v_accvgpr_write_b32 a246, 1
 v_accvgpr_write_b32 a247, 1
 s_cmp_lt_u32 s28, 14
 s_cselect_b32 s62, 1, 0
 s_andn2_b32 s62, s62, s27
 s_cmp_ge_u32 s44, 2
 s_cbranch_scc1 L_nomask0
 v_mov_b32 v11, 0xf149f2ca
 v_cmp_gt_i32 s[16:17], 0, v14
 v_cmp_gt_i32 s[18:19], 1, v14
 v_cmp_gt_i32 s[20:21], 2, v14
 v_cmp_gt_i32 s[22:23], 3, v14
 v_cndmask_b32 v96, v9, v11, s[16:17]
 v_cndmask_b32 v97, v9, v11, s[18:19]
 v_cndmask_b32 v98, v9, v11, s[20:21]
 v_cndmask_b32 v99, v9, v11, s[22:23]
 v_cmp_gt_i32 s[16:17], 16, v14
 v_cmp_gt_i32 s[18:19], 17, v14
 v_cmp_gt_i32 s[20:21], 18, v14
 v_cmp_gt_i32 s[22:23], 19, v14
 v_cndmask_b32 v104, v9, v11, s[16:17]
 v_cndmask_b32 v105, v9, v11, s[18:19]
 v_cndmask_b32 v106, v9, v11, s[20:21]
 v_cndmask_b32 v107, v9, v11, s[22:23]
 v_cmp_gt_i32 s[16:17], 32, v14
 v_cmp_gt_i32 s[18:19], 33, v14
 v_cmp_gt_i32 s[20:21], 34, v14
 v_cmp_gt_i32 s[22:23], 35, v14
 v_cndmask_b32 v112, v9, v11, s[16:17]
 v_cndmask_b32 v113, v9, v11, s[18:19]
 v_cndmask_b32 v114, v9, v11, s[20:21]
 v_cndmask_b32 v115, v9, v11, s[22:23]
 v_cmp_gt_i32 s[16:17], 48, v14
 v_cmp_gt_i32 s[18:19], 49, v14
 v_cmp_gt_i32 s[20:21], 50, v14
 v_cmp_gt_i32 s[22:23], 51, v14
 v_cndmask_b32 v120, v9, v11, s[16:17]
 v_cndmask_b32 v121, v9, v11, s[18:19]
 v_cndmask_b32 v122, v9, v11, s[20:21]
 v_cndmask_b32 v123, v9, v11, s[22:23]
L_nomask0:
 v_accvgpr_read_b32 v27, a245
 s_lshl_b32 s36, s95, 2
 s_add_u32 s36, s36, 84959232
 s_cmp_lt_u32 s28, 14
 s_cselect_b32 s36, s36, 2.0
 s_add_u32 s33, s94, 4
 s_cmp_eq_u32 s27, 1
 s_cselect_b32 s33, s33, 2.0
 s_cmp_eq_u32 s48, 0
 s_cbranch_scc1 L_kvlate
 s_add_u32 s42, s52, s70
L_kvok:
 s_waitcnt vmcnt(8) lgkmcnt(0)
 s_barrier
 ds_read_b128 a[64:67], v2 offset:0
 ds_read_b128 a[68:71], v2 offset:1024
 ds_read_b128 a[72:75], v2 offset:2048
 ds_read_b128 a[76:79], v2 offset:3072
 ds_read_b128 a[80:83], v2 offset:4096
 ds_read_b128 a[84:87], v2 offset:5120
 ds_read_b128 a[88:91], v2 offset:6144
 ds_read_b128 a[92:95], v2 offset:7168
 buffer_store_dword v27, v27, s[12:15], s1 offen sc1
 buffer_store_dword v27, v27, s[12:15], s33 offen sc1
 s_cmp_ge_u32 s28, 14
 s_cbranch_scc1 L_s1c
 ds_read_b64_tr_b16 v[16:17], v24 offset:0
 ds_read_b64_tr_b16 v[18:19], v24 offset:2048
 ds_read_b64_tr_b16 v[20:21], v24 offset:256
 ds_read_b64_tr_b16 v[22:23], v24 offset:2304
 s_waitcnt lgkmcnt(0)
 buffer_store_dwordx4 v[16:19], v25, s[12:15], s35 offen offset:0 sc1
 buffer_store_dwordx4 v[20:23], v25, s[12:15], s35 offen offset:64 sc1
L_s1c:
 s_mov_b32 m0, s41
 s_waitcnt lgkmcnt(0)
 v_mfma_f32_16x16x32_bf16 v[32:35], a[64:67], a[0:3], v[96:99]
 ds_read_b128 a[96:99], v2 offset:8192
 v_mfma_f32_16x16x32_bf16 v[32:35], a[68:71], a[4:7], v[32:35]
 buffer_load_dwordx4 v1, s[12:15], s43 offen offset:0 sc1 lds
 v_mfma_f32_16x16x32_bf16 v[32:35], a[72:75], a[8:11], v[32:35]
 ds_read_b128 a[100:103], v2 offset:9216
 v_mfma_f32_16x16x32_bf16 v[32:35], a[76:79], a[12:15], v[32:35]
 v_mfma_f32_16x16x32_bf16 v[32:35], a[80:83], a[16:19], v[32:35]
 ds_read_b128 a[104:107], v2 offset:10240
 v_mfma_f32_16x16x32_bf16 v[32:35], a[84:87], a[20:23], v[32:35]
 buffer_load_dwordx4 v1, s[12:15], s43 offen offset:1024 sc1 lds
 v_mfma_f32_16x16x32_bf16 v[32:35], a[88:91], a[24:27], v[32:35]
 ds_read_b128 a[108:111], v2 offset:11264
 v_mfma_f32_16x16x32_bf16 v[32:35], a[92:95], a[28:31], v[32:35]
 v_mfma_f32_16x16x32_bf16 v[36:39], a[64:67], a[32:35], v[100:103]
 ds_read_b128 a[112:115], v2 offset:12288
 v_mfma_f32_16x16x32_bf16 v[36:39], a[68:71], a[36:39], v[36:39]
 buffer_load_dwordx4 v1, s[12:15], s43 offen offset:2048 sc1 lds
 v_mfma_f32_16x16x32_bf16 v[36:39], a[72:75], a[40:43], v[36:39]
 ds_read_b128 a[116:119], v2 offset:13312
 v_mfma_f32_16x16x32_bf16 v[36:39], a[76:79], a[44:47], v[36:39]
 v_mfma_f32_16x16x32_bf16 v[36:39], a[80:83], a[48:51], v[36:39]
 ds_read_b128 a[120:123], v2 offset:14336
 v_mfma_f32_16x16x32_bf16 v[36:39], a[84:87], a[52:55], v[36:39]
 buffer_load_dwordx4 v1, s[12:15], s43 offen offset:3072 sc1 lds
 v_mfma_f32_16x16x32_bf16 v[36:39], a[88:91], a[56:59], v[36:39]
 ds_read_b128 a[124:127], v2 offset:15360
 v_mfma_f32_16x16x32_bf16 v[36:39], a[92:95], a[60:63], v[36:39]
 s_waitcnt lgkmcnt(6)
 v_exp_f32 v64, v32
 v_mfma_f32_16x16x32_bf16 v[40:43], a[96:99], a[0:3], v[104:107]
 s_bitset1_b32 m0, 12
 ds_read_b128 a[64:67], v2 offset:16384
 v_mfma_f32_16x16x32_bf16 v[40:43], a[100:103], a[4:7], v[40:43]
 s_waitcnt lgkmcnt(5)
 buffer_load_dwordx4 v4, s[12:15], s43 offen offset:0 sc1 lds
 v_mfma_f32_16x16x32_bf16 v[40:43], a[104:107], a[8:11], v[40:43]
 ds_read_b128 a[68:71], v2 offset:17408
 v_mfma_f32_16x16x32_bf16 v[40:43], a[108:111], a[12:15], v[40:43]
 s_waitcnt lgkmcnt(4)
 v_exp_f32 v65, v33
 v_mfma_f32_16x16x32_bf16 v[40:43], a[112:115], a[16:19], v[40:43]
 ds_read_b128 a[72:75], v2 offset:18432
 v_add_f32 v5, v64, v65
 v_mfma_f32_16x16x32_bf16 v[40:43], a[116:119], a[20:23], v[40:43]
 s_waitcnt lgkmcnt(3)
 buffer_load_dwordx4 v4, s[12:15], s43 offen offset:1024 sc1 lds
 v_mfma_f32_16x16x32_bf16 v[40:43], a[120:123], a[24:27], v[40:43]
 ds_read_b128 a[76:79], v2 offset:19456
 v_mfma_f32_16x16x32_bf16 v[40:43], a[124:127], a[28:31], v[40:43]
 v_exp_f32 v66, v34
 v_mfma_f32_16x16x32_bf16 v[44:47], a[96:99], a[32:35], v[108:111]
 ds_read_b128 a[80:83], v2 offset:20480
 v_add_f32 v5, v5, v66
 v_mfma_f32_16x16x32_bf16 v[44:47], a[100:103], a[36:39], v[44:47]
 buffer_load_dwordx4 v4, s[12:15], s43 offen offset:2048 sc1 lds
 v_mfma_f32_16x16x32_bf16 v[44:47], a[104:107], a[40:43], v[44:47]
 ds_read_b128 a[84:87], v2 offset:21504
 v_mfma_f32_16x16x32_bf16 v[44:47], a[108:111], a[44:47], v[44:47]
 v_exp_f32 v67, v35
 v_mfma_f32_16x16x32_bf16 v[44:47], a[112:115], a[48:51], v[44:47]
 ds_read_b128 a[88:91], v2 offset:22528
 v_add_f32 v5, v5, v67
 v_mfma_f32_16x16x32_bf16 v[44:47], a[116:119], a[52:55], v[44:47]
 buffer_load_dwordx4 v4, s[12:15], s43 offen offset:3072 sc1 lds
 v_mfma_f32_16x16x32_bf16 v[44:47], a[120:123], a[56:59], v[44:47]
 ds_read_b128 a[92:95], v2 offset:23552
 v_mfma_f32_16x16x32_bf16 v[44:47], a[124:127], a[60:63], v[44:47]
 s_waitcnt lgkmcnt(6)
 v_exp_f32 v68, v36
 v_mfma_f32_16x16x32_bf16 v[48:51], a[64:67], a[0:3], v[112:115]
 s_add_u32 s43, s43, s71
 ds_read_b128 a[96:99], v2 offset:24576
 v_mfma_f32_16x16x32_bf16 v[48:51], a[68:71], a[4:7], v[48:51]
 s_waitcnt lgkmcnt(5)
 v_exp_f32 v69, v37
 v_mfma_f32_16x16x32_bf16 v[48:51], a[72:75], a[8:11], v[48:51]
 s_xor_b32 s41, s41, 0x8000
 ds_read_b128 a[100:103], v2 offset:25600
 v_add_f32 v6, v68, v69
 v_mfma_f32_16x16x32_bf16 v[48:51], a[76:79], a[12:15], v[48:51]
 s_waitcnt lgkmcnt(4)
 v_exp_f32 v70, v38
 v_mfma_f32_16x16x32_bf16 v[48:51], a[80:83], a[16:19], v[48:51]
 ds_read_b128 a[104:107], v2 offset:26624
 v_add_f32 v6, v6, v70
 v_mfma_f32_16x16x32_bf16 v[48:51], a[84:87], a[20:23], v[48:51]
 s_waitcnt lgkmcnt(3)
 v_exp_f32 v71, v39
 v_mfma_f32_16x16x32_bf16 v[48:51], a[88:91], a[24:27], v[48:51]
 ds_read_b128 a[108:111], v2 offset:27648
 v_add_f32 v6, v6, v71
 v_mfma_f32_16x16x32_bf16 v[48:51], a[92:95], a[28:31], v[48:51]
 v_exp_f32 v72, v40
 v_mfma_f32_16x16x32_bf16 v[52:55], a[64:67], a[32:35], v[116:119]
 ds_read_b128 a[112:115], v2 offset:28672
 v_add_f32 v5, v5, v72
 v_mfma_f32_16x16x32_bf16 v[52:55], a[68:71], a[36:39], v[52:55]
 v_exp_f32 v73, v41
 v_mfma_f32_16x16x32_bf16 v[52:55], a[72:75], a[40:43], v[52:55]
 ds_read_b128 a[116:119], v2 offset:29696
 v_add_f32 v5, v5, v73
 v_mfma_f32_16x16x32_bf16 v[52:55], a[76:79], a[44:47], v[52:55]
 v_exp_f32 v74, v42
 v_mfma_f32_16x16x32_bf16 v[52:55], a[80:83], a[48:51], v[52:55]
 ds_read_b128 a[120:123], v2 offset:30720
 v_add_f32 v5, v5, v74
 v_mfma_f32_16x16x32_bf16 v[52:55], a[84:87], a[52:55], v[52:55]
 v_exp_f32 v75, v43
 v_mfma_f32_16x16x32_bf16 v[52:55], a[88:91], a[56:59], v[52:55]
 ds_read_b128 a[124:127], v2 offset:31744
 v_add_f32 v5, v5, v75
 v_mfma_f32_16x16x32_bf16 v[52:55], a[92:95], a[60:63], v[52:55]
 s_waitcnt lgkmcnt(6)
 v_exp_f32 v76, v44
 v_mfma_f32_16x16x32_bf16 v[56:59], a[96:99], a[0:3], v[120:123]
 v_exp_f32 v77, v45
 v_mfma_f32_16x16x32_bf16 v[56:59], a[100:103], a[4:7], v[56:59]
 s_waitcnt lgkmcnt(4)
 v_exp_f32 v78, v46
 v_mfma_f32_16x16x32_bf16 v[56:59], a[104:107], a[8:11], v[56:59]
 v_exp_f32 v79, v47
 v_mfma_f32_16x16x32_bf16 v[56:59], a[108:111], a[12:15], v[56:59]
 s_waitcnt lgkmcnt(2)
 v_exp_f32 v80, v48
 v_mfma_f32_16x16x32_bf16 v[56:59], a[112:115], a[16:19], v[56:59]
 v_exp_f32 v81, v49
 v_mfma_f32_16x16x32_bf16 v[56:59], a[116:119], a[20:23], v[56:59]
 s_waitcnt lgkmcnt(0)
 v_exp_f32 v82, v50
 v_mfma_f32_16x16x32_bf16 v[56:59], a[120:123], a[24:27], v[56:59]
 v_exp_f32 v83, v51
 v_mfma_f32_16x16x32_bf16 v[56:59], a[124:127], a[28:31], v[56:59]
 v_exp_f32 v84, v52
 v_mfma_f32_16x16x32_bf16 v[60:63], a[96:99], a[32:35], v[124:127]
 v_exp_f32 v85, v53
 v_mfma_f32_16x16x32_bf16 v[60:63], a[100:103], a[36:39], v[60:63]
 v_exp_f32 v86, v54
 v_mfma_f32_16x16x32_bf16 v[60:63], a[104:107], a[40:43], v[60:63]
 v_exp_f32 v87, v55
 v_mfma_f32_16x16x32_bf16 v[60:63], a[108:111], a[44:47], v[60:63]
 v_add_f32 v6, v6, v76
 v_mfma_f32_16x16x32_bf16 v[60:63], a[112:115], a[48:51], v[60:63]
 v_add_f32 v6, v6, v77
 v_mfma_f32_16x16x32_bf16 v[60:63], a[116:119], a[52:55], v[60:63]
 v_exp_f32 v88, v56
 v_mfma_f32_16x16x32_bf16 v[60:63], a[120:123], a[56:59], v[60:63]
 v_exp_f32 v89, v57
 v_mfma_f32_16x16x32_bf16 v[60:63], a[124:127], a[60:63], v[60:63]
 v_exp_f32 v90, v58
 v_xor_b32 v2, 0x8000, v2
 s_waitcnt vmcnt(8)
 s_barrier
 ds_read_b128 a[64:67], v2 offset:0
 ds_read_b128 a[68:71], v2 offset:1024
 ds_read_b128 a[72:75], v2 offset:2048
 ds_read_b128 a[76:79], v2 offset:3072
 ds_read_b128 a[80:83], v2 offset:4096
 ds_read_b128 a[84:87], v2 offset:5120
 ds_read_b128 a[88:91], v2 offset:6144
 ds_read_b128 a[92:95], v2 offset:7168
 buffer_store_dword v27, v27, s[12:15], s36 offen sc1
 v_exp_f32 v91, v59
 v_exp_f32 v92, v60
 v_exp_f32 v93, v61
 v_exp_f32 v94, v62
 v_exp_f32 v95, v63
 v_add_f32 v6, v6, v78
 v_add_f32 v6, v6, v79
 v_add_f32 v5, v5, v80
 v_add_f32 v5, v5, v81
 v_add_f32 v5, v5, v82
 v_add_f32 v5, v5, v83
 v_add_f32 v6, v6, v84
 v_add_f32 v6, v6, v85
 v_add_f32 v6, v6, v86
 v_add_f32 v6, v6, v87
 v_add_f32 v5, v5, v88
 v_add_f32 v5, v5, v89
 v_add_f32 v5, v5, v90
 v_add_f32 v5, v5, v91
 v_add_f32 v6, v6, v92
 v_add_f32 v6, v6, v93
 v_add_f32 v6, v6, v94
 v_add_f32 v6, v6, v95
L_first:
 v_add_f32 v11, v5, v6
 v_min_f32 v12, v5, v6
 v_cmp_nge_f32 vcc, s47, v11
 s_mov_b32 s46, 0xff800000
 s_cbranch_vccnz L_slow2
 v_cmp_gt_f32 vcc, 0x33800000, v12
 s_cbranch_vccnz L_rowchk
L_firstok:
 s_mov_b32 s46, 0
 s_waitcnt lgkmcnt(0)
 s_branch L_ret
L_kvlate:
 v_cmp_gt_u32 vcc, 256, v5
 v_mov_b32 v29, 0
 s_mov_b32 s32, 0
 s_cbranch_vccz L_armed
L_pollA:
 global_load_dword v28, v29, s[90:91] offset:128 sc1
 s_add_u32 s32, s32, 1
 s_waitcnt vmcnt(0)
 v_cmp_gt_u32 vcc, 256, v28
 s_cmp_lt_u32 s32, 0x80000
 s_cselect_b64 vcc, vcc, 0
 s_cbranch_vccnz L_pollA
L_armed:
 v_and_b32 v28, 11, v0
 v_lshlrev_b32 v28, 2, v28
 s_mov_b32 s32, 0
L_poll0:
 buffer_load_dword v29, v28, s[12:15], s58 offen sc1
 s_waitcnt vmcnt(0)
 v_cmp_ne_u32 vcc, 0, v29
 s_cbranch_vccz L_poll0_ok
 s_sleep 8
 s_add_u32 s32, s32, 1
 s_cmp_lt_u32 s32, 0x80000
 s_cbranch_scc1 L_poll0
L_poll0_ok:
 s_mov_b32 m0, s40
 s_nop 0
 buffer_load_dwordx4 v1, s[12:15], s42 offen offset:0 sc1 lds
 buffer_load_dwordx4 v1, s[12:15], s42 offen offset:1024 sc1 lds
 buffer_load_dwordx4 v1, s[12:15], s42 offen offset:2048 sc1 lds
 buffer_load_dwordx4 v1, s[12:15], s42 offen offset:3072 sc1 lds
 s_bitset1_b32 m0, 12
 s_nop 0
 buffer_load_dwordx4 v4, s[12:15], s42 offen offset:0 sc1 lds
 buffer_load_dwordx4 v4, s[12:15], s42 offen offset:1024 sc1 lds
 buffer_load_dwordx4 v4, s[12:15], s42 offen offset:2048 sc1 lds
 buffer_load_dwordx4 v4, s[12:15], s42 offen offset:3072 sc1 lds
 s_add_u32 s42, s42, s70
 s_xor_b32 s40, s40, 0x8000
 s_mov_b32 m0, s40
 s_nop 0
 buffer_load_dwordx4 v1, s[12:15], s42 offen offset:0 sc1 lds
 buffer_load_dwordx4 v1, s[12:15], s42 offen offset:1024 sc1 lds
 buffer_load_dwordx4 v1, s[12:15], s42 offen offset:2048 sc1 lds
 buffer_load_dwordx4 v1, s[12:15], s42 offen offset:3072 sc1 lds
 s_bitset1_b32 m0, 12
 s_nop 0
 buffer_load_dwordx4 v4, s[12:15], s42 offen offset:0 sc1 lds
 buffer_load_dwordx4 v4, s[12:15], s42 offen offset:1024 sc1 lds
 buffer_load_dwordx4 v4, s[12:15], s42 offen offset:2048 sc1 lds
 buffer_load_dwordx4 v4, s[12:15], s42 offen offset:3072 sc1 lds
 s_add_u32 s42, s42, s70
 s_xor_b32 s40, s40, 0x8000
 s_branch L_kvok
L_rowchk:
 v_mov_b32 v16, v5
 v_mov_b32 v17, v6
 v_mov_b32 v18, v16
 v_mov_b32 v19, v17
 s_nop 0
 v_permlane32_swap_b32 v16, v18
 v_permlane32_swap_b32 v17, v19
 s_nop 0
 v_add_f32 v16, v16, v18
 v_add_f32 v17, v17, v19
 v_mov_b32 v18, v16
 v_mov_b32 v19, v17
 s_nop 0
 v_permlane16_swap_b32 v16, v18
 v_permlane16_swap_b32 v17, v19
 s_nop 0
 v_add_f32 v16, v16, v18
 v_add_f32 v17, v17, v19
 v_min_f32 v16, v16, v17
 v_cmp_gt_f32 vcc, 0x33800000, v16
 s_cbranch_vccz L_firstok
 s_branch L_slow2
L_slow:
 s_cmp_lg_u32 s47, 0x4b800000
 s_cbranch_scc1 L_switched
 s_nop 5
L_slow2:
 v_max3_f32 v11, v32, v33, v34
 v_max3_f32 v11, v11, v35, v40
 v_max3_f32 v11, v11, v41, v42
 v_max3_f32 v11, v11, v43, v48
 v_max3_f32 v11, v11, v49, v50
 v_max3_f32 v11, v11, v51, v56
 v_max3_f32 v11, v11, v57, v58
 v_max_f32 v11, v11, v59
 v_mov_b32 v13, v11
 s_nop 1
 v_permlane32_swap_b32 v11, v13
 s_nop 1
 v_max_f32 v11, v11, v13
 v_mov_b32 v13, v11
 s_nop 1
 v_permlane16_swap_b32 v11, v13
 s_nop 1
 v_max_f32 v11, v11, v13
 v_max_f32 v11, s46, v11
 v_sub_f32 v9, v9, v11
 v_sub_f32 v32, v32, v11
 v_sub_f32 v33, v33, v11
 v_sub_f32 v34, v34, v11
 v_sub_f32 v35, v35, v11
 v_sub_f32 v40, v40, v11
 v_sub_f32 v41, v41, v11
 v_sub_f32 v42, v42, v11
 v_sub_f32 v43, v43, v11
 v_sub_f32 v48, v48, v11
 v_sub_f32 v49, v49, v11
 v_sub_f32 v50, v50, v11
 v_sub_f32 v51, v51, v11
 v_sub_f32 v56, v56, v11
 v_sub_f32 v57, v57, v11
 v_sub_f32 v58, v58, v11
 v_sub_f32 v59, v59, v11
 v_exp_f32 v64, v32
 v_mov_b32 v96, v9
 v_exp_f32 v65, v33
 v_mov_b32 v97, v9
 v_exp_f32 v66, v34
 v_mov_b32 v98, v9
 v_exp_f32 v67, v35
 v_mov_b32 v99, v9
 v_exp_f32 v72, v40
 v_mov_b32 v104, v9
 v_exp_f32 v73, v41
 v_mov_b32 v105, v9
 v_exp_f32 v74, v42
 v_mov_b32 v106, v9
 v_exp_f32 v75, v43
 v_mov_b32 v107, v9
 v_exp_f32 v80, v48
 v_mov_b32 v112, v9
 v_exp_f32 v81, v49
 v_mov_b32 v113, v9
 v_exp_f32 v82, v50
 v_mov_b32 v114, v9
 v_exp_f32 v83, v51
 v_mov_b32 v115, v9
 v_exp_f32 v88, v56
 v_mov_b32 v120, v9
 v_exp_f32 v89, v57
 v_mov_b32 v121, v9
 v_exp_f32 v90, v58
 v_mov_b32 v122, v9
 v_exp_f32 v91, v59
 v_mov_b32 v123, v9
 v_add_f32 v5, v64, v65
 v_add_f32 v5, v5, v66
 v_add_f32 v5, v5, v67
 v_add_f32 v5, v5, v72
 v_add_f32 v5, v5, v73
 v_add_f32 v5, v5, v74
 v_add_f32 v5, v5, v75
 v_add_f32 v5, v5, v80
 v_add_f32 v5, v5, v81
 v_add_f32 v5, v5, v82
 v_add_f32 v5, v5, v83
 v_add_f32 v5, v5, v88
 v_add_f32 v5, v5, v89
 v_add_f32 v5, v5, v90
 v_add_f32 v5, v5, v91
 v_max3_f32 v12, v36, v37, v38
 v_max3_f32 v12, v12, v39, v44
 v_max3_f32 v12, v12, v45, v46
 v_max3_f32 v12, v12, v47, v52
 v_max3_f32 v12, v12, v53, v54
 v_max3_f32 v12, v12, v55, v60
 v_max3_f32 v12, v12, v61, v62
 v_max_f32 v12, v12, v63
 v_mov_b32 v13, v12
 s_nop 1
 v_permlane32_swap_b32 v12, v13
 s_nop 1
 v_max_f32 v12, v12, v13
 v_mov_b32 v13, v12
 s_nop 1
 v_permlane16_swap_b32 v12, v13
 s_nop 1
 v_max_f32 v12, v12, v13
 v_max_f32 v12, s46, v12
 v_sub_f32 v10, v10, v12
 v_sub_f32 v36, v36, v12
 v_sub_f32 v37, v37, v12
 v_sub_f32 v38, v38, v12
 v_sub_f32 v39, v39, v12
 v_sub_f32 v44, v44, v12
 v_sub_f32 v45, v45, v12
 v_sub_f32 v46, v46, v12
 v_sub_f32 v47, v47, v12
 v_sub_f32 v52, v52, v12
 v_sub_f32 v53, v53, v12
 v_sub_f32 v54, v54, v12
 v_sub_f32 v55, v55, v12
 v_sub_f32 v60, v60, v12
 v_sub_f32 v61, v61, v12
 v_sub_f32 v62, v62, v12
 v_sub_f32 v63, v63, v12
 v_exp_f32 v68, v36
 v_mov_b32 v100, v10
 v_exp_f32 v69, v37
 v_mov_b32 v101, v10
 v_exp_f32 v70, v38
 v_mov_b32 v102, v10
 v_exp_f32 v71, v39
 v_mov_b32 v103, v10
 v_exp_f32 v76, v44
 v_mov_b32 v108, v10
 v_exp_f32 v77, v45
 v_mov_b32 v109, v10
 v_exp_f32 v78, v46
 v_mov_b32 v110, v10
 v_exp_f32 v79, v47
 v_mov_b32 v111, v10
 v_exp_f32 v84, v52
 v_mov_b32 v116, v10
 v_exp_f32 v85, v53
 v_mov_b32 v117, v10
 v_exp_f32 v86, v54
 v_mov_b32 v118, v10
 v_exp_f32 v87, v55
 v_mov_b32 v119, v10
 v_exp_f32 v92, v60
 v_mov_b32 v124, v10
 v_exp_f32 v93, v61
 v_mov_b32 v125, v10
 v_exp_f32 v94, v62
 v_mov_b32 v126, v10
 v_exp_f32 v95, v63
 v_mov_b32 v127, v10
 v_add_f32 v6, v68, v69
 v_add_f32 v6, v6, v70
 v_add_f32 v6, v6, v71
 v_add_f32 v6, v6, v76
 v_add_f32 v6, v6, v77
 v_add_f32 v6, v6, v78
 v_add_f32 v6, v6, v79
 v_add_f32 v6, v6, v84
 v_add_f32 v6, v6, v85
 v_add_f32 v6, v6, v86
 v_add_f32 v6, v6, v87
 v_add_f32 v6, v6, v92
 v_add_f32 v6, v6, v93
 v_add_f32 v6, v6, v94
 v_add_f32 v6, v6, v95
 s_waitcnt lgkmcnt(0)
 s_cmp_lg_u32 s46, 0
 s_mov_b32 s46, 0
 s_cbranch_scc1 L_ret
 v_exp_f32 v11, -v11
 s_nop 0
 v_mul_f32 v7, v7, v11
 v_mul_f32 v128, v128, v11
 v_mul_f32 v129, v129, v11
 v_mul_f32 v130, v130, v11
 v_mul_f32 v131, v131, v11
 v_mul_f32 v132, v132, v11
 v_mul_f32 v133, v133, v11
 v_mul_f32 v134, v134, v11
 v_mul_f32 v135, v135, v11
 v_mul_f32 v136, v136, v11
 v_mul_f32 v137, v137, v11
 v_mul_f32 v138, v138, v11
 v_mul_f32 v139, v139, v11
 v_mul_f32 v140, v140, v11
 v_mul_f32 v141, v141, v11
 v_mul_f32 v142, v142, v11
 v_mul_f32 v143, v143, v11
 v_mul_f32 v144, v144, v11
 v_mul_f32 v145, v145, v11
 v_mul_f32 v146, v146, v11
 v_mul_f32 v147, v147, v11
 v_mul_f32 v148, v148, v11
 v_mul_f32 v149, v149, v11
 v_mul_f32 v150, v150, v11
 v_mul_f32 v151, v151, v11
 v_mul_f32 v152, v152, v11
 v_mul_f32 v153, v153, v11
 v_mul_f32 v154, v154, v11
 v_mul_f32 v155, v155, v11
 v_mul_f32 v156, v156, v11
 v_mul_f32 v157, v157, v11
 v_mul_f32 v158, v158, v11
 v_mul_f32 v159, v159, v11
 v_mul_f32 v160, v160, v11
 v_mul_f32 v161, v161, v11
 v_mul_f32 v162, v162, v11
 v_mul_f32 v163, v163, v11
 v_mul_f32 v164, v164, v11
 v_mul_f32 v165, v165, v11
 v_mul_f32 v166, v166, v11
 v_mul_f32 v167, v167, v11
 v_mul_f32 v168, v168, v11
 v_mul_f32 v169, v169, v11
 v_mul_f32 v170, v170, v11
 v_mul_f32 v171, v171, v11
 v_mul_f32 v172, v172, v11
 v_mul_f32 v173, v173, v11
 v_mul_f32 v174, v174, v11
 v_mul_f32 v175, v175, v11
 v_mul_f32 v176, v176, v11
 v_mul_f32 v177, v177, v11
 v_mul_f32 v178, v178, v11
 v_mul_f32 v179, v179, v11
 v_mul_f32 v180, v180, v11
 v_mul_f32 v181, v181, v11
 v_mul_f32 v182, v182, v11
 v_mul_f32 v183, v183, v11
 v_mul_f32 v184, v184, v11
 v_mul_f32 v185, v185, v11
 v_mul_f32 v186, v186, v11
 v_mul_f32 v187, v187, v11
 v_mul_f32 v188, v188, v11
 v_mul_f32 v189, v189, v11
 v_mul_f32 v190, v190, v11
 v_mul_f32 v191, v191, v11
 v_exp_f32 v12, -v12
 s_nop 0
 v_mul_f32 v8, v8, v12
 v_mul_f32 v192, v192, v12
 v_mul_f32 v193, v193, v12
 v_mul_f32 v194, v194, v12
 v_mul_f32 v195, v195, v12
 v_mul_f32 v196, v196, v12
 v_mul_f32 v197, v197, v12
 v_mul_f32 v198, v198, v12
 v_mul_f32 v199, v199, v12
 v_mul_f32 v200, v200, v12
 v_mul_f32 v201, v201, v12
 v_mul_f32 v202, v202, v12
 v_mul_f32 v203, v203, v12
 v_mul_f32 v204, v204, v12
 v_mul_f32 v205, v205, v12
 v_mul_f32 v206, v206, v12
 v_mul_f32 v207, v207, v12
 v_mul_f32 v208, v208, v12
 v_mul_f32 v209, v209, v12
 v_mul_f32 v210, v210, v12
 v_mul_f32 v211, v211, v12
 v_mul_f32 v212, v212, v12
 v_mul_f32 v213, v213, v12
 v_mul_f32 v214, v214, v12
 v_mul_f32 v215, v215, v12
 v_mul_f32 v216, v216, v12
 v_mul_f32 v217, v217, v12
 v_mul_f32 v218, v218, v12
 v_mul_f32 v219, v219, v12
 v_mul_f32 v220, v220, v12
 v_mul_f32 v221, v221, v12
 v_mul_f32 v222, v222, v12
 v_mul_f32 v223, v223, v12
 v_mul_f32 v224, v224, v12
 v_mul_f32 v225, v225, v12
 v_mul_f32 v226, v226, v12
 v_mul_f32 v227, v227, v12
 v_mul_f32 v228, v228, v12
 v_mul_f32 v229, v229, v12
 v_mul_f32 v230, v230, v12
 v_mul_f32 v231, v231, v12
 v_mul_f32 v232, v232, v12
 v_mul_f32 v233, v233, v12
 v_mul_f32 v234, v234, v12
 v_mul_f32 v235, v235, v12
 v_mul_f32 v236, v236, v12
 v_mul_f32 v237, v237, v12
 v_mul_f32 v238, v238, v12
 v_mul_f32 v239, v239, v12
 v_mul_f32 v240, v240, v12
 v_mul_f32 v241, v241, v12
 v_mul_f32 v242, v242, v12
 v_mul_f32 v243, v243, v12
 v_mul_f32 v244, v244, v12
 v_mul_f32 v245, v245, v12
 v_mul_f32 v246, v246, v12
 v_mul_f32 v247, v247, v12
 v_mul_f32 v248, v248, v12
 v_mul_f32 v249, v249, v12
 v_mul_f32 v250, v250, v12
 v_mul_f32 v251, v251, v12
 v_mul_f32 v252, v252, v12
 v_mul_f32 v253, v253, v12
 v_mul_f32 v254, v254, v12
 v_mul_f32 v255, v255, v12
 s_branch L_ret
.p2align 6
L_loop:
 v_mfma_f32_16x16x32_bf16 v[32:35], a[64:67], a[0:3], v[96:99]
 s_mov_b32 m0, s40
 ds_read_b128 a[96:99], v2 offset:8192
 v_cvt_pk_bf16_f32 v16, v64, v65
 v_mfma_f32_16x16x32_bf16 v[32:35], a[68:71], a[4:7], v[32:35]
 s_waitcnt lgkmcnt(5)
 buffer_load_dwordx4 v1, s[12:15], s42 offen offset:0 sc1 lds
 v_mfma_f32_16x16x32_bf16 v[32:35], a[72:75], a[8:11], v[32:35]
 ds_read_b128 a[100:103], v2 offset:9216
 v_cvt_pk_bf16_f32 v17, v66, v67
 v_mfma_f32_16x16x32_bf16 v[32:35], a[76:79], a[12:15], v[32:35]
 s_waitcnt lgkmcnt(4)
 v_cvt_pk_bf16_f32 v20, v68, v69
 v_cvt_pk_bf16_f32 v21, v70, v71
 v_mfma_f32_16x16x32_bf16 v[32:35], a[80:83], a[16:19], v[32:35]
 ds_read_b128 a[104:107], v2 offset:10240
 v_add_f32 v7, v7, v5
 v_mfma_f32_16x16x32_bf16 v[32:35], a[84:87], a[20:23], v[32:35]
 s_waitcnt lgkmcnt(3)
 v_add_f32 v8, v8, v6
 v_cvt_pk_bf16_f32 v18, v72, v73
 v_mfma_f32_16x16x32_bf16 v[32:35], a[88:91], a[24:27], v[32:35]
 ds_read_b128 a[108:111], v2 offset:11264
 v_cvt_pk_bf16_f32 v19, v74, v75
 v_mfma_f32_16x16x32_bf16 v[32:35], a[92:95], a[28:31], v[32:35]
 buffer_load_dwordx4 v1, s[12:15], s42 offen offset:1024 sc1 lds
 v_mfma_f32_16x16x32_bf16 v[36:39], a[64:67], a[32:35], v[100:103]
 ds_read_b128 a[112:115], v2 offset:12288
 v_cvt_pk_bf16_f32 v22, v76, v77
 v_mfma_f32_16x16x32_bf16 v[36:39], a[68:71], a[36:39], v[36:39]
 v_cvt_pk_bf16_f32 v23, v78, v79
 v_cvt_pk_bf16_f32 v24, v80, v81
 v_mfma_f32_16x16x32_bf16 v[36:39], a[72:75], a[40:43], v[36:39]
 ds_read_b128 a[116:119], v2 offset:13312
 v_cvt_pk_bf16_f32 v25, v82, v83
 v_mfma_f32_16x16x32_bf16 v[36:39], a[76:79], a[44:47], v[36:39]
 v_cvt_pk_bf16_f32 v28, v84, v85
 v_cvt_pk_bf16_f32 v29, v86, v87
 v_mfma_f32_16x16x32_bf16 v[36:39], a[80:83], a[48:51], v[36:39]
 ds_read_b128 a[120:123], v2 offset:14336
 v_cvt_pk_bf16_f32 v26, v88, v89
 v_mfma_f32_16x16x32_bf16 v[36:39], a[84:87], a[52:55], v[36:39]
 buffer_load_dwordx4 v1, s[12:15], s42 offen offset:2048 sc1 lds
 v_mfma_f32_16x16x32_bf16 v[36:39], a[88:91], a[56:59], v[36:39]
 ds_read_b128 a[124:127], v2 offset:15360
 v_cvt_pk_bf16_f32 v27, v90, v91
 v_mfma_f32_16x16x32_bf16 v[36:39], a[92:95], a[60:63], v[36:39]
 s_waitcnt lgkmcnt(6)
 v_exp_f32 v64, v32
 v_mfma_f32_16x16x32_bf16 v[40:43], a[96:99], a[0:3], v[104:107]
 ds_read_b128 a[64:67], v2 offset:16384
 v_cvt_pk_bf16_f32 v30, v92, v93
 v_mfma_f32_16x16x32_bf16 v[40:43], a[100:103], a[4:7], v[40:43]
 s_waitcnt lgkmcnt(5)
 v_exp_f32 v65, v33
 v_mfma_f32_16x16x32_bf16 v[40:43], a[104:107], a[8:11], v[40:43]
 ds_read_b128 a[68:71], v2 offset:17408
 v_cvt_pk_bf16_f32 v31, v94, v95
 v_mfma_f32_16x16x32_bf16 v[40:43], a[108:111], a[12:15], v[40:43]
 s_waitcnt lgkmcnt(4)
 buffer_load_dwordx4 v1, s[12:15], s42 offen offset:3072 sc1 lds
 v_mfma_f32_16x16x32_bf16 v[40:43], a[112:115], a[16:19], v[40:43]
 ds_read_b128 a[72:75], v2 offset:18432
 v_add_f32 v5, v64, v65
 v_mfma_f32_16x16x32_bf16 v[40:43], a[116:119], a[20:23], v[40:43]
 s_waitcnt lgkmcnt(3)
 v_exp_f32 v66, v34
 v_mfma_f32_16x16x32_bf16 v[40:43], a[120:123], a[24:27], v[40:43]
 ds_read_b128 a[76:79], v2 offset:19456
 v_add_f32 v5, v5, v66
 v_mfma_f32_16x16x32_bf16 v[40:43], a[124:127], a[28:31], v[40:43]
 v_exp_f32 v67, v35
 v_mfma_f32_16x16x32_bf16 v[44:47], a[96:99], a[32:35], v[108:111]
 s_bitset1_b32 m0, 12
 ds_read_b128 a[80:83], v2 offset:20480
 v_add_f32 v5, v5, v67
 v_mfma_f32_16x16x32_bf16 v[44:47], a[100:103], a[36:39], v[44:47]
 buffer_load_dwordx4 v4, s[12:15], s42 offen offset:0 sc1 lds
 v_mfma_f32_16x16x32_bf16 v[44:47], a[104:107], a[40:43], v[44:47]
 ds_read_b128 a[84:87], v2 offset:21504
 v_mfma_f32_16x16x32_bf16 v[44:47], a[108:111], a[44:47], v[44:47]
 v_exp_f32 v68, v36
 v_mfma_f32_16x16x32_bf16 v[44:47], a[112:115], a[48:51], v[44:47]
 ds_read_b128 a[88:91], v2 offset:22528
 v_mfma_f32_16x16x32_bf16 v[44:47], a[116:119], a[52:55], v[44:47]
 v_exp_f32 v69, v37
 v_mfma_f32_16x16x32_bf16 v[44:47], a[120:123], a[56:59], v[44:47]
 ds_read_b128 a[92:95], v2 offset:23552
 v_add_f32 v6, v68, v69
 v_mfma_f32_16x16x32_bf16 v[44:47], a[124:127], a[60:63], v[44:47]
 s_waitcnt lgkmcnt(6)
 buffer_load_dwordx4 v4, s[12:15], s42 offen offset:1024 sc1 lds
 v_mfma_f32_16x16x32_bf16 v[48:51], a[64:67], a[0:3], v[112:115]
 ds_read_b128 a[96:99], v2 offset:24576
 v_mfma_f32_16x16x32_bf16 v[48:51], a[68:71], a[4:7], v[48:51]
 s_waitcnt lgkmcnt(5)
 v_exp_f32 v70, v38
 v_mfma_f32_16x16x32_bf16 v[48:51], a[72:75], a[8:11], v[48:51]
 ds_read_b128 a[100:103], v2 offset:25600
 v_add_f32 v6, v6, v70
 v_mfma_f32_16x16x32_bf16 v[48:51], a[76:79], a[12:15], v[48:51]
 s_waitcnt lgkmcnt(4)
 v_exp_f32 v71, v39
 v_mfma_f32_16x16x32_bf16 v[48:51], a[80:83], a[16:19], v[48:51]
 ds_read_b128 a[104:107], v2 offset:26624
 v_add_f32 v6, v6, v71
 v_mfma_f32_16x16x32_bf16 v[48:51], a[84:87], a[20:23], v[48:51]
 s_waitcnt lgkmcnt(3)
 buffer_load_dwordx4 v4, s[12:15], s42 offen offset:2048 sc1 lds
 v_mfma_f32_16x16x32_bf16 v[48:51], a[88:91], a[24:27], v[48:51]
 ds_read_b128 a[108:111], v2 offset:27648
 v_mfma_f32_16x16x32_bf16 v[48:51], a[92:95], a[28:31], v[48:51]
 v_exp_f32 v72, v40
 v_mfma_f32_16x16x32_bf16 v[52:55], a[64:67], a[32:35], v[116:119]
 ds_read_b128 a[112:115], v2 offset:28672
 v_add_f32 v5, v5, v72
 v_mfma_f32_16x16x32_bf16 v[52:55], a[68:71], a[36:39], v[52:55]
 v_exp_f32 v73, v41
 v_mfma_f32_16x16x32_bf16 v[52:55], a[72:75], a[40:43], v[52:55]
 s_xor_b32 s40, s40, 0x8000
 ds_read_b128 a[116:119], v2 offset:29696
 v_add_f32 v5, v5, v73
 v_mfma_f32_16x16x32_bf16 v[52:55], a[76:79], a[44:47], v[52:55]
 buffer_load_dwordx4 v4, s[12:15], s42 offen offset:3072 sc1 lds
 v_mfma_f32_16x16x32_bf16 v[52:55], a[80:83], a[48:51], v[52:55]
 s_add_u32 s42, s42, s70
 ds_read_b128 a[120:123], v2 offset:30720
 v_mfma_f32_16x16x32_bf16 v[52:55], a[84:87], a[52:55], v[52:55]
 v_exp_f32 v74, v42
 v_mfma_f32_16x16x32_bf16 v[52:55], a[88:91], a[56:59], v[52:55]
 s_waitcnt vmcnt(8)
 ds_read_b128 a[124:127], v2 offset:31744
 v_add_f32 v5, v5, v74
 v_mfma_f32_16x16x32_bf16 v[52:55], a[92:95], a[60:63], v[52:55]
 s_waitcnt lgkmcnt(6)
 s_barrier
 v_mfma_f32_16x16x32_bf16 v[56:59], a[96:99], a[0:3], v[120:123]
 s_mov_b32 m0, s41
 ds_read_b128 a[64:67], v3 offset:0
 v_xor_b32 v2, 0x8000, v2
 v_mfma_f32_16x16x32_bf16 v[56:59], a[100:103], a[4:7], v[56:59]
 s_waitcnt lgkmcnt(5)
 buffer_load_dwordx4 v1, s[12:15], s43 offen offset:0 sc1 lds
 v_mfma_f32_16x16x32_bf16 v[56:59], a[104:107], a[8:11], v[56:59]
 s_cmp_eq_u32 s42, s66
 ds_read_b128 a[68:71], v3 offset:16384
 v_mfma_f32_16x16x32_bf16 v[56:59], a[108:111], a[12:15], v[56:59]
 s_waitcnt lgkmcnt(4)
 v_exp_f32 v75, v43
 v_mfma_f32_16x16x32_bf16 v[56:59], a[112:115], a[16:19], v[56:59]
 s_cmov_b32 s42, s67
 ds_read_b128 a[72:75], v3 offset:1024
 v_add_f32 v5, v5, v75
 v_mfma_f32_16x16x32_bf16 v[56:59], a[116:119], a[20:23], v[56:59]
 s_waitcnt lgkmcnt(3)
 v_exp_f32 v76, v44
 v_mfma_f32_16x16x32_bf16 v[56:59], a[120:123], a[24:27], v[56:59]
 s_cmov_b32 s70, 0x8000
 ds_read_b128 a[76:79], v3 offset:17408
 v_add_f32 v6, v6, v76
 v_mfma_f32_16x16x32_bf16 v[56:59], a[124:127], a[28:31], v[56:59]
 buffer_load_dwordx4 v1, s[12:15], s43 offen offset:1024 sc1 lds
 v_mfma_f32_16x16x32_bf16 v[60:63], a[96:99], a[32:35], v[124:127]
 ds_read_b128 a[80:83], v3 offset:2048
 v_mfma_f32_16x16x32_bf16 v[60:63], a[100:103], a[36:39], v[60:63]
 v_exp_f32 v77, v45
 v_mfma_f32_16x16x32_bf16 v[60:63], a[104:107], a[40:43], v[60:63]
 ds_read_b128 a[84:87], v3 offset:18432
 v_add_f32 v6, v6, v77
 v_mfma_f32_16x16x32_bf16 v[60:63], a[108:111], a[44:47], v[60:63]
 v_exp_f32 v78, v46
 v_mfma_f32_16x16x32_bf16 v[60:63], a[112:115], a[48:51], v[60:63]
 ds_read_b128 a[88:91], v3 offset:3072
 v_add_f32 v6, v6, v78
 v_mfma_f32_16x16x32_bf16 v[60:63], a[116:119], a[52:55], v[60:63]
 buffer_load_dwordx4 v1, s[12:15], s43 offen offset:2048 sc1 lds
 v_mfma_f32_16x16x32_bf16 v[60:63], a[120:123], a[56:59], v[60:63]
 ds_read_b128 a[92:95], v3 offset:19456
 v_mfma_f32_16x16x32_bf16 v[60:63], a[124:127], a[60:63], v[60:63]
 s_waitcnt lgkmcnt(6)
 v_exp_f32 v79, v47
 v_mfma_f32_16x16x32_bf16 v[128:131], a[64:67], v[16:19], v[128:131]
 ds_read_b128 a[96:99], v3 offset:4096
 v_add_f32 v6, v6, v79
 v_mfma_f32_16x16x32_bf16 v[128:131], a[68:71], v[24:27], v[128:131]
 v_exp_f32 v80, v48
 v_mfma_f32_16x16x32_bf16 v[192:195], a[68:71], v[28:31], v[192:195]
 ds_read_b128 a[100:103], v3 offset:20480
 v_add_f32 v5, v5, v80
 v_mfma_f32_16x16x32_bf16 v[192:195], a[64:67], v[20:23], v[192:195]
 s_waitcnt lgkmcnt(6)
 buffer_load_dwordx4 v1, s[12:15], s43 offen offset:3072 sc1 lds
 v_mfma_f32_16x16x32_bf16 v[132:135], a[72:75], v[16:19], v[132:135]
 ds_read_b128 a[104:107], v3 offset:5120
 v_mfma_f32_16x16x32_bf16 v[132:135], a[76:79], v[24:27], v[132:135]
 v_exp_f32 v81, v49
 v_mfma_f32_16x16x32_bf16 v[196:199], a[76:79], v[28:31], v[196:199]
 ds_read_b128 a[108:111], v3 offset:21504
 v_add_f32 v5, v5, v81
 v_mfma_f32_16x16x32_bf16 v[196:199], a[72:75], v[20:23], v[196:199]
 s_waitcnt lgkmcnt(6)
 v_exp_f32 v82, v50
 v_mfma_f32_16x16x32_bf16 v[136:139], a[80:83], v[16:19], v[136:139]
 s_bitset1_b32 m0, 12
 ds_read_b128 a[112:115], v3 offset:6144
 v_add_f32 v5, v5, v82
 v_mfma_f32_16x16x32_bf16 v[136:139], a[84:87], v[24:27], v[136:139]
 buffer_load_dwordx4 v4, s[12:15], s43 offen offset:0 sc1 lds
 v_mfma_f32_16x16x32_bf16 v[200:203], a[84:87], v[28:31], v[200:203]
 ds_read_b128 a[116:119], v3 offset:22528
 v_mfma_f32_16x16x32_bf16 v[200:203], a[80:83], v[20:23], v[200:203]
 s_waitcnt lgkmcnt(6)
 v_exp_f32 v83, v51
 v_mfma_f32_16x16x32_bf16 v[140:143], a[88:91], v[16:19], v[140:143]
 ds_read_b128 a[120:123], v3 offset:7168
 v_add_f32 v5, v5, v83
 v_mfma_f32_16x16x32_bf16 v[140:143], a[92:95], v[24:27], v[140:143]
 v_exp_f32 v84, v52
 v_mfma_f32_16x16x32_bf16 v[204:207], a[92:95], v[28:31], v[204:207]
 ds_read_b128 a[124:127], v3 offset:23552
 v_add_f32 v6, v6, v84
 v_mfma_f32_16x16x32_bf16 v[204:207], a[88:91], v[20:23], v[204:207]
 s_waitcnt lgkmcnt(6)
 buffer_load_dwordx4 v4, s[12:15], s43 offen offset:1024 sc1 lds
 v_mfma_f32_16x16x32_bf16 v[144:147], a[96:99], v[16:19], v[144:147]
 ds_read_b128 a[64:67], v3 offset:8192
 v_mfma_f32_16x16x32_bf16 v[144:147], a[100:103], v[24:27], v[144:147]
 v_exp_f32 v85, v53
 v_mfma_f32_16x16x32_bf16 v[208:211], a[100:103], v[28:31], v[208:211]
 ds_read_b128 a[68:71], v3 offset:24576
 v_add_f32 v6, v6, v85
 v_mfma_f32_16x16x32_bf16 v[208:211], a[96:99], v[20:23], v[208:211]
 s_waitcnt lgkmcnt(6)
 v_exp_f32 v86, v54
 v_mfma_f32_16x16x32_bf16 v[148:151], a[104:107], v[16:19], v[148:151]
 ds_read_b128 a[72:75], v3 offset:9216
 v_add_f32 v6, v6, v86
 v_mfma_f32_16x16x32_bf16 v[148:151], a[108:111], v[24:27], v[148:151]
 buffer_load_dwordx4 v4, s[12:15], s43 offen offset:2048 sc1 lds
 v_mfma_f32_16x16x32_bf16 v[212:215], a[108:111], v[28:31], v[212:215]
 ds_read_b128 a[76:79], v3 offset:25600
 v_mfma_f32_16x16x32_bf16 v[212:215], a[104:107], v[20:23], v[212:215]
 s_waitcnt lgkmcnt(6)
 v_exp_f32 v87, v55
 v_mfma_f32_16x16x32_bf16 v[152:155], a[112:115], v[16:19], v[152:155]
 ds_read_b128 a[80:83], v3 offset:10240
 v_add_f32 v6, v6, v87
 v_mfma_f32_16x16x32_bf16 v[152:155], a[116:119], v[24:27], v[152:155]
 v_exp_f32 v88, v56
 v_mfma_f32_16x16x32_bf16 v[216:219], a[116:119], v[28:31], v[216:219]
 s_xor_b32 s41, s41, 0x8000
 ds_read_b128 a[84:87], v3 offset:26624
 v_add_f32 v5, v5, v88
 v_mfma_f32_16x16x32_bf16 v[216:219], a[112:115], v[20:23], v[216:219]
 s_waitcnt lgkmcnt(6)
 buffer_load_dwordx4 v4, s[12:15], s43 offen offset:3072 sc1 lds
 v_mfma_f32_16x16x32_bf16 v[156:159], a[120:123], v[16:19], v[156:159]
 s_add_u32 s43, s43, s71
 ds_read_b128 a[88:91], v3 offset:11264
 v_mfma_f32_16x16x32_bf16 v[156:159], a[124:127], v[24:27], v[156:159]
 v_exp_f32 v89, v57
 v_mfma_f32_16x16x32_bf16 v[220:223], a[124:127], v[28:31], v[220:223]
 s_cmp_eq_u32 s43, s68
 ds_read_b128 a[92:95], v3 offset:27648
 v_add_f32 v5, v5, v89
 v_mfma_f32_16x16x32_bf16 v[220:223], a[120:123], v[20:23], v[220:223]
 s_waitcnt lgkmcnt(6)
 v_exp_f32 v90, v58
 v_mfma_f32_16x16x32_bf16 v[160:163], a[64:67], v[16:19], v[160:163]
 s_cmov_b32 s43, s69
 ds_read_b128 a[96:99], v3 offset:12288
 v_add_f32 v5, v5, v90
 v_mfma_f32_16x16x32_bf16 v[160:163], a[68:71], v[24:27], v[160:163]
 s_cmov_b32 s71, 0x8000
 v_exp_f32 v91, v59
 v_mfma_f32_16x16x32_bf16 v[224:227], a[68:71], v[28:31], v[224:227]
 ds_read_b128 a[100:103], v3 offset:28672
 v_add_f32 v5, v5, v91
 v_mfma_f32_16x16x32_bf16 v[224:227], a[64:67], v[20:23], v[224:227]
 s_waitcnt lgkmcnt(6)
 v_exp_f32 v92, v60
 v_mfma_f32_16x16x32_bf16 v[164:167], a[72:75], v[16:19], v[164:167]
 ds_read_b128 a[104:107], v3 offset:13312
 v_add_f32 v6, v6, v92
 v_mfma_f32_16x16x32_bf16 v[164:167], a[76:79], v[24:27], v[164:167]
 v_exp_f32 v93, v61
 v_mfma_f32_16x16x32_bf16 v[228:231], a[76:79], v[28:31], v[228:231]
 ds_read_b128 a[108:111], v3 offset:29696
 v_add_f32 v6, v6, v93
 v_mfma_f32_16x16x32_bf16 v[228:231], a[72:75], v[20:23], v[228:231]
 s_waitcnt lgkmcnt(6)
 v_exp_f32 v94, v62
 v_mfma_f32_16x16x32_bf16 v[168:171], a[80:83], v[16:19], v[168:171]
 ds_read_b128 a[112:115], v3 offset:14336
 v_add_f32 v6, v6, v94
 v_mfma_f32_16x16x32_bf16 v[168:171], a[84:87], v[24:27], v[168:171]
 v_exp_f32 v95, v63
 v_mfma_f32_16x16x32_bf16 v[232:235], a[84:87], v[28:31], v[232:235]
 ds_read_b128 a[116:119], v3 offset:30720
 v_add_f32 v6, v6, v95
 v_mfma_f32_16x16x32_bf16 v[232:235], a[80:83], v[20:23], v[232:235]
 s_waitcnt lgkmcnt(6)
 v_add_f32 v11, v5, v6
 v_mfma_f32_16x16x32_bf16 v[172:175], a[88:91], v[16:19], v[172:175]
 ds_read_b128 a[120:123], v3 offset:15360
 v_cmp_nge_f32 vcc, s47, v11
 v_mfma_f32_16x16x32_bf16 v[172:175], a[92:95], v[24:27], v[172:175]
 buffer_load_dword a246, v15, s[12:15], s60 offen sc1
 v_mfma_f32_16x16x32_bf16 v[236:239], a[92:95], v[28:31], v[236:239]
 s_waitcnt vmcnt(9)
 ds_read_b128 a[124:127], v3 offset:31744
 v_mfma_f32_16x16x32_bf16 v[236:239], a[88:91], v[20:23], v[236:239]
 s_waitcnt lgkmcnt(6)
 s_barrier
 v_mfma_f32_16x16x32_bf16 v[176:179], a[96:99], v[16:19], v[176:179]
 ds_read_b128 a[64:67], v2 offset:0
 v_xor_b32 v3, 0x8000, v3
 v_mfma_f32_16x16x32_bf16 v[176:179], a[100:103], v[24:27], v[176:179]
 v_mfma_f32_16x16x32_bf16 v[240:243], a[100:103], v[28:31], v[240:243]
 ds_read_b128 a[68:71], v2 offset:1024
 v_mfma_f32_16x16x32_bf16 v[240:243], a[96:99], v[20:23], v[240:243]
 s_waitcnt lgkmcnt(6)
 v_mfma_f32_16x16x32_bf16 v[180:183], a[104:107], v[16:19], v[180:183]
 ds_read_b128 a[72:75], v2 offset:2048
 v_mfma_f32_16x16x32_bf16 v[180:183], a[108:111], v[24:27], v[180:183]
 v_mfma_f32_16x16x32_bf16 v[244:247], a[108:111], v[28:31], v[244:247]
 ds_read_b128 a[76:79], v2 offset:3072
 v_mfma_f32_16x16x32_bf16 v[244:247], a[104:107], v[20:23], v[244:247]
 s_waitcnt lgkmcnt(6)
 v_mfma_f32_16x16x32_bf16 v[184:187], a[112:115], v[16:19], v[184:187]
 s_sub_u32 s44, s44, 1
 ds_read_b128 a[80:83], v2 offset:4096
 v_mfma_f32_16x16x32_bf16 v[184:187], a[116:119], v[24:27], v[184:187]
 v_mfma_f32_16x16x32_bf16 v[248:251], a[116:119], v[28:31], v[248:251]
 ds_read_b128 a[84:87], v2 offset:5120
 v_mfma_f32_16x16x32_bf16 v[248:251], a[112:115], v[20:23], v[248:251]
 s_waitcnt lgkmcnt(6)
 v_mfma_f32_16x16x32_bf16 v[188:191], a[120:123], v[16:19], v[188:191]
 ds_read_b128 a[88:91], v2 offset:6144
 v_mfma_f32_16x16x32_bf16 v[188:191], a[124:127], v[24:27], v[188:191]
 v_mfma_f32_16x16x32_bf16 v[252:255], a[124:127], v[28:31], v[252:255]
 ds_read_b128 a[92:95], v2 offset:7168
 v_mfma_f32_16x16x32_bf16 v[252:255], a[120:123], v[20:23], v[252:255]
 s_waitcnt lgkmcnt(6)
 s_cbranch_vccnz L_slow
L_ret:
 s_cmp_gt_u32 s44, s45
 s_cbranch_scc1 L_loop
 s_cmp_eq_u32 s44, 0
 s_cbranch_scc1 L_segend
 s_cmp_eq_u32 s44, 1
 s_cbranch_scc1 L_d1
 s_cmp_eq_u32 s44, 2
 s_cbranch_scc1 L_d0
 s_waitcnt vmcnt(0)
 v_accvgpr_read_b32 v12, a246
 v_cmp_ne_u32 vcc, 0, v12
 s_cbranch_vccz L_poll1_ok
 v_and_b32 v11, 11, v0
 v_lshlrev_b32 v11, 2, v11
 s_mov_b32 s32, 0
L_poll1:
 buffer_load_dword v12, v11, s[12:15], s60 offen sc1
 s_waitcnt vmcnt(0)
 v_cmp_ne_u32 vcc, 0, v12
 s_cbranch_vccz L_poll1_ok
 s_sleep 8
 s_add_u32 s32, s32, 1
 s_cmp_lt_u32 s32, 0x80000
 s_cbranch_scc1 L_poll1
L_poll1_ok:
 s_mov_b32 s60, s94
 v_mov_b32 v15, 0
 s_mov_b32 s45, 2
 s_branch L_loop
L_d0:
 v_mov_b32 v11, 0xf149f2ca
 v_cmp_gt_i32 s[16:17], 0, v14
 v_cmp_gt_i32 s[18:19], 1, v14
 v_cmp_gt_i32 s[20:21], 2, v14
 v_cmp_gt_i32 s[22:23], 3, v14
 v_cndmask_b32 v96, v9, v11, s[16:17]
 v_cndmask_b32 v97, v9, v11, s[18:19]
 v_cndmask_b32 v98, v9, v11, s[20:21]
 v_cndmask_b32 v99, v9, v11, s[22:23]
 v_cmp_gt_i32 s[16:17], 16, v14
 v_cmp_gt_i32 s[18:19], 17, v14
 v_cmp_gt_i32 s[20:21], 18, v14
 v_cmp_gt_i32 s[22:23], 19, v14
 v_cndmask_b32 v104, v9, v11, s[16:17]
 v_cndmask_b32 v105, v9, v11, s[18:19]
 v_cndmask_b32 v106, v9, v11, s[20:21]
 v_cndmask_b32 v107, v9, v11, s[22:23]
 v_cmp_gt_i32 s[16:17], 32, v14
 v_cmp_gt_i32 s[18:19], 33, v14
 v_cmp_gt_i32 s[20:21], 34, v14
 v_cmp_gt_i32 s[22:23], 35, v14
 v_cndmask_b32 v112, v9, v11, s[16:17]
 v_cndmask_b32 v113, v9, v11, s[18:19]
 v_cndmask_b32 v114, v9, v11, s[20:21]
 v_cndmask_b32 v115, v9, v11, s[22:23]
 v_cmp_gt_i32 s[16:17], 48, v14
 v_cmp_gt_i32 s[18:19], 49, v14
 v_cmp_gt_i32 s[20:21], 50, v14
 v_cmp_gt_i32 s[22:23], 51, v14
 v_cndmask_b32 v120, v9, v11, s[16:17]
 v_cndmask_b32 v121, v9, v11, s[18:19]
 v_cndmask_b32 v122, v9, v11, s[20:21]
 v_cndmask_b32 v123, v9, v11, s[22:23]
 s_nop 0
 s_branch L_loop
L_d1:
 s_cmp_eq_u32 s54, 0
 s_cselect_b32 s57, s38, 0
 s_cmp_lg_u32 s57, 0
 s_cselect_b32 s42, s49, 0xf0000000
 s_cbranch_scc1 L_d1q
 s_cmp_eq_u32 s54, 1
 s_cbranch_scc1 L_d1w
 v_and_b32 v11, 31, v0
 v_lshlrev_b32 v11, 2, v11
 buffer_load_dword a247, v11, s[12:15], s61 offen sc1
 v_accvgpr_read_b32 v12, a244
 global_load_dword a243, v12, s[100:101]
 v_lshrrev_b32 v12, 3, v0
 s_lshl_b32 s78, s3, 3
 v_add_u32 v13, s78, v12
 v_mul_u32_u24 v13, 896, v13
 v_and_b32 v12, 6, v12
 v_xor_b32 v12, v12, v0
 v_and_b32 v12, 7, v12
 v_lshl_add_u32 v13, v12, 4, v13
 s_mul_i32 s78, s26, 229376
 s_add_u32 s79, s78, 28672
 s_add_u32 s80, s78, 57344
 s_add_u32 s81, s78, 86016
 s_add_u32 s82, s78, 114688
 s_add_u32 s83, s78, 143360
 s_add_u32 s84, s78, 172032
 s_add_u32 s85, s78, 200704
 s_mov_b32 s8, s86
 s_mov_b32 s9, s87
 s_mov_b32 s10, 3670016
 s_mov_b32 s11, 0x20000
 s_add_u32 m0, s29, 131072
 s_nop 0
 buffer_load_dwordx4 v13, s[8:11], s78 offen lds
 v_mov_b32 v11, 0xf149f2ca
 v_cmp_gt_i32 s[16:17], 0, v14
 v_cmp_gt_i32 s[18:19], 1, v14
 v_cmp_gt_i32 s[20:21], 2, v14
 v_cmp_gt_i32 s[22:23], 3, v14
 v_cndmask_b32 v100, v10, v11, s[16:17]
 s_add_u32 m0, s29, 135168
 s_nop 0
 buffer_load_dwordx4 v13, s[8:11], s79 offen lds
 v_cndmask_b32 v101, v10, v11, s[18:19]
 v_cndmask_b32 v102, v10, v11, s[20:21]
 v_cndmask_b32 v103, v10, v11, s[22:23]
 v_cmp_gt_i32 s[16:17], 16, v14
 v_cmp_gt_i32 s[18:19], 17, v14
 s_add_u32 m0, s29, 139264
 s_nop 0
 buffer_load_dwordx4 v13, s[8:11], s80 offen lds
 v_cmp_gt_i32 s[20:21], 18, v14
 v_cmp_gt_i32 s[22:23], 19, v14
 v_cndmask_b32 v108, v10, v11, s[16:17]
 v_cndmask_b32 v109, v10, v11, s[18:19]
 v_cndmask_b32 v110, v10, v11, s[20:21]
 v_cndmask_b32 v111, v10, v11, s[22:23]
 s_add_u32 m0, s29, 143360
 s_nop 0
 buffer_load_dwordx4 v13, s[8:11], s81 offen lds
 v_cmp_gt_i32 s[16:17], 32, v14
 v_cmp_gt_i32 s[18:19], 33, v14
 v_cmp_gt_i32 s[20:21], 34, v14
 v_cmp_gt_i32 s[22:23], 35, v14
 v_cndmask_b32 v116, v10, v11, s[16:17]
 s_add_u32 m0, s29, 147456
 s_nop 0
 buffer_load_dwordx4 v13, s[8:11], s82 offen lds
 v_cndmask_b32 v117, v10, v11, s[18:19]
 v_cndmask_b32 v118, v10, v11, s[20:21]
 v_cndmask_b32 v119, v10, v11, s[22:23]
 v_cmp_gt_i32 s[16:17], 48, v14
 v_cmp_gt_i32 s[18:19], 49, v14
 s_add_u32 m0, s29, 151552
 s_nop 0
 buffer_load_dwordx4 v13, s[8:11], s83 offen lds
 v_cmp_gt_i32 s[20:21], 50, v14
 v_cmp_gt_i32 s[22:23], 51, v14
 v_cndmask_b32 v124, v10, v11, s[16:17]
 v_cndmask_b32 v125, v10, v11, s[18:19]
 v_cndmask_b32 v126, v10, v11, s[20:21]
 v_cndmask_b32 v127, v10, v11, s[22:23]
 s_add_u32 m0, s29, 155648
 s_nop 0
 buffer_load_dwordx4 v13, s[8:11], s84 offen lds
 s_mov_b32 s16, 0xf149f2ca
 s_mov_b32 s17, s16
 v_mov_b64 v[96:97], s[16:17]
 v_mov_b64 v[98:99], s[16:17]
 v_mov_b64 v[104:105], s[16:17]
 s_add_u32 m0, s29, 159744
 s_nop 0
 buffer_load_dwordx4 v13, s[8:11], s85 offen lds
 v_mov_b64 v[106:107], s[16:17]
 v_mov_b64 v[112:113], s[16:17]
 v_mov_b64 v[114:115], s[16:17]
 v_mov_b64 v[120:121], s[16:17]
 v_mov_b64 v[122:123], s[16:17]
 v_add_u32 v13, 128, v13
 v_accvgpr_write_b32 a252, v13
 s_branch L_loop
L_d1q:
 s_sub_u32 s58, 15, s25
 s_waitcnt vmcnt(0)
 v_accvgpr_read_b32 v12, a246
 v_cmp_ne_u32 vcc, 0, v12
 s_cbranch_vccz L_poll2_ok
 v_and_b32 v11, 0, v0
 v_lshlrev_b32 v11, 2, v11
 s_mov_b32 s32, 0
L_poll2:
 buffer_load_dword v12, v11, s[12:15], s60 offen sc1
 s_waitcnt vmcnt(0)
 v_cmp_ne_u32 vcc, 0, v12
 s_cbranch_vccz L_poll2_ok
 s_sleep 8
 s_add_u32 s32, s32, 1
 s_cmp_lt_u32 s32, 0x80000
 s_cbranch_scc1 L_poll2
L_poll2_ok:
 s_lshl_b32 s55, s58, 16
 s_add_u32 s55, s55, s49
 s_add_u32 s55, s55, 33554432
 s_add_u32 s56, s55, 0x8000
 buffer_load_dwordx4 a[128:131], v1, s[12:15], s55 offen offset:0 sc1
 v_mov_b32 v11, 0xf149f2ca
 v_cmp_gt_i32 s[16:17], 0, v14
 v_cmp_gt_i32 s[18:19], 1, v14
 buffer_load_dwordx4 a[132:135], v1, s[12:15], s55 offen offset:1024 sc1
 v_cmp_gt_i32 s[20:21], 2, v14
 v_cmp_gt_i32 s[22:23], 3, v14
 v_cndmask_b32 v100, v10, v11, s[16:17]
 buffer_load_dwordx4 a[136:139], v1, s[12:15], s55 offen offset:2048 sc1
 v_cndmask_b32 v101, v10, v11, s[18:19]
 v_cndmask_b32 v102, v10, v11, s[20:21]
 v_cndmask_b32 v103, v10, v11, s[22:23]
 buffer_load_dwordx4 a[140:143], v1, s[12:15], s55 offen offset:3072 sc1
 v_cmp_gt_i32 s[16:17], 16, v14
 v_cmp_gt_i32 s[18:19], 17, v14
 buffer_load_dwordx4 a[144:147], v4, s[12:15], s55 offen offset:0 sc1
 v_cmp_gt_i32 s[20:21], 18, v14
 v_cmp_gt_i32 s[22:23], 19, v14
 v_cndmask_b32 v108, v10, v11, s[16:17]
 buffer_load_dwordx4 a[148:151], v4, s[12:15], s55 offen offset:1024 sc1
 v_cndmask_b32 v109, v10, v11, s[18:19]
 v_cndmask_b32 v110, v10, v11, s[20:21]
 v_cndmask_b32 v111, v10, v11, s[22:23]
 buffer_load_dwordx4 a[152:155], v4, s[12:15], s55 offen offset:2048 sc1
 v_cmp_gt_i32 s[16:17], 32, v14
 v_cmp_gt_i32 s[18:19], 33, v14
 buffer_load_dwordx4 a[156:159], v4, s[12:15], s55 offen offset:3072 sc1
 v_cmp_gt_i32 s[20:21], 34, v14
 v_cmp_gt_i32 s[22:23], 35, v14
 v_cndmask_b32 v116, v10, v11, s[16:17]
 buffer_load_dwordx4 a[160:163], v1, s[12:15], s56 offen offset:0 sc1
 v_cndmask_b32 v117, v10, v11, s[18:19]
 v_cndmask_b32 v118, v10, v11, s[20:21]
 v_cndmask_b32 v119, v10, v11, s[22:23]
 buffer_load_dwordx4 a[164:167], v1, s[12:15], s56 offen offset:1024 sc1
 v_cmp_gt_i32 s[16:17], 48, v14
 v_cmp_gt_i32 s[18:19], 49, v14
 buffer_load_dwordx4 a[168:171], v1, s[12:15], s56 offen offset:2048 sc1
 v_cmp_gt_i32 s[20:21], 50, v14
 v_cmp_gt_i32 s[22:23], 51, v14
 v_cndmask_b32 v124, v10, v11, s[16:17]
 buffer_load_dwordx4 a[172:175], v1, s[12:15], s56 offen offset:3072 sc1
 v_cndmask_b32 v125, v10, v11, s[18:19]
 v_cndmask_b32 v126, v10, v11, s[20:21]
 v_cndmask_b32 v127, v10, v11, s[22:23]
 buffer_load_dwordx4 a[176:179], v4, s[12:15], s56 offen offset:0 sc1
 s_mov_b32 s16, 0xf149f2ca
 s_mov_b32 s17, s16
 buffer_load_dwordx4 a[180:183], v4, s[12:15], s56 offen offset:1024 sc1
 v_mov_b64 v[96:97], s[16:17]
 v_mov_b64 v[98:99], s[16:17]
 v_mov_b64 v[104:105], s[16:17]
 buffer_load_dwordx4 a[184:187], v4, s[12:15], s56 offen offset:2048 sc1
 v_mov_b64 v[106:107], s[16:17]
 v_mov_b64 v[112:113], s[16:17]
 v_mov_b64 v[114:115], s[16:17]
 buffer_load_dwordx4 a[188:191], v4, s[12:15], s56 offen offset:3072 sc1
 v_mov_b64 v[120:121], s[16:17]
 v_mov_b64 v[122:123], s[16:17]
 s_cmp_lg_u32 s57, 1
 s_cbranch_scc1 L_loop
L_d1w:
 v_and_b32 v11, 31, v0
 v_lshlrev_b32 v11, 2, v11
 buffer_load_dword a247, v11, s[12:15], s61 offen sc1
 v_accvgpr_read_b32 v12, a244
 global_load_dword a243, v12, s[100:101]
 v_lshrrev_b32 v12, 3, v0
 s_lshl_b32 s78, s3, 3
 v_add_u32 v13, s78, v12
 v_mul_u32_u24 v13, 896, v13
 v_and_b32 v12, 6, v12
 v_xor_b32 v12, v12, v0
 v_and_b32 v12, 7, v12
 v_lshl_add_u32 v13, v12, 4, v13
 s_mul_i32 s78, s26, 229376
 s_add_u32 s79, s78, 28672
 s_add_u32 s80, s78, 57344
 s_add_u32 s81, s78, 86016
 s_add_u32 s82, s78, 114688
 s_add_u32 s83, s78, 143360
 s_add_u32 s84, s78, 172032
 s_add_u32 s85, s78, 200704
 s_mov_b32 s8, s86
 s_mov_b32 s9, s87
 s_mov_b32 s10, 3670016
 s_mov_b32 s11, 0x20000
 s_add_u32 m0, s29, 131072
 s_nop 0
 buffer_load_dwordx4 v13, s[8:11], s78 offen lds
 s_add_u32 m0, s29, 135168
 s_nop 0
 buffer_load_dwordx4 v13, s[8:11], s79 offen lds
 s_add_u32 m0, s29, 139264
 s_nop 0
 buffer_load_dwordx4 v13, s[8:11], s80 offen lds
 s_add_u32 m0, s29, 143360
 s_nop 0
 buffer_load_dwordx4 v13, s[8:11], s81 offen lds
 s_add_u32 m0, s29, 147456
 s_nop 0
 buffer_load_dwordx4 v13, s[8:11], s82 offen lds
 s_add_u32 m0, s29, 151552
 s_nop 0
 buffer_load_dwordx4 v13, s[8:11], s83 offen lds
 s_add_u32 m0, s29, 155648
 s_nop 0
 buffer_load_dwordx4 v13, s[8:11], s84 offen lds
 s_add_u32 m0, s29, 159744
 s_nop 0
 buffer_load_dwordx4 v13, s[8:11], s85 offen lds
 v_add_u32 v13, 128, v13
 v_accvgpr_write_b32 a252, v13
 s_branch L_loop
L_segend:
 s_cmp_eq_u32 s54, 0
 s_cselect_b32 s57, s38, 0
 s_cmp_eq_u32 s57, 0
 s_cbranch_scc1 L_tail
 v_accvgpr_mov_b32 a0, a128
 v_accvgpr_mov_b32 a1, a129
 v_accvgpr_mov_b32 a2, a130
 v_accvgpr_mov_b32 a3, a131
 v_accvgpr_mov_b32 a4, a132
 v_accvgpr_mov_b32 a5, a133
 v_accvgpr_mov_b32 a6, a134
 v_accvgpr_mov_b32 a7, a135
 v_accvgpr_mov_b32 a8, a136
 v_accvgpr_mov_b32 a9, a137
 v_accvgpr_mov_b32 a10, a138
 v_accvgpr_mov_b32 a11, a139
 v_accvgpr_mov_b32 a12, a140
 v_accvgpr_mov_b32 a13, a141
 v_accvgpr_mov_b32 a14, a142
 v_accvgpr_mov_b32 a15, a143
 v_accvgpr_mov_b32 a16, a144
 v_accvgpr_mov_b32 a17, a145
 v_accvgpr_mov_b32 a18, a146
 v_accvgpr_mov_b32 a19, a147
 v_accvgpr_mov_b32 a20, a148
 v_accvgpr_mov_b32 a21, a149
 v_accvgpr_mov_b32 a22, a150
 v_accvgpr_mov_b32 a23, a151
 v_accvgpr_mov_b32 a24, a152
 v_accvgpr_mov_b32 a25, a153
 v_accvgpr_mov_b32 a26, a154
 v_accvgpr_mov_b32 a27, a155
 v_accvgpr_mov_b32 a28, a156
 v_accvgpr_mov_b32 a29, a157
 v_accvgpr_mov_b32 a30, a158
 v_accvgpr_mov_b32 a31, a159
 v_accvgpr_mov_b32 a32, a160
 v_accvgpr_mov_b32 a33, a161
 v_accvgpr_mov_b32 a34, a162
 v_accvgpr_mov_b32 a35, a163
 v_accvgpr_mov_b32 a36, a164
 v_accvgpr_mov_b32 a37, a165
 v_accvgpr_mov_b32 a38, a166
 v_accvgpr_mov_b32 a39, a167
 v_accvgpr_mov_b32 a40, a168
 v_accvgpr_mov_b32 a41, a169
 v_accvgpr_mov_b32 a42, a170
 v_accvgpr_mov_b32 a43, a171
 v_accvgpr_mov_b32 a44, a172
 v_accvgpr_mov_b32 a45, a173
 v_accvgpr_mov_b32 a46, a174
 v_accvgpr_mov_b32 a47, a175
 v_accvgpr_mov_b32 a48, a176
 v_accvgpr_mov_b32 a49, a177
 v_accvgpr_mov_b32 a50, a178
 v_accvgpr_mov_b32 a51, a179
 v_accvgpr_mov_b32 a52, a180
 v_accvgpr_mov_b32 a53, a181
 v_accvgpr_mov_b32 a54, a182
 v_accvgpr_mov_b32 a55, a183
 v_accvgpr_mov_b32 a56, a184
 v_accvgpr_mov_b32 a57, a185
 v_accvgpr_mov_b32 a58, a186
 v_accvgpr_mov_b32 a59, a187
 v_accvgpr_mov_b32 a60, a188
 v_accvgpr_mov_b32 a61, a189
 v_accvgpr_mov_b32 a62, a190
 v_accvgpr_mov_b32 a63, a191
 v_mov_b64 v[96:97], 0
 v_mov_b64 v[98:99], 0
 v_mov_b64 v[100:101], 0
 v_mov_b64 v[102:103], 0
 v_mov_b64 v[104:105], 0
 v_mov_b64 v[106:107], 0
 v_mov_b64 v[108:109], 0
 v_mov_b64 v[110:111], 0
 v_mov_b64 v[112:113], 0
 v_mov_b64 v[114:115], 0
 v_mov_b64 v[116:117], 0
 v_mov_b64 v[118:119], 0
 v_mov_b64 v[120:121], 0
 v_mov_b64 v[122:123], 0
 v_mov_b64 v[124:125], 0
 v_mov_b64 v[126:127], 0
 s_add_u32 s43, s49, 16777216
 s_mov_b32 s44, s38
 s_mov_b32 s45, 1
 s_mov_b32 s47, -1.0
 s_branch L_loop
L_switched:
 v_mov_b32 v18, v7
 v_mov_b32 v19, v8
 s_nop 0
 v_permlane32_swap_b32 v7, v18
 v_permlane32_swap_b32 v8, v19
 s_nop 0
 v_add_f32 v7, v7, v18
 v_add_f32 v8, v8, v19
 s_nop 0
 v_mov_b32 v18, v7
 v_mov_b32 v19, v8
 s_nop 0
 v_permlane16_swap_b32 v7, v18
 v_permlane16_swap_b32 v8, v19
 s_nop 0
 v_add_f32 v7, v7, v18
 v_add_f32 v8, v8, v19
 s_nop 0
 v_rcp_f32 v16, v7
 v_rcp_f32 v17, v8
 s_mov_b32 s47, 0x4b800000
 s_mov_b32 s54, 1
 v_accvgpr_write_b32 a250, v16
 v_cvt_pk_bf16_f32 v128, v128, v129
 v_cvt_pk_bf16_f32 v129, v130, v131
 v_cvt_pk_bf16_f32 v130, v132, v133
 v_cvt_pk_bf16_f32 v131, v134, v135
 v_accvgpr_write_b32 a128, v128
 v_accvgpr_write_b32 a129, v129
 v_accvgpr_write_b32 a130, v130
 v_accvgpr_write_b32 a131, v131
 v_cvt_pk_bf16_f32 v136, v136, v137
 v_cvt_pk_bf16_f32 v137, v138, v139
 v_cvt_pk_bf16_f32 v138, v140, v141
 v_cvt_pk_bf16_f32 v139, v142, v143
 v_accvgpr_write_b32 a132, v136
 v_accvgpr_write_b32 a133, v137
 v_accvgpr_write_b32 a134, v138
 v_accvgpr_write_b32 a135, v139
 v_cvt_pk_bf16_f32 v144, v144, v145
 v_cvt_pk_bf16_f32 v145, v146, v147
 v_cvt_pk_bf16_f32 v146, v148, v149
 v_cvt_pk_bf16_f32 v147, v150, v151
 v_accvgpr_write_b32 a136, v144
 v_accvgpr_write_b32 a137, v145
 v_accvgpr_write_b32 a138, v146
 v_accvgpr_write_b32 a139, v147
 v_cvt_pk_bf16_f32 v152, v152, v153
 v_cvt_pk_bf16_f32 v153, v154, v155
 v_cvt_pk_bf16_f32 v154, v156, v157
 v_cvt_pk_bf16_f32 v155, v158, v159
 v_accvgpr_write_b32 a140, v152
 v_accvgpr_write_b32 a141, v153
 v_accvgpr_write_b32 a142, v154
 v_accvgpr_write_b32 a143, v155
 v_cvt_pk_bf16_f32 v160, v160, v161
 v_cvt_pk_bf16_f32 v161, v162, v163
 v_cvt_pk_bf16_f32 v162, v164, v165
 v_cvt_pk_bf16_f32 v163, v166, v167
 v_accvgpr_write_b32 a144, v160
 v_accvgpr_write_b32 a145, v161
 v_accvgpr_write_b32 a146, v162
 v_accvgpr_write_b32 a147, v163
 v_cvt_pk_bf16_f32 v168, v168, v169
 v_cvt_pk_bf16_f32 v169, v170, v171
 v_cvt_pk_bf16_f32 v170, v172, v173
 v_cvt_pk_bf16_f32 v171, v174, v175
 v_accvgpr_write_b32 a148, v168
 v_accvgpr_write_b32 a149, v169
 v_accvgpr_write_b32 a150, v170
 v_accvgpr_write_b32 a151, v171
 v_cvt_pk_bf16_f32 v176, v176, v177
 v_cvt_pk_bf16_f32 v177, v178, v179
 v_cvt_pk_bf16_f32 v178, v180, v181
 v_cvt_pk_bf16_f32 v179, v182, v183
 v_accvgpr_write_b32 a152, v176
 v_accvgpr_write_b32 a153, v177
 v_accvgpr_write_b32 a154, v178
 v_accvgpr_write_b32 a155, v179
 v_cvt_pk_bf16_f32 v184, v184, v185
 v_cvt_pk_bf16_f32 v185, v186, v187
 v_cvt_pk_bf16_f32 v186, v188, v189
 v_cvt_pk_bf16_f32 v187, v190, v191
 v_accvgpr_write_b32 a156, v184
 v_accvgpr_write_b32 a157, v185
 v_accvgpr_write_b32 a158, v186
 v_accvgpr_write_b32 a159, v187
 v_accvgpr_write_b32 a251, v17
 v_cvt_pk_bf16_f32 v192, v192, v193
 v_cvt_pk_bf16_f32 v193, v194, v195
 v_cvt_pk_bf16_f32 v194, v196, v197
 v_cvt_pk_bf16_f32 v195, v198, v199
 v_accvgpr_write_b32 a160, v192
 v_accvgpr_write_b32 a161, v193
 v_accvgpr_write_b32 a162, v194
 v_accvgpr_write_b32 a163, v195
 v_cvt_pk_bf16_f32 v200, v200, v201
 v_cvt_pk_bf16_f32 v201, v202, v203
 v_cvt_pk_bf16_f32 v202, v204, v205
 v_cvt_pk_bf16_f32 v203, v206, v207
 v_accvgpr_write_b32 a164, v200
 v_accvgpr_write_b32 a165, v201
 v_accvgpr_write_b32 a166, v202
 v_accvgpr_write_b32 a167, v203
 v_cvt_pk_bf16_f32 v208, v208, v209
 v_cvt_pk_bf16_f32 v209, v210, v211
 v_cvt_pk_bf16_f32 v210, v212, v213
 v_cvt_pk_bf16_f32 v211, v214, v215
 v_accvgpr_write_b32 a168, v208
 v_accvgpr_write_b32 a169, v209
 v_accvgpr_write_b32 a170, v210
 v_accvgpr_write_b32 a171, v211
 v_cvt_pk_bf16_f32 v216, v216, v217
 v_cvt_pk_bf16_f32 v217, v218, v219
 v_cvt_pk_bf16_f32 v218, v220, v221
 v_cvt_pk_bf16_f32 v219, v222, v223
 v_accvgpr_write_b32 a172, v216
 v_accvgpr_write_b32 a173, v217
 v_accvgpr_write_b32 a174, v218
 v_accvgpr_write_b32 a175, v219
 v_cvt_pk_bf16_f32 v224, v224, v225
 v_cvt_pk_bf16_f32 v225, v226, v227
 v_cvt_pk_bf16_f32 v226, v228, v229
 v_cvt_pk_bf16_f32 v227, v230, v231
 v_accvgpr_write_b32 a176, v224
 v_accvgpr_write_b32 a177, v225
 v_accvgpr_write_b32 a178, v226
 v_accvgpr_write_b32 a179, v227
 v_cvt_pk_bf16_f32 v232, v232, v233
 v_cvt_pk_bf16_f32 v233, v234, v235
 v_cvt_pk_bf16_f32 v234, v236, v237
 v_cvt_pk_bf16_f32 v235, v238, v239
 v_accvgpr_write_b32 a180, v232
 v_accvgpr_write_b32 a181, v233
 v_accvgpr_write_b32 a182, v234
 v_accvgpr_write_b32 a183, v235
 v_cvt_pk_bf16_f32 v240, v240, v241
 v_cvt_pk_bf16_f32 v241, v242, v243
 v_cvt_pk_bf16_f32 v242, v244, v245
 v_cvt_pk_bf16_f32 v243, v246, v247
 v_accvgpr_write_b32 a184, v240
 v_accvgpr_write_b32 a185, v241
 v_accvgpr_write_b32 a186, v242
 v_accvgpr_write_b32 a187, v243
 v_cvt_pk_bf16_f32 v248, v248, v249
 v_cvt_pk_bf16_f32 v249, v250, v251
 v_cvt_pk_bf16_f32 v250, v252, v253
 v_cvt_pk_bf16_f32 v251, v254, v255
 v_accvgpr_write_b32 a188, v248
 v_accvgpr_write_b32 a189, v249
 v_accvgpr_write_b32 a190, v250
 v_accvgpr_write_b32 a191, v251
 v_mov_b64 v[128:129], 0
 v_mov_b64 v[130:131], 0
 v_mov_b64 v[132:133], 0
 v_mov_b64 v[134:135], 0
 v_mov_b64 v[136:137], 0
 v_mov_b64 v[138:139], 0
 v_mov_b64 v[140:141], 0
 v_mov_b64 v[142:143], 0
 v_mov_b64 v[144:145], 0
 v_mov_b64 v[146:147], 0
 v_mov_b64 v[148:149], 0
 v_mov_b64 v[150:151], 0
 v_mov_b64 v[152:153], 0
 v_mov_b64 v[154:155], 0
 v_mov_b64 v[156:157], 0
 v_mov_b64 v[158:159], 0
 v_mov_b64 v[160:161], 0
 v_mov_b64 v[162:163], 0
 v_mov_b64 v[164:165], 0
 v_mov_b64 v[166:167], 0
 v_mov_b64 v[168:169], 0
 v_mov_b64 v[170:171], 0
 v_mov_b64 v[172:173], 0
 v_mov_b64 v[174:175], 0
 v_mov_b64 v[176:177], 0
 v_mov_b64 v[178:179], 0
 v_mov_b64 v[180:181], 0
 v_mov_b64 v[182:183], 0
 v_mov_b64 v[184:185], 0
 v_mov_b64 v[186:187], 0
 v_mov_b64 v[188:189], 0
 v_mov_b64 v[190:191], 0
 v_mov_b64 v[192:193], 0
 v_mov_b64 v[194:195], 0
 v_mov_b64 v[196:197], 0
 v_mov_b64 v[198:199], 0
 v_mov_b64 v[200:201], 0
 v_mov_b64 v[202:203], 0
 v_mov_b64 v[204:205], 0
 v_mov_b64 v[206:207], 0
 v_mov_b64 v[208:209], 0
 v_mov_b64 v[210:211], 0
 v_mov_b64 v[212:213], 0
 v_mov_b64 v[214:215], 0
 v_mov_b64 v[216:217], 0
 v_mov_b64 v[218:219], 0
 v_mov_b64 v[220:221], 0
 v_mov_b64 v[222:223], 0
 v_mov_b64 v[224:225], 0
 v_mov_b64 v[226:227], 0
 v_mov_b64 v[228:229], 0
 v_mov_b64 v[230:231], 0
 v_mov_b64 v[232:233], 0
 v_mov_b64 v[234:235], 0
 v_mov_b64 v[236:237], 0
 v_mov_b64 v[238:239], 0
 v_mov_b64 v[240:241], 0
 v_mov_b64 v[242:243], 0
 v_mov_b64 v[244:245], 0
 v_mov_b64 v[246:247], 0
 v_mov_b64 v[248:249], 0
 v_mov_b64 v[250:251], 0
 v_mov_b64 v[252:253], 0
 v_mov_b64 v[254:255], 0
 v_mov_b32 v7, 0
 v_mov_b32 v8, 0
 v_mov_b32 v9, 0
 v_mov_b32 v10, 0
 s_branch L_first
L_tail:
 s_and_b32 s39, s2, 127
 s_lshl_b32 s57, s39, 2
 s_add_u32 s57, s57, s3
 s_lshl_b32 s55, s57, 14
 s_add_u32 s55, s55, 67108864
 s_lshl_b32 s57, s57, 10
 s_add_u32 s57, s57, 83886080
 v_accvgpr_read_b32 v2, a252
 v_cvt_pk_bf16_f32 v16, v64, v65
 v_cvt_pk_bf16_f32 v17, v66, v67
 v_cvt_pk_bf16_f32 v20, v68, v69
 v_cvt_pk_bf16_f32 v21, v70, v71
 v_cvt_pk_bf16_f32 v18, v72, v73
 v_cvt_pk_bf16_f32 v19, v74, v75
 v_cvt_pk_bf16_f32 v22, v76, v77
 v_cvt_pk_bf16_f32 v23, v78, v79
 v_cvt_pk_bf16_f32 v24, v80, v81
 v_cvt_pk_bf16_f32 v25, v82, v83
 v_cvt_pk_bf16_f32 v28, v84, v85
 v_cvt_pk_bf16_f32 v29, v86, v87
 v_cvt_pk_bf16_f32 v26, v88, v89
 v_cvt_pk_bf16_f32 v27, v90, v91
 v_cvt_pk_bf16_f32 v30, v92, v93
 v_cvt_pk_bf16_f32 v31, v94, v95
 v_add_f32 v7, v7, v5
 v_add_f32 v8, v8, v6
 s_waitcnt vmcnt(0) lgkmcnt(0)
 s_barrier
 ds_read_b128 a[64:67], v3 offset:0
 ds_read_b128 a[68:71], v3 offset:16384
 ds_read_b128 a[72:75], v3 offset:1024
 ds_read_b128 a[76:79], v3 offset:17408
 ds_read_b128 a[80:83], v3 offset:2048
 ds_read_b128 a[84:87], v3 offset:18432
 ds_read_b128 a[88:91], v3 offset:3072
 ds_read_b128 a[92:95], v3 offset:19456
 s_cmp_lg_u32 s38, 0
 s_cselect_b32 s58, s54, 0
 s_cmp_eq_u32 s58, 2
 s_cbranch_scc1 L_tail2
 s_cmp_eq_u32 s62, 0
 s_cbranch_scc1 L_nou
 v_accvgpr_read_b32 v12, a247
 v_cmp_ne_u32 vcc, 0, v12
 s_cbranch_vccz L_poll3_ok
 v_and_b32 v11, 31, v0
 v_lshlrev_b32 v11, 2, v11
 s_mov_b32 s32, 0
L_poll3:
 buffer_load_dword v12, v11, s[12:15], s61 offen sc1
 s_waitcnt vmcnt(0)
 v_cmp_ne_u32 vcc, 0, v12
 s_cbranch_vccz L_poll3_ok
 s_sleep 8
 s_add_u32 s32, s32, 1
 s_cmp_lt_u32 s32, 0x80000
 s_cbranch_scc1 L_poll3
L_poll3_ok:
L_nou:
 s_cmp_eq_u32 s54, 1
 s_cselect_b32 s55, s55, 2.0
 s_cselect_b32 s57, s57, 2.0
 s_cselect_b32 s59, s94, 2.0
 s_add_u32 s56, s55, 0x2000
 s_waitcnt lgkmcnt(0)
 v_mfma_f32_16x16x32_bf16 v[128:131], a[64:67], v[16:19], v[128:131]
 s_add_u32 m0, s29, 0
 ds_read_b128 a[96:99], v3 offset:4096
 v_mov_b32 v72, v7
 v_mfma_f32_16x16x32_bf16 v[128:131], a[68:71], v[24:27], v[128:131]
 buffer_load_dwordx4 v2, s[8:11], s78 offen lds
 v_mfma_f32_16x16x32_bf16 v[192:195], a[68:71], v[28:31], v[192:195]
 ds_read_b128 a[100:103], v3 offset:20480
 v_mov_b32 v73, v8
 v_mfma_f32_16x16x32_bf16 v[192:195], a[64:67], v[20:23], v[192:195]
 v_permlane32_swap_b32 v7, v72
 v_permlane32_swap_b32 v8, v73
 v_mfma_f32_16x16x32_bf16 v[132:135], a[72:75], v[16:19], v[132:135]
 s_add_u32 m0, s29, 4096
 ds_read_b128 a[104:107], v3 offset:5120
 v_mfma_f32_16x16x32_bf16 v[132:135], a[76:79], v[24:27], v[132:135]
 buffer_load_dwordx4 v2, s[8:11], s79 offen lds
 v_mfma_f32_16x16x32_bf16 v[196:199], a[76:79], v[28:31], v[196:199]
 ds_read_b128 a[108:111], v3 offset:21504
 v_add_f32 v7, v7, v72
 v_mfma_f32_16x16x32_bf16 v[196:199], a[72:75], v[20:23], v[196:199]
 v_add_f32 v8, v8, v73
 v_mfma_f32_16x16x32_bf16 v[136:139], a[80:83], v[16:19], v[136:139]
 s_add_u32 m0, s29, 8192
 ds_read_b128 a[112:115], v3 offset:6144
 v_mov_b32 v72, v7
 v_mfma_f32_16x16x32_bf16 v[136:139], a[84:87], v[24:27], v[136:139]
 buffer_load_dwordx4 v2, s[8:11], s80 offen lds
 v_mfma_f32_16x16x32_bf16 v[200:203], a[84:87], v[28:31], v[200:203]
 s_add_u32 m0, s29, 12288
 ds_read_b128 a[116:119], v3 offset:22528
 v_mov_b32 v73, v8
 v_mfma_f32_16x16x32_bf16 v[200:203], a[80:83], v[20:23], v[200:203]
 buffer_load_dwordx4 v2, s[8:11], s81 offen lds
 v_mfma_f32_16x16x32_bf16 v[140:143], a[88:91], v[16:19], v[140:143]
 s_add_u32 m0, s29, 16384
 ds_read_b128 a[120:123], v3 offset:7168
 v_mfma_f32_16x16x32_bf16 v[140:143], a[92:95], v[24:27], v[140:143]
 buffer_load_dwordx4 v2, s[8:11], s82 offen lds
 v_mfma_f32_16x16x32_bf16 v[204:207], a[92:95], v[28:31], v[204:207]
 ds_read_b128 a[124:127], v3 offset:23552
 v_permlane16_swap_b32 v7, v72
 v_mfma_f32_16x16x32_bf16 v[204:207], a[88:91], v[20:23], v[204:207]
 s_waitcnt lgkmcnt(6)
 v_permlane16_swap_b32 v8, v73
 v_cvt_pk_bf16_f32 v128, v128, v129
 v_mfma_f32_16x16x32_bf16 v[144:147], a[96:99], v[16:19], v[144:147]
 s_add_u32 m0, s29, 20480
 ds_read_b128 a[64:67], v3 offset:8192
 v_cvt_pk_bf16_f32 v129, v130, v131
 v_mfma_f32_16x16x32_bf16 v[144:147], a[100:103], v[24:27], v[144:147]
 buffer_load_dwordx4 v2, s[8:11], s83 offen lds
 v_mfma_f32_16x16x32_bf16 v[208:211], a[100:103], v[28:31], v[208:211]
 s_add_u32 m0, s29, 24576
 ds_read_b128 a[68:71], v3 offset:24576
 v_add_f32 v7, v7, v72
 v_mfma_f32_16x16x32_bf16 v[208:211], a[96:99], v[20:23], v[208:211]
 s_waitcnt lgkmcnt(6)
 buffer_load_dwordx4 v2, s[8:11], s84 offen lds
 v_mfma_f32_16x16x32_bf16 v[148:151], a[104:107], v[16:19], v[148:151]
 s_add_u32 m0, s29, 28672
 ds_read_b128 a[72:75], v3 offset:9216
 v_add_f32 v8, v8, v73
 v_mfma_f32_16x16x32_bf16 v[148:151], a[108:111], v[24:27], v[148:151]
 buffer_load_dwordx4 v2, s[8:11], s85 offen lds
 v_mfma_f32_16x16x32_bf16 v[212:215], a[108:111], v[28:31], v[212:215]
 ds_read_b128 a[76:79], v3 offset:25600
 v_add_u32 v2, 128, v2
 v_mfma_f32_16x16x32_bf16 v[212:215], a[104:107], v[20:23], v[212:215]
 s_waitcnt lgkmcnt(6)
 v_cvt_pk_bf16_f32 v130, v132, v133
 v_cvt_pk_bf16_f32 v131, v134, v135
 v_mfma_f32_16x16x32_bf16 v[152:155], a[112:115], v[16:19], v[152:155]
 ds_read_b128 a[80:83], v3 offset:10240
 v_cvt_pk_bf16_f32 v192, v192, v193
 v_mfma_f32_16x16x32_bf16 v[152:155], a[116:119], v[24:27], v[152:155]
 buffer_store_dwordx4 v[128:131], v1, s[12:15], s55 offen offset:0 sc1
 v_mfma_f32_16x16x32_bf16 v[216:219], a[116:119], v[28:31], v[216:219]
 ds_read_b128 a[84:87], v3 offset:26624
 v_cvt_pk_bf16_f32 v193, v194, v195
 v_mfma_f32_16x16x32_bf16 v[216:219], a[112:115], v[20:23], v[216:219]
 s_waitcnt lgkmcnt(6)
 v_cvt_pk_bf16_f32 v194, v196, v197
 v_cvt_pk_bf16_f32 v195, v198, v199
 v_mfma_f32_16x16x32_bf16 v[156:159], a[120:123], v[16:19], v[156:159]
 ds_read_b128 a[88:91], v3 offset:11264
 v_cvt_pk_bf16_f32 v136, v136, v137
 v_mfma_f32_16x16x32_bf16 v[156:159], a[124:127], v[24:27], v[156:159]
 buffer_store_dwordx4 v[192:195], v1, s[12:15], s56 offen offset:0 sc1
 v_mfma_f32_16x16x32_bf16 v[220:223], a[124:127], v[28:31], v[220:223]
 ds_read_b128 a[92:95], v3 offset:27648
 v_cvt_pk_bf16_f32 v137, v138, v139
 v_mfma_f32_16x16x32_bf16 v[220:223], a[120:123], v[20:23], v[220:223]
 s_waitcnt lgkmcnt(6)
 v_cvt_pk_bf16_f32 v138, v140, v141
 v_cvt_pk_bf16_f32 v139, v142, v143
 v_mfma_f32_16x16x32_bf16 v[160:163], a[64:67], v[16:19], v[160:163]
 ds_read_b128 a[96:99], v3 offset:12288
 v_cvt_pk_bf16_f32 v200, v200, v201
 v_mfma_f32_16x16x32_bf16 v[160:163], a[68:71], v[24:27], v[160:163]
 buffer_store_dwordx4 v[136:139], v1, s[12:15], s55 offen offset:1024 sc1
 v_mfma_f32_16x16x32_bf16 v[224:227], a[68:71], v[28:31], v[224:227]
 ds_read_b128 a[100:103], v3 offset:28672
 v_cvt_pk_bf16_f32 v201, v202, v203
 v_mfma_f32_16x16x32_bf16 v[224:227], a[64:67], v[20:23], v[224:227]
 s_waitcnt lgkmcnt(6)
 v_cvt_pk_bf16_f32 v202, v204, v205
 v_cvt_pk_bf16_f32 v203, v206, v207
 v_mfma_f32_16x16x32_bf16 v[164:167], a[72:75], v[16:19], v[164:167]
 ds_read_b128 a[104:107], v3 offset:13312
 v_cvt_pk_bf16_f32 v144, v144, v145
 v_mfma_f32_16x16x32_bf16 v[164:167], a[76:79], v[24:27], v[164:167]
 buffer_store_dwordx4 v[200:203], v1, s[12:15], s56 offen offset:1024 sc1
 v_mfma_f32_16x16x32_bf16 v[228:231], a[76:79], v[28:31], v[228:231]
 ds_read_b128 a[108:111], v3 offset:29696
 v_cvt_pk_bf16_f32 v145, v146, v147
 v_mfma_f32_16x16x32_bf16 v[228:231], a[72:75], v[20:23], v[228:231]
 s_waitcnt lgkmcnt(6)
 v_cvt_pk_bf16_f32 v146, v148, v149
 v_cvt_pk_bf16_f32 v147, v150, v151
 v_mfma_f32_16x16x32_bf16 v[168:171], a[80:83], v[16:19], v[168:171]
 ds_read_b128 a[112:115], v3 offset:14336
 v_cvt_pk_bf16_f32 v208, v208, v209
 v_mfma_f32_16x16x32_bf16 v[168:171], a[84:87], v[24:27], v[168:171]
 buffer_store_dwordx4 v[144:147], v1, s[12:15], s55 offen offset:2048 sc1
 v_mfma_f32_16x16x32_bf16 v[232:235], a[84:87], v[28:31], v[232:235]
 ds_read_b128 a[116:119], v3 offset:30720
 v_cvt_pk_bf16_f32 v209, v210, v211
 v_mfma_f32_16x16x32_bf16 v[232:235], a[80:83], v[20:23], v[232:235]
 s_waitcnt lgkmcnt(6)
 v_cvt_pk_bf16_f32 v210, v212, v213
 v_cvt_pk_bf16_f32 v211, v214, v215
 v_mfma_f32_16x16x32_bf16 v[172:175], a[88:91], v[16:19], v[172:175]
 ds_read_b128 a[120:123], v3 offset:15360
 v_cvt_pk_bf16_f32 v152, v152, v153
 v_mfma_f32_16x16x32_bf16 v[172:175], a[92:95], v[24:27], v[172:175]
 buffer_store_dwordx4 v[208:211], v1, s[12:15], s56 offen offset:2048 sc1
 v_mfma_f32_16x16x32_bf16 v[236:239], a[92:95], v[28:31], v[236:239]
 ds_read_b128 a[124:127], v3 offset:31744
 v_cvt_pk_bf16_f32 v153, v154, v155
 v_mfma_f32_16x16x32_bf16 v[236:239], a[88:91], v[20:23], v[236:239]
 s_waitcnt lgkmcnt(6)
 v_cvt_pk_bf16_f32 v154, v156, v157
 v_cvt_pk_bf16_f32 v155, v158, v159
 v_mfma_f32_16x16x32_bf16 v[176:179], a[96:99], v[16:19], v[176:179]
 v_cvt_pk_bf16_f32 v216, v216, v217
 v_cvt_pk_bf16_f32 v217, v218, v219
 v_mfma_f32_16x16x32_bf16 v[176:179], a[100:103], v[24:27], v[176:179]
 buffer_store_dwordx4 v[152:155], v1, s[12:15], s55 offen offset:3072 sc1
 v_mfma_f32_16x16x32_bf16 v[240:243], a[100:103], v[28:31], v[240:243]
 v_cvt_pk_bf16_f32 v218, v220, v221
 v_cvt_pk_bf16_f32 v219, v222, v223
 v_mfma_f32_16x16x32_bf16 v[240:243], a[96:99], v[20:23], v[240:243]
 s_waitcnt lgkmcnt(4)
 v_cvt_pk_bf16_f32 v160, v160, v161
 v_cvt_pk_bf16_f32 v161, v162, v163
 v_mfma_f32_16x16x32_bf16 v[180:183], a[104:107], v[16:19], v[180:183]
 v_cvt_pk_bf16_f32 v162, v164, v165
 v_cvt_pk_bf16_f32 v163, v166, v167
 v_mfma_f32_16x16x32_bf16 v[180:183], a[108:111], v[24:27], v[180:183]
 buffer_store_dwordx4 v[216:219], v1, s[12:15], s56 offen offset:3072 sc1
 v_mfma_f32_16x16x32_bf16 v[244:247], a[108:111], v[28:31], v[244:247]
 v_cvt_pk_bf16_f32 v224, v224, v225
 v_cvt_pk_bf16_f32 v225, v226, v227
 v_mfma_f32_16x16x32_bf16 v[244:247], a[104:107], v[20:23], v[244:247]
 s_waitcnt lgkmcnt(2)
 v_cvt_pk_bf16_f32 v226, v228, v229
 v_cvt_pk_bf16_f32 v227, v230, v231
 v_mfma_f32_16x16x32_bf16 v[184:187], a[112:115], v[16:19], v[184:187]
 v_cvt_pk_bf16_f32 v168, v168, v169
 v_cvt_pk_bf16_f32 v169, v170, v171
 v_mfma_f32_16x16x32_bf16 v[184:187], a[116:119], v[24:27], v[184:187]
 buffer_store_dwordx4 v[160:163], v4, s[12:15], s55 offen offset:0 sc1
 v_mfma_f32_16x16x32_bf16 v[248:251], a[116:119], v[28:31], v[248:251]
 v_cvt_pk_bf16_f32 v170, v172, v173
 v_cvt_pk_bf16_f32 v171, v174, v175
 v_mfma_f32_16x16x32_bf16 v[248:251], a[112:115], v[20:23], v[248:251]
 s_waitcnt lgkmcnt(0)
 v_cvt_pk_bf16_f32 v232, v232, v233
 v_cvt_pk_bf16_f32 v233, v234, v235
 v_mfma_f32_16x16x32_bf16 v[188:191], a[120:123], v[16:19], v[188:191]
 v_cvt_pk_bf16_f32 v234, v236, v237
 v_cvt_pk_bf16_f32 v235, v238, v239
 v_mfma_f32_16x16x32_bf16 v[188:191], a[124:127], v[24:27], v[188:191]
 buffer_store_dwordx4 v[224:227], v4, s[12:15], s56 offen offset:0 sc1
 v_mfma_f32_16x16x32_bf16 v[252:255], a[124:127], v[28:31], v[252:255]
 v_mfma_f32_16x16x32_bf16 v[252:255], a[120:123], v[20:23], v[252:255]
 v_mov_b32 v68, v7
 v_mov_b32 v69, v8
 v_mov_b32 v70, v9
 v_mov_b32 v71, v10
 v_rcp_f32 v64, v7
 v_rcp_f32 v65, v8
 v_cvt_pk_bf16_f32 v176, v176, v177
 v_cvt_pk_bf16_f32 v177, v178, v179
 v_cvt_pk_bf16_f32 v178, v180, v181
 v_cvt_pk_bf16_f32 v179, v182, v183
 v_cvt_pk_bf16_f32 v240, v240, v241
 v_cvt_pk_bf16_f32 v241, v242, v243
 v_cvt_pk_bf16_f32 v242, v244, v245
 v_cvt_pk_bf16_f32 v243, v246, v247
 v_cvt_pk_bf16_f32 v184, v184, v185
 v_cvt_pk_bf16_f32 v185, v186, v187
 v_cvt_pk_bf16_f32 v186, v188, v189
 v_cvt_pk_bf16_f32 v187, v190, v191
 v_cvt_pk_bf16_f32 v248, v248, v249
 v_cvt_pk_bf16_f32 v249, v250, v251
 v_cvt_pk_bf16_f32 v250, v252, v253
 v_cvt_pk_bf16_f32 v251, v254, v255
 s_waitcnt vmcnt(10)
 s_cmp_lg_u32 s27, 0
 s_cbranch_scc1 L_attdone
 v_mov_b32 v3, v4
 s_cmp_eq_u32 s54, 1
 s_cbranch_scc0 L_t1park
 v_accvgpr_read_b32 v64, a250
 v_accvgpr_read_b32 v65, a251
 s_branch L_opB
L_t1park:
 v_accvgpr_write_b32 a128, v128
 v_accvgpr_write_b32 a129, v129
 v_accvgpr_write_b32 a130, v130
 v_accvgpr_write_b32 a131, v131
 v_accvgpr_write_b32 a160, v192
 v_accvgpr_write_b32 a161, v193
 v_accvgpr_write_b32 a162, v194
 v_accvgpr_write_b32 a163, v195
 v_accvgpr_write_b32 a132, v136
 v_accvgpr_write_b32 a133, v137
 v_accvgpr_write_b32 a134, v138
 v_accvgpr_write_b32 a135, v139
 v_accvgpr_write_b32 a164, v200
 v_accvgpr_write_b32 a165, v201
 v_accvgpr_write_b32 a166, v202
 v_accvgpr_write_b32 a167, v203
 v_accvgpr_write_b32 a136, v144
 v_accvgpr_write_b32 a137, v145
 v_accvgpr_write_b32 a138, v146
 v_accvgpr_write_b32 a139, v147
 v_accvgpr_write_b32 a168, v208
 v_accvgpr_write_b32 a169, v209
 v_accvgpr_write_b32 a170, v210
 v_accvgpr_write_b32 a171, v211
 v_accvgpr_write_b32 a140, v152
 v_accvgpr_write_b32 a141, v153
 v_accvgpr_write_b32 a142, v154
 v_accvgpr_write_b32 a143, v155
 v_accvgpr_write_b32 a172, v216
 v_accvgpr_write_b32 a173, v217
 v_accvgpr_write_b32 a174, v218
 v_accvgpr_write_b32 a175, v219
 v_accvgpr_write_b32 a144, v160
 v_accvgpr_write_b32 a145, v161
 v_accvgpr_write_b32 a146, v162
 v_accvgpr_write_b32 a147, v163
 v_accvgpr_write_b32 a176, v224
 v_accvgpr_write_b32 a177, v225
 v_accvgpr_write_b32 a178, v226
 v_accvgpr_write_b32 a179, v227
 v_accvgpr_write_b32 a148, v168
 v_accvgpr_write_b32 a149, v169
 v_accvgpr_write_b32 a150, v170
 v_accvgpr_write_b32 a151, v171
 v_accvgpr_write_b32 a180, v232
 v_accvgpr_write_b32 a181, v233
 v_accvgpr_write_b32 a182, v234
 v_accvgpr_write_b32 a183, v235
 v_accvgpr_write_b32 a152, v176
 v_accvgpr_write_b32 a153, v177
 v_accvgpr_write_b32 a154, v178
 v_accvgpr_write_b32 a155, v179
 v_accvgpr_write_b32 a184, v240
 v_accvgpr_write_b32 a185, v241
 v_accvgpr_write_b32 a186, v242
 v_accvgpr_write_b32 a187, v243
 v_accvgpr_write_b32 a156, v184
 v_accvgpr_write_b32 a157, v185
 v_accvgpr_write_b32 a158, v186
 v_accvgpr_write_b32 a159, v187
 v_accvgpr_write_b32 a188, v248
 v_accvgpr_write_b32 a189, v249
 v_accvgpr_write_b32 a190, v250
 v_accvgpr_write_b32 a191, v251
 s_branch L_opB
L_tail2:
 v_accvgpr_read_b32 v11, a246
 s_mov_b32 s52, s55
 s_mov_b32 s53, s57
 v_readfirstlane_b32 s58, v11
 s_mov_b32 s59, 2.0
 s_nop 1
 s_cmp_eq_u32 s58, 0
 s_cselect_b32 s55, s55, 2.0
 s_cselect_b32 s57, s57, 2.0
 s_add_u32 s56, s55, 0x2000
 buffer_load_dwordx4 v[68:71], v1, s[12:15], s57 offen sc1
 s_waitcnt lgkmcnt(0)
 v_mfma_f32_16x16x32_bf16 v[128:131], a[64:67], v[16:19], v[128:131]
 ds_read_b128 a[96:99], v3 offset:4096
 v_mfma_f32_16x16x32_bf16 v[128:131], a[68:71], v[24:27], v[128:131]
 buffer_load_dwordx4 v[32:35], v1, s[12:15], s55 offen offset:0 sc1
 v_mfma_f32_16x16x32_bf16 v[192:195], a[68:71], v[28:31], v[192:195]
 ds_read_b128 a[100:103], v3 offset:20480
 v_mfma_f32_16x16x32_bf16 v[192:195], a[64:67], v[20:23], v[192:195]
 v_mov_b32 v72, v7
 v_mov_b32 v73, v8
 v_mfma_f32_16x16x32_bf16 v[132:135], a[72:75], v[16:19], v[132:135]
 ds_read_b128 a[104:107], v3 offset:5120
 v_mfma_f32_16x16x32_bf16 v[132:135], a[76:79], v[24:27], v[132:135]
 buffer_load_dwordx4 v[96:99], v1, s[12:15], s56 offen offset:0 sc1
 v_mfma_f32_16x16x32_bf16 v[196:199], a[76:79], v[28:31], v[196:199]
 ds_read_b128 a[108:111], v3 offset:21504
 v_mfma_f32_16x16x32_bf16 v[196:199], a[72:75], v[20:23], v[196:199]
 v_permlane32_swap_b32 v7, v72
 v_permlane32_swap_b32 v8, v73
 v_mfma_f32_16x16x32_bf16 v[136:139], a[80:83], v[16:19], v[136:139]
 ds_read_b128 a[112:115], v3 offset:6144
 v_mfma_f32_16x16x32_bf16 v[136:139], a[84:87], v[24:27], v[136:139]
 buffer_load_dwordx4 v[36:39], v1, s[12:15], s55 offen offset:1024 sc1
 v_mfma_f32_16x16x32_bf16 v[200:203], a[84:87], v[28:31], v[200:203]
 ds_read_b128 a[116:119], v3 offset:22528
 v_mfma_f32_16x16x32_bf16 v[200:203], a[80:83], v[20:23], v[200:203]
 v_add_f32 v7, v7, v72
 v_add_f32 v8, v8, v73
 v_mfma_f32_16x16x32_bf16 v[140:143], a[88:91], v[16:19], v[140:143]
 ds_read_b128 a[120:123], v3 offset:7168
 v_mfma_f32_16x16x32_bf16 v[140:143], a[92:95], v[24:27], v[140:143]
 buffer_load_dwordx4 v[100:103], v1, s[12:15], s56 offen offset:1024 sc1
 v_mfma_f32_16x16x32_bf16 v[204:207], a[92:95], v[28:31], v[204:207]
 ds_read_b128 a[124:127], v3 offset:23552
 v_mfma_f32_16x16x32_bf16 v[204:207], a[88:91], v[20:23], v[204:207]
 s_waitcnt lgkmcnt(6)
 v_mov_b32 v72, v7
 v_mov_b32 v73, v8
 v_mfma_f32_16x16x32_bf16 v[144:147], a[96:99], v[16:19], v[144:147]
 ds_read_b128 a[64:67], v3 offset:8192
 v_mfma_f32_16x16x32_bf16 v[144:147], a[100:103], v[24:27], v[144:147]
 buffer_load_dwordx4 v[40:43], v1, s[12:15], s55 offen offset:2048 sc1
 v_mfma_f32_16x16x32_bf16 v[208:211], a[100:103], v[28:31], v[208:211]
 ds_read_b128 a[68:71], v3 offset:24576
 v_mfma_f32_16x16x32_bf16 v[208:211], a[96:99], v[20:23], v[208:211]
 s_waitcnt lgkmcnt(6)
 v_permlane16_swap_b32 v7, v72
 v_permlane16_swap_b32 v8, v73
 v_mfma_f32_16x16x32_bf16 v[148:151], a[104:107], v[16:19], v[148:151]
 ds_read_b128 a[72:75], v3 offset:9216
 v_mfma_f32_16x16x32_bf16 v[148:151], a[108:111], v[24:27], v[148:151]
 buffer_load_dwordx4 v[104:107], v1, s[12:15], s56 offen offset:2048 sc1
 v_mfma_f32_16x16x32_bf16 v[212:215], a[108:111], v[28:31], v[212:215]
 ds_read_b128 a[76:79], v3 offset:25600
 v_mfma_f32_16x16x32_bf16 v[212:215], a[104:107], v[20:23], v[212:215]
 s_waitcnt lgkmcnt(6)
 v_add_f32 v7, v7, v72
 v_add_f32 v8, v8, v73
 v_mfma_f32_16x16x32_bf16 v[152:155], a[112:115], v[16:19], v[152:155]
 ds_read_b128 a[80:83], v3 offset:10240
 v_mfma_f32_16x16x32_bf16 v[152:155], a[116:119], v[24:27], v[152:155]
 buffer_load_dwordx4 v[44:47], v1, s[12:15], s55 offen offset:3072 sc1
 v_mfma_f32_16x16x32_bf16 v[216:219], a[116:119], v[28:31], v[216:219]
 ds_read_b128 a[84:87], v3 offset:26624
 v_mfma_f32_16x16x32_bf16 v[216:219], a[112:115], v[20:23], v[216:219]
 s_waitcnt lgkmcnt(6)
 v_mov_b32 v76, 0
 v_mov_b32 v77, 0
 v_mfma_f32_16x16x32_bf16 v[156:159], a[120:123], v[16:19], v[156:159]
 ds_read_b128 a[88:91], v3 offset:11264
 v_mov_b32 v80, 0
 v_mfma_f32_16x16x32_bf16 v[156:159], a[124:127], v[24:27], v[156:159]
 buffer_load_dwordx4 v[108:111], v1, s[12:15], s56 offen offset:3072 sc1
 v_mfma_f32_16x16x32_bf16 v[220:223], a[124:127], v[28:31], v[220:223]
 ds_read_b128 a[92:95], v3 offset:27648
 v_mov_b32 v81, 0
 v_mfma_f32_16x16x32_bf16 v[220:223], a[120:123], v[20:23], v[220:223]
 s_waitcnt lgkmcnt(6)
 v_and_b32 v82, 1, v0
 v_lshlrev_b32 v82, 4, v82
 v_mfma_f32_16x16x32_bf16 v[160:163], a[64:67], v[16:19], v[160:163]
 ds_read_b128 a[96:99], v3 offset:12288
 v_mov_b32 v83, 0x3f80
 v_mfma_f32_16x16x32_bf16 v[160:163], a[68:71], v[24:27], v[160:163]
 buffer_load_dwordx4 v[48:51], v4, s[12:15], s55 offen offset:0 sc1
 v_mfma_f32_16x16x32_bf16 v[224:227], a[68:71], v[28:31], v[224:227]
 ds_read_b128 a[100:103], v3 offset:28672
 v_lshlrev_b32 v82, v82, v83
 v_mfma_f32_16x16x32_bf16 v[224:227], a[64:67], v[20:23], v[224:227]
 s_waitcnt lgkmcnt(6)
 v_bfe_u32 v83, v0, 1, 3
 v_lshrrev_b32 v84, 4, v0
 v_mfma_f32_16x16x32_bf16 v[164:167], a[72:75], v[16:19], v[164:167]
 ds_read_b128 a[104:107], v3 offset:13312
 v_lshlrev_b32 v84, 1, v84
 v_mfma_f32_16x16x32_bf16 v[164:167], a[76:79], v[24:27], v[164:167]
 buffer_load_dwordx4 v[112:115], v4, s[12:15], s56 offen offset:0 sc1
 v_mfma_f32_16x16x32_bf16 v[228:231], a[76:79], v[28:31], v[228:231]
 ds_read_b128 a[108:111], v3 offset:29696
 v_sub_u32 v83, v83, v84
 v_mfma_f32_16x16x32_bf16 v[228:231], a[72:75], v[20:23], v[228:231]
 s_waitcnt lgkmcnt(6)
 v_cmp_eq_u32 s[20:21], 0, v83
 v_cmp_eq_u32 s[22:23], 1, v83
 v_mfma_f32_16x16x32_bf16 v[168:171], a[80:83], v[16:19], v[168:171]
 ds_read_b128 a[112:115], v3 offset:14336
 v_mfma_f32_16x16x32_bf16 v[168:171], a[84:87], v[24:27], v[168:171]
 buffer_load_dwordx4 v[52:55], v4, s[12:15], s55 offen offset:1024 sc1
 v_mfma_f32_16x16x32_bf16 v[232:235], a[84:87], v[28:31], v[232:235]
 ds_read_b128 a[116:119], v3 offset:30720
 v_cndmask_b32 v78, 0, v82, s[20:21]
 v_mfma_f32_16x16x32_bf16 v[232:235], a[80:83], v[20:23], v[232:235]
 s_waitcnt lgkmcnt(6)
 v_mfma_f32_16x16x32_bf16 v[172:175], a[88:91], v[16:19], v[172:175]
 ds_read_b128 a[120:123], v3 offset:15360
 v_cndmask_b32 v79, 0, v82, s[22:23]
 v_mfma_f32_16x16x32_bf16 v[172:175], a[92:95], v[24:27], v[172:175]
 buffer_load_dwordx4 v[116:119], v4, s[12:15], s56 offen offset:1024 sc1
 v_mfma_f32_16x16x32_bf16 v[236:239], a[92:95], v[28:31], v[236:239]
 ds_read_b128 a[124:127], v3 offset:31744
 v_mfma_f32_16x16x32_bf16 v[236:239], a[88:91], v[20:23], v[236:239]
 s_waitcnt lgkmcnt(6)
 v_mfma_f32_16x16x32_bf16 v[176:179], a[96:99], v[16:19], v[176:179]
 v_mfma_f32_16x16x32_bf16 v[176:179], a[100:103], v[24:27], v[176:179]
 buffer_load_dwordx4 v[56:59], v4, s[12:15], s55 offen offset:2048 sc1
 v_mfma_f32_16x16x32_bf16 v[240:243], a[100:103], v[28:31], v[240:243]
 v_mfma_f32_16x16x32_bf16 v[240:243], a[96:99], v[20:23], v[240:243]
 s_waitcnt lgkmcnt(4)
 v_mfma_f32_16x16x32_bf16 v[180:183], a[104:107], v[16:19], v[180:183]
 v_mfma_f32_16x16x32_bf16 v[180:183], a[108:111], v[24:27], v[180:183]
 buffer_load_dwordx4 v[120:123], v4, s[12:15], s56 offen offset:2048 sc1
 v_mfma_f32_16x16x32_bf16 v[244:247], a[108:111], v[28:31], v[244:247]
 v_mfma_f32_16x16x32_bf16 v[244:247], a[104:107], v[20:23], v[244:247]
 s_waitcnt lgkmcnt(2)
 v_mfma_f32_16x16x32_bf16 v[184:187], a[112:115], v[16:19], v[184:187]
 v_mfma_f32_16x16x32_bf16 v[184:187], a[116:119], v[24:27], v[184:187]
 buffer_load_dwordx4 v[60:63], v4, s[12:15], s55 offen offset:3072 sc1
 v_mfma_f32_16x16x32_bf16 v[248:251], a[116:119], v[28:31], v[248:251]
 v_mfma_f32_16x16x32_bf16 v[248:251], a[112:115], v[20:23], v[248:251]
 s_waitcnt lgkmcnt(0)
 v_mfma_f32_16x16x32_bf16 v[188:191], a[120:123], v[16:19], v[188:191]
 v_mfma_f32_16x16x32_bf16 v[188:191], a[124:127], v[24:27], v[188:191]
 v_mfma_f32_16x16x32_bf16 v[252:255], a[124:127], v[28:31], v[252:255]
 v_mfma_f32_16x16x32_bf16 v[252:255], a[120:123], v[20:23], v[252:255]
 buffer_load_dwordx4 v[124:127], v4, s[12:15], s56 offen offset:3072 sc1
 s_cmp_eq_u32 s58, 0
 s_cbranch_scc1 L_merge2
 v_and_b32 v11, 0, v0
 v_lshlrev_b32 v11, 2, v11
 s_mov_b32 s32, 0
L_poll4:
 buffer_load_dword v12, v11, s[12:15], s94 offen sc1
 s_waitcnt vmcnt(0)
 v_cmp_ne_u32 vcc, 0, v12
 s_cbranch_vccz L_poll4_ok
 s_sleep 8
 s_add_u32 s32, s32, 1
 s_cmp_lt_u32 s32, 0x80000
 s_cbranch_scc1 L_poll4
L_poll4_ok:
 s_mov_b32 s55, s52
 s_mov_b32 s57, s53
 s_add_u32 s56, s55, 0x2000
 buffer_load_dwordx4 v[68:71], v1, s[12:15], s57 offen sc1
 buffer_load_dwordx4 v[32:35], v1, s[12:15], s55 offen offset:0 sc1
 buffer_load_dwordx4 v[96:99], v1, s[12:15], s56 offen offset:0 sc1
 buffer_load_dwordx4 v[36:39], v1, s[12:15], s55 offen offset:1024 sc1
 buffer_load_dwordx4 v[100:103], v1, s[12:15], s56 offen offset:1024 sc1
 buffer_load_dwordx4 v[40:43], v1, s[12:15], s55 offen offset:2048 sc1
 buffer_load_dwordx4 v[104:107], v1, s[12:15], s56 offen offset:2048 sc1
 buffer_load_dwordx4 v[44:47], v1, s[12:15], s55 offen offset:3072 sc1
 buffer_load_dwordx4 v[108:111], v1, s[12:15], s56 offen offset:3072 sc1
 buffer_load_dwordx4 v[48:51], v4, s[12:15], s55 offen offset:0 sc1
 buffer_load_dwordx4 v[112:115], v4, s[12:15], s56 offen offset:0 sc1
 buffer_load_dwordx4 v[52:55], v4, s[12:15], s55 offen offset:1024 sc1
 buffer_load_dwordx4 v[116:119], v4, s[12:15], s56 offen offset:1024 sc1
 buffer_load_dwordx4 v[56:59], v4, s[12:15], s55 offen offset:2048 sc1
 buffer_load_dwordx4 v[120:123], v4, s[12:15], s56 offen offset:2048 sc1
 buffer_load_dwordx4 v[60:63], v4, s[12:15], s55 offen offset:3072 sc1
 buffer_load_dwordx4 v[124:127], v4, s[12:15], s56 offen offset:3072 sc1
L_merge2:
 s_waitcnt vmcnt(14)
 v_cmp_neq_f32 vcc, v70, v9
 v_cmp_neq_f32 s[20:21], v71, v10
 s_or_b64 vcc, vcc, s[20:21]
 s_cbranch_vccnz L_mslow
 v_mfma_f32_16x16x32_bf16 v[128:131], v[78:81], v[32:35], v[128:131]
 s_add_u32 m0, s29, 0
 v_add_f32 v7, v7, v68
 v_add_f32 v8, v8, v69
 v_mfma_f32_16x16x32_bf16 v[132:135], v[76:79], v[32:35], v[132:135]
 buffer_load_dwordx4 v2, s[8:11], s78 offen lds
 v_mfma_f32_16x16x32_bf16 v[192:195], v[78:81], v[96:99], v[192:195]
 v_rcp_f32 v64, v7
 v_mfma_f32_16x16x32_bf16 v[196:199], v[76:79], v[96:99], v[196:199]
 s_waitcnt vmcnt(13)
 v_rcp_f32 v65, v8
 v_mfma_f32_16x16x32_bf16 v[136:139], v[78:81], v[36:39], v[136:139]
 s_add_u32 m0, s29, 4096
 v_mfma_f32_16x16x32_bf16 v[140:143], v[76:79], v[36:39], v[140:143]
 buffer_load_dwordx4 v2, s[8:11], s79 offen lds
 v_mfma_f32_16x16x32_bf16 v[200:203], v[78:81], v[100:103], v[200:203]
 v_cvt_pk_bf16_f32 v128, v128, v129
 v_cvt_pk_bf16_f32 v129, v130, v131
 v_mfma_f32_16x16x32_bf16 v[204:207], v[76:79], v[100:103], v[204:207]
 s_waitcnt vmcnt(12)
 v_cvt_pk_bf16_f32 v130, v132, v133
 v_cvt_pk_bf16_f32 v131, v134, v135
 v_mfma_f32_16x16x32_bf16 v[144:147], v[78:81], v[40:43], v[144:147]
 s_add_u32 m0, s29, 8192
 v_cvt_pk_bf16_f32 v192, v192, v193
 v_cvt_pk_bf16_f32 v193, v194, v195
 v_mfma_f32_16x16x32_bf16 v[148:151], v[76:79], v[40:43], v[148:151]
 buffer_load_dwordx4 v2, s[8:11], s80 offen lds
 v_mfma_f32_16x16x32_bf16 v[208:211], v[78:81], v[104:107], v[208:211]
 v_cvt_pk_bf16_f32 v194, v196, v197
 v_cvt_pk_bf16_f32 v195, v198, v199
 v_mfma_f32_16x16x32_bf16 v[212:215], v[76:79], v[104:107], v[212:215]
 s_waitcnt vmcnt(11)
 v_cvt_pk_bf16_f32 v136, v136, v137
 v_cvt_pk_bf16_f32 v137, v138, v139
 v_mfma_f32_16x16x32_bf16 v[152:155], v[78:81], v[44:47], v[152:155]
 s_add_u32 m0, s29, 12288
 v_cvt_pk_bf16_f32 v138, v140, v141
 v_cvt_pk_bf16_f32 v139, v142, v143
 v_mfma_f32_16x16x32_bf16 v[156:159], v[76:79], v[44:47], v[156:159]
 buffer_load_dwordx4 v2, s[8:11], s81 offen lds
 v_mfma_f32_16x16x32_bf16 v[216:219], v[78:81], v[108:111], v[216:219]
 v_cvt_pk_bf16_f32 v200, v200, v201
 v_cvt_pk_bf16_f32 v201, v202, v203
 v_mfma_f32_16x16x32_bf16 v[220:223], v[76:79], v[108:111], v[220:223]
 s_waitcnt vmcnt(10)
 v_cvt_pk_bf16_f32 v202, v204, v205
 v_cvt_pk_bf16_f32 v203, v206, v207
 v_mfma_f32_16x16x32_bf16 v[160:163], v[78:81], v[48:51], v[160:163]
 s_add_u32 m0, s29, 16384
 v_cvt_pk_bf16_f32 v144, v144, v145
 v_cvt_pk_bf16_f32 v145, v146, v147
 v_mfma_f32_16x16x32_bf16 v[164:167], v[76:79], v[48:51], v[164:167]
 buffer_load_dwordx4 v2, s[8:11], s82 offen lds
 v_mfma_f32_16x16x32_bf16 v[224:227], v[78:81], v[112:115], v[224:227]
 v_cvt_pk_bf16_f32 v146, v148, v149
 v_cvt_pk_bf16_f32 v147, v150, v151
 v_mfma_f32_16x16x32_bf16 v[228:231], v[76:79], v[112:115], v[228:231]
 s_waitcnt vmcnt(9)
 v_cvt_pk_bf16_f32 v208, v208, v209
 v_cvt_pk_bf16_f32 v209, v210, v211
 v_mfma_f32_16x16x32_bf16 v[168:171], v[78:81], v[52:55], v[168:171]
 s_add_u32 m0, s29, 20480
 v_cvt_pk_bf16_f32 v210, v212, v213
 v_cvt_pk_bf16_f32 v211, v214, v215
 v_mfma_f32_16x16x32_bf16 v[172:175], v[76:79], v[52:55], v[172:175]
 buffer_load_dwordx4 v2, s[8:11], s83 offen lds
 v_mfma_f32_16x16x32_bf16 v[232:235], v[78:81], v[116:119], v[232:235]
 v_cvt_pk_bf16_f32 v152, v152, v153
 v_cvt_pk_bf16_f32 v153, v154, v155
 v_mfma_f32_16x16x32_bf16 v[236:239], v[76:79], v[116:119], v[236:239]
 s_waitcnt vmcnt(8)
 v_cvt_pk_bf16_f32 v154, v156, v157
 v_cvt_pk_bf16_f32 v155, v158, v159
 v_mfma_f32_16x16x32_bf16 v[176:179], v[78:81], v[56:59], v[176:179]
 s_add_u32 m0, s29, 24576
 v_cvt_pk_bf16_f32 v216, v216, v217
 v_cvt_pk_bf16_f32 v217, v218, v219
 v_mfma_f32_16x16x32_bf16 v[180:183], v[76:79], v[56:59], v[180:183]
 buffer_load_dwordx4 v2, s[8:11], s84 offen lds
 v_mfma_f32_16x16x32_bf16 v[240:243], v[78:81], v[120:123], v[240:243]
 v_cvt_pk_bf16_f32 v218, v220, v221
 v_cvt_pk_bf16_f32 v219, v222, v223
 v_mfma_f32_16x16x32_bf16 v[244:247], v[76:79], v[120:123], v[244:247]
 s_waitcnt vmcnt(7)
 v_cvt_pk_bf16_f32 v160, v160, v161
 v_cvt_pk_bf16_f32 v161, v162, v163
 v_mfma_f32_16x16x32_bf16 v[184:187], v[78:81], v[60:63], v[184:187]
 s_add_u32 m0, s29, 28672
 v_cvt_pk_bf16_f32 v162, v164, v165
 v_cvt_pk_bf16_f32 v163, v166, v167
 v_mfma_f32_16x16x32_bf16 v[188:191], v[76:79], v[60:63], v[188:191]
 buffer_load_dwordx4 v2, s[8:11], s85 offen lds
 v_mfma_f32_16x16x32_bf16 v[248:251], v[78:81], v[124:127], v[248:251]
 v_cvt_pk_bf16_f32 v224, v224, v225
 v_cvt_pk_bf16_f32 v225, v226, v227
 v_mfma_f32_16x16x32_bf16 v[252:255], v[76:79], v[124:127], v[252:255]
 v_cvt_pk_bf16_f32 v226, v228, v229
 v_cvt_pk_bf16_f32 v227, v230, v231
 v_add_u32 v2, 128, v2
 v_cvt_pk_bf16_f32 v168, v168, v169
 v_cvt_pk_bf16_f32 v169, v170, v171
 v_cvt_pk_bf16_f32 v170, v172, v173
 v_cvt_pk_bf16_f32 v171, v174, v175
 v_cvt_pk_bf16_f32 v232, v232, v233
 v_cvt_pk_bf16_f32 v233, v234, v235
 v_cvt_pk_bf16_f32 v234, v236, v237
 v_cvt_pk_bf16_f32 v235, v238, v239
 v_cvt_pk_bf16_f32 v176, v176, v177
 v_cvt_pk_bf16_f32 v177, v178, v179
 v_cvt_pk_bf16_f32 v178, v180, v181
 v_cvt_pk_bf16_f32 v179, v182, v183
 v_cvt_pk_bf16_f32 v240, v240, v241
 v_cvt_pk_bf16_f32 v241, v242, v243
 v_cvt_pk_bf16_f32 v242, v244, v245
 v_cvt_pk_bf16_f32 v243, v246, v247
 v_cvt_pk_bf16_f32 v184, v184, v185
 v_cvt_pk_bf16_f32 v185, v186, v187
 v_cvt_pk_bf16_f32 v186, v188, v189
 v_cvt_pk_bf16_f32 v187, v190, v191
 v_cvt_pk_bf16_f32 v248, v248, v249
 v_cvt_pk_bf16_f32 v249, v250, v251
 v_cvt_pk_bf16_f32 v250, v252, v253
 v_cvt_pk_bf16_f32 v251, v254, v255
 s_waitcnt vmcnt(0)
 s_branch L_attdone
L_mslow:
 s_add_u32 m0, s29, 0
 s_nop 0
 buffer_load_dwordx4 v2, s[8:11], s78 offen lds
 s_add_u32 m0, s29, 4096
 s_nop 0
 buffer_load_dwordx4 v2, s[8:11], s79 offen lds
 s_add_u32 m0, s29, 8192
 s_nop 0
 buffer_load_dwordx4 v2, s[8:11], s80 offen lds
 s_add_u32 m0, s29, 12288
 s_nop 0
 buffer_load_dwordx4 v2, s[8:11], s81 offen lds
 s_add_u32 m0, s29, 16384
 s_nop 0
 buffer_load_dwordx4 v2, s[8:11], s82 offen lds
 s_add_u32 m0, s29, 20480
 s_nop 0
 buffer_load_dwordx4 v2, s[8:11], s83 offen lds
 s_add_u32 m0, s29, 24576
 s_nop 0
 buffer_load_dwordx4 v2, s[8:11], s84 offen lds
 s_add_u32 m0, s29, 28672
 s_nop 0
 buffer_load_dwordx4 v2, s[8:11], s85 offen lds
 v_add_u32 v2, 128, v2
 s_mov_b32 s58, 0xffff0000
 s_waitcnt vmcnt(0)
 v_min_f32 v20, v70, v9
 v_sub_f32 v21, v20, v9
 v_sub_f32 v22, v20, v70
 v_exp_f32 v16, v21
 v_exp_f32 v18, v22
 s_nop 0
 v_mul_f32 v7, v7, v16
 v_fmac_f32 v7, v68, v18
 v_rcp_f32 v64, v7
 v_min_f32 v20, v71, v10
 v_sub_f32 v21, v20, v10
 v_sub_f32 v22, v20, v71
 v_exp_f32 v17, v21
 v_exp_f32 v19, v22
 s_nop 0
 v_mul_f32 v8, v8, v17
 v_fmac_f32 v8, v69, v19
 v_rcp_f32 v65, v8
 v_lshlrev_b32 v24, 16, v32
 v_and_b32 v25, s58, v32
 v_pk_mul_f32 v[24:25], v[24:25], v[18:19] op_sel:[0,0] op_sel_hi:[1,0]
 v_pk_fma_f32 v[128:129], v[128:129], v[16:17], v[24:25] op_sel:[0,0,0] op_sel_hi:[1,0,1]
 v_lshlrev_b32 v26, 16, v33
 v_and_b32 v27, s58, v33
 v_pk_mul_f32 v[26:27], v[26:27], v[18:19] op_sel:[0,0] op_sel_hi:[1,0]
 v_pk_fma_f32 v[130:131], v[130:131], v[16:17], v[26:27] op_sel:[0,0,0] op_sel_hi:[1,0,1]
 v_lshlrev_b32 v28, 16, v34
 v_and_b32 v29, s58, v34
 v_pk_mul_f32 v[28:29], v[28:29], v[18:19] op_sel:[0,0] op_sel_hi:[1,0]
 v_pk_fma_f32 v[132:133], v[132:133], v[16:17], v[28:29] op_sel:[0,0,0] op_sel_hi:[1,0,1]
 v_lshlrev_b32 v30, 16, v35
 v_and_b32 v31, s58, v35
 v_pk_mul_f32 v[30:31], v[30:31], v[18:19] op_sel:[0,0] op_sel_hi:[1,0]
 v_pk_fma_f32 v[134:135], v[134:135], v[16:17], v[30:31] op_sel:[0,0,0] op_sel_hi:[1,0,1]
 v_cvt_pk_bf16_f32 v128, v128, v129
 v_cvt_pk_bf16_f32 v129, v130, v131
 v_cvt_pk_bf16_f32 v130, v132, v133
 v_cvt_pk_bf16_f32 v131, v134, v135
 v_lshlrev_b32 v24, 16, v36
 v_and_b32 v25, s58, v36
 v_pk_mul_f32 v[24:25], v[24:25], v[18:19] op_sel:[0,0] op_sel_hi:[1,0]
 v_pk_fma_f32 v[136:137], v[136:137], v[16:17], v[24:25] op_sel:[0,0,0] op_sel_hi:[1,0,1]
 v_lshlrev_b32 v26, 16, v37
 v_and_b32 v27, s58, v37
 v_pk_mul_f32 v[26:27], v[26:27], v[18:19] op_sel:[0,0] op_sel_hi:[1,0]
 v_pk_fma_f32 v[138:139], v[138:139], v[16:17], v[26:27] op_sel:[0,0,0] op_sel_hi:[1,0,1]
 v_lshlrev_b32 v28, 16, v38
 v_and_b32 v29, s58, v38
 v_pk_mul_f32 v[28:29], v[28:29], v[18:19] op_sel:[0,0] op_sel_hi:[1,0]
 v_pk_fma_f32 v[140:141], v[140:141], v[16:17], v[28:29] op_sel:[0,0,0] op_sel_hi:[1,0,1]
 v_lshlrev_b32 v30, 16, v39
 v_and_b32 v31, s58, v39
 v_pk_mul_f32 v[30:31], v[30:31], v[18:19] op_sel:[0,0] op_sel_hi:[1,0]
 v_pk_fma_f32 v[142:143], v[142:143], v[16:17], v[30:31] op_sel:[0,0,0] op_sel_hi:[1,0,1]
 v_cvt_pk_bf16_f32 v136, v136, v137
 v_cvt_pk_bf16_f32 v137, v138, v139
 v_cvt_pk_bf16_f32 v138, v140, v141
 v_cvt_pk_bf16_f32 v139, v142, v143
 v_lshlrev_b32 v24, 16, v40
 v_and_b32 v25, s58, v40
 v_pk_mul_f32 v[24:25], v[24:25], v[18:19] op_sel:[0,0] op_sel_hi:[1,0]
 v_pk_fma_f32 v[144:145], v[144:145], v[16:17], v[24:25] op_sel:[0,0,0] op_sel_hi:[1,0,1]
 v_lshlrev_b32 v26, 16, v41
 v_and_b32 v27, s58, v41
 v_pk_mul_f32 v[26:27], v[26:27], v[18:19] op_sel:[0,0] op_sel_hi:[1,0]
 v_pk_fma_f32 v[146:147], v[146:147], v[16:17], v[26:27] op_sel:[0,0,0] op_sel_hi:[1,0,1]
 v_lshlrev_b32 v28, 16, v42
 v_and_b32 v29, s58, v42
 v_pk_mul_f32 v[28:29], v[28:29], v[18:19] op_sel:[0,0] op_sel_hi:[1,0]
 v_pk_fma_f32 v[148:149], v[148:149], v[16:17], v[28:29] op_sel:[0,0,0] op_sel_hi:[1,0,1]
 v_lshlrev_b32 v30, 16, v43
 v_and_b32 v31, s58, v43
 v_pk_mul_f32 v[30:31], v[30:31], v[18:19] op_sel:[0,0] op_sel_hi:[1,0]
 v_pk_fma_f32 v[150:151], v[150:151], v[16:17], v[30:31] op_sel:[0,0,0] op_sel_hi:[1,0,1]
 v_cvt_pk_bf16_f32 v144, v144, v145
 v_cvt_pk_bf16_f32 v145, v146, v147
 v_cvt_pk_bf16_f32 v146, v148, v149
 v_cvt_pk_bf16_f32 v147, v150, v151
 v_lshlrev_b32 v24, 16, v44
 v_and_b32 v25, s58, v44
 v_pk_mul_f32 v[24:25], v[24:25], v[18:19] op_sel:[0,0] op_sel_hi:[1,0]
 v_pk_fma_f32 v[152:153], v[152:153], v[16:17], v[24:25] op_sel:[0,0,0] op_sel_hi:[1,0,1]
 v_lshlrev_b32 v26, 16, v45
 v_and_b32 v27, s58, v45
 v_pk_mul_f32 v[26:27], v[26:27], v[18:19] op_sel:[0,0] op_sel_hi:[1,0]
 v_pk_fma_f32 v[154:155], v[154:155], v[16:17], v[26:27] op_sel:[0,0,0] op_sel_hi:[1,0,1]
 v_lshlrev_b32 v28, 16, v46
 v_and_b32 v29, s58, v46
 v_pk_mul_f32 v[28:29], v[28:29], v[18:19] op_sel:[0,0] op_sel_hi:[1,0]
 v_pk_fma_f32 v[156:157], v[156:157], v[16:17], v[28:29] op_sel:[0,0,0] op_sel_hi:[1,0,1]
 v_lshlrev_b32 v30, 16, v47
 v_and_b32 v31, s58, v47
 v_pk_mul_f32 v[30:31], v[30:31], v[18:19] op_sel:[0,0] op_sel_hi:[1,0]
 v_pk_fma_f32 v[158:159], v[158:159], v[16:17], v[30:31] op_sel:[0,0,0] op_sel_hi:[1,0,1]
 v_cvt_pk_bf16_f32 v152, v152, v153
 v_cvt_pk_bf16_f32 v153, v154, v155
 v_cvt_pk_bf16_f32 v154, v156, v157
 v_cvt_pk_bf16_f32 v155, v158, v159
 v_lshlrev_b32 v24, 16, v48
 v_and_b32 v25, s58, v48
 v_pk_mul_f32 v[24:25], v[24:25], v[18:19] op_sel:[0,0] op_sel_hi:[1,0]
 v_pk_fma_f32 v[160:161], v[160:161], v[16:17], v[24:25] op_sel:[0,0,0] op_sel_hi:[1,0,1]
 v_lshlrev_b32 v26, 16, v49
 v_and_b32 v27, s58, v49
 v_pk_mul_f32 v[26:27], v[26:27], v[18:19] op_sel:[0,0] op_sel_hi:[1,0]
 v_pk_fma_f32 v[162:163], v[162:163], v[16:17], v[26:27] op_sel:[0,0,0] op_sel_hi:[1,0,1]
 v_lshlrev_b32 v28, 16, v50
 v_and_b32 v29, s58, v50
 v_pk_mul_f32 v[28:29], v[28:29], v[18:19] op_sel:[0,0] op_sel_hi:[1,0]
 v_pk_fma_f32 v[164:165], v[164:165], v[16:17], v[28:29] op_sel:[0,0,0] op_sel_hi:[1,0,1]
 v_lshlrev_b32 v30, 16, v51
 v_and_b32 v31, s58, v51
 v_pk_mul_f32 v[30:31], v[30:31], v[18:19] op_sel:[0,0] op_sel_hi:[1,0]
 v_pk_fma_f32 v[166:167], v[166:167], v[16:17], v[30:31] op_sel:[0,0,0] op_sel_hi:[1,0,1]
 v_cvt_pk_bf16_f32 v160, v160, v161
 v_cvt_pk_bf16_f32 v161, v162, v163
 v_cvt_pk_bf16_f32 v162, v164, v165
 v_cvt_pk_bf16_f32 v163, v166, v167
 v_lshlrev_b32 v24, 16, v52
 v_and_b32 v25, s58, v52
 v_pk_mul_f32 v[24:25], v[24:25], v[18:19] op_sel:[0,0] op_sel_hi:[1,0]
 v_pk_fma_f32 v[168:169], v[168:169], v[16:17], v[24:25] op_sel:[0,0,0] op_sel_hi:[1,0,1]
 v_lshlrev_b32 v26, 16, v53
 v_and_b32 v27, s58, v53
 v_pk_mul_f32 v[26:27], v[26:27], v[18:19] op_sel:[0,0] op_sel_hi:[1,0]
 v_pk_fma_f32 v[170:171], v[170:171], v[16:17], v[26:27] op_sel:[0,0,0] op_sel_hi:[1,0,1]
 v_lshlrev_b32 v28, 16, v54
 v_and_b32 v29, s58, v54
 v_pk_mul_f32 v[28:29], v[28:29], v[18:19] op_sel:[0,0] op_sel_hi:[1,0]
 v_pk_fma_f32 v[172:173], v[172:173], v[16:17], v[28:29] op_sel:[0,0,0] op_sel_hi:[1,0,1]
 v_lshlrev_b32 v30, 16, v55
 v_and_b32 v31, s58, v55
 v_pk_mul_f32 v[30:31], v[30:31], v[18:19] op_sel:[0,0] op_sel_hi:[1,0]
 v_pk_fma_f32 v[174:175], v[174:175], v[16:17], v[30:31] op_sel:[0,0,0] op_sel_hi:[1,0,1]
 v_cvt_pk_bf16_f32 v168, v168, v169
 v_cvt_pk_bf16_f32 v169, v170, v171
 v_cvt_pk_bf16_f32 v170, v172, v173
 v_cvt_pk_bf16_f32 v171, v174, v175
 v_lshlrev_b32 v24, 16, v56
 v_and_b32 v25, s58, v56
 v_pk_mul_f32 v[24:25], v[24:25], v[18:19] op_sel:[0,0] op_sel_hi:[1,0]
 v_pk_fma_f32 v[176:177], v[176:177], v[16:17], v[24:25] op_sel:[0,0,0] op_sel_hi:[1,0,1]
 v_lshlrev_b32 v26, 16, v57
 v_and_b32 v27, s58, v57
 v_pk_mul_f32 v[26:27], v[26:27], v[18:19] op_sel:[0,0] op_sel_hi:[1,0]
 v_pk_fma_f32 v[178:179], v[178:179], v[16:17], v[26:27] op_sel:[0,0,0] op_sel_hi:[1,0,1]
 v_lshlrev_b32 v28, 16, v58
 v_and_b32 v29, s58, v58
 v_pk_mul_f32 v[28:29], v[28:29], v[18:19] op_sel:[0,0] op_sel_hi:[1,0]
 v_pk_fma_f32 v[180:181], v[180:181], v[16:17], v[28:29] op_sel:[0,0,0] op_sel_hi:[1,0,1]
 v_lshlrev_b32 v30, 16, v59
 v_and_b32 v31, s58, v59
 v_pk_mul_f32 v[30:31], v[30:31], v[18:19] op_sel:[0,0] op_sel_hi:[1,0]
 v_pk_fma_f32 v[182:183], v[182:183], v[16:17], v[30:31] op_sel:[0,0,0] op_sel_hi:[1,0,1]
 v_cvt_pk_bf16_f32 v176, v176, v177
 v_cvt_pk_bf16_f32 v177, v178, v179
 v_cvt_pk_bf16_f32 v178, v180, v181
 v_cvt_pk_bf16_f32 v179, v182, v183
 v_lshlrev_b32 v24, 16, v60
 v_and_b32 v25, s58, v60
 v_pk_mul_f32 v[24:25], v[24:25], v[18:19] op_sel:[0,0] op_sel_hi:[1,0]
 v_pk_fma_f32 v[184:185], v[184:185], v[16:17], v[24:25] op_sel:[0,0,0] op_sel_hi:[1,0,1]
 v_lshlrev_b32 v26, 16, v61
 v_and_b32 v27, s58, v61
 v_pk_mul_f32 v[26:27], v[26:27], v[18:19] op_sel:[0,0] op_sel_hi:[1,0]
 v_pk_fma_f32 v[186:187], v[186:187], v[16:17], v[26:27] op_sel:[0,0,0] op_sel_hi:[1,0,1]
 v_lshlrev_b32 v28, 16, v62
 v_and_b32 v29, s58, v62
 v_pk_mul_f32 v[28:29], v[28:29], v[18:19] op_sel:[0,0] op_sel_hi:[1,0]
 v_pk_fma_f32 v[188:189], v[188:189], v[16:17], v[28:29] op_sel:[0,0,0] op_sel_hi:[1,0,1]
 v_lshlrev_b32 v30, 16, v63
 v_and_b32 v31, s58, v63
 v_pk_mul_f32 v[30:31], v[30:31], v[18:19] op_sel:[0,0] op_sel_hi:[1,0]
 v_pk_fma_f32 v[190:191], v[190:191], v[16:17], v[30:31] op_sel:[0,0,0] op_sel_hi:[1,0,1]
 v_cvt_pk_bf16_f32 v184, v184, v185
 v_cvt_pk_bf16_f32 v185, v186, v187
 v_cvt_pk_bf16_f32 v186, v188, v189
 v_cvt_pk_bf16_f32 v187, v190, v191
 v_lshlrev_b32 v24, 16, v96
 v_and_b32 v25, s58, v96
 v_pk_mul_f32 v[24:25], v[24:25], v[18:19] op_sel:[0,1] op_sel_hi:[1,1]
 v_pk_fma_f32 v[192:193], v[192:193], v[16:17], v[24:25] op_sel:[0,1,0] op_sel_hi:[1,1,1]
 v_lshlrev_b32 v26, 16, v97
 v_and_b32 v27, s58, v97
 v_pk_mul_f32 v[26:27], v[26:27], v[18:19] op_sel:[0,1] op_sel_hi:[1,1]
 v_pk_fma_f32 v[194:195], v[194:195], v[16:17], v[26:27] op_sel:[0,1,0] op_sel_hi:[1,1,1]
 v_lshlrev_b32 v28, 16, v98
 v_and_b32 v29, s58, v98
 v_pk_mul_f32 v[28:29], v[28:29], v[18:19] op_sel:[0,1] op_sel_hi:[1,1]
 v_pk_fma_f32 v[196:197], v[196:197], v[16:17], v[28:29] op_sel:[0,1,0] op_sel_hi:[1,1,1]
 v_lshlrev_b32 v30, 16, v99
 v_and_b32 v31, s58, v99
 v_pk_mul_f32 v[30:31], v[30:31], v[18:19] op_sel:[0,1] op_sel_hi:[1,1]
 v_pk_fma_f32 v[198:199], v[198:199], v[16:17], v[30:31] op_sel:[0,1,0] op_sel_hi:[1,1,1]
 v_cvt_pk_bf16_f32 v192, v192, v193
 v_cvt_pk_bf16_f32 v193, v194, v195
 v_cvt_pk_bf16_f32 v194, v196, v197
 v_cvt_pk_bf16_f32 v195, v198, v199
 v_lshlrev_b32 v24, 16, v100
 v_and_b32 v25, s58, v100
 v_pk_mul_f32 v[24:25], v[24:25], v[18:19] op_sel:[0,1] op_sel_hi:[1,1]
 v_pk_fma_f32 v[200:201], v[200:201], v[16:17], v[24:25] op_sel:[0,1,0] op_sel_hi:[1,1,1]
 v_lshlrev_b32 v26, 16, v101
 v_and_b32 v27, s58, v101
 v_pk_mul_f32 v[26:27], v[26:27], v[18:19] op_sel:[0,1] op_sel_hi:[1,1]
 v_pk_fma_f32 v[202:203], v[202:203], v[16:17], v[26:27] op_sel:[0,1,0] op_sel_hi:[1,1,1]
 v_lshlrev_b32 v28, 16, v102
 v_and_b32 v29, s58, v102
 v_pk_mul_f32 v[28:29], v[28:29], v[18:19] op_sel:[0,1] op_sel_hi:[1,1]
 v_pk_fma_f32 v[204:205], v[204:205], v[16:17], v[28:29] op_sel:[0,1,0] op_sel_hi:[1,1,1]
 v_lshlrev_b32 v30, 16, v103
 v_and_b32 v31, s58, v103
 v_pk_mul_f32 v[30:31], v[30:31], v[18:19] op_sel:[0,1] op_sel_hi:[1,1]
 v_pk_fma_f32 v[206:207], v[206:207], v[16:17], v[30:31] op_sel:[0,1,0] op_sel_hi:[1,1,1]
 v_cvt_pk_bf16_f32 v200, v200, v201
 v_cvt_pk_bf16_f32 v201, v202, v203
 v_cvt_pk_bf16_f32 v202, v204, v205
 v_cvt_pk_bf16_f32 v203, v206, v207
 v_lshlrev_b32 v24, 16, v104
 v_and_b32 v25, s58, v104
 v_pk_mul_f32 v[24:25], v[24:25], v[18:19] op_sel:[0,1] op_sel_hi:[1,1]
 v_pk_fma_f32 v[208:209], v[208:209], v[16:17], v[24:25] op_sel:[0,1,0] op_sel_hi:[1,1,1]
 v_lshlrev_b32 v26, 16, v105
 v_and_b32 v27, s58, v105
 v_pk_mul_f32 v[26:27], v[26:27], v[18:19] op_sel:[0,1] op_sel_hi:[1,1]
 v_pk_fma_f32 v[210:211], v[210:211], v[16:17], v[26:27] op_sel:[0,1,0] op_sel_hi:[1,1,1]
 v_lshlrev_b32 v28, 16, v106
 v_and_b32 v29, s58, v106
 v_pk_mul_f32 v[28:29], v[28:29], v[18:19] op_sel:[0,1] op_sel_hi:[1,1]
 v_pk_fma_f32 v[212:213], v[212:213], v[16:17], v[28:29] op_sel:[0,1,0] op_sel_hi:[1,1,1]
 v_lshlrev_b32 v30, 16, v107
 v_and_b32 v31, s58, v107
 v_pk_mul_f32 v[30:31], v[30:31], v[18:19] op_sel:[0,1] op_sel_hi:[1,1]
 v_pk_fma_f32 v[214:215], v[214:215], v[16:17], v[30:31] op_sel:[0,1,0] op_sel_hi:[1,1,1]
 v_cvt_pk_bf16_f32 v208, v208, v209
 v_cvt_pk_bf16_f32 v209, v210, v211
 v_cvt_pk_bf16_f32 v210, v212, v213
 v_cvt_pk_bf16_f32 v211, v214, v215
 v_lshlrev_b32 v24, 16, v108
 v_and_b32 v25, s58, v108
 v_pk_mul_f32 v[24:25], v[24:25], v[18:19] op_sel:[0,1] op_sel_hi:[1,1]
 v_pk_fma_f32 v[216:217], v[216:217], v[16:17], v[24:25] op_sel:[0,1,0] op_sel_hi:[1,1,1]
 v_lshlrev_b32 v26, 16, v109
 v_and_b32 v27, s58, v109
 v_pk_mul_f32 v[26:27], v[26:27], v[18:19] op_sel:[0,1] op_sel_hi:[1,1]
 v_pk_fma_f32 v[218:219], v[218:219], v[16:17], v[26:27] op_sel:[0,1,0] op_sel_hi:[1,1,1]
 v_lshlrev_b32 v28, 16, v110
 v_and_b32 v29, s58, v110
 v_pk_mul_f32 v[28:29], v[28:29], v[18:19] op_sel:[0,1] op_sel_hi:[1,1]
 v_pk_fma_f32 v[220:221], v[220:221], v[16:17], v[28:29] op_sel:[0,1,0] op_sel_hi:[1,1,1]
 v_lshlrev_b32 v30, 16, v111
 v_and_b32 v31, s58, v111
 v_pk_mul_f32 v[30:31], v[30:31], v[18:19] op_sel:[0,1] op_sel_hi:[1,1]
 v_pk_fma_f32 v[222:223], v[222:223], v[16:17], v[30:31] op_sel:[0,1,0] op_sel_hi:[1,1,1]
 v_cvt_pk_bf16_f32 v216, v216, v217
 v_cvt_pk_bf16_f32 v217, v218, v219
 v_cvt_pk_bf16_f32 v218, v220, v221
 v_cvt_pk_bf16_f32 v219, v222, v223
 v_lshlrev_b32 v24, 16, v112
 v_and_b32 v25, s58, v112
 v_pk_mul_f32 v[24:25], v[24:25], v[18:19] op_sel:[0,1] op_sel_hi:[1,1]
 v_pk_fma_f32 v[224:225], v[224:225], v[16:17], v[24:25] op_sel:[0,1,0] op_sel_hi:[1,1,1]
 v_lshlrev_b32 v26, 16, v113
 v_and_b32 v27, s58, v113
 v_pk_mul_f32 v[26:27], v[26:27], v[18:19] op_sel:[0,1] op_sel_hi:[1,1]
 v_pk_fma_f32 v[226:227], v[226:227], v[16:17], v[26:27] op_sel:[0,1,0] op_sel_hi:[1,1,1]
 v_lshlrev_b32 v28, 16, v114
 v_and_b32 v29, s58, v114
 v_pk_mul_f32 v[28:29], v[28:29], v[18:19] op_sel:[0,1] op_sel_hi:[1,1]
 v_pk_fma_f32 v[228:229], v[228:229], v[16:17], v[28:29] op_sel:[0,1,0] op_sel_hi:[1,1,1]
 v_lshlrev_b32 v30, 16, v115
 v_and_b32 v31, s58, v115
 v_pk_mul_f32 v[30:31], v[30:31], v[18:19] op_sel:[0,1] op_sel_hi:[1,1]
 v_pk_fma_f32 v[230:231], v[230:231], v[16:17], v[30:31] op_sel:[0,1,0] op_sel_hi:[1,1,1]
 v_cvt_pk_bf16_f32 v224, v224, v225
 v_cvt_pk_bf16_f32 v225, v226, v227
 v_cvt_pk_bf16_f32 v226, v228, v229
 v_cvt_pk_bf16_f32 v227, v230, v231
 v_lshlrev_b32 v24, 16, v116
 v_and_b32 v25, s58, v116
 v_pk_mul_f32 v[24:25], v[24:25], v[18:19] op_sel:[0,1] op_sel_hi:[1,1]
 v_pk_fma_f32 v[232:233], v[232:233], v[16:17], v[24:25] op_sel:[0,1,0] op_sel_hi:[1,1,1]
 v_lshlrev_b32 v26, 16, v117
 v_and_b32 v27, s58, v117
 v_pk_mul_f32 v[26:27], v[26:27], v[18:19] op_sel:[0,1] op_sel_hi:[1,1]
 v_pk_fma_f32 v[234:235], v[234:235], v[16:17], v[26:27] op_sel:[0,1,0] op_sel_hi:[1,1,1]
 v_lshlrev_b32 v28, 16, v118
 v_and_b32 v29, s58, v118
 v_pk_mul_f32 v[28:29], v[28:29], v[18:19] op_sel:[0,1] op_sel_hi:[1,1]
 v_pk_fma_f32 v[236:237], v[236:237], v[16:17], v[28:29] op_sel:[0,1,0] op_sel_hi:[1,1,1]
 v_lshlrev_b32 v30, 16, v119
 v_and_b32 v31, s58, v119
 v_pk_mul_f32 v[30:31], v[30:31], v[18:19] op_sel:[0,1] op_sel_hi:[1,1]
 v_pk_fma_f32 v[238:239], v[238:239], v[16:17], v[30:31] op_sel:[0,1,0] op_sel_hi:[1,1,1]
 v_cvt_pk_bf16_f32 v232, v232, v233
 v_cvt_pk_bf16_f32 v233, v234, v235
 v_cvt_pk_bf16_f32 v234, v236, v237
 v_cvt_pk_bf16_f32 v235, v238, v239
 v_lshlrev_b32 v24, 16, v120
 v_and_b32 v25, s58, v120
 v_pk_mul_f32 v[24:25], v[24:25], v[18:19] op_sel:[0,1] op_sel_hi:[1,1]
 v_pk_fma_f32 v[240:241], v[240:241], v[16:17], v[24:25] op_sel:[0,1,0] op_sel_hi:[1,1,1]
 v_lshlrev_b32 v26, 16, v121
 v_and_b32 v27, s58, v121
 v_pk_mul_f32 v[26:27], v[26:27], v[18:19] op_sel:[0,1] op_sel_hi:[1,1]
 v_pk_fma_f32 v[242:243], v[242:243], v[16:17], v[26:27] op_sel:[0,1,0] op_sel_hi:[1,1,1]
 v_lshlrev_b32 v28, 16, v122
 v_and_b32 v29, s58, v122
 v_pk_mul_f32 v[28:29], v[28:29], v[18:19] op_sel:[0,1] op_sel_hi:[1,1]
 v_pk_fma_f32 v[244:245], v[244:245], v[16:17], v[28:29] op_sel:[0,1,0] op_sel_hi:[1,1,1]
 v_lshlrev_b32 v30, 16, v123
 v_and_b32 v31, s58, v123
 v_pk_mul_f32 v[30:31], v[30:31], v[18:19] op_sel:[0,1] op_sel_hi:[1,1]
 v_pk_fma_f32 v[246:247], v[246:247], v[16:17], v[30:31] op_sel:[0,1,0] op_sel_hi:[1,1,1]
 v_cvt_pk_bf16_f32 v240, v240, v241
 v_cvt_pk_bf16_f32 v241, v242, v243
 v_cvt_pk_bf16_f32 v242, v244, v245
 v_cvt_pk_bf16_f32 v243, v246, v247
 v_lshlrev_b32 v24, 16, v124
 v_and_b32 v25, s58, v124
 v_pk_mul_f32 v[24:25], v[24:25], v[18:19] op_sel:[0,1] op_sel_hi:[1,1]
 v_pk_fma_f32 v[248:249], v[248:249], v[16:17], v[24:25] op_sel:[0,1,0] op_sel_hi:[1,1,1]
 v_lshlrev_b32 v26, 16, v125
 v_and_b32 v27, s58, v125
 v_pk_mul_f32 v[26:27], v[26:27], v[18:19] op_sel:[0,1] op_sel_hi:[1,1]
 v_pk_fma_f32 v[250:251], v[250:251], v[16:17], v[26:27] op_sel:[0,1,0] op_sel_hi:[1,1,1]
 v_lshlrev_b32 v28, 16, v126
 v_and_b32 v29, s58, v126
 v_pk_mul_f32 v[28:29], v[28:29], v[18:19] op_sel:[0,1] op_sel_hi:[1,1]
 v_pk_fma_f32 v[252:253], v[252:253], v[16:17], v[28:29] op_sel:[0,1,0] op_sel_hi:[1,1,1]
 v_lshlrev_b32 v30, 16, v127
 v_and_b32 v31, s58, v127
 v_pk_mul_f32 v[30:31], v[30:31], v[18:19] op_sel:[0,1] op_sel_hi:[1,1]
 v_pk_fma_f32 v[254:255], v[254:255], v[16:17], v[30:31] op_sel:[0,1,0] op_sel_hi:[1,1,1]
 v_cvt_pk_bf16_f32 v248, v248, v249
 v_cvt_pk_bf16_f32 v249, v250, v251
 v_cvt_pk_bf16_f32 v250, v252, v253
 v_cvt_pk_bf16_f32 v251, v254, v255
L_attdone:
 v_lshrrev_b32 v8, 2, v0
 v_lshlrev_b32 v4, 7, v8
 v_bfe_u32 v8, v8, 1, 2
 v_lshl_add_u32 v4, v8, 5, v4
 v_and_b32 v8, 3, v0
 v_lshl_add_u32 v4, v8, 3, v4
 v_add_u32 v4, 131072, v4
 s_barrier
 ds_read_b64_tr_b16 a[0:1], v4 offset:0
 ds_read_b64_tr_b16 a[2:3], v4 offset:2048
 ds_read_b64_tr_b16 a[4:5], v4 offset:4096
 ds_read_b64_tr_b16 a[6:7], v4 offset:6144
 ds_read_b64_tr_b16 a[8:9], v4 offset:8192
 ds_read_b64_tr_b16 a[10:11], v4 offset:10240
 ds_read_b64_tr_b16 a[12:13], v4 offset:12288
 ds_read_b64_tr_b16 a[14:15], v4 offset:14336
 ds_read_b64_tr_b16 a[16:17], v4 offset:16384
 ds_read_b64_tr_b16 a[18:19], v4 offset:18432
 ds_read_b64_tr_b16 a[20:21], v4 offset:20480
 ds_read_b64_tr_b16 a[22:23], v4 offset:22528
 ds_read_b64_tr_b16 a[24:25], v4 offset:24576
 ds_read_b64_tr_b16 a[26:27], v4 offset:26624
 v_xor_b32 v5, 32, v4
 v_xor_b32 v6, 64, v4
 v_xor_b32 v7, 96, v4
 v_and_b32 v10, 15, v0
 v_lshlrev_b32 v10, 2, v10
 s_cmp_lt_u32 s28, 14
 s_cselect_b32 s52, 0, 1
 s_mov_b32 s53, 0
 v_accvgpr_read_b32 v9, a245
 s_lshl_b32 s48, s63, 3
 s_add_u32 s48, s48, s3
 s_mul_i32 s48, s48, 229376
 s_lshl_b32 s58, s26, 10
 s_add_u32 s48, s48, s58
 s_add_u32 s48, s48, 117440512
 s_waitcnt lgkmcnt(7)
 v_mfma_f32_16x16x32_bf16 v[72:75], a[0:3], v[128:131], 0
 s_add_u32 m0, s29, 32768
 ds_read_b64_tr_b16 a[28:29], v4 offset:28672
 v_mfma_f32_16x16x32_bf16 v[72:75], a[4:7], v[136:139], v[72:75]
 ds_read_b64_tr_b16 a[30:31], v4 offset:30720
 buffer_load_dwordx4 v2, s[8:11], s78 offen lds
 v_mfma_f32_16x16x32_bf16 v[72:75], a[8:11], v[144:147], v[72:75]
 s_waitcnt lgkmcnt(4)
 ds_read_b64_tr_b16 a[32:33], v5 offset:0
 v_mfma_f32_16x16x32_bf16 v[72:75], a[12:15], v[152:155], v[72:75]
 ds_read_b64_tr_b16 a[34:35], v5 offset:2048
 v_mfma_f32_16x16x32_bf16 v[72:75], a[16:19], v[160:163], v[72:75]
 s_add_u32 m0, s29, 36864
 ds_read_b64_tr_b16 a[36:37], v5 offset:4096
 v_mfma_f32_16x16x32_bf16 v[72:75], a[20:23], v[168:171], v[72:75]
 s_waitcnt lgkmcnt(3)
 ds_read_b64_tr_b16 a[38:39], v5 offset:6144
 v_mfma_f32_16x16x32_bf16 v[72:75], a[24:27], v[176:179], v[72:75]
 ds_read_b64_tr_b16 a[40:41], v5 offset:8192
 buffer_load_dwordx4 v2, s[8:11], s79 offen lds
 v_mfma_f32_16x16x32_bf16 v[72:75], a[28:31], v[184:187], v[72:75]
 ds_read_b64_tr_b16 a[42:43], v5 offset:10240
 v_mfma_f32_16x16x32_bf16 v[80:83], a[0:3], v[192:195], 0
 ds_read_b64_tr_b16 a[44:45], v5 offset:12288
 v_mfma_f32_16x16x32_bf16 v[80:83], a[4:7], v[200:203], v[80:83]
 ds_read_b64_tr_b16 a[46:47], v5 offset:14336
 v_mfma_f32_16x16x32_bf16 v[80:83], a[8:11], v[208:211], v[80:83]
 s_add_u32 m0, s29, 40960
 ds_read_b64_tr_b16 a[48:49], v5 offset:16384
 v_mfma_f32_16x16x32_bf16 v[80:83], a[12:15], v[216:219], v[80:83]
 ds_read_b64_tr_b16 a[50:51], v5 offset:18432
 buffer_load_dwordx4 v2, s[8:11], s80 offen lds
 v_mfma_f32_16x16x32_bf16 v[80:83], a[16:19], v[224:227], v[80:83]
 ds_read_b64_tr_b16 a[52:53], v5 offset:20480
 v_mul_f32 v72, v72, v64
 v_mfma_f32_16x16x32_bf16 v[80:83], a[20:23], v[232:235], v[80:83]
 ds_read_b64_tr_b16 a[54:55], v5 offset:22528
 v_mul_f32 v73, v73, v64
 v_mfma_f32_16x16x32_bf16 v[80:83], a[24:27], v[240:243], v[80:83]
 s_add_u32 m0, s29, 45056
 ds_read_b64_tr_b16 a[56:57], v5 offset:24576
 v_mul_f32 v74, v74, v64
 v_mfma_f32_16x16x32_bf16 v[80:83], a[28:31], v[248:251], v[80:83]
 s_waitcnt lgkmcnt(7)
 ds_read_b64_tr_b16 a[58:59], v5 offset:26624
 v_mul_f32 v75, v75, v64
 v_mfma_f32_16x16x32_bf16 v[76:79], a[32:35], v[128:131], 0
 ds_read_b64_tr_b16 a[60:61], v5 offset:28672
 buffer_load_dwordx4 v2, s[8:11], s81 offen lds
 v_mfma_f32_16x16x32_bf16 v[76:79], a[36:39], v[136:139], v[76:79]
 ds_read_b64_tr_b16 a[62:63], v5 offset:30720
 v_mfma_f32_16x16x32_bf16 v[76:79], a[40:43], v[144:147], v[76:79]
 s_waitcnt lgkmcnt(4)
 ds_read_b64_tr_b16 a[0:1], v6 offset:0
 v_mfma_f32_16x16x32_bf16 v[76:79], a[44:47], v[152:155], v[76:79]
 ds_read_b64_tr_b16 a[2:3], v6 offset:2048
 v_mfma_f32_16x16x32_bf16 v[76:79], a[48:51], v[160:163], v[76:79]
 s_add_u32 m0, s29, 49152
 ds_read_b64_tr_b16 a[4:5], v6 offset:4096
 v_mul_f32 v80, v80, v65
 v_mfma_f32_16x16x32_bf16 v[76:79], a[52:55], v[168:171], v[76:79]
 s_waitcnt lgkmcnt(3)
 ds_read_b64_tr_b16 a[6:7], v6 offset:6144
 buffer_load_dwordx4 v2, s[8:11], s82 offen lds
 v_mfma_f32_16x16x32_bf16 v[76:79], a[56:59], v[176:179], v[76:79]
 ds_read_b64_tr_b16 a[8:9], v6 offset:8192
 v_mul_f32 v81, v81, v65
 v_mfma_f32_16x16x32_bf16 v[76:79], a[60:63], v[184:187], v[76:79]
 ds_read_b64_tr_b16 a[10:11], v6 offset:10240
 v_mul_f32 v82, v82, v65
 v_mfma_f32_16x16x32_bf16 v[84:87], a[32:35], v[192:195], 0
 ds_read_b64_tr_b16 a[12:13], v6 offset:12288
 v_mul_f32 v83, v83, v65
 v_mfma_f32_16x16x32_bf16 v[84:87], a[36:39], v[200:203], v[84:87]
 s_add_u32 m0, s29, 53248
 ds_read_b64_tr_b16 a[14:15], v6 offset:14336
 v_mfma_f32_16x16x32_bf16 v[84:87], a[40:43], v[208:211], v[84:87]
 ds_read_b64_tr_b16 a[16:17], v6 offset:16384
 buffer_load_dwordx4 v2, s[8:11], s83 offen lds
 v_mfma_f32_16x16x32_bf16 v[84:87], a[44:47], v[216:219], v[84:87]
 ds_read_b64_tr_b16 a[18:19], v6 offset:18432
 v_mfma_f32_16x16x32_bf16 v[84:87], a[48:51], v[224:227], v[84:87]
 ds_read_b64_tr_b16 a[20:21], v6 offset:20480
 v_mul_f32 v76, v76, v64
 v_mfma_f32_16x16x32_bf16 v[84:87], a[52:55], v[232:235], v[84:87]
 ds_read_b64_tr_b16 a[22:23], v6 offset:22528
 v_mul_f32 v77, v77, v64
 v_mfma_f32_16x16x32_bf16 v[84:87], a[56:59], v[240:243], v[84:87]
 s_add_u32 m0, s29, 57344
 ds_read_b64_tr_b16 a[24:25], v6 offset:24576
 v_mul_f32 v78, v78, v64
 v_mfma_f32_16x16x32_bf16 v[84:87], a[60:63], v[248:251], v[84:87]
 s_waitcnt lgkmcnt(7)
 ds_read_b64_tr_b16 a[26:27], v6 offset:26624
 buffer_load_dwordx4 v2, s[8:11], s84 offen lds
 v_mfma_f32_16x16x32_bf16 v[88:91], a[0:3], v[128:131], 0
 s_lshl_b32 s44, s24, 7
 ds_read_b64_tr_b16 a[28:29], v6 offset:28672
 v_mul_f32 v79, v79, v64
 v_mfma_f32_16x16x32_bf16 v[88:91], a[4:7], v[136:139], v[88:91]
 s_add_u32 s44, s44, 84938752
 ds_read_b64_tr_b16 a[30:31], v6 offset:30720
 v_cvt_pk_bf16_f32 v72, v72, v73
 v_mfma_f32_16x16x32_bf16 v[88:91], a[8:11], v[144:147], v[88:91]
 s_waitcnt lgkmcnt(4)
 ds_read_b64_tr_b16 a[32:33], v7 offset:0
 v_cvt_pk_bf16_f32 v73, v74, v75
 v_mfma_f32_16x16x32_bf16 v[88:91], a[12:15], v[152:155], v[88:91]
 s_add_u32 m0, s29, 61440
 ds_read_b64_tr_b16 a[34:35], v7 offset:2048
 v_cvt_pk_bf16_f32 v74, v76, v77
 v_mfma_f32_16x16x32_bf16 v[88:91], a[16:19], v[160:163], v[88:91]
 ds_read_b64_tr_b16 a[36:37], v7 offset:4096
 buffer_load_dwordx4 v2, s[8:11], s85 offen lds
 v_mfma_f32_16x16x32_bf16 v[88:91], a[20:23], v[168:171], v[88:91]
 s_waitcnt lgkmcnt(3)
 ds_read_b64_tr_b16 a[38:39], v7 offset:6144
 v_add_u32 v2, 128, v2
 v_mfma_f32_16x16x32_bf16 v[88:91], a[24:27], v[176:179], v[88:91]
 s_add_u32 s58, s48, 0
 ds_read_b64_tr_b16 a[40:41], v7 offset:8192
 v_cvt_pk_bf16_f32 v75, v78, v79
 v_mfma_f32_16x16x32_bf16 v[88:91], a[28:31], v[184:187], v[88:91]
 ds_read_b64_tr_b16 a[42:43], v7 offset:10240
 buffer_store_dwordx4 v[72:75], v1, s[12:15], s58 offen sc1
 v_mfma_f32_16x16x32_bf16 v[96:99], a[0:3], v[192:195], 0
 s_add_u32 m0, s29, 65536
 ds_read_b64_tr_b16 a[44:45], v7 offset:12288
 v_mul_f32 v84, v84, v65
 v_mfma_f32_16x16x32_bf16 v[96:99], a[4:7], v[200:203], v[96:99]
 ds_read_b64_tr_b16 a[46:47], v7 offset:14336
 buffer_load_dwordx4 v2, s[8:11], s78 offen lds
 v_mfma_f32_16x16x32_bf16 v[96:99], a[8:11], v[208:211], v[96:99]
 s_lshl_b32 s40, s24, 1
 ds_read_b64_tr_b16 a[48:49], v7 offset:16384
 v_mul_f32 v85, v85, v65
 v_mfma_f32_16x16x32_bf16 v[96:99], a[12:15], v[216:219], v[96:99]
 s_and_b32 s41, s28, 1
 ds_read_b64_tr_b16 a[50:51], v7 offset:18432
 v_mul_f32 v86, v86, v65
 v_mfma_f32_16x16x32_bf16 v[96:99], a[16:19], v[224:227], v[96:99]
 s_add_u32 s40, s40, s41
 ds_read_b64_tr_b16 a[52:53], v7 offset:20480
 v_mul_f32 v87, v87, v65
 v_mfma_f32_16x16x32_bf16 v[96:99], a[20:23], v[232:235], v[96:99]
 s_add_u32 m0, s29, 69632
 ds_read_b64_tr_b16 a[54:55], v7 offset:22528
 v_cvt_pk_bf16_f32 v80, v80, v81
 v_mfma_f32_16x16x32_bf16 v[96:99], a[24:27], v[240:243], v[96:99]
 ds_read_b64_tr_b16 a[56:57], v7 offset:24576
 buffer_load_dwordx4 v2, s[8:11], s79 offen lds
 v_mfma_f32_16x16x32_bf16 v[96:99], a[28:31], v[248:251], v[96:99]
 s_waitcnt lgkmcnt(7)
 ds_read_b64_tr_b16 a[58:59], v7 offset:26624
 v_cvt_pk_bf16_f32 v81, v82, v83
 v_mfma_f32_16x16x32_bf16 v[92:95], a[32:35], v[128:131], 0
 s_lshr_b32 s41, s28, 1
 ds_read_b64_tr_b16 a[60:61], v7 offset:28672
 v_cvt_pk_bf16_f32 v82, v84, v85
 v_mfma_f32_16x16x32_bf16 v[92:95], a[36:39], v[136:139], v[92:95]
 s_add_u32 m0, s29, 73728
 ds_read_b64_tr_b16 a[62:63], v7 offset:30720
 v_xor_b32 v4, 0x20000, v4
 v_mfma_f32_16x16x32_bf16 v[92:95], a[40:43], v[144:147], v[92:95]
 s_waitcnt lgkmcnt(4)
 ds_read_b64_tr_b16 a[0:1], v4 offset:0
 v_cvt_pk_bf16_f32 v83, v86, v87
 v_mfma_f32_16x16x32_bf16 v[92:95], a[44:47], v[152:155], v[92:95]
 ds_read_b64_tr_b16 a[2:3], v4 offset:2048
 buffer_load_dwordx4 v2, s[8:11], s80 offen lds
 v_mfma_f32_16x16x32_bf16 v[92:95], a[48:51], v[160:163], v[92:95]
 s_add_u32 s58, s48, 917504
 ds_read_b64_tr_b16 a[4:5], v4 offset:4096
 v_mul_f32 v88, v88, v64
 v_mfma_f32_16x16x32_bf16 v[92:95], a[52:55], v[168:171], v[92:95]
 s_waitcnt lgkmcnt(3)
 ds_read_b64_tr_b16 a[6:7], v4 offset:6144
 buffer_store_dwordx4 v[80:83], v1, s[12:15], s58 offen sc1
 v_mfma_f32_16x16x32_bf16 v[92:95], a[56:59], v[176:179], v[92:95]
 s_lshl_b32 s42, s40, 2
 ds_read_b64_tr_b16 a[8:9], v4 offset:8192
 v_mul_f32 v89, v89, v64
 v_mfma_f32_16x16x32_bf16 v[92:95], a[60:63], v[184:187], v[92:95]
 s_add_u32 m0, s29, 77824
 ds_read_b64_tr_b16 a[10:11], v4 offset:10240
 v_mul_f32 v90, v90, v64
 v_mfma_f32_16x16x32_bf16 v[100:103], a[32:35], v[192:195], 0
 ds_read_b64_tr_b16 a[12:13], v4 offset:12288
 buffer_load_dwordx4 v2, s[8:11], s81 offen lds
 v_mfma_f32_16x16x32_bf16 v[100:103], a[36:39], v[200:203], v[100:103]
 s_add_u32 s42, s42, s3
 ds_read_b64_tr_b16 a[14:15], v4 offset:14336
 v_mul_f32 v91, v91, v64
 v_mfma_f32_16x16x32_bf16 v[100:103], a[40:43], v[208:211], v[100:103]
 s_mul_i32 s37, s42, 229376
 ds_read_b64_tr_b16 a[16:17], v4 offset:16384
 v_mul_f32 v96, v96, v65
 v_mfma_f32_16x16x32_bf16 v[100:103], a[44:47], v[216:219], v[100:103]
 s_lshl_b32 s43, s41, 14
 ds_read_b64_tr_b16 a[18:19], v4 offset:18432
 v_mul_f32 v97, v97, v65
 v_mfma_f32_16x16x32_bf16 v[100:103], a[48:51], v[224:227], v[100:103]
 s_add_u32 m0, s29, 81920
 ds_read_b64_tr_b16 a[20:21], v4 offset:20480
 v_mul_f32 v92, v92, v64
 v_mfma_f32_16x16x32_bf16 v[100:103], a[52:55], v[232:235], v[100:103]
 ds_read_b64_tr_b16 a[22:23], v4 offset:22528
 buffer_load_dwordx4 v2, s[8:11], s82 offen lds
 v_mfma_f32_16x16x32_bf16 v[100:103], a[56:59], v[240:243], v[100:103]
 s_add_u32 s37, s37, s43
 ds_read_b64_tr_b16 a[24:25], v4 offset:24576
 v_mul_f32 v93, v93, v64
 v_mfma_f32_16x16x32_bf16 v[100:103], a[60:63], v[248:251], v[100:103]
 s_waitcnt lgkmcnt(7)
 ds_read_b64_tr_b16 a[26:27], v4 offset:26624
 v_mul_f32 v94, v94, v64
 v_mfma_f32_16x16x32_bf16 v[104:107], a[0:3], v[128:131], 0
 s_add_u32 s37, s37, 117440512
 ds_read_b64_tr_b16 a[28:29], v4 offset:28672
 v_mul_f32 v95, v95, v64
 v_mfma_f32_16x16x32_bf16 v[104:107], a[4:7], v[136:139], v[104:107]
 s_add_u32 m0, s29, 86016
 ds_read_b64_tr_b16 a[30:31], v4 offset:30720
 v_xor_b32 v5, 0x20000, v5
 v_mfma_f32_16x16x32_bf16 v[104:107], a[8:11], v[144:147], v[104:107]
 s_waitcnt lgkmcnt(4)
 ds_read_b64_tr_b16 a[32:33], v5 offset:0
 buffer_load_dwordx4 v2, s[8:11], s83 offen lds
 v_mfma_f32_16x16x32_bf16 v[104:107], a[12:15], v[152:155], v[104:107]
 s_add_u32 s38, s37, 114688
 ds_read_b64_tr_b16 a[34:35], v5 offset:2048
 v_cvt_pk_bf16_f32 v88, v88, v89
 v_mfma_f32_16x16x32_bf16 v[104:107], a[16:19], v[160:163], v[104:107]
 ds_read_b64_tr_b16 a[36:37], v5 offset:4096
 v_cvt_pk_bf16_f32 v89, v90, v91
 v_mfma_f32_16x16x32_bf16 v[104:107], a[20:23], v[168:171], v[104:107]
 s_waitcnt lgkmcnt(3)
 ds_read_b64_tr_b16 a[38:39], v5 offset:6144
 v_cvt_pk_bf16_f32 v90, v92, v93
 v_mfma_f32_16x16x32_bf16 v[104:107], a[24:27], v[176:179], v[104:107]
 s_add_u32 m0, s29, 90112
 ds_read_b64_tr_b16 a[40:41], v5 offset:8192
 v_cvt_pk_bf16_f32 v91, v94, v95
 v_mfma_f32_16x16x32_bf16 v[104:107], a[28:31], v[184:187], v[104:107]
 ds_read_b64_tr_b16 a[42:43], v5 offset:10240
 buffer_load_dwordx4 v2, s[8:11], s84 offen lds
 v_mfma_f32_16x16x32_bf16 v[112:115], a[0:3], v[192:195], 0
 s_add_u32 s58, s48, 16384
 ds_read_b64_tr_b16 a[44:45], v5 offset:12288
 v_mul_f32 v98, v98, v65
 v_mfma_f32_16x16x32_bf16 v[112:115], a[4:7], v[200:203], v[112:115]
 ds_read_b64_tr_b16 a[46:47], v5 offset:14336
 buffer_store_dwordx4 v[88:91], v1, s[12:15], s58 offen sc1
 v_mfma_f32_16x16x32_bf16 v[112:115], a[8:11], v[208:211], v[112:115]
 ds_read_b64_tr_b16 a[48:49], v5 offset:16384
 v_mul_f32 v99, v99, v65
 v_mfma_f32_16x16x32_bf16 v[112:115], a[12:15], v[216:219], v[112:115]
 s_add_u32 m0, s29, 94208
 ds_read_b64_tr_b16 a[50:51], v5 offset:18432
 v_mul_f32 v100, v100, v65
 v_mfma_f32_16x16x32_bf16 v[112:115], a[16:19], v[224:227], v[112:115]
 ds_read_b64_tr_b16 a[52:53], v5 offset:20480
 buffer_load_dwordx4 v2, s[8:11], s85 offen lds
 v_mfma_f32_16x16x32_bf16 v[112:115], a[20:23], v[232:235], v[112:115]
 ds_read_b64_tr_b16 a[54:55], v5 offset:22528
 v_add_u32 v2, 128, v2
 v_mfma_f32_16x16x32_bf16 v[112:115], a[24:27], v[240:243], v[112:115]
 ds_read_b64_tr_b16 a[56:57], v5 offset:24576
 v_mul_f32 v101, v101, v65
 v_mfma_f32_16x16x32_bf16 v[112:115], a[28:31], v[248:251], v[112:115]
 s_waitcnt lgkmcnt(7)
 ds_read_b64_tr_b16 a[58:59], v5 offset:26624
 v_mul_f32 v102, v102, v65
 v_mfma_f32_16x16x32_bf16 v[108:111], a[32:35], v[128:131], 0
 ds_read_b64_tr_b16 a[60:61], v5 offset:28672
 v_mul_f32 v103, v103, v65
 v_mfma_f32_16x16x32_bf16 v[108:111], a[36:39], v[136:139], v[108:111]
 s_add_u32 m0, s29, 98304
 ds_read_b64_tr_b16 a[62:63], v5 offset:30720
 v_xor_b32 v6, 0x20000, v6
 v_mfma_f32_16x16x32_bf16 v[108:111], a[40:43], v[144:147], v[108:111]
 s_waitcnt lgkmcnt(4)
 ds_read_b64_tr_b16 a[0:1], v6 offset:0
 buffer_load_dwordx4 v2, s[8:11], s78 offen lds
 v_mfma_f32_16x16x32_bf16 v[108:111], a[44:47], v[152:155], v[108:111]
 ds_read_b64_tr_b16 a[2:3], v6 offset:2048
 v_cvt_pk_bf16_f32 v96, v96, v97
 v_mfma_f32_16x16x32_bf16 v[108:111], a[48:51], v[160:163], v[108:111]
 ds_read_b64_tr_b16 a[4:5], v6 offset:4096
 v_cvt_pk_bf16_f32 v97, v98, v99
 v_mfma_f32_16x16x32_bf16 v[108:111], a[52:55], v[168:171], v[108:111]
 s_waitcnt lgkmcnt(3)
 ds_read_b64_tr_b16 a[6:7], v6 offset:6144
 v_cvt_pk_bf16_f32 v98, v100, v101
 v_mfma_f32_16x16x32_bf16 v[108:111], a[56:59], v[176:179], v[108:111]
 s_add_u32 m0, s29, 102400
 ds_read_b64_tr_b16 a[8:9], v6 offset:8192
 v_cvt_pk_bf16_f32 v99, v102, v103
 v_mfma_f32_16x16x32_bf16 v[108:111], a[60:63], v[184:187], v[108:111]
 ds_read_b64_tr_b16 a[10:11], v6 offset:10240
 buffer_load_dwordx4 v2, s[8:11], s79 offen lds
 v_mfma_f32_16x16x32_bf16 v[116:119], a[32:35], v[192:195], 0
 s_add_u32 s58, s48, 933888
 ds_read_b64_tr_b16 a[12:13], v6 offset:12288
 v_mul_f32 v104, v104, v64
 v_mfma_f32_16x16x32_bf16 v[116:119], a[36:39], v[200:203], v[116:119]
 ds_read_b64_tr_b16 a[14:15], v6 offset:14336
 buffer_store_dwordx4 v[96:99], v1, s[12:15], s58 offen sc1
 v_mfma_f32_16x16x32_bf16 v[116:119], a[40:43], v[208:211], v[116:119]
 ds_read_b64_tr_b16 a[16:17], v6 offset:16384
 v_mul_f32 v105, v105, v64
 v_mfma_f32_16x16x32_bf16 v[116:119], a[44:47], v[216:219], v[116:119]
 s_add_u32 m0, s29, 106496
 ds_read_b64_tr_b16 a[18:19], v6 offset:18432
 v_mul_f32 v106, v106, v64
 v_mfma_f32_16x16x32_bf16 v[116:119], a[48:51], v[224:227], v[116:119]
 ds_read_b64_tr_b16 a[20:21], v6 offset:20480
 buffer_load_dwordx4 v2, s[8:11], s80 offen lds
 v_mfma_f32_16x16x32_bf16 v[116:119], a[52:55], v[232:235], v[116:119]
 ds_read_b64_tr_b16 a[22:23], v6 offset:22528
 v_mul_f32 v107, v107, v64
 v_mfma_f32_16x16x32_bf16 v[116:119], a[56:59], v[240:243], v[116:119]
 ds_read_b64_tr_b16 a[24:25], v6 offset:24576
 v_mul_f32 v108, v108, v64
 v_mfma_f32_16x16x32_bf16 v[116:119], a[60:63], v[248:251], v[116:119]
 s_waitcnt lgkmcnt(7)
 ds_read_b64_tr_b16 a[26:27], v6 offset:26624
 v_mul_f32 v109, v109, v64
 v_mfma_f32_16x16x32_bf16 v[72:75], a[0:3], v[128:131], 0
 ds_read_b64_tr_b16 a[28:29], v6 offset:28672
 v_mul_f32 v110, v110, v64
 v_mfma_f32_16x16x32_bf16 v[72:75], a[4:7], v[136:139], v[72:75]
 s_add_u32 m0, s29, 110592
 ds_read_b64_tr_b16 a[30:31], v6 offset:30720
 v_xor_b32 v7, 0x20000, v7
 v_mfma_f32_16x16x32_bf16 v[72:75], a[8:11], v[144:147], v[72:75]
 s_waitcnt lgkmcnt(4)
 ds_read_b64_tr_b16 a[32:33], v7 offset:0
 buffer_load_dwordx4 v2, s[8:11], s81 offen lds
 v_mfma_f32_16x16x32_bf16 v[72:75], a[12:15], v[152:155], v[72:75]
 ds_read_b64_tr_b16 a[34:35], v7 offset:2048
 v_mul_f32 v111, v111, v64
 v_mfma_f32_16x16x32_bf16 v[72:75], a[16:19], v[160:163], v[72:75]
 ds_read_b64_tr_b16 a[36:37], v7 offset:4096
 v_cvt_pk_bf16_f32 v104, v104, v105
 v_mfma_f32_16x16x32_bf16 v[72:75], a[20:23], v[168:171], v[72:75]
 s_waitcnt lgkmcnt(3)
 ds_read_b64_tr_b16 a[38:39], v7 offset:6144
 v_cvt_pk_bf16_f32 v105, v106, v107
 v_mfma_f32_16x16x32_bf16 v[72:75], a[24:27], v[176:179], v[72:75]
 s_add_u32 m0, s29, 114688
 ds_read_b64_tr_b16 a[40:41], v7 offset:8192
 v_cvt_pk_bf16_f32 v106, v108, v109
 v_mfma_f32_16x16x32_bf16 v[72:75], a[28:31], v[184:187], v[72:75]
 ds_read_b64_tr_b16 a[42:43], v7 offset:10240
 buffer_load_dwordx4 v2, s[8:11], s82 offen lds
 v_mfma_f32_16x16x32_bf16 v[80:83], a[0:3], v[192:195], 0
 s_add_u32 s58, s48, 32768
 ds_read_b64_tr_b16 a[44:45], v7 offset:12288
 v_cvt_pk_bf16_f32 v107, v110, v111
 v_mfma_f32_16x16x32_bf16 v[80:83], a[4:7], v[200:203], v[80:83]
 ds_read_b64_tr_b16 a[46:47], v7 offset:14336
 buffer_store_dwordx4 v[104:107], v1, s[12:15], s58 offen sc1
 v_mfma_f32_16x16x32_bf16 v[80:83], a[8:11], v[208:211], v[80:83]
 ds_read_b64_tr_b16 a[48:49], v7 offset:16384
 v_mul_f32 v112, v112, v65
 v_mfma_f32_16x16x32_bf16 v[80:83], a[12:15], v[216:219], v[80:83]
 s_add_u32 m0, s29, 118784
 ds_read_b64_tr_b16 a[50:51], v7 offset:18432
 v_mul_f32 v113, v113, v65
 v_mfma_f32_16x16x32_bf16 v[80:83], a[16:19], v[224:227], v[80:83]
 ds_read_b64_tr_b16 a[52:53], v7 offset:20480
 buffer_load_dwordx4 v2, s[8:11], s83 offen lds
 v_mfma_f32_16x16x32_bf16 v[80:83], a[20:23], v[232:235], v[80:83]
 ds_read_b64_tr_b16 a[54:55], v7 offset:22528
 v_mul_f32 v114, v114, v65
 v_mfma_f32_16x16x32_bf16 v[80:83], a[24:27], v[240:243], v[80:83]
 ds_read_b64_tr_b16 a[56:57], v7 offset:24576
 v_mul_f32 v115, v115, v65
 v_mfma_f32_16x16x32_bf16 v[80:83], a[28:31], v[248:251], v[80:83]
 s_waitcnt lgkmcnt(7)
 ds_read_b64_tr_b16 a[58:59], v7 offset:26624
 v_mul_f32 v116, v116, v65
 v_mfma_f32_16x16x32_bf16 v[76:79], a[32:35], v[128:131], 0
 s_waitcnt vmcnt(19)
 ds_read_b64_tr_b16 a[60:61], v7 offset:28672
 v_mul_f32 v117, v117, v65
 v_mfma_f32_16x16x32_bf16 v[76:79], a[36:39], v[136:139], v[76:79]
 s_barrier
 ds_read_b64_tr_b16 a[62:63], v7 offset:30720
 v_mul_f32 v118, v118, v65
 v_mfma_f32_16x16x32_bf16 v[76:79], a[40:43], v[144:147], v[76:79]
 s_waitcnt lgkmcnt(4)
 ds_read_b64_tr_b16 a[0:1], v4 offset:32768
 v_mul_f32 v119, v119, v65
 v_mfma_f32_16x16x32_bf16 v[76:79], a[44:47], v[152:155], v[76:79]
 s_add_u32 m0, s29, 122880
 ds_read_b64_tr_b16 a[2:3], v4 offset:34816
 v_cvt_pk_bf16_f32 v112, v112, v113
 v_mfma_f32_16x16x32_bf16 v[76:79], a[48:51], v[160:163], v[76:79]
 ds_read_b64_tr_b16 a[4:5], v4 offset:36864
 buffer_load_dwordx4 v2, s[8:11], s84 offen lds
 v_mfma_f32_16x16x32_bf16 v[76:79], a[52:55], v[168:171], v[76:79]
 s_waitcnt lgkmcnt(3)
 ds_read_b64_tr_b16 a[6:7], v4 offset:38912
 v_cvt_pk_bf16_f32 v113, v114, v115
 v_mfma_f32_16x16x32_bf16 v[76:79], a[56:59], v[176:179], v[76:79]
 ds_read_b64_tr_b16 a[8:9], v4 offset:40960
 v_cvt_pk_bf16_f32 v114, v116, v117
 v_mfma_f32_16x16x32_bf16 v[76:79], a[60:63], v[184:187], v[76:79]
 ds_read_b64_tr_b16 a[10:11], v4 offset:43008
 v_cvt_pk_bf16_f32 v115, v118, v119
 v_mfma_f32_16x16x32_bf16 v[84:87], a[32:35], v[192:195], 0
 s_add_u32 m0, s29, 126976
 ds_read_b64_tr_b16 a[12:13], v4 offset:45056
 v_mul_f32 v72, v72, v64
 v_mfma_f32_16x16x32_bf16 v[84:87], a[36:39], v[200:203], v[84:87]
 ds_read_b64_tr_b16 a[14:15], v4 offset:47104
 buffer_load_dwordx4 v2, s[8:11], s85 offen lds
 v_mfma_f32_16x16x32_bf16 v[84:87], a[40:43], v[208:211], v[84:87]
 s_add_u32 s58, s48, 950272
 ds_read_b64_tr_b16 a[16:17], v4 offset:49152
 v_add_u32 v2, 128, v2
 v_mfma_f32_16x16x32_bf16 v[84:87], a[44:47], v[216:219], v[84:87]
 s_waitcnt lgkmcnt(9)
 ds_read_b64_tr_b16 a[18:19], v4 offset:51200
 buffer_store_dwordx4 v[112:115], v1, s[12:15], s58 offen sc1
 v_mfma_f32_16x16x32_bf16 v[84:87], a[48:51], v[224:227], v[84:87]
 s_barrier
 ds_read_b64_tr_b16 a[20:21], v4 offset:53248
 v_mul_f32 v73, v73, v64
 v_mfma_f32_16x16x32_bf16 v[84:87], a[52:55], v[232:235], v[84:87]
 s_add_u32 m0, s29, 131072
 ds_read_b64_tr_b16 a[22:23], v4 offset:55296
 v_mul_f32 v74, v74, v64
 v_mfma_f32_16x16x32_bf16 v[84:87], a[56:59], v[240:243], v[84:87]
 ds_read_b64_tr_b16 a[24:25], v4 offset:57344
 buffer_load_dwordx4 v2, s[8:11], s78 offen lds
 v_mfma_f32_16x16x32_bf16 v[84:87], a[60:63], v[248:251], v[84:87]
 s_waitcnt lgkmcnt(7)
 ds_read_b64_tr_b16 a[26:27], v4 offset:59392
 v_mul_f32 v75, v75, v64
 v_mfma_f32_16x16x32_bf16 v[88:91], a[0:3], v[128:131], 0
 ds_read_b64_tr_b16 a[28:29], v4 offset:61440
 v_mul_f32 v76, v76, v64
 v_mfma_f32_16x16x32_bf16 v[88:91], a[4:7], v[136:139], v[88:91]
 s_add_u32 m0, s29, 135168
 ds_read_b64_tr_b16 a[30:31], v4 offset:63488
 v_mul_f32 v77, v77, v64
 v_mfma_f32_16x16x32_bf16 v[88:91], a[8:11], v[144:147], v[88:91]
 s_waitcnt lgkmcnt(4)
 ds_read_b64_tr_b16 a[32:33], v5 offset:32768
 v_mul_f32 v78, v78, v64
 v_mfma_f32_16x16x32_bf16 v[88:91], a[12:15], v[152:155], v[88:91]
 ds_read_b64_tr_b16 a[34:35], v5 offset:34816
 buffer_load_dwordx4 v2, s[8:11], s79 offen lds
 v_mfma_f32_16x16x32_bf16 v[88:91], a[16:19], v[160:163], v[88:91]
 ds_read_b64_tr_b16 a[36:37], v5 offset:36864
 v_mul_f32 v79, v79, v64
 v_mfma_f32_16x16x32_bf16 v[88:91], a[20:23], v[168:171], v[88:91]
 s_waitcnt lgkmcnt(3)
 ds_read_b64_tr_b16 a[38:39], v5 offset:38912
 v_cvt_pk_bf16_f32 v72, v72, v73
 v_mfma_f32_16x16x32_bf16 v[88:91], a[24:27], v[176:179], v[88:91]
 ds_read_b64_tr_b16 a[40:41], v5 offset:40960
 v_cvt_pk_bf16_f32 v73, v74, v75
 v_mfma_f32_16x16x32_bf16 v[88:91], a[28:31], v[184:187], v[88:91]
 s_add_u32 m0, s29, 139264
 ds_read_b64_tr_b16 a[42:43], v5 offset:43008
 v_cvt_pk_bf16_f32 v74, v76, v77
 v_mfma_f32_16x16x32_bf16 v[96:99], a[0:3], v[192:195], 0
 ds_read_b64_tr_b16 a[44:45], v5 offset:45056
 buffer_load_dwordx4 v2, s[8:11], s80 offen lds
 v_mfma_f32_16x16x32_bf16 v[96:99], a[4:7], v[200:203], v[96:99]
 ds_read_b64_tr_b16 a[46:47], v5 offset:47104
 v_cvt_pk_bf16_f32 v75, v78, v79
 v_mfma_f32_16x16x32_bf16 v[96:99], a[8:11], v[208:211], v[96:99]
 ds_read_b64_tr_b16 a[48:49], v5 offset:49152
 buffer_load_dword v11, v10, s[12:15], s44 offen offset:64 sc1
 v_mfma_f32_16x16x32_bf16 v[96:99], a[12:15], v[216:219], v[96:99]
 ds_read_b64_tr_b16 a[50:51], v5 offset:51200
 v_mul_f32 v80, v80, v65
 v_mfma_f32_16x16x32_bf16 v[96:99], a[16:19], v[224:227], v[96:99]
 s_add_u32 m0, s29, 143360
 ds_read_b64_tr_b16 a[52:53], v5 offset:53248
 v_mul_f32 v81, v81, v65
 v_mfma_f32_16x16x32_bf16 v[96:99], a[20:23], v[232:235], v[96:99]
 ds_read_b64_tr_b16 a[54:55], v5 offset:55296
 buffer_load_dwordx4 v2, s[8:11], s81 offen lds
 v_mfma_f32_16x16x32_bf16 v[96:99], a[24:27], v[240:243], v[96:99]
 s_add_u32 s58, s48, 49152
 ds_read_b64_tr_b16 a[56:57], v5 offset:57344
 v_mul_f32 v82, v82, v65
 v_mfma_f32_16x16x32_bf16 v[96:99], a[28:31], v[248:251], v[96:99]
 s_waitcnt lgkmcnt(7)
 ds_read_b64_tr_b16 a[58:59], v5 offset:59392
 buffer_store_dwordx4 v[72:75], v1, s[12:15], s58 offen sc1
 v_mfma_f32_16x16x32_bf16 v[92:95], a[32:35], v[128:131], 0
 ds_read_b64_tr_b16 a[60:61], v5 offset:61440
 v_mul_f32 v83, v83, v65
 v_mfma_f32_16x16x32_bf16 v[92:95], a[36:39], v[136:139], v[92:95]
 s_add_u32 m0, s29, 147456
 ds_read_b64_tr_b16 a[62:63], v5 offset:63488
 v_mul_f32 v84, v84, v65
 v_mfma_f32_16x16x32_bf16 v[92:95], a[40:43], v[144:147], v[92:95]
 s_waitcnt lgkmcnt(4)
 ds_read_b64_tr_b16 a[0:1], v6 offset:32768
 buffer_load_dwordx4 v2, s[8:11], s82 offen lds
 v_mfma_f32_16x16x32_bf16 v[92:95], a[44:47], v[152:155], v[92:95]
 ds_read_b64_tr_b16 a[2:3], v6 offset:34816
 v_mul_f32 v85, v85, v65
 v_mfma_f32_16x16x32_bf16 v[92:95], a[48:51], v[160:163], v[92:95]
 ds_read_b64_tr_b16 a[4:5], v6 offset:36864
 v_mul_f32 v86, v86, v65
 v_mfma_f32_16x16x32_bf16 v[92:95], a[52:55], v[168:171], v[92:95]
 s_waitcnt lgkmcnt(3)
 ds_read_b64_tr_b16 a[6:7], v6 offset:38912
 v_mul_f32 v87, v87, v65
 v_mfma_f32_16x16x32_bf16 v[92:95], a[56:59], v[176:179], v[92:95]
 s_add_u32 m0, s29, 151552
 ds_read_b64_tr_b16 a[8:9], v6 offset:40960
 v_cvt_pk_bf16_f32 v80, v80, v81
 v_mfma_f32_16x16x32_bf16 v[92:95], a[60:63], v[184:187], v[92:95]
 ds_read_b64_tr_b16 a[10:11], v6 offset:43008
 buffer_load_dwordx4 v2, s[8:11], s83 offen lds
 v_mfma_f32_16x16x32_bf16 v[100:103], a[32:35], v[192:195], 0
 ds_read_b64_tr_b16 a[12:13], v6 offset:45056
 v_cvt_pk_bf16_f32 v81, v82, v83
 v_mfma_f32_16x16x32_bf16 v[100:103], a[36:39], v[200:203], v[100:103]
 ds_read_b64_tr_b16 a[14:15], v6 offset:47104
 v_cvt_pk_bf16_f32 v82, v84, v85
 v_mfma_f32_16x16x32_bf16 v[100:103], a[40:43], v[208:211], v[100:103]
 ds_read_b64_tr_b16 a[16:17], v6 offset:49152
 v_cvt_pk_bf16_f32 v83, v86, v87
 v_mfma_f32_16x16x32_bf16 v[100:103], a[44:47], v[216:219], v[100:103]
 s_add_u32 m0, s29, 155648
 ds_read_b64_tr_b16 a[18:19], v6 offset:51200
 v_mul_f32 v88, v88, v64
 v_mfma_f32_16x16x32_bf16 v[100:103], a[48:51], v[224:227], v[100:103]
 ds_read_b64_tr_b16 a[20:21], v6 offset:53248
 buffer_load_dwordx4 v2, s[8:11], s84 offen lds
 v_mfma_f32_16x16x32_bf16 v[100:103], a[52:55], v[232:235], v[100:103]
 s_add_u32 s58, s48, 966656
 ds_read_b64_tr_b16 a[22:23], v6 offset:55296
 v_mul_f32 v89, v89, v64
 v_mfma_f32_16x16x32_bf16 v[100:103], a[56:59], v[240:243], v[100:103]
 ds_read_b64_tr_b16 a[24:25], v6 offset:57344
 buffer_store_dwordx4 v[80:83], v1, s[12:15], s58 offen sc1
 v_mfma_f32_16x16x32_bf16 v[100:103], a[60:63], v[248:251], v[100:103]
 s_waitcnt lgkmcnt(7)
 ds_read_b64_tr_b16 a[26:27], v6 offset:59392
 v_mul_f32 v90, v90, v64
 v_mfma_f32_16x16x32_bf16 v[104:107], a[0:3], v[128:131], 0
 s_add_u32 m0, s29, 159744
 ds_read_b64_tr_b16 a[28:29], v6 offset:61440
 v_mul_f32 v91, v91, v64
 v_mfma_f32_16x16x32_bf16 v[104:107], a[4:7], v[136:139], v[104:107]
 ds_read_b64_tr_b16 a[30:31], v6 offset:63488
 buffer_load_dwordx4 v2, s[8:11], s85 offen lds
 v_mfma_f32_16x16x32_bf16 v[104:107], a[8:11], v[144:147], v[104:107]
 s_waitcnt lgkmcnt(4)
 ds_read_b64_tr_b16 a[32:33], v7 offset:32768
 v_add_u32 v2, 128, v2
 v_mfma_f32_16x16x32_bf16 v[104:107], a[12:15], v[152:155], v[104:107]
 ds_read_b64_tr_b16 a[34:35], v7 offset:34816
 v_mul_f32 v92, v92, v64
 v_mfma_f32_16x16x32_bf16 v[104:107], a[16:19], v[160:163], v[104:107]
 s_add_u32 m0, s29, 0
 ds_read_b64_tr_b16 a[36:37], v7 offset:36864
 v_mul_f32 v93, v93, v64
 v_mfma_f32_16x16x32_bf16 v[104:107], a[20:23], v[168:171], v[104:107]
 s_waitcnt lgkmcnt(3)
 ds_read_b64_tr_b16 a[38:39], v7 offset:38912
 v_mul_f32 v94, v94, v64
 v_mfma_f32_16x16x32_bf16 v[104:107], a[24:27], v[176:179], v[104:107]
 ds_read_b64_tr_b16 a[40:41], v7 offset:40960
 buffer_load_dwordx4 v2, s[8:11], s78 offen lds
 v_mfma_f32_16x16x32_bf16 v[104:107], a[28:31], v[184:187], v[104:107]
 ds_read_b64_tr_b16 a[42:43], v7 offset:43008
 v_mul_f32 v95, v95, v64
 v_mfma_f32_16x16x32_bf16 v[112:115], a[0:3], v[192:195], 0
 ds_read_b64_tr_b16 a[44:45], v7 offset:45056
 v_cvt_pk_bf16_f32 v88, v88, v89
 v_mfma_f32_16x16x32_bf16 v[112:115], a[4:7], v[200:203], v[112:115]
 ds_read_b64_tr_b16 a[46:47], v7 offset:47104
 v_cvt_pk_bf16_f32 v89, v90, v91
 v_mfma_f32_16x16x32_bf16 v[112:115], a[8:11], v[208:211], v[112:115]
 s_add_u32 m0, s29, 4096
 ds_read_b64_tr_b16 a[48:49], v7 offset:49152
 v_cvt_pk_bf16_f32 v90, v92, v93
 v_mfma_f32_16x16x32_bf16 v[112:115], a[12:15], v[216:219], v[112:115]
 ds_read_b64_tr_b16 a[50:51], v7 offset:51200
 buffer_load_dwordx4 v2, s[8:11], s79 offen lds
 v_mfma_f32_16x16x32_bf16 v[112:115], a[16:19], v[224:227], v[112:115]
 s_add_u32 s58, s48, 65536
 ds_read_b64_tr_b16 a[52:53], v7 offset:53248
 v_cvt_pk_bf16_f32 v91, v94, v95
 v_mfma_f32_16x16x32_bf16 v[112:115], a[20:23], v[232:235], v[112:115]
 ds_read_b64_tr_b16 a[54:55], v7 offset:55296
 buffer_store_dwordx4 v[88:91], v1, s[12:15], s58 offen sc1
 v_mfma_f32_16x16x32_bf16 v[112:115], a[24:27], v[240:243], v[112:115]
 s_add_u32 m0, s29, 8192
 ds_read_b64_tr_b16 a[56:57], v7 offset:57344
 v_mul_f32 v96, v96, v65
 v_mfma_f32_16x16x32_bf16 v[112:115], a[28:31], v[248:251], v[112:115]
 s_waitcnt lgkmcnt(7)
 ds_read_b64_tr_b16 a[58:59], v7 offset:59392
 v_mul_f32 v97, v97, v65
 v_mfma_f32_16x16x32_bf16 v[108:111], a[32:35], v[128:131], 0
 s_waitcnt vmcnt(10)
 ds_read_b64_tr_b16 a[60:61], v7 offset:61440
 buffer_load_dwordx4 v2, s[8:11], s80 offen lds
 v_mfma_f32_16x16x32_bf16 v[108:111], a[36:39], v[136:139], v[108:111]
 s_barrier
 ds_read_b64_tr_b16 a[62:63], v7 offset:63488
 v_xor_b32 v4, 0x10000, v4
 v_mfma_f32_16x16x32_bf16 v[108:111], a[40:43], v[144:147], v[108:111]
 s_waitcnt lgkmcnt(4)
 ds_read_b64_tr_b16 a[0:1], v4 offset:0
 v_cmp_ne_u32 vcc, 0, v11
 v_mfma_f32_16x16x32_bf16 v[108:111], a[44:47], v[152:155], v[108:111]
 s_cmp_eq_u64 vcc, s[52:53]
 s_cselect_b32 s49, 1, 0
 s_cselect_b32 s51, s37, 2.0
 ds_read_b64_tr_b16 a[2:3], v4 offset:2048
 v_mfma_f32_16x16x32_bf16 v[108:111], a[48:51], v[160:163], v[108:111]
 ds_read_b64_tr_b16 a[4:5], v4 offset:4096
 buffer_load_dwordx4 a[64:67], v1, s[12:15], s51 offen offset:0 sc1
 v_mfma_f32_16x16x32_bf16 v[108:111], a[52:55], v[168:171], v[108:111]
 s_waitcnt lgkmcnt(3)
 ds_read_b64_tr_b16 a[6:7], v4 offset:6144
 v_mul_f32 v98, v98, v65
 v_mfma_f32_16x16x32_bf16 v[108:111], a[56:59], v[176:179], v[108:111]
 s_add_u32 m0, s29, 12288
 ds_read_b64_tr_b16 a[8:9], v4 offset:8192
 v_mul_f32 v99, v99, v65
 v_mfma_f32_16x16x32_bf16 v[108:111], a[60:63], v[184:187], v[108:111]
 ds_read_b64_tr_b16 a[10:11], v4 offset:10240
 buffer_load_dwordx4 v2, s[8:11], s81 offen lds
 v_mfma_f32_16x16x32_bf16 v[116:119], a[32:35], v[192:195], 0
 ds_read_b64_tr_b16 a[12:13], v4 offset:12288
 v_mul_f32 v100, v100, v65
 v_mfma_f32_16x16x32_bf16 v[116:119], a[36:39], v[200:203], v[116:119]
 ds_read_b64_tr_b16 a[14:15], v4 offset:14336
 v_mul_f32 v101, v101, v65
 v_mfma_f32_16x16x32_bf16 v[116:119], a[40:43], v[208:211], v[116:119]
 ds_read_b64_tr_b16 a[16:17], v4 offset:16384
 buffer_load_dwordx4 a[68:71], v1, s[12:15], s51 offen offset:1024 sc1
 v_mfma_f32_16x16x32_bf16 v[116:119], a[44:47], v[216:219], v[116:119]
 s_add_u32 m0, s29, 16384
 ds_read_b64_tr_b16 a[18:19], v4 offset:18432
 v_mul_f32 v102, v102, v65
 v_mfma_f32_16x16x32_bf16 v[116:119], a[48:51], v[224:227], v[116:119]
 ds_read_b64_tr_b16 a[20:21], v4 offset:20480
 buffer_load_dwordx4 v2, s[8:11], s82 offen lds
 v_mfma_f32_16x16x32_bf16 v[116:119], a[52:55], v[232:235], v[116:119]
 ds_read_b64_tr_b16 a[22:23], v4 offset:22528
 v_mul_f32 v103, v103, v65
 v_mfma_f32_16x16x32_bf16 v[116:119], a[56:59], v[240:243], v[116:119]
 ds_read_b64_tr_b16 a[24:25], v4 offset:24576
 v_cvt_pk_bf16_f32 v96, v96, v97
 v_mfma_f32_16x16x32_bf16 v[116:119], a[60:63], v[248:251], v[116:119]
 s_waitcnt lgkmcnt(7)
 ds_read_b64_tr_b16 a[26:27], v4 offset:26624
 v_cvt_pk_bf16_f32 v97, v98, v99
 v_mfma_f32_16x16x32_bf16 v[72:75], a[0:3], v[128:131], 0
 ds_read_b64_tr_b16 a[28:29], v4 offset:28672
 buffer_load_dwordx4 a[72:75], v1, s[12:15], s51 offen offset:2048 sc1
 v_mfma_f32_16x16x32_bf16 v[72:75], a[4:7], v[136:139], v[72:75]
 s_add_u32 m0, s29, 20480
 ds_read_b64_tr_b16 a[30:31], v4 offset:30720
 v_xor_b32 v5, 0x10000, v5
 v_mfma_f32_16x16x32_bf16 v[72:75], a[8:11], v[144:147], v[72:75]
 s_waitcnt lgkmcnt(4)
 ds_read_b64_tr_b16 a[32:33], v5 offset:0
 buffer_load_dwordx4 v2, s[8:11], s83 offen lds
 v_mfma_f32_16x16x32_bf16 v[72:75], a[12:15], v[152:155], v[72:75]
 ds_read_b64_tr_b16 a[34:35], v5 offset:2048
 v_cvt_pk_bf16_f32 v98, v100, v101
 v_mfma_f32_16x16x32_bf16 v[72:75], a[16:19], v[160:163], v[72:75]
 ds_read_b64_tr_b16 a[36:37], v5 offset:4096
 v_cvt_pk_bf16_f32 v99, v102, v103
 v_mfma_f32_16x16x32_bf16 v[72:75], a[20:23], v[168:171], v[72:75]
 s_waitcnt lgkmcnt(3)
 ds_read_b64_tr_b16 a[38:39], v5 offset:6144
 v_mul_f32 v104, v104, v64
 v_mfma_f32_16x16x32_bf16 v[72:75], a[24:27], v[176:179], v[72:75]
 ds_read_b64_tr_b16 a[40:41], v5 offset:8192
 buffer_load_dwordx4 a[76:79], v1, s[12:15], s51 offen offset:3072 sc1
 v_mfma_f32_16x16x32_bf16 v[72:75], a[28:31], v[184:187], v[72:75]
 s_add_u32 m0, s29, 24576
 ds_read_b64_tr_b16 a[42:43], v5 offset:10240
 v_mul_f32 v105, v105, v64
 v_mfma_f32_16x16x32_bf16 v[80:83], a[0:3], v[192:195], 0
 ds_read_b64_tr_b16 a[44:45], v5 offset:12288
 buffer_load_dwordx4 v2, s[8:11], s84 offen lds
 v_mfma_f32_16x16x32_bf16 v[80:83], a[4:7], v[200:203], v[80:83]
 s_add_u32 s58, s48, 983040
 ds_read_b64_tr_b16 a[46:47], v5 offset:14336
 v_mul_f32 v106, v106, v64
 v_mfma_f32_16x16x32_bf16 v[80:83], a[8:11], v[208:211], v[80:83]
 ds_read_b64_tr_b16 a[48:49], v5 offset:16384
 buffer_store_dwordx4 v[96:99], v1, s[12:15], s58 offen sc1
 v_mfma_f32_16x16x32_bf16 v[80:83], a[12:15], v[216:219], v[80:83]
 s_add_u32 s51, s51, 4096
 ds_read_b64_tr_b16 a[50:51], v5 offset:18432
 v_mul_f32 v107, v107, v64
 v_mfma_f32_16x16x32_bf16 v[80:83], a[16:19], v[224:227], v[80:83]
 ds_read_b64_tr_b16 a[52:53], v5 offset:20480
 buffer_load_dwordx4 a[80:83], v1, s[12:15], s51 offen offset:0 sc1
 v_mfma_f32_16x16x32_bf16 v[80:83], a[20:23], v[232:235], v[80:83]
 s_add_u32 m0, s29, 28672
 ds_read_b64_tr_b16 a[54:55], v5 offset:22528
 v_mul_f32 v108, v108, v64
 v_mfma_f32_16x16x32_bf16 v[80:83], a[24:27], v[240:243], v[80:83]
 ds_read_b64_tr_b16 a[56:57], v5 offset:24576
 buffer_load_dwordx4 v2, s[8:11], s85 offen lds
 v_mfma_f32_16x16x32_bf16 v[80:83], a[28:31], v[248:251], v[80:83]
 s_waitcnt lgkmcnt(7)
 ds_read_b64_tr_b16 a[58:59], v5 offset:26624
 v_add_u32 v2, 128, v2
 v_mfma_f32_16x16x32_bf16 v[76:79], a[32:35], v[128:131], 0
 ds_read_b64_tr_b16 a[60:61], v5 offset:28672
 v_mul_f32 v109, v109, v64
 v_mfma_f32_16x16x32_bf16 v[76:79], a[36:39], v[136:139], v[76:79]
 ds_read_b64_tr_b16 a[62:63], v5 offset:30720
 v_xor_b32 v6, 0x10000, v6
 v_mfma_f32_16x16x32_bf16 v[76:79], a[40:43], v[144:147], v[76:79]
 s_waitcnt lgkmcnt(4)
 ds_read_b64_tr_b16 a[0:1], v6 offset:0
 buffer_load_dwordx4 a[84:87], v1, s[12:15], s51 offen offset:1024 sc1
 v_mfma_f32_16x16x32_bf16 v[76:79], a[44:47], v[152:155], v[76:79]
 ds_read_b64_tr_b16 a[2:3], v6 offset:2048
 v_mul_f32 v110, v110, v64
 v_mfma_f32_16x16x32_bf16 v[76:79], a[48:51], v[160:163], v[76:79]
 ds_read_b64_tr_b16 a[4:5], v6 offset:4096
 v_mul_f32 v111, v111, v64
 v_mfma_f32_16x16x32_bf16 v[76:79], a[52:55], v[168:171], v[76:79]
 s_waitcnt lgkmcnt(3)
 ds_read_b64_tr_b16 a[6:7], v6 offset:6144
 v_cvt_pk_bf16_f32 v104, v104, v105
 v_mfma_f32_16x16x32_bf16 v[76:79], a[56:59], v[176:179], v[76:79]
 ds_read_b64_tr_b16 a[8:9], v6 offset:8192
 v_cvt_pk_bf16_f32 v105, v106, v107
 v_mfma_f32_16x16x32_bf16 v[76:79], a[60:63], v[184:187], v[76:79]
 ds_read_b64_tr_b16 a[10:11], v6 offset:10240
 v_cvt_pk_bf16_f32 v106, v108, v109
 v_mfma_f32_16x16x32_bf16 v[84:87], a[32:35], v[192:195], 0
 ds_read_b64_tr_b16 a[12:13], v6 offset:12288
 buffer_load_dwordx4 a[88:91], v1, s[12:15], s51 offen offset:2048 sc1
 v_mfma_f32_16x16x32_bf16 v[84:87], a[36:39], v[200:203], v[84:87]
 s_add_u32 s58, s48, 81920
 ds_read_b64_tr_b16 a[14:15], v6 offset:14336
 v_cvt_pk_bf16_f32 v107, v110, v111
 v_mfma_f32_16x16x32_bf16 v[84:87], a[40:43], v[208:211], v[84:87]
 ds_read_b64_tr_b16 a[16:17], v6 offset:16384
 buffer_store_dwordx4 v[104:107], v1, s[12:15], s58 offen sc1
 v_mfma_f32_16x16x32_bf16 v[84:87], a[44:47], v[216:219], v[84:87]
 ds_read_b64_tr_b16 a[18:19], v6 offset:18432
 v_mul_f32 v112, v112, v65
 v_mfma_f32_16x16x32_bf16 v[84:87], a[48:51], v[224:227], v[84:87]
 ds_read_b64_tr_b16 a[20:21], v6 offset:20480
 v_mul_f32 v113, v113, v65
 v_mfma_f32_16x16x32_bf16 v[84:87], a[52:55], v[232:235], v[84:87]
 ds_read_b64_tr_b16 a[22:23], v6 offset:22528
 v_mul_f32 v114, v114, v65
 v_mfma_f32_16x16x32_bf16 v[84:87], a[56:59], v[240:243], v[84:87]
 ds_read_b64_tr_b16 a[24:25], v6 offset:24576
 buffer_load_dwordx4 a[92:95], v1, s[12:15], s51 offen offset:3072 sc1
 v_mfma_f32_16x16x32_bf16 v[84:87], a[60:63], v[248:251], v[84:87]
 s_waitcnt lgkmcnt(7)
 ds_read_b64_tr_b16 a[26:27], v6 offset:26624
 v_mul_f32 v115, v115, v65
 v_mfma_f32_16x16x32_bf16 v[88:91], a[0:3], v[128:131], 0
 ds_read_b64_tr_b16 a[28:29], v6 offset:28672
 v_mul_f32 v116, v116, v65
 v_mfma_f32_16x16x32_bf16 v[88:91], a[4:7], v[136:139], v[88:91]
 ds_read_b64_tr_b16 a[30:31], v6 offset:30720
 v_xor_b32 v7, 0x10000, v7
 v_mfma_f32_16x16x32_bf16 v[88:91], a[8:11], v[144:147], v[88:91]
 s_waitcnt lgkmcnt(4)
 ds_read_b64_tr_b16 a[32:33], v7 offset:0
 v_mul_f32 v117, v117, v65
 v_mfma_f32_16x16x32_bf16 v[88:91], a[12:15], v[152:155], v[88:91]
 s_add_u32 s51, s51, 4096
 ds_read_b64_tr_b16 a[34:35], v7 offset:2048
 v_mul_f32 v118, v118, v65
 v_mfma_f32_16x16x32_bf16 v[88:91], a[16:19], v[160:163], v[88:91]
 ds_read_b64_tr_b16 a[36:37], v7 offset:4096
 buffer_load_dwordx4 a[96:99], v1, s[12:15], s51 offen offset:0 sc1
 v_mfma_f32_16x16x32_bf16 v[88:91], a[20:23], v[168:171], v[88:91]
 s_waitcnt lgkmcnt(3)
 ds_read_b64_tr_b16 a[38:39], v7 offset:6144
 v_mul_f32 v119, v119, v65
 v_mfma_f32_16x16x32_bf16 v[88:91], a[24:27], v[176:179], v[88:91]
 ds_read_b64_tr_b16 a[40:41], v7 offset:8192
 v_cvt_pk_bf16_f32 v112, v112, v113
 v_mfma_f32_16x16x32_bf16 v[88:91], a[28:31], v[184:187], v[88:91]
 ds_read_b64_tr_b16 a[42:43], v7 offset:10240
 v_cvt_pk_bf16_f32 v113, v114, v115
 v_mfma_f32_16x16x32_bf16 v[96:99], a[0:3], v[192:195], 0
 ds_read_b64_tr_b16 a[44:45], v7 offset:12288
 v_cvt_pk_bf16_f32 v114, v116, v117
 v_mfma_f32_16x16x32_bf16 v[96:99], a[4:7], v[200:203], v[96:99]
 ds_read_b64_tr_b16 a[46:47], v7 offset:14336
 v_cvt_pk_bf16_f32 v115, v118, v119
 v_mfma_f32_16x16x32_bf16 v[96:99], a[8:11], v[208:211], v[96:99]
 ds_read_b64_tr_b16 a[48:49], v7 offset:16384
 buffer_load_dwordx4 a[100:103], v1, s[12:15], s51 offen offset:1024 sc1
 v_mfma_f32_16x16x32_bf16 v[96:99], a[12:15], v[216:219], v[96:99]
 s_add_u32 s58, s48, 999424
 ds_read_b64_tr_b16 a[50:51], v7 offset:18432
 v_mul_f32 v72, v72, v64
 v_mfma_f32_16x16x32_bf16 v[96:99], a[16:19], v[224:227], v[96:99]
 ds_read_b64_tr_b16 a[52:53], v7 offset:20480
 buffer_store_dwordx4 v[112:115], v1, s[12:15], s58 offen sc1
 v_mfma_f32_16x16x32_bf16 v[96:99], a[20:23], v[232:235], v[96:99]
 ds_read_b64_tr_b16 a[54:55], v7 offset:22528
 v_mul_f32 v73, v73, v64
 v_mfma_f32_16x16x32_bf16 v[96:99], a[24:27], v[240:243], v[96:99]
 ds_read_b64_tr_b16 a[56:57], v7 offset:24576
 v_mul_f32 v74, v74, v64
 v_mfma_f32_16x16x32_bf16 v[96:99], a[28:31], v[248:251], v[96:99]
 s_waitcnt lgkmcnt(7)
 ds_read_b64_tr_b16 a[58:59], v7 offset:26624
 v_mul_f32 v75, v75, v64
 v_mfma_f32_16x16x32_bf16 v[92:95], a[32:35], v[128:131], 0
 ds_read_b64_tr_b16 a[60:61], v7 offset:28672
 buffer_load_dwordx4 a[104:107], v1, s[12:15], s51 offen offset:2048 sc1
 v_mfma_f32_16x16x32_bf16 v[92:95], a[36:39], v[136:139], v[92:95]
 ds_read_b64_tr_b16 a[62:63], v7 offset:30720
 v_mul_f32 v76, v76, v64
 v_mfma_f32_16x16x32_bf16 v[92:95], a[40:43], v[144:147], v[92:95]
 s_waitcnt lgkmcnt(4)
 ds_read_b64_tr_b16 a[0:1], v4 offset:32768
 v_mul_f32 v77, v77, v64
 v_mfma_f32_16x16x32_bf16 v[92:95], a[44:47], v[152:155], v[92:95]
 ds_read_b64_tr_b16 a[2:3], v4 offset:34816
 v_mul_f32 v78, v78, v64
 v_mfma_f32_16x16x32_bf16 v[92:95], a[48:51], v[160:163], v[92:95]
 ds_read_b64_tr_b16 a[4:5], v4 offset:36864
 v_mul_f32 v79, v79, v64
 v_mfma_f32_16x16x32_bf16 v[92:95], a[52:55], v[168:171], v[92:95]
 s_waitcnt lgkmcnt(3)
 ds_read_b64_tr_b16 a[6:7], v4 offset:38912
 v_cvt_pk_bf16_f32 v72, v72, v73
 v_mfma_f32_16x16x32_bf16 v[92:95], a[56:59], v[176:179], v[92:95]
 ds_read_b64_tr_b16 a[8:9], v4 offset:40960
 buffer_load_dwordx4 a[108:111], v1, s[12:15], s51 offen offset:3072 sc1
 v_mfma_f32_16x16x32_bf16 v[92:95], a[60:63], v[184:187], v[92:95]
 ds_read_b64_tr_b16 a[10:11], v4 offset:43008
 v_cvt_pk_bf16_f32 v73, v74, v75
 v_mfma_f32_16x16x32_bf16 v[100:103], a[32:35], v[192:195], 0
 ds_read_b64_tr_b16 a[12:13], v4 offset:45056
 v_cvt_pk_bf16_f32 v74, v76, v77
 v_mfma_f32_16x16x32_bf16 v[100:103], a[36:39], v[200:203], v[100:103]
 s_add_u32 s58, s48, 98304
 ds_read_b64_tr_b16 a[14:15], v4 offset:47104
 v_cvt_pk_bf16_f32 v75, v78, v79
 v_mfma_f32_16x16x32_bf16 v[100:103], a[40:43], v[208:211], v[100:103]
 ds_read_b64_tr_b16 a[16:17], v4 offset:49152
 buffer_store_dwordx4 v[72:75], v1, s[12:15], s58 offen sc1
 v_mfma_f32_16x16x32_bf16 v[100:103], a[44:47], v[216:219], v[100:103]
 s_add_u32 s51, s51, 4096
 ds_read_b64_tr_b16 a[18:19], v4 offset:51200
 v_mul_f32 v80, v80, v65
 v_mfma_f32_16x16x32_bf16 v[100:103], a[48:51], v[224:227], v[100:103]
 ds_read_b64_tr_b16 a[20:21], v4 offset:53248
 buffer_load_dwordx4 a[112:115], v1, s[12:15], s51 offen offset:0 sc1
 v_mfma_f32_16x16x32_bf16 v[100:103], a[52:55], v[232:235], v[100:103]
 ds_read_b64_tr_b16 a[22:23], v4 offset:55296
 v_mul_f32 v81, v81, v65
 v_mfma_f32_16x16x32_bf16 v[100:103], a[56:59], v[240:243], v[100:103]
 ds_read_b64_tr_b16 a[24:25], v4 offset:57344
 v_mul_f32 v82, v82, v65
 v_mfma_f32_16x16x32_bf16 v[100:103], a[60:63], v[248:251], v[100:103]
 s_waitcnt lgkmcnt(7)
 ds_read_b64_tr_b16 a[26:27], v4 offset:59392
 v_mul_f32 v83, v83, v65
 v_mfma_f32_16x16x32_bf16 v[104:107], a[0:3], v[128:131], 0
 ds_read_b64_tr_b16 a[28:29], v4 offset:61440
 v_mul_f32 v84, v84, v65
 v_mfma_f32_16x16x32_bf16 v[104:107], a[4:7], v[136:139], v[104:107]
 ds_read_b64_tr_b16 a[30:31], v4 offset:63488
 v_mul_f32 v85, v85, v65
 v_mfma_f32_16x16x32_bf16 v[104:107], a[8:11], v[144:147], v[104:107]
 s_waitcnt lgkmcnt(4)
 ds_read_b64_tr_b16 a[32:33], v5 offset:32768
 buffer_load_dwordx4 a[116:119], v1, s[12:15], s51 offen offset:1024 sc1
 v_mfma_f32_16x16x32_bf16 v[104:107], a[12:15], v[152:155], v[104:107]
 ds_read_b64_tr_b16 a[34:35], v5 offset:34816
 v_mul_f32 v86, v86, v65
 v_mfma_f32_16x16x32_bf16 v[104:107], a[16:19], v[160:163], v[104:107]
 ds_read_b64_tr_b16 a[36:37], v5 offset:36864
 v_mul_f32 v87, v87, v65
 v_mfma_f32_16x16x32_bf16 v[104:107], a[20:23], v[168:171], v[104:107]
 s_waitcnt lgkmcnt(3)
 ds_read_b64_tr_b16 a[38:39], v5 offset:38912
 v_cvt_pk_bf16_f32 v80, v80, v81
 v_mfma_f32_16x16x32_bf16 v[104:107], a[24:27], v[176:179], v[104:107]
 ds_read_b64_tr_b16 a[40:41], v5 offset:40960
 v_cvt_pk_bf16_f32 v81, v82, v83
 v_mfma_f32_16x16x32_bf16 v[104:107], a[28:31], v[184:187], v[104:107]
 ds_read_b64_tr_b16 a[42:43], v5 offset:43008
 v_cvt_pk_bf16_f32 v82, v84, v85
 v_mfma_f32_16x16x32_bf16 v[112:115], a[0:3], v[192:195], 0
 ds_read_b64_tr_b16 a[44:45], v5 offset:45056
 buffer_load_dwordx4 a[120:123], v1, s[12:15], s51 offen offset:2048 sc1
 v_mfma_f32_16x16x32_bf16 v[112:115], a[4:7], v[200:203], v[112:115]
 s_add_u32 s58, s48, 1015808
 ds_read_b64_tr_b16 a[46:47], v5 offset:47104
 v_cvt_pk_bf16_f32 v83, v86, v87
 v_mfma_f32_16x16x32_bf16 v[112:115], a[8:11], v[208:211], v[112:115]
 ds_read_b64_tr_b16 a[48:49], v5 offset:49152
 buffer_store_dwordx4 v[80:83], v1, s[12:15], s58 offen sc1
 v_mfma_f32_16x16x32_bf16 v[112:115], a[12:15], v[216:219], v[112:115]
 ds_read_b64_tr_b16 a[50:51], v5 offset:51200
 v_mul_f32 v88, v88, v64
 v_mfma_f32_16x16x32_bf16 v[112:115], a[16:19], v[224:227], v[112:115]
 ds_read_b64_tr_b16 a[52:53], v5 offset:53248
 v_mul_f32 v89, v89, v64
 v_mfma_f32_16x16x32_bf16 v[112:115], a[20:23], v[232:235], v[112:115]
 ds_read_b64_tr_b16 a[54:55], v5 offset:55296
 v_mul_f32 v90, v90, v64
 v_mfma_f32_16x16x32_bf16 v[112:115], a[24:27], v[240:243], v[112:115]
 ds_read_b64_tr_b16 a[56:57], v5 offset:57344
 buffer_load_dwordx4 a[124:127], v1, s[12:15], s51 offen offset:3072 sc1
 v_mfma_f32_16x16x32_bf16 v[112:115], a[28:31], v[248:251], v[112:115]
 s_waitcnt lgkmcnt(7)
 ds_read_b64_tr_b16 a[58:59], v5 offset:59392
 v_mul_f32 v91, v91, v64
 v_mfma_f32_16x16x32_bf16 v[108:111], a[32:35], v[128:131], 0
 ds_read_b64_tr_b16 a[60:61], v5 offset:61440
 v_mul_f32 v92, v92, v64
 v_mfma_f32_16x16x32_bf16 v[108:111], a[36:39], v[136:139], v[108:111]
 ds_read_b64_tr_b16 a[62:63], v5 offset:63488
 v_mul_f32 v93, v93, v64
 v_mfma_f32_16x16x32_bf16 v[108:111], a[40:43], v[144:147], v[108:111]
 s_waitcnt lgkmcnt(4)
 ds_read_b64_tr_b16 a[0:1], v6 offset:32768
 v_mul_f32 v94, v94, v64
 v_mfma_f32_16x16x32_bf16 v[108:111], a[44:47], v[152:155], v[108:111]
 ds_read_b64_tr_b16 a[2:3], v6 offset:34816
 v_mul_f32 v95, v95, v64
 v_mfma_f32_16x16x32_bf16 v[108:111], a[48:51], v[160:163], v[108:111]
 ds_read_b64_tr_b16 a[4:5], v6 offset:36864
 v_cvt_pk_bf16_f32 v88, v88, v89
 v_mfma_f32_16x16x32_bf16 v[108:111], a[52:55], v[168:171], v[108:111]
 s_waitcnt lgkmcnt(3)
 ds_read_b64_tr_b16 a[6:7], v6 offset:38912
 v_cvt_pk_bf16_f32 v89, v90, v91
 v_mfma_f32_16x16x32_bf16 v[108:111], a[56:59], v[176:179], v[108:111]
 ds_read_b64_tr_b16 a[8:9], v6 offset:40960
 v_cvt_pk_bf16_f32 v90, v92, v93
 v_mfma_f32_16x16x32_bf16 v[108:111], a[60:63], v[184:187], v[108:111]
 s_add_u32 s58, s48, 114688
 ds_read_b64_tr_b16 a[10:11], v6 offset:43008
 v_cvt_pk_bf16_f32 v91, v94, v95
 v_mfma_f32_16x16x32_bf16 v[116:119], a[32:35], v[192:195], 0
 ds_read_b64_tr_b16 a[12:13], v6 offset:45056
 buffer_store_dwordx4 v[88:91], v1, s[12:15], s58 offen sc1
 v_mfma_f32_16x16x32_bf16 v[116:119], a[36:39], v[200:203], v[116:119]
 ds_read_b64_tr_b16 a[14:15], v6 offset:47104
 v_mul_f32 v96, v96, v65
 v_mfma_f32_16x16x32_bf16 v[116:119], a[40:43], v[208:211], v[116:119]
 ds_read_b64_tr_b16 a[16:17], v6 offset:49152
 v_mul_f32 v97, v97, v65
 v_mfma_f32_16x16x32_bf16 v[116:119], a[44:47], v[216:219], v[116:119]
 ds_read_b64_tr_b16 a[18:19], v6 offset:51200
 v_mul_f32 v98, v98, v65
 v_mfma_f32_16x16x32_bf16 v[116:119], a[48:51], v[224:227], v[116:119]
 ds_read_b64_tr_b16 a[20:21], v6 offset:53248
 v_mul_f32 v99, v99, v65
 v_mfma_f32_16x16x32_bf16 v[116:119], a[52:55], v[232:235], v[116:119]
 ds_read_b64_tr_b16 a[22:23], v6 offset:55296
 v_mul_f32 v100, v100, v65
 v_mfma_f32_16x16x32_bf16 v[116:119], a[56:59], v[240:243], v[116:119]
 ds_read_b64_tr_b16 a[24:25], v6 offset:57344
 v_mul_f32 v101, v101, v65
 v_mfma_f32_16x16x32_bf16 v[116:119], a[60:63], v[248:251], v[116:119]
 s_waitcnt lgkmcnt(7)
 ds_read_b64_tr_b16 a[26:27], v6 offset:59392
 v_mul_f32 v102, v102, v65
 v_mfma_f32_16x16x32_bf16 v[72:75], a[0:3], v[128:131], 0
 ds_read_b64_tr_b16 a[28:29], v6 offset:61440
 v_mul_f32 v103, v103, v65
 v_mfma_f32_16x16x32_bf16 v[72:75], a[4:7], v[136:139], v[72:75]
 ds_read_b64_tr_b16 a[30:31], v6 offset:63488
 v_cvt_pk_bf16_f32 v96, v96, v97
 v_mfma_f32_16x16x32_bf16 v[72:75], a[8:11], v[144:147], v[72:75]
 s_waitcnt lgkmcnt(4)
 ds_read_b64_tr_b16 a[32:33], v7 offset:32768
 v_cvt_pk_bf16_f32 v97, v98, v99
 v_mfma_f32_16x16x32_bf16 v[72:75], a[12:15], v[152:155], v[72:75]
 ds_read_b64_tr_b16 a[34:35], v7 offset:34816
 v_cvt_pk_bf16_f32 v98, v100, v101
 v_mfma_f32_16x16x32_bf16 v[72:75], a[16:19], v[160:163], v[72:75]
 s_add_u32 s58, s48, 1032192
 ds_read_b64_tr_b16 a[36:37], v7 offset:36864
 v_cvt_pk_bf16_f32 v99, v102, v103
 v_mfma_f32_16x16x32_bf16 v[72:75], a[20:23], v[168:171], v[72:75]
 s_waitcnt lgkmcnt(3)
 ds_read_b64_tr_b16 a[38:39], v7 offset:38912
 buffer_store_dwordx4 v[96:99], v1, s[12:15], s58 offen sc1
 v_mfma_f32_16x16x32_bf16 v[72:75], a[24:27], v[176:179], v[72:75]
 ds_read_b64_tr_b16 a[40:41], v7 offset:40960
 v_mul_f32 v104, v104, v64
 v_mfma_f32_16x16x32_bf16 v[72:75], a[28:31], v[184:187], v[72:75]
 ds_read_b64_tr_b16 a[42:43], v7 offset:43008
 v_mul_f32 v105, v105, v64
 v_mfma_f32_16x16x32_bf16 v[80:83], a[0:3], v[192:195], 0
 ds_read_b64_tr_b16 a[44:45], v7 offset:45056
 v_mul_f32 v106, v106, v64
 v_mfma_f32_16x16x32_bf16 v[80:83], a[4:7], v[200:203], v[80:83]
 ds_read_b64_tr_b16 a[46:47], v7 offset:47104
 v_mul_f32 v107, v107, v64
 v_mfma_f32_16x16x32_bf16 v[80:83], a[8:11], v[208:211], v[80:83]
 ds_read_b64_tr_b16 a[48:49], v7 offset:49152
 v_mul_f32 v108, v108, v64
 v_mfma_f32_16x16x32_bf16 v[80:83], a[12:15], v[216:219], v[80:83]
 ds_read_b64_tr_b16 a[50:51], v7 offset:51200
 v_mul_f32 v109, v109, v64
 v_mfma_f32_16x16x32_bf16 v[80:83], a[16:19], v[224:227], v[80:83]
 ds_read_b64_tr_b16 a[52:53], v7 offset:53248
 v_mul_f32 v110, v110, v64
 v_mfma_f32_16x16x32_bf16 v[80:83], a[20:23], v[232:235], v[80:83]
 ds_read_b64_tr_b16 a[54:55], v7 offset:55296
 v_mul_f32 v111, v111, v64
 v_mfma_f32_16x16x32_bf16 v[80:83], a[24:27], v[240:243], v[80:83]
 ds_read_b64_tr_b16 a[56:57], v7 offset:57344
 v_cvt_pk_bf16_f32 v104, v104, v105
 v_mfma_f32_16x16x32_bf16 v[80:83], a[28:31], v[248:251], v[80:83]
 s_waitcnt lgkmcnt(7)
 ds_read_b64_tr_b16 a[58:59], v7 offset:59392
 v_cvt_pk_bf16_f32 v105, v106, v107
 v_mfma_f32_16x16x32_bf16 v[76:79], a[32:35], v[128:131], 0
 s_waitcnt vmcnt(3)
 ds_read_b64_tr_b16 a[60:61], v7 offset:61440
 v_cvt_pk_bf16_f32 v106, v108, v109
 v_mfma_f32_16x16x32_bf16 v[76:79], a[36:39], v[136:139], v[76:79]
 s_barrier
 ds_read_b64_tr_b16 a[62:63], v7 offset:63488
 v_xor_b32 v4, 0x30000, v4
 v_mfma_f32_16x16x32_bf16 v[76:79], a[40:43], v[144:147], v[76:79]
 s_waitcnt lgkmcnt(4)
 ds_read_b64_tr_b16 a[0:1], v4 offset:0
 buffer_store_dword v9, v9, s[12:15], s93 offen offset:64 sc1
 v_mfma_f32_16x16x32_bf16 v[76:79], a[44:47], v[152:155], v[76:79]
 s_add_u32 s58, s48, 131072
 ds_read_b64_tr_b16 a[2:3], v4 offset:2048
 v_cvt_pk_bf16_f32 v107, v110, v111
 v_mfma_f32_16x16x32_bf16 v[76:79], a[48:51], v[160:163], v[76:79]
 ds_read_b64_tr_b16 a[4:5], v4 offset:4096
 buffer_store_dwordx4 v[104:107], v1, s[12:15], s58 offen sc1
 v_mfma_f32_16x16x32_bf16 v[76:79], a[52:55], v[168:171], v[76:79]
 s_waitcnt lgkmcnt(3)
 ds_read_b64_tr_b16 a[6:7], v4 offset:6144
 v_mul_f32 v112, v112, v65
 v_mfma_f32_16x16x32_bf16 v[76:79], a[56:59], v[176:179], v[76:79]
 ds_read_b64_tr_b16 a[8:9], v4 offset:8192
 v_mul_f32 v113, v113, v65
 v_mfma_f32_16x16x32_bf16 v[76:79], a[60:63], v[184:187], v[76:79]
 ds_read_b64_tr_b16 a[10:11], v4 offset:10240
 v_mul_f32 v114, v114, v65
 v_mfma_f32_16x16x32_bf16 v[84:87], a[32:35], v[192:195], 0
 ds_read_b64_tr_b16 a[12:13], v4 offset:12288
 v_mul_f32 v115, v115, v65
 v_mfma_f32_16x16x32_bf16 v[84:87], a[36:39], v[200:203], v[84:87]
 ds_read_b64_tr_b16 a[14:15], v4 offset:14336
 v_mul_f32 v116, v116, v65
 v_mfma_f32_16x16x32_bf16 v[84:87], a[40:43], v[208:211], v[84:87]
 ds_read_b64_tr_b16 a[16:17], v4 offset:16384
 v_mul_f32 v117, v117, v65
 v_mfma_f32_16x16x32_bf16 v[84:87], a[44:47], v[216:219], v[84:87]
 ds_read_b64_tr_b16 a[18:19], v4 offset:18432
 v_mul_f32 v118, v118, v65
 v_mfma_f32_16x16x32_bf16 v[84:87], a[48:51], v[224:227], v[84:87]
 ds_read_b64_tr_b16 a[20:21], v4 offset:20480
 v_mul_f32 v119, v119, v65
 v_mfma_f32_16x16x32_bf16 v[84:87], a[52:55], v[232:235], v[84:87]
 ds_read_b64_tr_b16 a[22:23], v4 offset:22528
 v_cvt_pk_bf16_f32 v112, v112, v113
 v_mfma_f32_16x16x32_bf16 v[84:87], a[56:59], v[240:243], v[84:87]
 ds_read_b64_tr_b16 a[24:25], v4 offset:24576
 v_cvt_pk_bf16_f32 v113, v114, v115
 v_mfma_f32_16x16x32_bf16 v[84:87], a[60:63], v[248:251], v[84:87]
 s_waitcnt lgkmcnt(7)
 ds_read_b64_tr_b16 a[26:27], v4 offset:26624
 v_cvt_pk_bf16_f32 v114, v116, v117
 v_mfma_f32_16x16x32_bf16 v[88:91], a[0:3], v[128:131], 0
 ds_read_b64_tr_b16 a[28:29], v4 offset:28672
 v_cvt_pk_bf16_f32 v115, v118, v119
 v_mfma_f32_16x16x32_bf16 v[88:91], a[4:7], v[136:139], v[88:91]
 s_add_u32 s58, s48, 1048576
 ds_read_b64_tr_b16 a[30:31], v4 offset:30720
 v_xor_b32 v5, 0x30000, v5
 v_mfma_f32_16x16x32_bf16 v[88:91], a[8:11], v[144:147], v[88:91]
 s_waitcnt lgkmcnt(4)
 ds_read_b64_tr_b16 a[32:33], v5 offset:0
 buffer_store_dwordx4 v[112:115], v1, s[12:15], s58 offen sc1
 v_mfma_f32_16x16x32_bf16 v[88:91], a[12:15], v[152:155], v[88:91]
 ds_read_b64_tr_b16 a[34:35], v5 offset:2048
 v_mul_f32 v72, v72, v64
 v_mfma_f32_16x16x32_bf16 v[88:91], a[16:19], v[160:163], v[88:91]
 ds_read_b64_tr_b16 a[36:37], v5 offset:4096
 v_mul_f32 v73, v73, v64
 v_mfma_f32_16x16x32_bf16 v[88:91], a[20:23], v[168:171], v[88:91]
 s_waitcnt lgkmcnt(3)
 ds_read_b64_tr_b16 a[38:39], v5 offset:6144
 v_mul_f32 v74, v74, v64
 v_mfma_f32_16x16x32_bf16 v[88:91], a[24:27], v[176:179], v[88:91]
 ds_read_b64_tr_b16 a[40:41], v5 offset:8192
 v_mul_f32 v75, v75, v64
 v_mfma_f32_16x16x32_bf16 v[88:91], a[28:31], v[184:187], v[88:91]
 ds_read_b64_tr_b16 a[42:43], v5 offset:10240
 v_mul_f32 v76, v76, v64
 v_mfma_f32_16x16x32_bf16 v[96:99], a[0:3], v[192:195], 0
 ds_read_b64_tr_b16 a[44:45], v5 offset:12288
 v_mul_f32 v77, v77, v64
 v_mfma_f32_16x16x32_bf16 v[96:99], a[4:7], v[200:203], v[96:99]
 ds_read_b64_tr_b16 a[46:47], v5 offset:14336
 v_mul_f32 v78, v78, v64
 v_mfma_f32_16x16x32_bf16 v[96:99], a[8:11], v[208:211], v[96:99]
 ds_read_b64_tr_b16 a[48:49], v5 offset:16384
 v_mul_f32 v79, v79, v64
 v_mfma_f32_16x16x32_bf16 v[96:99], a[12:15], v[216:219], v[96:99]
 ds_read_b64_tr_b16 a[50:51], v5 offset:18432
 v_cvt_pk_bf16_f32 v72, v72, v73
 v_mfma_f32_16x16x32_bf16 v[96:99], a[16:19], v[224:227], v[96:99]
 ds_read_b64_tr_b16 a[52:53], v5 offset:20480
 v_cvt_pk_bf16_f32 v73, v74, v75
 v_mfma_f32_16x16x32_bf16 v[96:99], a[20:23], v[232:235], v[96:99]
 ds_read_b64_tr_b16 a[54:55], v5 offset:22528
 v_cvt_pk_bf16_f32 v74, v76, v77
 v_mfma_f32_16x16x32_bf16 v[96:99], a[24:27], v[240:243], v[96:99]
 s_add_u32 s58, s48, 147456
 ds_read_b64_tr_b16 a[56:57], v5 offset:24576
 v_cvt_pk_bf16_f32 v75, v78, v79
 v_mfma_f32_16x16x32_bf16 v[96:99], a[28:31], v[248:251], v[96:99]
 s_waitcnt lgkmcnt(7)
 ds_read_b64_tr_b16 a[58:59], v5 offset:26624
 buffer_store_dwordx4 v[72:75], v1, s[12:15], s58 offen sc1
 v_mfma_f32_16x16x32_bf16 v[92:95], a[32:35], v[128:131], 0
 ds_read_b64_tr_b16 a[60:61], v5 offset:28672
 v_mul_f32 v80, v80, v65
 v_mfma_f32_16x16x32_bf16 v[92:95], a[36:39], v[136:139], v[92:95]
 ds_read_b64_tr_b16 a[62:63], v5 offset:30720
 v_xor_b32 v6, 0x30000, v6
 v_mfma_f32_16x16x32_bf16 v[92:95], a[40:43], v[144:147], v[92:95]
 s_waitcnt lgkmcnt(4)
 ds_read_b64_tr_b16 a[0:1], v6 offset:0
 v_mul_f32 v81, v81, v65
 v_mfma_f32_16x16x32_bf16 v[92:95], a[44:47], v[152:155], v[92:95]
 ds_read_b64_tr_b16 a[2:3], v6 offset:2048
 v_mul_f32 v82, v82, v65
 v_mfma_f32_16x16x32_bf16 v[92:95], a[48:51], v[160:163], v[92:95]
 ds_read_b64_tr_b16 a[4:5], v6 offset:4096
 v_mul_f32 v83, v83, v65
 v_mfma_f32_16x16x32_bf16 v[92:95], a[52:55], v[168:171], v[92:95]
 s_waitcnt lgkmcnt(3)
 ds_read_b64_tr_b16 a[6:7], v6 offset:6144
 v_mul_f32 v84, v84, v65
 v_mfma_f32_16x16x32_bf16 v[92:95], a[56:59], v[176:179], v[92:95]
 ds_read_b64_tr_b16 a[8:9], v6 offset:8192
 v_mul_f32 v85, v85, v65
 v_mfma_f32_16x16x32_bf16 v[92:95], a[60:63], v[184:187], v[92:95]
 ds_read_b64_tr_b16 a[10:11], v6 offset:10240
 v_mul_f32 v86, v86, v65
 v_mfma_f32_16x16x32_bf16 v[100:103], a[32:35], v[192:195], 0
 ds_read_b64_tr_b16 a[12:13], v6 offset:12288
 v_mul_f32 v87, v87, v65
 v_mfma_f32_16x16x32_bf16 v[100:103], a[36:39], v[200:203], v[100:103]
 ds_read_b64_tr_b16 a[14:15], v6 offset:14336
 v_cvt_pk_bf16_f32 v80, v80, v81
 v_mfma_f32_16x16x32_bf16 v[100:103], a[40:43], v[208:211], v[100:103]
 ds_read_b64_tr_b16 a[16:17], v6 offset:16384
 v_cvt_pk_bf16_f32 v81, v82, v83
 v_mfma_f32_16x16x32_bf16 v[100:103], a[44:47], v[216:219], v[100:103]
 ds_read_b64_tr_b16 a[18:19], v6 offset:18432
 v_cvt_pk_bf16_f32 v82, v84, v85
 v_mfma_f32_16x16x32_bf16 v[100:103], a[48:51], v[224:227], v[100:103]
 s_add_u32 s58, s48, 1064960
 ds_read_b64_tr_b16 a[20:21], v6 offset:20480
 v_cvt_pk_bf16_f32 v83, v86, v87
 v_mfma_f32_16x16x32_bf16 v[100:103], a[52:55], v[232:235], v[100:103]
 ds_read_b64_tr_b16 a[22:23], v6 offset:22528
 buffer_store_dwordx4 v[80:83], v1, s[12:15], s58 offen sc1
 v_mfma_f32_16x16x32_bf16 v[100:103], a[56:59], v[240:243], v[100:103]
 ds_read_b64_tr_b16 a[24:25], v6 offset:24576
 v_mul_f32 v88, v88, v64
 v_mfma_f32_16x16x32_bf16 v[100:103], a[60:63], v[248:251], v[100:103]
 s_waitcnt lgkmcnt(7)
 ds_read_b64_tr_b16 a[26:27], v6 offset:26624
 v_mul_f32 v89, v89, v64
 v_mfma_f32_16x16x32_bf16 v[104:107], a[0:3], v[128:131], 0
 ds_read_b64_tr_b16 a[28:29], v6 offset:28672
 v_mul_f32 v90, v90, v64
 v_mfma_f32_16x16x32_bf16 v[104:107], a[4:7], v[136:139], v[104:107]
 ds_read_b64_tr_b16 a[30:31], v6 offset:30720
 v_xor_b32 v7, 0x30000, v7
 v_mfma_f32_16x16x32_bf16 v[104:107], a[8:11], v[144:147], v[104:107]
 s_waitcnt lgkmcnt(4)
 ds_read_b64_tr_b16 a[32:33], v7 offset:0
 v_mul_f32 v91, v91, v64
 v_mfma_f32_16x16x32_bf16 v[104:107], a[12:15], v[152:155], v[104:107]
 ds_read_b64_tr_b16 a[34:35], v7 offset:2048
 v_mul_f32 v92, v92, v64
 v_mfma_f32_16x16x32_bf16 v[104:107], a[16:19], v[160:163], v[104:107]
 ds_read_b64_tr_b16 a[36:37], v7 offset:4096
 v_mul_f32 v93, v93, v64
 v_mfma_f32_16x16x32_bf16 v[104:107], a[20:23], v[168:171], v[104:107]
 s_waitcnt lgkmcnt(3)
 ds_read_b64_tr_b16 a[38:39], v7 offset:6144
 v_mul_f32 v94, v94, v64
 v_mfma_f32_16x16x32_bf16 v[104:107], a[24:27], v[176:179], v[104:107]
 ds_read_b64_tr_b16 a[40:41], v7 offset:8192
 v_mul_f32 v95, v95, v64
 v_mfma_f32_16x16x32_bf16 v[104:107], a[28:31], v[184:187], v[104:107]
 ds_read_b64_tr_b16 a[42:43], v7 offset:10240
 v_cvt_pk_bf16_f32 v88, v88, v89
 v_mfma_f32_16x16x32_bf16 v[112:115], a[0:3], v[192:195], 0
 ds_read_b64_tr_b16 a[44:45], v7 offset:12288
 v_cvt_pk_bf16_f32 v89, v90, v91
 v_mfma_f32_16x16x32_bf16 v[112:115], a[4:7], v[200:203], v[112:115]
 ds_read_b64_tr_b16 a[46:47], v7 offset:14336
 v_cvt_pk_bf16_f32 v90, v92, v93
 v_mfma_f32_16x16x32_bf16 v[112:115], a[8:11], v[208:211], v[112:115]
 s_add_u32 s58, s48, 163840
 ds_read_b64_tr_b16 a[48:49], v7 offset:16384
 v_cvt_pk_bf16_f32 v91, v94, v95
 v_mfma_f32_16x16x32_bf16 v[112:115], a[12:15], v[216:219], v[112:115]
 ds_read_b64_tr_b16 a[50:51], v7 offset:18432
 buffer_store_dwordx4 v[88:91], v1, s[12:15], s58 offen sc1
 v_mfma_f32_16x16x32_bf16 v[112:115], a[16:19], v[224:227], v[112:115]
 ds_read_b64_tr_b16 a[52:53], v7 offset:20480
 v_mul_f32 v96, v96, v65
 v_mfma_f32_16x16x32_bf16 v[112:115], a[20:23], v[232:235], v[112:115]
 ds_read_b64_tr_b16 a[54:55], v7 offset:22528
 v_mul_f32 v97, v97, v65
 v_mfma_f32_16x16x32_bf16 v[112:115], a[24:27], v[240:243], v[112:115]
 ds_read_b64_tr_b16 a[56:57], v7 offset:24576
 v_mul_f32 v98, v98, v65
 v_mfma_f32_16x16x32_bf16 v[112:115], a[28:31], v[248:251], v[112:115]
 s_waitcnt lgkmcnt(7)
 ds_read_b64_tr_b16 a[58:59], v7 offset:26624
 v_mul_f32 v99, v99, v65
 v_mfma_f32_16x16x32_bf16 v[108:111], a[32:35], v[128:131], 0
 ds_read_b64_tr_b16 a[60:61], v7 offset:28672
 v_mul_f32 v100, v100, v65
 v_mfma_f32_16x16x32_bf16 v[108:111], a[36:39], v[136:139], v[108:111]
 ds_read_b64_tr_b16 a[62:63], v7 offset:30720
 v_xor_b32 v4, 0x20000, v4
 v_mfma_f32_16x16x32_bf16 v[108:111], a[40:43], v[144:147], v[108:111]
 s_waitcnt lgkmcnt(4)
 ds_read_b64_tr_b16 a[0:1], v4 offset:0
 v_mul_f32 v101, v101, v65
 v_mfma_f32_16x16x32_bf16 v[108:111], a[44:47], v[152:155], v[108:111]
 ds_read_b64_tr_b16 a[2:3], v4 offset:2048
 v_mul_f32 v102, v102, v65
 v_mfma_f32_16x16x32_bf16 v[108:111], a[48:51], v[160:163], v[108:111]
 ds_read_b64_tr_b16 a[4:5], v4 offset:4096
 v_mul_f32 v103, v103, v65
 v_mfma_f32_16x16x32_bf16 v[108:111], a[52:55], v[168:171], v[108:111]
 s_waitcnt lgkmcnt(3)
 ds_read_b64_tr_b16 a[6:7], v4 offset:6144
 v_cvt_pk_bf16_f32 v96, v96, v97
 v_mfma_f32_16x16x32_bf16 v[108:111], a[56:59], v[176:179], v[108:111]
 ds_read_b64_tr_b16 a[8:9], v4 offset:8192
 v_cvt_pk_bf16_f32 v97, v98, v99
 v_mfma_f32_16x16x32_bf16 v[108:111], a[60:63], v[184:187], v[108:111]
 ds_read_b64_tr_b16 a[10:11], v4 offset:10240
 v_cvt_pk_bf16_f32 v98, v100, v101
 v_mfma_f32_16x16x32_bf16 v[116:119], a[32:35], v[192:195], 0
 s_add_u32 s58, s48, 1081344
 ds_read_b64_tr_b16 a[12:13], v4 offset:12288
 v_cvt_pk_bf16_f32 v99, v102, v103
 v_mfma_f32_16x16x32_bf16 v[116:119], a[36:39], v[200:203], v[116:119]
 ds_read_b64_tr_b16 a[14:15], v4 offset:14336
 buffer_store_dwordx4 v[96:99], v1, s[12:15], s58 offen sc1
 v_mfma_f32_16x16x32_bf16 v[116:119], a[40:43], v[208:211], v[116:119]
 ds_read_b64_tr_b16 a[16:17], v4 offset:16384
 v_mul_f32 v104, v104, v64
 v_mfma_f32_16x16x32_bf16 v[116:119], a[44:47], v[216:219], v[116:119]
 ds_read_b64_tr_b16 a[18:19], v4 offset:18432
 v_mul_f32 v105, v105, v64
 v_mfma_f32_16x16x32_bf16 v[116:119], a[48:51], v[224:227], v[116:119]
 ds_read_b64_tr_b16 a[20:21], v4 offset:20480
 v_mul_f32 v106, v106, v64
 v_mfma_f32_16x16x32_bf16 v[116:119], a[52:55], v[232:235], v[116:119]
 ds_read_b64_tr_b16 a[22:23], v4 offset:22528
 v_mul_f32 v107, v107, v64
 v_mfma_f32_16x16x32_bf16 v[116:119], a[56:59], v[240:243], v[116:119]
 ds_read_b64_tr_b16 a[24:25], v4 offset:24576
 v_mul_f32 v108, v108, v64
 v_mfma_f32_16x16x32_bf16 v[116:119], a[60:63], v[248:251], v[116:119]
 s_waitcnt lgkmcnt(7)
 ds_read_b64_tr_b16 a[26:27], v4 offset:26624
 v_mul_f32 v109, v109, v64
 v_mfma_f32_16x16x32_bf16 v[72:75], a[0:3], v[128:131], 0
 ds_read_b64_tr_b16 a[28:29], v4 offset:28672
 v_mul_f32 v110, v110, v64
 v_mfma_f32_16x16x32_bf16 v[72:75], a[4:7], v[136:139], v[72:75]
 ds_read_b64_tr_b16 a[30:31], v4 offset:30720
 v_xor_b32 v5, 0x20000, v5
 v_mfma_f32_16x16x32_bf16 v[72:75], a[8:11], v[144:147], v[72:75]
 s_waitcnt lgkmcnt(4)
 ds_read_b64_tr_b16 a[32:33], v5 offset:0
 v_mul_f32 v111, v111, v64
 v_mfma_f32_16x16x32_bf16 v[72:75], a[12:15], v[152:155], v[72:75]
 ds_read_b64_tr_b16 a[34:35], v5 offset:2048
 v_cvt_pk_bf16_f32 v104, v104, v105
 v_mfma_f32_16x16x32_bf16 v[72:75], a[16:19], v[160:163], v[72:75]
 ds_read_b64_tr_b16 a[36:37], v5 offset:4096
 v_cvt_pk_bf16_f32 v105, v106, v107
 v_mfma_f32_16x16x32_bf16 v[72:75], a[20:23], v[168:171], v[72:75]
 s_waitcnt lgkmcnt(3)
 ds_read_b64_tr_b16 a[38:39], v5 offset:6144
 v_cvt_pk_bf16_f32 v106, v108, v109
 v_mfma_f32_16x16x32_bf16 v[72:75], a[24:27], v[176:179], v[72:75]
 s_add_u32 s58, s48, 180224
 ds_read_b64_tr_b16 a[40:41], v5 offset:8192
 v_cvt_pk_bf16_f32 v107, v110, v111
 v_mfma_f32_16x16x32_bf16 v[72:75], a[28:31], v[184:187], v[72:75]
 ds_read_b64_tr_b16 a[42:43], v5 offset:10240
 buffer_store_dwordx4 v[104:107], v1, s[12:15], s58 offen sc1
 v_mfma_f32_16x16x32_bf16 v[80:83], a[0:3], v[192:195], 0
 ds_read_b64_tr_b16 a[44:45], v5 offset:12288
 v_mul_f32 v112, v112, v65
 v_mfma_f32_16x16x32_bf16 v[80:83], a[4:7], v[200:203], v[80:83]
 ds_read_b64_tr_b16 a[46:47], v5 offset:14336
 v_mul_f32 v113, v113, v65
 v_mfma_f32_16x16x32_bf16 v[80:83], a[8:11], v[208:211], v[80:83]
 ds_read_b64_tr_b16 a[48:49], v5 offset:16384
 v_mul_f32 v114, v114, v65
 v_mfma_f32_16x16x32_bf16 v[80:83], a[12:15], v[216:219], v[80:83]
 ds_read_b64_tr_b16 a[50:51], v5 offset:18432
 v_mul_f32 v115, v115, v65
 v_mfma_f32_16x16x32_bf16 v[80:83], a[16:19], v[224:227], v[80:83]
 ds_read_b64_tr_b16 a[52:53], v5 offset:20480
 v_mul_f32 v116, v116, v65
 v_mfma_f32_16x16x32_bf16 v[80:83], a[20:23], v[232:235], v[80:83]
 ds_read_b64_tr_b16 a[54:55], v5 offset:22528
 v_mul_f32 v117, v117, v65
 v_mfma_f32_16x16x32_bf16 v[80:83], a[24:27], v[240:243], v[80:83]
 ds_read_b64_tr_b16 a[56:57], v5 offset:24576
 v_mul_f32 v118, v118, v65
 v_mfma_f32_16x16x32_bf16 v[80:83], a[28:31], v[248:251], v[80:83]
 s_waitcnt lgkmcnt(7)
 ds_read_b64_tr_b16 a[58:59], v5 offset:26624
 v_mul_f32 v119, v119, v65
 v_mfma_f32_16x16x32_bf16 v[76:79], a[32:35], v[128:131], 0
 ds_read_b64_tr_b16 a[60:61], v5 offset:28672
 v_cvt_pk_bf16_f32 v112, v112, v113
 v_mfma_f32_16x16x32_bf16 v[76:79], a[36:39], v[136:139], v[76:79]
 ds_read_b64_tr_b16 a[62:63], v5 offset:30720
 v_xor_b32 v6, 0x20000, v6
 v_mfma_f32_16x16x32_bf16 v[76:79], a[40:43], v[144:147], v[76:79]
 s_waitcnt lgkmcnt(4)
 ds_read_b64_tr_b16 a[0:1], v6 offset:0
 v_cvt_pk_bf16_f32 v113, v114, v115
 v_mfma_f32_16x16x32_bf16 v[76:79], a[44:47], v[152:155], v[76:79]
 ds_read_b64_tr_b16 a[2:3], v6 offset:2048
 v_cvt_pk_bf16_f32 v114, v116, v117
 v_mfma_f32_16x16x32_bf16 v[76:79], a[48:51], v[160:163], v[76:79]
 s_add_u32 s58, s48, 1097728
 ds_read_b64_tr_b16 a[4:5], v6 offset:4096
 v_cvt_pk_bf16_f32 v115, v118, v119
 v_mfma_f32_16x16x32_bf16 v[76:79], a[52:55], v[168:171], v[76:79]
 s_waitcnt lgkmcnt(3)
 ds_read_b64_tr_b16 a[6:7], v6 offset:6144
 buffer_store_dwordx4 v[112:115], v1, s[12:15], s58 offen sc1
 v_mfma_f32_16x16x32_bf16 v[76:79], a[56:59], v[176:179], v[76:79]
 ds_read_b64_tr_b16 a[8:9], v6 offset:8192
 v_mul_f32 v72, v72, v64
 v_mfma_f32_16x16x32_bf16 v[76:79], a[60:63], v[184:187], v[76:79]
 ds_read_b64_tr_b16 a[10:11], v6 offset:10240
 v_mul_f32 v73, v73, v64
 v_mfma_f32_16x16x32_bf16 v[84:87], a[32:35], v[192:195], 0
 ds_read_b64_tr_b16 a[12:13], v6 offset:12288
 buffer_load_dword v12, v10, s[12:15], s44 offen sc1
 v_mfma_f32_16x16x32_bf16 v[84:87], a[36:39], v[200:203], v[84:87]
 ds_read_b64_tr_b16 a[14:15], v6 offset:14336
 v_mul_f32 v74, v74, v64
 v_mfma_f32_16x16x32_bf16 v[84:87], a[40:43], v[208:211], v[84:87]
 ds_read_b64_tr_b16 a[16:17], v6 offset:16384
 v_mul_f32 v75, v75, v64
 v_mfma_f32_16x16x32_bf16 v[84:87], a[44:47], v[216:219], v[84:87]
 ds_read_b64_tr_b16 a[18:19], v6 offset:18432
 v_mul_f32 v80, v80, v65
 v_mfma_f32_16x16x32_bf16 v[84:87], a[48:51], v[224:227], v[84:87]
 ds_read_b64_tr_b16 a[20:21], v6 offset:20480
 v_mul_f32 v76, v76, v64
 v_mfma_f32_16x16x32_bf16 v[84:87], a[52:55], v[232:235], v[84:87]
 ds_read_b64_tr_b16 a[22:23], v6 offset:22528
 v_mul_f32 v77, v77, v64
 v_mfma_f32_16x16x32_bf16 v[84:87], a[56:59], v[240:243], v[84:87]
 ds_read_b64_tr_b16 a[24:25], v6 offset:24576
 v_mul_f32 v78, v78, v64
 v_mfma_f32_16x16x32_bf16 v[84:87], a[60:63], v[248:251], v[84:87]
 s_waitcnt lgkmcnt(7)
 ds_read_b64_tr_b16 a[26:27], v6 offset:26624
 v_mul_f32 v79, v79, v64
 v_mfma_f32_16x16x32_bf16 v[88:91], a[0:3], v[128:131], 0
 ds_read_b64_tr_b16 a[28:29], v6 offset:28672
 v_cvt_pk_bf16_f32 v72, v72, v73
 v_mfma_f32_16x16x32_bf16 v[88:91], a[4:7], v[136:139], v[88:91]
 ds_read_b64_tr_b16 a[30:31], v6 offset:30720
 v_xor_b32 v7, 0x20000, v7
 v_mfma_f32_16x16x32_bf16 v[88:91], a[8:11], v[144:147], v[88:91]
 s_waitcnt lgkmcnt(4)
 ds_read_b64_tr_b16 a[32:33], v7 offset:0
 v_cvt_pk_bf16_f32 v73, v74, v75
 v_mfma_f32_16x16x32_bf16 v[88:91], a[12:15], v[152:155], v[88:91]
 ds_read_b64_tr_b16 a[34:35], v7 offset:2048
 v_cvt_pk_bf16_f32 v74, v76, v77
 v_mfma_f32_16x16x32_bf16 v[88:91], a[16:19], v[160:163], v[88:91]
 s_add_u32 s58, s48, 196608
 ds_read_b64_tr_b16 a[36:37], v7 offset:4096
 v_cvt_pk_bf16_f32 v75, v78, v79
 v_mfma_f32_16x16x32_bf16 v[88:91], a[20:23], v[168:171], v[88:91]
 s_waitcnt lgkmcnt(3)
 ds_read_b64_tr_b16 a[38:39], v7 offset:6144
 buffer_store_dwordx4 v[72:75], v1, s[12:15], s58 offen sc1
 v_mfma_f32_16x16x32_bf16 v[88:91], a[24:27], v[176:179], v[88:91]
 ds_read_b64_tr_b16 a[40:41], v7 offset:8192
 v_mul_f32 v81, v81, v65
 v_mfma_f32_16x16x32_bf16 v[88:91], a[28:31], v[184:187], v[88:91]
 ds_read_b64_tr_b16 a[42:43], v7 offset:10240
 v_mul_f32 v82, v82, v65
 v_mfma_f32_16x16x32_bf16 v[96:99], a[0:3], v[192:195], 0
 ds_read_b64_tr_b16 a[44:45], v7 offset:12288
 v_mul_f32 v83, v83, v65
 v_mfma_f32_16x16x32_bf16 v[96:99], a[4:7], v[200:203], v[96:99]
 ds_read_b64_tr_b16 a[46:47], v7 offset:14336
 v_mul_f32 v84, v84, v65
 v_mfma_f32_16x16x32_bf16 v[96:99], a[8:11], v[208:211], v[96:99]
 ds_read_b64_tr_b16 a[48:49], v7 offset:16384
 v_mul_f32 v85, v85, v65
 v_mfma_f32_16x16x32_bf16 v[96:99], a[12:15], v[216:219], v[96:99]
 ds_read_b64_tr_b16 a[50:51], v7 offset:18432
 v_mul_f32 v86, v86, v65
 v_mfma_f32_16x16x32_bf16 v[96:99], a[16:19], v[224:227], v[96:99]
 ds_read_b64_tr_b16 a[52:53], v7 offset:20480
 v_mul_f32 v87, v87, v65
 v_mfma_f32_16x16x32_bf16 v[96:99], a[20:23], v[232:235], v[96:99]
 ds_read_b64_tr_b16 a[54:55], v7 offset:22528
 v_cvt_pk_bf16_f32 v80, v80, v81
 v_mfma_f32_16x16x32_bf16 v[96:99], a[24:27], v[240:243], v[96:99]
 ds_read_b64_tr_b16 a[56:57], v7 offset:24576
 v_cvt_pk_bf16_f32 v81, v82, v83
 v_mfma_f32_16x16x32_bf16 v[96:99], a[28:31], v[248:251], v[96:99]
 s_waitcnt lgkmcnt(7)
 ds_read_b64_tr_b16 a[58:59], v7 offset:26624
 v_cvt_pk_bf16_f32 v82, v84, v85
 v_mfma_f32_16x16x32_bf16 v[92:95], a[32:35], v[128:131], 0
 s_add_u32 s58, s48, 1114112
 ds_read_b64_tr_b16 a[60:61], v7 offset:28672
 v_cvt_pk_bf16_f32 v83, v86, v87
 v_mfma_f32_16x16x32_bf16 v[92:95], a[36:39], v[136:139], v[92:95]
 ds_read_b64_tr_b16 a[62:63], v7 offset:30720
 buffer_store_dwordx4 v[80:83], v1, s[12:15], s58 offen sc1
 v_mfma_f32_16x16x32_bf16 v[92:95], a[40:43], v[144:147], v[92:95]
 s_waitcnt lgkmcnt(4)
 v_mul_f32 v88, v88, v64
 v_mul_f32 v89, v89, v64
 v_mfma_f32_16x16x32_bf16 v[92:95], a[44:47], v[152:155], v[92:95]
 v_mul_f32 v90, v90, v64
 v_mul_f32 v91, v91, v64
 v_mfma_f32_16x16x32_bf16 v[92:95], a[48:51], v[160:163], v[92:95]
 v_mul_f32 v96, v96, v65
 v_mul_f32 v97, v97, v65
 v_mfma_f32_16x16x32_bf16 v[92:95], a[52:55], v[168:171], v[92:95]
 s_waitcnt lgkmcnt(0)
 v_mul_f32 v98, v98, v65
 v_mul_f32 v99, v99, v65
 v_mfma_f32_16x16x32_bf16 v[92:95], a[56:59], v[176:179], v[92:95]
 v_mfma_f32_16x16x32_bf16 v[92:95], a[60:63], v[184:187], v[92:95]
 v_mfma_f32_16x16x32_bf16 v[100:103], a[32:35], v[192:195], 0
 v_mfma_f32_16x16x32_bf16 v[100:103], a[36:39], v[200:203], v[100:103]
 v_mfma_f32_16x16x32_bf16 v[100:103], a[40:43], v[208:211], v[100:103]
 v_mfma_f32_16x16x32_bf16 v[100:103], a[44:47], v[216:219], v[100:103]
 v_mfma_f32_16x16x32_bf16 v[100:103], a[48:51], v[224:227], v[100:103]
 v_mfma_f32_16x16x32_bf16 v[100:103], a[52:55], v[232:235], v[100:103]
 v_mfma_f32_16x16x32_bf16 v[100:103], a[56:59], v[240:243], v[100:103]
 v_mfma_f32_16x16x32_bf16 v[100:103], a[60:63], v[248:251], v[100:103]
 s_nop 4
 v_mul_f32 v92, v92, v64
 v_mul_f32 v93, v93, v64
 v_mul_f32 v94, v94, v64
 v_mul_f32 v95, v95, v64
 v_cvt_pk_bf16_f32 v88, v88, v89
 v_cvt_pk_bf16_f32 v89, v90, v91
 v_cvt_pk_bf16_f32 v90, v92, v93
 v_cvt_pk_bf16_f32 v91, v94, v95
 s_add_u32 s58, s48, 212992
 buffer_store_dwordx4 v[88:91], v1, s[12:15], s58 offen sc1
 v_mul_f32 v100, v100, v65
 v_mul_f32 v101, v101, v65
 v_mul_f32 v102, v102, v65
 v_mul_f32 v103, v103, v65
 v_cvt_pk_bf16_f32 v96, v96, v97
 v_cvt_pk_bf16_f32 v97, v98, v99
 v_cvt_pk_bf16_f32 v98, v100, v101
 v_cvt_pk_bf16_f32 v99, v102, v103
 s_add_u32 s58, s48, 1130496
 buffer_store_dwordx4 v[96:99], v1, s[12:15], s58 offen sc1
 s_cmp_ge_u32 s28, 14
 s_cbranch_scc1 L_idle
 s_waitcnt vmcnt(4)
 v_cmp_ne_u32 vcc, 0, v12
 s_cmp_eq_u64 vcc, 0
 s_cselect_b32 s50, 1, 0
 s_cselect_b32 s51, s38, 2.0
 buffer_load_dwordx4 a[128:131], v1, s[12:15], s51 offen offset:0 sc1
 s_lshl_b32 s42, s42, 4
 s_lshl_b32 s36, s41, 6
 s_add_u32 s36, s36, 896
 s_add_u32 s35, s36, 1835008
 s_add_u32 s39, s37, 14680064
 buffer_load_dwordx4 a[132:135], v1, s[12:15], s51 offen offset:1024 sc1
 s_mov_b32 s8, s88
 s_mov_b32 s9, s89
 s_mov_b32 s10, 3670016
 s_mov_b32 s11, 0x20000
 buffer_load_dwordx4 a[136:139], v1, s[12:15], s51 offen offset:2048 sc1
 v_and_b32 v2, 15, v0
 v_add_u32 v2, s42, v2
 v_mul_u32_u24 v7, 896, v2
 v_lshrrev_b32 v3, 4, v0
 buffer_load_dwordx4 a[140:143], v1, s[12:15], s51 offen offset:3072 sc1
 v_lshlrev_b32 v8, 4, v3
 v_lshl_add_u32 v2, v7, 1, v8
 v_add_u32 v7, v7, v8
 v_and_b32 v4, 1, v0
 v_lshlrev_b32 v4, 4, v4
 s_add_u32 s51, s51, 4096
 v_mov_b32 v5, 0x3f80
 v_lshlrev_b32 v4, v4, v5
 v_bfe_u32 v5, v0, 3, 1
 v_bfe_u32 v6, v0, 1, 1
 buffer_load_dwordx4 a[144:147], v1, s[12:15], s51 offen offset:0 sc1
 v_lshl_add_u32 v5, v5, 1, v6
 v_bfe_u32 v6, v0, 2, 1
 v_lshlrev_b32 v6, 1, v6
 v_sub_u32 v6, v3, v6
 buffer_load_dwordx4 a[148:151], v1, s[12:15], s51 offen offset:1024 sc1
 v_lshl_add_u32 v5, v6, 2, v5
 v_cmp_eq_u32 s[16:17], 0, v5
 v_cmp_eq_u32 s[18:19], 1, v5
 v_cmp_eq_u32 s[20:21], 2, v5
 v_cmp_eq_u32 s[22:23], 3, v5
 buffer_load_dwordx4 a[152:155], v1, s[12:15], s51 offen offset:2048 sc1
 v_cndmask_b32 v24, 0, v4, s[16:17]
 v_cndmask_b32 v25, 0, v4, s[18:19]
 v_cndmask_b32 v26, 0, v4, s[20:21]
 v_cndmask_b32 v27, 0, v4, s[22:23]
 buffer_load_dwordx4 a[156:159], v1, s[12:15], s51 offen offset:3072 sc1
 v_cmp_eq_u32 s[16:17], 4, v5
 v_cmp_eq_u32 s[18:19], 5, v5
 v_cmp_eq_u32 s[20:21], 6, v5
 v_cmp_eq_u32 s[22:23], 7, v5
 s_add_u32 s51, s51, 4096
 v_cndmask_b32 v28, 0, v4, s[16:17]
 v_cndmask_b32 v29, 0, v4, s[18:19]
 v_cndmask_b32 v30, 0, v4, s[20:21]
 v_cndmask_b32 v31, 0, v4, s[22:23]
 s_add_u32 s45, s44, 1024
 s_add_u32 s39, s39, 114688
 s_waitcnt vmcnt(8)
 s_barrier
 buffer_store_dword v9, v9, s[12:15], s93 offen sc1
 buffer_load_dwordx4 a[160:163], v1, s[12:15], s51 offen offset:0 sc1
 buffer_load_dwordx4 a[164:167], v1, s[12:15], s51 offen offset:1024 sc1
 buffer_load_dwordx4 a[168:171], v1, s[12:15], s51 offen offset:2048 sc1
 buffer_load_dwordx4 a[172:175], v1, s[12:15], s51 offen offset:3072 sc1
 s_add_u32 s51, s51, 4096
 buffer_load_dwordx4 a[176:179], v1, s[12:15], s51 offen offset:0 sc1
 buffer_load_dwordx4 a[180:183], v1, s[12:15], s51 offen offset:1024 sc1
 buffer_load_dwordx4 a[184:187], v1, s[12:15], s51 offen offset:2048 sc1
 buffer_load_dwordx4 a[188:191], v1, s[12:15], s51 offen offset:3072 sc1
 s_add_u32 s51, s51, 4096
 s_and_b32 s51, s49, s50
 s_cbranch_scc1 L_haveshort
 v_and_b32 v16, 15, v0
 v_lshlrev_b32 v16, 2, v16
 s_mov_b32 s32, 0
L_poll5:
 buffer_load_dword v17, v16, s[12:15], s44 offen sc1
 s_waitcnt vmcnt(0)
 v_cmp_ne_u32 vcc, 0, v17
 s_cbranch_vccz L_poll5_ok
 s_sleep 8
 s_add_u32 s32, s32, 1
 s_cmp_lt_u32 s32, 0x80000
 s_cbranch_scc1 L_poll5
L_poll5_ok:
 s_cmp_eq_u32 s49, 1
 s_cbranch_scc1 L_have1
 buffer_load_dwordx4 a[64:67], v1, s[12:15], s37 offen offset:0 sc1
 buffer_load_dwordx4 a[68:71], v1, s[12:15], s37 offen offset:1024 sc1
 buffer_load_dwordx4 a[72:75], v1, s[12:15], s37 offen offset:2048 sc1
 buffer_load_dwordx4 a[76:79], v1, s[12:15], s37 offen offset:3072 sc1
 s_add_u32 s37, s37, 4096
 buffer_load_dwordx4 a[80:83], v1, s[12:15], s37 offen offset:0 sc1
 buffer_load_dwordx4 a[84:87], v1, s[12:15], s37 offen offset:1024 sc1
 buffer_load_dwordx4 a[88:91], v1, s[12:15], s37 offen offset:2048 sc1
 buffer_load_dwordx4 a[92:95], v1, s[12:15], s37 offen offset:3072 sc1
 s_add_u32 s37, s37, 4096
 buffer_load_dwordx4 a[96:99], v1, s[12:15], s37 offen offset:0 sc1
 buffer_load_dwordx4 a[100:103], v1, s[12:15], s37 offen offset:1024 sc1
 buffer_load_dwordx4 a[104:107], v1, s[12:15], s37 offen offset:2048 sc1
 buffer_load_dwordx4 a[108:111], v1, s[12:15], s37 offen offset:3072 sc1
 s_add_u32 s37, s37, 4096
 buffer_load_dwordx4 a[112:115], v1, s[12:15], s37 offen offset:0 sc1
 buffer_load_dwordx4 a[116:119], v1, s[12:15], s37 offen offset:1024 sc1
 buffer_load_dwordx4 a[120:123], v1, s[12:15], s37 offen offset:2048 sc1
 buffer_load_dwordx4 a[124:127], v1, s[12:15], s37 offen offset:3072 sc1
 s_add_u32 s37, s37, 4096
L_have1:
 s_cmp_eq_u32 s50, 1
 s_cbranch_scc1 L_have2
 buffer_load_dwordx4 a[128:131], v1, s[12:15], s38 offen offset:0 sc1
 buffer_load_dwordx4 a[132:135], v1, s[12:15], s38 offen offset:1024 sc1
 buffer_load_dwordx4 a[136:139], v1, s[12:15], s38 offen offset:2048 sc1
 buffer_load_dwordx4 a[140:143], v1, s[12:15], s38 offen offset:3072 sc1
 s_add_u32 s38, s38, 4096
 buffer_load_dwordx4 a[144:147], v1, s[12:15], s38 offen offset:0 sc1
 buffer_load_dwordx4 a[148:151], v1, s[12:15], s38 offen offset:1024 sc1
 buffer_load_dwordx4 a[152:155], v1, s[12:15], s38 offen offset:2048 sc1
 buffer_load_dwordx4 a[156:159], v1, s[12:15], s38 offen offset:3072 sc1
 s_add_u32 s38, s38, 4096
 buffer_load_dwordx4 a[160:163], v1, s[12:15], s38 offen offset:0 sc1
 buffer_load_dwordx4 a[164:167], v1, s[12:15], s38 offen offset:1024 sc1
 buffer_load_dwordx4 a[168:171], v1, s[12:15], s38 offen offset:2048 sc1
 buffer_load_dwordx4 a[172:175], v1, s[12:15], s38 offen offset:3072 sc1
 s_add_u32 s38, s38, 4096
 buffer_load_dwordx4 a[176:179], v1, s[12:15], s38 offen offset:0 sc1
 buffer_load_dwordx4 a[180:183], v1, s[12:15], s38 offen offset:1024 sc1
 buffer_load_dwordx4 a[184:187], v1, s[12:15], s38 offen offset:2048 sc1
 buffer_load_dwordx4 a[188:191], v1, s[12:15], s38 offen offset:3072 sc1
 s_add_u32 s38, s38, 4096
L_have2:
 s_waitcnt vmcnt(0)
L_haveshort:
 v_mfma_f32_16x16x32_bf16 v[32:35], v[24:27], a[64:67], 0
 v_mfma_f32_16x16x32_bf16 v[36:39], v[28:31], a[64:67], 0
 v_mfma_f32_16x16x32_bf16 v[32:35], v[24:27], a[68:71], v[32:35]
 v_mfma_f32_16x16x32_bf16 v[36:39], v[28:31], a[68:71], v[36:39]
 v_mfma_f32_16x16x32_bf16 v[32:35], v[24:27], a[72:75], v[32:35]
 v_mfma_f32_16x16x32_bf16 v[36:39], v[28:31], a[72:75], v[36:39]
 v_mfma_f32_16x16x32_bf16 v[32:35], v[24:27], a[76:79], v[32:35]
 v_mfma_f32_16x16x32_bf16 v[36:39], v[28:31], a[76:79], v[36:39]
 v_mfma_f32_16x16x32_bf16 v[32:35], v[24:27], a[80:83], v[32:35]
 v_mfma_f32_16x16x32_bf16 v[36:39], v[28:31], a[80:83], v[36:39]
 v_mfma_f32_16x16x32_bf16 v[32:35], v[24:27], a[84:87], v[32:35]
 v_mfma_f32_16x16x32_bf16 v[36:39], v[28:31], a[84:87], v[36:39]
 v_mfma_f32_16x16x32_bf16 v[32:35], v[24:27], a[88:91], v[32:35]
 v_mfma_f32_16x16x32_bf16 v[36:39], v[28:31], a[88:91], v[36:39]
 v_mfma_f32_16x16x32_bf16 v[32:35], v[24:27], a[92:95], v[32:35]
 v_mfma_f32_16x16x32_bf16 v[36:39], v[28:31], a[92:95], v[36:39]
 v_mfma_f32_16x16x32_bf16 v[32:35], v[24:27], a[96:99], v[32:35]
 v_mfma_f32_16x16x32_bf16 v[36:39], v[28:31], a[96:99], v[36:39]
 v_mfma_f32_16x16x32_bf16 v[32:35], v[24:27], a[100:103], v[32:35]
 v_mfma_f32_16x16x32_bf16 v[36:39], v[28:31], a[100:103], v[36:39]
 v_mfma_f32_16x16x32_bf16 v[32:35], v[24:27], a[104:107], v[32:35]
 v_mfma_f32_16x16x32_bf16 v[36:39], v[28:31], a[104:107], v[36:39]
 v_mfma_f32_16x16x32_bf16 v[32:35], v[24:27], a[108:111], v[32:35]
 v_mfma_f32_16x16x32_bf16 v[36:39], v[28:31], a[108:111], v[36:39]
 v_mfma_f32_16x16x32_bf16 v[32:35], v[24:27], a[112:115], v[32:35]
 v_mfma_f32_16x16x32_bf16 v[36:39], v[28:31], a[112:115], v[36:39]
 v_mfma_f32_16x16x32_bf16 v[32:35], v[24:27], a[116:119], v[32:35]
 v_mfma_f32_16x16x32_bf16 v[36:39], v[28:31], a[116:119], v[36:39]
 v_mfma_f32_16x16x32_bf16 v[32:35], v[24:27], a[120:123], v[32:35]
 v_mfma_f32_16x16x32_bf16 v[36:39], v[28:31], a[120:123], v[36:39]
 v_mfma_f32_16x16x32_bf16 v[32:35], v[24:27], a[124:127], v[32:35]
 v_mfma_f32_16x16x32_bf16 v[36:39], v[28:31], a[124:127], v[36:39]
 v_and_b32 v17, 15, v0
 v_lshlrev_b32 v17, 2, v17
 buffer_load_dword a246, v17, s[12:15], s45 offen sc1
 s_waitcnt vmcnt(16)
 v_mfma_f32_16x16x32_bf16 v[40:43], v[24:27], a[128:131], 0
 v_mfma_f32_16x16x32_bf16 v[44:47], v[28:31], a[128:131], 0
 s_waitcnt vmcnt(15)
 v_mfma_f32_16x16x32_bf16 v[40:43], v[24:27], a[132:135], v[40:43]
 v_mfma_f32_16x16x32_bf16 v[44:47], v[28:31], a[132:135], v[44:47]
 s_waitcnt vmcnt(14)
 v_mfma_f32_16x16x32_bf16 v[40:43], v[24:27], a[136:139], v[40:43]
 v_mfma_f32_16x16x32_bf16 v[44:47], v[28:31], a[136:139], v[44:47]
 s_waitcnt vmcnt(13)
 v_mfma_f32_16x16x32_bf16 v[40:43], v[24:27], a[140:143], v[40:43]
 v_mfma_f32_16x16x32_bf16 v[44:47], v[28:31], a[140:143], v[44:47]
 s_waitcnt vmcnt(12)
 v_mfma_f32_16x16x32_bf16 v[40:43], v[24:27], a[144:147], v[40:43]
 v_mfma_f32_16x16x32_bf16 v[44:47], v[28:31], a[144:147], v[44:47]
 s_waitcnt vmcnt(11)
 v_mfma_f32_16x16x32_bf16 v[40:43], v[24:27], a[148:151], v[40:43]
 v_mfma_f32_16x16x32_bf16 v[44:47], v[28:31], a[148:151], v[44:47]
 s_waitcnt vmcnt(10)
 v_mfma_f32_16x16x32_bf16 v[40:43], v[24:27], a[152:155], v[40:43]
 v_mfma_f32_16x16x32_bf16 v[44:47], v[28:31], a[152:155], v[44:47]
 s_waitcnt vmcnt(9)
 v_mfma_f32_16x16x32_bf16 v[40:43], v[24:27], a[156:159], v[40:43]
 v_mfma_f32_16x16x32_bf16 v[44:47], v[28:31], a[156:159], v[44:47]
 s_waitcnt vmcnt(8)
 v_mfma_f32_16x16x32_bf16 v[40:43], v[24:27], a[160:163], v[40:43]
 v_mfma_f32_16x16x32_bf16 v[44:47], v[28:31], a[160:163], v[44:47]
 s_waitcnt vmcnt(7)
 v_mfma_f32_16x16x32_bf16 v[40:43], v[24:27], a[164:167], v[40:43]
 v_mfma_f32_16x16x32_bf16 v[44:47], v[28:31], a[164:167], v[44:47]
 s_waitcnt vmcnt(6)
 v_mfma_f32_16x16x32_bf16 v[40:43], v[24:27], a[168:171], v[40:43]
 v_mfma_f32_16x16x32_bf16 v[44:47], v[28:31], a[168:171], v[44:47]
 s_waitcnt vmcnt(5)
 v_mfma_f32_16x16x32_bf16 v[40:43], v[24:27], a[172:175], v[40:43]
 v_mfma_f32_16x16x32_bf16 v[44:47], v[28:31], a[172:175], v[44:47]
 s_waitcnt vmcnt(4)
 v_mfma_f32_16x16x32_bf16 v[40:43], v[24:27], a[176:179], v[40:43]
 v_mfma_f32_16x16x32_bf16 v[44:47], v[28:31], a[176:179], v[44:47]
 s_waitcnt vmcnt(3)
 v_mfma_f32_16x16x32_bf16 v[40:43], v[24:27], a[180:183], v[40:43]
 v_mfma_f32_16x16x32_bf16 v[44:47], v[28:31], a[180:183], v[44:47]
 s_waitcnt vmcnt(2)
 v_mfma_f32_16x16x32_bf16 v[40:43], v[24:27], a[184:187], v[40:43]
 v_mfma_f32_16x16x32_bf16 v[44:47], v[28:31], a[184:187], v[44:47]
 s_waitcnt vmcnt(1)
 v_mfma_f32_16x16x32_bf16 v[40:43], v[24:27], a[188:191], v[40:43]
 v_mfma_f32_16x16x32_bf16 v[44:47], v[28:31], a[188:191], v[44:47]
 v_cvt_pk_bf16_f32 v32, v32, v33
 v_cvt_pk_bf16_f32 v33, v34, v35
 v_cvt_pk_bf16_f32 v34, v36, v37
 v_cvt_pk_bf16_f32 v35, v38, v39
 buffer_store_dwordx4 v[32:35], v2, s[8:11], s36 offen offset:0
 s_nop 2
 v_cvt_pk_bf16_f32 v40, v40, v41
 v_cvt_pk_bf16_f32 v41, v42, v43
 v_cvt_pk_bf16_f32 v42, v44, v45
 v_cvt_pk_bf16_f32 v43, v46, v47
 buffer_store_dwordx4 v[40:43], v2, s[8:11], s36 offen offset:448
 s_waitcnt vmcnt(2)
 v_accvgpr_read_b32 v17, a246
 v_cmp_ne_u32 vcc, 0, v17
 s_cbranch_vccz L_poll6_ok
 v_and_b32 v16, 15, v0
 v_lshlrev_b32 v16, 2, v16
 s_mov_b32 s32, 0
L_poll6:
 buffer_load_dword v17, v16, s[12:15], s45 offen sc1
 s_waitcnt vmcnt(0)
 v_cmp_ne_u32 vcc, 0, v17
 s_cbranch_vccz L_poll6_ok
 s_sleep 8
 s_add_u32 s32, s32, 1
 s_cmp_lt_u32 s32, 0x80000
 s_cbranch_scc1 L_poll6
L_poll6_ok:
 buffer_load_dwordx4 a[0:3], v1, s[12:15], s39 offen offset:0 sc1
 buffer_load_dwordx4 a[4:7], v1, s[12:15], s39 offen offset:1024 sc1
 buffer_load_dwordx4 a[8:11], v1, s[12:15], s39 offen offset:2048 sc1
 buffer_load_dwordx4 a[12:15], v1, s[12:15], s39 offen offset:3072 sc1
 s_add_u32 s39, s39, 4096
 buffer_load_dwordx4 a[16:19], v1, s[12:15], s39 offen offset:0 sc1
 buffer_load_dwordx4 a[20:23], v1, s[12:15], s39 offen offset:1024 sc1
 buffer_load_dwordx4 a[24:27], v1, s[12:15], s39 offen offset:2048 sc1
 buffer_load_dwordx4 a[28:31], v1, s[12:15], s39 offen offset:3072 sc1
 s_add_u32 s39, s39, 4096
 buffer_load_dwordx4 a[32:35], v1, s[12:15], s39 offen offset:0 sc1
 buffer_load_dwordx4 a[36:39], v1, s[12:15], s39 offen offset:1024 sc1
 buffer_load_dwordx4 a[40:43], v1, s[12:15], s39 offen offset:2048 sc1
 buffer_load_dwordx4 a[44:47], v1, s[12:15], s39 offen offset:3072 sc1
 s_add_u32 s39, s39, 4096
 buffer_load_dwordx4 a[48:51], v1, s[12:15], s39 offen offset:0 sc1
 buffer_load_dwordx4 a[52:55], v1, s[12:15], s39 offen offset:1024 sc1
 buffer_load_dwordx4 a[56:59], v1, s[12:15], s39 offen offset:2048 sc1
 buffer_load_dwordx4 a[60:63], v1, s[12:15], s39 offen offset:3072 sc1
 s_add_u32 s39, s39, 4096
 s_waitcnt vmcnt(15)
 v_mfma_f32_16x16x32_bf16 v[48:51], v[24:27], a[0:3], 0
 v_mfma_f32_16x16x32_bf16 v[52:55], v[28:31], a[0:3], 0
 s_waitcnt vmcnt(14)
 v_mfma_f32_16x16x32_bf16 v[48:51], v[24:27], a[4:7], v[48:51]
 v_mfma_f32_16x16x32_bf16 v[52:55], v[28:31], a[4:7], v[52:55]
 s_waitcnt vmcnt(13)
 v_mfma_f32_16x16x32_bf16 v[48:51], v[24:27], a[8:11], v[48:51]
 v_mfma_f32_16x16x32_bf16 v[52:55], v[28:31], a[8:11], v[52:55]
 s_waitcnt vmcnt(12)
 v_mfma_f32_16x16x32_bf16 v[48:51], v[24:27], a[12:15], v[48:51]
 v_mfma_f32_16x16x32_bf16 v[52:55], v[28:31], a[12:15], v[52:55]
 s_waitcnt vmcnt(11)
 v_mfma_f32_16x16x32_bf16 v[48:51], v[24:27], a[16:19], v[48:51]
 v_mfma_f32_16x16x32_bf16 v[52:55], v[28:31], a[16:19], v[52:55]
 s_waitcnt vmcnt(10)
 v_mfma_f32_16x16x32_bf16 v[48:51], v[24:27], a[20:23], v[48:51]
 v_mfma_f32_16x16x32_bf16 v[52:55], v[28:31], a[20:23], v[52:55]
 s_waitcnt vmcnt(9)
 v_mfma_f32_16x16x32_bf16 v[48:51], v[24:27], a[24:27], v[48:51]
 v_mfma_f32_16x16x32_bf16 v[52:55], v[28:31], a[24:27], v[52:55]
 s_waitcnt vmcnt(8)
 v_mfma_f32_16x16x32_bf16 v[48:51], v[24:27], a[28:31], v[48:51]
 v_mfma_f32_16x16x32_bf16 v[52:55], v[28:31], a[28:31], v[52:55]
 s_waitcnt vmcnt(7)
 v_mfma_f32_16x16x32_bf16 v[48:51], v[24:27], a[32:35], v[48:51]
 v_mfma_f32_16x16x32_bf16 v[52:55], v[28:31], a[32:35], v[52:55]
 s_waitcnt vmcnt(6)
 v_mfma_f32_16x16x32_bf16 v[48:51], v[24:27], a[36:39], v[48:51]
 v_mfma_f32_16x16x32_bf16 v[52:55], v[28:31], a[36:39], v[52:55]
 s_waitcnt vmcnt(5)
 v_mfma_f32_16x16x32_bf16 v[48:51], v[24:27], a[40:43], v[48:51]
 v_mfma_f32_16x16x32_bf16 v[52:55], v[28:31], a[40:43], v[52:55]
 s_waitcnt vmcnt(4)
 v_mfma_f32_16x16x32_bf16 v[48:51], v[24:27], a[44:47], v[48:51]
 v_mfma_f32_16x16x32_bf16 v[52:55], v[28:31], a[44:47], v[52:55]
 s_waitcnt vmcnt(3)
 v_mfma_f32_16x16x32_bf16 v[48:51], v[24:27], a[48:51], v[48:51]
 v_mfma_f32_16x16x32_bf16 v[52:55], v[28:31], a[48:51], v[52:55]
 s_waitcnt vmcnt(2)
 v_mfma_f32_16x16x32_bf16 v[48:51], v[24:27], a[52:55], v[48:51]
 v_mfma_f32_16x16x32_bf16 v[52:55], v[28:31], a[52:55], v[52:55]
 s_waitcnt vmcnt(1)
 v_mfma_f32_16x16x32_bf16 v[48:51], v[24:27], a[56:59], v[48:51]
 v_mfma_f32_16x16x32_bf16 v[52:55], v[28:31], a[56:59], v[52:55]
 s_waitcnt vmcnt(0)
 v_mfma_f32_16x16x32_bf16 v[48:51], v[24:27], a[60:63], v[48:51]
 v_mfma_f32_16x16x32_bf16 v[52:55], v[28:31], a[60:63], v[52:55]
 s_nop 7
 v_cvt_pk_bf16_f32 v48, v48, v49
 v_cvt_pk_bf16_f32 v49, v50, v51
 v_cvt_pk_bf16_f32 v50, v52, v53
 v_cvt_pk_bf16_f32 v51, v54, v55
 buffer_store_dwordx4 v[48:51], v2, s[8:11], s35 offen offset:448
 s_branch L_fin
L_idle:
 s_waitcnt vmcnt(0)
 s_barrier
 s_cmp_lg_u32 s3, 0
 s_cbranch_scc1 L_pub7
 v_mov_b32 v11, 0
 s_mov_b64 exec, 1
 buffer_store_dword v11, v11, s[12:15], s93 offen sc1
 s_mov_b64 exec, -1
L_pub7:
 s_branch L_fin
L_opB:
 v_lshrrev_b32 v8, 2, v0
 v_lshlrev_b32 v4, 7, v8
 v_bfe_u32 v8, v8, 1, 2
 v_lshl_add_u32 v4, v8, 5, v4
 v_and_b32 v8, 3, v0
 v_lshl_add_u32 v4, v8, 3, v4
 v_add_u32 v4, 131072, v4
 s_barrier
 ds_read_b64_tr_b16 a[0:1], v4 offset:0
 ds_read_b64_tr_b16 a[2:3], v4 offset:2048
 ds_read_b64_tr_b16 a[4:5], v4 offset:4096
 ds_read_b64_tr_b16 a[6:7], v4 offset:6144
 ds_read_b64_tr_b16 a[8:9], v4 offset:8192
 ds_read_b64_tr_b16 a[10:11], v4 offset:10240
 ds_read_b64_tr_b16 a[12:13], v4 offset:12288
 ds_read_b64_tr_b16 a[14:15], v4 offset:14336
 ds_read_b64_tr_b16 a[16:17], v4 offset:16384
 ds_read_b64_tr_b16 a[18:19], v4 offset:18432
 ds_read_b64_tr_b16 a[20:21], v4 offset:20480
 ds_read_b64_tr_b16 a[22:23], v4 offset:22528
 ds_read_b64_tr_b16 a[24:25], v4 offset:24576
 ds_read_b64_tr_b16 a[26:27], v4 offset:26624
 v_xor_b32 v5, 32, v4
 v_xor_b32 v6, 64, v4
 v_xor_b32 v7, 96, v4
 s_lshl_b32 s34, s95, 2
 s_add_u32 s34, s34, s3
 s_lshl_b32 s34, s34, 12
 s_cmp_eq_u32 s62, 0
 s_cmov_b32 s34, 2.0
 s_add_u32 s35, s34, 85983232
 s_mul_i32 s33, s3, 8736
 s_add_u32 s33, s33, 0x10000
 s_mov_b32 s4, s72
 s_mov_b32 s5, s73
 s_mov_b32 s6, 1835008
 s_mov_b32 s7, 0x20000
 v_lshrrev_b32 v10, 1, v0
 v_lshlrev_b32 v10, 7, v10
 v_and_b32 v11, 1, v0
 v_lshl_add_u32 v10, v11, 4, v10
 v_and_b32 v11, 31, v0
 v_lshl_add_u32 v11, v11, 2, s33
 v_and_b32 v12, 7, v0
 v_lshl_add_u32 v12, v12, 2, s33
 v_mov_b32 v13, 0
 v_accvgpr_read_b32 v9, a245
 s_lshl_b32 s48, s63, 3
 s_add_u32 s48, s48, s3
 s_mul_i32 s48, s48, 229376
 s_lshl_b32 s58, s26, 10
 s_add_u32 s48, s48, s58
 s_add_u32 s48, s48, 117440512
 s_waitcnt lgkmcnt(7)
 v_mfma_f32_16x16x32_bf16 v[72:75], a[0:3], a[128:131], 0
 ds_read_b64_tr_b16 a[28:29], v4 offset:28672
 buffer_store_dwordx4 v[68:71], v1, s[12:15], s57 offen sc1
 v_mfma_f32_16x16x32_bf16 v[72:75], a[4:7], a[132:135], v[72:75]
 ds_read_b64_tr_b16 a[30:31], v4 offset:30720
 v_mfma_f32_16x16x32_bf16 v[72:75], a[8:11], a[136:139], v[72:75]
 s_waitcnt lgkmcnt(4)
 ds_read_b64_tr_b16 a[32:33], v5 offset:0
 v_mfma_f32_16x16x32_bf16 v[72:75], a[12:15], a[140:143], v[72:75]
 ds_read_b64_tr_b16 a[34:35], v5 offset:2048
 buffer_store_dwordx4 v[168:171], v3, s[12:15], s55 offen offset:1024 sc1
 v_mfma_f32_16x16x32_bf16 v[72:75], a[16:19], a[144:147], v[72:75]
 ds_read_b64_tr_b16 a[36:37], v5 offset:4096
 v_mfma_f32_16x16x32_bf16 v[72:75], a[20:23], a[148:151], v[72:75]
 s_waitcnt lgkmcnt(3)
 ds_read_b64_tr_b16 a[38:39], v5 offset:6144
 v_mfma_f32_16x16x32_bf16 v[72:75], a[24:27], a[152:155], v[72:75]
 ds_read_b64_tr_b16 a[40:41], v5 offset:8192
 buffer_store_dwordx4 v[232:235], v3, s[12:15], s56 offen offset:1024 sc1
 v_mfma_f32_16x16x32_bf16 v[72:75], a[28:31], a[156:159], v[72:75]
 ds_read_b64_tr_b16 a[42:43], v5 offset:10240
 v_mfma_f32_16x16x32_bf16 v[80:83], a[0:3], a[160:163], 0
 ds_read_b64_tr_b16 a[44:45], v5 offset:12288
 v_mfma_f32_16x16x32_bf16 v[80:83], a[4:7], a[164:167], v[80:83]
 ds_read_b64_tr_b16 a[46:47], v5 offset:14336
 buffer_store_dwordx4 v[176:179], v3, s[12:15], s55 offen offset:2048 sc1
 v_mfma_f32_16x16x32_bf16 v[80:83], a[8:11], a[168:171], v[80:83]
 ds_read_b64_tr_b16 a[48:49], v5 offset:16384
 v_mfma_f32_16x16x32_bf16 v[80:83], a[12:15], a[172:175], v[80:83]
 ds_read_b64_tr_b16 a[50:51], v5 offset:18432
 v_mfma_f32_16x16x32_bf16 v[80:83], a[16:19], a[176:179], v[80:83]
 ds_read_b64_tr_b16 a[52:53], v5 offset:20480
 buffer_store_dwordx4 v[240:243], v3, s[12:15], s56 offen offset:2048 sc1
 v_mfma_f32_16x16x32_bf16 v[80:83], a[20:23], a[180:183], v[80:83]
 ds_read_b64_tr_b16 a[54:55], v5 offset:22528
 v_mul_f32 v72, v72, v64
 v_mfma_f32_16x16x32_bf16 v[80:83], a[24:27], a[184:187], v[80:83]
 ds_read_b64_tr_b16 a[56:57], v5 offset:24576
 v_mul_f32 v73, v73, v64
 v_mfma_f32_16x16x32_bf16 v[80:83], a[28:31], a[188:191], v[80:83]
 s_waitcnt lgkmcnt(7)
 ds_read_b64_tr_b16 a[58:59], v5 offset:26624
 buffer_store_dwordx4 v[184:187], v3, s[12:15], s55 offen offset:3072 sc1
 v_mfma_f32_16x16x32_bf16 v[76:79], a[32:35], a[128:131], 0
 ds_read_b64_tr_b16 a[60:61], v5 offset:28672
 v_mul_f32 v74, v74, v64
 v_mfma_f32_16x16x32_bf16 v[76:79], a[36:39], a[132:135], v[76:79]
 ds_read_b64_tr_b16 a[62:63], v5 offset:30720
 v_mul_f32 v75, v75, v64
 v_mfma_f32_16x16x32_bf16 v[76:79], a[40:43], a[136:139], v[76:79]
 s_waitcnt lgkmcnt(4)
 ds_read_b64_tr_b16 a[0:1], v6 offset:0
 buffer_store_dwordx4 v[248:251], v3, s[12:15], s56 offen offset:3072 sc1
 v_mfma_f32_16x16x32_bf16 v[76:79], a[44:47], a[140:143], v[76:79]
 ds_read_b64_tr_b16 a[2:3], v6 offset:2048
 v_mfma_f32_16x16x32_bf16 v[76:79], a[48:51], a[144:147], v[76:79]
 s_add_u32 m0, s29, 32768
 ds_read_b64_tr_b16 a[4:5], v6 offset:4096
 v_mul_f32 v80, v80, v65
 v_mfma_f32_16x16x32_bf16 v[76:79], a[52:55], a[148:151], v[76:79]
 s_waitcnt lgkmcnt(3)
 ds_read_b64_tr_b16 a[6:7], v6 offset:6144
 buffer_load_dwordx4 v2, s[8:11], s78 offen lds
 v_mfma_f32_16x16x32_bf16 v[76:79], a[56:59], a[152:155], v[76:79]
 ds_read_b64_tr_b16 a[8:9], v6 offset:8192
 v_mul_f32 v81, v81, v65
 v_mfma_f32_16x16x32_bf16 v[76:79], a[60:63], a[156:159], v[76:79]
 ds_read_b64_tr_b16 a[10:11], v6 offset:10240
 v_mul_f32 v82, v82, v65
 v_mfma_f32_16x16x32_bf16 v[84:87], a[32:35], a[160:163], 0
 ds_read_b64_tr_b16 a[12:13], v6 offset:12288
 v_mul_f32 v83, v83, v65
 v_mfma_f32_16x16x32_bf16 v[84:87], a[36:39], a[164:167], v[84:87]
 s_add_u32 m0, s29, 36864
 ds_read_b64_tr_b16 a[14:15], v6 offset:14336
 v_mfma_f32_16x16x32_bf16 v[84:87], a[40:43], a[168:171], v[84:87]
 ds_read_b64_tr_b16 a[16:17], v6 offset:16384
 buffer_load_dwordx4 v2, s[8:11], s79 offen lds
 v_mfma_f32_16x16x32_bf16 v[84:87], a[44:47], a[172:175], v[84:87]
 ds_read_b64_tr_b16 a[18:19], v6 offset:18432
 v_mfma_f32_16x16x32_bf16 v[84:87], a[48:51], a[176:179], v[84:87]
 ds_read_b64_tr_b16 a[20:21], v6 offset:20480
 v_mul_f32 v76, v76, v64
 v_mfma_f32_16x16x32_bf16 v[84:87], a[52:55], a[180:183], v[84:87]
 ds_read_b64_tr_b16 a[22:23], v6 offset:22528
 v_mul_f32 v77, v77, v64
 v_mfma_f32_16x16x32_bf16 v[84:87], a[56:59], a[184:187], v[84:87]
 s_add_u32 m0, s29, 40960
 ds_read_b64_tr_b16 a[24:25], v6 offset:24576
 v_mul_f32 v78, v78, v64
 v_mfma_f32_16x16x32_bf16 v[84:87], a[60:63], a[188:191], v[84:87]
 s_waitcnt lgkmcnt(7)
 ds_read_b64_tr_b16 a[26:27], v6 offset:26624
 buffer_load_dwordx4 v2, s[8:11], s80 offen lds
 v_mfma_f32_16x16x32_bf16 v[88:91], a[0:3], a[128:131], 0
 s_lshl_b32 s44, s24, 7
 ds_read_b64_tr_b16 a[28:29], v6 offset:28672
 v_mul_f32 v79, v79, v64
 v_mfma_f32_16x16x32_bf16 v[88:91], a[4:7], a[132:135], v[88:91]
 s_add_u32 s44, s44, 84938752
 ds_read_b64_tr_b16 a[30:31], v6 offset:30720
 v_cvt_pk_bf16_f32 v72, v72, v73
 v_mfma_f32_16x16x32_bf16 v[88:91], a[8:11], a[136:139], v[88:91]
 s_waitcnt lgkmcnt(4)
 ds_read_b64_tr_b16 a[32:33], v7 offset:0
 v_cvt_pk_bf16_f32 v73, v74, v75
 v_mfma_f32_16x16x32_bf16 v[88:91], a[12:15], a[140:143], v[88:91]
 s_add_u32 m0, s29, 45056
 ds_read_b64_tr_b16 a[34:35], v7 offset:2048
 v_cvt_pk_bf16_f32 v74, v76, v77
 v_mfma_f32_16x16x32_bf16 v[88:91], a[16:19], a[144:147], v[88:91]
 ds_read_b64_tr_b16 a[36:37], v7 offset:4096
 buffer_load_dwordx4 v2, s[8:11], s81 offen lds
 v_mfma_f32_16x16x32_bf16 v[88:91], a[20:23], a[148:151], v[88:91]
 s_waitcnt lgkmcnt(3)
 ds_read_b64_tr_b16 a[38:39], v7 offset:6144
 v_cvt_pk_bf16_f32 v75, v78, v79
 v_mfma_f32_16x16x32_bf16 v[88:91], a[24:27], a[152:155], v[88:91]
 s_add_u32 s58, s48, 0
 ds_read_b64_tr_b16 a[40:41], v7 offset:8192
 v_mul_f32 v84, v84, v65
 v_mfma_f32_16x16x32_bf16 v[88:91], a[28:31], a[156:159], v[88:91]
 s_waitcnt vmcnt(4)
 ds_read_b64_tr_b16 a[42:43], v7 offset:10240
 buffer_store_dwordx4 v[72:75], v1, s[12:15], s58 offen sc1
 v_mfma_f32_16x16x32_bf16 v[96:99], a[0:3], a[160:163], 0
 s_barrier
 ds_read_b64_tr_b16 a[44:45], v7 offset:12288
 v_mul_f32 v85, v85, v65
 v_mfma_f32_16x16x32_bf16 v[96:99], a[4:7], a[164:167], v[96:99]
 ds_read_b64_tr_b16 a[46:47], v7 offset:14336
 buffer_store_dword v9, v9, s[12:15], s59 offen sc1
 v_mfma_f32_16x16x32_bf16 v[96:99], a[8:11], a[168:171], v[96:99]
 s_add_u32 m0, s29, 49152
 ds_read_b64_tr_b16 a[48:49], v7 offset:16384
 v_mul_f32 v86, v86, v65
 v_mfma_f32_16x16x32_bf16 v[96:99], a[12:15], a[172:175], v[96:99]
 ds_read_b64_tr_b16 a[50:51], v7 offset:18432
 buffer_load_dwordx4 v2, s[8:11], s82 offen lds
 v_mfma_f32_16x16x32_bf16 v[96:99], a[16:19], a[176:179], v[96:99]
 s_lshl_b32 s40, s24, 1
 ds_read_b64_tr_b16 a[52:53], v7 offset:20480
 v_mul_f32 v87, v87, v65
 v_mfma_f32_16x16x32_bf16 v[96:99], a[20:23], a[180:183], v[96:99]
 s_and_b32 s41, s28, 1
 ds_read_b64_tr_b16 a[54:55], v7 offset:22528
 v_cvt_pk_bf16_f32 v80, v80, v81
 v_mfma_f32_16x16x32_bf16 v[96:99], a[24:27], a[184:187], v[96:99]
 s_add_u32 m0, s29, 53248
 ds_read_b64_tr_b16 a[56:57], v7 offset:24576
 v_cvt_pk_bf16_f32 v81, v82, v83
 v_mfma_f32_16x16x32_bf16 v[96:99], a[28:31], a[188:191], v[96:99]
 s_waitcnt lgkmcnt(7)
 ds_read_b64_tr_b16 a[58:59], v7 offset:26624
 v_cvt_pk_bf16_f32 v82, v84, v85
 v_mfma_f32_16x16x32_bf16 v[92:95], a[32:35], a[128:131], 0
 ds_read_b64_tr_b16 a[60:61], v7 offset:28672
 buffer_load_dwordx4 v2, s[8:11], s83 offen lds
 v_mfma_f32_16x16x32_bf16 v[92:95], a[36:39], a[132:135], v[92:95]
 s_add_u32 s58, s48, 917504
 ds_read_b64_tr_b16 a[62:63], v7 offset:30720
 v_xor_b32 v4, 0x20000, v4
 v_mfma_f32_16x16x32_bf16 v[92:95], a[40:43], a[136:139], v[92:95]
 s_waitcnt lgkmcnt(4)
 ds_read_b64_tr_b16 a[0:1], v4 offset:0
 v_cvt_pk_bf16_f32 v83, v86, v87
 v_mfma_f32_16x16x32_bf16 v[92:95], a[44:47], a[140:143], v[92:95]
 ds_read_b64_tr_b16 a[2:3], v4 offset:2048
 buffer_store_dwordx4 v[80:83], v1, s[12:15], s58 offen sc1
 v_mfma_f32_16x16x32_bf16 v[92:95], a[48:51], a[144:147], v[92:95]
 s_add_u32 m0, s29, 57344
 ds_read_b64_tr_b16 a[4:5], v4 offset:4096
 v_mul_f32 v88, v88, v64
 v_mfma_f32_16x16x32_bf16 v[92:95], a[52:55], a[148:151], v[92:95]
 s_waitcnt lgkmcnt(3)
 ds_read_b64_tr_b16 a[6:7], v4 offset:6144
 buffer_load_dwordx4 v2, s[8:11], s84 offen lds
 v_mfma_f32_16x16x32_bf16 v[92:95], a[56:59], a[152:155], v[92:95]
 s_add_u32 s40, s40, s41
 ds_read_b64_tr_b16 a[8:9], v4 offset:8192
 v_mul_f32 v89, v89, v64
 v_mfma_f32_16x16x32_bf16 v[92:95], a[60:63], a[156:159], v[92:95]
 s_lshr_b32 s41, s28, 1
 ds_read_b64_tr_b16 a[10:11], v4 offset:10240
 v_mul_f32 v90, v90, v64
 v_mfma_f32_16x16x32_bf16 v[100:103], a[32:35], a[160:163], 0
 s_lshl_b32 s42, s40, 2
 ds_read_b64_tr_b16 a[12:13], v4 offset:12288
 v_mul_f32 v91, v91, v64
 v_mfma_f32_16x16x32_bf16 v[100:103], a[36:39], a[164:167], v[100:103]
 s_add_u32 m0, s29, 61440
 ds_read_b64_tr_b16 a[14:15], v4 offset:14336
 v_mul_f32 v96, v96, v65
 v_mfma_f32_16x16x32_bf16 v[100:103], a[40:43], a[168:171], v[100:103]
 ds_read_b64_tr_b16 a[16:17], v4 offset:16384
 buffer_load_dwordx4 v2, s[8:11], s85 offen lds
 v_mfma_f32_16x16x32_bf16 v[100:103], a[44:47], a[172:175], v[100:103]
 s_add_u32 s42, s42, s3
 ds_read_b64_tr_b16 a[18:19], v4 offset:18432
 v_add_u32 v2, 128, v2
 v_mfma_f32_16x16x32_bf16 v[100:103], a[48:51], a[176:179], v[100:103]
 s_mul_i32 s37, s42, 229376
 ds_read_b64_tr_b16 a[20:21], v4 offset:20480
 v_mul_f32 v92, v92, v64
 v_mfma_f32_16x16x32_bf16 v[100:103], a[52:55], a[180:183], v[100:103]
 s_lshl_b32 s43, s41, 14
 ds_read_b64_tr_b16 a[22:23], v4 offset:22528
 v_mul_f32 v93, v93, v64
 v_mfma_f32_16x16x32_bf16 v[100:103], a[56:59], a[184:187], v[100:103]
 s_add_u32 m0, s29, 65536
 ds_read_b64_tr_b16 a[24:25], v4 offset:24576
 v_mul_f32 v94, v94, v64
 v_mfma_f32_16x16x32_bf16 v[100:103], a[60:63], a[188:191], v[100:103]
 s_waitcnt lgkmcnt(7)
 ds_read_b64_tr_b16 a[26:27], v4 offset:26624
 buffer_load_dwordx4 v2, s[8:11], s78 offen lds
 v_mfma_f32_16x16x32_bf16 v[104:107], a[0:3], a[128:131], 0
 s_add_u32 s37, s37, s43
 ds_read_b64_tr_b16 a[28:29], v4 offset:28672
 v_mul_f32 v95, v95, v64
 v_mfma_f32_16x16x32_bf16 v[104:107], a[4:7], a[132:135], v[104:107]
 s_add_u32 s37, s37, 117440512
 ds_read_b64_tr_b16 a[30:31], v4 offset:30720
 v_xor_b32 v5, 0x20000, v5
 v_mfma_f32_16x16x32_bf16 v[104:107], a[8:11], a[136:139], v[104:107]
 s_waitcnt lgkmcnt(4)
 ds_read_b64_tr_b16 a[32:33], v5 offset:0
 v_cvt_pk_bf16_f32 v88, v88, v89
 v_mfma_f32_16x16x32_bf16 v[104:107], a[12:15], a[140:143], v[104:107]
 s_add_u32 m0, s29, 69632
 ds_read_b64_tr_b16 a[34:35], v5 offset:2048
 v_cvt_pk_bf16_f32 v89, v90, v91
 v_mfma_f32_16x16x32_bf16 v[104:107], a[16:19], a[144:147], v[104:107]
 ds_read_b64_tr_b16 a[36:37], v5 offset:4096
 buffer_load_dwordx4 v2, s[8:11], s79 offen lds
 v_mfma_f32_16x16x32_bf16 v[104:107], a[20:23], a[148:151], v[104:107]
 s_waitcnt lgkmcnt(3)
 ds_read_b64_tr_b16 a[38:39], v5 offset:6144
 v_cvt_pk_bf16_f32 v90, v92, v93
 v_mfma_f32_16x16x32_bf16 v[104:107], a[24:27], a[152:155], v[104:107]
 s_add_u32 s58, s48, 16384
 ds_read_b64_tr_b16 a[40:41], v5 offset:8192
 v_cvt_pk_bf16_f32 v91, v94, v95
 v_mfma_f32_16x16x32_bf16 v[104:107], a[28:31], a[156:159], v[104:107]
 ds_read_b64_tr_b16 a[42:43], v5 offset:10240
 buffer_store_dwordx4 v[88:91], v1, s[12:15], s58 offen sc1
 v_mfma_f32_16x16x32_bf16 v[112:115], a[0:3], a[160:163], 0
 s_add_u32 m0, s29, 73728
 ds_read_b64_tr_b16 a[44:45], v5 offset:12288
 v_mul_f32 v97, v97, v65
 v_mfma_f32_16x16x32_bf16 v[112:115], a[4:7], a[164:167], v[112:115]
 ds_read_b64_tr_b16 a[46:47], v5 offset:14336
 buffer_load_dwordx4 v2, s[8:11], s80 offen lds
 v_mfma_f32_16x16x32_bf16 v[112:115], a[8:11], a[168:171], v[112:115]
 s_add_u32 s38, s37, 114688
 ds_read_b64_tr_b16 a[48:49], v5 offset:16384
 v_mul_f32 v98, v98, v65
 v_mfma_f32_16x16x32_bf16 v[112:115], a[12:15], a[172:175], v[112:115]
 ds_read_b64_tr_b16 a[50:51], v5 offset:18432
 v_mul_f32 v99, v99, v65
 v_mfma_f32_16x16x32_bf16 v[112:115], a[16:19], a[176:179], v[112:115]
 ds_read_b64_tr_b16 a[52:53], v5 offset:20480
 v_mul_f32 v100, v100, v65
 v_mfma_f32_16x16x32_bf16 v[112:115], a[20:23], a[180:183], v[112:115]
 s_add_u32 m0, s29, 77824
 ds_read_b64_tr_b16 a[54:55], v5 offset:22528
 v_mul_f32 v101, v101, v65
 v_mfma_f32_16x16x32_bf16 v[112:115], a[24:27], a[184:187], v[112:115]
 ds_read_b64_tr_b16 a[56:57], v5 offset:24576
 buffer_load_dwordx4 v2, s[8:11], s81 offen lds
 v_mfma_f32_16x16x32_bf16 v[112:115], a[28:31], a[188:191], v[112:115]
 s_waitcnt lgkmcnt(7)
 ds_read_b64_tr_b16 a[58:59], v5 offset:26624
 v_mul_f32 v102, v102, v65
 v_mfma_f32_16x16x32_bf16 v[108:111], a[32:35], a[128:131], 0
 ds_read_b64_tr_b16 a[60:61], v5 offset:28672
 v_mul_f32 v103, v103, v65
 v_mfma_f32_16x16x32_bf16 v[108:111], a[36:39], a[132:135], v[108:111]
 s_add_u32 m0, s29, 81920
 ds_read_b64_tr_b16 a[62:63], v5 offset:30720
 v_xor_b32 v6, 0x20000, v6
 v_mfma_f32_16x16x32_bf16 v[108:111], a[40:43], a[136:139], v[108:111]
 s_waitcnt lgkmcnt(4)
 ds_read_b64_tr_b16 a[0:1], v6 offset:0
 v_cvt_pk_bf16_f32 v96, v96, v97
 v_mfma_f32_16x16x32_bf16 v[108:111], a[44:47], a[140:143], v[108:111]
 ds_read_b64_tr_b16 a[2:3], v6 offset:2048
 buffer_load_dwordx4 v2, s[8:11], s82 offen lds
 v_mfma_f32_16x16x32_bf16 v[108:111], a[48:51], a[144:147], v[108:111]
 ds_read_b64_tr_b16 a[4:5], v6 offset:4096
 v_cvt_pk_bf16_f32 v97, v98, v99
 v_mfma_f32_16x16x32_bf16 v[108:111], a[52:55], a[148:151], v[108:111]
 s_waitcnt lgkmcnt(3)
 ds_read_b64_tr_b16 a[6:7], v6 offset:6144
 v_cvt_pk_bf16_f32 v98, v100, v101
 v_mfma_f32_16x16x32_bf16 v[108:111], a[56:59], a[152:155], v[108:111]
 ds_read_b64_tr_b16 a[8:9], v6 offset:8192
 v_cvt_pk_bf16_f32 v99, v102, v103
 v_mfma_f32_16x16x32_bf16 v[108:111], a[60:63], a[156:159], v[108:111]
 s_add_u32 m0, s29, 86016
 ds_read_b64_tr_b16 a[10:11], v6 offset:10240
 v_mul_f32 v104, v104, v64
 v_mfma_f32_16x16x32_bf16 v[116:119], a[32:35], a[160:163], 0
 ds_read_b64_tr_b16 a[12:13], v6 offset:12288
 buffer_load_dwordx4 v2, s[8:11], s83 offen lds
 v_mfma_f32_16x16x32_bf16 v[116:119], a[36:39], a[164:167], v[116:119]
 s_add_u32 s58, s48, 933888
 ds_read_b64_tr_b16 a[14:15], v6 offset:14336
 v_mul_f32 v105, v105, v64
 v_mfma_f32_16x16x32_bf16 v[116:119], a[40:43], a[168:171], v[116:119]
 ds_read_b64_tr_b16 a[16:17], v6 offset:16384
 buffer_store_dwordx4 v[96:99], v1, s[12:15], s58 offen sc1
 v_mfma_f32_16x16x32_bf16 v[116:119], a[44:47], a[172:175], v[116:119]
 ds_read_b64_tr_b16 a[18:19], v6 offset:18432
 v_mul_f32 v106, v106, v64
 v_mfma_f32_16x16x32_bf16 v[116:119], a[48:51], a[176:179], v[116:119]
 s_add_u32 m0, s29, 90112
 ds_read_b64_tr_b16 a[20:21], v6 offset:20480
 v_mul_f32 v107, v107, v64
 v_mfma_f32_16x16x32_bf16 v[116:119], a[52:55], a[180:183], v[116:119]
 ds_read_b64_tr_b16 a[22:23], v6 offset:22528
 buffer_load_dwordx4 v2, s[8:11], s84 offen lds
 v_mfma_f32_16x16x32_bf16 v[116:119], a[56:59], a[184:187], v[116:119]
 ds_read_b64_tr_b16 a[24:25], v6 offset:24576
 v_mul_f32 v108, v108, v64
 v_mfma_f32_16x16x32_bf16 v[116:119], a[60:63], a[188:191], v[116:119]
 s_waitcnt lgkmcnt(7)
 ds_read_b64_tr_b16 a[26:27], v6 offset:26624
 v_mul_f32 v109, v109, v64
 v_mfma_f32_16x16x32_bf16 v[72:75], a[0:3], a[128:131], 0
 ds_read_b64_tr_b16 a[28:29], v6 offset:28672
 v_mul_f32 v110, v110, v64
 v_mfma_f32_16x16x32_bf16 v[72:75], a[4:7], a[132:135], v[72:75]
 s_add_u32 m0, s29, 94208
 ds_read_b64_tr_b16 a[30:31], v6 offset:30720
 v_xor_b32 v7, 0x20000, v7
 v_mfma_f32_16x16x32_bf16 v[72:75], a[8:11], a[136:139], v[72:75]
 s_waitcnt lgkmcnt(4)
 ds_read_b64_tr_b16 a[32:33], v7 offset:0
 buffer_load_dwordx4 v2, s[8:11], s85 offen lds
 v_mfma_f32_16x16x32_bf16 v[72:75], a[12:15], a[140:143], v[72:75]
 ds_read_b64_tr_b16 a[34:35], v7 offset:2048
 v_add_u32 v2, 128, v2
 v_mfma_f32_16x16x32_bf16 v[72:75], a[16:19], a[144:147], v[72:75]
 ds_read_b64_tr_b16 a[36:37], v7 offset:4096
 v_mul_f32 v111, v111, v64
 v_mfma_f32_16x16x32_bf16 v[72:75], a[20:23], a[148:151], v[72:75]
 s_waitcnt lgkmcnt(3)
 ds_read_b64_tr_b16 a[38:39], v7 offset:6144
 v_cvt_pk_bf16_f32 v104, v104, v105
 v_mfma_f32_16x16x32_bf16 v[72:75], a[24:27], a[152:155], v[72:75]
 s_add_u32 m0, s29, 98304
 ds_read_b64_tr_b16 a[40:41], v7 offset:8192
 v_cvt_pk_bf16_f32 v105, v106, v107
 v_mfma_f32_16x16x32_bf16 v[72:75], a[28:31], a[156:159], v[72:75]
 ds_read_b64_tr_b16 a[42:43], v7 offset:10240
 buffer_load_dwordx4 v2, s[8:11], s78 offen lds
 v_mfma_f32_16x16x32_bf16 v[80:83], a[0:3], a[160:163], 0
 ds_read_b64_tr_b16 a[44:45], v7 offset:12288
 v_cvt_pk_bf16_f32 v106, v108, v109
 v_mfma_f32_16x16x32_bf16 v[80:83], a[4:7], a[164:167], v[80:83]
 s_add_u32 s58, s48, 32768
 ds_read_b64_tr_b16 a[46:47], v7 offset:14336
 v_cvt_pk_bf16_f32 v107, v110, v111
 v_mfma_f32_16x16x32_bf16 v[80:83], a[8:11], a[168:171], v[80:83]
 ds_read_b64_tr_b16 a[48:49], v7 offset:16384
 buffer_store_dwordx4 v[104:107], v1, s[12:15], s58 offen sc1
 v_mfma_f32_16x16x32_bf16 v[80:83], a[12:15], a[172:175], v[80:83]
 s_add_u32 m0, s29, 102400
 ds_read_b64_tr_b16 a[50:51], v7 offset:18432
 v_mul_f32 v112, v112, v65
 v_mfma_f32_16x16x32_bf16 v[80:83], a[16:19], a[176:179], v[80:83]
 ds_read_b64_tr_b16 a[52:53], v7 offset:20480
 buffer_load_dwordx4 v2, s[8:11], s79 offen lds
 v_mfma_f32_16x16x32_bf16 v[80:83], a[20:23], a[180:183], v[80:83]
 ds_read_b64_tr_b16 a[54:55], v7 offset:22528
 v_mul_f32 v113, v113, v65
 v_mfma_f32_16x16x32_bf16 v[80:83], a[24:27], a[184:187], v[80:83]
 ds_read_b64_tr_b16 a[56:57], v7 offset:24576
 v_mul_f32 v114, v114, v65
 v_mfma_f32_16x16x32_bf16 v[80:83], a[28:31], a[188:191], v[80:83]
 s_waitcnt lgkmcnt(7)
 ds_read_b64_tr_b16 a[58:59], v7 offset:26624
 v_mul_f32 v115, v115, v65
 v_mfma_f32_16x16x32_bf16 v[76:79], a[32:35], a[128:131], 0
 s_waitcnt vmcnt(13)
 ds_read_b64_tr_b16 a[60:61], v7 offset:28672
 v_mul_f32 v116, v116, v65
 v_mfma_f32_16x16x32_bf16 v[76:79], a[36:39], a[132:135], v[76:79]
 s_barrier
 ds_read_b64_tr_b16 a[62:63], v7 offset:30720
 v_mul_f32 v117, v117, v65
 v_mfma_f32_16x16x32_bf16 v[76:79], a[40:43], a[136:139], v[76:79]
 s_waitcnt lgkmcnt(4)
 ds_read_b64_tr_b16 a[0:1], v4 offset:32768
 v_mul_f32 v118, v118, v65
 v_mfma_f32_16x16x32_bf16 v[76:79], a[44:47], a[140:143], v[76:79]
 s_add_u32 m0, s29, 106496
 ds_read_b64_tr_b16 a[2:3], v4 offset:34816
 v_mul_f32 v119, v119, v65
 v_mfma_f32_16x16x32_bf16 v[76:79], a[48:51], a[144:147], v[76:79]
 ds_read_b64_tr_b16 a[4:5], v4 offset:36864
 buffer_load_dwordx4 v2, s[8:11], s80 offen lds
 v_mfma_f32_16x16x32_bf16 v[76:79], a[52:55], a[148:151], v[76:79]
 s_waitcnt lgkmcnt(3)
 ds_read_b64_tr_b16 a[6:7], v4 offset:38912
 v_cvt_pk_bf16_f32 v112, v112, v113
 v_mfma_f32_16x16x32_bf16 v[76:79], a[56:59], a[152:155], v[76:79]
 ds_read_b64_tr_b16 a[8:9], v4 offset:40960
 v_cvt_pk_bf16_f32 v113, v114, v115
 v_mfma_f32_16x16x32_bf16 v[76:79], a[60:63], a[156:159], v[76:79]
 ds_read_b64_tr_b16 a[10:11], v4 offset:43008
 v_cvt_pk_bf16_f32 v114, v116, v117
 v_mfma_f32_16x16x32_bf16 v[84:87], a[32:35], a[160:163], 0
 s_add_u32 m0, s29, 110592
 ds_read_b64_tr_b16 a[12:13], v4 offset:45056
 v_cvt_pk_bf16_f32 v115, v118, v119
 v_mfma_f32_16x16x32_bf16 v[84:87], a[36:39], a[164:167], v[84:87]
 ds_read_b64_tr_b16 a[14:15], v4 offset:47104
 buffer_load_dwordx4 v2, s[8:11], s81 offen lds
 v_mfma_f32_16x16x32_bf16 v[84:87], a[40:43], a[168:171], v[84:87]
 s_add_u32 s58, s48, 950272
 ds_read_b64_tr_b16 a[16:17], v4 offset:49152
 v_mul_f32 v72, v72, v64
 v_mfma_f32_16x16x32_bf16 v[84:87], a[44:47], a[172:175], v[84:87]
 s_waitcnt lgkmcnt(9)
 ds_read_b64_tr_b16 a[18:19], v4 offset:51200
 buffer_store_dwordx4 v[112:115], v1, s[12:15], s58 offen sc1
 v_mfma_f32_16x16x32_bf16 v[84:87], a[48:51], a[176:179], v[84:87]
 s_barrier
 ds_read_b64_tr_b16 a[20:21], v4 offset:53248
 v_mul_f32 v73, v73, v64
 v_mfma_f32_16x16x32_bf16 v[84:87], a[52:55], a[180:183], v[84:87]
 s_add_u32 m0, s29, 114688
 ds_read_b64_tr_b16 a[22:23], v4 offset:55296
 v_mul_f32 v74, v74, v64
 v_mfma_f32_16x16x32_bf16 v[84:87], a[56:59], a[184:187], v[84:87]
 ds_read_b64_tr_b16 a[24:25], v4 offset:57344
 buffer_load_dwordx4 v2, s[8:11], s82 offen lds
 v_mfma_f32_16x16x32_bf16 v[84:87], a[60:63], a[188:191], v[84:87]
 s_waitcnt lgkmcnt(7)
 ds_read_b64_tr_b16 a[26:27], v4 offset:59392
 v_mul_f32 v75, v75, v64
 v_mfma_f32_16x16x32_bf16 v[88:91], a[0:3], a[128:131], 0
 ds_read_b64_tr_b16 a[28:29], v4 offset:61440
 v_mul_f32 v76, v76, v64
 v_mfma_f32_16x16x32_bf16 v[88:91], a[4:7], a[132:135], v[88:91]
 s_add_u32 m0, s29, 118784
 ds_read_b64_tr_b16 a[30:31], v4 offset:63488
 v_mul_f32 v77, v77, v64
 v_mfma_f32_16x16x32_bf16 v[88:91], a[8:11], a[136:139], v[88:91]
 s_waitcnt lgkmcnt(4)
 ds_read_b64_tr_b16 a[32:33], v5 offset:32768
 v_mul_f32 v78, v78, v64
 v_mfma_f32_16x16x32_bf16 v[88:91], a[12:15], a[140:143], v[88:91]
 ds_read_b64_tr_b16 a[34:35], v5 offset:34816
 buffer_load_dwordx4 v2, s[8:11], s83 offen lds
 v_mfma_f32_16x16x32_bf16 v[88:91], a[16:19], a[144:147], v[88:91]
 ds_read_b64_tr_b16 a[36:37], v5 offset:36864
 v_mul_f32 v79, v79, v64
 v_mfma_f32_16x16x32_bf16 v[88:91], a[20:23], a[148:151], v[88:91]
 s_waitcnt lgkmcnt(3)
 ds_read_b64_tr_b16 a[38:39], v5 offset:38912
 v_cvt_pk_bf16_f32 v72, v72, v73
 v_mfma_f32_16x16x32_bf16 v[88:91], a[24:27], a[152:155], v[88:91]
 ds_read_b64_tr_b16 a[40:41], v5 offset:40960
 v_cvt_pk_bf16_f32 v73, v74, v75
 v_mfma_f32_16x16x32_bf16 v[88:91], a[28:31], a[156:159], v[88:91]
 s_add_u32 m0, s29, 122880
 ds_read_b64_tr_b16 a[42:43], v5 offset:43008
 v_cvt_pk_bf16_f32 v74, v76, v77
 v_mfma_f32_16x16x32_bf16 v[96:99], a[0:3], a[160:163], 0
 ds_read_b64_tr_b16 a[44:45], v5 offset:45056
 buffer_load_dwordx4 v2, s[8:11], s84 offen lds
 v_mfma_f32_16x16x32_bf16 v[96:99], a[4:7], a[164:167], v[96:99]
 s_add_u32 s58, s48, 49152
 ds_read_b64_tr_b16 a[46:47], v5 offset:47104
 v_cvt_pk_bf16_f32 v75, v78, v79
 v_mfma_f32_16x16x32_bf16 v[96:99], a[8:11], a[168:171], v[96:99]
 ds_read_b64_tr_b16 a[48:49], v5 offset:49152
 buffer_store_dwordx4 v[72:75], v1, s[12:15], s58 offen sc1
 v_mfma_f32_16x16x32_bf16 v[96:99], a[12:15], a[172:175], v[96:99]
 ds_read_b64_tr_b16 a[50:51], v5 offset:51200
 v_mul_f32 v80, v80, v65
 v_mfma_f32_16x16x32_bf16 v[96:99], a[16:19], a[176:179], v[96:99]
 s_add_u32 m0, s29, 126976
 ds_read_b64_tr_b16 a[52:53], v5 offset:53248
 v_mul_f32 v81, v81, v65
 v_mfma_f32_16x16x32_bf16 v[96:99], a[20:23], a[180:183], v[96:99]
 ds_read_b64_tr_b16 a[54:55], v5 offset:55296
 buffer_load_dwordx4 v2, s[8:11], s85 offen lds
 v_mfma_f32_16x16x32_bf16 v[96:99], a[24:27], a[184:187], v[96:99]
 ds_read_b64_tr_b16 a[56:57], v5 offset:57344
 v_add_u32 v2, 128, v2
 v_mfma_f32_16x16x32_bf16 v[96:99], a[28:31], a[188:191], v[96:99]
 s_waitcnt lgkmcnt(7)
 ds_read_b64_tr_b16 a[58:59], v5 offset:59392
 v_mul_f32 v82, v82, v65
 v_mfma_f32_16x16x32_bf16 v[92:95], a[32:35], a[128:131], 0
 ds_read_b64_tr_b16 a[60:61], v5 offset:61440
 v_mul_f32 v83, v83, v65
 v_mfma_f32_16x16x32_bf16 v[92:95], a[36:39], a[132:135], v[92:95]
 s_add_u32 m0, s29, 131072
 ds_read_b64_tr_b16 a[62:63], v5 offset:63488
 v_mul_f32 v84, v84, v65
 v_mfma_f32_16x16x32_bf16 v[92:95], a[40:43], a[136:139], v[92:95]
 s_waitcnt lgkmcnt(4)
 ds_read_b64_tr_b16 a[0:1], v6 offset:32768
 buffer_load_dwordx4 v2, s[8:11], s78 offen lds
 v_mfma_f32_16x16x32_bf16 v[92:95], a[44:47], a[140:143], v[92:95]
 ds_read_b64_tr_b16 a[2:3], v6 offset:34816
 v_mul_f32 v85, v85, v65
 v_mfma_f32_16x16x32_bf16 v[92:95], a[48:51], a[144:147], v[92:95]
 ds_read_b64_tr_b16 a[4:5], v6 offset:36864
 v_mul_f32 v86, v86, v65
 v_mfma_f32_16x16x32_bf16 v[92:95], a[52:55], a[148:151], v[92:95]
 s_waitcnt lgkmcnt(3)
 ds_read_b64_tr_b16 a[6:7], v6 offset:38912
 v_mul_f32 v87, v87, v65
 v_mfma_f32_16x16x32_bf16 v[92:95], a[56:59], a[152:155], v[92:95]
 s_add_u32 m0, s29, 135168
 ds_read_b64_tr_b16 a[8:9], v6 offset:40960
 v_cvt_pk_bf16_f32 v80, v80, v81
 v_mfma_f32_16x16x32_bf16 v[92:95], a[60:63], a[156:159], v[92:95]
 ds_read_b64_tr_b16 a[10:11], v6 offset:43008
 buffer_load_dwordx4 v2, s[8:11], s79 offen lds
 v_mfma_f32_16x16x32_bf16 v[100:103], a[32:35], a[160:163], 0
 ds_read_b64_tr_b16 a[12:13], v6 offset:45056
 v_cvt_pk_bf16_f32 v81, v82, v83
 v_mfma_f32_16x16x32_bf16 v[100:103], a[36:39], a[164:167], v[100:103]
 ds_read_b64_tr_b16 a[14:15], v6 offset:47104
 v_cvt_pk_bf16_f32 v82, v84, v85
 v_mfma_f32_16x16x32_bf16 v[100:103], a[40:43], a[168:171], v[100:103]
 ds_read_b64_tr_b16 a[16:17], v6 offset:49152
 v_cvt_pk_bf16_f32 v83, v86, v87
 v_mfma_f32_16x16x32_bf16 v[100:103], a[44:47], a[172:175], v[100:103]
 s_add_u32 m0, s29, 139264
 ds_read_b64_tr_b16 a[18:19], v6 offset:51200
 v_mul_f32 v88, v88, v64
 v_mfma_f32_16x16x32_bf16 v[100:103], a[48:51], a[176:179], v[100:103]
 ds_read_b64_tr_b16 a[20:21], v6 offset:53248
 buffer_load_dwordx4 v2, s[8:11], s80 offen lds
 v_mfma_f32_16x16x32_bf16 v[100:103], a[52:55], a[180:183], v[100:103]
 s_add_u32 s58, s48, 966656
 ds_read_b64_tr_b16 a[22:23], v6 offset:55296
 v_mul_f32 v89, v89, v64
 v_mfma_f32_16x16x32_bf16 v[100:103], a[56:59], a[184:187], v[100:103]
 ds_read_b64_tr_b16 a[24:25], v6 offset:57344
 buffer_store_dwordx4 v[80:83], v1, s[12:15], s58 offen sc1
 v_mfma_f32_16x16x32_bf16 v[100:103], a[60:63], a[188:191], v[100:103]
 s_waitcnt lgkmcnt(7)
 ds_read_b64_tr_b16 a[26:27], v6 offset:59392
 v_mul_f32 v90, v90, v64
 v_mfma_f32_16x16x32_bf16 v[104:107], a[0:3], a[128:131], 0
 s_add_u32 m0, s29, 143360
 ds_read_b64_tr_b16 a[28:29], v6 offset:61440
 v_mul_f32 v91, v91, v64
 v_mfma_f32_16x16x32_bf16 v[104:107], a[4:7], a[132:135], v[104:107]
 ds_read_b64_tr_b16 a[30:31], v6 offset:63488
 buffer_load_dwordx4 v2, s[8:11], s81 offen lds
 v_mfma_f32_16x16x32_bf16 v[104:107], a[8:11], a[136:139], v[104:107]
 s_waitcnt lgkmcnt(4)
 ds_read_b64_tr_b16 a[32:33], v7 offset:32768
 v_mul_f32 v92, v92, v64
 v_mfma_f32_16x16x32_bf16 v[104:107], a[12:15], a[140:143], v[104:107]
 ds_read_b64_tr_b16 a[34:35], v7 offset:34816
 v_mul_f32 v93, v93, v64
 v_mfma_f32_16x16x32_bf16 v[104:107], a[16:19], a[144:147], v[104:107]
 s_add_u32 m0, s29, 147456
 ds_read_b64_tr_b16 a[36:37], v7 offset:36864
 v_mul_f32 v94, v94, v64
 v_mfma_f32_16x16x32_bf16 v[104:107], a[20:23], a[148:151], v[104:107]
 s_waitcnt lgkmcnt(3)
 ds_read_b64_tr_b16 a[38:39], v7 offset:38912
 v_mul_f32 v95, v95, v64
 v_mfma_f32_16x16x32_bf16 v[104:107], a[24:27], a[152:155], v[104:107]
 ds_read_b64_tr_b16 a[40:41], v7 offset:40960
 buffer_load_dwordx4 v2, s[8:11], s82 offen lds
 v_mfma_f32_16x16x32_bf16 v[104:107], a[28:31], a[156:159], v[104:107]
 ds_read_b64_tr_b16 a[42:43], v7 offset:43008
 v_cvt_pk_bf16_f32 v88, v88, v89
 v_mfma_f32_16x16x32_bf16 v[112:115], a[0:3], a[160:163], 0
 ds_read_b64_tr_b16 a[44:45], v7 offset:45056
 v_cvt_pk_bf16_f32 v89, v90, v91
 v_mfma_f32_16x16x32_bf16 v[112:115], a[4:7], a[164:167], v[112:115]
 ds_read_b64_tr_b16 a[46:47], v7 offset:47104
 v_cvt_pk_bf16_f32 v90, v92, v93
 v_mfma_f32_16x16x32_bf16 v[112:115], a[8:11], a[168:171], v[112:115]
 s_add_u32 m0, s29, 151552
 ds_read_b64_tr_b16 a[48:49], v7 offset:49152
 v_cvt_pk_bf16_f32 v91, v94, v95
 v_mfma_f32_16x16x32_bf16 v[112:115], a[12:15], a[172:175], v[112:115]
 ds_read_b64_tr_b16 a[50:51], v7 offset:51200
 buffer_load_dwordx4 v2, s[8:11], s83 offen lds
 v_mfma_f32_16x16x32_bf16 v[112:115], a[16:19], a[176:179], v[112:115]
 s_add_u32 s58, s48, 65536
 ds_read_b64_tr_b16 a[52:53], v7 offset:53248
 v_mul_f32 v96, v96, v65
 v_mfma_f32_16x16x32_bf16 v[112:115], a[20:23], a[180:183], v[112:115]
 ds_read_b64_tr_b16 a[54:55], v7 offset:55296
 buffer_store_dwordx4 v[88:91], v1, s[12:15], s58 offen sc1
 v_mfma_f32_16x16x32_bf16 v[112:115], a[24:27], a[184:187], v[112:115]
 s_add_u32 m0, s29, 155648
 ds_read_b64_tr_b16 a[56:57], v7 offset:57344
 v_mul_f32 v97, v97, v65
 v_mfma_f32_16x16x32_bf16 v[112:115], a[28:31], a[188:191], v[112:115]
 s_waitcnt lgkmcnt(7)
 ds_read_b64_tr_b16 a[58:59], v7 offset:59392
 v_mul_f32 v98, v98, v65
 v_mfma_f32_16x16x32_bf16 v[108:111], a[32:35], a[128:131], 0
 s_waitcnt vmcnt(8)
 ds_read_b64_tr_b16 a[60:61], v7 offset:61440
 buffer_load_dwordx4 v2, s[8:11], s84 offen lds
 v_mfma_f32_16x16x32_bf16 v[108:111], a[36:39], a[132:135], v[108:111]
 s_barrier
 ds_read_b64_tr_b16 a[62:63], v7 offset:63488
 v_xor_b32 v4, 0x10000, v4
 v_mfma_f32_16x16x32_bf16 v[108:111], a[40:43], a[136:139], v[108:111]
 s_waitcnt lgkmcnt(4)
 ds_read_b64_tr_b16 a[0:1], v4 offset:0
 v_mul_f32 v99, v99, v65
 v_mfma_f32_16x16x32_bf16 v[108:111], a[44:47], a[140:143], v[108:111]
 ds_read_b64_tr_b16 a[2:3], v4 offset:2048
 v_mul_f32 v100, v100, v65
 v_mfma_f32_16x16x32_bf16 v[108:111], a[48:51], a[144:147], v[108:111]
 s_add_u32 m0, s29, 159744
 ds_read_b64_tr_b16 a[4:5], v4 offset:4096
 v_mul_f32 v101, v101, v65
 v_mfma_f32_16x16x32_bf16 v[108:111], a[52:55], a[148:151], v[108:111]
 s_waitcnt lgkmcnt(3)
 ds_read_b64_tr_b16 a[6:7], v4 offset:6144
 buffer_load_dwordx4 v2, s[8:11], s85 offen lds
 v_mfma_f32_16x16x32_bf16 v[108:111], a[56:59], a[152:155], v[108:111]
 ds_read_b64_tr_b16 a[8:9], v4 offset:8192
 v_add_u32 v2, 128, v2
 v_mfma_f32_16x16x32_bf16 v[108:111], a[60:63], a[156:159], v[108:111]
 ds_read_b64_tr_b16 a[10:11], v4 offset:10240
 v_mul_f32 v102, v102, v65
 v_mfma_f32_16x16x32_bf16 v[116:119], a[32:35], a[160:163], 0
 ds_read_b64_tr_b16 a[12:13], v4 offset:12288
 v_mul_f32 v103, v103, v65
 v_mfma_f32_16x16x32_bf16 v[116:119], a[36:39], a[164:167], v[116:119]
 s_add_u32 m0, s29, 0
 ds_read_b64_tr_b16 a[14:15], v4 offset:14336
 v_cvt_pk_bf16_f32 v96, v96, v97
 v_mfma_f32_16x16x32_bf16 v[116:119], a[40:43], a[168:171], v[116:119]
 ds_read_b64_tr_b16 a[16:17], v4 offset:16384
 buffer_load_dwordx4 v2, s[8:11], s78 offen lds
 v_mfma_f32_16x16x32_bf16 v[116:119], a[44:47], a[172:175], v[116:119]
 ds_read_b64_tr_b16 a[18:19], v4 offset:18432
 v_cvt_pk_bf16_f32 v97, v98, v99
 v_mfma_f32_16x16x32_bf16 v[116:119], a[48:51], a[176:179], v[116:119]
 ds_read_b64_tr_b16 a[20:21], v4 offset:20480
 v_cvt_pk_bf16_f32 v98, v100, v101
 v_mfma_f32_16x16x32_bf16 v[116:119], a[52:55], a[180:183], v[116:119]
 ds_read_b64_tr_b16 a[22:23], v4 offset:22528
 v_cvt_pk_bf16_f32 v99, v102, v103
 v_mfma_f32_16x16x32_bf16 v[116:119], a[56:59], a[184:187], v[116:119]
 s_add_u32 m0, s29, 4096
 ds_read_b64_tr_b16 a[24:25], v4 offset:24576
 v_mul_f32 v104, v104, v64
 v_mfma_f32_16x16x32_bf16 v[116:119], a[60:63], a[188:191], v[116:119]
 s_waitcnt lgkmcnt(7)
 ds_read_b64_tr_b16 a[26:27], v4 offset:26624
 buffer_load_dwordx4 v2, s[8:11], s79 offen lds
 v_mfma_f32_16x16x32_bf16 v[72:75], a[0:3], a[128:131], 0
 ds_read_b64_tr_b16 a[28:29], v4 offset:28672
 v_mul_f32 v105, v105, v64
 v_mfma_f32_16x16x32_bf16 v[72:75], a[4:7], a[132:135], v[72:75]
 s_add_u32 s58, s48, 983040
 ds_read_b64_tr_b16 a[30:31], v4 offset:30720
 v_xor_b32 v5, 0x10000, v5
 v_mfma_f32_16x16x32_bf16 v[72:75], a[8:11], a[136:139], v[72:75]
 s_waitcnt lgkmcnt(4)
 ds_read_b64_tr_b16 a[32:33], v5 offset:0
 buffer_store_dwordx4 v[96:99], v1, s[12:15], s58 offen sc1
 v_mfma_f32_16x16x32_bf16 v[72:75], a[12:15], a[140:143], v[72:75]
 s_add_u32 m0, s29, 8192
 ds_read_b64_tr_b16 a[34:35], v5 offset:2048
 v_mul_f32 v106, v106, v64
 v_mfma_f32_16x16x32_bf16 v[72:75], a[16:19], a[144:147], v[72:75]
 ds_read_b64_tr_b16 a[36:37], v5 offset:4096
 buffer_load_dwordx4 v2, s[8:11], s80 offen lds
 v_mfma_f32_16x16x32_bf16 v[72:75], a[20:23], a[148:151], v[72:75]
 s_waitcnt lgkmcnt(3)
 ds_read_b64_tr_b16 a[38:39], v5 offset:6144
 v_mul_f32 v107, v107, v64
 v_mfma_f32_16x16x32_bf16 v[72:75], a[24:27], a[152:155], v[72:75]
 ds_read_b64_tr_b16 a[40:41], v5 offset:8192
 v_mul_f32 v108, v108, v64
 v_mfma_f32_16x16x32_bf16 v[72:75], a[28:31], a[156:159], v[72:75]
 ds_read_b64_tr_b16 a[42:43], v5 offset:10240
 v_mul_f32 v109, v109, v64
 v_mfma_f32_16x16x32_bf16 v[80:83], a[0:3], a[160:163], 0
 s_add_u32 m0, s29, 12288
 ds_read_b64_tr_b16 a[44:45], v5 offset:12288
 v_mul_f32 v110, v110, v64
 v_mfma_f32_16x16x32_bf16 v[80:83], a[4:7], a[164:167], v[80:83]
 ds_read_b64_tr_b16 a[46:47], v5 offset:14336
 buffer_load_dwordx4 v2, s[8:11], s81 offen lds
 v_mfma_f32_16x16x32_bf16 v[80:83], a[8:11], a[168:171], v[80:83]
 ds_read_b64_tr_b16 a[48:49], v5 offset:16384
 v_mul_f32 v111, v111, v64
 v_mfma_f32_16x16x32_bf16 v[80:83], a[12:15], a[172:175], v[80:83]
 ds_read_b64_tr_b16 a[50:51], v5 offset:18432
 v_cvt_pk_bf16_f32 v104, v104, v105
 v_mfma_f32_16x16x32_bf16 v[80:83], a[16:19], a[176:179], v[80:83]
 ds_read_b64_tr_b16 a[52:53], v5 offset:20480
 v_cvt_pk_bf16_f32 v105, v106, v107
 v_mfma_f32_16x16x32_bf16 v[80:83], a[20:23], a[180:183], v[80:83]
 s_add_u32 m0, s29, 16384
 ds_read_b64_tr_b16 a[54:55], v5 offset:22528
 v_cvt_pk_bf16_f32 v106, v108, v109
 v_mfma_f32_16x16x32_bf16 v[80:83], a[24:27], a[184:187], v[80:83]
 ds_read_b64_tr_b16 a[56:57], v5 offset:24576
 buffer_load_dwordx4 v2, s[8:11], s82 offen lds
 v_mfma_f32_16x16x32_bf16 v[80:83], a[28:31], a[188:191], v[80:83]
 s_waitcnt lgkmcnt(7)
 ds_read_b64_tr_b16 a[58:59], v5 offset:26624
 v_cvt_pk_bf16_f32 v107, v110, v111
 v_mfma_f32_16x16x32_bf16 v[76:79], a[32:35], a[128:131], 0
 ds_read_b64_tr_b16 a[60:61], v5 offset:28672
 v_mul_f32 v112, v112, v65
 v_mfma_f32_16x16x32_bf16 v[76:79], a[36:39], a[132:135], v[76:79]
 s_add_u32 m0, s29, 20480
 ds_read_b64_tr_b16 a[62:63], v5 offset:30720
 v_xor_b32 v6, 0x10000, v6
 v_mfma_f32_16x16x32_bf16 v[76:79], a[40:43], a[136:139], v[76:79]
 s_waitcnt lgkmcnt(4)
 ds_read_b64_tr_b16 a[0:1], v6 offset:0
 v_mul_f32 v113, v113, v65
 v_mfma_f32_16x16x32_bf16 v[76:79], a[44:47], a[140:143], v[76:79]
 ds_read_b64_tr_b16 a[2:3], v6 offset:2048
 buffer_load_dwordx4 v2, s[8:11], s83 offen lds
 v_mfma_f32_16x16x32_bf16 v[76:79], a[48:51], a[144:147], v[76:79]
 s_add_u32 s58, s48, 81920
 ds_read_b64_tr_b16 a[4:5], v6 offset:4096
 v_mul_f32 v114, v114, v65
 v_mfma_f32_16x16x32_bf16 v[76:79], a[52:55], a[148:151], v[76:79]
 s_waitcnt lgkmcnt(3)
 ds_read_b64_tr_b16 a[6:7], v6 offset:6144
 buffer_store_dwordx4 v[104:107], v1, s[12:15], s58 offen sc1
 v_mfma_f32_16x16x32_bf16 v[76:79], a[56:59], a[152:155], v[76:79]
 ds_read_b64_tr_b16 a[8:9], v6 offset:8192
 v_mul_f32 v115, v115, v65
 v_mfma_f32_16x16x32_bf16 v[76:79], a[60:63], a[156:159], v[76:79]
 s_add_u32 m0, s29, 24576
 ds_read_b64_tr_b16 a[10:11], v6 offset:10240
 v_mul_f32 v116, v116, v65
 v_mfma_f32_16x16x32_bf16 v[84:87], a[32:35], a[160:163], 0
 ds_read_b64_tr_b16 a[12:13], v6 offset:12288
 buffer_load_dwordx4 v2, s[8:11], s84 offen lds
 v_mfma_f32_16x16x32_bf16 v[84:87], a[36:39], a[164:167], v[84:87]
 ds_read_b64_tr_b16 a[14:15], v6 offset:14336
 v_mul_f32 v117, v117, v65
 v_mfma_f32_16x16x32_bf16 v[84:87], a[40:43], a[168:171], v[84:87]
 ds_read_b64_tr_b16 a[16:17], v6 offset:16384
 v_mul_f32 v118, v118, v65
 v_mfma_f32_16x16x32_bf16 v[84:87], a[44:47], a[172:175], v[84:87]
 ds_read_b64_tr_b16 a[18:19], v6 offset:18432
 v_mul_f32 v119, v119, v65
 v_mfma_f32_16x16x32_bf16 v[84:87], a[48:51], a[176:179], v[84:87]
 s_add_u32 m0, s29, 28672
 ds_read_b64_tr_b16 a[20:21], v6 offset:20480
 v_cvt_pk_bf16_f32 v112, v112, v113
 v_mfma_f32_16x16x32_bf16 v[84:87], a[52:55], a[180:183], v[84:87]
 ds_read_b64_tr_b16 a[22:23], v6 offset:22528
 buffer_load_dwordx4 v2, s[8:11], s85 offen lds
 v_mfma_f32_16x16x32_bf16 v[84:87], a[56:59], a[184:187], v[84:87]
 ds_read_b64_tr_b16 a[24:25], v6 offset:24576
 v_add_u32 v2, 128, v2
 v_mfma_f32_16x16x32_bf16 v[84:87], a[60:63], a[188:191], v[84:87]
 s_waitcnt lgkmcnt(7)
 ds_read_b64_tr_b16 a[26:27], v6 offset:26624
 v_cvt_pk_bf16_f32 v113, v114, v115
 v_mfma_f32_16x16x32_bf16 v[88:91], a[0:3], a[128:131], 0
 ds_read_b64_tr_b16 a[28:29], v6 offset:28672
 v_cvt_pk_bf16_f32 v114, v116, v117
 v_mfma_f32_16x16x32_bf16 v[88:91], a[4:7], a[132:135], v[88:91]
 s_add_u32 s58, s48, 999424
 ds_read_b64_tr_b16 a[30:31], v6 offset:30720
 v_xor_b32 v7, 0x10000, v7
 v_mfma_f32_16x16x32_bf16 v[88:91], a[8:11], a[136:139], v[88:91]
 s_waitcnt lgkmcnt(4)
 ds_read_b64_tr_b16 a[32:33], v7 offset:0
 v_cvt_pk_bf16_f32 v115, v118, v119
 v_mfma_f32_16x16x32_bf16 v[88:91], a[12:15], a[140:143], v[88:91]
 ds_read_b64_tr_b16 a[34:35], v7 offset:2048
 buffer_store_dwordx4 v[112:115], v1, s[12:15], s58 offen sc1
 v_mfma_f32_16x16x32_bf16 v[88:91], a[16:19], a[144:147], v[88:91]
 ds_read_b64_tr_b16 a[36:37], v7 offset:4096
 v_mul_f32 v72, v72, v64
 v_mfma_f32_16x16x32_bf16 v[88:91], a[20:23], a[148:151], v[88:91]
 s_waitcnt lgkmcnt(3)
 ds_read_b64_tr_b16 a[38:39], v7 offset:6144
 v_mul_f32 v73, v73, v64
 v_mfma_f32_16x16x32_bf16 v[88:91], a[24:27], a[152:155], v[88:91]
 ds_read_b64_tr_b16 a[40:41], v7 offset:8192
 v_mul_f32 v74, v74, v64
 v_mfma_f32_16x16x32_bf16 v[88:91], a[28:31], a[156:159], v[88:91]
 ds_read_b64_tr_b16 a[42:43], v7 offset:10240
 v_mul_f32 v75, v75, v64
 v_mfma_f32_16x16x32_bf16 v[96:99], a[0:3], a[160:163], 0
 ds_read_b64_tr_b16 a[44:45], v7 offset:12288
 v_mul_f32 v76, v76, v64
 v_mfma_f32_16x16x32_bf16 v[96:99], a[4:7], a[164:167], v[96:99]
 ds_read_b64_tr_b16 a[46:47], v7 offset:14336
 v_mul_f32 v77, v77, v64
 v_mfma_f32_16x16x32_bf16 v[96:99], a[8:11], a[168:171], v[96:99]
 ds_read_b64_tr_b16 a[48:49], v7 offset:16384
 v_mul_f32 v78, v78, v64
 v_mfma_f32_16x16x32_bf16 v[96:99], a[12:15], a[172:175], v[96:99]
 ds_read_b64_tr_b16 a[50:51], v7 offset:18432
 v_mul_f32 v79, v79, v64
 v_mfma_f32_16x16x32_bf16 v[96:99], a[16:19], a[176:179], v[96:99]
 ds_read_b64_tr_b16 a[52:53], v7 offset:20480
 v_cvt_pk_bf16_f32 v72, v72, v73
 v_mfma_f32_16x16x32_bf16 v[96:99], a[20:23], a[180:183], v[96:99]
 ds_read_b64_tr_b16 a[54:55], v7 offset:22528
 v_cvt_pk_bf16_f32 v73, v74, v75
 v_mfma_f32_16x16x32_bf16 v[96:99], a[24:27], a[184:187], v[96:99]
 s_add_u32 s58, s48, 98304
 ds_read_b64_tr_b16 a[56:57], v7 offset:24576
 v_cvt_pk_bf16_f32 v74, v76, v77
 v_mfma_f32_16x16x32_bf16 v[96:99], a[28:31], a[188:191], v[96:99]
 s_waitcnt lgkmcnt(7)
 ds_read_b64_tr_b16 a[58:59], v7 offset:26624
 v_cvt_pk_bf16_f32 v75, v78, v79
 v_mfma_f32_16x16x32_bf16 v[92:95], a[32:35], a[128:131], 0
 ds_read_b64_tr_b16 a[60:61], v7 offset:28672
 buffer_store_dwordx4 v[72:75], v1, s[12:15], s58 offen sc1
 v_mfma_f32_16x16x32_bf16 v[92:95], a[36:39], a[132:135], v[92:95]
 ds_read_b64_tr_b16 a[62:63], v7 offset:30720
 v_mul_f32 v80, v80, v65
 v_mfma_f32_16x16x32_bf16 v[92:95], a[40:43], a[136:139], v[92:95]
 s_waitcnt lgkmcnt(4)
 ds_read_b64_tr_b16 a[0:1], v4 offset:32768
 v_mul_f32 v81, v81, v65
 v_mfma_f32_16x16x32_bf16 v[92:95], a[44:47], a[140:143], v[92:95]
 ds_read_b64_tr_b16 a[2:3], v4 offset:34816
 v_mul_f32 v82, v82, v65
 v_mfma_f32_16x16x32_bf16 v[92:95], a[48:51], a[144:147], v[92:95]
 ds_read_b64_tr_b16 a[4:5], v4 offset:36864
 v_mul_f32 v83, v83, v65
 v_mfma_f32_16x16x32_bf16 v[92:95], a[52:55], a[148:151], v[92:95]
 s_waitcnt lgkmcnt(3)
 ds_read_b64_tr_b16 a[6:7], v4 offset:38912
 v_mul_f32 v84, v84, v65
 v_mfma_f32_16x16x32_bf16 v[92:95], a[56:59], a[152:155], v[92:95]
 ds_read_b64_tr_b16 a[8:9], v4 offset:40960
 v_mul_f32 v85, v85, v65
 v_mfma_f32_16x16x32_bf16 v[92:95], a[60:63], a[156:159], v[92:95]
 ds_read_b64_tr_b16 a[10:11], v4 offset:43008
 v_mul_f32 v86, v86, v65
 v_mfma_f32_16x16x32_bf16 v[100:103], a[32:35], a[160:163], 0
 ds_read_b64_tr_b16 a[12:13], v4 offset:45056
 v_mul_f32 v87, v87, v65
 v_mfma_f32_16x16x32_bf16 v[100:103], a[36:39], a[164:167], v[100:103]
 ds_read_b64_tr_b16 a[14:15], v4 offset:47104
 v_cvt_pk_bf16_f32 v80, v80, v81
 v_mfma_f32_16x16x32_bf16 v[100:103], a[40:43], a[168:171], v[100:103]
 ds_read_b64_tr_b16 a[16:17], v4 offset:49152
 v_cvt_pk_bf16_f32 v81, v82, v83
 v_mfma_f32_16x16x32_bf16 v[100:103], a[44:47], a[172:175], v[100:103]
 ds_read_b64_tr_b16 a[18:19], v4 offset:51200
 v_cvt_pk_bf16_f32 v82, v84, v85
 v_mfma_f32_16x16x32_bf16 v[100:103], a[48:51], a[176:179], v[100:103]
 s_add_u32 s58, s48, 1015808
 ds_read_b64_tr_b16 a[20:21], v4 offset:53248
 v_cvt_pk_bf16_f32 v83, v86, v87
 v_mfma_f32_16x16x32_bf16 v[100:103], a[52:55], a[180:183], v[100:103]
 ds_read_b64_tr_b16 a[22:23], v4 offset:55296
 buffer_store_dwordx4 v[80:83], v1, s[12:15], s58 offen sc1
 v_mfma_f32_16x16x32_bf16 v[100:103], a[56:59], a[184:187], v[100:103]
 ds_read_b64_tr_b16 a[24:25], v4 offset:57344
 v_mul_f32 v88, v88, v64
 v_mfma_f32_16x16x32_bf16 v[100:103], a[60:63], a[188:191], v[100:103]
 s_waitcnt lgkmcnt(7)
 ds_read_b64_tr_b16 a[26:27], v4 offset:59392
 v_mul_f32 v89, v89, v64
 v_mfma_f32_16x16x32_bf16 v[104:107], a[0:3], a[128:131], 0
 ds_read_b64_tr_b16 a[28:29], v4 offset:61440
 v_mul_f32 v90, v90, v64
 v_mfma_f32_16x16x32_bf16 v[104:107], a[4:7], a[132:135], v[104:107]
 ds_read_b64_tr_b16 a[30:31], v4 offset:63488
 v_mul_f32 v91, v91, v64
 v_mfma_f32_16x16x32_bf16 v[104:107], a[8:11], a[136:139], v[104:107]
 s_waitcnt lgkmcnt(4)
 ds_read_b64_tr_b16 a[32:33], v5 offset:32768
 v_mul_f32 v92, v92, v64
 v_mfma_f32_16x16x32_bf16 v[104:107], a[12:15], a[140:143], v[104:107]
 ds_read_b64_tr_b16 a[34:35], v5 offset:34816
 v_mul_f32 v93, v93, v64
 v_mfma_f32_16x16x32_bf16 v[104:107], a[16:19], a[144:147], v[104:107]
 ds_read_b64_tr_b16 a[36:37], v5 offset:36864
 v_mul_f32 v94, v94, v64
 v_mfma_f32_16x16x32_bf16 v[104:107], a[20:23], a[148:151], v[104:107]
 s_waitcnt lgkmcnt(3)
 ds_read_b64_tr_b16 a[38:39], v5 offset:38912
 v_mul_f32 v95, v95, v64
 v_mfma_f32_16x16x32_bf16 v[104:107], a[24:27], a[152:155], v[104:107]
 ds_read_b64_tr_b16 a[40:41], v5 offset:40960
 v_cvt_pk_bf16_f32 v88, v88, v89
 v_mfma_f32_16x16x32_bf16 v[104:107], a[28:31], a[156:159], v[104:107]
 ds_read_b64_tr_b16 a[42:43], v5 offset:43008
 v_cvt_pk_bf16_f32 v89, v90, v91
 v_mfma_f32_16x16x32_bf16 v[112:115], a[0:3], a[160:163], 0
 ds_read_b64_tr_b16 a[44:45], v5 offset:45056
 v_cvt_pk_bf16_f32 v90, v92, v93
 v_mfma_f32_16x16x32_bf16 v[112:115], a[4:7], a[164:167], v[112:115]
 s_add_u32 s58, s48, 114688
 ds_read_b64_tr_b16 a[46:47], v5 offset:47104
 v_cvt_pk_bf16_f32 v91, v94, v95
 v_mfma_f32_16x16x32_bf16 v[112:115], a[8:11], a[168:171], v[112:115]
 ds_read_b64_tr_b16 a[48:49], v5 offset:49152
 buffer_store_dwordx4 v[88:91], v1, s[12:15], s58 offen sc1
 v_mfma_f32_16x16x32_bf16 v[112:115], a[12:15], a[172:175], v[112:115]
 ds_read_b64_tr_b16 a[50:51], v5 offset:51200
 v_mul_f32 v96, v96, v65
 v_mfma_f32_16x16x32_bf16 v[112:115], a[16:19], a[176:179], v[112:115]
 ds_read_b64_tr_b16 a[52:53], v5 offset:53248
 v_mul_f32 v97, v97, v65
 v_mfma_f32_16x16x32_bf16 v[112:115], a[20:23], a[180:183], v[112:115]
 ds_read_b64_tr_b16 a[54:55], v5 offset:55296
 v_mul_f32 v98, v98, v65
 v_mfma_f32_16x16x32_bf16 v[112:115], a[24:27], a[184:187], v[112:115]
 ds_read_b64_tr_b16 a[56:57], v5 offset:57344
 v_mul_f32 v99, v99, v65
 v_mfma_f32_16x16x32_bf16 v[112:115], a[28:31], a[188:191], v[112:115]
 s_waitcnt lgkmcnt(7)
 ds_read_b64_tr_b16 a[58:59], v5 offset:59392
 v_mul_f32 v100, v100, v65
 v_mfma_f32_16x16x32_bf16 v[108:111], a[32:35], a[128:131], 0
 ds_read_b64_tr_b16 a[60:61], v5 offset:61440
 v_mul_f32 v101, v101, v65
 v_mfma_f32_16x16x32_bf16 v[108:111], a[36:39], a[132:135], v[108:111]
 ds_read_b64_tr_b16 a[62:63], v5 offset:63488
 v_mul_f32 v102, v102, v65
 v_mfma_f32_16x16x32_bf16 v[108:111], a[40:43], a[136:139], v[108:111]
 s_waitcnt lgkmcnt(4)
 ds_read_b64_tr_b16 a[0:1], v6 offset:32768
 v_mul_f32 v103, v103, v65
 v_mfma_f32_16x16x32_bf16 v[108:111], a[44:47], a[140:143], v[108:111]
 ds_read_b64_tr_b16 a[2:3], v6 offset:34816
 v_cvt_pk_bf16_f32 v96, v96, v97
 v_mfma_f32_16x16x32_bf16 v[108:111], a[48:51], a[144:147], v[108:111]
 ds_read_b64_tr_b16 a[4:5], v6 offset:36864
 v_cvt_pk_bf16_f32 v97, v98, v99
 v_mfma_f32_16x16x32_bf16 v[108:111], a[52:55], a[148:151], v[108:111]
 s_waitcnt lgkmcnt(3)
 ds_read_b64_tr_b16 a[6:7], v6 offset:38912
 v_cvt_pk_bf16_f32 v98, v100, v101
 v_mfma_f32_16x16x32_bf16 v[108:111], a[56:59], a[152:155], v[108:111]
 s_add_u32 s58, s48, 1032192
 ds_read_b64_tr_b16 a[8:9], v6 offset:40960
 v_cvt_pk_bf16_f32 v99, v102, v103
 v_mfma_f32_16x16x32_bf16 v[108:111], a[60:63], a[156:159], v[108:111]
 ds_read_b64_tr_b16 a[10:11], v6 offset:43008
 buffer_store_dwordx4 v[96:99], v1, s[12:15], s58 offen sc1
 v_mfma_f32_16x16x32_bf16 v[116:119], a[32:35], a[160:163], 0
 ds_read_b64_tr_b16 a[12:13], v6 offset:45056
 v_mul_f32 v104, v104, v64
 v_mfma_f32_16x16x32_bf16 v[116:119], a[36:39], a[164:167], v[116:119]
 ds_read_b64_tr_b16 a[14:15], v6 offset:47104
 v_mul_f32 v105, v105, v64
 v_mfma_f32_16x16x32_bf16 v[116:119], a[40:43], a[168:171], v[116:119]
 ds_read_b64_tr_b16 a[16:17], v6 offset:49152
 v_mul_f32 v106, v106, v64
 v_mfma_f32_16x16x32_bf16 v[116:119], a[44:47], a[172:175], v[116:119]
 ds_read_b64_tr_b16 a[18:19], v6 offset:51200
 v_mul_f32 v107, v107, v64
 v_mfma_f32_16x16x32_bf16 v[116:119], a[48:51], a[176:179], v[116:119]
 ds_read_b64_tr_b16 a[20:21], v6 offset:53248
 v_mul_f32 v108, v108, v64
 v_mfma_f32_16x16x32_bf16 v[116:119], a[52:55], a[180:183], v[116:119]
 ds_read_b64_tr_b16 a[22:23], v6 offset:55296
 v_mul_f32 v109, v109, v64
 v_mfma_f32_16x16x32_bf16 v[116:119], a[56:59], a[184:187], v[116:119]
 ds_read_b64_tr_b16 a[24:25], v6 offset:57344
 v_mul_f32 v110, v110, v64
 v_mfma_f32_16x16x32_bf16 v[116:119], a[60:63], a[188:191], v[116:119]
 s_waitcnt lgkmcnt(7)
 ds_read_b64_tr_b16 a[26:27], v6 offset:59392
 v_mul_f32 v111, v111, v64
 v_mfma_f32_16x16x32_bf16 v[72:75], a[0:3], a[128:131], 0
 ds_read_b64_tr_b16 a[28:29], v6 offset:61440
 v_cvt_pk_bf16_f32 v104, v104, v105
 v_mfma_f32_16x16x32_bf16 v[72:75], a[4:7], a[132:135], v[72:75]
 ds_read_b64_tr_b16 a[30:31], v6 offset:63488
 v_cvt_pk_bf16_f32 v105, v106, v107
 v_mfma_f32_16x16x32_bf16 v[72:75], a[8:11], a[136:139], v[72:75]
 s_waitcnt lgkmcnt(4)
 ds_read_b64_tr_b16 a[32:33], v7 offset:32768
 v_cvt_pk_bf16_f32 v106, v108, v109
 v_mfma_f32_16x16x32_bf16 v[72:75], a[12:15], a[140:143], v[72:75]
 s_add_u32 s58, s48, 131072
 ds_read_b64_tr_b16 a[34:35], v7 offset:34816
 v_cvt_pk_bf16_f32 v107, v110, v111
 v_mfma_f32_16x16x32_bf16 v[72:75], a[16:19], a[144:147], v[72:75]
 ds_read_b64_tr_b16 a[36:37], v7 offset:36864
 buffer_store_dwordx4 v[104:107], v1, s[12:15], s58 offen sc1
 v_mfma_f32_16x16x32_bf16 v[72:75], a[20:23], a[148:151], v[72:75]
 s_waitcnt lgkmcnt(3)
 ds_read_b64_tr_b16 a[38:39], v7 offset:38912
 v_mul_f32 v112, v112, v65
 v_mfma_f32_16x16x32_bf16 v[72:75], a[24:27], a[152:155], v[72:75]
 ds_read_b64_tr_b16 a[40:41], v7 offset:40960
 v_mul_f32 v113, v113, v65
 v_mfma_f32_16x16x32_bf16 v[72:75], a[28:31], a[156:159], v[72:75]
 ds_read_b64_tr_b16 a[42:43], v7 offset:43008
 v_mul_f32 v114, v114, v65
 v_mfma_f32_16x16x32_bf16 v[80:83], a[0:3], a[160:163], 0
 ds_read_b64_tr_b16 a[44:45], v7 offset:45056
 v_mul_f32 v115, v115, v65
 v_mfma_f32_16x16x32_bf16 v[80:83], a[4:7], a[164:167], v[80:83]
 ds_read_b64_tr_b16 a[46:47], v7 offset:47104
 v_mul_f32 v116, v116, v65
 v_mfma_f32_16x16x32_bf16 v[80:83], a[8:11], a[168:171], v[80:83]
 ds_read_b64_tr_b16 a[48:49], v7 offset:49152
 v_mul_f32 v117, v117, v65
 v_mfma_f32_16x16x32_bf16 v[80:83], a[12:15], a[172:175], v[80:83]
 ds_read_b64_tr_b16 a[50:51], v7 offset:51200
 v_mul_f32 v118, v118, v65
 v_mfma_f32_16x16x32_bf16 v[80:83], a[16:19], a[176:179], v[80:83]
 ds_read_b64_tr_b16 a[52:53], v7 offset:53248
 v_mul_f32 v119, v119, v65
 v_mfma_f32_16x16x32_bf16 v[80:83], a[20:23], a[180:183], v[80:83]
 ds_read_b64_tr_b16 a[54:55], v7 offset:55296
 v_cvt_pk_bf16_f32 v112, v112, v113
 v_mfma_f32_16x16x32_bf16 v[80:83], a[24:27], a[184:187], v[80:83]
 ds_read_b64_tr_b16 a[56:57], v7 offset:57344
 v_cvt_pk_bf16_f32 v113, v114, v115
 v_mfma_f32_16x16x32_bf16 v[80:83], a[28:31], a[188:191], v[80:83]
 s_waitcnt lgkmcnt(7)
 ds_read_b64_tr_b16 a[58:59], v7 offset:59392
 v_cvt_pk_bf16_f32 v114, v116, v117
 v_mfma_f32_16x16x32_bf16 v[76:79], a[32:35], a[128:131], 0
 s_waitcnt vmcnt(3)
 ds_read_b64_tr_b16 a[60:61], v7 offset:61440
 v_cvt_pk_bf16_f32 v115, v118, v119
 v_mfma_f32_16x16x32_bf16 v[76:79], a[36:39], a[132:135], v[76:79]
 s_barrier
 ds_read_b64_tr_b16 a[62:63], v7 offset:63488
 v_xor_b32 v4, 0x30000, v4
 v_mfma_f32_16x16x32_bf16 v[76:79], a[40:43], a[136:139], v[76:79]
 s_waitcnt lgkmcnt(4)
 ds_read_b64_tr_b16 a[0:1], v4 offset:0
 buffer_store_dword v9, v9, s[12:15], s93 offen offset:64 sc1
 v_mfma_f32_16x16x32_bf16 v[76:79], a[44:47], a[140:143], v[76:79]
 s_add_u32 s58, s48, 1048576
 ds_read_b64_tr_b16 a[2:3], v4 offset:2048
 v_mul_f32 v72, v72, v64
 v_mfma_f32_16x16x32_bf16 v[76:79], a[48:51], a[144:147], v[76:79]
 ds_read_b64_tr_b16 a[4:5], v4 offset:4096
 buffer_store_dwordx4 v[112:115], v1, s[12:15], s58 offen sc1
 v_mfma_f32_16x16x32_bf16 v[76:79], a[52:55], a[148:151], v[76:79]
 s_waitcnt lgkmcnt(3)
 ds_read_b64_tr_b16 a[6:7], v4 offset:6144
 v_mul_f32 v73, v73, v64
 v_mfma_f32_16x16x32_bf16 v[76:79], a[56:59], a[152:155], v[76:79]
 ds_read_b64_tr_b16 a[8:9], v4 offset:8192
 v_mul_f32 v74, v74, v64
 v_mfma_f32_16x16x32_bf16 v[76:79], a[60:63], a[156:159], v[76:79]
 ds_read_b64_tr_b16 a[10:11], v4 offset:10240
 v_mul_f32 v75, v75, v64
 v_mfma_f32_16x16x32_bf16 v[84:87], a[32:35], a[160:163], 0
 ds_read_b64_tr_b16 a[12:13], v4 offset:12288
 v_mul_f32 v80, v80, v65
 v_mfma_f32_16x16x32_bf16 v[84:87], a[36:39], a[164:167], v[84:87]
 ds_read_b64_tr_b16 a[14:15], v4 offset:14336
 v_mul_f32 v81, v81, v65
 v_mfma_f32_16x16x32_bf16 v[84:87], a[40:43], a[168:171], v[84:87]
 ds_read_b64_tr_b16 a[16:17], v4 offset:16384
 v_mul_f32 v82, v82, v65
 v_mfma_f32_16x16x32_bf16 v[84:87], a[44:47], a[172:175], v[84:87]
 s_waitcnt lgkmcnt(9)
 ds_read_b64_tr_b16 a[18:19], v4 offset:18432
 v_mul_f32 v83, v83, v65
 v_mfma_f32_16x16x32_bf16 v[84:87], a[48:51], a[176:179], v[84:87]
 s_barrier
 ds_read_b64_tr_b16 a[20:21], v4 offset:20480
 v_mul_f32 v76, v76, v64
 v_mfma_f32_16x16x32_bf16 v[84:87], a[52:55], a[180:183], v[84:87]
 s_add_u32 m0, s33, 4640
 ds_read_b64_tr_b16 a[22:23], v4 offset:22528
 v_mul_f32 v77, v77, v64
 v_mfma_f32_16x16x32_bf16 v[84:87], a[56:59], a[184:187], v[84:87]
 ds_read_b64_tr_b16 a[24:25], v4 offset:24576
 buffer_load_dwordx4 v1, s[4:7], s34 offen offset:0 lds
 v_mfma_f32_16x16x32_bf16 v[84:87], a[60:63], a[188:191], v[84:87]
 s_waitcnt lgkmcnt(7)
 ds_read_b64_tr_b16 a[26:27], v4 offset:26624
 v_mul_f32 v78, v78, v64
 v_mfma_f32_16x16x32_bf16 v[88:91], a[0:3], a[128:131], 0
 ds_read_b64_tr_b16 a[28:29], v4 offset:28672
 v_mul_f32 v79, v79, v64
 v_mfma_f32_16x16x32_bf16 v[88:91], a[4:7], a[132:135], v[88:91]
 ds_read_b64_tr_b16 a[30:31], v4 offset:30720
 v_xor_b32 v5, 0x30000, v5
 v_mfma_f32_16x16x32_bf16 v[88:91], a[8:11], a[136:139], v[88:91]
 s_waitcnt lgkmcnt(4)
 ds_read_b64_tr_b16 a[32:33], v5 offset:0
 v_cvt_pk_bf16_f32 v72, v72, v73
 v_mfma_f32_16x16x32_bf16 v[88:91], a[12:15], a[140:143], v[88:91]
 ds_read_b64_tr_b16 a[34:35], v5 offset:2048
 buffer_load_dwordx4 v1, s[4:7], s34 offen offset:1024 lds
 v_mfma_f32_16x16x32_bf16 v[88:91], a[16:19], a[144:147], v[88:91]
 ds_read_b64_tr_b16 a[36:37], v5 offset:4096
 v_cvt_pk_bf16_f32 v73, v74, v75
 v_mfma_f32_16x16x32_bf16 v[88:91], a[20:23], a[148:151], v[88:91]
 s_waitcnt lgkmcnt(3)
 ds_read_b64_tr_b16 a[38:39], v5 offset:6144
 v_cvt_pk_bf16_f32 v74, v76, v77
 v_mfma_f32_16x16x32_bf16 v[88:91], a[24:27], a[152:155], v[88:91]
 ds_read_b64_tr_b16 a[40:41], v5 offset:8192
 v_cvt_pk_bf16_f32 v75, v78, v79
 v_mfma_f32_16x16x32_bf16 v[88:91], a[28:31], a[156:159], v[88:91]
 ds_read_b64_tr_b16 a[42:43], v5 offset:10240
 v_mul_f32 v84, v84, v65
 v_mfma_f32_16x16x32_bf16 v[96:99], a[0:3], a[160:163], 0
 ds_read_b64_tr_b16 a[44:45], v5 offset:12288
 buffer_load_dwordx4 v1, s[4:7], s34 offen offset:2048 lds
 v_mfma_f32_16x16x32_bf16 v[96:99], a[4:7], a[164:167], v[96:99]
 s_add_u32 s58, s48, 147456
 ds_read_b64_tr_b16 a[46:47], v5 offset:14336
 v_mul_f32 v85, v85, v65
 v_mfma_f32_16x16x32_bf16 v[96:99], a[8:11], a[168:171], v[96:99]
 ds_read_b64_tr_b16 a[48:49], v5 offset:16384
 buffer_store_dwordx4 v[72:75], v1, s[12:15], s58 offen sc1
 v_mfma_f32_16x16x32_bf16 v[96:99], a[12:15], a[172:175], v[96:99]
 ds_read_b64_tr_b16 a[50:51], v5 offset:18432
 v_mul_f32 v86, v86, v65
 v_mfma_f32_16x16x32_bf16 v[96:99], a[16:19], a[176:179], v[96:99]
 ds_read_b64_tr_b16 a[52:53], v5 offset:20480
 v_mul_f32 v87, v87, v65
 v_mfma_f32_16x16x32_bf16 v[96:99], a[20:23], a[180:183], v[96:99]
 ds_read_b64_tr_b16 a[54:55], v5 offset:22528
 buffer_load_dwordx4 v1, s[4:7], s34 offen offset:3072 lds
 v_mfma_f32_16x16x32_bf16 v[96:99], a[24:27], a[184:187], v[96:99]
 ds_read_b64_tr_b16 a[56:57], v5 offset:24576
 v_cvt_pk_bf16_f32 v80, v80, v81
 v_mfma_f32_16x16x32_bf16 v[96:99], a[28:31], a[188:191], v[96:99]
 s_waitcnt lgkmcnt(7)
 ds_read_b64_tr_b16 a[58:59], v5 offset:26624
 v_cvt_pk_bf16_f32 v81, v82, v83
 v_mfma_f32_16x16x32_bf16 v[92:95], a[32:35], a[128:131], 0
 ds_read_b64_tr_b16 a[60:61], v5 offset:28672
 v_cvt_pk_bf16_f32 v82, v84, v85
 v_mfma_f32_16x16x32_bf16 v[92:95], a[36:39], a[132:135], v[92:95]
 s_add_u32 m0, s33, 128
 ds_read_b64_tr_b16 a[62:63], v5 offset:30720
 v_xor_b32 v6, 0x30000, v6
 v_mfma_f32_16x16x32_bf16 v[92:95], a[40:43], a[136:139], v[92:95]
 s_waitcnt lgkmcnt(4)
 ds_read_b64_tr_b16 a[0:1], v6 offset:0
 buffer_load_dwordx4 v10, s[12:15], s35 offen offset:0 sc1 lds
 v_mfma_f32_16x16x32_bf16 v[92:95], a[44:47], a[140:143], v[92:95]
 s_add_u32 s58, s48, 1064960
 ds_read_b64_tr_b16 a[2:3], v6 offset:2048
 v_cvt_pk_bf16_f32 v83, v86, v87
 v_mfma_f32_16x16x32_bf16 v[92:95], a[48:51], a[144:147], v[92:95]
 ds_read_b64_tr_b16 a[4:5], v6 offset:4096
 buffer_store_dwordx4 v[80:83], v1, s[12:15], s58 offen sc1
 v_mfma_f32_16x16x32_bf16 v[92:95], a[52:55], a[148:151], v[92:95]
 s_waitcnt lgkmcnt(3)
 ds_read_b64_tr_b16 a[6:7], v6 offset:6144
 v_mul_f32 v88, v88, v64
 v_mfma_f32_16x16x32_bf16 v[92:95], a[56:59], a[152:155], v[92:95]
 s_add_u32 m0, s33, 1248
 ds_read_b64_tr_b16 a[8:9], v6 offset:8192
 v_mul_f32 v89, v89, v64
 v_mfma_f32_16x16x32_bf16 v[92:95], a[60:63], a[156:159], v[92:95]
 ds_read_b64_tr_b16 a[10:11], v6 offset:10240
 buffer_load_dwordx4 v10, s[12:15], s35 offen offset:32 sc1 lds
 v_mfma_f32_16x16x32_bf16 v[100:103], a[32:35], a[160:163], 0
 ds_read_b64_tr_b16 a[12:13], v6 offset:12288
 v_mul_f32 v90, v90, v64
 v_mfma_f32_16x16x32_bf16 v[100:103], a[36:39], a[164:167], v[100:103]
 ds_read_b64_tr_b16 a[14:15], v6 offset:14336
 v_mul_f32 v91, v91, v64
 v_mfma_f32_16x16x32_bf16 v[100:103], a[40:43], a[168:171], v[100:103]
 ds_read_b64_tr_b16 a[16:17], v6 offset:16384
 v_mul_f32 v96, v96, v65
 v_mfma_f32_16x16x32_bf16 v[100:103], a[44:47], a[172:175], v[100:103]
 s_add_u32 m0, s33, 2368
 ds_read_b64_tr_b16 a[18:19], v6 offset:18432
 v_mul_f32 v97, v97, v65
 v_mfma_f32_16x16x32_bf16 v[100:103], a[48:51], a[176:179], v[100:103]
 ds_read_b64_tr_b16 a[20:21], v6 offset:20480
 buffer_load_dwordx4 v10, s[12:15], s35 offen offset:64 sc1 lds
 v_mfma_f32_16x16x32_bf16 v[100:103], a[52:55], a[180:183], v[100:103]
 ds_read_b64_tr_b16 a[22:23], v6 offset:22528
 v_mul_f32 v92, v92, v64
 v_mfma_f32_16x16x32_bf16 v[100:103], a[56:59], a[184:187], v[100:103]
 ds_read_b64_tr_b16 a[24:25], v6 offset:24576
 v_mul_f32 v93, v93, v64
 v_mfma_f32_16x16x32_bf16 v[100:103], a[60:63], a[188:191], v[100:103]
 s_waitcnt lgkmcnt(7)
 ds_read_b64_tr_b16 a[26:27], v6 offset:26624
 v_mul_f32 v94, v94, v64
 v_mfma_f32_16x16x32_bf16 v[104:107], a[0:3], a[128:131], 0
 ds_read_b64_tr_b16 a[28:29], v6 offset:28672
 v_mul_f32 v95, v95, v64
 v_mfma_f32_16x16x32_bf16 v[104:107], a[4:7], a[132:135], v[104:107]
 s_add_u32 m0, s33, 3488
 ds_read_b64_tr_b16 a[30:31], v6 offset:30720
 v_xor_b32 v7, 0x30000, v7
 v_mfma_f32_16x16x32_bf16 v[104:107], a[8:11], a[136:139], v[104:107]
 s_waitcnt lgkmcnt(4)
 ds_read_b64_tr_b16 a[32:33], v7 offset:0
 buffer_load_dwordx4 v10, s[12:15], s35 offen offset:96 sc1 lds
 v_mfma_f32_16x16x32_bf16 v[104:107], a[12:15], a[140:143], v[104:107]
 ds_read_b64_tr_b16 a[34:35], v7 offset:2048
 v_cvt_pk_bf16_f32 v88, v88, v89
 v_mfma_f32_16x16x32_bf16 v[104:107], a[16:19], a[144:147], v[104:107]
 ds_read_b64_tr_b16 a[36:37], v7 offset:4096
 v_cvt_pk_bf16_f32 v89, v90, v91
 v_mfma_f32_16x16x32_bf16 v[104:107], a[20:23], a[148:151], v[104:107]
 s_waitcnt lgkmcnt(3)
 ds_read_b64_tr_b16 a[38:39], v7 offset:6144
 v_cvt_pk_bf16_f32 v90, v92, v93
 v_mfma_f32_16x16x32_bf16 v[104:107], a[24:27], a[152:155], v[104:107]
 s_add_u32 s58, s48, 163840
 ds_read_b64_tr_b16 a[40:41], v7 offset:8192
 v_cvt_pk_bf16_f32 v91, v94, v95
 v_mfma_f32_16x16x32_bf16 v[104:107], a[28:31], a[156:159], v[104:107]
 ds_read_b64_tr_b16 a[42:43], v7 offset:10240
 buffer_store_dwordx4 v[88:91], v1, s[12:15], s58 offen sc1
 v_mfma_f32_16x16x32_bf16 v[112:115], a[0:3], a[160:163], 0
 ds_read_b64_tr_b16 a[44:45], v7 offset:12288
 v_mul_f32 v98, v98, v65
 v_mfma_f32_16x16x32_bf16 v[112:115], a[4:7], a[164:167], v[112:115]
 ds_read_b64_tr_b16 a[46:47], v7 offset:14336
 v_mul_f32 v99, v99, v65
 v_mfma_f32_16x16x32_bf16 v[112:115], a[8:11], a[168:171], v[112:115]
 ds_read_b64_tr_b16 a[48:49], v7 offset:16384
 v_mul_f32 v100, v100, v65
 v_mfma_f32_16x16x32_bf16 v[112:115], a[12:15], a[172:175], v[112:115]
 ds_read_b64_tr_b16 a[50:51], v7 offset:18432
 v_mul_f32 v101, v101, v65
 v_mfma_f32_16x16x32_bf16 v[112:115], a[16:19], a[176:179], v[112:115]
 ds_read_b64_tr_b16 a[52:53], v7 offset:20480
 v_mul_f32 v102, v102, v65
 v_mfma_f32_16x16x32_bf16 v[112:115], a[20:23], a[180:183], v[112:115]
 ds_read_b64_tr_b16 a[54:55], v7 offset:22528
 v_mul_f32 v103, v103, v65
 v_mfma_f32_16x16x32_bf16 v[112:115], a[24:27], a[184:187], v[112:115]
 ds_read_b64_tr_b16 a[56:57], v7 offset:24576
 v_cvt_pk_bf16_f32 v96, v96, v97
 v_mfma_f32_16x16x32_bf16 v[112:115], a[28:31], a[188:191], v[112:115]
 s_waitcnt lgkmcnt(7)
 ds_read_b64_tr_b16 a[58:59], v7 offset:26624
 v_cvt_pk_bf16_f32 v97, v98, v99
 v_mfma_f32_16x16x32_bf16 v[108:111], a[32:35], a[128:131], 0
 ds_read_b64_tr_b16 a[60:61], v7 offset:28672
 v_cvt_pk_bf16_f32 v98, v100, v101
 v_mfma_f32_16x16x32_bf16 v[108:111], a[36:39], a[132:135], v[108:111]
 s_add_u32 s58, s48, 1081344
 ds_read_b64_tr_b16 a[62:63], v7 offset:30720
 v_xor_b32 v4, 0x20000, v4
 v_mfma_f32_16x16x32_bf16 v[108:111], a[40:43], a[136:139], v[108:111]
 s_waitcnt lgkmcnt(4)
 ds_read_b64_tr_b16 a[0:1], v4 offset:0
 v_cvt_pk_bf16_f32 v99, v102, v103
 v_mfma_f32_16x16x32_bf16 v[108:111], a[44:47], a[140:143], v[108:111]
 ds_read_b64_tr_b16 a[2:3], v4 offset:2048
 buffer_store_dwordx4 v[96:99], v1, s[12:15], s58 offen sc1
 v_mfma_f32_16x16x32_bf16 v[108:111], a[48:51], a[144:147], v[108:111]
 ds_read_b64_tr_b16 a[4:5], v4 offset:4096
 v_mul_f32 v104, v104, v64
 v_mfma_f32_16x16x32_bf16 v[108:111], a[52:55], a[148:151], v[108:111]
 s_waitcnt lgkmcnt(3)
 ds_read_b64_tr_b16 a[6:7], v4 offset:6144
 v_mul_f32 v105, v105, v64
 v_mfma_f32_16x16x32_bf16 v[108:111], a[56:59], a[152:155], v[108:111]
 ds_read_b64_tr_b16 a[8:9], v4 offset:8192
 v_mul_f32 v106, v106, v64
 v_mfma_f32_16x16x32_bf16 v[108:111], a[60:63], a[156:159], v[108:111]
 ds_read_b64_tr_b16 a[10:11], v4 offset:10240
 v_mul_f32 v107, v107, v64
 v_mfma_f32_16x16x32_bf16 v[116:119], a[32:35], a[160:163], 0
 ds_read_b64_tr_b16 a[12:13], v4 offset:12288
 v_mul_f32 v112, v112, v65
 v_mfma_f32_16x16x32_bf16 v[116:119], a[36:39], a[164:167], v[116:119]
 ds_read_b64_tr_b16 a[14:15], v4 offset:14336
 v_mul_f32 v113, v113, v65
 v_mfma_f32_16x16x32_bf16 v[116:119], a[40:43], a[168:171], v[116:119]
 ds_read_b64_tr_b16 a[16:17], v4 offset:16384
 v_mul_f32 v114, v114, v65
 v_mfma_f32_16x16x32_bf16 v[116:119], a[44:47], a[172:175], v[116:119]
 ds_read_b64_tr_b16 a[18:19], v4 offset:18432
 v_mul_f32 v115, v115, v65
 v_mfma_f32_16x16x32_bf16 v[116:119], a[48:51], a[176:179], v[116:119]
 ds_read_b64_tr_b16 a[20:21], v4 offset:20480
 v_mul_f32 v108, v108, v64
 v_mfma_f32_16x16x32_bf16 v[116:119], a[52:55], a[180:183], v[116:119]
 ds_read_b64_tr_b16 a[22:23], v4 offset:22528
 v_mul_f32 v109, v109, v64
 v_mfma_f32_16x16x32_bf16 v[116:119], a[56:59], a[184:187], v[116:119]
 ds_read_b64_tr_b16 a[24:25], v4 offset:24576
 v_mul_f32 v110, v110, v64
 v_mfma_f32_16x16x32_bf16 v[116:119], a[60:63], a[188:191], v[116:119]
 s_waitcnt lgkmcnt(7)
 ds_read_b64_tr_b16 a[26:27], v4 offset:26624
 v_mul_f32 v111, v111, v64
 v_mfma_f32_16x16x32_bf16 v[72:75], a[0:3], a[128:131], 0
 ds_read_b64_tr_b16 a[28:29], v4 offset:28672
 v_cvt_pk_bf16_f32 v104, v104, v105
 v_mfma_f32_16x16x32_bf16 v[72:75], a[4:7], a[132:135], v[72:75]
 ds_read_b64_tr_b16 a[30:31], v4 offset:30720
 v_xor_b32 v5, 0x20000, v5
 v_mfma_f32_16x16x32_bf16 v[72:75], a[8:11], a[136:139], v[72:75]
 s_waitcnt lgkmcnt(4)
 ds_read_b64_tr_b16 a[32:33], v5 offset:0
 v_cvt_pk_bf16_f32 v105, v106, v107
 v_mfma_f32_16x16x32_bf16 v[72:75], a[12:15], a[140:143], v[72:75]
 ds_read_b64_tr_b16 a[34:35], v5 offset:2048
 v_cvt_pk_bf16_f32 v106, v108, v109
 v_mfma_f32_16x16x32_bf16 v[72:75], a[16:19], a[144:147], v[72:75]
 s_add_u32 s58, s48, 180224
 ds_read_b64_tr_b16 a[36:37], v5 offset:4096
 v_cvt_pk_bf16_f32 v107, v110, v111
 v_mfma_f32_16x16x32_bf16 v[72:75], a[20:23], a[148:151], v[72:75]
 s_waitcnt lgkmcnt(3)
 ds_read_b64_tr_b16 a[38:39], v5 offset:6144
 buffer_store_dwordx4 v[104:107], v1, s[12:15], s58 offen sc1
 v_mfma_f32_16x16x32_bf16 v[72:75], a[24:27], a[152:155], v[72:75]
 ds_read_b64_tr_b16 a[40:41], v5 offset:8192
 v_mul_f32 v116, v116, v65
 v_mfma_f32_16x16x32_bf16 v[72:75], a[28:31], a[156:159], v[72:75]
 ds_read_b64_tr_b16 a[42:43], v5 offset:10240
 v_mul_f32 v117, v117, v65
 v_mfma_f32_16x16x32_bf16 v[80:83], a[0:3], a[160:163], 0
 ds_read_b64_tr_b16 a[44:45], v5 offset:12288
 v_mul_f32 v118, v118, v65
 v_mfma_f32_16x16x32_bf16 v[80:83], a[4:7], a[164:167], v[80:83]
 ds_read_b64_tr_b16 a[46:47], v5 offset:14336
 v_mul_f32 v119, v119, v65
 v_mfma_f32_16x16x32_bf16 v[80:83], a[8:11], a[168:171], v[80:83]
 ds_read_b64_tr_b16 a[48:49], v5 offset:16384
 v_cvt_pk_bf16_f32 v112, v112, v113
 v_mfma_f32_16x16x32_bf16 v[80:83], a[12:15], a[172:175], v[80:83]
 ds_read_b64_tr_b16 a[50:51], v5 offset:18432
 v_cvt_pk_bf16_f32 v113, v114, v115
 v_mfma_f32_16x16x32_bf16 v[80:83], a[16:19], a[176:179], v[80:83]
 ds_read_b64_tr_b16 a[52:53], v5 offset:20480
 v_cvt_pk_bf16_f32 v114, v116, v117
 v_mfma_f32_16x16x32_bf16 v[80:83], a[20:23], a[180:183], v[80:83]
 s_add_u32 s58, s48, 1097728
 ds_read_b64_tr_b16 a[54:55], v5 offset:22528
 v_cvt_pk_bf16_f32 v115, v118, v119
 v_mfma_f32_16x16x32_bf16 v[80:83], a[24:27], a[184:187], v[80:83]
 ds_read_b64_tr_b16 a[56:57], v5 offset:24576
 buffer_store_dwordx4 v[112:115], v1, s[12:15], s58 offen sc1
 v_mfma_f32_16x16x32_bf16 v[80:83], a[28:31], a[188:191], v[80:83]
 s_waitcnt lgkmcnt(7)
 ds_read_b64_tr_b16 a[58:59], v5 offset:26624
 v_mul_f32 v72, v72, v64
 v_mfma_f32_16x16x32_bf16 v[76:79], a[32:35], a[128:131], 0
 ds_read_b64_tr_b16 a[60:61], v5 offset:28672
 v_mul_f32 v73, v73, v64
 v_mfma_f32_16x16x32_bf16 v[76:79], a[36:39], a[132:135], v[76:79]
 ds_read_b64_tr_b16 a[62:63], v5 offset:30720
 v_xor_b32 v6, 0x20000, v6
 v_mfma_f32_16x16x32_bf16 v[76:79], a[40:43], a[136:139], v[76:79]
 s_waitcnt lgkmcnt(4)
 ds_read_b64_tr_b16 a[0:1], v6 offset:0
 v_mul_f32 v74, v74, v64
 v_mfma_f32_16x16x32_bf16 v[76:79], a[44:47], a[140:143], v[76:79]
 ds_read_b64_tr_b16 a[2:3], v6 offset:2048
 v_mul_f32 v75, v75, v64
 v_mfma_f32_16x16x32_bf16 v[76:79], a[48:51], a[144:147], v[76:79]
 ds_read_b64_tr_b16 a[4:5], v6 offset:4096
 v_mul_f32 v80, v80, v65
 v_mfma_f32_16x16x32_bf16 v[76:79], a[52:55], a[148:151], v[76:79]
 s_waitcnt lgkmcnt(3)
 ds_read_b64_tr_b16 a[6:7], v6 offset:6144
 v_mul_f32 v81, v81, v65
 v_mfma_f32_16x16x32_bf16 v[76:79], a[56:59], a[152:155], v[76:79]
 ds_read_b64_tr_b16 a[8:9], v6 offset:8192
 v_mul_f32 v82, v82, v65
 v_mfma_f32_16x16x32_bf16 v[76:79], a[60:63], a[156:159], v[76:79]
 ds_read_b64_tr_b16 a[10:11], v6 offset:10240
 v_mul_f32 v83, v83, v65
 v_mfma_f32_16x16x32_bf16 v[84:87], a[32:35], a[160:163], 0
 ds_read_b64_tr_b16 a[12:13], v6 offset:12288
 v_mfma_f32_16x16x32_bf16 v[84:87], a[36:39], a[164:167], v[84:87]
 ds_read_b64_tr_b16 a[14:15], v6 offset:14336
 v_mfma_f32_16x16x32_bf16 v[84:87], a[40:43], a[168:171], v[84:87]
 ds_read_b64_tr_b16 a[16:17], v6 offset:16384
 v_mfma_f32_16x16x32_bf16 v[84:87], a[44:47], a[172:175], v[84:87]
 ds_read_b64_tr_b16 a[18:19], v6 offset:18432
 v_mfma_f32_16x16x32_bf16 v[84:87], a[48:51], a[176:179], v[84:87]
 ds_read_b64_tr_b16 a[20:21], v6 offset:20480
 v_mul_f32 v76, v76, v64
 v_mfma_f32_16x16x32_bf16 v[84:87], a[52:55], a[180:183], v[84:87]
 ds_read_b64_tr_b16 a[22:23], v6 offset:22528
 v_mul_f32 v77, v77, v64
 v_mfma_f32_16x16x32_bf16 v[84:87], a[56:59], a[184:187], v[84:87]
 ds_read_b64_tr_b16 a[24:25], v6 offset:24576
 v_mul_f32 v78, v78, v64
 v_mfma_f32_16x16x32_bf16 v[84:87], a[60:63], a[188:191], v[84:87]
 s_waitcnt lgkmcnt(7)
 ds_read_b64_tr_b16 a[26:27], v6 offset:26624
 v_mul_f32 v79, v79, v64
 v_mfma_f32_16x16x32_bf16 v[88:91], a[0:3], a[128:131], 0
 ds_read_b64_tr_b16 a[28:29], v6 offset:28672
 v_cvt_pk_bf16_f32 v72, v72, v73
 v_mfma_f32_16x16x32_bf16 v[88:91], a[4:7], a[132:135], v[88:91]
 ds_read_b64_tr_b16 a[30:31], v6 offset:30720
 v_xor_b32 v7, 0x20000, v7
 v_mfma_f32_16x16x32_bf16 v[88:91], a[8:11], a[136:139], v[88:91]
 s_waitcnt lgkmcnt(4)
 ds_read_b64_tr_b16 a[32:33], v7 offset:0
 v_cvt_pk_bf16_f32 v73, v74, v75
 v_mfma_f32_16x16x32_bf16 v[88:91], a[12:15], a[140:143], v[88:91]
 ds_read_b64_tr_b16 a[34:35], v7 offset:2048
 v_cvt_pk_bf16_f32 v74, v76, v77
 v_mfma_f32_16x16x32_bf16 v[88:91], a[16:19], a[144:147], v[88:91]
 s_add_u32 s58, s48, 196608
 ds_read_b64_tr_b16 a[36:37], v7 offset:4096
 v_cvt_pk_bf16_f32 v75, v78, v79
 v_mfma_f32_16x16x32_bf16 v[88:91], a[20:23], a[148:151], v[88:91]
 s_waitcnt lgkmcnt(3)
 ds_read_b64_tr_b16 a[38:39], v7 offset:6144
 buffer_store_dwordx4 v[72:75], v1, s[12:15], s58 offen sc1
 v_mfma_f32_16x16x32_bf16 v[88:91], a[24:27], a[152:155], v[88:91]
 ds_read_b64_tr_b16 a[40:41], v7 offset:8192
 v_mul_f32 v84, v84, v65
 v_mfma_f32_16x16x32_bf16 v[88:91], a[28:31], a[156:159], v[88:91]
 ds_read_b64_tr_b16 a[42:43], v7 offset:10240
 v_mul_f32 v85, v85, v65
 v_mfma_f32_16x16x32_bf16 v[96:99], a[0:3], a[160:163], 0
 ds_read_b64_tr_b16 a[44:45], v7 offset:12288
 v_mul_f32 v86, v86, v65
 v_mfma_f32_16x16x32_bf16 v[96:99], a[4:7], a[164:167], v[96:99]
 ds_read_b64_tr_b16 a[46:47], v7 offset:14336
 v_mul_f32 v87, v87, v65
 v_mfma_f32_16x16x32_bf16 v[96:99], a[8:11], a[168:171], v[96:99]
 ds_read_b64_tr_b16 a[48:49], v7 offset:16384
 v_cvt_pk_bf16_f32 v80, v80, v81
 v_mfma_f32_16x16x32_bf16 v[96:99], a[12:15], a[172:175], v[96:99]
 ds_read_b64_tr_b16 a[50:51], v7 offset:18432
 v_cvt_pk_bf16_f32 v81, v82, v83
 v_mfma_f32_16x16x32_bf16 v[96:99], a[16:19], a[176:179], v[96:99]
 ds_read_b64_tr_b16 a[52:53], v7 offset:20480
 v_cvt_pk_bf16_f32 v82, v84, v85
 v_mfma_f32_16x16x32_bf16 v[96:99], a[20:23], a[180:183], v[96:99]
 s_add_u32 s58, s48, 1114112
 ds_read_b64_tr_b16 a[54:55], v7 offset:22528
 v_cvt_pk_bf16_f32 v83, v86, v87
 v_mfma_f32_16x16x32_bf16 v[96:99], a[24:27], a[184:187], v[96:99]
 ds_read_b64_tr_b16 a[56:57], v7 offset:24576
 buffer_store_dwordx4 v[80:83], v1, s[12:15], s58 offen sc1
 v_mfma_f32_16x16x32_bf16 v[96:99], a[28:31], a[188:191], v[96:99]
 s_waitcnt lgkmcnt(7)
 ds_read_b64_tr_b16 a[58:59], v7 offset:26624
 v_mul_f32 v88, v88, v64
 v_mfma_f32_16x16x32_bf16 v[92:95], a[32:35], a[128:131], 0
 ds_read_b64_tr_b16 a[60:61], v7 offset:28672
 v_mul_f32 v89, v89, v64
 v_mfma_f32_16x16x32_bf16 v[92:95], a[36:39], a[132:135], v[92:95]
 ds_read_b64_tr_b16 a[62:63], v7 offset:30720
 v_mul_f32 v90, v90, v64
 v_mfma_f32_16x16x32_bf16 v[92:95], a[40:43], a[136:139], v[92:95]
 s_waitcnt lgkmcnt(4)
 v_mul_f32 v91, v91, v64
 v_mfma_f32_16x16x32_bf16 v[92:95], a[44:47], a[140:143], v[92:95]
 ds_write_b32 v11, v13 offset:0
 v_mfma_f32_16x16x32_bf16 v[92:95], a[48:51], a[144:147], v[92:95]
 ds_write_b32 v11, v13 offset:1152
 v_mul_f32 v96, v96, v65
 v_mul_f32 v97, v97, v65
 v_mfma_f32_16x16x32_bf16 v[92:95], a[52:55], a[148:151], v[92:95]
 s_waitcnt lgkmcnt(0)
 ds_write_b32 v11, v13 offset:2304
 v_mul_f32 v98, v98, v65
 v_mul_f32 v99, v99, v65
 v_mfma_f32_16x16x32_bf16 v[92:95], a[56:59], a[152:155], v[92:95]
 ds_write_b32 v11, v13 offset:3456
 v_mfma_f32_16x16x32_bf16 v[92:95], a[60:63], a[156:159], v[92:95]
 ds_write_b32 v12, v13 offset:4608
 v_mfma_f32_16x16x32_bf16 v[100:103], a[32:35], a[160:163], 0
 v_mfma_f32_16x16x32_bf16 v[100:103], a[36:39], a[164:167], v[100:103]
 v_mfma_f32_16x16x32_bf16 v[100:103], a[40:43], a[168:171], v[100:103]
 v_mfma_f32_16x16x32_bf16 v[100:103], a[44:47], a[172:175], v[100:103]
 v_mfma_f32_16x16x32_bf16 v[100:103], a[48:51], a[176:179], v[100:103]
 v_mfma_f32_16x16x32_bf16 v[100:103], a[52:55], a[180:183], v[100:103]
 v_mfma_f32_16x16x32_bf16 v[100:103], a[56:59], a[184:187], v[100:103]
 v_mfma_f32_16x16x32_bf16 v[100:103], a[60:63], a[188:191], v[100:103]
 s_nop 4
 v_mul_f32 v92, v92, v64
 v_mul_f32 v93, v93, v64
 v_mul_f32 v94, v94, v64
 v_mul_f32 v95, v95, v64
 v_cvt_pk_bf16_f32 v88, v88, v89
 v_cvt_pk_bf16_f32 v89, v90, v91
 v_cvt_pk_bf16_f32 v90, v92, v93
 v_cvt_pk_bf16_f32 v91, v94, v95
 s_add_u32 s58, s48, 212992
 buffer_store_dwordx4 v[88:91], v1, s[12:15], s58 offen sc1
 v_mul_f32 v100, v100, v65
 v_mul_f32 v101, v101, v65
 v_mul_f32 v102, v102, v65
 v_mul_f32 v103, v103, v65
 v_cvt_pk_bf16_f32 v96, v96, v97
 v_cvt_pk_bf16_f32 v97, v98, v99
 v_cvt_pk_bf16_f32 v98, v100, v101
 v_cvt_pk_bf16_f32 v99, v102, v103
 s_add_u32 s58, s48, 1130496
 buffer_store_dwordx4 v[96:99], v1, s[12:15], s58 offen sc1
 s_cmp_ge_u32 s28, 14
 s_cbranch_scc1 L_idle
 v_and_b32 v22, 15, v0
 v_lshrrev_b32 v23, 4, v0
 v_lshl_add_u32 v18, v22, 3, s33
 v_lshl_add_u32 v16, v23, 4, v18
 v_lshl_add_u32 v18, v23, 1, v18
 v_and_b32 v17, 3, v0
 v_bfe_u32 v24, v0, 2, 2
 v_sub_u32 v17, v17, v24
 v_lshlrev_b32 v24, 3, v23
 v_sub_u32 v17, v17, v24
 v_add_u32 v17, 32, v17
 v_lshl_add_u32 v17, v17, 3, s33
 v_lshlrev_b32 v20, 5, v22
 v_lshl_add_u32 v20, v23, 3, v20
 v_add_u32 v24, -1, v0
 v_and_b32 v24, 15, v24
 v_add_u32 v24, 48, v24
 v_add_u32 v19, -16, v0
 v_cmp_gt_u32 vcc, 16, v0
 v_accvgpr_read_b32 v21, a245
 s_add_u32 s34, s34, 90177536
 v_cndmask_b32 v19, v19, v24, vcc
 v_lshlrev_b32 v19, 2, v19
 v_cmp_eq_u32 vcc, 63, v0
 s_lshl_b32 s30, s31, 16
 s_and_b32 s31, s31, 0xffff0000
 s_bitcmp1_b32 s3, 0
 s_cselect_b32 s31, s31, s30
 v_mov_b64 v[224:225], 0
 v_mov_b64 v[226:227], 0
 v_mov_b64 v[228:229], 0
 v_mov_b64 v[230:231], 0
 v_mov_b64 v[232:233], 0
 v_mov_b64 v[234:235], 0
 v_mov_b64 v[236:237], 0
 v_mov_b64 v[238:239], 0
 v_mov_b64 v[240:241], 0
 v_mov_b64 v[242:243], 0
 v_mov_b64 v[244:245], 0
 v_mov_b64 v[246:247], 0
 v_mov_b64 v[248:249], 0
 v_mov_b64 v[250:251], 0
 v_mov_b64 v[252:253], 0
 v_mov_b64 v[254:255], 0
 s_waitcnt vmcnt(8) lgkmcnt(0)
 ds_read_b64_tr_b16 v[160:161], v17 offset:4608
 ds_read_b64_tr_b16 v[162:163], v17 offset:4576
 ds_read_b64_tr_b16 v[164:165], v17 offset:4864
 ds_read_b64_tr_b16 v[166:167], v17 offset:4832
 ds_read_b64 a[4:5], v16 offset:72
 ds_read_b64 a[6:7], v16 offset:80
 ds_read_b64 a[0:1], v16 offset:8
 ds_read_b64 a[2:3], v16 offset:16
 s_waitcnt lgkmcnt(6)
 ds_read_b64 a[68:69], v16 offset:1224
 ds_read_b64 a[70:71], v16 offset:1232
 ds_read_b64 a[64:65], v16 offset:1160
 ds_read_b64 a[66:67], v16 offset:1168
 ds_read_b64 a[132:133], v16 offset:2376
 ds_read_b64 a[134:135], v16 offset:2384
 ds_read_b64 a[128:129], v16 offset:2312
 ds_read_b64 a[130:131], v16 offset:2320
 s_waitcnt lgkmcnt(6)
 ds_read_b64 a[196:197], v16 offset:3528
 ds_read_b64 a[198:199], v16 offset:3536
 ds_read_b64 a[192:193], v16 offset:3464
 ds_read_b64 a[194:195], v16 offset:3472
 ds_read_b64_tr_b16 v[168:169], v17 offset:5120
 ds_read_b64_tr_b16 v[170:171], v17 offset:5088
 ds_read_b64_tr_b16 v[172:173], v17 offset:5376
 ds_read_b64_tr_b16 v[174:175], v17 offset:5344
 s_waitcnt lgkmcnt(6)
 ds_read_b64 a[12:13], v16 offset:200
 ds_read_b64 a[14:15], v16 offset:208
 ds_read_b64 a[8:9], v16 offset:136
 ds_read_b64 a[10:11], v16 offset:144
 ds_read_b64 a[76:77], v16 offset:1352
 ds_read_b64 a[78:79], v16 offset:1360
 ds_read_b64 a[72:73], v16 offset:1288
 ds_read_b64 a[74:75], v16 offset:1296
 s_waitcnt lgkmcnt(6)
 ds_read_b64 a[140:141], v16 offset:2504
 ds_read_b64 a[142:143], v16 offset:2512
 ds_read_b64 a[136:137], v16 offset:2440
 ds_read_b64 a[138:139], v16 offset:2448
 ds_read_b64 a[204:205], v16 offset:3656
 ds_read_b64 a[206:207], v16 offset:3664
 ds_read_b64 a[200:201], v16 offset:3592
 ds_read_b64 a[202:203], v16 offset:3600
 s_waitcnt lgkmcnt(6)
 ds_read_b64_tr_b16 v[176:177], v17 offset:5632
 ds_read_b64_tr_b16 v[178:179], v17 offset:5600
 ds_read_b64_tr_b16 v[180:181], v17 offset:5888
 ds_read_b64_tr_b16 v[182:183], v17 offset:5856
 s_waitcnt lgkmcnt(0)
 v_lshlrev_b32 v25, 2, v22
 s_add_u32 s45, s44, 1088
 v_mfma_f32_16x16x32_bf16 v[32:35], v[160:163], a[4:7], 0
 ds_read_b64 a[20:21], v16 offset:328
 v_mfma_f32_16x16x32_bf16 v[32:35], v[164:167], a[0:3], v[32:35]
 ds_read_b64 a[22:23], v16 offset:336
 v_mfma_f32_16x16x32_bf16 v[36:39], v[160:163], a[68:71], 0
 ds_read_b64 a[16:17], v16 offset:264
 v_mfma_f32_16x16x32_bf16 v[36:39], v[164:167], a[64:67], v[36:39]
 ds_read_b64 a[18:19], v16 offset:272
 v_mfma_f32_16x16x32_bf16 v[40:43], v[160:163], a[132:135], 0
 ds_read_b64 a[84:85], v16 offset:1480
 v_mfma_f32_16x16x32_bf16 v[40:43], v[164:167], a[128:131], v[40:43]
 s_waitcnt vmcnt(0)
 ds_read_b64 a[86:87], v16 offset:1488
 v_mfma_f32_16x16x32_bf16 v[44:47], v[160:163], a[196:199], 0
 s_barrier
 ds_read_b64 a[80:81], v16 offset:1416
 v_mfma_f32_16x16x32_bf16 v[44:47], v[164:167], a[192:195], v[44:47]
 ds_read_b64 a[82:83], v16 offset:1424
 buffer_store_dword v21, v21, s[12:15], s93 offen sc1
 v_mfma_f32_16x16x32_bf16 v[48:51], v[160:163], a[12:15], 0
 ds_read_b64 a[148:149], v16 offset:2632
 v_mfma_f32_16x16x32_bf16 v[48:51], v[164:167], a[8:11], v[48:51]
 ds_read_b64 a[150:151], v16 offset:2640
 v_mfma_f32_16x16x32_bf16 v[48:51], v[168:171], a[4:7], v[48:51]
 ds_read_b64 a[144:145], v16 offset:2568
 v_mfma_f32_16x16x32_bf16 v[48:51], v[172:175], a[0:3], v[48:51]
 ds_read_b64 a[146:147], v16 offset:2576
 v_mfma_f32_16x16x32_bf16 v[52:55], v[160:163], a[76:79], 0
 ds_read_b64 a[212:213], v16 offset:3784
 v_mfma_f32_16x16x32_bf16 v[52:55], v[164:167], a[72:75], v[52:55]
 ds_read_b64 a[214:215], v16 offset:3792
 v_mfma_f32_16x16x32_bf16 v[52:55], v[168:171], a[68:71], v[52:55]
 ds_read_b64 a[208:209], v16 offset:3720
 v_mfma_f32_16x16x32_bf16 v[52:55], v[172:175], a[64:67], v[52:55]
 ds_read_b64 a[210:211], v16 offset:3728
 v_mfma_f32_16x16x32_bf16 v[56:59], v[160:163], a[140:143], 0
 ds_read_b64_tr_b16 v[184:185], v17 offset:6144
 v_mfma_f32_16x16x32_bf16 v[56:59], v[164:167], a[136:139], v[56:59]
 ds_read_b64_tr_b16 v[186:187], v17 offset:6112
 v_mfma_f32_16x16x32_bf16 v[56:59], v[168:171], a[132:135], v[56:59]
 ds_read_b64_tr_b16 v[188:189], v17 offset:6400
 v_mfma_f32_16x16x32_bf16 v[56:59], v[172:175], a[128:131], v[56:59]
 ds_read_b64_tr_b16 v[190:191], v17 offset:6368
 v_mfma_f32_16x16x32_bf16 v[60:63], v[160:163], a[204:207], 0
 ds_read_b64 a[28:29], v16 offset:456
 v_mfma_f32_16x16x32_bf16 v[60:63], v[164:167], a[200:203], v[60:63]
 ds_read_b64 a[30:31], v16 offset:464
 v_mfma_f32_16x16x32_bf16 v[60:63], v[168:171], a[196:199], v[60:63]
 ds_read_b64 a[24:25], v16 offset:392
 v_mfma_f32_16x16x32_bf16 v[60:63], v[172:175], a[192:195], v[60:63]
 s_waitcnt lgkmcnt(15)
 ds_read_b64 a[26:27], v16 offset:400
 v_mfma_f32_16x16x32_bf16 v[64:67], v[160:163], a[20:23], 0
 ds_read_b64 a[92:93], v16 offset:1608
 v_mfma_f32_16x16x32_bf16 v[64:67], v[164:167], a[16:19], v[64:67]
 ds_read_b64 a[94:95], v16 offset:1616
 v_mfma_f32_16x16x32_bf16 v[64:67], v[168:171], a[12:15], v[64:67]
 ds_read_b64 a[88:89], v16 offset:1544
 v_mfma_f32_16x16x32_bf16 v[64:67], v[172:175], a[8:11], v[64:67]
 ds_read_b64 a[90:91], v16 offset:1552
 v_mfma_f32_16x16x32_bf16 v[64:67], v[176:179], a[4:7], v[64:67]
 ds_read_b64 a[156:157], v16 offset:2760
 v_mfma_f32_16x16x32_bf16 v[64:67], v[180:183], a[0:3], v[64:67]
 ds_read_b64 a[158:159], v16 offset:2768
 v_mfma_f32_16x16x32_bf16 v[68:71], v[160:163], a[84:87], 0
 ds_read_b64 a[152:153], v16 offset:2696
 v_mfma_f32_16x16x32_bf16 v[68:71], v[164:167], a[80:83], v[68:71]
 ds_read_b64 a[154:155], v16 offset:2704
 v_mfma_f32_16x16x32_bf16 v[68:71], v[168:171], a[76:79], v[68:71]
 ds_read_b64 a[220:221], v16 offset:3912
 v_mfma_f32_16x16x32_bf16 v[68:71], v[172:175], a[72:75], v[68:71]
 ds_read_b64 a[222:223], v16 offset:3920
 v_mfma_f32_16x16x32_bf16 v[68:71], v[176:179], a[68:71], v[68:71]
 ds_read_b64 a[216:217], v16 offset:3848
 v_mfma_f32_16x16x32_bf16 v[68:71], v[180:183], a[64:67], v[68:71]
 s_waitcnt lgkmcnt(15)
 ds_read_b64 a[218:219], v16 offset:3856
 v_mfma_f32_16x16x32_bf16 v[72:75], v[160:163], a[148:151], 0
 ds_read_b64_tr_b16 v[192:193], v17 offset:6656
 v_mfma_f32_16x16x32_bf16 v[72:75], v[164:167], a[144:147], v[72:75]
 ds_read_b64_tr_b16 v[194:195], v17 offset:6624
 v_mfma_f32_16x16x32_bf16 v[72:75], v[168:171], a[140:143], v[72:75]
 ds_read_b64_tr_b16 v[196:197], v17 offset:6912
 v_mfma_f32_16x16x32_bf16 v[72:75], v[172:175], a[136:139], v[72:75]
 ds_read_b64_tr_b16 v[198:199], v17 offset:6880
 v_mfma_f32_16x16x32_bf16 v[72:75], v[176:179], a[132:135], v[72:75]
 ds_read_b64 a[36:37], v16 offset:584
 v_mfma_f32_16x16x32_bf16 v[72:75], v[180:183], a[128:131], v[72:75]
 ds_read_b64 a[38:39], v16 offset:592
 v_mfma_f32_16x16x32_bf16 v[76:79], v[160:163], a[212:215], 0
 ds_read_b64 a[32:33], v16 offset:520
 v_mfma_f32_16x16x32_bf16 v[76:79], v[164:167], a[208:211], v[76:79]
 ds_read_b64 a[34:35], v16 offset:528
 v_mfma_f32_16x16x32_bf16 v[76:79], v[168:171], a[204:207], v[76:79]
 ds_read_b64 a[100:101], v16 offset:1736
 v_mfma_f32_16x16x32_bf16 v[76:79], v[172:175], a[200:203], v[76:79]
 ds_read_b64 a[102:103], v16 offset:1744
 v_mfma_f32_16x16x32_bf16 v[76:79], v[176:179], a[196:199], v[76:79]
 ds_read_b64 a[96:97], v16 offset:1672
 v_mfma_f32_16x16x32_bf16 v[76:79], v[180:183], a[192:195], v[76:79]
 s_waitcnt lgkmcnt(15)
 ds_read_b64 a[98:99], v16 offset:1680
 v_mfma_f32_16x16x32_bf16 v[80:83], v[160:163], a[28:31], 0
 ds_read_b64 a[164:165], v16 offset:2888
 v_mfma_f32_16x16x32_bf16 v[80:83], v[164:167], a[24:27], v[80:83]
 ds_read_b64 a[166:167], v16 offset:2896
 v_mfma_f32_16x16x32_bf16 v[80:83], v[168:171], a[20:23], v[80:83]
 ds_read_b64 a[160:161], v16 offset:2824
 v_mfma_f32_16x16x32_bf16 v[80:83], v[172:175], a[16:19], v[80:83]
 ds_read_b64 a[162:163], v16 offset:2832
 v_mfma_f32_16x16x32_bf16 v[80:83], v[176:179], a[12:15], v[80:83]
 ds_read_b64 a[228:229], v16 offset:4040
 v_mfma_f32_16x16x32_bf16 v[80:83], v[180:183], a[8:11], v[80:83]
 ds_read_b64 a[230:231], v16 offset:4048
 v_mfma_f32_16x16x32_bf16 v[80:83], v[184:187], a[4:7], v[80:83]
 ds_read_b64 a[224:225], v16 offset:3976
 v_mfma_f32_16x16x32_bf16 v[80:83], v[188:191], a[0:3], v[80:83]
 ds_read_b64 a[226:227], v16 offset:3984
 v_mfma_f32_16x16x32_bf16 v[84:87], v[160:163], a[92:95], 0
 ds_read_b64_tr_b16 v[200:201], v17 offset:7168
 v_mfma_f32_16x16x32_bf16 v[84:87], v[164:167], a[88:91], v[84:87]
 ds_read_b64_tr_b16 v[202:203], v17 offset:7136
 v_mfma_f32_16x16x32_bf16 v[84:87], v[168:171], a[84:87], v[84:87]
 ds_read_b64_tr_b16 v[204:205], v17 offset:7424
 v_mfma_f32_16x16x32_bf16 v[84:87], v[172:175], a[80:83], v[84:87]
 ds_read_b64_tr_b16 v[206:207], v17 offset:7392
 v_mfma_f32_16x16x32_bf16 v[84:87], v[176:179], a[76:79], v[84:87]
 ds_read_b64 a[44:45], v16 offset:712
 v_mfma_f32_16x16x32_bf16 v[84:87], v[180:183], a[72:75], v[84:87]
 ds_read_b64 a[46:47], v16 offset:720
 v_mfma_f32_16x16x32_bf16 v[84:87], v[184:187], a[68:71], v[84:87]
 ds_read_b64 a[40:41], v16 offset:648
 v_mfma_f32_16x16x32_bf16 v[84:87], v[188:191], a[64:67], v[84:87]
 ds_read_b64 a[42:43], v16 offset:656
 v_mfma_f32_16x16x32_bf16 v[88:91], v[160:163], a[156:159], 0
 ds_read_b64 a[108:109], v16 offset:1864
 v_mfma_f32_16x16x32_bf16 v[88:91], v[164:167], a[152:155], v[88:91]
 ds_read_b64 a[110:111], v16 offset:1872
 v_mfma_f32_16x16x32_bf16 v[88:91], v[168:171], a[148:151], v[88:91]
 ds_read_b64 a[104:105], v16 offset:1800
 v_mfma_f32_16x16x32_bf16 v[88:91], v[172:175], a[144:147], v[88:91]
 ds_read_b64 a[106:107], v16 offset:1808
 v_mfma_f32_16x16x32_bf16 v[88:91], v[176:179], a[140:143], v[88:91]
 ds_read_b64 a[172:173], v16 offset:3016
 v_mfma_f32_16x16x32_bf16 v[88:91], v[180:183], a[136:139], v[88:91]
 ds_read_b64 a[174:175], v16 offset:3024
 v_mfma_f32_16x16x32_bf16 v[88:91], v[184:187], a[132:135], v[88:91]
 ds_read_b64 a[168:169], v16 offset:2952
 v_mfma_f32_16x16x32_bf16 v[88:91], v[188:191], a[128:131], v[88:91]
 s_waitcnt lgkmcnt(15)
 ds_read_b64 a[170:171], v16 offset:2960
 v_mfma_f32_16x16x32_bf16 v[92:95], v[160:163], a[220:223], 0
 ds_read_b64 a[236:237], v16 offset:4168
 v_mfma_f32_16x16x32_bf16 v[92:95], v[164:167], a[216:219], v[92:95]
 ds_read_b64 a[238:239], v16 offset:4176
 v_mfma_f32_16x16x32_bf16 v[92:95], v[168:171], a[212:215], v[92:95]
 ds_read_b64 a[232:233], v16 offset:4104
 v_mfma_f32_16x16x32_bf16 v[92:95], v[172:175], a[208:211], v[92:95]
 ds_read_b64 a[234:235], v16 offset:4112
 v_mfma_f32_16x16x32_bf16 v[92:95], v[176:179], a[204:207], v[92:95]
 ds_read_b64_tr_b16 v[208:209], v17 offset:7680
 v_mfma_f32_16x16x32_bf16 v[92:95], v[180:183], a[200:203], v[92:95]
 ds_read_b64_tr_b16 v[210:211], v17 offset:7648
 v_mfma_f32_16x16x32_bf16 v[92:95], v[184:187], a[196:199], v[92:95]
 ds_read_b64_tr_b16 v[212:213], v17 offset:7936
 v_mfma_f32_16x16x32_bf16 v[92:95], v[188:191], a[192:195], v[92:95]
 ds_read_b64_tr_b16 v[214:215], v17 offset:7904
 v_mfma_f32_16x16x32_bf16 v[96:99], v[160:163], a[36:39], 0
 ds_read_b64 a[52:53], v16 offset:840
 v_mfma_f32_16x16x32_bf16 v[96:99], v[164:167], a[32:35], v[96:99]
 ds_read_b64 a[54:55], v16 offset:848
 v_mfma_f32_16x16x32_bf16 v[96:99], v[168:171], a[28:31], v[96:99]
 ds_read_b64 a[48:49], v16 offset:776
 v_mfma_f32_16x16x32_bf16 v[96:99], v[172:175], a[24:27], v[96:99]
 ds_read_b64 a[50:51], v16 offset:784
 v_mfma_f32_16x16x32_bf16 v[96:99], v[176:179], a[20:23], v[96:99]
 ds_read_b64 a[116:117], v16 offset:1992
 v_mfma_f32_16x16x32_bf16 v[96:99], v[180:183], a[16:19], v[96:99]
 ds_read_b64 a[118:119], v16 offset:2000
 v_mfma_f32_16x16x32_bf16 v[96:99], v[184:187], a[12:15], v[96:99]
 ds_read_b64 a[112:113], v16 offset:1928
 v_add_f32 v39, v39, v42
 v_mfma_f32_16x16x32_bf16 v[96:99], v[188:191], a[8:11], v[96:99]
 ds_read_b64 a[114:115], v16 offset:1936
 v_add_f32 v43, v43, v46
 v_mfma_f32_16x16x32_bf16 v[96:99], v[192:195], a[4:7], v[96:99]
 ds_read_b64 a[180:181], v16 offset:3144
 v_add_f32 v39, v39, v45
 v_mfma_f32_16x16x32_bf16 v[96:99], v[196:199], a[0:3], v[96:99]
 ds_read_b64 a[182:183], v16 offset:3152
 v_cndmask_b32_e64 v224, v39, 0, vcc
 v_mfma_f32_16x16x32_bf16 v[100:103], v[160:163], a[100:103], 0
 ds_read_b64 a[176:177], v16 offset:3080
 v_cndmask_b32_e64 v225, v43, 0, vcc
 v_mfma_f32_16x16x32_bf16 v[100:103], v[164:167], a[96:99], v[100:103]
 ds_read_b64 a[178:179], v16 offset:3088
 v_cndmask_b32_e64 v226, v47, 0, vcc
 v_mfma_f32_16x16x32_bf16 v[100:103], v[168:171], a[92:95], v[100:103]
 ds_read_b64 a[244:245], v16 offset:4296
 v_add_f32 v33, v33, v36
 v_mfma_f32_16x16x32_bf16 v[100:103], v[172:175], a[88:91], v[100:103]
 ds_read_b64 a[246:247], v16 offset:4304
 v_add_f32 v34, v34, v37
 v_mfma_f32_16x16x32_bf16 v[100:103], v[176:179], a[84:87], v[100:103]
 ds_read_b64 a[240:241], v16 offset:4232
 v_add_f32 v35, v35, v38
 v_mfma_f32_16x16x32_bf16 v[100:103], v[180:183], a[80:83], v[100:103]
 ds_read_b64 a[242:243], v16 offset:4240
 v_add_f32 v34, v34, v40
 v_mfma_f32_16x16x32_bf16 v[100:103], v[184:187], a[76:79], v[100:103]
 ds_read_b64_tr_b16 v[216:217], v17 offset:8192
 v_add_f32 v35, v35, v41
 v_mfma_f32_16x16x32_bf16 v[100:103], v[188:191], a[72:75], v[100:103]
 ds_read_b64_tr_b16 v[218:219], v17 offset:8160
 v_add_f32 v35, v35, v44
 v_mfma_f32_16x16x32_bf16 v[100:103], v[192:195], a[68:71], v[100:103]
 ds_read_b64_tr_b16 v[220:221], v17 offset:8448
 v_add_f32 v55, v55, v58
 v_mfma_f32_16x16x32_bf16 v[100:103], v[196:199], a[64:67], v[100:103]
 ds_read_b64_tr_b16 v[222:223], v17 offset:8416
 v_add_f32 v59, v59, v62
 v_mfma_f32_16x16x32_bf16 v[104:107], v[160:163], a[164:167], 0
 ds_read_b64 a[60:61], v16 offset:968
 v_add_f32 v55, v55, v61
 v_mfma_f32_16x16x32_bf16 v[104:107], v[164:167], a[160:163], v[104:107]
 ds_read_b64 a[62:63], v16 offset:976
 v_cndmask_b32_e64 v232, v55, v39, vcc
 v_mfma_f32_16x16x32_bf16 v[104:107], v[168:171], a[156:159], v[104:107]
 ds_read_b64 a[56:57], v16 offset:904
 v_cndmask_b32_e64 v233, v59, v43, vcc
 v_mfma_f32_16x16x32_bf16 v[104:107], v[172:175], a[152:155], v[104:107]
 ds_read_b64 a[58:59], v16 offset:912
 v_cndmask_b32_e64 v234, v63, v47, vcc
 v_mfma_f32_16x16x32_bf16 v[104:107], v[176:179], a[148:151], v[104:107]
 ds_read_b64 a[124:125], v16 offset:2120
 v_add_f32 v49, v49, v52
 v_mfma_f32_16x16x32_bf16 v[104:107], v[180:183], a[144:147], v[104:107]
 ds_read_b64 a[126:127], v16 offset:2128
 v_add_f32 v50, v50, v53
 v_mfma_f32_16x16x32_bf16 v[104:107], v[184:187], a[140:143], v[104:107]
 ds_read_b64 a[120:121], v16 offset:2056
 v_add_f32 v51, v51, v54
 v_mfma_f32_16x16x32_bf16 v[104:107], v[188:191], a[136:139], v[104:107]
 ds_read_b64 a[122:123], v16 offset:2064
 v_add_f32 v50, v50, v56
 v_mfma_f32_16x16x32_bf16 v[104:107], v[192:195], a[132:135], v[104:107]
 ds_read_b64 a[188:189], v16 offset:3272
 v_add_f32 v51, v51, v57
 v_mfma_f32_16x16x32_bf16 v[104:107], v[196:199], a[128:131], v[104:107]
 ds_read_b64 a[190:191], v16 offset:3280
 v_add_f32 v51, v51, v60
 v_mfma_f32_16x16x32_bf16 v[108:111], v[160:163], a[228:231], 0
 ds_read_b64 a[184:185], v16 offset:3208
 v_add_f32 v71, v71, v74
 v_mfma_f32_16x16x32_bf16 v[108:111], v[164:167], a[224:227], v[108:111]
 ds_read_b64 a[186:187], v16 offset:3216
 v_add_f32 v75, v75, v78
 v_mfma_f32_16x16x32_bf16 v[108:111], v[168:171], a[220:223], v[108:111]
 ds_read_b64 v[28:29], v16 offset:4424
 v_add_f32 v71, v71, v77
 v_mfma_f32_16x16x32_bf16 v[108:111], v[172:175], a[216:219], v[108:111]
 ds_read_b64 v[30:31], v16 offset:4432
 v_cndmask_b32_e64 v240, v71, v55, vcc
 v_mfma_f32_16x16x32_bf16 v[108:111], v[176:179], a[212:215], v[108:111]
 ds_read_b64 a[248:249], v16 offset:4360
 v_cndmask_b32_e64 v241, v75, v59, vcc
 v_mfma_f32_16x16x32_bf16 v[108:111], v[180:183], a[208:211], v[108:111]
 ds_read_b64 a[250:251], v16 offset:4368
 v_cndmask_b32_e64 v242, v79, v63, vcc
 v_mfma_f32_16x16x32_bf16 v[108:111], v[184:187], a[204:207], v[108:111]
 ds_bpermute_b32 v224, v19, v224
 v_add_f32 v65, v65, v68
 v_mfma_f32_16x16x32_bf16 v[108:111], v[188:191], a[200:203], v[108:111]
 ds_bpermute_b32 v225, v19, v225
 v_add_f32 v66, v66, v69
 v_mfma_f32_16x16x32_bf16 v[108:111], v[192:195], a[196:199], v[108:111]
 ds_bpermute_b32 v226, v19, v226
 v_add_f32 v67, v67, v70
 v_mfma_f32_16x16x32_bf16 v[108:111], v[196:199], a[192:195], v[108:111]
 s_waitcnt lgkmcnt(15)
 ds_read_u16_d16_hi v228, v18 offset:128
 v_add_f32 v66, v66, v72
 v_mfma_f32_16x16x32_bf16 v[112:115], v[160:163], a[44:47], 0
 ds_read_u16_d16_hi v229, v18 offset:1280
 v_add_f32 v67, v67, v73
 v_mfma_f32_16x16x32_bf16 v[112:115], v[164:167], a[40:43], v[112:115]
 ds_read_u16_d16_hi v230, v18 offset:2432
 v_add_f32 v67, v67, v76
 v_mfma_f32_16x16x32_bf16 v[112:115], v[168:171], a[36:39], v[112:115]
 ds_read_u16_d16_hi v231, v18 offset:3584
 v_add_f32 v87, v87, v90
 v_mfma_f32_16x16x32_bf16 v[112:115], v[172:175], a[32:35], v[112:115]
 ds_bpermute_b32 v232, v19, v232
 v_add_f32 v91, v91, v94
 v_mfma_f32_16x16x32_bf16 v[112:115], v[176:179], a[28:31], v[112:115]
 ds_bpermute_b32 v233, v19, v233
 v_add_f32 v87, v87, v93
 v_mfma_f32_16x16x32_bf16 v[112:115], v[180:183], a[24:27], v[112:115]
 ds_bpermute_b32 v234, v19, v234
 v_cndmask_b32_e64 v248, v87, v71, vcc
 v_mfma_f32_16x16x32_bf16 v[112:115], v[184:187], a[20:23], v[112:115]
 ds_read_u16_d16_hi v236, v18 offset:256
 v_cndmask_b32_e64 v249, v91, v75, vcc
 v_mfma_f32_16x16x32_bf16 v[112:115], v[188:191], a[16:19], v[112:115]
 ds_read_u16_d16_hi v237, v18 offset:1408
 v_cndmask_b32_e64 v250, v95, v79, vcc
 v_mfma_f32_16x16x32_bf16 v[112:115], v[192:195], a[12:15], v[112:115]
 s_waitcnt lgkmcnt(10)
 v_add_f32 v32, v32, v224
 v_add_f32 v33, v33, v225
 v_mfma_f32_16x16x32_bf16 v[112:115], v[196:199], a[8:11], v[112:115]
 s_waitcnt lgkmcnt(8)
 v_add_f32 v34, v34, v226
 v_fmac_f32 v32, s31, v228
 v_mfma_f32_16x16x32_bf16 v[112:115], v[200:203], a[4:7], v[112:115]
 s_waitcnt lgkmcnt(6)
 v_fmac_f32 v33, s31, v229
 v_fmac_f32 v34, s31, v230
 v_mfma_f32_16x16x32_bf16 v[112:115], v[204:207], a[0:3], v[112:115]
 s_waitcnt lgkmcnt(5)
 v_fmac_f32 v35, s31, v231
 v_cvt_pk_bf16_f32 v32, v32, v33
 v_mfma_f32_16x16x32_bf16 v[116:119], v[160:163], a[108:111], 0
 ds_read_u16_d16_hi v238, v18 offset:2560
 v_cvt_pk_bf16_f32 v33, v34, v35
 v_mfma_f32_16x16x32_bf16 v[116:119], v[164:167], a[104:107], v[116:119]
 buffer_store_dwordx2 v[32:33], v20, s[12:15], s34 offen offset:0 sc1
 v_mfma_f32_16x16x32_bf16 v[116:119], v[168:171], a[100:103], v[116:119]
 ds_read_u16_d16_hi v239, v18 offset:3712
 v_add_f32 v81, v81, v84
 v_mfma_f32_16x16x32_bf16 v[116:119], v[172:175], a[96:99], v[116:119]
 ds_bpermute_b32 v240, v19, v240
 v_add_f32 v82, v82, v85
 v_mfma_f32_16x16x32_bf16 v[116:119], v[176:179], a[92:95], v[116:119]
 ds_bpermute_b32 v241, v19, v241
 v_add_f32 v83, v83, v86
 v_mfma_f32_16x16x32_bf16 v[116:119], v[180:183], a[88:91], v[116:119]
 ds_bpermute_b32 v242, v19, v242
 v_add_f32 v82, v82, v88
 v_mfma_f32_16x16x32_bf16 v[116:119], v[184:187], a[84:87], v[116:119]
 ds_read_u16_d16_hi v244, v18 offset:384
 v_add_f32 v83, v83, v89
 v_mfma_f32_16x16x32_bf16 v[116:119], v[188:191], a[80:83], v[116:119]
 ds_read_u16_d16_hi v245, v18 offset:1536
 v_add_f32 v83, v83, v92
 v_mfma_f32_16x16x32_bf16 v[116:119], v[192:195], a[76:79], v[116:119]
 s_waitcnt lgkmcnt(10)
 v_add_f32 v48, v48, v232
 v_add_f32 v49, v49, v233
 v_mfma_f32_16x16x32_bf16 v[116:119], v[196:199], a[72:75], v[116:119]
 s_waitcnt lgkmcnt(8)
 v_add_f32 v50, v50, v234
 v_fmac_f32 v48, s31, v236
 v_mfma_f32_16x16x32_bf16 v[116:119], v[200:203], a[68:71], v[116:119]
 s_waitcnt lgkmcnt(6)
 v_fmac_f32 v49, s31, v237
 v_fmac_f32 v50, s31, v238
 v_mfma_f32_16x16x32_bf16 v[116:119], v[204:207], a[64:67], v[116:119]
 s_waitcnt lgkmcnt(5)
 v_fmac_f32 v51, s31, v239
 v_cvt_pk_bf16_f32 v48, v48, v49
 v_mfma_f32_16x16x32_bf16 v[120:123], v[160:163], a[172:175], 0
 ds_read_u16_d16_hi v246, v18 offset:2688
 v_cvt_pk_bf16_f32 v49, v50, v51
 v_mfma_f32_16x16x32_bf16 v[120:123], v[164:167], a[168:171], v[120:123]
 buffer_store_dwordx2 v[48:49], v20, s[12:15], s34 offen offset:512 sc1
 v_mfma_f32_16x16x32_bf16 v[120:123], v[168:171], a[164:167], v[120:123]
 ds_read_u16_d16_hi v247, v18 offset:3840
 v_add_f32 v103, v103, v106
 v_mfma_f32_16x16x32_bf16 v[120:123], v[172:175], a[160:163], v[120:123]
 ds_bpermute_b32 v248, v19, v248
 v_add_f32 v107, v107, v110
 v_mfma_f32_16x16x32_bf16 v[120:123], v[176:179], a[156:159], v[120:123]
 ds_bpermute_b32 v249, v19, v249
 v_add_f32 v103, v103, v109
 v_mfma_f32_16x16x32_bf16 v[120:123], v[180:183], a[152:155], v[120:123]
 ds_bpermute_b32 v250, v19, v250
 v_cndmask_b32_e64 v224, v103, v87, vcc
 v_mfma_f32_16x16x32_bf16 v[120:123], v[184:187], a[148:151], v[120:123]
 ds_read_u16_d16_hi v252, v18 offset:512
 v_cndmask_b32_e64 v225, v107, v91, vcc
 v_mfma_f32_16x16x32_bf16 v[120:123], v[188:191], a[144:147], v[120:123]
 ds_read_u16_d16_hi v253, v18 offset:1664
 v_cndmask_b32_e64 v226, v111, v95, vcc
 v_mfma_f32_16x16x32_bf16 v[120:123], v[192:195], a[140:143], v[120:123]
 s_waitcnt lgkmcnt(10)
 v_add_f32 v64, v64, v240
 v_add_f32 v65, v65, v241
 v_mfma_f32_16x16x32_bf16 v[120:123], v[196:199], a[136:139], v[120:123]
 s_waitcnt lgkmcnt(8)
 v_add_f32 v66, v66, v242
 v_fmac_f32 v64, s31, v244
 v_mfma_f32_16x16x32_bf16 v[120:123], v[200:203], a[132:135], v[120:123]
 s_waitcnt lgkmcnt(6)
 v_fmac_f32 v65, s31, v245
 v_fmac_f32 v66, s31, v246
 v_mfma_f32_16x16x32_bf16 v[120:123], v[204:207], a[128:131], v[120:123]
 s_waitcnt lgkmcnt(5)
 v_fmac_f32 v67, s31, v247
 v_cvt_pk_bf16_f32 v64, v64, v65
 v_mfma_f32_16x16x32_bf16 v[124:127], v[160:163], a[236:239], 0
 ds_read_u16_d16_hi v254, v18 offset:2816
 v_cvt_pk_bf16_f32 v65, v66, v67
 v_mfma_f32_16x16x32_bf16 v[124:127], v[164:167], a[232:235], v[124:127]
 buffer_store_dwordx2 v[64:65], v20, s[12:15], s34 offen offset:1024 sc1
 v_mfma_f32_16x16x32_bf16 v[124:127], v[168:171], a[228:231], v[124:127]
 ds_read_u16_d16_hi v255, v18 offset:3968
 v_add_f32 v97, v97, v100
 v_mfma_f32_16x16x32_bf16 v[124:127], v[172:175], a[224:227], v[124:127]
 ds_bpermute_b32 v224, v19, v224
 v_add_f32 v98, v98, v101
 v_mfma_f32_16x16x32_bf16 v[124:127], v[176:179], a[220:223], v[124:127]
 ds_bpermute_b32 v225, v19, v225
 v_add_f32 v99, v99, v102
 v_mfma_f32_16x16x32_bf16 v[124:127], v[180:183], a[216:219], v[124:127]
 ds_bpermute_b32 v226, v19, v226
 v_add_f32 v98, v98, v104
 v_mfma_f32_16x16x32_bf16 v[124:127], v[184:187], a[212:215], v[124:127]
 ds_read_u16_d16_hi v228, v18 offset:640
 v_add_f32 v99, v99, v105
 v_mfma_f32_16x16x32_bf16 v[124:127], v[188:191], a[208:211], v[124:127]
 ds_read_u16_d16_hi v229, v18 offset:1792
 v_add_f32 v99, v99, v108
 v_mfma_f32_16x16x32_bf16 v[124:127], v[192:195], a[204:207], v[124:127]
 s_waitcnt lgkmcnt(10)
 v_add_f32 v80, v80, v248
 v_add_f32 v81, v81, v249
 v_mfma_f32_16x16x32_bf16 v[124:127], v[196:199], a[200:203], v[124:127]
 s_waitcnt lgkmcnt(8)
 v_add_f32 v82, v82, v250
 v_fmac_f32 v80, s31, v252
 v_mfma_f32_16x16x32_bf16 v[124:127], v[200:203], a[196:199], v[124:127]
 s_waitcnt lgkmcnt(6)
 v_fmac_f32 v81, s31, v253
 v_fmac_f32 v82, s31, v254
 v_mfma_f32_16x16x32_bf16 v[124:127], v[204:207], a[192:195], v[124:127]
 s_waitcnt lgkmcnt(5)
 v_fmac_f32 v83, s31, v255
 v_cvt_pk_bf16_f32 v80, v80, v81
 v_mfma_f32_16x16x32_bf16 v[128:131], v[160:163], a[52:55], 0
 ds_read_u16_d16_hi v230, v18 offset:2944
 v_cvt_pk_bf16_f32 v81, v82, v83
 v_mfma_f32_16x16x32_bf16 v[128:131], v[164:167], a[48:51], v[128:131]
 buffer_store_dwordx2 v[80:81], v20, s[12:15], s34 offen offset:1536 sc1
 v_mfma_f32_16x16x32_bf16 v[128:131], v[168:171], a[44:47], v[128:131]
 ds_read_u16_d16_hi v231, v18 offset:4096
 v_mfma_f32_16x16x32_bf16 v[128:131], v[172:175], a[40:43], v[128:131]
 v_mfma_f32_16x16x32_bf16 v[128:131], v[176:179], a[36:39], v[128:131]
 v_mfma_f32_16x16x32_bf16 v[128:131], v[180:183], a[32:35], v[128:131]
 v_mfma_f32_16x16x32_bf16 v[128:131], v[184:187], a[28:31], v[128:131]
 v_mfma_f32_16x16x32_bf16 v[128:131], v[188:191], a[24:27], v[128:131]
 v_add_f32 v119, v119, v122
 v_add_f32 v123, v123, v126
 v_mfma_f32_16x16x32_bf16 v[128:131], v[192:195], a[20:23], v[128:131]
 s_waitcnt lgkmcnt(5)
 v_add_f32 v96, v96, v224
 v_add_f32 v97, v97, v225
 v_mfma_f32_16x16x32_bf16 v[128:131], v[196:199], a[16:19], v[128:131]
 s_waitcnt lgkmcnt(3)
 v_add_f32 v98, v98, v226
 v_fmac_f32 v96, s31, v228
 v_mfma_f32_16x16x32_bf16 v[128:131], v[200:203], a[12:15], v[128:131]
 s_waitcnt lgkmcnt(1)
 v_fmac_f32 v97, s31, v229
 v_fmac_f32 v98, s31, v230
 v_mfma_f32_16x16x32_bf16 v[128:131], v[204:207], a[8:11], v[128:131]
 s_waitcnt lgkmcnt(0)
 v_fmac_f32 v99, s31, v231
 v_cvt_pk_bf16_f32 v96, v96, v97
 v_mfma_f32_16x16x32_bf16 v[128:131], v[208:211], a[4:7], v[128:131]
 v_cvt_pk_bf16_f32 v97, v98, v99
 v_add_f32 v119, v119, v125
 v_mfma_f32_16x16x32_bf16 v[128:131], v[212:215], a[0:3], v[128:131]
 buffer_store_dwordx2 v[96:97], v20, s[12:15], s34 offen offset:2048 sc1
 v_mfma_f32_16x16x32_bf16 v[132:135], v[160:163], a[116:119], 0
 v_cndmask_b32_e64 v232, v119, v103, vcc
 v_cndmask_b32_e64 v233, v123, v107, vcc
 v_mfma_f32_16x16x32_bf16 v[132:135], v[164:167], a[112:115], v[132:135]
 v_cndmask_b32_e64 v234, v127, v111, vcc
 v_add_f32 v113, v113, v116
 v_mfma_f32_16x16x32_bf16 v[132:135], v[168:171], a[108:111], v[132:135]
 ds_bpermute_b32 v232, v19, v232
 v_add_f32 v114, v114, v117
 v_mfma_f32_16x16x32_bf16 v[132:135], v[172:175], a[104:107], v[132:135]
 ds_bpermute_b32 v233, v19, v233
 v_add_f32 v115, v115, v118
 v_mfma_f32_16x16x32_bf16 v[132:135], v[176:179], a[100:103], v[132:135]
 ds_bpermute_b32 v234, v19, v234
 v_add_f32 v114, v114, v120
 v_mfma_f32_16x16x32_bf16 v[132:135], v[180:183], a[96:99], v[132:135]
 ds_read_u16_d16_hi v236, v18 offset:768
 v_add_f32 v115, v115, v121
 v_mfma_f32_16x16x32_bf16 v[132:135], v[184:187], a[92:95], v[132:135]
 ds_read_u16_d16_hi v237, v18 offset:1920
 v_add_f32 v115, v115, v124
 v_mfma_f32_16x16x32_bf16 v[132:135], v[188:191], a[88:91], v[132:135]
 ds_read_u16_d16_hi v238, v18 offset:3072
 v_mfma_f32_16x16x32_bf16 v[132:135], v[192:195], a[84:87], v[132:135]
 ds_read_u16_d16_hi v239, v18 offset:4224
 v_mfma_f32_16x16x32_bf16 v[132:135], v[196:199], a[80:83], v[132:135]
 v_mfma_f32_16x16x32_bf16 v[132:135], v[200:203], a[76:79], v[132:135]
 v_mfma_f32_16x16x32_bf16 v[132:135], v[204:207], a[72:75], v[132:135]
 v_mfma_f32_16x16x32_bf16 v[132:135], v[208:211], a[68:71], v[132:135]
 v_mfma_f32_16x16x32_bf16 v[132:135], v[212:215], a[64:67], v[132:135]
 v_mfma_f32_16x16x32_bf16 v[136:139], v[160:163], a[180:183], 0
 s_waitcnt lgkmcnt(5)
 v_add_f32 v112, v112, v232
 v_add_f32 v113, v113, v233
 v_mfma_f32_16x16x32_bf16 v[136:139], v[164:167], a[176:179], v[136:139]
 s_waitcnt lgkmcnt(3)
 v_add_f32 v114, v114, v234
 v_fmac_f32 v112, s31, v236
 v_mfma_f32_16x16x32_bf16 v[136:139], v[168:171], a[172:175], v[136:139]
 s_waitcnt lgkmcnt(1)
 v_fmac_f32 v113, s31, v237
 v_fmac_f32 v114, s31, v238
 v_mfma_f32_16x16x32_bf16 v[136:139], v[172:175], a[168:171], v[136:139]
 s_waitcnt lgkmcnt(0)
 v_fmac_f32 v115, s31, v239
 v_cvt_pk_bf16_f32 v112, v112, v113
 v_mfma_f32_16x16x32_bf16 v[136:139], v[176:179], a[164:167], v[136:139]
 v_cvt_pk_bf16_f32 v113, v114, v115
 v_mfma_f32_16x16x32_bf16 v[136:139], v[180:183], a[160:163], v[136:139]
 buffer_store_dwordx2 v[112:113], v20, s[12:15], s34 offen offset:2560 sc1
 v_mfma_f32_16x16x32_bf16 v[136:139], v[184:187], a[156:159], v[136:139]
 v_mfma_f32_16x16x32_bf16 v[136:139], v[188:191], a[152:155], v[136:139]
 v_mfma_f32_16x16x32_bf16 v[136:139], v[192:195], a[148:151], v[136:139]
 v_mfma_f32_16x16x32_bf16 v[136:139], v[196:199], a[144:147], v[136:139]
 v_mfma_f32_16x16x32_bf16 v[136:139], v[200:203], a[140:143], v[136:139]
 v_mfma_f32_16x16x32_bf16 v[136:139], v[204:207], a[136:139], v[136:139]
 v_mfma_f32_16x16x32_bf16 v[136:139], v[208:211], a[132:135], v[136:139]
 v_mfma_f32_16x16x32_bf16 v[136:139], v[212:215], a[128:131], v[136:139]
 v_mfma_f32_16x16x32_bf16 v[140:143], v[160:163], a[244:247], 0
 v_mfma_f32_16x16x32_bf16 v[140:143], v[164:167], a[240:243], v[140:143]
 v_mfma_f32_16x16x32_bf16 v[140:143], v[168:171], a[236:239], v[140:143]
 v_mfma_f32_16x16x32_bf16 v[140:143], v[172:175], a[232:235], v[140:143]
 v_mfma_f32_16x16x32_bf16 v[140:143], v[176:179], a[228:231], v[140:143]
 v_mfma_f32_16x16x32_bf16 v[140:143], v[180:183], a[224:227], v[140:143]
 v_mfma_f32_16x16x32_bf16 v[140:143], v[184:187], a[220:223], v[140:143]
 v_mfma_f32_16x16x32_bf16 v[140:143], v[188:191], a[216:219], v[140:143]
 v_mfma_f32_16x16x32_bf16 v[140:143], v[192:195], a[212:215], v[140:143]
 v_mfma_f32_16x16x32_bf16 v[140:143], v[196:199], a[208:211], v[140:143]
 v_mfma_f32_16x16x32_bf16 v[140:143], v[200:203], a[204:207], v[140:143]
 v_mfma_f32_16x16x32_bf16 v[140:143], v[204:207], a[200:203], v[140:143]
 v_mfma_f32_16x16x32_bf16 v[140:143], v[208:211], a[196:199], v[140:143]
 v_mfma_f32_16x16x32_bf16 v[140:143], v[212:215], a[192:195], v[140:143]
 v_mfma_f32_16x16x32_bf16 v[144:147], v[160:163], a[60:63], 0
 v_mfma_f32_16x16x32_bf16 v[144:147], v[164:167], a[56:59], v[144:147]
 v_mfma_f32_16x16x32_bf16 v[144:147], v[168:171], a[52:55], v[144:147]
 v_mfma_f32_16x16x32_bf16 v[144:147], v[172:175], a[48:51], v[144:147]
 v_mfma_f32_16x16x32_bf16 v[144:147], v[176:179], a[44:47], v[144:147]
 v_mfma_f32_16x16x32_bf16 v[144:147], v[180:183], a[40:43], v[144:147]
 v_mfma_f32_16x16x32_bf16 v[144:147], v[184:187], a[36:39], v[144:147]
 v_mfma_f32_16x16x32_bf16 v[144:147], v[188:191], a[32:35], v[144:147]
 v_add_f32 v135, v135, v138
 v_add_f32 v139, v139, v142
 v_mfma_f32_16x16x32_bf16 v[144:147], v[192:195], a[28:31], v[144:147]
 v_add_f32 v135, v135, v141
 v_cndmask_b32_e64 v240, v135, v119, vcc
 v_mfma_f32_16x16x32_bf16 v[144:147], v[196:199], a[24:27], v[144:147]
 v_cndmask_b32_e64 v241, v139, v123, vcc
 v_cndmask_b32_e64 v242, v143, v127, vcc
 v_mfma_f32_16x16x32_bf16 v[144:147], v[200:203], a[20:23], v[144:147]
 ds_bpermute_b32 v240, v19, v240
 v_add_f32 v129, v129, v132
 v_mfma_f32_16x16x32_bf16 v[144:147], v[204:207], a[16:19], v[144:147]
 ds_bpermute_b32 v241, v19, v241
 v_add_f32 v130, v130, v133
 v_mfma_f32_16x16x32_bf16 v[144:147], v[208:211], a[12:15], v[144:147]
 ds_bpermute_b32 v242, v19, v242
 v_add_f32 v131, v131, v134
 v_mfma_f32_16x16x32_bf16 v[144:147], v[212:215], a[8:11], v[144:147]
 ds_read_u16_d16_hi v244, v18 offset:896
 v_add_f32 v130, v130, v136
 v_mfma_f32_16x16x32_bf16 v[144:147], v[216:219], a[4:7], v[144:147]
 ds_read_u16_d16_hi v245, v18 offset:2048
 v_add_f32 v131, v131, v137
 v_mfma_f32_16x16x32_bf16 v[144:147], v[220:223], a[0:3], v[144:147]
 ds_read_u16_d16_hi v246, v18 offset:3200
 v_add_f32 v131, v131, v140
 v_mfma_f32_16x16x32_bf16 v[148:151], v[160:163], a[124:127], 0
 ds_read_u16_d16_hi v247, v18 offset:4352
 v_mfma_f32_16x16x32_bf16 v[148:151], v[164:167], a[120:123], v[148:151]
 v_mfma_f32_16x16x32_bf16 v[148:151], v[168:171], a[116:119], v[148:151]
 v_mfma_f32_16x16x32_bf16 v[148:151], v[172:175], a[112:115], v[148:151]
 v_mfma_f32_16x16x32_bf16 v[148:151], v[176:179], a[108:111], v[148:151]
 v_mfma_f32_16x16x32_bf16 v[148:151], v[180:183], a[104:107], v[148:151]
 v_mfma_f32_16x16x32_bf16 v[148:151], v[184:187], a[100:103], v[148:151]
 s_waitcnt lgkmcnt(5)
 v_add_f32 v128, v128, v240
 v_add_f32 v129, v129, v241
 v_mfma_f32_16x16x32_bf16 v[148:151], v[188:191], a[96:99], v[148:151]
 s_waitcnt lgkmcnt(3)
 v_add_f32 v130, v130, v242
 v_fmac_f32 v128, s31, v244
 v_mfma_f32_16x16x32_bf16 v[148:151], v[192:195], a[92:95], v[148:151]
 buffer_load_dword v26, v25, s[12:15], s45 offen sc1
 v_mfma_f32_16x16x32_bf16 v[148:151], v[196:199], a[88:91], v[148:151]
 s_waitcnt lgkmcnt(1)
 v_fmac_f32 v129, s31, v245
 v_fmac_f32 v130, s31, v246
 v_mfma_f32_16x16x32_bf16 v[148:151], v[200:203], a[84:87], v[148:151]
 s_waitcnt lgkmcnt(0)
 v_fmac_f32 v131, s31, v247
 v_cvt_pk_bf16_f32 v128, v128, v129
 v_mfma_f32_16x16x32_bf16 v[148:151], v[204:207], a[80:83], v[148:151]
 v_cvt_pk_bf16_f32 v129, v130, v131
 v_mfma_f32_16x16x32_bf16 v[148:151], v[208:211], a[76:79], v[148:151]
 buffer_store_dwordx2 v[128:129], v20, s[12:15], s34 offen offset:3072 sc1
 v_mfma_f32_16x16x32_bf16 v[148:151], v[212:215], a[72:75], v[148:151]
 v_mfma_f32_16x16x32_bf16 v[148:151], v[216:219], a[68:71], v[148:151]
 v_mfma_f32_16x16x32_bf16 v[148:151], v[220:223], a[64:67], v[148:151]
 v_mfma_f32_16x16x32_bf16 v[152:155], v[160:163], a[188:191], 0
 v_mfma_f32_16x16x32_bf16 v[152:155], v[164:167], a[184:187], v[152:155]
 v_mfma_f32_16x16x32_bf16 v[152:155], v[168:171], a[180:183], v[152:155]
 v_mfma_f32_16x16x32_bf16 v[152:155], v[172:175], a[176:179], v[152:155]
 v_mfma_f32_16x16x32_bf16 v[152:155], v[176:179], a[172:175], v[152:155]
 v_mfma_f32_16x16x32_bf16 v[152:155], v[180:183], a[168:171], v[152:155]
 v_mfma_f32_16x16x32_bf16 v[152:155], v[184:187], a[164:167], v[152:155]
 v_mfma_f32_16x16x32_bf16 v[152:155], v[188:191], a[160:163], v[152:155]
 v_mfma_f32_16x16x32_bf16 v[152:155], v[192:195], a[156:159], v[152:155]
 v_mfma_f32_16x16x32_bf16 v[152:155], v[196:199], a[152:155], v[152:155]
 v_mfma_f32_16x16x32_bf16 v[152:155], v[200:203], a[148:151], v[152:155]
 v_mfma_f32_16x16x32_bf16 v[152:155], v[204:207], a[144:147], v[152:155]
 v_mfma_f32_16x16x32_bf16 v[152:155], v[208:211], a[140:143], v[152:155]
 v_mfma_f32_16x16x32_bf16 v[152:155], v[212:215], a[136:139], v[152:155]
 v_mfma_f32_16x16x32_bf16 v[152:155], v[216:219], a[132:135], v[152:155]
 v_mfma_f32_16x16x32_bf16 v[152:155], v[220:223], a[128:131], v[152:155]
 v_mfma_f32_16x16x32_bf16 v[156:159], v[160:163], v[28:31], 0
 v_mfma_f32_16x16x32_bf16 v[156:159], v[164:167], a[248:251], v[156:159]
 v_mfma_f32_16x16x32_bf16 v[156:159], v[168:171], a[244:247], v[156:159]
 v_mfma_f32_16x16x32_bf16 v[156:159], v[172:175], a[240:243], v[156:159]
 v_mfma_f32_16x16x32_bf16 v[156:159], v[176:179], a[236:239], v[156:159]
 v_mfma_f32_16x16x32_bf16 v[156:159], v[180:183], a[232:235], v[156:159]
 v_mfma_f32_16x16x32_bf16 v[156:159], v[184:187], a[228:231], v[156:159]
 v_mfma_f32_16x16x32_bf16 v[156:159], v[188:191], a[224:227], v[156:159]
 v_mfma_f32_16x16x32_bf16 v[156:159], v[192:195], a[220:223], v[156:159]
 v_mfma_f32_16x16x32_bf16 v[156:159], v[196:199], a[216:219], v[156:159]
 v_mfma_f32_16x16x32_bf16 v[156:159], v[200:203], a[212:215], v[156:159]
 v_mfma_f32_16x16x32_bf16 v[156:159], v[204:207], a[208:211], v[156:159]
 v_mfma_f32_16x16x32_bf16 v[156:159], v[208:211], a[204:207], v[156:159]
 v_mfma_f32_16x16x32_bf16 v[156:159], v[212:215], a[200:203], v[156:159]
 v_mfma_f32_16x16x32_bf16 v[156:159], v[216:219], a[196:199], v[156:159]
 v_mfma_f32_16x16x32_bf16 v[156:159], v[220:223], a[192:195], v[156:159]
 s_nop 7
 v_add_f32 v151, v151, v154
 v_add_f32 v155, v155, v158
 v_add_f32 v151, v151, v157
 v_cndmask_b32_e64 v248, v151, v135, vcc
 v_cndmask_b32_e64 v249, v155, v139, vcc
 v_cndmask_b32_e64 v250, v159, v143, vcc
 ds_bpermute_b32 v248, v19, v248
 ds_bpermute_b32 v249, v19, v249
 ds_bpermute_b32 v250, v19, v250
 ds_read_u16_d16_hi v252, v18 offset:1024
 ds_read_u16_d16_hi v253, v18 offset:2176
 ds_read_u16_d16_hi v254, v18 offset:3328
 ds_read_u16_d16_hi v255, v18 offset:4480
 v_add_f32 v145, v145, v148
 v_add_f32 v146, v146, v149
 v_add_f32 v147, v147, v150
 v_add_f32 v146, v146, v152
 v_add_f32 v147, v147, v153
 v_add_f32 v147, v147, v156
 s_waitcnt lgkmcnt(0)
 v_add_f32 v144, v144, v248
 v_add_f32 v145, v145, v249
 v_add_f32 v146, v146, v250
 v_fmac_f32 v144, s31, v252
 v_fmac_f32 v145, s31, v253
 v_fmac_f32 v146, s31, v254
 v_fmac_f32 v147, s31, v255
 v_cvt_pk_bf16_f32 v144, v144, v145
 v_cvt_pk_bf16_f32 v145, v146, v147
 buffer_store_dwordx2 v[144:145], v20, s[12:15], s34 offen offset:3584 sc1
 s_add_u32 s47, s37, 14680064
 s_waitcnt vmcnt(2)
 v_cmp_ne_u32 vcc, 0, v26
 s_cmp_eq_u64 vcc, 0
 s_cselect_b32 s50, 1, 0
 s_cselect_b32 s51, s47, 2.0
 buffer_load_dwordx4 a[0:3], v1, s[12:15], s51 offen offset:0 sc1
 s_lshl_b32 s42, s42, 4
 s_lshl_b32 s36, s41, 6
 s_add_u32 s36, s36, 896
 s_add_u32 s35, s36, 1835008
 s_add_u32 s39, s37, 14680064
 s_mov_b32 s8, s88
 s_mov_b32 s9, s89
 s_mov_b32 s10, 3670016
 buffer_load_dwordx4 a[4:7], v1, s[12:15], s51 offen offset:1024 sc1
 s_mov_b32 s11, 0x20000
 v_and_b32 v2, 15, v0
 v_add_u32 v2, s42, v2
 v_mul_u32_u24 v7, 896, v2
 v_lshrrev_b32 v3, 4, v0
 v_lshlrev_b32 v8, 4, v3
 v_lshl_add_u32 v2, v7, 1, v8
 buffer_load_dwordx4 a[8:11], v1, s[12:15], s51 offen offset:2048 sc1
 v_add_u32 v7, v7, v8
 v_and_b32 v4, 1, v0
 v_lshlrev_b32 v4, 4, v4
 v_mov_b32 v5, 0x3f80
 v_lshlrev_b32 v4, v4, v5
 v_bfe_u32 v5, v0, 3, 1
 v_bfe_u32 v6, v0, 1, 1
 buffer_load_dwordx4 a[12:15], v1, s[12:15], s51 offen offset:3072 sc1
 v_lshl_add_u32 v5, v5, 1, v6
 v_bfe_u32 v6, v0, 2, 1
 v_lshlrev_b32 v6, 1, v6
 v_sub_u32 v6, v3, v6
 v_lshl_add_u32 v5, v6, 2, v5
 v_cmp_eq_u32 s[16:17], 0, v5
 v_cmp_eq_u32 s[18:19], 1, v5
 s_add_u32 s51, s51, 4096
 v_cmp_eq_u32 s[20:21], 2, v5
 v_cmp_eq_u32 s[22:23], 3, v5
 v_cndmask_b32 v24, 0, v4, s[16:17]
 v_cndmask_b32 v25, 0, v4, s[18:19]
 v_cndmask_b32 v26, 0, v4, s[20:21]
 v_cndmask_b32 v27, 0, v4, s[22:23]
 v_cmp_eq_u32 s[16:17], 4, v5
 buffer_load_dwordx4 a[16:19], v1, s[12:15], s51 offen offset:0 sc1
 v_cmp_eq_u32 s[18:19], 5, v5
 v_cmp_eq_u32 s[20:21], 6, v5
 v_cmp_eq_u32 s[22:23], 7, v5
 v_cndmask_b32 v28, 0, v4, s[16:17]
 v_cndmask_b32 v29, 0, v4, s[18:19]
 v_cndmask_b32 v30, 0, v4, s[20:21]
 v_cndmask_b32 v31, 0, v4, s[22:23]
 s_mov_b32 s16, s64
 buffer_load_dwordx4 a[20:23], v1, s[12:15], s51 offen offset:1024 sc1
 s_mov_b32 s17, s65
 s_mov_b32 s18, 1835008
 s_mov_b32 s19, 0x20000
 s_lshl_b32 s93, s95, 2
 s_add_u32 s93, s93, 84963328
 s_lshl_b32 s43, s41, 6
 s_add_u32 s43, s43, 84963328
 buffer_load_dwordx4 a[24:27], v1, s[12:15], s51 offen offset:2048 sc1
 s_lshl_b32 s46, s41, 7
 s_add_u32 s54, s46, 917504
 s_add_u32 s55, s46, 1835008
 v_lshrrev_b32 v8, 1, v0
 v_lshlrev_b32 v8, 12, v8
 v_and_b32 v9, 1, v0
 v_lshl_add_u32 v8, v9, 4, v8
 buffer_load_dwordx4 a[28:31], v1, s[12:15], s51 offen offset:3072 sc1
 s_lshl_b32 s56, s42, 1
 s_lshl_b32 s57, s41, 18
 s_add_u32 s56, s56, s57
 s_add_u32 s56, s56, 90177536
 s_add_u32 s57, s56, 0x20000
 s_lshl_b32 s58, s3, 12
 v_lshlrev_b32 v10, 3, v3
 s_add_u32 s51, s51, 4096
 v_bfe_u32 v15, v0, 2, 2
 v_add_u32 v10, v10, v15
 v_lshlrev_b32 v10, 5, v10
 v_and_b32 v15, 3, v0
 v_lshl_add_u32 v10, v15, 3, v10
 v_add_u32 v10, s58, v10
 s_mov_b32 s59, 0xffff0000
 s_waitcnt vmcnt(8)
 s_barrier
 buffer_store_dword v21, v21, s[12:15], s93 offen sc1
 buffer_load_dwordx4 a[32:35], v1, s[12:15], s51 offen offset:0 sc1
 buffer_load_dwordx4 a[36:39], v1, s[12:15], s51 offen offset:1024 sc1
 buffer_load_dwordx4 a[40:43], v1, s[12:15], s51 offen offset:2048 sc1
 buffer_load_dwordx4 a[44:47], v1, s[12:15], s51 offen offset:3072 sc1
 s_add_u32 s51, s51, 4096
 buffer_load_dwordx4 a[48:51], v1, s[12:15], s51 offen offset:0 sc1
 buffer_load_dwordx4 a[52:55], v1, s[12:15], s51 offen offset:1024 sc1
 buffer_load_dwordx4 a[56:59], v1, s[12:15], s51 offen offset:2048 sc1
 buffer_load_dwordx4 a[60:63], v1, s[12:15], s51 offen offset:3072 sc1
 s_add_u32 s51, s51, 4096
 s_cmp_eq_u32 s50, 1
 s_cbranch_scc1 L_havelong
 v_and_b32 v16, 15, v0
 v_lshlrev_b32 v16, 2, v16
 s_mov_b32 s32, 0
L_poll8:
 buffer_load_dword v17, v16, s[12:15], s45 offen sc1
 s_waitcnt vmcnt(0)
 v_cmp_ne_u32 vcc, 0, v17
 s_cbranch_vccz L_poll8_ok
 s_sleep 8
 s_add_u32 s32, s32, 1
 s_cmp_lt_u32 s32, 0x80000
 s_cbranch_scc1 L_poll8
L_poll8_ok:
 buffer_load_dwordx4 a[0:3], v1, s[12:15], s39 offen offset:0 sc1
 buffer_load_dwordx4 a[4:7], v1, s[12:15], s39 offen offset:1024 sc1
 buffer_load_dwordx4 a[8:11], v1, s[12:15], s39 offen offset:2048 sc1
 buffer_load_dwordx4 a[12:15], v1, s[12:15], s39 offen offset:3072 sc1
 s_add_u32 s39, s39, 4096
 buffer_load_dwordx4 a[16:19], v1, s[12:15], s39 offen offset:0 sc1
 buffer_load_dwordx4 a[20:23], v1, s[12:15], s39 offen offset:1024 sc1
 buffer_load_dwordx4 a[24:27], v1, s[12:15], s39 offen offset:2048 sc1
 buffer_load_dwordx4 a[28:31], v1, s[12:15], s39 offen offset:3072 sc1
 s_add_u32 s39, s39, 4096
 buffer_load_dwordx4 a[32:35], v1, s[12:15], s39 offen offset:0 sc1
 buffer_load_dwordx4 a[36:39], v1, s[12:15], s39 offen offset:1024 sc1
 buffer_load_dwordx4 a[40:43], v1, s[12:15], s39 offen offset:2048 sc1
 buffer_load_dwordx4 a[44:47], v1, s[12:15], s39 offen offset:3072 sc1
 s_add_u32 s39, s39, 4096
 buffer_load_dwordx4 a[48:51], v1, s[12:15], s39 offen offset:0 sc1
 buffer_load_dwordx4 a[52:55], v1, s[12:15], s39 offen offset:1024 sc1
 buffer_load_dwordx4 a[56:59], v1, s[12:15], s39 offen offset:2048 sc1
 buffer_load_dwordx4 a[60:63], v1, s[12:15], s39 offen offset:3072 sc1
 s_add_u32 s39, s39, 4096
L_havelong:
 buffer_load_dwordx4 v[48:51], v7, s[16:19], s46 offen offset:0
 buffer_load_dwordx4 v[52:55], v7, s[16:19], s46 offen offset:64
 buffer_load_dwordx4 v[56:59], v7, s[16:19], s54 offen offset:0
 buffer_load_dwordx4 v[60:63], v7, s[16:19], s54 offen offset:64
 v_and_b32 v17, 15, v0
 v_lshlrev_b32 v17, 2, v17
 buffer_load_dword a246, v17, s[12:15], s43 offen sc1
 s_waitcnt vmcnt(20)
 v_mfma_f32_16x16x32_bf16 v[32:35], v[24:27], a[0:3], 0
 v_mfma_f32_16x16x32_bf16 v[36:39], v[28:31], a[0:3], 0
 s_waitcnt vmcnt(19)
 v_mfma_f32_16x16x32_bf16 v[32:35], v[24:27], a[4:7], v[32:35]
 v_mfma_f32_16x16x32_bf16 v[36:39], v[28:31], a[4:7], v[36:39]
 s_waitcnt vmcnt(18)
 v_mfma_f32_16x16x32_bf16 v[32:35], v[24:27], a[8:11], v[32:35]
 v_mfma_f32_16x16x32_bf16 v[36:39], v[28:31], a[8:11], v[36:39]
 s_waitcnt vmcnt(17)
 v_mfma_f32_16x16x32_bf16 v[32:35], v[24:27], a[12:15], v[32:35]
 v_mfma_f32_16x16x32_bf16 v[36:39], v[28:31], a[12:15], v[36:39]
 s_waitcnt vmcnt(16)
 v_mfma_f32_16x16x32_bf16 v[32:35], v[24:27], a[16:19], v[32:35]
 v_mfma_f32_16x16x32_bf16 v[36:39], v[28:31], a[16:19], v[36:39]
 s_waitcnt vmcnt(15)
 v_mfma_f32_16x16x32_bf16 v[32:35], v[24:27], a[20:23], v[32:35]
 v_mfma_f32_16x16x32_bf16 v[36:39], v[28:31], a[20:23], v[36:39]
 s_waitcnt vmcnt(14)
 v_mfma_f32_16x16x32_bf16 v[32:35], v[24:27], a[24:27], v[32:35]
 v_mfma_f32_16x16x32_bf16 v[36:39], v[28:31], a[24:27], v[36:39]
 s_waitcnt vmcnt(13)
 v_mfma_f32_16x16x32_bf16 v[32:35], v[24:27], a[28:31], v[32:35]
 v_mfma_f32_16x16x32_bf16 v[36:39], v[28:31], a[28:31], v[36:39]
 s_waitcnt vmcnt(12)
 v_mfma_f32_16x16x32_bf16 v[32:35], v[24:27], a[32:35], v[32:35]
 v_mfma_f32_16x16x32_bf16 v[36:39], v[28:31], a[32:35], v[36:39]
 s_waitcnt vmcnt(11)
 v_mfma_f32_16x16x32_bf16 v[32:35], v[24:27], a[36:39], v[32:35]
 v_mfma_f32_16x16x32_bf16 v[36:39], v[28:31], a[36:39], v[36:39]
 s_waitcnt vmcnt(10)
 v_mfma_f32_16x16x32_bf16 v[32:35], v[24:27], a[40:43], v[32:35]
 v_mfma_f32_16x16x32_bf16 v[36:39], v[28:31], a[40:43], v[36:39]
 s_waitcnt vmcnt(9)
 v_mfma_f32_16x16x32_bf16 v[32:35], v[24:27], a[44:47], v[32:35]
 v_mfma_f32_16x16x32_bf16 v[36:39], v[28:31], a[44:47], v[36:39]
 s_waitcnt vmcnt(8)
 v_mfma_f32_16x16x32_bf16 v[32:35], v[24:27], a[48:51], v[32:35]
 v_mfma_f32_16x16x32_bf16 v[36:39], v[28:31], a[48:51], v[36:39]
 s_waitcnt vmcnt(7)
 v_mfma_f32_16x16x32_bf16 v[32:35], v[24:27], a[52:55], v[32:35]
 v_mfma_f32_16x16x32_bf16 v[36:39], v[28:31], a[52:55], v[36:39]
 s_waitcnt vmcnt(6)
 v_mfma_f32_16x16x32_bf16 v[32:35], v[24:27], a[56:59], v[32:35]
 v_mfma_f32_16x16x32_bf16 v[36:39], v[28:31], a[56:59], v[36:39]
 s_waitcnt vmcnt(5)
 v_mfma_f32_16x16x32_bf16 v[32:35], v[24:27], a[60:63], v[32:35]
 v_mfma_f32_16x16x32_bf16 v[36:39], v[28:31], a[60:63], v[36:39]
 s_nop 7
 v_cvt_pk_bf16_f32 v32, v32, v33
 v_cvt_pk_bf16_f32 v33, v34, v35
 v_cvt_pk_bf16_f32 v34, v36, v37
 v_cvt_pk_bf16_f32 v35, v38, v39
 buffer_store_dwordx4 v[32:35], v2, s[8:11], s35 offen offset:0
 s_waitcnt vmcnt(1)
 v_accvgpr_read_b32 v17, a246
 v_cmp_ne_u32 vcc, 0, v17
 s_cbranch_vccz L_poll9_ok
 v_and_b32 v16, 15, v0
 v_lshlrev_b32 v16, 2, v16
 s_mov_b32 s32, 0
L_poll9:
 buffer_load_dword v17, v16, s[12:15], s43 offen sc1
 s_waitcnt vmcnt(0)
 v_cmp_ne_u32 vcc, 0, v17
 s_cbranch_vccz L_poll9_ok
 s_sleep 8
 s_add_u32 s32, s32, 1
 s_cmp_lt_u32 s32, 0x80000
 s_cbranch_scc1 L_poll9
L_poll9_ok:
 s_add_u32 m0, s58, 0
 s_nop 0
 buffer_load_dwordx4 v8, s[12:15], s56 offen offset:0 sc1 lds
 s_add_u32 m0, s58, 1024
 s_nop 0
 buffer_load_dwordx4 v8, s[12:15], s57 offen offset:0 sc1 lds
 s_add_u32 m0, s58, 0
 s_nop 0
 buffer_load_dwordx4 v8, s[12:15], s56 offen offset:2048 sc1 lds
 s_add_u32 m0, s58, 1024
 s_nop 0
 buffer_load_dwordx4 v8, s[12:15], s57 offen offset:2048 sc1 lds
 s_waitcnt vmcnt(3)
 ds_read_b64_tr_b16 v[12:13], v10 offset:0
 ds_read_b64_tr_b16 v[14:15], v10 offset:128
 s_waitcnt lgkmcnt(0)
 v_lshlrev_b32 v16, 16, v48
 v_and_b32 v17, s59, v48
 v_lshlrev_b32 v18, 16, v12
 v_and_b32 v19, s59, v12
 v_pk_mul_f32 v[16:17], v[16:17], v[18:19]
 v_cvt_pk_bf16_f32 v48, v16, v17
 v_lshlrev_b32 v16, 16, v49
 v_and_b32 v17, s59, v49
 v_lshlrev_b32 v18, 16, v13
 v_and_b32 v19, s59, v13
 v_pk_mul_f32 v[16:17], v[16:17], v[18:19]
 v_cvt_pk_bf16_f32 v49, v16, v17
 v_lshlrev_b32 v16, 16, v50
 v_and_b32 v17, s59, v50
 v_lshlrev_b32 v18, 16, v14
 v_and_b32 v19, s59, v14
 v_pk_mul_f32 v[16:17], v[16:17], v[18:19]
 v_cvt_pk_bf16_f32 v50, v16, v17
 v_lshlrev_b32 v16, 16, v51
 v_and_b32 v17, s59, v51
 v_lshlrev_b32 v18, 16, v15
 v_and_b32 v19, s59, v15
 v_pk_mul_f32 v[16:17], v[16:17], v[18:19]
 v_cvt_pk_bf16_f32 v51, v16, v17
 buffer_store_dwordx4 v[48:51], v2, s[8:11], s46 offen offset:0
 s_waitcnt vmcnt(3)
 ds_read_b64_tr_b16 v[12:13], v10 offset:1024
 ds_read_b64_tr_b16 v[14:15], v10 offset:1152
 s_waitcnt lgkmcnt(0)
 v_lshlrev_b32 v16, 16, v52
 v_and_b32 v17, s59, v52
 v_lshlrev_b32 v18, 16, v12
 v_and_b32 v19, s59, v12
 v_pk_mul_f32 v[16:17], v[16:17], v[18:19]
 v_cvt_pk_bf16_f32 v52, v16, v17
 v_lshlrev_b32 v16, 16, v53
 v_and_b32 v17, s59, v53
 v_lshlrev_b32 v18, 16, v13
 v_and_b32 v19, s59, v13
 v_pk_mul_f32 v[16:17], v[16:17], v[18:19]
 v_cvt_pk_bf16_f32 v53, v16, v17
 v_lshlrev_b32 v16, 16, v54
 v_and_b32 v17, s59, v54
 v_lshlrev_b32 v18, 16, v14
 v_and_b32 v19, s59, v14
 v_pk_mul_f32 v[16:17], v[16:17], v[18:19]
 v_cvt_pk_bf16_f32 v54, v16, v17
 v_lshlrev_b32 v16, 16, v55
 v_and_b32 v17, s59, v55
 v_lshlrev_b32 v18, 16, v15
 v_and_b32 v19, s59, v15
 v_pk_mul_f32 v[16:17], v[16:17], v[18:19]
 v_cvt_pk_bf16_f32 v55, v16, v17
 buffer_store_dwordx4 v[52:55], v2, s[8:11], s46 offen offset:64
 s_waitcnt vmcnt(3)
 ds_read_b64_tr_b16 v[12:13], v10 offset:2048
 ds_read_b64_tr_b16 v[14:15], v10 offset:2176
 s_waitcnt lgkmcnt(0)
 v_lshlrev_b32 v16, 16, v56
 v_and_b32 v17, s59, v56
 v_lshlrev_b32 v18, 16, v12
 v_and_b32 v19, s59, v12
 v_pk_mul_f32 v[16:17], v[16:17], v[18:19]
 v_cvt_pk_bf16_f32 v56, v16, v17
 v_lshlrev_b32 v16, 16, v57
 v_and_b32 v17, s59, v57
 v_lshlrev_b32 v18, 16, v13
 v_and_b32 v19, s59, v13
 v_pk_mul_f32 v[16:17], v[16:17], v[18:19]
 v_cvt_pk_bf16_f32 v57, v16, v17
 v_lshlrev_b32 v16, 16, v58
 v_and_b32 v17, s59, v58
 v_lshlrev_b32 v18, 16, v14
 v_and_b32 v19, s59, v14
 v_pk_mul_f32 v[16:17], v[16:17], v[18:19]
 v_cvt_pk_bf16_f32 v58, v16, v17
 v_lshlrev_b32 v16, 16, v59
 v_and_b32 v17, s59, v59
 v_lshlrev_b32 v18, 16, v15
 v_and_b32 v19, s59, v15
 v_pk_mul_f32 v[16:17], v[16:17], v[18:19]
 v_cvt_pk_bf16_f32 v59, v16, v17
 buffer_store_dwordx4 v[56:59], v2, s[8:11], s55 offen offset:0
 s_waitcnt vmcnt(3)
 ds_read_b64_tr_b16 v[12:13], v10 offset:3072
 ds_read_b64_tr_b16 v[14:15], v10 offset:3200
 s_waitcnt lgkmcnt(0)
 v_lshlrev_b32 v16, 16, v60
 v_and_b32 v17, s59, v60
 v_lshlrev_b32 v18, 16, v12
 v_and_b32 v19, s59, v12
 v_pk_mul_f32 v[16:17], v[16:17], v[18:19]
 v_cvt_pk_bf16_f32 v60, v16, v17
 v_lshlrev_b32 v16, 16, v61
 v_and_b32 v17, s59, v61
 v_lshlrev_b32 v18, 16, v13
 v_and_b32 v19, s59, v13
 v_pk_mul_f32 v[16:17], v[16:17], v[18:19]
 v_cvt_pk_bf16_f32 v61, v16, v17
 v_lshlrev_b32 v16, 16, v62
 v_and_b32 v17, s59, v62
 v_lshlrev_b32 v18, 16, v14
 v_and_b32 v19, s59, v14
 v_pk_mul_f32 v[16:17], v[16:17], v[18:19]
 v_cvt_pk_bf16_f32 v62, v16, v17
 v_lshlrev_b32 v16, 16, v63
 v_and_b32 v17, s59, v63
 v_lshlrev_b32 v18, 16, v15
 v_and_b32 v19, s59, v15
 v_pk_mul_f32 v[16:17], v[16:17], v[18:19]
 v_cvt_pk_bf16_f32 v63, v16, v17
 buffer_store_dwordx4 v[60:63], v2, s[8:11], s55 offen offset:64
L_fin:
 s_endpgm
L_codeend:
.section .rodata,"a"
.p2align 6
.amdhsa_kernel concat_heads__ssm_conv_h3__compressed_kv_cla__prompt_kernel
  .amdhsa_next_free_vgpr 512
  .amdhsa_next_free_sgpr 102
  .amdhsa_accum_offset 256
  .amdhsa_group_segment_fixed_size 0
  .amdhsa_kernarg_size 120
  .amdhsa_user_sgpr_count 2
  .amdhsa_user_sgpr_kernarg_segment_ptr 1
  .amdhsa_system_sgpr_workgroup_id_x 1
.end_amdhsa_kernel
```

```asm
; @launch grid=(256,1,1) block=(256,1,1) lds=163840
.amdgcn_target "amdgcn-amd-amdhsa--gfx950"
.text
.globl concat_heads__ssm_conv_h3__compressed_kv_cla__prompt_kernel
.p2align 8
.type concat_heads__ssm_conv_h3__compressed_kv_cla__prompt_kernel,@function
concat_heads__ssm_conv_h3__compressed_kv_cla__prompt_kernel:
 s_cmp_lt_u32 s2, 256
 s_cbranch_scc1 L_go
 s_endpgm
L_go:
 s_load_dwordx16 s[64:79], s[0:1], 0
 s_load_dwordx8 s[80:87], s[0:1], 64
 s_load_dwordx4 s[88:91], s[0:1], 96
 s_load_dwordx2 s[12:13], s[0:1], 112
 v_lshrrev_b32 v1, 6, v0
 v_and_b32 v0, 63, v0
 v_readfirstlane_b32 s3, v1
 s_and_b32 s24, s2, 7
 s_bfe_u32 s25, s2, 0x30003
 s_bfe_u32 s26, s2, 0x10006
 s_lshl_b32 s37, s24, 1
 s_add_u32 s26, s26, s37
 s_lshr_b32 s27, s2, 7
 s_bfe_u32 s28, s2, 0x40003
 s_lshl_b32 s29, s3, 10
 s_and_b32 s39, s3, 1
 s_lshr_b32 s40, s3, 1
 s_mul_i32 s37, s27, 2
 s_add_u32 s37, s37, s25
 s_and_b32 s37, s37, 7
 s_lshl_b32 s37, s37, 1
 s_lshr_b32 s28, s28, 3
 s_add_u32 s28, s28, s37
 s_getpc_b64 s[100:101]
L_pc:
 s_sub_u32 s100, s100, L_pc-L_go
 s_subb_u32 s101, s101, 0
 s_lshr_b32 s32, s2, 1
 s_and_b32 s32, s32, 124
 s_add_u32 s32, s32, s3
 s_mul_i32 s32, s32, 1152
 s_add_u32 s32, s32, 0
 v_min_u32 v14, 8, v0
 v_lshl_add_u32 v14, v14, 7, s32
 v_min_u32 v14, L_codeend-L_go-4, v14
 v_accvgpr_write_b32 a244, v14
 global_load_dword a243, v14, s[100:101]
 s_mov_b32 s41, 65536
 s_mov_b32 s48, 32768
 s_mov_b32 s42, 131072
 s_mov_b32 s49, 131072
 s_mov_b32 s43, 196608
 s_mov_b32 s50, 163840
 s_mov_b32 s44, 262144
 s_mov_b32 s51, 262144
 s_mov_b32 s45, 327680
 s_mov_b32 s52, 294912
 s_mov_b32 s46, 393216
 s_mov_b32 s53, 393216
 s_mov_b32 s47, 458752
 s_mov_b32 s54, 425984
 s_lshl_b32 s56, s39, 1
 s_lshl_b32 s57, s40, 3
 s_add_u32 s56, s56, s57
 s_lshl_b32 s60, s25, 8
 s_lshl_b32 s58, s3, 3
 s_add_u32 s58, s58, s60
 v_lshrrev_b32 v14, 3, v0
 v_add_u32 v14, s58, v14
 v_lshlrev_b32 v14, 11, v14
 s_lshl_b32 s58, s39, 2
 v_lshrrev_b32 v15, 4, v0
 v_add_u32 v15, s58, v15
 v_xor_b32 v15, v0, v15
 v_and_b32 v15, 7, v15
 v_lshl_add_u32 v1, v15, 4, v14
 v_lshrrev_b32 v14, 5, v0
 s_lshl_b32 s58, s3, 1
 v_add_u32 v15, s58, v14
 v_lshlrev_b32 v15, 1, v15
 v_xor_b32 v15, v0, v15
 v_and_b32 v15, 31, v15
 v_lshlrev_b32 v15, 4, v15
 v_add_u32 v14, s56, v14
 v_lshl_add_u32 v14, v14, 13, v15
 s_lshl_b32 s58, s26, 9
 v_add_u32 v2, s58, v14
 s_waitcnt lgkmcnt(0)
 s_cmp_eq_u32 s27, 0
 s_cselect_b32 s8, s82, s84
 s_cselect_b32 s9, s83, s85
 s_mov_b32 s10, 8388608
 s_mov_b32 s11, 0x20000
 s_mov_b32 s4, s78
 s_mov_b32 s5, s79
 s_mov_b32 s6, 4194304
 s_mov_b32 s7, 0x20000
 s_mov_b32 s14, 268435456
 s_mov_b32 s15, 0x20000
 s_add_u32 m0, s29, 65536
 s_nop 0
 buffer_load_dwordx4 v2, s[8:11], 0 offen  lds
 s_lshl_b32 s58, s27, 3
 s_add_u32 s59, s58, s25
 s_lshl_b32 s59, s59, 2
 s_lshl_b32 s92, s26, 7
 s_add_u32 s92, s92, s59
 s_add_u32 s92, s92, 84934656
 s_add_u32 s58, s58, s24
 s_mul_i32 s95, s58, 14
 s_add_u32 m0, s29, 0
 s_nop 0
 buffer_load_dwordx4 v1, s[4:7], 0 offen  lds
 s_add_u32 s95, s95, s28
 s_sub_u32 s63, 15, s25
 s_cmp_eq_u32 s27, 0
 s_cselect_b32 s63, s25, s63
 s_lshl_b32 s93, s63, 7
 s_lshl_b32 s59, s26, 2
 s_add_u32 s93, s93, s59
 s_add_u32 s93, s93, 84938752
 s_add_u32 m0, s29, 69632
 s_nop 0
 buffer_load_dwordx4 v2, s[8:11], s48 offen  lds
 s_and_b32 s94, s2, 127
 s_lshl_b32 s94, s94, 7
 s_add_u32 s94, s94, 84942848
 s_cmp_lg_u32 s3, 0
 s_cbranch_scc1 L_noclr
 s_lshl_b32 s58, s95, 2
 s_add_u32 s59, s58, 84963328
 s_add_u32 s58, s58, 84959232
 s_lshl_b32 s61, s27, 2
 s_add_u32 s61, s61, s94
 s_cmp_lt_u32 s28, 14
 s_cselect_b32 s58, s58, s92
 s_cselect_b32 s59, s59, s92
 v_mov_b32 v14, s92
 v_writelane_b32 v14, s93, 1
 v_writelane_b32 v14, s61, 2
 v_writelane_b32 v14, s58, 3
 v_writelane_b32 v14, s59, 4
 s_add_u32 s58, s93, 64
 v_writelane_b32 v14, s58, 5
 v_mov_b32 v15, 1
 s_mov_b64 exec, 63
 buffer_store_dword v15, v14, s[12:15], 0 offen sc1
 s_mov_b64 exec, -1
L_noclr:
 s_add_u32 m0, s29, 4096
 s_nop 0
 buffer_load_dwordx4 v1, s[4:7], s41 offen  lds
 s_add_u32 m0, s29, 73728
 s_nop 0
 buffer_load_dwordx4 v2, s[8:11], s49 offen  lds
 s_add_u32 m0, s29, 8192
 s_nop 0
 buffer_load_dwordx4 v1, s[4:7], s42 offen  lds
 s_cmp_eq_u32 s3, 0
 s_cselect_b32 s58, 0, 0x80000000
 v_bfrev_b32 v14, 1
 v_writelane_b32 v14, s58, 0
 v_accvgpr_write_b32 a245, v14
 s_add_u32 m0, s29, 77824
 s_nop 0
 buffer_load_dwordx4 v2, s[8:11], s50 offen  lds
 s_lshl_b32 s58, s39, 7
 s_lshl_b32 s59, s40, 3
 v_and_b32 v14, 15, v0
 v_lshrrev_b32 v15, 4, v0
 s_lshl_b32 s60, s63, 7
 s_lshl_b32 s62, s3, 4
 s_add_u32 s60, s60, s62
 v_lshrrev_b32 v13, 3, v0
 s_add_u32 m0, s29, 12288
 s_nop 0
 buffer_load_dwordx4 v1, s[4:7], s43 offen  lds
 v_lshlrev_b32 v13, 1, v13
 v_add_u32 v12, s60, v13
 v_mul_u32_u24 v12, 896, v12
 v_lshrrev_b32 v13, 1, v13
 v_xor_b32 v13, v0, v13
 v_and_b32 v13, 7, v13
 v_lshl_add_u32 v13, v13, 4, v12
 s_add_u32 m0, s29, 81920
 s_nop 0
 buffer_load_dwordx4 v2, s[8:11], s51 offen  lds
 v_accvgpr_write_b32 a240, v13
 v_lshrrev_b32 v13, 1, v14
 v_xor_b32 v12, v13, v15
 v_lshlrev_b32 v12, 4, v12
 v_lshl_add_u32 v12, v13, 7, v12
 v_and_b32 v13, 1, v14
 v_lshl_add_u32 v12, v13, 10, v12
 s_lshl_b32 s33, s3, 13
 s_add_u32 m0, s29, 16384
 s_nop 0
 buffer_load_dwordx4 v1, s[4:7], s44 offen  lds
 s_add_u32 s33, s33, 0x20000
 v_add_u32 v12, s33, v12
 v_accvgpr_write_b32 a242, v12
 v_lshrrev_b32 v5, 1, v14
 v_xor_b32 v5, v5, v15
 v_add_u32 v14, s58, v14
 v_lshlrev_b32 v14, 7, v14
 s_add_u32 m0, s29, 86016
 s_nop 0
 buffer_load_dwordx4 v2, s[8:11], s52 offen  lds
 v_lshl_add_u32 v4, v5, 4, v14
 v_xor_b32 v5, 64, v4
 v_bfe_u32 v14, v0, 2, 3
 v_lshrrev_b32 v15, 5, v0
 v_lshl_add_u32 v13, v15, 4, v14
 v_lshlrev_b32 v13, 9, v13
 v_xor_b32 v14, s59, v14
 v_lshl_add_u32 v13, v14, 5, v13
 s_add_u32 m0, s29, 20480
 s_nop 0
 buffer_load_dwordx4 v1, s[4:7], s45 offen  lds
 v_and_b32 v14, 3, v0
 v_lshl_add_u32 v13, v14, 3, v13
 v_add_u32 v6, 0x10000, v13
 v_xor_b32 v7, 32, v6
 v_xor_b32 v8, 64, v6
 v_xor_b32 v9, 96, v6
 v_xor_b32 v10, 128, v6
 s_add_u32 m0, s29, 90112
 s_nop 0
 buffer_load_dwordx4 v2, s[8:11], s53 offen  lds
 v_xor_b32 v11, 160, v6
 v_xor_b32 v12, 192, v6
 v_xor_b32 v13, 224, v6
 s_mov_b32 s16, s80
 s_mov_b32 s17, s81
 s_mov_b32 s18, 3670016
 s_mov_b32 s19, 0x20000
 s_mov_b32 s20, s76
 s_add_u32 m0, s29, 24576
 s_nop 0
 buffer_load_dwordx4 v1, s[4:7], s46 offen  lds
 s_mov_b32 s21, s77
 s_mov_b32 s22, 1835008
 s_mov_b32 s23, 0x20000
 s_and_b32 s62, s2, 127
 s_lshl_b32 s62, s62, 2
 s_add_u32 s62, s62, s3
 s_mul_i32 s62, s62, 17408
 s_add_u32 s62, s62, 50331648
 s_add_u32 m0, s29, 94208
 s_nop 0
 buffer_load_dwordx4 v2, s[8:11], s54 offen  lds
 s_mul_i32 s58, s26, 1048576
 s_mul_i32 s59, s25, 131072
 s_add_u32 s58, s58, s59
 s_mul_i32 s59, s39, 65536
 s_add_u32 s58, s58, s59
 s_lshl_b32 s59, s40, 12
 s_lshl_b32 s59, s59, s27
 s_add_u32 m0, s29, 28672
 s_nop 0
 buffer_load_dwordx4 v1, s[4:7], s47 offen  lds
 v_add_u32 v1, 128, v1
 v_add_u32 v2, 0x80000, v2
 s_add_u32 s58, s58, s59
 s_mul_i32 s59, s27, 16777216
 s_add_u32 s58, s58, s59
 s_mov_b32 s57, 57344
 s_lshl_b32 s60, s40, 8
 s_add_u32 s60, s60, 0x10000
 s_mov_b32 s34, 0x3db8aa3b
 s_mov_b32 s35, 0x3db8aa3b
 s_add_u32 m0, s29, 98304
 s_nop 0
 buffer_load_dwordx4 v2, s[8:11], 0 offen  lds
 s_mul_i32 s55, s25, 5
 s_lshr_b32 s55, s55, 3
 s_add_u32 s55, s55, 1
 s_cmp_lg_u32 s3, 0
 s_cmov_b32 s55, 64
 v_mov_b32 v15, 1
 s_cmp_ge_u32 s25, 6
 s_cmov_b32 s62, 2.0
 s_add_u32 m0, s29, 32768
 s_nop 0
 buffer_load_dwordx4 v1, s[4:7], 0 offen  lds
 s_lshl_b32 s31, s25, 16
 s_lshl_b32 s32, s26, 9
 s_add_u32 s31, s31, s32
 v_lshrrev_b32 v15, 3, v0
 v_lshlrev_b32 v15, 13, v15
 v_and_b32 v14, 7, v0
 v_lshlrev_b32 v14, 6, v14
 s_add_u32 m0, s29, 102400
 s_nop 0
 buffer_load_dwordx4 v2, s[8:11], s48 offen  lds
 v_add3_u32 v16, v14, v15, s31
 s_lshl_b32 s31, s25, 2
 s_lshr_b32 s32, s2, 6
 s_add_u32 s31, s31, s32
 s_lshl_b32 s31, s31, 17
 v_lshlrev_b32 v17, 11, v0
 v_add_u32 v17, s31, v17
 s_add_u32 m0, s29, 36864
 s_nop 0
 buffer_load_dwordx4 v1, s[4:7], s41 offen  lds
 s_mul_i32 s36, s2, 7282
 s_lshr_b32 s36, s36, 16
 s_mul_i32 s37, s36, 9
 s_sub_u32 s37, s2, s37
 s_lshl_b32 s38, s36, 16
 s_mov_b64 s[30:31], s[80:81]
 s_cmp_eq_u32 s37, 2
 s_cmov_b64 s[30:31], s[76:77]
 s_add_u32 m0, s29, 106496
 s_nop 0
 buffer_load_dwordx4 v2, s[8:11], s49 offen  lds
 s_cmp_eq_u32 s37, 3
 s_cmov_b64 s[30:31], s[66:67]
 s_cmp_eq_u32 s37, 4
 s_cmov_b64 s[30:31], s[68:69]
 s_cmp_eq_u32 s37, 5
 s_cmov_b64 s[30:31], s[86:87]
 s_cmp_eq_u32 s37, 6
 s_cmov_b64 s[30:31], s[86:87]
 s_add_u32 m0, s29, 40960
 s_nop 0
 buffer_load_dwordx4 v1, s[4:7], s42 offen  lds
 s_cmp_eq_u32 s37, 7
 s_cmov_b64 s[30:31], s[72:73]
 s_cmp_eq_u32 s37, 8
 s_cmov_b64 s[30:31], s[64:65]
 s_add_u32 s32, s38, 1835008
 s_cmp_eq_u32 s37, 1
 s_cmov_b32 s38, s32
 s_add_u32 m0, s29, 110592
 s_nop 0
 buffer_load_dwordx4 v2, s[8:11], s50 offen  lds
 s_cmp_eq_u32 s37, 6
 s_cmov_b32 s38, s32
 s_lshl_b32 s32, s39, 15
 s_add_u32 s38, s38, s32
 s_cmp_ge_u32 s37, 9
 s_cmov_b32 s36, 28
 s_cmp_lt_u32 s36, 28
 s_cselect_b32 s32, 0x8000, 0
 s_cselect_b32 s38, s38, 0
 s_add_u32 m0, s29, 45056
 s_nop 0
 buffer_load_dwordx4 v1, s[4:7], s43 offen  lds
 s_add_u32 s36, s30, s38
 s_addc_u32 s37, s31, 0
 s_mov_b32 s38, s32
 s_mov_b32 s39, 0x20000
 v_lshlrev_b32 v14, 6, v0
 s_mov_b32 s56, 0xffffd000
 s_add_u32 m0, s29, 114688
 s_nop 0
 buffer_load_dwordx4 v2, s[8:11], s51 offen  lds
 s_movk_i32 s30, 0x1000
 s_cmp_ge_u32 s3, 2
 s_cbranch_scc1 L_pfset
 s_mov_b32 s38, 0
 s_cmp_eq_u32 s3, 0
 s_cselect_b64 s[36:37], s[8:9], s[4:5]
 s_cselect_b32 s38, s10, s6
 s_movk_i32 s30, 128
 s_cmov_b32 s30, 0x80000
 s_cselect_b64 vcc, -1, 0
 s_lshl_b32 s56, s30, 1
 v_cndmask_b32 v14, v17, v16, vcc
L_pfset:
 s_add_u32 m0, s29, 49152
 s_nop 0
 buffer_load_dwordx4 v1, s[4:7], s44 offen  lds
 v_mov_b32 v15, 1
 v_mov_b32 v3, 0
 s_mov_b32 s61, 0
 s_waitcnt vmcnt(10)
 s_barrier
 ds_read_b64_tr_b16 a[0:1], v6 offset:0
 ds_read_b64_tr_b16 a[2:3], v6 offset:4096
 ds_read_b128 a[64:67], v4 offset:0
 ds_read_b64_tr_b16 a[4:5], v6 offset:16384
 ds_read_b64_tr_b16 a[6:7], v6 offset:20480
 ds_read_b128 a[68:71], v5 offset:0
 ds_read_b128 a[76:79], v5 offset:2048
 ds_read_b128 a[72:75], v4 offset:2048
 ds_read_b128 a[80:83], v4 offset:4096
 ds_read_b128 a[84:87], v5 offset:4096
 ds_read_b128 a[92:95], v5 offset:6144
 ds_read_b128 a[88:91], v4 offset:6144
 ds_read_b64_tr_b16 a[8:9], v7 offset:0
 ds_read_b64_tr_b16 a[10:11], v7 offset:4096
 ds_read_b64_tr_b16 a[12:13], v7 offset:16384
 ds_read_b64_tr_b16 a[14:15], v7 offset:20480
 ds_read_b64_tr_b16 a[16:17], v8 offset:0
 ds_read_b64_tr_b16 a[18:19], v8 offset:4096
 ds_read_b64_tr_b16 a[20:21], v8 offset:16384
 ds_read_b64_tr_b16 a[22:23], v8 offset:20480
 s_cmp_eq_u32 s27, 0
 s_waitcnt lgkmcnt(0)
 s_cbranch_scc0 L_vloop_head
L_kloop_head:
 v_mfma_f32_16x16x32_bf16 v[88:91], a[0:3], a[64:67], 0
 s_add_u32 m0, s29, 118784
 ds_read_b64_tr_b16 a[24:25], v9 offset:0
 v_mfma_f32_16x16x32_bf16 v[88:91], a[4:7], a[68:71], v[88:91]
 ds_read_b64_tr_b16 a[26:27], v9 offset:4096
 buffer_load_dwordx4 v2, s[8:11], s52 offen  lds
 v_mfma_f32_16x16x32_bf16 v[80:83], a[4:7], a[76:79], 0
 ds_read_b64_tr_b16 a[28:29], v9 offset:16384
 v_mfma_f32_16x16x32_bf16 v[80:83], a[0:3], a[72:75], v[80:83]
 ds_read_b64_tr_b16 a[30:31], v9 offset:20480
 v_mfma_f32_16x16x32_bf16 v[72:75], a[0:3], a[80:83], 0
 s_add_u32 m0, s29, 53248
 ds_read_b128 a[96:99], v4 offset:8192
 v_mfma_f32_16x16x32_bf16 v[72:75], a[4:7], a[84:87], v[72:75]
 buffer_load_dwordx4 v1, s[4:7], s45 offen  lds
 v_mfma_f32_16x16x32_bf16 v[64:67], a[4:7], a[92:95], 0
 ds_read_b128 a[100:103], v5 offset:8192
 v_mfma_f32_16x16x32_bf16 v[64:67], a[0:3], a[88:91], v[64:67]
 v_mfma_f32_16x16x32_bf16 v[68:71], a[8:11], a[88:91], 0
 s_add_u32 m0, s29, 122880
 ds_read_b128 a[108:111], v5 offset:10240
 v_mfma_f32_16x16x32_bf16 v[68:71], a[12:15], a[92:95], v[68:71]
 buffer_load_dwordx4 v2, s[8:11], s53 offen  lds
 v_mfma_f32_16x16x32_bf16 v[76:79], a[12:15], a[84:87], 0
 ds_read_b128 a[104:107], v4 offset:10240
 v_mfma_f32_16x16x32_bf16 v[76:79], a[8:11], a[80:83], v[76:79]
 v_mfma_f32_16x16x32_bf16 v[84:87], a[8:11], a[72:75], 0
 s_add_u32 m0, s29, 57344
 ds_read_b128 a[112:115], v4 offset:12288
 v_mfma_f32_16x16x32_bf16 v[84:87], a[12:15], a[76:79], v[84:87]
 buffer_load_dwordx4 v1, s[4:7], s46 offen  lds
 v_mfma_f32_16x16x32_bf16 v[92:95], a[12:15], a[68:71], 0
 ds_read_b128 a[116:119], v5 offset:12288
 v_mfma_f32_16x16x32_bf16 v[92:95], a[8:11], a[64:67], v[92:95]
 v_mfma_f32_16x16x32_bf16 v[120:123], a[16:19], a[64:67], 0
 s_add_u32 m0, s29, 126976
 ds_read_b128 a[124:127], v5 offset:14336
 v_mfma_f32_16x16x32_bf16 v[120:123], a[20:23], a[68:71], v[120:123]
 buffer_load_dwordx4 v2, s[8:11], s54 offen  lds
 v_mfma_f32_16x16x32_bf16 v[112:115], a[20:23], a[76:79], 0
 ds_read_b128 a[120:123], v4 offset:14336
 v_mfma_f32_16x16x32_bf16 v[112:115], a[16:19], a[72:75], v[112:115]
 v_mfma_f32_16x16x32_bf16 v[104:107], a[16:19], a[80:83], 0
 s_add_u32 m0, s29, 61440
 ds_read_b64_tr_b16 a[32:33], v10 offset:0
 v_mfma_f32_16x16x32_bf16 v[104:107], a[20:23], a[84:87], v[104:107]
 ds_read_b64_tr_b16 a[34:35], v10 offset:4096
 buffer_load_dwordx4 v1, s[4:7], s47 offen  lds
 v_mfma_f32_16x16x32_bf16 v[96:99], a[20:23], a[92:95], 0
 ds_read_b64_tr_b16 a[36:37], v10 offset:16384
 v_add_u32 v1, 128, v1
 v_mfma_f32_16x16x32_bf16 v[96:99], a[16:19], a[88:91], v[96:99]
 s_waitcnt lgkmcnt(8)
 ds_read_b64_tr_b16 a[38:39], v10 offset:20480
 v_add_u32 v2, 0x80000, v2
 v_mfma_f32_16x16x32_bf16 v[100:103], a[24:27], a[88:91], 0
 ds_read_b64_tr_b16 a[40:41], v11 offset:0
 v_mfma_f32_16x16x32_bf16 v[100:103], a[28:31], a[92:95], v[100:103]
 ds_read_b64_tr_b16 a[42:43], v11 offset:4096
 v_mfma_f32_16x16x32_bf16 v[108:111], a[28:31], a[84:87], 0
 ds_read_b64_tr_b16 a[44:45], v11 offset:16384
 v_mfma_f32_16x16x32_bf16 v[108:111], a[24:27], a[80:83], v[108:111]
 ds_read_b64_tr_b16 a[46:47], v11 offset:20480
 v_mfma_f32_16x16x32_bf16 v[116:119], a[24:27], a[72:75], 0
 ds_read_b64_tr_b16 a[48:49], v12 offset:0
 v_mfma_f32_16x16x32_bf16 v[116:119], a[28:31], a[76:79], v[116:119]
 ds_read_b64_tr_b16 a[50:51], v12 offset:4096
 v_mfma_f32_16x16x32_bf16 v[124:127], a[28:31], a[68:71], 0
 ds_read_b64_tr_b16 a[52:53], v12 offset:16384
 v_mfma_f32_16x16x32_bf16 v[124:127], a[24:27], a[64:67], v[124:127]
 ds_read_b64_tr_b16 a[54:55], v12 offset:20480
 v_mfma_f32_16x16x32_bf16 a[232:235], a[0:3], a[96:99], 0
 ds_read_b64_tr_b16 a[56:57], v13 offset:0
 v_mfma_f32_16x16x32_bf16 a[232:235], a[4:7], a[100:103], a[232:235]
 ds_read_b64_tr_b16 a[58:59], v13 offset:4096
 v_mfma_f32_16x16x32_bf16 a[224:227], a[4:7], a[108:111], 0
 s_waitcnt lgkmcnt(8)
 ds_read_b64_tr_b16 a[60:61], v13 offset:16384
 v_mfma_f32_16x16x32_bf16 a[224:227], a[0:3], a[104:107], a[224:227]
 ds_read_b64_tr_b16 a[62:63], v13 offset:20480
 v_mfma_f32_16x16x32_bf16 v[24:27], a[0:3], a[112:115], 0
 v_mfma_f32_16x16x32_bf16 v[24:27], a[4:7], a[116:119], v[24:27]
 v_mfma_f32_16x16x32_bf16 v[16:19], a[4:7], a[124:127], 0
 v_mfma_f32_16x16x32_bf16 v[16:19], a[0:3], a[120:123], v[16:19]
 s_waitcnt lgkmcnt(0)
 v_mfma_f32_16x16x32_bf16 v[20:23], a[8:11], a[120:123], 0
 s_barrier
 v_mfma_f32_16x16x32_bf16 v[20:23], a[12:15], a[124:127], v[20:23]
 s_add_u32 m0, s29, 65536
 v_mfma_f32_16x16x32_bf16 v[28:31], a[12:15], a[116:119], 0
 buffer_load_dwordx4 v2, s[8:11], 0 offen  lds
 v_mfma_f32_16x16x32_bf16 v[28:31], a[8:11], a[112:115], v[28:31]
 v_mfma_f32_16x16x32_bf16 a[228:231], a[8:11], a[104:107], 0
 v_mfma_f32_16x16x32_bf16 a[228:231], a[12:15], a[108:111], a[228:231]
 v_mfma_f32_16x16x32_bf16 a[236:239], a[12:15], a[100:103], 0
 s_add_u32 m0, s29, 0
 v_mfma_f32_16x16x32_bf16 a[236:239], a[8:11], a[96:99], a[236:239]
 buffer_load_dwordx4 v1, s[4:7], 0 offen  lds
 v_mfma_f32_16x16x32_bf16 v[56:59], a[16:19], a[96:99], 0
 v_mfma_f32_16x16x32_bf16 v[56:59], a[20:23], a[100:103], v[56:59]
 v_mfma_f32_16x16x32_bf16 v[48:51], a[20:23], a[108:111], 0
 v_mfma_f32_16x16x32_bf16 v[48:51], a[16:19], a[104:107], v[48:51]
 s_add_u32 m0, s29, 69632
 v_mfma_f32_16x16x32_bf16 v[40:43], a[16:19], a[112:115], 0
 buffer_load_dwordx4 v2, s[8:11], s48 offen  lds
 v_mfma_f32_16x16x32_bf16 v[40:43], a[20:23], a[116:119], v[40:43]
 v_mfma_f32_16x16x32_bf16 v[32:35], a[20:23], a[124:127], 0
 v_mfma_f32_16x16x32_bf16 v[32:35], a[16:19], a[120:123], v[32:35]
 v_mfma_f32_16x16x32_bf16 v[36:39], a[24:27], a[120:123], 0
 s_add_u32 m0, s29, 4096
 v_mfma_f32_16x16x32_bf16 v[36:39], a[28:31], a[124:127], v[36:39]
 buffer_load_dwordx4 v1, s[4:7], s41 offen  lds
 v_mfma_f32_16x16x32_bf16 v[44:47], a[28:31], a[116:119], 0
 v_mfma_f32_16x16x32_bf16 v[44:47], a[24:27], a[112:115], v[44:47]
 v_mfma_f32_16x16x32_bf16 v[52:55], a[24:27], a[104:107], 0
 v_mfma_f32_16x16x32_bf16 v[52:55], a[28:31], a[108:111], v[52:55]
 s_add_u32 m0, s29, 73728
 v_mfma_f32_16x16x32_bf16 v[60:63], a[28:31], a[100:103], 0
 buffer_load_dwordx4 v2, s[8:11], s49 offen  lds
 v_mfma_f32_16x16x32_bf16 v[60:63], a[24:27], a[96:99], v[60:63]
 v_mfma_f32_16x16x32_bf16 v[216:219], a[32:35], a[96:99], 0
 v_mfma_f32_16x16x32_bf16 v[216:219], a[36:39], a[100:103], v[216:219]
 v_mfma_f32_16x16x32_bf16 v[208:211], a[36:39], a[108:111], 0
 s_add_u32 m0, s29, 8192
 v_mfma_f32_16x16x32_bf16 v[208:211], a[32:35], a[104:107], v[208:211]
 buffer_load_dwordx4 v1, s[4:7], s42 offen  lds
 v_mfma_f32_16x16x32_bf16 v[200:203], a[32:35], a[112:115], 0
 v_mfma_f32_16x16x32_bf16 v[200:203], a[36:39], a[116:119], v[200:203]
 v_mfma_f32_16x16x32_bf16 v[192:195], a[36:39], a[124:127], 0
 v_mfma_f32_16x16x32_bf16 v[192:195], a[32:35], a[120:123], v[192:195]
 s_add_u32 m0, s29, 77824
 v_mfma_f32_16x16x32_bf16 v[196:199], a[40:43], a[120:123], 0
 buffer_load_dwordx4 v2, s[8:11], s50 offen  lds
 v_mfma_f32_16x16x32_bf16 v[196:199], a[44:47], a[124:127], v[196:199]
 v_mfma_f32_16x16x32_bf16 v[204:207], a[44:47], a[116:119], 0
 v_mfma_f32_16x16x32_bf16 v[204:207], a[40:43], a[112:115], v[204:207]
 v_mfma_f32_16x16x32_bf16 v[212:215], a[40:43], a[104:107], 0
 s_add_u32 m0, s29, 12288
 v_mfma_f32_16x16x32_bf16 v[212:215], a[44:47], a[108:111], v[212:215]
 buffer_load_dwordx4 v1, s[4:7], s43 offen  lds
 v_mfma_f32_16x16x32_bf16 v[220:223], a[44:47], a[100:103], 0
 v_mfma_f32_16x16x32_bf16 v[220:223], a[40:43], a[96:99], v[220:223]
 v_mfma_f32_16x16x32_bf16 v[248:251], a[48:51], a[96:99], 0
 v_mfma_f32_16x16x32_bf16 v[248:251], a[52:55], a[100:103], v[248:251]
 s_add_u32 m0, s29, 81920
 v_mfma_f32_16x16x32_bf16 v[240:243], a[52:55], a[108:111], 0
 buffer_load_dwordx4 v2, s[8:11], s51 offen  lds
 v_mfma_f32_16x16x32_bf16 v[240:243], a[48:51], a[104:107], v[240:243]
 v_mfma_f32_16x16x32_bf16 v[232:235], a[48:51], a[112:115], 0
 v_mfma_f32_16x16x32_bf16 v[232:235], a[52:55], a[116:119], v[232:235]
 v_mfma_f32_16x16x32_bf16 v[224:227], a[52:55], a[124:127], 0
 s_add_u32 m0, s29, 16384
 v_mfma_f32_16x16x32_bf16 v[224:227], a[48:51], a[120:123], v[224:227]
 buffer_load_dwordx4 v1, s[4:7], s44 offen  lds
 v_mfma_f32_16x16x32_bf16 v[228:231], a[56:59], a[120:123], 0
 v_mfma_f32_16x16x32_bf16 v[228:231], a[60:63], a[124:127], v[228:231]
 v_mfma_f32_16x16x32_bf16 v[236:239], a[60:63], a[116:119], 0
 v_mfma_f32_16x16x32_bf16 v[236:239], a[56:59], a[112:115], v[236:239]
 s_add_u32 m0, s29, 86016
 v_mfma_f32_16x16x32_bf16 v[244:247], a[56:59], a[104:107], 0
 s_waitcnt vmcnt(10)
 buffer_load_dwordx4 v2, s[8:11], s52 offen  lds
 v_mfma_f32_16x16x32_bf16 v[244:247], a[60:63], a[108:111], v[244:247]
 s_barrier
 ds_read_b64_tr_b16 a[0:1], v6 offset:32768
 v_mfma_f32_16x16x32_bf16 v[252:255], a[60:63], a[100:103], 0
 ds_read_b64_tr_b16 a[2:3], v6 offset:36864
 v_mfma_f32_16x16x32_bf16 v[252:255], a[56:59], a[96:99], v[252:255]
 ds_read_b128 a[96:99], v4 offset:40960
 v_mfma_f32_16x16x32_bf16 v[152:155], a[32:35], a[64:67], 0
 s_add_u32 m0, s29, 20480
 v_mfma_f32_16x16x32_bf16 v[152:155], a[36:39], a[68:71], v[152:155]
 buffer_load_dwordx4 v1, s[4:7], s45 offen  lds
 v_mfma_f32_16x16x32_bf16 v[144:147], a[36:39], a[76:79], 0
 ds_read_b64_tr_b16 a[4:5], v6 offset:49152
 v_mfma_f32_16x16x32_bf16 v[144:147], a[32:35], a[72:75], v[144:147]
 ds_read_b64_tr_b16 a[6:7], v6 offset:53248
 v_mfma_f32_16x16x32_bf16 v[136:139], a[32:35], a[80:83], 0
 ds_read_b128 a[100:103], v5 offset:40960
 v_mfma_f32_16x16x32_bf16 v[136:139], a[36:39], a[84:87], v[136:139]
 s_add_u32 m0, s29, 90112
 v_mfma_f32_16x16x32_bf16 v[128:131], a[36:39], a[92:95], 0
 buffer_load_dwordx4 v2, s[8:11], s53 offen  lds
 v_mfma_f32_16x16x32_bf16 v[128:131], a[32:35], a[88:91], v[128:131]
 ds_read_b128 a[108:111], v5 offset:43008
 v_mfma_f32_16x16x32_bf16 v[132:135], a[40:43], a[88:91], 0
 v_mfma_f32_16x16x32_bf16 v[132:135], a[44:47], a[92:95], v[132:135]
 ds_read_b128 a[104:107], v4 offset:43008
 v_mfma_f32_16x16x32_bf16 v[140:143], a[44:47], a[84:87], 0
 s_add_u32 m0, s29, 24576
 v_mfma_f32_16x16x32_bf16 v[140:143], a[40:43], a[80:83], v[140:143]
 buffer_load_dwordx4 v1, s[4:7], s46 offen  lds
 v_mfma_f32_16x16x32_bf16 v[148:151], a[40:43], a[72:75], 0
 ds_read_b128 a[112:115], v4 offset:45056
 v_mfma_f32_16x16x32_bf16 v[148:151], a[44:47], a[76:79], v[148:151]
 v_mfma_f32_16x16x32_bf16 v[156:159], a[44:47], a[68:71], 0
 ds_read_b128 a[116:119], v5 offset:45056
 v_mfma_f32_16x16x32_bf16 v[156:159], a[40:43], a[64:67], v[156:159]
 s_add_u32 m0, s29, 94208
 v_mfma_f32_16x16x32_bf16 v[184:187], a[48:51], a[64:67], 0
 buffer_load_dwordx4 v2, s[8:11], s54 offen  lds
 v_mfma_f32_16x16x32_bf16 v[184:187], a[52:55], a[68:71], v[184:187]
 ds_read_b128 a[124:127], v5 offset:47104
 v_mfma_f32_16x16x32_bf16 v[176:179], a[52:55], a[76:79], 0
 v_mfma_f32_16x16x32_bf16 v[176:179], a[48:51], a[72:75], v[176:179]
 ds_read_b128 a[120:123], v4 offset:47104
 v_mfma_f32_16x16x32_bf16 v[168:171], a[48:51], a[80:83], 0
 s_add_u32 m0, s29, 28672
 v_mfma_f32_16x16x32_bf16 v[168:171], a[52:55], a[84:87], v[168:171]
 buffer_load_dwordx4 v1, s[4:7], s47 offen  lds
 v_mfma_f32_16x16x32_bf16 v[160:163], a[52:55], a[92:95], 0
 v_mfma_f32_16x16x32_bf16 v[160:163], a[48:51], a[88:91], v[160:163]
 ds_read_b64_tr_b16 a[8:9], v7 offset:32768
 v_mfma_f32_16x16x32_bf16 v[164:167], a[56:59], a[88:91], 0
 v_mfma_f32_16x16x32_bf16 v[164:167], a[60:63], a[92:95], v[164:167]
 ds_read_b64_tr_b16 a[10:11], v7 offset:36864
 v_mfma_f32_16x16x32_bf16 v[172:175], a[60:63], a[84:87], 0
 ds_read_b64_tr_b16 a[12:13], v7 offset:49152
 v_mfma_f32_16x16x32_bf16 v[172:175], a[56:59], a[80:83], v[172:175]
 ds_read_b64_tr_b16 a[14:15], v7 offset:53248
 v_mfma_f32_16x16x32_bf16 v[180:183], a[56:59], a[72:75], 0
 ds_read_b64_tr_b16 a[16:17], v8 offset:32768
 v_mfma_f32_16x16x32_bf16 v[180:183], a[60:63], a[76:79], v[180:183]
 ds_read_b64_tr_b16 a[18:19], v8 offset:36864
 v_mfma_f32_16x16x32_bf16 v[188:191], a[60:63], a[68:71], 0
 ds_read_b64_tr_b16 a[20:21], v8 offset:49152
 v_mfma_f32_16x16x32_bf16 v[188:191], a[56:59], a[64:67], v[188:191]
 s_waitcnt lgkmcnt(8)
 ds_read_b64_tr_b16 a[22:23], v8 offset:53248
 v_add_u32 v1, 128, v1
 v_add_u32 v2, 0x80000, v2
 s_add_u32 s56, s56, s30
 buffer_load_dword a243, v14, s[36:39], s56 offen
 s_add_u32 s56, s56, s30
 buffer_load_dword a243, v14, s[36:39], s56 offen
 s_add_u32 s56, s56, s30
 s_branch L_kloop_mid
.p2align 6
L_kloop:
 v_mfma_f32_16x16x32_bf16 v[88:91], a[0:3], a[64:67], v[88:91]
 ds_read_b64_tr_b16 a[24:25], v9 offset:0
 v_mfma_f32_16x16x32_bf16 v[88:91], a[4:7], a[68:71], v[88:91]
 ds_read_b64_tr_b16 a[26:27], v9 offset:4096
 v_mfma_f32_16x16x32_bf16 v[80:83], a[4:7], a[76:79], v[80:83]
 ds_read_b64_tr_b16 a[28:29], v9 offset:16384
 v_mfma_f32_16x16x32_bf16 v[80:83], a[0:3], a[72:75], v[80:83]
 ds_read_b64_tr_b16 a[30:31], v9 offset:20480
 v_mfma_f32_16x16x32_bf16 v[72:75], a[0:3], a[80:83], v[72:75]
 ds_read_b128 a[96:99], v4 offset:8192
 v_mfma_f32_16x16x32_bf16 v[72:75], a[4:7], a[84:87], v[72:75]
 s_cmp_eq_u32 s61, s55
 s_cbranch_scc1 L_kloop_side
L_kloop_back:
 v_mfma_f32_16x16x32_bf16 v[64:67], a[4:7], a[92:95], v[64:67]
 s_waitcnt lgkmcnt(8)
 ds_read_b128 a[100:103], v5 offset:8192
 v_mfma_f32_16x16x32_bf16 v[64:67], a[0:3], a[88:91], v[64:67]
 v_mfma_f32_16x16x32_bf16 v[68:71], a[8:11], a[88:91], v[68:71]
 ds_read_b128 a[108:111], v5 offset:10240
 v_mfma_f32_16x16x32_bf16 v[68:71], a[12:15], a[92:95], v[68:71]
 v_mfma_f32_16x16x32_bf16 v[76:79], a[12:15], a[84:87], v[76:79]
 ds_read_b128 a[104:107], v4 offset:10240
 v_mfma_f32_16x16x32_bf16 v[76:79], a[8:11], a[80:83], v[76:79]
 v_mfma_f32_16x16x32_bf16 v[84:87], a[8:11], a[72:75], v[84:87]
 ds_read_b128 a[112:115], v4 offset:12288
 v_mfma_f32_16x16x32_bf16 v[84:87], a[12:15], a[76:79], v[84:87]
 v_mfma_f32_16x16x32_bf16 v[92:95], a[12:15], a[68:71], v[92:95]
 ds_read_b128 a[116:119], v5 offset:12288
 v_mfma_f32_16x16x32_bf16 v[92:95], a[8:11], a[64:67], v[92:95]
 s_waitcnt lgkmcnt(8)
 v_mfma_f32_16x16x32_bf16 v[120:123], a[16:19], a[64:67], v[120:123]
 ds_read_b128 a[124:127], v5 offset:14336
 v_mfma_f32_16x16x32_bf16 v[120:123], a[20:23], a[68:71], v[120:123]
 v_mfma_f32_16x16x32_bf16 v[112:115], a[20:23], a[76:79], v[112:115]
 ds_read_b128 a[120:123], v4 offset:14336
 v_mfma_f32_16x16x32_bf16 v[112:115], a[16:19], a[72:75], v[112:115]
 v_mfma_f32_16x16x32_bf16 v[104:107], a[16:19], a[80:83], v[104:107]
 ds_read_b64_tr_b16 a[32:33], v10 offset:0
 v_mfma_f32_16x16x32_bf16 v[104:107], a[20:23], a[84:87], v[104:107]
 ds_read_b64_tr_b16 a[34:35], v10 offset:4096
 v_mfma_f32_16x16x32_bf16 v[96:99], a[20:23], a[92:95], v[96:99]
 ds_read_b64_tr_b16 a[36:37], v10 offset:16384
 v_mfma_f32_16x16x32_bf16 v[96:99], a[16:19], a[88:91], v[96:99]
 ds_read_b64_tr_b16 a[38:39], v10 offset:20480
 v_mfma_f32_16x16x32_bf16 v[100:103], a[24:27], a[88:91], v[100:103]
 s_waitcnt lgkmcnt(8)
 ds_read_b64_tr_b16 a[40:41], v11 offset:0
 v_mfma_f32_16x16x32_bf16 v[100:103], a[28:31], a[92:95], v[100:103]
 ds_read_b64_tr_b16 a[42:43], v11 offset:4096
 v_mfma_f32_16x16x32_bf16 v[108:111], a[28:31], a[84:87], v[108:111]
 ds_read_b64_tr_b16 a[44:45], v11 offset:16384
 v_mfma_f32_16x16x32_bf16 v[108:111], a[24:27], a[80:83], v[108:111]
 ds_read_b64_tr_b16 a[46:47], v11 offset:20480
 v_mfma_f32_16x16x32_bf16 v[116:119], a[24:27], a[72:75], v[116:119]
 ds_read_b64_tr_b16 a[48:49], v12 offset:0
 v_mfma_f32_16x16x32_bf16 v[116:119], a[28:31], a[76:79], v[116:119]
 ds_read_b64_tr_b16 a[50:51], v12 offset:4096
 v_mfma_f32_16x16x32_bf16 v[124:127], a[28:31], a[68:71], v[124:127]
 ds_read_b64_tr_b16 a[52:53], v12 offset:16384
 v_mfma_f32_16x16x32_bf16 v[124:127], a[24:27], a[64:67], v[124:127]
 ds_read_b64_tr_b16 a[54:55], v12 offset:20480
 v_mfma_f32_16x16x32_bf16 a[232:235], a[0:3], a[96:99], a[232:235]
 ds_read_b64_tr_b16 a[56:57], v13 offset:0
 v_mfma_f32_16x16x32_bf16 a[232:235], a[4:7], a[100:103], a[232:235]
 ds_read_b64_tr_b16 a[58:59], v13 offset:4096
 v_mfma_f32_16x16x32_bf16 a[224:227], a[4:7], a[108:111], a[224:227]
 ds_read_b64_tr_b16 a[60:61], v13 offset:16384
 v_mfma_f32_16x16x32_bf16 a[224:227], a[0:3], a[104:107], a[224:227]
 s_waitcnt lgkmcnt(8)
 ds_read_b64_tr_b16 a[62:63], v13 offset:20480
 v_mfma_f32_16x16x32_bf16 v[24:27], a[0:3], a[112:115], v[24:27]
 v_mfma_f32_16x16x32_bf16 v[24:27], a[4:7], a[116:119], v[24:27]
 v_mfma_f32_16x16x32_bf16 v[16:19], a[4:7], a[124:127], v[16:19]
 v_mfma_f32_16x16x32_bf16 v[16:19], a[0:3], a[120:123], v[16:19]
 s_waitcnt lgkmcnt(0)
 v_mfma_f32_16x16x32_bf16 v[20:23], a[8:11], a[120:123], v[20:23]
 s_barrier
 v_mfma_f32_16x16x32_bf16 v[20:23], a[12:15], a[124:127], v[20:23]
 s_add_u32 m0, s29, 65536
 v_mfma_f32_16x16x32_bf16 v[28:31], a[12:15], a[116:119], v[28:31]
 buffer_load_dwordx4 v2, s[8:11], 0 offen  lds
 v_mfma_f32_16x16x32_bf16 v[28:31], a[8:11], a[112:115], v[28:31]
 v_mfma_f32_16x16x32_bf16 a[228:231], a[8:11], a[104:107], a[228:231]
 v_mfma_f32_16x16x32_bf16 a[228:231], a[12:15], a[108:111], a[228:231]
 v_mfma_f32_16x16x32_bf16 a[236:239], a[12:15], a[100:103], a[236:239]
 s_add_u32 m0, s29, 0
 v_mfma_f32_16x16x32_bf16 a[236:239], a[8:11], a[96:99], a[236:239]
 buffer_load_dwordx4 v1, s[4:7], 0 offen  lds
 v_mfma_f32_16x16x32_bf16 v[56:59], a[16:19], a[96:99], v[56:59]
 v_mfma_f32_16x16x32_bf16 v[56:59], a[20:23], a[100:103], v[56:59]
 v_mfma_f32_16x16x32_bf16 v[48:51], a[20:23], a[108:111], v[48:51]
 v_mfma_f32_16x16x32_bf16 v[48:51], a[16:19], a[104:107], v[48:51]
 s_add_u32 m0, s29, 69632
 v_mfma_f32_16x16x32_bf16 v[40:43], a[16:19], a[112:115], v[40:43]
 buffer_load_dwordx4 v2, s[8:11], s48 offen  lds
 v_mfma_f32_16x16x32_bf16 v[40:43], a[20:23], a[116:119], v[40:43]
 v_mfma_f32_16x16x32_bf16 v[32:35], a[20:23], a[124:127], v[32:35]
 v_mfma_f32_16x16x32_bf16 v[32:35], a[16:19], a[120:123], v[32:35]
 v_mfma_f32_16x16x32_bf16 v[36:39], a[24:27], a[120:123], v[36:39]
 s_add_u32 m0, s29, 4096
 v_mfma_f32_16x16x32_bf16 v[36:39], a[28:31], a[124:127], v[36:39]
 buffer_load_dwordx4 v1, s[4:7], s41 offen  lds
 v_mfma_f32_16x16x32_bf16 v[44:47], a[28:31], a[116:119], v[44:47]
 v_mfma_f32_16x16x32_bf16 v[44:47], a[24:27], a[112:115], v[44:47]
 v_mfma_f32_16x16x32_bf16 v[52:55], a[24:27], a[104:107], v[52:55]
 v_mfma_f32_16x16x32_bf16 v[52:55], a[28:31], a[108:111], v[52:55]
 s_add_u32 m0, s29, 73728
 v_mfma_f32_16x16x32_bf16 v[60:63], a[28:31], a[100:103], v[60:63]
 buffer_load_dwordx4 v2, s[8:11], s49 offen  lds
 v_mfma_f32_16x16x32_bf16 v[60:63], a[24:27], a[96:99], v[60:63]
 v_mfma_f32_16x16x32_bf16 v[216:219], a[32:35], a[96:99], v[216:219]
 v_mfma_f32_16x16x32_bf16 v[216:219], a[36:39], a[100:103], v[216:219]
 v_mfma_f32_16x16x32_bf16 v[208:211], a[36:39], a[108:111], v[208:211]
 s_add_u32 m0, s29, 8192
 v_mfma_f32_16x16x32_bf16 v[208:211], a[32:35], a[104:107], v[208:211]
 buffer_load_dwordx4 v1, s[4:7], s42 offen  lds
 v_mfma_f32_16x16x32_bf16 v[200:203], a[32:35], a[112:115], v[200:203]
 v_mfma_f32_16x16x32_bf16 v[200:203], a[36:39], a[116:119], v[200:203]
 v_mfma_f32_16x16x32_bf16 v[192:195], a[36:39], a[124:127], v[192:195]
 v_mfma_f32_16x16x32_bf16 v[192:195], a[32:35], a[120:123], v[192:195]
 s_add_u32 m0, s29, 77824
 v_mfma_f32_16x16x32_bf16 v[196:199], a[40:43], a[120:123], v[196:199]
 buffer_load_dwordx4 v2, s[8:11], s50 offen  lds
 v_mfma_f32_16x16x32_bf16 v[196:199], a[44:47], a[124:127], v[196:199]
 v_mfma_f32_16x16x32_bf16 v[204:207], a[44:47], a[116:119], v[204:207]
 v_mfma_f32_16x16x32_bf16 v[204:207], a[40:43], a[112:115], v[204:207]
 v_mfma_f32_16x16x32_bf16 v[212:215], a[40:43], a[104:107], v[212:215]
 s_add_u32 m0, s29, 12288
 v_mfma_f32_16x16x32_bf16 v[212:215], a[44:47], a[108:111], v[212:215]
 buffer_load_dwordx4 v1, s[4:7], s43 offen  lds
 v_mfma_f32_16x16x32_bf16 v[220:223], a[44:47], a[100:103], v[220:223]
 v_mfma_f32_16x16x32_bf16 v[220:223], a[40:43], a[96:99], v[220:223]
 v_mfma_f32_16x16x32_bf16 v[248:251], a[48:51], a[96:99], v[248:251]
 v_mfma_f32_16x16x32_bf16 v[248:251], a[52:55], a[100:103], v[248:251]
 s_add_u32 m0, s29, 81920
 v_mfma_f32_16x16x32_bf16 v[240:243], a[52:55], a[108:111], v[240:243]
 buffer_load_dwordx4 v2, s[8:11], s51 offen  lds
 v_mfma_f32_16x16x32_bf16 v[240:243], a[48:51], a[104:107], v[240:243]
 v_mfma_f32_16x16x32_bf16 v[232:235], a[48:51], a[112:115], v[232:235]
 v_mfma_f32_16x16x32_bf16 v[232:235], a[52:55], a[116:119], v[232:235]
 v_mfma_f32_16x16x32_bf16 v[224:227], a[52:55], a[124:127], v[224:227]
 s_add_u32 m0, s29, 16384
 v_mfma_f32_16x16x32_bf16 v[224:227], a[48:51], a[120:123], v[224:227]
 buffer_load_dwordx4 v1, s[4:7], s44 offen  lds
 v_mfma_f32_16x16x32_bf16 v[228:231], a[56:59], a[120:123], v[228:231]
 v_mfma_f32_16x16x32_bf16 v[228:231], a[60:63], a[124:127], v[228:231]
 v_mfma_f32_16x16x32_bf16 v[236:239], a[60:63], a[116:119], v[236:239]
 v_mfma_f32_16x16x32_bf16 v[236:239], a[56:59], a[112:115], v[236:239]
 s_add_u32 m0, s29, 86016
 v_mfma_f32_16x16x32_bf16 v[244:247], a[56:59], a[104:107], v[244:247]
 s_waitcnt vmcnt(11)
 buffer_load_dwordx4 v2, s[8:11], s52 offen  lds
 v_mfma_f32_16x16x32_bf16 v[244:247], a[60:63], a[108:111], v[244:247]
 s_barrier
 ds_read_b64_tr_b16 a[0:1], v6 offset:32768
 v_mfma_f32_16x16x32_bf16 v[252:255], a[60:63], a[100:103], v[252:255]
 ds_read_b64_tr_b16 a[2:3], v6 offset:36864
 v_mfma_f32_16x16x32_bf16 v[252:255], a[56:59], a[96:99], v[252:255]
 ds_read_b128 a[96:99], v4 offset:40960
 v_mfma_f32_16x16x32_bf16 v[152:155], a[32:35], a[64:67], v[152:155]
 s_add_u32 m0, s29, 20480
 v_mfma_f32_16x16x32_bf16 v[152:155], a[36:39], a[68:71], v[152:155]
 buffer_load_dwordx4 v1, s[4:7], s45 offen  lds
 v_mfma_f32_16x16x32_bf16 v[144:147], a[36:39], a[76:79], v[144:147]
 ds_read_b64_tr_b16 a[4:5], v6 offset:49152
 v_mfma_f32_16x16x32_bf16 v[144:147], a[32:35], a[72:75], v[144:147]
 ds_read_b64_tr_b16 a[6:7], v6 offset:53248
 v_mfma_f32_16x16x32_bf16 v[136:139], a[32:35], a[80:83], v[136:139]
 ds_read_b128 a[100:103], v5 offset:40960
 v_mfma_f32_16x16x32_bf16 v[136:139], a[36:39], a[84:87], v[136:139]
 s_add_u32 m0, s29, 90112
 v_mfma_f32_16x16x32_bf16 v[128:131], a[36:39], a[92:95], v[128:131]
 buffer_load_dwordx4 v2, s[8:11], s53 offen  lds
 v_mfma_f32_16x16x32_bf16 v[128:131], a[32:35], a[88:91], v[128:131]
 ds_read_b128 a[108:111], v5 offset:43008
 v_mfma_f32_16x16x32_bf16 v[132:135], a[40:43], a[88:91], v[132:135]
 v_mfma_f32_16x16x32_bf16 v[132:135], a[44:47], a[92:95], v[132:135]
 ds_read_b128 a[104:107], v4 offset:43008
 v_mfma_f32_16x16x32_bf16 v[140:143], a[44:47], a[84:87], v[140:143]
 s_add_u32 m0, s29, 24576
 v_mfma_f32_16x16x32_bf16 v[140:143], a[40:43], a[80:83], v[140:143]
 buffer_load_dwordx4 v1, s[4:7], s46 offen  lds
 v_mfma_f32_16x16x32_bf16 v[148:151], a[40:43], a[72:75], v[148:151]
 ds_read_b128 a[112:115], v4 offset:45056
 v_mfma_f32_16x16x32_bf16 v[148:151], a[44:47], a[76:79], v[148:151]
 v_mfma_f32_16x16x32_bf16 v[156:159], a[44:47], a[68:71], v[156:159]
 ds_read_b128 a[116:119], v5 offset:45056
 v_mfma_f32_16x16x32_bf16 v[156:159], a[40:43], a[64:67], v[156:159]
 s_add_u32 m0, s29, 94208
 v_mfma_f32_16x16x32_bf16 v[184:187], a[48:51], a[64:67], v[184:187]
 buffer_load_dwordx4 v2, s[8:11], s54 offen  lds
 v_mfma_f32_16x16x32_bf16 v[184:187], a[52:55], a[68:71], v[184:187]
 ds_read_b128 a[124:127], v5 offset:47104
 v_mfma_f32_16x16x32_bf16 v[176:179], a[52:55], a[76:79], v[176:179]
 v_mfma_f32_16x16x32_bf16 v[176:179], a[48:51], a[72:75], v[176:179]
 ds_read_b128 a[120:123], v4 offset:47104
 v_mfma_f32_16x16x32_bf16 v[168:171], a[48:51], a[80:83], v[168:171]
 s_add_u32 m0, s29, 28672
 v_mfma_f32_16x16x32_bf16 v[168:171], a[52:55], a[84:87], v[168:171]
 buffer_load_dwordx4 v1, s[4:7], s47 offen  lds
 v_mfma_f32_16x16x32_bf16 v[160:163], a[52:55], a[92:95], v[160:163]
 v_add_u32 v1, 128, v1
 v_add_u32 v2, 0x80000, v2
 v_mfma_f32_16x16x32_bf16 v[160:163], a[48:51], a[88:91], v[160:163]
 ds_read_b64_tr_b16 a[8:9], v7 offset:32768
 v_mfma_f32_16x16x32_bf16 v[164:167], a[56:59], a[88:91], v[164:167]
 buffer_load_dword a243, v14, s[36:39], s56 offen
 v_mfma_f32_16x16x32_bf16 v[164:167], a[60:63], a[92:95], v[164:167]
 s_add_u32 s56, s56, s30
 ds_read_b64_tr_b16 a[10:11], v7 offset:36864
 v_mfma_f32_16x16x32_bf16 v[172:175], a[60:63], a[84:87], v[172:175]
 ds_read_b64_tr_b16 a[12:13], v7 offset:49152
 v_mfma_f32_16x16x32_bf16 v[172:175], a[56:59], a[80:83], v[172:175]
 ds_read_b64_tr_b16 a[14:15], v7 offset:53248
 v_mfma_f32_16x16x32_bf16 v[180:183], a[56:59], a[72:75], v[180:183]
 ds_read_b64_tr_b16 a[16:17], v8 offset:32768
 v_mfma_f32_16x16x32_bf16 v[180:183], a[60:63], a[76:79], v[180:183]
 ds_read_b64_tr_b16 a[18:19], v8 offset:36864
 v_mfma_f32_16x16x32_bf16 v[188:191], a[60:63], a[68:71], v[188:191]
 ds_read_b64_tr_b16 a[20:21], v8 offset:49152
 v_mfma_f32_16x16x32_bf16 v[188:191], a[56:59], a[64:67], v[188:191]
 s_waitcnt lgkmcnt(8)
 ds_read_b64_tr_b16 a[22:23], v8 offset:53248
L_kloop_mid:
 v_mfma_f32_16x16x32_bf16 a[232:235], a[0:3], a[96:99], a[232:235]
 ds_read_b64_tr_b16 a[24:25], v9 offset:32768
 v_mfma_f32_16x16x32_bf16 a[232:235], a[4:7], a[100:103], a[232:235]
 ds_read_b64_tr_b16 a[26:27], v9 offset:36864
 v_mfma_f32_16x16x32_bf16 a[224:227], a[4:7], a[108:111], a[224:227]
 ds_read_b64_tr_b16 a[28:29], v9 offset:49152
 v_mfma_f32_16x16x32_bf16 a[224:227], a[0:3], a[104:107], a[224:227]
 ds_read_b64_tr_b16 a[30:31], v9 offset:53248
 v_mfma_f32_16x16x32_bf16 v[24:27], a[0:3], a[112:115], v[24:27]
 ds_read_b128 a[64:67], v4 offset:32768
 v_mfma_f32_16x16x32_bf16 v[24:27], a[4:7], a[116:119], v[24:27]
 v_mfma_f32_16x16x32_bf16 v[16:19], a[4:7], a[124:127], v[16:19]
 s_waitcnt lgkmcnt(8)
 ds_read_b128 a[68:71], v5 offset:32768
 v_mfma_f32_16x16x32_bf16 v[16:19], a[0:3], a[120:123], v[16:19]
 v_mfma_f32_16x16x32_bf16 v[20:23], a[8:11], a[120:123], v[20:23]
 ds_read_b128 a[76:79], v5 offset:34816
 v_mfma_f32_16x16x32_bf16 v[20:23], a[12:15], a[124:127], v[20:23]
 v_mfma_f32_16x16x32_bf16 v[28:31], a[12:15], a[116:119], v[28:31]
 ds_read_b128 a[72:75], v4 offset:34816
 v_mfma_f32_16x16x32_bf16 v[28:31], a[8:11], a[112:115], v[28:31]
 v_mfma_f32_16x16x32_bf16 a[228:231], a[8:11], a[104:107], a[228:231]
 ds_read_b128 a[80:83], v4 offset:36864
 v_mfma_f32_16x16x32_bf16 a[228:231], a[12:15], a[108:111], a[228:231]
 v_mfma_f32_16x16x32_bf16 a[236:239], a[12:15], a[100:103], a[236:239]
 ds_read_b128 a[84:87], v5 offset:36864
 v_mfma_f32_16x16x32_bf16 a[236:239], a[8:11], a[96:99], a[236:239]
 s_waitcnt lgkmcnt(8)
 v_mfma_f32_16x16x32_bf16 v[56:59], a[16:19], a[96:99], v[56:59]
 ds_read_b128 a[92:95], v5 offset:38912
 v_mfma_f32_16x16x32_bf16 v[56:59], a[20:23], a[100:103], v[56:59]
 v_mfma_f32_16x16x32_bf16 v[48:51], a[20:23], a[108:111], v[48:51]
 ds_read_b128 a[88:91], v4 offset:38912
 v_mfma_f32_16x16x32_bf16 v[48:51], a[16:19], a[104:107], v[48:51]
 v_mfma_f32_16x16x32_bf16 v[40:43], a[16:19], a[112:115], v[40:43]
 ds_read_b64_tr_b16 a[32:33], v10 offset:32768
 v_mfma_f32_16x16x32_bf16 v[40:43], a[20:23], a[116:119], v[40:43]
 ds_read_b64_tr_b16 a[34:35], v10 offset:36864
 v_mfma_f32_16x16x32_bf16 v[32:35], a[20:23], a[124:127], v[32:35]
 ds_read_b64_tr_b16 a[36:37], v10 offset:49152
 v_mfma_f32_16x16x32_bf16 v[32:35], a[16:19], a[120:123], v[32:35]
 ds_read_b64_tr_b16 a[38:39], v10 offset:53248
 v_mfma_f32_16x16x32_bf16 v[36:39], a[24:27], a[120:123], v[36:39]
 s_waitcnt lgkmcnt(8)
 ds_read_b64_tr_b16 a[40:41], v11 offset:32768
 v_mfma_f32_16x16x32_bf16 v[36:39], a[28:31], a[124:127], v[36:39]
 ds_read_b64_tr_b16 a[42:43], v11 offset:36864
 v_mfma_f32_16x16x32_bf16 v[44:47], a[28:31], a[116:119], v[44:47]
 ds_read_b64_tr_b16 a[44:45], v11 offset:49152
 v_mfma_f32_16x16x32_bf16 v[44:47], a[24:27], a[112:115], v[44:47]
 ds_read_b64_tr_b16 a[46:47], v11 offset:53248
 v_mfma_f32_16x16x32_bf16 v[52:55], a[24:27], a[104:107], v[52:55]
 ds_read_b64_tr_b16 a[48:49], v12 offset:32768
 v_mfma_f32_16x16x32_bf16 v[52:55], a[28:31], a[108:111], v[52:55]
 ds_read_b64_tr_b16 a[50:51], v12 offset:36864
 v_mfma_f32_16x16x32_bf16 v[60:63], a[28:31], a[100:103], v[60:63]
 ds_read_b64_tr_b16 a[52:53], v12 offset:49152
 v_mfma_f32_16x16x32_bf16 v[60:63], a[24:27], a[96:99], v[60:63]
 ds_read_b64_tr_b16 a[54:55], v12 offset:53248
 v_mfma_f32_16x16x32_bf16 v[88:91], a[0:3], a[64:67], v[88:91]
 ds_read_b64_tr_b16 a[56:57], v13 offset:32768
 v_mfma_f32_16x16x32_bf16 v[88:91], a[4:7], a[68:71], v[88:91]
 ds_read_b64_tr_b16 a[58:59], v13 offset:36864
 v_mfma_f32_16x16x32_bf16 v[80:83], a[4:7], a[76:79], v[80:83]
 ds_read_b64_tr_b16 a[60:61], v13 offset:49152
 v_mfma_f32_16x16x32_bf16 v[80:83], a[0:3], a[72:75], v[80:83]
 s_waitcnt lgkmcnt(8)
 ds_read_b64_tr_b16 a[62:63], v13 offset:53248
 v_mfma_f32_16x16x32_bf16 v[72:75], a[0:3], a[80:83], v[72:75]
 v_mfma_f32_16x16x32_bf16 v[72:75], a[4:7], a[84:87], v[72:75]
 v_mfma_f32_16x16x32_bf16 v[64:67], a[4:7], a[92:95], v[64:67]
 v_mfma_f32_16x16x32_bf16 v[64:67], a[0:3], a[88:91], v[64:67]
 s_waitcnt lgkmcnt(0)
 v_mfma_f32_16x16x32_bf16 v[68:71], a[8:11], a[88:91], v[68:71]
 s_barrier
 v_mfma_f32_16x16x32_bf16 v[68:71], a[12:15], a[92:95], v[68:71]
 s_add_u32 m0, s29, 98304
 v_mfma_f32_16x16x32_bf16 v[76:79], a[12:15], a[84:87], v[76:79]
 buffer_load_dwordx4 v2, s[8:11], 0 offen  lds
 v_mfma_f32_16x16x32_bf16 v[76:79], a[8:11], a[80:83], v[76:79]
 v_mfma_f32_16x16x32_bf16 v[84:87], a[8:11], a[72:75], v[84:87]
 v_mfma_f32_16x16x32_bf16 v[84:87], a[12:15], a[76:79], v[84:87]
 v_mfma_f32_16x16x32_bf16 v[92:95], a[12:15], a[68:71], v[92:95]
 s_add_u32 m0, s29, 32768
 v_mfma_f32_16x16x32_bf16 v[92:95], a[8:11], a[64:67], v[92:95]
 buffer_load_dwordx4 v1, s[4:7], 0 offen  lds
 v_mfma_f32_16x16x32_bf16 v[120:123], a[16:19], a[64:67], v[120:123]
 v_mfma_f32_16x16x32_bf16 v[120:123], a[20:23], a[68:71], v[120:123]
 v_mfma_f32_16x16x32_bf16 v[112:115], a[20:23], a[76:79], v[112:115]
 v_mfma_f32_16x16x32_bf16 v[112:115], a[16:19], a[72:75], v[112:115]
 s_add_u32 m0, s29, 102400
 v_mfma_f32_16x16x32_bf16 v[104:107], a[16:19], a[80:83], v[104:107]
 buffer_load_dwordx4 v2, s[8:11], s48 offen  lds
 v_mfma_f32_16x16x32_bf16 v[104:107], a[20:23], a[84:87], v[104:107]
 v_mfma_f32_16x16x32_bf16 v[96:99], a[20:23], a[92:95], v[96:99]
 v_mfma_f32_16x16x32_bf16 v[96:99], a[16:19], a[88:91], v[96:99]
 v_mfma_f32_16x16x32_bf16 v[100:103], a[24:27], a[88:91], v[100:103]
 s_add_u32 m0, s29, 36864
 v_mfma_f32_16x16x32_bf16 v[100:103], a[28:31], a[92:95], v[100:103]
 buffer_load_dwordx4 v1, s[4:7], s41 offen  lds
 v_mfma_f32_16x16x32_bf16 v[108:111], a[28:31], a[84:87], v[108:111]
 v_mfma_f32_16x16x32_bf16 v[108:111], a[24:27], a[80:83], v[108:111]
 v_mfma_f32_16x16x32_bf16 v[116:119], a[24:27], a[72:75], v[116:119]
 v_mfma_f32_16x16x32_bf16 v[116:119], a[28:31], a[76:79], v[116:119]
 s_add_u32 m0, s29, 106496
 v_mfma_f32_16x16x32_bf16 v[124:127], a[28:31], a[68:71], v[124:127]
 buffer_load_dwordx4 v2, s[8:11], s49 offen  lds
 v_mfma_f32_16x16x32_bf16 v[124:127], a[24:27], a[64:67], v[124:127]
 v_mfma_f32_16x16x32_bf16 v[152:155], a[32:35], a[64:67], v[152:155]
 v_mfma_f32_16x16x32_bf16 v[152:155], a[36:39], a[68:71], v[152:155]
 v_mfma_f32_16x16x32_bf16 v[144:147], a[36:39], a[76:79], v[144:147]
 s_add_u32 m0, s29, 40960
 v_mfma_f32_16x16x32_bf16 v[144:147], a[32:35], a[72:75], v[144:147]
 buffer_load_dwordx4 v1, s[4:7], s42 offen  lds
 v_mfma_f32_16x16x32_bf16 v[136:139], a[32:35], a[80:83], v[136:139]
 v_mfma_f32_16x16x32_bf16 v[136:139], a[36:39], a[84:87], v[136:139]
 v_mfma_f32_16x16x32_bf16 v[128:131], a[36:39], a[92:95], v[128:131]
 v_mfma_f32_16x16x32_bf16 v[128:131], a[32:35], a[88:91], v[128:131]
 s_add_u32 m0, s29, 110592
 v_mfma_f32_16x16x32_bf16 v[132:135], a[40:43], a[88:91], v[132:135]
 buffer_load_dwordx4 v2, s[8:11], s50 offen  lds
 v_mfma_f32_16x16x32_bf16 v[132:135], a[44:47], a[92:95], v[132:135]
 v_mfma_f32_16x16x32_bf16 v[140:143], a[44:47], a[84:87], v[140:143]
 v_mfma_f32_16x16x32_bf16 v[140:143], a[40:43], a[80:83], v[140:143]
 v_mfma_f32_16x16x32_bf16 v[148:151], a[40:43], a[72:75], v[148:151]
 s_add_u32 m0, s29, 45056
 v_mfma_f32_16x16x32_bf16 v[148:151], a[44:47], a[76:79], v[148:151]
 buffer_load_dwordx4 v1, s[4:7], s43 offen  lds
 v_mfma_f32_16x16x32_bf16 v[156:159], a[44:47], a[68:71], v[156:159]
 v_mfma_f32_16x16x32_bf16 v[156:159], a[40:43], a[64:67], v[156:159]
 v_mfma_f32_16x16x32_bf16 v[184:187], a[48:51], a[64:67], v[184:187]
 v_mfma_f32_16x16x32_bf16 v[184:187], a[52:55], a[68:71], v[184:187]
 s_add_u32 m0, s29, 114688
 v_mfma_f32_16x16x32_bf16 v[176:179], a[52:55], a[76:79], v[176:179]
 buffer_load_dwordx4 v2, s[8:11], s51 offen  lds
 v_mfma_f32_16x16x32_bf16 v[176:179], a[48:51], a[72:75], v[176:179]
 v_mfma_f32_16x16x32_bf16 v[168:171], a[48:51], a[80:83], v[168:171]
 v_mfma_f32_16x16x32_bf16 v[168:171], a[52:55], a[84:87], v[168:171]
 v_mfma_f32_16x16x32_bf16 v[160:163], a[52:55], a[92:95], v[160:163]
 s_add_u32 m0, s29, 49152
 v_mfma_f32_16x16x32_bf16 v[160:163], a[48:51], a[88:91], v[160:163]
 buffer_load_dwordx4 v1, s[4:7], s44 offen  lds
 v_mfma_f32_16x16x32_bf16 v[164:167], a[56:59], a[88:91], v[164:167]
 v_mfma_f32_16x16x32_bf16 v[164:167], a[60:63], a[92:95], v[164:167]
 v_mfma_f32_16x16x32_bf16 v[172:175], a[60:63], a[84:87], v[172:175]
 v_mfma_f32_16x16x32_bf16 v[172:175], a[56:59], a[80:83], v[172:175]
 s_add_u32 m0, s29, 118784
 v_mfma_f32_16x16x32_bf16 v[180:183], a[56:59], a[72:75], v[180:183]
 s_waitcnt vmcnt(11)
 buffer_load_dwordx4 v2, s[8:11], s52 offen  lds
 v_mfma_f32_16x16x32_bf16 v[180:183], a[60:63], a[76:79], v[180:183]
 s_barrier
 ds_read_b64_tr_b16 a[0:1], v6 offset:0
 v_mfma_f32_16x16x32_bf16 v[188:191], a[60:63], a[68:71], v[188:191]
 ds_read_b64_tr_b16 a[2:3], v6 offset:4096
 v_mfma_f32_16x16x32_bf16 v[188:191], a[56:59], a[64:67], v[188:191]
 ds_read_b128 a[64:67], v4 offset:0
 v_mfma_f32_16x16x32_bf16 v[216:219], a[32:35], a[96:99], v[216:219]
 s_add_u32 m0, s29, 53248
 v_mfma_f32_16x16x32_bf16 v[216:219], a[36:39], a[100:103], v[216:219]
 buffer_load_dwordx4 v1, s[4:7], s45 offen  lds
 v_mfma_f32_16x16x32_bf16 v[208:211], a[36:39], a[108:111], v[208:211]
 ds_read_b64_tr_b16 a[4:5], v6 offset:16384
 v_mfma_f32_16x16x32_bf16 v[208:211], a[32:35], a[104:107], v[208:211]
 ds_read_b64_tr_b16 a[6:7], v6 offset:20480
 v_mfma_f32_16x16x32_bf16 v[200:203], a[32:35], a[112:115], v[200:203]
 ds_read_b128 a[68:71], v5 offset:0
 v_mfma_f32_16x16x32_bf16 v[200:203], a[36:39], a[116:119], v[200:203]
 s_add_u32 m0, s29, 122880
 v_mfma_f32_16x16x32_bf16 v[192:195], a[36:39], a[124:127], v[192:195]
 buffer_load_dwordx4 v2, s[8:11], s53 offen  lds
 v_mfma_f32_16x16x32_bf16 v[192:195], a[32:35], a[120:123], v[192:195]
 ds_read_b128 a[76:79], v5 offset:2048
 v_mfma_f32_16x16x32_bf16 v[196:199], a[40:43], a[120:123], v[196:199]
 v_mfma_f32_16x16x32_bf16 v[196:199], a[44:47], a[124:127], v[196:199]
 ds_read_b128 a[72:75], v4 offset:2048
 v_mfma_f32_16x16x32_bf16 v[204:207], a[44:47], a[116:119], v[204:207]
 s_add_u32 m0, s29, 57344
 v_mfma_f32_16x16x32_bf16 v[204:207], a[40:43], a[112:115], v[204:207]
 buffer_load_dwordx4 v1, s[4:7], s46 offen  lds
 v_mfma_f32_16x16x32_bf16 v[212:215], a[40:43], a[104:107], v[212:215]
 ds_read_b128 a[80:83], v4 offset:4096
 v_mfma_f32_16x16x32_bf16 v[212:215], a[44:47], a[108:111], v[212:215]
 v_mfma_f32_16x16x32_bf16 v[220:223], a[44:47], a[100:103], v[220:223]
 ds_read_b128 a[84:87], v5 offset:4096
 v_mfma_f32_16x16x32_bf16 v[220:223], a[40:43], a[96:99], v[220:223]
 s_add_u32 m0, s29, 126976
 v_mfma_f32_16x16x32_bf16 v[248:251], a[48:51], a[96:99], v[248:251]
 buffer_load_dwordx4 v2, s[8:11], s54 offen  lds
 v_mfma_f32_16x16x32_bf16 v[248:251], a[52:55], a[100:103], v[248:251]
 ds_read_b128 a[92:95], v5 offset:6144
 v_mfma_f32_16x16x32_bf16 v[240:243], a[52:55], a[108:111], v[240:243]
 v_mfma_f32_16x16x32_bf16 v[240:243], a[48:51], a[104:107], v[240:243]
 ds_read_b128 a[88:91], v4 offset:6144
 v_mfma_f32_16x16x32_bf16 v[232:235], a[48:51], a[112:115], v[232:235]
 s_add_u32 m0, s29, 61440
 v_mfma_f32_16x16x32_bf16 v[232:235], a[52:55], a[116:119], v[232:235]
 buffer_load_dwordx4 v1, s[4:7], s47 offen  lds
 v_mfma_f32_16x16x32_bf16 v[224:227], a[52:55], a[124:127], v[224:227]
 v_add_u32 v1, 128, v1
 v_add_u32 v2, 0x80000, v2
 v_mfma_f32_16x16x32_bf16 v[224:227], a[48:51], a[120:123], v[224:227]
 ds_read_b64_tr_b16 a[8:9], v7 offset:0
 v_mfma_f32_16x16x32_bf16 v[228:231], a[56:59], a[120:123], v[228:231]
 buffer_load_dword a243, v14, s[36:39], s56 offen
 v_mfma_f32_16x16x32_bf16 v[228:231], a[60:63], a[124:127], v[228:231]
 s_add_u32 s56, s56, s30
 ds_read_b64_tr_b16 a[10:11], v7 offset:4096
 v_mfma_f32_16x16x32_bf16 v[236:239], a[60:63], a[116:119], v[236:239]
 ds_read_b64_tr_b16 a[12:13], v7 offset:16384
 v_mfma_f32_16x16x32_bf16 v[236:239], a[56:59], a[112:115], v[236:239]
 ds_read_b64_tr_b16 a[14:15], v7 offset:20480
 v_mfma_f32_16x16x32_bf16 v[244:247], a[56:59], a[104:107], v[244:247]
 ds_read_b64_tr_b16 a[16:17], v8 offset:0
 v_mfma_f32_16x16x32_bf16 v[244:247], a[60:63], a[108:111], v[244:247]
 ds_read_b64_tr_b16 a[18:19], v8 offset:4096
 v_mfma_f32_16x16x32_bf16 v[252:255], a[60:63], a[100:103], v[252:255]
 s_add_u32 s61, s61, 1
 ds_read_b64_tr_b16 a[20:21], v8 offset:16384
 v_mfma_f32_16x16x32_bf16 v[252:255], a[56:59], a[96:99], v[252:255]
 s_waitcnt lgkmcnt(8)
 ds_read_b64_tr_b16 a[22:23], v8 offset:20480
 s_cmp_lt_u32 s61, 6
 s_cbranch_scc1 L_kloop
 v_mfma_f32_16x16x32_bf16 v[88:91], a[0:3], a[64:67], v[88:91]
 ds_read_b64_tr_b16 a[24:25], v9 offset:0
 v_accvgpr_read_b32 v15, a240
 v_mfma_f32_16x16x32_bf16 v[88:91], a[4:7], a[68:71], v[88:91]
 ds_read_b64_tr_b16 a[26:27], v9 offset:4096
 v_accvgpr_read_b32 v14, a242
 v_mfma_f32_16x16x32_bf16 v[80:83], a[4:7], a[76:79], v[80:83]
 s_waitcnt lgkmcnt(12)
 ds_read_b64_tr_b16 a[28:29], v9 offset:16384
 v_xor_b32 v3, 64, v14
 v_mfma_f32_16x16x32_bf16 v[80:83], a[0:3], a[72:75], v[80:83]
 ds_read_b64_tr_b16 a[30:31], v9 offset:20480
 v_mfma_f32_16x16x32_bf16 v[72:75], a[0:3], a[80:83], v[72:75]
 s_add_u32 m0, s33, 0x0
 ds_read_b128 a[96:99], v4 offset:8192
 v_mfma_f32_16x16x32_bf16 v[72:75], a[4:7], a[84:87], v[72:75]
 s_waitcnt lgkmcnt(11)
 v_mfma_f32_16x16x32_bf16 v[64:67], a[4:7], a[92:95], v[64:67]
 ds_read_b128 a[100:103], v5 offset:8192
 buffer_load_dwordx4 v15, s[20:23], 0 offen offset:0 lds
 v_mfma_f32_16x16x32_bf16 v[64:67], a[0:3], a[88:91], v[64:67]
 v_mfma_f32_16x16x32_bf16 v[68:71], a[8:11], a[88:91], v[68:71]
 s_waitcnt lgkmcnt(10)
 ds_read_b128 a[108:111], v5 offset:10240
 v_mfma_f32_16x16x32_bf16 v[68:71], a[12:15], a[92:95], v[68:71]
 s_add_u32 m0, s33, 0x80
 v_mfma_f32_16x16x32_bf16 v[76:79], a[12:15], a[84:87], v[76:79]
 ds_read_b128 a[104:107], v4 offset:10240
 buffer_load_dwordx4 v15, s[20:23], 0 offen offset:896 lds
 v_mfma_f32_16x16x32_bf16 v[76:79], a[8:11], a[80:83], v[76:79]
 v_mfma_f32_16x16x32_bf16 v[84:87], a[8:11], a[72:75], v[84:87]
 ds_read_b128 a[112:115], v4 offset:12288
 v_mfma_f32_16x16x32_bf16 v[84:87], a[12:15], a[76:79], v[84:87]
 s_add_u32 m0, s33, 0x800
 v_mfma_f32_16x16x32_bf16 v[92:95], a[12:15], a[68:71], v[92:95]
 ds_read_b128 a[116:119], v5 offset:12288
 buffer_load_dwordx4 v15, s[20:23], s57 offen offset:0 lds
 v_mfma_f32_16x16x32_bf16 v[92:95], a[8:11], a[64:67], v[92:95]
 s_waitcnt lgkmcnt(10)
 v_mfma_f32_16x16x32_bf16 v[120:123], a[16:19], a[64:67], v[120:123]
 ds_read_b128 a[124:127], v5 offset:14336
 v_mfma_f32_16x16x32_bf16 v[120:123], a[20:23], a[68:71], v[120:123]
 s_add_u32 m0, s33, 0x880
 v_mfma_f32_16x16x32_bf16 v[112:115], a[20:23], a[76:79], v[112:115]
 ds_read_b128 a[120:123], v4 offset:14336
 buffer_load_dwordx4 v15, s[20:23], s57 offen offset:896 lds
 v_mfma_f32_16x16x32_bf16 v[112:115], a[16:19], a[72:75], v[112:115]
 v_mfma_f32_16x16x32_bf16 v[104:107], a[16:19], a[80:83], v[104:107]
 ds_read_b64_tr_b16 a[32:33], v10 offset:0
 v_mfma_f32_16x16x32_bf16 v[104:107], a[20:23], a[84:87], v[104:107]
 s_add_u32 m0, s33, 0xf80
 ds_read_b64_tr_b16 a[34:35], v10 offset:4096
 v_mfma_f32_16x16x32_bf16 v[96:99], a[20:23], a[92:95], v[96:99]
 ds_read_b64_tr_b16 a[36:37], v10 offset:16384
 buffer_load_dwordx4 v15, s[20:23], 0 offen offset:128 lds
 v_mfma_f32_16x16x32_bf16 v[96:99], a[16:19], a[88:91], v[96:99]
 s_waitcnt lgkmcnt(11)
 ds_read_b64_tr_b16 a[38:39], v10 offset:20480
 v_mfma_f32_16x16x32_bf16 v[100:103], a[24:27], a[88:91], v[100:103]
 ds_read_b64_tr_b16 a[40:41], v11 offset:0
 v_mfma_f32_16x16x32_bf16 v[100:103], a[28:31], a[92:95], v[100:103]
 s_add_u32 m0, s33, 0x1000
 ds_read_b64_tr_b16 a[42:43], v11 offset:4096
 v_mfma_f32_16x16x32_bf16 v[108:111], a[28:31], a[84:87], v[108:111]
 ds_read_b64_tr_b16 a[44:45], v11 offset:16384
 buffer_load_dwordx4 v15, s[20:23], 0 offen offset:1024 lds
 v_mfma_f32_16x16x32_bf16 v[108:111], a[24:27], a[80:83], v[108:111]
 ds_read_b64_tr_b16 a[46:47], v11 offset:20480
 v_mfma_f32_16x16x32_bf16 v[116:119], a[24:27], a[72:75], v[116:119]
 ds_read_b64_tr_b16 a[48:49], v12 offset:0
 v_mfma_f32_16x16x32_bf16 v[116:119], a[28:31], a[76:79], v[116:119]
 s_add_u32 m0, s33, 0x1780
 ds_read_b64_tr_b16 a[50:51], v12 offset:4096
 v_mfma_f32_16x16x32_bf16 v[124:127], a[28:31], a[68:71], v[124:127]
 ds_read_b64_tr_b16 a[52:53], v12 offset:16384
 buffer_load_dwordx4 v15, s[20:23], s57 offen offset:128 lds
 v_mfma_f32_16x16x32_bf16 v[124:127], a[24:27], a[64:67], v[124:127]
 s_waitcnt lgkmcnt(15)
 ds_read_b64_tr_b16 a[54:55], v12 offset:20480
 v_mfma_f32_16x16x32_bf16 a[232:235], a[0:3], a[96:99], a[232:235]
 ds_read_b64_tr_b16 a[56:57], v13 offset:0
 v_mfma_f32_16x16x32_bf16 a[232:235], a[4:7], a[100:103], a[232:235]
 s_add_u32 m0, s33, 0x1800
 ds_read_b64_tr_b16 a[58:59], v13 offset:4096
 v_mfma_f32_16x16x32_bf16 a[224:227], a[4:7], a[108:111], a[224:227]
 ds_read_b64_tr_b16 a[60:61], v13 offset:16384
 buffer_load_dwordx4 v15, s[20:23], s57 offen offset:1024 lds
 v_mfma_f32_16x16x32_bf16 a[224:227], a[0:3], a[104:107], a[224:227]
 s_waitcnt lgkmcnt(15)
 ds_read_b64_tr_b16 a[62:63], v13 offset:20480
 v_mfma_f32_16x16x32_bf16 v[24:27], a[0:3], a[112:115], v[24:27]
 v_mfma_f32_16x16x32_bf16 v[24:27], a[4:7], a[116:119], v[24:27]
 v_mfma_f32_16x16x32_bf16 v[16:19], a[4:7], a[124:127], v[16:19]
 v_mfma_f32_16x16x32_bf16 v[16:19], a[0:3], a[120:123], v[16:19]
 s_waitcnt lgkmcnt(0)
 v_mfma_f32_16x16x32_bf16 v[20:23], a[8:11], a[120:123], v[20:23]
 s_barrier
 v_mfma_f32_16x16x32_bf16 v[20:23], a[12:15], a[124:127], v[20:23]
 s_add_u32 m0, s29, 65536
 v_mfma_f32_16x16x32_bf16 v[28:31], a[12:15], a[116:119], v[28:31]
 buffer_load_dwordx4 v2, s[8:11], 0 offen  lds
 v_mfma_f32_16x16x32_bf16 v[28:31], a[8:11], a[112:115], v[28:31]
 v_mfma_f32_16x16x32_bf16 a[228:231], a[8:11], a[104:107], a[228:231]
 v_mfma_f32_16x16x32_bf16 a[228:231], a[12:15], a[108:111], a[228:231]
 v_mfma_f32_16x16x32_bf16 a[236:239], a[12:15], a[100:103], a[236:239]
 s_add_u32 m0, s29, 0
 v_mfma_f32_16x16x32_bf16 a[236:239], a[8:11], a[96:99], a[236:239]
 buffer_load_dwordx4 v1, s[4:7], 0 offen  lds
 v_mfma_f32_16x16x32_bf16 v[56:59], a[16:19], a[96:99], v[56:59]
 v_mfma_f32_16x16x32_bf16 v[56:59], a[20:23], a[100:103], v[56:59]
 v_mfma_f32_16x16x32_bf16 v[48:51], a[20:23], a[108:111], v[48:51]
 v_mfma_f32_16x16x32_bf16 v[48:51], a[16:19], a[104:107], v[48:51]
 s_add_u32 m0, s29, 69632
 v_mfma_f32_16x16x32_bf16 v[40:43], a[16:19], a[112:115], v[40:43]
 buffer_load_dwordx4 v2, s[8:11], s48 offen  lds
 v_mfma_f32_16x16x32_bf16 v[40:43], a[20:23], a[116:119], v[40:43]
 v_mfma_f32_16x16x32_bf16 v[32:35], a[20:23], a[124:127], v[32:35]
 v_mfma_f32_16x16x32_bf16 v[32:35], a[16:19], a[120:123], v[32:35]
 v_mfma_f32_16x16x32_bf16 v[36:39], a[24:27], a[120:123], v[36:39]
 s_add_u32 m0, s29, 4096
 v_mfma_f32_16x16x32_bf16 v[36:39], a[28:31], a[124:127], v[36:39]
 buffer_load_dwordx4 v1, s[4:7], s41 offen  lds
 v_mfma_f32_16x16x32_bf16 v[44:47], a[28:31], a[116:119], v[44:47]
 v_mfma_f32_16x16x32_bf16 v[44:47], a[24:27], a[112:115], v[44:47]
 v_mfma_f32_16x16x32_bf16 v[52:55], a[24:27], a[104:107], v[52:55]
 v_mfma_f32_16x16x32_bf16 v[52:55], a[28:31], a[108:111], v[52:55]
 s_add_u32 m0, s29, 73728
 v_mfma_f32_16x16x32_bf16 v[60:63], a[28:31], a[100:103], v[60:63]
 buffer_load_dwordx4 v2, s[8:11], s49 offen  lds
 v_mfma_f32_16x16x32_bf16 v[60:63], a[24:27], a[96:99], v[60:63]
 v_mfma_f32_16x16x32_bf16 v[216:219], a[32:35], a[96:99], v[216:219]
 v_mfma_f32_16x16x32_bf16 v[216:219], a[36:39], a[100:103], v[216:219]
 v_mfma_f32_16x16x32_bf16 v[208:211], a[36:39], a[108:111], v[208:211]
 s_add_u32 m0, s29, 8192
 v_mfma_f32_16x16x32_bf16 v[208:211], a[32:35], a[104:107], v[208:211]
 buffer_load_dwordx4 v1, s[4:7], s42 offen  lds
 v_mfma_f32_16x16x32_bf16 v[200:203], a[32:35], a[112:115], v[200:203]
 v_mfma_f32_16x16x32_bf16 v[200:203], a[36:39], a[116:119], v[200:203]
 v_mfma_f32_16x16x32_bf16 v[192:195], a[36:39], a[124:127], v[192:195]
 v_mfma_f32_16x16x32_bf16 v[192:195], a[32:35], a[120:123], v[192:195]
 s_add_u32 m0, s29, 77824
 v_mfma_f32_16x16x32_bf16 v[196:199], a[40:43], a[120:123], v[196:199]
 buffer_load_dwordx4 v2, s[8:11], s50 offen  lds
 v_mfma_f32_16x16x32_bf16 v[196:199], a[44:47], a[124:127], v[196:199]
 v_mfma_f32_16x16x32_bf16 v[204:207], a[44:47], a[116:119], v[204:207]
 v_mfma_f32_16x16x32_bf16 v[204:207], a[40:43], a[112:115], v[204:207]
 v_mfma_f32_16x16x32_bf16 v[212:215], a[40:43], a[104:107], v[212:215]
 s_add_u32 m0, s29, 12288
 v_mfma_f32_16x16x32_bf16 v[212:215], a[44:47], a[108:111], v[212:215]
 buffer_load_dwordx4 v1, s[4:7], s43 offen  lds
 v_mfma_f32_16x16x32_bf16 v[220:223], a[44:47], a[100:103], v[220:223]
 v_mfma_f32_16x16x32_bf16 v[220:223], a[40:43], a[96:99], v[220:223]
 v_mfma_f32_16x16x32_bf16 v[248:251], a[48:51], a[96:99], v[248:251]
 v_mfma_f32_16x16x32_bf16 v[248:251], a[52:55], a[100:103], v[248:251]
 s_add_u32 m0, s29, 81920
 v_mfma_f32_16x16x32_bf16 v[240:243], a[52:55], a[108:111], v[240:243]
 buffer_load_dwordx4 v2, s[8:11], s51 offen  lds
 v_mfma_f32_16x16x32_bf16 v[240:243], a[48:51], a[104:107], v[240:243]
 v_mfma_f32_16x16x32_bf16 v[232:235], a[48:51], a[112:115], v[232:235]
 v_mfma_f32_16x16x32_bf16 v[232:235], a[52:55], a[116:119], v[232:235]
 v_mfma_f32_16x16x32_bf16 v[224:227], a[52:55], a[124:127], v[224:227]
 s_add_u32 m0, s29, 16384
 v_mfma_f32_16x16x32_bf16 v[224:227], a[48:51], a[120:123], v[224:227]
 buffer_load_dwordx4 v1, s[4:7], s44 offen  lds
 v_mfma_f32_16x16x32_bf16 v[228:231], a[56:59], a[120:123], v[228:231]
 v_mfma_f32_16x16x32_bf16 v[228:231], a[60:63], a[124:127], v[228:231]
 v_mfma_f32_16x16x32_bf16 v[236:239], a[60:63], a[116:119], v[236:239]
 v_mfma_f32_16x16x32_bf16 v[236:239], a[56:59], a[112:115], v[236:239]
 s_add_u32 m0, s29, 86016
 v_mfma_f32_16x16x32_bf16 v[244:247], a[56:59], a[104:107], v[244:247]
 s_waitcnt vmcnt(10)
 buffer_load_dwordx4 v2, s[8:11], s52 offen  lds
 v_mfma_f32_16x16x32_bf16 v[244:247], a[60:63], a[108:111], v[244:247]
 s_barrier
 ds_read_b64_tr_b16 a[0:1], v6 offset:32768
 v_mfma_f32_16x16x32_bf16 v[252:255], a[60:63], a[100:103], v[252:255]
 ds_read_b64_tr_b16 a[2:3], v6 offset:36864
 v_mfma_f32_16x16x32_bf16 v[252:255], a[56:59], a[96:99], v[252:255]
 ds_read_b128 a[96:99], v4 offset:40960
 v_mfma_f32_16x16x32_bf16 v[152:155], a[32:35], a[64:67], v[152:155]
 s_add_u32 m0, s29, 20480
 ds_read_b128 a[128:131], v14 offset:0
 v_mfma_f32_16x16x32_bf16 v[152:155], a[36:39], a[68:71], v[152:155]
 buffer_load_dwordx4 v1, s[4:7], s45 offen  lds
 v_mfma_f32_16x16x32_bf16 v[144:147], a[36:39], a[76:79], v[144:147]
 ds_read_b64_tr_b16 a[4:5], v6 offset:49152
 v_mfma_f32_16x16x32_bf16 v[144:147], a[32:35], a[72:75], v[144:147]
 ds_read_b64_tr_b16 a[6:7], v6 offset:53248
 v_mfma_f32_16x16x32_bf16 v[136:139], a[32:35], a[80:83], v[136:139]
 ds_read_b128 a[100:103], v5 offset:40960
 v_mfma_f32_16x16x32_bf16 v[136:139], a[36:39], a[84:87], v[136:139]
 s_add_u32 m0, s29, 90112
 ds_read_b128 a[136:139], v3 offset:0
 v_mfma_f32_16x16x32_bf16 v[128:131], a[36:39], a[92:95], v[128:131]
 buffer_load_dwordx4 v2, s[8:11], s53 offen  lds
 v_mfma_f32_16x16x32_bf16 v[128:131], a[32:35], a[88:91], v[128:131]
 ds_read_b128 a[108:111], v5 offset:43008
 v_mfma_f32_16x16x32_bf16 v[132:135], a[40:43], a[88:91], v[132:135]
 ds_read_b128 a[132:135], v14 offset:2048
 v_mfma_f32_16x16x32_bf16 v[132:135], a[44:47], a[92:95], v[132:135]
 ds_read_b128 a[104:107], v4 offset:43008
 v_mfma_f32_16x16x32_bf16 v[140:143], a[44:47], a[84:87], v[140:143]
 s_add_u32 m0, s29, 24576
 ds_read_b128 a[140:143], v3 offset:2048
 v_mfma_f32_16x16x32_bf16 v[140:143], a[40:43], a[80:83], v[140:143]
 buffer_load_dwordx4 v1, s[4:7], s46 offen  lds
 v_mfma_f32_16x16x32_bf16 v[148:151], a[40:43], a[72:75], v[148:151]
 ds_read_b128 a[112:115], v4 offset:45056
 v_mfma_f32_16x16x32_bf16 v[148:151], a[44:47], a[76:79], v[148:151]
 ds_read_b128 a[144:147], v14 offset:4096
 v_mfma_f32_16x16x32_bf16 v[156:159], a[44:47], a[68:71], v[156:159]
 ds_read_b128 a[116:119], v5 offset:45056
 v_mfma_f32_16x16x32_bf16 v[156:159], a[40:43], a[64:67], v[156:159]
 s_add_u32 m0, s29, 94208
 ds_read_b128 a[152:155], v3 offset:4096
 v_mfma_f32_16x16x32_bf16 v[184:187], a[48:51], a[64:67], v[184:187]
 buffer_load_dwordx4 v2, s[8:11], s54 offen  lds
 v_mfma_f32_16x16x32_bf16 v[184:187], a[52:55], a[68:71], v[184:187]
 ds_read_b128 a[124:127], v5 offset:47104
 v_mfma_f32_16x16x32_bf16 v[176:179], a[52:55], a[76:79], v[176:179]
 ds_read_b128 a[148:151], v14 offset:6144
 v_mfma_f32_16x16x32_bf16 v[176:179], a[48:51], a[72:75], v[176:179]
 ds_read_b128 a[120:123], v4 offset:47104
 v_mfma_f32_16x16x32_bf16 v[168:171], a[48:51], a[80:83], v[168:171]
 s_add_u32 m0, s29, 28672
 ds_read_b128 a[156:159], v3 offset:6144
 v_mfma_f32_16x16x32_bf16 v[168:171], a[52:55], a[84:87], v[168:171]
 buffer_load_dwordx4 v1, s[4:7], s47 offen  lds
 v_mfma_f32_16x16x32_bf16 v[160:163], a[52:55], a[92:95], v[160:163]
 v_add_u32 v1, 128, v1
 v_add_u32 v2, 0x80000, v2
 v_mfma_f32_16x16x32_bf16 v[160:163], a[48:51], a[88:91], v[160:163]
 ds_read_b64_tr_b16 a[8:9], v7 offset:32768
 v_mfma_f32_16x16x32_bf16 v[164:167], a[56:59], a[88:91], v[164:167]
 v_mfma_f32_16x16x32_bf16 v[164:167], a[60:63], a[92:95], v[164:167]
 ds_read_b64_tr_b16 a[10:11], v7 offset:36864
 v_mfma_f32_16x16x32_bf16 v[172:175], a[60:63], a[84:87], v[172:175]
 ds_read_b64_tr_b16 a[12:13], v7 offset:49152
 v_mfma_f32_16x16x32_bf16 v[172:175], a[56:59], a[80:83], v[172:175]
 ds_read_b64_tr_b16 a[14:15], v7 offset:53248
 v_mfma_f32_16x16x32_bf16 v[180:183], a[56:59], a[72:75], v[180:183]
 ds_read_b64_tr_b16 a[16:17], v8 offset:32768
 v_mfma_f32_16x16x32_bf16 v[180:183], a[60:63], a[76:79], v[180:183]
 ds_read_b64_tr_b16 a[18:19], v8 offset:36864
 v_mfma_f32_16x16x32_bf16 v[188:191], a[60:63], a[68:71], v[188:191]
 ds_read_b64_tr_b16 a[20:21], v8 offset:49152
 v_mfma_f32_16x16x32_bf16 v[188:191], a[56:59], a[64:67], v[188:191]
 s_waitcnt lgkmcnt(15)
 ds_read_b64_tr_b16 a[22:23], v8 offset:53248
 v_mfma_f32_16x16x32_bf16 a[232:235], a[0:3], a[96:99], a[232:235]
 ds_read_b64_tr_b16 a[24:25], v9 offset:32768
 v_mfma_f32_16x16x32_bf16 a[232:235], a[4:7], a[100:103], a[232:235]
 s_add_u32 m0, s33, 0xffffff00
 ds_read_b64_tr_b16 a[26:27], v9 offset:36864
 v_mfma_f32_16x16x32_bf16 a[224:227], a[4:7], a[108:111], a[224:227]
 s_waitcnt lgkmcnt(10)
 ds_read_b64_tr_b16 a[28:29], v9 offset:49152
 v_mfma_f32_16x16x32_bf16 a[224:227], a[0:3], a[104:107], a[224:227]
 ds_read_b64_tr_b16 a[30:31], v9 offset:53248
 buffer_load_dwordx4 v15, s[20:23], 0 offen offset:256 lds
 v_mfma_f32_16x16x32_bf16 v[24:27], a[0:3], a[112:115], v[24:27]
 ds_read_b128 a[64:67], v4 offset:32768
 v_mfma_f32_16x16x32_bf16 v[24:27], a[4:7], a[116:119], v[24:27]
 v_mfma_f32_16x16x32_bf16 v[16:19], a[4:7], a[124:127], v[16:19]
 s_add_u32 m0, s33, 0xffffff80
 ds_read_b128 a[68:71], v5 offset:32768
 v_mfma_f32_16x16x32_bf16 v[16:19], a[0:3], a[120:123], v[16:19]
 s_waitcnt lgkmcnt(10)
 buffer_load_dwordx4 v15, s[20:23], 0 offen offset:1152 lds
 v_mfma_f32_16x16x32_bf16 v[20:23], a[8:11], a[120:123], v[20:23]
 ds_read_b128 a[76:79], v5 offset:34816
 v_mfma_f32_16x16x32_bf16 v[20:23], a[12:15], a[124:127], v[20:23]
 v_mfma_f32_16x16x32_bf16 v[28:31], a[12:15], a[116:119], v[28:31]
 s_add_u32 m0, s33, 0x700
 ds_read_b128 a[72:75], v4 offset:34816
 v_mfma_f32_16x16x32_bf16 v[28:31], a[8:11], a[112:115], v[28:31]
 buffer_load_dwordx4 v15, s[20:23], s57 offen offset:256 lds
 v_mfma_f32_16x16x32_bf16 a[228:231], a[8:11], a[104:107], a[228:231]
 ds_read_b128 a[80:83], v4 offset:36864
 v_mfma_f32_16x16x32_bf16 a[228:231], a[12:15], a[108:111], a[228:231]
 v_mfma_f32_16x16x32_bf16 a[236:239], a[12:15], a[100:103], a[236:239]
 s_add_u32 m0, s33, 0x780
 ds_read_b128 a[84:87], v5 offset:36864
 v_mfma_f32_16x16x32_bf16 a[236:239], a[8:11], a[96:99], a[236:239]
 s_waitcnt lgkmcnt(10)
 buffer_load_dwordx4 v15, s[20:23], s57 offen offset:1152 lds
 v_mfma_f32_16x16x32_bf16 v[56:59], a[16:19], a[96:99], v[56:59]
 ds_read_b128 a[92:95], v5 offset:38912
 v_mfma_f32_16x16x32_bf16 v[56:59], a[20:23], a[100:103], v[56:59]
 v_mfma_f32_16x16x32_bf16 v[48:51], a[20:23], a[108:111], v[48:51]
 s_add_u32 m0, s33, 0xe80
 ds_read_b128 a[88:91], v4 offset:38912
 v_mfma_f32_16x16x32_bf16 v[48:51], a[16:19], a[104:107], v[48:51]
 buffer_load_dwordx4 v15, s[20:23], 0 offen offset:384 lds
 v_mfma_f32_16x16x32_bf16 v[40:43], a[16:19], a[112:115], v[40:43]
 ds_read_b64_tr_b16 a[32:33], v10 offset:32768
 v_mfma_f32_16x16x32_bf16 v[40:43], a[20:23], a[116:119], v[40:43]
 ds_read_b64_tr_b16 a[34:35], v10 offset:36864
 v_mfma_f32_16x16x32_bf16 v[32:35], a[20:23], a[124:127], v[32:35]
 s_add_u32 m0, s33, 0xf00
 ds_read_b64_tr_b16 a[36:37], v10 offset:49152
 v_mfma_f32_16x16x32_bf16 v[32:35], a[16:19], a[120:123], v[32:35]
 s_waitcnt lgkmcnt(11)
 ds_read_b64_tr_b16 a[38:39], v10 offset:53248
 buffer_load_dwordx4 v15, s[20:23], 0 offen offset:1280 lds
 v_mfma_f32_16x16x32_bf16 v[36:39], a[24:27], a[120:123], v[36:39]
 ds_read_b64_tr_b16 a[40:41], v11 offset:32768
 v_mfma_f32_16x16x32_bf16 v[36:39], a[28:31], a[124:127], v[36:39]
 ds_read_b64_tr_b16 a[42:43], v11 offset:36864
 v_mfma_f32_16x16x32_bf16 v[44:47], a[28:31], a[116:119], v[44:47]
 s_add_u32 m0, s33, 0x1680
 ds_read_b64_tr_b16 a[44:45], v11 offset:49152
 v_mfma_f32_16x16x32_bf16 v[44:47], a[24:27], a[112:115], v[44:47]
 ds_read_b64_tr_b16 a[46:47], v11 offset:53248
 buffer_load_dwordx4 v15, s[20:23], s57 offen offset:384 lds
 v_mfma_f32_16x16x32_bf16 v[52:55], a[24:27], a[104:107], v[52:55]
 ds_read_b64_tr_b16 a[48:49], v12 offset:32768
 v_mfma_f32_16x16x32_bf16 v[52:55], a[28:31], a[108:111], v[52:55]
 ds_read_b64_tr_b16 a[50:51], v12 offset:36864
 v_mfma_f32_16x16x32_bf16 v[60:63], a[28:31], a[100:103], v[60:63]
 s_add_u32 m0, s33, 0x1700
 ds_read_b64_tr_b16 a[52:53], v12 offset:49152
 v_mfma_f32_16x16x32_bf16 v[60:63], a[24:27], a[96:99], v[60:63]
 s_waitcnt lgkmcnt(15)
 ds_read_b64_tr_b16 a[54:55], v12 offset:53248
 buffer_load_dwordx4 v15, s[20:23], s57 offen offset:1280 lds
 v_mfma_f32_16x16x32_bf16 v[88:91], a[0:3], a[64:67], v[88:91]
 ds_read_b64_tr_b16 a[56:57], v13 offset:32768
 v_mfma_f32_16x16x32_bf16 v[88:91], a[4:7], a[68:71], v[88:91]
 ds_read_b64_tr_b16 a[58:59], v13 offset:36864
 v_mfma_f32_16x16x32_bf16 v[80:83], a[4:7], a[76:79], v[80:83]
 ds_read_b64_tr_b16 a[60:61], v13 offset:49152
 v_mfma_f32_16x16x32_bf16 v[80:83], a[0:3], a[72:75], v[80:83]
 s_waitcnt lgkmcnt(15)
 ds_read_b64_tr_b16 a[62:63], v13 offset:53248
 v_mfma_f32_16x16x32_bf16 v[72:75], a[0:3], a[80:83], v[72:75]
 v_mfma_f32_16x16x32_bf16 v[72:75], a[4:7], a[84:87], v[72:75]
 v_mfma_f32_16x16x32_bf16 v[64:67], a[4:7], a[92:95], v[64:67]
 v_mfma_f32_16x16x32_bf16 v[64:67], a[0:3], a[88:91], v[64:67]
 s_waitcnt lgkmcnt(0)
 v_mfma_f32_16x16x32_bf16 v[68:71], a[8:11], a[88:91], v[68:71]
 s_barrier
 v_mfma_f32_16x16x32_bf16 v[68:71], a[12:15], a[92:95], v[68:71]
 s_add_u32 m0, s29, 98304
 v_mfma_f32_16x16x32_bf16 v[76:79], a[12:15], a[84:87], v[76:79]
 buffer_load_dwordx4 v2, s[8:11], 0 offen  lds
 v_mfma_f32_16x16x32_bf16 v[76:79], a[8:11], a[80:83], v[76:79]
 v_mfma_f32_16x16x32_bf16 v[84:87], a[8:11], a[72:75], v[84:87]
 v_mfma_f32_16x16x32_bf16 v[84:87], a[12:15], a[76:79], v[84:87]
 v_mfma_f32_16x16x32_bf16 v[92:95], a[12:15], a[68:71], v[92:95]
 s_add_u32 m0, s29, 32768
 v_mfma_f32_16x16x32_bf16 v[92:95], a[8:11], a[64:67], v[92:95]
 buffer_load_dwordx4 v1, s[4:7], 0 offen  lds
 v_mfma_f32_16x16x32_bf16 v[120:123], a[16:19], a[64:67], v[120:123]
 v_mfma_f32_16x16x32_bf16 v[120:123], a[20:23], a[68:71], v[120:123]
 v_mfma_f32_16x16x32_bf16 v[112:115], a[20:23], a[76:79], v[112:115]
 v_mfma_f32_16x16x32_bf16 v[112:115], a[16:19], a[72:75], v[112:115]
 s_add_u32 m0, s29, 102400
 v_mfma_f32_16x16x32_bf16 v[104:107], a[16:19], a[80:83], v[104:107]
 buffer_load_dwordx4 v2, s[8:11], s48 offen  lds
 v_mfma_f32_16x16x32_bf16 v[104:107], a[20:23], a[84:87], v[104:107]
 v_mfma_f32_16x16x32_bf16 v[96:99], a[20:23], a[92:95], v[96:99]
 v_mfma_f32_16x16x32_bf16 v[96:99], a[16:19], a[88:91], v[96:99]
 v_mfma_f32_16x16x32_bf16 v[100:103], a[24:27], a[88:91], v[100:103]
 s_add_u32 m0, s29, 36864
 v_mfma_f32_16x16x32_bf16 v[100:103], a[28:31], a[92:95], v[100:103]
 buffer_load_dwordx4 v1, s[4:7], s41 offen  lds
 v_mfma_f32_16x16x32_bf16 v[108:111], a[28:31], a[84:87], v[108:111]
 v_mfma_f32_16x16x32_bf16 v[108:111], a[24:27], a[80:83], v[108:111]
 v_mfma_f32_16x16x32_bf16 v[116:119], a[24:27], a[72:75], v[116:119]
 v_mfma_f32_16x16x32_bf16 v[116:119], a[28:31], a[76:79], v[116:119]
 s_add_u32 m0, s29, 106496
 v_mfma_f32_16x16x32_bf16 v[124:127], a[28:31], a[68:71], v[124:127]
 buffer_load_dwordx4 v2, s[8:11], s49 offen  lds
 v_mfma_f32_16x16x32_bf16 v[124:127], a[24:27], a[64:67], v[124:127]
 v_mfma_f32_16x16x32_bf16 v[152:155], a[32:35], a[64:67], v[152:155]
 v_mfma_f32_16x16x32_bf16 v[152:155], a[36:39], a[68:71], v[152:155]
 v_mfma_f32_16x16x32_bf16 v[144:147], a[36:39], a[76:79], v[144:147]
 s_add_u32 m0, s29, 40960
 v_mfma_f32_16x16x32_bf16 v[144:147], a[32:35], a[72:75], v[144:147]
 buffer_load_dwordx4 v1, s[4:7], s42 offen  lds
 v_mfma_f32_16x16x32_bf16 v[136:139], a[32:35], a[80:83], v[136:139]
 v_mfma_f32_16x16x32_bf16 v[136:139], a[36:39], a[84:87], v[136:139]
 v_mfma_f32_16x16x32_bf16 v[128:131], a[36:39], a[92:95], v[128:131]
 v_mfma_f32_16x16x32_bf16 v[128:131], a[32:35], a[88:91], v[128:131]
 s_add_u32 m0, s29, 110592
 v_mfma_f32_16x16x32_bf16 v[132:135], a[40:43], a[88:91], v[132:135]
 buffer_load_dwordx4 v2, s[8:11], s50 offen  lds
 v_mfma_f32_16x16x32_bf16 v[132:135], a[44:47], a[92:95], v[132:135]
 v_mfma_f32_16x16x32_bf16 v[140:143], a[44:47], a[84:87], v[140:143]
 v_mfma_f32_16x16x32_bf16 v[140:143], a[40:43], a[80:83], v[140:143]
 v_mfma_f32_16x16x32_bf16 v[148:151], a[40:43], a[72:75], v[148:151]
 s_add_u32 m0, s29, 45056
 v_mfma_f32_16x16x32_bf16 v[148:151], a[44:47], a[76:79], v[148:151]
 buffer_load_dwordx4 v1, s[4:7], s43 offen  lds
 v_mfma_f32_16x16x32_bf16 v[156:159], a[44:47], a[68:71], v[156:159]
 v_mfma_f32_16x16x32_bf16 v[156:159], a[40:43], a[64:67], v[156:159]
 v_mfma_f32_16x16x32_bf16 v[184:187], a[48:51], a[64:67], v[184:187]
 v_mfma_f32_16x16x32_bf16 v[184:187], a[52:55], a[68:71], v[184:187]
 s_add_u32 m0, s29, 114688
 v_mfma_f32_16x16x32_bf16 v[176:179], a[52:55], a[76:79], v[176:179]
 buffer_load_dwordx4 v2, s[8:11], s51 offen  lds
 v_mfma_f32_16x16x32_bf16 v[176:179], a[48:51], a[72:75], v[176:179]
 v_mfma_f32_16x16x32_bf16 v[168:171], a[48:51], a[80:83], v[168:171]
 v_mfma_f32_16x16x32_bf16 v[168:171], a[52:55], a[84:87], v[168:171]
 v_mfma_f32_16x16x32_bf16 v[160:163], a[52:55], a[92:95], v[160:163]
 s_add_u32 m0, s29, 49152
 v_mfma_f32_16x16x32_bf16 v[160:163], a[48:51], a[88:91], v[160:163]
 buffer_load_dwordx4 v1, s[4:7], s44 offen  lds
 v_mfma_f32_16x16x32_bf16 v[164:167], a[56:59], a[88:91], v[164:167]
 v_mfma_f32_16x16x32_bf16 v[164:167], a[60:63], a[92:95], v[164:167]
 v_mfma_f32_16x16x32_bf16 v[172:175], a[60:63], a[84:87], v[172:175]
 v_mfma_f32_16x16x32_bf16 v[172:175], a[56:59], a[80:83], v[172:175]
 s_add_u32 m0, s29, 118784
 v_mfma_f32_16x16x32_bf16 v[180:183], a[56:59], a[72:75], v[180:183]
 s_waitcnt vmcnt(10)
 buffer_load_dwordx4 v2, s[8:11], s52 offen  lds
 v_mfma_f32_16x16x32_bf16 v[180:183], a[60:63], a[76:79], v[180:183]
 s_barrier
 ds_read_b64_tr_b16 a[0:1], v6 offset:0
 v_mfma_f32_16x16x32_bf16 v[188:191], a[60:63], a[68:71], v[188:191]
 ds_read_b64_tr_b16 a[2:3], v6 offset:4096
 v_mfma_f32_16x16x32_bf16 v[188:191], a[56:59], a[64:67], v[188:191]
 ds_read_b128 a[64:67], v4 offset:0
 v_mfma_f32_16x16x32_bf16 v[216:219], a[32:35], a[96:99], v[216:219]
 s_add_u32 m0, s29, 53248
 ds_read_b128 a[160:163], v14 offset:0
 v_mfma_f32_16x16x32_bf16 v[216:219], a[36:39], a[100:103], v[216:219]
 buffer_load_dwordx4 v1, s[4:7], s45 offen  lds
 v_mfma_f32_16x16x32_bf16 v[208:211], a[36:39], a[108:111], v[208:211]
 ds_read_b64_tr_b16 a[4:5], v6 offset:16384
 v_mfma_f32_16x16x32_bf16 v[208:211], a[32:35], a[104:107], v[208:211]
 ds_read_b64_tr_b16 a[6:7], v6 offset:20480
 v_mfma_f32_16x16x32_bf16 v[200:203], a[32:35], a[112:115], v[200:203]
 ds_read_b128 a[68:71], v5 offset:0
 v_mfma_f32_16x16x32_bf16 v[200:203], a[36:39], a[116:119], v[200:203]
 s_add_u32 m0, s29, 122880
 ds_read_b128 a[168:171], v3 offset:0
 v_mfma_f32_16x16x32_bf16 v[192:195], a[36:39], a[124:127], v[192:195]
 buffer_load_dwordx4 v2, s[8:11], s53 offen  lds
 v_mfma_f32_16x16x32_bf16 v[192:195], a[32:35], a[120:123], v[192:195]
 ds_read_b128 a[76:79], v5 offset:2048
 v_mfma_f32_16x16x32_bf16 v[196:199], a[40:43], a[120:123], v[196:199]
 ds_read_b128 a[164:167], v14 offset:2048
 v_mfma_f32_16x16x32_bf16 v[196:199], a[44:47], a[124:127], v[196:199]
 ds_read_b128 a[72:75], v4 offset:2048
 v_mfma_f32_16x16x32_bf16 v[204:207], a[44:47], a[116:119], v[204:207]
 s_add_u32 m0, s29, 57344
 ds_read_b128 a[172:175], v3 offset:2048
 v_mfma_f32_16x16x32_bf16 v[204:207], a[40:43], a[112:115], v[204:207]
 buffer_load_dwordx4 v1, s[4:7], s46 offen  lds
 v_mfma_f32_16x16x32_bf16 v[212:215], a[40:43], a[104:107], v[212:215]
 ds_read_b128 a[80:83], v4 offset:4096
 v_mfma_f32_16x16x32_bf16 v[212:215], a[44:47], a[108:111], v[212:215]
 ds_read_b128 a[176:179], v14 offset:4096
 v_mfma_f32_16x16x32_bf16 v[220:223], a[44:47], a[100:103], v[220:223]
 ds_read_b128 a[84:87], v5 offset:4096
 v_mfma_f32_16x16x32_bf16 v[220:223], a[40:43], a[96:99], v[220:223]
 s_add_u32 m0, s29, 126976
 ds_read_b128 a[184:187], v3 offset:4096
 v_mfma_f32_16x16x32_bf16 v[248:251], a[48:51], a[96:99], v[248:251]
 buffer_load_dwordx4 v2, s[8:11], s54 offen  lds
 v_mfma_f32_16x16x32_bf16 v[248:251], a[52:55], a[100:103], v[248:251]
 ds_read_b128 a[92:95], v5 offset:6144
 v_mfma_f32_16x16x32_bf16 v[240:243], a[52:55], a[108:111], v[240:243]
 ds_read_b128 a[180:183], v14 offset:6144
 v_mfma_f32_16x16x32_bf16 v[240:243], a[48:51], a[104:107], v[240:243]
 ds_read_b128 a[88:91], v4 offset:6144
 v_mfma_f32_16x16x32_bf16 v[232:235], a[48:51], a[112:115], v[232:235]
 s_add_u32 m0, s29, 61440
 ds_read_b128 a[188:191], v3 offset:6144
 v_mfma_f32_16x16x32_bf16 v[232:235], a[52:55], a[116:119], v[232:235]
 buffer_load_dwordx4 v1, s[4:7], s47 offen  lds
 v_mfma_f32_16x16x32_bf16 v[224:227], a[52:55], a[124:127], v[224:227]
 v_add_u32 v1, 128, v1
 v_add_u32 v2, 0x80000, v2
 v_mfma_f32_16x16x32_bf16 v[224:227], a[48:51], a[120:123], v[224:227]
 ds_read_b64_tr_b16 a[8:9], v7 offset:0
 v_mfma_f32_16x16x32_bf16 v[228:231], a[56:59], a[120:123], v[228:231]
 v_mfma_f32_16x16x32_bf16 v[228:231], a[60:63], a[124:127], v[228:231]
 ds_read_b64_tr_b16 a[10:11], v7 offset:4096
 v_mfma_f32_16x16x32_bf16 v[236:239], a[60:63], a[116:119], v[236:239]
 ds_read_b64_tr_b16 a[12:13], v7 offset:16384
 v_mfma_f32_16x16x32_bf16 v[236:239], a[56:59], a[112:115], v[236:239]
 ds_read_b64_tr_b16 a[14:15], v7 offset:20480
 v_mfma_f32_16x16x32_bf16 v[244:247], a[56:59], a[104:107], v[244:247]
 ds_read_b64_tr_b16 a[16:17], v8 offset:0
 v_mfma_f32_16x16x32_bf16 v[244:247], a[60:63], a[108:111], v[244:247]
 ds_read_b64_tr_b16 a[18:19], v8 offset:4096
 v_mfma_f32_16x16x32_bf16 v[252:255], a[60:63], a[100:103], v[252:255]
 ds_read_b64_tr_b16 a[20:21], v8 offset:16384
 v_mfma_f32_16x16x32_bf16 v[252:255], a[56:59], a[96:99], v[252:255]
 s_waitcnt lgkmcnt(15)
 ds_read_b64_tr_b16 a[22:23], v8 offset:20480
 v_mfma_f32_16x16x32_bf16 v[88:91], a[0:3], a[64:67], v[88:91]
 ds_read_b64_tr_b16 a[24:25], v9 offset:0
 v_lshlrev_b32 v1, 4, v0
 v_mfma_f32_16x16x32_bf16 v[88:91], a[4:7], a[68:71], v[88:91]
 s_add_u32 m0, s33, 0xfffffe00
 ds_read_b64_tr_b16 a[26:27], v9 offset:4096
 v_mfma_f32_16x16x32_bf16 v[80:83], a[4:7], a[76:79], v[80:83]
 s_waitcnt lgkmcnt(10)
 ds_read_b64_tr_b16 a[28:29], v9 offset:16384
 v_mfma_f32_16x16x32_bf16 v[80:83], a[0:3], a[72:75], v[80:83]
 ds_read_b64_tr_b16 a[30:31], v9 offset:20480
 buffer_load_dwordx4 v15, s[20:23], 0 offen offset:512 lds
 v_mfma_f32_16x16x32_bf16 v[72:75], a[0:3], a[80:83], v[72:75]
 ds_read_b128 a[96:99], v4 offset:8192
 v_mfma_f32_16x16x32_bf16 v[72:75], a[4:7], a[84:87], v[72:75]
 v_mfma_f32_16x16x32_bf16 v[64:67], a[4:7], a[92:95], v[64:67]
 s_add_u32 m0, s33, 0xfffffe80
 ds_read_b128 a[100:103], v5 offset:8192
 v_mfma_f32_16x16x32_bf16 v[64:67], a[0:3], a[88:91], v[64:67]
 s_waitcnt lgkmcnt(10)
 buffer_load_dwordx4 v15, s[20:23], 0 offen offset:1408 lds
 v_mfma_f32_16x16x32_bf16 v[68:71], a[8:11], a[88:91], v[68:71]
 ds_read_b128 a[108:111], v5 offset:10240
 v_mfma_f32_16x16x32_bf16 v[68:71], a[12:15], a[92:95], v[68:71]
 v_mfma_f32_16x16x32_bf16 v[76:79], a[12:15], a[84:87], v[76:79]
 s_add_u32 m0, s33, 0x600
 ds_read_b128 a[104:107], v4 offset:10240
 v_mfma_f32_16x16x32_bf16 v[76:79], a[8:11], a[80:83], v[76:79]
 buffer_load_dwordx4 v15, s[20:23], s57 offen offset:512 lds
 v_mfma_f32_16x16x32_bf16 v[84:87], a[8:11], a[72:75], v[84:87]
 ds_read_b128 a[112:115], v4 offset:12288
 v_mfma_f32_16x16x32_bf16 v[84:87], a[12:15], a[76:79], v[84:87]
 v_mfma_f32_16x16x32_bf16 v[92:95], a[12:15], a[68:71], v[92:95]
 s_add_u32 m0, s33, 0x680
 ds_read_b128 a[116:119], v5 offset:12288
 v_mfma_f32_16x16x32_bf16 v[92:95], a[8:11], a[64:67], v[92:95]
 s_waitcnt lgkmcnt(10)
 buffer_load_dwordx4 v15, s[20:23], s57 offen offset:1408 lds
 v_mfma_f32_16x16x32_bf16 v[120:123], a[16:19], a[64:67], v[120:123]
 ds_read_b128 a[124:127], v5 offset:14336
 v_mfma_f32_16x16x32_bf16 v[120:123], a[20:23], a[68:71], v[120:123]
 v_mfma_f32_16x16x32_bf16 v[112:115], a[20:23], a[76:79], v[112:115]
 s_add_u32 m0, s33, 0xd80
 ds_read_b128 a[120:123], v4 offset:14336
 v_mfma_f32_16x16x32_bf16 v[112:115], a[16:19], a[72:75], v[112:115]
 buffer_load_dwordx4 v15, s[20:23], 0 offen offset:640 lds
 v_mfma_f32_16x16x32_bf16 v[104:107], a[16:19], a[80:83], v[104:107]
 ds_read_b64_tr_b16 a[32:33], v10 offset:0
 v_mfma_f32_16x16x32_bf16 v[104:107], a[20:23], a[84:87], v[104:107]
 ds_read_b64_tr_b16 a[34:35], v10 offset:4096
 v_mfma_f32_16x16x32_bf16 v[96:99], a[20:23], a[92:95], v[96:99]
 s_add_u32 m0, s33, 0xe00
 ds_read_b64_tr_b16 a[36:37], v10 offset:16384
 v_mfma_f32_16x16x32_bf16 v[96:99], a[16:19], a[88:91], v[96:99]
 s_waitcnt lgkmcnt(11)
 ds_read_b64_tr_b16 a[38:39], v10 offset:20480
 buffer_load_dwordx4 v15, s[20:23], 0 offen offset:1536 lds
 v_mfma_f32_16x16x32_bf16 v[100:103], a[24:27], a[88:91], v[100:103]
 ds_read_b64_tr_b16 a[40:41], v11 offset:0
 v_mfma_f32_16x16x32_bf16 v[100:103], a[28:31], a[92:95], v[100:103]
 ds_read_b64_tr_b16 a[42:43], v11 offset:4096
 v_mfma_f32_16x16x32_bf16 v[108:111], a[28:31], a[84:87], v[108:111]
 s_add_u32 m0, s33, 0x1580
 ds_read_b64_tr_b16 a[44:45], v11 offset:16384
 v_mfma_f32_16x16x32_bf16 v[108:111], a[24:27], a[80:83], v[108:111]
 ds_read_b64_tr_b16 a[46:47], v11 offset:20480
 buffer_load_dwordx4 v15, s[20:23], s57 offen offset:640 lds
 v_mfma_f32_16x16x32_bf16 v[116:119], a[24:27], a[72:75], v[116:119]
 ds_read_b64_tr_b16 a[48:49], v12 offset:0
 v_mfma_f32_16x16x32_bf16 v[116:119], a[28:31], a[76:79], v[116:119]
 ds_read_b64_tr_b16 a[50:51], v12 offset:4096
 v_mfma_f32_16x16x32_bf16 v[124:127], a[28:31], a[68:71], v[124:127]
 s_add_u32 m0, s33, 0x1600
 ds_read_b64_tr_b16 a[52:53], v12 offset:16384
 v_mfma_f32_16x16x32_bf16 v[124:127], a[24:27], a[64:67], v[124:127]
 s_waitcnt lgkmcnt(15)
 ds_read_b64_tr_b16 a[54:55], v12 offset:20480
 buffer_load_dwordx4 v15, s[20:23], s57 offen offset:1536 lds
 v_mfma_f32_16x16x32_bf16 a[232:235], a[0:3], a[96:99], a[232:235]
 ds_read_b64_tr_b16 a[56:57], v13 offset:0
 v_mfma_f32_16x16x32_bf16 a[232:235], a[4:7], a[100:103], a[232:235]
 ds_read_b64_tr_b16 a[58:59], v13 offset:4096
 v_mfma_f32_16x16x32_bf16 a[224:227], a[4:7], a[108:111], a[224:227]
 ds_read_b64_tr_b16 a[60:61], v13 offset:16384
 v_mfma_f32_16x16x32_bf16 a[224:227], a[0:3], a[104:107], a[224:227]
 s_waitcnt lgkmcnt(15)
 ds_read_b64_tr_b16 a[62:63], v13 offset:20480
 v_mfma_f32_16x16x32_bf16 v[24:27], a[0:3], a[112:115], v[24:27]
 v_mfma_f32_16x16x32_bf16 v[24:27], a[4:7], a[116:119], v[24:27]
 v_mfma_f32_16x16x32_bf16 v[16:19], a[4:7], a[124:127], v[16:19]
 v_mfma_f32_16x16x32_bf16 v[16:19], a[0:3], a[120:123], v[16:19]
 s_waitcnt lgkmcnt(0)
 v_mfma_f32_16x16x32_bf16 v[20:23], a[8:11], a[120:123], v[20:23]
 s_barrier
 v_mfma_f32_16x16x32_bf16 v[20:23], a[12:15], a[124:127], v[20:23]
 s_add_u32 m0, s29, 0
 v_add_u32 v2, 0xff800000, v2
 v_mfma_f32_16x16x32_bf16 v[28:31], a[12:15], a[116:119], v[28:31]
 buffer_load_dwordx4 v2, s[16:19], 0 offen lds
 v_mfma_f32_16x16x32_bf16 v[28:31], a[8:11], a[112:115], v[28:31]
 v_mfma_f32_16x16x32_bf16 a[228:231], a[8:11], a[104:107], a[228:231]
 v_mfma_f32_16x16x32_bf16 a[228:231], a[12:15], a[108:111], a[228:231]
 v_mfma_f32_16x16x32_bf16 a[236:239], a[12:15], a[100:103], a[236:239]
 s_add_u32 m0, s29, 4096
 v_mfma_f32_16x16x32_bf16 a[236:239], a[8:11], a[96:99], a[236:239]
 buffer_load_dwordx4 v2, s[16:19], s48 offen lds
 v_mfma_f32_16x16x32_bf16 v[56:59], a[16:19], a[96:99], v[56:59]
 v_mfma_f32_16x16x32_bf16 v[56:59], a[20:23], a[100:103], v[56:59]
 v_mfma_f32_16x16x32_bf16 v[48:51], a[20:23], a[108:111], v[48:51]
 v_mfma_f32_16x16x32_bf16 v[48:51], a[16:19], a[104:107], v[48:51]
 s_add_u32 m0, s29, 8192
 v_mfma_f32_16x16x32_bf16 v[40:43], a[16:19], a[112:115], v[40:43]
 buffer_load_dwordx4 v2, s[16:19], s49 offen lds
 v_mfma_f32_16x16x32_bf16 v[40:43], a[20:23], a[116:119], v[40:43]
 v_mfma_f32_16x16x32_bf16 v[32:35], a[20:23], a[124:127], v[32:35]
 v_mfma_f32_16x16x32_bf16 v[32:35], a[16:19], a[120:123], v[32:35]
 v_mfma_f32_16x16x32_bf16 v[36:39], a[24:27], a[120:123], v[36:39]
 s_add_u32 m0, s29, 12288
 v_mfma_f32_16x16x32_bf16 v[36:39], a[28:31], a[124:127], v[36:39]
 buffer_load_dwordx4 v2, s[16:19], s50 offen lds
 v_mfma_f32_16x16x32_bf16 v[44:47], a[28:31], a[116:119], v[44:47]
 v_mfma_f32_16x16x32_bf16 v[44:47], a[24:27], a[112:115], v[44:47]
 v_mfma_f32_16x16x32_bf16 v[52:55], a[24:27], a[104:107], v[52:55]
 v_mfma_f32_16x16x32_bf16 v[52:55], a[28:31], a[108:111], v[52:55]
 s_add_u32 m0, s29, 16384
 v_mfma_f32_16x16x32_bf16 v[60:63], a[28:31], a[100:103], v[60:63]
 buffer_load_dwordx4 v2, s[16:19], s51 offen lds
 v_mfma_f32_16x16x32_bf16 v[60:63], a[24:27], a[96:99], v[60:63]
 v_mfma_f32_16x16x32_bf16 v[216:219], a[32:35], a[96:99], v[216:219]
 v_mfma_f32_16x16x32_bf16 v[216:219], a[36:39], a[100:103], v[216:219]
 v_mfma_f32_16x16x32_bf16 v[208:211], a[36:39], a[108:111], v[208:211]
 s_add_u32 m0, s29, 20480
 v_mfma_f32_16x16x32_bf16 v[208:211], a[32:35], a[104:107], v[208:211]
 buffer_load_dwordx4 v2, s[16:19], s52 offen lds
 v_mfma_f32_16x16x32_bf16 v[200:203], a[32:35], a[112:115], v[200:203]
 v_mfma_f32_16x16x32_bf16 v[200:203], a[36:39], a[116:119], v[200:203]
 v_mfma_f32_16x16x32_bf16 v[192:195], a[36:39], a[124:127], v[192:195]
 v_mfma_f32_16x16x32_bf16 v[192:195], a[32:35], a[120:123], v[192:195]
 s_add_u32 m0, s29, 24576
 v_mfma_f32_16x16x32_bf16 v[196:199], a[40:43], a[120:123], v[196:199]
 buffer_load_dwordx4 v2, s[16:19], s53 offen lds
 v_mfma_f32_16x16x32_bf16 v[196:199], a[44:47], a[124:127], v[196:199]
 v_mfma_f32_16x16x32_bf16 v[204:207], a[44:47], a[116:119], v[204:207]
 v_mfma_f32_16x16x32_bf16 v[204:207], a[40:43], a[112:115], v[204:207]
 v_mfma_f32_16x16x32_bf16 v[212:215], a[40:43], a[104:107], v[212:215]
 s_add_u32 m0, s29, 28672
 v_mfma_f32_16x16x32_bf16 v[212:215], a[44:47], a[108:111], v[212:215]
 buffer_load_dwordx4 v2, s[16:19], s54 offen lds
 v_mfma_f32_16x16x32_bf16 v[220:223], a[44:47], a[100:103], v[220:223]
 v_mfma_f32_16x16x32_bf16 v[220:223], a[40:43], a[96:99], v[220:223]
 v_mfma_f32_16x16x32_bf16 v[248:251], a[48:51], a[96:99], v[248:251]
 s_add_u32 m0, s29, 65536
 v_add_u32 v2, 0x80000, v2
 v_mfma_f32_16x16x32_bf16 v[248:251], a[52:55], a[100:103], v[248:251]
 buffer_load_dwordx4 v2, s[16:19], 0 offen lds
 v_mfma_f32_16x16x32_bf16 v[240:243], a[52:55], a[108:111], v[240:243]
 v_mfma_f32_16x16x32_bf16 v[240:243], a[48:51], a[104:107], v[240:243]
 v_mfma_f32_16x16x32_bf16 v[232:235], a[48:51], a[112:115], v[232:235]
 v_mfma_f32_16x16x32_bf16 v[232:235], a[52:55], a[116:119], v[232:235]
 s_add_u32 m0, s29, 69632
 v_mfma_f32_16x16x32_bf16 v[224:227], a[52:55], a[124:127], v[224:227]
 buffer_load_dwordx4 v2, s[16:19], s48 offen lds
 v_mfma_f32_16x16x32_bf16 v[224:227], a[48:51], a[120:123], v[224:227]
 v_mfma_f32_16x16x32_bf16 v[228:231], a[56:59], a[120:123], v[228:231]
 v_mfma_f32_16x16x32_bf16 v[228:231], a[60:63], a[124:127], v[228:231]
 v_mfma_f32_16x16x32_bf16 v[236:239], a[60:63], a[116:119], v[236:239]
 s_add_u32 m0, s29, 73728
 v_mfma_f32_16x16x32_bf16 v[236:239], a[56:59], a[112:115], v[236:239]
 buffer_load_dwordx4 v2, s[16:19], s49 offen lds
 v_mfma_f32_16x16x32_bf16 v[244:247], a[56:59], a[104:107], v[244:247]
 s_waitcnt vmcnt(11)
 v_mfma_f32_16x16x32_bf16 v[244:247], a[60:63], a[108:111], v[244:247]
 s_barrier
 ds_read_b64_tr_b16 a[0:1], v6 offset:32768
 v_mfma_f32_16x16x32_bf16 v[252:255], a[60:63], a[100:103], v[252:255]
 ds_read_b64_tr_b16 a[2:3], v6 offset:36864
 v_mfma_f32_16x16x32_bf16 v[252:255], a[56:59], a[96:99], v[252:255]
 s_add_u32 m0, s29, 77824
 ds_read_b128 a[96:99], v4 offset:40960
 v_mfma_f32_16x16x32_bf16 v[152:155], a[32:35], a[64:67], v[152:155]
 ds_read_b128 a[192:195], v14 offset:0
 buffer_load_dwordx4 v2, s[16:19], s50 offen lds
 v_mfma_f32_16x16x32_bf16 v[152:155], a[36:39], a[68:71], v[152:155]
 ds_read_b128 a[200:203], v3 offset:0
 v_mfma_f32_16x16x32_bf16 v[144:147], a[36:39], a[76:79], v[144:147]
 s_mov_b32 s56, s58
 ds_read_b64_tr_b16 a[4:5], v6 offset:49152
 v_mfma_f32_16x16x32_bf16 v[144:147], a[32:35], a[72:75], v[144:147]
 ds_read_b64_tr_b16 a[6:7], v6 offset:53248
 v_mfma_f32_16x16x32_bf16 v[136:139], a[32:35], a[80:83], v[136:139]
 s_add_u32 m0, s29, 81920
 ds_read_b128 a[100:103], v5 offset:40960
 v_mfma_f32_16x16x32_bf16 v[136:139], a[36:39], a[84:87], v[136:139]
 ds_read_b128 a[196:199], v14 offset:2048
 buffer_load_dwordx4 v2, s[16:19], s51 offen lds
 v_mfma_f32_16x16x32_bf16 v[128:131], a[36:39], a[92:95], v[128:131]
 ds_read_b128 a[204:207], v3 offset:2048
 v_mfma_f32_16x16x32_bf16 v[128:131], a[32:35], a[88:91], v[128:131]
 ds_read_b128 a[108:111], v5 offset:43008
 v_mfma_f32_16x16x32_bf16 v[132:135], a[40:43], a[88:91], v[132:135]
 ds_read_b128 a[208:211], v14 offset:4096
 v_mfma_f32_16x16x32_bf16 v[132:135], a[44:47], a[92:95], v[132:135]
 s_add_u32 m0, s29, 86016
 ds_read_b128 a[104:107], v4 offset:43008
 v_mfma_f32_16x16x32_bf16 v[140:143], a[44:47], a[84:87], v[140:143]
 ds_read_b128 a[216:219], v3 offset:4096
 buffer_load_dwordx4 v2, s[16:19], s52 offen lds
 v_mfma_f32_16x16x32_bf16 v[140:143], a[40:43], a[80:83], v[140:143]
 ds_read_b128 a[212:215], v14 offset:6144
 v_mfma_f32_16x16x32_bf16 v[148:151], a[40:43], a[72:75], v[148:151]
 s_cmp_lt_u32 s25, 4
 s_cselect_b32 s1, 2.0, s92
 ds_read_b128 a[112:115], v4 offset:45056
 v_mfma_f32_16x16x32_bf16 v[148:151], a[44:47], a[76:79], v[148:151]
 ds_read_b128 a[220:223], v3 offset:6144
 v_mfma_f32_16x16x32_bf16 v[156:159], a[44:47], a[68:71], v[156:159]
 s_add_u32 m0, s29, 90112
 ds_read_b128 a[116:119], v5 offset:45056
 v_mfma_f32_16x16x32_bf16 v[156:159], a[40:43], a[64:67], v[156:159]
 buffer_load_dwordx4 v2, s[16:19], s53 offen lds
 v_mfma_f32_16x16x32_bf16 v[184:187], a[48:51], a[64:67], v[184:187]
 v_mfma_f32_16x16x32_bf16 v[184:187], a[52:55], a[68:71], v[184:187]
 ds_read_b128 a[124:127], v5 offset:47104
 v_mfma_f32_16x16x32_bf16 v[176:179], a[52:55], a[76:79], v[176:179]
 v_mfma_f32_16x16x32_bf16 v[176:179], a[48:51], a[72:75], v[176:179]
 s_add_u32 m0, s29, 94208
 ds_read_b128 a[120:123], v4 offset:47104
 v_mfma_f32_16x16x32_bf16 v[168:171], a[48:51], a[80:83], v[168:171]
 buffer_load_dwordx4 v2, s[16:19], s54 offen lds
 v_mfma_f32_16x16x32_bf16 v[168:171], a[52:55], a[84:87], v[168:171]
 v_mfma_f32_16x16x32_bf16 v[160:163], a[52:55], a[92:95], v[160:163]
 v_mfma_f32_16x16x32_bf16 v[160:163], a[48:51], a[88:91], v[160:163]
 ds_read_b64_tr_b16 a[8:9], v7 offset:32768
 v_mfma_f32_16x16x32_bf16 v[164:167], a[56:59], a[88:91], v[164:167]
 v_mfma_f32_16x16x32_bf16 v[164:167], a[60:63], a[92:95], v[164:167]
 ds_read_b64_tr_b16 a[10:11], v7 offset:36864
 v_mfma_f32_16x16x32_bf16 v[172:175], a[60:63], a[84:87], v[172:175]
 ds_read_b64_tr_b16 a[12:13], v7 offset:49152
 v_mfma_f32_16x16x32_bf16 v[172:175], a[56:59], a[80:83], v[172:175]
 ds_read_b64_tr_b16 a[14:15], v7 offset:53248
 v_mfma_f32_16x16x32_bf16 v[180:183], a[56:59], a[72:75], v[180:183]
 ds_read_b64_tr_b16 a[16:17], v8 offset:32768
 v_mfma_f32_16x16x32_bf16 v[180:183], a[60:63], a[76:79], v[180:183]
 ds_read_b64_tr_b16 a[18:19], v8 offset:36864
 v_mfma_f32_16x16x32_bf16 v[188:191], a[60:63], a[68:71], v[188:191]
 ds_read_b64_tr_b16 a[20:21], v8 offset:49152
 v_mfma_f32_16x16x32_bf16 v[188:191], a[56:59], a[64:67], v[188:191]
 s_waitcnt lgkmcnt(15)
 ds_read_b64_tr_b16 a[22:23], v8 offset:53248
 s_cmp_ge_u32 s25, 4
 s_cbranch_scc1 L_late0
 v_mfma_f32_16x16x32_bf16 a[232:235], a[0:3], a[96:99], a[232:235]
 ds_read_b64_tr_b16 a[24:25], v9 offset:32768
 v_mfma_f32_16x16x32_bf16 a[232:235], a[4:7], a[100:103], a[232:235]
 s_add_u32 m0, s33, 0xfffffd00
 ds_read_b64_tr_b16 a[26:27], v9 offset:36864
 v_mfma_f32_16x16x32_bf16 a[224:227], a[4:7], a[108:111], a[224:227]
 s_waitcnt lgkmcnt(13)
 ds_read_b64_tr_b16 a[28:29], v9 offset:49152
 v_mfma_f32_16x16x32_bf16 a[224:227], a[0:3], a[104:107], a[224:227]
 ds_read_b64_tr_b16 a[30:31], v9 offset:53248
 buffer_load_dwordx4 v15, s[20:23], 0 offen offset:768 lds
 v_mfma_f32_16x16x32_bf16 v[24:27], a[0:3], a[112:115], v[24:27]
 s_waitcnt lgkmcnt(12)
 ds_read_b128 a[64:67], v4 offset:32768
 v_mfma_f32_16x16x32_bf16 v[24:27], a[4:7], a[116:119], v[24:27]
 v_mfma_f32_16x16x32_bf16 v[16:19], a[4:7], a[124:127], v[16:19]
 s_add_u32 m0, s33, 0xfffffd80
 ds_read_b128 a[68:71], v5 offset:32768
 v_mfma_f32_16x16x32_bf16 v[16:19], a[0:3], a[120:123], v[16:19]
 s_waitcnt lgkmcnt(10)
 buffer_load_dwordx4 v15, s[20:23], 0 offen offset:1664 lds
 v_mfma_f32_16x16x32_bf16 v[20:23], a[8:11], a[120:123], v[20:23]
 ds_read_b128 a[76:79], v5 offset:34816
 v_mfma_f32_16x16x32_bf16 v[20:23], a[12:15], a[124:127], v[20:23]
 v_mfma_f32_16x16x32_bf16 v[28:31], a[12:15], a[116:119], v[28:31]
 s_add_u32 m0, s33, 0x500
 ds_read_b128 a[72:75], v4 offset:34816
 v_mfma_f32_16x16x32_bf16 v[28:31], a[8:11], a[112:115], v[28:31]
 buffer_load_dwordx4 v15, s[20:23], s57 offen offset:768 lds
 v_mfma_f32_16x16x32_bf16 a[228:231], a[8:11], a[104:107], a[228:231]
 ds_read_b128 a[80:83], v4 offset:36864
 v_mfma_f32_16x16x32_bf16 a[228:231], a[12:15], a[108:111], a[228:231]
 v_mfma_f32_16x16x32_bf16 a[236:239], a[12:15], a[100:103], a[236:239]
 s_add_u32 m0, s33, 0x580
 ds_read_b128 a[84:87], v5 offset:36864
 v_mfma_f32_16x16x32_bf16 a[236:239], a[8:11], a[96:99], a[236:239]
 s_waitcnt lgkmcnt(10)
 buffer_load_dwordx4 v15, s[20:23], s57 offen offset:1664 lds
 v_mfma_f32_16x16x32_bf16 v[56:59], a[16:19], a[96:99], v[56:59]
 ds_read_b128 a[92:95], v5 offset:38912
 v_mfma_f32_16x16x32_bf16 v[56:59], a[20:23], a[100:103], v[56:59]
 v_cvt_pk_bf16_f32 v16, v16, v17
 v_cvt_pk_bf16_f32 v17, v18, v19
 v_mfma_f32_16x16x32_bf16 v[48:51], a[20:23], a[108:111], v[48:51]
 ds_read_b128 a[88:91], v4 offset:38912
 v_cvt_pk_bf16_f32 v18, v20, v21
 v_mfma_f32_16x16x32_bf16 v[48:51], a[16:19], a[104:107], v[48:51]
 v_cvt_pk_bf16_f32 v19, v22, v23
 v_cvt_pk_bf16_f32 v24, v24, v25
 v_mfma_f32_16x16x32_bf16 v[40:43], a[16:19], a[112:115], v[40:43]
 ds_read_b64_tr_b16 a[32:33], v10 offset:32768
 v_cvt_pk_bf16_f32 v25, v26, v27
 v_mfma_f32_16x16x32_bf16 v[40:43], a[20:23], a[116:119], v[40:43]
 ds_read_b64_tr_b16 a[34:35], v10 offset:36864
 v_cvt_pk_bf16_f32 v26, v28, v29
 v_mfma_f32_16x16x32_bf16 v[32:35], a[20:23], a[124:127], v[32:35]
 s_add_u32 s59, s56, 57344
 ds_read_b64_tr_b16 a[36:37], v10 offset:49152
 v_cvt_pk_bf16_f32 v27, v30, v31
 v_mfma_f32_16x16x32_bf16 v[32:35], a[16:19], a[120:123], v[32:35]
 s_waitcnt lgkmcnt(11)
 ds_read_b64_tr_b16 a[38:39], v10 offset:53248
 v_accvgpr_read_b32 v20, a224
 v_mfma_f32_16x16x32_bf16 v[36:39], a[24:27], a[120:123], v[36:39]
 ds_read_b64_tr_b16 a[40:41], v11 offset:32768
 buffer_store_dwordx4 v[16:19], v1, s[12:15], s59 offen offset:0 sc1
 v_mfma_f32_16x16x32_bf16 v[36:39], a[28:31], a[124:127], v[36:39]
 ds_read_b64_tr_b16 a[42:43], v11 offset:36864
 v_accvgpr_read_b32 v21, a225
 v_mfma_f32_16x16x32_bf16 v[44:47], a[28:31], a[116:119], v[44:47]
 ds_read_b64_tr_b16 a[44:45], v11 offset:49152
 v_accvgpr_read_b32 v22, a226
 v_mfma_f32_16x16x32_bf16 v[44:47], a[24:27], a[112:115], v[44:47]
 ds_read_b64_tr_b16 a[46:47], v11 offset:53248
 v_accvgpr_read_b32 v23, a227
 v_mfma_f32_16x16x32_bf16 v[52:55], a[24:27], a[104:107], v[52:55]
 ds_read_b64_tr_b16 a[48:49], v12 offset:32768
 v_accvgpr_read_b32 v28, a228
 v_mfma_f32_16x16x32_bf16 v[52:55], a[28:31], a[108:111], v[52:55]
 ds_read_b64_tr_b16 a[50:51], v12 offset:36864
 v_accvgpr_read_b32 v29, a229
 v_mfma_f32_16x16x32_bf16 v[60:63], a[28:31], a[100:103], v[60:63]
 s_add_u32 s59, s56, 49152
 ds_read_b64_tr_b16 a[52:53], v12 offset:49152
 v_accvgpr_read_b32 v30, a230
 v_mfma_f32_16x16x32_bf16 v[60:63], a[24:27], a[96:99], v[60:63]
 s_waitcnt lgkmcnt(15)
 ds_read_b64_tr_b16 a[54:55], v12 offset:53248
 buffer_store_dwordx4 v[24:27], v1, s[12:15], s59 offen offset:0 sc1
 v_mfma_f32_16x16x32_bf16 v[88:91], a[0:3], a[64:67], v[88:91]
 ds_read_b64_tr_b16 a[56:57], v13 offset:32768
 v_accvgpr_read_b32 v31, a231
 v_mfma_f32_16x16x32_bf16 v[88:91], a[4:7], a[68:71], v[88:91]
 ds_read_b64_tr_b16 a[58:59], v13 offset:36864
 v_cvt_pk_bf16_f32 v20, v20, v21
 v_mfma_f32_16x16x32_bf16 v[80:83], a[4:7], a[76:79], v[80:83]
 ds_read_b64_tr_b16 a[60:61], v13 offset:49152
 v_cvt_pk_bf16_f32 v21, v22, v23
 v_mfma_f32_16x16x32_bf16 v[80:83], a[0:3], a[72:75], v[80:83]
 s_waitcnt lgkmcnt(15)
 ds_read_b64_tr_b16 a[62:63], v13 offset:53248
 v_cvt_pk_bf16_f32 v22, v28, v29
 v_mfma_f32_16x16x32_bf16 v[72:75], a[0:3], a[80:83], v[72:75]
 v_cvt_pk_bf16_f32 v23, v30, v31
 v_cvt_pk_bf16_f32 v32, v32, v33
 v_mfma_f32_16x16x32_bf16 v[72:75], a[4:7], a[84:87], v[72:75]
 s_add_u32 s59, s56, 40960
 v_cvt_pk_bf16_f32 v33, v34, v35
 v_cvt_pk_bf16_f32 v34, v36, v37
 v_mfma_f32_16x16x32_bf16 v[64:67], a[4:7], a[92:95], v[64:67]
 buffer_store_dwordx4 v[20:23], v1, s[12:15], s59 offen offset:0 sc1
 v_mfma_f32_16x16x32_bf16 v[64:67], a[0:3], a[88:91], v[64:67]
 s_waitcnt lgkmcnt(0)
 v_cvt_pk_bf16_f32 v35, v38, v39
 v_cvt_pk_bf16_f32 v40, v40, v41
 v_mfma_f32_16x16x32_bf16 v[68:71], a[8:11], a[88:91], v[68:71]
 s_barrier
 v_xor_b32 v6, s60, v6
 v_cvt_pk_bf16_f32 v41, v42, v43
 v_mfma_f32_16x16x32_bf16 v[68:71], a[12:15], a[92:95], v[68:71]
 s_add_u32 m0, s29, 32768
 v_add_u32 v2, 0x80000, v2
 v_cvt_pk_bf16_f32 v42, v44, v45
 v_mfma_f32_16x16x32_bf16 v[76:79], a[12:15], a[84:87], v[76:79]
 buffer_load_dwordx4 v2, s[16:19], 0 offen lds
 v_mfma_f32_16x16x32_bf16 v[76:79], a[8:11], a[80:83], v[76:79]
 v_cvt_pk_bf16_f32 v43, v46, v47
 v_accvgpr_read_b32 v36, a232
 v_mfma_f32_16x16x32_bf16 v[84:87], a[8:11], a[72:75], v[84:87]
 s_add_u32 s59, s56, 57344
 v_accvgpr_read_b32 v37, a233
 v_accvgpr_read_b32 v38, a234
 v_mfma_f32_16x16x32_bf16 v[84:87], a[12:15], a[76:79], v[84:87]
 buffer_store_dwordx4 v[32:35], v1, s[12:15], s59 offen offset:1024 sc1
 v_mfma_f32_16x16x32_bf16 v[92:95], a[12:15], a[68:71], v[92:95]
 s_add_u32 m0, s29, 36864
 v_accvgpr_read_b32 v39, a235
 v_accvgpr_read_b32 v44, a236
 v_mfma_f32_16x16x32_bf16 v[92:95], a[8:11], a[64:67], v[92:95]
 buffer_load_dwordx4 v2, s[16:19], s48 offen lds
 v_mfma_f32_16x16x32_bf16 v[120:123], a[16:19], a[64:67], v[120:123]
 v_accvgpr_read_b32 v45, a237
 v_accvgpr_read_b32 v46, a238
 v_mfma_f32_16x16x32_bf16 v[120:123], a[20:23], a[68:71], v[120:123]
 v_accvgpr_read_b32 v47, a239
 v_cvt_pk_bf16_f32 v36, v36, v37
 v_mfma_f32_16x16x32_bf16 v[112:115], a[20:23], a[76:79], v[112:115]
 v_cvt_pk_bf16_f32 v37, v38, v39
 v_cvt_pk_bf16_f32 v38, v44, v45
 v_mfma_f32_16x16x32_bf16 v[112:115], a[16:19], a[72:75], v[112:115]
 s_add_u32 m0, s29, 40960
 v_cvt_pk_bf16_f32 v39, v46, v47
 v_cvt_pk_bf16_f32 v48, v48, v49
 v_mfma_f32_16x16x32_bf16 v[104:107], a[16:19], a[80:83], v[104:107]
 buffer_load_dwordx4 v2, s[16:19], s49 offen lds
 v_mfma_f32_16x16x32_bf16 v[104:107], a[20:23], a[84:87], v[104:107]
 s_add_u32 s59, s56, 49152
 v_cvt_pk_bf16_f32 v49, v50, v51
 v_cvt_pk_bf16_f32 v50, v52, v53
 v_mfma_f32_16x16x32_bf16 v[96:99], a[20:23], a[92:95], v[96:99]
 buffer_store_dwordx4 v[40:43], v1, s[12:15], s59 offen offset:1024 sc1
 v_mfma_f32_16x16x32_bf16 v[96:99], a[16:19], a[88:91], v[96:99]
 v_cvt_pk_bf16_f32 v51, v54, v55
 v_cvt_pk_bf16_f32 v56, v56, v57
 v_mfma_f32_16x16x32_bf16 v[100:103], a[24:27], a[88:91], v[100:103]
 s_add_u32 m0, s29, 45056
 v_cvt_pk_bf16_f32 v57, v58, v59
 v_cvt_pk_bf16_f32 v58, v60, v61
 v_mfma_f32_16x16x32_bf16 v[100:103], a[28:31], a[92:95], v[100:103]
 buffer_load_dwordx4 v2, s[16:19], s50 offen lds
 v_mfma_f32_16x16x32_bf16 v[108:111], a[28:31], a[84:87], v[108:111]
 v_cvt_pk_bf16_f32 v59, v62, v63
 v_cvt_pk_bf16_f32 v64, v64, v65
 v_mfma_f32_16x16x32_bf16 v[108:111], a[24:27], a[80:83], v[108:111]
 v_cvt_pk_bf16_f32 v65, v66, v67
 v_cvt_pk_bf16_f32 v66, v68, v69
 v_mfma_f32_16x16x32_bf16 v[116:119], a[24:27], a[72:75], v[116:119]
 v_cvt_pk_bf16_f32 v67, v70, v71
 v_cvt_pk_bf16_f32 v72, v72, v73
 v_mfma_f32_16x16x32_bf16 v[116:119], a[28:31], a[76:79], v[116:119]
 s_add_u32 m0, s29, 49152
 v_cvt_pk_bf16_f32 v73, v74, v75
 v_cvt_pk_bf16_f32 v74, v76, v77
 v_mfma_f32_16x16x32_bf16 v[124:127], a[28:31], a[68:71], v[124:127]
 buffer_load_dwordx4 v2, s[16:19], s51 offen lds
 v_mfma_f32_16x16x32_bf16 v[124:127], a[24:27], a[64:67], v[124:127]
 s_add_u32 s59, s56, 32768
 v_cvt_pk_bf16_f32 v75, v78, v79
 v_cvt_pk_bf16_f32 v80, v80, v81
 v_mfma_f32_16x16x32_bf16 v[152:155], a[32:35], a[64:67], v[152:155]
 buffer_store_dwordx4 v[36:39], v1, s[12:15], s59 offen offset:0 sc1
 v_mfma_f32_16x16x32_bf16 v[152:155], a[36:39], a[68:71], v[152:155]
 v_cvt_pk_bf16_f32 v81, v82, v83
 v_cvt_pk_bf16_f32 v82, v84, v85
 v_mfma_f32_16x16x32_bf16 v[144:147], a[36:39], a[76:79], v[144:147]
 s_add_u32 m0, s29, 53248
 v_cvt_pk_bf16_f32 v83, v86, v87
 v_cvt_pk_bf16_f32 v88, v88, v89
 v_mfma_f32_16x16x32_bf16 v[144:147], a[32:35], a[72:75], v[144:147]
 buffer_load_dwordx4 v2, s[16:19], s52 offen lds
 v_mfma_f32_16x16x32_bf16 v[136:139], a[32:35], a[80:83], v[136:139]
 v_cvt_pk_bf16_f32 v89, v90, v91
 v_cvt_pk_bf16_f32 v90, v92, v93
 v_mfma_f32_16x16x32_bf16 v[136:139], a[36:39], a[84:87], v[136:139]
 v_cvt_pk_bf16_f32 v91, v94, v95
 v_cvt_pk_bf16_f32 v96, v96, v97
 v_mfma_f32_16x16x32_bf16 v[128:131], a[36:39], a[92:95], v[128:131]
 v_cvt_pk_bf16_f32 v97, v98, v99
 v_cvt_pk_bf16_f32 v98, v100, v101
 v_mfma_f32_16x16x32_bf16 v[128:131], a[32:35], a[88:91], v[128:131]
 s_add_u32 m0, s29, 57344
 v_cvt_pk_bf16_f32 v99, v102, v103
 v_cvt_pk_bf16_f32 v104, v104, v105
 v_mfma_f32_16x16x32_bf16 v[132:135], a[40:43], a[88:91], v[132:135]
 buffer_load_dwordx4 v2, s[16:19], s53 offen lds
 v_mfma_f32_16x16x32_bf16 v[132:135], a[44:47], a[92:95], v[132:135]
 s_add_u32 s59, s56, 40960
 v_cvt_pk_bf16_f32 v105, v106, v107
 v_cvt_pk_bf16_f32 v106, v108, v109
 v_mfma_f32_16x16x32_bf16 v[140:143], a[44:47], a[84:87], v[140:143]
 buffer_store_dwordx4 v[48:51], v1, s[12:15], s59 offen offset:1024 sc1
 v_mfma_f32_16x16x32_bf16 v[140:143], a[40:43], a[80:83], v[140:143]
 v_cvt_pk_bf16_f32 v107, v110, v111
 v_cvt_pk_bf16_f32 v112, v112, v113
 v_mfma_f32_16x16x32_bf16 v[148:151], a[40:43], a[72:75], v[148:151]
 s_add_u32 m0, s29, 61440
 v_cvt_pk_bf16_f32 v113, v114, v115
 v_cvt_pk_bf16_f32 v114, v116, v117
 v_mfma_f32_16x16x32_bf16 v[148:151], a[44:47], a[76:79], v[148:151]
 buffer_load_dwordx4 v2, s[16:19], s54 offen lds
 v_mfma_f32_16x16x32_bf16 v[156:159], a[44:47], a[68:71], v[156:159]
 v_cvt_pk_bf16_f32 v115, v118, v119
 v_cvt_pk_bf16_f32 v120, v120, v121
 v_mfma_f32_16x16x32_bf16 v[156:159], a[40:43], a[64:67], v[156:159]
 v_cvt_pk_bf16_f32 v121, v122, v123
 v_cvt_pk_bf16_f32 v122, v124, v125
 v_mfma_f32_16x16x32_bf16 v[184:187], a[48:51], a[64:67], v[184:187]
 s_add_u32 m0, s29, 98304
 v_add_u32 v2, 0x80000, v2
 v_cvt_pk_bf16_f32 v123, v126, v127
 v_mfma_f32_16x16x32_bf16 v[184:187], a[52:55], a[68:71], v[184:187]
 buffer_load_dwordx4 v2, s[16:19], 0 offen lds
 v_mfma_f32_16x16x32_bf16 v[176:179], a[52:55], a[76:79], v[176:179]
 s_add_u32 s59, s56, 32768
 v_cvt_pk_bf16_f32 v128, v128, v129
 v_cvt_pk_bf16_f32 v129, v130, v131
 v_mfma_f32_16x16x32_bf16 v[176:179], a[48:51], a[72:75], v[176:179]
 buffer_store_dwordx4 v[56:59], v1, s[12:15], s59 offen offset:1024 sc1
 v_mfma_f32_16x16x32_bf16 v[168:171], a[48:51], a[80:83], v[168:171]
 v_cvt_pk_bf16_f32 v130, v132, v133
 v_cvt_pk_bf16_f32 v131, v134, v135
 v_mfma_f32_16x16x32_bf16 v[168:171], a[52:55], a[84:87], v[168:171]
 s_add_u32 m0, s29, 102400
 v_cvt_pk_bf16_f32 v136, v136, v137
 v_cvt_pk_bf16_f32 v137, v138, v139
 v_mfma_f32_16x16x32_bf16 v[160:163], a[52:55], a[92:95], v[160:163]
 buffer_load_dwordx4 v2, s[16:19], s48 offen lds
 v_mfma_f32_16x16x32_bf16 v[160:163], a[48:51], a[88:91], v[160:163]
 v_cvt_pk_bf16_f32 v138, v140, v141
 v_cvt_pk_bf16_f32 v139, v142, v143
 v_mfma_f32_16x16x32_bf16 v[164:167], a[56:59], a[88:91], v[164:167]
 v_cvt_pk_bf16_f32 v144, v144, v145
 v_cvt_pk_bf16_f32 v145, v146, v147
 v_mfma_f32_16x16x32_bf16 v[164:167], a[60:63], a[92:95], v[164:167]
 v_cvt_pk_bf16_f32 v146, v148, v149
 v_cvt_pk_bf16_f32 v147, v150, v151
 v_mfma_f32_16x16x32_bf16 v[172:175], a[60:63], a[84:87], v[172:175]
 s_add_u32 m0, s29, 106496
 v_cvt_pk_bf16_f32 v152, v152, v153
 v_cvt_pk_bf16_f32 v153, v154, v155
 v_mfma_f32_16x16x32_bf16 v[172:175], a[56:59], a[80:83], v[172:175]
 buffer_load_dwordx4 v2, s[16:19], s49 offen lds
 v_mfma_f32_16x16x32_bf16 v[180:183], a[56:59], a[72:75], v[180:183]
 s_add_u32 s59, s56, 24576
 v_cvt_pk_bf16_f32 v154, v156, v157
 v_cvt_pk_bf16_f32 v155, v158, v159
 v_mfma_f32_16x16x32_bf16 v[180:183], a[60:63], a[76:79], v[180:183]
 buffer_store_dwordx4 v[64:67], v1, s[12:15], s59 offen offset:0 sc1
 v_mfma_f32_16x16x32_bf16 v[188:191], a[60:63], a[68:71], v[188:191]
 v_mfma_f32_16x16x32_bf16 v[188:191], a[56:59], a[64:67], v[188:191]
 s_add_u32 m0, s29, 110592
 v_mfma_f32_16x16x32_bf16 v[216:219], a[32:35], a[96:99], v[216:219]
 buffer_load_dwordx4 v2, s[16:19], s50 offen lds
 v_mfma_f32_16x16x32_bf16 v[216:219], a[36:39], a[100:103], v[216:219]
 v_cvt_pk_bf16_f32 v160, v160, v161
 v_cvt_pk_bf16_f32 v161, v162, v163
 v_mfma_f32_16x16x32_bf16 v[208:211], a[36:39], a[108:111], v[208:211]
 v_cvt_pk_bf16_f32 v162, v164, v165
 v_cvt_pk_bf16_f32 v163, v166, v167
 v_mfma_f32_16x16x32_bf16 v[208:211], a[32:35], a[104:107], v[208:211]
 v_cvt_pk_bf16_f32 v168, v168, v169
 v_cvt_pk_bf16_f32 v169, v170, v171
 v_mfma_f32_16x16x32_bf16 v[200:203], a[32:35], a[112:115], v[200:203]
 s_add_u32 m0, s29, 114688
 v_cvt_pk_bf16_f32 v170, v172, v173
 v_cvt_pk_bf16_f32 v171, v174, v175
 v_mfma_f32_16x16x32_bf16 v[200:203], a[36:39], a[116:119], v[200:203]
 buffer_load_dwordx4 v2, s[16:19], s51 offen lds
 v_mfma_f32_16x16x32_bf16 v[192:195], a[36:39], a[124:127], v[192:195]
 s_add_u32 s59, s56, 16384
 v_cvt_pk_bf16_f32 v176, v176, v177
 v_cvt_pk_bf16_f32 v177, v178, v179
 v_mfma_f32_16x16x32_bf16 v[192:195], a[32:35], a[120:123], v[192:195]
 buffer_store_dwordx4 v[72:75], v1, s[12:15], s59 offen offset:0 sc1
 v_mfma_f32_16x16x32_bf16 v[196:199], a[40:43], a[120:123], v[196:199]
 v_cvt_pk_bf16_f32 v178, v180, v181
 v_cvt_pk_bf16_f32 v179, v182, v183
 v_mfma_f32_16x16x32_bf16 v[196:199], a[44:47], a[124:127], v[196:199]
 s_add_u32 m0, s29, 118784
 v_cvt_pk_bf16_f32 v184, v184, v185
 v_cvt_pk_bf16_f32 v185, v186, v187
 v_mfma_f32_16x16x32_bf16 v[204:207], a[44:47], a[116:119], v[204:207]
 buffer_load_dwordx4 v2, s[16:19], s52 offen lds
 v_mfma_f32_16x16x32_bf16 v[204:207], a[40:43], a[112:115], v[204:207]
 v_cvt_pk_bf16_f32 v186, v188, v189
 v_cvt_pk_bf16_f32 v187, v190, v191
 v_mfma_f32_16x16x32_bf16 v[212:215], a[40:43], a[104:107], v[212:215]
 v_mfma_f32_16x16x32_bf16 v[212:215], a[44:47], a[108:111], v[212:215]
 v_mfma_f32_16x16x32_bf16 v[220:223], a[44:47], a[100:103], v[220:223]
 s_add_u32 m0, s29, 122880
 v_mfma_f32_16x16x32_bf16 v[220:223], a[40:43], a[96:99], v[220:223]
 buffer_load_dwordx4 v2, s[16:19], s53 offen lds
 v_mfma_f32_16x16x32_bf16 v[248:251], a[48:51], a[96:99], v[248:251]
 s_add_u32 s59, s56, 8192
 v_mfma_f32_16x16x32_bf16 v[248:251], a[52:55], a[100:103], v[248:251]
 s_waitcnt vmcnt(25)
 buffer_store_dwordx4 v[80:83], v1, s[12:15], s59 offen offset:0 sc1
 v_mfma_f32_16x16x32_bf16 v[240:243], a[52:55], a[108:111], v[240:243]
 s_barrier
 v_xor_b32 v7, 0, v6
 v_cvt_pk_bf16_f32 v192, v192, v193
 v_mfma_f32_16x16x32_bf16 v[240:243], a[48:51], a[104:107], v[240:243]
 s_add_u32 m0, s29, 126976
 ds_read_b64_tr_b16 a[64:65], v7 offset:0
 v_cvt_pk_bf16_f32 v193, v194, v195
 v_mfma_f32_16x16x32_bf16 v[232:235], a[48:51], a[112:115], v[232:235]
 ds_read_b64_tr_b16 a[66:67], v7 offset:4096
 buffer_load_dwordx4 v2, s[16:19], s54 offen lds
 v_mfma_f32_16x16x32_bf16 v[232:235], a[52:55], a[116:119], v[232:235]
 ds_read_b64_tr_b16 a[68:69], v7 offset:16384
 v_cvt_pk_bf16_f32 v194, v196, v197
 v_mfma_f32_16x16x32_bf16 v[224:227], a[52:55], a[124:127], v[224:227]
 ds_read_b64_tr_b16 a[70:71], v7 offset:20480
 v_xor_b32 v8, 65536, v6
 v_mfma_f32_16x16x32_bf16 v[224:227], a[48:51], a[120:123], v[224:227]
 s_add_u32 s59, s56, 0
 ds_read_b64_tr_b16 a[72:73], v8 offset:0
 v_cvt_pk_bf16_f32 v195, v198, v199
 v_mfma_f32_16x16x32_bf16 v[228:231], a[56:59], a[120:123], v[228:231]
 ds_read_b64_tr_b16 a[74:75], v8 offset:4096
 buffer_store_dwordx4 v[88:91], v1, s[12:15], s59 offen offset:0 sc1
 v_mfma_f32_16x16x32_bf16 v[228:231], a[60:63], a[124:127], v[228:231]
 ds_read_b64_tr_b16 a[76:77], v8 offset:16384
 v_cvt_pk_bf16_f32 v200, v200, v201
 v_mfma_f32_16x16x32_bf16 v[236:239], a[60:63], a[116:119], v[236:239]
 ds_read_b64_tr_b16 a[78:79], v8 offset:20480
 v_xor_b32 v9, 32, v6
 v_mfma_f32_16x16x32_bf16 v[236:239], a[56:59], a[112:115], v[236:239]
 ds_read_b64_tr_b16 a[80:81], v9 offset:0
 v_cvt_pk_bf16_f32 v201, v202, v203
 v_mfma_f32_16x16x32_bf16 v[244:247], a[56:59], a[104:107], v[244:247]
 ds_read_b64_tr_b16 a[82:83], v9 offset:4096
 v_cvt_pk_bf16_f32 v202, v204, v205
 v_mfma_f32_16x16x32_bf16 v[244:247], a[60:63], a[108:111], v[244:247]
 ds_read_b64_tr_b16 a[84:85], v9 offset:16384
 v_cvt_pk_bf16_f32 v203, v206, v207
 v_mfma_f32_16x16x32_bf16 v[252:255], a[60:63], a[100:103], v[252:255]
 s_add_u32 s59, s56, 24576
 ds_read_b64_tr_b16 a[86:87], v9 offset:20480
 v_xor_b32 v10, 65568, v6
 v_mfma_f32_16x16x32_bf16 v[252:255], a[56:59], a[96:99], v[252:255]
 s_waitcnt lgkmcnt(6)
 ds_read_b64_tr_b16 a[88:89], v10 offset:0
 buffer_store_dwordx4 v[96:99], v1, s[12:15], s59 offen offset:1024 sc1
 v_mfma_f32_16x16x32_bf16 v[28:31], a[64:67], a[128:131], 0
 ds_read_b64_tr_b16 a[90:91], v10 offset:4096
 v_cvt_pk_bf16_f32 v208, v208, v209
 v_mfma_f32_16x16x32_bf16 v[28:31], a[68:71], a[136:139], v[28:31]
 ds_read_b64_tr_b16 a[92:93], v10 offset:16384
 v_xor_b32 v7, 64, v6
 v_mfma_f32_16x16x32_bf16 v[28:31], a[72:75], a[144:147], v[28:31]
 s_waitcnt lgkmcnt(7)
 ds_read_b128 a[112:115], v14 offset:0
 ds_read_b64_tr_b16 a[94:95], v10 offset:20480
 v_mfma_f32_16x16x32_bf16 v[28:31], a[76:79], a[152:155], v[28:31]
 ds_read_b64_tr_b16 a[96:97], v7 offset:0
 v_cvt_pk_bf16_f32 v209, v210, v211
 v_mfma_f32_16x16x32_bf16 v[44:47], a[64:67], a[132:135], 0
 ds_read_b128 a[120:123], v3 offset:0
 ds_read_b64_tr_b16 a[98:99], v7 offset:4096
 v_mfma_f32_16x16x32_bf16 v[44:47], a[68:71], a[140:143], v[44:47]
 s_add_u32 s59, s56, 16384
 ds_read_b64_tr_b16 a[100:101], v7 offset:16384
 v_xor_b32 v8, 65600, v6
 v_mfma_f32_16x16x32_bf16 v[44:47], a[72:75], a[148:151], v[44:47]
 ds_read_b128 a[116:119], v14 offset:2048
 ds_read_b64_tr_b16 a[102:103], v7 offset:20480
 buffer_store_dwordx4 v[104:107], v1, s[12:15], s59 offen offset:1024 sc1
 v_mfma_f32_16x16x32_bf16 v[44:47], a[76:79], a[156:159], v[44:47]
 s_waitcnt lgkmcnt(9)
 ds_read_b64_tr_b16 a[104:105], v8 offset:0
 v_cvt_pk_bf16_f32 v210, v212, v213
 v_mfma_f32_16x16x32_bf16 v[52:55], a[80:83], a[128:131], 0
 ds_read_b128 a[124:127], v3 offset:2048
 ds_read_b64_tr_b16 a[106:107], v8 offset:4096
 v_mfma_f32_16x16x32_bf16 v[52:55], a[84:87], a[136:139], v[52:55]
 ds_read_b64_tr_b16 a[108:109], v8 offset:16384
 v_cvt_pk_bf16_f32 v211, v214, v215
 v_mfma_f32_16x16x32_bf16 v[52:55], a[88:91], a[144:147], v[52:55]
 s_waitcnt lgkmcnt(10)
 ds_read_b64_tr_b16 a[110:111], v8 offset:20480
 v_xor_b32 v9, 96, v6
 v_mfma_f32_16x16x32_bf16 v[52:55], a[92:95], a[152:155], v[52:55]
 ds_read_b64_tr_b16 a[64:65], v9 offset:0
 v_cvt_pk_bf16_f32 v216, v216, v217
 v_mfma_f32_16x16x32_bf16 v[60:63], a[80:83], a[132:135], 0
 s_add_u32 s59, s56, 8192
 ds_read_b64_tr_b16 a[66:67], v9 offset:4096
 v_cvt_pk_bf16_f32 v217, v218, v219
 v_mfma_f32_16x16x32_bf16 v[60:63], a[84:87], a[140:143], v[60:63]
 ds_read_b64_tr_b16 a[68:69], v9 offset:16384
 buffer_store_dwordx4 v[112:115], v1, s[12:15], s59 offen offset:1024 sc1
 v_mfma_f32_16x16x32_bf16 v[60:63], a[88:91], a[148:151], v[60:63]
 ds_read_b64_tr_b16 a[70:71], v9 offset:20480
 v_xor_b32 v10, 65632, v6
 v_mfma_f32_16x16x32_bf16 v[60:63], a[92:95], a[156:159], v[60:63]
 s_waitcnt lgkmcnt(6)
 ds_read_b64_tr_b16 a[72:73], v10 offset:0
 v_cvt_pk_bf16_f32 v218, v220, v221
 v_mfma_f32_16x16x32_bf16 v[20:23], a[96:99], a[128:131], 0
 ds_read_b64_tr_b16 a[74:75], v10 offset:4096
 v_cvt_pk_bf16_f32 v219, v222, v223
 v_mfma_f32_16x16x32_bf16 v[20:23], a[100:103], a[136:139], v[20:23]
 s_waitcnt lgkmcnt(8)
 ds_read_b64_tr_b16 a[76:77], v10 offset:16384
 v_xor_b32 v7, 128, v6
 v_mfma_f32_16x16x32_bf16 v[20:23], a[104:107], a[144:147], v[20:23]
 s_waitcnt lgkmcnt(7)
 s_barrier
 ds_read_b64_tr_b16 a[78:79], v10 offset:20480
 v_mfma_f32_16x16x32_bf16 v[20:23], a[108:111], a[152:155], v[20:23]
 s_add_u32 m0, s29, 131072
 ds_read_b64_tr_b16 a[80:81], v7 offset:0
 v_add_u32 v2, 0x80000, v2
 v_mfma_f32_16x16x32_bf16 v[36:39], a[96:99], a[132:135], 0
 ds_read_b64_tr_b16 a[82:83], v7 offset:4096
 buffer_load_dwordx4 v2, s[16:19], 0 offen lds
 v_mfma_f32_16x16x32_bf16 v[36:39], a[100:103], a[140:143], v[36:39]
 ds_read_b64_tr_b16 a[84:85], v7 offset:16384
 v_cvt_pk_bf16_f32 v224, v224, v225
 v_mfma_f32_16x16x32_bf16 v[36:39], a[104:107], a[148:151], v[36:39]
 s_add_u32 s59, s56, 0
 ds_read_b64_tr_b16 a[86:87], v7 offset:20480
 v_xor_b32 v8, 65664, v6
 v_mfma_f32_16x16x32_bf16 v[36:39], a[108:111], a[156:159], v[36:39]
 s_waitcnt lgkmcnt(6)
 ds_read_b64_tr_b16 a[88:89], v8 offset:0
 buffer_store_dwordx4 v[120:123], v1, s[12:15], s59 offen offset:1024 sc1
 v_mfma_f32_16x16x32_bf16 v[68:71], a[64:67], a[128:131], 0
 ds_read_b64_tr_b16 a[90:91], v8 offset:4096
 v_cvt_pk_bf16_f32 v225, v226, v227
 v_mfma_f32_16x16x32_bf16 v[68:71], a[68:71], a[136:139], v[68:71]
 s_add_u32 m0, s29, 135168
 ds_read_b64_tr_b16 a[92:93], v8 offset:16384
 v_cvt_pk_bf16_f32 v226, v228, v229
 v_mfma_f32_16x16x32_bf16 v[68:71], a[72:75], a[144:147], v[68:71]
 s_waitcnt lgkmcnt(7)
 ds_read_b64_tr_b16 a[94:95], v8 offset:20480
 v_xor_b32 v9, 160, v6
 v_mfma_f32_16x16x32_bf16 v[68:71], a[76:79], a[152:155], v[68:71]
 ds_read_b64_tr_b16 a[96:97], v9 offset:0
 buffer_load_dwordx4 v2, s[16:19], s48 offen lds
 v_mfma_f32_16x16x32_bf16 v[76:79], a[64:67], a[132:135], 0
 ds_read_b64_tr_b16 a[98:99], v9 offset:4096
 v_cvt_pk_bf16_f32 v227, v230, v231
 v_mfma_f32_16x16x32_bf16 v[76:79], a[68:71], a[140:143], v[76:79]
 ds_read_b64_tr_b16 a[100:101], v9 offset:16384
 v_cvt_pk_bf16_f32 v232, v232, v233
 v_mfma_f32_16x16x32_bf16 v[76:79], a[72:75], a[148:151], v[76:79]
 s_add_u32 s59, s56, 24576
 ds_read_b64_tr_b16 a[102:103], v9 offset:20480
 v_xor_b32 v10, 65696, v6
 v_mfma_f32_16x16x32_bf16 v[76:79], a[76:79], a[156:159], v[76:79]
 s_waitcnt lgkmcnt(6)
 ds_read_b64_tr_b16 a[104:105], v10 offset:0
 buffer_store_dwordx4 v[128:131], v1, s[12:15], s59 offen offset:2048 sc1
 v_mfma_f32_16x16x32_bf16 v[84:87], a[80:83], a[128:131], 0
 s_add_u32 m0, s29, 139264
 ds_read_b64_tr_b16 a[106:107], v10 offset:4096
 v_cvt_pk_bf16_f32 v233, v234, v235
 v_mfma_f32_16x16x32_bf16 v[84:87], a[84:87], a[136:139], v[84:87]
 ds_read_b64_tr_b16 a[108:109], v10 offset:16384
 buffer_load_dwordx4 v2, s[16:19], s49 offen lds
 v_mfma_f32_16x16x32_bf16 v[84:87], a[88:91], a[144:147], v[84:87]
 s_waitcnt lgkmcnt(7)
 ds_read_b64_tr_b16 a[110:111], v10 offset:20480
 v_xor_b32 v7, 192, v6
 v_mfma_f32_16x16x32_bf16 v[84:87], a[92:95], a[152:155], v[84:87]
 ds_read_b64_tr_b16 a[64:65], v7 offset:0
 v_cvt_pk_bf16_f32 v234, v236, v237
 v_mfma_f32_16x16x32_bf16 v[92:95], a[80:83], a[132:135], 0
 ds_read_b64_tr_b16 a[66:67], v7 offset:4096
 v_cvt_pk_bf16_f32 v235, v238, v239
 v_mfma_f32_16x16x32_bf16 v[92:95], a[84:87], a[140:143], v[92:95]
 ds_read_b64_tr_b16 a[68:69], v7 offset:16384
 v_cvt_pk_bf16_f32 v240, v240, v241
 v_mfma_f32_16x16x32_bf16 v[92:95], a[88:91], a[148:151], v[92:95]
 s_add_u32 m0, s29, 143360
 ds_read_b64_tr_b16 a[70:71], v7 offset:20480
 v_xor_b32 v8, 65728, v6
 v_mfma_f32_16x16x32_bf16 v[92:95], a[92:95], a[156:159], v[92:95]
 s_waitcnt lgkmcnt(6)
 ds_read_b64_tr_b16 a[72:73], v8 offset:0
 buffer_load_dwordx4 v2, s[16:19], s50 offen lds
 v_mfma_f32_16x16x32_bf16 v[100:103], a[96:99], a[128:131], 0
 s_add_u32 s59, s56, 16384
 ds_read_b64_tr_b16 a[74:75], v8 offset:4096
 v_cvt_pk_bf16_f32 v241, v242, v243
 v_mfma_f32_16x16x32_bf16 v[100:103], a[100:103], a[136:139], v[100:103]
 ds_read_b64_tr_b16 a[76:77], v8 offset:16384
 buffer_store_dwordx4 v[136:139], v1, s[12:15], s59 offen offset:2048 sc1
 v_mfma_f32_16x16x32_bf16 v[100:103], a[104:107], a[144:147], v[100:103]
 s_waitcnt lgkmcnt(7)
 ds_read_b64_tr_b16 a[78:79], v8 offset:20480
 v_xor_b32 v9, 224, v6
 v_mfma_f32_16x16x32_bf16 v[100:103], a[108:111], a[152:155], v[100:103]
 s_and_b32 s36, s95, 31
 ds_read_b64_tr_b16 a[80:81], v9 offset:0
 v_cvt_pk_bf16_f32 v242, v244, v245
 v_mfma_f32_16x16x32_bf16 v[108:111], a[96:99], a[132:135], 0
 s_add_u32 m0, s29, 147456
 ds_read_b64_tr_b16 a[82:83], v9 offset:4096
 v_cvt_pk_bf16_f32 v243, v246, v247
 v_mfma_f32_16x16x32_bf16 v[108:111], a[100:103], a[140:143], v[108:111]
 ds_read_b64_tr_b16 a[84:85], v9 offset:16384
 buffer_load_dwordx4 v2, s[16:19], s51 offen lds
 v_mfma_f32_16x16x32_bf16 v[108:111], a[104:107], a[148:151], v[108:111]
 s_add_u32 s59, s56, 8192
 ds_read_b64_tr_b16 a[86:87], v9 offset:20480
 v_xor_b32 v10, 65760, v6
 v_mfma_f32_16x16x32_bf16 v[108:111], a[108:111], a[156:159], v[108:111]
 s_waitcnt lgkmcnt(6)
 ds_read_b64_tr_b16 a[88:89], v10 offset:0
 v_cvt_pk_bf16_f32 v248, v248, v249
 v_mfma_f32_16x16x32_bf16 v[116:119], a[64:67], a[128:131], 0
 ds_read_b64_tr_b16 a[90:91], v10 offset:4096
 buffer_store_dwordx4 v[144:147], v1, s[12:15], s59 offen offset:2048 sc1
 v_mfma_f32_16x16x32_bf16 v[116:119], a[68:71], a[136:139], v[116:119]
 s_add_u32 m0, s29, 151552
 ds_read_b64_tr_b16 a[92:93], v10 offset:16384
 v_cvt_pk_bf16_f32 v249, v250, v251
 v_mfma_f32_16x16x32_bf16 v[116:119], a[72:75], a[144:147], v[116:119]
 s_waitcnt lgkmcnt(7)
 ds_read_b64_tr_b16 a[94:95], v10 offset:20480
 v_xor_b32 v7, 256, v6
 v_mfma_f32_16x16x32_bf16 v[116:119], a[76:79], a[152:155], v[116:119]
 ds_read_b64_tr_b16 a[96:97], v7 offset:0
 buffer_load_dwordx4 v2, s[16:19], s52 offen lds
 v_mfma_f32_16x16x32_bf16 v[124:127], a[64:67], a[132:135], 0
 s_lshr_b32 s37, s95, 5
 ds_read_b64_tr_b16 a[98:99], v7 offset:4096
 v_cvt_pk_bf16_f32 v250, v252, v253
 v_mfma_f32_16x16x32_bf16 v[124:127], a[68:71], a[140:143], v[124:127]
 s_lshl_b32 s38, s3, 4
 ds_read_b64_tr_b16 a[100:101], v7 offset:16384
 v_cvt_pk_bf16_f32 v251, v254, v255
 v_mfma_f32_16x16x32_bf16 v[124:127], a[72:75], a[148:151], v[124:127]
 s_add_u32 s59, s56, 0
 ds_read_b64_tr_b16 a[102:103], v7 offset:20480
 v_xor_b32 v8, 65792, v6
 v_mfma_f32_16x16x32_bf16 v[124:127], a[76:79], a[156:159], v[124:127]
 s_waitcnt lgkmcnt(6)
 ds_read_b64_tr_b16 a[104:105], v8 offset:0
 buffer_store_dwordx4 v[152:155], v1, s[12:15], s59 offen offset:2048 sc1
 v_mfma_f32_16x16x32_bf16 v[132:135], a[80:83], a[128:131], 0
 s_add_u32 m0, s29, 155648
 ds_read_b64_tr_b16 a[106:107], v8 offset:4096
 v_accvgpr_read_b32 v11, a245
 v_mfma_f32_16x16x32_bf16 v[132:135], a[84:87], a[136:139], v[132:135]
 ds_read_b64_tr_b16 a[108:109], v8 offset:16384
 buffer_load_dwordx4 v2, s[16:19], s53 offen lds
 v_mfma_f32_16x16x32_bf16 v[132:135], a[88:91], a[144:147], v[132:135]
 s_waitcnt lgkmcnt(7)
 ds_read_b64_tr_b16 a[110:111], v8 offset:20480
 v_xor_b32 v9, 288, v6
 v_mfma_f32_16x16x32_bf16 v[132:135], a[92:95], a[152:155], v[132:135]
 s_lshl_b32 s39, s36, 6
 ds_read_b64_tr_b16 a[64:65], v9 offset:0
 v_mov_b32 v12, 0
 v_mfma_f32_16x16x32_bf16 v[140:143], a[80:83], a[132:135], 0
 ds_read_b64_tr_b16 a[66:67], v9 offset:4096
 global_load_dword a248, v12, s[90:91] offset:128 sc1
 v_mfma_f32_16x16x32_bf16 v[140:143], a[84:87], a[140:143], v[140:143]
 s_add_u32 s38, s38, s39
 ds_read_b64_tr_b16 a[68:69], v9 offset:16384
 v_and_b32 v12, 11, v0
 v_mfma_f32_16x16x32_bf16 v[140:143], a[88:91], a[148:151], v[140:143]
 s_add_u32 m0, s29, 159744
 ds_read_b64_tr_b16 a[70:71], v9 offset:20480
 v_xor_b32 v10, 65824, v6
 v_mfma_f32_16x16x32_bf16 v[140:143], a[92:95], a[156:159], v[140:143]
 s_waitcnt lgkmcnt(6)
 ds_read_b64_tr_b16 a[72:73], v10 offset:0
 buffer_load_dwordx4 v2, s[16:19], s54 offen lds
 v_mfma_f32_16x16x32_bf16 v[148:151], a[96:99], a[128:131], 0
 s_add_u32 s59, s56, 24576
 ds_read_b64_tr_b16 a[74:75], v10 offset:4096
 v_lshlrev_b32 v12, 2, v12
 v_mfma_f32_16x16x32_bf16 v[148:151], a[100:103], a[136:139], v[148:151]
 ds_read_b64_tr_b16 a[76:77], v10 offset:16384
 buffer_store_dwordx4 v[160:163], v1, s[12:15], s59 offen offset:3072 sc1
 v_mfma_f32_16x16x32_bf16 v[148:151], a[104:107], a[144:147], v[148:151]
 s_waitcnt lgkmcnt(7)
 ds_read_b64_tr_b16 a[78:79], v10 offset:20480
 v_xor_b32 v7, 320, v6
 v_mfma_f32_16x16x32_bf16 v[148:151], a[108:111], a[152:155], v[148:151]
 s_mul_i32 s38, s38, 896
 ds_read_b64_tr_b16 a[80:81], v7 offset:0
 v_mfma_f32_16x16x32_bf16 v[156:159], a[96:99], a[132:135], 0
 s_lshl_b32 s39, s37, 7
 ds_read_b64_tr_b16 a[82:83], v7 offset:4096
 v_mfma_f32_16x16x32_bf16 v[156:159], a[100:103], a[140:143], v[156:159]
 s_add_u32 s38, s38, s39
 ds_read_b64_tr_b16 a[84:85], v7 offset:16384
 v_mfma_f32_16x16x32_bf16 v[156:159], a[104:107], a[148:151], v[156:159]
 s_add_u32 s59, s56, 16384
 ds_read_b64_tr_b16 a[86:87], v7 offset:20480
 v_xor_b32 v8, 65856, v6
 v_mfma_f32_16x16x32_bf16 v[156:159], a[108:111], a[156:159], v[156:159]
 s_waitcnt lgkmcnt(6)
 ds_read_b64_tr_b16 a[88:89], v8 offset:0
 v_mfma_f32_16x16x32_bf16 v[164:167], a[64:67], a[128:131], 0
 ds_read_b64_tr_b16 a[90:91], v8 offset:4096
 buffer_store_dwordx4 v[168:171], v1, s[12:15], s59 offen offset:3072 sc1
 v_mfma_f32_16x16x32_bf16 v[164:167], a[68:71], a[136:139], v[164:167]
 s_lshl_b32 s39, s37, 9
 ds_read_b64_tr_b16 a[92:93], v8 offset:16384
 v_mfma_f32_16x16x32_bf16 v[164:167], a[72:75], a[144:147], v[164:167]
 s_waitcnt lgkmcnt(7)
 ds_read_b64_tr_b16 a[94:95], v8 offset:20480
 v_xor_b32 v9, 352, v6
 v_mfma_f32_16x16x32_bf16 v[164:167], a[76:79], a[152:155], v[164:167]
 s_mov_b32 s4, s66
 ds_read_b64_tr_b16 a[96:97], v9 offset:0
 v_mfma_f32_16x16x32_bf16 v[172:175], a[64:67], a[132:135], 0
 s_mov_b32 s5, s67
 ds_read_b64_tr_b16 a[98:99], v9 offset:4096
 v_mfma_f32_16x16x32_bf16 v[172:175], a[68:71], a[140:143], v[172:175]
 s_mov_b32 s6, 1835008
 ds_read_b64_tr_b16 a[100:101], v9 offset:16384
 v_mfma_f32_16x16x32_bf16 v[172:175], a[72:75], a[148:151], v[172:175]
 s_add_u32 s59, s56, 8192
 ds_read_b64_tr_b16 a[102:103], v9 offset:20480
 v_xor_b32 v10, 65888, v6
 v_mfma_f32_16x16x32_bf16 v[172:175], a[76:79], a[156:159], v[172:175]
 s_waitcnt lgkmcnt(6)
 ds_read_b64_tr_b16 a[104:105], v10 offset:0
 buffer_store_dwordx4 v[176:179], v1, s[12:15], s59 offen offset:3072 sc1
 v_mfma_f32_16x16x32_bf16 v[180:183], a[80:83], a[128:131], 0
 s_mov_b32 s7, 0x20000
 ds_read_b64_tr_b16 a[106:107], v10 offset:4096
 v_mfma_f32_16x16x32_bf16 v[180:183], a[84:87], a[136:139], v[180:183]
 s_mov_b32 s8, s68
 ds_read_b64_tr_b16 a[108:109], v10 offset:16384
 v_mfma_f32_16x16x32_bf16 v[180:183], a[88:91], a[144:147], v[180:183]
 s_waitcnt lgkmcnt(7)
 ds_read_b64_tr_b16 a[110:111], v10 offset:20480
 v_xor_b32 v7, 384, v6
 v_mfma_f32_16x16x32_bf16 v[180:183], a[92:95], a[152:155], v[180:183]
 s_mov_b32 s9, s69
 ds_read_b64_tr_b16 a[64:65], v7 offset:0
 v_mfma_f32_16x16x32_bf16 v[188:191], a[80:83], a[132:135], 0
 s_mov_b32 s10, 1835008
 ds_read_b64_tr_b16 a[66:67], v7 offset:4096
 v_mfma_f32_16x16x32_bf16 v[188:191], a[84:87], a[140:143], v[188:191]
 s_mov_b32 s11, 0x20000
 ds_read_b64_tr_b16 a[68:69], v7 offset:16384
 v_mfma_f32_16x16x32_bf16 v[188:191], a[88:91], a[148:151], v[188:191]
 s_add_u32 s59, s56, 0
 ds_read_b64_tr_b16 a[70:71], v7 offset:20480
 v_xor_b32 v8, 65920, v6
 v_mfma_f32_16x16x32_bf16 v[188:191], a[92:95], a[156:159], v[188:191]
 s_waitcnt lgkmcnt(6)
 ds_read_b64_tr_b16 a[72:73], v8 offset:0
 buffer_store_dwordx4 v[184:187], v1, s[12:15], s59 offen offset:3072 sc1
 v_mfma_f32_16x16x32_bf16 v[196:199], a[96:99], a[128:131], 0
 s_mov_b32 s20, s70
 ds_read_b64_tr_b16 a[74:75], v8 offset:4096
 v_mfma_f32_16x16x32_bf16 v[196:199], a[100:103], a[136:139], v[196:199]
 s_mov_b32 s21, s71
 ds_read_b64_tr_b16 a[76:77], v8 offset:16384
 v_mfma_f32_16x16x32_bf16 v[196:199], a[104:107], a[144:147], v[196:199]
 s_waitcnt lgkmcnt(7)
 ds_read_b64_tr_b16 a[78:79], v8 offset:20480
 v_xor_b32 v9, 416, v6
 v_mfma_f32_16x16x32_bf16 v[196:199], a[108:111], a[152:155], v[196:199]
 s_mov_b32 s22, 3584
 ds_read_b64_tr_b16 a[80:81], v9 offset:0
 v_mfma_f32_16x16x32_bf16 v[204:207], a[96:99], a[132:135], 0
 s_mov_b32 s23, 0x20000
 ds_read_b64_tr_b16 a[82:83], v9 offset:4096
 v_mfma_f32_16x16x32_bf16 v[204:207], a[100:103], a[140:143], v[204:207]
 ds_read_b64_tr_b16 a[84:85], v9 offset:16384
 v_lshrrev_b32 v120, 3, v0
 v_mfma_f32_16x16x32_bf16 v[204:207], a[104:107], a[148:151], v[204:207]
 s_add_u32 s59, s56, 57344
 ds_read_b64_tr_b16 a[86:87], v9 offset:20480
 v_xor_b32 v10, 65952, v6
 v_mfma_f32_16x16x32_bf16 v[204:207], a[108:111], a[156:159], v[204:207]
 s_waitcnt lgkmcnt(6)
 ds_read_b64_tr_b16 a[88:89], v10 offset:0
 buffer_store_dwordx4 v[192:195], v1, s[12:15], s59 offen offset:2048 sc1
 v_mfma_f32_16x16x32_bf16 v[212:215], a[64:67], a[128:131], 0
 ds_read_b64_tr_b16 a[90:91], v10 offset:4096
 v_mul_u32_u24 v120, 1792, v120
 v_mfma_f32_16x16x32_bf16 v[212:215], a[68:71], a[136:139], v[212:215]
 ds_read_b64_tr_b16 a[92:93], v10 offset:16384
 v_and_b32 v121, 7, v0
 v_mfma_f32_16x16x32_bf16 v[212:215], a[72:75], a[144:147], v[212:215]
 s_waitcnt lgkmcnt(7)
 ds_read_b64_tr_b16 a[94:95], v10 offset:20480
 v_xor_b32 v7, 448, v6
 v_mfma_f32_16x16x32_bf16 v[212:215], a[76:79], a[152:155], v[212:215]
 ds_read_b64_tr_b16 a[96:97], v7 offset:0
 v_lshl_add_u32 v120, v121, 4, v120
 v_mfma_f32_16x16x32_bf16 v[220:223], a[64:67], a[132:135], 0
 ds_read_b64_tr_b16 a[98:99], v7 offset:4096
 v_add_u32 v120, s38, v120
 v_mfma_f32_16x16x32_bf16 v[220:223], a[68:71], a[140:143], v[220:223]
 ds_read_b64_tr_b16 a[100:101], v7 offset:16384
 v_lshlrev_b32 v121, 6, v121
 v_mfma_f32_16x16x32_bf16 v[220:223], a[72:75], a[148:151], v[220:223]
 s_add_u32 s59, s56, 49152
 ds_read_b64_tr_b16 a[102:103], v7 offset:20480
 v_xor_b32 v8, 65984, v6
 v_mfma_f32_16x16x32_bf16 v[220:223], a[76:79], a[156:159], v[220:223]
 s_waitcnt lgkmcnt(6)
 ds_read_b64_tr_b16 a[104:105], v8 offset:0
 buffer_store_dwordx4 v[200:203], v1, s[12:15], s59 offen offset:2048 sc1
 v_mfma_f32_16x16x32_bf16 v[228:231], a[80:83], a[128:131], 0
 ds_read_b64_tr_b16 a[106:107], v8 offset:4096
 v_subrev_u32 v122, 2688, v120
 v_mfma_f32_16x16x32_bf16 v[228:231], a[84:87], a[136:139], v[228:231]
 ds_read_b64_tr_b16 a[108:109], v8 offset:16384
 v_subrev_u32 v123, 1792, v120
 v_mfma_f32_16x16x32_bf16 v[228:231], a[88:91], a[144:147], v[228:231]
 s_waitcnt lgkmcnt(7)
 ds_read_b64_tr_b16 a[110:111], v8 offset:20480
 v_xor_b32 v9, 480, v6
 v_mfma_f32_16x16x32_bf16 v[228:231], a[92:95], a[152:155], v[228:231]
 ds_read_b64_tr_b16 a[64:65], v9 offset:0
 v_subrev_u32 v128, 896, v120
 v_mfma_f32_16x16x32_bf16 v[236:239], a[80:83], a[132:135], 0
 ds_read_b64_tr_b16 a[66:67], v9 offset:4096
 v_mfma_f32_16x16x32_bf16 v[236:239], a[84:87], a[140:143], v[236:239]
 ds_read_b64_tr_b16 a[68:69], v9 offset:16384
 v_mfma_f32_16x16x32_bf16 v[236:239], a[88:91], a[148:151], v[236:239]
 s_add_u32 s59, s56, 40960
 ds_read_b64_tr_b16 a[70:71], v9 offset:20480
 v_xor_b32 v10, 66016, v6
 v_mfma_f32_16x16x32_bf16 v[236:239], a[92:95], a[156:159], v[236:239]
 s_waitcnt lgkmcnt(6)
 ds_read_b64_tr_b16 a[72:73], v10 offset:0
 buffer_store_dwordx4 v[208:211], v1, s[12:15], s59 offen offset:2048 sc1
 v_mfma_f32_16x16x32_bf16 v[244:247], a[96:99], a[128:131], 0
 ds_read_b64_tr_b16 a[74:75], v10 offset:4096
 v_mfma_f32_16x16x32_bf16 v[244:247], a[100:103], a[136:139], v[244:247]
 s_waitcnt vmcnt(25)
 ds_read_b64_tr_b16 a[76:77], v10 offset:16384
 v_xor_b32 v7, 32768, v6
 v_mfma_f32_16x16x32_bf16 v[244:247], a[104:107], a[144:147], v[244:247]
 s_waitcnt lgkmcnt(7)
 s_barrier
 ds_read_b64_tr_b16 a[78:79], v10 offset:20480
 v_mfma_f32_16x16x32_bf16 v[244:247], a[108:111], a[152:155], v[244:247]
 ds_read_b64_tr_b16 a[80:81], v7 offset:0
 v_mfma_f32_16x16x32_bf16 v[252:255], a[96:99], a[132:135], 0
 ds_read_b64_tr_b16 a[82:83], v7 offset:4096
 v_mfma_f32_16x16x32_bf16 v[252:255], a[100:103], a[140:143], v[252:255]
 ds_read_b64_tr_b16 a[84:85], v7 offset:16384
 v_mfma_f32_16x16x32_bf16 v[252:255], a[104:107], a[148:151], v[252:255]
 s_add_u32 s59, s56, 32768
 ds_read_b64_tr_b16 a[86:87], v7 offset:20480
 v_xor_b32 v8, 98304, v6
 v_mfma_f32_16x16x32_bf16 v[252:255], a[108:111], a[156:159], v[252:255]
 s_waitcnt lgkmcnt(6)
 ds_read_b64_tr_b16 a[88:89], v8 offset:0
 buffer_store_dwordx4 v[216:219], v1, s[12:15], s59 offen offset:2048 sc1
 v_mfma_f32_16x16x32_bf16 v[16:19], a[64:67], a[128:131], 0
 ds_read_b64_tr_b16 a[90:91], v8 offset:4096
 v_mfma_f32_16x16x32_bf16 v[16:19], a[68:71], a[136:139], v[16:19]
 ds_read_b64_tr_b16 a[92:93], v8 offset:16384
 v_mfma_f32_16x16x32_bf16 v[16:19], a[72:75], a[144:147], v[16:19]
 s_waitcnt lgkmcnt(7)
 ds_read_b64_tr_b16 a[94:95], v8 offset:20480
 v_xor_b32 v9, 32800, v6
 v_mfma_f32_16x16x32_bf16 v[16:19], a[76:79], a[152:155], v[16:19]
 ds_read_b64_tr_b16 a[96:97], v9 offset:0
 v_mfma_f32_16x16x32_bf16 v[24:27], a[64:67], a[132:135], 0
 s_waitcnt lgkmcnt(9)
 ds_read_b64_tr_b16 a[98:99], v9 offset:4096
 v_mfma_f32_16x16x32_bf16 v[24:27], a[68:71], a[140:143], v[24:27]
 s_barrier
 ds_read_b64_tr_b16 a[100:101], v9 offset:16384
 v_mfma_f32_16x16x32_bf16 v[24:27], a[72:75], a[148:151], v[24:27]
 s_add_u32 m0, s29, 0
 ds_read_b64_tr_b16 a[102:103], v9 offset:20480
 v_xor_b32 v10, 98336, v6
 v_mfma_f32_16x16x32_bf16 v[24:27], a[76:79], a[156:159], v[24:27]
 s_waitcnt lgkmcnt(6)
 ds_read_b64_tr_b16 a[104:105], v10 offset:0
 v_add_u32 v2, 0x80000, v2
 v_mfma_f32_16x16x32_bf16 v[28:31], a[80:83], a[160:163], v[28:31]
 ds_read_b64_tr_b16 a[106:107], v10 offset:4096
 buffer_load_dwordx4 v2, s[16:19], 0 offen lds
 v_mfma_f32_16x16x32_bf16 v[28:31], a[84:87], a[168:171], v[28:31]
 s_add_u32 s59, s56, 57344
 ds_read_b64_tr_b16 a[108:109], v10 offset:16384
 v_mfma_f32_16x16x32_bf16 v[28:31], a[88:91], a[176:179], v[28:31]
 s_waitcnt lgkmcnt(7)
 ds_read_b64_tr_b16 a[110:111], v10 offset:20480
 v_xor_b32 v7, 32832, v6
 v_mfma_f32_16x16x32_bf16 v[28:31], a[92:95], a[184:187], v[28:31]
 ds_read_b64_tr_b16 a[64:65], v7 offset:0
 buffer_store_dwordx4 v[224:227], v1, s[12:15], s59 offen offset:3072 sc1
 v_mfma_f32_16x16x32_bf16 v[44:47], a[80:83], a[164:167], v[44:47]
 s_add_u32 m0, s29, 4096
 ds_read_b64_tr_b16 a[66:67], v7 offset:4096
 v_add_u32 v4, 4096, v1
 v_mfma_f32_16x16x32_bf16 v[44:47], a[84:87], a[172:175], v[44:47]
 ds_read_b64_tr_b16 a[68:69], v7 offset:16384
 buffer_load_dwordx4 v2, s[16:19], s48 offen lds
 v_mfma_f32_16x16x32_bf16 v[44:47], a[88:91], a[180:183], v[44:47]
 ds_read_b64_tr_b16 a[70:71], v7 offset:20480
 v_xor_b32 v8, 98368, v6
 v_mfma_f32_16x16x32_bf16 v[44:47], a[92:95], a[188:191], v[44:47]
 s_waitcnt lgkmcnt(6)
 ds_read_b64_tr_b16 a[72:73], v8 offset:0
 v_mfma_f32_16x16x32_bf16 v[52:55], a[96:99], a[160:163], v[52:55]
 ds_read_b64_tr_b16 a[74:75], v8 offset:4096
 v_mfma_f32_16x16x32_bf16 v[52:55], a[100:103], a[168:171], v[52:55]
 s_add_u32 m0, s29, 8192
 ds_read_b64_tr_b16 a[76:77], v8 offset:16384
 v_mfma_f32_16x16x32_bf16 v[52:55], a[104:107], a[176:179], v[52:55]
 s_waitcnt lgkmcnt(7)
 ds_read_b64_tr_b16 a[78:79], v8 offset:20480
 v_xor_b32 v9, 32864, v6
 v_mfma_f32_16x16x32_bf16 v[52:55], a[108:111], a[184:187], v[52:55]
 ds_read_b64_tr_b16 a[80:81], v9 offset:0
 buffer_load_dwordx4 v2, s[16:19], s49 offen lds
 v_mfma_f32_16x16x32_bf16 v[60:63], a[96:99], a[164:167], v[60:63]
 s_add_u32 s59, s56, 49152
 ds_read_b64_tr_b16 a[82:83], v9 offset:4096
 v_mfma_f32_16x16x32_bf16 v[60:63], a[100:103], a[172:175], v[60:63]
 ds_read_b64_tr_b16 a[84:85], v9 offset:16384
 buffer_store_dwordx4 v[232:235], v1, s[12:15], s59 offen offset:3072 sc1
 v_mfma_f32_16x16x32_bf16 v[60:63], a[104:107], a[180:183], v[60:63]
 s_add_u32 m0, s29, 12288
 ds_read_b64_tr_b16 a[86:87], v9 offset:20480
 v_xor_b32 v10, 98400, v6
 v_mfma_f32_16x16x32_bf16 v[60:63], a[108:111], a[188:191], v[60:63]
 s_waitcnt lgkmcnt(6)
 ds_read_b64_tr_b16 a[88:89], v10 offset:0
 v_mfma_f32_16x16x32_bf16 v[20:23], a[64:67], a[160:163], v[20:23]
 ds_read_b64_tr_b16 a[90:91], v10 offset:4096
 buffer_load_dwordx4 v2, s[16:19], s50 offen lds
 v_mfma_f32_16x16x32_bf16 v[20:23], a[68:71], a[168:171], v[20:23]
 ds_read_b64_tr_b16 a[92:93], v10 offset:16384
 v_mfma_f32_16x16x32_bf16 v[20:23], a[72:75], a[176:179], v[20:23]
 s_waitcnt lgkmcnt(7)
 ds_read_b64_tr_b16 a[94:95], v10 offset:20480
 v_xor_b32 v7, 32896, v6
 v_mfma_f32_16x16x32_bf16 v[20:23], a[76:79], a[184:187], v[20:23]
 ds_read_b64_tr_b16 a[96:97], v7 offset:0
 v_mfma_f32_16x16x32_bf16 v[36:39], a[64:67], a[164:167], v[36:39]
 s_add_u32 m0, s29, 16384
 ds_read_b64_tr_b16 a[98:99], v7 offset:4096
 v_mfma_f32_16x16x32_bf16 v[36:39], a[68:71], a[172:175], v[36:39]
 ds_read_b64_tr_b16 a[100:101], v7 offset:16384
 buffer_load_dwordx4 v2, s[16:19], s51 offen lds
 v_mfma_f32_16x16x32_bf16 v[36:39], a[72:75], a[180:183], v[36:39]
 s_add_u32 s59, s56, 40960
 ds_read_b64_tr_b16 a[102:103], v7 offset:20480
 v_xor_b32 v8, 98432, v6
 v_mfma_f32_16x16x32_bf16 v[36:39], a[76:79], a[188:191], v[36:39]
 s_waitcnt lgkmcnt(6)
 ds_read_b64_tr_b16 a[104:105], v8 offset:0
 buffer_store_dwordx4 v[240:243], v1, s[12:15], s59 offen offset:3072 sc1
 v_mfma_f32_16x16x32_bf16 v[68:71], a[80:83], a[160:163], v[68:71]
 ds_read_b64_tr_b16 a[106:107], v8 offset:4096
 v_mfma_f32_16x16x32_bf16 v[68:71], a[84:87], a[168:171], v[68:71]
 s_add_u32 m0, s29, 20480
 ds_read_b64_tr_b16 a[108:109], v8 offset:16384
 v_mfma_f32_16x16x32_bf16 v[68:71], a[88:91], a[176:179], v[68:71]
 s_waitcnt lgkmcnt(7)
 ds_read_b64_tr_b16 a[110:111], v8 offset:20480
 v_xor_b32 v9, 32928, v6
 v_mfma_f32_16x16x32_bf16 v[68:71], a[92:95], a[184:187], v[68:71]
 ds_read_b64_tr_b16 a[64:65], v9 offset:0
 buffer_load_dwordx4 v2, s[16:19], s52 offen lds
 v_mfma_f32_16x16x32_bf16 v[76:79], a[80:83], a[164:167], v[76:79]
 ds_read_b64_tr_b16 a[66:67], v9 offset:4096
 v_mfma_f32_16x16x32_bf16 v[76:79], a[84:87], a[172:175], v[76:79]
 ds_read_b64_tr_b16 a[68:69], v9 offset:16384
 v_mfma_f32_16x16x32_bf16 v[76:79], a[88:91], a[180:183], v[76:79]
 s_add_u32 m0, s29, 24576
 ds_read_b64_tr_b16 a[70:71], v9 offset:20480
 v_xor_b32 v10, 98464, v6
 v_mfma_f32_16x16x32_bf16 v[76:79], a[92:95], a[188:191], v[76:79]
 s_waitcnt lgkmcnt(6)
 ds_read_b64_tr_b16 a[72:73], v10 offset:0
 v_mfma_f32_16x16x32_bf16 v[84:87], a[96:99], a[160:163], v[84:87]
 ds_read_b64_tr_b16 a[74:75], v10 offset:4096
 buffer_load_dwordx4 v2, s[16:19], s53 offen lds
 v_mfma_f32_16x16x32_bf16 v[84:87], a[100:103], a[168:171], v[84:87]
 s_add_u32 s59, s56, 32768
 ds_read_b64_tr_b16 a[76:77], v10 offset:16384
 v_mfma_f32_16x16x32_bf16 v[84:87], a[104:107], a[176:179], v[84:87]
 s_waitcnt lgkmcnt(7)
 ds_read_b64_tr_b16 a[78:79], v10 offset:20480
 v_xor_b32 v7, 32960, v6
 v_mfma_f32_16x16x32_bf16 v[84:87], a[108:111], a[184:187], v[84:87]
 ds_read_b64_tr_b16 a[80:81], v7 offset:0
 buffer_store_dwordx4 v[248:251], v1, s[12:15], s59 offen offset:3072 sc1
 v_mfma_f32_16x16x32_bf16 v[92:95], a[96:99], a[164:167], v[92:95]
 s_add_u32 m0, s29, 28672
 ds_read_b64_tr_b16 a[82:83], v7 offset:4096
 v_mfma_f32_16x16x32_bf16 v[92:95], a[100:103], a[172:175], v[92:95]
 ds_read_b64_tr_b16 a[84:85], v7 offset:16384
 buffer_load_dwordx4 v2, s[16:19], s54 offen lds
 v_mfma_f32_16x16x32_bf16 v[92:95], a[104:107], a[180:183], v[92:95]
 ds_read_b64_tr_b16 a[86:87], v7 offset:20480
 v_xor_b32 v8, 98496, v6
 v_mfma_f32_16x16x32_bf16 v[92:95], a[108:111], a[188:191], v[92:95]
 s_waitcnt lgkmcnt(6)
 ds_read_b64_tr_b16 a[88:89], v8 offset:0
 v_mfma_f32_16x16x32_bf16 v[100:103], a[64:67], a[160:163], v[100:103]
 s_add_u32 m0, s29, 65536
 ds_read_b64_tr_b16 a[90:91], v8 offset:4096
 v_add_u32 v2, 0x80000, v2
 v_mfma_f32_16x16x32_bf16 v[100:103], a[68:71], a[168:171], v[100:103]
 ds_read_b64_tr_b16 a[92:93], v8 offset:16384
 buffer_load_dwordx4 v2, s[16:19], 0 offen lds
 v_mfma_f32_16x16x32_bf16 v[100:103], a[72:75], a[176:179], v[100:103]
 s_waitcnt lgkmcnt(7)
 ds_read_b64_tr_b16 a[94:95], v8 offset:20480
 v_xor_b32 v9, 32992, v6
 v_mfma_f32_16x16x32_bf16 v[100:103], a[76:79], a[184:187], v[100:103]
 ds_read_b64_tr_b16 a[96:97], v9 offset:0
 v_mfma_f32_16x16x32_bf16 v[108:111], a[64:67], a[164:167], v[108:111]
 ds_read_b64_tr_b16 a[98:99], v9 offset:4096
 v_mfma_f32_16x16x32_bf16 v[108:111], a[68:71], a[172:175], v[108:111]
 ds_read_b64_tr_b16 a[100:101], v9 offset:16384
 v_mfma_f32_16x16x32_bf16 v[108:111], a[72:75], a[180:183], v[108:111]
 s_add_u32 m0, s29, 69632
 ds_read_b64_tr_b16 a[102:103], v9 offset:20480
 v_xor_b32 v10, 98528, v6
 v_mfma_f32_16x16x32_bf16 v[108:111], a[76:79], a[188:191], v[108:111]
 s_waitcnt lgkmcnt(6)
 ds_read_b64_tr_b16 a[104:105], v10 offset:0
 buffer_load_dwordx4 v2, s[16:19], s48 offen lds
 v_mfma_f32_16x16x32_bf16 v[116:119], a[80:83], a[160:163], v[116:119]
 ds_read_b64_tr_b16 a[106:107], v10 offset:4096
 v_mfma_f32_16x16x32_bf16 v[116:119], a[84:87], a[168:171], v[116:119]
 ds_read_b64_tr_b16 a[108:109], v10 offset:16384
 v_mfma_f32_16x16x32_bf16 v[116:119], a[88:91], a[176:179], v[116:119]
 s_waitcnt lgkmcnt(7)
 ds_read_b64_tr_b16 a[110:111], v10 offset:20480
 v_xor_b32 v7, 33024, v6
 v_mfma_f32_16x16x32_bf16 v[116:119], a[92:95], a[184:187], v[116:119]
 s_add_u32 m0, s29, 73728
 ds_read_b64_tr_b16 a[64:65], v7 offset:0
 v_mfma_f32_16x16x32_bf16 v[124:127], a[80:83], a[164:167], v[124:127]
 ds_read_b64_tr_b16 a[66:67], v7 offset:4096
 buffer_load_dwordx4 v2, s[16:19], s49 offen lds
 v_mfma_f32_16x16x32_bf16 v[124:127], a[84:87], a[172:175], v[124:127]
 ds_read_b64_tr_b16 a[68:69], v7 offset:16384
 v_mfma_f32_16x16x32_bf16 v[124:127], a[88:91], a[180:183], v[124:127]
 ds_read_b64_tr_b16 a[70:71], v7 offset:20480
 v_xor_b32 v8, 98560, v6
 v_mfma_f32_16x16x32_bf16 v[124:127], a[92:95], a[188:191], v[124:127]
 s_waitcnt lgkmcnt(6)
 ds_read_b64_tr_b16 a[72:73], v8 offset:0
 v_mfma_f32_16x16x32_bf16 v[132:135], a[96:99], a[160:163], v[132:135]
 s_add_u32 m0, s29, 77824
 ds_read_b64_tr_b16 a[74:75], v8 offset:4096
 v_mfma_f32_16x16x32_bf16 v[132:135], a[100:103], a[168:171], v[132:135]
 ds_read_b64_tr_b16 a[76:77], v8 offset:16384
 buffer_load_dwordx4 v2, s[16:19], s50 offen lds
 v_mfma_f32_16x16x32_bf16 v[132:135], a[104:107], a[176:179], v[132:135]
 s_waitcnt lgkmcnt(7)
 ds_read_b64_tr_b16 a[78:79], v8 offset:20480
 v_xor_b32 v9, 33056, v6
 v_mfma_f32_16x16x32_bf16 v[132:135], a[108:111], a[184:187], v[132:135]
 ds_read_b64_tr_b16 a[80:81], v9 offset:0
 v_mfma_f32_16x16x32_bf16 v[140:143], a[96:99], a[164:167], v[140:143]
 ds_read_b64_tr_b16 a[82:83], v9 offset:4096
 v_mfma_f32_16x16x32_bf16 v[140:143], a[100:103], a[172:175], v[140:143]
 ds_read_b64_tr_b16 a[84:85], v9 offset:16384
 v_mfma_f32_16x16x32_bf16 v[140:143], a[104:107], a[180:183], v[140:143]
 s_add_u32 m0, s29, 81920
 ds_read_b64_tr_b16 a[86:87], v9 offset:20480
 v_xor_b32 v10, 98592, v6
 v_mfma_f32_16x16x32_bf16 v[140:143], a[108:111], a[188:191], v[140:143]
 s_waitcnt lgkmcnt(6)
 ds_read_b64_tr_b16 a[88:89], v10 offset:0
 buffer_load_dwordx4 v2, s[16:19], s51 offen lds
 v_mfma_f32_16x16x32_bf16 v[148:151], a[64:67], a[160:163], v[148:151]
 ds_read_b64_tr_b16 a[90:91], v10 offset:4096
 v_mfma_f32_16x16x32_bf16 v[148:151], a[68:71], a[168:171], v[148:151]
 ds_read_b64_tr_b16 a[92:93], v10 offset:16384
 v_mfma_f32_16x16x32_bf16 v[148:151], a[72:75], a[176:179], v[148:151]
 s_waitcnt lgkmcnt(7)
 ds_read_b64_tr_b16 a[94:95], v10 offset:20480
 v_xor_b32 v7, 33088, v6
 v_mfma_f32_16x16x32_bf16 v[148:151], a[76:79], a[184:187], v[148:151]
 s_add_u32 m0, s29, 86016
 ds_read_b64_tr_b16 a[96:97], v7 offset:0
 v_mfma_f32_16x16x32_bf16 v[156:159], a[64:67], a[164:167], v[156:159]
 ds_read_b64_tr_b16 a[98:99], v7 offset:4096
 buffer_load_dwordx4 v2, s[16:19], s52 offen lds
 v_mfma_f32_16x16x32_bf16 v[156:159], a[68:71], a[172:175], v[156:159]
 ds_read_b64_tr_b16 a[100:101], v7 offset:16384
 v_mfma_f32_16x16x32_bf16 v[156:159], a[72:75], a[180:183], v[156:159]
 ds_read_b64_tr_b16 a[102:103], v7 offset:20480
 v_xor_b32 v8, 98624, v6
 v_mfma_f32_16x16x32_bf16 v[156:159], a[76:79], a[188:191], v[156:159]
 s_waitcnt lgkmcnt(6)
 ds_read_b64_tr_b16 a[104:105], v8 offset:0
 v_mfma_f32_16x16x32_bf16 v[164:167], a[80:83], a[160:163], v[164:167]
 s_add_u32 m0, s29, 90112
 ds_read_b64_tr_b16 a[106:107], v8 offset:4096
 v_mfma_f32_16x16x32_bf16 v[164:167], a[84:87], a[168:171], v[164:167]
 ds_read_b64_tr_b16 a[108:109], v8 offset:16384
 buffer_load_dwordx4 v2, s[16:19], s53 offen lds
 v_mfma_f32_16x16x32_bf16 v[164:167], a[88:91], a[176:179], v[164:167]
 s_waitcnt lgkmcnt(7)
 ds_read_b64_tr_b16 a[110:111], v8 offset:20480
 v_xor_b32 v9, 33120, v6
 v_mfma_f32_16x16x32_bf16 v[164:167], a[92:95], a[184:187], v[164:167]
 s_waitcnt vmcnt(8)
 ds_read_b64_tr_b16 a[64:65], v9 offset:0
 v_mfma_f32_16x16x32_bf16 v[172:175], a[80:83], a[164:167], v[172:175]
 s_barrier
 ds_read_b64_tr_b16 a[66:67], v9 offset:4096
 v_mfma_f32_16x16x32_bf16 v[172:175], a[84:87], a[172:175], v[172:175]
 ds_read_b64_tr_b16 a[68:69], v9 offset:16384
 buffer_store_dword v11, v11, s[12:15], s92 offen sc1
 v_mfma_f32_16x16x32_bf16 v[172:175], a[88:91], a[180:183], v[172:175]
 s_add_u32 m0, s29, 94208
 ds_read_b64_tr_b16 a[70:71], v9 offset:20480
 v_xor_b32 v10, 98656, v6
 v_mfma_f32_16x16x32_bf16 v[172:175], a[92:95], a[188:191], v[172:175]
 s_waitcnt lgkmcnt(6)
 ds_read_b64_tr_b16 a[72:73], v10 offset:0
 buffer_load_dwordx4 v2, s[16:19], s54 offen lds
 v_mfma_f32_16x16x32_bf16 v[180:183], a[96:99], a[160:163], v[180:183]
 ds_read_b64_tr_b16 a[74:75], v10 offset:4096
 v_mfma_f32_16x16x32_bf16 v[180:183], a[100:103], a[168:171], v[180:183]
 ds_read_b64_tr_b16 a[76:77], v10 offset:16384
 v_mfma_f32_16x16x32_bf16 v[180:183], a[104:107], a[176:179], v[180:183]
 s_waitcnt lgkmcnt(7)
 ds_read_b64_tr_b16 a[78:79], v10 offset:20480
 v_xor_b32 v7, 33152, v6
 v_mfma_f32_16x16x32_bf16 v[180:183], a[108:111], a[184:187], v[180:183]
 ds_read_b64_tr_b16 a[80:81], v7 offset:0
 v_mfma_f32_16x16x32_bf16 v[188:191], a[96:99], a[164:167], v[188:191]
 ds_read_b64_tr_b16 a[82:83], v7 offset:4096
 v_mfma_f32_16x16x32_bf16 v[188:191], a[100:103], a[172:175], v[188:191]
 ds_read_b64_tr_b16 a[84:85], v7 offset:16384
 v_mfma_f32_16x16x32_bf16 v[188:191], a[104:107], a[180:183], v[188:191]
 ds_read_b64_tr_b16 a[86:87], v7 offset:20480
 v_xor_b32 v8, 98688, v6
 v_mfma_f32_16x16x32_bf16 v[188:191], a[108:111], a[188:191], v[188:191]
 s_waitcnt lgkmcnt(6)
 ds_read_b64_tr_b16 a[88:89], v8 offset:0
 v_mfma_f32_16x16x32_bf16 v[196:199], a[64:67], a[160:163], v[196:199]
 s_and_b32 s58, s92, ~127
 ds_read_b64_tr_b16 a[90:91], v8 offset:4096
 v_mfma_f32_16x16x32_bf16 v[196:199], a[68:71], a[168:171], v[196:199]
 s_lshl_b32 s37, s25, 1
 ds_read_b64_tr_b16 a[92:93], v8 offset:16384
 v_mfma_f32_16x16x32_bf16 v[196:199], a[72:75], a[176:179], v[196:199]
 s_waitcnt lgkmcnt(7)
 ds_read_b64_tr_b16 a[94:95], v8 offset:20480
 v_xor_b32 v9, 33184, v6
 v_mfma_f32_16x16x32_bf16 v[196:199], a[76:79], a[184:187], v[196:199]
 s_sub_i32 s38, 12, s37
 ds_read_b64_tr_b16 a[96:97], v9 offset:0
 v_mfma_f32_16x16x32_bf16 v[204:207], a[64:67], a[164:167], v[204:207]
 s_max_i32 s38, s38, 0
 ds_read_b64_tr_b16 a[98:99], v9 offset:4096
 v_mfma_f32_16x16x32_bf16 v[204:207], a[68:71], a[172:175], v[204:207]
 s_mul_i32 s49, s26, 1048576
 ds_read_b64_tr_b16 a[100:101], v9 offset:16384
 v_mfma_f32_16x16x32_bf16 v[204:207], a[72:75], a[180:183], v[204:207]
 s_lshl_b32 s50, s3, 13
 ds_read_b64_tr_b16 a[102:103], v9 offset:20480
 v_xor_b32 v10, 98720, v6
 v_mfma_f32_16x16x32_bf16 v[204:207], a[76:79], a[188:191], v[204:207]
 s_waitcnt lgkmcnt(6)
 ds_read_b64_tr_b16 a[104:105], v10 offset:0
 v_mfma_f32_16x16x32_bf16 v[212:215], a[80:83], a[160:163], v[212:215]
 s_add_u32 s49, s49, s50
 ds_read_b64_tr_b16 a[106:107], v10 offset:4096
 v_mfma_f32_16x16x32_bf16 v[212:215], a[84:87], a[168:171], v[212:215]
 s_mov_b32 s54, 0
 ds_read_b64_tr_b16 a[108:109], v10 offset:16384
 v_mfma_f32_16x16x32_bf16 v[212:215], a[88:91], a[176:179], v[212:215]
 s_waitcnt lgkmcnt(7)
 ds_read_b64_tr_b16 a[110:111], v10 offset:20480
 v_xor_b32 v7, 33216, v6
 v_mfma_f32_16x16x32_bf16 v[212:215], a[92:95], a[184:187], v[212:215]
 s_add_u32 s44, s37, 1
 ds_read_b64_tr_b16 a[64:65], v7 offset:0
 v_mfma_f32_16x16x32_bf16 v[220:223], a[80:83], a[164:167], v[220:223]
 s_mov_b32 s42, s49
 ds_read_b64_tr_b16 a[66:67], v7 offset:4096
 v_mfma_f32_16x16x32_bf16 v[220:223], a[84:87], a[172:175], v[220:223]
 s_add_u32 s60, s94, 4
 ds_read_b64_tr_b16 a[68:69], v7 offset:16384
 v_mfma_f32_16x16x32_bf16 v[220:223], a[88:91], a[180:183], v[220:223]
 s_mov_b32 s45, 2
 ds_read_b64_tr_b16 a[70:71], v7 offset:20480
 v_xor_b32 v8, 98752, v6
 v_mfma_f32_16x16x32_bf16 v[220:223], a[92:95], a[188:191], v[220:223]
 s_waitcnt lgkmcnt(6)
 ds_read_b64_tr_b16 a[72:73], v8 offset:0
 buffer_load_dwordx4 v[32:35], v122, s[4:7], 0 offen
 v_mfma_f32_16x16x32_bf16 v[228:231], a[96:99], a[160:163], v[228:231]
 s_mov_b32 s66, 1
 ds_read_b64_tr_b16 a[74:75], v8 offset:4096
 v_mfma_f32_16x16x32_bf16 v[228:231], a[100:103], a[168:171], v[228:231]
 s_mov_b32 s68, 1
 ds_read_b64_tr_b16 a[76:77], v8 offset:16384
 v_mfma_f32_16x16x32_bf16 v[228:231], a[104:107], a[176:179], v[228:231]
 s_waitcnt lgkmcnt(7)
 ds_read_b64_tr_b16 a[78:79], v8 offset:20480
 v_xor_b32 v9, 33248, v6
 v_mfma_f32_16x16x32_bf16 v[228:231], a[108:111], a[184:187], v[228:231]
 ds_read_b64_tr_b16 a[80:81], v9 offset:0
 buffer_load_dwordx4 v[40:43], v123, s[4:7], 0 offen
 v_mfma_f32_16x16x32_bf16 v[236:239], a[96:99], a[164:167], v[236:239]
 s_mov_b32 s70, 32768
 ds_read_b64_tr_b16 a[82:83], v9 offset:4096
 v_mfma_f32_16x16x32_bf16 v[236:239], a[100:103], a[172:175], v[236:239]
 s_mov_b32 s71, s70
 ds_read_b64_tr_b16 a[84:85], v9 offset:16384
 v_mfma_f32_16x16x32_bf16 v[236:239], a[104:107], a[180:183], v[236:239]
 s_add_u32 s43, s42, 16777216
 ds_read_b64_tr_b16 a[86:87], v9 offset:20480
 v_xor_b32 v10, 98784, v6
 v_mfma_f32_16x16x32_bf16 v[236:239], a[108:111], a[188:191], v[236:239]
 s_waitcnt lgkmcnt(6)
 ds_read_b64_tr_b16 a[88:89], v10 offset:0
 buffer_load_dwordx4 v[48:51], v128, s[4:7], 0 offen
 v_mfma_f32_16x16x32_bf16 v[244:247], a[64:67], a[160:163], v[244:247]
 s_mov_b32 s40, s50
 ds_read_b64_tr_b16 a[90:91], v10 offset:4096
 v_mfma_f32_16x16x32_bf16 v[244:247], a[68:71], a[168:171], v[244:247]
 s_waitcnt vmcnt(3)
 ds_read_b64_tr_b16 a[92:93], v10 offset:16384
 v_xor_b32 v7, 131072, v6
 v_mfma_f32_16x16x32_bf16 v[244:247], a[72:75], a[176:179], v[244:247]
 s_waitcnt lgkmcnt(7)
 s_barrier
 ds_read_b64_tr_b16 a[94:95], v10 offset:20480
 v_mfma_f32_16x16x32_bf16 v[244:247], a[76:79], a[184:187], v[244:247]
 ds_read_b64_tr_b16 a[96:97], v7 offset:0
 buffer_load_dwordx4 v[56:59], v120, s[4:7], 0 offen offset:0
 v_mfma_f32_16x16x32_bf16 v[252:255], a[64:67], a[164:167], v[252:255]
 s_add_u32 s41, s50, 0x10000
 ds_read_b64_tr_b16 a[98:99], v7 offset:4096
 v_mfma_f32_16x16x32_bf16 v[252:255], a[68:71], a[172:175], v[252:255]
 s_lshr_b32 s61, s95, 4
 ds_read_b64_tr_b16 a[100:101], v7 offset:16384
 v_accvgpr_read_b32 v5, a248
 v_mfma_f32_16x16x32_bf16 v[252:255], a[72:75], a[180:183], v[252:255]
 s_lshl_b32 s61, s61, 7
 ds_read_b64_tr_b16 a[102:103], v7 offset:20480
 v_xor_b32 v8, 0, v6
 v_mfma_f32_16x16x32_bf16 v[252:255], a[76:79], a[188:191], v[252:255]
 s_waitcnt lgkmcnt(6)
 ds_read_b64_tr_b16 a[104:105], v8 offset:0
 buffer_load_dwordx4 v[64:67], v120, s[4:7], 0 offen offset:896
 v_mfma_f32_16x16x32_bf16 v[16:19], a[80:83], a[160:163], v[16:19]
 s_add_u32 s61, s61, 84959232
 ds_read_b64_tr_b16 a[106:107], v8 offset:4096
 v_mfma_f32_16x16x32_bf16 v[16:19], a[84:87], a[168:171], v[16:19]
 s_mov_b32 s47, 0x4b800000
 ds_read_b64_tr_b16 a[108:109], v8 offset:16384
 v_mfma_f32_16x16x32_bf16 v[16:19], a[88:91], a[176:179], v[16:19]
 s_waitcnt lgkmcnt(7)
 ds_read_b64_tr_b16 a[110:111], v8 offset:20480
 v_xor_b32 v9, 65536, v6
 v_mfma_f32_16x16x32_bf16 v[16:19], a[92:95], a[184:187], v[16:19]
 ds_read_b64_tr_b16 a[64:65], v9 offset:0
 buffer_load_dwordx4 v[72:75], v120, s[8:11], 0 offen offset:0
 v_mfma_f32_16x16x32_bf16 v[24:27], a[80:83], a[164:167], v[24:27]
 s_lshl_b32 s30, s95, 1
 ds_read_b64_tr_b16 a[66:67], v9 offset:4096
 v_mfma_f32_16x16x32_bf16 v[24:27], a[84:87], a[172:175], v[24:27]
 s_lshr_b32 s31, s3, 1
 ds_read_b64_tr_b16 a[68:69], v9 offset:16384
 v_mfma_f32_16x16x32_bf16 v[24:27], a[88:91], a[180:183], v[24:27]
 s_add_u32 s30, s30, s31
 ds_read_b64_tr_b16 a[70:71], v9 offset:20480
 v_xor_b32 v10, 131104, v6
 v_mfma_f32_16x16x32_bf16 v[24:27], a[92:95], a[188:191], v[24:27]
 s_waitcnt lgkmcnt(6)
 ds_read_b64_tr_b16 a[72:73], v10 offset:0
 buffer_load_dwordx4 v[80:83], v120, s[8:11], 0 offen offset:896
 v_mfma_f32_16x16x32_bf16 v[28:31], a[96:99], a[192:195], v[28:31]
 s_min_u32 s30, s30, 223
 ds_read_b64_tr_b16 a[74:75], v10 offset:4096
 v_mfma_f32_16x16x32_bf16 v[28:31], a[100:103], a[200:203], v[28:31]
 s_lshl_b32 s30, s30, 2
 ds_read_b64_tr_b16 a[76:77], v10 offset:16384
 v_mfma_f32_16x16x32_bf16 v[28:31], a[104:107], a[208:211], v[28:31]
 s_waitcnt lgkmcnt(3)
 ds_read_b64_tr_b16 a[78:79], v10 offset:20480
 v_xor_b32 v7, 32, v6
 v_mfma_f32_16x16x32_bf16 v[28:31], a[108:111], a[216:219], v[28:31]
 ds_read_b64_tr_b16 a[80:81], v7 offset:0
 buffer_load_dwordx4 v[88:91], v121, s[20:23], s39 offen offset:0
 v_mfma_f32_16x16x32_bf16 v[28:31], a[64:67], a[112:115], v[28:31]
 s_lshl_b32 s53, s3, 4
 ds_read_b64_tr_b16 a[82:83], v7 offset:4096
 v_mfma_f32_16x16x32_bf16 v[28:31], a[68:71], a[120:123], v[28:31]
 ds_read_b64_tr_b16 a[84:85], v7 offset:16384
 v_mfma_f32_16x16x32_bf16 v[44:47], a[96:99], a[196:199], v[44:47]
 ds_read_b64_tr_b16 a[86:87], v7 offset:20480
 v_xor_b32 v8, 65568, v6
 v_mfma_f32_16x16x32_bf16 v[44:47], a[100:103], a[204:207], v[44:47]
 ds_read_b64_tr_b16 a[88:89], v8 offset:0
 buffer_load_dwordx4 v[96:99], v121, s[20:23], s39 offen offset:16
 v_mfma_f32_16x16x32_bf16 v[44:47], a[104:107], a[212:215], v[44:47]
 ds_read_b64_tr_b16 a[90:91], v8 offset:4096
 v_mfma_f32_16x16x32_bf16 v[44:47], a[108:111], a[220:223], v[44:47]
 ds_read_b64_tr_b16 a[92:93], v8 offset:16384
 v_mfma_f32_16x16x32_bf16 v[44:47], a[64:67], a[116:119], v[44:47]
 ds_read_b64_tr_b16 a[94:95], v8 offset:20480
 v_xor_b32 v9, 131136, v6
 v_mfma_f32_16x16x32_bf16 v[44:47], a[68:71], a[124:127], v[44:47]
 s_waitcnt lgkmcnt(6)
 ds_read_b64_tr_b16 a[96:97], v9 offset:0
 buffer_load_dwordx4 v[104:107], v121, s[20:23], s39 offen offset:32
 v_mfma_f32_16x16x32_bf16 v[52:55], a[72:75], a[192:195], v[52:55]
 ds_read_b64_tr_b16 a[98:99], v9 offset:4096
 v_mfma_f32_16x16x32_bf16 v[52:55], a[76:79], a[200:203], v[52:55]
 ds_read_b64_tr_b16 a[100:101], v9 offset:16384
 v_mfma_f32_16x16x32_bf16 v[52:55], a[80:83], a[208:211], v[52:55]
 s_waitcnt lgkmcnt(3)
 ds_read_b64_tr_b16 a[102:103], v9 offset:20480
 v_xor_b32 v10, 64, v6
 v_mfma_f32_16x16x32_bf16 v[52:55], a[84:87], a[216:219], v[52:55]
 ds_read_b64_tr_b16 a[104:105], v10 offset:0
 buffer_load_dwordx4 v[112:115], v121, s[20:23], s39 offen offset:48
 v_mfma_f32_16x16x32_bf16 v[52:55], a[88:91], a[112:115], v[52:55]
 ds_read_b64_tr_b16 a[106:107], v10 offset:4096
 v_mfma_f32_16x16x32_bf16 v[52:55], a[92:95], a[120:123], v[52:55]
 ds_read_b64_tr_b16 a[108:109], v10 offset:16384
 v_mfma_f32_16x16x32_bf16 v[60:63], a[72:75], a[196:199], v[60:63]
 ds_read_b64_tr_b16 a[110:111], v10 offset:20480
 v_xor_b32 v7, 65600, v6
 v_mfma_f32_16x16x32_bf16 v[60:63], a[76:79], a[204:207], v[60:63]
 ds_read_b64_tr_b16 a[64:65], v7 offset:0
 v_mfma_f32_16x16x32_bf16 v[60:63], a[80:83], a[212:215], v[60:63]
 ds_read_b64_tr_b16 a[66:67], v7 offset:4096
 v_mfma_f32_16x16x32_bf16 v[60:63], a[84:87], a[220:223], v[60:63]
 ds_read_b64_tr_b16 a[68:69], v7 offset:16384
 v_mfma_f32_16x16x32_bf16 v[60:63], a[88:91], a[116:119], v[60:63]
 ds_read_b64_tr_b16 a[70:71], v7 offset:20480
 v_xor_b32 v8, 131168, v6
 v_mfma_f32_16x16x32_bf16 v[60:63], a[92:95], a[124:127], v[60:63]
 s_waitcnt lgkmcnt(6)
 ds_read_b64_tr_b16 a[72:73], v8 offset:0
 v_mfma_f32_16x16x32_bf16 v[20:23], a[96:99], a[192:195], v[20:23]
 ds_read_b64_tr_b16 a[74:75], v8 offset:4096
 v_mfma_f32_16x16x32_bf16 v[20:23], a[100:103], a[200:203], v[20:23]
 ds_read_b64_tr_b16 a[76:77], v8 offset:16384
 v_mul_f32 v28, s34, v28
 v_mfma_f32_16x16x32_bf16 v[20:23], a[104:107], a[208:211], v[20:23]
 s_waitcnt lgkmcnt(3)
 ds_read_b64_tr_b16 a[78:79], v8 offset:20480
 v_xor_b32 v9, 96, v6
 v_mfma_f32_16x16x32_bf16 v[20:23], a[108:111], a[216:219], v[20:23]
 ds_read_b64_tr_b16 a[80:81], v9 offset:0
 v_mul_f32 v29, s34, v29
 v_mfma_f32_16x16x32_bf16 v[20:23], a[64:67], a[112:115], v[20:23]
 ds_read_b64_tr_b16 a[82:83], v9 offset:4096
 v_mul_f32 v30, s34, v30
 v_mfma_f32_16x16x32_bf16 v[20:23], a[68:71], a[120:123], v[20:23]
 ds_read_b64_tr_b16 a[84:85], v9 offset:16384
 v_mul_f32 v31, s34, v31
 v_mfma_f32_16x16x32_bf16 v[36:39], a[96:99], a[196:199], v[36:39]
 ds_read_b64_tr_b16 a[86:87], v9 offset:20480
 v_xor_b32 v10, 65632, v6
 v_mfma_f32_16x16x32_bf16 v[36:39], a[100:103], a[204:207], v[36:39]
 ds_read_b64_tr_b16 a[88:89], v10 offset:0
 v_mul_f32 v52, s34, v52
 v_mfma_f32_16x16x32_bf16 v[36:39], a[104:107], a[212:215], v[36:39]
 ds_read_b64_tr_b16 a[90:91], v10 offset:4096
 v_mul_f32 v53, s34, v53
 v_mfma_f32_16x16x32_bf16 v[36:39], a[108:111], a[220:223], v[36:39]
 ds_read_b64_tr_b16 a[92:93], v10 offset:16384
 v_mul_f32 v54, s34, v54
 v_mfma_f32_16x16x32_bf16 v[36:39], a[64:67], a[116:119], v[36:39]
 ds_read_b64_tr_b16 a[94:95], v10 offset:20480
 v_xor_b32 v7, 131200, v6
 v_mfma_f32_16x16x32_bf16 v[36:39], a[68:71], a[124:127], v[36:39]
 s_waitcnt lgkmcnt(6)
 ds_read_b64_tr_b16 a[96:97], v7 offset:0
 v_mul_f32 v55, s34, v55
 v_mfma_f32_16x16x32_bf16 v[68:71], a[72:75], a[192:195], v[68:71]
 ds_read_b64_tr_b16 a[98:99], v7 offset:4096
 v_cvt_pk_bf16_f32 v28, v28, v29
 v_mfma_f32_16x16x32_bf16 v[68:71], a[76:79], a[200:203], v[68:71]
 ds_read_b64_tr_b16 a[100:101], v7 offset:16384
 v_cvt_pk_bf16_f32 v29, v30, v31
 v_mfma_f32_16x16x32_bf16 v[68:71], a[80:83], a[208:211], v[68:71]
 s_waitcnt lgkmcnt(3)
 ds_read_b64_tr_b16 a[102:103], v7 offset:20480
 v_xor_b32 v8, 128, v6
 v_mfma_f32_16x16x32_bf16 v[68:71], a[84:87], a[216:219], v[68:71]
 ds_read_b64_tr_b16 a[104:105], v8 offset:0
 v_cvt_pk_bf16_f32 v30, v52, v53
 v_mfma_f32_16x16x32_bf16 v[68:71], a[88:91], a[112:115], v[68:71]
 ds_read_b64_tr_b16 a[106:107], v8 offset:4096
 v_cvt_pk_bf16_f32 v31, v54, v55
 v_mfma_f32_16x16x32_bf16 v[68:71], a[92:95], a[120:123], v[68:71]
 ds_read_b64_tr_b16 a[108:109], v8 offset:16384
 v_accvgpr_write_b32 a0, v28
 v_mfma_f32_16x16x32_bf16 v[76:79], a[72:75], a[196:199], v[76:79]
 ds_read_b64_tr_b16 a[110:111], v8 offset:20480
 v_xor_b32 v9, 65664, v6
 v_mfma_f32_16x16x32_bf16 v[76:79], a[76:79], a[204:207], v[76:79]
 ds_read_b64_tr_b16 a[64:65], v9 offset:0
 v_accvgpr_write_b32 a1, v29
 v_mfma_f32_16x16x32_bf16 v[76:79], a[80:83], a[212:215], v[76:79]
 ds_read_b64_tr_b16 a[66:67], v9 offset:4096
 v_accvgpr_write_b32 a2, v30
 v_mfma_f32_16x16x32_bf16 v[76:79], a[84:87], a[220:223], v[76:79]
 ds_read_b64_tr_b16 a[68:69], v9 offset:16384
 v_accvgpr_write_b32 a3, v31
 v_mfma_f32_16x16x32_bf16 v[76:79], a[88:91], a[116:119], v[76:79]
 ds_read_b64_tr_b16 a[70:71], v9 offset:20480
 v_xor_b32 v10, 131232, v6
 v_mfma_f32_16x16x32_bf16 v[76:79], a[92:95], a[124:127], v[76:79]
 s_waitcnt lgkmcnt(6)
 ds_read_b64_tr_b16 a[72:73], v10 offset:0
 v_mul_f32 v44, s34, v44
 v_mfma_f32_16x16x32_bf16 v[84:87], a[96:99], a[192:195], v[84:87]
 ds_read_b64_tr_b16 a[74:75], v10 offset:4096
 v_mul_f32 v45, s34, v45
 v_mfma_f32_16x16x32_bf16 v[84:87], a[100:103], a[200:203], v[84:87]
 ds_read_b64_tr_b16 a[76:77], v10 offset:16384
 v_mul_f32 v46, s34, v46
 v_mfma_f32_16x16x32_bf16 v[84:87], a[104:107], a[208:211], v[84:87]
 s_waitcnt lgkmcnt(3)
 ds_read_b64_tr_b16 a[78:79], v10 offset:20480
 v_xor_b32 v7, 160, v6
 v_mfma_f32_16x16x32_bf16 v[84:87], a[108:111], a[216:219], v[84:87]
 ds_read_b64_tr_b16 a[80:81], v7 offset:0
 v_mul_f32 v47, s34, v47
 v_mfma_f32_16x16x32_bf16 v[84:87], a[64:67], a[112:115], v[84:87]
 ds_read_b64_tr_b16 a[82:83], v7 offset:4096
 v_mul_f32 v60, s34, v60
 v_mfma_f32_16x16x32_bf16 v[84:87], a[68:71], a[120:123], v[84:87]
 ds_read_b64_tr_b16 a[84:85], v7 offset:16384
 v_mul_f32 v61, s34, v61
 v_mfma_f32_16x16x32_bf16 v[92:95], a[96:99], a[196:199], v[92:95]
 ds_read_b64_tr_b16 a[86:87], v7 offset:20480
 v_xor_b32 v8, 65696, v6
 v_mfma_f32_16x16x32_bf16 v[92:95], a[100:103], a[204:207], v[92:95]
 ds_read_b64_tr_b16 a[88:89], v8 offset:0
 v_mul_f32 v62, s34, v62
 v_mfma_f32_16x16x32_bf16 v[92:95], a[104:107], a[212:215], v[92:95]
 ds_read_b64_tr_b16 a[90:91], v8 offset:4096
 v_mul_f32 v63, s34, v63
 v_mfma_f32_16x16x32_bf16 v[92:95], a[108:111], a[220:223], v[92:95]
 ds_read_b64_tr_b16 a[92:93], v8 offset:16384
 v_cvt_pk_bf16_f32 v44, v44, v45
 v_mfma_f32_16x16x32_bf16 v[92:95], a[64:67], a[116:119], v[92:95]
 ds_read_b64_tr_b16 a[94:95], v8 offset:20480
 v_xor_b32 v9, 131264, v6
 v_mfma_f32_16x16x32_bf16 v[92:95], a[68:71], a[124:127], v[92:95]
 s_waitcnt lgkmcnt(6)
 ds_read_b64_tr_b16 a[96:97], v9 offset:0
 v_cvt_pk_bf16_f32 v45, v46, v47
 v_mfma_f32_16x16x32_bf16 v[100:103], a[72:75], a[192:195], v[100:103]
 ds_read_b64_tr_b16 a[98:99], v9 offset:4096
 v_cvt_pk_bf16_f32 v46, v60, v61
 v_mfma_f32_16x16x32_bf16 v[100:103], a[76:79], a[200:203], v[100:103]
 ds_read_b64_tr_b16 a[100:101], v9 offset:16384
 v_cvt_pk_bf16_f32 v47, v62, v63
 v_mfma_f32_16x16x32_bf16 v[100:103], a[80:83], a[208:211], v[100:103]
 s_waitcnt lgkmcnt(3)
 ds_read_b64_tr_b16 a[102:103], v9 offset:20480
 v_xor_b32 v10, 192, v6
 v_mfma_f32_16x16x32_bf16 v[100:103], a[84:87], a[216:219], v[100:103]
 ds_read_b64_tr_b16 a[104:105], v10 offset:0
 v_accvgpr_write_b32 a32, v44
 v_mfma_f32_16x16x32_bf16 v[100:103], a[88:91], a[112:115], v[100:103]
 ds_read_b64_tr_b16 a[106:107], v10 offset:4096
 v_accvgpr_write_b32 a33, v45
 v_mfma_f32_16x16x32_bf16 v[100:103], a[92:95], a[120:123], v[100:103]
 ds_read_b64_tr_b16 a[108:109], v10 offset:16384
 v_accvgpr_write_b32 a34, v46
 v_mfma_f32_16x16x32_bf16 v[108:111], a[72:75], a[196:199], v[108:111]
 ds_read_b64_tr_b16 a[110:111], v10 offset:20480
 v_xor_b32 v7, 65728, v6
 v_mfma_f32_16x16x32_bf16 v[108:111], a[76:79], a[204:207], v[108:111]
 ds_read_b64_tr_b16 a[64:65], v7 offset:0
 v_accvgpr_write_b32 a35, v47
 v_mfma_f32_16x16x32_bf16 v[108:111], a[80:83], a[212:215], v[108:111]
 ds_read_b64_tr_b16 a[66:67], v7 offset:4096
 v_mul_f32 v20, s34, v20
 v_mfma_f32_16x16x32_bf16 v[108:111], a[84:87], a[220:223], v[108:111]
 ds_read_b64_tr_b16 a[68:69], v7 offset:16384
 v_mul_f32 v21, s34, v21
 v_mfma_f32_16x16x32_bf16 v[108:111], a[88:91], a[116:119], v[108:111]
 ds_read_b64_tr_b16 a[70:71], v7 offset:20480
 v_xor_b32 v8, 131296, v6
 v_mfma_f32_16x16x32_bf16 v[108:111], a[92:95], a[124:127], v[108:111]
 s_waitcnt lgkmcnt(6)
 ds_read_b64_tr_b16 a[72:73], v8 offset:0
 v_mul_f32 v22, s34, v22
 v_mfma_f32_16x16x32_bf16 v[116:119], a[96:99], a[192:195], v[116:119]
 ds_read_b64_tr_b16 a[74:75], v8 offset:4096
 v_mul_f32 v23, s34, v23
 v_mfma_f32_16x16x32_bf16 v[116:119], a[100:103], a[200:203], v[116:119]
 ds_read_b64_tr_b16 a[76:77], v8 offset:16384
 v_mul_f32 v68, s34, v68
 v_mfma_f32_16x16x32_bf16 v[116:119], a[104:107], a[208:211], v[116:119]
 s_waitcnt lgkmcnt(3)
 ds_read_b64_tr_b16 a[78:79], v8 offset:20480
 v_xor_b32 v9, 224, v6
 v_mfma_f32_16x16x32_bf16 v[116:119], a[108:111], a[216:219], v[116:119]
 ds_read_b64_tr_b16 a[80:81], v9 offset:0
 v_mul_f32 v69, s34, v69
 v_mfma_f32_16x16x32_bf16 v[116:119], a[64:67], a[112:115], v[116:119]
 ds_read_b64_tr_b16 a[82:83], v9 offset:4096
 v_mul_f32 v70, s34, v70
 v_mfma_f32_16x16x32_bf16 v[116:119], a[68:71], a[120:123], v[116:119]
 ds_read_b64_tr_b16 a[84:85], v9 offset:16384
 v_mul_f32 v71, s34, v71
 v_mfma_f32_16x16x32_bf16 v[124:127], a[96:99], a[196:199], v[124:127]
 ds_read_b64_tr_b16 a[86:87], v9 offset:20480
 v_xor_b32 v10, 65760, v6
 v_mfma_f32_16x16x32_bf16 v[124:127], a[100:103], a[204:207], v[124:127]
 ds_read_b64_tr_b16 a[88:89], v10 offset:0
 v_cvt_pk_bf16_f32 v20, v20, v21
 v_mfma_f32_16x16x32_bf16 v[124:127], a[104:107], a[212:215], v[124:127]
 ds_read_b64_tr_b16 a[90:91], v10 offset:4096
 v_cvt_pk_bf16_f32 v21, v22, v23
 v_mfma_f32_16x16x32_bf16 v[124:127], a[108:111], a[220:223], v[124:127]
 ds_read_b64_tr_b16 a[92:93], v10 offset:16384
 v_cvt_pk_bf16_f32 v22, v68, v69
 v_mfma_f32_16x16x32_bf16 v[124:127], a[64:67], a[116:119], v[124:127]
 ds_read_b64_tr_b16 a[94:95], v10 offset:20480
 v_xor_b32 v7, 131328, v6
 v_mfma_f32_16x16x32_bf16 v[124:127], a[68:71], a[124:127], v[124:127]
 s_waitcnt lgkmcnt(6)
 ds_read_b64_tr_b16 a[96:97], v7 offset:0
 v_cvt_pk_bf16_f32 v23, v70, v71
 v_mfma_f32_16x16x32_bf16 v[132:135], a[72:75], a[192:195], v[132:135]
 ds_read_b64_tr_b16 a[98:99], v7 offset:4096
 v_accvgpr_write_b32 a4, v20
 v_mfma_f32_16x16x32_bf16 v[132:135], a[76:79], a[200:203], v[132:135]
 ds_read_b64_tr_b16 a[100:101], v7 offset:16384
 v_accvgpr_write_b32 a5, v21
 v_mfma_f32_16x16x32_bf16 v[132:135], a[80:83], a[208:211], v[132:135]
 s_waitcnt lgkmcnt(3)
 ds_read_b64_tr_b16 a[102:103], v7 offset:20480
 v_xor_b32 v8, 256, v6
 v_mfma_f32_16x16x32_bf16 v[132:135], a[84:87], a[216:219], v[132:135]
 ds_read_b64_tr_b16 a[104:105], v8 offset:0
 v_accvgpr_write_b32 a6, v22
 v_mfma_f32_16x16x32_bf16 v[132:135], a[88:91], a[112:115], v[132:135]
 ds_read_b64_tr_b16 a[106:107], v8 offset:4096
 v_accvgpr_write_b32 a7, v23
 v_mfma_f32_16x16x32_bf16 v[132:135], a[92:95], a[120:123], v[132:135]
 ds_read_b64_tr_b16 a[108:109], v8 offset:16384
 v_mul_f32 v36, s34, v36
 v_mfma_f32_16x16x32_bf16 v[140:143], a[72:75], a[196:199], v[140:143]
 ds_read_b64_tr_b16 a[110:111], v8 offset:20480
 v_xor_b32 v9, 65792, v6
 v_mfma_f32_16x16x32_bf16 v[140:143], a[76:79], a[204:207], v[140:143]
 ds_read_b64_tr_b16 a[64:65], v9 offset:0
 v_mul_f32 v37, s34, v37
 v_mfma_f32_16x16x32_bf16 v[140:143], a[80:83], a[212:215], v[140:143]
 ds_read_b64_tr_b16 a[66:67], v9 offset:4096
 v_mul_f32 v38, s34, v38
 v_mfma_f32_16x16x32_bf16 v[140:143], a[84:87], a[220:223], v[140:143]
 ds_read_b64_tr_b16 a[68:69], v9 offset:16384
 v_mul_f32 v39, s34, v39
 v_mfma_f32_16x16x32_bf16 v[140:143], a[88:91], a[116:119], v[140:143]
 ds_read_b64_tr_b16 a[70:71], v9 offset:20480
 v_xor_b32 v10, 131360, v6
 v_mfma_f32_16x16x32_bf16 v[140:143], a[92:95], a[124:127], v[140:143]
 s_waitcnt lgkmcnt(6)
 ds_read_b64_tr_b16 a[72:73], v10 offset:0
 v_mul_f32 v76, s34, v76
 v_mfma_f32_16x16x32_bf16 v[148:151], a[96:99], a[192:195], v[148:151]
 ds_read_b64_tr_b16 a[74:75], v10 offset:4096
 v_mul_f32 v77, s34, v77
 v_mfma_f32_16x16x32_bf16 v[148:151], a[100:103], a[200:203], v[148:151]
 ds_read_b64_tr_b16 a[76:77], v10 offset:16384
 v_mul_f32 v78, s34, v78
 v_mfma_f32_16x16x32_bf16 v[148:151], a[104:107], a[208:211], v[148:151]
 s_waitcnt lgkmcnt(3)
 ds_read_b64_tr_b16 a[78:79], v10 offset:20480
 v_xor_b32 v7, 288, v6
 v_mfma_f32_16x16x32_bf16 v[148:151], a[108:111], a[216:219], v[148:151]
 ds_read_b64_tr_b16 a[80:81], v7 offset:0
 v_mul_f32 v79, s34, v79
 v_mfma_f32_16x16x32_bf16 v[148:151], a[64:67], a[112:115], v[148:151]
 ds_read_b64_tr_b16 a[82:83], v7 offset:4096
 v_cvt_pk_bf16_f32 v36, v36, v37
 v_mfma_f32_16x16x32_bf16 v[148:151], a[68:71], a[120:123], v[148:151]
 ds_read_b64_tr_b16 a[84:85], v7 offset:16384
 v_cvt_pk_bf16_f32 v37, v38, v39
 v_mfma_f32_16x16x32_bf16 v[156:159], a[96:99], a[196:199], v[156:159]
 ds_read_b64_tr_b16 a[86:87], v7 offset:20480
 v_xor_b32 v8, 65824, v6
 v_mfma_f32_16x16x32_bf16 v[156:159], a[100:103], a[204:207], v[156:159]
 ds_read_b64_tr_b16 a[88:89], v8 offset:0
 v_cvt_pk_bf16_f32 v38, v76, v77
 v_mfma_f32_16x16x32_bf16 v[156:159], a[104:107], a[212:215], v[156:159]
 ds_read_b64_tr_b16 a[90:91], v8 offset:4096
 v_cvt_pk_bf16_f32 v39, v78, v79
 v_mfma_f32_16x16x32_bf16 v[156:159], a[108:111], a[220:223], v[156:159]
 ds_read_b64_tr_b16 a[92:93], v8 offset:16384
 v_accvgpr_write_b32 a36, v36
 v_mfma_f32_16x16x32_bf16 v[156:159], a[64:67], a[116:119], v[156:159]
 ds_read_b64_tr_b16 a[94:95], v8 offset:20480
 v_xor_b32 v9, 131392, v6
 v_mfma_f32_16x16x32_bf16 v[156:159], a[68:71], a[124:127], v[156:159]
 s_waitcnt lgkmcnt(6)
 ds_read_b64_tr_b16 a[96:97], v9 offset:0
 v_accvgpr_write_b32 a37, v37
 v_mfma_f32_16x16x32_bf16 v[164:167], a[72:75], a[192:195], v[164:167]
 ds_read_b64_tr_b16 a[98:99], v9 offset:4096
 v_accvgpr_write_b32 a38, v38
 v_mfma_f32_16x16x32_bf16 v[164:167], a[76:79], a[200:203], v[164:167]
 ds_read_b64_tr_b16 a[100:101], v9 offset:16384
 v_accvgpr_write_b32 a39, v39
 v_mfma_f32_16x16x32_bf16 v[164:167], a[80:83], a[208:211], v[164:167]
 s_waitcnt lgkmcnt(3)
 ds_read_b64_tr_b16 a[102:103], v9 offset:20480
 v_xor_b32 v10, 320, v6
 v_mfma_f32_16x16x32_bf16 v[164:167], a[84:87], a[216:219], v[164:167]
 ds_read_b64_tr_b16 a[104:105], v10 offset:0
 v_mul_f32 v84, s34, v84
 v_mfma_f32_16x16x32_bf16 v[164:167], a[88:91], a[112:115], v[164:167]
 ds_read_b64_tr_b16 a[106:107], v10 offset:4096
 v_mul_f32 v85, s34, v85
 v_mfma_f32_16x16x32_bf16 v[164:167], a[92:95], a[120:123], v[164:167]
 ds_read_b64_tr_b16 a[108:109], v10 offset:16384
 v_mul_f32 v86, s34, v86
 v_mfma_f32_16x16x32_bf16 v[172:175], a[72:75], a[196:199], v[172:175]
 ds_read_b64_tr_b16 a[110:111], v10 offset:20480
 v_xor_b32 v7, 65856, v6
 v_mfma_f32_16x16x32_bf16 v[172:175], a[76:79], a[204:207], v[172:175]
 ds_read_b64_tr_b16 a[64:65], v7 offset:0
 v_mul_f32 v87, s34, v87
 v_mfma_f32_16x16x32_bf16 v[172:175], a[80:83], a[212:215], v[172:175]
 ds_read_b64_tr_b16 a[66:67], v7 offset:4096
 v_mul_f32 v100, s34, v100
 v_mfma_f32_16x16x32_bf16 v[172:175], a[84:87], a[220:223], v[172:175]
 ds_read_b64_tr_b16 a[68:69], v7 offset:16384
 v_mul_f32 v101, s34, v101
 v_mfma_f32_16x16x32_bf16 v[172:175], a[88:91], a[116:119], v[172:175]
 ds_read_b64_tr_b16 a[70:71], v7 offset:20480
 v_xor_b32 v8, 131424, v6
 v_mfma_f32_16x16x32_bf16 v[172:175], a[92:95], a[124:127], v[172:175]
 s_waitcnt lgkmcnt(6)
 ds_read_b64_tr_b16 a[72:73], v8 offset:0
 v_mul_f32 v102, s34, v102
 v_mfma_f32_16x16x32_bf16 v[180:183], a[96:99], a[192:195], v[180:183]
 ds_read_b64_tr_b16 a[74:75], v8 offset:4096
 v_mul_f32 v103, s34, v103
 v_mfma_f32_16x16x32_bf16 v[180:183], a[100:103], a[200:203], v[180:183]
 ds_read_b64_tr_b16 a[76:77], v8 offset:16384
 v_cvt_pk_bf16_f32 v84, v84, v85
 v_mfma_f32_16x16x32_bf16 v[180:183], a[104:107], a[208:211], v[180:183]
 s_waitcnt lgkmcnt(3)
 ds_read_b64_tr_b16 a[78:79], v8 offset:20480
 v_xor_b32 v9, 352, v6
 v_mfma_f32_16x16x32_bf16 v[180:183], a[108:111], a[216:219], v[180:183]
 ds_read_b64_tr_b16 a[80:81], v9 offset:0
 v_cvt_pk_bf16_f32 v85, v86, v87
 v_mfma_f32_16x16x32_bf16 v[180:183], a[64:67], a[112:115], v[180:183]
 ds_read_b64_tr_b16 a[82:83], v9 offset:4096
 v_cvt_pk_bf16_f32 v86, v100, v101
 v_mfma_f32_16x16x32_bf16 v[180:183], a[68:71], a[120:123], v[180:183]
 ds_read_b64_tr_b16 a[84:85], v9 offset:16384
 v_cvt_pk_bf16_f32 v87, v102, v103
 v_mfma_f32_16x16x32_bf16 v[188:191], a[96:99], a[196:199], v[188:191]
 ds_read_b64_tr_b16 a[86:87], v9 offset:20480
 v_xor_b32 v10, 65888, v6
 v_mfma_f32_16x16x32_bf16 v[188:191], a[100:103], a[204:207], v[188:191]
 ds_read_b64_tr_b16 a[88:89], v10 offset:0
 v_accvgpr_write_b32 a8, v84
 v_mfma_f32_16x16x32_bf16 v[188:191], a[104:107], a[212:215], v[188:191]
 ds_read_b64_tr_b16 a[90:91], v10 offset:4096
 v_accvgpr_write_b32 a9, v85
 v_mfma_f32_16x16x32_bf16 v[188:191], a[108:111], a[220:223], v[188:191]
 ds_read_b64_tr_b16 a[92:93], v10 offset:16384
 v_accvgpr_write_b32 a10, v86
 v_mfma_f32_16x16x32_bf16 v[188:191], a[64:67], a[116:119], v[188:191]
 ds_read_b64_tr_b16 a[94:95], v10 offset:20480
 v_xor_b32 v7, 131456, v6
 v_mfma_f32_16x16x32_bf16 v[188:191], a[68:71], a[124:127], v[188:191]
 s_waitcnt lgkmcnt(6)
 ds_read_b64_tr_b16 a[96:97], v7 offset:0
 v_accvgpr_write_b32 a11, v87
 v_mfma_f32_16x16x32_bf16 v[196:199], a[72:75], a[192:195], v[196:199]
 ds_read_b64_tr_b16 a[98:99], v7 offset:4096
 v_mul_f32 v92, s34, v92
 v_mfma_f32_16x16x32_bf16 v[196:199], a[76:79], a[200:203], v[196:199]
 ds_read_b64_tr_b16 a[100:101], v7 offset:16384
 v_mul_f32 v93, s34, v93
 v_mfma_f32_16x16x32_bf16 v[196:199], a[80:83], a[208:211], v[196:199]
 s_waitcnt lgkmcnt(3)
 ds_read_b64_tr_b16 a[102:103], v7 offset:20480
 v_xor_b32 v8, 384, v6
 v_mfma_f32_16x16x32_bf16 v[196:199], a[84:87], a[216:219], v[196:199]
 ds_read_b64_tr_b16 a[104:105], v8 offset:0
 v_mul_f32 v94, s34, v94
 v_mfma_f32_16x16x32_bf16 v[196:199], a[88:91], a[112:115], v[196:199]
 ds_read_b64_tr_b16 a[106:107], v8 offset:4096
 v_mul_f32 v95, s34, v95
 v_mfma_f32_16x16x32_bf16 v[196:199], a[92:95], a[120:123], v[196:199]
 ds_read_b64_tr_b16 a[108:109], v8 offset:16384
 v_mul_f32 v108, s34, v108
 v_mfma_f32_16x16x32_bf16 v[204:207], a[72:75], a[196:199], v[204:207]
 ds_read_b64_tr_b16 a[110:111], v8 offset:20480
 v_xor_b32 v9, 65920, v6
 v_mfma_f32_16x16x32_bf16 v[204:207], a[76:79], a[204:207], v[204:207]
 ds_read_b64_tr_b16 a[64:65], v9 offset:0
 v_mul_f32 v109, s34, v109
 v_mfma_f32_16x16x32_bf16 v[204:207], a[80:83], a[212:215], v[204:207]
 ds_read_b64_tr_b16 a[66:67], v9 offset:4096
 v_mul_f32 v110, s34, v110
 v_mfma_f32_16x16x32_bf16 v[204:207], a[84:87], a[220:223], v[204:207]
 ds_read_b64_tr_b16 a[68:69], v9 offset:16384
 v_mul_f32 v111, s34, v111
 v_mfma_f32_16x16x32_bf16 v[204:207], a[88:91], a[116:119], v[204:207]
 ds_read_b64_tr_b16 a[70:71], v9 offset:20480
 v_xor_b32 v10, 131488, v6
 v_mfma_f32_16x16x32_bf16 v[204:207], a[92:95], a[124:127], v[204:207]
 s_waitcnt lgkmcnt(6)
 ds_read_b64_tr_b16 a[72:73], v10 offset:0
 v_cvt_pk_bf16_f32 v92, v92, v93
 v_mfma_f32_16x16x32_bf16 v[212:215], a[96:99], a[192:195], v[212:215]
 ds_read_b64_tr_b16 a[74:75], v10 offset:4096
 v_cvt_pk_bf16_f32 v93, v94, v95
 v_mfma_f32_16x16x32_bf16 v[212:215], a[100:103], a[200:203], v[212:215]
 ds_read_b64_tr_b16 a[76:77], v10 offset:16384
 v_cvt_pk_bf16_f32 v94, v108, v109
 v_mfma_f32_16x16x32_bf16 v[212:215], a[104:107], a[208:211], v[212:215]
 s_waitcnt lgkmcnt(3)
 ds_read_b64_tr_b16 a[78:79], v10 offset:20480
 v_xor_b32 v7, 416, v6
 v_mfma_f32_16x16x32_bf16 v[212:215], a[108:111], a[216:219], v[212:215]
 ds_read_b64_tr_b16 a[80:81], v7 offset:0
 v_cvt_pk_bf16_f32 v95, v110, v111
 v_mfma_f32_16x16x32_bf16 v[212:215], a[64:67], a[112:115], v[212:215]
 ds_read_b64_tr_b16 a[82:83], v7 offset:4096
 v_accvgpr_write_b32 a40, v92
 v_mfma_f32_16x16x32_bf16 v[212:215], a[68:71], a[120:123], v[212:215]
 ds_read_b64_tr_b16 a[84:85], v7 offset:16384
 v_accvgpr_write_b32 a41, v93
 v_mfma_f32_16x16x32_bf16 v[220:223], a[96:99], a[196:199], v[220:223]
 ds_read_b64_tr_b16 a[86:87], v7 offset:20480
 v_xor_b32 v8, 65952, v6
 v_mfma_f32_16x16x32_bf16 v[220:223], a[100:103], a[204:207], v[220:223]
 ds_read_b64_tr_b16 a[88:89], v8 offset:0
 v_accvgpr_write_b32 a42, v94
 v_mfma_f32_16x16x32_bf16 v[220:223], a[104:107], a[212:215], v[220:223]
 ds_read_b64_tr_b16 a[90:91], v8 offset:4096
 v_accvgpr_write_b32 a43, v95
 v_mfma_f32_16x16x32_bf16 v[220:223], a[108:111], a[220:223], v[220:223]
 ds_read_b64_tr_b16 a[92:93], v8 offset:16384
 v_mul_f32 v116, s34, v116
 v_mfma_f32_16x16x32_bf16 v[220:223], a[64:67], a[116:119], v[220:223]
 ds_read_b64_tr_b16 a[94:95], v8 offset:20480
 v_xor_b32 v9, 131520, v6
 v_mfma_f32_16x16x32_bf16 v[220:223], a[68:71], a[124:127], v[220:223]
 s_waitcnt lgkmcnt(6)
 ds_read_b64_tr_b16 a[96:97], v9 offset:0
 v_mul_f32 v117, s34, v117
 v_mfma_f32_16x16x32_bf16 v[228:231], a[72:75], a[192:195], v[228:231]
 ds_read_b64_tr_b16 a[98:99], v9 offset:4096
 v_mul_f32 v118, s34, v118
 v_mfma_f32_16x16x32_bf16 v[228:231], a[76:79], a[200:203], v[228:231]
 ds_read_b64_tr_b16 a[100:101], v9 offset:16384
 v_mul_f32 v119, s34, v119
 v_mfma_f32_16x16x32_bf16 v[228:231], a[80:83], a[208:211], v[228:231]
 s_waitcnt lgkmcnt(3)
 ds_read_b64_tr_b16 a[102:103], v9 offset:20480
 v_xor_b32 v10, 448, v6
 v_mfma_f32_16x16x32_bf16 v[228:231], a[84:87], a[216:219], v[228:231]
 ds_read_b64_tr_b16 a[104:105], v10 offset:0
 v_mul_f32 v132, s34, v132
 v_mfma_f32_16x16x32_bf16 v[228:231], a[88:91], a[112:115], v[228:231]
 ds_read_b64_tr_b16 a[106:107], v10 offset:4096
 v_mul_f32 v133, s34, v133
 v_mfma_f32_16x16x32_bf16 v[228:231], a[92:95], a[120:123], v[228:231]
 ds_read_b64_tr_b16 a[108:109], v10 offset:16384
 v_mul_f32 v134, s34, v134
 v_mfma_f32_16x16x32_bf16 v[236:239], a[72:75], a[196:199], v[236:239]
 ds_read_b64_tr_b16 a[110:111], v10 offset:20480
 v_xor_b32 v7, 65984, v6
 v_mfma_f32_16x16x32_bf16 v[236:239], a[76:79], a[204:207], v[236:239]
 ds_read_b64_tr_b16 a[64:65], v7 offset:0
 buffer_load_dword v13, v12, s[12:15], s58 offen sc1
 v_mfma_f32_16x16x32_bf16 v[236:239], a[80:83], a[212:215], v[236:239]
 ds_read_b64_tr_b16 a[66:67], v7 offset:4096
 v_mul_f32 v135, s34, v135
 v_mfma_f32_16x16x32_bf16 v[236:239], a[84:87], a[220:223], v[236:239]
 ds_read_b64_tr_b16 a[68:69], v7 offset:16384
 v_cvt_pk_bf16_f32 v116, v116, v117
 v_mfma_f32_16x16x32_bf16 v[236:239], a[88:91], a[116:119], v[236:239]
 ds_read_b64_tr_b16 a[70:71], v7 offset:20480
 v_xor_b32 v8, 131552, v6
 v_mfma_f32_16x16x32_bf16 v[236:239], a[92:95], a[124:127], v[236:239]
 s_waitcnt lgkmcnt(6)
 ds_read_b64_tr_b16 a[72:73], v8 offset:0
 v_cvt_pk_bf16_f32 v117, v118, v119
 v_mfma_f32_16x16x32_bf16 v[244:247], a[96:99], a[192:195], v[244:247]
 ds_read_b64_tr_b16 a[74:75], v8 offset:4096
 v_cvt_pk_bf16_f32 v118, v132, v133
 v_mfma_f32_16x16x32_bf16 v[244:247], a[100:103], a[200:203], v[244:247]
 ds_read_b64_tr_b16 a[76:77], v8 offset:16384
 v_cvt_pk_bf16_f32 v119, v134, v135
 v_mfma_f32_16x16x32_bf16 v[244:247], a[104:107], a[208:211], v[244:247]
 s_waitcnt lgkmcnt(3)
 ds_read_b64_tr_b16 a[78:79], v8 offset:20480
 v_xor_b32 v9, 480, v6
 v_mfma_f32_16x16x32_bf16 v[244:247], a[108:111], a[216:219], v[244:247]
 ds_read_b64_tr_b16 a[80:81], v9 offset:0
 v_accvgpr_write_b32 a12, v116
 v_mfma_f32_16x16x32_bf16 v[244:247], a[64:67], a[112:115], v[244:247]
 ds_read_b64_tr_b16 a[82:83], v9 offset:4096
 v_accvgpr_write_b32 a13, v117
 v_mfma_f32_16x16x32_bf16 v[244:247], a[68:71], a[120:123], v[244:247]
 ds_read_b64_tr_b16 a[84:85], v9 offset:16384
 v_accvgpr_write_b32 a14, v118
 v_mfma_f32_16x16x32_bf16 v[252:255], a[96:99], a[196:199], v[252:255]
 ds_read_b64_tr_b16 a[86:87], v9 offset:20480
 v_xor_b32 v10, 66016, v6
 v_mfma_f32_16x16x32_bf16 v[252:255], a[100:103], a[204:207], v[252:255]
 ds_read_b64_tr_b16 a[88:89], v10 offset:0
 v_accvgpr_write_b32 a15, v119
 v_mfma_f32_16x16x32_bf16 v[252:255], a[104:107], a[212:215], v[252:255]
 ds_read_b64_tr_b16 a[90:91], v10 offset:4096
 v_mfma_f32_16x16x32_bf16 v[252:255], a[108:111], a[220:223], v[252:255]
 ds_read_b64_tr_b16 a[92:93], v10 offset:16384
 v_mfma_f32_16x16x32_bf16 v[252:255], a[64:67], a[116:119], v[252:255]
 ds_read_b64_tr_b16 a[94:95], v10 offset:20480
 v_mfma_f32_16x16x32_bf16 v[252:255], a[68:71], a[124:127], v[252:255]
 s_waitcnt lgkmcnt(6)
 v_mfma_f32_16x16x32_bf16 v[16:19], a[72:75], a[192:195], v[16:19]
 v_mfma_f32_16x16x32_bf16 v[16:19], a[76:79], a[200:203], v[16:19]
 v_mfma_f32_16x16x32_bf16 v[16:19], a[80:83], a[208:211], v[16:19]
 s_waitcnt lgkmcnt(0)
 v_mfma_f32_16x16x32_bf16 v[16:19], a[84:87], a[216:219], v[16:19]
 v_mfma_f32_16x16x32_bf16 v[16:19], a[88:91], a[112:115], v[16:19]
 v_mfma_f32_16x16x32_bf16 v[16:19], a[92:95], a[120:123], v[16:19]
 v_mfma_f32_16x16x32_bf16 v[24:27], a[72:75], a[196:199], v[24:27]
 v_mfma_f32_16x16x32_bf16 v[24:27], a[76:79], a[204:207], v[24:27]
 v_mfma_f32_16x16x32_bf16 v[24:27], a[80:83], a[212:215], v[24:27]
 v_mfma_f32_16x16x32_bf16 v[24:27], a[84:87], a[220:223], v[24:27]
 s_waitcnt lgkmcnt(0)
 v_mfma_f32_16x16x32_bf16 v[24:27], a[88:91], a[116:119], v[24:27]
 s_barrier
 v_mfma_f32_16x16x32_bf16 v[24:27], a[92:95], a[124:127], v[24:27]
 s_waitcnt vmcnt(0)
 v_cmp_ne_u32 s[16:17], 0, v13
 v_cmp_gt_u32 vcc, 256, v5
 s_or_b64 vcc, vcc, s[16:17]
 s_mov_b32 m0, s40
 s_cselect_b32 s48, 0, 1
 s_cselect_b32 s52, 2.0, s42
 buffer_load_dwordx4 v1, s[12:15], s52 offen offset:0 sc1 lds
 v_pk_mul_f32 v[124:125], v[124:125], s[34:35]
 v_pk_mul_f32 v[126:127], v[126:127], s[34:35]
 v_pk_mul_f32 v[140:141], v[140:141], s[34:35]
 v_pk_mul_f32 v[142:143], v[142:143], s[34:35]
 v_cvt_pk_bf16_f32 v124, v124, v125
 v_cvt_pk_bf16_f32 v125, v126, v127
 v_cvt_pk_bf16_f32 v126, v140, v141
 v_cvt_pk_bf16_f32 v127, v142, v143
 v_accvgpr_write_b32 a44, v124
 v_accvgpr_write_b32 a45, v125
 v_accvgpr_write_b32 a46, v126
 v_accvgpr_write_b32 a47, v127
 v_pk_mul_f32 v[148:149], v[148:149], s[34:35]
 v_pk_mul_f32 v[150:151], v[150:151], s[34:35]
 buffer_load_dwordx4 v1, s[12:15], s52 offen offset:1024 sc1 lds
 v_pk_mul_f32 v[164:165], v[164:165], s[34:35]
 v_pk_mul_f32 v[166:167], v[166:167], s[34:35]
 v_cvt_pk_bf16_f32 v148, v148, v149
 v_cvt_pk_bf16_f32 v149, v150, v151
 v_cvt_pk_bf16_f32 v150, v164, v165
 v_cvt_pk_bf16_f32 v151, v166, v167
 v_accvgpr_write_b32 a16, v148
 v_accvgpr_write_b32 a17, v149
 v_accvgpr_write_b32 a18, v150
 v_accvgpr_write_b32 a19, v151
 v_pk_mul_f32 v[156:157], v[156:157], s[34:35]
 v_pk_mul_f32 v[158:159], v[158:159], s[34:35]
 v_pk_mul_f32 v[172:173], v[172:173], s[34:35]
 buffer_load_dwordx4 v1, s[12:15], s52 offen offset:2048 sc1 lds
 v_pk_mul_f32 v[174:175], v[174:175], s[34:35]
 v_cvt_pk_bf16_f32 v156, v156, v157
 v_cvt_pk_bf16_f32 v157, v158, v159
 v_cvt_pk_bf16_f32 v158, v172, v173
 v_cvt_pk_bf16_f32 v159, v174, v175
 v_accvgpr_write_b32 a48, v156
 v_accvgpr_write_b32 a49, v157
 v_accvgpr_write_b32 a50, v158
 v_accvgpr_write_b32 a51, v159
 v_pk_mul_f32 v[180:181], v[180:181], s[34:35]
 v_pk_mul_f32 v[182:183], v[182:183], s[34:35]
 v_pk_mul_f32 v[196:197], v[196:197], s[34:35]
 v_pk_mul_f32 v[198:199], v[198:199], s[34:35]
 v_cvt_pk_bf16_f32 v180, v180, v181
 buffer_load_dwordx4 v1, s[12:15], s52 offen offset:3072 sc1 lds
 v_cvt_pk_bf16_f32 v181, v182, v183
 v_cvt_pk_bf16_f32 v182, v196, v197
 v_cvt_pk_bf16_f32 v183, v198, v199
 v_accvgpr_write_b32 a20, v180
 v_accvgpr_write_b32 a21, v181
 v_accvgpr_write_b32 a22, v182
 v_accvgpr_write_b32 a23, v183
 v_pk_mul_f32 v[188:189], v[188:189], s[34:35]
 v_pk_mul_f32 v[190:191], v[190:191], s[34:35]
 v_pk_mul_f32 v[204:205], v[204:205], s[34:35]
 v_pk_mul_f32 v[206:207], v[206:207], s[34:35]
 v_cvt_pk_bf16_f32 v188, v188, v189
 v_cvt_pk_bf16_f32 v189, v190, v191
 s_bitset1_b32 m0, 12
 s_nop 0
 buffer_load_dwordx4 v4, s[12:15], s52 offen offset:0 sc1 lds
 v_cvt_pk_bf16_f32 v190, v204, v205
 v_cvt_pk_bf16_f32 v191, v206, v207
 v_accvgpr_write_b32 a52, v188
 v_accvgpr_write_b32 a53, v189
 v_accvgpr_write_b32 a54, v190
 v_accvgpr_write_b32 a55, v191
 v_pk_mul_f32 v[212:213], v[212:213], s[34:35]
 v_pk_mul_f32 v[214:215], v[214:215], s[34:35]
 v_pk_mul_f32 v[228:229], v[228:229], s[34:35]
 v_pk_mul_f32 v[230:231], v[230:231], s[34:35]
 v_cvt_pk_bf16_f32 v212, v212, v213
 v_cvt_pk_bf16_f32 v213, v214, v215
 v_cvt_pk_bf16_f32 v214, v228, v229
 v_cvt_pk_bf16_f32 v215, v230, v231
 buffer_load_dwordx4 v4, s[12:15], s52 offen offset:1024 sc1 lds
 v_accvgpr_write_b32 a24, v212
 v_accvgpr_write_b32 a25, v213
 v_accvgpr_write_b32 a26, v214
 v_accvgpr_write_b32 a27, v215
 v_pk_mul_f32 v[220:221], v[220:221], s[34:35]
 v_pk_mul_f32 v[222:223], v[222:223], s[34:35]
 v_pk_mul_f32 v[236:237], v[236:237], s[34:35]
 v_pk_mul_f32 v[238:239], v[238:239], s[34:35]
 v_cvt_pk_bf16_f32 v220, v220, v221
 v_cvt_pk_bf16_f32 v221, v222, v223
 v_cvt_pk_bf16_f32 v222, v236, v237
 v_cvt_pk_bf16_f32 v223, v238, v239
 v_accvgpr_write_b32 a56, v220
 buffer_load_dwordx4 v4, s[12:15], s52 offen offset:2048 sc1 lds
 v_accvgpr_write_b32 a57, v221
 v_accvgpr_write_b32 a58, v222
 v_accvgpr_write_b32 a59, v223
 v_pk_mul_f32 v[244:245], v[244:245], s[34:35]
 v_pk_mul_f32 v[246:247], v[246:247], s[34:35]
 v_pk_mul_f32 v[16:17], v[16:17], s[34:35]
 v_pk_mul_f32 v[18:19], v[18:19], s[34:35]
 v_cvt_pk_bf16_f32 v244, v244, v245
 v_cvt_pk_bf16_f32 v245, v246, v247
 v_cvt_pk_bf16_f32 v246, v16, v17
 v_cvt_pk_bf16_f32 v247, v18, v19
 v_accvgpr_write_b32 a28, v244
 v_accvgpr_write_b32 a29, v245
 v_accvgpr_write_b32 a30, v246
 buffer_load_dwordx4 v4, s[12:15], s52 offen offset:3072 sc1 lds
 v_accvgpr_write_b32 a31, v247
 v_pk_mul_f32 v[252:253], v[252:253], s[34:35]
 v_pk_mul_f32 v[254:255], v[254:255], s[34:35]
 v_pk_mul_f32 v[24:25], v[24:25], s[34:35]
 v_pk_mul_f32 v[26:27], v[26:27], s[34:35]
 v_cvt_pk_bf16_f32 v252, v252, v253
 v_cvt_pk_bf16_f32 v253, v254, v255
 v_cvt_pk_bf16_f32 v254, v24, v25
 v_cvt_pk_bf16_f32 v255, v26, v27
 v_accvgpr_write_b32 a60, v252
 v_accvgpr_write_b32 a61, v253
 v_accvgpr_write_b32 a62, v254
 v_accvgpr_write_b32 a63, v255
 s_branch L_kvdone
L_late0:
 v_mfma_f32_16x16x32_bf16 a[232:235], a[0:3], a[96:99], a[232:235]
 ds_read_b64_tr_b16 a[24:25], v9 offset:32768
 v_mfma_f32_16x16x32_bf16 a[232:235], a[4:7], a[100:103], a[232:235]
 s_add_u32 m0, s33, 0xfffffd00
 ds_read_b64_tr_b16 a[26:27], v9 offset:36864
 v_mfma_f32_16x16x32_bf16 a[224:227], a[4:7], a[108:111], a[224:227]
 s_waitcnt lgkmcnt(13)
 ds_read_b64_tr_b16 a[28:29], v9 offset:49152
 v_mfma_f32_16x16x32_bf16 a[224:227], a[0:3], a[104:107], a[224:227]
 ds_read_b64_tr_b16 a[30:31], v9 offset:53248
 buffer_load_dwordx4 v15, s[20:23], 0 offen offset:768 lds
 v_mfma_f32_16x16x32_bf16 v[24:27], a[0:3], a[112:115], v[24:27]
 s_waitcnt lgkmcnt(12)
 ds_read_b128 a[64:67], v4 offset:32768
 v_mfma_f32_16x16x32_bf16 v[24:27], a[4:7], a[116:119], v[24:27]
 v_mfma_f32_16x16x32_bf16 v[16:19], a[4:7], a[124:127], v[16:19]
 s_add_u32 m0, s33, 0xfffffd80
 ds_read_b128 a[68:71], v5 offset:32768
 v_mfma_f32_16x16x32_bf16 v[16:19], a[0:3], a[120:123], v[16:19]
 s_waitcnt lgkmcnt(10)
 buffer_load_dwordx4 v15, s[20:23], 0 offen offset:1664 lds
 v_mfma_f32_16x16x32_bf16 v[20:23], a[8:11], a[120:123], v[20:23]
 ds_read_b128 a[76:79], v5 offset:34816
 v_mfma_f32_16x16x32_bf16 v[20:23], a[12:15], a[124:127], v[20:23]
 v_mfma_f32_16x16x32_bf16 v[28:31], a[12:15], a[116:119], v[28:31]
 s_add_u32 m0, s33, 0x500
 ds_read_b128 a[72:75], v4 offset:34816
 v_mfma_f32_16x16x32_bf16 v[28:31], a[8:11], a[112:115], v[28:31]
 buffer_load_dwordx4 v15, s[20:23], s57 offen offset:768 lds
 v_mfma_f32_16x16x32_bf16 a[228:231], a[8:11], a[104:107], a[228:231]
 ds_read_b128 a[80:83], v4 offset:36864
 v_mfma_f32_16x16x32_bf16 a[228:231], a[12:15], a[108:111], a[228:231]
 v_mfma_f32_16x16x32_bf16 a[236:239], a[12:15], a[100:103], a[236:239]
 s_add_u32 m0, s33, 0x580
 ds_read_b128 a[84:87], v5 offset:36864
 v_mfma_f32_16x16x32_bf16 a[236:239], a[8:11], a[96:99], a[236:239]
 s_waitcnt lgkmcnt(10)
 buffer_load_dwordx4 v15, s[20:23], s57 offen offset:1664 lds
 v_mfma_f32_16x16x32_bf16 v[56:59], a[16:19], a[96:99], v[56:59]
 ds_read_b128 a[92:95], v5 offset:38912
 v_mfma_f32_16x16x32_bf16 v[56:59], a[20:23], a[100:103], v[56:59]
 v_cvt_pk_bf16_f32 v16, v16, v17
 v_cvt_pk_bf16_f32 v17, v18, v19
 v_mfma_f32_16x16x32_bf16 v[48:51], a[20:23], a[108:111], v[48:51]
 ds_read_b128 a[88:91], v4 offset:38912
 v_cvt_pk_bf16_f32 v18, v20, v21
 v_mfma_f32_16x16x32_bf16 v[48:51], a[16:19], a[104:107], v[48:51]
 v_cvt_pk_bf16_f32 v19, v22, v23
 v_cvt_pk_bf16_f32 v24, v24, v25
 v_mfma_f32_16x16x32_bf16 v[40:43], a[16:19], a[112:115], v[40:43]
 ds_read_b64_tr_b16 a[32:33], v10 offset:32768
 v_cvt_pk_bf16_f32 v25, v26, v27
 v_mfma_f32_16x16x32_bf16 v[40:43], a[20:23], a[116:119], v[40:43]
 ds_read_b64_tr_b16 a[34:35], v10 offset:36864
 v_cvt_pk_bf16_f32 v26, v28, v29
 v_mfma_f32_16x16x32_bf16 v[32:35], a[20:23], a[124:127], v[32:35]
 s_add_u32 s59, s56, 57344
 ds_read_b64_tr_b16 a[36:37], v10 offset:49152
 v_cvt_pk_bf16_f32 v27, v30, v31
 v_mfma_f32_16x16x32_bf16 v[32:35], a[16:19], a[120:123], v[32:35]
 s_waitcnt lgkmcnt(11)
 ds_read_b64_tr_b16 a[38:39], v10 offset:53248
 v_accvgpr_read_b32 v20, a224
 v_mfma_f32_16x16x32_bf16 v[36:39], a[24:27], a[120:123], v[36:39]
 ds_read_b64_tr_b16 a[40:41], v11 offset:32768
 buffer_store_dwordx4 v[16:19], v1, s[12:15], s59 offen offset:0 sc1
 v_mfma_f32_16x16x32_bf16 v[36:39], a[28:31], a[124:127], v[36:39]
 ds_read_b64_tr_b16 a[42:43], v11 offset:36864
 v_accvgpr_read_b32 v21, a225
 v_mfma_f32_16x16x32_bf16 v[44:47], a[28:31], a[116:119], v[44:47]
 ds_read_b64_tr_b16 a[44:45], v11 offset:49152
 v_accvgpr_read_b32 v22, a226
 v_mfma_f32_16x16x32_bf16 v[44:47], a[24:27], a[112:115], v[44:47]
 ds_read_b64_tr_b16 a[46:47], v11 offset:53248
 v_accvgpr_read_b32 v23, a227
 v_mfma_f32_16x16x32_bf16 v[52:55], a[24:27], a[104:107], v[52:55]
 ds_read_b64_tr_b16 a[48:49], v12 offset:32768
 v_accvgpr_read_b32 v28, a228
 v_mfma_f32_16x16x32_bf16 v[52:55], a[28:31], a[108:111], v[52:55]
 ds_read_b64_tr_b16 a[50:51], v12 offset:36864
 v_accvgpr_read_b32 v29, a229
 v_mfma_f32_16x16x32_bf16 v[60:63], a[28:31], a[100:103], v[60:63]
 s_add_u32 s59, s56, 49152
 ds_read_b64_tr_b16 a[52:53], v12 offset:49152
 v_accvgpr_read_b32 v30, a230
 v_mfma_f32_16x16x32_bf16 v[60:63], a[24:27], a[96:99], v[60:63]
 s_waitcnt lgkmcnt(15)
 ds_read_b64_tr_b16 a[54:55], v12 offset:53248
 buffer_store_dwordx4 v[24:27], v1, s[12:15], s59 offen offset:0 sc1
 v_mfma_f32_16x16x32_bf16 v[88:91], a[0:3], a[64:67], v[88:91]
 ds_read_b64_tr_b16 a[56:57], v13 offset:32768
 v_accvgpr_read_b32 v31, a231
 v_mfma_f32_16x16x32_bf16 v[88:91], a[4:7], a[68:71], v[88:91]
 ds_read_b64_tr_b16 a[58:59], v13 offset:36864
 v_cvt_pk_bf16_f32 v20, v20, v21
 v_mfma_f32_16x16x32_bf16 v[80:83], a[4:7], a[76:79], v[80:83]
 ds_read_b64_tr_b16 a[60:61], v13 offset:49152
 v_cvt_pk_bf16_f32 v21, v22, v23
 v_mfma_f32_16x16x32_bf16 v[80:83], a[0:3], a[72:75], v[80:83]
 s_waitcnt lgkmcnt(15)
 ds_read_b64_tr_b16 a[62:63], v13 offset:53248
 v_cvt_pk_bf16_f32 v22, v28, v29
 v_mfma_f32_16x16x32_bf16 v[72:75], a[0:3], a[80:83], v[72:75]
 v_cvt_pk_bf16_f32 v23, v30, v31
 v_cvt_pk_bf16_f32 v32, v32, v33
 v_mfma_f32_16x16x32_bf16 v[72:75], a[4:7], a[84:87], v[72:75]
 s_add_u32 s59, s56, 40960
 v_cvt_pk_bf16_f32 v33, v34, v35
 v_cvt_pk_bf16_f32 v34, v36, v37
 v_mfma_f32_16x16x32_bf16 v[64:67], a[4:7], a[92:95], v[64:67]
 buffer_store_dwordx4 v[20:23], v1, s[12:15], s59 offen offset:0 sc1
 v_mfma_f32_16x16x32_bf16 v[64:67], a[0:3], a[88:91], v[64:67]
 s_waitcnt lgkmcnt(0)
 v_cvt_pk_bf16_f32 v35, v38, v39
 v_cvt_pk_bf16_f32 v40, v40, v41
 v_mfma_f32_16x16x32_bf16 v[68:71], a[8:11], a[88:91], v[68:71]
 s_barrier
 v_xor_b32 v6, s60, v6
 v_cvt_pk_bf16_f32 v41, v42, v43
 v_mfma_f32_16x16x32_bf16 v[68:71], a[12:15], a[92:95], v[68:71]
 s_add_u32 m0, s29, 32768
 v_add_u32 v2, 0x80000, v2
 v_cvt_pk_bf16_f32 v42, v44, v45
 v_mfma_f32_16x16x32_bf16 v[76:79], a[12:15], a[84:87], v[76:79]
 buffer_load_dwordx4 v2, s[16:19], 0 offen lds
 v_mfma_f32_16x16x32_bf16 v[76:79], a[8:11], a[80:83], v[76:79]
 v_cvt_pk_bf16_f32 v43, v46, v47
 v_accvgpr_read_b32 v36, a232
 v_mfma_f32_16x16x32_bf16 v[84:87], a[8:11], a[72:75], v[84:87]
 v_accvgpr_read_b32 v37, a233
 v_accvgpr_read_b32 v38, a234
 v_mfma_f32_16x16x32_bf16 v[84:87], a[12:15], a[76:79], v[84:87]
 v_accvgpr_read_b32 v39, a235
 v_accvgpr_read_b32 v44, a236
 v_mfma_f32_16x16x32_bf16 v[92:95], a[12:15], a[68:71], v[92:95]
 s_add_u32 m0, s29, 36864
 v_accvgpr_read_b32 v45, a237
 v_accvgpr_read_b32 v46, a238
 v_mfma_f32_16x16x32_bf16 v[92:95], a[8:11], a[64:67], v[92:95]
 buffer_load_dwordx4 v2, s[16:19], s48 offen lds
 v_mfma_f32_16x16x32_bf16 v[120:123], a[16:19], a[64:67], v[120:123]
 v_accvgpr_read_b32 v47, a239
 v_cvt_pk_bf16_f32 v36, v36, v37
 v_mfma_f32_16x16x32_bf16 v[120:123], a[20:23], a[68:71], v[120:123]
 v_cvt_pk_bf16_f32 v37, v38, v39
 v_cvt_pk_bf16_f32 v38, v44, v45
 v_mfma_f32_16x16x32_bf16 v[112:115], a[20:23], a[76:79], v[112:115]
 v_cvt_pk_bf16_f32 v39, v46, v47
 v_cvt_pk_bf16_f32 v48, v48, v49
 v_mfma_f32_16x16x32_bf16 v[112:115], a[16:19], a[72:75], v[112:115]
 s_add_u32 m0, s29, 40960
 v_cvt_pk_bf16_f32 v49, v50, v51
 v_cvt_pk_bf16_f32 v50, v52, v53
 v_mfma_f32_16x16x32_bf16 v[104:107], a[16:19], a[80:83], v[104:107]
 buffer_load_dwordx4 v2, s[16:19], s49 offen lds
 v_mfma_f32_16x16x32_bf16 v[104:107], a[20:23], a[84:87], v[104:107]
 v_cvt_pk_bf16_f32 v51, v54, v55
 v_cvt_pk_bf16_f32 v56, v56, v57
 v_mfma_f32_16x16x32_bf16 v[96:99], a[20:23], a[92:95], v[96:99]
 v_cvt_pk_bf16_f32 v57, v58, v59
 v_cvt_pk_bf16_f32 v58, v60, v61
 v_mfma_f32_16x16x32_bf16 v[96:99], a[16:19], a[88:91], v[96:99]
 v_cvt_pk_bf16_f32 v59, v62, v63
 v_cvt_pk_bf16_f32 v64, v64, v65
 v_mfma_f32_16x16x32_bf16 v[100:103], a[24:27], a[88:91], v[100:103]
 s_add_u32 m0, s29, 45056
 v_cvt_pk_bf16_f32 v65, v66, v67
 v_cvt_pk_bf16_f32 v66, v68, v69
 v_mfma_f32_16x16x32_bf16 v[100:103], a[28:31], a[92:95], v[100:103]
 buffer_load_dwordx4 v2, s[16:19], s50 offen lds
 v_mfma_f32_16x16x32_bf16 v[108:111], a[28:31], a[84:87], v[108:111]
 s_add_u32 s59, s56, 32768
 v_cvt_pk_bf16_f32 v67, v70, v71
 v_cvt_pk_bf16_f32 v72, v72, v73
 v_mfma_f32_16x16x32_bf16 v[108:111], a[24:27], a[80:83], v[108:111]
 buffer_store_dwordx4 v[36:39], v1, s[12:15], s59 offen offset:0 sc1
 v_mfma_f32_16x16x32_bf16 v[116:119], a[24:27], a[72:75], v[116:119]
 v_cvt_pk_bf16_f32 v73, v74, v75
 v_cvt_pk_bf16_f32 v74, v76, v77
 v_mfma_f32_16x16x32_bf16 v[116:119], a[28:31], a[76:79], v[116:119]
 s_add_u32 m0, s29, 49152
 v_cvt_pk_bf16_f32 v75, v78, v79
 v_cvt_pk_bf16_f32 v80, v80, v81
 v_mfma_f32_16x16x32_bf16 v[124:127], a[28:31], a[68:71], v[124:127]
 buffer_load_dwordx4 v2, s[16:19], s51 offen lds
 v_mfma_f32_16x16x32_bf16 v[124:127], a[24:27], a[64:67], v[124:127]
 v_cvt_pk_bf16_f32 v81, v82, v83
 v_cvt_pk_bf16_f32 v82, v84, v85
 v_mfma_f32_16x16x32_bf16 v[152:155], a[32:35], a[64:67], v[152:155]
 v_cvt_pk_bf16_f32 v83, v86, v87
 v_cvt_pk_bf16_f32 v88, v88, v89
 v_mfma_f32_16x16x32_bf16 v[152:155], a[36:39], a[68:71], v[152:155]
 v_cvt_pk_bf16_f32 v89, v90, v91
 v_cvt_pk_bf16_f32 v90, v92, v93
 v_mfma_f32_16x16x32_bf16 v[144:147], a[36:39], a[76:79], v[144:147]
 s_add_u32 m0, s29, 53248
 v_cvt_pk_bf16_f32 v91, v94, v95
 v_cvt_pk_bf16_f32 v96, v96, v97
 v_mfma_f32_16x16x32_bf16 v[144:147], a[32:35], a[72:75], v[144:147]
 buffer_load_dwordx4 v2, s[16:19], s52 offen lds
 v_mfma_f32_16x16x32_bf16 v[136:139], a[32:35], a[80:83], v[136:139]
 v_cvt_pk_bf16_f32 v97, v98, v99
 v_cvt_pk_bf16_f32 v98, v100, v101
 v_mfma_f32_16x16x32_bf16 v[136:139], a[36:39], a[84:87], v[136:139]
 v_cvt_pk_bf16_f32 v99, v102, v103
 v_cvt_pk_bf16_f32 v104, v104, v105
 v_mfma_f32_16x16x32_bf16 v[128:131], a[36:39], a[92:95], v[128:131]
 v_cvt_pk_bf16_f32 v105, v106, v107
 v_cvt_pk_bf16_f32 v106, v108, v109
 v_mfma_f32_16x16x32_bf16 v[128:131], a[32:35], a[88:91], v[128:131]
 s_add_u32 m0, s29, 57344
 v_cvt_pk_bf16_f32 v107, v110, v111
 v_cvt_pk_bf16_f32 v112, v112, v113
 v_mfma_f32_16x16x32_bf16 v[132:135], a[40:43], a[88:91], v[132:135]
 buffer_load_dwordx4 v2, s[16:19], s53 offen lds
 v_mfma_f32_16x16x32_bf16 v[132:135], a[44:47], a[92:95], v[132:135]
 v_cvt_pk_bf16_f32 v113, v114, v115
 v_cvt_pk_bf16_f32 v114, v116, v117
 v_mfma_f32_16x16x32_bf16 v[140:143], a[44:47], a[84:87], v[140:143]
 v_cvt_pk_bf16_f32 v115, v118, v119
 v_cvt_pk_bf16_f32 v120, v120, v121
 v_mfma_f32_16x16x32_bf16 v[140:143], a[40:43], a[80:83], v[140:143]
 v_cvt_pk_bf16_f32 v121, v122, v123
 v_cvt_pk_bf16_f32 v122, v124, v125
 v_mfma_f32_16x16x32_bf16 v[148:151], a[40:43], a[72:75], v[148:151]
 s_add_u32 m0, s29, 61440
 v_cvt_pk_bf16_f32 v123, v126, v127
 v_mfma_f32_16x16x32_bf16 v[148:151], a[44:47], a[76:79], v[148:151]
 buffer_load_dwordx4 v2, s[16:19], s54 offen lds
 v_mfma_f32_16x16x32_bf16 v[156:159], a[44:47], a[68:71], v[156:159]
 v_mfma_f32_16x16x32_bf16 v[156:159], a[40:43], a[64:67], v[156:159]
 v_mfma_f32_16x16x32_bf16 v[184:187], a[48:51], a[64:67], v[184:187]
 s_add_u32 m0, s29, 98304
 v_add_u32 v2, 0x80000, v2
 v_mfma_f32_16x16x32_bf16 v[184:187], a[52:55], a[68:71], v[184:187]
 buffer_load_dwordx4 v2, s[16:19], 0 offen lds
 v_mfma_f32_16x16x32_bf16 v[176:179], a[52:55], a[76:79], v[176:179]
 v_cvt_pk_bf16_f32 v128, v128, v129
 v_cvt_pk_bf16_f32 v129, v130, v131
 v_mfma_f32_16x16x32_bf16 v[176:179], a[48:51], a[72:75], v[176:179]
 v_cvt_pk_bf16_f32 v130, v132, v133
 v_cvt_pk_bf16_f32 v131, v134, v135
 v_mfma_f32_16x16x32_bf16 v[168:171], a[48:51], a[80:83], v[168:171]
 v_cvt_pk_bf16_f32 v136, v136, v137
 v_cvt_pk_bf16_f32 v137, v138, v139
 v_mfma_f32_16x16x32_bf16 v[168:171], a[52:55], a[84:87], v[168:171]
 s_add_u32 m0, s29, 102400
 v_cvt_pk_bf16_f32 v138, v140, v141
 v_cvt_pk_bf16_f32 v139, v142, v143
 v_mfma_f32_16x16x32_bf16 v[160:163], a[52:55], a[92:95], v[160:163]
 buffer_load_dwordx4 v2, s[16:19], s48 offen lds
 v_mfma_f32_16x16x32_bf16 v[160:163], a[48:51], a[88:91], v[160:163]
 v_cvt_pk_bf16_f32 v144, v144, v145
 v_cvt_pk_bf16_f32 v145, v146, v147
 v_mfma_f32_16x16x32_bf16 v[164:167], a[56:59], a[88:91], v[164:167]
 v_cvt_pk_bf16_f32 v146, v148, v149
 v_cvt_pk_bf16_f32 v147, v150, v151
 v_mfma_f32_16x16x32_bf16 v[164:167], a[60:63], a[92:95], v[164:167]
 v_cvt_pk_bf16_f32 v152, v152, v153
 v_cvt_pk_bf16_f32 v153, v154, v155
 v_mfma_f32_16x16x32_bf16 v[172:175], a[60:63], a[84:87], v[172:175]
 s_add_u32 m0, s29, 106496
 v_cvt_pk_bf16_f32 v154, v156, v157
 v_cvt_pk_bf16_f32 v155, v158, v159
 v_mfma_f32_16x16x32_bf16 v[172:175], a[56:59], a[80:83], v[172:175]
 buffer_load_dwordx4 v2, s[16:19], s49 offen lds
 v_mfma_f32_16x16x32_bf16 v[180:183], a[56:59], a[72:75], v[180:183]
 v_mfma_f32_16x16x32_bf16 v[180:183], a[60:63], a[76:79], v[180:183]
 v_mfma_f32_16x16x32_bf16 v[188:191], a[60:63], a[68:71], v[188:191]
 v_mfma_f32_16x16x32_bf16 v[188:191], a[56:59], a[64:67], v[188:191]
 s_add_u32 m0, s29, 110592
 v_mfma_f32_16x16x32_bf16 v[216:219], a[32:35], a[96:99], v[216:219]
 buffer_load_dwordx4 v2, s[16:19], s50 offen lds
 v_mfma_f32_16x16x32_bf16 v[216:219], a[36:39], a[100:103], v[216:219]
 v_cvt_pk_bf16_f32 v160, v160, v161
 v_cvt_pk_bf16_f32 v161, v162, v163
 v_mfma_f32_16x16x32_bf16 v[208:211], a[36:39], a[108:111], v[208:211]
 v_cvt_pk_bf16_f32 v162, v164, v165
 v_cvt_pk_bf16_f32 v163, v166, v167
 v_mfma_f32_16x16x32_bf16 v[208:211], a[32:35], a[104:107], v[208:211]
 v_cvt_pk_bf16_f32 v168, v168, v169
 v_cvt_pk_bf16_f32 v169, v170, v171
 v_mfma_f32_16x16x32_bf16 v[200:203], a[32:35], a[112:115], v[200:203]
 s_add_u32 m0, s29, 114688
 v_cvt_pk_bf16_f32 v170, v172, v173
 v_cvt_pk_bf16_f32 v171, v174, v175
 v_mfma_f32_16x16x32_bf16 v[200:203], a[36:39], a[116:119], v[200:203]
 buffer_load_dwordx4 v2, s[16:19], s51 offen lds
 v_mfma_f32_16x16x32_bf16 v[192:195], a[36:39], a[124:127], v[192:195]
 v_cvt_pk_bf16_f32 v176, v176, v177
 v_cvt_pk_bf16_f32 v177, v178, v179
 v_mfma_f32_16x16x32_bf16 v[192:195], a[32:35], a[120:123], v[192:195]
 v_cvt_pk_bf16_f32 v178, v180, v181
 v_cvt_pk_bf16_f32 v179, v182, v183
 v_mfma_f32_16x16x32_bf16 v[196:199], a[40:43], a[120:123], v[196:199]
 v_cvt_pk_bf16_f32 v184, v184, v185
 v_cvt_pk_bf16_f32 v185, v186, v187
 v_mfma_f32_16x16x32_bf16 v[196:199], a[44:47], a[124:127], v[196:199]
 s_add_u32 m0, s29, 118784
 v_cvt_pk_bf16_f32 v186, v188, v189
 v_cvt_pk_bf16_f32 v187, v190, v191
 v_mfma_f32_16x16x32_bf16 v[204:207], a[44:47], a[116:119], v[204:207]
 buffer_load_dwordx4 v2, s[16:19], s52 offen lds
 v_mfma_f32_16x16x32_bf16 v[204:207], a[40:43], a[112:115], v[204:207]
 v_mfma_f32_16x16x32_bf16 v[212:215], a[40:43], a[104:107], v[212:215]
 v_mfma_f32_16x16x32_bf16 v[212:215], a[44:47], a[108:111], v[212:215]
 v_mfma_f32_16x16x32_bf16 v[220:223], a[44:47], a[100:103], v[220:223]
 s_add_u32 m0, s29, 122880
 v_mfma_f32_16x16x32_bf16 v[220:223], a[40:43], a[96:99], v[220:223]
 buffer_load_dwordx4 v2, s[16:19], s53 offen lds
 v_mfma_f32_16x16x32_bf16 v[248:251], a[48:51], a[96:99], v[248:251]
 v_mfma_f32_16x16x32_bf16 v[248:251], a[52:55], a[100:103], v[248:251]
 s_waitcnt vmcnt(19)
 v_cvt_pk_bf16_f32 v192, v192, v193
 v_cvt_pk_bf16_f32 v193, v194, v195
 v_mfma_f32_16x16x32_bf16 v[240:243], a[52:55], a[108:111], v[240:243]
 s_barrier
 v_xor_b32 v7, 0, v6
 v_cvt_pk_bf16_f32 v194, v196, v197
 v_mfma_f32_16x16x32_bf16 v[240:243], a[48:51], a[104:107], v[240:243]
 s_add_u32 m0, s29, 126976
 ds_read_b64_tr_b16 a[64:65], v7 offset:0
 v_cvt_pk_bf16_f32 v195, v198, v199
 v_mfma_f32_16x16x32_bf16 v[232:235], a[48:51], a[112:115], v[232:235]
 ds_read_b64_tr_b16 a[66:67], v7 offset:4096
 buffer_load_dwordx4 v2, s[16:19], s54 offen lds
 v_mfma_f32_16x16x32_bf16 v[232:235], a[52:55], a[116:119], v[232:235]
 ds_read_b64_tr_b16 a[68:69], v7 offset:16384
 v_cvt_pk_bf16_f32 v200, v200, v201
 v_mfma_f32_16x16x32_bf16 v[224:227], a[52:55], a[124:127], v[224:227]
 ds_read_b64_tr_b16 a[70:71], v7 offset:20480
 v_xor_b32 v8, 65536, v6
 v_mfma_f32_16x16x32_bf16 v[224:227], a[48:51], a[120:123], v[224:227]
 ds_read_b64_tr_b16 a[72:73], v8 offset:0
 v_cvt_pk_bf16_f32 v201, v202, v203
 v_mfma_f32_16x16x32_bf16 v[228:231], a[56:59], a[120:123], v[228:231]
 ds_read_b64_tr_b16 a[74:75], v8 offset:4096
 v_cvt_pk_bf16_f32 v202, v204, v205
 v_mfma_f32_16x16x32_bf16 v[228:231], a[60:63], a[124:127], v[228:231]
 ds_read_b64_tr_b16 a[76:77], v8 offset:16384
 v_cvt_pk_bf16_f32 v203, v206, v207
 v_mfma_f32_16x16x32_bf16 v[236:239], a[60:63], a[116:119], v[236:239]
 ds_read_b64_tr_b16 a[78:79], v8 offset:20480
 v_xor_b32 v9, 32, v6
 v_mfma_f32_16x16x32_bf16 v[236:239], a[56:59], a[112:115], v[236:239]
 ds_read_b64_tr_b16 a[80:81], v9 offset:0
 v_cvt_pk_bf16_f32 v208, v208, v209
 v_mfma_f32_16x16x32_bf16 v[244:247], a[56:59], a[104:107], v[244:247]
 ds_read_b64_tr_b16 a[82:83], v9 offset:4096
 v_cvt_pk_bf16_f32 v209, v210, v211
 v_mfma_f32_16x16x32_bf16 v[244:247], a[60:63], a[108:111], v[244:247]
 ds_read_b64_tr_b16 a[84:85], v9 offset:16384
 v_cvt_pk_bf16_f32 v210, v212, v213
 v_mfma_f32_16x16x32_bf16 v[252:255], a[60:63], a[100:103], v[252:255]
 ds_read_b64_tr_b16 a[86:87], v9 offset:20480
 v_xor_b32 v10, 65568, v6
 v_mfma_f32_16x16x32_bf16 v[252:255], a[56:59], a[96:99], v[252:255]
 s_waitcnt lgkmcnt(6)
 ds_read_b64_tr_b16 a[88:89], v10 offset:0
 v_cvt_pk_bf16_f32 v211, v214, v215
 v_mfma_f32_16x16x32_bf16 v[28:31], a[64:67], a[128:131], 0
 ds_read_b64_tr_b16 a[90:91], v10 offset:4096
 v_cvt_pk_bf16_f32 v216, v216, v217
 v_mfma_f32_16x16x32_bf16 v[28:31], a[68:71], a[136:139], v[28:31]
 ds_read_b64_tr_b16 a[92:93], v10 offset:16384
 v_xor_b32 v7, 64, v6
 v_mfma_f32_16x16x32_bf16 v[28:31], a[72:75], a[144:147], v[28:31]
 s_waitcnt lgkmcnt(7)
 ds_read_b128 a[112:115], v14 offset:0
 ds_read_b64_tr_b16 a[94:95], v10 offset:20480
 v_mfma_f32_16x16x32_bf16 v[28:31], a[76:79], a[152:155], v[28:31]
 ds_read_b64_tr_b16 a[96:97], v7 offset:0
 v_cvt_pk_bf16_f32 v217, v218, v219
 v_mfma_f32_16x16x32_bf16 v[44:47], a[64:67], a[132:135], 0
 ds_read_b128 a[120:123], v3 offset:0
 ds_read_b64_tr_b16 a[98:99], v7 offset:4096
 v_mfma_f32_16x16x32_bf16 v[44:47], a[68:71], a[140:143], v[44:47]
 ds_read_b64_tr_b16 a[100:101], v7 offset:16384
 v_xor_b32 v8, 65600, v6
 v_mfma_f32_16x16x32_bf16 v[44:47], a[72:75], a[148:151], v[44:47]
 ds_read_b128 a[116:119], v14 offset:2048
 ds_read_b64_tr_b16 a[102:103], v7 offset:20480
 v_mfma_f32_16x16x32_bf16 v[44:47], a[76:79], a[156:159], v[44:47]
 s_waitcnt lgkmcnt(9)
 ds_read_b64_tr_b16 a[104:105], v8 offset:0
 v_cvt_pk_bf16_f32 v218, v220, v221
 v_mfma_f32_16x16x32_bf16 v[52:55], a[80:83], a[128:131], 0
 ds_read_b128 a[124:127], v3 offset:2048
 ds_read_b64_tr_b16 a[106:107], v8 offset:4096
 v_mfma_f32_16x16x32_bf16 v[52:55], a[84:87], a[136:139], v[52:55]
 ds_read_b64_tr_b16 a[108:109], v8 offset:16384
 v_cvt_pk_bf16_f32 v219, v222, v223
 v_mfma_f32_16x16x32_bf16 v[52:55], a[88:91], a[144:147], v[52:55]
 s_waitcnt lgkmcnt(10)
 ds_read_b64_tr_b16 a[110:111], v8 offset:20480
 v_xor_b32 v9, 96, v6
 v_mfma_f32_16x16x32_bf16 v[52:55], a[92:95], a[152:155], v[52:55]
 ds_read_b64_tr_b16 a[64:65], v9 offset:0
 v_cvt_pk_bf16_f32 v224, v224, v225
 v_mfma_f32_16x16x32_bf16 v[60:63], a[80:83], a[132:135], 0
 ds_read_b64_tr_b16 a[66:67], v9 offset:4096
 v_cvt_pk_bf16_f32 v225, v226, v227
 v_mfma_f32_16x16x32_bf16 v[60:63], a[84:87], a[140:143], v[60:63]
 ds_read_b64_tr_b16 a[68:69], v9 offset:16384
 v_cvt_pk_bf16_f32 v226, v228, v229
 v_mfma_f32_16x16x32_bf16 v[60:63], a[88:91], a[148:151], v[60:63]
 ds_read_b64_tr_b16 a[70:71], v9 offset:20480
 v_xor_b32 v10, 65632, v6
 v_mfma_f32_16x16x32_bf16 v[60:63], a[92:95], a[156:159], v[60:63]
 s_waitcnt lgkmcnt(6)
 ds_read_b64_tr_b16 a[72:73], v10 offset:0
 v_cvt_pk_bf16_f32 v227, v230, v231
 v_mfma_f32_16x16x32_bf16 v[20:23], a[96:99], a[128:131], 0
 ds_read_b64_tr_b16 a[74:75], v10 offset:4096
 v_cvt_pk_bf16_f32 v232, v232, v233
 v_mfma_f32_16x16x32_bf16 v[20:23], a[100:103], a[136:139], v[20:23]
 s_waitcnt lgkmcnt(8)
 ds_read_b64_tr_b16 a[76:77], v10 offset:16384
 v_xor_b32 v7, 128, v6
 v_mfma_f32_16x16x32_bf16 v[20:23], a[104:107], a[144:147], v[20:23]
 s_waitcnt lgkmcnt(7)
 s_barrier
 ds_read_b64_tr_b16 a[78:79], v10 offset:20480
 v_mfma_f32_16x16x32_bf16 v[20:23], a[108:111], a[152:155], v[20:23]
 s_add_u32 m0, s29, 131072
 ds_read_b64_tr_b16 a[80:81], v7 offset:0
 v_add_u32 v2, 0x80000, v2
 v_mfma_f32_16x16x32_bf16 v[36:39], a[96:99], a[132:135], 0
 ds_read_b64_tr_b16 a[82:83], v7 offset:4096
 buffer_load_dwordx4 v2, s[16:19], 0 offen lds
 v_mfma_f32_16x16x32_bf16 v[36:39], a[100:103], a[140:143], v[36:39]
 ds_read_b64_tr_b16 a[84:85], v7 offset:16384
 v_cvt_pk_bf16_f32 v233, v234, v235
 v_mfma_f32_16x16x32_bf16 v[36:39], a[104:107], a[148:151], v[36:39]
 ds_read_b64_tr_b16 a[86:87], v7 offset:20480
 v_xor_b32 v8, 65664, v6
 v_mfma_f32_16x16x32_bf16 v[36:39], a[108:111], a[156:159], v[36:39]
 s_waitcnt lgkmcnt(6)
 ds_read_b64_tr_b16 a[88:89], v8 offset:0
 v_cvt_pk_bf16_f32 v234, v236, v237
 v_mfma_f32_16x16x32_bf16 v[68:71], a[64:67], a[128:131], 0
 ds_read_b64_tr_b16 a[90:91], v8 offset:4096
 v_cvt_pk_bf16_f32 v235, v238, v239
 v_mfma_f32_16x16x32_bf16 v[68:71], a[68:71], a[136:139], v[68:71]
 s_add_u32 m0, s29, 135168
 ds_read_b64_tr_b16 a[92:93], v8 offset:16384
 v_cvt_pk_bf16_f32 v240, v240, v241
 v_mfma_f32_16x16x32_bf16 v[68:71], a[72:75], a[144:147], v[68:71]
 s_waitcnt lgkmcnt(7)
 ds_read_b64_tr_b16 a[94:95], v8 offset:20480
 v_xor_b32 v9, 160, v6
 v_mfma_f32_16x16x32_bf16 v[68:71], a[76:79], a[152:155], v[68:71]
 ds_read_b64_tr_b16 a[96:97], v9 offset:0
 buffer_load_dwordx4 v2, s[16:19], s48 offen lds
 v_mfma_f32_16x16x32_bf16 v[76:79], a[64:67], a[132:135], 0
 ds_read_b64_tr_b16 a[98:99], v9 offset:4096
 v_cvt_pk_bf16_f32 v241, v242, v243
 v_mfma_f32_16x16x32_bf16 v[76:79], a[68:71], a[140:143], v[76:79]
 ds_read_b64_tr_b16 a[100:101], v9 offset:16384
 v_cvt_pk_bf16_f32 v242, v244, v245
 v_mfma_f32_16x16x32_bf16 v[76:79], a[72:75], a[148:151], v[76:79]
 ds_read_b64_tr_b16 a[102:103], v9 offset:20480
 v_xor_b32 v10, 65696, v6
 v_mfma_f32_16x16x32_bf16 v[76:79], a[76:79], a[156:159], v[76:79]
 s_waitcnt lgkmcnt(6)
 ds_read_b64_tr_b16 a[104:105], v10 offset:0
 v_cvt_pk_bf16_f32 v243, v246, v247
 v_mfma_f32_16x16x32_bf16 v[84:87], a[80:83], a[128:131], 0
 s_add_u32 m0, s29, 139264
 ds_read_b64_tr_b16 a[106:107], v10 offset:4096
 v_cvt_pk_bf16_f32 v248, v248, v249
 v_mfma_f32_16x16x32_bf16 v[84:87], a[84:87], a[136:139], v[84:87]
 ds_read_b64_tr_b16 a[108:109], v10 offset:16384
 buffer_load_dwordx4 v2, s[16:19], s49 offen lds
 v_mfma_f32_16x16x32_bf16 v[84:87], a[88:91], a[144:147], v[84:87]
 s_waitcnt lgkmcnt(7)
 ds_read_b64_tr_b16 a[110:111], v10 offset:20480
 v_xor_b32 v7, 192, v6
 v_mfma_f32_16x16x32_bf16 v[84:87], a[92:95], a[152:155], v[84:87]
 ds_read_b64_tr_b16 a[64:65], v7 offset:0
 v_cvt_pk_bf16_f32 v249, v250, v251
 v_mfma_f32_16x16x32_bf16 v[92:95], a[80:83], a[132:135], 0
 ds_read_b64_tr_b16 a[66:67], v7 offset:4096
 v_cvt_pk_bf16_f32 v250, v252, v253
 v_mfma_f32_16x16x32_bf16 v[92:95], a[84:87], a[140:143], v[92:95]
 ds_read_b64_tr_b16 a[68:69], v7 offset:16384
 v_cvt_pk_bf16_f32 v251, v254, v255
 v_mfma_f32_16x16x32_bf16 v[92:95], a[88:91], a[148:151], v[92:95]
 s_add_u32 m0, s29, 143360
 ds_read_b64_tr_b16 a[70:71], v7 offset:20480
 v_xor_b32 v8, 65728, v6
 v_mfma_f32_16x16x32_bf16 v[92:95], a[92:95], a[156:159], v[92:95]
 s_waitcnt lgkmcnt(6)
 ds_read_b64_tr_b16 a[72:73], v8 offset:0
 buffer_load_dwordx4 v2, s[16:19], s50 offen lds
 v_mfma_f32_16x16x32_bf16 v[100:103], a[96:99], a[128:131], 0
 ds_read_b64_tr_b16 a[74:75], v8 offset:4096
 v_mov_b32 v12, 0
 v_mfma_f32_16x16x32_bf16 v[100:103], a[100:103], a[136:139], v[100:103]
 ds_read_b64_tr_b16 a[76:77], v8 offset:16384
 global_load_dword a248, v12, s[90:91] offset:128 sc1
 v_mfma_f32_16x16x32_bf16 v[100:103], a[104:107], a[144:147], v[100:103]
 s_waitcnt lgkmcnt(7)
 ds_read_b64_tr_b16 a[78:79], v8 offset:20480
 v_xor_b32 v9, 224, v6
 v_mfma_f32_16x16x32_bf16 v[100:103], a[108:111], a[152:155], v[100:103]
 s_and_b32 s36, s95, 31
 ds_read_b64_tr_b16 a[80:81], v9 offset:0
 v_and_b32 v12, 11, v0
 v_mfma_f32_16x16x32_bf16 v[108:111], a[96:99], a[132:135], 0
 s_add_u32 m0, s29, 147456
 ds_read_b64_tr_b16 a[82:83], v9 offset:4096
 v_lshlrev_b32 v12, 2, v12
 v_mfma_f32_16x16x32_bf16 v[108:111], a[100:103], a[140:143], v[108:111]
 ds_read_b64_tr_b16 a[84:85], v9 offset:16384
 buffer_load_dwordx4 v2, s[16:19], s51 offen lds
 v_mfma_f32_16x16x32_bf16 v[108:111], a[104:107], a[148:151], v[108:111]
 s_lshr_b32 s37, s95, 5
 ds_read_b64_tr_b16 a[86:87], v9 offset:20480
 v_xor_b32 v10, 65760, v6
 v_mfma_f32_16x16x32_bf16 v[108:111], a[108:111], a[156:159], v[108:111]
 s_waitcnt lgkmcnt(6)
 ds_read_b64_tr_b16 a[88:89], v10 offset:0
 v_mfma_f32_16x16x32_bf16 v[116:119], a[64:67], a[128:131], 0
 s_lshl_b32 s38, s3, 4
 ds_read_b64_tr_b16 a[90:91], v10 offset:4096
 v_mfma_f32_16x16x32_bf16 v[116:119], a[68:71], a[136:139], v[116:119]
 s_add_u32 m0, s29, 151552
 ds_read_b64_tr_b16 a[92:93], v10 offset:16384
 v_mfma_f32_16x16x32_bf16 v[116:119], a[72:75], a[144:147], v[116:119]
 s_waitcnt lgkmcnt(7)
 ds_read_b64_tr_b16 a[94:95], v10 offset:20480
 v_xor_b32 v7, 256, v6
 v_mfma_f32_16x16x32_bf16 v[116:119], a[76:79], a[152:155], v[116:119]
 ds_read_b64_tr_b16 a[96:97], v7 offset:0
 buffer_load_dwordx4 v2, s[16:19], s52 offen lds
 v_mfma_f32_16x16x32_bf16 v[124:127], a[64:67], a[132:135], 0
 s_lshl_b32 s39, s36, 6
 ds_read_b64_tr_b16 a[98:99], v7 offset:4096
 v_mfma_f32_16x16x32_bf16 v[124:127], a[68:71], a[140:143], v[124:127]
 s_add_u32 s38, s38, s39
 ds_read_b64_tr_b16 a[100:101], v7 offset:16384
 v_mfma_f32_16x16x32_bf16 v[124:127], a[72:75], a[148:151], v[124:127]
 s_mul_i32 s38, s38, 896
 ds_read_b64_tr_b16 a[102:103], v7 offset:20480
 v_xor_b32 v8, 65792, v6
 v_mfma_f32_16x16x32_bf16 v[124:127], a[76:79], a[156:159], v[124:127]
 s_waitcnt lgkmcnt(6)
 ds_read_b64_tr_b16 a[104:105], v8 offset:0
 v_mfma_f32_16x16x32_bf16 v[132:135], a[80:83], a[128:131], 0
 s_add_u32 m0, s29, 155648
 ds_read_b64_tr_b16 a[106:107], v8 offset:4096
 v_mfma_f32_16x16x32_bf16 v[132:135], a[84:87], a[136:139], v[132:135]
 ds_read_b64_tr_b16 a[108:109], v8 offset:16384
 buffer_load_dwordx4 v2, s[16:19], s53 offen lds
 v_mfma_f32_16x16x32_bf16 v[132:135], a[88:91], a[144:147], v[132:135]
 s_waitcnt lgkmcnt(7)
 ds_read_b64_tr_b16 a[110:111], v8 offset:20480
 v_xor_b32 v9, 288, v6
 v_mfma_f32_16x16x32_bf16 v[132:135], a[92:95], a[152:155], v[132:135]
 s_lshl_b32 s39, s37, 7
 ds_read_b64_tr_b16 a[64:65], v9 offset:0
 v_mfma_f32_16x16x32_bf16 v[140:143], a[80:83], a[132:135], 0
 s_add_u32 s38, s38, s39
 ds_read_b64_tr_b16 a[66:67], v9 offset:4096
 v_mfma_f32_16x16x32_bf16 v[140:143], a[84:87], a[140:143], v[140:143]
 s_lshl_b32 s39, s37, 9
 ds_read_b64_tr_b16 a[68:69], v9 offset:16384
 v_mfma_f32_16x16x32_bf16 v[140:143], a[88:91], a[148:151], v[140:143]
 s_add_u32 m0, s29, 159744
 ds_read_b64_tr_b16 a[70:71], v9 offset:20480
 v_xor_b32 v10, 65824, v6
 v_mfma_f32_16x16x32_bf16 v[140:143], a[92:95], a[156:159], v[140:143]
 s_waitcnt lgkmcnt(6)
 ds_read_b64_tr_b16 a[72:73], v10 offset:0
 buffer_load_dwordx4 v2, s[16:19], s54 offen lds
 v_mfma_f32_16x16x32_bf16 v[148:151], a[96:99], a[128:131], 0
 s_mov_b32 s4, s66
 ds_read_b64_tr_b16 a[74:75], v10 offset:4096
 v_mfma_f32_16x16x32_bf16 v[148:151], a[100:103], a[136:139], v[148:151]
 s_mov_b32 s5, s67
 ds_read_b64_tr_b16 a[76:77], v10 offset:16384
 v_mfma_f32_16x16x32_bf16 v[148:151], a[104:107], a[144:147], v[148:151]
 s_waitcnt lgkmcnt(7)
 ds_read_b64_tr_b16 a[78:79], v10 offset:20480
 v_xor_b32 v7, 320, v6
 v_mfma_f32_16x16x32_bf16 v[148:151], a[108:111], a[152:155], v[148:151]
 s_mov_b32 s6, 1835008
 ds_read_b64_tr_b16 a[80:81], v7 offset:0
 v_mfma_f32_16x16x32_bf16 v[156:159], a[96:99], a[132:135], 0
 s_mov_b32 s7, 0x20000
 ds_read_b64_tr_b16 a[82:83], v7 offset:4096
 v_mfma_f32_16x16x32_bf16 v[156:159], a[100:103], a[140:143], v[156:159]
 s_mov_b32 s8, s68
 ds_read_b64_tr_b16 a[84:85], v7 offset:16384
 v_mfma_f32_16x16x32_bf16 v[156:159], a[104:107], a[148:151], v[156:159]
 s_mov_b32 s9, s69
 ds_read_b64_tr_b16 a[86:87], v7 offset:20480
 v_xor_b32 v8, 65856, v6
 v_mfma_f32_16x16x32_bf16 v[156:159], a[108:111], a[156:159], v[156:159]
 s_waitcnt lgkmcnt(6)
 ds_read_b64_tr_b16 a[88:89], v8 offset:0
 v_mfma_f32_16x16x32_bf16 v[164:167], a[64:67], a[128:131], 0
 s_mov_b32 s10, 1835008
 ds_read_b64_tr_b16 a[90:91], v8 offset:4096
 v_mfma_f32_16x16x32_bf16 v[164:167], a[68:71], a[136:139], v[164:167]
 s_mov_b32 s11, 0x20000
 ds_read_b64_tr_b16 a[92:93], v8 offset:16384
 v_mfma_f32_16x16x32_bf16 v[164:167], a[72:75], a[144:147], v[164:167]
 s_waitcnt lgkmcnt(7)
 ds_read_b64_tr_b16 a[94:95], v8 offset:20480
 v_xor_b32 v9, 352, v6
 v_mfma_f32_16x16x32_bf16 v[164:167], a[76:79], a[152:155], v[164:167]
 s_mov_b32 s20, s70
 ds_read_b64_tr_b16 a[96:97], v9 offset:0
 v_mfma_f32_16x16x32_bf16 v[172:175], a[64:67], a[132:135], 0
 s_mov_b32 s21, s71
 ds_read_b64_tr_b16 a[98:99], v9 offset:4096
 v_mfma_f32_16x16x32_bf16 v[172:175], a[68:71], a[140:143], v[172:175]
 s_mov_b32 s22, 3584
 ds_read_b64_tr_b16 a[100:101], v9 offset:16384
 v_mfma_f32_16x16x32_bf16 v[172:175], a[72:75], a[148:151], v[172:175]
 s_mov_b32 s23, 0x20000
 ds_read_b64_tr_b16 a[102:103], v9 offset:20480
 v_xor_b32 v10, 65888, v6
 v_mfma_f32_16x16x32_bf16 v[172:175], a[76:79], a[156:159], v[172:175]
 s_waitcnt lgkmcnt(6)
 ds_read_b64_tr_b16 a[104:105], v10 offset:0
 v_mfma_f32_16x16x32_bf16 v[180:183], a[80:83], a[128:131], 0
 ds_read_b64_tr_b16 a[106:107], v10 offset:4096
 v_mfma_f32_16x16x32_bf16 v[180:183], a[84:87], a[136:139], v[180:183]
 ds_read_b64_tr_b16 a[108:109], v10 offset:16384
 v_mfma_f32_16x16x32_bf16 v[180:183], a[88:91], a[144:147], v[180:183]
 s_waitcnt lgkmcnt(7)
 ds_read_b64_tr_b16 a[110:111], v10 offset:20480
 v_xor_b32 v7, 384, v6
 v_mfma_f32_16x16x32_bf16 v[180:183], a[92:95], a[152:155], v[180:183]
 ds_read_b64_tr_b16 a[64:65], v7 offset:0
 v_mfma_f32_16x16x32_bf16 v[188:191], a[80:83], a[132:135], 0
 ds_read_b64_tr_b16 a[66:67], v7 offset:4096
 v_mfma_f32_16x16x32_bf16 v[188:191], a[84:87], a[140:143], v[188:191]
 ds_read_b64_tr_b16 a[68:69], v7 offset:16384
 v_mfma_f32_16x16x32_bf16 v[188:191], a[88:91], a[148:151], v[188:191]
 ds_read_b64_tr_b16 a[70:71], v7 offset:20480
 v_xor_b32 v8, 65920, v6
 v_mfma_f32_16x16x32_bf16 v[188:191], a[92:95], a[156:159], v[188:191]
 s_waitcnt lgkmcnt(6)
 ds_read_b64_tr_b16 a[72:73], v8 offset:0
 v_mfma_f32_16x16x32_bf16 v[196:199], a[96:99], a[128:131], 0
 ds_read_b64_tr_b16 a[74:75], v8 offset:4096
 v_mfma_f32_16x16x32_bf16 v[196:199], a[100:103], a[136:139], v[196:199]
 ds_read_b64_tr_b16 a[76:77], v8 offset:16384
 v_mfma_f32_16x16x32_bf16 v[196:199], a[104:107], a[144:147], v[196:199]
 s_waitcnt lgkmcnt(7)
 ds_read_b64_tr_b16 a[78:79], v8 offset:20480
 v_xor_b32 v9, 416, v6
 v_mfma_f32_16x16x32_bf16 v[196:199], a[108:111], a[152:155], v[196:199]
 ds_read_b64_tr_b16 a[80:81], v9 offset:0
 v_mfma_f32_16x16x32_bf16 v[204:207], a[96:99], a[132:135], 0
 ds_read_b64_tr_b16 a[82:83], v9 offset:4096
 v_mfma_f32_16x16x32_bf16 v[204:207], a[100:103], a[140:143], v[204:207]
 ds_read_b64_tr_b16 a[84:85], v9 offset:16384
 v_mfma_f32_16x16x32_bf16 v[204:207], a[104:107], a[148:151], v[204:207]
 ds_read_b64_tr_b16 a[86:87], v9 offset:20480
 v_xor_b32 v10, 65952, v6
 v_mfma_f32_16x16x32_bf16 v[204:207], a[108:111], a[156:159], v[204:207]
 s_waitcnt lgkmcnt(6)
 ds_read_b64_tr_b16 a[88:89], v10 offset:0
 v_mfma_f32_16x16x32_bf16 v[212:215], a[64:67], a[128:131], 0
 ds_read_b64_tr_b16 a[90:91], v10 offset:4096
 v_mfma_f32_16x16x32_bf16 v[212:215], a[68:71], a[136:139], v[212:215]
 ds_read_b64_tr_b16 a[92:93], v10 offset:16384
 v_mfma_f32_16x16x32_bf16 v[212:215], a[72:75], a[144:147], v[212:215]
 s_waitcnt lgkmcnt(7)
 ds_read_b64_tr_b16 a[94:95], v10 offset:20480
 v_xor_b32 v7, 448, v6
 v_mfma_f32_16x16x32_bf16 v[212:215], a[76:79], a[152:155], v[212:215]
 s_add_u32 s59, s56, 57344
 ds_read_b64_tr_b16 a[96:97], v7 offset:0
 v_mfma_f32_16x16x32_bf16 v[220:223], a[64:67], a[132:135], 0
 ds_read_b64_tr_b16 a[98:99], v7 offset:4096
 buffer_store_dwordx4 v[32:35], v1, s[12:15], s59 offen offset:1024 sc1
 v_mfma_f32_16x16x32_bf16 v[220:223], a[68:71], a[140:143], v[220:223]
 ds_read_b64_tr_b16 a[100:101], v7 offset:16384
 v_mfma_f32_16x16x32_bf16 v[220:223], a[72:75], a[148:151], v[220:223]
 ds_read_b64_tr_b16 a[102:103], v7 offset:20480
 v_xor_b32 v8, 65984, v6
 v_mfma_f32_16x16x32_bf16 v[220:223], a[76:79], a[156:159], v[220:223]
 s_waitcnt lgkmcnt(6)
 ds_read_b64_tr_b16 a[104:105], v8 offset:0
 v_mfma_f32_16x16x32_bf16 v[228:231], a[80:83], a[128:131], 0
 ds_read_b64_tr_b16 a[106:107], v8 offset:4096
 v_mfma_f32_16x16x32_bf16 v[228:231], a[84:87], a[136:139], v[228:231]
 ds_read_b64_tr_b16 a[108:109], v8 offset:16384
 v_mfma_f32_16x16x32_bf16 v[228:231], a[88:91], a[144:147], v[228:231]
 s_waitcnt lgkmcnt(7)
 ds_read_b64_tr_b16 a[110:111], v8 offset:20480
 v_xor_b32 v9, 480, v6
 v_mfma_f32_16x16x32_bf16 v[228:231], a[92:95], a[152:155], v[228:231]
 ds_read_b64_tr_b16 a[64:65], v9 offset:0
 v_mfma_f32_16x16x32_bf16 v[236:239], a[80:83], a[132:135], 0
 ds_read_b64_tr_b16 a[66:67], v9 offset:4096
 v_mfma_f32_16x16x32_bf16 v[236:239], a[84:87], a[140:143], v[236:239]
 ds_read_b64_tr_b16 a[68:69], v9 offset:16384
 v_mfma_f32_16x16x32_bf16 v[236:239], a[88:91], a[148:151], v[236:239]
 s_add_u32 s59, s56, 49152
 ds_read_b64_tr_b16 a[70:71], v9 offset:20480
 v_xor_b32 v10, 66016, v6
 v_mfma_f32_16x16x32_bf16 v[236:239], a[92:95], a[156:159], v[236:239]
 s_waitcnt lgkmcnt(6)
 ds_read_b64_tr_b16 a[72:73], v10 offset:0
 buffer_store_dwordx4 v[40:43], v1, s[12:15], s59 offen offset:1024 sc1
 v_mfma_f32_16x16x32_bf16 v[244:247], a[96:99], a[128:131], 0
 ds_read_b64_tr_b16 a[74:75], v10 offset:4096
 v_mfma_f32_16x16x32_bf16 v[244:247], a[100:103], a[136:139], v[244:247]
 s_waitcnt vmcnt(11)
 ds_read_b64_tr_b16 a[76:77], v10 offset:16384
 v_xor_b32 v7, 32768, v6
 v_mfma_f32_16x16x32_bf16 v[244:247], a[104:107], a[144:147], v[244:247]
 s_waitcnt lgkmcnt(7)
 s_barrier
 ds_read_b64_tr_b16 a[78:79], v10 offset:20480
 v_mfma_f32_16x16x32_bf16 v[244:247], a[108:111], a[152:155], v[244:247]
 ds_read_b64_tr_b16 a[80:81], v7 offset:0
 v_mfma_f32_16x16x32_bf16 v[252:255], a[96:99], a[132:135], 0
 ds_read_b64_tr_b16 a[82:83], v7 offset:4096
 v_mfma_f32_16x16x32_bf16 v[252:255], a[100:103], a[140:143], v[252:255]
 ds_read_b64_tr_b16 a[84:85], v7 offset:16384
 v_mfma_f32_16x16x32_bf16 v[252:255], a[104:107], a[148:151], v[252:255]
 ds_read_b64_tr_b16 a[86:87], v7 offset:20480
 v_xor_b32 v8, 98304, v6
 v_mfma_f32_16x16x32_bf16 v[252:255], a[108:111], a[156:159], v[252:255]
 s_waitcnt lgkmcnt(6)
 ds_read_b64_tr_b16 a[88:89], v8 offset:0
 v_mfma_f32_16x16x32_bf16 v[16:19], a[64:67], a[128:131], 0
 s_add_u32 s59, s56, 40960
 ds_read_b64_tr_b16 a[90:91], v8 offset:4096
 v_mfma_f32_16x16x32_bf16 v[16:19], a[68:71], a[136:139], v[16:19]
 ds_read_b64_tr_b16 a[92:93], v8 offset:16384
 buffer_store_dwordx4 v[48:51], v1, s[12:15], s59 offen offset:1024 sc1
 v_mfma_f32_16x16x32_bf16 v[16:19], a[72:75], a[144:147], v[16:19]
 s_waitcnt lgkmcnt(7)
 ds_read_b64_tr_b16 a[94:95], v8 offset:20480
 v_xor_b32 v9, 32800, v6
 v_mfma_f32_16x16x32_bf16 v[16:19], a[76:79], a[152:155], v[16:19]
 ds_read_b64_tr_b16 a[96:97], v9 offset:0
 v_mfma_f32_16x16x32_bf16 v[24:27], a[64:67], a[132:135], 0
 s_waitcnt lgkmcnt(9)
 ds_read_b64_tr_b16 a[98:99], v9 offset:4096
 v_mfma_f32_16x16x32_bf16 v[24:27], a[68:71], a[140:143], v[24:27]
 s_barrier
 ds_read_b64_tr_b16 a[100:101], v9 offset:16384
 v_mfma_f32_16x16x32_bf16 v[24:27], a[72:75], a[148:151], v[24:27]
 s_add_u32 m0, s29, 0
 ds_read_b64_tr_b16 a[102:103], v9 offset:20480
 v_xor_b32 v10, 98336, v6
 v_mfma_f32_16x16x32_bf16 v[24:27], a[76:79], a[156:159], v[24:27]
 s_waitcnt lgkmcnt(6)
 ds_read_b64_tr_b16 a[104:105], v10 offset:0
 v_add_u32 v2, 0x80000, v2
 v_mfma_f32_16x16x32_bf16 v[28:31], a[80:83], a[160:163], v[28:31]
 ds_read_b64_tr_b16 a[106:107], v10 offset:4096
 buffer_load_dwordx4 v2, s[16:19], 0 offen lds
 v_mfma_f32_16x16x32_bf16 v[28:31], a[84:87], a[168:171], v[28:31]
 s_add_u32 s59, s56, 32768
 ds_read_b64_tr_b16 a[108:109], v10 offset:16384
 v_mfma_f32_16x16x32_bf16 v[28:31], a[88:91], a[176:179], v[28:31]
 s_waitcnt lgkmcnt(7)
 ds_read_b64_tr_b16 a[110:111], v10 offset:20480
 v_xor_b32 v7, 32832, v6
 v_mfma_f32_16x16x32_bf16 v[28:31], a[92:95], a[184:187], v[28:31]
 ds_read_b64_tr_b16 a[64:65], v7 offset:0
 buffer_store_dwordx4 v[56:59], v1, s[12:15], s59 offen offset:1024 sc1
 v_mfma_f32_16x16x32_bf16 v[44:47], a[80:83], a[164:167], v[44:47]
 s_add_u32 m0, s29, 4096
 ds_read_b64_tr_b16 a[66:67], v7 offset:4096
 v_add_u32 v4, 4096, v1
 v_mfma_f32_16x16x32_bf16 v[44:47], a[84:87], a[172:175], v[44:47]
 ds_read_b64_tr_b16 a[68:69], v7 offset:16384
 buffer_load_dwordx4 v2, s[16:19], s48 offen lds
 v_mfma_f32_16x16x32_bf16 v[44:47], a[88:91], a[180:183], v[44:47]
 ds_read_b64_tr_b16 a[70:71], v7 offset:20480
 v_xor_b32 v8, 98368, v6
 v_mfma_f32_16x16x32_bf16 v[44:47], a[92:95], a[188:191], v[44:47]
 s_waitcnt lgkmcnt(6)
 ds_read_b64_tr_b16 a[72:73], v8 offset:0
 v_mfma_f32_16x16x32_bf16 v[52:55], a[96:99], a[160:163], v[52:55]
 ds_read_b64_tr_b16 a[74:75], v8 offset:4096
 v_mfma_f32_16x16x32_bf16 v[52:55], a[100:103], a[168:171], v[52:55]
 s_add_u32 m0, s29, 8192
 ds_read_b64_tr_b16 a[76:77], v8 offset:16384
 v_mfma_f32_16x16x32_bf16 v[52:55], a[104:107], a[176:179], v[52:55]
 s_waitcnt lgkmcnt(7)
 ds_read_b64_tr_b16 a[78:79], v8 offset:20480
 v_xor_b32 v9, 32864, v6
 v_mfma_f32_16x16x32_bf16 v[52:55], a[108:111], a[184:187], v[52:55]
 ds_read_b64_tr_b16 a[80:81], v9 offset:0
 buffer_load_dwordx4 v2, s[16:19], s49 offen lds
 v_mfma_f32_16x16x32_bf16 v[60:63], a[96:99], a[164:167], v[60:63]
 s_add_u32 s59, s56, 24576
 ds_read_b64_tr_b16 a[82:83], v9 offset:4096
 v_mfma_f32_16x16x32_bf16 v[60:63], a[100:103], a[172:175], v[60:63]
 ds_read_b64_tr_b16 a[84:85], v9 offset:16384
 buffer_store_dwordx4 v[64:67], v1, s[12:15], s59 offen offset:0 sc1
 v_mfma_f32_16x16x32_bf16 v[60:63], a[104:107], a[180:183], v[60:63]
 s_add_u32 m0, s29, 12288
 ds_read_b64_tr_b16 a[86:87], v9 offset:20480
 v_xor_b32 v10, 98400, v6
 v_mfma_f32_16x16x32_bf16 v[60:63], a[108:111], a[188:191], v[60:63]
 s_waitcnt lgkmcnt(6)
 ds_read_b64_tr_b16 a[88:89], v10 offset:0
 v_mfma_f32_16x16x32_bf16 v[20:23], a[64:67], a[160:163], v[20:23]
 ds_read_b64_tr_b16 a[90:91], v10 offset:4096
 buffer_load_dwordx4 v2, s[16:19], s50 offen lds
 v_mfma_f32_16x16x32_bf16 v[20:23], a[68:71], a[168:171], v[20:23]
 ds_read_b64_tr_b16 a[92:93], v10 offset:16384
 v_mfma_f32_16x16x32_bf16 v[20:23], a[72:75], a[176:179], v[20:23]
 s_waitcnt lgkmcnt(7)
 ds_read_b64_tr_b16 a[94:95], v10 offset:20480
 v_xor_b32 v7, 32896, v6
 v_mfma_f32_16x16x32_bf16 v[20:23], a[76:79], a[184:187], v[20:23]
 ds_read_b64_tr_b16 a[96:97], v7 offset:0
 v_mfma_f32_16x16x32_bf16 v[36:39], a[64:67], a[164:167], v[36:39]
 s_add_u32 m0, s29, 16384
 ds_read_b64_tr_b16 a[98:99], v7 offset:4096
 v_mfma_f32_16x16x32_bf16 v[36:39], a[68:71], a[172:175], v[36:39]
 ds_read_b64_tr_b16 a[100:101], v7 offset:16384
 buffer_load_dwordx4 v2, s[16:19], s51 offen lds
 v_mfma_f32_16x16x32_bf16 v[36:39], a[72:75], a[180:183], v[36:39]
 s_add_u32 s59, s56, 16384
 ds_read_b64_tr_b16 a[102:103], v7 offset:20480
 v_xor_b32 v8, 98432, v6
 v_mfma_f32_16x16x32_bf16 v[36:39], a[76:79], a[188:191], v[36:39]
 s_waitcnt lgkmcnt(6)
 ds_read_b64_tr_b16 a[104:105], v8 offset:0
 buffer_store_dwordx4 v[72:75], v1, s[12:15], s59 offen offset:0 sc1
 v_mfma_f32_16x16x32_bf16 v[68:71], a[80:83], a[160:163], v[68:71]
 ds_read_b64_tr_b16 a[106:107], v8 offset:4096
 v_mfma_f32_16x16x32_bf16 v[68:71], a[84:87], a[168:171], v[68:71]
 s_add_u32 m0, s29, 20480
 ds_read_b64_tr_b16 a[108:109], v8 offset:16384
 v_mfma_f32_16x16x32_bf16 v[68:71], a[88:91], a[176:179], v[68:71]
 s_waitcnt lgkmcnt(7)
 ds_read_b64_tr_b16 a[110:111], v8 offset:20480
 v_xor_b32 v9, 32928, v6
 v_mfma_f32_16x16x32_bf16 v[68:71], a[92:95], a[184:187], v[68:71]
 ds_read_b64_tr_b16 a[64:65], v9 offset:0
 buffer_load_dwordx4 v2, s[16:19], s52 offen lds
 v_mfma_f32_16x16x32_bf16 v[76:79], a[80:83], a[164:167], v[76:79]
 ds_read_b64_tr_b16 a[66:67], v9 offset:4096
 v_mfma_f32_16x16x32_bf16 v[76:79], a[84:87], a[172:175], v[76:79]
 ds_read_b64_tr_b16 a[68:69], v9 offset:16384
 v_mfma_f32_16x16x32_bf16 v[76:79], a[88:91], a[180:183], v[76:79]
 s_add_u32 m0, s29, 24576
 ds_read_b64_tr_b16 a[70:71], v9 offset:20480
 v_xor_b32 v10, 98464, v6
 v_mfma_f32_16x16x32_bf16 v[76:79], a[92:95], a[188:191], v[76:79]
 s_waitcnt lgkmcnt(6)
 ds_read_b64_tr_b16 a[72:73], v10 offset:0
 v_mfma_f32_16x16x32_bf16 v[84:87], a[96:99], a[160:163], v[84:87]
 ds_read_b64_tr_b16 a[74:75], v10 offset:4096
 buffer_load_dwordx4 v2, s[16:19], s53 offen lds
 v_mfma_f32_16x16x32_bf16 v[84:87], a[100:103], a[168:171], v[84:87]
 s_add_u32 s59, s56, 8192
 ds_read_b64_tr_b16 a[76:77], v10 offset:16384
 v_mfma_f32_16x16x32_bf16 v[84:87], a[104:107], a[176:179], v[84:87]
 s_waitcnt lgkmcnt(7)
 ds_read_b64_tr_b16 a[78:79], v10 offset:20480
 v_xor_b32 v7, 32960, v6
 v_mfma_f32_16x16x32_bf16 v[84:87], a[108:111], a[184:187], v[84:87]
 ds_read_b64_tr_b16 a[80:81], v7 offset:0
 buffer_store_dwordx4 v[80:83], v1, s[12:15], s59 offen offset:0 sc1
 v_mfma_f32_16x16x32_bf16 v[92:95], a[96:99], a[164:167], v[92:95]
 s_add_u32 m0, s29, 28672
 ds_read_b64_tr_b16 a[82:83], v7 offset:4096
 v_mfma_f32_16x16x32_bf16 v[92:95], a[100:103], a[172:175], v[92:95]
 ds_read_b64_tr_b16 a[84:85], v7 offset:16384
 buffer_load_dwordx4 v2, s[16:19], s54 offen lds
 v_mfma_f32_16x16x32_bf16 v[92:95], a[104:107], a[180:183], v[92:95]
 ds_read_b64_tr_b16 a[86:87], v7 offset:20480
 v_xor_b32 v8, 98496, v6
 v_mfma_f32_16x16x32_bf16 v[92:95], a[108:111], a[188:191], v[92:95]
 s_waitcnt lgkmcnt(6)
 ds_read_b64_tr_b16 a[88:89], v8 offset:0
 v_mfma_f32_16x16x32_bf16 v[100:103], a[64:67], a[160:163], v[100:103]
 s_add_u32 m0, s29, 65536
 ds_read_b64_tr_b16 a[90:91], v8 offset:4096
 v_add_u32 v2, 0x80000, v2
 v_mfma_f32_16x16x32_bf16 v[100:103], a[68:71], a[168:171], v[100:103]
 ds_read_b64_tr_b16 a[92:93], v8 offset:16384
 buffer_load_dwordx4 v2, s[16:19], 0 offen lds
 v_mfma_f32_16x16x32_bf16 v[100:103], a[72:75], a[176:179], v[100:103]
 s_waitcnt lgkmcnt(7)
 ds_read_b64_tr_b16 a[94:95], v8 offset:20480
 v_xor_b32 v9, 32992, v6
 v_mfma_f32_16x16x32_bf16 v[100:103], a[76:79], a[184:187], v[100:103]
 ds_read_b64_tr_b16 a[96:97], v9 offset:0
 v_mfma_f32_16x16x32_bf16 v[108:111], a[64:67], a[164:167], v[108:111]
 s_add_u32 s59, s56, 0
 ds_read_b64_tr_b16 a[98:99], v9 offset:4096
 v_mfma_f32_16x16x32_bf16 v[108:111], a[68:71], a[172:175], v[108:111]
 ds_read_b64_tr_b16 a[100:101], v9 offset:16384
 buffer_store_dwordx4 v[88:91], v1, s[12:15], s59 offen offset:0 sc1
 v_mfma_f32_16x16x32_bf16 v[108:111], a[72:75], a[180:183], v[108:111]
 s_add_u32 m0, s29, 69632
 ds_read_b64_tr_b16 a[102:103], v9 offset:20480
 v_xor_b32 v10, 98528, v6
 v_mfma_f32_16x16x32_bf16 v[108:111], a[76:79], a[188:191], v[108:111]
 s_waitcnt lgkmcnt(6)
 ds_read_b64_tr_b16 a[104:105], v10 offset:0
 buffer_load_dwordx4 v2, s[16:19], s48 offen lds
 v_mfma_f32_16x16x32_bf16 v[116:119], a[80:83], a[160:163], v[116:119]
 ds_read_b64_tr_b16 a[106:107], v10 offset:4096
 v_mfma_f32_16x16x32_bf16 v[116:119], a[84:87], a[168:171], v[116:119]
 ds_read_b64_tr_b16 a[108:109], v10 offset:16384
 v_mfma_f32_16x16x32_bf16 v[116:119], a[88:91], a[176:179], v[116:119]
 s_waitcnt lgkmcnt(7)
 ds_read_b64_tr_b16 a[110:111], v10 offset:20480
 v_xor_b32 v7, 33024, v6
 v_mfma_f32_16x16x32_bf16 v[116:119], a[92:95], a[184:187], v[116:119]
 s_add_u32 m0, s29, 73728
 ds_read_b64_tr_b16 a[64:65], v7 offset:0
 v_mfma_f32_16x16x32_bf16 v[124:127], a[80:83], a[164:167], v[124:127]
 ds_read_b64_tr_b16 a[66:67], v7 offset:4096
 buffer_load_dwordx4 v2, s[16:19], s49 offen lds
 v_mfma_f32_16x16x32_bf16 v[124:127], a[84:87], a[172:175], v[124:127]
 ds_read_b64_tr_b16 a[68:69], v7 offset:16384
 v_mfma_f32_16x16x32_bf16 v[124:127], a[88:91], a[180:183], v[124:127]
 s_add_u32 s59, s56, 24576
 ds_read_b64_tr_b16 a[70:71], v7 offset:20480
 v_xor_b32 v8, 98560, v6
 v_mfma_f32_16x16x32_bf16 v[124:127], a[92:95], a[188:191], v[124:127]
 s_waitcnt lgkmcnt(6)
 ds_read_b64_tr_b16 a[72:73], v8 offset:0
 buffer_store_dwordx4 v[96:99], v1, s[12:15], s59 offen offset:1024 sc1
 v_mfma_f32_16x16x32_bf16 v[132:135], a[96:99], a[160:163], v[132:135]
 s_add_u32 m0, s29, 77824
 ds_read_b64_tr_b16 a[74:75], v8 offset:4096
 v_mfma_f32_16x16x32_bf16 v[132:135], a[100:103], a[168:171], v[132:135]
 ds_read_b64_tr_b16 a[76:77], v8 offset:16384
 buffer_load_dwordx4 v2, s[16:19], s50 offen lds
 v_mfma_f32_16x16x32_bf16 v[132:135], a[104:107], a[176:179], v[132:135]
 s_waitcnt lgkmcnt(7)
 ds_read_b64_tr_b16 a[78:79], v8 offset:20480
 v_xor_b32 v9, 33056, v6
 v_mfma_f32_16x16x32_bf16 v[132:135], a[108:111], a[184:187], v[132:135]
 ds_read_b64_tr_b16 a[80:81], v9 offset:0
 v_mfma_f32_16x16x32_bf16 v[140:143], a[96:99], a[164:167], v[140:143]
 ds_read_b64_tr_b16 a[82:83], v9 offset:4096
 v_mfma_f32_16x16x32_bf16 v[140:143], a[100:103], a[172:175], v[140:143]
 ds_read_b64_tr_b16 a[84:85], v9 offset:16384
 v_mfma_f32_16x16x32_bf16 v[140:143], a[104:107], a[180:183], v[140:143]
 s_add_u32 m0, s29, 81920
 ds_read_b64_tr_b16 a[86:87], v9 offset:20480
 v_xor_b32 v10, 98592, v6
 v_mfma_f32_16x16x32_bf16 v[140:143], a[108:111], a[188:191], v[140:143]
 s_waitcnt lgkmcnt(6)
 ds_read_b64_tr_b16 a[88:89], v10 offset:0
 buffer_load_dwordx4 v2, s[16:19], s51 offen lds
 v_mfma_f32_16x16x32_bf16 v[148:151], a[64:67], a[160:163], v[148:151]
 s_add_u32 s59, s56, 16384
 ds_read_b64_tr_b16 a[90:91], v10 offset:4096
 v_mfma_f32_16x16x32_bf16 v[148:151], a[68:71], a[168:171], v[148:151]
 ds_read_b64_tr_b16 a[92:93], v10 offset:16384
 buffer_store_dwordx4 v[104:107], v1, s[12:15], s59 offen offset:1024 sc1
 v_mfma_f32_16x16x32_bf16 v[148:151], a[72:75], a[176:179], v[148:151]
 s_waitcnt lgkmcnt(7)
 ds_read_b64_tr_b16 a[94:95], v10 offset:20480
 v_xor_b32 v7, 33088, v6
 v_mfma_f32_16x16x32_bf16 v[148:151], a[76:79], a[184:187], v[148:151]
 s_add_u32 m0, s29, 86016
 ds_read_b64_tr_b16 a[96:97], v7 offset:0
 v_mfma_f32_16x16x32_bf16 v[156:159], a[64:67], a[164:167], v[156:159]
 ds_read_b64_tr_b16 a[98:99], v7 offset:4096
 buffer_load_dwordx4 v2, s[16:19], s52 offen lds
 v_mfma_f32_16x16x32_bf16 v[156:159], a[68:71], a[172:175], v[156:159]
 ds_read_b64_tr_b16 a[100:101], v7 offset:16384
 v_mfma_f32_16x16x32_bf16 v[156:159], a[72:75], a[180:183], v[156:159]
 ds_read_b64_tr_b16 a[102:103], v7 offset:20480
 v_xor_b32 v8, 98624, v6
 v_mfma_f32_16x16x32_bf16 v[156:159], a[76:79], a[188:191], v[156:159]
 s_waitcnt lgkmcnt(6)
 ds_read_b64_tr_b16 a[104:105], v8 offset:0
 v_mfma_f32_16x16x32_bf16 v[164:167], a[80:83], a[160:163], v[164:167]
 s_add_u32 m0, s29, 90112
 ds_read_b64_tr_b16 a[106:107], v8 offset:4096
 v_mfma_f32_16x16x32_bf16 v[164:167], a[84:87], a[168:171], v[164:167]
 ds_read_b64_tr_b16 a[108:109], v8 offset:16384
 buffer_load_dwordx4 v2, s[16:19], s53 offen lds
 v_mfma_f32_16x16x32_bf16 v[164:167], a[88:91], a[176:179], v[164:167]
 s_waitcnt lgkmcnt(7)
 ds_read_b64_tr_b16 a[110:111], v8 offset:20480
 v_xor_b32 v9, 33120, v6
 v_mfma_f32_16x16x32_bf16 v[164:167], a[92:95], a[184:187], v[164:167]
 s_add_u32 s59, s56, 8192
 ds_read_b64_tr_b16 a[64:65], v9 offset:0
 v_mfma_f32_16x16x32_bf16 v[172:175], a[80:83], a[164:167], v[172:175]
 ds_read_b64_tr_b16 a[66:67], v9 offset:4096
 buffer_store_dwordx4 v[112:115], v1, s[12:15], s59 offen offset:1024 sc1
 v_mfma_f32_16x16x32_bf16 v[172:175], a[84:87], a[172:175], v[172:175]
 ds_read_b64_tr_b16 a[68:69], v9 offset:16384
 v_mfma_f32_16x16x32_bf16 v[172:175], a[88:91], a[180:183], v[172:175]
 s_add_u32 m0, s29, 94208
 ds_read_b64_tr_b16 a[70:71], v9 offset:20480
 v_xor_b32 v10, 98656, v6
 v_mfma_f32_16x16x32_bf16 v[172:175], a[92:95], a[188:191], v[172:175]
 s_waitcnt lgkmcnt(6)
 ds_read_b64_tr_b16 a[72:73], v10 offset:0
 buffer_load_dwordx4 v2, s[16:19], s54 offen lds
 v_mfma_f32_16x16x32_bf16 v[180:183], a[96:99], a[160:163], v[180:183]
 ds_read_b64_tr_b16 a[74:75], v10 offset:4096
 v_mfma_f32_16x16x32_bf16 v[180:183], a[100:103], a[168:171], v[180:183]
 ds_read_b64_tr_b16 a[76:77], v10 offset:16384
 v_mfma_f32_16x16x32_bf16 v[180:183], a[104:107], a[176:179], v[180:183]
 s_waitcnt lgkmcnt(7)
 ds_read_b64_tr_b16 a[78:79], v10 offset:20480
 v_xor_b32 v7, 33152, v6
 v_mfma_f32_16x16x32_bf16 v[180:183], a[108:111], a[184:187], v[180:183]
 ds_read_b64_tr_b16 a[80:81], v7 offset:0
 v_mfma_f32_16x16x32_bf16 v[188:191], a[96:99], a[164:167], v[188:191]
 ds_read_b64_tr_b16 a[82:83], v7 offset:4096
 v_mfma_f32_16x16x32_bf16 v[188:191], a[100:103], a[172:175], v[188:191]
 ds_read_b64_tr_b16 a[84:85], v7 offset:16384
 v_mfma_f32_16x16x32_bf16 v[188:191], a[104:107], a[180:183], v[188:191]
 s_add_u32 s59, s56, 0
 ds_read_b64_tr_b16 a[86:87], v7 offset:20480
 v_xor_b32 v8, 98688, v6
 v_mfma_f32_16x16x32_bf16 v[188:191], a[108:111], a[188:191], v[188:191]
 s_waitcnt lgkmcnt(6)
 ds_read_b64_tr_b16 a[88:89], v8 offset:0
 buffer_store_dwordx4 v[120:123], v1, s[12:15], s59 offen offset:1024 sc1
 v_mfma_f32_16x16x32_bf16 v[196:199], a[64:67], a[160:163], v[196:199]
 ds_read_b64_tr_b16 a[90:91], v8 offset:4096
 v_mfma_f32_16x16x32_bf16 v[196:199], a[68:71], a[168:171], v[196:199]
 ds_read_b64_tr_b16 a[92:93], v8 offset:16384
 v_mfma_f32_16x16x32_bf16 v[196:199], a[72:75], a[176:179], v[196:199]
 s_waitcnt lgkmcnt(7)
 ds_read_b64_tr_b16 a[94:95], v8 offset:20480
 v_xor_b32 v9, 33184, v6
 v_mfma_f32_16x16x32_bf16 v[196:199], a[76:79], a[184:187], v[196:199]
 ds_read_b64_tr_b16 a[96:97], v9 offset:0
 v_mfma_f32_16x16x32_bf16 v[204:207], a[64:67], a[164:167], v[204:207]
 ds_read_b64_tr_b16 a[98:99], v9 offset:4096
 v_mfma_f32_16x16x32_bf16 v[204:207], a[68:71], a[172:175], v[204:207]
 ds_read_b64_tr_b16 a[100:101], v9 offset:16384
 v_mfma_f32_16x16x32_bf16 v[204:207], a[72:75], a[180:183], v[204:207]
 ds_read_b64_tr_b16 a[102:103], v9 offset:20480
 v_xor_b32 v10, 98720, v6
 v_mfma_f32_16x16x32_bf16 v[204:207], a[76:79], a[188:191], v[204:207]
 s_waitcnt lgkmcnt(6)
 ds_read_b64_tr_b16 a[104:105], v10 offset:0
 v_mfma_f32_16x16x32_bf16 v[212:215], a[80:83], a[160:163], v[212:215]
 s_add_u32 s59, s56, 24576
 ds_read_b64_tr_b16 a[106:107], v10 offset:4096
 v_mfma_f32_16x16x32_bf16 v[212:215], a[84:87], a[168:171], v[212:215]
 ds_read_b64_tr_b16 a[108:109], v10 offset:16384
 buffer_store_dwordx4 v[128:131], v1, s[12:15], s59 offen offset:2048 sc1
 v_mfma_f32_16x16x32_bf16 v[212:215], a[88:91], a[176:179], v[212:215]
 s_waitcnt lgkmcnt(7)
 ds_read_b64_tr_b16 a[110:111], v10 offset:20480
 v_xor_b32 v7, 33216, v6
 v_mfma_f32_16x16x32_bf16 v[212:215], a[92:95], a[184:187], v[212:215]
 ds_read_b64_tr_b16 a[64:65], v7 offset:0
 v_lshrrev_b32 v120, 3, v0
 v_mfma_f32_16x16x32_bf16 v[220:223], a[80:83], a[164:167], v[220:223]
 ds_read_b64_tr_b16 a[66:67], v7 offset:4096
 v_mul_u32_u24 v120, 1792, v120
 v_mfma_f32_16x16x32_bf16 v[220:223], a[84:87], a[172:175], v[220:223]
 ds_read_b64_tr_b16 a[68:69], v7 offset:16384
 v_and_b32 v121, 7, v0
 v_mfma_f32_16x16x32_bf16 v[220:223], a[88:91], a[180:183], v[220:223]
 ds_read_b64_tr_b16 a[70:71], v7 offset:20480
 v_xor_b32 v8, 98752, v6
 v_mfma_f32_16x16x32_bf16 v[220:223], a[92:95], a[188:191], v[220:223]
 s_waitcnt lgkmcnt(6)
 ds_read_b64_tr_b16 a[72:73], v8 offset:0
 v_lshl_add_u32 v120, v121, 4, v120
 v_mfma_f32_16x16x32_bf16 v[228:231], a[96:99], a[160:163], v[228:231]
 ds_read_b64_tr_b16 a[74:75], v8 offset:4096
 v_add_u32 v120, s38, v120
 v_mfma_f32_16x16x32_bf16 v[228:231], a[100:103], a[168:171], v[228:231]
 s_add_u32 s59, s56, 16384
 ds_read_b64_tr_b16 a[76:77], v8 offset:16384
 v_lshlrev_b32 v121, 6, v121
 v_mfma_f32_16x16x32_bf16 v[228:231], a[104:107], a[176:179], v[228:231]
 s_waitcnt lgkmcnt(7)
 ds_read_b64_tr_b16 a[78:79], v8 offset:20480
 v_xor_b32 v9, 33248, v6
 v_mfma_f32_16x16x32_bf16 v[228:231], a[108:111], a[184:187], v[228:231]
 ds_read_b64_tr_b16 a[80:81], v9 offset:0
 buffer_store_dwordx4 v[136:139], v1, s[12:15], s59 offen offset:2048 sc1
 v_mfma_f32_16x16x32_bf16 v[236:239], a[96:99], a[164:167], v[236:239]
 ds_read_b64_tr_b16 a[82:83], v9 offset:4096
 v_subrev_u32 v122, 2688, v120
 v_mfma_f32_16x16x32_bf16 v[236:239], a[100:103], a[172:175], v[236:239]
 ds_read_b64_tr_b16 a[84:85], v9 offset:16384
 v_subrev_u32 v123, 1792, v120
 v_mfma_f32_16x16x32_bf16 v[236:239], a[104:107], a[180:183], v[236:239]
 ds_read_b64_tr_b16 a[86:87], v9 offset:20480
 v_xor_b32 v10, 98784, v6
 v_mfma_f32_16x16x32_bf16 v[236:239], a[108:111], a[188:191], v[236:239]
 s_waitcnt lgkmcnt(6)
 ds_read_b64_tr_b16 a[88:89], v10 offset:0
 v_subrev_u32 v128, 896, v120
 v_mfma_f32_16x16x32_bf16 v[244:247], a[64:67], a[160:163], v[244:247]
 ds_read_b64_tr_b16 a[90:91], v10 offset:4096
 buffer_load_dwordx4 v[32:35], v122, s[4:7], 0 offen
 v_mfma_f32_16x16x32_bf16 v[244:247], a[68:71], a[168:171], v[244:247]
 s_waitcnt vmcnt(4)
 ds_read_b64_tr_b16 a[92:93], v10 offset:16384
 v_xor_b32 v7, 131072, v6
 v_mfma_f32_16x16x32_bf16 v[244:247], a[72:75], a[176:179], v[244:247]
 s_waitcnt lgkmcnt(7)
 s_barrier
 ds_read_b64_tr_b16 a[94:95], v10 offset:20480
 v_mfma_f32_16x16x32_bf16 v[244:247], a[76:79], a[184:187], v[244:247]
 s_and_b32 s58, s92, ~127
 ds_read_b64_tr_b16 a[96:97], v7 offset:0
 v_mfma_f32_16x16x32_bf16 v[252:255], a[64:67], a[164:167], v[252:255]
 s_add_u32 s59, s56, 8192
 ds_read_b64_tr_b16 a[98:99], v7 offset:4096
 v_mfma_f32_16x16x32_bf16 v[252:255], a[68:71], a[172:175], v[252:255]
 ds_read_b64_tr_b16 a[100:101], v7 offset:16384
 buffer_store_dwordx4 v[144:147], v1, s[12:15], s59 offen offset:2048 sc1
 v_mfma_f32_16x16x32_bf16 v[252:255], a[72:75], a[180:183], v[252:255]
 s_lshl_b32 s37, s25, 1
 ds_read_b64_tr_b16 a[102:103], v7 offset:20480
 v_xor_b32 v8, 0, v6
 v_mfma_f32_16x16x32_bf16 v[252:255], a[76:79], a[188:191], v[252:255]
 s_waitcnt lgkmcnt(6)
 ds_read_b64_tr_b16 a[104:105], v8 offset:0
 buffer_load_dwordx4 v[40:43], v123, s[4:7], 0 offen
 v_mfma_f32_16x16x32_bf16 v[16:19], a[80:83], a[160:163], v[16:19]
 s_sub_i32 s38, 12, s37
 ds_read_b64_tr_b16 a[106:107], v8 offset:4096
 v_accvgpr_read_b32 v5, a248
 v_mfma_f32_16x16x32_bf16 v[16:19], a[84:87], a[168:171], v[16:19]
 s_max_i32 s38, s38, 0
 ds_read_b64_tr_b16 a[108:109], v8 offset:16384
 v_mfma_f32_16x16x32_bf16 v[16:19], a[88:91], a[176:179], v[16:19]
 s_waitcnt lgkmcnt(7)
 ds_read_b64_tr_b16 a[110:111], v8 offset:20480
 v_xor_b32 v9, 65536, v6
 v_mfma_f32_16x16x32_bf16 v[16:19], a[92:95], a[184:187], v[16:19]
 ds_read_b64_tr_b16 a[64:65], v9 offset:0
 buffer_load_dwordx4 v[48:51], v128, s[4:7], 0 offen
 v_mfma_f32_16x16x32_bf16 v[24:27], a[80:83], a[164:167], v[24:27]
 s_mul_i32 s49, s26, 1048576
 ds_read_b64_tr_b16 a[66:67], v9 offset:4096
 v_mfma_f32_16x16x32_bf16 v[24:27], a[84:87], a[172:175], v[24:27]
 s_lshl_b32 s50, s3, 13
 ds_read_b64_tr_b16 a[68:69], v9 offset:16384
 v_mfma_f32_16x16x32_bf16 v[24:27], a[88:91], a[180:183], v[24:27]
 s_add_u32 s59, s56, 0
 ds_read_b64_tr_b16 a[70:71], v9 offset:20480
 v_xor_b32 v10, 131104, v6
 v_mfma_f32_16x16x32_bf16 v[24:27], a[92:95], a[188:191], v[24:27]
 s_waitcnt lgkmcnt(6)
 ds_read_b64_tr_b16 a[72:73], v10 offset:0
 buffer_store_dwordx4 v[152:155], v1, s[12:15], s59 offen offset:2048 sc1
 v_mfma_f32_16x16x32_bf16 v[28:31], a[96:99], a[192:195], v[28:31]
 s_add_u32 s49, s49, s50
 ds_read_b64_tr_b16 a[74:75], v10 offset:4096
 v_mfma_f32_16x16x32_bf16 v[28:31], a[100:103], a[200:203], v[28:31]
 ds_read_b64_tr_b16 a[76:77], v10 offset:16384
 buffer_load_dwordx4 v[56:59], v120, s[4:7], 0 offen offset:0
 v_mfma_f32_16x16x32_bf16 v[28:31], a[104:107], a[208:211], v[28:31]
 s_waitcnt lgkmcnt(3)
 ds_read_b64_tr_b16 a[78:79], v10 offset:20480
 v_xor_b32 v7, 32, v6
 v_mfma_f32_16x16x32_bf16 v[28:31], a[108:111], a[216:219], v[28:31]
 s_mov_b32 s54, 0
 ds_read_b64_tr_b16 a[80:81], v7 offset:0
 v_mfma_f32_16x16x32_bf16 v[28:31], a[64:67], a[112:115], v[28:31]
 s_add_u32 s44, s37, 1
 ds_read_b64_tr_b16 a[82:83], v7 offset:4096
 v_mfma_f32_16x16x32_bf16 v[28:31], a[68:71], a[120:123], v[28:31]
 ds_read_b64_tr_b16 a[84:85], v7 offset:16384
 buffer_load_dwordx4 v[64:67], v120, s[4:7], 0 offen offset:896
 v_mfma_f32_16x16x32_bf16 v[44:47], a[96:99], a[196:199], v[44:47]
 s_mov_b32 s42, s49
 ds_read_b64_tr_b16 a[86:87], v7 offset:20480
 v_xor_b32 v8, 65568, v6
 v_mfma_f32_16x16x32_bf16 v[44:47], a[100:103], a[204:207], v[44:47]
 s_add_u32 s60, s94, 4
 ds_read_b64_tr_b16 a[88:89], v8 offset:0
 v_mfma_f32_16x16x32_bf16 v[44:47], a[104:107], a[212:215], v[44:47]
 s_add_u32 s59, s56, 24576
 ds_read_b64_tr_b16 a[90:91], v8 offset:4096
 v_mfma_f32_16x16x32_bf16 v[44:47], a[108:111], a[220:223], v[44:47]
 ds_read_b64_tr_b16 a[92:93], v8 offset:16384
 buffer_store_dwordx4 v[160:163], v1, s[12:15], s59 offen offset:3072 sc1
 v_mfma_f32_16x16x32_bf16 v[44:47], a[64:67], a[116:119], v[44:47]
 s_mov_b32 s45, 2
 ds_read_b64_tr_b16 a[94:95], v8 offset:20480
 v_xor_b32 v9, 131136, v6
 v_mfma_f32_16x16x32_bf16 v[44:47], a[68:71], a[124:127], v[44:47]
 s_waitcnt lgkmcnt(6)
 ds_read_b64_tr_b16 a[96:97], v9 offset:0
 buffer_load_dwordx4 v[72:75], v120, s[8:11], 0 offen offset:0
 v_mfma_f32_16x16x32_bf16 v[52:55], a[72:75], a[192:195], v[52:55]
 s_mov_b32 s66, 1
 ds_read_b64_tr_b16 a[98:99], v9 offset:4096
 v_mfma_f32_16x16x32_bf16 v[52:55], a[76:79], a[200:203], v[52:55]
 s_mov_b32 s68, 1
 ds_read_b64_tr_b16 a[100:101], v9 offset:16384
 v_mfma_f32_16x16x32_bf16 v[52:55], a[80:83], a[208:211], v[52:55]
 s_waitcnt lgkmcnt(3)
 ds_read_b64_tr_b16 a[102:103], v9 offset:20480
 v_xor_b32 v10, 64, v6
 v_mfma_f32_16x16x32_bf16 v[52:55], a[84:87], a[216:219], v[52:55]
 ds_read_b64_tr_b16 a[104:105], v10 offset:0
 buffer_load_dwordx4 v[80:83], v120, s[8:11], 0 offen offset:896
 v_mfma_f32_16x16x32_bf16 v[52:55], a[88:91], a[112:115], v[52:55]
 s_mov_b32 s70, 32768
 ds_read_b64_tr_b16 a[106:107], v10 offset:4096
 v_mfma_f32_16x16x32_bf16 v[52:55], a[92:95], a[120:123], v[52:55]
 s_mov_b32 s71, s70
 ds_read_b64_tr_b16 a[108:109], v10 offset:16384
 v_mfma_f32_16x16x32_bf16 v[60:63], a[72:75], a[196:199], v[60:63]
 s_add_u32 s59, s56, 16384
 ds_read_b64_tr_b16 a[110:111], v10 offset:20480
 v_xor_b32 v7, 65600, v6
 v_mfma_f32_16x16x32_bf16 v[60:63], a[76:79], a[204:207], v[60:63]
 ds_read_b64_tr_b16 a[64:65], v7 offset:0
 buffer_store_dwordx4 v[168:171], v1, s[12:15], s59 offen offset:3072 sc1
 v_mfma_f32_16x16x32_bf16 v[60:63], a[80:83], a[212:215], v[60:63]
 s_add_u32 s43, s42, 16777216
 ds_read_b64_tr_b16 a[66:67], v7 offset:4096
 v_mfma_f32_16x16x32_bf16 v[60:63], a[84:87], a[220:223], v[60:63]
 ds_read_b64_tr_b16 a[68:69], v7 offset:16384
 buffer_load_dwordx4 v[88:91], v121, s[20:23], s39 offen offset:0
 v_mfma_f32_16x16x32_bf16 v[60:63], a[88:91], a[116:119], v[60:63]
 s_mov_b32 s40, s50
 ds_read_b64_tr_b16 a[70:71], v7 offset:20480
 v_xor_b32 v8, 131168, v6
 v_mfma_f32_16x16x32_bf16 v[60:63], a[92:95], a[124:127], v[60:63]
 s_waitcnt lgkmcnt(6)
 ds_read_b64_tr_b16 a[72:73], v8 offset:0
 v_mfma_f32_16x16x32_bf16 v[20:23], a[96:99], a[192:195], v[20:23]
 s_add_u32 s41, s50, 0x10000
 ds_read_b64_tr_b16 a[74:75], v8 offset:4096
 v_mfma_f32_16x16x32_bf16 v[20:23], a[100:103], a[200:203], v[20:23]
 ds_read_b64_tr_b16 a[76:77], v8 offset:16384
 buffer_load_dwordx4 v[96:99], v121, s[20:23], s39 offen offset:16
 v_mfma_f32_16x16x32_bf16 v[20:23], a[104:107], a[208:211], v[20:23]
 s_waitcnt lgkmcnt(3)
 ds_read_b64_tr_b16 a[78:79], v8 offset:20480
 v_xor_b32 v9, 96, v6
 v_mfma_f32_16x16x32_bf16 v[20:23], a[108:111], a[216:219], v[20:23]
 s_lshr_b32 s61, s95, 4
 ds_read_b64_tr_b16 a[80:81], v9 offset:0
 v_mul_f32 v28, s34, v28
 v_mfma_f32_16x16x32_bf16 v[20:23], a[64:67], a[112:115], v[20:23]
 s_add_u32 s59, s56, 8192
 ds_read_b64_tr_b16 a[82:83], v9 offset:4096
 v_mul_f32 v29, s34, v29
 v_mfma_f32_16x16x32_bf16 v[20:23], a[68:71], a[120:123], v[20:23]
 ds_read_b64_tr_b16 a[84:85], v9 offset:16384
 buffer_store_dwordx4 v[176:179], v1, s[12:15], s59 offen offset:3072 sc1
 v_mfma_f32_16x16x32_bf16 v[36:39], a[96:99], a[196:199], v[36:39]
 s_lshl_b32 s61, s61, 7
 ds_read_b64_tr_b16 a[86:87], v9 offset:20480
 v_xor_b32 v10, 65632, v6
 v_mfma_f32_16x16x32_bf16 v[36:39], a[100:103], a[204:207], v[36:39]
 ds_read_b64_tr_b16 a[88:89], v10 offset:0
 buffer_load_dwordx4 v[104:107], v121, s[20:23], s39 offen offset:32
 v_mfma_f32_16x16x32_bf16 v[36:39], a[104:107], a[212:215], v[36:39]
 s_add_u32 s61, s61, 84959232
 ds_read_b64_tr_b16 a[90:91], v10 offset:4096
 v_mul_f32 v30, s34, v30
 v_mfma_f32_16x16x32_bf16 v[36:39], a[108:111], a[220:223], v[36:39]
 s_mov_b32 s47, 0x4b800000
 ds_read_b64_tr_b16 a[92:93], v10 offset:16384
 v_mul_f32 v31, s34, v31
 v_mfma_f32_16x16x32_bf16 v[36:39], a[64:67], a[116:119], v[36:39]
 s_lshl_b32 s30, s95, 1
 ds_read_b64_tr_b16 a[94:95], v10 offset:20480
 v_xor_b32 v7, 131200, v6
 v_mfma_f32_16x16x32_bf16 v[36:39], a[68:71], a[124:127], v[36:39]
 s_waitcnt lgkmcnt(6)
 ds_read_b64_tr_b16 a[96:97], v7 offset:0
 buffer_load_dwordx4 v[112:115], v121, s[20:23], s39 offen offset:48
 v_mfma_f32_16x16x32_bf16 v[68:71], a[72:75], a[192:195], v[68:71]
 s_lshr_b32 s31, s3, 1
 ds_read_b64_tr_b16 a[98:99], v7 offset:4096
 v_mul_f32 v52, s34, v52
 v_mfma_f32_16x16x32_bf16 v[68:71], a[76:79], a[200:203], v[68:71]
 s_add_u32 s59, s56, 0
 ds_read_b64_tr_b16 a[100:101], v7 offset:16384
 v_mul_f32 v53, s34, v53
 v_mfma_f32_16x16x32_bf16 v[68:71], a[80:83], a[208:211], v[68:71]
 s_waitcnt lgkmcnt(3)
 ds_read_b64_tr_b16 a[102:103], v7 offset:20480
 v_xor_b32 v8, 128, v6
 v_mfma_f32_16x16x32_bf16 v[68:71], a[84:87], a[216:219], v[68:71]
 ds_read_b64_tr_b16 a[104:105], v8 offset:0
 buffer_store_dwordx4 v[184:187], v1, s[12:15], s59 offen offset:3072 sc1
 v_mfma_f32_16x16x32_bf16 v[68:71], a[88:91], a[112:115], v[68:71]
 s_add_u32 s30, s30, s31
 ds_read_b64_tr_b16 a[106:107], v8 offset:4096
 v_mul_f32 v54, s34, v54
 v_mfma_f32_16x16x32_bf16 v[68:71], a[92:95], a[120:123], v[68:71]
 s_min_u32 s30, s30, 223
 ds_read_b64_tr_b16 a[108:109], v8 offset:16384
 v_mul_f32 v55, s34, v55
 v_mfma_f32_16x16x32_bf16 v[76:79], a[72:75], a[196:199], v[76:79]
 s_lshl_b32 s30, s30, 2
 ds_read_b64_tr_b16 a[110:111], v8 offset:20480
 v_xor_b32 v9, 65664, v6
 v_mfma_f32_16x16x32_bf16 v[76:79], a[76:79], a[204:207], v[76:79]
 s_lshl_b32 s53, s3, 4
 ds_read_b64_tr_b16 a[64:65], v9 offset:0
 v_cvt_pk_bf16_f32 v28, v28, v29
 v_mfma_f32_16x16x32_bf16 v[76:79], a[80:83], a[212:215], v[76:79]
 ds_read_b64_tr_b16 a[66:67], v9 offset:4096
 v_cvt_pk_bf16_f32 v29, v30, v31
 v_mfma_f32_16x16x32_bf16 v[76:79], a[84:87], a[220:223], v[76:79]
 ds_read_b64_tr_b16 a[68:69], v9 offset:16384
 v_cvt_pk_bf16_f32 v30, v52, v53
 v_mfma_f32_16x16x32_bf16 v[76:79], a[88:91], a[116:119], v[76:79]
 ds_read_b64_tr_b16 a[70:71], v9 offset:20480
 v_xor_b32 v10, 131232, v6
 v_mfma_f32_16x16x32_bf16 v[76:79], a[92:95], a[124:127], v[76:79]
 s_waitcnt lgkmcnt(6)
 ds_read_b64_tr_b16 a[72:73], v10 offset:0
 v_cvt_pk_bf16_f32 v31, v54, v55
 v_mfma_f32_16x16x32_bf16 v[84:87], a[96:99], a[192:195], v[84:87]
 s_add_u32 s59, s56, 57344
 ds_read_b64_tr_b16 a[74:75], v10 offset:4096
 v_accvgpr_write_b32 a0, v28
 v_mfma_f32_16x16x32_bf16 v[84:87], a[100:103], a[200:203], v[84:87]
 ds_read_b64_tr_b16 a[76:77], v10 offset:16384
 buffer_store_dwordx4 v[192:195], v1, s[12:15], s59 offen offset:2048 sc1
 v_mfma_f32_16x16x32_bf16 v[84:87], a[104:107], a[208:211], v[84:87]
 s_waitcnt lgkmcnt(3)
 ds_read_b64_tr_b16 a[78:79], v10 offset:20480
 v_xor_b32 v7, 160, v6
 v_mfma_f32_16x16x32_bf16 v[84:87], a[108:111], a[216:219], v[84:87]
 ds_read_b64_tr_b16 a[80:81], v7 offset:0
 v_accvgpr_write_b32 a1, v29
 v_mfma_f32_16x16x32_bf16 v[84:87], a[64:67], a[112:115], v[84:87]
 ds_read_b64_tr_b16 a[82:83], v7 offset:4096
 v_accvgpr_write_b32 a2, v30
 v_mfma_f32_16x16x32_bf16 v[84:87], a[68:71], a[120:123], v[84:87]
 ds_read_b64_tr_b16 a[84:85], v7 offset:16384
 v_accvgpr_write_b32 a3, v31
 v_mfma_f32_16x16x32_bf16 v[92:95], a[96:99], a[196:199], v[92:95]
 ds_read_b64_tr_b16 a[86:87], v7 offset:20480
 v_xor_b32 v8, 65696, v6
 v_mfma_f32_16x16x32_bf16 v[92:95], a[100:103], a[204:207], v[92:95]
 ds_read_b64_tr_b16 a[88:89], v8 offset:0
 v_mul_f32 v44, s34, v44
 v_mfma_f32_16x16x32_bf16 v[92:95], a[104:107], a[212:215], v[92:95]
 ds_read_b64_tr_b16 a[90:91], v8 offset:4096
 v_mul_f32 v45, s34, v45
 v_mfma_f32_16x16x32_bf16 v[92:95], a[108:111], a[220:223], v[92:95]
 ds_read_b64_tr_b16 a[92:93], v8 offset:16384
 v_mul_f32 v46, s34, v46
 v_mfma_f32_16x16x32_bf16 v[92:95], a[64:67], a[116:119], v[92:95]
 s_add_u32 s59, s56, 49152
 ds_read_b64_tr_b16 a[94:95], v8 offset:20480
 v_xor_b32 v9, 131264, v6
 v_mfma_f32_16x16x32_bf16 v[92:95], a[68:71], a[124:127], v[92:95]
 s_waitcnt lgkmcnt(6)
 ds_read_b64_tr_b16 a[96:97], v9 offset:0
 buffer_store_dwordx4 v[200:203], v1, s[12:15], s59 offen offset:2048 sc1
 v_mfma_f32_16x16x32_bf16 v[100:103], a[72:75], a[192:195], v[100:103]
 ds_read_b64_tr_b16 a[98:99], v9 offset:4096
 v_mul_f32 v47, s34, v47
 v_mfma_f32_16x16x32_bf16 v[100:103], a[76:79], a[200:203], v[100:103]
 ds_read_b64_tr_b16 a[100:101], v9 offset:16384
 v_mul_f32 v60, s34, v60
 v_mfma_f32_16x16x32_bf16 v[100:103], a[80:83], a[208:211], v[100:103]
 s_waitcnt lgkmcnt(3)
 ds_read_b64_tr_b16 a[102:103], v9 offset:20480
 v_xor_b32 v10, 192, v6
 v_mfma_f32_16x16x32_bf16 v[100:103], a[84:87], a[216:219], v[100:103]
 ds_read_b64_tr_b16 a[104:105], v10 offset:0
 v_mul_f32 v61, s34, v61
 v_mfma_f32_16x16x32_bf16 v[100:103], a[88:91], a[112:115], v[100:103]
 ds_read_b64_tr_b16 a[106:107], v10 offset:4096
 v_mul_f32 v62, s34, v62
 v_mfma_f32_16x16x32_bf16 v[100:103], a[92:95], a[120:123], v[100:103]
 ds_read_b64_tr_b16 a[108:109], v10 offset:16384
 v_mul_f32 v63, s34, v63
 v_mfma_f32_16x16x32_bf16 v[108:111], a[72:75], a[196:199], v[108:111]
 ds_read_b64_tr_b16 a[110:111], v10 offset:20480
 v_xor_b32 v7, 65728, v6
 v_mfma_f32_16x16x32_bf16 v[108:111], a[76:79], a[204:207], v[108:111]
 ds_read_b64_tr_b16 a[64:65], v7 offset:0
 v_cvt_pk_bf16_f32 v44, v44, v45
 v_mfma_f32_16x16x32_bf16 v[108:111], a[80:83], a[212:215], v[108:111]
 s_add_u32 s59, s56, 40960
 ds_read_b64_tr_b16 a[66:67], v7 offset:4096
 v_cvt_pk_bf16_f32 v45, v46, v47
 v_mfma_f32_16x16x32_bf16 v[108:111], a[84:87], a[220:223], v[108:111]
 ds_read_b64_tr_b16 a[68:69], v7 offset:16384
 buffer_store_dwordx4 v[208:211], v1, s[12:15], s59 offen offset:2048 sc1
 v_mfma_f32_16x16x32_bf16 v[108:111], a[88:91], a[116:119], v[108:111]
 ds_read_b64_tr_b16 a[70:71], v7 offset:20480
 v_xor_b32 v8, 131296, v6
 v_mfma_f32_16x16x32_bf16 v[108:111], a[92:95], a[124:127], v[108:111]
 s_waitcnt lgkmcnt(6)
 ds_read_b64_tr_b16 a[72:73], v8 offset:0
 v_cvt_pk_bf16_f32 v46, v60, v61
 v_mfma_f32_16x16x32_bf16 v[116:119], a[96:99], a[192:195], v[116:119]
 ds_read_b64_tr_b16 a[74:75], v8 offset:4096
 v_cvt_pk_bf16_f32 v47, v62, v63
 v_mfma_f32_16x16x32_bf16 v[116:119], a[100:103], a[200:203], v[116:119]
 ds_read_b64_tr_b16 a[76:77], v8 offset:16384
 v_accvgpr_write_b32 a32, v44
 v_mfma_f32_16x16x32_bf16 v[116:119], a[104:107], a[208:211], v[116:119]
 s_waitcnt lgkmcnt(3)
 ds_read_b64_tr_b16 a[78:79], v8 offset:20480
 v_xor_b32 v9, 224, v6
 v_mfma_f32_16x16x32_bf16 v[116:119], a[108:111], a[216:219], v[116:119]
 ds_read_b64_tr_b16 a[80:81], v9 offset:0
 v_accvgpr_write_b32 a33, v45
 v_mfma_f32_16x16x32_bf16 v[116:119], a[64:67], a[112:115], v[116:119]
 ds_read_b64_tr_b16 a[82:83], v9 offset:4096
 v_accvgpr_write_b32 a34, v46
 v_mfma_f32_16x16x32_bf16 v[116:119], a[68:71], a[120:123], v[116:119]
 ds_read_b64_tr_b16 a[84:85], v9 offset:16384
 v_accvgpr_write_b32 a35, v47
 v_mfma_f32_16x16x32_bf16 v[124:127], a[96:99], a[196:199], v[124:127]
 s_add_u32 s59, s56, 32768
 ds_read_b64_tr_b16 a[86:87], v9 offset:20480
 v_xor_b32 v10, 65760, v6
 v_mfma_f32_16x16x32_bf16 v[124:127], a[100:103], a[204:207], v[124:127]
 ds_read_b64_tr_b16 a[88:89], v10 offset:0
 buffer_store_dwordx4 v[216:219], v1, s[12:15], s59 offen offset:2048 sc1
 v_mfma_f32_16x16x32_bf16 v[124:127], a[104:107], a[212:215], v[124:127]
 ds_read_b64_tr_b16 a[90:91], v10 offset:4096
 v_mul_f32 v20, s34, v20
 v_mfma_f32_16x16x32_bf16 v[124:127], a[108:111], a[220:223], v[124:127]
 ds_read_b64_tr_b16 a[92:93], v10 offset:16384
 v_mul_f32 v21, s34, v21
 v_mfma_f32_16x16x32_bf16 v[124:127], a[64:67], a[116:119], v[124:127]
 ds_read_b64_tr_b16 a[94:95], v10 offset:20480
 v_xor_b32 v7, 131328, v6
 v_mfma_f32_16x16x32_bf16 v[124:127], a[68:71], a[124:127], v[124:127]
 s_waitcnt lgkmcnt(6)
 ds_read_b64_tr_b16 a[96:97], v7 offset:0
 v_mul_f32 v22, s34, v22
 v_mfma_f32_16x16x32_bf16 v[132:135], a[72:75], a[192:195], v[132:135]
 ds_read_b64_tr_b16 a[98:99], v7 offset:4096
 v_mul_f32 v23, s34, v23
 v_mfma_f32_16x16x32_bf16 v[132:135], a[76:79], a[200:203], v[132:135]
 ds_read_b64_tr_b16 a[100:101], v7 offset:16384
 v_mul_f32 v68, s34, v68
 v_mfma_f32_16x16x32_bf16 v[132:135], a[80:83], a[208:211], v[132:135]
 s_waitcnt lgkmcnt(3)
 ds_read_b64_tr_b16 a[102:103], v7 offset:20480
 v_xor_b32 v8, 256, v6
 v_mfma_f32_16x16x32_bf16 v[132:135], a[84:87], a[216:219], v[132:135]
 ds_read_b64_tr_b16 a[104:105], v8 offset:0
 v_mul_f32 v69, s34, v69
 v_mfma_f32_16x16x32_bf16 v[132:135], a[88:91], a[112:115], v[132:135]
 s_add_u32 s59, s56, 57344
 ds_read_b64_tr_b16 a[106:107], v8 offset:4096
 v_mul_f32 v70, s34, v70
 v_mfma_f32_16x16x32_bf16 v[132:135], a[92:95], a[120:123], v[132:135]
 ds_read_b64_tr_b16 a[108:109], v8 offset:16384
 buffer_store_dwordx4 v[224:227], v1, s[12:15], s59 offen offset:3072 sc1
 v_mfma_f32_16x16x32_bf16 v[140:143], a[72:75], a[196:199], v[140:143]
 ds_read_b64_tr_b16 a[110:111], v8 offset:20480
 v_xor_b32 v9, 65792, v6
 v_mfma_f32_16x16x32_bf16 v[140:143], a[76:79], a[204:207], v[140:143]
 ds_read_b64_tr_b16 a[64:65], v9 offset:0
 v_mul_f32 v71, s34, v71
 v_mfma_f32_16x16x32_bf16 v[140:143], a[80:83], a[212:215], v[140:143]
 ds_read_b64_tr_b16 a[66:67], v9 offset:4096
 v_cvt_pk_bf16_f32 v20, v20, v21
 v_mfma_f32_16x16x32_bf16 v[140:143], a[84:87], a[220:223], v[140:143]
 ds_read_b64_tr_b16 a[68:69], v9 offset:16384
 v_cvt_pk_bf16_f32 v21, v22, v23
 v_mfma_f32_16x16x32_bf16 v[140:143], a[88:91], a[116:119], v[140:143]
 ds_read_b64_tr_b16 a[70:71], v9 offset:20480
 v_xor_b32 v10, 131360, v6
 v_mfma_f32_16x16x32_bf16 v[140:143], a[92:95], a[124:127], v[140:143]
 s_waitcnt lgkmcnt(6)
 ds_read_b64_tr_b16 a[72:73], v10 offset:0
 v_cvt_pk_bf16_f32 v22, v68, v69
 v_mfma_f32_16x16x32_bf16 v[148:151], a[96:99], a[192:195], v[148:151]
 ds_read_b64_tr_b16 a[74:75], v10 offset:4096
 v_cvt_pk_bf16_f32 v23, v70, v71
 v_mfma_f32_16x16x32_bf16 v[148:151], a[100:103], a[200:203], v[148:151]
 s_add_u32 s59, s56, 49152
 ds_read_b64_tr_b16 a[76:77], v10 offset:16384
 v_accvgpr_write_b32 a4, v20
 v_mfma_f32_16x16x32_bf16 v[148:151], a[104:107], a[208:211], v[148:151]
 s_waitcnt lgkmcnt(3)
 ds_read_b64_tr_b16 a[78:79], v10 offset:20480
 v_xor_b32 v7, 288, v6
 v_mfma_f32_16x16x32_bf16 v[148:151], a[108:111], a[216:219], v[148:151]
 ds_read_b64_tr_b16 a[80:81], v7 offset:0
 buffer_store_dwordx4 v[232:235], v1, s[12:15], s59 offen offset:3072 sc1
 v_mfma_f32_16x16x32_bf16 v[148:151], a[64:67], a[112:115], v[148:151]
 ds_read_b64_tr_b16 a[82:83], v7 offset:4096
 v_accvgpr_write_b32 a5, v21
 v_mfma_f32_16x16x32_bf16 v[148:151], a[68:71], a[120:123], v[148:151]
 ds_read_b64_tr_b16 a[84:85], v7 offset:16384
 v_accvgpr_write_b32 a6, v22
 v_mfma_f32_16x16x32_bf16 v[156:159], a[96:99], a[196:199], v[156:159]
 ds_read_b64_tr_b16 a[86:87], v7 offset:20480
 v_xor_b32 v8, 65824, v6
 v_mfma_f32_16x16x32_bf16 v[156:159], a[100:103], a[204:207], v[156:159]
 ds_read_b64_tr_b16 a[88:89], v8 offset:0
 v_accvgpr_write_b32 a7, v23
 v_mfma_f32_16x16x32_bf16 v[156:159], a[104:107], a[212:215], v[156:159]
 ds_read_b64_tr_b16 a[90:91], v8 offset:4096
 v_mul_f32 v36, s34, v36
 v_mfma_f32_16x16x32_bf16 v[156:159], a[108:111], a[220:223], v[156:159]
 ds_read_b64_tr_b16 a[92:93], v8 offset:16384
 v_mul_f32 v37, s34, v37
 v_mfma_f32_16x16x32_bf16 v[156:159], a[64:67], a[116:119], v[156:159]
 ds_read_b64_tr_b16 a[94:95], v8 offset:20480
 v_xor_b32 v9, 131392, v6
 v_mfma_f32_16x16x32_bf16 v[156:159], a[68:71], a[124:127], v[156:159]
 s_waitcnt lgkmcnt(6)
 ds_read_b64_tr_b16 a[96:97], v9 offset:0
 v_mul_f32 v38, s34, v38
 v_mfma_f32_16x16x32_bf16 v[164:167], a[72:75], a[192:195], v[164:167]
 s_add_u32 s59, s56, 40960
 ds_read_b64_tr_b16 a[98:99], v9 offset:4096
 v_mul_f32 v39, s34, v39
 v_mfma_f32_16x16x32_bf16 v[164:167], a[76:79], a[200:203], v[164:167]
 ds_read_b64_tr_b16 a[100:101], v9 offset:16384
 buffer_store_dwordx4 v[240:243], v1, s[12:15], s59 offen offset:3072 sc1
 v_mfma_f32_16x16x32_bf16 v[164:167], a[80:83], a[208:211], v[164:167]
 s_waitcnt lgkmcnt(3)
 ds_read_b64_tr_b16 a[102:103], v9 offset:20480
 v_xor_b32 v10, 320, v6
 v_mfma_f32_16x16x32_bf16 v[164:167], a[84:87], a[216:219], v[164:167]
 ds_read_b64_tr_b16 a[104:105], v10 offset:0
 v_mul_f32 v76, s34, v76
 v_mfma_f32_16x16x32_bf16 v[164:167], a[88:91], a[112:115], v[164:167]
 ds_read_b64_tr_b16 a[106:107], v10 offset:4096
 v_mul_f32 v77, s34, v77
 v_mfma_f32_16x16x32_bf16 v[164:167], a[92:95], a[120:123], v[164:167]
 ds_read_b64_tr_b16 a[108:109], v10 offset:16384
 v_mul_f32 v78, s34, v78
 v_mfma_f32_16x16x32_bf16 v[172:175], a[72:75], a[196:199], v[172:175]
 ds_read_b64_tr_b16 a[110:111], v10 offset:20480
 v_xor_b32 v7, 65856, v6
 v_mfma_f32_16x16x32_bf16 v[172:175], a[76:79], a[204:207], v[172:175]
 ds_read_b64_tr_b16 a[64:65], v7 offset:0
 v_mul_f32 v79, s34, v79
 v_mfma_f32_16x16x32_bf16 v[172:175], a[80:83], a[212:215], v[172:175]
 ds_read_b64_tr_b16 a[66:67], v7 offset:4096
 v_cvt_pk_bf16_f32 v36, v36, v37
 v_mfma_f32_16x16x32_bf16 v[172:175], a[84:87], a[220:223], v[172:175]
 ds_read_b64_tr_b16 a[68:69], v7 offset:16384
 v_cvt_pk_bf16_f32 v37, v38, v39
 v_mfma_f32_16x16x32_bf16 v[172:175], a[88:91], a[116:119], v[172:175]
 s_add_u32 s59, s56, 32768
 ds_read_b64_tr_b16 a[70:71], v7 offset:20480
 v_xor_b32 v8, 131424, v6
 v_mfma_f32_16x16x32_bf16 v[172:175], a[92:95], a[124:127], v[172:175]
 s_waitcnt lgkmcnt(6)
 ds_read_b64_tr_b16 a[72:73], v8 offset:0
 buffer_store_dwordx4 v[248:251], v1, s[12:15], s59 offen offset:3072 sc1
 v_mfma_f32_16x16x32_bf16 v[180:183], a[96:99], a[192:195], v[180:183]
 ds_read_b64_tr_b16 a[74:75], v8 offset:4096
 v_cvt_pk_bf16_f32 v38, v76, v77
 v_mfma_f32_16x16x32_bf16 v[180:183], a[100:103], a[200:203], v[180:183]
 ds_read_b64_tr_b16 a[76:77], v8 offset:16384
 v_cvt_pk_bf16_f32 v39, v78, v79
 v_mfma_f32_16x16x32_bf16 v[180:183], a[104:107], a[208:211], v[180:183]
 s_waitcnt lgkmcnt(3)
 ds_read_b64_tr_b16 a[78:79], v8 offset:20480
 v_xor_b32 v9, 352, v6
 v_mfma_f32_16x16x32_bf16 v[180:183], a[108:111], a[216:219], v[180:183]
 ds_read_b64_tr_b16 a[80:81], v9 offset:0
 v_accvgpr_write_b32 a36, v36
 v_mfma_f32_16x16x32_bf16 v[180:183], a[64:67], a[112:115], v[180:183]
 ds_read_b64_tr_b16 a[82:83], v9 offset:4096
 v_accvgpr_write_b32 a37, v37
 v_mfma_f32_16x16x32_bf16 v[180:183], a[68:71], a[120:123], v[180:183]
 ds_read_b64_tr_b16 a[84:85], v9 offset:16384
 v_accvgpr_write_b32 a38, v38
 v_mfma_f32_16x16x32_bf16 v[188:191], a[96:99], a[196:199], v[188:191]
 ds_read_b64_tr_b16 a[86:87], v9 offset:20480
 v_xor_b32 v10, 65888, v6
 v_mfma_f32_16x16x32_bf16 v[188:191], a[100:103], a[204:207], v[188:191]
 ds_read_b64_tr_b16 a[88:89], v10 offset:0
 v_accvgpr_write_b32 a39, v39
 v_mfma_f32_16x16x32_bf16 v[188:191], a[104:107], a[212:215], v[188:191]
 ds_read_b64_tr_b16 a[90:91], v10 offset:4096
 v_mul_f32 v84, s34, v84
 v_mfma_f32_16x16x32_bf16 v[188:191], a[108:111], a[220:223], v[188:191]
 ds_read_b64_tr_b16 a[92:93], v10 offset:16384
 v_mul_f32 v85, s34, v85
 v_mfma_f32_16x16x32_bf16 v[188:191], a[64:67], a[116:119], v[188:191]
 ds_read_b64_tr_b16 a[94:95], v10 offset:20480
 v_xor_b32 v7, 131456, v6
 v_mfma_f32_16x16x32_bf16 v[188:191], a[68:71], a[124:127], v[188:191]
 s_waitcnt lgkmcnt(6)
 ds_read_b64_tr_b16 a[96:97], v7 offset:0
 v_mul_f32 v86, s34, v86
 v_mfma_f32_16x16x32_bf16 v[196:199], a[72:75], a[192:195], v[196:199]
 ds_read_b64_tr_b16 a[98:99], v7 offset:4096
 v_mul_f32 v87, s34, v87
 v_mfma_f32_16x16x32_bf16 v[196:199], a[76:79], a[200:203], v[196:199]
 ds_read_b64_tr_b16 a[100:101], v7 offset:16384
 v_mul_f32 v100, s34, v100
 v_mfma_f32_16x16x32_bf16 v[196:199], a[80:83], a[208:211], v[196:199]
 s_waitcnt lgkmcnt(3)
 ds_read_b64_tr_b16 a[102:103], v7 offset:20480
 v_xor_b32 v8, 384, v6
 v_mfma_f32_16x16x32_bf16 v[196:199], a[84:87], a[216:219], v[196:199]
 ds_read_b64_tr_b16 a[104:105], v8 offset:0
 v_mul_f32 v101, s34, v101
 v_mfma_f32_16x16x32_bf16 v[196:199], a[88:91], a[112:115], v[196:199]
 ds_read_b64_tr_b16 a[106:107], v8 offset:4096
 v_mul_f32 v102, s34, v102
 v_mfma_f32_16x16x32_bf16 v[196:199], a[92:95], a[120:123], v[196:199]
 ds_read_b64_tr_b16 a[108:109], v8 offset:16384
 v_mul_f32 v103, s34, v103
 v_mfma_f32_16x16x32_bf16 v[204:207], a[72:75], a[196:199], v[204:207]
 ds_read_b64_tr_b16 a[110:111], v8 offset:20480
 v_xor_b32 v9, 65920, v6
 v_mfma_f32_16x16x32_bf16 v[204:207], a[76:79], a[204:207], v[204:207]
 ds_read_b64_tr_b16 a[64:65], v9 offset:0
 v_cvt_pk_bf16_f32 v84, v84, v85
 v_mfma_f32_16x16x32_bf16 v[204:207], a[80:83], a[212:215], v[204:207]
 ds_read_b64_tr_b16 a[66:67], v9 offset:4096
 v_cvt_pk_bf16_f32 v85, v86, v87
 v_mfma_f32_16x16x32_bf16 v[204:207], a[84:87], a[220:223], v[204:207]
 ds_read_b64_tr_b16 a[68:69], v9 offset:16384
 v_cvt_pk_bf16_f32 v86, v100, v101
 v_mfma_f32_16x16x32_bf16 v[204:207], a[88:91], a[116:119], v[204:207]
 ds_read_b64_tr_b16 a[70:71], v9 offset:20480
 v_xor_b32 v10, 131488, v6
 v_mfma_f32_16x16x32_bf16 v[204:207], a[92:95], a[124:127], v[204:207]
 s_waitcnt lgkmcnt(6)
 ds_read_b64_tr_b16 a[72:73], v10 offset:0
 v_cvt_pk_bf16_f32 v87, v102, v103
 v_mfma_f32_16x16x32_bf16 v[212:215], a[96:99], a[192:195], v[212:215]
 ds_read_b64_tr_b16 a[74:75], v10 offset:4096
 v_accvgpr_write_b32 a8, v84
 v_mfma_f32_16x16x32_bf16 v[212:215], a[100:103], a[200:203], v[212:215]
 ds_read_b64_tr_b16 a[76:77], v10 offset:16384
 v_accvgpr_write_b32 a9, v85
 v_mfma_f32_16x16x32_bf16 v[212:215], a[104:107], a[208:211], v[212:215]
 s_waitcnt lgkmcnt(3)
 ds_read_b64_tr_b16 a[78:79], v10 offset:20480
 v_xor_b32 v7, 416, v6
 v_mfma_f32_16x16x32_bf16 v[212:215], a[108:111], a[216:219], v[212:215]
 ds_read_b64_tr_b16 a[80:81], v7 offset:0
 v_accvgpr_write_b32 a10, v86
 v_mfma_f32_16x16x32_bf16 v[212:215], a[64:67], a[112:115], v[212:215]
 ds_read_b64_tr_b16 a[82:83], v7 offset:4096
 v_accvgpr_write_b32 a11, v87
 v_mfma_f32_16x16x32_bf16 v[212:215], a[68:71], a[120:123], v[212:215]
 ds_read_b64_tr_b16 a[84:85], v7 offset:16384
 v_mul_f32 v92, s34, v92
 v_mfma_f32_16x16x32_bf16 v[220:223], a[96:99], a[196:199], v[220:223]
 ds_read_b64_tr_b16 a[86:87], v7 offset:20480
 v_xor_b32 v8, 65952, v6
 v_mfma_f32_16x16x32_bf16 v[220:223], a[100:103], a[204:207], v[220:223]
 ds_read_b64_tr_b16 a[88:89], v8 offset:0
 v_mul_f32 v93, s34, v93
 v_mfma_f32_16x16x32_bf16 v[220:223], a[104:107], a[212:215], v[220:223]
 ds_read_b64_tr_b16 a[90:91], v8 offset:4096
 v_mul_f32 v94, s34, v94
 v_mfma_f32_16x16x32_bf16 v[220:223], a[108:111], a[220:223], v[220:223]
 ds_read_b64_tr_b16 a[92:93], v8 offset:16384
 v_mul_f32 v95, s34, v95
 v_mfma_f32_16x16x32_bf16 v[220:223], a[64:67], a[116:119], v[220:223]
 ds_read_b64_tr_b16 a[94:95], v8 offset:20480
 v_xor_b32 v9, 131520, v6
 v_mfma_f32_16x16x32_bf16 v[220:223], a[68:71], a[124:127], v[220:223]
 s_waitcnt lgkmcnt(6)
 ds_read_b64_tr_b16 a[96:97], v9 offset:0
 v_mul_f32 v108, s34, v108
 v_mfma_f32_16x16x32_bf16 v[228:231], a[72:75], a[192:195], v[228:231]
 ds_read_b64_tr_b16 a[98:99], v9 offset:4096
 v_mul_f32 v109, s34, v109
 v_mfma_f32_16x16x32_bf16 v[228:231], a[76:79], a[200:203], v[228:231]
 ds_read_b64_tr_b16 a[100:101], v9 offset:16384
 v_mul_f32 v110, s34, v110
 v_mfma_f32_16x16x32_bf16 v[228:231], a[80:83], a[208:211], v[228:231]
 s_waitcnt lgkmcnt(3)
 ds_read_b64_tr_b16 a[102:103], v9 offset:20480
 v_xor_b32 v10, 448, v6
 v_mfma_f32_16x16x32_bf16 v[228:231], a[84:87], a[216:219], v[228:231]
 ds_read_b64_tr_b16 a[104:105], v10 offset:0
 v_mul_f32 v111, s34, v111
 v_mfma_f32_16x16x32_bf16 v[228:231], a[88:91], a[112:115], v[228:231]
 ds_read_b64_tr_b16 a[106:107], v10 offset:4096
 v_cvt_pk_bf16_f32 v92, v92, v93
 v_mfma_f32_16x16x32_bf16 v[228:231], a[92:95], a[120:123], v[228:231]
 ds_read_b64_tr_b16 a[108:109], v10 offset:16384
 v_cvt_pk_bf16_f32 v93, v94, v95
 v_mfma_f32_16x16x32_bf16 v[236:239], a[72:75], a[196:199], v[236:239]
 ds_read_b64_tr_b16 a[110:111], v10 offset:20480
 v_xor_b32 v7, 65984, v6
 v_mfma_f32_16x16x32_bf16 v[236:239], a[76:79], a[204:207], v[236:239]
 ds_read_b64_tr_b16 a[64:65], v7 offset:0
 buffer_load_dword v13, v12, s[12:15], s58 offen sc1
 v_mfma_f32_16x16x32_bf16 v[236:239], a[80:83], a[212:215], v[236:239]
 ds_read_b64_tr_b16 a[66:67], v7 offset:4096
 v_cvt_pk_bf16_f32 v94, v108, v109
 v_mfma_f32_16x16x32_bf16 v[236:239], a[84:87], a[220:223], v[236:239]
 ds_read_b64_tr_b16 a[68:69], v7 offset:16384
 v_cvt_pk_bf16_f32 v95, v110, v111
 v_mfma_f32_16x16x32_bf16 v[236:239], a[88:91], a[116:119], v[236:239]
 ds_read_b64_tr_b16 a[70:71], v7 offset:20480
 v_xor_b32 v8, 131552, v6
 v_mfma_f32_16x16x32_bf16 v[236:239], a[92:95], a[124:127], v[236:239]
 s_waitcnt lgkmcnt(6)
 ds_read_b64_tr_b16 a[72:73], v8 offset:0
 v_accvgpr_write_b32 a40, v92
 v_mfma_f32_16x16x32_bf16 v[244:247], a[96:99], a[192:195], v[244:247]
 ds_read_b64_tr_b16 a[74:75], v8 offset:4096
 v_accvgpr_write_b32 a41, v93
 v_mfma_f32_16x16x32_bf16 v[244:247], a[100:103], a[200:203], v[244:247]
 ds_read_b64_tr_b16 a[76:77], v8 offset:16384
 v_accvgpr_write_b32 a42, v94
 v_mfma_f32_16x16x32_bf16 v[244:247], a[104:107], a[208:211], v[244:247]
 s_waitcnt lgkmcnt(3)
 ds_read_b64_tr_b16 a[78:79], v8 offset:20480
 v_xor_b32 v9, 480, v6
 v_mfma_f32_16x16x32_bf16 v[244:247], a[108:111], a[216:219], v[244:247]
 ds_read_b64_tr_b16 a[80:81], v9 offset:0
 v_accvgpr_write_b32 a43, v95
 v_mfma_f32_16x16x32_bf16 v[244:247], a[64:67], a[112:115], v[244:247]
 ds_read_b64_tr_b16 a[82:83], v9 offset:4096
 v_mfma_f32_16x16x32_bf16 v[244:247], a[68:71], a[120:123], v[244:247]
 ds_read_b64_tr_b16 a[84:85], v9 offset:16384
 v_mfma_f32_16x16x32_bf16 v[252:255], a[96:99], a[196:199], v[252:255]
 ds_read_b64_tr_b16 a[86:87], v9 offset:20480
 v_xor_b32 v10, 66016, v6
 v_mfma_f32_16x16x32_bf16 v[252:255], a[100:103], a[204:207], v[252:255]
 ds_read_b64_tr_b16 a[88:89], v10 offset:0
 v_mfma_f32_16x16x32_bf16 v[252:255], a[104:107], a[212:215], v[252:255]
 ds_read_b64_tr_b16 a[90:91], v10 offset:4096
 v_mfma_f32_16x16x32_bf16 v[252:255], a[108:111], a[220:223], v[252:255]
 ds_read_b64_tr_b16 a[92:93], v10 offset:16384
 v_mfma_f32_16x16x32_bf16 v[252:255], a[64:67], a[116:119], v[252:255]
 ds_read_b64_tr_b16 a[94:95], v10 offset:20480
 v_mfma_f32_16x16x32_bf16 v[252:255], a[68:71], a[124:127], v[252:255]
 s_waitcnt lgkmcnt(6)
 v_mfma_f32_16x16x32_bf16 v[16:19], a[72:75], a[192:195], v[16:19]
 v_mfma_f32_16x16x32_bf16 v[16:19], a[76:79], a[200:203], v[16:19]
 v_mfma_f32_16x16x32_bf16 v[16:19], a[80:83], a[208:211], v[16:19]
 s_waitcnt lgkmcnt(0)
 v_mfma_f32_16x16x32_bf16 v[16:19], a[84:87], a[216:219], v[16:19]
 v_mfma_f32_16x16x32_bf16 v[16:19], a[88:91], a[112:115], v[16:19]
 v_mfma_f32_16x16x32_bf16 v[16:19], a[92:95], a[120:123], v[16:19]
 v_mfma_f32_16x16x32_bf16 v[24:27], a[72:75], a[196:199], v[24:27]
 v_mfma_f32_16x16x32_bf16 v[24:27], a[76:79], a[204:207], v[24:27]
 v_mfma_f32_16x16x32_bf16 v[24:27], a[80:83], a[212:215], v[24:27]
 v_mfma_f32_16x16x32_bf16 v[24:27], a[84:87], a[220:223], v[24:27]
 s_waitcnt lgkmcnt(0)
 v_mfma_f32_16x16x32_bf16 v[24:27], a[88:91], a[116:119], v[24:27]
 s_barrier
 v_mfma_f32_16x16x32_bf16 v[24:27], a[92:95], a[124:127], v[24:27]
 s_waitcnt vmcnt(0)
 v_cmp_ne_u32 s[16:17], 0, v13
 v_cmp_gt_u32 vcc, 256, v5
 s_or_b64 vcc, vcc, s[16:17]
 s_mov_b32 m0, s40
 s_cselect_b32 s48, 0, 1
 s_cselect_b32 s52, 2.0, s42
 buffer_load_dwordx4 v1, s[12:15], s52 offen offset:0 sc1 lds
 v_pk_mul_f32 v[116:117], v[116:117], s[34:35]
 v_pk_mul_f32 v[118:119], v[118:119], s[34:35]
 v_pk_mul_f32 v[132:133], v[132:133], s[34:35]
 v_pk_mul_f32 v[134:135], v[134:135], s[34:35]
 v_cvt_pk_bf16_f32 v116, v116, v117
 v_cvt_pk_bf16_f32 v117, v118, v119
 v_cvt_pk_bf16_f32 v118, v132, v133
 v_cvt_pk_bf16_f32 v119, v134, v135
 v_accvgpr_write_b32 a12, v116
 v_accvgpr_write_b32 a13, v117
 v_accvgpr_write_b32 a14, v118
 v_accvgpr_write_b32 a15, v119
 v_pk_mul_f32 v[124:125], v[124:125], s[34:35]
 v_pk_mul_f32 v[126:127], v[126:127], s[34:35]
 v_pk_mul_f32 v[140:141], v[140:141], s[34:35]
 buffer_load_dwordx4 v1, s[12:15], s52 offen offset:1024 sc1 lds
 v_pk_mul_f32 v[142:143], v[142:143], s[34:35]
 v_cvt_pk_bf16_f32 v124, v124, v125
 v_cvt_pk_bf16_f32 v125, v126, v127
 v_cvt_pk_bf16_f32 v126, v140, v141
 v_cvt_pk_bf16_f32 v127, v142, v143
 v_accvgpr_write_b32 a44, v124
 v_accvgpr_write_b32 a45, v125
 v_accvgpr_write_b32 a46, v126
 v_accvgpr_write_b32 a47, v127
 v_pk_mul_f32 v[148:149], v[148:149], s[34:35]
 v_pk_mul_f32 v[150:151], v[150:151], s[34:35]
 v_pk_mul_f32 v[164:165], v[164:165], s[34:35]
 v_pk_mul_f32 v[166:167], v[166:167], s[34:35]
 v_cvt_pk_bf16_f32 v148, v148, v149
 v_cvt_pk_bf16_f32 v149, v150, v151
 buffer_load_dwordx4 v1, s[12:15], s52 offen offset:2048 sc1 lds
 v_cvt_pk_bf16_f32 v150, v164, v165
 v_cvt_pk_bf16_f32 v151, v166, v167
 v_accvgpr_write_b32 a16, v148
 v_accvgpr_write_b32 a17, v149
 v_accvgpr_write_b32 a18, v150
 v_accvgpr_write_b32 a19, v151
 v_pk_mul_f32 v[156:157], v[156:157], s[34:35]
 v_pk_mul_f32 v[158:159], v[158:159], s[34:35]
 v_pk_mul_f32 v[172:173], v[172:173], s[34:35]
 v_pk_mul_f32 v[174:175], v[174:175], s[34:35]
 v_cvt_pk_bf16_f32 v156, v156, v157
 v_cvt_pk_bf16_f32 v157, v158, v159
 v_cvt_pk_bf16_f32 v158, v172, v173
 v_cvt_pk_bf16_f32 v159, v174, v175
 v_accvgpr_write_b32 a48, v156
 buffer_load_dwordx4 v1, s[12:15], s52 offen offset:3072 sc1 lds
 v_accvgpr_write_b32 a49, v157
 v_accvgpr_write_b32 a50, v158
 v_accvgpr_write_b32 a51, v159
 v_pk_mul_f32 v[180:181], v[180:181], s[34:35]
 v_pk_mul_f32 v[182:183], v[182:183], s[34:35]
 v_pk_mul_f32 v[196:197], v[196:197], s[34:35]
 v_pk_mul_f32 v[198:199], v[198:199], s[34:35]
 v_cvt_pk_bf16_f32 v180, v180, v181
 v_cvt_pk_bf16_f32 v181, v182, v183
 v_cvt_pk_bf16_f32 v182, v196, v197
 v_cvt_pk_bf16_f32 v183, v198, v199
 v_accvgpr_write_b32 a20, v180
 v_accvgpr_write_b32 a21, v181
 v_accvgpr_write_b32 a22, v182
 v_accvgpr_write_b32 a23, v183
 s_bitset1_b32 m0, 12
 s_nop 0
 buffer_load_dwordx4 v4, s[12:15], s52 offen offset:0 sc1 lds
 v_pk_mul_f32 v[188:189], v[188:189], s[34:35]
 v_pk_mul_f32 v[190:191], v[190:191], s[34:35]
 v_pk_mul_f32 v[204:205], v[204:205], s[34:35]
 v_pk_mul_f32 v[206:207], v[206:207], s[34:35]
 v_cvt_pk_bf16_f32 v188, v188, v189
 v_cvt_pk_bf16_f32 v189, v190, v191
 v_cvt_pk_bf16_f32 v190, v204, v205
 v_cvt_pk_bf16_f32 v191, v206, v207
 v_accvgpr_write_b32 a52, v188
 v_accvgpr_write_b32 a53, v189
 v_accvgpr_write_b32 a54, v190
 v_accvgpr_write_b32 a55, v191
 v_pk_mul_f32 v[212:213], v[212:213], s[34:35]
 v_pk_mul_f32 v[214:215], v[214:215], s[34:35]
 v_pk_mul_f32 v[228:229], v[228:229], s[34:35]
 buffer_load_dwordx4 v4, s[12:15], s52 offen offset:1024 sc1 lds
 v_pk_mul_f32 v[230:231], v[230:231], s[34:35]
 v_cvt_pk_bf16_f32 v212, v212, v213
 v_cvt_pk_bf16_f32 v213, v214, v215
 v_cvt_pk_bf16_f32 v214, v228, v229
 v_cvt_pk_bf16_f32 v215, v230, v231
 v_accvgpr_write_b32 a24, v212
 v_accvgpr_write_b32 a25, v213
 v_accvgpr_write_b32 a26, v214
 v_accvgpr_write_b32 a27, v215
 v_pk_mul_f32 v[220:221], v[220:221], s[34:35]
 v_pk_mul_f32 v[222:223], v[222:223], s[34:35]
 v_pk_mul_f32 v[236:237], v[236:237], s[34:35]
 v_pk_mul_f32 v[238:239], v[238:239], s[34:35]
 v_cvt_pk_bf16_f32 v220, v220, v221
 v_cvt_pk_bf16_f32 v221, v222, v223
 buffer_load_dwordx4 v4, s[12:15], s52 offen offset:2048 sc1 lds
 v_cvt_pk_bf16_f32 v222, v236, v237
 v_cvt_pk_bf16_f32 v223, v238, v239
 v_accvgpr_write_b32 a56, v220
 v_accvgpr_write_b32 a57, v221
 v_accvgpr_write_b32 a58, v222
 v_accvgpr_write_b32 a59, v223
 v_pk_mul_f32 v[244:245], v[244:245], s[34:35]
 v_pk_mul_f32 v[246:247], v[246:247], s[34:35]
 v_pk_mul_f32 v[16:17], v[16:17], s[34:35]
 v_pk_mul_f32 v[18:19], v[18:19], s[34:35]
 v_cvt_pk_bf16_f32 v244, v244, v245
 v_cvt_pk_bf16_f32 v245, v246, v247
 v_cvt_pk_bf16_f32 v246, v16, v17
 v_cvt_pk_bf16_f32 v247, v18, v19
 v_accvgpr_write_b32 a28, v244
 buffer_load_dwordx4 v4, s[12:15], s52 offen offset:3072 sc1 lds
 v_accvgpr_write_b32 a29, v245
 v_accvgpr_write_b32 a30, v246
 v_accvgpr_write_b32 a31, v247
 v_pk_mul_f32 v[252:253], v[252:253], s[34:35]
 v_pk_mul_f32 v[254:255], v[254:255], s[34:35]
 v_pk_mul_f32 v[24:25], v[24:25], s[34:35]
 v_pk_mul_f32 v[26:27], v[26:27], s[34:35]
 v_cvt_pk_bf16_f32 v252, v252, v253
 v_cvt_pk_bf16_f32 v253, v254, v255
 v_cvt_pk_bf16_f32 v254, v24, v25
 v_cvt_pk_bf16_f32 v255, v26, v27
 v_accvgpr_write_b32 a60, v252
 v_accvgpr_write_b32 a61, v253
 v_accvgpr_write_b32 a62, v254
 v_accvgpr_write_b32 a63, v255
 s_branch L_kvdone
L_kloop_side:
 s_mov_b64 exec, 1
 global_atomic_add v3, v15, s[90:91] offset:128 sc1
 s_mov_b64 exec, -1
 s_branch L_kloop_back
L_vloop_side:
 s_mov_b64 exec, 1
 global_atomic_add v3, v15, s[90:91] offset:128 sc1
 s_mov_b64 exec, -1
 s_branch L_vloop_back
L_vloop_head:
 v_mfma_f32_16x16x32_bf16 v[64:67], a[64:67], a[0:3], 0
 s_add_u32 m0, s29, 118784
 ds_read_b64_tr_b16 a[24:25], v9 offset:0
 v_mfma_f32_16x16x32_bf16 v[64:67], a[68:71], a[4:7], v[64:67]
 ds_read_b64_tr_b16 a[26:27], v9 offset:4096
 buffer_load_dwordx4 v2, s[8:11], s52 offen  lds
 v_mfma_f32_16x16x32_bf16 v[68:71], a[76:79], a[4:7], 0
 ds_read_b64_tr_b16 a[28:29], v9 offset:16384
 v_mfma_f32_16x16x32_bf16 v[68:71], a[72:75], a[0:3], v[68:71]
 ds_read_b64_tr_b16 a[30:31], v9 offset:20480
 v_mfma_f32_16x16x32_bf16 v[72:75], a[80:83], a[0:3], 0
 s_add_u32 m0, s29, 53248
 ds_read_b128 a[96:99], v4 offset:8192
 v_mfma_f32_16x16x32_bf16 v[72:75], a[84:87], a[4:7], v[72:75]
 buffer_load_dwordx4 v1, s[4:7], s45 offen  lds
 v_mfma_f32_16x16x32_bf16 v[76:79], a[92:95], a[4:7], 0
 ds_read_b128 a[100:103], v5 offset:8192
 v_mfma_f32_16x16x32_bf16 v[76:79], a[88:91], a[0:3], v[76:79]
 v_mfma_f32_16x16x32_bf16 v[84:87], a[88:91], a[8:11], 0
 s_add_u32 m0, s29, 122880
 ds_read_b128 a[108:111], v5 offset:10240
 v_mfma_f32_16x16x32_bf16 v[84:87], a[92:95], a[12:15], v[84:87]
 buffer_load_dwordx4 v2, s[8:11], s53 offen  lds
 v_mfma_f32_16x16x32_bf16 v[80:83], a[84:87], a[12:15], 0
 ds_read_b128 a[104:107], v4 offset:10240
 v_mfma_f32_16x16x32_bf16 v[80:83], a[80:83], a[8:11], v[80:83]
 v_mfma_f32_16x16x32_bf16 v[92:95], a[72:75], a[8:11], 0
 s_add_u32 m0, s29, 57344
 ds_read_b128 a[112:115], v4 offset:12288
 v_mfma_f32_16x16x32_bf16 v[92:95], a[76:79], a[12:15], v[92:95]
 buffer_load_dwordx4 v1, s[4:7], s46 offen  lds
 v_mfma_f32_16x16x32_bf16 v[88:91], a[68:71], a[12:15], 0
 ds_read_b128 a[116:119], v5 offset:12288
 v_mfma_f32_16x16x32_bf16 v[88:91], a[64:67], a[8:11], v[88:91]
 v_mfma_f32_16x16x32_bf16 v[96:99], a[64:67], a[16:19], 0
 s_add_u32 m0, s29, 126976
 ds_read_b128 a[124:127], v5 offset:14336
 v_mfma_f32_16x16x32_bf16 v[96:99], a[68:71], a[20:23], v[96:99]
 buffer_load_dwordx4 v2, s[8:11], s54 offen  lds
 v_mfma_f32_16x16x32_bf16 v[100:103], a[76:79], a[20:23], 0
 ds_read_b128 a[120:123], v4 offset:14336
 v_mfma_f32_16x16x32_bf16 v[100:103], a[72:75], a[16:19], v[100:103]
 v_mfma_f32_16x16x32_bf16 v[104:107], a[80:83], a[16:19], 0
 s_add_u32 m0, s29, 61440
 ds_read_b64_tr_b16 a[32:33], v10 offset:0
 v_mfma_f32_16x16x32_bf16 v[104:107], a[84:87], a[20:23], v[104:107]
 ds_read_b64_tr_b16 a[34:35], v10 offset:4096
 buffer_load_dwordx4 v1, s[4:7], s47 offen  lds
 v_mfma_f32_16x16x32_bf16 v[108:111], a[92:95], a[20:23], 0
 ds_read_b64_tr_b16 a[36:37], v10 offset:16384
 v_add_u32 v1, 128, v1
 v_mfma_f32_16x16x32_bf16 v[108:111], a[88:91], a[16:19], v[108:111]
 s_waitcnt lgkmcnt(8)
 ds_read_b64_tr_b16 a[38:39], v10 offset:20480
 v_add_u32 v2, 0x80000, v2
 v_mfma_f32_16x16x32_bf16 v[116:119], a[88:91], a[24:27], 0
 ds_read_b64_tr_b16 a[40:41], v11 offset:0
 v_mfma_f32_16x16x32_bf16 v[116:119], a[92:95], a[28:31], v[116:119]
 ds_read_b64_tr_b16 a[42:43], v11 offset:4096
 v_mfma_f32_16x16x32_bf16 v[112:115], a[84:87], a[28:31], 0
 ds_read_b64_tr_b16 a[44:45], v11 offset:16384
 v_mfma_f32_16x16x32_bf16 v[112:115], a[80:83], a[24:27], v[112:115]
 ds_read_b64_tr_b16 a[46:47], v11 offset:20480
 v_mfma_f32_16x16x32_bf16 v[124:127], a[72:75], a[24:27], 0
 ds_read_b64_tr_b16 a[48:49], v12 offset:0
 v_mfma_f32_16x16x32_bf16 v[124:127], a[76:79], a[28:31], v[124:127]
 ds_read_b64_tr_b16 a[50:51], v12 offset:4096
 v_mfma_f32_16x16x32_bf16 v[120:123], a[68:71], a[28:31], 0
 ds_read_b64_tr_b16 a[52:53], v12 offset:16384
 v_mfma_f32_16x16x32_bf16 v[120:123], a[64:67], a[24:27], v[120:123]
 ds_read_b64_tr_b16 a[54:55], v12 offset:20480
 v_mfma_f32_16x16x32_bf16 v[16:19], a[96:99], a[0:3], 0
 ds_read_b64_tr_b16 a[56:57], v13 offset:0
 v_mfma_f32_16x16x32_bf16 v[16:19], a[100:103], a[4:7], v[16:19]
 ds_read_b64_tr_b16 a[58:59], v13 offset:4096
 v_mfma_f32_16x16x32_bf16 v[20:23], a[108:111], a[4:7], 0
 s_waitcnt lgkmcnt(8)
 ds_read_b64_tr_b16 a[60:61], v13 offset:16384
 v_mfma_f32_16x16x32_bf16 v[20:23], a[104:107], a[0:3], v[20:23]
 ds_read_b64_tr_b16 a[62:63], v13 offset:20480
 v_mfma_f32_16x16x32_bf16 v[24:27], a[112:115], a[0:3], 0
 v_mfma_f32_16x16x32_bf16 v[24:27], a[116:119], a[4:7], v[24:27]
 v_mfma_f32_16x16x32_bf16 v[28:31], a[124:127], a[4:7], 0
 v_mfma_f32_16x16x32_bf16 v[28:31], a[120:123], a[0:3], v[28:31]
 s_waitcnt lgkmcnt(0)
 v_mfma_f32_16x16x32_bf16 a[228:231], a[120:123], a[8:11], 0
 s_barrier
 v_mfma_f32_16x16x32_bf16 a[228:231], a[124:127], a[12:15], a[228:231]
 s_add_u32 m0, s29, 65536
 v_mfma_f32_16x16x32_bf16 a[224:227], a[116:119], a[12:15], 0
 buffer_load_dwordx4 v2, s[8:11], 0 offen  lds
 v_mfma_f32_16x16x32_bf16 a[224:227], a[112:115], a[8:11], a[224:227]
 v_mfma_f32_16x16x32_bf16 a[236:239], a[104:107], a[8:11], 0
 v_mfma_f32_16x16x32_bf16 a[236:239], a[108:111], a[12:15], a[236:239]
 v_mfma_f32_16x16x32_bf16 a[232:235], a[100:103], a[12:15], 0
 s_add_u32 m0, s29, 0
 v_mfma_f32_16x16x32_bf16 a[232:235], a[96:99], a[8:11], a[232:235]
 buffer_load_dwordx4 v1, s[4:7], 0 offen  lds
 v_mfma_f32_16x16x32_bf16 v[32:35], a[96:99], a[16:19], 0
 v_mfma_f32_16x16x32_bf16 v[32:35], a[100:103], a[20:23], v[32:35]
 v_mfma_f32_16x16x32_bf16 v[36:39], a[108:111], a[20:23], 0
 v_mfma_f32_16x16x32_bf16 v[36:39], a[104:107], a[16:19], v[36:39]
 s_add_u32 m0, s29, 69632
 v_mfma_f32_16x16x32_bf16 v[40:43], a[112:115], a[16:19], 0
 buffer_load_dwordx4 v2, s[8:11], s48 offen  lds
 v_mfma_f32_16x16x32_bf16 v[40:43], a[116:119], a[20:23], v[40:43]
 v_mfma_f32_16x16x32_bf16 v[44:47], a[124:127], a[20:23], 0
 v_mfma_f32_16x16x32_bf16 v[44:47], a[120:123], a[16:19], v[44:47]
 v_mfma_f32_16x16x32_bf16 v[52:55], a[120:123], a[24:27], 0
 s_add_u32 m0, s29, 4096
 v_mfma_f32_16x16x32_bf16 v[52:55], a[124:127], a[28:31], v[52:55]
 buffer_load_dwordx4 v1, s[4:7], s41 offen  lds
 v_mfma_f32_16x16x32_bf16 v[48:51], a[116:119], a[28:31], 0
 v_mfma_f32_16x16x32_bf16 v[48:51], a[112:115], a[24:27], v[48:51]
 v_mfma_f32_16x16x32_bf16 v[60:63], a[104:107], a[24:27], 0
 v_mfma_f32_16x16x32_bf16 v[60:63], a[108:111], a[28:31], v[60:63]
 s_add_u32 m0, s29, 73728
 v_mfma_f32_16x16x32_bf16 v[56:59], a[100:103], a[28:31], 0
 buffer_load_dwordx4 v2, s[8:11], s49 offen  lds
 v_mfma_f32_16x16x32_bf16 v[56:59], a[96:99], a[24:27], v[56:59]
 v_mfma_f32_16x16x32_bf16 v[192:195], a[96:99], a[32:35], 0
 v_mfma_f32_16x16x32_bf16 v[192:195], a[100:103], a[36:39], v[192:195]
 v_mfma_f32_16x16x32_bf16 v[196:199], a[108:111], a[36:39], 0
 s_add_u32 m0, s29, 8192
 v_mfma_f32_16x16x32_bf16 v[196:199], a[104:107], a[32:35], v[196:199]
 buffer_load_dwordx4 v1, s[4:7], s42 offen  lds
 v_mfma_f32_16x16x32_bf16 v[200:203], a[112:115], a[32:35], 0
 v_mfma_f32_16x16x32_bf16 v[200:203], a[116:119], a[36:39], v[200:203]
 v_mfma_f32_16x16x32_bf16 v[204:207], a[124:127], a[36:39], 0
 v_mfma_f32_16x16x32_bf16 v[204:207], a[120:123], a[32:35], v[204:207]
 s_add_u32 m0, s29, 77824
 v_mfma_f32_16x16x32_bf16 v[212:215], a[120:123], a[40:43], 0
 buffer_load_dwordx4 v2, s[8:11], s50 offen  lds
 v_mfma_f32_16x16x32_bf16 v[212:215], a[124:127], a[44:47], v[212:215]
 v_mfma_f32_16x16x32_bf16 v[208:211], a[116:119], a[44:47], 0
 v_mfma_f32_16x16x32_bf16 v[208:211], a[112:115], a[40:43], v[208:211]
 v_mfma_f32_16x16x32_bf16 v[220:223], a[104:107], a[40:43], 0
 s_add_u32 m0, s29, 12288
 v_mfma_f32_16x16x32_bf16 v[220:223], a[108:111], a[44:47], v[220:223]
 buffer_load_dwordx4 v1, s[4:7], s43 offen  lds
 v_mfma_f32_16x16x32_bf16 v[216:219], a[100:103], a[44:47], 0
 v_mfma_f32_16x16x32_bf16 v[216:219], a[96:99], a[40:43], v[216:219]
 v_mfma_f32_16x16x32_bf16 v[224:227], a[96:99], a[48:51], 0
 v_mfma_f32_16x16x32_bf16 v[224:227], a[100:103], a[52:55], v[224:227]
 s_add_u32 m0, s29, 81920
 v_mfma_f32_16x16x32_bf16 v[228:231], a[108:111], a[52:55], 0
 buffer_load_dwordx4 v2, s[8:11], s51 offen  lds
 v_mfma_f32_16x16x32_bf16 v[228:231], a[104:107], a[48:51], v[228:231]
 v_mfma_f32_16x16x32_bf16 v[232:235], a[112:115], a[48:51], 0
 v_mfma_f32_16x16x32_bf16 v[232:235], a[116:119], a[52:55], v[232:235]
 v_mfma_f32_16x16x32_bf16 v[236:239], a[124:127], a[52:55], 0
 s_add_u32 m0, s29, 16384
 v_mfma_f32_16x16x32_bf16 v[236:239], a[120:123], a[48:51], v[236:239]
 buffer_load_dwordx4 v1, s[4:7], s44 offen  lds
 v_mfma_f32_16x16x32_bf16 v[244:247], a[120:123], a[56:59], 0
 v_mfma_f32_16x16x32_bf16 v[244:247], a[124:127], a[60:63], v[244:247]
 v_mfma_f32_16x16x32_bf16 v[240:243], a[116:119], a[60:63], 0
 v_mfma_f32_16x16x32_bf16 v[240:243], a[112:115], a[56:59], v[240:243]
 s_add_u32 m0, s29, 86016
 v_mfma_f32_16x16x32_bf16 v[252:255], a[104:107], a[56:59], 0
 s_waitcnt vmcnt(10)
 buffer_load_dwordx4 v2, s[8:11], s52 offen  lds
 v_mfma_f32_16x16x32_bf16 v[252:255], a[108:111], a[60:63], v[252:255]
 s_barrier
 ds_read_b64_tr_b16 a[0:1], v6 offset:32768
 v_mfma_f32_16x16x32_bf16 v[248:251], a[100:103], a[60:63], 0
 ds_read_b64_tr_b16 a[2:3], v6 offset:36864
 v_mfma_f32_16x16x32_bf16 v[248:251], a[96:99], a[56:59], v[248:251]
 ds_read_b128 a[96:99], v4 offset:40960
 v_mfma_f32_16x16x32_bf16 v[128:131], a[64:67], a[32:35], 0
 s_add_u32 m0, s29, 20480
 v_mfma_f32_16x16x32_bf16 v[128:131], a[68:71], a[36:39], v[128:131]
 buffer_load_dwordx4 v1, s[4:7], s45 offen  lds
 v_mfma_f32_16x16x32_bf16 v[132:135], a[76:79], a[36:39], 0
 ds_read_b64_tr_b16 a[4:5], v6 offset:49152
 v_mfma_f32_16x16x32_bf16 v[132:135], a[72:75], a[32:35], v[132:135]
 ds_read_b64_tr_b16 a[6:7], v6 offset:53248
 v_mfma_f32_16x16x32_bf16 v[136:139], a[80:83], a[32:35], 0
 ds_read_b128 a[100:103], v5 offset:40960
 v_mfma_f32_16x16x32_bf16 v[136:139], a[84:87], a[36:39], v[136:139]
 s_add_u32 m0, s29, 90112
 v_mfma_f32_16x16x32_bf16 v[140:143], a[92:95], a[36:39], 0
 buffer_load_dwordx4 v2, s[8:11], s53 offen  lds
 v_mfma_f32_16x16x32_bf16 v[140:143], a[88:91], a[32:35], v[140:143]
 ds_read_b128 a[108:111], v5 offset:43008
 v_mfma_f32_16x16x32_bf16 v[148:151], a[88:91], a[40:43], 0
 v_mfma_f32_16x16x32_bf16 v[148:151], a[92:95], a[44:47], v[148:151]
 ds_read_b128 a[104:107], v4 offset:43008
 v_mfma_f32_16x16x32_bf16 v[144:147], a[84:87], a[44:47], 0
 s_add_u32 m0, s29, 24576
 v_mfma_f32_16x16x32_bf16 v[144:147], a[80:83], a[40:43], v[144:147]
 buffer_load_dwordx4 v1, s[4:7], s46 offen  lds
 v_mfma_f32_16x16x32_bf16 v[156:159], a[72:75], a[40:43], 0
 ds_read_b128 a[112:115], v4 offset:45056
 v_mfma_f32_16x16x32_bf16 v[156:159], a[76:79], a[44:47], v[156:159]
 v_mfma_f32_16x16x32_bf16 v[152:155], a[68:71], a[44:47], 0
 ds_read_b128 a[116:119], v5 offset:45056
 v_mfma_f32_16x16x32_bf16 v[152:155], a[64:67], a[40:43], v[152:155]
 s_add_u32 m0, s29, 94208
 v_mfma_f32_16x16x32_bf16 v[160:163], a[64:67], a[48:51], 0
 buffer_load_dwordx4 v2, s[8:11], s54 offen  lds
 v_mfma_f32_16x16x32_bf16 v[160:163], a[68:71], a[52:55], v[160:163]
 ds_read_b128 a[124:127], v5 offset:47104
 v_mfma_f32_16x16x32_bf16 v[164:167], a[76:79], a[52:55], 0
 v_mfma_f32_16x16x32_bf16 v[164:167], a[72:75], a[48:51], v[164:167]
 ds_read_b128 a[120:123], v4 offset:47104
 v_mfma_f32_16x16x32_bf16 v[168:171], a[80:83], a[48:51], 0
 s_add_u32 m0, s29, 28672
 v_mfma_f32_16x16x32_bf16 v[168:171], a[84:87], a[52:55], v[168:171]
 buffer_load_dwordx4 v1, s[4:7], s47 offen  lds
 v_mfma_f32_16x16x32_bf16 v[172:175], a[92:95], a[52:55], 0
 v_mfma_f32_16x16x32_bf16 v[172:175], a[88:91], a[48:51], v[172:175]
 ds_read_b64_tr_b16 a[8:9], v7 offset:32768
 v_mfma_f32_16x16x32_bf16 v[180:183], a[88:91], a[56:59], 0
 v_mfma_f32_16x16x32_bf16 v[180:183], a[92:95], a[60:63], v[180:183]
 ds_read_b64_tr_b16 a[10:11], v7 offset:36864
 v_mfma_f32_16x16x32_bf16 v[176:179], a[84:87], a[60:63], 0
 ds_read_b64_tr_b16 a[12:13], v7 offset:49152
 v_mfma_f32_16x16x32_bf16 v[176:179], a[80:83], a[56:59], v[176:179]
 ds_read_b64_tr_b16 a[14:15], v7 offset:53248
 v_mfma_f32_16x16x32_bf16 v[188:191], a[72:75], a[56:59], 0
 ds_read_b64_tr_b16 a[16:17], v8 offset:32768
 v_mfma_f32_16x16x32_bf16 v[188:191], a[76:79], a[60:63], v[188:191]
 ds_read_b64_tr_b16 a[18:19], v8 offset:36864
 v_mfma_f32_16x16x32_bf16 v[184:187], a[68:71], a[60:63], 0
 ds_read_b64_tr_b16 a[20:21], v8 offset:49152
 v_mfma_f32_16x16x32_bf16 v[184:187], a[64:67], a[56:59], v[184:187]
 s_waitcnt lgkmcnt(8)
 ds_read_b64_tr_b16 a[22:23], v8 offset:53248
 v_add_u32 v1, 128, v1
 v_add_u32 v2, 0x80000, v2
 s_add_u32 s56, s56, s30
 buffer_load_dword a243, v14, s[36:39], s56 offen
 s_add_u32 s56, s56, s30
 buffer_load_dword a243, v14, s[36:39], s56 offen
 s_add_u32 s56, s56, s30
 s_branch L_vloop_mid
.p2align 6
L_vloop:
 v_mfma_f32_16x16x32_bf16 v[64:67], a[64:67], a[0:3], v[64:67]
 ds_read_b64_tr_b16 a[24:25], v9 offset:0
 v_mfma_f32_16x16x32_bf16 v[64:67], a[68:71], a[4:7], v[64:67]
 ds_read_b64_tr_b16 a[26:27], v9 offset:4096
 v_mfma_f32_16x16x32_bf16 v[68:71], a[76:79], a[4:7], v[68:71]
 ds_read_b64_tr_b16 a[28:29], v9 offset:16384
 v_mfma_f32_16x16x32_bf16 v[68:71], a[72:75], a[0:3], v[68:71]
 ds_read_b64_tr_b16 a[30:31], v9 offset:20480
 v_mfma_f32_16x16x32_bf16 v[72:75], a[80:83], a[0:3], v[72:75]
 ds_read_b128 a[96:99], v4 offset:8192
 v_mfma_f32_16x16x32_bf16 v[72:75], a[84:87], a[4:7], v[72:75]
 s_cmp_eq_u32 s61, s55
 s_cbranch_scc1 L_vloop_side
L_vloop_back:
 v_mfma_f32_16x16x32_bf16 v[76:79], a[92:95], a[4:7], v[76:79]
 s_waitcnt lgkmcnt(8)
 ds_read_b128 a[100:103], v5 offset:8192
 v_mfma_f32_16x16x32_bf16 v[76:79], a[88:91], a[0:3], v[76:79]
 v_mfma_f32_16x16x32_bf16 v[84:87], a[88:91], a[8:11], v[84:87]
 ds_read_b128 a[108:111], v5 offset:10240
 v_mfma_f32_16x16x32_bf16 v[84:87], a[92:95], a[12:15], v[84:87]
 v_mfma_f32_16x16x32_bf16 v[80:83], a[84:87], a[12:15], v[80:83]
 ds_read_b128 a[104:107], v4 offset:10240
 v_mfma_f32_16x16x32_bf16 v[80:83], a[80:83], a[8:11], v[80:83]
 v_mfma_f32_16x16x32_bf16 v[92:95], a[72:75], a[8:11], v[92:95]
 ds_read_b128 a[112:115], v4 offset:12288
 v_mfma_f32_16x16x32_bf16 v[92:95], a[76:79], a[12:15], v[92:95]
 v_mfma_f32_16x16x32_bf16 v[88:91], a[68:71], a[12:15], v[88:91]
 ds_read_b128 a[116:119], v5 offset:12288
 v_mfma_f32_16x16x32_bf16 v[88:91], a[64:67], a[8:11], v[88:91]
 s_waitcnt lgkmcnt(8)
 v_mfma_f32_16x16x32_bf16 v[96:99], a[64:67], a[16:19], v[96:99]
 ds_read_b128 a[124:127], v5 offset:14336
 v_mfma_f32_16x16x32_bf16 v[96:99], a[68:71], a[20:23], v[96:99]
 v_mfma_f32_16x16x32_bf16 v[100:103], a[76:79], a[20:23], v[100:103]
 ds_read_b128 a[120:123], v4 offset:14336
 v_mfma_f32_16x16x32_bf16 v[100:103], a[72:75], a[16:19], v[100:103]
 v_mfma_f32_16x16x32_bf16 v[104:107], a[80:83], a[16:19], v[104:107]
 ds_read_b64_tr_b16 a[32:33], v10 offset:0
 v_mfma_f32_16x16x32_bf16 v[104:107], a[84:87], a[20:23], v[104:107]
 ds_read_b64_tr_b16 a[34:35], v10 offset:4096
 v_mfma_f32_16x16x32_bf16 v[108:111], a[92:95], a[20:23], v[108:111]
 ds_read_b64_tr_b16 a[36:37], v10 offset:16384
 v_mfma_f32_16x16x32_bf16 v[108:111], a[88:91], a[16:19], v[108:111]
 ds_read_b64_tr_b16 a[38:39], v10 offset:20480
 v_mfma_f32_16x16x32_bf16 v[116:119], a[88:91], a[24:27], v[116:119]
 s_waitcnt lgkmcnt(8)
 ds_read_b64_tr_b16 a[40:41], v11 offset:0
 v_mfma_f32_16x16x32_bf16 v[116:119], a[92:95], a[28:31], v[116:119]
 ds_read_b64_tr_b16 a[42:43], v11 offset:4096
 v_mfma_f32_16x16x32_bf16 v[112:115], a[84:87], a[28:31], v[112:115]
 ds_read_b64_tr_b16 a[44:45], v11 offset:16384
 v_mfma_f32_16x16x32_bf16 v[112:115], a[80:83], a[24:27], v[112:115]
 ds_read_b64_tr_b16 a[46:47], v11 offset:20480
 v_mfma_f32_16x16x32_bf16 v[124:127], a[72:75], a[24:27], v[124:127]
 ds_read_b64_tr_b16 a[48:49], v12 offset:0
 v_mfma_f32_16x16x32_bf16 v[124:127], a[76:79], a[28:31], v[124:127]
 ds_read_b64_tr_b16 a[50:51], v12 offset:4096
 v_mfma_f32_16x16x32_bf16 v[120:123], a[68:71], a[28:31], v[120:123]
 ds_read_b64_tr_b16 a[52:53], v12 offset:16384
 v_mfma_f32_16x16x32_bf16 v[120:123], a[64:67], a[24:27], v[120:123]
 ds_read_b64_tr_b16 a[54:55], v12 offset:20480
 v_mfma_f32_16x16x32_bf16 v[16:19], a[96:99], a[0:3], v[16:19]
 ds_read_b64_tr_b16 a[56:57], v13 offset:0
 v_mfma_f32_16x16x32_bf16 v[16:19], a[100:103], a[4:7], v[16:19]
 ds_read_b64_tr_b16 a[58:59], v13 offset:4096
 v_mfma_f32_16x16x32_bf16 v[20:23], a[108:111], a[4:7], v[20:23]
 ds_read_b64_tr_b16 a[60:61], v13 offset:16384
 v_mfma_f32_16x16x32_bf16 v[20:23], a[104:107], a[0:3], v[20:23]
 s_waitcnt lgkmcnt(8)
 ds_read_b64_tr_b16 a[62:63], v13 offset:20480
 v_mfma_f32_16x16x32_bf16 v[24:27], a[112:115], a[0:3], v[24:27]
 v_mfma_f32_16x16x32_bf16 v[24:27], a[116:119], a[4:7], v[24:27]
 v_mfma_f32_16x16x32_bf16 v[28:31], a[124:127], a[4:7], v[28:31]
 v_mfma_f32_16x16x32_bf16 v[28:31], a[120:123], a[0:3], v[28:31]
 s_waitcnt lgkmcnt(0)
 v_mfma_f32_16x16x32_bf16 a[228:231], a[120:123], a[8:11], a[228:231]
 s_barrier
 v_mfma_f32_16x16x32_bf16 a[228:231], a[124:127], a[12:15], a[228:231]
 s_add_u32 m0, s29, 65536
 v_mfma_f32_16x16x32_bf16 a[224:227], a[116:119], a[12:15], a[224:227]
 buffer_load_dwordx4 v2, s[8:11], 0 offen  lds
 v_mfma_f32_16x16x32_bf16 a[224:227], a[112:115], a[8:11], a[224:227]
 v_mfma_f32_16x16x32_bf16 a[236:239], a[104:107], a[8:11], a[236:239]
 v_mfma_f32_16x16x32_bf16 a[236:239], a[108:111], a[12:15], a[236:239]
 v_mfma_f32_16x16x32_bf16 a[232:235], a[100:103], a[12:15], a[232:235]
 s_add_u32 m0, s29, 0
 v_mfma_f32_16x16x32_bf16 a[232:235], a[96:99], a[8:11], a[232:235]
 buffer_load_dwordx4 v1, s[4:7], 0 offen  lds
 v_mfma_f32_16x16x32_bf16 v[32:35], a[96:99], a[16:19], v[32:35]
 v_mfma_f32_16x16x32_bf16 v[32:35], a[100:103], a[20:23], v[32:35]
 v_mfma_f32_16x16x32_bf16 v[36:39], a[108:111], a[20:23], v[36:39]
 v_mfma_f32_16x16x32_bf16 v[36:39], a[104:107], a[16:19], v[36:39]
 s_add_u32 m0, s29, 69632
 v_mfma_f32_16x16x32_bf16 v[40:43], a[112:115], a[16:19], v[40:43]
 buffer_load_dwordx4 v2, s[8:11], s48 offen  lds
 v_mfma_f32_16x16x32_bf16 v[40:43], a[116:119], a[20:23], v[40:43]
 v_mfma_f32_16x16x32_bf16 v[44:47], a[124:127], a[20:23], v[44:47]
 v_mfma_f32_16x16x32_bf16 v[44:47], a[120:123], a[16:19], v[44:47]
 v_mfma_f32_16x16x32_bf16 v[52:55], a[120:123], a[24:27], v[52:55]
 s_add_u32 m0, s29, 4096
 v_mfma_f32_16x16x32_bf16 v[52:55], a[124:127], a[28:31], v[52:55]
 buffer_load_dwordx4 v1, s[4:7], s41 offen  lds
 v_mfma_f32_16x16x32_bf16 v[48:51], a[116:119], a[28:31], v[48:51]
 v_mfma_f32_16x16x32_bf16 v[48:51], a[112:115], a[24:27], v[48:51]
 v_mfma_f32_16x16x32_bf16 v[60:63], a[104:107], a[24:27], v[60:63]
 v_mfma_f32_16x16x32_bf16 v[60:63], a[108:111], a[28:31], v[60:63]
 s_add_u32 m0, s29, 73728
 v_mfma_f32_16x16x32_bf16 v[56:59], a[100:103], a[28:31], v[56:59]
 buffer_load_dwordx4 v2, s[8:11], s49 offen  lds
 v_mfma_f32_16x16x32_bf16 v[56:59], a[96:99], a[24:27], v[56:59]
 v_mfma_f32_16x16x32_bf16 v[192:195], a[96:99], a[32:35], v[192:195]
 v_mfma_f32_16x16x32_bf16 v[192:195], a[100:103], a[36:39], v[192:195]
 v_mfma_f32_16x16x32_bf16 v[196:199], a[108:111], a[36:39], v[196:199]
 s_add_u32 m0, s29, 8192
 v_mfma_f32_16x16x32_bf16 v[196:199], a[104:107], a[32:35], v[196:199]
 buffer_load_dwordx4 v1, s[4:7], s42 offen  lds
 v_mfma_f32_16x16x32_bf16 v[200:203], a[112:115], a[32:35], v[200:203]
 v_mfma_f32_16x16x32_bf16 v[200:203], a[116:119], a[36:39], v[200:203]
 v_mfma_f32_16x16x32_bf16 v[204:207], a[124:127], a[36:39], v[204:207]
 v_mfma_f32_16x16x32_bf16 v[204:207], a[120:123], a[32:35], v[204:207]
 s_add_u32 m0, s29, 77824
 v_mfma_f32_16x16x32_bf16 v[212:215], a[120:123], a[40:43], v[212:215]
 buffer_load_dwordx4 v2, s[8:11], s50 offen  lds
 v_mfma_f32_16x16x32_bf16 v[212:215], a[124:127], a[44:47], v[212:215]
 v_mfma_f32_16x16x32_bf16 v[208:211], a[116:119], a[44:47], v[208:211]
 v_mfma_f32_16x16x32_bf16 v[208:211], a[112:115], a[40:43], v[208:211]
 v_mfma_f32_16x16x32_bf16 v[220:223], a[104:107], a[40:43], v[220:223]
 s_add_u32 m0, s29, 12288
 v_mfma_f32_16x16x32_bf16 v[220:223], a[108:111], a[44:47], v[220:223]
 buffer_load_dwordx4 v1, s[4:7], s43 offen  lds
 v_mfma_f32_16x16x32_bf16 v[216:219], a[100:103], a[44:47], v[216:219]
 v_mfma_f32_16x16x32_bf16 v[216:219], a[96:99], a[40:43], v[216:219]
 v_mfma_f32_16x16x32_bf16 v[224:227], a[96:99], a[48:51], v[224:227]
 v_mfma_f32_16x16x32_bf16 v[224:227], a[100:103], a[52:55], v[224:227]
 s_add_u32 m0, s29, 81920
 v_mfma_f32_16x16x32_bf16 v[228:231], a[108:111], a[52:55], v[228:231]
 buffer_load_dwordx4 v2, s[8:11], s51 offen  lds
 v_mfma_f32_16x16x32_bf16 v[228:231], a[104:107], a[48:51], v[228:231]
 v_mfma_f32_16x16x32_bf16 v[232:235], a[112:115], a[48:51], v[232:235]
 v_mfma_f32_16x16x32_bf16 v[232:235], a[116:119], a[52:55], v[232:235]
 v_mfma_f32_16x16x32_bf16 v[236:239], a[124:127], a[52:55], v[236:239]
 s_add_u32 m0, s29, 16384
 v_mfma_f32_16x16x32_bf16 v[236:239], a[120:123], a[48:51], v[236:239]
 buffer_load_dwordx4 v1, s[4:7], s44 offen  lds
 v_mfma_f32_16x16x32_bf16 v[244:247], a[120:123], a[56:59], v[244:247]
 v_mfma_f32_16x16x32_bf16 v[244:247], a[124:127], a[60:63], v[244:247]
 v_mfma_f32_16x16x32_bf16 v[240:243], a[116:119], a[60:63], v[240:243]
 v_mfma_f32_16x16x32_bf16 v[240:243], a[112:115], a[56:59], v[240:243]
 s_add_u32 m0, s29, 86016
 v_mfma_f32_16x16x32_bf16 v[252:255], a[104:107], a[56:59], v[252:255]
 s_waitcnt vmcnt(11)
 buffer_load_dwordx4 v2, s[8:11], s52 offen  lds
 v_mfma_f32_16x16x32_bf16 v[252:255], a[108:111], a[60:63], v[252:255]
 s_barrier
 ds_read_b64_tr_b16 a[0:1], v6 offset:32768
 v_mfma_f32_16x16x32_bf16 v[248:251], a[100:103], a[60:63], v[248:251]
 ds_read_b64_tr_b16 a[2:3], v6 offset:36864
 v_mfma_f32_16x16x32_bf16 v[248:251], a[96:99], a[56:59], v[248:251]
 ds_read_b128 a[96:99], v4 offset:40960
 v_mfma_f32_16x16x32_bf16 v[128:131], a[64:67], a[32:35], v[128:131]
 s_add_u32 m0, s29, 20480
 v_mfma_f32_16x16x32_bf16 v[128:131], a[68:71], a[36:39], v[128:131]
 buffer_load_dwordx4 v1, s[4:7], s45 offen  lds
 v_mfma_f32_16x16x32_bf16 v[132:135], a[76:79], a[36:39], v[132:135]
 ds_read_b64_tr_b16 a[4:5], v6 offset:49152
 v_mfma_f32_16x16x32_bf16 v[132:135], a[72:75], a[32:35], v[132:135]
 ds_read_b64_tr_b16 a[6:7], v6 offset:53248
 v_mfma_f32_16x16x32_bf16 v[136:139], a[80:83], a[32:35], v[136:139]
 ds_read_b128 a[100:103], v5 offset:40960
 v_mfma_f32_16x16x32_bf16 v[136:139], a[84:87], a[36:39], v[136:139]
 s_add_u32 m0, s29, 90112
 v_mfma_f32_16x16x32_bf16 v[140:143], a[92:95], a[36:39], v[140:143]
 buffer_load_dwordx4 v2, s[8:11], s53 offen  lds
 v_mfma_f32_16x16x32_bf16 v[140:143], a[88:91], a[32:35], v[140:143]
 ds_read_b128 a[108:111], v5 offset:43008
 v_mfma_f32_16x16x32_bf16 v[148:151], a[88:91], a[40:43], v[148:151]
 v_mfma_f32_16x16x32_bf16 v[148:151], a[92:95], a[44:47], v[148:151]
 ds_read_b128 a[104:107], v4 offset:43008
 v_mfma_f32_16x16x32_bf16 v[144:147], a[84:87], a[44:47], v[144:147]
 s_add_u32 m0, s29, 24576
 v_mfma_f32_16x16x32_bf16 v[144:147], a[80:83], a[40:43], v[144:147]
 buffer_load_dwordx4 v1, s[4:7], s46 offen  lds
 v_mfma_f32_16x16x32_bf16 v[156:159], a[72:75], a[40:43], v[156:159]
 ds_read_b128 a[112:115], v4 offset:45056
 v_mfma_f32_16x16x32_bf16 v[156:159], a[76:79], a[44:47], v[156:159]
 v_mfma_f32_16x16x32_bf16 v[152:155], a[68:71], a[44:47], v[152:155]
 ds_read_b128 a[116:119], v5 offset:45056
 v_mfma_f32_16x16x32_bf16 v[152:155], a[64:67], a[40:43], v[152:155]
 s_add_u32 m0, s29, 94208
 v_mfma_f32_16x16x32_bf16 v[160:163], a[64:67], a[48:51], v[160:163]
 buffer_load_dwordx4 v2, s[8:11], s54 offen  lds
 v_mfma_f32_16x16x32_bf16 v[160:163], a[68:71], a[52:55], v[160:163]
 ds_read_b128 a[124:127], v5 offset:47104
 v_mfma_f32_16x16x32_bf16 v[164:167], a[76:79], a[52:55], v[164:167]
 v_mfma_f32_16x16x32_bf16 v[164:167], a[72:75], a[48:51], v[164:167]
 ds_read_b128 a[120:123], v4 offset:47104
 v_mfma_f32_16x16x32_bf16 v[168:171], a[80:83], a[48:51], v[168:171]
 s_add_u32 m0, s29, 28672
 v_mfma_f32_16x16x32_bf16 v[168:171], a[84:87], a[52:55], v[168:171]
 buffer_load_dwordx4 v1, s[4:7], s47 offen  lds
 v_mfma_f32_16x16x32_bf16 v[172:175], a[92:95], a[52:55], v[172:175]
 v_add_u32 v1, 128, v1
 v_add_u32 v2, 0x80000, v2
 v_mfma_f32_16x16x32_bf16 v[172:175], a[88:91], a[48:51], v[172:175]
 ds_read_b64_tr_b16 a[8:9], v7 offset:32768
 v_mfma_f32_16x16x32_bf16 v[180:183], a[88:91], a[56:59], v[180:183]
 buffer_load_dword a243, v14, s[36:39], s56 offen
 v_mfma_f32_16x16x32_bf16 v[180:183], a[92:95], a[60:63], v[180:183]
 s_add_u32 s56, s56, s30
 ds_read_b64_tr_b16 a[10:11], v7 offset:36864
 v_mfma_f32_16x16x32_bf16 v[176:179], a[84:87], a[60:63], v[176:179]
 ds_read_b64_tr_b16 a[12:13], v7 offset:49152
 v_mfma_f32_16x16x32_bf16 v[176:179], a[80:83], a[56:59], v[176:179]
 ds_read_b64_tr_b16 a[14:15], v7 offset:53248
 v_mfma_f32_16x16x32_bf16 v[188:191], a[72:75], a[56:59], v[188:191]
 ds_read_b64_tr_b16 a[16:17], v8 offset:32768
 v_mfma_f32_16x16x32_bf16 v[188:191], a[76:79], a[60:63], v[188:191]
 ds_read_b64_tr_b16 a[18:19], v8 offset:36864
 v_mfma_f32_16x16x32_bf16 v[184:187], a[68:71], a[60:63], v[184:187]
 ds_read_b64_tr_b16 a[20:21], v8 offset:49152
 v_mfma_f32_16x16x32_bf16 v[184:187], a[64:67], a[56:59], v[184:187]
 s_waitcnt lgkmcnt(8)
 ds_read_b64_tr_b16 a[22:23], v8 offset:53248
L_vloop_mid:
 v_mfma_f32_16x16x32_bf16 v[16:19], a[96:99], a[0:3], v[16:19]
 ds_read_b64_tr_b16 a[24:25], v9 offset:32768
 v_mfma_f32_16x16x32_bf16 v[16:19], a[100:103], a[4:7], v[16:19]
 ds_read_b64_tr_b16 a[26:27], v9 offset:36864
 v_mfma_f32_16x16x32_bf16 v[20:23], a[108:111], a[4:7], v[20:23]
 ds_read_b64_tr_b16 a[28:29], v9 offset:49152
 v_mfma_f32_16x16x32_bf16 v[20:23], a[104:107], a[0:3], v[20:23]
 ds_read_b64_tr_b16 a[30:31], v9 offset:53248
 v_mfma_f32_16x16x32_bf16 v[24:27], a[112:115], a[0:3], v[24:27]
 ds_read_b128 a[64:67], v4 offset:32768
 v_mfma_f32_16x16x32_bf16 v[24:27], a[116:119], a[4:7], v[24:27]
 v_mfma_f32_16x16x32_bf16 v[28:31], a[124:127], a[4:7], v[28:31]
 s_waitcnt lgkmcnt(8)
 ds_read_b128 a[68:71], v5 offset:32768
 v_mfma_f32_16x16x32_bf16 v[28:31], a[120:123], a[0:3], v[28:31]
 v_mfma_f32_16x16x32_bf16 a[228:231], a[120:123], a[8:11], a[228:231]
 ds_read_b128 a[76:79], v5 offset:34816
 v_mfma_f32_16x16x32_bf16 a[228:231], a[124:127], a[12:15], a[228:231]
 v_mfma_f32_16x16x32_bf16 a[224:227], a[116:119], a[12:15], a[224:227]
 ds_read_b128 a[72:75], v4 offset:34816
 v_mfma_f32_16x16x32_bf16 a[224:227], a[112:115], a[8:11], a[224:227]
 v_mfma_f32_16x16x32_bf16 a[236:239], a[104:107], a[8:11], a[236:239]
 ds_read_b128 a[80:83], v4 offset:36864
 v_mfma_f32_16x16x32_bf16 a[236:239], a[108:111], a[12:15], a[236:239]
 v_mfma_f32_16x16x32_bf16 a[232:235], a[100:103], a[12:15], a[232:235]
 ds_read_b128 a[84:87], v5 offset:36864
 v_mfma_f32_16x16x32_bf16 a[232:235], a[96:99], a[8:11], a[232:235]
 s_waitcnt lgkmcnt(8)
 v_mfma_f32_16x16x32_bf16 v[32:35], a[96:99], a[16:19], v[32:35]
 ds_read_b128 a[92:95], v5 offset:38912
 v_mfma_f32_16x16x32_bf16 v[32:35], a[100:103], a[20:23], v[32:35]
 v_mfma_f32_16x16x32_bf16 v[36:39], a[108:111], a[20:23], v[36:39]
 ds_read_b128 a[88:91], v4 offset:38912
 v_mfma_f32_16x16x32_bf16 v[36:39], a[104:107], a[16:19], v[36:39]
 v_mfma_f32_16x16x32_bf16 v[40:43], a[112:115], a[16:19], v[40:43]
 ds_read_b64_tr_b16 a[32:33], v10 offset:32768
 v_mfma_f32_16x16x32_bf16 v[40:43], a[116:119], a[20:23], v[40:43]
 ds_read_b64_tr_b16 a[34:35], v10 offset:36864
 v_mfma_f32_16x16x32_bf16 v[44:47], a[124:127], a[20:23], v[44:47]
 ds_read_b64_tr_b16 a[36:37], v10 offset:49152
 v_mfma_f32_16x16x32_bf16 v[44:47], a[120:123], a[16:19], v[44:47]
 ds_read_b64_tr_b16 a[38:39], v10 offset:53248
 v_mfma_f32_16x16x32_bf16 v[52:55], a[120:123], a[24:27], v[52:55]
 s_waitcnt lgkmcnt(8)
 ds_read_b64_tr_b16 a[40:41], v11 offset:32768
 v_mfma_f32_16x16x32_bf16 v[52:55], a[124:127], a[28:31], v[52:55]
 ds_read_b64_tr_b16 a[42:43], v11 offset:36864
 v_mfma_f32_16x16x32_bf16 v[48:51], a[116:119], a[28:31], v[48:51]
 ds_read_b64_tr_b16 a[44:45], v11 offset:49152
 v_mfma_f32_16x16x32_bf16 v[48:51], a[112:115], a[24:27], v[48:51]
 ds_read_b64_tr_b16 a[46:47], v11 offset:53248
 v_mfma_f32_16x16x32_bf16 v[60:63], a[104:107], a[24:27], v[60:63]
 ds_read_b64_tr_b16 a[48:49], v12 offset:32768
 v_mfma_f32_16x16x32_bf16 v[60:63], a[108:111], a[28:31], v[60:63]
 ds_read_b64_tr_b16 a[50:51], v12 offset:36864
 v_mfma_f32_16x16x32_bf16 v[56:59], a[100:103], a[28:31], v[56:59]
 ds_read_b64_tr_b16 a[52:53], v12 offset:49152
 v_mfma_f32_16x16x32_bf16 v[56:59], a[96:99], a[24:27], v[56:59]
 ds_read_b64_tr_b16 a[54:55], v12 offset:53248
 v_mfma_f32_16x16x32_bf16 v[64:67], a[64:67], a[0:3], v[64:67]
 ds_read_b64_tr_b16 a[56:57], v13 offset:32768
 v_mfma_f32_16x16x32_bf16 v[64:67], a[68:71], a[4:7], v[64:67]
 ds_read_b64_tr_b16 a[58:59], v13 offset:36864
 v_mfma_f32_16x16x32_bf16 v[68:71], a[76:79], a[4:7], v[68:71]
 ds_read_b64_tr_b16 a[60:61], v13 offset:49152
 v_mfma_f32_16x16x32_bf16 v[68:71], a[72:75], a[0:3], v[68:71]
 s_waitcnt lgkmcnt(8)
 ds_read_b64_tr_b16 a[62:63], v13 offset:53248
 v_mfma_f32_16x16x32_bf16 v[72:75], a[80:83], a[0:3], v[72:75]
 v_mfma_f32_16x16x32_bf16 v[72:75], a[84:87], a[4:7], v[72:75]
 v_mfma_f32_16x16x32_bf16 v[76:79], a[92:95], a[4:7], v[76:79]
 v_mfma_f32_16x16x32_bf16 v[76:79], a[88:91], a[0:3], v[76:79]
 s_waitcnt lgkmcnt(0)
 v_mfma_f32_16x16x32_bf16 v[84:87], a[88:91], a[8:11], v[84:87]
 s_barrier
 v_mfma_f32_16x16x32_bf16 v[84:87], a[92:95], a[12:15], v[84:87]
 s_add_u32 m0, s29, 98304
 v_mfma_f32_16x16x32_bf16 v[80:83], a[84:87], a[12:15], v[80:83]
 buffer_load_dwordx4 v2, s[8:11], 0 offen  lds
 v_mfma_f32_16x16x32_bf16 v[80:83], a[80:83], a[8:11], v[80:83]
 v_mfma_f32_16x16x32_bf16 v[92:95], a[72:75], a[8:11], v[92:95]
 v_mfma_f32_16x16x32_bf16 v[92:95], a[76:79], a[12:15], v[92:95]
 v_mfma_f32_16x16x32_bf16 v[88:91], a[68:71], a[12:15], v[88:91]
 s_add_u32 m0, s29, 32768
 v_mfma_f32_16x16x32_bf16 v[88:91], a[64:67], a[8:11], v[88:91]
 buffer_load_dwordx4 v1, s[4:7], 0 offen  lds
 v_mfma_f32_16x16x32_bf16 v[96:99], a[64:67], a[16:19], v[96:99]
 v_mfma_f32_16x16x32_bf16 v[96:99], a[68:71], a[20:23], v[96:99]
 v_mfma_f32_16x16x32_bf16 v[100:103], a[76:79], a[20:23], v[100:103]
 v_mfma_f32_16x16x32_bf16 v[100:103], a[72:75], a[16:19], v[100:103]
 s_add_u32 m0, s29, 102400
 v_mfma_f32_16x16x32_bf16 v[104:107], a[80:83], a[16:19], v[104:107]
 buffer_load_dwordx4 v2, s[8:11], s48 offen  lds
 v_mfma_f32_16x16x32_bf16 v[104:107], a[84:87], a[20:23], v[104:107]
 v_mfma_f32_16x16x32_bf16 v[108:111], a[92:95], a[20:23], v[108:111]
 v_mfma_f32_16x16x32_bf16 v[108:111], a[88:91], a[16:19], v[108:111]
 v_mfma_f32_16x16x32_bf16 v[116:119], a[88:91], a[24:27], v[116:119]
 s_add_u32 m0, s29, 36864
 v_mfma_f32_16x16x32_bf16 v[116:119], a[92:95], a[28:31], v[116:119]
 buffer_load_dwordx4 v1, s[4:7], s41 offen  lds
 v_mfma_f32_16x16x32_bf16 v[112:115], a[84:87], a[28:31], v[112:115]
 v_mfma_f32_16x16x32_bf16 v[112:115], a[80:83], a[24:27], v[112:115]
 v_mfma_f32_16x16x32_bf16 v[124:127], a[72:75], a[24:27], v[124:127]
 v_mfma_f32_16x16x32_bf16 v[124:127], a[76:79], a[28:31], v[124:127]
 s_add_u32 m0, s29, 106496
 v_mfma_f32_16x16x32_bf16 v[120:123], a[68:71], a[28:31], v[120:123]
 buffer_load_dwordx4 v2, s[8:11], s49 offen  lds
 v_mfma_f32_16x16x32_bf16 v[120:123], a[64:67], a[24:27], v[120:123]
 v_mfma_f32_16x16x32_bf16 v[128:131], a[64:67], a[32:35], v[128:131]
 v_mfma_f32_16x16x32_bf16 v[128:131], a[68:71], a[36:39], v[128:131]
 v_mfma_f32_16x16x32_bf16 v[132:135], a[76:79], a[36:39], v[132:135]
 s_add_u32 m0, s29, 40960
 v_mfma_f32_16x16x32_bf16 v[132:135], a[72:75], a[32:35], v[132:135]
 buffer_load_dwordx4 v1, s[4:7], s42 offen  lds
 v_mfma_f32_16x16x32_bf16 v[136:139], a[80:83], a[32:35], v[136:139]
 v_mfma_f32_16x16x32_bf16 v[136:139], a[84:87], a[36:39], v[136:139]
 v_mfma_f32_16x16x32_bf16 v[140:143], a[92:95], a[36:39], v[140:143]
 v_mfma_f32_16x16x32_bf16 v[140:143], a[88:91], a[32:35], v[140:143]
 s_add_u32 m0, s29, 110592
 v_mfma_f32_16x16x32_bf16 v[148:151], a[88:91], a[40:43], v[148:151]
 buffer_load_dwordx4 v2, s[8:11], s50 offen  lds
 v_mfma_f32_16x16x32_bf16 v[148:151], a[92:95], a[44:47], v[148:151]
 v_mfma_f32_16x16x32_bf16 v[144:147], a[84:87], a[44:47], v[144:147]
 v_mfma_f32_16x16x32_bf16 v[144:147], a[80:83], a[40:43], v[144:147]
 v_mfma_f32_16x16x32_bf16 v[156:159], a[72:75], a[40:43], v[156:159]
 s_add_u32 m0, s29, 45056
 v_mfma_f32_16x16x32_bf16 v[156:159], a[76:79], a[44:47], v[156:159]
 buffer_load_dwordx4 v1, s[4:7], s43 offen  lds
 v_mfma_f32_16x16x32_bf16 v[152:155], a[68:71], a[44:47], v[152:155]
 v_mfma_f32_16x16x32_bf16 v[152:155], a[64:67], a[40:43], v[152:155]
 v_mfma_f32_16x16x32_bf16 v[160:163], a[64:67], a[48:51], v[160:163]
 v_mfma_f32_16x16x32_bf16 v[160:163], a[68:71], a[52:55], v[160:163]
 s_add_u32 m0, s29, 114688
 v_mfma_f32_16x16x32_bf16 v[164:167], a[76:79], a[52:55], v[164:167]
 buffer_load_dwordx4 v2, s[8:11], s51 offen  lds
 v_mfma_f32_16x16x32_bf16 v[164:167], a[72:75], a[48:51], v[164:167]
 v_mfma_f32_16x16x32_bf16 v[168:171], a[80:83], a[48:51], v[168:171]
 v_mfma_f32_16x16x32_bf16 v[168:171], a[84:87], a[52:55], v[168:171]
 v_mfma_f32_16x16x32_bf16 v[172:175], a[92:95], a[52:55], v[172:175]
 s_add_u32 m0, s29, 49152
 v_mfma_f32_16x16x32_bf16 v[172:175], a[88:91], a[48:51], v[172:175]
 buffer_load_dwordx4 v1, s[4:7], s44 offen  lds
 v_mfma_f32_16x16x32_bf16 v[180:183], a[88:91], a[56:59], v[180:183]
 v_mfma_f32_16x16x32_bf16 v[180:183], a[92:95], a[60:63], v[180:183]
 v_mfma_f32_16x16x32_bf16 v[176:179], a[84:87], a[60:63], v[176:179]
 v_mfma_f32_16x16x32_bf16 v[176:179], a[80:83], a[56:59], v[176:179]
 s_add_u32 m0, s29, 118784
 v_mfma_f32_16x16x32_bf16 v[188:191], a[72:75], a[56:59], v[188:191]
 s_waitcnt vmcnt(11)
 buffer_load_dwordx4 v2, s[8:11], s52 offen  lds
 v_mfma_f32_16x16x32_bf16 v[188:191], a[76:79], a[60:63], v[188:191]
 s_barrier
 ds_read_b64_tr_b16 a[0:1], v6 offset:0
 v_mfma_f32_16x16x32_bf16 v[184:187], a[68:71], a[60:63], v[184:187]
 ds_read_b64_tr_b16 a[2:3], v6 offset:4096
 v_mfma_f32_16x16x32_bf16 v[184:187], a[64:67], a[56:59], v[184:187]
 ds_read_b128 a[64:67], v4 offset:0
 v_mfma_f32_16x16x32_bf16 v[192:195], a[96:99], a[32:35], v[192:195]
 s_add_u32 m0, s29, 53248
 v_mfma_f32_16x16x32_bf16 v[192:195], a[100:103], a[36:39], v[192:195]
 buffer_load_dwordx4 v1, s[4:7], s45 offen  lds
 v_mfma_f32_16x16x32_bf16 v[196:199], a[108:111], a[36:39], v[196:199]
 ds_read_b64_tr_b16 a[4:5], v6 offset:16384
 v_mfma_f32_16x16x32_bf16 v[196:199], a[104:107], a[32:35], v[196:199]
 ds_read_b64_tr_b16 a[6:7], v6 offset:20480
 v_mfma_f32_16x16x32_bf16 v[200:203], a[112:115], a[32:35], v[200:203]
 ds_read_b128 a[68:71], v5 offset:0
 v_mfma_f32_16x16x32_bf16 v[200:203], a[116:119], a[36:39], v[200:203]
 s_add_u32 m0, s29, 122880
 v_mfma_f32_16x16x32_bf16 v[204:207], a[124:127], a[36:39], v[204:207]
 buffer_load_dwordx4 v2, s[8:11], s53 offen  lds
 v_mfma_f32_16x16x32_bf16 v[204:207], a[120:123], a[32:35], v[204:207]
 ds_read_b128 a[76:79], v5 offset:2048
 v_mfma_f32_16x16x32_bf16 v[212:215], a[120:123], a[40:43], v[212:215]
 v_mfma_f32_16x16x32_bf16 v[212:215], a[124:127], a[44:47], v[212:215]
 ds_read_b128 a[72:75], v4 offset:2048
 v_mfma_f32_16x16x32_bf16 v[208:211], a[116:119], a[44:47], v[208:211]
 s_add_u32 m0, s29, 57344
 v_mfma_f32_16x16x32_bf16 v[208:211], a[112:115], a[40:43], v[208:211]
 buffer_load_dwordx4 v1, s[4:7], s46 offen  lds
 v_mfma_f32_16x16x32_bf16 v[220:223], a[104:107], a[40:43], v[220:223]
 ds_read_b128 a[80:83], v4 offset:4096
 v_mfma_f32_16x16x32_bf16 v[220:223], a[108:111], a[44:47], v[220:223]
 v_mfma_f32_16x16x32_bf16 v[216:219], a[100:103], a[44:47], v[216:219]
 ds_read_b128 a[84:87], v5 offset:4096
 v_mfma_f32_16x16x32_bf16 v[216:219], a[96:99], a[40:43], v[216:219]
 s_add_u32 m0, s29, 126976
 v_mfma_f32_16x16x32_bf16 v[224:227], a[96:99], a[48:51], v[224:227]
 buffer_load_dwordx4 v2, s[8:11], s54 offen  lds
 v_mfma_f32_16x16x32_bf16 v[224:227], a[100:103], a[52:55], v[224:227]
 ds_read_b128 a[92:95], v5 offset:6144
 v_mfma_f32_16x16x32_bf16 v[228:231], a[108:111], a[52:55], v[228:231]
 v_mfma_f32_16x16x32_bf16 v[228:231], a[104:107], a[48:51], v[228:231]
 ds_read_b128 a[88:91], v4 offset:6144
 v_mfma_f32_16x16x32_bf16 v[232:235], a[112:115], a[48:51], v[232:235]
 s_add_u32 m0, s29, 61440
 v_mfma_f32_16x16x32_bf16 v[232:235], a[116:119], a[52:55], v[232:235]
 buffer_load_dwordx4 v1, s[4:7], s47 offen  lds
 v_mfma_f32_16x16x32_bf16 v[236:239], a[124:127], a[52:55], v[236:239]
 v_add_u32 v1, 128, v1
 v_add_u32 v2, 0x80000, v2
 v_mfma_f32_16x16x32_bf16 v[236:239], a[120:123], a[48:51], v[236:239]
 ds_read_b64_tr_b16 a[8:9], v7 offset:0
 v_mfma_f32_16x16x32_bf16 v[244:247], a[120:123], a[56:59], v[244:247]
 buffer_load_dword a243, v14, s[36:39], s56 offen
 v_mfma_f32_16x16x32_bf16 v[244:247], a[124:127], a[60:63], v[244:247]
 s_add_u32 s56, s56, s30
 ds_read_b64_tr_b16 a[10:11], v7 offset:4096
 v_mfma_f32_16x16x32_bf16 v[240:243], a[116:119], a[60:63], v[240:243]
 ds_read_b64_tr_b16 a[12:13], v7 offset:16384
 v_mfma_f32_16x16x32_bf16 v[240:243], a[112:115], a[56:59], v[240:243]
 ds_read_b64_tr_b16 a[14:15], v7 offset:20480
 v_mfma_f32_16x16x32_bf16 v[252:255], a[104:107], a[56:59], v[252:255]
 ds_read_b64_tr_b16 a[16:17], v8 offset:0
 v_mfma_f32_16x16x32_bf16 v[252:255], a[108:111], a[60:63], v[252:255]
 ds_read_b64_tr_b16 a[18:19], v8 offset:4096
 v_mfma_f32_16x16x32_bf16 v[248:251], a[100:103], a[60:63], v[248:251]
 s_add_u32 s61, s61, 1
 ds_read_b64_tr_b16 a[20:21], v8 offset:16384
 v_mfma_f32_16x16x32_bf16 v[248:251], a[96:99], a[56:59], v[248:251]
 s_waitcnt lgkmcnt(8)
 ds_read_b64_tr_b16 a[22:23], v8 offset:20480
 s_cmp_lt_u32 s61, 6
 s_cbranch_scc1 L_vloop
 v_mfma_f32_16x16x32_bf16 v[64:67], a[64:67], a[0:3], v[64:67]
 ds_read_b64_tr_b16 a[24:25], v9 offset:0
 v_accvgpr_read_b32 v15, a240
 v_mfma_f32_16x16x32_bf16 v[64:67], a[68:71], a[4:7], v[64:67]
 ds_read_b64_tr_b16 a[26:27], v9 offset:4096
 v_accvgpr_read_b32 v14, a242
 v_mfma_f32_16x16x32_bf16 v[68:71], a[76:79], a[4:7], v[68:71]
 s_waitcnt lgkmcnt(12)
 ds_read_b64_tr_b16 a[28:29], v9 offset:16384
 v_xor_b32 v3, 64, v14
 v_mfma_f32_16x16x32_bf16 v[68:71], a[72:75], a[0:3], v[68:71]
 ds_read_b64_tr_b16 a[30:31], v9 offset:20480
 v_mfma_f32_16x16x32_bf16 v[72:75], a[80:83], a[0:3], v[72:75]
 s_add_u32 m0, s33, 0x0
 ds_read_b128 a[96:99], v4 offset:8192
 v_mfma_f32_16x16x32_bf16 v[72:75], a[84:87], a[4:7], v[72:75]
 s_waitcnt lgkmcnt(11)
 v_mfma_f32_16x16x32_bf16 v[76:79], a[92:95], a[4:7], v[76:79]
 ds_read_b128 a[100:103], v5 offset:8192
 buffer_load_dwordx4 v15, s[20:23], 0 offen offset:0 lds
 v_mfma_f32_16x16x32_bf16 v[76:79], a[88:91], a[0:3], v[76:79]
 v_mfma_f32_16x16x32_bf16 v[84:87], a[88:91], a[8:11], v[84:87]
 s_waitcnt lgkmcnt(10)
 ds_read_b128 a[108:111], v5 offset:10240
 v_mfma_f32_16x16x32_bf16 v[84:87], a[92:95], a[12:15], v[84:87]
 s_add_u32 m0, s33, 0x80
 v_mfma_f32_16x16x32_bf16 v[80:83], a[84:87], a[12:15], v[80:83]
 ds_read_b128 a[104:107], v4 offset:10240
 buffer_load_dwordx4 v15, s[20:23], 0 offen offset:896 lds
 v_mfma_f32_16x16x32_bf16 v[80:83], a[80:83], a[8:11], v[80:83]
 v_mfma_f32_16x16x32_bf16 v[92:95], a[72:75], a[8:11], v[92:95]
 ds_read_b128 a[112:115], v4 offset:12288
 v_mfma_f32_16x16x32_bf16 v[92:95], a[76:79], a[12:15], v[92:95]
 s_add_u32 m0, s33, 0x800
 v_mfma_f32_16x16x32_bf16 v[88:91], a[68:71], a[12:15], v[88:91]
 ds_read_b128 a[116:119], v5 offset:12288
 buffer_load_dwordx4 v15, s[20:23], s57 offen offset:0 lds
 v_mfma_f32_16x16x32_bf16 v[88:91], a[64:67], a[8:11], v[88:91]
 s_waitcnt lgkmcnt(10)
 v_mfma_f32_16x16x32_bf16 v[96:99], a[64:67], a[16:19], v[96:99]
 ds_read_b128 a[124:127], v5 offset:14336
 v_mfma_f32_16x16x32_bf16 v[96:99], a[68:71], a[20:23], v[96:99]
 s_add_u32 m0, s33, 0x880
 v_mfma_f32_16x16x32_bf16 v[100:103], a[76:79], a[20:23], v[100:103]
 ds_read_b128 a[120:123], v4 offset:14336
 buffer_load_dwordx4 v15, s[20:23], s57 offen offset:896 lds
 v_mfma_f32_16x16x32_bf16 v[100:103], a[72:75], a[16:19], v[100:103]
 v_mfma_f32_16x16x32_bf16 v[104:107], a[80:83], a[16:19], v[104:107]
 ds_read_b64_tr_b16 a[32:33], v10 offset:0
 v_mfma_f32_16x16x32_bf16 v[104:107], a[84:87], a[20:23], v[104:107]
 s_add_u32 m0, s33, 0xf80
 ds_read_b64_tr_b16 a[34:35], v10 offset:4096
 v_mfma_f32_16x16x32_bf16 v[108:111], a[92:95], a[20:23], v[108:111]
 ds_read_b64_tr_b16 a[36:37], v10 offset:16384
 buffer_load_dwordx4 v15, s[20:23], 0 offen offset:128 lds
 v_mfma_f32_16x16x32_bf16 v[108:111], a[88:91], a[16:19], v[108:111]
 s_waitcnt lgkmcnt(11)
 ds_read_b64_tr_b16 a[38:39], v10 offset:20480
 v_mfma_f32_16x16x32_bf16 v[116:119], a[88:91], a[24:27], v[116:119]
 ds_read_b64_tr_b16 a[40:41], v11 offset:0
 v_mfma_f32_16x16x32_bf16 v[116:119], a[92:95], a[28:31], v[116:119]
 s_add_u32 m0, s33, 0x1000
 ds_read_b64_tr_b16 a[42:43], v11 offset:4096
 v_mfma_f32_16x16x32_bf16 v[112:115], a[84:87], a[28:31], v[112:115]
 ds_read_b64_tr_b16 a[44:45], v11 offset:16384
 buffer_load_dwordx4 v15, s[20:23], 0 offen offset:1024 lds
 v_mfma_f32_16x16x32_bf16 v[112:115], a[80:83], a[24:27], v[112:115]
 ds_read_b64_tr_b16 a[46:47], v11 offset:20480
 v_mfma_f32_16x16x32_bf16 v[124:127], a[72:75], a[24:27], v[124:127]
 ds_read_b64_tr_b16 a[48:49], v12 offset:0
 v_mfma_f32_16x16x32_bf16 v[124:127], a[76:79], a[28:31], v[124:127]
 s_add_u32 m0, s33, 0x1780
 ds_read_b64_tr_b16 a[50:51], v12 offset:4096
 v_mfma_f32_16x16x32_bf16 v[120:123], a[68:71], a[28:31], v[120:123]
 ds_read_b64_tr_b16 a[52:53], v12 offset:16384
 buffer_load_dwordx4 v15, s[20:23], s57 offen offset:128 lds
 v_mfma_f32_16x16x32_bf16 v[120:123], a[64:67], a[24:27], v[120:123]
 s_waitcnt lgkmcnt(15)
 ds_read_b64_tr_b16 a[54:55], v12 offset:20480
 v_mfma_f32_16x16x32_bf16 v[16:19], a[96:99], a[0:3], v[16:19]
 ds_read_b64_tr_b16 a[56:57], v13 offset:0
 v_mfma_f32_16x16x32_bf16 v[16:19], a[100:103], a[4:7], v[16:19]
 s_add_u32 m0, s33, 0x1800
 ds_read_b64_tr_b16 a[58:59], v13 offset:4096
 v_mfma_f32_16x16x32_bf16 v[20:23], a[108:111], a[4:7], v[20:23]
 ds_read_b64_tr_b16 a[60:61], v13 offset:16384
 buffer_load_dwordx4 v15, s[20:23], s57 offen offset:1024 lds
 v_mfma_f32_16x16x32_bf16 v[20:23], a[104:107], a[0:3], v[20:23]
 s_waitcnt lgkmcnt(15)
 ds_read_b64_tr_b16 a[62:63], v13 offset:20480
 v_mfma_f32_16x16x32_bf16 v[24:27], a[112:115], a[0:3], v[24:27]
 v_mfma_f32_16x16x32_bf16 v[24:27], a[116:119], a[4:7], v[24:27]
 v_mfma_f32_16x16x32_bf16 v[28:31], a[124:127], a[4:7], v[28:31]
 v_mfma_f32_16x16x32_bf16 v[28:31], a[120:123], a[0:3], v[28:31]
 s_waitcnt lgkmcnt(0)
 v_mfma_f32_16x16x32_bf16 a[228:231], a[120:123], a[8:11], a[228:231]
 s_barrier
 v_mfma_f32_16x16x32_bf16 a[228:231], a[124:127], a[12:15], a[228:231]
 s_add_u32 m0, s29, 65536
 v_mfma_f32_16x16x32_bf16 a[224:227], a[116:119], a[12:15], a[224:227]
 buffer_load_dwordx4 v2, s[8:11], 0 offen  lds
 v_mfma_f32_16x16x32_bf16 a[224:227], a[112:115], a[8:11], a[224:227]
 v_mfma_f32_16x16x32_bf16 a[236:239], a[104:107], a[8:11], a[236:239]
 v_mfma_f32_16x16x32_bf16 a[236:239], a[108:111], a[12:15], a[236:239]
 v_mfma_f32_16x16x32_bf16 a[232:235], a[100:103], a[12:15], a[232:235]
 s_add_u32 m0, s29, 0
 v_mfma_f32_16x16x32_bf16 a[232:235], a[96:99], a[8:11], a[232:235]
 buffer_load_dwordx4 v1, s[4:7], 0 offen  lds
 v_mfma_f32_16x16x32_bf16 v[32:35], a[96:99], a[16:19], v[32:35]
 v_mfma_f32_16x16x32_bf16 v[32:35], a[100:103], a[20:23], v[32:35]
 v_mfma_f32_16x16x32_bf16 v[36:39], a[108:111], a[20:23], v[36:39]
 v_mfma_f32_16x16x32_bf16 v[36:39], a[104:107], a[16:19], v[36:39]
 s_add_u32 m0, s29, 69632
 v_mfma_f32_16x16x32_bf16 v[40:43], a[112:115], a[16:19], v[40:43]
 buffer_load_dwordx4 v2, s[8:11], s48 offen  lds
 v_mfma_f32_16x16x32_bf16 v[40:43], a[116:119], a[20:23], v[40:43]
 v_mfma_f32_16x16x32_bf16 v[44:47], a[124:127], a[20:23], v[44:47]
 v_mfma_f32_16x16x32_bf16 v[44:47], a[120:123], a[16:19], v[44:47]
 v_mfma_f32_16x16x32_bf16 v[52:55], a[120:123], a[24:27], v[52:55]
 s_add_u32 m0, s29, 4096
 v_mfma_f32_16x16x32_bf16 v[52:55], a[124:127], a[28:31], v[52:55]
 buffer_load_dwordx4 v1, s[4:7], s41 offen  lds
 v_mfma_f32_16x16x32_bf16 v[48:51], a[116:119], a[28:31], v[48:51]
 v_mfma_f32_16x16x32_bf16 v[48:51], a[112:115], a[24:27], v[48:51]
 v_mfma_f32_16x16x32_bf16 v[60:63], a[104:107], a[24:27], v[60:63]
 v_mfma_f32_16x16x32_bf16 v[60:63], a[108:111], a[28:31], v[60:63]
 s_add_u32 m0, s29, 73728
 v_mfma_f32_16x16x32_bf16 v[56:59], a[100:103], a[28:31], v[56:59]
 buffer_load_dwordx4 v2, s[8:11], s49 offen  lds
 v_mfma_f32_16x16x32_bf16 v[56:59], a[96:99], a[24:27], v[56:59]
 v_mfma_f32_16x16x32_bf16 v[192:195], a[96:99], a[32:35], v[192:195]
 v_mfma_f32_16x16x32_bf16 v[192:195], a[100:103], a[36:39], v[192:195]
 v_mfma_f32_16x16x32_bf16 v[196:199], a[108:111], a[36:39], v[196:199]
 s_add_u32 m0, s29, 8192
 v_mfma_f32_16x16x32_bf16 v[196:199], a[104:107], a[32:35], v[196:199]
 buffer_load_dwordx4 v1, s[4:7], s42 offen  lds
 v_mfma_f32_16x16x32_bf16 v[200:203], a[112:115], a[32:35], v[200:203]
 v_mfma_f32_16x16x32_bf16 v[200:203], a[116:119], a[36:39], v[200:203]
 v_mfma_f32_16x16x32_bf16 v[204:207], a[124:127], a[36:39], v[204:207]
 v_mfma_f32_16x16x32_bf16 v[204:207], a[120:123], a[32:35], v[204:207]
 s_add_u32 m0, s29, 77824
 v_mfma_f32_16x16x32_bf16 v[212:215], a[120:123], a[40:43], v[212:215]
 buffer_load_dwordx4 v2, s[8:11], s50 offen  lds
 v_mfma_f32_16x16x32_bf16 v[212:215], a[124:127], a[44:47], v[212:215]
 v_mfma_f32_16x16x32_bf16 v[208:211], a[116:119], a[44:47], v[208:211]
 v_mfma_f32_16x16x32_bf16 v[208:211], a[112:115], a[40:43], v[208:211]
 v_mfma_f32_16x16x32_bf16 v[220:223], a[104:107], a[40:43], v[220:223]
 s_add_u32 m0, s29, 12288
 v_mfma_f32_16x16x32_bf16 v[220:223], a[108:111], a[44:47], v[220:223]
 buffer_load_dwordx4 v1, s[4:7], s43 offen  lds
 v_mfma_f32_16x16x32_bf16 v[216:219], a[100:103], a[44:47], v[216:219]
 v_mfma_f32_16x16x32_bf16 v[216:219], a[96:99], a[40:43], v[216:219]
 v_mfma_f32_16x16x32_bf16 v[224:227], a[96:99], a[48:51], v[224:227]
 v_mfma_f32_16x16x32_bf16 v[224:227], a[100:103], a[52:55], v[224:227]
 s_add_u32 m0, s29, 81920
 v_mfma_f32_16x16x32_bf16 v[228:231], a[108:111], a[52:55], v[228:231]
 buffer_load_dwordx4 v2, s[8:11], s51 offen  lds
 v_mfma_f32_16x16x32_bf16 v[228:231], a[104:107], a[48:51], v[228:231]
 v_mfma_f32_16x16x32_bf16 v[232:235], a[112:115], a[48:51], v[232:235]
 v_mfma_f32_16x16x32_bf16 v[232:235], a[116:119], a[52:55], v[232:235]
 v_mfma_f32_16x16x32_bf16 v[236:239], a[124:127], a[52:55], v[236:239]
 s_add_u32 m0, s29, 16384
 v_mfma_f32_16x16x32_bf16 v[236:239], a[120:123], a[48:51], v[236:239]
 buffer_load_dwordx4 v1, s[4:7], s44 offen  lds
 v_mfma_f32_16x16x32_bf16 v[244:247], a[120:123], a[56:59], v[244:247]
 v_mfma_f32_16x16x32_bf16 v[244:247], a[124:127], a[60:63], v[244:247]
 v_mfma_f32_16x16x32_bf16 v[240:243], a[116:119], a[60:63], v[240:243]
 v_mfma_f32_16x16x32_bf16 v[240:243], a[112:115], a[56:59], v[240:243]
 s_add_u32 m0, s29, 86016
 v_mfma_f32_16x16x32_bf16 v[252:255], a[104:107], a[56:59], v[252:255]
 s_waitcnt vmcnt(10)
 buffer_load_dwordx4 v2, s[8:11], s52 offen  lds
 v_mfma_f32_16x16x32_bf16 v[252:255], a[108:111], a[60:63], v[252:255]
 s_barrier
 ds_read_b64_tr_b16 a[0:1], v6 offset:32768
 v_mfma_f32_16x16x32_bf16 v[248:251], a[100:103], a[60:63], v[248:251]
 ds_read_b64_tr_b16 a[2:3], v6 offset:36864
 v_mfma_f32_16x16x32_bf16 v[248:251], a[96:99], a[56:59], v[248:251]
 ds_read_b128 a[96:99], v4 offset:40960
 v_mfma_f32_16x16x32_bf16 v[128:131], a[64:67], a[32:35], v[128:131]
 s_add_u32 m0, s29, 20480
 ds_read_b128 a[128:131], v14 offset:0
 v_mfma_f32_16x16x32_bf16 v[128:131], a[68:71], a[36:39], v[128:131]
 buffer_load_dwordx4 v1, s[4:7], s45 offen  lds
 v_mfma_f32_16x16x32_bf16 v[132:135], a[76:79], a[36:39], v[132:135]
 ds_read_b64_tr_b16 a[4:5], v6 offset:49152
 v_mfma_f32_16x16x32_bf16 v[132:135], a[72:75], a[32:35], v[132:135]
 ds_read_b64_tr_b16 a[6:7], v6 offset:53248
 v_mfma_f32_16x16x32_bf16 v[136:139], a[80:83], a[32:35], v[136:139]
 ds_read_b128 a[100:103], v5 offset:40960
 v_mfma_f32_16x16x32_bf16 v[136:139], a[84:87], a[36:39], v[136:139]
 s_add_u32 m0, s29, 90112
 ds_read_b128 a[136:139], v3 offset:0
 v_mfma_f32_16x16x32_bf16 v[140:143], a[92:95], a[36:39], v[140:143]
 buffer_load_dwordx4 v2, s[8:11], s53 offen  lds
 v_mfma_f32_16x16x32_bf16 v[140:143], a[88:91], a[32:35], v[140:143]
 ds_read_b128 a[108:111], v5 offset:43008
 v_mfma_f32_16x16x32_bf16 v[148:151], a[88:91], a[40:43], v[148:151]
 ds_read_b128 a[132:135], v14 offset:2048
 v_mfma_f32_16x16x32_bf16 v[148:151], a[92:95], a[44:47], v[148:151]
 ds_read_b128 a[104:107], v4 offset:43008
 v_mfma_f32_16x16x32_bf16 v[144:147], a[84:87], a[44:47], v[144:147]
 s_add_u32 m0, s29, 24576
 ds_read_b128 a[140:143], v3 offset:2048
 v_mfma_f32_16x16x32_bf16 v[144:147], a[80:83], a[40:43], v[144:147]
 buffer_load_dwordx4 v1, s[4:7], s46 offen  lds
 v_mfma_f32_16x16x32_bf16 v[156:159], a[72:75], a[40:43], v[156:159]
 ds_read_b128 a[112:115], v4 offset:45056
 v_mfma_f32_16x16x32_bf16 v[156:159], a[76:79], a[44:47], v[156:159]
 ds_read_b128 a[144:147], v14 offset:4096
 v_mfma_f32_16x16x32_bf16 v[152:155], a[68:71], a[44:47], v[152:155]
 ds_read_b128 a[116:119], v5 offset:45056
 v_mfma_f32_16x16x32_bf16 v[152:155], a[64:67], a[40:43], v[152:155]
 s_add_u32 m0, s29, 94208
 ds_read_b128 a[152:155], v3 offset:4096
 v_mfma_f32_16x16x32_bf16 v[160:163], a[64:67], a[48:51], v[160:163]
 buffer_load_dwordx4 v2, s[8:11], s54 offen  lds
 v_mfma_f32_16x16x32_bf16 v[160:163], a[68:71], a[52:55], v[160:163]
 ds_read_b128 a[124:127], v5 offset:47104
 v_mfma_f32_16x16x32_bf16 v[164:167], a[76:79], a[52:55], v[164:167]
 ds_read_b128 a[148:151], v14 offset:6144
 v_mfma_f32_16x16x32_bf16 v[164:167], a[72:75], a[48:51], v[164:167]
 ds_read_b128 a[120:123], v4 offset:47104
 v_mfma_f32_16x16x32_bf16 v[168:171], a[80:83], a[48:51], v[168:171]
 s_add_u32 m0, s29, 28672
 ds_read_b128 a[156:159], v3 offset:6144
 v_mfma_f32_16x16x32_bf16 v[168:171], a[84:87], a[52:55], v[168:171]
 buffer_load_dwordx4 v1, s[4:7], s47 offen  lds
 v_mfma_f32_16x16x32_bf16 v[172:175], a[92:95], a[52:55], v[172:175]
 v_add_u32 v1, 128, v1
 v_add_u32 v2, 0x80000, v2
 v_mfma_f32_16x16x32_bf16 v[172:175], a[88:91], a[48:51], v[172:175]
 ds_read_b64_tr_b16 a[8:9], v7 offset:32768
 v_mfma_f32_16x16x32_bf16 v[180:183], a[88:91], a[56:59], v[180:183]
 v_mfma_f32_16x16x32_bf16 v[180:183], a[92:95], a[60:63], v[180:183]
 ds_read_b64_tr_b16 a[10:11], v7 offset:36864
 v_mfma_f32_16x16x32_bf16 v[176:179], a[84:87], a[60:63], v[176:179]
 ds_read_b64_tr_b16 a[12:13], v7 offset:49152
 v_mfma_f32_16x16x32_bf16 v[176:179], a[80:83], a[56:59], v[176:179]
 ds_read_b64_tr_b16 a[14:15], v7 offset:53248
 v_mfma_f32_16x16x32_bf16 v[188:191], a[72:75], a[56:59], v[188:191]
 ds_read_b64_tr_b16 a[16:17], v8 offset:32768
 v_mfma_f32_16x16x32_bf16 v[188:191], a[76:79], a[60:63], v[188:191]
 ds_read_b64_tr_b16 a[18:19], v8 offset:36864
 v_mfma_f32_16x16x32_bf16 v[184:187], a[68:71], a[60:63], v[184:187]
 ds_read_b64_tr_b16 a[20:21], v8 offset:49152
 v_mfma_f32_16x16x32_bf16 v[184:187], a[64:67], a[56:59], v[184:187]
 s_waitcnt lgkmcnt(15)
 ds_read_b64_tr_b16 a[22:23], v8 offset:53248
 v_mfma_f32_16x16x32_bf16 v[16:19], a[96:99], a[0:3], v[16:19]
 ds_read_b64_tr_b16 a[24:25], v9 offset:32768
 v_mfma_f32_16x16x32_bf16 v[16:19], a[100:103], a[4:7], v[16:19]
 s_add_u32 m0, s33, 0xffffff00
 ds_read_b64_tr_b16 a[26:27], v9 offset:36864
 v_mfma_f32_16x16x32_bf16 v[20:23], a[108:111], a[4:7], v[20:23]
 s_waitcnt lgkmcnt(10)
 ds_read_b64_tr_b16 a[28:29], v9 offset:49152
 v_mfma_f32_16x16x32_bf16 v[20:23], a[104:107], a[0:3], v[20:23]
 ds_read_b64_tr_b16 a[30:31], v9 offset:53248
 buffer_load_dwordx4 v15, s[20:23], 0 offen offset:256 lds
 v_mfma_f32_16x16x32_bf16 v[24:27], a[112:115], a[0:3], v[24:27]
 ds_read_b128 a[64:67], v4 offset:32768
 v_mfma_f32_16x16x32_bf16 v[24:27], a[116:119], a[4:7], v[24:27]
 v_mfma_f32_16x16x32_bf16 v[28:31], a[124:127], a[4:7], v[28:31]
 s_add_u32 m0, s33, 0xffffff80
 ds_read_b128 a[68:71], v5 offset:32768
 v_mfma_f32_16x16x32_bf16 v[28:31], a[120:123], a[0:3], v[28:31]
 s_waitcnt lgkmcnt(10)
 buffer_load_dwordx4 v15, s[20:23], 0 offen offset:1152 lds
 v_mfma_f32_16x16x32_bf16 a[228:231], a[120:123], a[8:11], a[228:231]
 ds_read_b128 a[76:79], v5 offset:34816
 v_mfma_f32_16x16x32_bf16 a[228:231], a[124:127], a[12:15], a[228:231]
 v_mfma_f32_16x16x32_bf16 a[224:227], a[116:119], a[12:15], a[224:227]
 s_add_u32 m0, s33, 0x700
 ds_read_b128 a[72:75], v4 offset:34816
 v_mfma_f32_16x16x32_bf16 a[224:227], a[112:115], a[8:11], a[224:227]
 buffer_load_dwordx4 v15, s[20:23], s57 offen offset:256 lds
 v_mfma_f32_16x16x32_bf16 a[236:239], a[104:107], a[8:11], a[236:239]
 ds_read_b128 a[80:83], v4 offset:36864
 v_mfma_f32_16x16x32_bf16 a[236:239], a[108:111], a[12:15], a[236:239]
 v_mfma_f32_16x16x32_bf16 a[232:235], a[100:103], a[12:15], a[232:235]
 s_add_u32 m0, s33, 0x780
 ds_read_b128 a[84:87], v5 offset:36864
 v_mfma_f32_16x16x32_bf16 a[232:235], a[96:99], a[8:11], a[232:235]
 s_waitcnt lgkmcnt(10)
 buffer_load_dwordx4 v15, s[20:23], s57 offen offset:1152 lds
 v_mfma_f32_16x16x32_bf16 v[32:35], a[96:99], a[16:19], v[32:35]
 ds_read_b128 a[92:95], v5 offset:38912
 v_mfma_f32_16x16x32_bf16 v[32:35], a[100:103], a[20:23], v[32:35]
 v_mfma_f32_16x16x32_bf16 v[36:39], a[108:111], a[20:23], v[36:39]
 s_add_u32 m0, s33, 0xe80
 ds_read_b128 a[88:91], v4 offset:38912
 v_mfma_f32_16x16x32_bf16 v[36:39], a[104:107], a[16:19], v[36:39]
 buffer_load_dwordx4 v15, s[20:23], 0 offen offset:384 lds
 v_mfma_f32_16x16x32_bf16 v[40:43], a[112:115], a[16:19], v[40:43]
 ds_read_b64_tr_b16 a[32:33], v10 offset:32768
 v_mfma_f32_16x16x32_bf16 v[40:43], a[116:119], a[20:23], v[40:43]
 ds_read_b64_tr_b16 a[34:35], v10 offset:36864
 v_mfma_f32_16x16x32_bf16 v[44:47], a[124:127], a[20:23], v[44:47]
 s_add_u32 m0, s33, 0xf00
 ds_read_b64_tr_b16 a[36:37], v10 offset:49152
 v_mfma_f32_16x16x32_bf16 v[44:47], a[120:123], a[16:19], v[44:47]
 s_waitcnt lgkmcnt(11)
 ds_read_b64_tr_b16 a[38:39], v10 offset:53248
 buffer_load_dwordx4 v15, s[20:23], 0 offen offset:1280 lds
 v_mfma_f32_16x16x32_bf16 v[52:55], a[120:123], a[24:27], v[52:55]
 ds_read_b64_tr_b16 a[40:41], v11 offset:32768
 v_mfma_f32_16x16x32_bf16 v[52:55], a[124:127], a[28:31], v[52:55]
 ds_read_b64_tr_b16 a[42:43], v11 offset:36864
 v_mfma_f32_16x16x32_bf16 v[48:51], a[116:119], a[28:31], v[48:51]
 s_add_u32 m0, s33, 0x1680
 ds_read_b64_tr_b16 a[44:45], v11 offset:49152
 v_mfma_f32_16x16x32_bf16 v[48:51], a[112:115], a[24:27], v[48:51]
 ds_read_b64_tr_b16 a[46:47], v11 offset:53248
 buffer_load_dwordx4 v15, s[20:23], s57 offen offset:384 lds
 v_mfma_f32_16x16x32_bf16 v[60:63], a[104:107], a[24:27], v[60:63]
 ds_read_b64_tr_b16 a[48:49], v12 offset:32768
 v_mfma_f32_16x16x32_bf16 v[60:63], a[108:111], a[28:31], v[60:63]
 ds_read_b64_tr_b16 a[50:51], v12 offset:36864
 v_mfma_f32_16x16x32_bf16 v[56:59], a[100:103], a[28:31], v[56:59]
 s_add_u32 m0, s33, 0x1700
 ds_read_b64_tr_b16 a[52:53], v12 offset:49152
 v_mfma_f32_16x16x32_bf16 v[56:59], a[96:99], a[24:27], v[56:59]
 s_waitcnt lgkmcnt(15)
 ds_read_b64_tr_b16 a[54:55], v12 offset:53248
 buffer_load_dwordx4 v15, s[20:23], s57 offen offset:1280 lds
 v_mfma_f32_16x16x32_bf16 v[64:67], a[64:67], a[0:3], v[64:67]
 ds_read_b64_tr_b16 a[56:57], v13 offset:32768
 v_mfma_f32_16x16x32_bf16 v[64:67], a[68:71], a[4:7], v[64:67]
 ds_read_b64_tr_b16 a[58:59], v13 offset:36864
 v_mfma_f32_16x16x32_bf16 v[68:71], a[76:79], a[4:7], v[68:71]
 ds_read_b64_tr_b16 a[60:61], v13 offset:49152
 v_mfma_f32_16x16x32_bf16 v[68:71], a[72:75], a[0:3], v[68:71]
 s_waitcnt lgkmcnt(15)
 ds_read_b64_tr_b16 a[62:63], v13 offset:53248
 v_mfma_f32_16x16x32_bf16 v[72:75], a[80:83], a[0:3], v[72:75]
 v_mfma_f32_16x16x32_bf16 v[72:75], a[84:87], a[4:7], v[72:75]
 v_mfma_f32_16x16x32_bf16 v[76:79], a[92:95], a[4:7], v[76:79]
 v_mfma_f32_16x16x32_bf16 v[76:79], a[88:91], a[0:3], v[76:79]
 s_waitcnt lgkmcnt(0)
 v_mfma_f32_16x16x32_bf16 v[84:87], a[88:91], a[8:11], v[84:87]
 s_barrier
 v_mfma_f32_16x16x32_bf16 v[84:87], a[92:95], a[12:15], v[84:87]
 s_add_u32 m0, s29, 98304
 v_mfma_f32_16x16x32_bf16 v[80:83], a[84:87], a[12:15], v[80:83]
 buffer_load_dwordx4 v2, s[8:11], 0 offen  lds
 v_mfma_f32_16x16x32_bf16 v[80:83], a[80:83], a[8:11], v[80:83]
 v_mfma_f32_16x16x32_bf16 v[92:95], a[72:75], a[8:11], v[92:95]
 v_mfma_f32_16x16x32_bf16 v[92:95], a[76:79], a[12:15], v[92:95]
 v_mfma_f32_16x16x32_bf16 v[88:91], a[68:71], a[12:15], v[88:91]
 s_add_u32 m0, s29, 32768
 v_mfma_f32_16x16x32_bf16 v[88:91], a[64:67], a[8:11], v[88:91]
 buffer_load_dwordx4 v1, s[4:7], 0 offen  lds
 v_mfma_f32_16x16x32_bf16 v[96:99], a[64:67], a[16:19], v[96:99]
 v_mfma_f32_16x16x32_bf16 v[96:99], a[68:71], a[20:23], v[96:99]
 v_mfma_f32_16x16x32_bf16 v[100:103], a[76:79], a[20:23], v[100:103]
 v_mfma_f32_16x16x32_bf16 v[100:103], a[72:75], a[16:19], v[100:103]
 s_add_u32 m0, s29, 102400
 v_mfma_f32_16x16x32_bf16 v[104:107], a[80:83], a[16:19], v[104:107]
 buffer_load_dwordx4 v2, s[8:11], s48 offen  lds
 v_mfma_f32_16x16x32_bf16 v[104:107], a[84:87], a[20:23], v[104:107]
 v_mfma_f32_16x16x32_bf16 v[108:111], a[92:95], a[20:23], v[108:111]
 v_mfma_f32_16x16x32_bf16 v[108:111], a[88:91], a[16:19], v[108:111]
 v_mfma_f32_16x16x32_bf16 v[116:119], a[88:91], a[24:27], v[116:119]
 s_add_u32 m0, s29, 36864
 v_mfma_f32_16x16x32_bf16 v[116:119], a[92:95], a[28:31], v[116:119]
 buffer_load_dwordx4 v1, s[4:7], s41 offen  lds
 v_mfma_f32_16x16x32_bf16 v[112:115], a[84:87], a[28:31], v[112:115]
 v_mfma_f32_16x16x32_bf16 v[112:115], a[80:83], a[24:27], v[112:115]
 v_mfma_f32_16x16x32_bf16 v[124:127], a[72:75], a[24:27], v[124:127]
 v_mfma_f32_16x16x32_bf16 v[124:127], a[76:79], a[28:31], v[124:127]
 s_add_u32 m0, s29, 106496
 v_mfma_f32_16x16x32_bf16 v[120:123], a[68:71], a[28:31], v[120:123]
 buffer_load_dwordx4 v2, s[8:11], s49 offen  lds
 v_mfma_f32_16x16x32_bf16 v[120:123], a[64:67], a[24:27], v[120:123]
 v_mfma_f32_16x16x32_bf16 v[128:131], a[64:67], a[32:35], v[128:131]
 v_mfma_f32_16x16x32_bf16 v[128:131], a[68:71], a[36:39], v[128:131]
 v_mfma_f32_16x16x32_bf16 v[132:135], a[76:79], a[36:39], v[132:135]
 s_add_u32 m0, s29, 40960
 v_mfma_f32_16x16x32_bf16 v[132:135], a[72:75], a[32:35], v[132:135]
 buffer_load_dwordx4 v1, s[4:7], s42 offen  lds
 v_mfma_f32_16x16x32_bf16 v[136:139], a[80:83], a[32:35], v[136:139]
 v_mfma_f32_16x16x32_bf16 v[136:139], a[84:87], a[36:39], v[136:139]
 v_mfma_f32_16x16x32_bf16 v[140:143], a[92:95], a[36:39], v[140:143]
 v_mfma_f32_16x16x32_bf16 v[140:143], a[88:91], a[32:35], v[140:143]
 s_add_u32 m0, s29, 110592
 v_mfma_f32_16x16x32_bf16 v[148:151], a[88:91], a[40:43], v[148:151]
 buffer_load_dwordx4 v2, s[8:11], s50 offen  lds
 v_mfma_f32_16x16x32_bf16 v[148:151], a[92:95], a[44:47], v[148:151]
 v_mfma_f32_16x16x32_bf16 v[144:147], a[84:87], a[44:47], v[144:147]
 v_mfma_f32_16x16x32_bf16 v[144:147], a[80:83], a[40:43], v[144:147]
 v_mfma_f32_16x16x32_bf16 v[156:159], a[72:75], a[40:43], v[156:159]
 s_add_u32 m0, s29, 45056
 v_mfma_f32_16x16x32_bf16 v[156:159], a[76:79], a[44:47], v[156:159]
 buffer_load_dwordx4 v1, s[4:7], s43 offen  lds
 v_mfma_f32_16x16x32_bf16 v[152:155], a[68:71], a[44:47], v[152:155]
 v_mfma_f32_16x16x32_bf16 v[152:155], a[64:67], a[40:43], v[152:155]
 v_mfma_f32_16x16x32_bf16 v[160:163], a[64:67], a[48:51], v[160:163]
 v_mfma_f32_16x16x32_bf16 v[160:163], a[68:71], a[52:55], v[160:163]
 s_add_u32 m0, s29, 114688
 v_mfma_f32_16x16x32_bf16 v[164:167], a[76:79], a[52:55], v[164:167]
 buffer_load_dwordx4 v2, s[8:11], s51 offen  lds
 v_mfma_f32_16x16x32_bf16 v[164:167], a[72:75], a[48:51], v[164:167]
 v_mfma_f32_16x16x32_bf16 v[168:171], a[80:83], a[48:51], v[168:171]
 v_mfma_f32_16x16x32_bf16 v[168:171], a[84:87], a[52:55], v[168:171]
 v_mfma_f32_16x16x32_bf16 v[172:175], a[92:95], a[52:55], v[172:175]
 s_add_u32 m0, s29, 49152
 v_mfma_f32_16x16x32_bf16 v[172:175], a[88:91], a[48:51], v[172:175]
 buffer_load_dwordx4 v1, s[4:7], s44 offen  lds
 v_mfma_f32_16x16x32_bf16 v[180:183], a[88:91], a[56:59], v[180:183]
 v_mfma_f32_16x16x32_bf16 v[180:183], a[92:95], a[60:63], v[180:183]
 v_mfma_f32_16x16x32_bf16 v[176:179], a[84:87], a[60:63], v[176:179]
 v_mfma_f32_16x16x32_bf16 v[176:179], a[80:83], a[56:59], v[176:179]
 s_add_u32 m0, s29, 118784
 v_mfma_f32_16x16x32_bf16 v[188:191], a[72:75], a[56:59], v[188:191]
 s_waitcnt vmcnt(10)
 buffer_load_dwordx4 v2, s[8:11], s52 offen  lds
 v_mfma_f32_16x16x32_bf16 v[188:191], a[76:79], a[60:63], v[188:191]
 s_barrier
 ds_read_b64_tr_b16 a[0:1], v6 offset:0
 v_mfma_f32_16x16x32_bf16 v[184:187], a[68:71], a[60:63], v[184:187]
 ds_read_b64_tr_b16 a[2:3], v6 offset:4096
 v_mfma_f32_16x16x32_bf16 v[184:187], a[64:67], a[56:59], v[184:187]
 ds_read_b128 a[64:67], v4 offset:0
 v_mfma_f32_16x16x32_bf16 v[192:195], a[96:99], a[32:35], v[192:195]
 s_add_u32 m0, s29, 53248
 ds_read_b128 a[160:163], v14 offset:0
 v_mfma_f32_16x16x32_bf16 v[192:195], a[100:103], a[36:39], v[192:195]
 buffer_load_dwordx4 v1, s[4:7], s45 offen  lds
 v_mfma_f32_16x16x32_bf16 v[196:199], a[108:111], a[36:39], v[196:199]
 ds_read_b64_tr_b16 a[4:5], v6 offset:16384
 v_mfma_f32_16x16x32_bf16 v[196:199], a[104:107], a[32:35], v[196:199]
 ds_read_b64_tr_b16 a[6:7], v6 offset:20480
 v_mfma_f32_16x16x32_bf16 v[200:203], a[112:115], a[32:35], v[200:203]
 ds_read_b128 a[68:71], v5 offset:0
 v_mfma_f32_16x16x32_bf16 v[200:203], a[116:119], a[36:39], v[200:203]
 s_add_u32 m0, s29, 122880
 ds_read_b128 a[168:171], v3 offset:0
 v_mfma_f32_16x16x32_bf16 v[204:207], a[124:127], a[36:39], v[204:207]
 buffer_load_dwordx4 v2, s[8:11], s53 offen  lds
 v_mfma_f32_16x16x32_bf16 v[204:207], a[120:123], a[32:35], v[204:207]
 ds_read_b128 a[76:79], v5 offset:2048
 v_mfma_f32_16x16x32_bf16 v[212:215], a[120:123], a[40:43], v[212:215]
 ds_read_b128 a[164:167], v14 offset:2048
 v_mfma_f32_16x16x32_bf16 v[212:215], a[124:127], a[44:47], v[212:215]
 ds_read_b128 a[72:75], v4 offset:2048
 v_mfma_f32_16x16x32_bf16 v[208:211], a[116:119], a[44:47], v[208:211]
 s_add_u32 m0, s29, 57344
 ds_read_b128 a[172:175], v3 offset:2048
 v_mfma_f32_16x16x32_bf16 v[208:211], a[112:115], a[40:43], v[208:211]
 buffer_load_dwordx4 v1, s[4:7], s46 offen  lds
 v_mfma_f32_16x16x32_bf16 v[220:223], a[104:107], a[40:43], v[220:223]
 ds_read_b128 a[80:83], v4 offset:4096
 v_mfma_f32_16x16x32_bf16 v[220:223], a[108:111], a[44:47], v[220:223]
 ds_read_b128 a[176:179], v14 offset:4096
 v_mfma_f32_16x16x32_bf16 v[216:219], a[100:103], a[44:47], v[216:219]
 ds_read_b128 a[84:87], v5 offset:4096
 v_mfma_f32_16x16x32_bf16 v[216:219], a[96:99], a[40:43], v[216:219]
 s_add_u32 m0, s29, 126976
 ds_read_b128 a[184:187], v3 offset:4096
 v_mfma_f32_16x16x32_bf16 v[224:227], a[96:99], a[48:51], v[224:227]
 buffer_load_dwordx4 v2, s[8:11], s54 offen  lds
 v_mfma_f32_16x16x32_bf16 v[224:227], a[100:103], a[52:55], v[224:227]
 ds_read_b128 a[92:95], v5 offset:6144
 v_mfma_f32_16x16x32_bf16 v[228:231], a[108:111], a[52:55], v[228:231]
 ds_read_b128 a[180:183], v14 offset:6144
 v_mfma_f32_16x16x32_bf16 v[228:231], a[104:107], a[48:51], v[228:231]
 ds_read_b128 a[88:91], v4 offset:6144
 v_mfma_f32_16x16x32_bf16 v[232:235], a[112:115], a[48:51], v[232:235]
 s_add_u32 m0, s29, 61440
 ds_read_b128 a[188:191], v3 offset:6144
 v_mfma_f32_16x16x32_bf16 v[232:235], a[116:119], a[52:55], v[232:235]
 buffer_load_dwordx4 v1, s[4:7], s47 offen  lds
 v_mfma_f32_16x16x32_bf16 v[236:239], a[124:127], a[52:55], v[236:239]
 v_add_u32 v1, 128, v1
 v_add_u32 v2, 0x80000, v2
 v_mfma_f32_16x16x32_bf16 v[236:239], a[120:123], a[48:51], v[236:239]
 ds_read_b64_tr_b16 a[8:9], v7 offset:0
 v_mfma_f32_16x16x32_bf16 v[244:247], a[120:123], a[56:59], v[244:247]
 v_mfma_f32_16x16x32_bf16 v[244:247], a[124:127], a[60:63], v[244:247]
 ds_read_b64_tr_b16 a[10:11], v7 offset:4096
 v_mfma_f32_16x16x32_bf16 v[240:243], a[116:119], a[60:63], v[240:243]
 ds_read_b64_tr_b16 a[12:13], v7 offset:16384
 v_mfma_f32_16x16x32_bf16 v[240:243], a[112:115], a[56:59], v[240:243]
 ds_read_b64_tr_b16 a[14:15], v7 offset:20480
 v_mfma_f32_16x16x32_bf16 v[252:255], a[104:107], a[56:59], v[252:255]
 ds_read_b64_tr_b16 a[16:17], v8 offset:0
 v_mfma_f32_16x16x32_bf16 v[252:255], a[108:111], a[60:63], v[252:255]
 ds_read_b64_tr_b16 a[18:19], v8 offset:4096
 v_mfma_f32_16x16x32_bf16 v[248:251], a[100:103], a[60:63], v[248:251]
 ds_read_b64_tr_b16 a[20:21], v8 offset:16384
 v_mfma_f32_16x16x32_bf16 v[248:251], a[96:99], a[56:59], v[248:251]
 s_waitcnt lgkmcnt(15)
 ds_read_b64_tr_b16 a[22:23], v8 offset:20480
 v_mfma_f32_16x16x32_bf16 v[64:67], a[64:67], a[0:3], v[64:67]
 ds_read_b64_tr_b16 a[24:25], v9 offset:0
 v_lshlrev_b32 v1, 4, v0
 v_mfma_f32_16x16x32_bf16 v[64:67], a[68:71], a[4:7], v[64:67]
 s_add_u32 m0, s33, 0xfffffe00
 ds_read_b64_tr_b16 a[26:27], v9 offset:4096
 v_mfma_f32_16x16x32_bf16 v[68:71], a[76:79], a[4:7], v[68:71]
 s_waitcnt lgkmcnt(10)
 ds_read_b64_tr_b16 a[28:29], v9 offset:16384
 v_mfma_f32_16x16x32_bf16 v[68:71], a[72:75], a[0:3], v[68:71]
 ds_read_b64_tr_b16 a[30:31], v9 offset:20480
 buffer_load_dwordx4 v15, s[20:23], 0 offen offset:512 lds
 v_mfma_f32_16x16x32_bf16 v[72:75], a[80:83], a[0:3], v[72:75]
 ds_read_b128 a[96:99], v4 offset:8192
 v_mfma_f32_16x16x32_bf16 v[72:75], a[84:87], a[4:7], v[72:75]
 v_mfma_f32_16x16x32_bf16 v[76:79], a[92:95], a[4:7], v[76:79]
 s_add_u32 m0, s33, 0xfffffe80
 ds_read_b128 a[100:103], v5 offset:8192
 v_mfma_f32_16x16x32_bf16 v[76:79], a[88:91], a[0:3], v[76:79]
 s_waitcnt lgkmcnt(10)
 buffer_load_dwordx4 v15, s[20:23], 0 offen offset:1408 lds
 v_mfma_f32_16x16x32_bf16 v[84:87], a[88:91], a[8:11], v[84:87]
 ds_read_b128 a[108:111], v5 offset:10240
 v_mfma_f32_16x16x32_bf16 v[84:87], a[92:95], a[12:15], v[84:87]
 v_mfma_f32_16x16x32_bf16 v[80:83], a[84:87], a[12:15], v[80:83]
 s_add_u32 m0, s33, 0x600
 ds_read_b128 a[104:107], v4 offset:10240
 v_mfma_f32_16x16x32_bf16 v[80:83], a[80:83], a[8:11], v[80:83]
 buffer_load_dwordx4 v15, s[20:23], s57 offen offset:512 lds
 v_mfma_f32_16x16x32_bf16 v[92:95], a[72:75], a[8:11], v[92:95]
 ds_read_b128 a[112:115], v4 offset:12288
 v_mfma_f32_16x16x32_bf16 v[92:95], a[76:79], a[12:15], v[92:95]
 v_mfma_f32_16x16x32_bf16 v[88:91], a[68:71], a[12:15], v[88:91]
 s_add_u32 m0, s33, 0x680
 ds_read_b128 a[116:119], v5 offset:12288
 v_mfma_f32_16x16x32_bf16 v[88:91], a[64:67], a[8:11], v[88:91]
 s_waitcnt lgkmcnt(10)
 buffer_load_dwordx4 v15, s[20:23], s57 offen offset:1408 lds
 v_mfma_f32_16x16x32_bf16 v[96:99], a[64:67], a[16:19], v[96:99]
 ds_read_b128 a[124:127], v5 offset:14336
 v_mfma_f32_16x16x32_bf16 v[96:99], a[68:71], a[20:23], v[96:99]
 v_mfma_f32_16x16x32_bf16 v[100:103], a[76:79], a[20:23], v[100:103]
 s_add_u32 m0, s33, 0xd80
 ds_read_b128 a[120:123], v4 offset:14336
 v_mfma_f32_16x16x32_bf16 v[100:103], a[72:75], a[16:19], v[100:103]
 buffer_load_dwordx4 v15, s[20:23], 0 offen offset:640 lds
 v_mfma_f32_16x16x32_bf16 v[104:107], a[80:83], a[16:19], v[104:107]
 ds_read_b64_tr_b16 a[32:33], v10 offset:0
 v_mfma_f32_16x16x32_bf16 v[104:107], a[84:87], a[20:23], v[104:107]
 ds_read_b64_tr_b16 a[34:35], v10 offset:4096
 v_mfma_f32_16x16x32_bf16 v[108:111], a[92:95], a[20:23], v[108:111]
 s_add_u32 m0, s33, 0xe00
 ds_read_b64_tr_b16 a[36:37], v10 offset:16384
 v_mfma_f32_16x16x32_bf16 v[108:111], a[88:91], a[16:19], v[108:111]
 s_waitcnt lgkmcnt(11)
 ds_read_b64_tr_b16 a[38:39], v10 offset:20480
 buffer_load_dwordx4 v15, s[20:23], 0 offen offset:1536 lds
 v_mfma_f32_16x16x32_bf16 v[116:119], a[88:91], a[24:27], v[116:119]
 ds_read_b64_tr_b16 a[40:41], v11 offset:0
 v_mfma_f32_16x16x32_bf16 v[116:119], a[92:95], a[28:31], v[116:119]
 ds_read_b64_tr_b16 a[42:43], v11 offset:4096
 v_mfma_f32_16x16x32_bf16 v[112:115], a[84:87], a[28:31], v[112:115]
 s_add_u32 m0, s33, 0x1580
 ds_read_b64_tr_b16 a[44:45], v11 offset:16384
 v_mfma_f32_16x16x32_bf16 v[112:115], a[80:83], a[24:27], v[112:115]
 ds_read_b64_tr_b16 a[46:47], v11 offset:20480
 buffer_load_dwordx4 v15, s[20:23], s57 offen offset:640 lds
 v_mfma_f32_16x16x32_bf16 v[124:127], a[72:75], a[24:27], v[124:127]
 ds_read_b64_tr_b16 a[48:49], v12 offset:0
 v_mfma_f32_16x16x32_bf16 v[124:127], a[76:79], a[28:31], v[124:127]
 ds_read_b64_tr_b16 a[50:51], v12 offset:4096
 v_mfma_f32_16x16x32_bf16 v[120:123], a[68:71], a[28:31], v[120:123]
 s_add_u32 m0, s33, 0x1600
 ds_read_b64_tr_b16 a[52:53], v12 offset:16384
 v_mfma_f32_16x16x32_bf16 v[120:123], a[64:67], a[24:27], v[120:123]
 s_waitcnt lgkmcnt(15)
 ds_read_b64_tr_b16 a[54:55], v12 offset:20480
 buffer_load_dwordx4 v15, s[20:23], s57 offen offset:1536 lds
 v_mfma_f32_16x16x32_bf16 v[16:19], a[96:99], a[0:3], v[16:19]
 ds_read_b64_tr_b16 a[56:57], v13 offset:0
 v_mfma_f32_16x16x32_bf16 v[16:19], a[100:103], a[4:7], v[16:19]
 ds_read_b64_tr_b16 a[58:59], v13 offset:4096
 v_mfma_f32_16x16x32_bf16 v[20:23], a[108:111], a[4:7], v[20:23]
 ds_read_b64_tr_b16 a[60:61], v13 offset:16384
 v_mfma_f32_16x16x32_bf16 v[20:23], a[104:107], a[0:3], v[20:23]
 s_waitcnt lgkmcnt(15)
 ds_read_b64_tr_b16 a[62:63], v13 offset:20480
 v_mfma_f32_16x16x32_bf16 v[24:27], a[112:115], a[0:3], v[24:27]
 v_mfma_f32_16x16x32_bf16 v[24:27], a[116:119], a[4:7], v[24:27]
 v_mfma_f32_16x16x32_bf16 v[28:31], a[124:127], a[4:7], v[28:31]
 v_mfma_f32_16x16x32_bf16 v[28:31], a[120:123], a[0:3], v[28:31]
 s_waitcnt lgkmcnt(0)
 v_mfma_f32_16x16x32_bf16 a[228:231], a[120:123], a[8:11], a[228:231]
 s_barrier
 v_mfma_f32_16x16x32_bf16 a[228:231], a[124:127], a[12:15], a[228:231]
 s_add_u32 m0, s29, 0
 v_add_u32 v2, 0xff800000, v2
 v_mfma_f32_16x16x32_bf16 a[224:227], a[116:119], a[12:15], a[224:227]
 buffer_load_dwordx4 v2, s[16:19], 0 offen lds
 v_mfma_f32_16x16x32_bf16 a[224:227], a[112:115], a[8:11], a[224:227]
 v_mfma_f32_16x16x32_bf16 a[236:239], a[104:107], a[8:11], a[236:239]
 v_mfma_f32_16x16x32_bf16 a[236:239], a[108:111], a[12:15], a[236:239]
 v_mfma_f32_16x16x32_bf16 a[232:235], a[100:103], a[12:15], a[232:235]
 s_add_u32 m0, s29, 4096
 v_mfma_f32_16x16x32_bf16 a[232:235], a[96:99], a[8:11], a[232:235]
 buffer_load_dwordx4 v2, s[16:19], s48 offen lds
 v_mfma_f32_16x16x32_bf16 v[32:35], a[96:99], a[16:19], v[32:35]
 v_mfma_f32_16x16x32_bf16 v[32:35], a[100:103], a[20:23], v[32:35]
 v_mfma_f32_16x16x32_bf16 v[36:39], a[108:111], a[20:23], v[36:39]
 v_mfma_f32_16x16x32_bf16 v[36:39], a[104:107], a[16:19], v[36:39]
 s_add_u32 m0, s29, 8192
 v_mfma_f32_16x16x32_bf16 v[40:43], a[112:115], a[16:19], v[40:43]
 buffer_load_dwordx4 v2, s[16:19], s49 offen lds
 v_mfma_f32_16x16x32_bf16 v[40:43], a[116:119], a[20:23], v[40:43]
 v_mfma_f32_16x16x32_bf16 v[44:47], a[124:127], a[20:23], v[44:47]
 v_mfma_f32_16x16x32_bf16 v[44:47], a[120:123], a[16:19], v[44:47]
 v_mfma_f32_16x16x32_bf16 v[52:55], a[120:123], a[24:27], v[52:55]
 s_add_u32 m0, s29, 12288
 v_mfma_f32_16x16x32_bf16 v[52:55], a[124:127], a[28:31], v[52:55]
 buffer_load_dwordx4 v2, s[16:19], s50 offen lds
 v_mfma_f32_16x16x32_bf16 v[48:51], a[116:119], a[28:31], v[48:51]
 v_mfma_f32_16x16x32_bf16 v[48:51], a[112:115], a[24:27], v[48:51]
 v_mfma_f32_16x16x32_bf16 v[60:63], a[104:107], a[24:27], v[60:63]
 v_mfma_f32_16x16x32_bf16 v[60:63], a[108:111], a[28:31], v[60:63]
 s_add_u32 m0, s29, 16384
 v_mfma_f32_16x16x32_bf16 v[56:59], a[100:103], a[28:31], v[56:59]
 buffer_load_dwordx4 v2, s[16:19], s51 offen lds
 v_mfma_f32_16x16x32_bf16 v[56:59], a[96:99], a[24:27], v[56:59]
 v_mfma_f32_16x16x32_bf16 v[192:195], a[96:99], a[32:35], v[192:195]
 v_mfma_f32_16x16x32_bf16 v[192:195], a[100:103], a[36:39], v[192:195]
 v_mfma_f32_16x16x32_bf16 v[196:199], a[108:111], a[36:39], v[196:199]
 s_add_u32 m0, s29, 20480
 v_mfma_f32_16x16x32_bf16 v[196:199], a[104:107], a[32:35], v[196:199]
 buffer_load_dwordx4 v2, s[16:19], s52 offen lds
 v_mfma_f32_16x16x32_bf16 v[200:203], a[112:115], a[32:35], v[200:203]
 v_mfma_f32_16x16x32_bf16 v[200:203], a[116:119], a[36:39], v[200:203]
 v_mfma_f32_16x16x32_bf16 v[204:207], a[124:127], a[36:39], v[204:207]
 v_mfma_f32_16x16x32_bf16 v[204:207], a[120:123], a[32:35], v[204:207]
 s_add_u32 m0, s29, 24576
 v_mfma_f32_16x16x32_bf16 v[212:215], a[120:123], a[40:43], v[212:215]
 buffer_load_dwordx4 v2, s[16:19], s53 offen lds
 v_mfma_f32_16x16x32_bf16 v[212:215], a[124:127], a[44:47], v[212:215]
 v_mfma_f32_16x16x32_bf16 v[208:211], a[116:119], a[44:47], v[208:211]
 v_mfma_f32_16x16x32_bf16 v[208:211], a[112:115], a[40:43], v[208:211]
 v_mfma_f32_16x16x32_bf16 v[220:223], a[104:107], a[40:43], v[220:223]
 s_add_u32 m0, s29, 28672
 v_mfma_f32_16x16x32_bf16 v[220:223], a[108:111], a[44:47], v[220:223]
 buffer_load_dwordx4 v2, s[16:19], s54 offen lds
 v_mfma_f32_16x16x32_bf16 v[216:219], a[100:103], a[44:47], v[216:219]
 v_mfma_f32_16x16x32_bf16 v[216:219], a[96:99], a[40:43], v[216:219]
 v_mfma_f32_16x16x32_bf16 v[224:227], a[96:99], a[48:51], v[224:227]
 s_add_u32 m0, s29, 65536
 v_add_u32 v2, 0x80000, v2
 v_mfma_f32_16x16x32_bf16 v[224:227], a[100:103], a[52:55], v[224:227]
 buffer_load_dwordx4 v2, s[16:19], 0 offen lds
 v_mfma_f32_16x16x32_bf16 v[228:231], a[108:111], a[52:55], v[228:231]
 v_mfma_f32_16x16x32_bf16 v[228:231], a[104:107], a[48:51], v[228:231]
 v_mfma_f32_16x16x32_bf16 v[232:235], a[112:115], a[48:51], v[232:235]
 v_mfma_f32_16x16x32_bf16 v[232:235], a[116:119], a[52:55], v[232:235]
 s_add_u32 m0, s29, 69632
 v_mfma_f32_16x16x32_bf16 v[236:239], a[124:127], a[52:55], v[236:239]
 buffer_load_dwordx4 v2, s[16:19], s48 offen lds
 v_mfma_f32_16x16x32_bf16 v[236:239], a[120:123], a[48:51], v[236:239]
 v_mfma_f32_16x16x32_bf16 v[244:247], a[120:123], a[56:59], v[244:247]
 v_mfma_f32_16x16x32_bf16 v[244:247], a[124:127], a[60:63], v[244:247]
 v_mfma_f32_16x16x32_bf16 v[240:243], a[116:119], a[60:63], v[240:243]
 s_add_u32 m0, s29, 73728
 v_mfma_f32_16x16x32_bf16 v[240:243], a[112:115], a[56:59], v[240:243]
 buffer_load_dwordx4 v2, s[16:19], s49 offen lds
 v_mfma_f32_16x16x32_bf16 v[252:255], a[104:107], a[56:59], v[252:255]
 s_waitcnt vmcnt(11)
 v_mfma_f32_16x16x32_bf16 v[252:255], a[108:111], a[60:63], v[252:255]
 s_barrier
 ds_read_b64_tr_b16 a[0:1], v6 offset:32768
 v_mfma_f32_16x16x32_bf16 v[248:251], a[100:103], a[60:63], v[248:251]
 ds_read_b64_tr_b16 a[2:3], v6 offset:36864
 v_mfma_f32_16x16x32_bf16 v[248:251], a[96:99], a[56:59], v[248:251]
 s_add_u32 m0, s29, 77824
 ds_read_b128 a[96:99], v4 offset:40960
 v_mfma_f32_16x16x32_bf16 v[128:131], a[64:67], a[32:35], v[128:131]
 ds_read_b128 a[192:195], v14 offset:0
 buffer_load_dwordx4 v2, s[16:19], s50 offen lds
 v_mfma_f32_16x16x32_bf16 v[128:131], a[68:71], a[36:39], v[128:131]
 ds_read_b128 a[200:203], v3 offset:0
 v_mfma_f32_16x16x32_bf16 v[132:135], a[76:79], a[36:39], v[132:135]
 s_mov_b32 s56, s58
 ds_read_b64_tr_b16 a[4:5], v6 offset:49152
 v_mfma_f32_16x16x32_bf16 v[132:135], a[72:75], a[32:35], v[132:135]
 ds_read_b64_tr_b16 a[6:7], v6 offset:53248
 v_mfma_f32_16x16x32_bf16 v[136:139], a[80:83], a[32:35], v[136:139]
 s_add_u32 m0, s29, 81920
 ds_read_b128 a[100:103], v5 offset:40960
 v_mfma_f32_16x16x32_bf16 v[136:139], a[84:87], a[36:39], v[136:139]
 ds_read_b128 a[196:199], v14 offset:2048
 buffer_load_dwordx4 v2, s[16:19], s51 offen lds
 v_mfma_f32_16x16x32_bf16 v[140:143], a[92:95], a[36:39], v[140:143]
 ds_read_b128 a[204:207], v3 offset:2048
 v_mfma_f32_16x16x32_bf16 v[140:143], a[88:91], a[32:35], v[140:143]
 ds_read_b128 a[108:111], v5 offset:43008
 v_mfma_f32_16x16x32_bf16 v[148:151], a[88:91], a[40:43], v[148:151]
 ds_read_b128 a[208:211], v14 offset:4096
 v_mfma_f32_16x16x32_bf16 v[148:151], a[92:95], a[44:47], v[148:151]
 s_add_u32 m0, s29, 86016
 ds_read_b128 a[104:107], v4 offset:43008
 v_mfma_f32_16x16x32_bf16 v[144:147], a[84:87], a[44:47], v[144:147]
 ds_read_b128 a[216:219], v3 offset:4096
 buffer_load_dwordx4 v2, s[16:19], s52 offen lds
 v_mfma_f32_16x16x32_bf16 v[144:147], a[80:83], a[40:43], v[144:147]
 ds_read_b128 a[212:215], v14 offset:6144
 v_mfma_f32_16x16x32_bf16 v[156:159], a[72:75], a[40:43], v[156:159]
 s_cmp_lt_u32 s25, 4
 s_cselect_b32 s1, 2.0, s92
 ds_read_b128 a[112:115], v4 offset:45056
 v_mfma_f32_16x16x32_bf16 v[156:159], a[76:79], a[44:47], v[156:159]
 ds_read_b128 a[220:223], v3 offset:6144
 v_mfma_f32_16x16x32_bf16 v[152:155], a[68:71], a[44:47], v[152:155]
 s_add_u32 m0, s29, 90112
 ds_read_b128 a[116:119], v5 offset:45056
 v_mfma_f32_16x16x32_bf16 v[152:155], a[64:67], a[40:43], v[152:155]
 buffer_load_dwordx4 v2, s[16:19], s53 offen lds
 v_mfma_f32_16x16x32_bf16 v[160:163], a[64:67], a[48:51], v[160:163]
 v_mfma_f32_16x16x32_bf16 v[160:163], a[68:71], a[52:55], v[160:163]
 ds_read_b128 a[124:127], v5 offset:47104
 v_mfma_f32_16x16x32_bf16 v[164:167], a[76:79], a[52:55], v[164:167]
 v_mfma_f32_16x16x32_bf16 v[164:167], a[72:75], a[48:51], v[164:167]
 s_add_u32 m0, s29, 94208
 ds_read_b128 a[120:123], v4 offset:47104
 v_mfma_f32_16x16x32_bf16 v[168:171], a[80:83], a[48:51], v[168:171]
 buffer_load_dwordx4 v2, s[16:19], s54 offen lds
 v_mfma_f32_16x16x32_bf16 v[168:171], a[84:87], a[52:55], v[168:171]
 v_mfma_f32_16x16x32_bf16 v[172:175], a[92:95], a[52:55], v[172:175]
 v_mfma_f32_16x16x32_bf16 v[172:175], a[88:91], a[48:51], v[172:175]
 ds_read_b64_tr_b16 a[8:9], v7 offset:32768
 v_mfma_f32_16x16x32_bf16 v[180:183], a[88:91], a[56:59], v[180:183]
 v_mfma_f32_16x16x32_bf16 v[180:183], a[92:95], a[60:63], v[180:183]
 ds_read_b64_tr_b16 a[10:11], v7 offset:36864
 v_mfma_f32_16x16x32_bf16 v[176:179], a[84:87], a[60:63], v[176:179]
 ds_read_b64_tr_b16 a[12:13], v7 offset:49152
 v_mfma_f32_16x16x32_bf16 v[176:179], a[80:83], a[56:59], v[176:179]
 ds_read_b64_tr_b16 a[14:15], v7 offset:53248
 v_mfma_f32_16x16x32_bf16 v[188:191], a[72:75], a[56:59], v[188:191]
 ds_read_b64_tr_b16 a[16:17], v8 offset:32768
 v_mfma_f32_16x16x32_bf16 v[188:191], a[76:79], a[60:63], v[188:191]
 ds_read_b64_tr_b16 a[18:19], v8 offset:36864
 v_mfma_f32_16x16x32_bf16 v[184:187], a[68:71], a[60:63], v[184:187]
 ds_read_b64_tr_b16 a[20:21], v8 offset:49152
 v_mfma_f32_16x16x32_bf16 v[184:187], a[64:67], a[56:59], v[184:187]
 s_waitcnt lgkmcnt(15)
 ds_read_b64_tr_b16 a[22:23], v8 offset:53248
 s_cmp_ge_u32 s25, 4
 s_cbranch_scc1 L_late1
 v_mfma_f32_16x16x32_bf16 v[16:19], a[96:99], a[0:3], v[16:19]
 ds_read_b64_tr_b16 a[24:25], v9 offset:32768
 v_mfma_f32_16x16x32_bf16 v[16:19], a[100:103], a[4:7], v[16:19]
 s_add_u32 m0, s33, 0xfffffd00
 ds_read_b64_tr_b16 a[26:27], v9 offset:36864
 v_mfma_f32_16x16x32_bf16 v[20:23], a[108:111], a[4:7], v[20:23]
 s_waitcnt lgkmcnt(13)
 ds_read_b64_tr_b16 a[28:29], v9 offset:49152
 v_mfma_f32_16x16x32_bf16 v[20:23], a[104:107], a[0:3], v[20:23]
 ds_read_b64_tr_b16 a[30:31], v9 offset:53248
 buffer_load_dwordx4 v15, s[20:23], 0 offen offset:768 lds
 v_mfma_f32_16x16x32_bf16 v[24:27], a[112:115], a[0:3], v[24:27]
 s_waitcnt lgkmcnt(12)
 ds_read_b128 a[64:67], v4 offset:32768
 v_mfma_f32_16x16x32_bf16 v[24:27], a[116:119], a[4:7], v[24:27]
 v_mfma_f32_16x16x32_bf16 v[28:31], a[124:127], a[4:7], v[28:31]
 s_add_u32 m0, s33, 0xfffffd80
 ds_read_b128 a[68:71], v5 offset:32768
 v_mfma_f32_16x16x32_bf16 v[28:31], a[120:123], a[0:3], v[28:31]
 s_waitcnt lgkmcnt(10)
 buffer_load_dwordx4 v15, s[20:23], 0 offen offset:1664 lds
 v_mfma_f32_16x16x32_bf16 a[228:231], a[120:123], a[8:11], a[228:231]
 ds_read_b128 a[76:79], v5 offset:34816
 v_mfma_f32_16x16x32_bf16 a[228:231], a[124:127], a[12:15], a[228:231]
 v_mfma_f32_16x16x32_bf16 a[224:227], a[116:119], a[12:15], a[224:227]
 s_add_u32 m0, s33, 0x500
 ds_read_b128 a[72:75], v4 offset:34816
 v_mfma_f32_16x16x32_bf16 a[224:227], a[112:115], a[8:11], a[224:227]
 buffer_load_dwordx4 v15, s[20:23], s57 offen offset:768 lds
 v_mfma_f32_16x16x32_bf16 a[236:239], a[104:107], a[8:11], a[236:239]
 ds_read_b128 a[80:83], v4 offset:36864
 v_cvt_pk_bf16_f32 v16, v16, v17
 v_mfma_f32_16x16x32_bf16 a[236:239], a[108:111], a[12:15], a[236:239]
 v_cvt_pk_bf16_f32 v17, v18, v19
 v_cvt_pk_bf16_f32 v18, v20, v21
 v_mfma_f32_16x16x32_bf16 a[232:235], a[100:103], a[12:15], a[232:235]
 s_add_u32 m0, s33, 0x580
 ds_read_b128 a[84:87], v5 offset:36864
 v_cvt_pk_bf16_f32 v19, v22, v23
 v_mfma_f32_16x16x32_bf16 a[232:235], a[96:99], a[8:11], a[232:235]
 s_waitcnt lgkmcnt(10)
 buffer_load_dwordx4 v15, s[20:23], s57 offen offset:1664 lds
 v_mfma_f32_16x16x32_bf16 v[32:35], a[96:99], a[16:19], v[32:35]
 ds_read_b128 a[92:95], v5 offset:38912
 v_cvt_pk_bf16_f32 v24, v24, v25
 v_mfma_f32_16x16x32_bf16 v[32:35], a[100:103], a[20:23], v[32:35]
 v_cvt_pk_bf16_f32 v25, v26, v27
 v_cvt_pk_bf16_f32 v26, v28, v29
 v_mfma_f32_16x16x32_bf16 v[36:39], a[108:111], a[20:23], v[36:39]
 ds_read_b128 a[88:91], v4 offset:38912
 v_cvt_pk_bf16_f32 v27, v30, v31
 v_mfma_f32_16x16x32_bf16 v[36:39], a[104:107], a[16:19], v[36:39]
 v_accvgpr_read_b32 v20, a224
 v_accvgpr_read_b32 v21, a225
 v_mfma_f32_16x16x32_bf16 v[40:43], a[112:115], a[16:19], v[40:43]
 ds_read_b64_tr_b16 a[32:33], v10 offset:32768
 v_accvgpr_read_b32 v22, a226
 v_mfma_f32_16x16x32_bf16 v[40:43], a[116:119], a[20:23], v[40:43]
 ds_read_b64_tr_b16 a[34:35], v10 offset:36864
 v_accvgpr_read_b32 v23, a227
 v_mfma_f32_16x16x32_bf16 v[44:47], a[124:127], a[20:23], v[44:47]
 s_add_u32 s59, s56, 32768
 ds_read_b64_tr_b16 a[36:37], v10 offset:49152
 v_accvgpr_read_b32 v28, a228
 v_mfma_f32_16x16x32_bf16 v[44:47], a[120:123], a[16:19], v[44:47]
 s_waitcnt lgkmcnt(11)
 ds_read_b64_tr_b16 a[38:39], v10 offset:53248
 v_accvgpr_read_b32 v29, a229
 v_mfma_f32_16x16x32_bf16 v[52:55], a[120:123], a[24:27], v[52:55]
 ds_read_b64_tr_b16 a[40:41], v11 offset:32768
 buffer_store_dwordx4 v[16:19], v1, s[12:15], s59 offen offset:0 sc1
 v_mfma_f32_16x16x32_bf16 v[52:55], a[124:127], a[28:31], v[52:55]
 ds_read_b64_tr_b16 a[42:43], v11 offset:36864
 v_accvgpr_read_b32 v30, a230
 v_mfma_f32_16x16x32_bf16 v[48:51], a[116:119], a[28:31], v[48:51]
 ds_read_b64_tr_b16 a[44:45], v11 offset:49152
 v_accvgpr_read_b32 v31, a231
 v_mfma_f32_16x16x32_bf16 v[48:51], a[112:115], a[24:27], v[48:51]
 ds_read_b64_tr_b16 a[46:47], v11 offset:53248
 v_cvt_pk_bf16_f32 v20, v20, v21
 v_mfma_f32_16x16x32_bf16 v[60:63], a[104:107], a[24:27], v[60:63]
 ds_read_b64_tr_b16 a[48:49], v12 offset:32768
 v_cvt_pk_bf16_f32 v21, v22, v23
 v_mfma_f32_16x16x32_bf16 v[60:63], a[108:111], a[28:31], v[60:63]
 ds_read_b64_tr_b16 a[50:51], v12 offset:36864
 v_cvt_pk_bf16_f32 v22, v28, v29
 v_mfma_f32_16x16x32_bf16 v[56:59], a[100:103], a[28:31], v[56:59]
 s_add_u32 s59, s56, 49152
 ds_read_b64_tr_b16 a[52:53], v12 offset:49152
 v_cvt_pk_bf16_f32 v23, v30, v31
 v_mfma_f32_16x16x32_bf16 v[56:59], a[96:99], a[24:27], v[56:59]
 s_waitcnt lgkmcnt(15)
 ds_read_b64_tr_b16 a[54:55], v12 offset:53248
 buffer_store_dwordx4 v[24:27], v1, s[12:15], s59 offen offset:0 sc1
 v_mfma_f32_16x16x32_bf16 v[64:67], a[64:67], a[0:3], v[64:67]
 ds_read_b64_tr_b16 a[56:57], v13 offset:32768
 v_cvt_pk_bf16_f32 v32, v32, v33
 v_mfma_f32_16x16x32_bf16 v[64:67], a[68:71], a[4:7], v[64:67]
 ds_read_b64_tr_b16 a[58:59], v13 offset:36864
 v_cvt_pk_bf16_f32 v33, v34, v35
 v_mfma_f32_16x16x32_bf16 v[68:71], a[76:79], a[4:7], v[68:71]
 ds_read_b64_tr_b16 a[60:61], v13 offset:49152
 v_cvt_pk_bf16_f32 v34, v36, v37
 v_mfma_f32_16x16x32_bf16 v[68:71], a[72:75], a[0:3], v[68:71]
 s_waitcnt lgkmcnt(15)
 ds_read_b64_tr_b16 a[62:63], v13 offset:53248
 v_cvt_pk_bf16_f32 v35, v38, v39
 v_mfma_f32_16x16x32_bf16 v[72:75], a[80:83], a[0:3], v[72:75]
 v_cvt_pk_bf16_f32 v40, v40, v41
 v_cvt_pk_bf16_f32 v41, v42, v43
 v_mfma_f32_16x16x32_bf16 v[72:75], a[84:87], a[4:7], v[72:75]
 s_add_u32 s59, s56, 49152
 v_cvt_pk_bf16_f32 v42, v44, v45
 v_cvt_pk_bf16_f32 v43, v46, v47
 v_mfma_f32_16x16x32_bf16 v[76:79], a[92:95], a[4:7], v[76:79]
 buffer_store_dwordx4 v[20:23], v1, s[12:15], s59 offen offset:1024 sc1
 v_mfma_f32_16x16x32_bf16 v[76:79], a[88:91], a[0:3], v[76:79]
 s_waitcnt lgkmcnt(0)
 v_accvgpr_read_b32 v36, a232
 v_accvgpr_read_b32 v37, a233
 v_mfma_f32_16x16x32_bf16 v[84:87], a[88:91], a[8:11], v[84:87]
 s_barrier
 v_xor_b32 v6, s60, v6
 v_accvgpr_read_b32 v38, a234
 v_mfma_f32_16x16x32_bf16 v[84:87], a[92:95], a[12:15], v[84:87]
 s_add_u32 m0, s29, 32768
 v_add_u32 v2, 0x80000, v2
 v_accvgpr_read_b32 v39, a235
 v_mfma_f32_16x16x32_bf16 v[80:83], a[84:87], a[12:15], v[80:83]
 buffer_load_dwordx4 v2, s[16:19], 0 offen lds
 v_mfma_f32_16x16x32_bf16 v[80:83], a[80:83], a[8:11], v[80:83]
 v_accvgpr_read_b32 v44, a236
 v_accvgpr_read_b32 v45, a237
 v_mfma_f32_16x16x32_bf16 v[92:95], a[72:75], a[8:11], v[92:95]
 s_add_u32 s59, s56, 32768
 v_accvgpr_read_b32 v46, a238
 v_accvgpr_read_b32 v47, a239
 v_mfma_f32_16x16x32_bf16 v[92:95], a[76:79], a[12:15], v[92:95]
 buffer_store_dwordx4 v[32:35], v1, s[12:15], s59 offen offset:2048 sc1
 v_mfma_f32_16x16x32_bf16 v[88:91], a[68:71], a[12:15], v[88:91]
 s_add_u32 m0, s29, 36864
 v_cvt_pk_bf16_f32 v36, v36, v37
 v_cvt_pk_bf16_f32 v37, v38, v39
 v_mfma_f32_16x16x32_bf16 v[88:91], a[64:67], a[8:11], v[88:91]
 buffer_load_dwordx4 v2, s[16:19], s48 offen lds
 v_mfma_f32_16x16x32_bf16 v[96:99], a[64:67], a[16:19], v[96:99]
 v_cvt_pk_bf16_f32 v38, v44, v45
 v_cvt_pk_bf16_f32 v39, v46, v47
 v_mfma_f32_16x16x32_bf16 v[96:99], a[68:71], a[20:23], v[96:99]
 v_cvt_pk_bf16_f32 v48, v48, v49
 v_cvt_pk_bf16_f32 v49, v50, v51
 v_mfma_f32_16x16x32_bf16 v[100:103], a[76:79], a[20:23], v[100:103]
 v_cvt_pk_bf16_f32 v50, v52, v53
 v_cvt_pk_bf16_f32 v51, v54, v55
 v_mfma_f32_16x16x32_bf16 v[100:103], a[72:75], a[16:19], v[100:103]
 s_add_u32 m0, s29, 40960
 v_cvt_pk_bf16_f32 v56, v56, v57
 v_cvt_pk_bf16_f32 v57, v58, v59
 v_mfma_f32_16x16x32_bf16 v[104:107], a[80:83], a[16:19], v[104:107]
 buffer_load_dwordx4 v2, s[16:19], s49 offen lds
 v_mfma_f32_16x16x32_bf16 v[104:107], a[84:87], a[20:23], v[104:107]
 s_add_u32 s59, s56, 49152
 v_cvt_pk_bf16_f32 v58, v60, v61
 v_cvt_pk_bf16_f32 v59, v62, v63
 v_mfma_f32_16x16x32_bf16 v[108:111], a[92:95], a[20:23], v[108:111]
 buffer_store_dwordx4 v[40:43], v1, s[12:15], s59 offen offset:2048 sc1
 v_mfma_f32_16x16x32_bf16 v[108:111], a[88:91], a[16:19], v[108:111]
 v_cvt_pk_bf16_f32 v64, v64, v65
 v_cvt_pk_bf16_f32 v65, v66, v67
 v_mfma_f32_16x16x32_bf16 v[116:119], a[88:91], a[24:27], v[116:119]
 s_add_u32 m0, s29, 45056
 v_cvt_pk_bf16_f32 v66, v68, v69
 v_cvt_pk_bf16_f32 v67, v70, v71
 v_mfma_f32_16x16x32_bf16 v[116:119], a[92:95], a[28:31], v[116:119]
 buffer_load_dwordx4 v2, s[16:19], s50 offen lds
 v_mfma_f32_16x16x32_bf16 v[112:115], a[84:87], a[28:31], v[112:115]
 v_cvt_pk_bf16_f32 v72, v72, v73
 v_cvt_pk_bf16_f32 v73, v74, v75
 v_mfma_f32_16x16x32_bf16 v[112:115], a[80:83], a[24:27], v[112:115]
 v_cvt_pk_bf16_f32 v74, v76, v77
 v_cvt_pk_bf16_f32 v75, v78, v79
 v_mfma_f32_16x16x32_bf16 v[124:127], a[72:75], a[24:27], v[124:127]
 v_cvt_pk_bf16_f32 v80, v80, v81
 v_cvt_pk_bf16_f32 v81, v82, v83
 v_mfma_f32_16x16x32_bf16 v[124:127], a[76:79], a[28:31], v[124:127]
 s_add_u32 m0, s29, 49152
 v_cvt_pk_bf16_f32 v82, v84, v85
 v_cvt_pk_bf16_f32 v83, v86, v87
 v_mfma_f32_16x16x32_bf16 v[120:123], a[68:71], a[28:31], v[120:123]
 buffer_load_dwordx4 v2, s[16:19], s51 offen lds
 v_mfma_f32_16x16x32_bf16 v[120:123], a[64:67], a[24:27], v[120:123]
 s_add_u32 s59, s56, 32768
 v_cvt_pk_bf16_f32 v88, v88, v89
 v_cvt_pk_bf16_f32 v89, v90, v91
 v_mfma_f32_16x16x32_bf16 v[128:131], a[64:67], a[32:35], v[128:131]
 buffer_store_dwordx4 v[36:39], v1, s[12:15], s59 offen offset:1024 sc1
 v_mfma_f32_16x16x32_bf16 v[128:131], a[68:71], a[36:39], v[128:131]
 v_cvt_pk_bf16_f32 v90, v92, v93
 v_cvt_pk_bf16_f32 v91, v94, v95
 v_mfma_f32_16x16x32_bf16 v[132:135], a[76:79], a[36:39], v[132:135]
 s_add_u32 m0, s29, 53248
 v_cvt_pk_bf16_f32 v96, v96, v97
 v_cvt_pk_bf16_f32 v97, v98, v99
 v_mfma_f32_16x16x32_bf16 v[132:135], a[72:75], a[32:35], v[132:135]
 buffer_load_dwordx4 v2, s[16:19], s52 offen lds
 v_mfma_f32_16x16x32_bf16 v[136:139], a[80:83], a[32:35], v[136:139]
 v_cvt_pk_bf16_f32 v98, v100, v101
 v_cvt_pk_bf16_f32 v99, v102, v103
 v_mfma_f32_16x16x32_bf16 v[136:139], a[84:87], a[36:39], v[136:139]
 v_cvt_pk_bf16_f32 v104, v104, v105
 v_cvt_pk_bf16_f32 v105, v106, v107
 v_mfma_f32_16x16x32_bf16 v[140:143], a[92:95], a[36:39], v[140:143]
 v_cvt_pk_bf16_f32 v106, v108, v109
 v_cvt_pk_bf16_f32 v107, v110, v111
 v_mfma_f32_16x16x32_bf16 v[140:143], a[88:91], a[32:35], v[140:143]
 s_add_u32 m0, s29, 57344
 v_cvt_pk_bf16_f32 v112, v112, v113
 v_cvt_pk_bf16_f32 v113, v114, v115
 v_mfma_f32_16x16x32_bf16 v[148:151], a[88:91], a[40:43], v[148:151]
 buffer_load_dwordx4 v2, s[16:19], s53 offen lds
 v_mfma_f32_16x16x32_bf16 v[148:151], a[92:95], a[44:47], v[148:151]
 s_add_u32 s59, s56, 49152
 v_cvt_pk_bf16_f32 v114, v116, v117
 v_cvt_pk_bf16_f32 v115, v118, v119
 v_mfma_f32_16x16x32_bf16 v[144:147], a[84:87], a[44:47], v[144:147]
 buffer_store_dwordx4 v[48:51], v1, s[12:15], s59 offen offset:3072 sc1
 v_mfma_f32_16x16x32_bf16 v[144:147], a[80:83], a[40:43], v[144:147]
 v_cvt_pk_bf16_f32 v120, v120, v121
 v_cvt_pk_bf16_f32 v121, v122, v123
 v_mfma_f32_16x16x32_bf16 v[156:159], a[72:75], a[40:43], v[156:159]
 s_add_u32 m0, s29, 61440
 v_cvt_pk_bf16_f32 v122, v124, v125
 v_cvt_pk_bf16_f32 v123, v126, v127
 v_mfma_f32_16x16x32_bf16 v[156:159], a[76:79], a[44:47], v[156:159]
 buffer_load_dwordx4 v2, s[16:19], s54 offen lds
 v_mfma_f32_16x16x32_bf16 v[152:155], a[68:71], a[44:47], v[152:155]
 v_cvt_pk_bf16_f32 v128, v128, v129
 v_cvt_pk_bf16_f32 v129, v130, v131
 v_mfma_f32_16x16x32_bf16 v[152:155], a[64:67], a[40:43], v[152:155]
 v_cvt_pk_bf16_f32 v130, v132, v133
 v_cvt_pk_bf16_f32 v131, v134, v135
 v_mfma_f32_16x16x32_bf16 v[160:163], a[64:67], a[48:51], v[160:163]
 s_add_u32 m0, s29, 98304
 v_add_u32 v2, 0x80000, v2
 v_cvt_pk_bf16_f32 v136, v136, v137
 v_mfma_f32_16x16x32_bf16 v[160:163], a[68:71], a[52:55], v[160:163]
 buffer_load_dwordx4 v2, s[16:19], 0 offen lds
 v_mfma_f32_16x16x32_bf16 v[164:167], a[76:79], a[52:55], v[164:167]
 s_add_u32 s59, s56, 32768
 v_cvt_pk_bf16_f32 v137, v138, v139
 v_cvt_pk_bf16_f32 v138, v140, v141
 v_mfma_f32_16x16x32_bf16 v[164:167], a[72:75], a[48:51], v[164:167]
 buffer_store_dwordx4 v[56:59], v1, s[12:15], s59 offen offset:3072 sc1
 v_mfma_f32_16x16x32_bf16 v[168:171], a[80:83], a[48:51], v[168:171]
 v_cvt_pk_bf16_f32 v139, v142, v143
 v_cvt_pk_bf16_f32 v144, v144, v145
 v_mfma_f32_16x16x32_bf16 v[168:171], a[84:87], a[52:55], v[168:171]
 s_add_u32 m0, s29, 102400
 v_cvt_pk_bf16_f32 v145, v146, v147
 v_cvt_pk_bf16_f32 v146, v148, v149
 v_mfma_f32_16x16x32_bf16 v[172:175], a[92:95], a[52:55], v[172:175]
 buffer_load_dwordx4 v2, s[16:19], s48 offen lds
 v_mfma_f32_16x16x32_bf16 v[172:175], a[88:91], a[48:51], v[172:175]
 v_cvt_pk_bf16_f32 v147, v150, v151
 v_cvt_pk_bf16_f32 v152, v152, v153
 v_mfma_f32_16x16x32_bf16 v[180:183], a[88:91], a[56:59], v[180:183]
 v_cvt_pk_bf16_f32 v153, v154, v155
 v_cvt_pk_bf16_f32 v154, v156, v157
 v_mfma_f32_16x16x32_bf16 v[180:183], a[92:95], a[60:63], v[180:183]
 v_cvt_pk_bf16_f32 v155, v158, v159
 v_mfma_f32_16x16x32_bf16 v[176:179], a[84:87], a[60:63], v[176:179]
 s_add_u32 m0, s29, 106496
 v_mfma_f32_16x16x32_bf16 v[176:179], a[80:83], a[56:59], v[176:179]
 buffer_load_dwordx4 v2, s[16:19], s49 offen lds
 v_mfma_f32_16x16x32_bf16 v[188:191], a[72:75], a[56:59], v[188:191]
 s_add_u32 s59, s56, 0
 v_cvt_pk_bf16_f32 v160, v160, v161
 v_cvt_pk_bf16_f32 v161, v162, v163
 v_mfma_f32_16x16x32_bf16 v[188:191], a[76:79], a[60:63], v[188:191]
 buffer_store_dwordx4 v[64:67], v1, s[12:15], s59 offen offset:0 sc1
 v_mfma_f32_16x16x32_bf16 v[184:187], a[68:71], a[60:63], v[184:187]
 v_cvt_pk_bf16_f32 v162, v164, v165
 v_cvt_pk_bf16_f32 v163, v166, v167
 v_mfma_f32_16x16x32_bf16 v[184:187], a[64:67], a[56:59], v[184:187]
 s_add_u32 m0, s29, 110592
 v_cvt_pk_bf16_f32 v168, v168, v169
 v_cvt_pk_bf16_f32 v169, v170, v171
 v_mfma_f32_16x16x32_bf16 v[192:195], a[96:99], a[32:35], v[192:195]
 buffer_load_dwordx4 v2, s[16:19], s50 offen lds
 v_mfma_f32_16x16x32_bf16 v[192:195], a[100:103], a[36:39], v[192:195]
 v_cvt_pk_bf16_f32 v170, v172, v173
 v_cvt_pk_bf16_f32 v171, v174, v175
 v_mfma_f32_16x16x32_bf16 v[196:199], a[108:111], a[36:39], v[196:199]
 v_mfma_f32_16x16x32_bf16 v[196:199], a[104:107], a[32:35], v[196:199]
 v_cvt_pk_bf16_f32 v176, v176, v177
 v_cvt_pk_bf16_f32 v177, v178, v179
 v_mfma_f32_16x16x32_bf16 v[200:203], a[112:115], a[32:35], v[200:203]
 s_add_u32 m0, s29, 114688
 v_cvt_pk_bf16_f32 v178, v180, v181
 v_cvt_pk_bf16_f32 v179, v182, v183
 v_mfma_f32_16x16x32_bf16 v[200:203], a[116:119], a[36:39], v[200:203]
 buffer_load_dwordx4 v2, s[16:19], s51 offen lds
 v_mfma_f32_16x16x32_bf16 v[204:207], a[124:127], a[36:39], v[204:207]
 s_add_u32 s59, s56, 16384
 v_mfma_f32_16x16x32_bf16 v[204:207], a[120:123], a[32:35], v[204:207]
 buffer_store_dwordx4 v[72:75], v1, s[12:15], s59 offen offset:0 sc1
 v_mfma_f32_16x16x32_bf16 v[212:215], a[120:123], a[40:43], v[212:215]
 v_cvt_pk_bf16_f32 v184, v184, v185
 v_cvt_pk_bf16_f32 v185, v186, v187
 v_mfma_f32_16x16x32_bf16 v[212:215], a[124:127], a[44:47], v[212:215]
 s_add_u32 m0, s29, 118784
 v_cvt_pk_bf16_f32 v186, v188, v189
 v_cvt_pk_bf16_f32 v187, v190, v191
 v_mfma_f32_16x16x32_bf16 v[208:211], a[116:119], a[44:47], v[208:211]
 buffer_load_dwordx4 v2, s[16:19], s52 offen lds
 v_mfma_f32_16x16x32_bf16 v[208:211], a[112:115], a[40:43], v[208:211]
 v_cvt_pk_bf16_f32 v192, v192, v193
 v_cvt_pk_bf16_f32 v193, v194, v195
 v_mfma_f32_16x16x32_bf16 v[220:223], a[104:107], a[40:43], v[220:223]
 v_cvt_pk_bf16_f32 v194, v196, v197
 v_cvt_pk_bf16_f32 v195, v198, v199
 v_mfma_f32_16x16x32_bf16 v[220:223], a[108:111], a[44:47], v[220:223]
 v_mfma_f32_16x16x32_bf16 v[216:219], a[100:103], a[44:47], v[216:219]
 s_add_u32 m0, s29, 122880
 v_mfma_f32_16x16x32_bf16 v[216:219], a[96:99], a[40:43], v[216:219]
 buffer_load_dwordx4 v2, s[16:19], s53 offen lds
 v_mfma_f32_16x16x32_bf16 v[224:227], a[96:99], a[48:51], v[224:227]
 s_add_u32 s59, s56, 16384
 v_cvt_pk_bf16_f32 v200, v200, v201
 v_cvt_pk_bf16_f32 v201, v202, v203
 v_mfma_f32_16x16x32_bf16 v[224:227], a[100:103], a[52:55], v[224:227]
 s_waitcnt vmcnt(25)
 buffer_store_dwordx4 v[80:83], v1, s[12:15], s59 offen offset:1024 sc1
 v_mfma_f32_16x16x32_bf16 v[228:231], a[108:111], a[52:55], v[228:231]
 s_barrier
 v_xor_b32 v7, 0, v6
 v_cvt_pk_bf16_f32 v202, v204, v205
 v_mfma_f32_16x16x32_bf16 v[228:231], a[104:107], a[48:51], v[228:231]
 s_add_u32 m0, s29, 126976
 ds_read_b64_tr_b16 a[64:65], v7 offset:0
 v_cvt_pk_bf16_f32 v203, v206, v207
 v_mfma_f32_16x16x32_bf16 v[232:235], a[112:115], a[48:51], v[232:235]
 ds_read_b64_tr_b16 a[66:67], v7 offset:4096
 buffer_load_dwordx4 v2, s[16:19], s54 offen lds
 v_mfma_f32_16x16x32_bf16 v[232:235], a[116:119], a[52:55], v[232:235]
 ds_read_b64_tr_b16 a[68:69], v7 offset:16384
 v_cvt_pk_bf16_f32 v208, v208, v209
 v_mfma_f32_16x16x32_bf16 v[236:239], a[124:127], a[52:55], v[236:239]
 ds_read_b64_tr_b16 a[70:71], v7 offset:20480
 v_xor_b32 v8, 65536, v6
 v_mfma_f32_16x16x32_bf16 v[236:239], a[120:123], a[48:51], v[236:239]
 s_add_u32 s59, s56, 0
 ds_read_b64_tr_b16 a[72:73], v8 offset:0
 v_cvt_pk_bf16_f32 v209, v210, v211
 v_mfma_f32_16x16x32_bf16 v[244:247], a[120:123], a[56:59], v[244:247]
 ds_read_b64_tr_b16 a[74:75], v8 offset:4096
 buffer_store_dwordx4 v[88:91], v1, s[12:15], s59 offen offset:1024 sc1
 v_mfma_f32_16x16x32_bf16 v[244:247], a[124:127], a[60:63], v[244:247]
 ds_read_b64_tr_b16 a[76:77], v8 offset:16384
 v_cvt_pk_bf16_f32 v210, v212, v213
 v_mfma_f32_16x16x32_bf16 v[240:243], a[116:119], a[60:63], v[240:243]
 ds_read_b64_tr_b16 a[78:79], v8 offset:20480
 v_xor_b32 v9, 32, v6
 v_mfma_f32_16x16x32_bf16 v[240:243], a[112:115], a[56:59], v[240:243]
 ds_read_b64_tr_b16 a[80:81], v9 offset:0
 v_cvt_pk_bf16_f32 v211, v214, v215
 v_mfma_f32_16x16x32_bf16 v[252:255], a[104:107], a[56:59], v[252:255]
 ds_read_b64_tr_b16 a[82:83], v9 offset:4096
 v_cvt_pk_bf16_f32 v216, v216, v217
 v_mfma_f32_16x16x32_bf16 v[252:255], a[108:111], a[60:63], v[252:255]
 ds_read_b64_tr_b16 a[84:85], v9 offset:16384
 v_cvt_pk_bf16_f32 v217, v218, v219
 v_mfma_f32_16x16x32_bf16 v[248:251], a[100:103], a[60:63], v[248:251]
 s_add_u32 s59, s56, 0
 ds_read_b64_tr_b16 a[86:87], v9 offset:20480
 v_xor_b32 v10, 65568, v6
 v_mfma_f32_16x16x32_bf16 v[248:251], a[96:99], a[56:59], v[248:251]
 s_waitcnt lgkmcnt(6)
 ds_read_b64_tr_b16 a[88:89], v10 offset:0
 buffer_store_dwordx4 v[96:99], v1, s[12:15], s59 offen offset:2048 sc1
 v_mfma_f32_16x16x32_bf16 v[28:31], a[64:67], a[128:131], 0
 ds_read_b64_tr_b16 a[90:91], v10 offset:4096
 v_cvt_pk_bf16_f32 v218, v220, v221
 v_mfma_f32_16x16x32_bf16 v[28:31], a[68:71], a[136:139], v[28:31]
 ds_read_b64_tr_b16 a[92:93], v10 offset:16384
 v_xor_b32 v7, 64, v6
 v_mfma_f32_16x16x32_bf16 v[28:31], a[72:75], a[144:147], v[28:31]
 s_waitcnt lgkmcnt(7)
 ds_read_b128 a[112:115], v14 offset:0
 ds_read_b64_tr_b16 a[94:95], v10 offset:20480
 v_mfma_f32_16x16x32_bf16 v[28:31], a[76:79], a[152:155], v[28:31]
 ds_read_b64_tr_b16 a[96:97], v7 offset:0
 v_cvt_pk_bf16_f32 v219, v222, v223
 v_mfma_f32_16x16x32_bf16 v[44:47], a[64:67], a[132:135], 0
 ds_read_b128 a[120:123], v3 offset:0
 ds_read_b64_tr_b16 a[98:99], v7 offset:4096
 v_mfma_f32_16x16x32_bf16 v[44:47], a[68:71], a[140:143], v[44:47]
 s_add_u32 s59, s56, 16384
 ds_read_b64_tr_b16 a[100:101], v7 offset:16384
 v_xor_b32 v8, 65600, v6
 v_mfma_f32_16x16x32_bf16 v[44:47], a[72:75], a[148:151], v[44:47]
 ds_read_b128 a[116:119], v14 offset:2048
 ds_read_b64_tr_b16 a[102:103], v7 offset:20480
 buffer_store_dwordx4 v[104:107], v1, s[12:15], s59 offen offset:2048 sc1
 v_mfma_f32_16x16x32_bf16 v[44:47], a[76:79], a[156:159], v[44:47]
 s_waitcnt lgkmcnt(9)
 ds_read_b64_tr_b16 a[104:105], v8 offset:0
 v_cvt_pk_bf16_f32 v224, v224, v225
 v_mfma_f32_16x16x32_bf16 v[52:55], a[80:83], a[128:131], 0
 ds_read_b128 a[124:127], v3 offset:2048
 ds_read_b64_tr_b16 a[106:107], v8 offset:4096
 v_mfma_f32_16x16x32_bf16 v[52:55], a[84:87], a[136:139], v[52:55]
 ds_read_b64_tr_b16 a[108:109], v8 offset:16384
 v_cvt_pk_bf16_f32 v225, v226, v227
 v_mfma_f32_16x16x32_bf16 v[52:55], a[88:91], a[144:147], v[52:55]
 s_waitcnt lgkmcnt(10)
 ds_read_b64_tr_b16 a[110:111], v8 offset:20480
 v_xor_b32 v9, 96, v6
 v_mfma_f32_16x16x32_bf16 v[52:55], a[92:95], a[152:155], v[52:55]
 ds_read_b64_tr_b16 a[64:65], v9 offset:0
 v_cvt_pk_bf16_f32 v226, v228, v229
 v_mfma_f32_16x16x32_bf16 v[60:63], a[80:83], a[132:135], 0
 s_add_u32 s59, s56, 16384
 ds_read_b64_tr_b16 a[66:67], v9 offset:4096
 v_cvt_pk_bf16_f32 v227, v230, v231
 v_mfma_f32_16x16x32_bf16 v[60:63], a[84:87], a[140:143], v[60:63]
 ds_read_b64_tr_b16 a[68:69], v9 offset:16384
 buffer_store_dwordx4 v[112:115], v1, s[12:15], s59 offen offset:3072 sc1
 v_mfma_f32_16x16x32_bf16 v[60:63], a[88:91], a[148:151], v[60:63]
 ds_read_b64_tr_b16 a[70:71], v9 offset:20480
 v_xor_b32 v10, 65632, v6
 v_mfma_f32_16x16x32_bf16 v[60:63], a[92:95], a[156:159], v[60:63]
 s_waitcnt lgkmcnt(6)
 ds_read_b64_tr_b16 a[72:73], v10 offset:0
 v_cvt_pk_bf16_f32 v232, v232, v233
 v_mfma_f32_16x16x32_bf16 v[20:23], a[96:99], a[128:131], 0
 ds_read_b64_tr_b16 a[74:75], v10 offset:4096
 v_cvt_pk_bf16_f32 v233, v234, v235
 v_mfma_f32_16x16x32_bf16 v[20:23], a[100:103], a[136:139], v[20:23]
 s_waitcnt lgkmcnt(8)
 ds_read_b64_tr_b16 a[76:77], v10 offset:16384
 v_xor_b32 v7, 128, v6
 v_mfma_f32_16x16x32_bf16 v[20:23], a[104:107], a[144:147], v[20:23]
 s_waitcnt lgkmcnt(7)
 s_barrier
 ds_read_b64_tr_b16 a[78:79], v10 offset:20480
 v_mfma_f32_16x16x32_bf16 v[20:23], a[108:111], a[152:155], v[20:23]
 s_add_u32 m0, s29, 131072
 ds_read_b64_tr_b16 a[80:81], v7 offset:0
 v_add_u32 v2, 0x80000, v2
 v_mfma_f32_16x16x32_bf16 v[36:39], a[96:99], a[132:135], 0
 ds_read_b64_tr_b16 a[82:83], v7 offset:4096
 buffer_load_dwordx4 v2, s[16:19], 0 offen lds
 v_mfma_f32_16x16x32_bf16 v[36:39], a[100:103], a[140:143], v[36:39]
 ds_read_b64_tr_b16 a[84:85], v7 offset:16384
 v_cvt_pk_bf16_f32 v234, v236, v237
 v_mfma_f32_16x16x32_bf16 v[36:39], a[104:107], a[148:151], v[36:39]
 s_add_u32 s59, s56, 0
 ds_read_b64_tr_b16 a[86:87], v7 offset:20480
 v_xor_b32 v8, 65664, v6
 v_mfma_f32_16x16x32_bf16 v[36:39], a[108:111], a[156:159], v[36:39]
 s_waitcnt lgkmcnt(6)
 ds_read_b64_tr_b16 a[88:89], v8 offset:0
 buffer_store_dwordx4 v[120:123], v1, s[12:15], s59 offen offset:3072 sc1
 v_mfma_f32_16x16x32_bf16 v[68:71], a[64:67], a[128:131], 0
 ds_read_b64_tr_b16 a[90:91], v8 offset:4096
 v_cvt_pk_bf16_f32 v235, v238, v239
 v_mfma_f32_16x16x32_bf16 v[68:71], a[68:71], a[136:139], v[68:71]
 s_add_u32 m0, s29, 135168
 ds_read_b64_tr_b16 a[92:93], v8 offset:16384
 v_cvt_pk_bf16_f32 v240, v240, v241
 v_mfma_f32_16x16x32_bf16 v[68:71], a[72:75], a[144:147], v[68:71]
 s_waitcnt lgkmcnt(7)
 ds_read_b64_tr_b16 a[94:95], v8 offset:20480
 v_xor_b32 v9, 160, v6
 v_mfma_f32_16x16x32_bf16 v[68:71], a[76:79], a[152:155], v[68:71]
 ds_read_b64_tr_b16 a[96:97], v9 offset:0
 buffer_load_dwordx4 v2, s[16:19], s48 offen lds
 v_mfma_f32_16x16x32_bf16 v[76:79], a[64:67], a[132:135], 0
 ds_read_b64_tr_b16 a[98:99], v9 offset:4096
 v_cvt_pk_bf16_f32 v241, v242, v243
 v_mfma_f32_16x16x32_bf16 v[76:79], a[68:71], a[140:143], v[76:79]
 ds_read_b64_tr_b16 a[100:101], v9 offset:16384
 v_cvt_pk_bf16_f32 v242, v244, v245
 v_mfma_f32_16x16x32_bf16 v[76:79], a[72:75], a[148:151], v[76:79]
 s_add_u32 s59, s56, 4096
 ds_read_b64_tr_b16 a[102:103], v9 offset:20480
 v_xor_b32 v10, 65696, v6
 v_mfma_f32_16x16x32_bf16 v[76:79], a[76:79], a[156:159], v[76:79]
 s_waitcnt lgkmcnt(6)
 ds_read_b64_tr_b16 a[104:105], v10 offset:0
 buffer_store_dwordx4 v[128:131], v1, s[12:15], s59 offen offset:0 sc1
 v_mfma_f32_16x16x32_bf16 v[84:87], a[80:83], a[128:131], 0
 s_add_u32 m0, s29, 139264
 ds_read_b64_tr_b16 a[106:107], v10 offset:4096
 v_cvt_pk_bf16_f32 v243, v246, v247
 v_mfma_f32_16x16x32_bf16 v[84:87], a[84:87], a[136:139], v[84:87]
 ds_read_b64_tr_b16 a[108:109], v10 offset:16384
 buffer_load_dwordx4 v2, s[16:19], s49 offen lds
 v_mfma_f32_16x16x32_bf16 v[84:87], a[88:91], a[144:147], v[84:87]
 s_waitcnt lgkmcnt(7)
 ds_read_b64_tr_b16 a[110:111], v10 offset:20480
 v_xor_b32 v7, 192, v6
 v_mfma_f32_16x16x32_bf16 v[84:87], a[92:95], a[152:155], v[84:87]
 ds_read_b64_tr_b16 a[64:65], v7 offset:0
 v_cvt_pk_bf16_f32 v248, v248, v249
 v_mfma_f32_16x16x32_bf16 v[92:95], a[80:83], a[132:135], 0
 ds_read_b64_tr_b16 a[66:67], v7 offset:4096
 v_cvt_pk_bf16_f32 v249, v250, v251
 v_mfma_f32_16x16x32_bf16 v[92:95], a[84:87], a[140:143], v[92:95]
 ds_read_b64_tr_b16 a[68:69], v7 offset:16384
 v_cvt_pk_bf16_f32 v250, v252, v253
 v_mfma_f32_16x16x32_bf16 v[92:95], a[88:91], a[148:151], v[92:95]
 s_add_u32 m0, s29, 143360
 ds_read_b64_tr_b16 a[70:71], v7 offset:20480
 v_xor_b32 v8, 65728, v6
 v_mfma_f32_16x16x32_bf16 v[92:95], a[92:95], a[156:159], v[92:95]
 s_waitcnt lgkmcnt(6)
 ds_read_b64_tr_b16 a[72:73], v8 offset:0
 buffer_load_dwordx4 v2, s[16:19], s50 offen lds
 v_mfma_f32_16x16x32_bf16 v[100:103], a[96:99], a[128:131], 0
 s_add_u32 s59, s56, 20480
 ds_read_b64_tr_b16 a[74:75], v8 offset:4096
 v_cvt_pk_bf16_f32 v251, v254, v255
 v_mfma_f32_16x16x32_bf16 v[100:103], a[100:103], a[136:139], v[100:103]
 ds_read_b64_tr_b16 a[76:77], v8 offset:16384
 buffer_store_dwordx4 v[136:139], v1, s[12:15], s59 offen offset:0 sc1
 v_mfma_f32_16x16x32_bf16 v[100:103], a[104:107], a[144:147], v[100:103]
 s_waitcnt lgkmcnt(7)
 ds_read_b64_tr_b16 a[78:79], v8 offset:20480
 v_xor_b32 v9, 224, v6
 v_mfma_f32_16x16x32_bf16 v[100:103], a[108:111], a[152:155], v[100:103]
 s_and_b32 s36, s95, 31
 ds_read_b64_tr_b16 a[80:81], v9 offset:0
 v_accvgpr_read_b32 v11, a245
 v_mfma_f32_16x16x32_bf16 v[108:111], a[96:99], a[132:135], 0
 s_add_u32 m0, s29, 147456
 ds_read_b64_tr_b16 a[82:83], v9 offset:4096
 v_mov_b32 v12, 0
 v_mfma_f32_16x16x32_bf16 v[108:111], a[100:103], a[140:143], v[108:111]
 ds_read_b64_tr_b16 a[84:85], v9 offset:16384
 buffer_load_dwordx4 v2, s[16:19], s51 offen lds
 v_mfma_f32_16x16x32_bf16 v[108:111], a[104:107], a[148:151], v[108:111]
 s_add_u32 s59, s56, 20480
 ds_read_b64_tr_b16 a[86:87], v9 offset:20480
 v_xor_b32 v10, 65760, v6
 v_mfma_f32_16x16x32_bf16 v[108:111], a[108:111], a[156:159], v[108:111]
 s_waitcnt lgkmcnt(6)
 ds_read_b64_tr_b16 a[88:89], v10 offset:0
 v_mfma_f32_16x16x32_bf16 v[116:119], a[64:67], a[128:131], 0
 ds_read_b64_tr_b16 a[90:91], v10 offset:4096
 buffer_store_dwordx4 v[144:147], v1, s[12:15], s59 offen offset:1024 sc1
 v_mfma_f32_16x16x32_bf16 v[116:119], a[68:71], a[136:139], v[116:119]
 s_add_u32 m0, s29, 151552
 ds_read_b64_tr_b16 a[92:93], v10 offset:16384
 v_mfma_f32_16x16x32_bf16 v[116:119], a[72:75], a[144:147], v[116:119]
 s_waitcnt lgkmcnt(7)
 ds_read_b64_tr_b16 a[94:95], v10 offset:20480
 v_xor_b32 v7, 256, v6
 v_mfma_f32_16x16x32_bf16 v[116:119], a[76:79], a[152:155], v[116:119]
 ds_read_b64_tr_b16 a[96:97], v7 offset:0
 buffer_load_dwordx4 v2, s[16:19], s52 offen lds
 v_mfma_f32_16x16x32_bf16 v[124:127], a[64:67], a[132:135], 0
 s_lshr_b32 s37, s95, 5
 ds_read_b64_tr_b16 a[98:99], v7 offset:4096
 v_mfma_f32_16x16x32_bf16 v[124:127], a[68:71], a[140:143], v[124:127]
 ds_read_b64_tr_b16 a[100:101], v7 offset:16384
 global_load_dword a248, v12, s[90:91] offset:128 sc1
 v_mfma_f32_16x16x32_bf16 v[124:127], a[72:75], a[148:151], v[124:127]
 s_add_u32 s59, s56, 4096
 ds_read_b64_tr_b16 a[102:103], v7 offset:20480
 v_xor_b32 v8, 65792, v6
 v_mfma_f32_16x16x32_bf16 v[124:127], a[76:79], a[156:159], v[124:127]
 s_waitcnt lgkmcnt(6)
 ds_read_b64_tr_b16 a[104:105], v8 offset:0
 buffer_store_dwordx4 v[152:155], v1, s[12:15], s59 offen offset:1024 sc1
 v_mfma_f32_16x16x32_bf16 v[132:135], a[80:83], a[128:131], 0
 s_add_u32 m0, s29, 155648
 ds_read_b64_tr_b16 a[106:107], v8 offset:4096
 v_and_b32 v12, 11, v0
 v_mfma_f32_16x16x32_bf16 v[132:135], a[84:87], a[136:139], v[132:135]
 ds_read_b64_tr_b16 a[108:109], v8 offset:16384
 buffer_load_dwordx4 v2, s[16:19], s53 offen lds
 v_mfma_f32_16x16x32_bf16 v[132:135], a[88:91], a[144:147], v[132:135]
 s_waitcnt lgkmcnt(7)
 ds_read_b64_tr_b16 a[110:111], v8 offset:20480
 v_xor_b32 v9, 288, v6
 v_mfma_f32_16x16x32_bf16 v[132:135], a[92:95], a[152:155], v[132:135]
 s_lshl_b32 s38, s3, 4
 ds_read_b64_tr_b16 a[64:65], v9 offset:0
 v_lshlrev_b32 v12, 2, v12
 v_mfma_f32_16x16x32_bf16 v[140:143], a[80:83], a[132:135], 0
 s_lshl_b32 s39, s36, 6
 ds_read_b64_tr_b16 a[66:67], v9 offset:4096
 v_mfma_f32_16x16x32_bf16 v[140:143], a[84:87], a[140:143], v[140:143]
 s_add_u32 s38, s38, s39
 ds_read_b64_tr_b16 a[68:69], v9 offset:16384
 v_mfma_f32_16x16x32_bf16 v[140:143], a[88:91], a[148:151], v[140:143]
 s_add_u32 m0, s29, 159744
 ds_read_b64_tr_b16 a[70:71], v9 offset:20480
 v_xor_b32 v10, 65824, v6
 v_mfma_f32_16x16x32_bf16 v[140:143], a[92:95], a[156:159], v[140:143]
 s_waitcnt lgkmcnt(6)
 ds_read_b64_tr_b16 a[72:73], v10 offset:0
 buffer_load_dwordx4 v2, s[16:19], s54 offen lds
 v_mfma_f32_16x16x32_bf16 v[148:151], a[96:99], a[128:131], 0
 s_add_u32 s59, s56, 4096
 ds_read_b64_tr_b16 a[74:75], v10 offset:4096
 v_mfma_f32_16x16x32_bf16 v[148:151], a[100:103], a[136:139], v[148:151]
 ds_read_b64_tr_b16 a[76:77], v10 offset:16384
 buffer_store_dwordx4 v[160:163], v1, s[12:15], s59 offen offset:2048 sc1
 v_mfma_f32_16x16x32_bf16 v[148:151], a[104:107], a[144:147], v[148:151]
 s_waitcnt lgkmcnt(7)
 ds_read_b64_tr_b16 a[78:79], v10 offset:20480
 v_xor_b32 v7, 320, v6
 v_mfma_f32_16x16x32_bf16 v[148:151], a[108:111], a[152:155], v[148:151]
 s_mul_i32 s38, s38, 896
 ds_read_b64_tr_b16 a[80:81], v7 offset:0
 v_mfma_f32_16x16x32_bf16 v[156:159], a[96:99], a[132:135], 0
 s_lshl_b32 s39, s37, 7
 ds_read_b64_tr_b16 a[82:83], v7 offset:4096
 v_mfma_f32_16x16x32_bf16 v[156:159], a[100:103], a[140:143], v[156:159]
 s_add_u32 s38, s38, s39
 ds_read_b64_tr_b16 a[84:85], v7 offset:16384
 v_mfma_f32_16x16x32_bf16 v[156:159], a[104:107], a[148:151], v[156:159]
 s_add_u32 s59, s56, 20480
 ds_read_b64_tr_b16 a[86:87], v7 offset:20480
 v_xor_b32 v8, 65856, v6
 v_mfma_f32_16x16x32_bf16 v[156:159], a[108:111], a[156:159], v[156:159]
 s_waitcnt lgkmcnt(6)
 ds_read_b64_tr_b16 a[88:89], v8 offset:0
 v_mfma_f32_16x16x32_bf16 v[164:167], a[64:67], a[128:131], 0
 ds_read_b64_tr_b16 a[90:91], v8 offset:4096
 buffer_store_dwordx4 v[168:171], v1, s[12:15], s59 offen offset:2048 sc1
 v_mfma_f32_16x16x32_bf16 v[164:167], a[68:71], a[136:139], v[164:167]
 s_lshl_b32 s39, s37, 9
 ds_read_b64_tr_b16 a[92:93], v8 offset:16384
 v_mfma_f32_16x16x32_bf16 v[164:167], a[72:75], a[144:147], v[164:167]
 s_waitcnt lgkmcnt(7)
 ds_read_b64_tr_b16 a[94:95], v8 offset:20480
 v_xor_b32 v9, 352, v6
 v_mfma_f32_16x16x32_bf16 v[164:167], a[76:79], a[152:155], v[164:167]
 s_mov_b32 s4, s66
 ds_read_b64_tr_b16 a[96:97], v9 offset:0
 v_mfma_f32_16x16x32_bf16 v[172:175], a[64:67], a[132:135], 0
 s_mov_b32 s5, s67
 ds_read_b64_tr_b16 a[98:99], v9 offset:4096
 v_mfma_f32_16x16x32_bf16 v[172:175], a[68:71], a[140:143], v[172:175]
 s_mov_b32 s6, 1835008
 ds_read_b64_tr_b16 a[100:101], v9 offset:16384
 v_mfma_f32_16x16x32_bf16 v[172:175], a[72:75], a[148:151], v[172:175]
 s_add_u32 s59, s56, 20480
 ds_read_b64_tr_b16 a[102:103], v9 offset:20480
 v_xor_b32 v10, 65888, v6
 v_mfma_f32_16x16x32_bf16 v[172:175], a[76:79], a[156:159], v[172:175]
 s_waitcnt lgkmcnt(6)
 ds_read_b64_tr_b16 a[104:105], v10 offset:0
 buffer_store_dwordx4 v[176:179], v1, s[12:15], s59 offen offset:3072 sc1
 v_mfma_f32_16x16x32_bf16 v[180:183], a[80:83], a[128:131], 0
 s_mov_b32 s7, 0x20000
 ds_read_b64_tr_b16 a[106:107], v10 offset:4096
 v_mfma_f32_16x16x32_bf16 v[180:183], a[84:87], a[136:139], v[180:183]
 s_mov_b32 s8, s68
 ds_read_b64_tr_b16 a[108:109], v10 offset:16384
 v_mfma_f32_16x16x32_bf16 v[180:183], a[88:91], a[144:147], v[180:183]
 s_waitcnt lgkmcnt(7)
 ds_read_b64_tr_b16 a[110:111], v10 offset:20480
 v_xor_b32 v7, 384, v6
 v_mfma_f32_16x16x32_bf16 v[180:183], a[92:95], a[152:155], v[180:183]
 s_mov_b32 s9, s69
 ds_read_b64_tr_b16 a[64:65], v7 offset:0
 v_mfma_f32_16x16x32_bf16 v[188:191], a[80:83], a[132:135], 0
 s_mov_b32 s10, 1835008
 ds_read_b64_tr_b16 a[66:67], v7 offset:4096
 v_mfma_f32_16x16x32_bf16 v[188:191], a[84:87], a[140:143], v[188:191]
 s_mov_b32 s11, 0x20000
 ds_read_b64_tr_b16 a[68:69], v7 offset:16384
 v_mfma_f32_16x16x32_bf16 v[188:191], a[88:91], a[148:151], v[188:191]
 s_add_u32 s59, s56, 4096
 ds_read_b64_tr_b16 a[70:71], v7 offset:20480
 v_xor_b32 v8, 65920, v6
 v_mfma_f32_16x16x32_bf16 v[188:191], a[92:95], a[156:159], v[188:191]
 s_waitcnt lgkmcnt(6)
 ds_read_b64_tr_b16 a[72:73], v8 offset:0
 buffer_store_dwordx4 v[184:187], v1, s[12:15], s59 offen offset:3072 sc1
 v_mfma_f32_16x16x32_bf16 v[196:199], a[96:99], a[128:131], 0
 s_mov_b32 s20, s70
 ds_read_b64_tr_b16 a[74:75], v8 offset:4096
 v_mfma_f32_16x16x32_bf16 v[196:199], a[100:103], a[136:139], v[196:199]
 s_mov_b32 s21, s71
 ds_read_b64_tr_b16 a[76:77], v8 offset:16384
 v_mfma_f32_16x16x32_bf16 v[196:199], a[104:107], a[144:147], v[196:199]
 s_waitcnt lgkmcnt(7)
 ds_read_b64_tr_b16 a[78:79], v8 offset:20480
 v_xor_b32 v9, 416, v6
 v_mfma_f32_16x16x32_bf16 v[196:199], a[108:111], a[152:155], v[196:199]
 s_mov_b32 s22, 3584
 ds_read_b64_tr_b16 a[80:81], v9 offset:0
 v_mfma_f32_16x16x32_bf16 v[204:207], a[96:99], a[132:135], 0
 s_mov_b32 s23, 0x20000
 ds_read_b64_tr_b16 a[82:83], v9 offset:4096
 v_mfma_f32_16x16x32_bf16 v[204:207], a[100:103], a[140:143], v[204:207]
 ds_read_b64_tr_b16 a[84:85], v9 offset:16384
 v_lshrrev_b32 v120, 3, v0
 v_mfma_f32_16x16x32_bf16 v[204:207], a[104:107], a[148:151], v[204:207]
 s_add_u32 s59, s56, 36864
 ds_read_b64_tr_b16 a[86:87], v9 offset:20480
 v_xor_b32 v10, 65952, v6
 v_mfma_f32_16x16x32_bf16 v[204:207], a[108:111], a[156:159], v[204:207]
 s_waitcnt lgkmcnt(6)
 ds_read_b64_tr_b16 a[88:89], v10 offset:0
 buffer_store_dwordx4 v[192:195], v1, s[12:15], s59 offen offset:0 sc1
 v_mfma_f32_16x16x32_bf16 v[212:215], a[64:67], a[128:131], 0
 ds_read_b64_tr_b16 a[90:91], v10 offset:4096
 v_mul_u32_u24 v120, 1792, v120
 v_mfma_f32_16x16x32_bf16 v[212:215], a[68:71], a[136:139], v[212:215]
 ds_read_b64_tr_b16 a[92:93], v10 offset:16384
 v_and_b32 v121, 7, v0
 v_mfma_f32_16x16x32_bf16 v[212:215], a[72:75], a[144:147], v[212:215]
 s_waitcnt lgkmcnt(7)
 ds_read_b64_tr_b16 a[94:95], v10 offset:20480
 v_xor_b32 v7, 448, v6
 v_mfma_f32_16x16x32_bf16 v[212:215], a[76:79], a[152:155], v[212:215]
 ds_read_b64_tr_b16 a[96:97], v7 offset:0
 v_lshl_add_u32 v120, v121, 4, v120
 v_mfma_f32_16x16x32_bf16 v[220:223], a[64:67], a[132:135], 0
 ds_read_b64_tr_b16 a[98:99], v7 offset:4096
 v_add_u32 v120, s38, v120
 v_mfma_f32_16x16x32_bf16 v[220:223], a[68:71], a[140:143], v[220:223]
 ds_read_b64_tr_b16 a[100:101], v7 offset:16384
 v_lshlrev_b32 v121, 6, v121
 v_mfma_f32_16x16x32_bf16 v[220:223], a[72:75], a[148:151], v[220:223]
 s_add_u32 s59, s56, 53248
 ds_read_b64_tr_b16 a[102:103], v7 offset:20480
 v_xor_b32 v8, 65984, v6
 v_mfma_f32_16x16x32_bf16 v[220:223], a[76:79], a[156:159], v[220:223]
 s_waitcnt lgkmcnt(6)
 ds_read_b64_tr_b16 a[104:105], v8 offset:0
 buffer_store_dwordx4 v[200:203], v1, s[12:15], s59 offen offset:0 sc1
 v_mfma_f32_16x16x32_bf16 v[228:231], a[80:83], a[128:131], 0
 ds_read_b64_tr_b16 a[106:107], v8 offset:4096
 v_subrev_u32 v122, 2688, v120
 v_mfma_f32_16x16x32_bf16 v[228:231], a[84:87], a[136:139], v[228:231]
 ds_read_b64_tr_b16 a[108:109], v8 offset:16384
 v_subrev_u32 v123, 1792, v120
 v_mfma_f32_16x16x32_bf16 v[228:231], a[88:91], a[144:147], v[228:231]
 s_waitcnt lgkmcnt(7)
 ds_read_b64_tr_b16 a[110:111], v8 offset:20480
 v_xor_b32 v9, 480, v6
 v_mfma_f32_16x16x32_bf16 v[228:231], a[92:95], a[152:155], v[228:231]
 ds_read_b64_tr_b16 a[64:65], v9 offset:0
 v_subrev_u32 v128, 896, v120
 v_mfma_f32_16x16x32_bf16 v[236:239], a[80:83], a[132:135], 0
 ds_read_b64_tr_b16 a[66:67], v9 offset:4096
 v_mfma_f32_16x16x32_bf16 v[236:239], a[84:87], a[140:143], v[236:239]
 ds_read_b64_tr_b16 a[68:69], v9 offset:16384
 v_mfma_f32_16x16x32_bf16 v[236:239], a[88:91], a[148:151], v[236:239]
 s_add_u32 s59, s56, 53248
 ds_read_b64_tr_b16 a[70:71], v9 offset:20480
 v_xor_b32 v10, 66016, v6
 v_mfma_f32_16x16x32_bf16 v[236:239], a[92:95], a[156:159], v[236:239]
 s_waitcnt lgkmcnt(6)
 ds_read_b64_tr_b16 a[72:73], v10 offset:0
 buffer_store_dwordx4 v[208:211], v1, s[12:15], s59 offen offset:1024 sc1
 v_mfma_f32_16x16x32_bf16 v[244:247], a[96:99], a[128:131], 0
 ds_read_b64_tr_b16 a[74:75], v10 offset:4096
 v_mfma_f32_16x16x32_bf16 v[244:247], a[100:103], a[136:139], v[244:247]
 s_waitcnt vmcnt(25)
 ds_read_b64_tr_b16 a[76:77], v10 offset:16384
 v_xor_b32 v7, 32768, v6
 v_mfma_f32_16x16x32_bf16 v[244:247], a[104:107], a[144:147], v[244:247]
 s_waitcnt lgkmcnt(7)
 s_barrier
 ds_read_b64_tr_b16 a[78:79], v10 offset:20480
 v_mfma_f32_16x16x32_bf16 v[244:247], a[108:111], a[152:155], v[244:247]
 ds_read_b64_tr_b16 a[80:81], v7 offset:0
 v_mfma_f32_16x16x32_bf16 v[252:255], a[96:99], a[132:135], 0
 ds_read_b64_tr_b16 a[82:83], v7 offset:4096
 v_mfma_f32_16x16x32_bf16 v[252:255], a[100:103], a[140:143], v[252:255]
 ds_read_b64_tr_b16 a[84:85], v7 offset:16384
 v_mfma_f32_16x16x32_bf16 v[252:255], a[104:107], a[148:151], v[252:255]
 s_add_u32 s59, s56, 36864
 ds_read_b64_tr_b16 a[86:87], v7 offset:20480
 v_xor_b32 v8, 98304, v6
 v_mfma_f32_16x16x32_bf16 v[252:255], a[108:111], a[156:159], v[252:255]
 s_waitcnt lgkmcnt(6)
 ds_read_b64_tr_b16 a[88:89], v8 offset:0
 buffer_store_dwordx4 v[216:219], v1, s[12:15], s59 offen offset:1024 sc1
 v_mfma_f32_16x16x32_bf16 v[16:19], a[64:67], a[128:131], 0
 ds_read_b64_tr_b16 a[90:91], v8 offset:4096
 v_mfma_f32_16x16x32_bf16 v[16:19], a[68:71], a[136:139], v[16:19]
 ds_read_b64_tr_b16 a[92:93], v8 offset:16384
 v_mfma_f32_16x16x32_bf16 v[16:19], a[72:75], a[144:147], v[16:19]
 s_waitcnt lgkmcnt(7)
 ds_read_b64_tr_b16 a[94:95], v8 offset:20480
 v_xor_b32 v9, 32800, v6
 v_mfma_f32_16x16x32_bf16 v[16:19], a[76:79], a[152:155], v[16:19]
 ds_read_b64_tr_b16 a[96:97], v9 offset:0
 v_mfma_f32_16x16x32_bf16 v[24:27], a[64:67], a[132:135], 0
 s_waitcnt lgkmcnt(9)
 ds_read_b64_tr_b16 a[98:99], v9 offset:4096
 v_mfma_f32_16x16x32_bf16 v[24:27], a[68:71], a[140:143], v[24:27]
 s_barrier
 ds_read_b64_tr_b16 a[100:101], v9 offset:16384
 v_mfma_f32_16x16x32_bf16 v[24:27], a[72:75], a[148:151], v[24:27]
 s_add_u32 m0, s29, 0
 ds_read_b64_tr_b16 a[102:103], v9 offset:20480
 v_xor_b32 v10, 98336, v6
 v_mfma_f32_16x16x32_bf16 v[24:27], a[76:79], a[156:159], v[24:27]
 s_waitcnt lgkmcnt(6)
 ds_read_b64_tr_b16 a[104:105], v10 offset:0
 v_add_u32 v2, 0x80000, v2
 v_mfma_f32_16x16x32_bf16 v[28:31], a[80:83], a[160:163], v[28:31]
 ds_read_b64_tr_b16 a[106:107], v10 offset:4096
 buffer_load_dwordx4 v2, s[16:19], 0 offen lds
 v_mfma_f32_16x16x32_bf16 v[28:31], a[84:87], a[168:171], v[28:31]
 s_add_u32 s59, s56, 36864
 ds_read_b64_tr_b16 a[108:109], v10 offset:16384
 v_mfma_f32_16x16x32_bf16 v[28:31], a[88:91], a[176:179], v[28:31]
 s_waitcnt lgkmcnt(7)
 ds_read_b64_tr_b16 a[110:111], v10 offset:20480
 v_xor_b32 v7, 32832, v6
 v_mfma_f32_16x16x32_bf16 v[28:31], a[92:95], a[184:187], v[28:31]
 ds_read_b64_tr_b16 a[64:65], v7 offset:0
 buffer_store_dwordx4 v[224:227], v1, s[12:15], s59 offen offset:2048 sc1
 v_mfma_f32_16x16x32_bf16 v[44:47], a[80:83], a[164:167], v[44:47]
 s_add_u32 m0, s29, 4096
 ds_read_b64_tr_b16 a[66:67], v7 offset:4096
 v_add_u32 v4, 4096, v1
 v_mfma_f32_16x16x32_bf16 v[44:47], a[84:87], a[172:175], v[44:47]
 ds_read_b64_tr_b16 a[68:69], v7 offset:16384
 buffer_load_dwordx4 v2, s[16:19], s48 offen lds
 v_mfma_f32_16x16x32_bf16 v[44:47], a[88:91], a[180:183], v[44:47]
 ds_read_b64_tr_b16 a[70:71], v7 offset:20480
 v_xor_b32 v8, 98368, v6
 v_mfma_f32_16x16x32_bf16 v[44:47], a[92:95], a[188:191], v[44:47]
 s_waitcnt lgkmcnt(6)
 ds_read_b64_tr_b16 a[72:73], v8 offset:0
 v_mfma_f32_16x16x32_bf16 v[52:55], a[96:99], a[160:163], v[52:55]
 ds_read_b64_tr_b16 a[74:75], v8 offset:4096
 v_mfma_f32_16x16x32_bf16 v[52:55], a[100:103], a[168:171], v[52:55]
 s_add_u32 m0, s29, 8192
 ds_read_b64_tr_b16 a[76:77], v8 offset:16384
 v_mfma_f32_16x16x32_bf16 v[52:55], a[104:107], a[176:179], v[52:55]
 s_waitcnt lgkmcnt(7)
 ds_read_b64_tr_b16 a[78:79], v8 offset:20480
 v_xor_b32 v9, 32864, v6
 v_mfma_f32_16x16x32_bf16 v[52:55], a[108:111], a[184:187], v[52:55]
 ds_read_b64_tr_b16 a[80:81], v9 offset:0
 buffer_load_dwordx4 v2, s[16:19], s49 offen lds
 v_mfma_f32_16x16x32_bf16 v[60:63], a[96:99], a[164:167], v[60:63]
 s_add_u32 s59, s56, 53248
 ds_read_b64_tr_b16 a[82:83], v9 offset:4096
 v_mfma_f32_16x16x32_bf16 v[60:63], a[100:103], a[172:175], v[60:63]
 ds_read_b64_tr_b16 a[84:85], v9 offset:16384
 buffer_store_dwordx4 v[232:235], v1, s[12:15], s59 offen offset:2048 sc1
 v_mfma_f32_16x16x32_bf16 v[60:63], a[104:107], a[180:183], v[60:63]
 s_add_u32 m0, s29, 12288
 ds_read_b64_tr_b16 a[86:87], v9 offset:20480
 v_xor_b32 v10, 98400, v6
 v_mfma_f32_16x16x32_bf16 v[60:63], a[108:111], a[188:191], v[60:63]
 s_waitcnt lgkmcnt(6)
 ds_read_b64_tr_b16 a[88:89], v10 offset:0
 v_mfma_f32_16x16x32_bf16 v[20:23], a[64:67], a[160:163], v[20:23]
 ds_read_b64_tr_b16 a[90:91], v10 offset:4096
 buffer_load_dwordx4 v2, s[16:19], s50 offen lds
 v_mfma_f32_16x16x32_bf16 v[20:23], a[68:71], a[168:171], v[20:23]
 ds_read_b64_tr_b16 a[92:93], v10 offset:16384
 v_mfma_f32_16x16x32_bf16 v[20:23], a[72:75], a[176:179], v[20:23]
 s_waitcnt lgkmcnt(7)
 ds_read_b64_tr_b16 a[94:95], v10 offset:20480
 v_xor_b32 v7, 32896, v6
 v_mfma_f32_16x16x32_bf16 v[20:23], a[76:79], a[184:187], v[20:23]
 ds_read_b64_tr_b16 a[96:97], v7 offset:0
 v_mfma_f32_16x16x32_bf16 v[36:39], a[64:67], a[164:167], v[36:39]
 s_add_u32 m0, s29, 16384
 ds_read_b64_tr_b16 a[98:99], v7 offset:4096
 v_mfma_f32_16x16x32_bf16 v[36:39], a[68:71], a[172:175], v[36:39]
 ds_read_b64_tr_b16 a[100:101], v7 offset:16384
 buffer_load_dwordx4 v2, s[16:19], s51 offen lds
 v_mfma_f32_16x16x32_bf16 v[36:39], a[72:75], a[180:183], v[36:39]
 s_add_u32 s59, s56, 53248
 ds_read_b64_tr_b16 a[102:103], v7 offset:20480
 v_xor_b32 v8, 98432, v6
 v_mfma_f32_16x16x32_bf16 v[36:39], a[76:79], a[188:191], v[36:39]
 s_waitcnt lgkmcnt(6)
 ds_read_b64_tr_b16 a[104:105], v8 offset:0
 buffer_store_dwordx4 v[240:243], v1, s[12:15], s59 offen offset:3072 sc1
 v_mfma_f32_16x16x32_bf16 v[68:71], a[80:83], a[160:163], v[68:71]
 ds_read_b64_tr_b16 a[106:107], v8 offset:4096
 v_mfma_f32_16x16x32_bf16 v[68:71], a[84:87], a[168:171], v[68:71]
 s_add_u32 m0, s29, 20480
 ds_read_b64_tr_b16 a[108:109], v8 offset:16384
 v_mfma_f32_16x16x32_bf16 v[68:71], a[88:91], a[176:179], v[68:71]
 s_waitcnt lgkmcnt(7)
 ds_read_b64_tr_b16 a[110:111], v8 offset:20480
 v_xor_b32 v9, 32928, v6
 v_mfma_f32_16x16x32_bf16 v[68:71], a[92:95], a[184:187], v[68:71]
 ds_read_b64_tr_b16 a[64:65], v9 offset:0
 buffer_load_dwordx4 v2, s[16:19], s52 offen lds
 v_mfma_f32_16x16x32_bf16 v[76:79], a[80:83], a[164:167], v[76:79]
 ds_read_b64_tr_b16 a[66:67], v9 offset:4096
 v_mfma_f32_16x16x32_bf16 v[76:79], a[84:87], a[172:175], v[76:79]
 ds_read_b64_tr_b16 a[68:69], v9 offset:16384
 v_mfma_f32_16x16x32_bf16 v[76:79], a[88:91], a[180:183], v[76:79]
 s_add_u32 m0, s29, 24576
 ds_read_b64_tr_b16 a[70:71], v9 offset:20480
 v_xor_b32 v10, 98464, v6
 v_mfma_f32_16x16x32_bf16 v[76:79], a[92:95], a[188:191], v[76:79]
 s_waitcnt lgkmcnt(6)
 ds_read_b64_tr_b16 a[72:73], v10 offset:0
 v_mfma_f32_16x16x32_bf16 v[84:87], a[96:99], a[160:163], v[84:87]
 ds_read_b64_tr_b16 a[74:75], v10 offset:4096
 buffer_load_dwordx4 v2, s[16:19], s53 offen lds
 v_mfma_f32_16x16x32_bf16 v[84:87], a[100:103], a[168:171], v[84:87]
 s_add_u32 s59, s56, 36864
 ds_read_b64_tr_b16 a[76:77], v10 offset:16384
 v_mfma_f32_16x16x32_bf16 v[84:87], a[104:107], a[176:179], v[84:87]
 s_waitcnt lgkmcnt(7)
 ds_read_b64_tr_b16 a[78:79], v10 offset:20480
 v_xor_b32 v7, 32960, v6
 v_mfma_f32_16x16x32_bf16 v[84:87], a[108:111], a[184:187], v[84:87]
 ds_read_b64_tr_b16 a[80:81], v7 offset:0
 buffer_store_dwordx4 v[248:251], v1, s[12:15], s59 offen offset:3072 sc1
 v_mfma_f32_16x16x32_bf16 v[92:95], a[96:99], a[164:167], v[92:95]
 s_add_u32 m0, s29, 28672
 ds_read_b64_tr_b16 a[82:83], v7 offset:4096
 v_mfma_f32_16x16x32_bf16 v[92:95], a[100:103], a[172:175], v[92:95]
 ds_read_b64_tr_b16 a[84:85], v7 offset:16384
 buffer_load_dwordx4 v2, s[16:19], s54 offen lds
 v_mfma_f32_16x16x32_bf16 v[92:95], a[104:107], a[180:183], v[92:95]
 ds_read_b64_tr_b16 a[86:87], v7 offset:20480
 v_xor_b32 v8, 98496, v6
 v_mfma_f32_16x16x32_bf16 v[92:95], a[108:111], a[188:191], v[92:95]
 s_waitcnt lgkmcnt(6)
 ds_read_b64_tr_b16 a[88:89], v8 offset:0
 v_mfma_f32_16x16x32_bf16 v[100:103], a[64:67], a[160:163], v[100:103]
 s_add_u32 m0, s29, 65536
 ds_read_b64_tr_b16 a[90:91], v8 offset:4096
 v_add_u32 v2, 0x80000, v2
 v_mfma_f32_16x16x32_bf16 v[100:103], a[68:71], a[168:171], v[100:103]
 ds_read_b64_tr_b16 a[92:93], v8 offset:16384
 buffer_load_dwordx4 v2, s[16:19], 0 offen lds
 v_mfma_f32_16x16x32_bf16 v[100:103], a[72:75], a[176:179], v[100:103]
 s_waitcnt lgkmcnt(7)
 ds_read_b64_tr_b16 a[94:95], v8 offset:20480
 v_xor_b32 v9, 32992, v6
 v_mfma_f32_16x16x32_bf16 v[100:103], a[76:79], a[184:187], v[100:103]
 ds_read_b64_tr_b16 a[96:97], v9 offset:0
 v_mfma_f32_16x16x32_bf16 v[108:111], a[64:67], a[164:167], v[108:111]
 ds_read_b64_tr_b16 a[98:99], v9 offset:4096
 v_mfma_f32_16x16x32_bf16 v[108:111], a[68:71], a[172:175], v[108:111]
 ds_read_b64_tr_b16 a[100:101], v9 offset:16384
 v_mfma_f32_16x16x32_bf16 v[108:111], a[72:75], a[180:183], v[108:111]
 s_add_u32 m0, s29, 69632
 ds_read_b64_tr_b16 a[102:103], v9 offset:20480
 v_xor_b32 v10, 98528, v6
 v_mfma_f32_16x16x32_bf16 v[108:111], a[76:79], a[188:191], v[108:111]
 s_waitcnt lgkmcnt(6)
 ds_read_b64_tr_b16 a[104:105], v10 offset:0
 buffer_load_dwordx4 v2, s[16:19], s48 offen lds
 v_mfma_f32_16x16x32_bf16 v[116:119], a[80:83], a[160:163], v[116:119]
 ds_read_b64_tr_b16 a[106:107], v10 offset:4096
 v_mfma_f32_16x16x32_bf16 v[116:119], a[84:87], a[168:171], v[116:119]
 ds_read_b64_tr_b16 a[108:109], v10 offset:16384
 v_mfma_f32_16x16x32_bf16 v[116:119], a[88:91], a[176:179], v[116:119]
 s_waitcnt lgkmcnt(7)
 ds_read_b64_tr_b16 a[110:111], v10 offset:20480
 v_xor_b32 v7, 33024, v6
 v_mfma_f32_16x16x32_bf16 v[116:119], a[92:95], a[184:187], v[116:119]
 s_add_u32 m0, s29, 73728
 ds_read_b64_tr_b16 a[64:65], v7 offset:0
 v_mfma_f32_16x16x32_bf16 v[124:127], a[80:83], a[164:167], v[124:127]
 ds_read_b64_tr_b16 a[66:67], v7 offset:4096
 buffer_load_dwordx4 v2, s[16:19], s49 offen lds
 v_mfma_f32_16x16x32_bf16 v[124:127], a[84:87], a[172:175], v[124:127]
 ds_read_b64_tr_b16 a[68:69], v7 offset:16384
 v_mfma_f32_16x16x32_bf16 v[124:127], a[88:91], a[180:183], v[124:127]
 ds_read_b64_tr_b16 a[70:71], v7 offset:20480
 v_xor_b32 v8, 98560, v6
 v_mfma_f32_16x16x32_bf16 v[124:127], a[92:95], a[188:191], v[124:127]
 s_waitcnt lgkmcnt(6)
 ds_read_b64_tr_b16 a[72:73], v8 offset:0
 v_mfma_f32_16x16x32_bf16 v[132:135], a[96:99], a[160:163], v[132:135]
 s_add_u32 m0, s29, 77824
 ds_read_b64_tr_b16 a[74:75], v8 offset:4096
 v_mfma_f32_16x16x32_bf16 v[132:135], a[100:103], a[168:171], v[132:135]
 ds_read_b64_tr_b16 a[76:77], v8 offset:16384
 buffer_load_dwordx4 v2, s[16:19], s50 offen lds
 v_mfma_f32_16x16x32_bf16 v[132:135], a[104:107], a[176:179], v[132:135]
 s_waitcnt lgkmcnt(7)
 ds_read_b64_tr_b16 a[78:79], v8 offset:20480
 v_xor_b32 v9, 33056, v6
 v_mfma_f32_16x16x32_bf16 v[132:135], a[108:111], a[184:187], v[132:135]
 ds_read_b64_tr_b16 a[80:81], v9 offset:0
 v_mfma_f32_16x16x32_bf16 v[140:143], a[96:99], a[164:167], v[140:143]
 ds_read_b64_tr_b16 a[82:83], v9 offset:4096
 v_mfma_f32_16x16x32_bf16 v[140:143], a[100:103], a[172:175], v[140:143]
 ds_read_b64_tr_b16 a[84:85], v9 offset:16384
 v_mfma_f32_16x16x32_bf16 v[140:143], a[104:107], a[180:183], v[140:143]
 s_add_u32 m0, s29, 81920
 ds_read_b64_tr_b16 a[86:87], v9 offset:20480
 v_xor_b32 v10, 98592, v6
 v_mfma_f32_16x16x32_bf16 v[140:143], a[108:111], a[188:191], v[140:143]
 s_waitcnt lgkmcnt(6)
 ds_read_b64_tr_b16 a[88:89], v10 offset:0
 buffer_load_dwordx4 v2, s[16:19], s51 offen lds
 v_mfma_f32_16x16x32_bf16 v[148:151], a[64:67], a[160:163], v[148:151]
 ds_read_b64_tr_b16 a[90:91], v10 offset:4096
 v_mfma_f32_16x16x32_bf16 v[148:151], a[68:71], a[168:171], v[148:151]
 ds_read_b64_tr_b16 a[92:93], v10 offset:16384
 v_mfma_f32_16x16x32_bf16 v[148:151], a[72:75], a[176:179], v[148:151]
 s_waitcnt lgkmcnt(7)
 ds_read_b64_tr_b16 a[94:95], v10 offset:20480
 v_xor_b32 v7, 33088, v6
 v_mfma_f32_16x16x32_bf16 v[148:151], a[76:79], a[184:187], v[148:151]
 s_add_u32 m0, s29, 86016
 ds_read_b64_tr_b16 a[96:97], v7 offset:0
 v_mfma_f32_16x16x32_bf16 v[156:159], a[64:67], a[164:167], v[156:159]
 ds_read_b64_tr_b16 a[98:99], v7 offset:4096
 buffer_load_dwordx4 v2, s[16:19], s52 offen lds
 v_mfma_f32_16x16x32_bf16 v[156:159], a[68:71], a[172:175], v[156:159]
 ds_read_b64_tr_b16 a[100:101], v7 offset:16384
 v_mfma_f32_16x16x32_bf16 v[156:159], a[72:75], a[180:183], v[156:159]
 ds_read_b64_tr_b16 a[102:103], v7 offset:20480
 v_xor_b32 v8, 98624, v6
 v_mfma_f32_16x16x32_bf16 v[156:159], a[76:79], a[188:191], v[156:159]
 s_waitcnt lgkmcnt(6)
 ds_read_b64_tr_b16 a[104:105], v8 offset:0
 v_mfma_f32_16x16x32_bf16 v[164:167], a[80:83], a[160:163], v[164:167]
 s_add_u32 m0, s29, 90112
 ds_read_b64_tr_b16 a[106:107], v8 offset:4096
 v_mfma_f32_16x16x32_bf16 v[164:167], a[84:87], a[168:171], v[164:167]
 ds_read_b64_tr_b16 a[108:109], v8 offset:16384
 buffer_load_dwordx4 v2, s[16:19], s53 offen lds
 v_mfma_f32_16x16x32_bf16 v[164:167], a[88:91], a[176:179], v[164:167]
 s_waitcnt lgkmcnt(7)
 ds_read_b64_tr_b16 a[110:111], v8 offset:20480
 v_xor_b32 v9, 33120, v6
 v_mfma_f32_16x16x32_bf16 v[164:167], a[92:95], a[184:187], v[164:167]
 s_waitcnt vmcnt(8)
 ds_read_b64_tr_b16 a[64:65], v9 offset:0
 v_mfma_f32_16x16x32_bf16 v[172:175], a[80:83], a[164:167], v[172:175]
 s_barrier
 ds_read_b64_tr_b16 a[66:67], v9 offset:4096
 v_mfma_f32_16x16x32_bf16 v[172:175], a[84:87], a[172:175], v[172:175]
 ds_read_b64_tr_b16 a[68:69], v9 offset:16384
 buffer_store_dword v11, v11, s[12:15], s92 offen sc1
 v_mfma_f32_16x16x32_bf16 v[172:175], a[88:91], a[180:183], v[172:175]
 s_add_u32 m0, s29, 94208
 ds_read_b64_tr_b16 a[70:71], v9 offset:20480
 v_xor_b32 v10, 98656, v6
 v_mfma_f32_16x16x32_bf16 v[172:175], a[92:95], a[188:191], v[172:175]
 s_waitcnt lgkmcnt(6)
 ds_read_b64_tr_b16 a[72:73], v10 offset:0
 buffer_load_dwordx4 v2, s[16:19], s54 offen lds
 v_mfma_f32_16x16x32_bf16 v[180:183], a[96:99], a[160:163], v[180:183]
 ds_read_b64_tr_b16 a[74:75], v10 offset:4096
 v_mfma_f32_16x16x32_bf16 v[180:183], a[100:103], a[168:171], v[180:183]
 ds_read_b64_tr_b16 a[76:77], v10 offset:16384
 v_mfma_f32_16x16x32_bf16 v[180:183], a[104:107], a[176:179], v[180:183]
 s_waitcnt lgkmcnt(7)
 ds_read_b64_tr_b16 a[78:79], v10 offset:20480
 v_xor_b32 v7, 33152, v6
 v_mfma_f32_16x16x32_bf16 v[180:183], a[108:111], a[184:187], v[180:183]
 ds_read_b64_tr_b16 a[80:81], v7 offset:0
 v_mfma_f32_16x16x32_bf16 v[188:191], a[96:99], a[164:167], v[188:191]
 ds_read_b64_tr_b16 a[82:83], v7 offset:4096
 v_mfma_f32_16x16x32_bf16 v[188:191], a[100:103], a[172:175], v[188:191]
 ds_read_b64_tr_b16 a[84:85], v7 offset:16384
 v_mfma_f32_16x16x32_bf16 v[188:191], a[104:107], a[180:183], v[188:191]
 ds_read_b64_tr_b16 a[86:87], v7 offset:20480
 v_xor_b32 v8, 98688, v6
 v_mfma_f32_16x16x32_bf16 v[188:191], a[108:111], a[188:191], v[188:191]
 s_waitcnt lgkmcnt(6)
 ds_read_b64_tr_b16 a[88:89], v8 offset:0
 v_mfma_f32_16x16x32_bf16 v[196:199], a[64:67], a[160:163], v[196:199]
 s_and_b32 s58, s92, ~127
 ds_read_b64_tr_b16 a[90:91], v8 offset:4096
 v_mfma_f32_16x16x32_bf16 v[196:199], a[68:71], a[168:171], v[196:199]
 s_lshl_b32 s37, s25, 1
 ds_read_b64_tr_b16 a[92:93], v8 offset:16384
 v_mfma_f32_16x16x32_bf16 v[196:199], a[72:75], a[176:179], v[196:199]
 s_waitcnt lgkmcnt(7)
 ds_read_b64_tr_b16 a[94:95], v8 offset:20480
 v_xor_b32 v9, 33184, v6
 v_mfma_f32_16x16x32_bf16 v[196:199], a[76:79], a[184:187], v[196:199]
 s_sub_i32 s38, 12, s37
 ds_read_b64_tr_b16 a[96:97], v9 offset:0
 v_mfma_f32_16x16x32_bf16 v[204:207], a[64:67], a[164:167], v[204:207]
 s_max_i32 s38, s38, 0
 ds_read_b64_tr_b16 a[98:99], v9 offset:4096
 v_mfma_f32_16x16x32_bf16 v[204:207], a[68:71], a[172:175], v[204:207]
 s_mul_i32 s49, s26, 1048576
 ds_read_b64_tr_b16 a[100:101], v9 offset:16384
 v_mfma_f32_16x16x32_bf16 v[204:207], a[72:75], a[180:183], v[204:207]
 s_lshl_b32 s50, s3, 13
 ds_read_b64_tr_b16 a[102:103], v9 offset:20480
 v_xor_b32 v10, 98720, v6
 v_mfma_f32_16x16x32_bf16 v[204:207], a[76:79], a[188:191], v[204:207]
 s_waitcnt lgkmcnt(6)
 ds_read_b64_tr_b16 a[104:105], v10 offset:0
 v_mfma_f32_16x16x32_bf16 v[212:215], a[80:83], a[160:163], v[212:215]
 s_add_u32 s49, s49, s50
 ds_read_b64_tr_b16 a[106:107], v10 offset:4096
 v_mfma_f32_16x16x32_bf16 v[212:215], a[84:87], a[168:171], v[212:215]
 s_mov_b32 s54, 2
 ds_read_b64_tr_b16 a[108:109], v10 offset:16384
 v_mfma_f32_16x16x32_bf16 v[212:215], a[88:91], a[176:179], v[212:215]
 s_waitcnt lgkmcnt(7)
 ds_read_b64_tr_b16 a[110:111], v10 offset:20480
 v_xor_b32 v7, 33216, v6
 v_mfma_f32_16x16x32_bf16 v[212:215], a[92:95], a[184:187], v[212:215]
 s_sub_u32 s44, 31, s37
 ds_read_b64_tr_b16 a[64:65], v7 offset:0
 v_mfma_f32_16x16x32_bf16 v[220:223], a[80:83], a[164:167], v[220:223]
 s_sub_u32 s44, s44, s38
 ds_read_b64_tr_b16 a[66:67], v7 offset:4096
 v_mfma_f32_16x16x32_bf16 v[220:223], a[84:87], a[172:175], v[220:223]
 s_mul_i32 s55, s38, 32768
 ds_read_b64_tr_b16 a[68:69], v7 offset:16384
 v_mfma_f32_16x16x32_bf16 v[220:223], a[88:91], a[180:183], v[220:223]
 s_add_u32 s42, s55, s49
 ds_read_b64_tr_b16 a[70:71], v7 offset:20480
 v_xor_b32 v8, 98752, v6
 v_mfma_f32_16x16x32_bf16 v[220:223], a[92:95], a[188:191], v[220:223]
 s_waitcnt lgkmcnt(6)
 ds_read_b64_tr_b16 a[72:73], v8 offset:0
 buffer_load_dwordx4 v[32:35], v122, s[4:7], 0 offen
 v_mfma_f32_16x16x32_bf16 v[228:231], a[96:99], a[160:163], v[228:231]
 s_add_u32 s60, s58, 16
 ds_read_b64_tr_b16 a[74:75], v8 offset:4096
 v_mfma_f32_16x16x32_bf16 v[228:231], a[100:103], a[168:171], v[228:231]
 s_sub_u32 s45, 17, s37
 ds_read_b64_tr_b16 a[76:77], v8 offset:16384
 v_mfma_f32_16x16x32_bf16 v[228:231], a[104:107], a[176:179], v[228:231]
 s_waitcnt lgkmcnt(7)
 ds_read_b64_tr_b16 a[78:79], v8 offset:20480
 v_xor_b32 v9, 33248, v6
 v_mfma_f32_16x16x32_bf16 v[228:231], a[108:111], a[184:187], v[228:231]
 ds_read_b64_tr_b16 a[80:81], v9 offset:0
 buffer_load_dwordx4 v[40:43], v123, s[4:7], 0 offen
 v_mfma_f32_16x16x32_bf16 v[236:239], a[96:99], a[164:167], v[236:239]
 s_sub_u32 s66, s42, 32768
 ds_read_b64_tr_b16 a[82:83], v9 offset:4096
 v_mfma_f32_16x16x32_bf16 v[236:239], a[100:103], a[172:175], v[236:239]
 s_add_u32 s42, s49, 491520
 ds_read_b64_tr_b16 a[84:85], v9 offset:16384
 v_mfma_f32_16x16x32_bf16 v[236:239], a[104:107], a[180:183], v[236:239]
 s_add_u32 s67, s49, 524288
 ds_read_b64_tr_b16 a[86:87], v9 offset:20480
 v_xor_b32 v10, 98784, v6
 v_mfma_f32_16x16x32_bf16 v[236:239], a[108:111], a[188:191], v[236:239]
 s_waitcnt lgkmcnt(6)
 ds_read_b64_tr_b16 a[88:89], v10 offset:0
 buffer_load_dwordx4 v[48:51], v128, s[4:7], 0 offen
 v_mfma_f32_16x16x32_bf16 v[244:247], a[64:67], a[160:163], v[244:247]
 s_add_u32 s68, s66, 16777216
 ds_read_b64_tr_b16 a[90:91], v10 offset:4096
 v_mfma_f32_16x16x32_bf16 v[244:247], a[68:71], a[168:171], v[244:247]
 s_waitcnt vmcnt(3)
 ds_read_b64_tr_b16 a[92:93], v10 offset:16384
 v_xor_b32 v7, 131072, v6
 v_mfma_f32_16x16x32_bf16 v[244:247], a[72:75], a[176:179], v[244:247]
 s_waitcnt lgkmcnt(7)
 s_barrier
 ds_read_b64_tr_b16 a[94:95], v10 offset:20480
 v_mfma_f32_16x16x32_bf16 v[244:247], a[76:79], a[184:187], v[244:247]
 ds_read_b64_tr_b16 a[96:97], v7 offset:0
 buffer_load_dwordx4 v[56:59], v120, s[4:7], 0 offen offset:0
 v_mfma_f32_16x16x32_bf16 v[252:255], a[64:67], a[164:167], v[252:255]
 s_add_u32 s69, s67, 16777216
 ds_read_b64_tr_b16 a[98:99], v7 offset:4096
 v_mfma_f32_16x16x32_bf16 v[252:255], a[68:71], a[172:175], v[252:255]
 s_mov_b32 s70, 0xffff8000
 ds_read_b64_tr_b16 a[100:101], v7 offset:16384
 v_accvgpr_read_b32 v5, a248
 v_mfma_f32_16x16x32_bf16 v[252:255], a[72:75], a[180:183], v[252:255]
 s_mov_b32 s71, s70
 ds_read_b64_tr_b16 a[102:103], v7 offset:20480
 v_xor_b32 v8, 0, v6
 v_mfma_f32_16x16x32_bf16 v[252:255], a[76:79], a[188:191], v[252:255]
 s_waitcnt lgkmcnt(6)
 ds_read_b64_tr_b16 a[104:105], v8 offset:0
 buffer_load_dwordx4 v[64:67], v120, s[4:7], 0 offen offset:896
 v_mfma_f32_16x16x32_bf16 v[16:19], a[80:83], a[160:163], v[16:19]
 s_add_u32 s43, s42, 16777216
 ds_read_b64_tr_b16 a[106:107], v8 offset:4096
 v_mfma_f32_16x16x32_bf16 v[16:19], a[84:87], a[168:171], v[16:19]
 s_mov_b32 s40, s50
 ds_read_b64_tr_b16 a[108:109], v8 offset:16384
 v_mfma_f32_16x16x32_bf16 v[16:19], a[88:91], a[176:179], v[16:19]
 s_waitcnt lgkmcnt(7)
 ds_read_b64_tr_b16 a[110:111], v8 offset:20480
 v_xor_b32 v9, 65536, v6
 v_mfma_f32_16x16x32_bf16 v[16:19], a[92:95], a[184:187], v[16:19]
 ds_read_b64_tr_b16 a[64:65], v9 offset:0
 buffer_load_dwordx4 v[72:75], v120, s[8:11], 0 offen offset:0
 v_mfma_f32_16x16x32_bf16 v[24:27], a[80:83], a[164:167], v[24:27]
 s_add_u32 s41, s50, 0x10000
 ds_read_b64_tr_b16 a[66:67], v9 offset:4096
 v_mfma_f32_16x16x32_bf16 v[24:27], a[84:87], a[172:175], v[24:27]
 s_lshr_b32 s61, s95, 4
 ds_read_b64_tr_b16 a[68:69], v9 offset:16384
 v_mfma_f32_16x16x32_bf16 v[24:27], a[88:91], a[180:183], v[24:27]
 s_lshl_b32 s61, s61, 7
 ds_read_b64_tr_b16 a[70:71], v9 offset:20480
 v_xor_b32 v10, 131104, v6
 v_mfma_f32_16x16x32_bf16 v[24:27], a[92:95], a[188:191], v[24:27]
 s_waitcnt lgkmcnt(6)
 ds_read_b64_tr_b16 a[72:73], v10 offset:0
 buffer_load_dwordx4 v[80:83], v120, s[8:11], 0 offen offset:896
 v_mfma_f32_16x16x32_bf16 v[28:31], a[96:99], a[192:195], v[28:31]
 s_add_u32 s61, s61, 84959232
 ds_read_b64_tr_b16 a[74:75], v10 offset:4096
 v_mfma_f32_16x16x32_bf16 v[28:31], a[100:103], a[200:203], v[28:31]
 s_mov_b32 s47, 0x4b800000
 ds_read_b64_tr_b16 a[76:77], v10 offset:16384
 v_mfma_f32_16x16x32_bf16 v[28:31], a[104:107], a[208:211], v[28:31]
 s_waitcnt lgkmcnt(3)
 ds_read_b64_tr_b16 a[78:79], v10 offset:20480
 v_xor_b32 v7, 32, v6
 v_mfma_f32_16x16x32_bf16 v[28:31], a[108:111], a[216:219], v[28:31]
 ds_read_b64_tr_b16 a[80:81], v7 offset:0
 buffer_load_dwordx4 v[88:91], v121, s[20:23], s39 offen offset:0
 v_mfma_f32_16x16x32_bf16 v[28:31], a[64:67], a[112:115], v[28:31]
 s_lshl_b32 s30, s95, 1
 ds_read_b64_tr_b16 a[82:83], v7 offset:4096
 v_mfma_f32_16x16x32_bf16 v[28:31], a[68:71], a[120:123], v[28:31]
 s_lshr_b32 s31, s3, 1
 ds_read_b64_tr_b16 a[84:85], v7 offset:16384
 v_mfma_f32_16x16x32_bf16 v[44:47], a[96:99], a[196:199], v[44:47]
 s_add_u32 s30, s30, s31
 ds_read_b64_tr_b16 a[86:87], v7 offset:20480
 v_xor_b32 v8, 65568, v6
 v_mfma_f32_16x16x32_bf16 v[44:47], a[100:103], a[204:207], v[44:47]
 ds_read_b64_tr_b16 a[88:89], v8 offset:0
 buffer_load_dwordx4 v[96:99], v121, s[20:23], s39 offen offset:16
 v_mfma_f32_16x16x32_bf16 v[44:47], a[104:107], a[212:215], v[44:47]
 s_min_u32 s30, s30, 223
 ds_read_b64_tr_b16 a[90:91], v8 offset:4096
 v_mfma_f32_16x16x32_bf16 v[44:47], a[108:111], a[220:223], v[44:47]
 s_lshl_b32 s30, s30, 2
 ds_read_b64_tr_b16 a[92:93], v8 offset:16384
 v_mfma_f32_16x16x32_bf16 v[44:47], a[64:67], a[116:119], v[44:47]
 s_lshl_b32 s53, s3, 4
 ds_read_b64_tr_b16 a[94:95], v8 offset:20480
 v_xor_b32 v9, 131136, v6
 v_mfma_f32_16x16x32_bf16 v[44:47], a[68:71], a[124:127], v[44:47]
 s_waitcnt lgkmcnt(6)
 ds_read_b64_tr_b16 a[96:97], v9 offset:0
 buffer_load_dwordx4 v[104:107], v121, s[20:23], s39 offen offset:32
 v_mfma_f32_16x16x32_bf16 v[52:55], a[72:75], a[192:195], v[52:55]
 ds_read_b64_tr_b16 a[98:99], v9 offset:4096
 v_mfma_f32_16x16x32_bf16 v[52:55], a[76:79], a[200:203], v[52:55]
 ds_read_b64_tr_b16 a[100:101], v9 offset:16384
 v_mfma_f32_16x16x32_bf16 v[52:55], a[80:83], a[208:211], v[52:55]
 s_waitcnt lgkmcnt(3)
 ds_read_b64_tr_b16 a[102:103], v9 offset:20480
 v_xor_b32 v10, 64, v6
 v_mfma_f32_16x16x32_bf16 v[52:55], a[84:87], a[216:219], v[52:55]
 ds_read_b64_tr_b16 a[104:105], v10 offset:0
 buffer_load_dwordx4 v[112:115], v121, s[20:23], s39 offen offset:48
 v_mfma_f32_16x16x32_bf16 v[52:55], a[88:91], a[112:115], v[52:55]
 ds_read_b64_tr_b16 a[106:107], v10 offset:4096
 v_mfma_f32_16x16x32_bf16 v[52:55], a[92:95], a[120:123], v[52:55]
 ds_read_b64_tr_b16 a[108:109], v10 offset:16384
 v_mfma_f32_16x16x32_bf16 v[60:63], a[72:75], a[196:199], v[60:63]
 ds_read_b64_tr_b16 a[110:111], v10 offset:20480
 v_xor_b32 v7, 65600, v6
 v_mfma_f32_16x16x32_bf16 v[60:63], a[76:79], a[204:207], v[60:63]
 ds_read_b64_tr_b16 a[64:65], v7 offset:0
 v_mfma_f32_16x16x32_bf16 v[60:63], a[80:83], a[212:215], v[60:63]
 ds_read_b64_tr_b16 a[66:67], v7 offset:4096
 v_mfma_f32_16x16x32_bf16 v[60:63], a[84:87], a[220:223], v[60:63]
 ds_read_b64_tr_b16 a[68:69], v7 offset:16384
 v_mfma_f32_16x16x32_bf16 v[60:63], a[88:91], a[116:119], v[60:63]
 ds_read_b64_tr_b16 a[70:71], v7 offset:20480
 v_xor_b32 v8, 131168, v6
 v_mfma_f32_16x16x32_bf16 v[60:63], a[92:95], a[124:127], v[60:63]
 s_waitcnt lgkmcnt(6)
 ds_read_b64_tr_b16 a[72:73], v8 offset:0
 v_mfma_f32_16x16x32_bf16 v[20:23], a[96:99], a[192:195], v[20:23]
 ds_read_b64_tr_b16 a[74:75], v8 offset:4096
 v_mfma_f32_16x16x32_bf16 v[20:23], a[100:103], a[200:203], v[20:23]
 ds_read_b64_tr_b16 a[76:77], v8 offset:16384
 v_mul_f32 v28, s34, v28
 v_mfma_f32_16x16x32_bf16 v[20:23], a[104:107], a[208:211], v[20:23]
 s_waitcnt lgkmcnt(3)
 ds_read_b64_tr_b16 a[78:79], v8 offset:20480
 v_xor_b32 v9, 96, v6
 v_mfma_f32_16x16x32_bf16 v[20:23], a[108:111], a[216:219], v[20:23]
 ds_read_b64_tr_b16 a[80:81], v9 offset:0
 v_mul_f32 v29, s34, v29
 v_mfma_f32_16x16x32_bf16 v[20:23], a[64:67], a[112:115], v[20:23]
 ds_read_b64_tr_b16 a[82:83], v9 offset:4096
 v_mul_f32 v30, s34, v30
 v_mfma_f32_16x16x32_bf16 v[20:23], a[68:71], a[120:123], v[20:23]
 ds_read_b64_tr_b16 a[84:85], v9 offset:16384
 v_mul_f32 v31, s34, v31
 v_mfma_f32_16x16x32_bf16 v[36:39], a[96:99], a[196:199], v[36:39]
 ds_read_b64_tr_b16 a[86:87], v9 offset:20480
 v_xor_b32 v10, 65632, v6
 v_mfma_f32_16x16x32_bf16 v[36:39], a[100:103], a[204:207], v[36:39]
 ds_read_b64_tr_b16 a[88:89], v10 offset:0
 v_mul_f32 v52, s34, v52
 v_mfma_f32_16x16x32_bf16 v[36:39], a[104:107], a[212:215], v[36:39]
 ds_read_b64_tr_b16 a[90:91], v10 offset:4096
 v_mul_f32 v53, s34, v53
 v_mfma_f32_16x16x32_bf16 v[36:39], a[108:111], a[220:223], v[36:39]
 ds_read_b64_tr_b16 a[92:93], v10 offset:16384
 v_mul_f32 v54, s34, v54
 v_mfma_f32_16x16x32_bf16 v[36:39], a[64:67], a[116:119], v[36:39]
 ds_read_b64_tr_b16 a[94:95], v10 offset:20480
 v_xor_b32 v7, 131200, v6
 v_mfma_f32_16x16x32_bf16 v[36:39], a[68:71], a[124:127], v[36:39]
 s_waitcnt lgkmcnt(6)
 ds_read_b64_tr_b16 a[96:97], v7 offset:0
 v_mul_f32 v55, s34, v55
 v_mfma_f32_16x16x32_bf16 v[68:71], a[72:75], a[192:195], v[68:71]
 ds_read_b64_tr_b16 a[98:99], v7 offset:4096
 v_cvt_pk_bf16_f32 v28, v28, v29
 v_mfma_f32_16x16x32_bf16 v[68:71], a[76:79], a[200:203], v[68:71]
 ds_read_b64_tr_b16 a[100:101], v7 offset:16384
 v_cvt_pk_bf16_f32 v29, v30, v31
 v_mfma_f32_16x16x32_bf16 v[68:71], a[80:83], a[208:211], v[68:71]
 s_waitcnt lgkmcnt(3)
 ds_read_b64_tr_b16 a[102:103], v7 offset:20480
 v_xor_b32 v8, 128, v6
 v_mfma_f32_16x16x32_bf16 v[68:71], a[84:87], a[216:219], v[68:71]
 ds_read_b64_tr_b16 a[104:105], v8 offset:0
 v_cvt_pk_bf16_f32 v30, v52, v53
 v_mfma_f32_16x16x32_bf16 v[68:71], a[88:91], a[112:115], v[68:71]
 s_add_u32 s59, s62, 0
 ds_read_b64_tr_b16 a[106:107], v8 offset:4096
 v_cvt_pk_bf16_f32 v31, v54, v55
 v_mfma_f32_16x16x32_bf16 v[68:71], a[92:95], a[120:123], v[68:71]
 ds_read_b64_tr_b16 a[108:109], v8 offset:16384
 buffer_store_dwordx4 v[28:31], v1, s[12:15], s59 offen offset:0 sc1
 v_mfma_f32_16x16x32_bf16 v[76:79], a[72:75], a[196:199], v[76:79]
 ds_read_b64_tr_b16 a[110:111], v8 offset:20480
 v_xor_b32 v9, 65664, v6
 v_mfma_f32_16x16x32_bf16 v[76:79], a[76:79], a[204:207], v[76:79]
 ds_read_b64_tr_b16 a[64:65], v9 offset:0
 v_accvgpr_write_b32 a0, v28
 v_mfma_f32_16x16x32_bf16 v[76:79], a[80:83], a[212:215], v[76:79]
 ds_read_b64_tr_b16 a[66:67], v9 offset:4096
 v_accvgpr_write_b32 a1, v29
 v_mfma_f32_16x16x32_bf16 v[76:79], a[84:87], a[220:223], v[76:79]
 ds_read_b64_tr_b16 a[68:69], v9 offset:16384
 v_accvgpr_write_b32 a2, v30
 v_mfma_f32_16x16x32_bf16 v[76:79], a[88:91], a[116:119], v[76:79]
 ds_read_b64_tr_b16 a[70:71], v9 offset:20480
 v_xor_b32 v10, 131232, v6
 v_mfma_f32_16x16x32_bf16 v[76:79], a[92:95], a[124:127], v[76:79]
 s_waitcnt lgkmcnt(6)
 ds_read_b64_tr_b16 a[72:73], v10 offset:0
 v_accvgpr_write_b32 a3, v31
 v_mfma_f32_16x16x32_bf16 v[84:87], a[96:99], a[192:195], v[84:87]
 ds_read_b64_tr_b16 a[74:75], v10 offset:4096
 v_mul_f32 v44, s34, v44
 v_mfma_f32_16x16x32_bf16 v[84:87], a[100:103], a[200:203], v[84:87]
 ds_read_b64_tr_b16 a[76:77], v10 offset:16384
 v_mul_f32 v45, s34, v45
 v_mfma_f32_16x16x32_bf16 v[84:87], a[104:107], a[208:211], v[84:87]
 s_waitcnt lgkmcnt(3)
 ds_read_b64_tr_b16 a[78:79], v10 offset:20480
 v_xor_b32 v7, 160, v6
 v_mfma_f32_16x16x32_bf16 v[84:87], a[108:111], a[216:219], v[84:87]
 ds_read_b64_tr_b16 a[80:81], v7 offset:0
 v_mul_f32 v46, s34, v46
 v_mfma_f32_16x16x32_bf16 v[84:87], a[64:67], a[112:115], v[84:87]
 ds_read_b64_tr_b16 a[82:83], v7 offset:4096
 v_mul_f32 v47, s34, v47
 v_mfma_f32_16x16x32_bf16 v[84:87], a[68:71], a[120:123], v[84:87]
 ds_read_b64_tr_b16 a[84:85], v7 offset:16384
 v_mul_f32 v60, s34, v60
 v_mfma_f32_16x16x32_bf16 v[92:95], a[96:99], a[196:199], v[92:95]
 ds_read_b64_tr_b16 a[86:87], v7 offset:20480
 v_xor_b32 v8, 65696, v6
 v_mfma_f32_16x16x32_bf16 v[92:95], a[100:103], a[204:207], v[92:95]
 ds_read_b64_tr_b16 a[88:89], v8 offset:0
 v_mul_f32 v61, s34, v61
 v_mfma_f32_16x16x32_bf16 v[92:95], a[104:107], a[212:215], v[92:95]
 ds_read_b64_tr_b16 a[90:91], v8 offset:4096
 v_mul_f32 v62, s34, v62
 v_mfma_f32_16x16x32_bf16 v[92:95], a[108:111], a[220:223], v[92:95]
 ds_read_b64_tr_b16 a[92:93], v8 offset:16384
 v_mul_f32 v63, s34, v63
 v_mfma_f32_16x16x32_bf16 v[92:95], a[64:67], a[116:119], v[92:95]
 ds_read_b64_tr_b16 a[94:95], v8 offset:20480
 v_xor_b32 v9, 131264, v6
 v_mfma_f32_16x16x32_bf16 v[92:95], a[68:71], a[124:127], v[92:95]
 s_waitcnt lgkmcnt(6)
 ds_read_b64_tr_b16 a[96:97], v9 offset:0
 v_cvt_pk_bf16_f32 v44, v44, v45
 v_mfma_f32_16x16x32_bf16 v[100:103], a[72:75], a[192:195], v[100:103]
 ds_read_b64_tr_b16 a[98:99], v9 offset:4096
 v_cvt_pk_bf16_f32 v45, v46, v47
 v_mfma_f32_16x16x32_bf16 v[100:103], a[76:79], a[200:203], v[100:103]
 ds_read_b64_tr_b16 a[100:101], v9 offset:16384
 v_cvt_pk_bf16_f32 v46, v60, v61
 v_mfma_f32_16x16x32_bf16 v[100:103], a[80:83], a[208:211], v[100:103]
 s_waitcnt lgkmcnt(3)
 ds_read_b64_tr_b16 a[102:103], v9 offset:20480
 v_xor_b32 v10, 192, v6
 v_mfma_f32_16x16x32_bf16 v[100:103], a[84:87], a[216:219], v[100:103]
 s_add_u32 s59, s62, 8192
 ds_read_b64_tr_b16 a[104:105], v10 offset:0
 v_cvt_pk_bf16_f32 v47, v62, v63
 v_mfma_f32_16x16x32_bf16 v[100:103], a[88:91], a[112:115], v[100:103]
 ds_read_b64_tr_b16 a[106:107], v10 offset:4096
 buffer_store_dwordx4 v[44:47], v1, s[12:15], s59 offen offset:0 sc1
 v_mfma_f32_16x16x32_bf16 v[100:103], a[92:95], a[120:123], v[100:103]
 ds_read_b64_tr_b16 a[108:109], v10 offset:16384
 v_accvgpr_write_b32 a32, v44
 v_mfma_f32_16x16x32_bf16 v[108:111], a[72:75], a[196:199], v[108:111]
 ds_read_b64_tr_b16 a[110:111], v10 offset:20480
 v_xor_b32 v7, 65728, v6
 v_mfma_f32_16x16x32_bf16 v[108:111], a[76:79], a[204:207], v[108:111]
 ds_read_b64_tr_b16 a[64:65], v7 offset:0
 v_accvgpr_write_b32 a33, v45
 v_mfma_f32_16x16x32_bf16 v[108:111], a[80:83], a[212:215], v[108:111]
 ds_read_b64_tr_b16 a[66:67], v7 offset:4096
 v_accvgpr_write_b32 a34, v46
 v_mfma_f32_16x16x32_bf16 v[108:111], a[84:87], a[220:223], v[108:111]
 ds_read_b64_tr_b16 a[68:69], v7 offset:16384
 v_accvgpr_write_b32 a35, v47
 v_mfma_f32_16x16x32_bf16 v[108:111], a[88:91], a[116:119], v[108:111]
 ds_read_b64_tr_b16 a[70:71], v7 offset:20480
 v_xor_b32 v8, 131296, v6
 v_mfma_f32_16x16x32_bf16 v[108:111], a[92:95], a[124:127], v[108:111]
 s_waitcnt lgkmcnt(6)
 ds_read_b64_tr_b16 a[72:73], v8 offset:0
 v_mul_f32 v20, s34, v20
 v_mfma_f32_16x16x32_bf16 v[116:119], a[96:99], a[192:195], v[116:119]
 ds_read_b64_tr_b16 a[74:75], v8 offset:4096
 v_mul_f32 v21, s34, v21
 v_mfma_f32_16x16x32_bf16 v[116:119], a[100:103], a[200:203], v[116:119]
 ds_read_b64_tr_b16 a[76:77], v8 offset:16384
 v_mul_f32 v22, s34, v22
 v_mfma_f32_16x16x32_bf16 v[116:119], a[104:107], a[208:211], v[116:119]
 s_waitcnt lgkmcnt(3)
 ds_read_b64_tr_b16 a[78:79], v8 offset:20480
 v_xor_b32 v9, 224, v6
 v_mfma_f32_16x16x32_bf16 v[116:119], a[108:111], a[216:219], v[116:119]
 ds_read_b64_tr_b16 a[80:81], v9 offset:0
 v_mul_f32 v23, s34, v23
 v_mfma_f32_16x16x32_bf16 v[116:119], a[64:67], a[112:115], v[116:119]
 ds_read_b64_tr_b16 a[82:83], v9 offset:4096
 v_mul_f32 v68, s34, v68
 v_mfma_f32_16x16x32_bf16 v[116:119], a[68:71], a[120:123], v[116:119]
 ds_read_b64_tr_b16 a[84:85], v9 offset:16384
 v_mul_f32 v69, s34, v69
 v_mfma_f32_16x16x32_bf16 v[124:127], a[96:99], a[196:199], v[124:127]
 ds_read_b64_tr_b16 a[86:87], v9 offset:20480
 v_xor_b32 v10, 65760, v6
 v_mfma_f32_16x16x32_bf16 v[124:127], a[100:103], a[204:207], v[124:127]
 ds_read_b64_tr_b16 a[88:89], v10 offset:0
 v_mul_f32 v70, s34, v70
 v_mfma_f32_16x16x32_bf16 v[124:127], a[104:107], a[212:215], v[124:127]
 ds_read_b64_tr_b16 a[90:91], v10 offset:4096
 v_mul_f32 v71, s34, v71
 v_mfma_f32_16x16x32_bf16 v[124:127], a[108:111], a[220:223], v[124:127]
 ds_read_b64_tr_b16 a[92:93], v10 offset:16384
 v_cvt_pk_bf16_f32 v20, v20, v21
 v_mfma_f32_16x16x32_bf16 v[124:127], a[64:67], a[116:119], v[124:127]
 ds_read_b64_tr_b16 a[94:95], v10 offset:20480
 v_xor_b32 v7, 131328, v6
 v_mfma_f32_16x16x32_bf16 v[124:127], a[68:71], a[124:127], v[124:127]
 s_waitcnt lgkmcnt(6)
 ds_read_b64_tr_b16 a[96:97], v7 offset:0
 v_cvt_pk_bf16_f32 v21, v22, v23
 v_mfma_f32_16x16x32_bf16 v[132:135], a[72:75], a[192:195], v[132:135]
 ds_read_b64_tr_b16 a[98:99], v7 offset:4096
 v_cvt_pk_bf16_f32 v22, v68, v69
 v_mfma_f32_16x16x32_bf16 v[132:135], a[76:79], a[200:203], v[132:135]
 s_add_u32 s59, s62, 0
 ds_read_b64_tr_b16 a[100:101], v7 offset:16384
 v_cvt_pk_bf16_f32 v23, v70, v71
 v_mfma_f32_16x16x32_bf16 v[132:135], a[80:83], a[208:211], v[132:135]
 s_waitcnt lgkmcnt(3)
 ds_read_b64_tr_b16 a[102:103], v7 offset:20480
 v_xor_b32 v8, 256, v6
 v_mfma_f32_16x16x32_bf16 v[132:135], a[84:87], a[216:219], v[132:135]
 ds_read_b64_tr_b16 a[104:105], v8 offset:0
 buffer_store_dwordx4 v[20:23], v1, s[12:15], s59 offen offset:1024 sc1
 v_mfma_f32_16x16x32_bf16 v[132:135], a[88:91], a[112:115], v[132:135]
 ds_read_b64_tr_b16 a[106:107], v8 offset:4096
 v_accvgpr_write_b32 a4, v20
 v_mfma_f32_16x16x32_bf16 v[132:135], a[92:95], a[120:123], v[132:135]
 ds_read_b64_tr_b16 a[108:109], v8 offset:16384
 v_accvgpr_write_b32 a5, v21
 v_mfma_f32_16x16x32_bf16 v[140:143], a[72:75], a[196:199], v[140:143]
 ds_read_b64_tr_b16 a[110:111], v8 offset:20480
 v_xor_b32 v9, 65792, v6
 v_mfma_f32_16x16x32_bf16 v[140:143], a[76:79], a[204:207], v[140:143]
 ds_read_b64_tr_b16 a[64:65], v9 offset:0
 v_accvgpr_write_b32 a6, v22
 v_mfma_f32_16x16x32_bf16 v[140:143], a[80:83], a[212:215], v[140:143]
 ds_read_b64_tr_b16 a[66:67], v9 offset:4096
 v_accvgpr_write_b32 a7, v23
 v_mfma_f32_16x16x32_bf16 v[140:143], a[84:87], a[220:223], v[140:143]
 ds_read_b64_tr_b16 a[68:69], v9 offset:16384
 v_mul_f32 v36, s34, v36
 v_mfma_f32_16x16x32_bf16 v[140:143], a[88:91], a[116:119], v[140:143]
 ds_read_b64_tr_b16 a[70:71], v9 offset:20480
 v_xor_b32 v10, 131360, v6
 v_mfma_f32_16x16x32_bf16 v[140:143], a[92:95], a[124:127], v[140:143]
 s_waitcnt lgkmcnt(6)
 ds_read_b64_tr_b16 a[72:73], v10 offset:0
 v_mul_f32 v37, s34, v37
 v_mfma_f32_16x16x32_bf16 v[148:151], a[96:99], a[192:195], v[148:151]
 ds_read_b64_tr_b16 a[74:75], v10 offset:4096
 v_mul_f32 v38, s34, v38
 v_mfma_f32_16x16x32_bf16 v[148:151], a[100:103], a[200:203], v[148:151]
 ds_read_b64_tr_b16 a[76:77], v10 offset:16384
 v_mul_f32 v39, s34, v39
 v_mfma_f32_16x16x32_bf16 v[148:151], a[104:107], a[208:211], v[148:151]
 s_waitcnt lgkmcnt(3)
 ds_read_b64_tr_b16 a[78:79], v10 offset:20480
 v_xor_b32 v7, 288, v6
 v_mfma_f32_16x16x32_bf16 v[148:151], a[108:111], a[216:219], v[148:151]
 ds_read_b64_tr_b16 a[80:81], v7 offset:0
 v_mul_f32 v76, s34, v76
 v_mfma_f32_16x16x32_bf16 v[148:151], a[64:67], a[112:115], v[148:151]
 ds_read_b64_tr_b16 a[82:83], v7 offset:4096
 v_mul_f32 v77, s34, v77
 v_mfma_f32_16x16x32_bf16 v[148:151], a[68:71], a[120:123], v[148:151]
 ds_read_b64_tr_b16 a[84:85], v7 offset:16384
 v_mul_f32 v78, s34, v78
 v_mfma_f32_16x16x32_bf16 v[156:159], a[96:99], a[196:199], v[156:159]
 ds_read_b64_tr_b16 a[86:87], v7 offset:20480
 v_xor_b32 v8, 65824, v6
 v_mfma_f32_16x16x32_bf16 v[156:159], a[100:103], a[204:207], v[156:159]
 ds_read_b64_tr_b16 a[88:89], v8 offset:0
 v_mul_f32 v79, s34, v79
 v_mfma_f32_16x16x32_bf16 v[156:159], a[104:107], a[212:215], v[156:159]
 ds_read_b64_tr_b16 a[90:91], v8 offset:4096
 v_cvt_pk_bf16_f32 v36, v36, v37
 v_mfma_f32_16x16x32_bf16 v[156:159], a[108:111], a[220:223], v[156:159]
 ds_read_b64_tr_b16 a[92:93], v8 offset:16384
 v_cvt_pk_bf16_f32 v37, v38, v39
 v_mfma_f32_16x16x32_bf16 v[156:159], a[64:67], a[116:119], v[156:159]
 ds_read_b64_tr_b16 a[94:95], v8 offset:20480
 v_xor_b32 v9, 131392, v6
 v_mfma_f32_16x16x32_bf16 v[156:159], a[68:71], a[124:127], v[156:159]
 s_waitcnt lgkmcnt(6)
 ds_read_b64_tr_b16 a[96:97], v9 offset:0
 v_cvt_pk_bf16_f32 v38, v76, v77
 v_mfma_f32_16x16x32_bf16 v[164:167], a[72:75], a[192:195], v[164:167]
 s_add_u32 s59, s62, 8192
 ds_read_b64_tr_b16 a[98:99], v9 offset:4096
 v_cvt_pk_bf16_f32 v39, v78, v79
 v_mfma_f32_16x16x32_bf16 v[164:167], a[76:79], a[200:203], v[164:167]
 ds_read_b64_tr_b16 a[100:101], v9 offset:16384
 buffer_store_dwordx4 v[36:39], v1, s[12:15], s59 offen offset:1024 sc1
 v_mfma_f32_16x16x32_bf16 v[164:167], a[80:83], a[208:211], v[164:167]
 s_waitcnt lgkmcnt(3)
 ds_read_b64_tr_b16 a[102:103], v9 offset:20480
 v_xor_b32 v10, 320, v6
 v_mfma_f32_16x16x32_bf16 v[164:167], a[84:87], a[216:219], v[164:167]
 ds_read_b64_tr_b16 a[104:105], v10 offset:0
 v_accvgpr_write_b32 a36, v36
 v_mfma_f32_16x16x32_bf16 v[164:167], a[88:91], a[112:115], v[164:167]
 ds_read_b64_tr_b16 a[106:107], v10 offset:4096
 v_accvgpr_write_b32 a37, v37
 v_mfma_f32_16x16x32_bf16 v[164:167], a[92:95], a[120:123], v[164:167]
 ds_read_b64_tr_b16 a[108:109], v10 offset:16384
 v_accvgpr_write_b32 a38, v38
 v_mfma_f32_16x16x32_bf16 v[172:175], a[72:75], a[196:199], v[172:175]
 ds_read_b64_tr_b16 a[110:111], v10 offset:20480
 v_xor_b32 v7, 65856, v6
 v_mfma_f32_16x16x32_bf16 v[172:175], a[76:79], a[204:207], v[172:175]
 ds_read_b64_tr_b16 a[64:65], v7 offset:0
 v_accvgpr_write_b32 a39, v39
 v_mfma_f32_16x16x32_bf16 v[172:175], a[80:83], a[212:215], v[172:175]
 ds_read_b64_tr_b16 a[66:67], v7 offset:4096
 v_mul_f32 v84, s34, v84
 v_mfma_f32_16x16x32_bf16 v[172:175], a[84:87], a[220:223], v[172:175]
 ds_read_b64_tr_b16 a[68:69], v7 offset:16384
 v_mul_f32 v85, s34, v85
 v_mfma_f32_16x16x32_bf16 v[172:175], a[88:91], a[116:119], v[172:175]
 ds_read_b64_tr_b16 a[70:71], v7 offset:20480
 v_xor_b32 v8, 131424, v6
 v_mfma_f32_16x16x32_bf16 v[172:175], a[92:95], a[124:127], v[172:175]
 s_waitcnt lgkmcnt(6)
 ds_read_b64_tr_b16 a[72:73], v8 offset:0
 v_mul_f32 v86, s34, v86
 v_mfma_f32_16x16x32_bf16 v[180:183], a[96:99], a[192:195], v[180:183]
 ds_read_b64_tr_b16 a[74:75], v8 offset:4096
 v_mul_f32 v87, s34, v87
 v_mfma_f32_16x16x32_bf16 v[180:183], a[100:103], a[200:203], v[180:183]
 ds_read_b64_tr_b16 a[76:77], v8 offset:16384
 v_mul_f32 v100, s34, v100
 v_mfma_f32_16x16x32_bf16 v[180:183], a[104:107], a[208:211], v[180:183]
 s_waitcnt lgkmcnt(3)
 ds_read_b64_tr_b16 a[78:79], v8 offset:20480
 v_xor_b32 v9, 352, v6
 v_mfma_f32_16x16x32_bf16 v[180:183], a[108:111], a[216:219], v[180:183]
 ds_read_b64_tr_b16 a[80:81], v9 offset:0
 v_mul_f32 v101, s34, v101
 v_mfma_f32_16x16x32_bf16 v[180:183], a[64:67], a[112:115], v[180:183]
 ds_read_b64_tr_b16 a[82:83], v9 offset:4096
 v_mul_f32 v102, s34, v102
 v_mfma_f32_16x16x32_bf16 v[180:183], a[68:71], a[120:123], v[180:183]
 ds_read_b64_tr_b16 a[84:85], v9 offset:16384
 v_mul_f32 v103, s34, v103
 v_mfma_f32_16x16x32_bf16 v[188:191], a[96:99], a[196:199], v[188:191]
 ds_read_b64_tr_b16 a[86:87], v9 offset:20480
 v_xor_b32 v10, 65888, v6
 v_mfma_f32_16x16x32_bf16 v[188:191], a[100:103], a[204:207], v[188:191]
 ds_read_b64_tr_b16 a[88:89], v10 offset:0
 v_cvt_pk_bf16_f32 v84, v84, v85
 v_mfma_f32_16x16x32_bf16 v[188:191], a[104:107], a[212:215], v[188:191]
 ds_read_b64_tr_b16 a[90:91], v10 offset:4096
 v_cvt_pk_bf16_f32 v85, v86, v87
 v_mfma_f32_16x16x32_bf16 v[188:191], a[108:111], a[220:223], v[188:191]
 ds_read_b64_tr_b16 a[92:93], v10 offset:16384
 v_cvt_pk_bf16_f32 v86, v100, v101
 v_mfma_f32_16x16x32_bf16 v[188:191], a[64:67], a[116:119], v[188:191]
 s_add_u32 s59, s62, 0
 ds_read_b64_tr_b16 a[94:95], v10 offset:20480
 v_xor_b32 v7, 131456, v6
 v_mfma_f32_16x16x32_bf16 v[188:191], a[68:71], a[124:127], v[188:191]
 s_waitcnt lgkmcnt(6)
 ds_read_b64_tr_b16 a[96:97], v7 offset:0
 v_cvt_pk_bf16_f32 v87, v102, v103
 v_mfma_f32_16x16x32_bf16 v[196:199], a[72:75], a[192:195], v[196:199]
 ds_read_b64_tr_b16 a[98:99], v7 offset:4096
 buffer_store_dwordx4 v[84:87], v1, s[12:15], s59 offen offset:2048 sc1
 v_mfma_f32_16x16x32_bf16 v[196:199], a[76:79], a[200:203], v[196:199]
 ds_read_b64_tr_b16 a[100:101], v7 offset:16384
 v_accvgpr_write_b32 a8, v84
 v_mfma_f32_16x16x32_bf16 v[196:199], a[80:83], a[208:211], v[196:199]
 s_waitcnt lgkmcnt(3)
 ds_read_b64_tr_b16 a[102:103], v7 offset:20480
 v_xor_b32 v8, 384, v6
 v_mfma_f32_16x16x32_bf16 v[196:199], a[84:87], a[216:219], v[196:199]
 ds_read_b64_tr_b16 a[104:105], v8 offset:0
 v_accvgpr_write_b32 a9, v85
 v_mfma_f32_16x16x32_bf16 v[196:199], a[88:91], a[112:115], v[196:199]
 ds_read_b64_tr_b16 a[106:107], v8 offset:4096
 v_accvgpr_write_b32 a10, v86
 v_mfma_f32_16x16x32_bf16 v[196:199], a[92:95], a[120:123], v[196:199]
 ds_read_b64_tr_b16 a[108:109], v8 offset:16384
 v_accvgpr_write_b32 a11, v87
 v_mfma_f32_16x16x32_bf16 v[204:207], a[72:75], a[196:199], v[204:207]
 ds_read_b64_tr_b16 a[110:111], v8 offset:20480
 v_xor_b32 v9, 65920, v6
 v_mfma_f32_16x16x32_bf16 v[204:207], a[76:79], a[204:207], v[204:207]
 ds_read_b64_tr_b16 a[64:65], v9 offset:0
 v_mul_f32 v92, s34, v92
 v_mfma_f32_16x16x32_bf16 v[204:207], a[80:83], a[212:215], v[204:207]
 ds_read_b64_tr_b16 a[66:67], v9 offset:4096
 v_mul_f32 v93, s34, v93
 v_mfma_f32_16x16x32_bf16 v[204:207], a[84:87], a[220:223], v[204:207]
 ds_read_b64_tr_b16 a[68:69], v9 offset:16384
 v_mul_f32 v94, s34, v94
 v_mfma_f32_16x16x32_bf16 v[204:207], a[88:91], a[116:119], v[204:207]
 ds_read_b64_tr_b16 a[70:71], v9 offset:20480
 v_xor_b32 v10, 131488, v6
 v_mfma_f32_16x16x32_bf16 v[204:207], a[92:95], a[124:127], v[204:207]
 s_waitcnt lgkmcnt(6)
 ds_read_b64_tr_b16 a[72:73], v10 offset:0
 v_mul_f32 v95, s34, v95
 v_mfma_f32_16x16x32_bf16 v[212:215], a[96:99], a[192:195], v[212:215]
 ds_read_b64_tr_b16 a[74:75], v10 offset:4096
 v_mul_f32 v108, s34, v108
 v_mfma_f32_16x16x32_bf16 v[212:215], a[100:103], a[200:203], v[212:215]
 ds_read_b64_tr_b16 a[76:77], v10 offset:16384
 v_mul_f32 v109, s34, v109
 v_mfma_f32_16x16x32_bf16 v[212:215], a[104:107], a[208:211], v[212:215]
 s_waitcnt lgkmcnt(3)
 ds_read_b64_tr_b16 a[78:79], v10 offset:20480
 v_xor_b32 v7, 416, v6
 v_mfma_f32_16x16x32_bf16 v[212:215], a[108:111], a[216:219], v[212:215]
 ds_read_b64_tr_b16 a[80:81], v7 offset:0
 v_mul_f32 v110, s34, v110
 v_mfma_f32_16x16x32_bf16 v[212:215], a[64:67], a[112:115], v[212:215]
 ds_read_b64_tr_b16 a[82:83], v7 offset:4096
 v_mul_f32 v111, s34, v111
 v_mfma_f32_16x16x32_bf16 v[212:215], a[68:71], a[120:123], v[212:215]
 ds_read_b64_tr_b16 a[84:85], v7 offset:16384
 v_cvt_pk_bf16_f32 v92, v92, v93
 v_mfma_f32_16x16x32_bf16 v[220:223], a[96:99], a[196:199], v[220:223]
 ds_read_b64_tr_b16 a[86:87], v7 offset:20480
 v_xor_b32 v8, 65952, v6
 v_mfma_f32_16x16x32_bf16 v[220:223], a[100:103], a[204:207], v[220:223]
 ds_read_b64_tr_b16 a[88:89], v8 offset:0
 v_cvt_pk_bf16_f32 v93, v94, v95
 v_mfma_f32_16x16x32_bf16 v[220:223], a[104:107], a[212:215], v[220:223]
 ds_read_b64_tr_b16 a[90:91], v8 offset:4096
 v_cvt_pk_bf16_f32 v94, v108, v109
 v_mfma_f32_16x16x32_bf16 v[220:223], a[108:111], a[220:223], v[220:223]
 ds_read_b64_tr_b16 a[92:93], v8 offset:16384
 v_cvt_pk_bf16_f32 v95, v110, v111
 v_mfma_f32_16x16x32_bf16 v[220:223], a[64:67], a[116:119], v[220:223]
 s_add_u32 s59, s62, 8192
 ds_read_b64_tr_b16 a[94:95], v8 offset:20480
 v_xor_b32 v9, 131520, v6
 v_mfma_f32_16x16x32_bf16 v[220:223], a[68:71], a[124:127], v[220:223]
 s_waitcnt lgkmcnt(6)
 ds_read_b64_tr_b16 a[96:97], v9 offset:0
 buffer_store_dwordx4 v[92:95], v1, s[12:15], s59 offen offset:2048 sc1
 v_mfma_f32_16x16x32_bf16 v[228:231], a[72:75], a[192:195], v[228:231]
 ds_read_b64_tr_b16 a[98:99], v9 offset:4096
 v_accvgpr_write_b32 a40, v92
 v_mfma_f32_16x16x32_bf16 v[228:231], a[76:79], a[200:203], v[228:231]
 ds_read_b64_tr_b16 a[100:101], v9 offset:16384
 v_accvgpr_write_b32 a41, v93
 v_mfma_f32_16x16x32_bf16 v[228:231], a[80:83], a[208:211], v[228:231]
 s_waitcnt lgkmcnt(3)
 ds_read_b64_tr_b16 a[102:103], v9 offset:20480
 v_xor_b32 v10, 448, v6
 v_mfma_f32_16x16x32_bf16 v[228:231], a[84:87], a[216:219], v[228:231]
 ds_read_b64_tr_b16 a[104:105], v10 offset:0
 v_accvgpr_write_b32 a42, v94
 v_mfma_f32_16x16x32_bf16 v[228:231], a[88:91], a[112:115], v[228:231]
 ds_read_b64_tr_b16 a[106:107], v10 offset:4096
 v_accvgpr_write_b32 a43, v95
 v_mfma_f32_16x16x32_bf16 v[228:231], a[92:95], a[120:123], v[228:231]
 ds_read_b64_tr_b16 a[108:109], v10 offset:16384
 v_mul_f32 v116, s34, v116
 v_mfma_f32_16x16x32_bf16 v[236:239], a[72:75], a[196:199], v[236:239]
 ds_read_b64_tr_b16 a[110:111], v10 offset:20480
 v_xor_b32 v7, 65984, v6
 v_mfma_f32_16x16x32_bf16 v[236:239], a[76:79], a[204:207], v[236:239]
 ds_read_b64_tr_b16 a[64:65], v7 offset:0
 buffer_load_dword v13, v12, s[12:15], s58 offen sc1
 v_mfma_f32_16x16x32_bf16 v[236:239], a[80:83], a[212:215], v[236:239]
 ds_read_b64_tr_b16 a[66:67], v7 offset:4096
 v_mul_f32 v117, s34, v117
 v_mfma_f32_16x16x32_bf16 v[236:239], a[84:87], a[220:223], v[236:239]
 ds_read_b64_tr_b16 a[68:69], v7 offset:16384
 v_mul_f32 v118, s34, v118
 v_mfma_f32_16x16x32_bf16 v[236:239], a[88:91], a[116:119], v[236:239]
 ds_read_b64_tr_b16 a[70:71], v7 offset:20480
 v_xor_b32 v8, 131552, v6
 v_mfma_f32_16x16x32_bf16 v[236:239], a[92:95], a[124:127], v[236:239]
 s_waitcnt lgkmcnt(6)
 ds_read_b64_tr_b16 a[72:73], v8 offset:0
 v_mul_f32 v119, s34, v119
 v_mfma_f32_16x16x32_bf16 v[244:247], a[96:99], a[192:195], v[244:247]
 ds_read_b64_tr_b16 a[74:75], v8 offset:4096
 v_mul_f32 v132, s34, v132
 v_mfma_f32_16x16x32_bf16 v[244:247], a[100:103], a[200:203], v[244:247]
 ds_read_b64_tr_b16 a[76:77], v8 offset:16384
 v_mul_f32 v133, s34, v133
 v_mfma_f32_16x16x32_bf16 v[244:247], a[104:107], a[208:211], v[244:247]
 s_waitcnt lgkmcnt(3)
 ds_read_b64_tr_b16 a[78:79], v8 offset:20480
 v_xor_b32 v9, 480, v6
 v_mfma_f32_16x16x32_bf16 v[244:247], a[108:111], a[216:219], v[244:247]
 ds_read_b64_tr_b16 a[80:81], v9 offset:0
 v_mul_f32 v134, s34, v134
 v_mfma_f32_16x16x32_bf16 v[244:247], a[64:67], a[112:115], v[244:247]
 ds_read_b64_tr_b16 a[82:83], v9 offset:4096
 v_mul_f32 v135, s34, v135
 v_mfma_f32_16x16x32_bf16 v[244:247], a[68:71], a[120:123], v[244:247]
 ds_read_b64_tr_b16 a[84:85], v9 offset:16384
 v_cvt_pk_bf16_f32 v116, v116, v117
 v_mfma_f32_16x16x32_bf16 v[252:255], a[96:99], a[196:199], v[252:255]
 ds_read_b64_tr_b16 a[86:87], v9 offset:20480
 v_xor_b32 v10, 66016, v6
 v_mfma_f32_16x16x32_bf16 v[252:255], a[100:103], a[204:207], v[252:255]
 ds_read_b64_tr_b16 a[88:89], v10 offset:0
 v_cvt_pk_bf16_f32 v117, v118, v119
 v_mfma_f32_16x16x32_bf16 v[252:255], a[104:107], a[212:215], v[252:255]
 ds_read_b64_tr_b16 a[90:91], v10 offset:4096
 v_cvt_pk_bf16_f32 v118, v132, v133
 v_mfma_f32_16x16x32_bf16 v[252:255], a[108:111], a[220:223], v[252:255]
 s_add_u32 s59, s62, 0
 ds_read_b64_tr_b16 a[92:93], v10 offset:16384
 v_cvt_pk_bf16_f32 v119, v134, v135
 v_mfma_f32_16x16x32_bf16 v[252:255], a[64:67], a[116:119], v[252:255]
 ds_read_b64_tr_b16 a[94:95], v10 offset:20480
 buffer_store_dwordx4 v[116:119], v1, s[12:15], s59 offen offset:3072 sc1
 v_mfma_f32_16x16x32_bf16 v[252:255], a[68:71], a[124:127], v[252:255]
 s_waitcnt lgkmcnt(6)
 v_accvgpr_write_b32 a12, v116
 v_accvgpr_write_b32 a13, v117
 v_mfma_f32_16x16x32_bf16 v[16:19], a[72:75], a[192:195], v[16:19]
 v_accvgpr_write_b32 a14, v118
 v_accvgpr_write_b32 a15, v119
 v_mfma_f32_16x16x32_bf16 v[16:19], a[76:79], a[200:203], v[16:19]
 v_mfma_f32_16x16x32_bf16 v[16:19], a[80:83], a[208:211], v[16:19]
 s_waitcnt lgkmcnt(0)
 v_mfma_f32_16x16x32_bf16 v[16:19], a[84:87], a[216:219], v[16:19]
 v_mfma_f32_16x16x32_bf16 v[16:19], a[88:91], a[112:115], v[16:19]
 v_mfma_f32_16x16x32_bf16 v[16:19], a[92:95], a[120:123], v[16:19]
 v_mfma_f32_16x16x32_bf16 v[24:27], a[72:75], a[196:199], v[24:27]
 v_mfma_f32_16x16x32_bf16 v[24:27], a[76:79], a[204:207], v[24:27]
 v_mfma_f32_16x16x32_bf16 v[24:27], a[80:83], a[212:215], v[24:27]
 v_mfma_f32_16x16x32_bf16 v[24:27], a[84:87], a[220:223], v[24:27]
 s_waitcnt lgkmcnt(0)
 v_mfma_f32_16x16x32_bf16 v[24:27], a[88:91], a[116:119], v[24:27]
 s_barrier
 v_mfma_f32_16x16x32_bf16 v[24:27], a[92:95], a[124:127], v[24:27]
 s_waitcnt vmcnt(1)
 v_cmp_ne_u32 s[16:17], 0, v13
 v_cmp_gt_u32 vcc, 256, v5
 s_or_b64 vcc, vcc, s[16:17]
 s_mov_b32 m0, s40
 s_cselect_b32 s48, 0, 1
 s_cselect_b32 s52, 2.0, s42
 buffer_load_dwordx4 v1, s[12:15], s52 offen offset:0 sc1 lds
 v_pk_mul_f32 v[124:125], v[124:125], s[34:35]
 v_pk_mul_f32 v[126:127], v[126:127], s[34:35]
 v_pk_mul_f32 v[140:141], v[140:141], s[34:35]
 v_pk_mul_f32 v[142:143], v[142:143], s[34:35]
 v_cvt_pk_bf16_f32 v124, v124, v125
 v_cvt_pk_bf16_f32 v125, v126, v127
 v_cvt_pk_bf16_f32 v126, v140, v141
 v_cvt_pk_bf16_f32 v127, v142, v143
 s_add_u32 s59, s62, 8192
 buffer_store_dwordx4 v[124:127], v1, s[12:15], s59 offen offset:3072 sc1
 v_accvgpr_write_b32 a44, v124
 v_accvgpr_write_b32 a45, v125
 v_accvgpr_write_b32 a46, v126
 v_accvgpr_write_b32 a47, v127
 v_pk_mul_f32 v[148:149], v[148:149], s[34:35]
 v_pk_mul_f32 v[150:151], v[150:151], s[34:35]
 buffer_load_dwordx4 v1, s[12:15], s52 offen offset:1024 sc1 lds
 v_pk_mul_f32 v[164:165], v[164:165], s[34:35]
 v_pk_mul_f32 v[166:167], v[166:167], s[34:35]
 v_cvt_pk_bf16_f32 v148, v148, v149
 v_cvt_pk_bf16_f32 v149, v150, v151
 v_cvt_pk_bf16_f32 v150, v164, v165
 v_cvt_pk_bf16_f32 v151, v166, v167
 s_add_u32 s59, s62, 4096
 buffer_store_dwordx4 v[148:151], v1, s[12:15], s59 offen offset:0 sc1
 v_accvgpr_write_b32 a16, v148
 v_accvgpr_write_b32 a17, v149
 v_accvgpr_write_b32 a18, v150
 v_accvgpr_write_b32 a19, v151
 v_pk_mul_f32 v[156:157], v[156:157], s[34:35]
 v_pk_mul_f32 v[158:159], v[158:159], s[34:35]
 v_pk_mul_f32 v[172:173], v[172:173], s[34:35]
 v_pk_mul_f32 v[174:175], v[174:175], s[34:35]
 buffer_load_dwordx4 v1, s[12:15], s52 offen offset:2048 sc1 lds
 v_cvt_pk_bf16_f32 v156, v156, v157
 v_cvt_pk_bf16_f32 v157, v158, v159
 v_cvt_pk_bf16_f32 v158, v172, v173
 v_cvt_pk_bf16_f32 v159, v174, v175
 s_add_u32 s59, s62, 12288
 buffer_store_dwordx4 v[156:159], v1, s[12:15], s59 offen offset:0 sc1
 v_accvgpr_write_b32 a48, v156
 v_accvgpr_write_b32 a49, v157
 v_accvgpr_write_b32 a50, v158
 v_accvgpr_write_b32 a51, v159
 v_pk_mul_f32 v[180:181], v[180:181], s[34:35]
 v_pk_mul_f32 v[182:183], v[182:183], s[34:35]
 v_pk_mul_f32 v[196:197], v[196:197], s[34:35]
 v_pk_mul_f32 v[198:199], v[198:199], s[34:35]
 v_cvt_pk_bf16_f32 v180, v180, v181
 v_cvt_pk_bf16_f32 v181, v182, v183
 buffer_load_dwordx4 v1, s[12:15], s52 offen offset:3072 sc1 lds
 v_cvt_pk_bf16_f32 v182, v196, v197
 v_cvt_pk_bf16_f32 v183, v198, v199
 s_add_u32 s59, s62, 4096
 buffer_store_dwordx4 v[180:183], v1, s[12:15], s59 offen offset:1024 sc1
 v_accvgpr_write_b32 a20, v180
 v_accvgpr_write_b32 a21, v181
 v_accvgpr_write_b32 a22, v182
 v_accvgpr_write_b32 a23, v183
 v_pk_mul_f32 v[188:189], v[188:189], s[34:35]
 v_pk_mul_f32 v[190:191], v[190:191], s[34:35]
 v_pk_mul_f32 v[204:205], v[204:205], s[34:35]
 v_pk_mul_f32 v[206:207], v[206:207], s[34:35]
 v_cvt_pk_bf16_f32 v188, v188, v189
 v_cvt_pk_bf16_f32 v189, v190, v191
 v_cvt_pk_bf16_f32 v190, v204, v205
 s_bitset1_b32 m0, 12
 s_nop 0
 buffer_load_dwordx4 v4, s[12:15], s52 offen offset:0 sc1 lds
 v_cvt_pk_bf16_f32 v191, v206, v207
 s_add_u32 s59, s62, 12288
 buffer_store_dwordx4 v[188:191], v1, s[12:15], s59 offen offset:1024 sc1
 v_accvgpr_write_b32 a52, v188
 v_accvgpr_write_b32 a53, v189
 v_accvgpr_write_b32 a54, v190
 v_accvgpr_write_b32 a55, v191
 v_pk_mul_f32 v[212:213], v[212:213], s[34:35]
 v_pk_mul_f32 v[214:215], v[214:215], s[34:35]
 v_pk_mul_f32 v[228:229], v[228:229], s[34:35]
 v_pk_mul_f32 v[230:231], v[230:231], s[34:35]
 v_cvt_pk_bf16_f32 v212, v212, v213
 v_cvt_pk_bf16_f32 v213, v214, v215
 v_cvt_pk_bf16_f32 v214, v228, v229
 v_cvt_pk_bf16_f32 v215, v230, v231
 s_add_u32 s59, s62, 4096
 buffer_load_dwordx4 v4, s[12:15], s52 offen offset:1024 sc1 lds
 buffer_store_dwordx4 v[212:215], v1, s[12:15], s59 offen offset:2048 sc1
 v_accvgpr_write_b32 a24, v212
 v_accvgpr_write_b32 a25, v213
 v_accvgpr_write_b32 a26, v214
 v_accvgpr_write_b32 a27, v215
 v_pk_mul_f32 v[220:221], v[220:221], s[34:35]
 v_pk_mul_f32 v[222:223], v[222:223], s[34:35]
 v_pk_mul_f32 v[236:237], v[236:237], s[34:35]
 v_pk_mul_f32 v[238:239], v[238:239], s[34:35]
 v_cvt_pk_bf16_f32 v220, v220, v221
 v_cvt_pk_bf16_f32 v221, v222, v223
 v_cvt_pk_bf16_f32 v222, v236, v237
 v_cvt_pk_bf16_f32 v223, v238, v239
 s_add_u32 s59, s62, 12288
 buffer_store_dwordx4 v[220:223], v1, s[12:15], s59 offen offset:2048 sc1
 v_accvgpr_write_b32 a56, v220
 buffer_load_dwordx4 v4, s[12:15], s52 offen offset:2048 sc1 lds
 v_accvgpr_write_b32 a57, v221
 v_accvgpr_write_b32 a58, v222
 v_accvgpr_write_b32 a59, v223
 v_pk_mul_f32 v[244:245], v[244:245], s[34:35]
 v_pk_mul_f32 v[246:247], v[246:247], s[34:35]
 v_pk_mul_f32 v[16:17], v[16:17], s[34:35]
 v_pk_mul_f32 v[18:19], v[18:19], s[34:35]
 v_cvt_pk_bf16_f32 v244, v244, v245
 v_cvt_pk_bf16_f32 v245, v246, v247
 v_cvt_pk_bf16_f32 v246, v16, v17
 v_cvt_pk_bf16_f32 v247, v18, v19
 s_add_u32 s59, s62, 4096
 buffer_store_dwordx4 v[244:247], v1, s[12:15], s59 offen offset:3072 sc1
 v_accvgpr_write_b32 a28, v244
 v_accvgpr_write_b32 a29, v245
 v_accvgpr_write_b32 a30, v246
 buffer_load_dwordx4 v4, s[12:15], s52 offen offset:3072 sc1 lds
 v_accvgpr_write_b32 a31, v247
 v_pk_mul_f32 v[252:253], v[252:253], s[34:35]
 v_pk_mul_f32 v[254:255], v[254:255], s[34:35]
 v_pk_mul_f32 v[24:25], v[24:25], s[34:35]
 v_pk_mul_f32 v[26:27], v[26:27], s[34:35]
 v_cvt_pk_bf16_f32 v252, v252, v253
 v_cvt_pk_bf16_f32 v253, v254, v255
 v_cvt_pk_bf16_f32 v254, v24, v25
 v_cvt_pk_bf16_f32 v255, v26, v27
 s_add_u32 s59, s62, 12288
 buffer_store_dwordx4 v[252:255], v1, s[12:15], s59 offen offset:3072 sc1
 v_accvgpr_write_b32 a60, v252
 v_accvgpr_write_b32 a61, v253
 v_accvgpr_write_b32 a62, v254
 v_accvgpr_write_b32 a63, v255
 s_branch L_kvdone
L_late1:
 v_mfma_f32_16x16x32_bf16 v[16:19], a[96:99], a[0:3], v[16:19]
 ds_read_b64_tr_b16 a[24:25], v9 offset:32768
 v_mfma_f32_16x16x32_bf16 v[16:19], a[100:103], a[4:7], v[16:19]
 s_add_u32 m0, s33, 0xfffffd00
 ds_read_b64_tr_b16 a[26:27], v9 offset:36864
 v_mfma_f32_16x16x32_bf16 v[20:23], a[108:111], a[4:7], v[20:23]
 s_waitcnt lgkmcnt(13)
 ds_read_b64_tr_b16 a[28:29], v9 offset:49152
 v_mfma_f32_16x16x32_bf16 v[20:23], a[104:107], a[0:3], v[20:23]
 ds_read_b64_tr_b16 a[30:31], v9 offset:53248
 buffer_load_dwordx4 v15, s[20:23], 0 offen offset:768 lds
 v_mfma_f32_16x16x32_bf16 v[24:27], a[112:115], a[0:3], v[24:27]
 s_waitcnt lgkmcnt(12)
 ds_read_b128 a[64:67], v4 offset:32768
 v_mfma_f32_16x16x32_bf16 v[24:27], a[116:119], a[4:7], v[24:27]
 v_mfma_f32_16x16x32_bf16 v[28:31], a[124:127], a[4:7], v[28:31]
 s_add_u32 m0, s33, 0xfffffd80
 ds_read_b128 a[68:71], v5 offset:32768
 v_mfma_f32_16x16x32_bf16 v[28:31], a[120:123], a[0:3], v[28:31]
 s_waitcnt lgkmcnt(10)
 buffer_load_dwordx4 v15, s[20:23], 0 offen offset:1664 lds
 v_mfma_f32_16x16x32_bf16 a[228:231], a[120:123], a[8:11], a[228:231]
 ds_read_b128 a[76:79], v5 offset:34816
 v_mfma_f32_16x16x32_bf16 a[228:231], a[124:127], a[12:15], a[228:231]
 v_mfma_f32_16x16x32_bf16 a[224:227], a[116:119], a[12:15], a[224:227]
 s_add_u32 m0, s33, 0x500
 ds_read_b128 a[72:75], v4 offset:34816
 v_mfma_f32_16x16x32_bf16 a[224:227], a[112:115], a[8:11], a[224:227]
 buffer_load_dwordx4 v15, s[20:23], s57 offen offset:768 lds
 v_mfma_f32_16x16x32_bf16 a[236:239], a[104:107], a[8:11], a[236:239]
 ds_read_b128 a[80:83], v4 offset:36864
 v_cvt_pk_bf16_f32 v16, v16, v17
 v_mfma_f32_16x16x32_bf16 a[236:239], a[108:111], a[12:15], a[236:239]
 v_cvt_pk_bf16_f32 v17, v18, v19
 v_cvt_pk_bf16_f32 v18, v20, v21
 v_mfma_f32_16x16x32_bf16 a[232:235], a[100:103], a[12:15], a[232:235]
 s_add_u32 m0, s33, 0x580
 ds_read_b128 a[84:87], v5 offset:36864
 v_cvt_pk_bf16_f32 v19, v22, v23
 v_mfma_f32_16x16x32_bf16 a[232:235], a[96:99], a[8:11], a[232:235]
 s_waitcnt lgkmcnt(10)
 buffer_load_dwordx4 v15, s[20:23], s57 offen offset:1664 lds
 v_mfma_f32_16x16x32_bf16 v[32:35], a[96:99], a[16:19], v[32:35]
 ds_read_b128 a[92:95], v5 offset:38912
 v_cvt_pk_bf16_f32 v24, v24, v25
 v_mfma_f32_16x16x32_bf16 v[32:35], a[100:103], a[20:23], v[32:35]
 v_cvt_pk_bf16_f32 v25, v26, v27
 v_cvt_pk_bf16_f32 v26, v28, v29
 v_mfma_f32_16x16x32_bf16 v[36:39], a[108:111], a[20:23], v[36:39]
 ds_read_b128 a[88:91], v4 offset:38912
 v_cvt_pk_bf16_f32 v27, v30, v31
 v_mfma_f32_16x16x32_bf16 v[36:39], a[104:107], a[16:19], v[36:39]
 v_accvgpr_read_b32 v20, a224
 v_accvgpr_read_b32 v21, a225
 v_mfma_f32_16x16x32_bf16 v[40:43], a[112:115], a[16:19], v[40:43]
 ds_read_b64_tr_b16 a[32:33], v10 offset:32768
 v_accvgpr_read_b32 v22, a226
 v_mfma_f32_16x16x32_bf16 v[40:43], a[116:119], a[20:23], v[40:43]
 ds_read_b64_tr_b16 a[34:35], v10 offset:36864
 v_accvgpr_read_b32 v23, a227
 v_mfma_f32_16x16x32_bf16 v[44:47], a[124:127], a[20:23], v[44:47]
 s_add_u32 s59, s56, 32768
 ds_read_b64_tr_b16 a[36:37], v10 offset:49152
 v_accvgpr_read_b32 v28, a228
 v_mfma_f32_16x16x32_bf16 v[44:47], a[120:123], a[16:19], v[44:47]
 s_waitcnt lgkmcnt(11)
 ds_read_b64_tr_b16 a[38:39], v10 offset:53248
 v_accvgpr_read_b32 v29, a229
 v_mfma_f32_16x16x32_bf16 v[52:55], a[120:123], a[24:27], v[52:55]
 ds_read_b64_tr_b16 a[40:41], v11 offset:32768
 buffer_store_dwordx4 v[16:19], v1, s[12:15], s59 offen offset:0 sc1
 v_mfma_f32_16x16x32_bf16 v[52:55], a[124:127], a[28:31], v[52:55]
 ds_read_b64_tr_b16 a[42:43], v11 offset:36864
 v_accvgpr_read_b32 v30, a230
 v_mfma_f32_16x16x32_bf16 v[48:51], a[116:119], a[28:31], v[48:51]
 ds_read_b64_tr_b16 a[44:45], v11 offset:49152
 v_accvgpr_read_b32 v31, a231
 v_mfma_f32_16x16x32_bf16 v[48:51], a[112:115], a[24:27], v[48:51]
 ds_read_b64_tr_b16 a[46:47], v11 offset:53248
 v_cvt_pk_bf16_f32 v20, v20, v21
 v_mfma_f32_16x16x32_bf16 v[60:63], a[104:107], a[24:27], v[60:63]
 ds_read_b64_tr_b16 a[48:49], v12 offset:32768
 v_cvt_pk_bf16_f32 v21, v22, v23
 v_mfma_f32_16x16x32_bf16 v[60:63], a[108:111], a[28:31], v[60:63]
 ds_read_b64_tr_b16 a[50:51], v12 offset:36864
 v_cvt_pk_bf16_f32 v22, v28, v29
 v_mfma_f32_16x16x32_bf16 v[56:59], a[100:103], a[28:31], v[56:59]
 s_add_u32 s59, s56, 49152
 ds_read_b64_tr_b16 a[52:53], v12 offset:49152
 v_cvt_pk_bf16_f32 v23, v30, v31
 v_mfma_f32_16x16x32_bf16 v[56:59], a[96:99], a[24:27], v[56:59]
 s_waitcnt lgkmcnt(15)
 ds_read_b64_tr_b16 a[54:55], v12 offset:53248
 buffer_store_dwordx4 v[24:27], v1, s[12:15], s59 offen offset:0 sc1
 v_mfma_f32_16x16x32_bf16 v[64:67], a[64:67], a[0:3], v[64:67]
 ds_read_b64_tr_b16 a[56:57], v13 offset:32768
 v_cvt_pk_bf16_f32 v32, v32, v33
 v_mfma_f32_16x16x32_bf16 v[64:67], a[68:71], a[4:7], v[64:67]
 ds_read_b64_tr_b16 a[58:59], v13 offset:36864
 v_cvt_pk_bf16_f32 v33, v34, v35
 v_mfma_f32_16x16x32_bf16 v[68:71], a[76:79], a[4:7], v[68:71]
 ds_read_b64_tr_b16 a[60:61], v13 offset:49152
 v_cvt_pk_bf16_f32 v34, v36, v37
 v_mfma_f32_16x16x32_bf16 v[68:71], a[72:75], a[0:3], v[68:71]
 s_waitcnt lgkmcnt(15)
 ds_read_b64_tr_b16 a[62:63], v13 offset:53248
 v_cvt_pk_bf16_f32 v35, v38, v39
 v_mfma_f32_16x16x32_bf16 v[72:75], a[80:83], a[0:3], v[72:75]
 v_cvt_pk_bf16_f32 v40, v40, v41
 v_cvt_pk_bf16_f32 v41, v42, v43
 v_mfma_f32_16x16x32_bf16 v[72:75], a[84:87], a[4:7], v[72:75]
 s_add_u32 s59, s56, 49152
 v_cvt_pk_bf16_f32 v42, v44, v45
 v_cvt_pk_bf16_f32 v43, v46, v47
 v_mfma_f32_16x16x32_bf16 v[76:79], a[92:95], a[4:7], v[76:79]
 buffer_store_dwordx4 v[20:23], v1, s[12:15], s59 offen offset:1024 sc1
 v_mfma_f32_16x16x32_bf16 v[76:79], a[88:91], a[0:3], v[76:79]
 s_waitcnt lgkmcnt(0)
 v_accvgpr_read_b32 v36, a232
 v_accvgpr_read_b32 v37, a233
 v_mfma_f32_16x16x32_bf16 v[84:87], a[88:91], a[8:11], v[84:87]
 s_barrier
 v_xor_b32 v6, s60, v6
 v_accvgpr_read_b32 v38, a234
 v_mfma_f32_16x16x32_bf16 v[84:87], a[92:95], a[12:15], v[84:87]
 s_add_u32 m0, s29, 32768
 v_add_u32 v2, 0x80000, v2
 v_accvgpr_read_b32 v39, a235
 v_mfma_f32_16x16x32_bf16 v[80:83], a[84:87], a[12:15], v[80:83]
 buffer_load_dwordx4 v2, s[16:19], 0 offen lds
 v_mfma_f32_16x16x32_bf16 v[80:83], a[80:83], a[8:11], v[80:83]
 v_accvgpr_read_b32 v44, a236
 v_accvgpr_read_b32 v45, a237
 v_mfma_f32_16x16x32_bf16 v[92:95], a[72:75], a[8:11], v[92:95]
 v_accvgpr_read_b32 v46, a238
 v_accvgpr_read_b32 v47, a239
 v_mfma_f32_16x16x32_bf16 v[92:95], a[76:79], a[12:15], v[92:95]
 v_cvt_pk_bf16_f32 v36, v36, v37
 v_cvt_pk_bf16_f32 v37, v38, v39
 v_mfma_f32_16x16x32_bf16 v[88:91], a[68:71], a[12:15], v[88:91]
 s_add_u32 m0, s29, 36864
 v_cvt_pk_bf16_f32 v38, v44, v45
 v_cvt_pk_bf16_f32 v39, v46, v47
 v_mfma_f32_16x16x32_bf16 v[88:91], a[64:67], a[8:11], v[88:91]
 buffer_load_dwordx4 v2, s[16:19], s48 offen lds
 v_mfma_f32_16x16x32_bf16 v[96:99], a[64:67], a[16:19], v[96:99]
 v_cvt_pk_bf16_f32 v48, v48, v49
 v_cvt_pk_bf16_f32 v49, v50, v51
 v_mfma_f32_16x16x32_bf16 v[96:99], a[68:71], a[20:23], v[96:99]
 v_cvt_pk_bf16_f32 v50, v52, v53
 v_cvt_pk_bf16_f32 v51, v54, v55
 v_mfma_f32_16x16x32_bf16 v[100:103], a[76:79], a[20:23], v[100:103]
 v_cvt_pk_bf16_f32 v56, v56, v57
 v_cvt_pk_bf16_f32 v57, v58, v59
 v_mfma_f32_16x16x32_bf16 v[100:103], a[72:75], a[16:19], v[100:103]
 s_add_u32 m0, s29, 40960
 v_cvt_pk_bf16_f32 v58, v60, v61
 v_cvt_pk_bf16_f32 v59, v62, v63
 v_mfma_f32_16x16x32_bf16 v[104:107], a[80:83], a[16:19], v[104:107]
 buffer_load_dwordx4 v2, s[16:19], s49 offen lds
 v_mfma_f32_16x16x32_bf16 v[104:107], a[84:87], a[20:23], v[104:107]
 v_cvt_pk_bf16_f32 v64, v64, v65
 v_cvt_pk_bf16_f32 v65, v66, v67
 v_mfma_f32_16x16x32_bf16 v[108:111], a[92:95], a[20:23], v[108:111]
 v_cvt_pk_bf16_f32 v66, v68, v69
 v_cvt_pk_bf16_f32 v67, v70, v71
 v_mfma_f32_16x16x32_bf16 v[108:111], a[88:91], a[16:19], v[108:111]
 v_cvt_pk_bf16_f32 v72, v72, v73
 v_cvt_pk_bf16_f32 v73, v74, v75
 v_mfma_f32_16x16x32_bf16 v[116:119], a[88:91], a[24:27], v[116:119]
 s_add_u32 m0, s29, 45056
 v_cvt_pk_bf16_f32 v74, v76, v77
 v_cvt_pk_bf16_f32 v75, v78, v79
 v_mfma_f32_16x16x32_bf16 v[116:119], a[92:95], a[28:31], v[116:119]
 buffer_load_dwordx4 v2, s[16:19], s50 offen lds
 v_mfma_f32_16x16x32_bf16 v[112:115], a[84:87], a[28:31], v[112:115]
 s_add_u32 s59, s56, 32768
 v_cvt_pk_bf16_f32 v80, v80, v81
 v_cvt_pk_bf16_f32 v81, v82, v83
 v_mfma_f32_16x16x32_bf16 v[112:115], a[80:83], a[24:27], v[112:115]
 buffer_store_dwordx4 v[36:39], v1, s[12:15], s59 offen offset:1024 sc1
 v_mfma_f32_16x16x32_bf16 v[124:127], a[72:75], a[24:27], v[124:127]
 v_cvt_pk_bf16_f32 v82, v84, v85
 v_cvt_pk_bf16_f32 v83, v86, v87
 v_mfma_f32_16x16x32_bf16 v[124:127], a[76:79], a[28:31], v[124:127]
 s_add_u32 m0, s29, 49152
 v_cvt_pk_bf16_f32 v88, v88, v89
 v_cvt_pk_bf16_f32 v89, v90, v91
 v_mfma_f32_16x16x32_bf16 v[120:123], a[68:71], a[28:31], v[120:123]
 buffer_load_dwordx4 v2, s[16:19], s51 offen lds
 v_mfma_f32_16x16x32_bf16 v[120:123], a[64:67], a[24:27], v[120:123]
 v_cvt_pk_bf16_f32 v90, v92, v93
 v_cvt_pk_bf16_f32 v91, v94, v95
 v_mfma_f32_16x16x32_bf16 v[128:131], a[64:67], a[32:35], v[128:131]
 v_cvt_pk_bf16_f32 v96, v96, v97
 v_cvt_pk_bf16_f32 v97, v98, v99
 v_mfma_f32_16x16x32_bf16 v[128:131], a[68:71], a[36:39], v[128:131]
 v_cvt_pk_bf16_f32 v98, v100, v101
 v_cvt_pk_bf16_f32 v99, v102, v103
 v_mfma_f32_16x16x32_bf16 v[132:135], a[76:79], a[36:39], v[132:135]
 s_add_u32 m0, s29, 53248
 v_cvt_pk_bf16_f32 v104, v104, v105
 v_cvt_pk_bf16_f32 v105, v106, v107
 v_mfma_f32_16x16x32_bf16 v[132:135], a[72:75], a[32:35], v[132:135]
 buffer_load_dwordx4 v2, s[16:19], s52 offen lds
 v_mfma_f32_16x16x32_bf16 v[136:139], a[80:83], a[32:35], v[136:139]
 v_cvt_pk_bf16_f32 v106, v108, v109
 v_cvt_pk_bf16_f32 v107, v110, v111
 v_mfma_f32_16x16x32_bf16 v[136:139], a[84:87], a[36:39], v[136:139]
 v_cvt_pk_bf16_f32 v112, v112, v113
 v_cvt_pk_bf16_f32 v113, v114, v115
 v_mfma_f32_16x16x32_bf16 v[140:143], a[92:95], a[36:39], v[140:143]
 v_cvt_pk_bf16_f32 v114, v116, v117
 v_cvt_pk_bf16_f32 v115, v118, v119
 v_mfma_f32_16x16x32_bf16 v[140:143], a[88:91], a[32:35], v[140:143]
 s_add_u32 m0, s29, 57344
 v_cvt_pk_bf16_f32 v120, v120, v121
 v_cvt_pk_bf16_f32 v121, v122, v123
 v_mfma_f32_16x16x32_bf16 v[148:151], a[88:91], a[40:43], v[148:151]
 buffer_load_dwordx4 v2, s[16:19], s53 offen lds
 v_mfma_f32_16x16x32_bf16 v[148:151], a[92:95], a[44:47], v[148:151]
 v_cvt_pk_bf16_f32 v122, v124, v125
 v_cvt_pk_bf16_f32 v123, v126, v127
 v_mfma_f32_16x16x32_bf16 v[144:147], a[84:87], a[44:47], v[144:147]
 v_mfma_f32_16x16x32_bf16 v[144:147], a[80:83], a[40:43], v[144:147]
 v_cvt_pk_bf16_f32 v128, v128, v129
 v_cvt_pk_bf16_f32 v129, v130, v131
 v_mfma_f32_16x16x32_bf16 v[156:159], a[72:75], a[40:43], v[156:159]
 s_add_u32 m0, s29, 61440
 v_cvt_pk_bf16_f32 v130, v132, v133
 v_cvt_pk_bf16_f32 v131, v134, v135
 v_mfma_f32_16x16x32_bf16 v[156:159], a[76:79], a[44:47], v[156:159]
 buffer_load_dwordx4 v2, s[16:19], s54 offen lds
 v_mfma_f32_16x16x32_bf16 v[152:155], a[68:71], a[44:47], v[152:155]
 v_mfma_f32_16x16x32_bf16 v[152:155], a[64:67], a[40:43], v[152:155]
 v_cvt_pk_bf16_f32 v136, v136, v137
 v_cvt_pk_bf16_f32 v137, v138, v139
 v_mfma_f32_16x16x32_bf16 v[160:163], a[64:67], a[48:51], v[160:163]
 s_add_u32 m0, s29, 98304
 v_add_u32 v2, 0x80000, v2
 v_cvt_pk_bf16_f32 v138, v140, v141
 v_mfma_f32_16x16x32_bf16 v[160:163], a[68:71], a[52:55], v[160:163]
 buffer_load_dwordx4 v2, s[16:19], 0 offen lds
 v_mfma_f32_16x16x32_bf16 v[164:167], a[76:79], a[52:55], v[164:167]
 v_cvt_pk_bf16_f32 v139, v142, v143
 v_mfma_f32_16x16x32_bf16 v[164:167], a[72:75], a[48:51], v[164:167]
 v_cvt_pk_bf16_f32 v144, v144, v145
 v_cvt_pk_bf16_f32 v145, v146, v147
 v_mfma_f32_16x16x32_bf16 v[168:171], a[80:83], a[48:51], v[168:171]
 v_cvt_pk_bf16_f32 v146, v148, v149
 v_cvt_pk_bf16_f32 v147, v150, v151
 v_mfma_f32_16x16x32_bf16 v[168:171], a[84:87], a[52:55], v[168:171]
 s_add_u32 m0, s29, 102400
 v_mfma_f32_16x16x32_bf16 v[172:175], a[92:95], a[52:55], v[172:175]
 buffer_load_dwordx4 v2, s[16:19], s48 offen lds
 v_mfma_f32_16x16x32_bf16 v[172:175], a[88:91], a[48:51], v[172:175]
 v_cvt_pk_bf16_f32 v152, v152, v153
 v_cvt_pk_bf16_f32 v153, v154, v155
 v_mfma_f32_16x16x32_bf16 v[180:183], a[88:91], a[56:59], v[180:183]
 v_cvt_pk_bf16_f32 v154, v156, v157
 v_cvt_pk_bf16_f32 v155, v158, v159
 v_mfma_f32_16x16x32_bf16 v[180:183], a[92:95], a[60:63], v[180:183]
 v_mfma_f32_16x16x32_bf16 v[176:179], a[84:87], a[60:63], v[176:179]
 s_add_u32 m0, s29, 106496
 v_mfma_f32_16x16x32_bf16 v[176:179], a[80:83], a[56:59], v[176:179]
 buffer_load_dwordx4 v2, s[16:19], s49 offen lds
 v_mfma_f32_16x16x32_bf16 v[188:191], a[72:75], a[56:59], v[188:191]
 v_cvt_pk_bf16_f32 v160, v160, v161
 v_cvt_pk_bf16_f32 v161, v162, v163
 v_mfma_f32_16x16x32_bf16 v[188:191], a[76:79], a[60:63], v[188:191]
 v_cvt_pk_bf16_f32 v162, v164, v165
 v_cvt_pk_bf16_f32 v163, v166, v167
 v_mfma_f32_16x16x32_bf16 v[184:187], a[68:71], a[60:63], v[184:187]
 v_mfma_f32_16x16x32_bf16 v[184:187], a[64:67], a[56:59], v[184:187]
 s_add_u32 m0, s29, 110592
 v_cvt_pk_bf16_f32 v168, v168, v169
 v_cvt_pk_bf16_f32 v169, v170, v171
 v_mfma_f32_16x16x32_bf16 v[192:195], a[96:99], a[32:35], v[192:195]
 buffer_load_dwordx4 v2, s[16:19], s50 offen lds
 v_mfma_f32_16x16x32_bf16 v[192:195], a[100:103], a[36:39], v[192:195]
 v_cvt_pk_bf16_f32 v170, v172, v173
 v_cvt_pk_bf16_f32 v171, v174, v175
 v_mfma_f32_16x16x32_bf16 v[196:199], a[108:111], a[36:39], v[196:199]
 v_mfma_f32_16x16x32_bf16 v[196:199], a[104:107], a[32:35], v[196:199]
 v_cvt_pk_bf16_f32 v176, v176, v177
 v_cvt_pk_bf16_f32 v177, v178, v179
 v_mfma_f32_16x16x32_bf16 v[200:203], a[112:115], a[32:35], v[200:203]
 s_add_u32 m0, s29, 114688
 v_cvt_pk_bf16_f32 v178, v180, v181
 v_cvt_pk_bf16_f32 v179, v182, v183
 v_mfma_f32_16x16x32_bf16 v[200:203], a[116:119], a[36:39], v[200:203]
 buffer_load_dwordx4 v2, s[16:19], s51 offen lds
 v_mfma_f32_16x16x32_bf16 v[204:207], a[124:127], a[36:39], v[204:207]
 v_mfma_f32_16x16x32_bf16 v[204:207], a[120:123], a[32:35], v[204:207]
 v_cvt_pk_bf16_f32 v184, v184, v185
 v_cvt_pk_bf16_f32 v185, v186, v187
 v_mfma_f32_16x16x32_bf16 v[212:215], a[120:123], a[40:43], v[212:215]
 v_cvt_pk_bf16_f32 v186, v188, v189
 v_cvt_pk_bf16_f32 v187, v190, v191
 v_mfma_f32_16x16x32_bf16 v[212:215], a[124:127], a[44:47], v[212:215]
 s_add_u32 m0, s29, 118784
 v_mfma_f32_16x16x32_bf16 v[208:211], a[116:119], a[44:47], v[208:211]
 buffer_load_dwordx4 v2, s[16:19], s52 offen lds
 v_mfma_f32_16x16x32_bf16 v[208:211], a[112:115], a[40:43], v[208:211]
 v_cvt_pk_bf16_f32 v192, v192, v193
 v_cvt_pk_bf16_f32 v193, v194, v195
 v_mfma_f32_16x16x32_bf16 v[220:223], a[104:107], a[40:43], v[220:223]
 v_cvt_pk_bf16_f32 v194, v196, v197
 v_cvt_pk_bf16_f32 v195, v198, v199
 v_mfma_f32_16x16x32_bf16 v[220:223], a[108:111], a[44:47], v[220:223]
 v_mfma_f32_16x16x32_bf16 v[216:219], a[100:103], a[44:47], v[216:219]
 s_add_u32 m0, s29, 122880
 v_mfma_f32_16x16x32_bf16 v[216:219], a[96:99], a[40:43], v[216:219]
 buffer_load_dwordx4 v2, s[16:19], s53 offen lds
 v_mfma_f32_16x16x32_bf16 v[224:227], a[96:99], a[48:51], v[224:227]
 v_cvt_pk_bf16_f32 v200, v200, v201
 v_cvt_pk_bf16_f32 v201, v202, v203
 v_mfma_f32_16x16x32_bf16 v[224:227], a[100:103], a[52:55], v[224:227]
 s_waitcnt vmcnt(19)
 v_cvt_pk_bf16_f32 v202, v204, v205
 v_cvt_pk_bf16_f32 v203, v206, v207
 v_mfma_f32_16x16x32_bf16 v[228:231], a[108:111], a[52:55], v[228:231]
 s_barrier
 v_xor_b32 v7, 0, v6
 v_mfma_f32_16x16x32_bf16 v[228:231], a[104:107], a[48:51], v[228:231]
 s_add_u32 m0, s29, 126976
 ds_read_b64_tr_b16 a[64:65], v7 offset:0
 v_cvt_pk_bf16_f32 v208, v208, v209
 v_mfma_f32_16x16x32_bf16 v[232:235], a[112:115], a[48:51], v[232:235]
 ds_read_b64_tr_b16 a[66:67], v7 offset:4096
 buffer_load_dwordx4 v2, s[16:19], s54 offen lds
 v_mfma_f32_16x16x32_bf16 v[232:235], a[116:119], a[52:55], v[232:235]
 ds_read_b64_tr_b16 a[68:69], v7 offset:16384
 v_cvt_pk_bf16_f32 v209, v210, v211
 v_mfma_f32_16x16x32_bf16 v[236:239], a[124:127], a[52:55], v[236:239]
 ds_read_b64_tr_b16 a[70:71], v7 offset:20480
 v_xor_b32 v8, 65536, v6
 v_mfma_f32_16x16x32_bf16 v[236:239], a[120:123], a[48:51], v[236:239]
 ds_read_b64_tr_b16 a[72:73], v8 offset:0
 v_cvt_pk_bf16_f32 v210, v212, v213
 v_mfma_f32_16x16x32_bf16 v[244:247], a[120:123], a[56:59], v[244:247]
 ds_read_b64_tr_b16 a[74:75], v8 offset:4096
 v_cvt_pk_bf16_f32 v211, v214, v215
 v_mfma_f32_16x16x32_bf16 v[244:247], a[124:127], a[60:63], v[244:247]
 ds_read_b64_tr_b16 a[76:77], v8 offset:16384
 v_cvt_pk_bf16_f32 v216, v216, v217
 v_mfma_f32_16x16x32_bf16 v[240:243], a[116:119], a[60:63], v[240:243]
 ds_read_b64_tr_b16 a[78:79], v8 offset:20480
 v_xor_b32 v9, 32, v6
 v_mfma_f32_16x16x32_bf16 v[240:243], a[112:115], a[56:59], v[240:243]
 ds_read_b64_tr_b16 a[80:81], v9 offset:0
 v_cvt_pk_bf16_f32 v217, v218, v219
 v_mfma_f32_16x16x32_bf16 v[252:255], a[104:107], a[56:59], v[252:255]
 ds_read_b64_tr_b16 a[82:83], v9 offset:4096
 v_cvt_pk_bf16_f32 v218, v220, v221
 v_mfma_f32_16x16x32_bf16 v[252:255], a[108:111], a[60:63], v[252:255]
 ds_read_b64_tr_b16 a[84:85], v9 offset:16384
 v_cvt_pk_bf16_f32 v219, v222, v223
 v_mfma_f32_16x16x32_bf16 v[248:251], a[100:103], a[60:63], v[248:251]
 ds_read_b64_tr_b16 a[86:87], v9 offset:20480
 v_xor_b32 v10, 65568, v6
 v_mfma_f32_16x16x32_bf16 v[248:251], a[96:99], a[56:59], v[248:251]
 s_waitcnt lgkmcnt(6)
 ds_read_b64_tr_b16 a[88:89], v10 offset:0
 v_cvt_pk_bf16_f32 v224, v224, v225
 v_mfma_f32_16x16x32_bf16 v[28:31], a[64:67], a[128:131], 0
 ds_read_b64_tr_b16 a[90:91], v10 offset:4096
 v_cvt_pk_bf16_f32 v225, v226, v227
 v_mfma_f32_16x16x32_bf16 v[28:31], a[68:71], a[136:139], v[28:31]
 ds_read_b64_tr_b16 a[92:93], v10 offset:16384
 v_xor_b32 v7, 64, v6
 v_mfma_f32_16x16x32_bf16 v[28:31], a[72:75], a[144:147], v[28:31]
 s_waitcnt lgkmcnt(7)
 ds_read_b128 a[112:115], v14 offset:0
 ds_read_b64_tr_b16 a[94:95], v10 offset:20480
 v_mfma_f32_16x16x32_bf16 v[28:31], a[76:79], a[152:155], v[28:31]
 ds_read_b64_tr_b16 a[96:97], v7 offset:0
 v_cvt_pk_bf16_f32 v226, v228, v229
 v_mfma_f32_16x16x32_bf16 v[44:47], a[64:67], a[132:135], 0
 ds_read_b128 a[120:123], v3 offset:0
 ds_read_b64_tr_b16 a[98:99], v7 offset:4096
 v_mfma_f32_16x16x32_bf16 v[44:47], a[68:71], a[140:143], v[44:47]
 ds_read_b64_tr_b16 a[100:101], v7 offset:16384
 v_xor_b32 v8, 65600, v6
 v_mfma_f32_16x16x32_bf16 v[44:47], a[72:75], a[148:151], v[44:47]
 ds_read_b128 a[116:119], v14 offset:2048
 ds_read_b64_tr_b16 a[102:103], v7 offset:20480
 v_mfma_f32_16x16x32_bf16 v[44:47], a[76:79], a[156:159], v[44:47]
 s_waitcnt lgkmcnt(9)
 ds_read_b64_tr_b16 a[104:105], v8 offset:0
 v_cvt_pk_bf16_f32 v227, v230, v231
 v_mfma_f32_16x16x32_bf16 v[52:55], a[80:83], a[128:131], 0
 ds_read_b128 a[124:127], v3 offset:2048
 ds_read_b64_tr_b16 a[106:107], v8 offset:4096
 v_mfma_f32_16x16x32_bf16 v[52:55], a[84:87], a[136:139], v[52:55]
 ds_read_b64_tr_b16 a[108:109], v8 offset:16384
 v_cvt_pk_bf16_f32 v232, v232, v233
 v_mfma_f32_16x16x32_bf16 v[52:55], a[88:91], a[144:147], v[52:55]
 s_waitcnt lgkmcnt(10)
 ds_read_b64_tr_b16 a[110:111], v8 offset:20480
 v_xor_b32 v9, 96, v6
 v_mfma_f32_16x16x32_bf16 v[52:55], a[92:95], a[152:155], v[52:55]
 ds_read_b64_tr_b16 a[64:65], v9 offset:0
 v_cvt_pk_bf16_f32 v233, v234, v235
 v_mfma_f32_16x16x32_bf16 v[60:63], a[80:83], a[132:135], 0
 ds_read_b64_tr_b16 a[66:67], v9 offset:4096
 v_cvt_pk_bf16_f32 v234, v236, v237
 v_mfma_f32_16x16x32_bf16 v[60:63], a[84:87], a[140:143], v[60:63]
 ds_read_b64_tr_b16 a[68:69], v9 offset:16384
 v_cvt_pk_bf16_f32 v235, v238, v239
 v_mfma_f32_16x16x32_bf16 v[60:63], a[88:91], a[148:151], v[60:63]
 ds_read_b64_tr_b16 a[70:71], v9 offset:20480
 v_xor_b32 v10, 65632, v6
 v_mfma_f32_16x16x32_bf16 v[60:63], a[92:95], a[156:159], v[60:63]
 s_waitcnt lgkmcnt(6)
 ds_read_b64_tr_b16 a[72:73], v10 offset:0
 v_cvt_pk_bf16_f32 v240, v240, v241
 v_mfma_f32_16x16x32_bf16 v[20:23], a[96:99], a[128:131], 0
 ds_read_b64_tr_b16 a[74:75], v10 offset:4096
 v_cvt_pk_bf16_f32 v241, v242, v243
 v_mfma_f32_16x16x32_bf16 v[20:23], a[100:103], a[136:139], v[20:23]
 s_waitcnt lgkmcnt(8)
 ds_read_b64_tr_b16 a[76:77], v10 offset:16384
 v_xor_b32 v7, 128, v6
 v_mfma_f32_16x16x32_bf16 v[20:23], a[104:107], a[144:147], v[20:23]
 s_waitcnt lgkmcnt(7)
 s_barrier
 ds_read_b64_tr_b16 a[78:79], v10 offset:20480
 v_mfma_f32_16x16x32_bf16 v[20:23], a[108:111], a[152:155], v[20:23]
 s_add_u32 m0, s29, 131072
 ds_read_b64_tr_b16 a[80:81], v7 offset:0
 v_add_u32 v2, 0x80000, v2
 v_mfma_f32_16x16x32_bf16 v[36:39], a[96:99], a[132:135], 0
 ds_read_b64_tr_b16 a[82:83], v7 offset:4096
 buffer_load_dwordx4 v2, s[16:19], 0 offen lds
 v_mfma_f32_16x16x32_bf16 v[36:39], a[100:103], a[140:143], v[36:39]
 ds_read_b64_tr_b16 a[84:85], v7 offset:16384
 v_cvt_pk_bf16_f32 v242, v244, v245
 v_mfma_f32_16x16x32_bf16 v[36:39], a[104:107], a[148:151], v[36:39]
 ds_read_b64_tr_b16 a[86:87], v7 offset:20480
 v_xor_b32 v8, 65664, v6
 v_mfma_f32_16x16x32_bf16 v[36:39], a[108:111], a[156:159], v[36:39]
 s_waitcnt lgkmcnt(6)
 ds_read_b64_tr_b16 a[88:89], v8 offset:0
 v_cvt_pk_bf16_f32 v243, v246, v247
 v_mfma_f32_16x16x32_bf16 v[68:71], a[64:67], a[128:131], 0
 ds_read_b64_tr_b16 a[90:91], v8 offset:4096
 v_cvt_pk_bf16_f32 v248, v248, v249
 v_mfma_f32_16x16x32_bf16 v[68:71], a[68:71], a[136:139], v[68:71]
 s_add_u32 m0, s29, 135168
 ds_read_b64_tr_b16 a[92:93], v8 offset:16384
 v_cvt_pk_bf16_f32 v249, v250, v251
 v_mfma_f32_16x16x32_bf16 v[68:71], a[72:75], a[144:147], v[68:71]
 s_waitcnt lgkmcnt(7)
 ds_read_b64_tr_b16 a[94:95], v8 offset:20480
 v_xor_b32 v9, 160, v6
 v_mfma_f32_16x16x32_bf16 v[68:71], a[76:79], a[152:155], v[68:71]
 ds_read_b64_tr_b16 a[96:97], v9 offset:0
 buffer_load_dwordx4 v2, s[16:19], s48 offen lds
 v_mfma_f32_16x16x32_bf16 v[76:79], a[64:67], a[132:135], 0
 ds_read_b64_tr_b16 a[98:99], v9 offset:4096
 v_cvt_pk_bf16_f32 v250, v252, v253
 v_mfma_f32_16x16x32_bf16 v[76:79], a[68:71], a[140:143], v[76:79]
 ds_read_b64_tr_b16 a[100:101], v9 offset:16384
 v_cvt_pk_bf16_f32 v251, v254, v255
 v_mfma_f32_16x16x32_bf16 v[76:79], a[72:75], a[148:151], v[76:79]
 ds_read_b64_tr_b16 a[102:103], v9 offset:20480
 v_xor_b32 v10, 65696, v6
 v_mfma_f32_16x16x32_bf16 v[76:79], a[76:79], a[156:159], v[76:79]
 s_waitcnt lgkmcnt(6)
 ds_read_b64_tr_b16 a[104:105], v10 offset:0
 v_mov_b32 v12, 0
 v_mfma_f32_16x16x32_bf16 v[84:87], a[80:83], a[128:131], 0
 s_add_u32 m0, s29, 139264
 ds_read_b64_tr_b16 a[106:107], v10 offset:4096
 v_mfma_f32_16x16x32_bf16 v[84:87], a[84:87], a[136:139], v[84:87]
 ds_read_b64_tr_b16 a[108:109], v10 offset:16384
 buffer_load_dwordx4 v2, s[16:19], s49 offen lds
 v_mfma_f32_16x16x32_bf16 v[84:87], a[88:91], a[144:147], v[84:87]
 s_waitcnt lgkmcnt(7)
 ds_read_b64_tr_b16 a[110:111], v10 offset:20480
 v_xor_b32 v7, 192, v6
 v_mfma_f32_16x16x32_bf16 v[84:87], a[92:95], a[152:155], v[84:87]
 ds_read_b64_tr_b16 a[64:65], v7 offset:0
 global_load_dword a248, v12, s[90:91] offset:128 sc1
 v_mfma_f32_16x16x32_bf16 v[92:95], a[80:83], a[132:135], 0
 ds_read_b64_tr_b16 a[66:67], v7 offset:4096
 v_and_b32 v12, 11, v0
 v_mfma_f32_16x16x32_bf16 v[92:95], a[84:87], a[140:143], v[92:95]
 ds_read_b64_tr_b16 a[68:69], v7 offset:16384
 v_lshlrev_b32 v12, 2, v12
 v_mfma_f32_16x16x32_bf16 v[92:95], a[88:91], a[148:151], v[92:95]
 s_add_u32 m0, s29, 143360
 ds_read_b64_tr_b16 a[70:71], v7 offset:20480
 v_xor_b32 v8, 65728, v6
 v_mfma_f32_16x16x32_bf16 v[92:95], a[92:95], a[156:159], v[92:95]
 s_waitcnt lgkmcnt(6)
 ds_read_b64_tr_b16 a[72:73], v8 offset:0
 buffer_load_dwordx4 v2, s[16:19], s50 offen lds
 v_mfma_f32_16x16x32_bf16 v[100:103], a[96:99], a[128:131], 0
 ds_read_b64_tr_b16 a[74:75], v8 offset:4096
 v_mfma_f32_16x16x32_bf16 v[100:103], a[100:103], a[136:139], v[100:103]
 s_and_b32 s36, s95, 31
 ds_read_b64_tr_b16 a[76:77], v8 offset:16384
 v_mfma_f32_16x16x32_bf16 v[100:103], a[104:107], a[144:147], v[100:103]
 s_waitcnt lgkmcnt(7)
 ds_read_b64_tr_b16 a[78:79], v8 offset:20480
 v_xor_b32 v9, 224, v6
 v_mfma_f32_16x16x32_bf16 v[100:103], a[108:111], a[152:155], v[100:103]
 s_lshr_b32 s37, s95, 5
 ds_read_b64_tr_b16 a[80:81], v9 offset:0
 v_mfma_f32_16x16x32_bf16 v[108:111], a[96:99], a[132:135], 0
 s_add_u32 m0, s29, 147456
 ds_read_b64_tr_b16 a[82:83], v9 offset:4096
 v_mfma_f32_16x16x32_bf16 v[108:111], a[100:103], a[140:143], v[108:111]
 ds_read_b64_tr_b16 a[84:85], v9 offset:16384
 buffer_load_dwordx4 v2, s[16:19], s51 offen lds
 v_mfma_f32_16x16x32_bf16 v[108:111], a[104:107], a[148:151], v[108:111]
 s_lshl_b32 s38, s3, 4
 ds_read_b64_tr_b16 a[86:87], v9 offset:20480
 v_xor_b32 v10, 65760, v6
 v_mfma_f32_16x16x32_bf16 v[108:111], a[108:111], a[156:159], v[108:111]
 s_waitcnt lgkmcnt(6)
 ds_read_b64_tr_b16 a[88:89], v10 offset:0
 v_mfma_f32_16x16x32_bf16 v[116:119], a[64:67], a[128:131], 0
 s_lshl_b32 s39, s36, 6
 ds_read_b64_tr_b16 a[90:91], v10 offset:4096
 v_mfma_f32_16x16x32_bf16 v[116:119], a[68:71], a[136:139], v[116:119]
 s_add_u32 m0, s29, 151552
 ds_read_b64_tr_b16 a[92:93], v10 offset:16384
 v_mfma_f32_16x16x32_bf16 v[116:119], a[72:75], a[144:147], v[116:119]
 s_waitcnt lgkmcnt(7)
 ds_read_b64_tr_b16 a[94:95], v10 offset:20480
 v_xor_b32 v7, 256, v6
 v_mfma_f32_16x16x32_bf16 v[116:119], a[76:79], a[152:155], v[116:119]
 ds_read_b64_tr_b16 a[96:97], v7 offset:0
 buffer_load_dwordx4 v2, s[16:19], s52 offen lds
 v_mfma_f32_16x16x32_bf16 v[124:127], a[64:67], a[132:135], 0
 s_add_u32 s38, s38, s39
 ds_read_b64_tr_b16 a[98:99], v7 offset:4096
 v_mfma_f32_16x16x32_bf16 v[124:127], a[68:71], a[140:143], v[124:127]
 s_mul_i32 s38, s38, 896
 ds_read_b64_tr_b16 a[100:101], v7 offset:16384
 v_mfma_f32_16x16x32_bf16 v[124:127], a[72:75], a[148:151], v[124:127]
 s_lshl_b32 s39, s37, 7
 ds_read_b64_tr_b16 a[102:103], v7 offset:20480
 v_xor_b32 v8, 65792, v6
 v_mfma_f32_16x16x32_bf16 v[124:127], a[76:79], a[156:159], v[124:127]
 s_waitcnt lgkmcnt(6)
 ds_read_b64_tr_b16 a[104:105], v8 offset:0
 v_mfma_f32_16x16x32_bf16 v[132:135], a[80:83], a[128:131], 0
 s_add_u32 m0, s29, 155648
 ds_read_b64_tr_b16 a[106:107], v8 offset:4096
 v_mfma_f32_16x16x32_bf16 v[132:135], a[84:87], a[136:139], v[132:135]
 ds_read_b64_tr_b16 a[108:109], v8 offset:16384
 buffer_load_dwordx4 v2, s[16:19], s53 offen lds
 v_mfma_f32_16x16x32_bf16 v[132:135], a[88:91], a[144:147], v[132:135]
 s_waitcnt lgkmcnt(7)
 ds_read_b64_tr_b16 a[110:111], v8 offset:20480
 v_xor_b32 v9, 288, v6
 v_mfma_f32_16x16x32_bf16 v[132:135], a[92:95], a[152:155], v[132:135]
 s_add_u32 s38, s38, s39
 ds_read_b64_tr_b16 a[64:65], v9 offset:0
 v_mfma_f32_16x16x32_bf16 v[140:143], a[80:83], a[132:135], 0
 s_lshl_b32 s39, s37, 9
 ds_read_b64_tr_b16 a[66:67], v9 offset:4096
 v_mfma_f32_16x16x32_bf16 v[140:143], a[84:87], a[140:143], v[140:143]
 s_mov_b32 s4, s66
 ds_read_b64_tr_b16 a[68:69], v9 offset:16384
 v_mfma_f32_16x16x32_bf16 v[140:143], a[88:91], a[148:151], v[140:143]
 s_add_u32 m0, s29, 159744
 ds_read_b64_tr_b16 a[70:71], v9 offset:20480
 v_xor_b32 v10, 65824, v6
 v_mfma_f32_16x16x32_bf16 v[140:143], a[92:95], a[156:159], v[140:143]
 s_waitcnt lgkmcnt(6)
 ds_read_b64_tr_b16 a[72:73], v10 offset:0
 buffer_load_dwordx4 v2, s[16:19], s54 offen lds
 v_mfma_f32_16x16x32_bf16 v[148:151], a[96:99], a[128:131], 0
 s_mov_b32 s5, s67
 ds_read_b64_tr_b16 a[74:75], v10 offset:4096
 v_mfma_f32_16x16x32_bf16 v[148:151], a[100:103], a[136:139], v[148:151]
 s_mov_b32 s6, 1835008
 ds_read_b64_tr_b16 a[76:77], v10 offset:16384
 v_mfma_f32_16x16x32_bf16 v[148:151], a[104:107], a[144:147], v[148:151]
 s_waitcnt lgkmcnt(7)
 ds_read_b64_tr_b16 a[78:79], v10 offset:20480
 v_xor_b32 v7, 320, v6
 v_mfma_f32_16x16x32_bf16 v[148:151], a[108:111], a[152:155], v[148:151]
 s_mov_b32 s7, 0x20000
 ds_read_b64_tr_b16 a[80:81], v7 offset:0
 v_mfma_f32_16x16x32_bf16 v[156:159], a[96:99], a[132:135], 0
 s_mov_b32 s8, s68
 ds_read_b64_tr_b16 a[82:83], v7 offset:4096
 v_mfma_f32_16x16x32_bf16 v[156:159], a[100:103], a[140:143], v[156:159]
 s_mov_b32 s9, s69
 ds_read_b64_tr_b16 a[84:85], v7 offset:16384
 v_mfma_f32_16x16x32_bf16 v[156:159], a[104:107], a[148:151], v[156:159]
 s_mov_b32 s10, 1835008
 ds_read_b64_tr_b16 a[86:87], v7 offset:20480
 v_xor_b32 v8, 65856, v6
 v_mfma_f32_16x16x32_bf16 v[156:159], a[108:111], a[156:159], v[156:159]
 s_waitcnt lgkmcnt(6)
 ds_read_b64_tr_b16 a[88:89], v8 offset:0
 v_mfma_f32_16x16x32_bf16 v[164:167], a[64:67], a[128:131], 0
 s_mov_b32 s11, 0x20000
 ds_read_b64_tr_b16 a[90:91], v8 offset:4096
 v_mfma_f32_16x16x32_bf16 v[164:167], a[68:71], a[136:139], v[164:167]
 s_mov_b32 s20, s70
 ds_read_b64_tr_b16 a[92:93], v8 offset:16384
 v_mfma_f32_16x16x32_bf16 v[164:167], a[72:75], a[144:147], v[164:167]
 s_waitcnt lgkmcnt(7)
 ds_read_b64_tr_b16 a[94:95], v8 offset:20480
 v_xor_b32 v9, 352, v6
 v_mfma_f32_16x16x32_bf16 v[164:167], a[76:79], a[152:155], v[164:167]
 s_mov_b32 s21, s71
 ds_read_b64_tr_b16 a[96:97], v9 offset:0
 v_mfma_f32_16x16x32_bf16 v[172:175], a[64:67], a[132:135], 0
 s_mov_b32 s22, 3584
 ds_read_b64_tr_b16 a[98:99], v9 offset:4096
 v_mfma_f32_16x16x32_bf16 v[172:175], a[68:71], a[140:143], v[172:175]
 s_mov_b32 s23, 0x20000
 ds_read_b64_tr_b16 a[100:101], v9 offset:16384
 v_mfma_f32_16x16x32_bf16 v[172:175], a[72:75], a[148:151], v[172:175]
 ds_read_b64_tr_b16 a[102:103], v9 offset:20480
 v_xor_b32 v10, 65888, v6
 v_mfma_f32_16x16x32_bf16 v[172:175], a[76:79], a[156:159], v[172:175]
 s_waitcnt lgkmcnt(6)
 ds_read_b64_tr_b16 a[104:105], v10 offset:0
 v_mfma_f32_16x16x32_bf16 v[180:183], a[80:83], a[128:131], 0
 ds_read_b64_tr_b16 a[106:107], v10 offset:4096
 v_mfma_f32_16x16x32_bf16 v[180:183], a[84:87], a[136:139], v[180:183]
 ds_read_b64_tr_b16 a[108:109], v10 offset:16384
 v_mfma_f32_16x16x32_bf16 v[180:183], a[88:91], a[144:147], v[180:183]
 s_waitcnt lgkmcnt(7)
 ds_read_b64_tr_b16 a[110:111], v10 offset:20480
 v_xor_b32 v7, 384, v6
 v_mfma_f32_16x16x32_bf16 v[180:183], a[92:95], a[152:155], v[180:183]
 ds_read_b64_tr_b16 a[64:65], v7 offset:0
 v_mfma_f32_16x16x32_bf16 v[188:191], a[80:83], a[132:135], 0
 ds_read_b64_tr_b16 a[66:67], v7 offset:4096
 v_mfma_f32_16x16x32_bf16 v[188:191], a[84:87], a[140:143], v[188:191]
 ds_read_b64_tr_b16 a[68:69], v7 offset:16384
 v_mfma_f32_16x16x32_bf16 v[188:191], a[88:91], a[148:151], v[188:191]
 ds_read_b64_tr_b16 a[70:71], v7 offset:20480
 v_xor_b32 v8, 65920, v6
 v_mfma_f32_16x16x32_bf16 v[188:191], a[92:95], a[156:159], v[188:191]
 s_waitcnt lgkmcnt(6)
 ds_read_b64_tr_b16 a[72:73], v8 offset:0
 v_mfma_f32_16x16x32_bf16 v[196:199], a[96:99], a[128:131], 0
 ds_read_b64_tr_b16 a[74:75], v8 offset:4096
 v_mfma_f32_16x16x32_bf16 v[196:199], a[100:103], a[136:139], v[196:199]
 ds_read_b64_tr_b16 a[76:77], v8 offset:16384
 v_mfma_f32_16x16x32_bf16 v[196:199], a[104:107], a[144:147], v[196:199]
 s_waitcnt lgkmcnt(7)
 ds_read_b64_tr_b16 a[78:79], v8 offset:20480
 v_xor_b32 v9, 416, v6
 v_mfma_f32_16x16x32_bf16 v[196:199], a[108:111], a[152:155], v[196:199]
 ds_read_b64_tr_b16 a[80:81], v9 offset:0
 v_mfma_f32_16x16x32_bf16 v[204:207], a[96:99], a[132:135], 0
 ds_read_b64_tr_b16 a[82:83], v9 offset:4096
 v_mfma_f32_16x16x32_bf16 v[204:207], a[100:103], a[140:143], v[204:207]
 ds_read_b64_tr_b16 a[84:85], v9 offset:16384
 v_mfma_f32_16x16x32_bf16 v[204:207], a[104:107], a[148:151], v[204:207]
 ds_read_b64_tr_b16 a[86:87], v9 offset:20480
 v_xor_b32 v10, 65952, v6
 v_mfma_f32_16x16x32_bf16 v[204:207], a[108:111], a[156:159], v[204:207]
 s_waitcnt lgkmcnt(6)
 ds_read_b64_tr_b16 a[88:89], v10 offset:0
 v_mfma_f32_16x16x32_bf16 v[212:215], a[64:67], a[128:131], 0
 ds_read_b64_tr_b16 a[90:91], v10 offset:4096
 v_mfma_f32_16x16x32_bf16 v[212:215], a[68:71], a[136:139], v[212:215]
 ds_read_b64_tr_b16 a[92:93], v10 offset:16384
 v_mfma_f32_16x16x32_bf16 v[212:215], a[72:75], a[144:147], v[212:215]
 s_waitcnt lgkmcnt(7)
 ds_read_b64_tr_b16 a[94:95], v10 offset:20480
 v_xor_b32 v7, 448, v6
 v_mfma_f32_16x16x32_bf16 v[212:215], a[76:79], a[152:155], v[212:215]
 s_add_u32 s59, s56, 32768
 ds_read_b64_tr_b16 a[96:97], v7 offset:0
 v_mfma_f32_16x16x32_bf16 v[220:223], a[64:67], a[132:135], 0
 ds_read_b64_tr_b16 a[98:99], v7 offset:4096
 buffer_store_dwordx4 v[32:35], v1, s[12:15], s59 offen offset:2048 sc1
 v_mfma_f32_16x16x32_bf16 v[220:223], a[68:71], a[140:143], v[220:223]
 ds_read_b64_tr_b16 a[100:101], v7 offset:16384
 v_mfma_f32_16x16x32_bf16 v[220:223], a[72:75], a[148:151], v[220:223]
 ds_read_b64_tr_b16 a[102:103], v7 offset:20480
 v_xor_b32 v8, 65984, v6
 v_mfma_f32_16x16x32_bf16 v[220:223], a[76:79], a[156:159], v[220:223]
 s_waitcnt lgkmcnt(6)
 ds_read_b64_tr_b16 a[104:105], v8 offset:0
 v_mfma_f32_16x16x32_bf16 v[228:231], a[80:83], a[128:131], 0
 ds_read_b64_tr_b16 a[106:107], v8 offset:4096
 v_mfma_f32_16x16x32_bf16 v[228:231], a[84:87], a[136:139], v[228:231]
 ds_read_b64_tr_b16 a[108:109], v8 offset:16384
 v_mfma_f32_16x16x32_bf16 v[228:231], a[88:91], a[144:147], v[228:231]
 s_waitcnt lgkmcnt(7)
 ds_read_b64_tr_b16 a[110:111], v8 offset:20480
 v_xor_b32 v9, 480, v6
 v_mfma_f32_16x16x32_bf16 v[228:231], a[92:95], a[152:155], v[228:231]
 ds_read_b64_tr_b16 a[64:65], v9 offset:0
 v_mfma_f32_16x16x32_bf16 v[236:239], a[80:83], a[132:135], 0
 ds_read_b64_tr_b16 a[66:67], v9 offset:4096
 v_mfma_f32_16x16x32_bf16 v[236:239], a[84:87], a[140:143], v[236:239]
 ds_read_b64_tr_b16 a[68:69], v9 offset:16384
 v_mfma_f32_16x16x32_bf16 v[236:239], a[88:91], a[148:151], v[236:239]
 s_add_u32 s59, s56, 49152
 ds_read_b64_tr_b16 a[70:71], v9 offset:20480
 v_xor_b32 v10, 66016, v6
 v_mfma_f32_16x16x32_bf16 v[236:239], a[92:95], a[156:159], v[236:239]
 s_waitcnt lgkmcnt(6)
 ds_read_b64_tr_b16 a[72:73], v10 offset:0
 buffer_store_dwordx4 v[40:43], v1, s[12:15], s59 offen offset:2048 sc1
 v_mfma_f32_16x16x32_bf16 v[244:247], a[96:99], a[128:131], 0
 ds_read_b64_tr_b16 a[74:75], v10 offset:4096
 v_mfma_f32_16x16x32_bf16 v[244:247], a[100:103], a[136:139], v[244:247]
 s_waitcnt vmcnt(11)
 ds_read_b64_tr_b16 a[76:77], v10 offset:16384
 v_xor_b32 v7, 32768, v6
 v_mfma_f32_16x16x32_bf16 v[244:247], a[104:107], a[144:147], v[244:247]
 s_waitcnt lgkmcnt(7)
 s_barrier
 ds_read_b64_tr_b16 a[78:79], v10 offset:20480
 v_mfma_f32_16x16x32_bf16 v[244:247], a[108:111], a[152:155], v[244:247]
 ds_read_b64_tr_b16 a[80:81], v7 offset:0
 v_mfma_f32_16x16x32_bf16 v[252:255], a[96:99], a[132:135], 0
 ds_read_b64_tr_b16 a[82:83], v7 offset:4096
 v_mfma_f32_16x16x32_bf16 v[252:255], a[100:103], a[140:143], v[252:255]
 ds_read_b64_tr_b16 a[84:85], v7 offset:16384
 v_mfma_f32_16x16x32_bf16 v[252:255], a[104:107], a[148:151], v[252:255]
 ds_read_b64_tr_b16 a[86:87], v7 offset:20480
 v_xor_b32 v8, 98304, v6
 v_mfma_f32_16x16x32_bf16 v[252:255], a[108:111], a[156:159], v[252:255]
 s_waitcnt lgkmcnt(6)
 ds_read_b64_tr_b16 a[88:89], v8 offset:0
 v_mfma_f32_16x16x32_bf16 v[16:19], a[64:67], a[128:131], 0
 s_add_u32 s59, s56, 49152
 ds_read_b64_tr_b16 a[90:91], v8 offset:4096
 v_mfma_f32_16x16x32_bf16 v[16:19], a[68:71], a[136:139], v[16:19]
 ds_read_b64_tr_b16 a[92:93], v8 offset:16384
 buffer_store_dwordx4 v[48:51], v1, s[12:15], s59 offen offset:3072 sc1
 v_mfma_f32_16x16x32_bf16 v[16:19], a[72:75], a[144:147], v[16:19]
 s_waitcnt lgkmcnt(7)
 ds_read_b64_tr_b16 a[94:95], v8 offset:20480
 v_xor_b32 v9, 32800, v6
 v_mfma_f32_16x16x32_bf16 v[16:19], a[76:79], a[152:155], v[16:19]
 ds_read_b64_tr_b16 a[96:97], v9 offset:0
 v_mfma_f32_16x16x32_bf16 v[24:27], a[64:67], a[132:135], 0
 s_waitcnt lgkmcnt(9)
 ds_read_b64_tr_b16 a[98:99], v9 offset:4096
 v_mfma_f32_16x16x32_bf16 v[24:27], a[68:71], a[140:143], v[24:27]
 s_barrier
 ds_read_b64_tr_b16 a[100:101], v9 offset:16384
 v_mfma_f32_16x16x32_bf16 v[24:27], a[72:75], a[148:151], v[24:27]
 s_add_u32 m0, s29, 0
 ds_read_b64_tr_b16 a[102:103], v9 offset:20480
 v_xor_b32 v10, 98336, v6
 v_mfma_f32_16x16x32_bf16 v[24:27], a[76:79], a[156:159], v[24:27]
 s_waitcnt lgkmcnt(6)
 ds_read_b64_tr_b16 a[104:105], v10 offset:0
 v_add_u32 v2, 0x80000, v2
 v_mfma_f32_16x16x32_bf16 v[28:31], a[80:83], a[160:163], v[28:31]
 ds_read_b64_tr_b16 a[106:107], v10 offset:4096
 buffer_load_dwordx4 v2, s[16:19], 0 offen lds
 v_mfma_f32_16x16x32_bf16 v[28:31], a[84:87], a[168:171], v[28:31]
 s_add_u32 s59, s56, 32768
 ds_read_b64_tr_b16 a[108:109], v10 offset:16384
 v_mfma_f32_16x16x32_bf16 v[28:31], a[88:91], a[176:179], v[28:31]
 s_waitcnt lgkmcnt(7)
 ds_read_b64_tr_b16 a[110:111], v10 offset:20480
 v_xor_b32 v7, 32832, v6
 v_mfma_f32_16x16x32_bf16 v[28:31], a[92:95], a[184:187], v[28:31]
 ds_read_b64_tr_b16 a[64:65], v7 offset:0
 buffer_store_dwordx4 v[56:59], v1, s[12:15], s59 offen offset:3072 sc1
 v_mfma_f32_16x16x32_bf16 v[44:47], a[80:83], a[164:167], v[44:47]
 s_add_u32 m0, s29, 4096
 ds_read_b64_tr_b16 a[66:67], v7 offset:4096
 v_add_u32 v4, 4096, v1
 v_mfma_f32_16x16x32_bf16 v[44:47], a[84:87], a[172:175], v[44:47]
 ds_read_b64_tr_b16 a[68:69], v7 offset:16384
 buffer_load_dwordx4 v2, s[16:19], s48 offen lds
 v_mfma_f32_16x16x32_bf16 v[44:47], a[88:91], a[180:183], v[44:47]
 ds_read_b64_tr_b16 a[70:71], v7 offset:20480
 v_xor_b32 v8, 98368, v6
 v_mfma_f32_16x16x32_bf16 v[44:47], a[92:95], a[188:191], v[44:47]
 s_waitcnt lgkmcnt(6)
 ds_read_b64_tr_b16 a[72:73], v8 offset:0
 v_mfma_f32_16x16x32_bf16 v[52:55], a[96:99], a[160:163], v[52:55]
 ds_read_b64_tr_b16 a[74:75], v8 offset:4096
 v_mfma_f32_16x16x32_bf16 v[52:55], a[100:103], a[168:171], v[52:55]
 s_add_u32 m0, s29, 8192
 ds_read_b64_tr_b16 a[76:77], v8 offset:16384
 v_mfma_f32_16x16x32_bf16 v[52:55], a[104:107], a[176:179], v[52:55]
 s_waitcnt lgkmcnt(7)
 ds_read_b64_tr_b16 a[78:79], v8 offset:20480
 v_xor_b32 v9, 32864, v6
 v_mfma_f32_16x16x32_bf16 v[52:55], a[108:111], a[184:187], v[52:55]
 ds_read_b64_tr_b16 a[80:81], v9 offset:0
 buffer_load_dwordx4 v2, s[16:19], s49 offen lds
 v_mfma_f32_16x16x32_bf16 v[60:63], a[96:99], a[164:167], v[60:63]
 s_add_u32 s59, s56, 0
 ds_read_b64_tr_b16 a[82:83], v9 offset:4096
 v_mfma_f32_16x16x32_bf16 v[60:63], a[100:103], a[172:175], v[60:63]
 ds_read_b64_tr_b16 a[84:85], v9 offset:16384
 buffer_store_dwordx4 v[64:67], v1, s[12:15], s59 offen offset:0 sc1
 v_mfma_f32_16x16x32_bf16 v[60:63], a[104:107], a[180:183], v[60:63]
 s_add_u32 m0, s29, 12288
 ds_read_b64_tr_b16 a[86:87], v9 offset:20480
 v_xor_b32 v10, 98400, v6
 v_mfma_f32_16x16x32_bf16 v[60:63], a[108:111], a[188:191], v[60:63]
 s_waitcnt lgkmcnt(6)
 ds_read_b64_tr_b16 a[88:89], v10 offset:0
 v_mfma_f32_16x16x32_bf16 v[20:23], a[64:67], a[160:163], v[20:23]
 ds_read_b64_tr_b16 a[90:91], v10 offset:4096
 buffer_load_dwordx4 v2, s[16:19], s50 offen lds
 v_mfma_f32_16x16x32_bf16 v[20:23], a[68:71], a[168:171], v[20:23]
 ds_read_b64_tr_b16 a[92:93], v10 offset:16384
 v_mfma_f32_16x16x32_bf16 v[20:23], a[72:75], a[176:179], v[20:23]
 s_waitcnt lgkmcnt(7)
 ds_read_b64_tr_b16 a[94:95], v10 offset:20480
 v_xor_b32 v7, 32896, v6
 v_mfma_f32_16x16x32_bf16 v[20:23], a[76:79], a[184:187], v[20:23]
 ds_read_b64_tr_b16 a[96:97], v7 offset:0
 v_mfma_f32_16x16x32_bf16 v[36:39], a[64:67], a[164:167], v[36:39]
 s_add_u32 m0, s29, 16384
 ds_read_b64_tr_b16 a[98:99], v7 offset:4096
 v_mfma_f32_16x16x32_bf16 v[36:39], a[68:71], a[172:175], v[36:39]
 ds_read_b64_tr_b16 a[100:101], v7 offset:16384
 buffer_load_dwordx4 v2, s[16:19], s51 offen lds
 v_mfma_f32_16x16x32_bf16 v[36:39], a[72:75], a[180:183], v[36:39]
 s_add_u32 s59, s56, 16384
 ds_read_b64_tr_b16 a[102:103], v7 offset:20480
 v_xor_b32 v8, 98432, v6
 v_mfma_f32_16x16x32_bf16 v[36:39], a[76:79], a[188:191], v[36:39]
 s_waitcnt lgkmcnt(6)
 ds_read_b64_tr_b16 a[104:105], v8 offset:0
 buffer_store_dwordx4 v[72:75], v1, s[12:15], s59 offen offset:0 sc1
 v_mfma_f32_16x16x32_bf16 v[68:71], a[80:83], a[160:163], v[68:71]
 ds_read_b64_tr_b16 a[106:107], v8 offset:4096
 v_mfma_f32_16x16x32_bf16 v[68:71], a[84:87], a[168:171], v[68:71]
 s_add_u32 m0, s29, 20480
 ds_read_b64_tr_b16 a[108:109], v8 offset:16384
 v_mfma_f32_16x16x32_bf16 v[68:71], a[88:91], a[176:179], v[68:71]
 s_waitcnt lgkmcnt(7)
 ds_read_b64_tr_b16 a[110:111], v8 offset:20480
 v_xor_b32 v9, 32928, v6
 v_mfma_f32_16x16x32_bf16 v[68:71], a[92:95], a[184:187], v[68:71]
 ds_read_b64_tr_b16 a[64:65], v9 offset:0
 buffer_load_dwordx4 v2, s[16:19], s52 offen lds
 v_mfma_f32_16x16x32_bf16 v[76:79], a[80:83], a[164:167], v[76:79]
 ds_read_b64_tr_b16 a[66:67], v9 offset:4096
 v_mfma_f32_16x16x32_bf16 v[76:79], a[84:87], a[172:175], v[76:79]
 ds_read_b64_tr_b16 a[68:69], v9 offset:16384
 v_mfma_f32_16x16x32_bf16 v[76:79], a[88:91], a[180:183], v[76:79]
 s_add_u32 m0, s29, 24576
 ds_read_b64_tr_b16 a[70:71], v9 offset:20480
 v_xor_b32 v10, 98464, v6
 v_mfma_f32_16x16x32_bf16 v[76:79], a[92:95], a[188:191], v[76:79]
 s_waitcnt lgkmcnt(6)
 ds_read_b64_tr_b16 a[72:73], v10 offset:0
 v_mfma_f32_16x16x32_bf16 v[84:87], a[96:99], a[160:163], v[84:87]
 ds_read_b64_tr_b16 a[74:75], v10 offset:4096
 buffer_load_dwordx4 v2, s[16:19], s53 offen lds
 v_mfma_f32_16x16x32_bf16 v[84:87], a[100:103], a[168:171], v[84:87]
 s_add_u32 s59, s56, 16384
 ds_read_b64_tr_b16 a[76:77], v10 offset:16384
 v_mfma_f32_16x16x32_bf16 v[84:87], a[104:107], a[176:179], v[84:87]
 s_waitcnt lgkmcnt(7)
 ds_read_b64_tr_b16 a[78:79], v10 offset:20480
 v_xor_b32 v7, 32960, v6
 v_mfma_f32_16x16x32_bf16 v[84:87], a[108:111], a[184:187], v[84:87]
 ds_read_b64_tr_b16 a[80:81], v7 offset:0
 buffer_store_dwordx4 v[80:83], v1, s[12:15], s59 offen offset:1024 sc1
 v_mfma_f32_16x16x32_bf16 v[92:95], a[96:99], a[164:167], v[92:95]
 s_add_u32 m0, s29, 28672
 ds_read_b64_tr_b16 a[82:83], v7 offset:4096
 v_mfma_f32_16x16x32_bf16 v[92:95], a[100:103], a[172:175], v[92:95]
 ds_read_b64_tr_b16 a[84:85], v7 offset:16384
 buffer_load_dwordx4 v2, s[16:19], s54 offen lds
 v_mfma_f32_16x16x32_bf16 v[92:95], a[104:107], a[180:183], v[92:95]
 ds_read_b64_tr_b16 a[86:87], v7 offset:20480
 v_xor_b32 v8, 98496, v6
 v_mfma_f32_16x16x32_bf16 v[92:95], a[108:111], a[188:191], v[92:95]
 s_waitcnt lgkmcnt(6)
 ds_read_b64_tr_b16 a[88:89], v8 offset:0
 v_mfma_f32_16x16x32_bf16 v[100:103], a[64:67], a[160:163], v[100:103]
 s_add_u32 m0, s29, 65536
 ds_read_b64_tr_b16 a[90:91], v8 offset:4096
 v_add_u32 v2, 0x80000, v2
 v_mfma_f32_16x16x32_bf16 v[100:103], a[68:71], a[168:171], v[100:103]
 ds_read_b64_tr_b16 a[92:93], v8 offset:16384
 buffer_load_dwordx4 v2, s[16:19], 0 offen lds
 v_mfma_f32_16x16x32_bf16 v[100:103], a[72:75], a[176:179], v[100:103]
 s_waitcnt lgkmcnt(7)
 ds_read_b64_tr_b16 a[94:95], v8 offset:20480
 v_xor_b32 v9, 32992, v6
 v_mfma_f32_16x16x32_bf16 v[100:103], a[76:79], a[184:187], v[100:103]
 ds_read_b64_tr_b16 a[96:97], v9 offset:0
 v_mfma_f32_16x16x32_bf16 v[108:111], a[64:67], a[164:167], v[108:111]
 s_add_u32 s59, s56, 0
 ds_read_b64_tr_b16 a[98:99], v9 offset:4096
 v_mfma_f32_16x16x32_bf16 v[108:111], a[68:71], a[172:175], v[108:111]
 ds_read_b64_tr_b16 a[100:101], v9 offset:16384
 buffer_store_dwordx4 v[88:91], v1, s[12:15], s59 offen offset:1024 sc1
 v_mfma_f32_16x16x32_bf16 v[108:111], a[72:75], a[180:183], v[108:111]
 s_add_u32 m0, s29, 69632
 ds_read_b64_tr_b16 a[102:103], v9 offset:20480
 v_xor_b32 v10, 98528, v6
 v_mfma_f32_16x16x32_bf16 v[108:111], a[76:79], a[188:191], v[108:111]
 s_waitcnt lgkmcnt(6)
 ds_read_b64_tr_b16 a[104:105], v10 offset:0
 buffer_load_dwordx4 v2, s[16:19], s48 offen lds
 v_mfma_f32_16x16x32_bf16 v[116:119], a[80:83], a[160:163], v[116:119]
 ds_read_b64_tr_b16 a[106:107], v10 offset:4096
 v_mfma_f32_16x16x32_bf16 v[116:119], a[84:87], a[168:171], v[116:119]
 ds_read_b64_tr_b16 a[108:109], v10 offset:16384
 v_mfma_f32_16x16x32_bf16 v[116:119], a[88:91], a[176:179], v[116:119]
 s_waitcnt lgkmcnt(7)
 ds_read_b64_tr_b16 a[110:111], v10 offset:20480
 v_xor_b32 v7, 33024, v6
 v_mfma_f32_16x16x32_bf16 v[116:119], a[92:95], a[184:187], v[116:119]
 s_add_u32 m0, s29, 73728
 ds_read_b64_tr_b16 a[64:65], v7 offset:0
 v_mfma_f32_16x16x32_bf16 v[124:127], a[80:83], a[164:167], v[124:127]
 ds_read_b64_tr_b16 a[66:67], v7 offset:4096
 buffer_load_dwordx4 v2, s[16:19], s49 offen lds
 v_mfma_f32_16x16x32_bf16 v[124:127], a[84:87], a[172:175], v[124:127]
 ds_read_b64_tr_b16 a[68:69], v7 offset:16384
 v_mfma_f32_16x16x32_bf16 v[124:127], a[88:91], a[180:183], v[124:127]
 s_add_u32 s59, s56, 0
 ds_read_b64_tr_b16 a[70:71], v7 offset:20480
 v_xor_b32 v8, 98560, v6
 v_mfma_f32_16x16x32_bf16 v[124:127], a[92:95], a[188:191], v[124:127]
 s_waitcnt lgkmcnt(6)
 ds_read_b64_tr_b16 a[72:73], v8 offset:0
 buffer_store_dwordx4 v[96:99], v1, s[12:15], s59 offen offset:2048 sc1
 v_mfma_f32_16x16x32_bf16 v[132:135], a[96:99], a[160:163], v[132:135]
 s_add_u32 m0, s29, 77824
 ds_read_b64_tr_b16 a[74:75], v8 offset:4096
 v_mfma_f32_16x16x32_bf16 v[132:135], a[100:103], a[168:171], v[132:135]
 ds_read_b64_tr_b16 a[76:77], v8 offset:16384
 buffer_load_dwordx4 v2, s[16:19], s50 offen lds
 v_mfma_f32_16x16x32_bf16 v[132:135], a[104:107], a[176:179], v[132:135]
 s_waitcnt lgkmcnt(7)
 ds_read_b64_tr_b16 a[78:79], v8 offset:20480
 v_xor_b32 v9, 33056, v6
 v_mfma_f32_16x16x32_bf16 v[132:135], a[108:111], a[184:187], v[132:135]
 ds_read_b64_tr_b16 a[80:81], v9 offset:0
 v_mfma_f32_16x16x32_bf16 v[140:143], a[96:99], a[164:167], v[140:143]
 ds_read_b64_tr_b16 a[82:83], v9 offset:4096
 v_mfma_f32_16x16x32_bf16 v[140:143], a[100:103], a[172:175], v[140:143]
 ds_read_b64_tr_b16 a[84:85], v9 offset:16384
 v_mfma_f32_16x16x32_bf16 v[140:143], a[104:107], a[180:183], v[140:143]
 s_add_u32 m0, s29, 81920
 ds_read_b64_tr_b16 a[86:87], v9 offset:20480
 v_xor_b32 v10, 98592, v6
 v_mfma_f32_16x16x32_bf16 v[140:143], a[108:111], a[188:191], v[140:143]
 s_waitcnt lgkmcnt(6)
 ds_read_b64_tr_b16 a[88:89], v10 offset:0
 buffer_load_dwordx4 v2, s[16:19], s51 offen lds
 v_mfma_f32_16x16x32_bf16 v[148:151], a[64:67], a[160:163], v[148:151]
 s_add_u32 s59, s56, 16384
 ds_read_b64_tr_b16 a[90:91], v10 offset:4096
 v_mfma_f32_16x16x32_bf16 v[148:151], a[68:71], a[168:171], v[148:151]
 ds_read_b64_tr_b16 a[92:93], v10 offset:16384
 buffer_store_dwordx4 v[104:107], v1, s[12:15], s59 offen offset:2048 sc1
 v_mfma_f32_16x16x32_bf16 v[148:151], a[72:75], a[176:179], v[148:151]
 s_waitcnt lgkmcnt(7)
 ds_read_b64_tr_b16 a[94:95], v10 offset:20480
 v_xor_b32 v7, 33088, v6
 v_mfma_f32_16x16x32_bf16 v[148:151], a[76:79], a[184:187], v[148:151]
 s_add_u32 m0, s29, 86016
 ds_read_b64_tr_b16 a[96:97], v7 offset:0
 v_mfma_f32_16x16x32_bf16 v[156:159], a[64:67], a[164:167], v[156:159]
 ds_read_b64_tr_b16 a[98:99], v7 offset:4096
 buffer_load_dwordx4 v2, s[16:19], s52 offen lds
 v_mfma_f32_16x16x32_bf16 v[156:159], a[68:71], a[172:175], v[156:159]
 ds_read_b64_tr_b16 a[100:101], v7 offset:16384
 v_mfma_f32_16x16x32_bf16 v[156:159], a[72:75], a[180:183], v[156:159]
 ds_read_b64_tr_b16 a[102:103], v7 offset:20480
 v_xor_b32 v8, 98624, v6
 v_mfma_f32_16x16x32_bf16 v[156:159], a[76:79], a[188:191], v[156:159]
 s_waitcnt lgkmcnt(6)
 ds_read_b64_tr_b16 a[104:105], v8 offset:0
 v_mfma_f32_16x16x32_bf16 v[164:167], a[80:83], a[160:163], v[164:167]
 s_add_u32 m0, s29, 90112
 ds_read_b64_tr_b16 a[106:107], v8 offset:4096
 v_mfma_f32_16x16x32_bf16 v[164:167], a[84:87], a[168:171], v[164:167]
 ds_read_b64_tr_b16 a[108:109], v8 offset:16384
 buffer_load_dwordx4 v2, s[16:19], s53 offen lds
 v_mfma_f32_16x16x32_bf16 v[164:167], a[88:91], a[176:179], v[164:167]
 s_waitcnt lgkmcnt(7)
 ds_read_b64_tr_b16 a[110:111], v8 offset:20480
 v_xor_b32 v9, 33120, v6
 v_mfma_f32_16x16x32_bf16 v[164:167], a[92:95], a[184:187], v[164:167]
 s_add_u32 s59, s56, 16384
 ds_read_b64_tr_b16 a[64:65], v9 offset:0
 v_mfma_f32_16x16x32_bf16 v[172:175], a[80:83], a[164:167], v[172:175]
 ds_read_b64_tr_b16 a[66:67], v9 offset:4096
 buffer_store_dwordx4 v[112:115], v1, s[12:15], s59 offen offset:3072 sc1
 v_mfma_f32_16x16x32_bf16 v[172:175], a[84:87], a[172:175], v[172:175]
 ds_read_b64_tr_b16 a[68:69], v9 offset:16384
 v_mfma_f32_16x16x32_bf16 v[172:175], a[88:91], a[180:183], v[172:175]
 s_add_u32 m0, s29, 94208
 ds_read_b64_tr_b16 a[70:71], v9 offset:20480
 v_xor_b32 v10, 98656, v6
 v_mfma_f32_16x16x32_bf16 v[172:175], a[92:95], a[188:191], v[172:175]
 s_waitcnt lgkmcnt(6)
 ds_read_b64_tr_b16 a[72:73], v10 offset:0
 buffer_load_dwordx4 v2, s[16:19], s54 offen lds
 v_mfma_f32_16x16x32_bf16 v[180:183], a[96:99], a[160:163], v[180:183]
 ds_read_b64_tr_b16 a[74:75], v10 offset:4096
 v_mfma_f32_16x16x32_bf16 v[180:183], a[100:103], a[168:171], v[180:183]
 ds_read_b64_tr_b16 a[76:77], v10 offset:16384
 v_mfma_f32_16x16x32_bf16 v[180:183], a[104:107], a[176:179], v[180:183]
 s_waitcnt lgkmcnt(7)
 ds_read_b64_tr_b16 a[78:79], v10 offset:20480
 v_xor_b32 v7, 33152, v6
 v_mfma_f32_16x16x32_bf16 v[180:183], a[108:111], a[184:187], v[180:183]
 ds_read_b64_tr_b16 a[80:81], v7 offset:0
 v_mfma_f32_16x16x32_bf16 v[188:191], a[96:99], a[164:167], v[188:191]
 ds_read_b64_tr_b16 a[82:83], v7 offset:4096
 v_mfma_f32_16x16x32_bf16 v[188:191], a[100:103], a[172:175], v[188:191]
 ds_read_b64_tr_b16 a[84:85], v7 offset:16384
 v_mfma_f32_16x16x32_bf16 v[188:191], a[104:107], a[180:183], v[188:191]
 s_add_u32 s59, s56, 0
 ds_read_b64_tr_b16 a[86:87], v7 offset:20480
 v_xor_b32 v8, 98688, v6
 v_mfma_f32_16x16x32_bf16 v[188:191], a[108:111], a[188:191], v[188:191]
 s_waitcnt lgkmcnt(6)
 ds_read_b64_tr_b16 a[88:89], v8 offset:0
 buffer_store_dwordx4 v[120:123], v1, s[12:15], s59 offen offset:3072 sc1
 v_mfma_f32_16x16x32_bf16 v[196:199], a[64:67], a[160:163], v[196:199]
 ds_read_b64_tr_b16 a[90:91], v8 offset:4096
 v_mfma_f32_16x16x32_bf16 v[196:199], a[68:71], a[168:171], v[196:199]
 ds_read_b64_tr_b16 a[92:93], v8 offset:16384
 v_mfma_f32_16x16x32_bf16 v[196:199], a[72:75], a[176:179], v[196:199]
 s_waitcnt lgkmcnt(7)
 ds_read_b64_tr_b16 a[94:95], v8 offset:20480
 v_xor_b32 v9, 33184, v6
 v_mfma_f32_16x16x32_bf16 v[196:199], a[76:79], a[184:187], v[196:199]
 ds_read_b64_tr_b16 a[96:97], v9 offset:0
 v_mfma_f32_16x16x32_bf16 v[204:207], a[64:67], a[164:167], v[204:207]
 ds_read_b64_tr_b16 a[98:99], v9 offset:4096
 v_mfma_f32_16x16x32_bf16 v[204:207], a[68:71], a[172:175], v[204:207]
 ds_read_b64_tr_b16 a[100:101], v9 offset:16384
 v_mfma_f32_16x16x32_bf16 v[204:207], a[72:75], a[180:183], v[204:207]
 ds_read_b64_tr_b16 a[102:103], v9 offset:20480
 v_xor_b32 v10, 98720, v6
 v_mfma_f32_16x16x32_bf16 v[204:207], a[76:79], a[188:191], v[204:207]
 s_waitcnt lgkmcnt(6)
 ds_read_b64_tr_b16 a[104:105], v10 offset:0
 v_mfma_f32_16x16x32_bf16 v[212:215], a[80:83], a[160:163], v[212:215]
 s_add_u32 s59, s56, 4096
 ds_read_b64_tr_b16 a[106:107], v10 offset:4096
 v_mfma_f32_16x16x32_bf16 v[212:215], a[84:87], a[168:171], v[212:215]
 ds_read_b64_tr_b16 a[108:109], v10 offset:16384
 buffer_store_dwordx4 v[128:131], v1, s[12:15], s59 offen offset:0 sc1
 v_mfma_f32_16x16x32_bf16 v[212:215], a[88:91], a[176:179], v[212:215]
 s_waitcnt lgkmcnt(7)
 ds_read_b64_tr_b16 a[110:111], v10 offset:20480
 v_xor_b32 v7, 33216, v6
 v_mfma_f32_16x16x32_bf16 v[212:215], a[92:95], a[184:187], v[212:215]
 ds_read_b64_tr_b16 a[64:65], v7 offset:0
 v_lshrrev_b32 v120, 3, v0
 v_mfma_f32_16x16x32_bf16 v[220:223], a[80:83], a[164:167], v[220:223]
 ds_read_b64_tr_b16 a[66:67], v7 offset:4096
 v_mul_u32_u24 v120, 1792, v120
 v_mfma_f32_16x16x32_bf16 v[220:223], a[84:87], a[172:175], v[220:223]
 ds_read_b64_tr_b16 a[68:69], v7 offset:16384
 v_and_b32 v121, 7, v0
 v_mfma_f32_16x16x32_bf16 v[220:223], a[88:91], a[180:183], v[220:223]
 ds_read_b64_tr_b16 a[70:71], v7 offset:20480
 v_xor_b32 v8, 98752, v6
 v_mfma_f32_16x16x32_bf16 v[220:223], a[92:95], a[188:191], v[220:223]
 s_waitcnt lgkmcnt(6)
 ds_read_b64_tr_b16 a[72:73], v8 offset:0
 v_lshl_add_u32 v120, v121, 4, v120
 v_mfma_f32_16x16x32_bf16 v[228:231], a[96:99], a[160:163], v[228:231]
 ds_read_b64_tr_b16 a[74:75], v8 offset:4096
 v_add_u32 v120, s38, v120
 v_mfma_f32_16x16x32_bf16 v[228:231], a[100:103], a[168:171], v[228:231]
 s_add_u32 s59, s56, 20480
 ds_read_b64_tr_b16 a[76:77], v8 offset:16384
 v_lshlrev_b32 v121, 6, v121
 v_mfma_f32_16x16x32_bf16 v[228:231], a[104:107], a[176:179], v[228:231]
 s_waitcnt lgkmcnt(7)
 ds_read_b64_tr_b16 a[78:79], v8 offset:20480
 v_xor_b32 v9, 33248, v6
 v_mfma_f32_16x16x32_bf16 v[228:231], a[108:111], a[184:187], v[228:231]
 ds_read_b64_tr_b16 a[80:81], v9 offset:0
 buffer_store_dwordx4 v[136:139], v1, s[12:15], s59 offen offset:0 sc1
 v_mfma_f32_16x16x32_bf16 v[236:239], a[96:99], a[164:167], v[236:239]
 ds_read_b64_tr_b16 a[82:83], v9 offset:4096
 v_subrev_u32 v122, 2688, v120
 v_mfma_f32_16x16x32_bf16 v[236:239], a[100:103], a[172:175], v[236:239]
 ds_read_b64_tr_b16 a[84:85], v9 offset:16384
 v_subrev_u32 v123, 1792, v120
 v_mfma_f32_16x16x32_bf16 v[236:239], a[104:107], a[180:183], v[236:239]
 ds_read_b64_tr_b16 a[86:87], v9 offset:20480
 v_xor_b32 v10, 98784, v6
 v_mfma_f32_16x16x32_bf16 v[236:239], a[108:111], a[188:191], v[236:239]
 s_waitcnt lgkmcnt(6)
 ds_read_b64_tr_b16 a[88:89], v10 offset:0
 v_subrev_u32 v128, 896, v120
 v_mfma_f32_16x16x32_bf16 v[244:247], a[64:67], a[160:163], v[244:247]
 ds_read_b64_tr_b16 a[90:91], v10 offset:4096
 buffer_load_dwordx4 v[32:35], v122, s[4:7], 0 offen
 v_mfma_f32_16x16x32_bf16 v[244:247], a[68:71], a[168:171], v[244:247]
 s_waitcnt vmcnt(4)
 ds_read_b64_tr_b16 a[92:93], v10 offset:16384
 v_xor_b32 v7, 131072, v6
 v_mfma_f32_16x16x32_bf16 v[244:247], a[72:75], a[176:179], v[244:247]
 s_waitcnt lgkmcnt(7)
 s_barrier
 ds_read_b64_tr_b16 a[94:95], v10 offset:20480
 v_mfma_f32_16x16x32_bf16 v[244:247], a[76:79], a[184:187], v[244:247]
 s_and_b32 s58, s92, ~127
 ds_read_b64_tr_b16 a[96:97], v7 offset:0
 v_mfma_f32_16x16x32_bf16 v[252:255], a[64:67], a[164:167], v[252:255]
 s_add_u32 s59, s56, 20480
 ds_read_b64_tr_b16 a[98:99], v7 offset:4096
 v_mfma_f32_16x16x32_bf16 v[252:255], a[68:71], a[172:175], v[252:255]
 ds_read_b64_tr_b16 a[100:101], v7 offset:16384
 buffer_store_dwordx4 v[144:147], v1, s[12:15], s59 offen offset:1024 sc1
 v_mfma_f32_16x16x32_bf16 v[252:255], a[72:75], a[180:183], v[252:255]
 s_lshl_b32 s37, s25, 1
 ds_read_b64_tr_b16 a[102:103], v7 offset:20480
 v_xor_b32 v8, 0, v6
 v_mfma_f32_16x16x32_bf16 v[252:255], a[76:79], a[188:191], v[252:255]
 s_waitcnt lgkmcnt(6)
 ds_read_b64_tr_b16 a[104:105], v8 offset:0
 buffer_load_dwordx4 v[40:43], v123, s[4:7], 0 offen
 v_mfma_f32_16x16x32_bf16 v[16:19], a[80:83], a[160:163], v[16:19]
 s_sub_i32 s38, 12, s37
 ds_read_b64_tr_b16 a[106:107], v8 offset:4096
 v_accvgpr_read_b32 v5, a248
 v_mfma_f32_16x16x32_bf16 v[16:19], a[84:87], a[168:171], v[16:19]
 s_max_i32 s38, s38, 0
 ds_read_b64_tr_b16 a[108:109], v8 offset:16384
 v_mfma_f32_16x16x32_bf16 v[16:19], a[88:91], a[176:179], v[16:19]
 s_waitcnt lgkmcnt(7)
 ds_read_b64_tr_b16 a[110:111], v8 offset:20480
 v_xor_b32 v9, 65536, v6
 v_mfma_f32_16x16x32_bf16 v[16:19], a[92:95], a[184:187], v[16:19]
 ds_read_b64_tr_b16 a[64:65], v9 offset:0
 buffer_load_dwordx4 v[48:51], v128, s[4:7], 0 offen
 v_mfma_f32_16x16x32_bf16 v[24:27], a[80:83], a[164:167], v[24:27]
 s_mul_i32 s49, s26, 1048576
 ds_read_b64_tr_b16 a[66:67], v9 offset:4096
 v_mfma_f32_16x16x32_bf16 v[24:27], a[84:87], a[172:175], v[24:27]
 s_lshl_b32 s50, s3, 13
 ds_read_b64_tr_b16 a[68:69], v9 offset:16384
 v_mfma_f32_16x16x32_bf16 v[24:27], a[88:91], a[180:183], v[24:27]
 s_add_u32 s59, s56, 4096
 ds_read_b64_tr_b16 a[70:71], v9 offset:20480
 v_xor_b32 v10, 131104, v6
 v_mfma_f32_16x16x32_bf16 v[24:27], a[92:95], a[188:191], v[24:27]
 s_waitcnt lgkmcnt(6)
 ds_read_b64_tr_b16 a[72:73], v10 offset:0
 buffer_store_dwordx4 v[152:155], v1, s[12:15], s59 offen offset:1024 sc1
 v_mfma_f32_16x16x32_bf16 v[28:31], a[96:99], a[192:195], v[28:31]
 s_add_u32 s49, s49, s50
 ds_read_b64_tr_b16 a[74:75], v10 offset:4096
 v_mfma_f32_16x16x32_bf16 v[28:31], a[100:103], a[200:203], v[28:31]
 ds_read_b64_tr_b16 a[76:77], v10 offset:16384
 buffer_load_dwordx4 v[56:59], v120, s[4:7], 0 offen offset:0
 v_mfma_f32_16x16x32_bf16 v[28:31], a[104:107], a[208:211], v[28:31]
 s_waitcnt lgkmcnt(3)
 ds_read_b64_tr_b16 a[78:79], v10 offset:20480
 v_xor_b32 v7, 32, v6
 v_mfma_f32_16x16x32_bf16 v[28:31], a[108:111], a[216:219], v[28:31]
 s_mov_b32 s54, 2
 ds_read_b64_tr_b16 a[80:81], v7 offset:0
 v_mfma_f32_16x16x32_bf16 v[28:31], a[64:67], a[112:115], v[28:31]
 s_sub_u32 s44, 31, s37
 ds_read_b64_tr_b16 a[82:83], v7 offset:4096
 v_mfma_f32_16x16x32_bf16 v[28:31], a[68:71], a[120:123], v[28:31]
 ds_read_b64_tr_b16 a[84:85], v7 offset:16384
 buffer_load_dwordx4 v[64:67], v120, s[4:7], 0 offen offset:896
 v_mfma_f32_16x16x32_bf16 v[44:47], a[96:99], a[196:199], v[44:47]
 s_sub_u32 s44, s44, s38
 ds_read_b64_tr_b16 a[86:87], v7 offset:20480
 v_xor_b32 v8, 65568, v6
 v_mfma_f32_16x16x32_bf16 v[44:47], a[100:103], a[204:207], v[44:47]
 s_mul_i32 s55, s38, 32768
 ds_read_b64_tr_b16 a[88:89], v8 offset:0
 v_mfma_f32_16x16x32_bf16 v[44:47], a[104:107], a[212:215], v[44:47]
 s_add_u32 s59, s56, 4096
 ds_read_b64_tr_b16 a[90:91], v8 offset:4096
 v_mfma_f32_16x16x32_bf16 v[44:47], a[108:111], a[220:223], v[44:47]
 ds_read_b64_tr_b16 a[92:93], v8 offset:16384
 buffer_store_dwordx4 v[160:163], v1, s[12:15], s59 offen offset:2048 sc1
 v_mfma_f32_16x16x32_bf16 v[44:47], a[64:67], a[116:119], v[44:47]
 s_add_u32 s42, s55, s49
 ds_read_b64_tr_b16 a[94:95], v8 offset:20480
 v_xor_b32 v9, 131136, v6
 v_mfma_f32_16x16x32_bf16 v[44:47], a[68:71], a[124:127], v[44:47]
 s_waitcnt lgkmcnt(6)
 ds_read_b64_tr_b16 a[96:97], v9 offset:0
 buffer_load_dwordx4 v[72:75], v120, s[8:11], 0 offen offset:0
 v_mfma_f32_16x16x32_bf16 v[52:55], a[72:75], a[192:195], v[52:55]
 s_add_u32 s60, s58, 16
 ds_read_b64_tr_b16 a[98:99], v9 offset:4096
 v_mfma_f32_16x16x32_bf16 v[52:55], a[76:79], a[200:203], v[52:55]
 s_sub_u32 s45, 17, s37
 ds_read_b64_tr_b16 a[100:101], v9 offset:16384
 v_mfma_f32_16x16x32_bf16 v[52:55], a[80:83], a[208:211], v[52:55]
 s_waitcnt lgkmcnt(3)
 ds_read_b64_tr_b16 a[102:103], v9 offset:20480
 v_xor_b32 v10, 64, v6
 v_mfma_f32_16x16x32_bf16 v[52:55], a[84:87], a[216:219], v[52:55]
 ds_read_b64_tr_b16 a[104:105], v10 offset:0
 buffer_load_dwordx4 v[80:83], v120, s[8:11], 0 offen offset:896
 v_mfma_f32_16x16x32_bf16 v[52:55], a[88:91], a[112:115], v[52:55]
 s_sub_u32 s66, s42, 32768
 ds_read_b64_tr_b16 a[106:107], v10 offset:4096
 v_mfma_f32_16x16x32_bf16 v[52:55], a[92:95], a[120:123], v[52:55]
 s_add_u32 s42, s49, 491520
 ds_read_b64_tr_b16 a[108:109], v10 offset:16384
 v_mfma_f32_16x16x32_bf16 v[60:63], a[72:75], a[196:199], v[60:63]
 s_add_u32 s59, s56, 20480
 ds_read_b64_tr_b16 a[110:111], v10 offset:20480
 v_xor_b32 v7, 65600, v6
 v_mfma_f32_16x16x32_bf16 v[60:63], a[76:79], a[204:207], v[60:63]
 ds_read_b64_tr_b16 a[64:65], v7 offset:0
 buffer_store_dwordx4 v[168:171], v1, s[12:15], s59 offen offset:2048 sc1
 v_mfma_f32_16x16x32_bf16 v[60:63], a[80:83], a[212:215], v[60:63]
 s_add_u32 s67, s49, 524288
 ds_read_b64_tr_b16 a[66:67], v7 offset:4096
 v_mfma_f32_16x16x32_bf16 v[60:63], a[84:87], a[220:223], v[60:63]
 ds_read_b64_tr_b16 a[68:69], v7 offset:16384
 buffer_load_dwordx4 v[88:91], v121, s[20:23], s39 offen offset:0
 v_mfma_f32_16x16x32_bf16 v[60:63], a[88:91], a[116:119], v[60:63]
 s_add_u32 s68, s66, 16777216
 ds_read_b64_tr_b16 a[70:71], v7 offset:20480
 v_xor_b32 v8, 131168, v6
 v_mfma_f32_16x16x32_bf16 v[60:63], a[92:95], a[124:127], v[60:63]
 s_waitcnt lgkmcnt(6)
 ds_read_b64_tr_b16 a[72:73], v8 offset:0
 v_mfma_f32_16x16x32_bf16 v[20:23], a[96:99], a[192:195], v[20:23]
 s_add_u32 s69, s67, 16777216
 ds_read_b64_tr_b16 a[74:75], v8 offset:4096
 v_mfma_f32_16x16x32_bf16 v[20:23], a[100:103], a[200:203], v[20:23]
 ds_read_b64_tr_b16 a[76:77], v8 offset:16384
 buffer_load_dwordx4 v[96:99], v121, s[20:23], s39 offen offset:16
 v_mfma_f32_16x16x32_bf16 v[20:23], a[104:107], a[208:211], v[20:23]
 s_waitcnt lgkmcnt(3)
 ds_read_b64_tr_b16 a[78:79], v8 offset:20480
 v_xor_b32 v9, 96, v6
 v_mfma_f32_16x16x32_bf16 v[20:23], a[108:111], a[216:219], v[20:23]
 s_mov_b32 s70, 0xffff8000
 ds_read_b64_tr_b16 a[80:81], v9 offset:0
 v_mul_f32 v28, s34, v28
 v_mfma_f32_16x16x32_bf16 v[20:23], a[64:67], a[112:115], v[20:23]
 s_add_u32 s59, s56, 20480
 ds_read_b64_tr_b16 a[82:83], v9 offset:4096
 v_mul_f32 v29, s34, v29
 v_mfma_f32_16x16x32_bf16 v[20:23], a[68:71], a[120:123], v[20:23]
 ds_read_b64_tr_b16 a[84:85], v9 offset:16384
 buffer_store_dwordx4 v[176:179], v1, s[12:15], s59 offen offset:3072 sc1
 v_mfma_f32_16x16x32_bf16 v[36:39], a[96:99], a[196:199], v[36:39]
 s_mov_b32 s71, s70
 ds_read_b64_tr_b16 a[86:87], v9 offset:20480
 v_xor_b32 v10, 65632, v6
 v_mfma_f32_16x16x32_bf16 v[36:39], a[100:103], a[204:207], v[36:39]
 ds_read_b64_tr_b16 a[88:89], v10 offset:0
 buffer_load_dwordx4 v[104:107], v121, s[20:23], s39 offen offset:32
 v_mfma_f32_16x16x32_bf16 v[36:39], a[104:107], a[212:215], v[36:39]
 s_add_u32 s43, s42, 16777216
 ds_read_b64_tr_b16 a[90:91], v10 offset:4096
 v_mul_f32 v30, s34, v30
 v_mfma_f32_16x16x32_bf16 v[36:39], a[108:111], a[220:223], v[36:39]
 s_mov_b32 s40, s50
 ds_read_b64_tr_b16 a[92:93], v10 offset:16384
 v_mul_f32 v31, s34, v31
 v_mfma_f32_16x16x32_bf16 v[36:39], a[64:67], a[116:119], v[36:39]
 s_add_u32 s41, s50, 0x10000
 ds_read_b64_tr_b16 a[94:95], v10 offset:20480
 v_xor_b32 v7, 131200, v6
 v_mfma_f32_16x16x32_bf16 v[36:39], a[68:71], a[124:127], v[36:39]
 s_waitcnt lgkmcnt(6)
 ds_read_b64_tr_b16 a[96:97], v7 offset:0
 buffer_load_dwordx4 v[112:115], v121, s[20:23], s39 offen offset:48
 v_mfma_f32_16x16x32_bf16 v[68:71], a[72:75], a[192:195], v[68:71]
 s_lshr_b32 s61, s95, 4
 ds_read_b64_tr_b16 a[98:99], v7 offset:4096
 v_mul_f32 v52, s34, v52
 v_mfma_f32_16x16x32_bf16 v[68:71], a[76:79], a[200:203], v[68:71]
 s_add_u32 s59, s56, 4096
 ds_read_b64_tr_b16 a[100:101], v7 offset:16384
 v_mul_f32 v53, s34, v53
 v_mfma_f32_16x16x32_bf16 v[68:71], a[80:83], a[208:211], v[68:71]
 s_waitcnt lgkmcnt(3)
 ds_read_b64_tr_b16 a[102:103], v7 offset:20480
 v_xor_b32 v8, 128, v6
 v_mfma_f32_16x16x32_bf16 v[68:71], a[84:87], a[216:219], v[68:71]
 ds_read_b64_tr_b16 a[104:105], v8 offset:0
 buffer_store_dwordx4 v[184:187], v1, s[12:15], s59 offen offset:3072 sc1
 v_mfma_f32_16x16x32_bf16 v[68:71], a[88:91], a[112:115], v[68:71]
 s_lshl_b32 s61, s61, 7
 ds_read_b64_tr_b16 a[106:107], v8 offset:4096
 v_mul_f32 v54, s34, v54
 v_mfma_f32_16x16x32_bf16 v[68:71], a[92:95], a[120:123], v[68:71]
 s_add_u32 s61, s61, 84959232
 ds_read_b64_tr_b16 a[108:109], v8 offset:16384
 v_mul_f32 v55, s34, v55
 v_mfma_f32_16x16x32_bf16 v[76:79], a[72:75], a[196:199], v[76:79]
 s_mov_b32 s47, 0x4b800000
 ds_read_b64_tr_b16 a[110:111], v8 offset:20480
 v_xor_b32 v9, 65664, v6
 v_mfma_f32_16x16x32_bf16 v[76:79], a[76:79], a[204:207], v[76:79]
 s_lshl_b32 s30, s95, 1
 ds_read_b64_tr_b16 a[64:65], v9 offset:0
 v_cvt_pk_bf16_f32 v28, v28, v29
 v_mfma_f32_16x16x32_bf16 v[76:79], a[80:83], a[212:215], v[76:79]
 s_lshr_b32 s31, s3, 1
 ds_read_b64_tr_b16 a[66:67], v9 offset:4096
 v_cvt_pk_bf16_f32 v29, v30, v31
 v_mfma_f32_16x16x32_bf16 v[76:79], a[84:87], a[220:223], v[76:79]
 s_add_u32 s30, s30, s31
 ds_read_b64_tr_b16 a[68:69], v9 offset:16384
 v_cvt_pk_bf16_f32 v30, v52, v53
 v_mfma_f32_16x16x32_bf16 v[76:79], a[88:91], a[116:119], v[76:79]
 s_min_u32 s30, s30, 223
 ds_read_b64_tr_b16 a[70:71], v9 offset:20480
 v_xor_b32 v10, 131232, v6
 v_mfma_f32_16x16x32_bf16 v[76:79], a[92:95], a[124:127], v[76:79]
 s_waitcnt lgkmcnt(6)
 ds_read_b64_tr_b16 a[72:73], v10 offset:0
 v_cvt_pk_bf16_f32 v31, v54, v55
 v_mfma_f32_16x16x32_bf16 v[84:87], a[96:99], a[192:195], v[84:87]
 s_add_u32 s59, s56, 36864
 ds_read_b64_tr_b16 a[74:75], v10 offset:4096
 v_accvgpr_write_b32 a0, v28
 v_mfma_f32_16x16x32_bf16 v[84:87], a[100:103], a[200:203], v[84:87]
 ds_read_b64_tr_b16 a[76:77], v10 offset:16384
 buffer_store_dwordx4 v[192:195], v1, s[12:15], s59 offen offset:0 sc1
 v_mfma_f32_16x16x32_bf16 v[84:87], a[104:107], a[208:211], v[84:87]
 s_waitcnt lgkmcnt(3)
 ds_read_b64_tr_b16 a[78:79], v10 offset:20480
 v_xor_b32 v7, 160, v6
 v_mfma_f32_16x16x32_bf16 v[84:87], a[108:111], a[216:219], v[84:87]
 s_lshl_b32 s30, s30, 2
 ds_read_b64_tr_b16 a[80:81], v7 offset:0
 v_accvgpr_write_b32 a1, v29
 v_mfma_f32_16x16x32_bf16 v[84:87], a[64:67], a[112:115], v[84:87]
 s_lshl_b32 s53, s3, 4
 ds_read_b64_tr_b16 a[82:83], v7 offset:4096
 v_accvgpr_write_b32 a2, v30
 v_mfma_f32_16x16x32_bf16 v[84:87], a[68:71], a[120:123], v[84:87]
 ds_read_b64_tr_b16 a[84:85], v7 offset:16384
 v_accvgpr_write_b32 a3, v31
 v_mfma_f32_16x16x32_bf16 v[92:95], a[96:99], a[196:199], v[92:95]
 s_add_u32 s59, s62, 0
 ds_read_b64_tr_b16 a[86:87], v7 offset:20480
 v_xor_b32 v8, 65696, v6
 v_mfma_f32_16x16x32_bf16 v[92:95], a[100:103], a[204:207], v[92:95]
 ds_read_b64_tr_b16 a[88:89], v8 offset:0
 buffer_store_dwordx4 v[28:31], v1, s[12:15], s59 offen offset:0 sc1
 v_mfma_f32_16x16x32_bf16 v[92:95], a[104:107], a[212:215], v[92:95]
 ds_read_b64_tr_b16 a[90:91], v8 offset:4096
 v_mul_f32 v44, s34, v44
 v_mfma_f32_16x16x32_bf16 v[92:95], a[108:111], a[220:223], v[92:95]
 ds_read_b64_tr_b16 a[92:93], v8 offset:16384
 v_mul_f32 v45, s34, v45
 v_mfma_f32_16x16x32_bf16 v[92:95], a[64:67], a[116:119], v[92:95]
 s_add_u32 s59, s56, 53248
 ds_read_b64_tr_b16 a[94:95], v8 offset:20480
 v_xor_b32 v9, 131264, v6
 v_mfma_f32_16x16x32_bf16 v[92:95], a[68:71], a[124:127], v[92:95]
 s_waitcnt lgkmcnt(6)
 ds_read_b64_tr_b16 a[96:97], v9 offset:0
 buffer_store_dwordx4 v[200:203], v1, s[12:15], s59 offen offset:0 sc1
 v_mfma_f32_16x16x32_bf16 v[100:103], a[72:75], a[192:195], v[100:103]
 ds_read_b64_tr_b16 a[98:99], v9 offset:4096
 v_mul_f32 v46, s34, v46
 v_mfma_f32_16x16x32_bf16 v[100:103], a[76:79], a[200:203], v[100:103]
 ds_read_b64_tr_b16 a[100:101], v9 offset:16384
 v_mul_f32 v47, s34, v47
 v_mfma_f32_16x16x32_bf16 v[100:103], a[80:83], a[208:211], v[100:103]
 s_waitcnt lgkmcnt(3)
 ds_read_b64_tr_b16 a[102:103], v9 offset:20480
 v_xor_b32 v10, 192, v6
 v_mfma_f32_16x16x32_bf16 v[100:103], a[84:87], a[216:219], v[100:103]
 ds_read_b64_tr_b16 a[104:105], v10 offset:0
 v_mul_f32 v60, s34, v60
 v_mfma_f32_16x16x32_bf16 v[100:103], a[88:91], a[112:115], v[100:103]
 ds_read_b64_tr_b16 a[106:107], v10 offset:4096
 v_mul_f32 v61, s34, v61
 v_mfma_f32_16x16x32_bf16 v[100:103], a[92:95], a[120:123], v[100:103]
 ds_read_b64_tr_b16 a[108:109], v10 offset:16384
 v_mul_f32 v62, s34, v62
 v_mfma_f32_16x16x32_bf16 v[108:111], a[72:75], a[196:199], v[108:111]
 ds_read_b64_tr_b16 a[110:111], v10 offset:20480
 v_xor_b32 v7, 65728, v6
 v_mfma_f32_16x16x32_bf16 v[108:111], a[76:79], a[204:207], v[108:111]
 ds_read_b64_tr_b16 a[64:65], v7 offset:0
 v_mul_f32 v63, s34, v63
 v_mfma_f32_16x16x32_bf16 v[108:111], a[80:83], a[212:215], v[108:111]
 s_add_u32 s59, s56, 53248
 ds_read_b64_tr_b16 a[66:67], v7 offset:4096
 v_cvt_pk_bf16_f32 v44, v44, v45
 v_mfma_f32_16x16x32_bf16 v[108:111], a[84:87], a[220:223], v[108:111]
 ds_read_b64_tr_b16 a[68:69], v7 offset:16384
 buffer_store_dwordx4 v[208:211], v1, s[12:15], s59 offen offset:1024 sc1
 v_mfma_f32_16x16x32_bf16 v[108:111], a[88:91], a[116:119], v[108:111]
 ds_read_b64_tr_b16 a[70:71], v7 offset:20480
 v_xor_b32 v8, 131296, v6
 v_mfma_f32_16x16x32_bf16 v[108:111], a[92:95], a[124:127], v[108:111]
 s_waitcnt lgkmcnt(6)
 ds_read_b64_tr_b16 a[72:73], v8 offset:0
 v_cvt_pk_bf16_f32 v45, v46, v47
 v_mfma_f32_16x16x32_bf16 v[116:119], a[96:99], a[192:195], v[116:119]
 ds_read_b64_tr_b16 a[74:75], v8 offset:4096
 v_cvt_pk_bf16_f32 v46, v60, v61
 v_mfma_f32_16x16x32_bf16 v[116:119], a[100:103], a[200:203], v[116:119]
 s_add_u32 s59, s62, 8192
 ds_read_b64_tr_b16 a[76:77], v8 offset:16384
 v_cvt_pk_bf16_f32 v47, v62, v63
 v_mfma_f32_16x16x32_bf16 v[116:119], a[104:107], a[208:211], v[116:119]
 s_waitcnt lgkmcnt(3)
 ds_read_b64_tr_b16 a[78:79], v8 offset:20480
 v_xor_b32 v9, 224, v6
 v_mfma_f32_16x16x32_bf16 v[116:119], a[108:111], a[216:219], v[116:119]
 ds_read_b64_tr_b16 a[80:81], v9 offset:0
 buffer_store_dwordx4 v[44:47], v1, s[12:15], s59 offen offset:0 sc1
 v_mfma_f32_16x16x32_bf16 v[116:119], a[64:67], a[112:115], v[116:119]
 ds_read_b64_tr_b16 a[82:83], v9 offset:4096
 v_accvgpr_write_b32 a32, v44
 v_mfma_f32_16x16x32_bf16 v[116:119], a[68:71], a[120:123], v[116:119]
 ds_read_b64_tr_b16 a[84:85], v9 offset:16384
 v_accvgpr_write_b32 a33, v45
 v_mfma_f32_16x16x32_bf16 v[124:127], a[96:99], a[196:199], v[124:127]
 s_add_u32 s59, s56, 36864
 ds_read_b64_tr_b16 a[86:87], v9 offset:20480
 v_xor_b32 v10, 65760, v6
 v_mfma_f32_16x16x32_bf16 v[124:127], a[100:103], a[204:207], v[124:127]
 ds_read_b64_tr_b16 a[88:89], v10 offset:0
 buffer_store_dwordx4 v[216:219], v1, s[12:15], s59 offen offset:1024 sc1
 v_mfma_f32_16x16x32_bf16 v[124:127], a[104:107], a[212:215], v[124:127]
 ds_read_b64_tr_b16 a[90:91], v10 offset:4096
 v_accvgpr_write_b32 a34, v46
 v_mfma_f32_16x16x32_bf16 v[124:127], a[108:111], a[220:223], v[124:127]
 ds_read_b64_tr_b16 a[92:93], v10 offset:16384
 v_accvgpr_write_b32 a35, v47
 v_mfma_f32_16x16x32_bf16 v[124:127], a[64:67], a[116:119], v[124:127]
 ds_read_b64_tr_b16 a[94:95], v10 offset:20480
 v_xor_b32 v7, 131328, v6
 v_mfma_f32_16x16x32_bf16 v[124:127], a[68:71], a[124:127], v[124:127]
 s_waitcnt lgkmcnt(6)
 ds_read_b64_tr_b16 a[96:97], v7 offset:0
 v_mul_f32 v20, s34, v20
 v_mfma_f32_16x16x32_bf16 v[132:135], a[72:75], a[192:195], v[132:135]
 ds_read_b64_tr_b16 a[98:99], v7 offset:4096
 v_mul_f32 v21, s34, v21
 v_mfma_f32_16x16x32_bf16 v[132:135], a[76:79], a[200:203], v[132:135]
 ds_read_b64_tr_b16 a[100:101], v7 offset:16384
 v_mul_f32 v22, s34, v22
 v_mfma_f32_16x16x32_bf16 v[132:135], a[80:83], a[208:211], v[132:135]
 s_waitcnt lgkmcnt(3)
 ds_read_b64_tr_b16 a[102:103], v7 offset:20480
 v_xor_b32 v8, 256, v6
 v_mfma_f32_16x16x32_bf16 v[132:135], a[84:87], a[216:219], v[132:135]
 ds_read_b64_tr_b16 a[104:105], v8 offset:0
 v_mul_f32 v23, s34, v23
 v_mfma_f32_16x16x32_bf16 v[132:135], a[88:91], a[112:115], v[132:135]
 s_add_u32 s59, s56, 36864
 ds_read_b64_tr_b16 a[106:107], v8 offset:4096
 v_mul_f32 v68, s34, v68
 v_mfma_f32_16x16x32_bf16 v[132:135], a[92:95], a[120:123], v[132:135]
 ds_read_b64_tr_b16 a[108:109], v8 offset:16384
 buffer_store_dwordx4 v[224:227], v1, s[12:15], s59 offen offset:2048 sc1
 v_mfma_f32_16x16x32_bf16 v[140:143], a[72:75], a[196:199], v[140:143]
 ds_read_b64_tr_b16 a[110:111], v8 offset:20480
 v_xor_b32 v9, 65792, v6
 v_mfma_f32_16x16x32_bf16 v[140:143], a[76:79], a[204:207], v[140:143]
 ds_read_b64_tr_b16 a[64:65], v9 offset:0
 v_mul_f32 v69, s34, v69
 v_mfma_f32_16x16x32_bf16 v[140:143], a[80:83], a[212:215], v[140:143]
 ds_read_b64_tr_b16 a[66:67], v9 offset:4096
 v_mul_f32 v70, s34, v70
 v_mfma_f32_16x16x32_bf16 v[140:143], a[84:87], a[220:223], v[140:143]
 ds_read_b64_tr_b16 a[68:69], v9 offset:16384
 v_mul_f32 v71, s34, v71
 v_mfma_f32_16x16x32_bf16 v[140:143], a[88:91], a[116:119], v[140:143]
 ds_read_b64_tr_b16 a[70:71], v9 offset:20480
 v_xor_b32 v10, 131360, v6
 v_mfma_f32_16x16x32_bf16 v[140:143], a[92:95], a[124:127], v[140:143]
 s_waitcnt lgkmcnt(6)
 ds_read_b64_tr_b16 a[72:73], v10 offset:0
 v_cvt_pk_bf16_f32 v20, v20, v21
 v_mfma_f32_16x16x32_bf16 v[148:151], a[96:99], a[192:195], v[148:151]
 ds_read_b64_tr_b16 a[74:75], v10 offset:4096
 v_cvt_pk_bf16_f32 v21, v22, v23
 v_mfma_f32_16x16x32_bf16 v[148:151], a[100:103], a[200:203], v[148:151]
 s_add_u32 s59, s56, 53248
 ds_read_b64_tr_b16 a[76:77], v10 offset:16384
 v_cvt_pk_bf16_f32 v22, v68, v69
 v_mfma_f32_16x16x32_bf16 v[148:151], a[104:107], a[208:211], v[148:151]
 s_waitcnt lgkmcnt(3)
 ds_read_b64_tr_b16 a[78:79], v10 offset:20480
 v_xor_b32 v7, 288, v6
 v_mfma_f32_16x16x32_bf16 v[148:151], a[108:111], a[216:219], v[148:151]
 ds_read_b64_tr_b16 a[80:81], v7 offset:0
 buffer_store_dwordx4 v[232:235], v1, s[12:15], s59 offen offset:2048 sc1
 v_mfma_f32_16x16x32_bf16 v[148:151], a[64:67], a[112:115], v[148:151]
 s_add_u32 s59, s62, 0
 ds_read_b64_tr_b16 a[82:83], v7 offset:4096
 v_cvt_pk_bf16_f32 v23, v70, v71
 v_mfma_f32_16x16x32_bf16 v[148:151], a[68:71], a[120:123], v[148:151]
 ds_read_b64_tr_b16 a[84:85], v7 offset:16384
 buffer_store_dwordx4 v[20:23], v1, s[12:15], s59 offen offset:1024 sc1
 v_mfma_f32_16x16x32_bf16 v[156:159], a[96:99], a[196:199], v[156:159]
 ds_read_b64_tr_b16 a[86:87], v7 offset:20480
 v_xor_b32 v8, 65824, v6
 v_mfma_f32_16x16x32_bf16 v[156:159], a[100:103], a[204:207], v[156:159]
 ds_read_b64_tr_b16 a[88:89], v8 offset:0
 v_accvgpr_write_b32 a4, v20
 v_mfma_f32_16x16x32_bf16 v[156:159], a[104:107], a[212:215], v[156:159]
 ds_read_b64_tr_b16 a[90:91], v8 offset:4096
 v_accvgpr_write_b32 a5, v21
 v_mfma_f32_16x16x32_bf16 v[156:159], a[108:111], a[220:223], v[156:159]
 ds_read_b64_tr_b16 a[92:93], v8 offset:16384
 v_accvgpr_write_b32 a6, v22
 v_mfma_f32_16x16x32_bf16 v[156:159], a[64:67], a[116:119], v[156:159]
 ds_read_b64_tr_b16 a[94:95], v8 offset:20480
 v_xor_b32 v9, 131392, v6
 v_mfma_f32_16x16x32_bf16 v[156:159], a[68:71], a[124:127], v[156:159]
 s_waitcnt lgkmcnt(6)
 ds_read_b64_tr_b16 a[96:97], v9 offset:0
 v_accvgpr_write_b32 a7, v23
 v_mfma_f32_16x16x32_bf16 v[164:167], a[72:75], a[192:195], v[164:167]
 s_add_u32 s59, s56, 53248
 ds_read_b64_tr_b16 a[98:99], v9 offset:4096
 v_mul_f32 v36, s34, v36
 v_mfma_f32_16x16x32_bf16 v[164:167], a[76:79], a[200:203], v[164:167]
 ds_read_b64_tr_b16 a[100:101], v9 offset:16384
 buffer_store_dwordx4 v[240:243], v1, s[12:15], s59 offen offset:3072 sc1
 v_mfma_f32_16x16x32_bf16 v[164:167], a[80:83], a[208:211], v[164:167]
 s_waitcnt lgkmcnt(3)
 ds_read_b64_tr_b16 a[102:103], v9 offset:20480
 v_xor_b32 v10, 320, v6
 v_mfma_f32_16x16x32_bf16 v[164:167], a[84:87], a[216:219], v[164:167]
 ds_read_b64_tr_b16 a[104:105], v10 offset:0
 v_mul_f32 v37, s34, v37
 v_mfma_f32_16x16x32_bf16 v[164:167], a[88:91], a[112:115], v[164:167]
 ds_read_b64_tr_b16 a[106:107], v10 offset:4096
 v_mul_f32 v38, s34, v38
 v_mfma_f32_16x16x32_bf16 v[164:167], a[92:95], a[120:123], v[164:167]
 ds_read_b64_tr_b16 a[108:109], v10 offset:16384
 v_mul_f32 v39, s34, v39
 v_mfma_f32_16x16x32_bf16 v[172:175], a[72:75], a[196:199], v[172:175]
 ds_read_b64_tr_b16 a[110:111], v10 offset:20480
 v_xor_b32 v7, 65856, v6
 v_mfma_f32_16x16x32_bf16 v[172:175], a[76:79], a[204:207], v[172:175]
 ds_read_b64_tr_b16 a[64:65], v7 offset:0
 v_mul_f32 v76, s34, v76
 v_mfma_f32_16x16x32_bf16 v[172:175], a[80:83], a[212:215], v[172:175]
 ds_read_b64_tr_b16 a[66:67], v7 offset:4096
 v_mul_f32 v77, s34, v77
 v_mfma_f32_16x16x32_bf16 v[172:175], a[84:87], a[220:223], v[172:175]
 ds_read_b64_tr_b16 a[68:69], v7 offset:16384
 v_mul_f32 v78, s34, v78
 v_mfma_f32_16x16x32_bf16 v[172:175], a[88:91], a[116:119], v[172:175]
 s_add_u32 s59, s56, 36864
 ds_read_b64_tr_b16 a[70:71], v7 offset:20480
 v_xor_b32 v8, 131424, v6
 v_mfma_f32_16x16x32_bf16 v[172:175], a[92:95], a[124:127], v[172:175]
 s_waitcnt lgkmcnt(6)
 ds_read_b64_tr_b16 a[72:73], v8 offset:0
 buffer_store_dwordx4 v[248:251], v1, s[12:15], s59 offen offset:3072 sc1
 v_mfma_f32_16x16x32_bf16 v[180:183], a[96:99], a[192:195], v[180:183]
 ds_read_b64_tr_b16 a[74:75], v8 offset:4096
 v_mul_f32 v79, s34, v79
 v_mfma_f32_16x16x32_bf16 v[180:183], a[100:103], a[200:203], v[180:183]
 ds_read_b64_tr_b16 a[76:77], v8 offset:16384
 v_cvt_pk_bf16_f32 v36, v36, v37
 v_mfma_f32_16x16x32_bf16 v[180:183], a[104:107], a[208:211], v[180:183]
 s_waitcnt lgkmcnt(3)
 ds_read_b64_tr_b16 a[78:79], v8 offset:20480
 v_xor_b32 v9, 352, v6
 v_mfma_f32_16x16x32_bf16 v[180:183], a[108:111], a[216:219], v[180:183]
 ds_read_b64_tr_b16 a[80:81], v9 offset:0
 v_cvt_pk_bf16_f32 v37, v38, v39
 v_mfma_f32_16x16x32_bf16 v[180:183], a[64:67], a[112:115], v[180:183]
 ds_read_b64_tr_b16 a[82:83], v9 offset:4096
 v_cvt_pk_bf16_f32 v38, v76, v77
 v_mfma_f32_16x16x32_bf16 v[180:183], a[68:71], a[120:123], v[180:183]
 ds_read_b64_tr_b16 a[84:85], v9 offset:16384
 v_cvt_pk_bf16_f32 v39, v78, v79
 v_mfma_f32_16x16x32_bf16 v[188:191], a[96:99], a[196:199], v[188:191]
 s_add_u32 s59, s62, 8192
 ds_read_b64_tr_b16 a[86:87], v9 offset:20480
 v_xor_b32 v10, 65888, v6
 v_mfma_f32_16x16x32_bf16 v[188:191], a[100:103], a[204:207], v[188:191]
 ds_read_b64_tr_b16 a[88:89], v10 offset:0
 buffer_store_dwordx4 v[36:39], v1, s[12:15], s59 offen offset:1024 sc1
 v_mfma_f32_16x16x32_bf16 v[188:191], a[104:107], a[212:215], v[188:191]
 ds_read_b64_tr_b16 a[90:91], v10 offset:4096
 v_accvgpr_write_b32 a36, v36
 v_mfma_f32_16x16x32_bf16 v[188:191], a[108:111], a[220:223], v[188:191]
 ds_read_b64_tr_b16 a[92:93], v10 offset:16384
 v_accvgpr_write_b32 a37, v37
 v_mfma_f32_16x16x32_bf16 v[188:191], a[64:67], a[116:119], v[188:191]
 ds_read_b64_tr_b16 a[94:95], v10 offset:20480
 v_xor_b32 v7, 131456, v6
 v_mfma_f32_16x16x32_bf16 v[188:191], a[68:71], a[124:127], v[188:191]
 s_waitcnt lgkmcnt(6)
 ds_read_b64_tr_b16 a[96:97], v7 offset:0
 v_accvgpr_write_b32 a38, v38
 v_mfma_f32_16x16x32_bf16 v[196:199], a[72:75], a[192:195], v[196:199]
 ds_read_b64_tr_b16 a[98:99], v7 offset:4096
 v_accvgpr_write_b32 a39, v39
 v_mfma_f32_16x16x32_bf16 v[196:199], a[76:79], a[200:203], v[196:199]
 ds_read_b64_tr_b16 a[100:101], v7 offset:16384
 v_mul_f32 v84, s34, v84
 v_mfma_f32_16x16x32_bf16 v[196:199], a[80:83], a[208:211], v[196:199]
 s_waitcnt lgkmcnt(3)
 ds_read_b64_tr_b16 a[102:103], v7 offset:20480
 v_xor_b32 v8, 384, v6
 v_mfma_f32_16x16x32_bf16 v[196:199], a[84:87], a[216:219], v[196:199]
 ds_read_b64_tr_b16 a[104:105], v8 offset:0
 v_mul_f32 v85, s34, v85
 v_mfma_f32_16x16x32_bf16 v[196:199], a[88:91], a[112:115], v[196:199]
 ds_read_b64_tr_b16 a[106:107], v8 offset:4096
 v_mul_f32 v86, s34, v86
 v_mfma_f32_16x16x32_bf16 v[196:199], a[92:95], a[120:123], v[196:199]
 ds_read_b64_tr_b16 a[108:109], v8 offset:16384
 v_mul_f32 v87, s34, v87
 v_mfma_f32_16x16x32_bf16 v[204:207], a[72:75], a[196:199], v[204:207]
 ds_read_b64_tr_b16 a[110:111], v8 offset:20480
 v_xor_b32 v9, 65920, v6
 v_mfma_f32_16x16x32_bf16 v[204:207], a[76:79], a[204:207], v[204:207]
 ds_read_b64_tr_b16 a[64:65], v9 offset:0
 v_mul_f32 v100, s34, v100
 v_mfma_f32_16x16x32_bf16 v[204:207], a[80:83], a[212:215], v[204:207]
 ds_read_b64_tr_b16 a[66:67], v9 offset:4096
 v_mul_f32 v101, s34, v101
 v_mfma_f32_16x16x32_bf16 v[204:207], a[84:87], a[220:223], v[204:207]
 ds_read_b64_tr_b16 a[68:69], v9 offset:16384
 v_mul_f32 v102, s34, v102
 v_mfma_f32_16x16x32_bf16 v[204:207], a[88:91], a[116:119], v[204:207]
 ds_read_b64_tr_b16 a[70:71], v9 offset:20480
 v_xor_b32 v10, 131488, v6
 v_mfma_f32_16x16x32_bf16 v[204:207], a[92:95], a[124:127], v[204:207]
 s_waitcnt lgkmcnt(6)
 ds_read_b64_tr_b16 a[72:73], v10 offset:0
 v_mul_f32 v103, s34, v103
 v_mfma_f32_16x16x32_bf16 v[212:215], a[96:99], a[192:195], v[212:215]
 ds_read_b64_tr_b16 a[74:75], v10 offset:4096
 v_cvt_pk_bf16_f32 v84, v84, v85
 v_mfma_f32_16x16x32_bf16 v[212:215], a[100:103], a[200:203], v[212:215]
 ds_read_b64_tr_b16 a[76:77], v10 offset:16384
 v_cvt_pk_bf16_f32 v85, v86, v87
 v_mfma_f32_16x16x32_bf16 v[212:215], a[104:107], a[208:211], v[212:215]
 s_waitcnt lgkmcnt(3)
 ds_read_b64_tr_b16 a[78:79], v10 offset:20480
 v_xor_b32 v7, 416, v6
 v_mfma_f32_16x16x32_bf16 v[212:215], a[108:111], a[216:219], v[212:215]
 ds_read_b64_tr_b16 a[80:81], v7 offset:0
 v_cvt_pk_bf16_f32 v86, v100, v101
 v_mfma_f32_16x16x32_bf16 v[212:215], a[64:67], a[112:115], v[212:215]
 s_add_u32 s59, s62, 0
 ds_read_b64_tr_b16 a[82:83], v7 offset:4096
 v_cvt_pk_bf16_f32 v87, v102, v103
 v_mfma_f32_16x16x32_bf16 v[212:215], a[68:71], a[120:123], v[212:215]
 ds_read_b64_tr_b16 a[84:85], v7 offset:16384
 buffer_store_dwordx4 v[84:87], v1, s[12:15], s59 offen offset:2048 sc1
 v_mfma_f32_16x16x32_bf16 v[220:223], a[96:99], a[196:199], v[220:223]
 ds_read_b64_tr_b16 a[86:87], v7 offset:20480
 v_xor_b32 v8, 65952, v6
 v_mfma_f32_16x16x32_bf16 v[220:223], a[100:103], a[204:207], v[220:223]
 ds_read_b64_tr_b16 a[88:89], v8 offset:0
 v_accvgpr_write_b32 a8, v84
 v_mfma_f32_16x16x32_bf16 v[220:223], a[104:107], a[212:215], v[220:223]
 ds_read_b64_tr_b16 a[90:91], v8 offset:4096
 v_accvgpr_write_b32 a9, v85
 v_mfma_f32_16x16x32_bf16 v[220:223], a[108:111], a[220:223], v[220:223]
 ds_read_b64_tr_b16 a[92:93], v8 offset:16384
 v_accvgpr_write_b32 a10, v86
 v_mfma_f32_16x16x32_bf16 v[220:223], a[64:67], a[116:119], v[220:223]
 ds_read_b64_tr_b16 a[94:95], v8 offset:20480
 v_xor_b32 v9, 131520, v6
 v_mfma_f32_16x16x32_bf16 v[220:223], a[68:71], a[124:127], v[220:223]
 s_waitcnt lgkmcnt(6)
 ds_read_b64_tr_b16 a[96:97], v9 offset:0
 v_accvgpr_write_b32 a11, v87
 v_mfma_f32_16x16x32_bf16 v[228:231], a[72:75], a[192:195], v[228:231]
 ds_read_b64_tr_b16 a[98:99], v9 offset:4096
 v_mul_f32 v92, s34, v92
 v_mfma_f32_16x16x32_bf16 v[228:231], a[76:79], a[200:203], v[228:231]
 ds_read_b64_tr_b16 a[100:101], v9 offset:16384
 v_mul_f32 v93, s34, v93
 v_mfma_f32_16x16x32_bf16 v[228:231], a[80:83], a[208:211], v[228:231]
 s_waitcnt lgkmcnt(3)
 ds_read_b64_tr_b16 a[102:103], v9 offset:20480
 v_xor_b32 v10, 448, v6
 v_mfma_f32_16x16x32_bf16 v[228:231], a[84:87], a[216:219], v[228:231]
 ds_read_b64_tr_b16 a[104:105], v10 offset:0
 v_mul_f32 v94, s34, v94
 v_mfma_f32_16x16x32_bf16 v[228:231], a[88:91], a[112:115], v[228:231]
 ds_read_b64_tr_b16 a[106:107], v10 offset:4096
 v_mul_f32 v95, s34, v95
 v_mfma_f32_16x16x32_bf16 v[228:231], a[92:95], a[120:123], v[228:231]
 ds_read_b64_tr_b16 a[108:109], v10 offset:16384
 v_mul_f32 v108, s34, v108
 v_mfma_f32_16x16x32_bf16 v[236:239], a[72:75], a[196:199], v[236:239]
 ds_read_b64_tr_b16 a[110:111], v10 offset:20480
 v_xor_b32 v7, 65984, v6
 v_mfma_f32_16x16x32_bf16 v[236:239], a[76:79], a[204:207], v[236:239]
 ds_read_b64_tr_b16 a[64:65], v7 offset:0
 buffer_load_dword v13, v12, s[12:15], s58 offen sc1
 v_mfma_f32_16x16x32_bf16 v[236:239], a[80:83], a[212:215], v[236:239]
 ds_read_b64_tr_b16 a[66:67], v7 offset:4096
 v_mul_f32 v109, s34, v109
 v_mfma_f32_16x16x32_bf16 v[236:239], a[84:87], a[220:223], v[236:239]
 ds_read_b64_tr_b16 a[68:69], v7 offset:16384
 v_mul_f32 v110, s34, v110
 v_mfma_f32_16x16x32_bf16 v[236:239], a[88:91], a[116:119], v[236:239]
 ds_read_b64_tr_b16 a[70:71], v7 offset:20480
 v_xor_b32 v8, 131552, v6
 v_mfma_f32_16x16x32_bf16 v[236:239], a[92:95], a[124:127], v[236:239]
 s_waitcnt lgkmcnt(6)
 ds_read_b64_tr_b16 a[72:73], v8 offset:0
 v_mul_f32 v111, s34, v111
 v_mfma_f32_16x16x32_bf16 v[244:247], a[96:99], a[192:195], v[244:247]
 ds_read_b64_tr_b16 a[74:75], v8 offset:4096
 v_cvt_pk_bf16_f32 v92, v92, v93
 v_mfma_f32_16x16x32_bf16 v[244:247], a[100:103], a[200:203], v[244:247]
 ds_read_b64_tr_b16 a[76:77], v8 offset:16384
 v_cvt_pk_bf16_f32 v93, v94, v95
 v_mfma_f32_16x16x32_bf16 v[244:247], a[104:107], a[208:211], v[244:247]
 s_waitcnt lgkmcnt(3)
 ds_read_b64_tr_b16 a[78:79], v8 offset:20480
 v_xor_b32 v9, 480, v6
 v_mfma_f32_16x16x32_bf16 v[244:247], a[108:111], a[216:219], v[244:247]
 ds_read_b64_tr_b16 a[80:81], v9 offset:0
 v_cvt_pk_bf16_f32 v94, v108, v109
 v_mfma_f32_16x16x32_bf16 v[244:247], a[64:67], a[112:115], v[244:247]
 s_add_u32 s59, s62, 8192
 ds_read_b64_tr_b16 a[82:83], v9 offset:4096
 v_cvt_pk_bf16_f32 v95, v110, v111
 v_mfma_f32_16x16x32_bf16 v[244:247], a[68:71], a[120:123], v[244:247]
 ds_read_b64_tr_b16 a[84:85], v9 offset:16384
 buffer_store_dwordx4 v[92:95], v1, s[12:15], s59 offen offset:2048 sc1
 v_mfma_f32_16x16x32_bf16 v[252:255], a[96:99], a[196:199], v[252:255]
 ds_read_b64_tr_b16 a[86:87], v9 offset:20480
 v_xor_b32 v10, 66016, v6
 v_mfma_f32_16x16x32_bf16 v[252:255], a[100:103], a[204:207], v[252:255]
 ds_read_b64_tr_b16 a[88:89], v10 offset:0
 v_accvgpr_write_b32 a40, v92
 v_mfma_f32_16x16x32_bf16 v[252:255], a[104:107], a[212:215], v[252:255]
 ds_read_b64_tr_b16 a[90:91], v10 offset:4096
 v_accvgpr_write_b32 a41, v93
 v_mfma_f32_16x16x32_bf16 v[252:255], a[108:111], a[220:223], v[252:255]
 ds_read_b64_tr_b16 a[92:93], v10 offset:16384
 v_accvgpr_write_b32 a42, v94
 v_mfma_f32_16x16x32_bf16 v[252:255], a[64:67], a[116:119], v[252:255]
 ds_read_b64_tr_b16 a[94:95], v10 offset:20480
 v_accvgpr_write_b32 a43, v95
 v_mfma_f32_16x16x32_bf16 v[252:255], a[68:71], a[124:127], v[252:255]
 s_waitcnt lgkmcnt(6)
 v_mfma_f32_16x16x32_bf16 v[16:19], a[72:75], a[192:195], v[16:19]
 v_mfma_f32_16x16x32_bf16 v[16:19], a[76:79], a[200:203], v[16:19]
 v_mfma_f32_16x16x32_bf16 v[16:19], a[80:83], a[208:211], v[16:19]
 s_waitcnt lgkmcnt(0)
 v_mfma_f32_16x16x32_bf16 v[16:19], a[84:87], a[216:219], v[16:19]
 v_mfma_f32_16x16x32_bf16 v[16:19], a[88:91], a[112:115], v[16:19]
 v_mfma_f32_16x16x32_bf16 v[16:19], a[92:95], a[120:123], v[16:19]
 v_mfma_f32_16x16x32_bf16 v[24:27], a[72:75], a[196:199], v[24:27]
 v_mfma_f32_16x16x32_bf16 v[24:27], a[76:79], a[204:207], v[24:27]
 v_mfma_f32_16x16x32_bf16 v[24:27], a[80:83], a[212:215], v[24:27]
 v_mfma_f32_16x16x32_bf16 v[24:27], a[84:87], a[220:223], v[24:27]
 s_waitcnt lgkmcnt(0)
 v_mfma_f32_16x16x32_bf16 v[24:27], a[88:91], a[116:119], v[24:27]
 s_barrier
 v_mfma_f32_16x16x32_bf16 v[24:27], a[92:95], a[124:127], v[24:27]
 s_waitcnt vmcnt(1)
 v_cmp_ne_u32 s[16:17], 0, v13
 v_cmp_gt_u32 vcc, 256, v5
 s_or_b64 vcc, vcc, s[16:17]
 s_mov_b32 m0, s40
 s_cselect_b32 s48, 0, 1
 s_cselect_b32 s52, 2.0, s42
 buffer_load_dwordx4 v1, s[12:15], s52 offen offset:0 sc1 lds
 v_pk_mul_f32 v[116:117], v[116:117], s[34:35]
 v_pk_mul_f32 v[118:119], v[118:119], s[34:35]
 v_pk_mul_f32 v[132:133], v[132:133], s[34:35]
 v_pk_mul_f32 v[134:135], v[134:135], s[34:35]
 v_cvt_pk_bf16_f32 v116, v116, v117
 v_cvt_pk_bf16_f32 v117, v118, v119
 v_cvt_pk_bf16_f32 v118, v132, v133
 v_cvt_pk_bf16_f32 v119, v134, v135
 s_add_u32 s59, s62, 0
 buffer_store_dwordx4 v[116:119], v1, s[12:15], s59 offen offset:3072 sc1
 v_accvgpr_write_b32 a12, v116
 v_accvgpr_write_b32 a13, v117
 v_accvgpr_write_b32 a14, v118
 v_accvgpr_write_b32 a15, v119
 v_pk_mul_f32 v[124:125], v[124:125], s[34:35]
 v_pk_mul_f32 v[126:127], v[126:127], s[34:35]
 v_pk_mul_f32 v[140:141], v[140:141], s[34:35]
 v_pk_mul_f32 v[142:143], v[142:143], s[34:35]
 buffer_load_dwordx4 v1, s[12:15], s52 offen offset:1024 sc1 lds
 v_cvt_pk_bf16_f32 v124, v124, v125
 v_cvt_pk_bf16_f32 v125, v126, v127
 v_cvt_pk_bf16_f32 v126, v140, v141
 v_cvt_pk_bf16_f32 v127, v142, v143
 s_add_u32 s59, s62, 8192
 buffer_store_dwordx4 v[124:127], v1, s[12:15], s59 offen offset:3072 sc1
 v_accvgpr_write_b32 a44, v124
 v_accvgpr_write_b32 a45, v125
 v_accvgpr_write_b32 a46, v126
 v_accvgpr_write_b32 a47, v127
 v_pk_mul_f32 v[148:149], v[148:149], s[34:35]
 v_pk_mul_f32 v[150:151], v[150:151], s[34:35]
 v_pk_mul_f32 v[164:165], v[164:165], s[34:35]
 v_pk_mul_f32 v[166:167], v[166:167], s[34:35]
 v_cvt_pk_bf16_f32 v148, v148, v149
 v_cvt_pk_bf16_f32 v149, v150, v151
 v_cvt_pk_bf16_f32 v150, v164, v165
 buffer_load_dwordx4 v1, s[12:15], s52 offen offset:2048 sc1 lds
 v_cvt_pk_bf16_f32 v151, v166, v167
 s_add_u32 s59, s62, 4096
 buffer_store_dwordx4 v[148:151], v1, s[12:15], s59 offen offset:0 sc1
 v_accvgpr_write_b32 a16, v148
 v_accvgpr_write_b32 a17, v149
 v_accvgpr_write_b32 a18, v150
 v_accvgpr_write_b32 a19, v151
 v_pk_mul_f32 v[156:157], v[156:157], s[34:35]
 v_pk_mul_f32 v[158:159], v[158:159], s[34:35]
 v_pk_mul_f32 v[172:173], v[172:173], s[34:35]
 v_pk_mul_f32 v[174:175], v[174:175], s[34:35]
 v_cvt_pk_bf16_f32 v156, v156, v157
 v_cvt_pk_bf16_f32 v157, v158, v159
 v_cvt_pk_bf16_f32 v158, v172, v173
 v_cvt_pk_bf16_f32 v159, v174, v175
 s_add_u32 s59, s62, 12288
 buffer_store_dwordx4 v[156:159], v1, s[12:15], s59 offen offset:0 sc1
 v_accvgpr_write_b32 a48, v156
 buffer_load_dwordx4 v1, s[12:15], s52 offen offset:3072 sc1 lds
 v_accvgpr_write_b32 a49, v157
 v_accvgpr_write_b32 a50, v158
 v_accvgpr_write_b32 a51, v159
 v_pk_mul_f32 v[180:181], v[180:181], s[34:35]
 v_pk_mul_f32 v[182:183], v[182:183], s[34:35]
 v_pk_mul_f32 v[196:197], v[196:197], s[34:35]
 v_pk_mul_f32 v[198:199], v[198:199], s[34:35]
 v_cvt_pk_bf16_f32 v180, v180, v181
 v_cvt_pk_bf16_f32 v181, v182, v183
 v_cvt_pk_bf16_f32 v182, v196, v197
 v_cvt_pk_bf16_f32 v183, v198, v199
 s_add_u32 s59, s62, 4096
 buffer_store_dwordx4 v[180:183], v1, s[12:15], s59 offen offset:1024 sc1
 v_accvgpr_write_b32 a20, v180
 v_accvgpr_write_b32 a21, v181
 v_accvgpr_write_b32 a22, v182
 v_accvgpr_write_b32 a23, v183
 s_bitset1_b32 m0, 12
 s_nop 0
 buffer_load_dwordx4 v4, s[12:15], s52 offen offset:0 sc1 lds
 v_pk_mul_f32 v[188:189], v[188:189], s[34:35]
 v_pk_mul_f32 v[190:191], v[190:191], s[34:35]
 v_pk_mul_f32 v[204:205], v[204:205], s[34:35]
 v_pk_mul_f32 v[206:207], v[206:207], s[34:35]
 v_cvt_pk_bf16_f32 v188, v188, v189
 v_cvt_pk_bf16_f32 v189, v190, v191
 v_cvt_pk_bf16_f32 v190, v204, v205
 v_cvt_pk_bf16_f32 v191, v206, v207
 s_add_u32 s59, s62, 12288
 buffer_store_dwordx4 v[188:191], v1, s[12:15], s59 offen offset:1024 sc1
 v_accvgpr_write_b32 a52, v188
 v_accvgpr_write_b32 a53, v189
 v_accvgpr_write_b32 a54, v190
 v_accvgpr_write_b32 a55, v191
 v_pk_mul_f32 v[212:213], v[212:213], s[34:35]
 v_pk_mul_f32 v[214:215], v[214:215], s[34:35]
 v_pk_mul_f32 v[228:229], v[228:229], s[34:35]
 v_pk_mul_f32 v[230:231], v[230:231], s[34:35]
 buffer_load_dwordx4 v4, s[12:15], s52 offen offset:1024 sc1 lds
 v_cvt_pk_bf16_f32 v212, v212, v213
 v_cvt_pk_bf16_f32 v213, v214, v215
 v_cvt_pk_bf16_f32 v214, v228, v229
 v_cvt_pk_bf16_f32 v215, v230, v231
 s_add_u32 s59, s62, 4096
 buffer_store_dwordx4 v[212:215], v1, s[12:15], s59 offen offset:2048 sc1
 v_accvgpr_write_b32 a24, v212
 v_accvgpr_write_b32 a25, v213
 v_accvgpr_write_b32 a26, v214
 v_accvgpr_write_b32 a27, v215
 v_pk_mul_f32 v[220:221], v[220:221], s[34:35]
 v_pk_mul_f32 v[222:223], v[222:223], s[34:35]
 v_pk_mul_f32 v[236:237], v[236:237], s[34:35]
 v_pk_mul_f32 v[238:239], v[238:239], s[34:35]
 v_cvt_pk_bf16_f32 v220, v220, v221
 v_cvt_pk_bf16_f32 v221, v222, v223
 v_cvt_pk_bf16_f32 v222, v236, v237
 buffer_load_dwordx4 v4, s[12:15], s52 offen offset:2048 sc1 lds
 v_cvt_pk_bf16_f32 v223, v238, v239
 s_add_u32 s59, s62, 12288
 buffer_store_dwordx4 v[220:223], v1, s[12:15], s59 offen offset:2048 sc1
 v_accvgpr_write_b32 a56, v220
 v_accvgpr_write_b32 a57, v221
 v_accvgpr_write_b32 a58, v222
 v_accvgpr_write_b32 a59, v223
 v_pk_mul_f32 v[244:245], v[244:245], s[34:35]
 v_pk_mul_f32 v[246:247], v[246:247], s[34:35]
 v_pk_mul_f32 v[16:17], v[16:17], s[34:35]
 v_pk_mul_f32 v[18:19], v[18:19], s[34:35]
 v_cvt_pk_bf16_f32 v244, v244, v245
 v_cvt_pk_bf16_f32 v245, v246, v247
 v_cvt_pk_bf16_f32 v246, v16, v17
 v_cvt_pk_bf16_f32 v247, v18, v19
 s_add_u32 s59, s62, 4096
 buffer_store_dwordx4 v[244:247], v1, s[12:15], s59 offen offset:3072 sc1
 v_accvgpr_write_b32 a28, v244
 buffer_load_dwordx4 v4, s[12:15], s52 offen offset:3072 sc1 lds
 v_accvgpr_write_b32 a29, v245
 v_accvgpr_write_b32 a30, v246
 v_accvgpr_write_b32 a31, v247
 v_pk_mul_f32 v[252:253], v[252:253], s[34:35]
 v_pk_mul_f32 v[254:255], v[254:255], s[34:35]
 v_pk_mul_f32 v[24:25], v[24:25], s[34:35]
 v_pk_mul_f32 v[26:27], v[26:27], s[34:35]
 v_cvt_pk_bf16_f32 v252, v252, v253
 v_cvt_pk_bf16_f32 v253, v254, v255
 v_cvt_pk_bf16_f32 v254, v24, v25
 v_cvt_pk_bf16_f32 v255, v26, v27
 s_add_u32 s59, s62, 12288
 buffer_store_dwordx4 v[252:255], v1, s[12:15], s59 offen offset:3072 sc1
 v_accvgpr_write_b32 a60, v252
 v_accvgpr_write_b32 a61, v253
 v_accvgpr_write_b32 a62, v254
 v_accvgpr_write_b32 a63, v255
L_kvdone:
 s_load_dword s31, s[74:75], s30
 s_cmp_ge_u32 s28, 14
 s_cbranch_scc1 L_s1b
 s_mov_b32 s36, 0xffff0000
 s_and_b32 s33, s95, 31
 s_lshr_b32 s34, s95, 5
 v_lshlrev_b32 v128, 16, v32
 v_and_b32 v129, s36, v32
 v_lshlrev_b32 v130, 16, v40
 v_and_b32 v131, s36, v40
 v_lshlrev_b32 v132, 16, v48
 v_and_b32 v133, s36, v48
 v_lshlrev_b32 v134, 16, v56
 v_and_b32 v135, s36, v56
 v_lshlrev_b32 v136, 16, v64
 v_and_b32 v137, s36, v64
 v_lshlrev_b32 v138, 16, v72
 v_and_b32 v139, s36, v72
 v_lshlrev_b32 v140, 16, v80
 v_and_b32 v141, s36, v80
 v_lshlrev_b32 v142, 16, v88
 v_lshlrev_b32 v143, 16, v90
 v_and_b32 v144, s36, v88
 v_and_b32 v145, s36, v90
 v_lshlrev_b32 v146, 16, v89
 v_lshlrev_b32 v147, 16, v91
 v_and_b32 v148, s36, v89
 v_and_b32 v149, s36, v91
 v_pk_mul_f32 v[150:151], v[128:129], v[148:149]
 v_pk_fma_f32 v[150:151], v[130:131], v[146:147], v[150:151]
 v_pk_fma_f32 v[150:151], v[132:133], v[144:145], v[150:151]
 v_pk_fma_f32 v[150:151], v[134:135], v[142:143], v[150:151]
 v_pk_mul_f32 v[150:151], v[150:151], v[138:139]
 v_cvt_pk_bf16_f32 v16, v150, v151
 v_pk_mul_f32 v[152:153], v[130:131], v[148:149]
 v_pk_fma_f32 v[152:153], v[132:133], v[146:147], v[152:153]
 v_pk_fma_f32 v[152:153], v[134:135], v[144:145], v[152:153]
 v_pk_fma_f32 v[152:153], v[136:137], v[142:143], v[152:153]
 v_pk_mul_f32 v[152:153], v[152:153], v[140:141]
 v_cvt_pk_bf16_f32 v20, v152, v153
 v_lshlrev_b32 v128, 16, v33
 v_and_b32 v129, s36, v33
 v_lshlrev_b32 v130, 16, v41
 v_and_b32 v131, s36, v41
 v_lshlrev_b32 v132, 16, v49
 v_and_b32 v133, s36, v49
 v_lshlrev_b32 v134, 16, v57
 v_and_b32 v135, s36, v57
 v_lshlrev_b32 v136, 16, v65
 v_and_b32 v137, s36, v65
 v_lshlrev_b32 v138, 16, v73
 v_and_b32 v139, s36, v73
 v_lshlrev_b32 v140, 16, v81
 v_and_b32 v141, s36, v81
 v_lshlrev_b32 v142, 16, v96
 v_lshlrev_b32 v143, 16, v98
 v_and_b32 v144, s36, v96
 v_and_b32 v145, s36, v98
 v_lshlrev_b32 v146, 16, v97
 v_lshlrev_b32 v147, 16, v99
 v_and_b32 v148, s36, v97
 v_and_b32 v149, s36, v99
 v_pk_mul_f32 v[150:151], v[128:129], v[148:149]
 v_pk_fma_f32 v[150:151], v[130:131], v[146:147], v[150:151]
 v_pk_fma_f32 v[150:151], v[132:133], v[144:145], v[150:151]
 v_pk_fma_f32 v[150:151], v[134:135], v[142:143], v[150:151]
 v_pk_mul_f32 v[150:151], v[150:151], v[138:139]
 v_cvt_pk_bf16_f32 v17, v150, v151
 v_pk_mul_f32 v[152:153], v[130:131], v[148:149]
 v_pk_fma_f32 v[152:153], v[132:133], v[146:147], v[152:153]
 v_pk_fma_f32 v[152:153], v[134:135], v[144:145], v[152:153]
 v_pk_fma_f32 v[152:153], v[136:137], v[142:143], v[152:153]
 v_pk_mul_f32 v[152:153], v[152:153], v[140:141]
 v_cvt_pk_bf16_f32 v21, v152, v153
 v_lshlrev_b32 v128, 16, v34
 v_and_b32 v129, s36, v34
 v_lshlrev_b32 v130, 16, v42
 v_and_b32 v131, s36, v42
 v_lshlrev_b32 v132, 16, v50
 v_and_b32 v133, s36, v50
 v_lshlrev_b32 v134, 16, v58
 v_and_b32 v135, s36, v58
 v_lshlrev_b32 v136, 16, v66
 v_and_b32 v137, s36, v66
 v_lshlrev_b32 v138, 16, v74
 v_and_b32 v139, s36, v74
 v_lshlrev_b32 v140, 16, v82
 v_and_b32 v141, s36, v82
 v_lshlrev_b32 v142, 16, v104
 v_lshlrev_b32 v143, 16, v106
 v_and_b32 v144, s36, v104
 v_and_b32 v145, s36, v106
 v_lshlrev_b32 v146, 16, v105
 v_lshlrev_b32 v147, 16, v107
 v_and_b32 v148, s36, v105
 v_and_b32 v149, s36, v107
 v_pk_mul_f32 v[150:151], v[128:129], v[148:149]
 v_pk_fma_f32 v[150:151], v[130:131], v[146:147], v[150:151]
 v_pk_fma_f32 v[150:151], v[132:133], v[144:145], v[150:151]
 v_pk_fma_f32 v[150:151], v[134:135], v[142:143], v[150:151]
 v_pk_mul_f32 v[150:151], v[150:151], v[138:139]
 v_cvt_pk_bf16_f32 v18, v150, v151
 v_pk_mul_f32 v[152:153], v[130:131], v[148:149]
 v_pk_fma_f32 v[152:153], v[132:133], v[146:147], v[152:153]
 v_pk_fma_f32 v[152:153], v[134:135], v[144:145], v[152:153]
 v_pk_fma_f32 v[152:153], v[136:137], v[142:143], v[152:153]
 v_pk_mul_f32 v[152:153], v[152:153], v[140:141]
 v_cvt_pk_bf16_f32 v22, v152, v153
 v_lshlrev_b32 v128, 16, v35
 v_and_b32 v129, s36, v35
 v_lshlrev_b32 v130, 16, v43
 v_and_b32 v131, s36, v43
 v_lshlrev_b32 v132, 16, v51
 v_and_b32 v133, s36, v51
 v_lshlrev_b32 v134, 16, v59
 v_and_b32 v135, s36, v59
 v_lshlrev_b32 v136, 16, v67
 v_and_b32 v137, s36, v67
 v_lshlrev_b32 v138, 16, v75
 v_and_b32 v139, s36, v75
 v_lshlrev_b32 v140, 16, v83
 v_and_b32 v141, s36, v83
 v_lshlrev_b32 v142, 16, v112
 v_lshlrev_b32 v143, 16, v114
 v_and_b32 v144, s36, v112
 v_and_b32 v145, s36, v114
 v_lshlrev_b32 v146, 16, v113
 v_lshlrev_b32 v147, 16, v115
 v_and_b32 v148, s36, v113
 v_and_b32 v149, s36, v115
 v_pk_mul_f32 v[150:151], v[128:129], v[148:149]
 v_pk_fma_f32 v[150:151], v[130:131], v[146:147], v[150:151]
 v_pk_fma_f32 v[150:151], v[132:133], v[144:145], v[150:151]
 v_pk_fma_f32 v[150:151], v[134:135], v[142:143], v[150:151]
 v_pk_mul_f32 v[150:151], v[150:151], v[138:139]
 v_cvt_pk_bf16_f32 v19, v150, v151
 v_pk_mul_f32 v[152:153], v[130:131], v[148:149]
 v_pk_fma_f32 v[152:153], v[132:133], v[146:147], v[152:153]
 v_pk_fma_f32 v[152:153], v[134:135], v[144:145], v[152:153]
 v_pk_fma_f32 v[152:153], v[136:137], v[142:143], v[152:153]
 v_pk_mul_f32 v[152:153], v[152:153], v[140:141]
 v_cvt_pk_bf16_f32 v23, v152, v153
 v_lshrrev_b32 v26, 3, v0
 v_lshlrev_b32 v26, 8, v26
 v_and_b32 v25, 7, v0
 v_lshl_add_u32 v26, v25, 4, v26
 s_lshl_b32 s35, s3, 11
 s_add_u32 s35, s35, 0x20000
 v_add_u32 v26, s35, v26
 ds_write_b128 v26, v[16:19] offset:0
 ds_write_b128 v26, v[20:23] offset:128
 v_bfe_u32 v24, v0, 2, 2
 v_bfe_u32 v28, v0, 4, 1
 v_lshl_add_u32 v24, v28, 3, v24
 v_lshlrev_b32 v24, 2, v24
 v_lshrrev_b32 v28, 5, v0
 v_add_u32 v24, v24, v28
 v_lshlrev_b32 v24, 7, v24
 v_and_b32 v28, 3, v0
 v_lshl_add_u32 v24, v28, 3, v24
 s_lshl_b32 s35, s3, 5
 s_add_u32 s35, s35, 0x20000
 v_add_u32 v24, s35, v24
 v_and_b32 v25, 15, v0
 v_mul_u32_u24 v25, 4096, v25
 v_lshrrev_b32 v28, 4, v0
 v_lshl_add_u32 v25, v28, 4, v25
 s_lshl_b32 s35, s34, 2
 s_add_u32 s35, s35, s3
 s_mul_i32 s35, s35, 65536
 s_lshl_b32 s36, s33, 7
 s_add_u32 s35, s35, s36
 s_add_u32 s35, s35, 85983232
L_s1b:
 s_add_u32 s52, s52, s70
 s_or_b32 m0, s40, 0x8000
 s_nop 0
 buffer_load_dwordx4 v1, s[12:15], s52 offen offset:0 sc1 lds
 v_and_b32 v14, 15, v0
 v_lshrrev_b32 v11, 4, v0
 v_lshlrev_b32 v11, 2, v11
 v_sub_u32 v14, v14, v11
 v_add_u32 v14, s53, v14
 v_mov_b32 v2, v1
 v_add_u32 v3, 0x10000, v1
 v_mov_b64 v[96:97], 0
 v_mov_b64 v[98:99], 0
 v_mov_b64 v[100:101], 0
 v_mov_b64 v[102:103], 0
 v_mov_b64 v[104:105], 0
 v_mov_b64 v[106:107], 0
 v_mov_b64 v[108:109], 0
 v_mov_b64 v[110:111], 0
 v_mov_b64 v[112:113], 0
 v_mov_b64 v[114:115], 0
 v_mov_b64 v[116:117], 0
 buffer_load_dwordx4 v1, s[12:15], s52 offen offset:1024 sc1 lds
 v_mov_b64 v[118:119], 0
 v_mov_b64 v[120:121], 0
 v_mov_b64 v[122:123], 0
 v_mov_b64 v[124:125], 0
 v_mov_b64 v[126:127], 0
 v_mov_b64 v[128:129], 0
 v_mov_b64 v[130:131], 0
 v_mov_b64 v[132:133], 0
 v_mov_b64 v[134:135], 0
 v_mov_b64 v[136:137], 0
 v_mov_b64 v[138:139], 0
 v_mov_b64 v[140:141], 0
 v_mov_b64 v[142:143], 0
 v_mov_b64 v[144:145], 0
 v_mov_b64 v[146:147], 0
 v_mov_b64 v[148:149], 0
 v_mov_b64 v[150:151], 0
 v_mov_b64 v[152:153], 0
 buffer_load_dwordx4 v1, s[12:15], s52 offen offset:2048 sc1 lds
 v_mov_b64 v[154:155], 0
 v_mov_b64 v[156:157], 0
 v_mov_b64 v[158:159], 0
 v_mov_b64 v[160:161], 0
 v_mov_b64 v[162:163], 0
 v_mov_b64 v[164:165], 0
 v_mov_b64 v[166:167], 0
 v_mov_b64 v[168:169], 0
 v_mov_b64 v[170:171], 0
 v_mov_b64 v[172:173], 0
 v_mov_b64 v[174:175], 0
 v_mov_b64 v[176:177], 0
 v_mov_b64 v[178:179], 0
 v_mov_b64 v[180:181], 0
 v_mov_b64 v[182:183], 0
 v_mov_b64 v[184:185], 0
 v_mov_b64 v[186:187], 0
 v_mov_b64 v[188:189], 0
 buffer_load_dwordx4 v1, s[12:15], s52 offen offset:3072 sc1 lds
 v_mov_b64 v[190:191], 0
 v_mov_b64 v[192:193], 0
 v_mov_b64 v[194:195], 0
 v_mov_b64 v[196:197], 0
 v_mov_b64 v[198:199], 0
 v_mov_b64 v[200:201], 0
 v_mov_b64 v[202:203], 0
 v_mov_b64 v[204:205], 0
 v_mov_b64 v[206:207], 0
 v_mov_b64 v[208:209], 0
 v_mov_b64 v[210:211], 0
 v_mov_b64 v[212:213], 0
 v_mov_b64 v[214:215], 0
 v_mov_b64 v[216:217], 0
 v_mov_b64 v[218:219], 0
 v_mov_b64 v[220:221], 0
 v_mov_b64 v[222:223], 0
 s_bitset1_b32 m0, 12
 s_nop 0
 buffer_load_dwordx4 v4, s[12:15], s52 offen offset:0 sc1 lds
 v_mov_b64 v[224:225], 0
 v_mov_b64 v[226:227], 0
 v_mov_b64 v[228:229], 0
 v_mov_b64 v[230:231], 0
 v_mov_b64 v[232:233], 0
 v_mov_b64 v[234:235], 0
 v_mov_b64 v[236:237], 0
 v_mov_b64 v[238:239], 0
 v_mov_b64 v[240:241], 0
 v_mov_b64 v[242:243], 0
 v_mov_b64 v[244:245], 0
 v_mov_b64 v[246:247], 0
 v_mov_b64 v[248:249], 0
 v_mov_b64 v[250:251], 0
 v_mov_b64 v[252:253], 0
 v_mov_b64 v[254:255], 0
 v_mov_b32 v7, 0
 v_mov_b32 v8, 0
 buffer_load_dwordx4 v4, s[12:15], s52 offen offset:1024 sc1 lds
 v_mov_b32 v9, 0
 v_mov_b32 v10, 0
 v_mov_b32 v13, v1
 s_mov_b64 s[8:9], s[12:13]
 s_mov_b32 s10, s14
 s_mov_b32 s76, 0
 s_movk_i32 s77, 0x1000
 s_mov_b32 s51, 0
 v_mul_u32_u24 v15, s27, v12
 v_accvgpr_write_b32 a246, 1
 v_accvgpr_write_b32 a247, 1
 s_cmp_lt_u32 s28, 14
 s_cselect_b32 s62, 1, 0
 s_andn2_b32 s62, s62, s27
 v_mov_b32 v40, 0
 v_mov_b32 v41, 0
 v_mov_b32 v44, 0
 v_mov_b32 v45, 0
 buffer_load_dwordx4 v4, s[12:15], s52 offen offset:2048 sc1 lds
 v_and_b32 v46, 1, v0
 v_lshlrev_b32 v46, 4, v46
 v_mov_b32 v47, 0x3f80
 v_lshlrev_b32 v46, v46, v47
 v_bfe_u32 v47, v0, 1, 3
 v_lshrrev_b32 v48, 4, v0
 v_lshlrev_b32 v48, 1, v48
 v_sub_u32 v47, v47, v48
 v_cmp_eq_u32 s[20:21], 0, v47
 v_cmp_eq_u32 s[22:23], 1, v47
 v_lshrrev_b32 v51, 3, v0
 s_lshl_b32 s78, s3, 6
 v_add_u32 v50, s78, v51
 v_mul_u32_u24 v50, 896, v50
 v_and_b32 v51, 6, v51
 v_xor_b32 v51, v51, v0
 v_and_b32 v51, 7, v51
 v_lshl_add_u32 v50, v51, 4, v50
 buffer_load_dwordx4 v4, s[12:15], s52 offen offset:3072 sc1 lds
 s_mul_i32 s78, s26, 229376
 s_add_u32 s79, s78, 28672
 s_add_u32 s80, s78, 57344
 s_add_u32 s81, s78, 86016
 s_add_u32 s82, s78, 114688
 s_add_u32 s83, s78, 143360
 s_add_u32 s84, s78, 172032
 s_add_u32 s85, s78, 200704
 v_cndmask_b32 v42, 0, v46, s[20:21]
 v_cndmask_b32 v43, 0, v46, s[22:23]
 v_accvgpr_write_b32 a196, v40
 v_accvgpr_write_b32 a197, v41
 v_accvgpr_write_b32 a198, v42
 v_accvgpr_write_b32 a199, v43
 v_accvgpr_write_b32 a200, v44
 v_accvgpr_write_b32 a201, v45
 v_accvgpr_write_b32 a252, v50
 s_cmp_ge_u32 s44, 2
 s_cbranch_scc1 L_nomask0
 v_mov_b32 v11, 0xf149f2ca
 v_cmp_gt_i32 s[16:17], 0, v14
 v_cmp_gt_i32 s[18:19], 1, v14
 v_cmp_gt_i32 s[20:21], 2, v14
 v_cmp_gt_i32 s[22:23], 3, v14
 v_cndmask_b32 v96, v9, v11, s[16:17]
 v_cndmask_b32 v97, v9, v11, s[18:19]
 v_cndmask_b32 v98, v9, v11, s[20:21]
 v_cndmask_b32 v99, v9, v11, s[22:23]
 v_cmp_gt_i32 s[16:17], 16, v14
 v_cmp_gt_i32 s[18:19], 17, v14
 v_cmp_gt_i32 s[20:21], 18, v14
 v_cmp_gt_i32 s[22:23], 19, v14
 v_cndmask_b32 v104, v9, v11, s[16:17]
 v_cndmask_b32 v105, v9, v11, s[18:19]
 v_cndmask_b32 v106, v9, v11, s[20:21]
 v_cndmask_b32 v107, v9, v11, s[22:23]
 v_cmp_gt_i32 s[16:17], 32, v14
 v_cmp_gt_i32 s[18:19], 33, v14
 v_cmp_gt_i32 s[20:21], 34, v14
 v_cmp_gt_i32 s[22:23], 35, v14
 v_cndmask_b32 v112, v9, v11, s[16:17]
 v_cndmask_b32 v113, v9, v11, s[18:19]
 v_cndmask_b32 v114, v9, v11, s[20:21]
 v_cndmask_b32 v115, v9, v11, s[22:23]
 v_cmp_gt_i32 s[16:17], 48, v14
 v_cmp_gt_i32 s[18:19], 49, v14
 v_cmp_gt_i32 s[20:21], 50, v14
 v_cmp_gt_i32 s[22:23], 51, v14
 v_cndmask_b32 v120, v9, v11, s[16:17]
 v_cndmask_b32 v121, v9, v11, s[18:19]
 v_cndmask_b32 v122, v9, v11, s[20:21]
 v_cndmask_b32 v123, v9, v11, s[22:23]
L_nomask0:
 v_accvgpr_read_b32 v27, a245
 s_lshl_b32 s36, s95, 2
 s_add_u32 s36, s36, 84959232
 s_cmp_lt_u32 s28, 14
 s_cselect_b32 s36, s36, 2.0
 s_add_u32 s33, s94, 4
 s_cmp_eq_u32 s27, 1
 s_cselect_b32 s33, s33, 2.0
 s_cmp_eq_u32 s48, 0
 s_cbranch_scc1 L_kvlate
 s_add_u32 s42, s52, s70
L_kvok:
 s_waitcnt vmcnt(8) lgkmcnt(0)
 s_barrier
 ds_read_b128 a[64:67], v2 offset:0
 ds_read_b128 a[68:71], v2 offset:1024
 ds_read_b128 a[72:75], v2 offset:2048
 ds_read_b128 a[76:79], v2 offset:3072
 ds_read_b128 a[80:83], v2 offset:4096
 ds_read_b128 a[84:87], v2 offset:5120
 ds_read_b128 a[88:91], v2 offset:6144
 ds_read_b128 a[92:95], v2 offset:7168
 buffer_store_dword v27, v27, s[12:15], s1 offen sc1
 buffer_store_dword v27, v27, s[12:15], s33 offen sc1
 s_cmp_ge_u32 s28, 14
 s_cbranch_scc1 L_s1c
 ds_read_b64_tr_b16 v[16:17], v24 offset:0
 ds_read_b64_tr_b16 v[18:19], v24 offset:2048
 ds_read_b64_tr_b16 v[20:21], v24 offset:256
 ds_read_b64_tr_b16 v[22:23], v24 offset:2304
 s_waitcnt lgkmcnt(0)
 buffer_store_dwordx4 v[16:19], v25, s[12:15], s35 offen offset:0 sc1
 buffer_store_dwordx4 v[20:23], v25, s[12:15], s35 offen offset:64 sc1
L_s1c:
 s_mov_b32 m0, s41
 s_waitcnt lgkmcnt(0)
 v_mfma_f32_16x16x32_bf16 v[32:35], a[64:67], a[0:3], v[96:99]
 ds_read_b128 a[96:99], v2 offset:8192
 v_mfma_f32_16x16x32_bf16 v[32:35], a[68:71], a[4:7], v[32:35]
 buffer_load_dwordx4 v1, s[12:15], s43 offen offset:0 sc1 lds
 v_mfma_f32_16x16x32_bf16 v[32:35], a[72:75], a[8:11], v[32:35]
 ds_read_b128 a[100:103], v2 offset:9216
 v_mfma_f32_16x16x32_bf16 v[32:35], a[76:79], a[12:15], v[32:35]
 v_mfma_f32_16x16x32_bf16 v[32:35], a[80:83], a[16:19], v[32:35]
 ds_read_b128 a[104:107], v2 offset:10240
 v_mfma_f32_16x16x32_bf16 v[32:35], a[84:87], a[20:23], v[32:35]
 buffer_load_dwordx4 v1, s[12:15], s43 offen offset:1024 sc1 lds
 v_mfma_f32_16x16x32_bf16 v[32:35], a[88:91], a[24:27], v[32:35]
 ds_read_b128 a[108:111], v2 offset:11264
 v_mfma_f32_16x16x32_bf16 v[32:35], a[92:95], a[28:31], v[32:35]
 v_mfma_f32_16x16x32_bf16 v[36:39], a[64:67], a[32:35], v[100:103]
 ds_read_b128 a[112:115], v2 offset:12288
 v_mfma_f32_16x16x32_bf16 v[36:39], a[68:71], a[36:39], v[36:39]
 buffer_load_dwordx4 v1, s[12:15], s43 offen offset:2048 sc1 lds
 v_mfma_f32_16x16x32_bf16 v[36:39], a[72:75], a[40:43], v[36:39]
 ds_read_b128 a[116:119], v2 offset:13312
 v_mfma_f32_16x16x32_bf16 v[36:39], a[76:79], a[44:47], v[36:39]
 v_mfma_f32_16x16x32_bf16 v[36:39], a[80:83], a[48:51], v[36:39]
 ds_read_b128 a[120:123], v2 offset:14336
 v_mfma_f32_16x16x32_bf16 v[36:39], a[84:87], a[52:55], v[36:39]
 buffer_load_dwordx4 v1, s[12:15], s43 offen offset:3072 sc1 lds
 v_mfma_f32_16x16x32_bf16 v[36:39], a[88:91], a[56:59], v[36:39]
 ds_read_b128 a[124:127], v2 offset:15360
 v_mfma_f32_16x16x32_bf16 v[36:39], a[92:95], a[60:63], v[36:39]
 s_waitcnt lgkmcnt(6)
 v_exp_f32 v64, v32
 v_mfma_f32_16x16x32_bf16 v[40:43], a[96:99], a[0:3], v[104:107]
 s_bitset1_b32 m0, 12
 ds_read_b128 a[64:67], v2 offset:16384
 v_mfma_f32_16x16x32_bf16 v[40:43], a[100:103], a[4:7], v[40:43]
 s_waitcnt lgkmcnt(5)
 buffer_load_dwordx4 v4, s[12:15], s43 offen offset:0 sc1 lds
 v_mfma_f32_16x16x32_bf16 v[40:43], a[104:107], a[8:11], v[40:43]
 ds_read_b128 a[68:71], v2 offset:17408
 v_mfma_f32_16x16x32_bf16 v[40:43], a[108:111], a[12:15], v[40:43]
 s_waitcnt lgkmcnt(4)
 v_exp_f32 v65, v33
 v_mfma_f32_16x16x32_bf16 v[40:43], a[112:115], a[16:19], v[40:43]
 ds_read_b128 a[72:75], v2 offset:18432
 v_add_f32 v5, v64, v65
 v_mfma_f32_16x16x32_bf16 v[40:43], a[116:119], a[20:23], v[40:43]
 s_waitcnt lgkmcnt(3)
 buffer_load_dwordx4 v4, s[12:15], s43 offen offset:1024 sc1 lds
 v_mfma_f32_16x16x32_bf16 v[40:43], a[120:123], a[24:27], v[40:43]
 ds_read_b128 a[76:79], v2 offset:19456
 v_mfma_f32_16x16x32_bf16 v[40:43], a[124:127], a[28:31], v[40:43]
 v_exp_f32 v66, v34
 v_mfma_f32_16x16x32_bf16 v[44:47], a[96:99], a[32:35], v[108:111]
 ds_read_b128 a[80:83], v2 offset:20480
 v_add_f32 v5, v5, v66
 v_mfma_f32_16x16x32_bf16 v[44:47], a[100:103], a[36:39], v[44:47]
 buffer_load_dwordx4 v4, s[12:15], s43 offen offset:2048 sc1 lds
 v_mfma_f32_16x16x32_bf16 v[44:47], a[104:107], a[40:43], v[44:47]
 ds_read_b128 a[84:87], v2 offset:21504
 v_mfma_f32_16x16x32_bf16 v[44:47], a[108:111], a[44:47], v[44:47]
 v_exp_f32 v67, v35
 v_mfma_f32_16x16x32_bf16 v[44:47], a[112:115], a[48:51], v[44:47]
 ds_read_b128 a[88:91], v2 offset:22528
 v_add_f32 v5, v5, v67
 v_mfma_f32_16x16x32_bf16 v[44:47], a[116:119], a[52:55], v[44:47]
 buffer_load_dwordx4 v4, s[12:15], s43 offen offset:3072 sc1 lds
 v_mfma_f32_16x16x32_bf16 v[44:47], a[120:123], a[56:59], v[44:47]
 ds_read_b128 a[92:95], v2 offset:23552
 v_mfma_f32_16x16x32_bf16 v[44:47], a[124:127], a[60:63], v[44:47]
 s_waitcnt lgkmcnt(6)
 v_exp_f32 v68, v36
 v_mfma_f32_16x16x32_bf16 v[48:51], a[64:67], a[0:3], v[112:115]
 s_add_u32 s43, s43, s71
 ds_read_b128 a[96:99], v2 offset:24576
 v_mfma_f32_16x16x32_bf16 v[48:51], a[68:71], a[4:7], v[48:51]
 s_waitcnt lgkmcnt(5)
 v_exp_f32 v69, v37
 v_mfma_f32_16x16x32_bf16 v[48:51], a[72:75], a[8:11], v[48:51]
 s_xor_b32 s41, s41, 0x8000
 ds_read_b128 a[100:103], v2 offset:25600
 v_add_f32 v6, v68, v69
 v_mfma_f32_16x16x32_bf16 v[48:51], a[76:79], a[12:15], v[48:51]
 s_waitcnt lgkmcnt(4)
 v_exp_f32 v70, v38
 v_mfma_f32_16x16x32_bf16 v[48:51], a[80:83], a[16:19], v[48:51]
 ds_read_b128 a[104:107], v2 offset:26624
 v_add_f32 v6, v6, v70
 v_mfma_f32_16x16x32_bf16 v[48:51], a[84:87], a[20:23], v[48:51]
 s_waitcnt lgkmcnt(3)
 v_exp_f32 v71, v39
 v_mfma_f32_16x16x32_bf16 v[48:51], a[88:91], a[24:27], v[48:51]
 ds_read_b128 a[108:111], v2 offset:27648
 v_add_f32 v6, v6, v71
 v_mfma_f32_16x16x32_bf16 v[48:51], a[92:95], a[28:31], v[48:51]
 v_exp_f32 v72, v40
 v_mfma_f32_16x16x32_bf16 v[52:55], a[64:67], a[32:35], v[116:119]
 ds_read_b128 a[112:115], v2 offset:28672
 v_add_f32 v5, v5, v72
 v_mfma_f32_16x16x32_bf16 v[52:55], a[68:71], a[36:39], v[52:55]
 v_exp_f32 v73, v41
 v_mfma_f32_16x16x32_bf16 v[52:55], a[72:75], a[40:43], v[52:55]
 ds_read_b128 a[116:119], v2 offset:29696
 v_add_f32 v5, v5, v73
 v_mfma_f32_16x16x32_bf16 v[52:55], a[76:79], a[44:47], v[52:55]
 v_exp_f32 v74, v42
 v_mfma_f32_16x16x32_bf16 v[52:55], a[80:83], a[48:51], v[52:55]
 ds_read_b128 a[120:123], v2 offset:30720
 v_add_f32 v5, v5, v74
 v_mfma_f32_16x16x32_bf16 v[52:55], a[84:87], a[52:55], v[52:55]
 v_exp_f32 v75, v43
 v_mfma_f32_16x16x32_bf16 v[52:55], a[88:91], a[56:59], v[52:55]
 ds_read_b128 a[124:127], v2 offset:31744
 v_add_f32 v5, v5, v75
 v_mfma_f32_16x16x32_bf16 v[52:55], a[92:95], a[60:63], v[52:55]
 s_waitcnt lgkmcnt(6)
 v_exp_f32 v76, v44
 v_mfma_f32_16x16x32_bf16 v[56:59], a[96:99], a[0:3], v[120:123]
 v_exp_f32 v77, v45
 v_mfma_f32_16x16x32_bf16 v[56:59], a[100:103], a[4:7], v[56:59]
 s_waitcnt lgkmcnt(4)
 v_exp_f32 v78, v46
 v_mfma_f32_16x16x32_bf16 v[56:59], a[104:107], a[8:11], v[56:59]
 v_exp_f32 v79, v47
 v_mfma_f32_16x16x32_bf16 v[56:59], a[108:111], a[12:15], v[56:59]
 s_waitcnt lgkmcnt(2)
 v_exp_f32 v80, v48
 v_mfma_f32_16x16x32_bf16 v[56:59], a[112:115], a[16:19], v[56:59]
 v_exp_f32 v81, v49
 v_mfma_f32_16x16x32_bf16 v[56:59], a[116:119], a[20:23], v[56:59]
 s_waitcnt lgkmcnt(0)
 v_exp_f32 v82, v50
 v_mfma_f32_16x16x32_bf16 v[56:59], a[120:123], a[24:27], v[56:59]
 v_exp_f32 v83, v51
 v_mfma_f32_16x16x32_bf16 v[56:59], a[124:127], a[28:31], v[56:59]
 v_exp_f32 v84, v52
 v_mfma_f32_16x16x32_bf16 v[60:63], a[96:99], a[32:35], v[124:127]
 v_exp_f32 v85, v53
 v_mfma_f32_16x16x32_bf16 v[60:63], a[100:103], a[36:39], v[60:63]
 v_exp_f32 v86, v54
 v_mfma_f32_16x16x32_bf16 v[60:63], a[104:107], a[40:43], v[60:63]
 v_exp_f32 v87, v55
 v_mfma_f32_16x16x32_bf16 v[60:63], a[108:111], a[44:47], v[60:63]
 v_add_f32 v6, v6, v76
 v_mfma_f32_16x16x32_bf16 v[60:63], a[112:115], a[48:51], v[60:63]
 v_add_f32 v6, v6, v77
 v_mfma_f32_16x16x32_bf16 v[60:63], a[116:119], a[52:55], v[60:63]
 v_exp_f32 v88, v56
 v_mfma_f32_16x16x32_bf16 v[60:63], a[120:123], a[56:59], v[60:63]
 v_exp_f32 v89, v57
 v_mfma_f32_16x16x32_bf16 v[60:63], a[124:127], a[60:63], v[60:63]
 v_exp_f32 v90, v58
 v_xor_b32 v2, 0x8000, v2
 s_waitcnt vmcnt(8)
 s_barrier
 ds_read_b128 a[64:67], v2 offset:0
 ds_read_b128 a[68:71], v2 offset:1024
 ds_read_b128 a[72:75], v2 offset:2048
 ds_read_b128 a[76:79], v2 offset:3072
 ds_read_b128 a[80:83], v2 offset:4096
 ds_read_b128 a[84:87], v2 offset:5120
 ds_read_b128 a[88:91], v2 offset:6144
 ds_read_b128 a[92:95], v2 offset:7168
 buffer_store_dword v27, v27, s[12:15], s36 offen sc1
 v_exp_f32 v91, v59
 v_exp_f32 v92, v60
 v_exp_f32 v93, v61
 v_exp_f32 v94, v62
 v_exp_f32 v95, v63
 v_add_f32 v6, v6, v78
 v_add_f32 v6, v6, v79
 v_add_f32 v5, v5, v80
 v_add_f32 v5, v5, v81
 v_add_f32 v5, v5, v82
 v_add_f32 v5, v5, v83
 v_add_f32 v6, v6, v84
 v_add_f32 v6, v6, v85
 v_add_f32 v6, v6, v86
 v_add_f32 v6, v6, v87
 v_add_f32 v5, v5, v88
 v_add_f32 v5, v5, v89
 v_add_f32 v5, v5, v90
 v_add_f32 v5, v5, v91
 v_add_f32 v6, v6, v92
 v_add_f32 v6, v6, v93
 v_add_f32 v6, v6, v94
 v_add_f32 v6, v6, v95
L_first:
 v_add_f32 v11, v5, v6
 v_min_f32 v12, v5, v6
 v_cmp_nge_f32 vcc, s47, v11
 s_mov_b32 s46, 0xff800000
 s_cbranch_vccnz L_slow2
 v_cmp_gt_f32 vcc, 0x33800000, v12
 s_cbranch_vccnz L_rowchk
L_firstok:
 s_mov_b32 s46, 0
 s_waitcnt lgkmcnt(0)
 s_branch L_ret
L_kvlate:
 v_cmp_gt_u32 vcc, 256, v5
 v_mov_b32 v29, 0
 s_mov_b32 s32, 0
 s_cbranch_vccz L_armed
L_pollA:
 global_load_dword v28, v29, s[90:91] offset:128 sc1
 s_add_u32 s32, s32, 1
 s_waitcnt vmcnt(0)
 v_cmp_gt_u32 vcc, 256, v28
 s_cmp_lt_u32 s32, 0x80000
 s_cselect_b64 vcc, vcc, 0
 s_cbranch_vccnz L_pollA
L_armed:
 v_and_b32 v28, 11, v0
 v_lshlrev_b32 v28, 2, v28
 s_mov_b32 s32, 0
L_poll0:
 buffer_load_dword v29, v28, s[12:15], s58 offen sc1
 s_waitcnt vmcnt(0)
 v_cmp_ne_u32 vcc, 0, v29
 s_cbranch_vccz L_poll0_ok
 s_sleep 8
 s_add_u32 s32, s32, 1
 s_cmp_lt_u32 s32, 0x80000
 s_cbranch_scc1 L_poll0
L_poll0_ok:
 s_mov_b32 m0, s40
 s_nop 0
 buffer_load_dwordx4 v1, s[12:15], s42 offen offset:0 sc1 lds
 buffer_load_dwordx4 v1, s[12:15], s42 offen offset:1024 sc1 lds
 buffer_load_dwordx4 v1, s[12:15], s42 offen offset:2048 sc1 lds
 buffer_load_dwordx4 v1, s[12:15], s42 offen offset:3072 sc1 lds
 s_bitset1_b32 m0, 12
 s_nop 0
 buffer_load_dwordx4 v4, s[12:15], s42 offen offset:0 sc1 lds
 buffer_load_dwordx4 v4, s[12:15], s42 offen offset:1024 sc1 lds
 buffer_load_dwordx4 v4, s[12:15], s42 offen offset:2048 sc1 lds
 buffer_load_dwordx4 v4, s[12:15], s42 offen offset:3072 sc1 lds
 s_add_u32 s42, s42, s70
 s_xor_b32 s40, s40, 0x8000
 s_mov_b32 m0, s40
 s_nop 0
 buffer_load_dwordx4 v1, s[12:15], s42 offen offset:0 sc1 lds
 buffer_load_dwordx4 v1, s[12:15], s42 offen offset:1024 sc1 lds
 buffer_load_dwordx4 v1, s[12:15], s42 offen offset:2048 sc1 lds
 buffer_load_dwordx4 v1, s[12:15], s42 offen offset:3072 sc1 lds
 s_bitset1_b32 m0, 12
 s_nop 0
 buffer_load_dwordx4 v4, s[12:15], s42 offen offset:0 sc1 lds
 buffer_load_dwordx4 v4, s[12:15], s42 offen offset:1024 sc1 lds
 buffer_load_dwordx4 v4, s[12:15], s42 offen offset:2048 sc1 lds
 buffer_load_dwordx4 v4, s[12:15], s42 offen offset:3072 sc1 lds
 s_add_u32 s42, s42, s70
 s_xor_b32 s40, s40, 0x8000
 s_branch L_kvok
L_rowchk:
 v_mov_b32 v16, v5
 v_mov_b32 v17, v6
 v_mov_b32 v18, v16
 v_mov_b32 v19, v17
 s_nop 0
 v_permlane32_swap_b32 v16, v18
 v_permlane32_swap_b32 v17, v19
 s_nop 0
 v_add_f32 v16, v16, v18
 v_add_f32 v17, v17, v19
 v_mov_b32 v18, v16
 v_mov_b32 v19, v17
 s_nop 0
 v_permlane16_swap_b32 v16, v18
 v_permlane16_swap_b32 v17, v19
 s_nop 0
 v_add_f32 v16, v16, v18
 v_add_f32 v17, v17, v19
 v_min_f32 v16, v16, v17
 v_cmp_gt_f32 vcc, 0x33800000, v16
 s_cbranch_vccz L_firstok
 s_branch L_slow2
L_slow:
 s_cmp_lg_u32 s47, 0x4b800000
 s_cbranch_scc1 L_switched
 s_nop 5
L_slow2:
 v_max3_f32 v11, v32, v33, v34
 v_max3_f32 v11, v11, v35, v40
 v_max3_f32 v11, v11, v41, v42
 v_max3_f32 v11, v11, v43, v48
 v_max3_f32 v11, v11, v49, v50
 v_max3_f32 v11, v11, v51, v56
 v_max3_f32 v11, v11, v57, v58
 v_max_f32 v11, v11, v59
 v_mov_b32 v16, v11
 s_nop 1
 v_permlane32_swap_b32 v11, v16
 s_nop 1
 v_max_f32 v11, v11, v16
 v_mov_b32 v16, v11
 s_nop 1
 v_permlane16_swap_b32 v11, v16
 s_nop 1
 v_max_f32 v11, v11, v16
 v_max_f32 v11, s46, v11
 v_sub_f32 v9, v9, v11
 v_sub_f32 v32, v32, v11
 v_sub_f32 v33, v33, v11
 v_sub_f32 v34, v34, v11
 v_sub_f32 v35, v35, v11
 v_sub_f32 v40, v40, v11
 v_sub_f32 v41, v41, v11
 v_sub_f32 v42, v42, v11
 v_sub_f32 v43, v43, v11
 v_sub_f32 v48, v48, v11
 v_sub_f32 v49, v49, v11
 v_sub_f32 v50, v50, v11
 v_sub_f32 v51, v51, v11
 v_sub_f32 v56, v56, v11
 v_sub_f32 v57, v57, v11
 v_sub_f32 v58, v58, v11
 v_sub_f32 v59, v59, v11
 v_exp_f32 v64, v32
 v_mov_b32 v96, v9
 v_exp_f32 v65, v33
 v_mov_b32 v97, v9
 v_exp_f32 v66, v34
 v_mov_b32 v98, v9
 v_exp_f32 v67, v35
 v_mov_b32 v99, v9
 v_exp_f32 v72, v40
 v_mov_b32 v104, v9
 v_exp_f32 v73, v41
 v_mov_b32 v105, v9
 v_exp_f32 v74, v42
 v_mov_b32 v106, v9
 v_exp_f32 v75, v43
 v_mov_b32 v107, v9
 v_exp_f32 v80, v48
 v_mov_b32 v112, v9
 v_exp_f32 v81, v49
 v_mov_b32 v113, v9
 v_exp_f32 v82, v50
 v_mov_b32 v114, v9
 v_exp_f32 v83, v51
 v_mov_b32 v115, v9
 v_exp_f32 v88, v56
 v_mov_b32 v120, v9
 v_exp_f32 v89, v57
 v_mov_b32 v121, v9
 v_exp_f32 v90, v58
 v_mov_b32 v122, v9
 v_exp_f32 v91, v59
 v_mov_b32 v123, v9
 v_add_f32 v5, v64, v65
 v_add_f32 v5, v5, v66
 v_add_f32 v5, v5, v67
 v_add_f32 v5, v5, v72
 v_add_f32 v5, v5, v73
 v_add_f32 v5, v5, v74
 v_add_f32 v5, v5, v75
 v_add_f32 v5, v5, v80
 v_add_f32 v5, v5, v81
 v_add_f32 v5, v5, v82
 v_add_f32 v5, v5, v83
 v_add_f32 v5, v5, v88
 v_add_f32 v5, v5, v89
 v_add_f32 v5, v5, v90
 v_add_f32 v5, v5, v91
 v_max3_f32 v12, v36, v37, v38
 v_max3_f32 v12, v12, v39, v44
 v_max3_f32 v12, v12, v45, v46
 v_max3_f32 v12, v12, v47, v52
 v_max3_f32 v12, v12, v53, v54
 v_max3_f32 v12, v12, v55, v60
 v_max3_f32 v12, v12, v61, v62
 v_max_f32 v12, v12, v63
 v_mov_b32 v16, v12
 s_nop 1
 v_permlane32_swap_b32 v12, v16
 s_nop 1
 v_max_f32 v12, v12, v16
 v_mov_b32 v16, v12
 s_nop 1
 v_permlane16_swap_b32 v12, v16
 s_nop 1
 v_max_f32 v12, v12, v16
 v_max_f32 v12, s46, v12
 v_sub_f32 v10, v10, v12
 v_sub_f32 v36, v36, v12
 v_sub_f32 v37, v37, v12
 v_sub_f32 v38, v38, v12
 v_sub_f32 v39, v39, v12
 v_sub_f32 v44, v44, v12
 v_sub_f32 v45, v45, v12
 v_sub_f32 v46, v46, v12
 v_sub_f32 v47, v47, v12
 v_sub_f32 v52, v52, v12
 v_sub_f32 v53, v53, v12
 v_sub_f32 v54, v54, v12
 v_sub_f32 v55, v55, v12
 v_sub_f32 v60, v60, v12
 v_sub_f32 v61, v61, v12
 v_sub_f32 v62, v62, v12
 v_sub_f32 v63, v63, v12
 v_exp_f32 v68, v36
 v_mov_b32 v100, v10
 v_exp_f32 v69, v37
 v_mov_b32 v101, v10
 v_exp_f32 v70, v38
 v_mov_b32 v102, v10
 v_exp_f32 v71, v39
 v_mov_b32 v103, v10
 v_exp_f32 v76, v44
 v_mov_b32 v108, v10
 v_exp_f32 v77, v45
 v_mov_b32 v109, v10
 v_exp_f32 v78, v46
 v_mov_b32 v110, v10
 v_exp_f32 v79, v47
 v_mov_b32 v111, v10
 v_exp_f32 v84, v52
 v_mov_b32 v116, v10
 v_exp_f32 v85, v53
 v_mov_b32 v117, v10
 v_exp_f32 v86, v54
 v_mov_b32 v118, v10
 v_exp_f32 v87, v55
 v_mov_b32 v119, v10
 v_exp_f32 v92, v60
 v_mov_b32 v124, v10
 v_exp_f32 v93, v61
 v_mov_b32 v125, v10
 v_exp_f32 v94, v62
 v_mov_b32 v126, v10
 v_exp_f32 v95, v63
 v_mov_b32 v127, v10
 v_add_f32 v6, v68, v69
 v_add_f32 v6, v6, v70
 v_add_f32 v6, v6, v71
 v_add_f32 v6, v6, v76
 v_add_f32 v6, v6, v77
 v_add_f32 v6, v6, v78
 v_add_f32 v6, v6, v79
 v_add_f32 v6, v6, v84
 v_add_f32 v6, v6, v85
 v_add_f32 v6, v6, v86
 v_add_f32 v6, v6, v87
 v_add_f32 v6, v6, v92
 v_add_f32 v6, v6, v93
 v_add_f32 v6, v6, v94
 v_add_f32 v6, v6, v95
 s_waitcnt lgkmcnt(0)
 s_cmp_lg_u32 s46, 0
 s_mov_b32 s46, 0
 s_cbranch_scc1 L_ret
 v_exp_f32 v11, -v11
 s_nop 0
 v_mul_f32 v7, v7, v11
 v_mul_f32 v128, v128, v11
 v_mul_f32 v129, v129, v11
 v_mul_f32 v130, v130, v11
 v_mul_f32 v131, v131, v11
 v_mul_f32 v132, v132, v11
 v_mul_f32 v133, v133, v11
 v_mul_f32 v134, v134, v11
 v_mul_f32 v135, v135, v11
 v_mul_f32 v136, v136, v11
 v_mul_f32 v137, v137, v11
 v_mul_f32 v138, v138, v11
 v_mul_f32 v139, v139, v11
 v_mul_f32 v140, v140, v11
 v_mul_f32 v141, v141, v11
 v_mul_f32 v142, v142, v11
 v_mul_f32 v143, v143, v11
 v_mul_f32 v144, v144, v11
 v_mul_f32 v145, v145, v11
 v_mul_f32 v146, v146, v11
 v_mul_f32 v147, v147, v11
 v_mul_f32 v148, v148, v11
 v_mul_f32 v149, v149, v11
 v_mul_f32 v150, v150, v11
 v_mul_f32 v151, v151, v11
 v_mul_f32 v152, v152, v11
 v_mul_f32 v153, v153, v11
 v_mul_f32 v154, v154, v11
 v_mul_f32 v155, v155, v11
 v_mul_f32 v156, v156, v11
 v_mul_f32 v157, v157, v11
 v_mul_f32 v158, v158, v11
 v_mul_f32 v159, v159, v11
 v_mul_f32 v160, v160, v11
 v_mul_f32 v161, v161, v11
 v_mul_f32 v162, v162, v11
 v_mul_f32 v163, v163, v11
 v_mul_f32 v164, v164, v11
 v_mul_f32 v165, v165, v11
 v_mul_f32 v166, v166, v11
 v_mul_f32 v167, v167, v11
 v_mul_f32 v168, v168, v11
 v_mul_f32 v169, v169, v11
 v_mul_f32 v170, v170, v11
 v_mul_f32 v171, v171, v11
 v_mul_f32 v172, v172, v11
 v_mul_f32 v173, v173, v11
 v_mul_f32 v174, v174, v11
 v_mul_f32 v175, v175, v11
 v_mul_f32 v176, v176, v11
 v_mul_f32 v177, v177, v11
 v_mul_f32 v178, v178, v11
 v_mul_f32 v179, v179, v11
 v_mul_f32 v180, v180, v11
 v_mul_f32 v181, v181, v11
 v_mul_f32 v182, v182, v11
 v_mul_f32 v183, v183, v11
 v_mul_f32 v184, v184, v11
 v_mul_f32 v185, v185, v11
 v_mul_f32 v186, v186, v11
 v_mul_f32 v187, v187, v11
 v_mul_f32 v188, v188, v11
 v_mul_f32 v189, v189, v11
 v_mul_f32 v190, v190, v11
 v_mul_f32 v191, v191, v11
 v_exp_f32 v12, -v12
 s_nop 0
 v_mul_f32 v8, v8, v12
 v_mul_f32 v192, v192, v12
 v_mul_f32 v193, v193, v12
 v_mul_f32 v194, v194, v12
 v_mul_f32 v195, v195, v12
 v_mul_f32 v196, v196, v12
 v_mul_f32 v197, v197, v12
 v_mul_f32 v198, v198, v12
 v_mul_f32 v199, v199, v12
 v_mul_f32 v200, v200, v12
 v_mul_f32 v201, v201, v12
 v_mul_f32 v202, v202, v12
 v_mul_f32 v203, v203, v12
 v_mul_f32 v204, v204, v12
 v_mul_f32 v205, v205, v12
 v_mul_f32 v206, v206, v12
 v_mul_f32 v207, v207, v12
 v_mul_f32 v208, v208, v12
 v_mul_f32 v209, v209, v12
 v_mul_f32 v210, v210, v12
 v_mul_f32 v211, v211, v12
 v_mul_f32 v212, v212, v12
 v_mul_f32 v213, v213, v12
 v_mul_f32 v214, v214, v12
 v_mul_f32 v215, v215, v12
 v_mul_f32 v216, v216, v12
 v_mul_f32 v217, v217, v12
 v_mul_f32 v218, v218, v12
 v_mul_f32 v219, v219, v12
 v_mul_f32 v220, v220, v12
 v_mul_f32 v221, v221, v12
 v_mul_f32 v222, v222, v12
 v_mul_f32 v223, v223, v12
 v_mul_f32 v224, v224, v12
 v_mul_f32 v225, v225, v12
 v_mul_f32 v226, v226, v12
 v_mul_f32 v227, v227, v12
 v_mul_f32 v228, v228, v12
 v_mul_f32 v229, v229, v12
 v_mul_f32 v230, v230, v12
 v_mul_f32 v231, v231, v12
 v_mul_f32 v232, v232, v12
 v_mul_f32 v233, v233, v12
 v_mul_f32 v234, v234, v12
 v_mul_f32 v235, v235, v12
 v_mul_f32 v236, v236, v12
 v_mul_f32 v237, v237, v12
 v_mul_f32 v238, v238, v12
 v_mul_f32 v239, v239, v12
 v_mul_f32 v240, v240, v12
 v_mul_f32 v241, v241, v12
 v_mul_f32 v242, v242, v12
 v_mul_f32 v243, v243, v12
 v_mul_f32 v244, v244, v12
 v_mul_f32 v245, v245, v12
 v_mul_f32 v246, v246, v12
 v_mul_f32 v247, v247, v12
 v_mul_f32 v248, v248, v12
 v_mul_f32 v249, v249, v12
 v_mul_f32 v250, v250, v12
 v_mul_f32 v251, v251, v12
 v_mul_f32 v252, v252, v12
 v_mul_f32 v253, v253, v12
 v_mul_f32 v254, v254, v12
 v_mul_f32 v255, v255, v12
 s_branch L_ret
.p2align 6
L_loop:
 v_mfma_f32_16x16x32_bf16 v[32:35], a[64:67], a[0:3], v[96:99]
 s_mov_b32 m0, s40
 ds_read_b128 a[96:99], v2 offset:8192
 v_cvt_pk_bf16_f32 v16, v64, v65
 v_mfma_f32_16x16x32_bf16 v[32:35], a[68:71], a[4:7], v[32:35]
 s_waitcnt lgkmcnt(5)
 buffer_load_dwordx4 v13, s[8:11], s42 offen offset:0 sc1 lds
 v_mfma_f32_16x16x32_bf16 v[32:35], a[72:75], a[8:11], v[32:35]
 ds_read_b128 a[100:103], v2 offset:9216
 v_cvt_pk_bf16_f32 v17, v66, v67
 v_mfma_f32_16x16x32_bf16 v[32:35], a[76:79], a[12:15], v[32:35]
 s_waitcnt lgkmcnt(4)
 v_cvt_pk_bf16_f32 v20, v68, v69
 v_cvt_pk_bf16_f32 v21, v70, v71
 v_mfma_f32_16x16x32_bf16 v[32:35], a[80:83], a[16:19], v[32:35]
 s_add_u32 s39, s42, s76
 ds_read_b128 a[104:107], v2 offset:10240
 v_add_f32 v7, v7, v5
 v_mfma_f32_16x16x32_bf16 v[32:35], a[84:87], a[20:23], v[32:35]
 s_waitcnt lgkmcnt(3)
 v_add_f32 v8, v8, v6
 v_cvt_pk_bf16_f32 v18, v72, v73
 v_mfma_f32_16x16x32_bf16 v[32:35], a[88:91], a[24:27], v[32:35]
 ds_read_b128 a[108:111], v2 offset:11264
 v_cvt_pk_bf16_f32 v19, v74, v75
 v_mfma_f32_16x16x32_bf16 v[32:35], a[92:95], a[28:31], v[32:35]
 buffer_load_dwordx4 v13, s[8:11], s39 offen offset:1024 sc1 lds
 v_mfma_f32_16x16x32_bf16 v[36:39], a[64:67], a[32:35], v[100:103]
 ds_read_b128 a[112:115], v2 offset:12288
 v_cvt_pk_bf16_f32 v22, v76, v77
 v_mfma_f32_16x16x32_bf16 v[36:39], a[68:71], a[36:39], v[36:39]
 v_cvt_pk_bf16_f32 v23, v78, v79
 v_cvt_pk_bf16_f32 v24, v80, v81
 v_mfma_f32_16x16x32_bf16 v[36:39], a[72:75], a[40:43], v[36:39]
 s_add_u32 s39, s39, s76
 ds_read_b128 a[116:119], v2 offset:13312
 v_cvt_pk_bf16_f32 v25, v82, v83
 v_mfma_f32_16x16x32_bf16 v[36:39], a[76:79], a[44:47], v[36:39]
 v_cvt_pk_bf16_f32 v28, v84, v85
 v_cvt_pk_bf16_f32 v29, v86, v87
 v_mfma_f32_16x16x32_bf16 v[36:39], a[80:83], a[48:51], v[36:39]
 ds_read_b128 a[120:123], v2 offset:14336
 v_cvt_pk_bf16_f32 v26, v88, v89
 v_mfma_f32_16x16x32_bf16 v[36:39], a[84:87], a[52:55], v[36:39]
 buffer_load_dwordx4 v13, s[8:11], s39 offen offset:2048 sc1 lds
 v_mfma_f32_16x16x32_bf16 v[36:39], a[88:91], a[56:59], v[36:39]
 ds_read_b128 a[124:127], v2 offset:15360
 v_cvt_pk_bf16_f32 v27, v90, v91
 v_mfma_f32_16x16x32_bf16 v[36:39], a[92:95], a[60:63], v[36:39]
 s_waitcnt lgkmcnt(6)
 v_exp_f32 v64, v32
 v_mfma_f32_16x16x32_bf16 v[40:43], a[96:99], a[0:3], v[104:107]
 s_add_u32 s39, s39, s76
 ds_read_b128 a[64:67], v2 offset:16384
 v_cvt_pk_bf16_f32 v30, v92, v93
 v_mfma_f32_16x16x32_bf16 v[40:43], a[100:103], a[4:7], v[40:43]
 s_waitcnt lgkmcnt(5)
 v_exp_f32 v65, v33
 v_mfma_f32_16x16x32_bf16 v[40:43], a[104:107], a[8:11], v[40:43]
 ds_read_b128 a[68:71], v2 offset:17408
 v_cvt_pk_bf16_f32 v31, v94, v95
 v_mfma_f32_16x16x32_bf16 v[40:43], a[108:111], a[12:15], v[40:43]
 s_waitcnt lgkmcnt(4)
 buffer_load_dwordx4 v13, s[8:11], s39 offen offset:3072 sc1 lds
 v_mfma_f32_16x16x32_bf16 v[40:43], a[112:115], a[16:19], v[40:43]
 ds_read_b128 a[72:75], v2 offset:18432
 v_add_f32 v5, v64, v65
 v_mfma_f32_16x16x32_bf16 v[40:43], a[116:119], a[20:23], v[40:43]
 s_waitcnt lgkmcnt(3)
 v_exp_f32 v66, v34
 v_mfma_f32_16x16x32_bf16 v[40:43], a[120:123], a[24:27], v[40:43]
 s_add_u32 s39, s39, s77
 ds_read_b128 a[76:79], v2 offset:19456
 v_add_f32 v5, v5, v66
 v_mfma_f32_16x16x32_bf16 v[40:43], a[124:127], a[28:31], v[40:43]
 v_exp_f32 v67, v35
 v_mfma_f32_16x16x32_bf16 v[44:47], a[96:99], a[32:35], v[108:111]
 s_bitset1_b32 m0, 12
 ds_read_b128 a[80:83], v2 offset:20480
 v_add_f32 v5, v5, v67
 v_mfma_f32_16x16x32_bf16 v[44:47], a[100:103], a[36:39], v[44:47]
 buffer_load_dwordx4 v13, s[8:11], s39 offen offset:0 sc1 lds
 v_mfma_f32_16x16x32_bf16 v[44:47], a[104:107], a[40:43], v[44:47]
 ds_read_b128 a[84:87], v2 offset:21504
 v_mfma_f32_16x16x32_bf16 v[44:47], a[108:111], a[44:47], v[44:47]
 v_exp_f32 v68, v36
 v_mfma_f32_16x16x32_bf16 v[44:47], a[112:115], a[48:51], v[44:47]
 s_add_u32 s39, s39, s76
 ds_read_b128 a[88:91], v2 offset:22528
 v_mfma_f32_16x16x32_bf16 v[44:47], a[116:119], a[52:55], v[44:47]
 v_exp_f32 v69, v37
 v_mfma_f32_16x16x32_bf16 v[44:47], a[120:123], a[56:59], v[44:47]
 ds_read_b128 a[92:95], v2 offset:23552
 v_add_f32 v6, v68, v69
 v_mfma_f32_16x16x32_bf16 v[44:47], a[124:127], a[60:63], v[44:47]
 s_waitcnt lgkmcnt(6)
 buffer_load_dwordx4 v13, s[8:11], s39 offen offset:1024 sc1 lds
 v_mfma_f32_16x16x32_bf16 v[48:51], a[64:67], a[0:3], v[112:115]
 ds_read_b128 a[96:99], v2 offset:24576
 v_mfma_f32_16x16x32_bf16 v[48:51], a[68:71], a[4:7], v[48:51]
 s_waitcnt lgkmcnt(5)
 v_exp_f32 v70, v38
 v_mfma_f32_16x16x32_bf16 v[48:51], a[72:75], a[8:11], v[48:51]
 s_add_u32 s39, s39, s76
 ds_read_b128 a[100:103], v2 offset:25600
 v_add_f32 v6, v6, v70
 v_mfma_f32_16x16x32_bf16 v[48:51], a[76:79], a[12:15], v[48:51]
 s_waitcnt lgkmcnt(4)
 v_exp_f32 v71, v39
 v_mfma_f32_16x16x32_bf16 v[48:51], a[80:83], a[16:19], v[48:51]
 ds_read_b128 a[104:107], v2 offset:26624
 v_add_f32 v6, v6, v71
 v_mfma_f32_16x16x32_bf16 v[48:51], a[84:87], a[20:23], v[48:51]
 s_waitcnt lgkmcnt(3)
 buffer_load_dwordx4 v13, s[8:11], s39 offen offset:2048 sc1 lds
 v_mfma_f32_16x16x32_bf16 v[48:51], a[88:91], a[24:27], v[48:51]
 ds_read_b128 a[108:111], v2 offset:27648
 v_mfma_f32_16x16x32_bf16 v[48:51], a[92:95], a[28:31], v[48:51]
 v_exp_f32 v72, v40
 v_mfma_f32_16x16x32_bf16 v[52:55], a[64:67], a[32:35], v[116:119]
 s_add_u32 s39, s39, s76
 ds_read_b128 a[112:115], v2 offset:28672
 v_add_f32 v5, v5, v72
 v_mfma_f32_16x16x32_bf16 v[52:55], a[68:71], a[36:39], v[52:55]
 v_exp_f32 v73, v41
 v_mfma_f32_16x16x32_bf16 v[52:55], a[72:75], a[40:43], v[52:55]
 s_xor_b32 s40, s40, 0x8000
 ds_read_b128 a[116:119], v2 offset:29696
 v_add_f32 v5, v5, v73
 v_mfma_f32_16x16x32_bf16 v[52:55], a[76:79], a[44:47], v[52:55]
 buffer_load_dwordx4 v13, s[8:11], s39 offen offset:3072 sc1 lds
 v_mfma_f32_16x16x32_bf16 v[52:55], a[80:83], a[48:51], v[52:55]
 s_add_u32 s42, s42, s70
 ds_read_b128 a[120:123], v2 offset:30720
 v_mfma_f32_16x16x32_bf16 v[52:55], a[84:87], a[52:55], v[52:55]
 v_exp_f32 v74, v42
 v_mfma_f32_16x16x32_bf16 v[52:55], a[88:91], a[56:59], v[52:55]
 s_waitcnt vmcnt(8)
 ds_read_b128 a[124:127], v2 offset:31744
 v_add_f32 v5, v5, v74
 v_mfma_f32_16x16x32_bf16 v[52:55], a[92:95], a[60:63], v[52:55]
 s_waitcnt lgkmcnt(6)
 s_barrier
 v_mfma_f32_16x16x32_bf16 v[56:59], a[96:99], a[0:3], v[120:123]
 s_mov_b32 m0, s41
 ds_read_b128 a[64:67], v3 offset:0
 v_xor_b32 v2, 0x8000, v2
 v_mfma_f32_16x16x32_bf16 v[56:59], a[100:103], a[4:7], v[56:59]
 s_waitcnt lgkmcnt(5)
 buffer_load_dwordx4 v1, s[12:15], s43 offen offset:0 sc1 lds
 v_mfma_f32_16x16x32_bf16 v[56:59], a[104:107], a[8:11], v[56:59]
 s_cmp_eq_u32 s42, s66
 ds_read_b128 a[68:71], v3 offset:16384
 v_mfma_f32_16x16x32_bf16 v[56:59], a[108:111], a[12:15], v[56:59]
 s_waitcnt lgkmcnt(4)
 v_exp_f32 v75, v43
 v_mfma_f32_16x16x32_bf16 v[56:59], a[112:115], a[16:19], v[56:59]
 s_cmov_b32 s42, s67
 ds_read_b128 a[72:75], v3 offset:1024
 v_add_f32 v5, v5, v75
 v_mfma_f32_16x16x32_bf16 v[56:59], a[116:119], a[20:23], v[56:59]
 s_waitcnt lgkmcnt(3)
 v_exp_f32 v76, v44
 v_mfma_f32_16x16x32_bf16 v[56:59], a[120:123], a[24:27], v[56:59]
 s_cmov_b32 s70, 32768
 ds_read_b128 a[76:79], v3 offset:17408
 v_add_f32 v6, v6, v76
 v_mfma_f32_16x16x32_bf16 v[56:59], a[124:127], a[28:31], v[56:59]
 buffer_load_dwordx4 v1, s[12:15], s43 offen offset:1024 sc1 lds
 v_mfma_f32_16x16x32_bf16 v[60:63], a[96:99], a[32:35], v[124:127]
 ds_read_b128 a[80:83], v3 offset:2048
 v_mfma_f32_16x16x32_bf16 v[60:63], a[100:103], a[36:39], v[60:63]
 v_exp_f32 v77, v45
 v_mfma_f32_16x16x32_bf16 v[60:63], a[104:107], a[40:43], v[60:63]
 ds_read_b128 a[84:87], v3 offset:18432
 v_add_f32 v6, v6, v77
 v_mfma_f32_16x16x32_bf16 v[60:63], a[108:111], a[44:47], v[60:63]
 v_exp_f32 v78, v46
 v_mfma_f32_16x16x32_bf16 v[60:63], a[112:115], a[48:51], v[60:63]
 ds_read_b128 a[88:91], v3 offset:3072
 v_add_f32 v6, v6, v78
 v_mfma_f32_16x16x32_bf16 v[60:63], a[116:119], a[52:55], v[60:63]
 buffer_load_dwordx4 v1, s[12:15], s43 offen offset:2048 sc1 lds
 v_mfma_f32_16x16x32_bf16 v[60:63], a[120:123], a[56:59], v[60:63]
 ds_read_b128 a[92:95], v3 offset:19456
 v_mfma_f32_16x16x32_bf16 v[60:63], a[124:127], a[60:63], v[60:63]
 s_waitcnt lgkmcnt(6)
 v_exp_f32 v79, v47
 v_mfma_f32_16x16x32_bf16 v[128:131], a[64:67], v[16:19], v[128:131]
 ds_read_b128 a[96:99], v3 offset:4096
 v_add_f32 v6, v6, v79
 v_mfma_f32_16x16x32_bf16 v[128:131], a[68:71], v[24:27], v[128:131]
 v_exp_f32 v80, v48
 v_mfma_f32_16x16x32_bf16 v[192:195], a[68:71], v[28:31], v[192:195]
 ds_read_b128 a[100:103], v3 offset:20480
 v_add_f32 v5, v5, v80
 v_mfma_f32_16x16x32_bf16 v[192:195], a[64:67], v[20:23], v[192:195]
 s_waitcnt lgkmcnt(6)
 buffer_load_dwordx4 v1, s[12:15], s43 offen offset:3072 sc1 lds
 v_mfma_f32_16x16x32_bf16 v[132:135], a[72:75], v[16:19], v[132:135]
 ds_read_b128 a[104:107], v3 offset:5120
 v_mfma_f32_16x16x32_bf16 v[132:135], a[76:79], v[24:27], v[132:135]
 v_exp_f32 v81, v49
 v_mfma_f32_16x16x32_bf16 v[196:199], a[76:79], v[28:31], v[196:199]
 ds_read_b128 a[108:111], v3 offset:21504
 v_add_f32 v5, v5, v81
 v_mfma_f32_16x16x32_bf16 v[196:199], a[72:75], v[20:23], v[196:199]
 s_waitcnt lgkmcnt(6)
 v_exp_f32 v82, v50
 v_mfma_f32_16x16x32_bf16 v[136:139], a[80:83], v[16:19], v[136:139]
 s_bitset1_b32 m0, 12
 ds_read_b128 a[112:115], v3 offset:6144
 v_add_f32 v5, v5, v82
 v_mfma_f32_16x16x32_bf16 v[136:139], a[84:87], v[24:27], v[136:139]
 buffer_load_dwordx4 v4, s[12:15], s43 offen offset:0 sc1 lds
 v_mfma_f32_16x16x32_bf16 v[200:203], a[84:87], v[28:31], v[200:203]
 ds_read_b128 a[116:119], v3 offset:22528
 v_mfma_f32_16x16x32_bf16 v[200:203], a[80:83], v[20:23], v[200:203]
 s_waitcnt lgkmcnt(6)
 v_exp_f32 v83, v51
 v_mfma_f32_16x16x32_bf16 v[140:143], a[88:91], v[16:19], v[140:143]
 ds_read_b128 a[120:123], v3 offset:7168
 v_add_f32 v5, v5, v83
 v_mfma_f32_16x16x32_bf16 v[140:143], a[92:95], v[24:27], v[140:143]
 v_exp_f32 v84, v52
 v_mfma_f32_16x16x32_bf16 v[204:207], a[92:95], v[28:31], v[204:207]
 ds_read_b128 a[124:127], v3 offset:23552
 v_add_f32 v6, v6, v84
 v_mfma_f32_16x16x32_bf16 v[204:207], a[88:91], v[20:23], v[204:207]
 s_waitcnt lgkmcnt(6)
 buffer_load_dwordx4 v4, s[12:15], s43 offen offset:1024 sc1 lds
 v_mfma_f32_16x16x32_bf16 v[144:147], a[96:99], v[16:19], v[144:147]
 ds_read_b128 a[64:67], v3 offset:8192
 v_mfma_f32_16x16x32_bf16 v[144:147], a[100:103], v[24:27], v[144:147]
 v_exp_f32 v85, v53
 v_mfma_f32_16x16x32_bf16 v[208:211], a[100:103], v[28:31], v[208:211]
 ds_read_b128 a[68:71], v3 offset:24576
 v_add_f32 v6, v6, v85
 v_mfma_f32_16x16x32_bf16 v[208:211], a[96:99], v[20:23], v[208:211]
 s_waitcnt lgkmcnt(6)
 v_exp_f32 v86, v54
 v_mfma_f32_16x16x32_bf16 v[148:151], a[104:107], v[16:19], v[148:151]
 ds_read_b128 a[72:75], v3 offset:9216
 v_add_f32 v6, v6, v86
 v_mfma_f32_16x16x32_bf16 v[148:151], a[108:111], v[24:27], v[148:151]
 buffer_load_dwordx4 v4, s[12:15], s43 offen offset:2048 sc1 lds
 v_mfma_f32_16x16x32_bf16 v[212:215], a[108:111], v[28:31], v[212:215]
 ds_read_b128 a[76:79], v3 offset:25600
 v_mfma_f32_16x16x32_bf16 v[212:215], a[104:107], v[20:23], v[212:215]
 s_waitcnt lgkmcnt(6)
 v_exp_f32 v87, v55
 v_mfma_f32_16x16x32_bf16 v[152:155], a[112:115], v[16:19], v[152:155]
 ds_read_b128 a[80:83], v3 offset:10240
 v_add_f32 v6, v6, v87
 v_mfma_f32_16x16x32_bf16 v[152:155], a[116:119], v[24:27], v[152:155]
 v_exp_f32 v88, v56
 v_mfma_f32_16x16x32_bf16 v[216:219], a[116:119], v[28:31], v[216:219]
 s_xor_b32 s41, s41, 0x8000
 ds_read_b128 a[84:87], v3 offset:26624
 v_add_f32 v5, v5, v88
 v_mfma_f32_16x16x32_bf16 v[216:219], a[112:115], v[20:23], v[216:219]
 s_waitcnt lgkmcnt(6)
 buffer_load_dwordx4 v4, s[12:15], s43 offen offset:3072 sc1 lds
 v_mfma_f32_16x16x32_bf16 v[156:159], a[120:123], v[16:19], v[156:159]
 s_add_u32 s43, s43, s71
 ds_read_b128 a[88:91], v3 offset:11264
 v_mfma_f32_16x16x32_bf16 v[156:159], a[124:127], v[24:27], v[156:159]
 v_exp_f32 v89, v57
 v_mfma_f32_16x16x32_bf16 v[220:223], a[124:127], v[28:31], v[220:223]
 s_cmp_eq_u32 s43, s68
 ds_read_b128 a[92:95], v3 offset:27648
 v_add_f32 v5, v5, v89
 v_mfma_f32_16x16x32_bf16 v[220:223], a[120:123], v[20:23], v[220:223]
 s_waitcnt lgkmcnt(6)
 v_exp_f32 v90, v58
 v_mfma_f32_16x16x32_bf16 v[160:163], a[64:67], v[16:19], v[160:163]
 s_cmov_b32 s43, s69
 ds_read_b128 a[96:99], v3 offset:12288
 v_add_f32 v5, v5, v90
 v_mfma_f32_16x16x32_bf16 v[160:163], a[68:71], v[24:27], v[160:163]
 s_cmov_b32 s71, 32768
 v_exp_f32 v91, v59
 v_mfma_f32_16x16x32_bf16 v[224:227], a[68:71], v[28:31], v[224:227]
 ds_read_b128 a[100:103], v3 offset:28672
 v_add_f32 v5, v5, v91
 v_mfma_f32_16x16x32_bf16 v[224:227], a[64:67], v[20:23], v[224:227]
 s_waitcnt lgkmcnt(6)
 v_exp_f32 v92, v60
 v_mfma_f32_16x16x32_bf16 v[164:167], a[72:75], v[16:19], v[164:167]
 ds_read_b128 a[104:107], v3 offset:13312
 v_add_f32 v6, v6, v92
 v_mfma_f32_16x16x32_bf16 v[164:167], a[76:79], v[24:27], v[164:167]
 v_exp_f32 v93, v61
 v_mfma_f32_16x16x32_bf16 v[228:231], a[76:79], v[28:31], v[228:231]
 ds_read_b128 a[108:111], v3 offset:29696
 v_add_f32 v6, v6, v93
 v_mfma_f32_16x16x32_bf16 v[228:231], a[72:75], v[20:23], v[228:231]
 s_waitcnt lgkmcnt(6)
 v_exp_f32 v94, v62
 v_mfma_f32_16x16x32_bf16 v[168:171], a[80:83], v[16:19], v[168:171]
 ds_read_b128 a[112:115], v3 offset:14336
 v_add_f32 v6, v6, v94
 v_mfma_f32_16x16x32_bf16 v[168:171], a[84:87], v[24:27], v[168:171]
 v_exp_f32 v95, v63
 v_mfma_f32_16x16x32_bf16 v[232:235], a[84:87], v[28:31], v[232:235]
 ds_read_b128 a[116:119], v3 offset:30720
 v_add_f32 v6, v6, v95
 v_mfma_f32_16x16x32_bf16 v[232:235], a[80:83], v[20:23], v[232:235]
 s_waitcnt lgkmcnt(6)
 v_add_f32 v11, v5, v6
 v_mfma_f32_16x16x32_bf16 v[172:175], a[88:91], v[16:19], v[172:175]
 ds_read_b128 a[120:123], v3 offset:15360
 v_cmp_nge_f32 vcc, s47, v11
 v_mfma_f32_16x16x32_bf16 v[172:175], a[92:95], v[24:27], v[172:175]
 buffer_load_dword a246, v15, s[12:15], s60 offen sc1
 v_mfma_f32_16x16x32_bf16 v[236:239], a[92:95], v[28:31], v[236:239]
 s_waitcnt vmcnt(9)
 ds_read_b128 a[124:127], v3 offset:31744
 v_mfma_f32_16x16x32_bf16 v[236:239], a[88:91], v[20:23], v[236:239]
 s_waitcnt lgkmcnt(6)
 s_barrier
 v_mfma_f32_16x16x32_bf16 v[176:179], a[96:99], v[16:19], v[176:179]
 ds_read_b128 a[64:67], v2 offset:0
 v_xor_b32 v3, 0x8000, v3
 v_mfma_f32_16x16x32_bf16 v[176:179], a[100:103], v[24:27], v[176:179]
 v_mfma_f32_16x16x32_bf16 v[240:243], a[100:103], v[28:31], v[240:243]
 ds_read_b128 a[68:71], v2 offset:1024
 v_mfma_f32_16x16x32_bf16 v[240:243], a[96:99], v[20:23], v[240:243]
 s_waitcnt lgkmcnt(6)
 v_mfma_f32_16x16x32_bf16 v[180:183], a[104:107], v[16:19], v[180:183]
 ds_read_b128 a[72:75], v2 offset:2048
 v_mfma_f32_16x16x32_bf16 v[180:183], a[108:111], v[24:27], v[180:183]
 v_mfma_f32_16x16x32_bf16 v[244:247], a[108:111], v[28:31], v[244:247]
 ds_read_b128 a[76:79], v2 offset:3072
 v_mfma_f32_16x16x32_bf16 v[244:247], a[104:107], v[20:23], v[244:247]
 s_waitcnt lgkmcnt(6)
 v_mfma_f32_16x16x32_bf16 v[184:187], a[112:115], v[16:19], v[184:187]
 s_sub_u32 s44, s44, 1
 ds_read_b128 a[80:83], v2 offset:4096
 v_mfma_f32_16x16x32_bf16 v[184:187], a[116:119], v[24:27], v[184:187]
 v_mfma_f32_16x16x32_bf16 v[248:251], a[116:119], v[28:31], v[248:251]
 ds_read_b128 a[84:87], v2 offset:5120
 v_mfma_f32_16x16x32_bf16 v[248:251], a[112:115], v[20:23], v[248:251]
 s_waitcnt lgkmcnt(6)
 v_mfma_f32_16x16x32_bf16 v[188:191], a[120:123], v[16:19], v[188:191]
 ds_read_b128 a[88:91], v2 offset:6144
 v_mfma_f32_16x16x32_bf16 v[188:191], a[124:127], v[24:27], v[188:191]
 v_mfma_f32_16x16x32_bf16 v[252:255], a[124:127], v[28:31], v[252:255]
 ds_read_b128 a[92:95], v2 offset:7168
 v_mfma_f32_16x16x32_bf16 v[252:255], a[120:123], v[20:23], v[252:255]
 s_waitcnt lgkmcnt(6)
 s_cbranch_vccnz L_slow
L_ret:
 s_cmp_gt_u32 s44, s45
 s_cbranch_scc1 L_loop
 s_cmp_eq_u32 s44, 0
 s_cbranch_scc1 L_segend
 s_cmp_eq_u32 s44, 1
 s_cbranch_scc1 L_d1
 s_cmp_eq_u32 s44, 2
 s_cbranch_scc1 L_d0
 s_waitcnt vmcnt(0)
 v_accvgpr_read_b32 v12, a246
 v_cmp_ne_u32 vcc, 0, v12
 s_cbranch_vccz L_poll1_ok
 v_and_b32 v11, 11, v0
 v_lshlrev_b32 v11, 2, v11
 s_mov_b32 s32, 0
L_poll1:
 buffer_load_dword v12, v11, s[12:15], s60 offen sc1
 s_waitcnt vmcnt(0)
 v_cmp_ne_u32 vcc, 0, v12
 s_cbranch_vccz L_poll1_ok
 s_sleep 8
 s_add_u32 s32, s32, 1
 s_cmp_lt_u32 s32, 0x80000
 s_cbranch_scc1 L_poll1
L_poll1_ok:
 s_mov_b32 s60, s94
 v_mov_b32 v15, 0
 s_mov_b32 s45, 2
 s_branch L_loop
L_d0:
 v_accvgpr_read_b32 v12, a246
 s_cmp_eq_u32 s54, 0
 s_cselect_b32 s57, s38, 0
 v_readfirstlane_b32 s58, v12
 s_cmp_eq_u32 s57, 0
 s_cbranch_scc1 L_d0a
 s_cmp_lg_u32 s58, 0
 s_cbranch_scc1 L_d0m
 s_mov_b32 s51, 1
 s_lshl_b32 s58, s2, 2
 s_add_u32 s55, s58, s3
 s_mul_i32 s55, s55, 17408
 s_add_u32 s55, s55, 50331648
 s_add_u32 s56, s55, 0x2000
 buffer_load_dwordx4 a[128:131], v1, s[12:15], s55 offen offset:0 sc1
 v_mov_b32 v11, 0xf149f2ca
 v_cmp_gt_i32 s[16:17], 0, v14
 v_cmp_gt_i32 s[18:19], 1, v14
 v_cmp_gt_i32 s[20:21], 2, v14
 v_cmp_gt_i32 s[22:23], 3, v14
 buffer_load_dwordx4 a[132:135], v1, s[12:15], s55 offen offset:1024 sc1
 v_cndmask_b32 v96, v9, v11, s[16:17]
 v_cndmask_b32 v97, v9, v11, s[18:19]
 v_cndmask_b32 v98, v9, v11, s[20:21]
 v_cndmask_b32 v99, v9, v11, s[22:23]
 buffer_load_dwordx4 a[136:139], v1, s[12:15], s55 offen offset:2048 sc1
 v_cmp_gt_i32 s[16:17], 16, v14
 v_cmp_gt_i32 s[18:19], 17, v14
 v_cmp_gt_i32 s[20:21], 18, v14
 v_cmp_gt_i32 s[22:23], 19, v14
 buffer_load_dwordx4 a[140:143], v1, s[12:15], s55 offen offset:3072 sc1
 v_cndmask_b32 v104, v9, v11, s[16:17]
 v_cndmask_b32 v105, v9, v11, s[18:19]
 v_cndmask_b32 v106, v9, v11, s[20:21]
 v_cndmask_b32 v107, v9, v11, s[22:23]
 buffer_load_dwordx4 a[144:147], v4, s[12:15], s55 offen offset:0 sc1
 v_cmp_gt_i32 s[16:17], 32, v14
 v_cmp_gt_i32 s[18:19], 33, v14
 v_cmp_gt_i32 s[20:21], 34, v14
 v_cmp_gt_i32 s[22:23], 35, v14
 buffer_load_dwordx4 a[148:151], v4, s[12:15], s55 offen offset:1024 sc1
 v_cndmask_b32 v112, v9, v11, s[16:17]
 v_cndmask_b32 v113, v9, v11, s[18:19]
 v_cndmask_b32 v114, v9, v11, s[20:21]
 v_cndmask_b32 v115, v9, v11, s[22:23]
 buffer_load_dwordx4 a[152:155], v4, s[12:15], s55 offen offset:2048 sc1
 v_cmp_gt_i32 s[16:17], 48, v14
 v_cmp_gt_i32 s[18:19], 49, v14
 v_cmp_gt_i32 s[20:21], 50, v14
 v_cmp_gt_i32 s[22:23], 51, v14
 buffer_load_dwordx4 a[156:159], v4, s[12:15], s55 offen offset:3072 sc1
 v_cndmask_b32 v120, v9, v11, s[16:17]
 v_cndmask_b32 v121, v9, v11, s[18:19]
 v_cndmask_b32 v122, v9, v11, s[20:21]
 v_cndmask_b32 v123, v9, v11, s[22:23]
 s_nop 0
 s_branch L_loop
L_d0m:
 v_mov_b32 v11, 0xf149f2ca
 v_cmp_gt_i32 s[16:17], 0, v14
 v_cmp_gt_i32 s[18:19], 1, v14
 v_cmp_gt_i32 s[20:21], 2, v14
 v_cmp_gt_i32 s[22:23], 3, v14
 v_cndmask_b32 v96, v9, v11, s[16:17]
 v_cndmask_b32 v97, v9, v11, s[18:19]
 v_cndmask_b32 v98, v9, v11, s[20:21]
 v_cndmask_b32 v99, v9, v11, s[22:23]
 v_cmp_gt_i32 s[16:17], 16, v14
 v_cmp_gt_i32 s[18:19], 17, v14
 v_cmp_gt_i32 s[20:21], 18, v14
 v_cmp_gt_i32 s[22:23], 19, v14
 v_cndmask_b32 v104, v9, v11, s[16:17]
 v_cndmask_b32 v105, v9, v11, s[18:19]
 v_cndmask_b32 v106, v9, v11, s[20:21]
 v_cndmask_b32 v107, v9, v11, s[22:23]
 v_cmp_gt_i32 s[16:17], 32, v14
 v_cmp_gt_i32 s[18:19], 33, v14
 v_cmp_gt_i32 s[20:21], 34, v14
 v_cmp_gt_i32 s[22:23], 35, v14
 v_cndmask_b32 v112, v9, v11, s[16:17]
 v_cndmask_b32 v113, v9, v11, s[18:19]
 v_cndmask_b32 v114, v9, v11, s[20:21]
 v_cndmask_b32 v115, v9, v11, s[22:23]
 v_cmp_gt_i32 s[16:17], 48, v14
 v_cmp_gt_i32 s[18:19], 49, v14
 v_cmp_gt_i32 s[20:21], 50, v14
 v_cmp_gt_i32 s[22:23], 51, v14
 v_cndmask_b32 v120, v9, v11, s[16:17]
 v_cndmask_b32 v121, v9, v11, s[18:19]
 v_cndmask_b32 v122, v9, v11, s[20:21]
 v_cndmask_b32 v123, v9, v11, s[22:23]
 s_nop 0
 s_branch L_loop
L_d0a:
 s_cmp_eq_u32 s38, 0
 s_cselect_b32 s55, 1, s27
 s_cmp_eq_u32 s55, 0
 s_cbranch_scc1 L_d0m
 s_waitcnt vmcnt(0)
 v_accvgpr_read_b32 v12, a246
 s_nop 0
 v_readfirstlane_b32 s58, v12
 s_and_b32 s55, s2, 127
 s_lshl_b32 s57, s55, 2
 s_add_u32 s57, s57, s3
 s_mul_i32 s55, s57, 17408
 s_add_u32 s55, s55, 67108864
 s_lshl_b32 s57, s57, 10
 s_add_u32 s57, s57, 83886080
 s_cmp_eq_u32 s38, 0
 s_cmov_b32 s58, 0
 s_cmov_b32 s55, 2.0
 s_cmov_b32 s57, 2.0
 s_cmp_lg_u32 s58, 0
 s_cbranch_scc1 L_d0m
 s_mov_b32 s51, 2
 s_add_u32 s56, s55, 0x2000
 buffer_load_dwordx4 a[192:195], v1, s[12:15], s57 offen sc1
 v_mov_b32 v11, 0xf149f2ca
 v_cmp_gt_i32 s[16:17], 0, v14
 v_cmp_gt_i32 s[18:19], 1, v14
 v_cmp_gt_i32 s[20:21], 2, v14
 buffer_load_dwordx4 a[128:131], v1, s[12:15], s55 offen offset:0 sc1
 v_cmp_gt_i32 s[22:23], 3, v14
 v_cndmask_b32 v96, v9, v11, s[16:17]
 v_cndmask_b32 v97, v9, v11, s[18:19]
 v_cndmask_b32 v98, v9, v11, s[20:21]
 buffer_load_dwordx4 a[132:135], v1, s[12:15], s55 offen offset:1024 sc1
 v_cndmask_b32 v99, v9, v11, s[22:23]
 v_cmp_gt_i32 s[16:17], 16, v14
 v_cmp_gt_i32 s[18:19], 17, v14
 buffer_load_dwordx4 a[136:139], v1, s[12:15], s55 offen offset:2048 sc1
 v_cmp_gt_i32 s[20:21], 18, v14
 v_cmp_gt_i32 s[22:23], 19, v14
 v_cndmask_b32 v104, v9, v11, s[16:17]
 v_cndmask_b32 v105, v9, v11, s[18:19]
 buffer_load_dwordx4 a[140:143], v1, s[12:15], s55 offen offset:3072 sc1
 v_cndmask_b32 v106, v9, v11, s[20:21]
 v_cndmask_b32 v107, v9, v11, s[22:23]
 v_cmp_gt_i32 s[16:17], 32, v14
 v_cmp_gt_i32 s[18:19], 33, v14
 buffer_load_dwordx4 a[144:147], v4, s[12:15], s55 offen offset:0 sc1
 v_cmp_gt_i32 s[20:21], 34, v14
 v_cmp_gt_i32 s[22:23], 35, v14
 v_cndmask_b32 v112, v9, v11, s[16:17]
 buffer_load_dwordx4 a[148:151], v4, s[12:15], s55 offen offset:1024 sc1
 v_cndmask_b32 v113, v9, v11, s[18:19]
 v_cndmask_b32 v114, v9, v11, s[20:21]
 v_cndmask_b32 v115, v9, v11, s[22:23]
 v_cmp_gt_i32 s[16:17], 48, v14
 buffer_load_dwordx4 a[152:155], v4, s[12:15], s55 offen offset:2048 sc1
 v_cmp_gt_i32 s[18:19], 49, v14
 v_cmp_gt_i32 s[20:21], 50, v14
 v_cmp_gt_i32 s[22:23], 51, v14
 v_cndmask_b32 v120, v9, v11, s[16:17]
 buffer_load_dwordx4 a[156:159], v4, s[12:15], s55 offen offset:3072 sc1
 v_cndmask_b32 v121, v9, v11, s[18:19]
 v_cndmask_b32 v122, v9, v11, s[20:21]
 v_cndmask_b32 v123, v9, v11, s[22:23]
 s_nop 0
 s_branch L_loop
L_d1:
 s_cmp_eq_u32 s51, 2
 s_cbranch_scc1 L_fa
 s_cmp_eq_u32 s38, 0
 s_cselect_b32 s55, 1, s27
 s_cmp_eq_u32 s55, 0
 s_cbranch_scc1 L_d1g
 s_waitcnt vmcnt(0)
 v_accvgpr_read_b32 v12, a246
 s_nop 0
 v_readfirstlane_b32 s58, v12
 s_and_b32 s55, s2, 127
 s_lshl_b32 s57, s55, 2
 s_add_u32 s57, s57, s3
 s_mul_i32 s55, s57, 17408
 s_add_u32 s55, s55, 67108864
 s_lshl_b32 s57, s57, 10
 s_add_u32 s57, s57, 83886080
 s_cmp_eq_u32 s38, 0
 s_cmov_b32 s58, 0
 s_cmov_b32 s55, 2.0
 s_cmov_b32 s57, 2.0
 s_cmp_lg_u32 s58, 0
 s_cbranch_scc1 L_d1g
 s_mov_b32 s51, 2
 s_add_u32 s56, s55, 0x2000
 buffer_load_dwordx4 a[192:195], v1, s[12:15], s57 offen sc1
 buffer_load_dwordx4 a[128:131], v1, s[12:15], s55 offen offset:0 sc1
 buffer_load_dwordx4 a[132:135], v1, s[12:15], s55 offen offset:1024 sc1
 buffer_load_dwordx4 a[136:139], v1, s[12:15], s55 offen offset:2048 sc1
 buffer_load_dwordx4 a[140:143], v1, s[12:15], s55 offen offset:3072 sc1
 buffer_load_dwordx4 a[144:147], v4, s[12:15], s55 offen offset:0 sc1
 buffer_load_dwordx4 a[148:151], v4, s[12:15], s55 offen offset:1024 sc1
 buffer_load_dwordx4 a[152:155], v4, s[12:15], s55 offen offset:2048 sc1
 buffer_load_dwordx4 a[156:159], v4, s[12:15], s55 offen offset:3072 sc1
 s_branch L_fa1
L_d1g:
 s_cmp_eq_u32 s54, 0
 s_cselect_b32 s57, s38, 0
 s_cmp_lg_u32 s57, 0
 s_cbranch_scc1 L_d1q
 s_cmp_eq_u32 s54, 1
 s_cbranch_scc1 L_last
 v_mov_b32 v11, 0xf149f2ca
 v_cmp_gt_i32 s[16:17], 0, v14
 v_cmp_gt_i32 s[18:19], 1, v14
 v_cmp_gt_i32 s[20:21], 2, v14
 v_cmp_gt_i32 s[22:23], 3, v14
 v_cndmask_b32 v100, v10, v11, s[16:17]
 v_cndmask_b32 v101, v10, v11, s[18:19]
 v_cndmask_b32 v102, v10, v11, s[20:21]
 v_cndmask_b32 v103, v10, v11, s[22:23]
 v_cmp_gt_i32 s[16:17], 16, v14
 v_cmp_gt_i32 s[18:19], 17, v14
 v_cmp_gt_i32 s[20:21], 18, v14
 v_cmp_gt_i32 s[22:23], 19, v14
 v_cndmask_b32 v108, v10, v11, s[16:17]
 v_cndmask_b32 v109, v10, v11, s[18:19]
 v_cndmask_b32 v110, v10, v11, s[20:21]
 v_cndmask_b32 v111, v10, v11, s[22:23]
 v_cmp_gt_i32 s[16:17], 32, v14
 v_cmp_gt_i32 s[18:19], 33, v14
 v_cmp_gt_i32 s[20:21], 34, v14
 v_cmp_gt_i32 s[22:23], 35, v14
 v_cndmask_b32 v116, v10, v11, s[16:17]
 v_cndmask_b32 v117, v10, v11, s[18:19]
 v_cndmask_b32 v118, v10, v11, s[20:21]
 v_cndmask_b32 v119, v10, v11, s[22:23]
 v_cmp_gt_i32 s[16:17], 48, v14
 v_cmp_gt_i32 s[18:19], 49, v14
 v_cmp_gt_i32 s[20:21], 50, v14
 v_cmp_gt_i32 s[22:23], 51, v14
 v_cndmask_b32 v124, v10, v11, s[16:17]
 v_cndmask_b32 v125, v10, v11, s[18:19]
 v_cndmask_b32 v126, v10, v11, s[20:21]
 v_cndmask_b32 v127, v10, v11, s[22:23]
 s_mov_b32 s16, 0xf149f2ca
 s_mov_b32 s17, s16
 v_mov_b64 v[96:97], s[16:17]
 v_mov_b64 v[98:99], s[16:17]
 v_mov_b64 v[104:105], s[16:17]
 v_mov_b64 v[106:107], s[16:17]
 v_mov_b64 v[112:113], s[16:17]
 v_mov_b64 v[114:115], s[16:17]
 v_mov_b64 v[120:121], s[16:17]
 v_mov_b64 v[122:123], s[16:17]
L_last:
 v_and_b32 v11, 31, v0
 v_lshlrev_b32 v11, 2, v11
 buffer_load_dword a247, v11, s[12:15], s61 offen sc1
 v_accvgpr_read_b32 v13, a252
 s_mov_b64 s[8:9], s[86:87]
 s_mov_b32 s10, 3670016
 s_mov_b32 s42, s78
 s_add_u32 s40, s50, 131072
 s_movk_i32 s76, 6144
 s_movk_i32 s77, 10240
 s_branch L_loop
L_d1q:
 s_mov_b32 s42, s49
 s_lshl_b32 s58, s2, 2
 s_add_u32 s55, s58, s3
 s_mul_i32 s55, s55, 17408
 s_add_u32 s55, s55, 50331648
 s_add_u32 s56, s55, 0x2000
 s_cmp_eq_u32 s51, 1
 s_cbranch_scc1 L_d1r
 s_waitcnt vmcnt(0)
 v_accvgpr_read_b32 v12, a246
 v_cmp_ne_u32 vcc, 0, v12
 s_cbranch_vccz L_poll2_ok
 v_and_b32 v11, 0, v0
 v_lshlrev_b32 v11, 2, v11
 s_mov_b32 s32, 0
L_poll2:
 buffer_load_dword v12, v11, s[12:15], s60 offen sc1
 s_waitcnt vmcnt(0)
 v_cmp_ne_u32 vcc, 0, v12
 s_cbranch_vccz L_poll2_ok
 s_sleep 8
 s_add_u32 s32, s32, 1
 s_cmp_lt_u32 s32, 0x80000
 s_cbranch_scc1 L_poll2
L_poll2_ok:
 buffer_load_dwordx4 a[128:131], v1, s[12:15], s55 offen offset:0 sc1
 buffer_load_dwordx4 a[132:135], v1, s[12:15], s55 offen offset:1024 sc1
 buffer_load_dwordx4 a[136:139], v1, s[12:15], s55 offen offset:2048 sc1
 buffer_load_dwordx4 a[140:143], v1, s[12:15], s55 offen offset:3072 sc1
 buffer_load_dwordx4 a[144:147], v4, s[12:15], s55 offen offset:0 sc1
 buffer_load_dwordx4 a[148:151], v4, s[12:15], s55 offen offset:1024 sc1
 buffer_load_dwordx4 a[152:155], v4, s[12:15], s55 offen offset:2048 sc1
 buffer_load_dwordx4 a[156:159], v4, s[12:15], s55 offen offset:3072 sc1
L_d1r:
 buffer_load_dwordx4 a[160:163], v1, s[12:15], s56 offen offset:0 sc1
 v_mov_b32 v11, 0xf149f2ca
 v_cmp_gt_i32 s[16:17], 0, v14
 v_cmp_gt_i32 s[18:19], 1, v14
 v_cmp_gt_i32 s[20:21], 2, v14
 v_cmp_gt_i32 s[22:23], 3, v14
 v_cndmask_b32 v100, v10, v11, s[16:17]
 buffer_load_dwordx4 a[164:167], v1, s[12:15], s56 offen offset:1024 sc1
 v_cndmask_b32 v101, v10, v11, s[18:19]
 v_cndmask_b32 v102, v10, v11, s[20:21]
 v_cndmask_b32 v103, v10, v11, s[22:23]
 v_cmp_gt_i32 s[16:17], 16, v14
 v_cmp_gt_i32 s[18:19], 17, v14
 buffer_load_dwordx4 a[168:171], v1, s[12:15], s56 offen offset:2048 sc1
 v_cmp_gt_i32 s[20:21], 18, v14
 v_cmp_gt_i32 s[22:23], 19, v14
 v_cndmask_b32 v108, v10, v11, s[16:17]
 v_cndmask_b32 v109, v10, v11, s[18:19]
 v_cndmask_b32 v110, v10, v11, s[20:21]
 v_cndmask_b32 v111, v10, v11, s[22:23]
 buffer_load_dwordx4 a[172:175], v1, s[12:15], s56 offen offset:3072 sc1
 v_cmp_gt_i32 s[16:17], 32, v14
 v_cmp_gt_i32 s[18:19], 33, v14
 v_cmp_gt_i32 s[20:21], 34, v14
 v_cmp_gt_i32 s[22:23], 35, v14
 v_cndmask_b32 v116, v10, v11, s[16:17]
 buffer_load_dwordx4 a[176:179], v4, s[12:15], s56 offen offset:0 sc1
 v_cndmask_b32 v117, v10, v11, s[18:19]
 v_cndmask_b32 v118, v10, v11, s[20:21]
 v_cndmask_b32 v119, v10, v11, s[22:23]
 v_cmp_gt_i32 s[16:17], 48, v14
 v_cmp_gt_i32 s[18:19], 49, v14
 buffer_load_dwordx4 a[180:183], v4, s[12:15], s56 offen offset:1024 sc1
 v_cmp_gt_i32 s[20:21], 50, v14
 v_cmp_gt_i32 s[22:23], 51, v14
 v_cndmask_b32 v124, v10, v11, s[16:17]
 v_cndmask_b32 v125, v10, v11, s[18:19]
 v_cndmask_b32 v126, v10, v11, s[20:21]
 v_cndmask_b32 v127, v10, v11, s[22:23]
 buffer_load_dwordx4 a[184:187], v4, s[12:15], s56 offen offset:2048 sc1
 s_mov_b32 s16, 0xf149f2ca
 s_mov_b32 s17, s16
 v_mov_b64 v[96:97], s[16:17]
 v_mov_b64 v[98:99], s[16:17]
 v_mov_b64 v[104:105], s[16:17]
 buffer_load_dwordx4 a[188:191], v4, s[12:15], s56 offen offset:3072 sc1
 v_mov_b64 v[106:107], s[16:17]
 v_mov_b64 v[112:113], s[16:17]
 v_mov_b64 v[114:115], s[16:17]
 v_mov_b64 v[120:121], s[16:17]
 v_mov_b64 v[122:123], s[16:17]
 s_nop 0
 s_branch L_loop
L_segend:
 s_cmp_eq_u32 s51, 2
 s_cbranch_scc1 L_fa2
 s_cmp_eq_u32 s54, 0
 s_cselect_b32 s57, s38, 0
 s_cmp_eq_u32 s57, 0
 s_cbranch_scc1 L_tail
 v_accvgpr_mov_b32 a0, a128
 v_accvgpr_mov_b32 a1, a129
 v_accvgpr_mov_b32 a2, a130
 v_accvgpr_mov_b32 a3, a131
 v_accvgpr_mov_b32 a4, a132
 v_accvgpr_mov_b32 a5, a133
 v_accvgpr_mov_b32 a6, a134
 v_accvgpr_mov_b32 a7, a135
 v_accvgpr_mov_b32 a8, a136
 v_accvgpr_mov_b32 a9, a137
 v_accvgpr_mov_b32 a10, a138
 v_accvgpr_mov_b32 a11, a139
 v_accvgpr_mov_b32 a12, a140
 v_accvgpr_mov_b32 a13, a141
 v_accvgpr_mov_b32 a14, a142
 v_accvgpr_mov_b32 a15, a143
 v_accvgpr_mov_b32 a16, a144
 v_accvgpr_mov_b32 a17, a145
 v_accvgpr_mov_b32 a18, a146
 v_accvgpr_mov_b32 a19, a147
 v_accvgpr_mov_b32 a20, a148
 v_accvgpr_mov_b32 a21, a149
 v_accvgpr_mov_b32 a22, a150
 v_accvgpr_mov_b32 a23, a151
 v_accvgpr_mov_b32 a24, a152
 v_accvgpr_mov_b32 a25, a153
 v_accvgpr_mov_b32 a26, a154
 v_accvgpr_mov_b32 a27, a155
 v_accvgpr_mov_b32 a28, a156
 v_accvgpr_mov_b32 a29, a157
 v_accvgpr_mov_b32 a30, a158
 v_accvgpr_mov_b32 a31, a159
 v_accvgpr_mov_b32 a32, a160
 v_accvgpr_mov_b32 a33, a161
 v_accvgpr_mov_b32 a34, a162
 v_accvgpr_mov_b32 a35, a163
 v_accvgpr_mov_b32 a36, a164
 v_accvgpr_mov_b32 a37, a165
 v_accvgpr_mov_b32 a38, a166
 v_accvgpr_mov_b32 a39, a167
 v_accvgpr_mov_b32 a40, a168
 v_accvgpr_mov_b32 a41, a169
 v_accvgpr_mov_b32 a42, a170
 v_accvgpr_mov_b32 a43, a171
 v_accvgpr_mov_b32 a44, a172
 v_accvgpr_mov_b32 a45, a173
 v_accvgpr_mov_b32 a46, a174
 v_accvgpr_mov_b32 a47, a175
 v_accvgpr_mov_b32 a48, a176
 v_accvgpr_mov_b32 a49, a177
 v_accvgpr_mov_b32 a50, a178
 v_accvgpr_mov_b32 a51, a179
 v_accvgpr_mov_b32 a52, a180
 v_accvgpr_mov_b32 a53, a181
 v_accvgpr_mov_b32 a54, a182
 v_accvgpr_mov_b32 a55, a183
 v_accvgpr_mov_b32 a56, a184
 v_accvgpr_mov_b32 a57, a185
 v_accvgpr_mov_b32 a58, a186
 v_accvgpr_mov_b32 a59, a187
 v_accvgpr_mov_b32 a60, a188
 v_accvgpr_mov_b32 a61, a189
 v_accvgpr_mov_b32 a62, a190
 v_accvgpr_mov_b32 a63, a191
 v_mov_b64 v[96:97], 0
 v_mov_b64 v[98:99], 0
 v_mov_b64 v[100:101], 0
 v_mov_b64 v[102:103], 0
 v_mov_b64 v[104:105], 0
 v_mov_b64 v[106:107], 0
 v_mov_b64 v[108:109], 0
 v_mov_b64 v[110:111], 0
 v_mov_b64 v[112:113], 0
 v_mov_b64 v[114:115], 0
 v_mov_b64 v[116:117], 0
 v_mov_b64 v[118:119], 0
 v_mov_b64 v[120:121], 0
 v_mov_b64 v[122:123], 0
 v_mov_b64 v[124:125], 0
 v_mov_b64 v[126:127], 0
 s_add_u32 s43, s49, 16777216
 s_mov_b32 s44, s38
 s_mov_b32 s45, 1
 s_mov_b32 s47, -1.0
 s_cmp_eq_u32 s57, 1
 s_cbranch_scc1 L_last
 s_branch L_loop
L_switched:
 v_mov_b32 v18, v7
 v_mov_b32 v19, v8
 s_nop 0
 v_permlane32_swap_b32 v7, v18
 v_permlane32_swap_b32 v8, v19
 s_nop 0
 v_add_f32 v7, v7, v18
 v_add_f32 v8, v8, v19
 s_nop 0
 v_mov_b32 v18, v7
 v_mov_b32 v19, v8
 s_nop 0
 v_permlane16_swap_b32 v7, v18
 v_permlane16_swap_b32 v8, v19
 s_nop 0
 v_add_f32 v7, v7, v18
 v_add_f32 v8, v8, v19
 s_nop 0
 v_rcp_f32 v16, v7
 v_rcp_f32 v17, v8
 s_mov_b32 s47, 0x4b800000
 s_mov_b32 s54, 1
 v_accvgpr_write_b32 a250, v16
 v_cvt_pk_bf16_f32 v128, v128, v129
 v_cvt_pk_bf16_f32 v129, v130, v131
 v_cvt_pk_bf16_f32 v130, v132, v133
 v_cvt_pk_bf16_f32 v131, v134, v135
 v_accvgpr_write_b32 a128, v128
 v_accvgpr_write_b32 a129, v129
 v_accvgpr_write_b32 a130, v130
 v_accvgpr_write_b32 a131, v131
 v_cvt_pk_bf16_f32 v136, v136, v137
 v_cvt_pk_bf16_f32 v137, v138, v139
 v_cvt_pk_bf16_f32 v138, v140, v141
 v_cvt_pk_bf16_f32 v139, v142, v143
 v_accvgpr_write_b32 a132, v136
 v_accvgpr_write_b32 a133, v137
 v_accvgpr_write_b32 a134, v138
 v_accvgpr_write_b32 a135, v139
 v_cvt_pk_bf16_f32 v144, v144, v145
 v_cvt_pk_bf16_f32 v145, v146, v147
 v_cvt_pk_bf16_f32 v146, v148, v149
 v_cvt_pk_bf16_f32 v147, v150, v151
 v_accvgpr_write_b32 a136, v144
 v_accvgpr_write_b32 a137, v145
 v_accvgpr_write_b32 a138, v146
 v_accvgpr_write_b32 a139, v147
 v_cvt_pk_bf16_f32 v152, v152, v153
 v_cvt_pk_bf16_f32 v153, v154, v155
 v_cvt_pk_bf16_f32 v154, v156, v157
 v_cvt_pk_bf16_f32 v155, v158, v159
 v_accvgpr_write_b32 a140, v152
 v_accvgpr_write_b32 a141, v153
 v_accvgpr_write_b32 a142, v154
 v_accvgpr_write_b32 a143, v155
 v_cvt_pk_bf16_f32 v160, v160, v161
 v_cvt_pk_bf16_f32 v161, v162, v163
 v_cvt_pk_bf16_f32 v162, v164, v165
 v_cvt_pk_bf16_f32 v163, v166, v167
 v_accvgpr_write_b32 a144, v160
 v_accvgpr_write_b32 a145, v161
 v_accvgpr_write_b32 a146, v162
 v_accvgpr_write_b32 a147, v163
 v_cvt_pk_bf16_f32 v168, v168, v169
 v_cvt_pk_bf16_f32 v169, v170, v171
 v_cvt_pk_bf16_f32 v170, v172, v173
 v_cvt_pk_bf16_f32 v171, v174, v175
 v_accvgpr_write_b32 a148, v168
 v_accvgpr_write_b32 a149, v169
 v_accvgpr_write_b32 a150, v170
 v_accvgpr_write_b32 a151, v171
 v_cvt_pk_bf16_f32 v176, v176, v177
 v_cvt_pk_bf16_f32 v177, v178, v179
 v_cvt_pk_bf16_f32 v178, v180, v181
 v_cvt_pk_bf16_f32 v179, v182, v183
 v_accvgpr_write_b32 a152, v176
 v_accvgpr_write_b32 a153, v177
 v_accvgpr_write_b32 a154, v178
 v_accvgpr_write_b32 a155, v179
 v_cvt_pk_bf16_f32 v184, v184, v185
 v_cvt_pk_bf16_f32 v185, v186, v187
 v_cvt_pk_bf16_f32 v186, v188, v189
 v_cvt_pk_bf16_f32 v187, v190, v191
 v_accvgpr_write_b32 a156, v184
 v_accvgpr_write_b32 a157, v185
 v_accvgpr_write_b32 a158, v186
 v_accvgpr_write_b32 a159, v187
 v_accvgpr_write_b32 a251, v17
 v_cvt_pk_bf16_f32 v192, v192, v193
 v_cvt_pk_bf16_f32 v193, v194, v195
 v_cvt_pk_bf16_f32 v194, v196, v197
 v_cvt_pk_bf16_f32 v195, v198, v199
 v_accvgpr_write_b32 a160, v192
 v_accvgpr_write_b32 a161, v193
 v_accvgpr_write_b32 a162, v194
 v_accvgpr_write_b32 a163, v195
 v_cvt_pk_bf16_f32 v200, v200, v201
 v_cvt_pk_bf16_f32 v201, v202, v203
 v_cvt_pk_bf16_f32 v202, v204, v205
 v_cvt_pk_bf16_f32 v203, v206, v207
 v_accvgpr_write_b32 a164, v200
 v_accvgpr_write_b32 a165, v201
 v_accvgpr_write_b32 a166, v202
 v_accvgpr_write_b32 a167, v203
 v_cvt_pk_bf16_f32 v208, v208, v209
 v_cvt_pk_bf16_f32 v209, v210, v211
 v_cvt_pk_bf16_f32 v210, v212, v213
 v_cvt_pk_bf16_f32 v211, v214, v215
 v_accvgpr_write_b32 a168, v208
 v_accvgpr_write_b32 a169, v209
 v_accvgpr_write_b32 a170, v210
 v_accvgpr_write_b32 a171, v211
 v_cvt_pk_bf16_f32 v216, v216, v217
 v_cvt_pk_bf16_f32 v217, v218, v219
 v_cvt_pk_bf16_f32 v218, v220, v221
 v_cvt_pk_bf16_f32 v219, v222, v223
 v_accvgpr_write_b32 a172, v216
 v_accvgpr_write_b32 a173, v217
 v_accvgpr_write_b32 a174, v218
 v_accvgpr_write_b32 a175, v219
 v_cvt_pk_bf16_f32 v224, v224, v225
 v_cvt_pk_bf16_f32 v225, v226, v227
 v_cvt_pk_bf16_f32 v226, v228, v229
 v_cvt_pk_bf16_f32 v227, v230, v231
 v_accvgpr_write_b32 a176, v224
 v_accvgpr_write_b32 a177, v225
 v_accvgpr_write_b32 a178, v226
 v_accvgpr_write_b32 a179, v227
 v_cvt_pk_bf16_f32 v232, v232, v233
 v_cvt_pk_bf16_f32 v233, v234, v235
 v_cvt_pk_bf16_f32 v234, v236, v237
 v_cvt_pk_bf16_f32 v235, v238, v239
 v_accvgpr_write_b32 a180, v232
 v_accvgpr_write_b32 a181, v233
 v_accvgpr_write_b32 a182, v234
 v_accvgpr_write_b32 a183, v235
 v_cvt_pk_bf16_f32 v240, v240, v241
 v_cvt_pk_bf16_f32 v241, v242, v243
 v_cvt_pk_bf16_f32 v242, v244, v245
 v_cvt_pk_bf16_f32 v243, v246, v247
 v_accvgpr_write_b32 a184, v240
 v_accvgpr_write_b32 a185, v241
 v_accvgpr_write_b32 a186, v242
 v_accvgpr_write_b32 a187, v243
 v_cvt_pk_bf16_f32 v248, v248, v249
 v_cvt_pk_bf16_f32 v249, v250, v251
 v_cvt_pk_bf16_f32 v250, v252, v253
 v_cvt_pk_bf16_f32 v251, v254, v255
 v_accvgpr_write_b32 a188, v248
 v_accvgpr_write_b32 a189, v249
 v_accvgpr_write_b32 a190, v250
 v_accvgpr_write_b32 a191, v251
 v_mov_b64 v[128:129], 0
 v_mov_b64 v[130:131], 0
 v_mov_b64 v[132:133], 0
 v_mov_b64 v[134:135], 0
 v_mov_b64 v[136:137], 0
 v_mov_b64 v[138:139], 0
 v_mov_b64 v[140:141], 0
 v_mov_b64 v[142:143], 0
 v_mov_b64 v[144:145], 0
 v_mov_b64 v[146:147], 0
 v_mov_b64 v[148:149], 0
 v_mov_b64 v[150:151], 0
 v_mov_b64 v[152:153], 0
 v_mov_b64 v[154:155], 0
 v_mov_b64 v[156:157], 0
 v_mov_b64 v[158:159], 0
 v_mov_b64 v[160:161], 0
 v_mov_b64 v[162:163], 0
 v_mov_b64 v[164:165], 0
 v_mov_b64 v[166:167], 0
 v_mov_b64 v[168:169], 0
 v_mov_b64 v[170:171], 0
 v_mov_b64 v[172:173], 0
 v_mov_b64 v[174:175], 0
 v_mov_b64 v[176:177], 0
 v_mov_b64 v[178:179], 0
 v_mov_b64 v[180:181], 0
 v_mov_b64 v[182:183], 0
 v_mov_b64 v[184:185], 0
 v_mov_b64 v[186:187], 0
 v_mov_b64 v[188:189], 0
 v_mov_b64 v[190:191], 0
 v_mov_b64 v[192:193], 0
 v_mov_b64 v[194:195], 0
 v_mov_b64 v[196:197], 0
 v_mov_b64 v[198:199], 0
 v_mov_b64 v[200:201], 0
 v_mov_b64 v[202:203], 0
 v_mov_b64 v[204:205], 0
 v_mov_b64 v[206:207], 0
 v_mov_b64 v[208:209], 0
 v_mov_b64 v[210:211], 0
 v_mov_b64 v[212:213], 0
 v_mov_b64 v[214:215], 0
 v_mov_b64 v[216:217], 0
 v_mov_b64 v[218:219], 0
 v_mov_b64 v[220:221], 0
 v_mov_b64 v[222:223], 0
 v_mov_b64 v[224:225], 0
 v_mov_b64 v[226:227], 0
 v_mov_b64 v[228:229], 0
 v_mov_b64 v[230:231], 0
 v_mov_b64 v[232:233], 0
 v_mov_b64 v[234:235], 0
 v_mov_b64 v[236:237], 0
 v_mov_b64 v[238:239], 0
 v_mov_b64 v[240:241], 0
 v_mov_b64 v[242:243], 0
 v_mov_b64 v[244:245], 0
 v_mov_b64 v[246:247], 0
 v_mov_b64 v[248:249], 0
 v_mov_b64 v[250:251], 0
 v_mov_b64 v[252:253], 0
 v_mov_b64 v[254:255], 0
 v_mov_b32 v7, 0
 v_mov_b32 v8, 0
 v_mov_b32 v9, 0
 v_mov_b32 v10, 0
 s_branch L_first
L_fa:
 s_waitcnt vmcnt(1)
L_fa1:
 v_mov_b32 v11, 0xf149f2ca
 v_cmp_gt_i32 s[16:17], 0, v14
 v_cmp_gt_i32 s[18:19], 1, v14
 v_cmp_gt_i32 s[20:21], 2, v14
 v_cmp_gt_i32 s[22:23], 3, v14
 v_cndmask_b32 v100, v10, v11, s[16:17]
 v_cndmask_b32 v101, v10, v11, s[18:19]
 v_cndmask_b32 v102, v10, v11, s[20:21]
 v_cndmask_b32 v103, v10, v11, s[22:23]
 s_barrier
 v_and_b32 v12, 31, v0
 v_lshlrev_b32 v12, 2, v12
 buffer_load_dword a247, v12, s[12:15], s61 offen sc1
 ds_read_b128 a[96:99], v3 offset:0
 ds_read_b128 a[100:103], v3 offset:16384
 ds_read_b128 a[104:107], v3 offset:1024
 ds_read_b128 a[108:111], v3 offset:17408
 ds_read_b128 a[112:115], v3 offset:2048
 ds_read_b128 a[116:119], v3 offset:18432
 ds_read_b128 a[120:123], v3 offset:3072
 ds_read_b128 a[124:127], v3 offset:19456
 v_cvt_pk_bf16_f32 v16, v64, v65
 v_cvt_pk_bf16_f32 v17, v66, v67
 v_cvt_pk_bf16_f32 v20, v68, v69
 v_cvt_pk_bf16_f32 v21, v70, v71
 v_cvt_pk_bf16_f32 v18, v72, v73
 v_cvt_pk_bf16_f32 v19, v74, v75
 v_cvt_pk_bf16_f32 v22, v76, v77
 v_cvt_pk_bf16_f32 v23, v78, v79
 v_cvt_pk_bf16_f32 v24, v80, v81
 v_cvt_pk_bf16_f32 v25, v82, v83
 v_cvt_pk_bf16_f32 v28, v84, v85
 v_cvt_pk_bf16_f32 v29, v86, v87
 v_cvt_pk_bf16_f32 v26, v88, v89
 v_cvt_pk_bf16_f32 v27, v90, v91
 v_cvt_pk_bf16_f32 v30, v92, v93
 v_cvt_pk_bf16_f32 v31, v94, v95
 v_add_f32 v7, v7, v5
 v_add_f32 v8, v8, v6
 v_accvgpr_read_b32 v13, a252
 s_mov_b64 s[8:9], s[86:87]
 s_mov_b32 s10, 3670016
 s_mul_i32 s58, s3, 50176
 s_sub_u32 s58, 128, s58
 s_mov_b32 s44, 0
 s_waitcnt lgkmcnt(0)
 v_mfma_f32_16x16x32_bf16 v[36:39], a[64:67], a[32:35], v[100:103]
 s_mov_b32 m0, s41
 v_mfma_f32_16x16x32_bf16 v[36:39], a[68:71], a[36:39], v[36:39]
 buffer_load_dwordx4 v1, s[12:15], s43 offen offset:0 sc1 lds
 v_mfma_f32_16x16x32_bf16 v[36:39], a[72:75], a[40:43], v[36:39]
 ds_read_b128 a[64:67], v2 offset:8192
 v_cmp_gt_i32 s[16:17], 16, v14
 v_mfma_f32_16x16x32_bf16 v[36:39], a[76:79], a[44:47], v[36:39]
 ds_read_b128 a[68:71], v2 offset:9216
 v_cmp_gt_i32 s[18:19], 17, v14
 v_mfma_f32_16x16x32_bf16 v[36:39], a[80:83], a[48:51], v[36:39]
 buffer_load_dwordx4 v1, s[12:15], s43 offen offset:1024 sc1 lds
 v_mfma_f32_16x16x32_bf16 v[36:39], a[84:87], a[52:55], v[36:39]
 ds_read_b128 a[72:75], v2 offset:10240
 v_cmp_gt_i32 s[20:21], 18, v14
 v_mfma_f32_16x16x32_bf16 v[36:39], a[88:91], a[56:59], v[36:39]
 ds_read_b128 a[76:79], v2 offset:11264
 v_cmp_gt_i32 s[22:23], 19, v14
 v_mfma_f32_16x16x32_bf16 v[36:39], a[92:95], a[60:63], v[36:39]
 v_cndmask_b32 v108, v10, v11, s[16:17]
 v_cndmask_b32 v109, v10, v11, s[18:19]
 v_mfma_f32_16x16x32_bf16 v[128:131], a[96:99], v[16:19], v[128:131]
 ds_read_b128 a[80:83], v2 offset:12288
 buffer_load_dwordx4 v1, s[12:15], s43 offen offset:2048 sc1 lds
 v_mfma_f32_16x16x32_bf16 v[128:131], a[100:103], v[24:27], v[128:131]
 ds_read_b128 a[84:87], v2 offset:13312
 v_cndmask_b32 v110, v10, v11, s[20:21]
 v_mfma_f32_16x16x32_bf16 v[192:195], a[100:103], v[28:31], v[192:195]
 v_cndmask_b32 v111, v10, v11, s[22:23]
 v_mfma_f32_16x16x32_bf16 v[192:195], a[96:99], v[20:23], v[192:195]
 ds_read_b128 a[88:91], v2 offset:14336
 v_cmp_gt_i32 s[16:17], 32, v14
 v_mfma_f32_16x16x32_bf16 v[132:135], a[104:107], v[16:19], v[132:135]
 ds_read_b128 a[92:95], v2 offset:15360
 v_exp_f32 v68, v36
 v_mfma_f32_16x16x32_bf16 v[132:135], a[108:111], v[24:27], v[132:135]
 buffer_load_dwordx4 v1, s[12:15], s43 offen offset:3072 sc1 lds
 v_mfma_f32_16x16x32_bf16 v[196:199], a[108:111], v[28:31], v[196:199]
 ds_read_b128 a[96:99], v3 offset:4096
 v_exp_f32 v69, v37
 v_mfma_f32_16x16x32_bf16 v[196:199], a[104:107], v[20:23], v[196:199]
 s_bitset1_b32 m0, 12
 ds_read_b128 a[100:103], v3 offset:20480
 v_add_f32 v6, v68, v69
 v_mfma_f32_16x16x32_bf16 v[136:139], a[112:115], v[16:19], v[136:139]
 buffer_load_dwordx4 v4, s[12:15], s43 offen offset:0 sc1 lds
 v_mfma_f32_16x16x32_bf16 v[136:139], a[116:119], v[24:27], v[136:139]
 ds_read_b128 a[104:107], v3 offset:5120
 v_exp_f32 v70, v38
 v_mfma_f32_16x16x32_bf16 v[200:203], a[116:119], v[28:31], v[200:203]
 ds_read_b128 a[108:111], v3 offset:21504
 v_add_f32 v6, v6, v70
 v_mfma_f32_16x16x32_bf16 v[200:203], a[112:115], v[20:23], v[200:203]
 buffer_load_dwordx4 v4, s[12:15], s43 offen offset:1024 sc1 lds
 v_mfma_f32_16x16x32_bf16 v[140:143], a[120:123], v[16:19], v[140:143]
 ds_read_b128 a[112:115], v3 offset:6144
 v_exp_f32 v71, v39
 v_mfma_f32_16x16x32_bf16 v[140:143], a[124:127], v[24:27], v[140:143]
 ds_read_b128 a[116:119], v3 offset:22528
 v_add_f32 v6, v6, v71
 v_mfma_f32_16x16x32_bf16 v[204:207], a[124:127], v[28:31], v[204:207]
 v_cmp_gt_i32 s[18:19], 33, v14
 v_cmp_gt_i32 s[20:21], 34, v14
 v_mfma_f32_16x16x32_bf16 v[204:207], a[120:123], v[20:23], v[204:207]
 s_waitcnt lgkmcnt(12)
 ds_read_b128 a[120:123], v3 offset:7168
 buffer_load_dwordx4 v4, s[12:15], s43 offen offset:2048 sc1 lds
 v_mfma_f32_16x16x32_bf16 v[44:47], a[64:67], a[32:35], v[108:111]
 ds_read_b128 a[124:127], v3 offset:23552
 v_cmp_gt_i32 s[22:23], 35, v14
 v_mfma_f32_16x16x32_bf16 v[44:47], a[68:71], a[36:39], v[44:47]
 s_waitcnt lgkmcnt(12)
 v_cndmask_b32 v116, v10, v11, s[16:17]
 v_cndmask_b32 v117, v10, v11, s[18:19]
 v_mfma_f32_16x16x32_bf16 v[44:47], a[72:75], a[40:43], v[44:47]
 ds_read_b128 a[64:67], v2 offset:16384
 buffer_load_dwordx4 v4, s[12:15], s43 offen offset:3072 sc1 lds
 v_mfma_f32_16x16x32_bf16 v[44:47], a[76:79], a[44:47], v[44:47]
 s_waitcnt lgkmcnt(11)
 ds_read_b128 a[68:71], v2 offset:17408
 v_cndmask_b32 v118, v10, v11, s[20:21]
 v_mfma_f32_16x16x32_bf16 v[44:47], a[80:83], a[48:51], v[44:47]
 v_cndmask_b32 v119, v10, v11, s[22:23]
 v_mfma_f32_16x16x32_bf16 v[44:47], a[84:87], a[52:55], v[44:47]
 s_waitcnt lgkmcnt(10)
 ds_read_b128 a[72:75], v2 offset:18432
 v_cmp_gt_i32 s[16:17], 48, v14
 v_mfma_f32_16x16x32_bf16 v[44:47], a[88:91], a[56:59], v[44:47]
 ds_read_b128 a[76:79], v2 offset:19456
 v_cmp_gt_i32 s[18:19], 49, v14
 v_mfma_f32_16x16x32_bf16 v[44:47], a[92:95], a[60:63], v[44:47]
 s_waitcnt lgkmcnt(10)
 buffer_load_dwordx4 a[160:163], v1, s[12:15], s56 offen offset:0 sc1
 v_mfma_f32_16x16x32_bf16 v[144:147], a[96:99], v[16:19], v[144:147]
 ds_read_b128 a[80:83], v2 offset:20480
 v_cmp_gt_i32 s[20:21], 50, v14
 v_mfma_f32_16x16x32_bf16 v[144:147], a[100:103], v[24:27], v[144:147]
 ds_read_b128 a[84:87], v2 offset:21504
 v_cmp_gt_i32 s[22:23], 51, v14
 v_mfma_f32_16x16x32_bf16 v[208:211], a[100:103], v[28:31], v[208:211]
 buffer_load_dwordx4 a[164:167], v1, s[12:15], s56 offen offset:1024 sc1
 v_mfma_f32_16x16x32_bf16 v[208:211], a[96:99], v[20:23], v[208:211]
 s_waitcnt lgkmcnt(10)
 ds_read_b128 a[88:91], v2 offset:22528
 v_cndmask_b32 v124, v10, v11, s[16:17]
 v_mfma_f32_16x16x32_bf16 v[148:151], a[104:107], v[16:19], v[148:151]
 ds_read_b128 a[92:95], v2 offset:23552
 v_cndmask_b32 v125, v10, v11, s[18:19]
 v_mfma_f32_16x16x32_bf16 v[148:151], a[108:111], v[24:27], v[148:151]
 v_exp_f32 v76, v44
 v_mfma_f32_16x16x32_bf16 v[212:215], a[108:111], v[28:31], v[212:215]
 ds_read_b128 a[96:99], v3 offset:8192
 buffer_load_dwordx4 a[168:171], v1, s[12:15], s56 offen offset:2048 sc1
 v_mfma_f32_16x16x32_bf16 v[212:215], a[104:107], v[20:23], v[212:215]
 s_waitcnt lgkmcnt(11)
 ds_read_b128 a[100:103], v3 offset:24576
 v_add_f32 v6, v6, v76
 v_mfma_f32_16x16x32_bf16 v[152:155], a[112:115], v[16:19], v[152:155]
 v_exp_f32 v77, v45
 v_mfma_f32_16x16x32_bf16 v[152:155], a[116:119], v[24:27], v[152:155]
 ds_read_b128 a[104:107], v3 offset:9216
 buffer_load_dwordx4 a[172:175], v1, s[12:15], s56 offen offset:3072 sc1
 v_mfma_f32_16x16x32_bf16 v[216:219], a[116:119], v[28:31], v[216:219]
 ds_read_b128 a[108:111], v3 offset:25600
 v_add_f32 v6, v6, v77
 v_mfma_f32_16x16x32_bf16 v[216:219], a[112:115], v[20:23], v[216:219]
 s_waitcnt lgkmcnt(12)
 v_exp_f32 v78, v46
 v_mfma_f32_16x16x32_bf16 v[156:159], a[120:123], v[16:19], v[156:159]
 ds_read_b128 a[112:115], v3 offset:10240
 v_add_f32 v6, v6, v78
 v_mfma_f32_16x16x32_bf16 v[156:159], a[124:127], v[24:27], v[156:159]
 ds_read_b128 a[116:119], v3 offset:26624
 v_exp_f32 v79, v47
 v_mfma_f32_16x16x32_bf16 v[220:223], a[124:127], v[28:31], v[220:223]
 buffer_load_dwordx4 a[176:179], v4, s[12:15], s56 offen offset:0 sc1
 v_mfma_f32_16x16x32_bf16 v[220:223], a[120:123], v[20:23], v[220:223]
 s_waitcnt lgkmcnt(12)
 ds_read_b128 a[120:123], v3 offset:11264
 v_add_f32 v6, v6, v79
 v_mfma_f32_16x16x32_bf16 v[52:55], a[64:67], a[32:35], v[116:119]
 ds_read_b128 a[124:127], v3 offset:27648
 v_cndmask_b32 v126, v10, v11, s[20:21]
 v_mfma_f32_16x16x32_bf16 v[52:55], a[68:71], a[36:39], v[52:55]
 s_waitcnt lgkmcnt(12)
 buffer_load_dwordx4 a[180:183], v4, s[12:15], s56 offen offset:1024 sc1
 v_mfma_f32_16x16x32_bf16 v[52:55], a[72:75], a[40:43], v[52:55]
 ds_read_b128 a[64:67], v2 offset:24576
 v_cndmask_b32 v127, v10, v11, s[22:23]
 v_mfma_f32_16x16x32_bf16 v[52:55], a[76:79], a[44:47], v[52:55]
 s_waitcnt lgkmcnt(11)
 ds_read_b128 a[68:71], v2 offset:25600
 v_mfma_f32_16x16x32_bf16 v[52:55], a[80:83], a[48:51], v[52:55]
 buffer_load_dwordx4 a[184:187], v4, s[12:15], s56 offen offset:2048 sc1
 v_mfma_f32_16x16x32_bf16 v[52:55], a[84:87], a[52:55], v[52:55]
 s_waitcnt lgkmcnt(10)
 ds_read_b128 a[72:75], v2 offset:26624
 v_mfma_f32_16x16x32_bf16 v[52:55], a[88:91], a[56:59], v[52:55]
 ds_read_b128 a[76:79], v2 offset:27648
 v_mfma_f32_16x16x32_bf16 v[52:55], a[92:95], a[60:63], v[52:55]
 s_waitcnt lgkmcnt(10)
 v_mfma_f32_16x16x32_bf16 v[160:163], a[96:99], v[16:19], v[160:163]
 ds_read_b128 a[80:83], v2 offset:28672
 buffer_load_dwordx4 a[188:191], v4, s[12:15], s56 offen offset:3072 sc1
 v_mfma_f32_16x16x32_bf16 v[160:163], a[100:103], v[24:27], v[160:163]
 ds_read_b128 a[84:87], v2 offset:29696
 v_mfma_f32_16x16x32_bf16 v[224:227], a[100:103], v[28:31], v[224:227]
 s_add_u32 m0, s50, 131072
 v_mfma_f32_16x16x32_bf16 v[224:227], a[96:99], v[20:23], v[224:227]
 s_waitcnt lgkmcnt(10)
 ds_read_b128 a[88:91], v2 offset:30720
 v_mfma_f32_16x16x32_bf16 v[164:167], a[104:107], v[16:19], v[164:167]
 s_add_u32 s39, s78, 0
 ds_read_b128 a[92:95], v2 offset:31744
 v_exp_f32 v84, v52
 v_mfma_f32_16x16x32_bf16 v[164:167], a[108:111], v[24:27], v[164:167]
 buffer_load_dwordx4 v13, s[8:11], s39 offen offset:0 lds
 v_mfma_f32_16x16x32_bf16 v[228:231], a[108:111], v[28:31], v[228:231]
 s_add_u32 s39, s78, 6144
 ds_read_b128 a[96:99], v3 offset:12288
 v_add_f32 v6, v6, v84
 v_mfma_f32_16x16x32_bf16 v[228:231], a[104:107], v[20:23], v[228:231]
 s_waitcnt lgkmcnt(11)
 ds_read_b128 a[100:103], v3 offset:28672
 v_exp_f32 v85, v53
 v_mfma_f32_16x16x32_bf16 v[168:171], a[112:115], v[16:19], v[168:171]
 buffer_load_dwordx4 v13, s[8:11], s39 offen offset:1024 lds
 v_mfma_f32_16x16x32_bf16 v[168:171], a[116:119], v[24:27], v[168:171]
 ds_read_b128 a[104:107], v3 offset:13312
 v_add_f32 v6, v6, v85
 v_mfma_f32_16x16x32_bf16 v[232:235], a[116:119], v[28:31], v[232:235]
 s_add_u32 s39, s78, 12288
 ds_read_b128 a[108:111], v3 offset:29696
 v_exp_f32 v86, v54
 v_mfma_f32_16x16x32_bf16 v[232:235], a[112:115], v[20:23], v[232:235]
 s_waitcnt lgkmcnt(12)
 buffer_load_dwordx4 v13, s[8:11], s39 offen offset:2048 lds
 v_mfma_f32_16x16x32_bf16 v[172:175], a[120:123], v[16:19], v[172:175]
 ds_read_b128 a[112:115], v3 offset:14336
 v_add_f32 v6, v6, v86
 v_mfma_f32_16x16x32_bf16 v[172:175], a[124:127], v[24:27], v[172:175]
 ds_read_b128 a[116:119], v3 offset:30720
 v_exp_f32 v87, v55
 v_mfma_f32_16x16x32_bf16 v[236:239], a[124:127], v[28:31], v[236:239]
 s_add_u32 s39, s78, 18432
 v_add_f32 v6, v6, v87
 v_mfma_f32_16x16x32_bf16 v[236:239], a[120:123], v[20:23], v[236:239]
 s_waitcnt lgkmcnt(12)
 ds_read_b128 a[120:123], v3 offset:15360
 buffer_load_dwordx4 v13, s[8:11], s39 offen offset:3072 lds
 v_mfma_f32_16x16x32_bf16 v[60:63], a[64:67], a[32:35], v[124:127]
 s_add_u32 m0, s50, 135168
 ds_read_b128 a[124:127], v3 offset:31744
 v_xor_b32 v3, 0x8000, v3
 v_mfma_f32_16x16x32_bf16 v[60:63], a[68:71], a[36:39], v[60:63]
 s_waitcnt lgkmcnt(12)
 v_mfma_f32_16x16x32_bf16 v[60:63], a[72:75], a[40:43], v[60:63]
 s_add_u32 s39, s78, 28672
 v_mfma_f32_16x16x32_bf16 v[60:63], a[76:79], a[44:47], v[60:63]
 s_waitcnt lgkmcnt(10)
 buffer_load_dwordx4 v13, s[8:11], s39 offen offset:0 lds
 v_mfma_f32_16x16x32_bf16 v[60:63], a[80:83], a[48:51], v[60:63]
 s_add_u32 s39, s78, 34816
 v_mfma_f32_16x16x32_bf16 v[60:63], a[84:87], a[52:55], v[60:63]
 s_waitcnt lgkmcnt(8)
 v_mfma_f32_16x16x32_bf16 v[60:63], a[88:91], a[56:59], v[60:63]
 buffer_load_dwordx4 v13, s[8:11], s39 offen offset:1024 lds
 v_mfma_f32_16x16x32_bf16 v[60:63], a[92:95], a[60:63], v[60:63]
 s_waitcnt lgkmcnt(6)
 v_mfma_f32_16x16x32_bf16 v[176:179], a[96:99], v[16:19], v[176:179]
 s_barrier
 v_mfma_f32_16x16x32_bf16 v[176:179], a[100:103], v[24:27], v[176:179]
 s_add_u32 s39, s78, 40960
 v_mfma_f32_16x16x32_bf16 v[240:243], a[100:103], v[28:31], v[240:243]
 buffer_load_dwordx4 v13, s[8:11], s39 offen offset:2048 lds
 v_mfma_f32_16x16x32_bf16 v[240:243], a[96:99], v[20:23], v[240:243]
 s_waitcnt lgkmcnt(4)
 v_mfma_f32_16x16x32_bf16 v[180:183], a[104:107], v[16:19], v[180:183]
 v_exp_f32 v92, v60
 v_mfma_f32_16x16x32_bf16 v[180:183], a[108:111], v[24:27], v[180:183]
 s_add_u32 s39, s78, 47104
 v_add_f32 v6, v6, v92
 v_mfma_f32_16x16x32_bf16 v[244:247], a[108:111], v[28:31], v[244:247]
 buffer_load_dwordx4 v13, s[8:11], s39 offen offset:3072 lds
 v_mfma_f32_16x16x32_bf16 v[244:247], a[104:107], v[20:23], v[244:247]
 s_waitcnt lgkmcnt(2)
 v_exp_f32 v93, v61
 v_mfma_f32_16x16x32_bf16 v[184:187], a[112:115], v[16:19], v[184:187]
 v_add_f32 v6, v6, v93
 v_mfma_f32_16x16x32_bf16 v[184:187], a[116:119], v[24:27], v[184:187]
 v_exp_f32 v94, v62
 v_mfma_f32_16x16x32_bf16 v[248:251], a[116:119], v[28:31], v[248:251]
 v_add_f32 v6, v6, v94
 v_mfma_f32_16x16x32_bf16 v[248:251], a[112:115], v[20:23], v[248:251]
 s_waitcnt lgkmcnt(0)
 v_exp_f32 v95, v63
 v_mfma_f32_16x16x32_bf16 v[188:191], a[120:123], v[16:19], v[188:191]
 v_add_f32 v6, v6, v95
 v_mfma_f32_16x16x32_bf16 v[188:191], a[124:127], v[24:27], v[188:191]
 v_cmp_nge_f32 vcc, s47, v6
 v_mfma_f32_16x16x32_bf16 v[252:255], a[124:127], v[28:31], v[252:255]
 s_waitcnt vmcnt(16)
 v_mfma_f32_16x16x32_bf16 v[252:255], a[120:123], v[20:23], v[252:255]
 s_cbranch_vccnz L_slow
L_fa2:
 v_accvgpr_read_b32 v32, a192
 v_accvgpr_read_b32 v33, a193
 v_accvgpr_read_b32 v34, a194
 v_accvgpr_read_b32 v35, a195
 v_add_u32 v2, s58, v13
 v_cmp_neq_f32 vcc, v34, v9
 v_cmp_neq_f32 s[20:21], v35, v10
 s_or_b64 vcc, vcc, s[20:21]
 s_cmp_eq_u32 s38, 0
 s_cselect_b64 vcc, 0, vcc
 s_cbranch_vccnz L_fagen
 v_mfma_f32_16x16x32_bf16 v[128:131], a[198:201], a[128:131], v[128:131]
 s_waitcnt vmcnt(8)
 v_cvt_pk_bf16_f32 v20, v68, v69
 v_cvt_pk_bf16_f32 v21, v70, v71
 v_mfma_f32_16x16x32_bf16 v[132:135], a[196:199], a[128:131], v[132:135]
 s_barrier
 ds_read_b128 a[64:67], v3 offset:0
 v_cvt_pk_bf16_f32 v22, v76, v77
 v_mfma_f32_16x16x32_bf16 v[136:139], a[198:201], a[132:135], v[136:139]
 s_add_u32 m0, s29, 0
 ds_read_b128 a[68:71], v3 offset:16384
 v_cvt_pk_bf16_f32 v23, v78, v79
 v_mfma_f32_16x16x32_bf16 v[140:143], a[196:199], a[132:135], v[140:143]
 buffer_load_dwordx4 v2, s[8:11], s78 offen lds
 v_mfma_f32_16x16x32_bf16 v[144:147], a[198:201], a[136:139], v[144:147]
 ds_read_b128 a[72:75], v3 offset:1024
 v_cvt_pk_bf16_f32 v28, v84, v85
 v_mfma_f32_16x16x32_bf16 v[148:151], a[196:199], a[136:139], v[148:151]
 ds_read_b128 a[76:79], v3 offset:17408
 v_cvt_pk_bf16_f32 v29, v86, v87
 v_mfma_f32_16x16x32_bf16 v[152:155], a[198:201], a[140:143], v[152:155]
 s_add_u32 m0, s29, 4096
 v_cvt_pk_bf16_f32 v30, v92, v93
 v_cvt_pk_bf16_f32 v31, v94, v95
 v_mfma_f32_16x16x32_bf16 v[156:159], a[196:199], a[140:143], v[156:159]
 ds_read_b128 a[80:83], v3 offset:2048
 buffer_load_dwordx4 v2, s[8:11], s79 offen lds
 v_mfma_f32_16x16x32_bf16 v[160:163], a[198:201], a[144:147], v[160:163]
 ds_read_b128 a[84:87], v3 offset:18432
 v_add_f32 v8, v8, v6
 v_mfma_f32_16x16x32_bf16 v[164:167], a[196:199], a[144:147], v[164:167]
 v_cvt_pk_bf16_f32 v128, v128, v129
 v_cvt_pk_bf16_f32 v129, v130, v131
 v_mfma_f32_16x16x32_bf16 v[168:171], a[198:201], a[148:151], v[168:171]
 ds_read_b128 a[88:91], v3 offset:3072
 v_mov_b32 v40, v7
 v_mfma_f32_16x16x32_bf16 v[172:175], a[196:199], a[148:151], v[172:175]
 s_add_u32 m0, s29, 8192
 ds_read_b128 a[92:95], v3 offset:19456
 v_mov_b32 v41, v8
 v_mfma_f32_16x16x32_bf16 v[176:179], a[198:201], a[152:155], v[176:179]
 buffer_load_dwordx4 v2, s[8:11], s80 offen lds
 v_mfma_f32_16x16x32_bf16 v[180:183], a[196:199], a[152:155], v[180:183]
 ds_read_b128 a[96:99], v3 offset:4096
 v_permlane32_swap_b32 v7, v40
 v_mfma_f32_16x16x32_bf16 v[184:187], a[198:201], a[156:159], v[184:187]
 s_add_u32 m0, s29, 12288
 ds_read_b128 a[100:103], v3 offset:20480
 v_permlane32_swap_b32 v8, v41
 v_mfma_f32_16x16x32_bf16 v[188:191], a[196:199], a[156:159], v[188:191]
 s_waitcnt lgkmcnt(8)
 v_cvt_pk_bf16_f32 v130, v132, v133
 v_cvt_pk_bf16_f32 v131, v134, v135
 v_mfma_f32_16x16x32_bf16 v[192:195], a[64:67], v[20:23], v[192:195]
 ds_read_b128 a[104:107], v3 offset:5120
 buffer_load_dwordx4 v2, s[8:11], s81 offen lds
 v_mfma_f32_16x16x32_bf16 v[192:195], a[68:71], v[28:31], v[192:195]
 ds_read_b128 a[108:111], v3 offset:21504
 v_add_f32 v7, v7, v40
 v_mfma_f32_16x16x32_bf16 v[192:195], a[198:201], a[160:163], v[192:195]
 s_waitcnt lgkmcnt(8)
 v_add_f32 v8, v8, v41
 v_cvt_pk_bf16_f32 v136, v136, v137
 v_mfma_f32_16x16x32_bf16 v[196:199], a[72:75], v[20:23], v[196:199]
 ds_read_b128 a[112:115], v3 offset:6144
 v_cvt_pk_bf16_f32 v137, v138, v139
 v_mfma_f32_16x16x32_bf16 v[196:199], a[76:79], v[28:31], v[196:199]
 s_add_u32 m0, s29, 16384
 ds_read_b128 a[116:119], v3 offset:22528
 v_mov_b32 v40, v7
 v_mfma_f32_16x16x32_bf16 v[196:199], a[196:199], a[160:163], v[196:199]
 s_waitcnt lgkmcnt(8)
 buffer_load_dwordx4 v2, s[8:11], s82 offen lds
 v_mfma_f32_16x16x32_bf16 v[200:203], a[80:83], v[20:23], v[200:203]
 ds_read_b128 a[120:123], v3 offset:7168
 v_mov_b32 v41, v8
 v_mfma_f32_16x16x32_bf16 v[200:203], a[84:87], v[28:31], v[200:203]
 s_add_u32 m0, s29, 20480
 ds_read_b128 a[124:127], v3 offset:23552
 v_cvt_pk_bf16_f32 v138, v140, v141
 v_mfma_f32_16x16x32_bf16 v[200:203], a[198:201], a[164:167], v[200:203]
 s_waitcnt lgkmcnt(8)
 v_permlane16_swap_b32 v7, v40
 v_permlane16_swap_b32 v8, v41
 v_mfma_f32_16x16x32_bf16 v[204:207], a[88:91], v[20:23], v[204:207]
 ds_read_b128 a[64:67], v3 offset:8192
 buffer_load_dwordx4 v2, s[8:11], s83 offen lds
 v_mfma_f32_16x16x32_bf16 v[204:207], a[92:95], v[28:31], v[204:207]
 ds_read_b128 a[68:71], v3 offset:24576
 v_add_f32 v7, v7, v40
 v_mfma_f32_16x16x32_bf16 v[204:207], a[196:199], a[164:167], v[204:207]
 s_waitcnt lgkmcnt(8)
 v_add_f32 v8, v8, v41
 v_cvt_pk_bf16_f32 v139, v142, v143
 v_mfma_f32_16x16x32_bf16 v[208:211], a[96:99], v[20:23], v[208:211]
 ds_read_b128 a[72:75], v3 offset:9216
 v_cvt_pk_bf16_f32 v144, v144, v145
 v_mfma_f32_16x16x32_bf16 v[208:211], a[100:103], v[28:31], v[208:211]
 s_add_u32 m0, s29, 24576
 ds_read_b128 a[76:79], v3 offset:25600
 v_add_f32 v7, v7, v32
 v_mfma_f32_16x16x32_bf16 v[208:211], a[198:201], a[168:171], v[208:211]
 s_waitcnt lgkmcnt(8)
 buffer_load_dwordx4 v2, s[8:11], s84 offen lds
 v_mfma_f32_16x16x32_bf16 v[212:215], a[104:107], v[20:23], v[212:215]
 ds_read_b128 a[80:83], v3 offset:10240
 v_add_f32 v8, v8, v33
 v_mfma_f32_16x16x32_bf16 v[212:215], a[108:111], v[28:31], v[212:215]
 s_add_u32 m0, s29, 28672
 ds_read_b128 a[84:87], v3 offset:26624
 v_cvt_pk_bf16_f32 v145, v146, v147
 v_mfma_f32_16x16x32_bf16 v[212:215], a[196:199], a[168:171], v[212:215]
 s_waitcnt lgkmcnt(8)
 v_cvt_pk_bf16_f32 v146, v148, v149
 v_cvt_pk_bf16_f32 v147, v150, v151
 v_mfma_f32_16x16x32_bf16 v[216:219], a[112:115], v[20:23], v[216:219]
 ds_read_b128 a[88:91], v3 offset:11264
 buffer_load_dwordx4 v2, s[8:11], s85 offen lds
 v_mfma_f32_16x16x32_bf16 v[216:219], a[116:119], v[28:31], v[216:219]
 ds_read_b128 a[92:95], v3 offset:27648
 v_add_u32 v2, 128, v2
 v_mfma_f32_16x16x32_bf16 v[216:219], a[198:201], a[172:175], v[216:219]
 s_waitcnt lgkmcnt(8)
 v_cvt_pk_bf16_f32 v152, v152, v153
 v_cvt_pk_bf16_f32 v153, v154, v155
 v_mfma_f32_16x16x32_bf16 v[220:223], a[120:123], v[20:23], v[220:223]
 ds_read_b128 a[96:99], v3 offset:12288
 v_cvt_pk_bf16_f32 v154, v156, v157
 v_mfma_f32_16x16x32_bf16 v[220:223], a[124:127], v[28:31], v[220:223]
 ds_read_b128 a[100:103], v3 offset:28672
 v_cvt_pk_bf16_f32 v155, v158, v159
 v_mfma_f32_16x16x32_bf16 v[220:223], a[196:199], a[172:175], v[220:223]
 s_waitcnt lgkmcnt(8)
 v_cvt_pk_bf16_f32 v160, v160, v161
 v_cvt_pk_bf16_f32 v161, v162, v163
 v_mfma_f32_16x16x32_bf16 v[224:227], a[64:67], v[20:23], v[224:227]
 ds_read_b128 a[104:107], v3 offset:13312
 v_cvt_pk_bf16_f32 v162, v164, v165
 v_mfma_f32_16x16x32_bf16 v[224:227], a[68:71], v[28:31], v[224:227]
 ds_read_b128 a[108:111], v3 offset:29696
 v_cvt_pk_bf16_f32 v163, v166, v167
 v_mfma_f32_16x16x32_bf16 v[224:227], a[198:201], a[176:179], v[224:227]
 s_waitcnt lgkmcnt(8)
 v_cvt_pk_bf16_f32 v168, v168, v169
 v_cvt_pk_bf16_f32 v169, v170, v171
 v_mfma_f32_16x16x32_bf16 v[228:231], a[72:75], v[20:23], v[228:231]
 ds_read_b128 a[112:115], v3 offset:14336
 v_cvt_pk_bf16_f32 v170, v172, v173
 v_mfma_f32_16x16x32_bf16 v[228:231], a[76:79], v[28:31], v[228:231]
 ds_read_b128 a[116:119], v3 offset:30720
 v_cvt_pk_bf16_f32 v171, v174, v175
 v_mfma_f32_16x16x32_bf16 v[228:231], a[196:199], a[176:179], v[228:231]
 s_waitcnt lgkmcnt(8)
 v_cvt_pk_bf16_f32 v176, v176, v177
 v_cvt_pk_bf16_f32 v177, v178, v179
 v_mfma_f32_16x16x32_bf16 v[232:235], a[80:83], v[20:23], v[232:235]
 ds_read_b128 a[120:123], v3 offset:15360
 v_cvt_pk_bf16_f32 v178, v180, v181
 v_mfma_f32_16x16x32_bf16 v[232:235], a[84:87], v[28:31], v[232:235]
 ds_read_b128 a[124:127], v3 offset:31744
 v_cvt_pk_bf16_f32 v179, v182, v183
 v_mfma_f32_16x16x32_bf16 v[232:235], a[198:201], a[180:183], v[232:235]
 s_waitcnt lgkmcnt(8)
 v_cvt_pk_bf16_f32 v184, v184, v185
 v_cvt_pk_bf16_f32 v185, v186, v187
 v_mfma_f32_16x16x32_bf16 v[236:239], a[88:91], v[20:23], v[236:239]
 v_cvt_pk_bf16_f32 v186, v188, v189
 v_cvt_pk_bf16_f32 v187, v190, v191
 v_mfma_f32_16x16x32_bf16 v[236:239], a[92:95], v[28:31], v[236:239]
 v_cvt_pk_bf16_f32 v192, v192, v193
 v_cvt_pk_bf16_f32 v193, v194, v195
 v_mfma_f32_16x16x32_bf16 v[236:239], a[196:199], a[180:183], v[236:239]
 s_waitcnt lgkmcnt(6)
 v_cvt_pk_bf16_f32 v194, v196, v197
 v_cvt_pk_bf16_f32 v195, v198, v199
 v_mfma_f32_16x16x32_bf16 v[240:243], a[96:99], v[20:23], v[240:243]
 v_cvt_pk_bf16_f32 v200, v200, v201
 v_cvt_pk_bf16_f32 v201, v202, v203
 v_mfma_f32_16x16x32_bf16 v[240:243], a[100:103], v[28:31], v[240:243]
 v_cvt_pk_bf16_f32 v202, v204, v205
 v_cvt_pk_bf16_f32 v203, v206, v207
 v_mfma_f32_16x16x32_bf16 v[240:243], a[198:201], a[184:187], v[240:243]
 s_waitcnt lgkmcnt(4)
 v_cvt_pk_bf16_f32 v208, v208, v209
 v_cvt_pk_bf16_f32 v209, v210, v211
 v_mfma_f32_16x16x32_bf16 v[244:247], a[104:107], v[20:23], v[244:247]
 v_cvt_pk_bf16_f32 v210, v212, v213
 v_cvt_pk_bf16_f32 v211, v214, v215
 v_mfma_f32_16x16x32_bf16 v[244:247], a[108:111], v[28:31], v[244:247]
 v_cvt_pk_bf16_f32 v216, v216, v217
 v_cvt_pk_bf16_f32 v217, v218, v219
 v_mfma_f32_16x16x32_bf16 v[244:247], a[196:199], a[184:187], v[244:247]
 s_waitcnt lgkmcnt(2)
 v_cvt_pk_bf16_f32 v218, v220, v221
 v_cvt_pk_bf16_f32 v219, v222, v223
 v_mfma_f32_16x16x32_bf16 v[248:251], a[112:115], v[20:23], v[248:251]
 v_cvt_pk_bf16_f32 v224, v224, v225
 v_cvt_pk_bf16_f32 v225, v226, v227
 v_mfma_f32_16x16x32_bf16 v[248:251], a[116:119], v[28:31], v[248:251]
 v_cvt_pk_bf16_f32 v226, v228, v229
 v_cvt_pk_bf16_f32 v227, v230, v231
 v_mfma_f32_16x16x32_bf16 v[248:251], a[198:201], a[188:191], v[248:251]
 s_waitcnt lgkmcnt(0)
 v_cvt_pk_bf16_f32 v232, v232, v233
 v_cvt_pk_bf16_f32 v233, v234, v235
 v_mfma_f32_16x16x32_bf16 v[252:255], a[120:123], v[20:23], v[252:255]
 v_cvt_pk_bf16_f32 v234, v236, v237
 v_cvt_pk_bf16_f32 v235, v238, v239
 v_mfma_f32_16x16x32_bf16 v[252:255], a[124:127], v[28:31], v[252:255]
 v_cvt_pk_bf16_f32 v240, v240, v241
 v_cvt_pk_bf16_f32 v241, v242, v243
 v_mfma_f32_16x16x32_bf16 v[252:255], a[196:199], a[188:191], v[252:255]
 v_cvt_pk_bf16_f32 v242, v244, v245
 v_cvt_pk_bf16_f32 v243, v246, v247
 s_nop 1
 v_rcp_f32 v64, v7
 v_rcp_f32 v65, v8
 v_cvt_pk_bf16_f32 v248, v248, v249
 v_cvt_pk_bf16_f32 v249, v250, v251
 v_cvt_pk_bf16_f32 v250, v252, v253
 v_cvt_pk_bf16_f32 v251, v254, v255
 s_waitcnt vmcnt(0)
 s_cmp_lg_u32 s27, 0
 s_cbranch_scc1 L_attdone
 s_mov_b32 s59, 2.0
 s_cmp_eq_u32 s62, 0
 s_cbranch_scc1 L_t1park
 v_accvgpr_read_b32 v12, a247
 v_cmp_ne_u32 vcc, 0, v12
 s_cbranch_vccz L_poll3_ok
 v_and_b32 v11, 31, v0
 v_lshlrev_b32 v11, 2, v11
 s_mov_b32 s32, 0
L_poll3:
 buffer_load_dword v12, v11, s[12:15], s61 offen sc1
 s_waitcnt vmcnt(0)
 v_cmp_ne_u32 vcc, 0, v12
 s_cbranch_vccz L_poll3_ok
 s_sleep 8
 s_add_u32 s32, s32, 1
 s_cmp_lt_u32 s32, 0x80000
 s_cbranch_scc1 L_poll3
L_poll3_ok:
 s_branch L_t1park
L_fagen:
 v_mov_b32 v5, 0
 v_mov_b32 v64, 0
 v_mov_b32 v65, 0
 v_mov_b32 v66, 0
 v_mov_b32 v67, 0
 v_mov_b32 v72, 0
 v_mov_b32 v73, 0
 v_mov_b32 v74, 0
 v_mov_b32 v75, 0
 v_mov_b32 v80, 0
 v_mov_b32 v81, 0
 v_mov_b32 v82, 0
 v_mov_b32 v83, 0
 v_mov_b32 v88, 0
 v_mov_b32 v89, 0
 v_mov_b32 v90, 0
 v_mov_b32 v91, 0
L_tail:
 s_and_b32 s55, s2, 127
 s_lshl_b32 s57, s55, 2
 s_add_u32 s57, s57, s3
 s_mul_i32 s55, s57, 17408
 s_add_u32 s55, s55, 67108864
 s_lshl_b32 s57, s57, 10
 s_add_u32 s57, s57, 83886080
 s_mul_i32 s58, s3, 50176
 s_sub_u32 s58, 128, s58
 v_add_u32 v2, s58, v13
 v_cvt_pk_bf16_f32 v16, v64, v65
 v_cvt_pk_bf16_f32 v17, v66, v67
 v_cvt_pk_bf16_f32 v20, v68, v69
 v_cvt_pk_bf16_f32 v21, v70, v71
 v_cvt_pk_bf16_f32 v18, v72, v73
 v_cvt_pk_bf16_f32 v19, v74, v75
 v_cvt_pk_bf16_f32 v22, v76, v77
 v_cvt_pk_bf16_f32 v23, v78, v79
 v_cvt_pk_bf16_f32 v24, v80, v81
 v_cvt_pk_bf16_f32 v25, v82, v83
 v_cvt_pk_bf16_f32 v28, v84, v85
 v_cvt_pk_bf16_f32 v29, v86, v87
 v_cvt_pk_bf16_f32 v26, v88, v89
 v_cvt_pk_bf16_f32 v27, v90, v91
 v_cvt_pk_bf16_f32 v30, v92, v93
 v_cvt_pk_bf16_f32 v31, v94, v95
 v_add_f32 v7, v7, v5
 v_add_f32 v8, v8, v6
 s_waitcnt vmcnt(0) lgkmcnt(0)
 s_barrier
 ds_read_b128 a[64:67], v3 offset:0
 ds_read_b128 a[68:71], v3 offset:16384
 ds_read_b128 a[72:75], v3 offset:1024
 ds_read_b128 a[76:79], v3 offset:17408
 ds_read_b128 a[80:83], v3 offset:2048
 ds_read_b128 a[84:87], v3 offset:18432
 ds_read_b128 a[88:91], v3 offset:3072
 ds_read_b128 a[92:95], v3 offset:19456
 s_cmp_lg_u32 s38, 0
 s_cselect_b32 s58, s54, 0
 s_cmp_eq_u32 s58, 2
 s_cbranch_scc1 L_tail2
 s_cmp_eq_u32 s62, 0
 s_cbranch_scc1 L_nou
 v_accvgpr_read_b32 v12, a247
 v_cmp_ne_u32 vcc, 0, v12
 s_cbranch_vccz L_poll4_ok
 v_and_b32 v11, 31, v0
 v_lshlrev_b32 v11, 2, v11
 s_mov_b32 s32, 0
L_poll4:
 buffer_load_dword v12, v11, s[12:15], s61 offen sc1
 s_waitcnt vmcnt(0)
 v_cmp_ne_u32 vcc, 0, v12
 s_cbranch_vccz L_poll4_ok
 s_sleep 8
 s_add_u32 s32, s32, 1
 s_cmp_lt_u32 s32, 0x80000
 s_cbranch_scc1 L_poll4
L_poll4_ok:
L_nou:
 s_cmp_eq_u32 s54, 1
 s_cselect_b32 s55, s55, 2.0
 s_cselect_b32 s57, s57, 2.0
 s_cselect_b32 s59, s94, 2.0
 s_add_u32 s56, s55, 0x2000
 s_waitcnt lgkmcnt(0)
 v_mfma_f32_16x16x32_bf16 v[128:131], a[64:67], v[16:19], v[128:131]
 s_add_u32 m0, s29, 0
 ds_read_b128 a[96:99], v3 offset:4096
 v_mov_b32 v72, v7
 v_mfma_f32_16x16x32_bf16 v[128:131], a[68:71], v[24:27], v[128:131]
 buffer_load_dwordx4 v2, s[8:11], s78 offen lds
 v_mfma_f32_16x16x32_bf16 v[192:195], a[68:71], v[28:31], v[192:195]
 ds_read_b128 a[100:103], v3 offset:20480
 v_mov_b32 v73, v8
 v_mfma_f32_16x16x32_bf16 v[192:195], a[64:67], v[20:23], v[192:195]
 v_permlane32_swap_b32 v7, v72
 v_permlane32_swap_b32 v8, v73
 v_mfma_f32_16x16x32_bf16 v[132:135], a[72:75], v[16:19], v[132:135]
 s_add_u32 m0, s29, 4096
 ds_read_b128 a[104:107], v3 offset:5120
 v_mfma_f32_16x16x32_bf16 v[132:135], a[76:79], v[24:27], v[132:135]
 buffer_load_dwordx4 v2, s[8:11], s79 offen lds
 v_mfma_f32_16x16x32_bf16 v[196:199], a[76:79], v[28:31], v[196:199]
 ds_read_b128 a[108:111], v3 offset:21504
 v_add_f32 v7, v7, v72
 v_mfma_f32_16x16x32_bf16 v[196:199], a[72:75], v[20:23], v[196:199]
 v_add_f32 v8, v8, v73
 v_mfma_f32_16x16x32_bf16 v[136:139], a[80:83], v[16:19], v[136:139]
 s_add_u32 m0, s29, 8192
 ds_read_b128 a[112:115], v3 offset:6144
 v_mov_b32 v72, v7
 v_mfma_f32_16x16x32_bf16 v[136:139], a[84:87], v[24:27], v[136:139]
 buffer_load_dwordx4 v2, s[8:11], s80 offen lds
 v_mfma_f32_16x16x32_bf16 v[200:203], a[84:87], v[28:31], v[200:203]
 s_add_u32 m0, s29, 12288
 ds_read_b128 a[116:119], v3 offset:22528
 v_mov_b32 v73, v8
 v_mfma_f32_16x16x32_bf16 v[200:203], a[80:83], v[20:23], v[200:203]
 buffer_load_dwordx4 v2, s[8:11], s81 offen lds
 v_mfma_f32_16x16x32_bf16 v[140:143], a[88:91], v[16:19], v[140:143]
 s_add_u32 m0, s29, 16384
 ds_read_b128 a[120:123], v3 offset:7168
 v_mfma_f32_16x16x32_bf16 v[140:143], a[92:95], v[24:27], v[140:143]
 buffer_load_dwordx4 v2, s[8:11], s82 offen lds
 v_mfma_f32_16x16x32_bf16 v[204:207], a[92:95], v[28:31], v[204:207]
 ds_read_b128 a[124:127], v3 offset:23552
 v_permlane16_swap_b32 v7, v72
 v_mfma_f32_16x16x32_bf16 v[204:207], a[88:91], v[20:23], v[204:207]
 s_waitcnt lgkmcnt(6)
 v_permlane16_swap_b32 v8, v73
 v_cvt_pk_bf16_f32 v128, v128, v129
 v_mfma_f32_16x16x32_bf16 v[144:147], a[96:99], v[16:19], v[144:147]
 s_add_u32 m0, s29, 20480
 ds_read_b128 a[64:67], v3 offset:8192
 v_cvt_pk_bf16_f32 v129, v130, v131
 v_mfma_f32_16x16x32_bf16 v[144:147], a[100:103], v[24:27], v[144:147]
 buffer_load_dwordx4 v2, s[8:11], s83 offen lds
 v_mfma_f32_16x16x32_bf16 v[208:211], a[100:103], v[28:31], v[208:211]
 s_add_u32 m0, s29, 24576
 ds_read_b128 a[68:71], v3 offset:24576
 v_add_f32 v7, v7, v72
 v_mfma_f32_16x16x32_bf16 v[208:211], a[96:99], v[20:23], v[208:211]
 s_waitcnt lgkmcnt(6)
 buffer_load_dwordx4 v2, s[8:11], s84 offen lds
 v_mfma_f32_16x16x32_bf16 v[148:151], a[104:107], v[16:19], v[148:151]
 s_add_u32 m0, s29, 28672
 ds_read_b128 a[72:75], v3 offset:9216
 v_add_f32 v8, v8, v73
 v_mfma_f32_16x16x32_bf16 v[148:151], a[108:111], v[24:27], v[148:151]
 buffer_load_dwordx4 v2, s[8:11], s85 offen lds
 v_mfma_f32_16x16x32_bf16 v[212:215], a[108:111], v[28:31], v[212:215]
 ds_read_b128 a[76:79], v3 offset:25600
 v_add_u32 v2, 128, v2
 v_mfma_f32_16x16x32_bf16 v[212:215], a[104:107], v[20:23], v[212:215]
 s_waitcnt lgkmcnt(6)
 v_cvt_pk_bf16_f32 v130, v132, v133
 v_cvt_pk_bf16_f32 v131, v134, v135
 v_mfma_f32_16x16x32_bf16 v[152:155], a[112:115], v[16:19], v[152:155]
 ds_read_b128 a[80:83], v3 offset:10240
 v_cvt_pk_bf16_f32 v192, v192, v193
 v_mfma_f32_16x16x32_bf16 v[152:155], a[116:119], v[24:27], v[152:155]
 buffer_store_dwordx4 v[128:131], v1, s[12:15], s55 offen offset:0 sc1
 v_mfma_f32_16x16x32_bf16 v[216:219], a[116:119], v[28:31], v[216:219]
 ds_read_b128 a[84:87], v3 offset:26624
 v_cvt_pk_bf16_f32 v193, v194, v195
 v_mfma_f32_16x16x32_bf16 v[216:219], a[112:115], v[20:23], v[216:219]
 s_waitcnt lgkmcnt(6)
 v_cvt_pk_bf16_f32 v194, v196, v197
 v_cvt_pk_bf16_f32 v195, v198, v199
 v_mfma_f32_16x16x32_bf16 v[156:159], a[120:123], v[16:19], v[156:159]
 ds_read_b128 a[88:91], v3 offset:11264
 v_cvt_pk_bf16_f32 v136, v136, v137
 v_mfma_f32_16x16x32_bf16 v[156:159], a[124:127], v[24:27], v[156:159]
 buffer_store_dwordx4 v[192:195], v1, s[12:15], s56 offen offset:0 sc1
 v_mfma_f32_16x16x32_bf16 v[220:223], a[124:127], v[28:31], v[220:223]
 ds_read_b128 a[92:95], v3 offset:27648
 v_cvt_pk_bf16_f32 v137, v138, v139
 v_mfma_f32_16x16x32_bf16 v[220:223], a[120:123], v[20:23], v[220:223]
 s_waitcnt lgkmcnt(6)
 v_cvt_pk_bf16_f32 v138, v140, v141
 v_cvt_pk_bf16_f32 v139, v142, v143
 v_mfma_f32_16x16x32_bf16 v[160:163], a[64:67], v[16:19], v[160:163]
 ds_read_b128 a[96:99], v3 offset:12288
 v_cvt_pk_bf16_f32 v200, v200, v201
 v_mfma_f32_16x16x32_bf16 v[160:163], a[68:71], v[24:27], v[160:163]
 buffer_store_dwordx4 v[136:139], v1, s[12:15], s55 offen offset:1024 sc1
 v_mfma_f32_16x16x32_bf16 v[224:227], a[68:71], v[28:31], v[224:227]
 ds_read_b128 a[100:103], v3 offset:28672
 v_cvt_pk_bf16_f32 v201, v202, v203
 v_mfma_f32_16x16x32_bf16 v[224:227], a[64:67], v[20:23], v[224:227]
 s_waitcnt lgkmcnt(6)
 v_cvt_pk_bf16_f32 v202, v204, v205
 v_cvt_pk_bf16_f32 v203, v206, v207
 v_mfma_f32_16x16x32_bf16 v[164:167], a[72:75], v[16:19], v[164:167]
 ds_read_b128 a[104:107], v3 offset:13312
 v_cvt_pk_bf16_f32 v144, v144, v145
 v_mfma_f32_16x16x32_bf16 v[164:167], a[76:79], v[24:27], v[164:167]
 buffer_store_dwordx4 v[200:203], v1, s[12:15], s56 offen offset:1024 sc1
 v_mfma_f32_16x16x32_bf16 v[228:231], a[76:79], v[28:31], v[228:231]
 ds_read_b128 a[108:111], v3 offset:29696
 v_cvt_pk_bf16_f32 v145, v146, v147
 v_mfma_f32_16x16x32_bf16 v[228:231], a[72:75], v[20:23], v[228:231]
 s_waitcnt lgkmcnt(6)
 v_cvt_pk_bf16_f32 v146, v148, v149
 v_cvt_pk_bf16_f32 v147, v150, v151
 v_mfma_f32_16x16x32_bf16 v[168:171], a[80:83], v[16:19], v[168:171]
 ds_read_b128 a[112:115], v3 offset:14336
 v_cvt_pk_bf16_f32 v208, v208, v209
 v_mfma_f32_16x16x32_bf16 v[168:171], a[84:87], v[24:27], v[168:171]
 buffer_store_dwordx4 v[144:147], v1, s[12:15], s55 offen offset:2048 sc1
 v_mfma_f32_16x16x32_bf16 v[232:235], a[84:87], v[28:31], v[232:235]
 ds_read_b128 a[116:119], v3 offset:30720
 v_cvt_pk_bf16_f32 v209, v210, v211
 v_mfma_f32_16x16x32_bf16 v[232:235], a[80:83], v[20:23], v[232:235]
 s_waitcnt lgkmcnt(6)
 v_cvt_pk_bf16_f32 v210, v212, v213
 v_cvt_pk_bf16_f32 v211, v214, v215
 v_mfma_f32_16x16x32_bf16 v[172:175], a[88:91], v[16:19], v[172:175]
 ds_read_b128 a[120:123], v3 offset:15360
 v_cvt_pk_bf16_f32 v152, v152, v153
 v_mfma_f32_16x16x32_bf16 v[172:175], a[92:95], v[24:27], v[172:175]
 buffer_store_dwordx4 v[208:211], v1, s[12:15], s56 offen offset:2048 sc1
 v_mfma_f32_16x16x32_bf16 v[236:239], a[92:95], v[28:31], v[236:239]
 ds_read_b128 a[124:127], v3 offset:31744
 v_cvt_pk_bf16_f32 v153, v154, v155
 v_mfma_f32_16x16x32_bf16 v[236:239], a[88:91], v[20:23], v[236:239]
 s_waitcnt lgkmcnt(6)
 v_cvt_pk_bf16_f32 v154, v156, v157
 v_cvt_pk_bf16_f32 v155, v158, v159
 v_mfma_f32_16x16x32_bf16 v[176:179], a[96:99], v[16:19], v[176:179]
 v_cvt_pk_bf16_f32 v216, v216, v217
 v_cvt_pk_bf16_f32 v217, v218, v219
 v_mfma_f32_16x16x32_bf16 v[176:179], a[100:103], v[24:27], v[176:179]
 buffer_store_dwordx4 v[152:155], v1, s[12:15], s55 offen offset:3072 sc1
 v_mfma_f32_16x16x32_bf16 v[240:243], a[100:103], v[28:31], v[240:243]
 v_cvt_pk_bf16_f32 v218, v220, v221
 v_cvt_pk_bf16_f32 v219, v222, v223
 v_mfma_f32_16x16x32_bf16 v[240:243], a[96:99], v[20:23], v[240:243]
 s_waitcnt lgkmcnt(4)
 v_cvt_pk_bf16_f32 v160, v160, v161
 v_cvt_pk_bf16_f32 v161, v162, v163
 v_mfma_f32_16x16x32_bf16 v[180:183], a[104:107], v[16:19], v[180:183]
 v_cvt_pk_bf16_f32 v162, v164, v165
 v_cvt_pk_bf16_f32 v163, v166, v167
 v_mfma_f32_16x16x32_bf16 v[180:183], a[108:111], v[24:27], v[180:183]
 buffer_store_dwordx4 v[216:219], v1, s[12:15], s56 offen offset:3072 sc1
 v_mfma_f32_16x16x32_bf16 v[244:247], a[108:111], v[28:31], v[244:247]
 v_cvt_pk_bf16_f32 v224, v224, v225
 v_cvt_pk_bf16_f32 v225, v226, v227
 v_mfma_f32_16x16x32_bf16 v[244:247], a[104:107], v[20:23], v[244:247]
 s_waitcnt lgkmcnt(2)
 v_cvt_pk_bf16_f32 v226, v228, v229
 v_cvt_pk_bf16_f32 v227, v230, v231
 v_mfma_f32_16x16x32_bf16 v[184:187], a[112:115], v[16:19], v[184:187]
 v_cvt_pk_bf16_f32 v168, v168, v169
 v_cvt_pk_bf16_f32 v169, v170, v171
 v_mfma_f32_16x16x32_bf16 v[184:187], a[116:119], v[24:27], v[184:187]
 buffer_store_dwordx4 v[160:163], v4, s[12:15], s55 offen offset:0 sc1
 v_mfma_f32_16x16x32_bf16 v[248:251], a[116:119], v[28:31], v[248:251]
 v_cvt_pk_bf16_f32 v170, v172, v173
 v_cvt_pk_bf16_f32 v171, v174, v175
 v_mfma_f32_16x16x32_bf16 v[248:251], a[112:115], v[20:23], v[248:251]
 s_waitcnt lgkmcnt(0)
 v_cvt_pk_bf16_f32 v232, v232, v233
 v_cvt_pk_bf16_f32 v233, v234, v235
 v_mfma_f32_16x16x32_bf16 v[188:191], a[120:123], v[16:19], v[188:191]
 v_cvt_pk_bf16_f32 v234, v236, v237
 v_cvt_pk_bf16_f32 v235, v238, v239
 v_mfma_f32_16x16x32_bf16 v[188:191], a[124:127], v[24:27], v[188:191]
 buffer_store_dwordx4 v[224:227], v4, s[12:15], s56 offen offset:0 sc1
 v_mfma_f32_16x16x32_bf16 v[252:255], a[124:127], v[28:31], v[252:255]
 v_mfma_f32_16x16x32_bf16 v[252:255], a[120:123], v[20:23], v[252:255]
 v_mov_b32 v68, v7
 v_mov_b32 v69, v8
 v_mov_b32 v70, v9
 v_mov_b32 v71, v10
 v_rcp_f32 v64, v7
 v_rcp_f32 v65, v8
 v_cvt_pk_bf16_f32 v176, v176, v177
 v_cvt_pk_bf16_f32 v177, v178, v179
 v_cvt_pk_bf16_f32 v178, v180, v181
 v_cvt_pk_bf16_f32 v179, v182, v183
 v_cvt_pk_bf16_f32 v240, v240, v241
 v_cvt_pk_bf16_f32 v241, v242, v243
 v_cvt_pk_bf16_f32 v242, v244, v245
 v_cvt_pk_bf16_f32 v243, v246, v247
 v_cvt_pk_bf16_f32 v184, v184, v185
 v_cvt_pk_bf16_f32 v185, v186, v187
 v_cvt_pk_bf16_f32 v186, v188, v189
 v_cvt_pk_bf16_f32 v187, v190, v191
 v_cvt_pk_bf16_f32 v248, v248, v249
 v_cvt_pk_bf16_f32 v249, v250, v251
 v_cvt_pk_bf16_f32 v250, v252, v253
 v_cvt_pk_bf16_f32 v251, v254, v255
 s_waitcnt vmcnt(10)
 s_cmp_lg_u32 s27, 0
 s_cbranch_scc1 L_attdone
 v_mov_b32 v3, v4
 s_cmp_eq_u32 s54, 1
 s_cbranch_scc0 L_t1park
 v_accvgpr_read_b32 v64, a250
 v_accvgpr_read_b32 v65, a251
 s_branch L_opB
L_t1park:
 v_accvgpr_write_b32 a128, v128
 v_accvgpr_write_b32 a129, v129
 v_accvgpr_write_b32 a130, v130
 v_accvgpr_write_b32 a131, v131
 v_accvgpr_write_b32 a160, v192
 v_accvgpr_write_b32 a161, v193
 v_accvgpr_write_b32 a162, v194
 v_accvgpr_write_b32 a163, v195
 v_accvgpr_write_b32 a132, v136
 v_accvgpr_write_b32 a133, v137
 v_accvgpr_write_b32 a134, v138
 v_accvgpr_write_b32 a135, v139
 v_accvgpr_write_b32 a164, v200
 v_accvgpr_write_b32 a165, v201
 v_accvgpr_write_b32 a166, v202
 v_accvgpr_write_b32 a167, v203
 v_accvgpr_write_b32 a136, v144
 v_accvgpr_write_b32 a137, v145
 v_accvgpr_write_b32 a138, v146
 v_accvgpr_write_b32 a139, v147
 v_accvgpr_write_b32 a168, v208
 v_accvgpr_write_b32 a169, v209
 v_accvgpr_write_b32 a170, v210
 v_accvgpr_write_b32 a171, v211
 v_accvgpr_write_b32 a140, v152
 v_accvgpr_write_b32 a141, v153
 v_accvgpr_write_b32 a142, v154
 v_accvgpr_write_b32 a143, v155
 v_accvgpr_write_b32 a172, v216
 v_accvgpr_write_b32 a173, v217
 v_accvgpr_write_b32 a174, v218
 v_accvgpr_write_b32 a175, v219
 v_accvgpr_write_b32 a144, v160
 v_accvgpr_write_b32 a145, v161
 v_accvgpr_write_b32 a146, v162
 v_accvgpr_write_b32 a147, v163
 v_accvgpr_write_b32 a176, v224
 v_accvgpr_write_b32 a177, v225
 v_accvgpr_write_b32 a178, v226
 v_accvgpr_write_b32 a179, v227
 v_accvgpr_write_b32 a148, v168
 v_accvgpr_write_b32 a149, v169
 v_accvgpr_write_b32 a150, v170
 v_accvgpr_write_b32 a151, v171
 v_accvgpr_write_b32 a180, v232
 v_accvgpr_write_b32 a181, v233
 v_accvgpr_write_b32 a182, v234
 v_accvgpr_write_b32 a183, v235
 v_accvgpr_write_b32 a152, v176
 v_accvgpr_write_b32 a153, v177
 v_accvgpr_write_b32 a154, v178
 v_accvgpr_write_b32 a155, v179
 v_accvgpr_write_b32 a184, v240
 v_accvgpr_write_b32 a185, v241
 v_accvgpr_write_b32 a186, v242
 v_accvgpr_write_b32 a187, v243
 v_accvgpr_write_b32 a156, v184
 v_accvgpr_write_b32 a157, v185
 v_accvgpr_write_b32 a158, v186
 v_accvgpr_write_b32 a159, v187
 v_accvgpr_write_b32 a188, v248
 v_accvgpr_write_b32 a189, v249
 v_accvgpr_write_b32 a190, v250
 v_accvgpr_write_b32 a191, v251
 s_branch L_opB
L_tail2:
 v_accvgpr_read_b32 v11, a246
 s_mov_b32 s52, s55
 s_mov_b32 s53, s57
 v_readfirstlane_b32 s58, v11
 s_mov_b32 s59, 2.0
 s_nop 1
 s_cmp_eq_u32 s58, 0
 s_cselect_b32 s55, s55, 2.0
 s_cselect_b32 s57, s57, 2.0
 s_add_u32 s56, s55, 0x2000
 buffer_load_dwordx4 v[68:71], v1, s[12:15], s57 offen sc1
 s_waitcnt lgkmcnt(0)
 v_mfma_f32_16x16x32_bf16 v[128:131], a[64:67], v[16:19], v[128:131]
 ds_read_b128 a[96:99], v3 offset:4096
 v_mfma_f32_16x16x32_bf16 v[128:131], a[68:71], v[24:27], v[128:131]
 buffer_load_dwordx4 v[32:35], v1, s[12:15], s55 offen offset:0 sc1
 v_mfma_f32_16x16x32_bf16 v[192:195], a[68:71], v[28:31], v[192:195]
 ds_read_b128 a[100:103], v3 offset:20480
 v_mfma_f32_16x16x32_bf16 v[192:195], a[64:67], v[20:23], v[192:195]
 v_mov_b32 v72, v7
 v_mov_b32 v73, v8
 v_mfma_f32_16x16x32_bf16 v[132:135], a[72:75], v[16:19], v[132:135]
 ds_read_b128 a[104:107], v3 offset:5120
 v_mfma_f32_16x16x32_bf16 v[132:135], a[76:79], v[24:27], v[132:135]
 buffer_load_dwordx4 v[96:99], v1, s[12:15], s56 offen offset:0 sc1
 v_mfma_f32_16x16x32_bf16 v[196:199], a[76:79], v[28:31], v[196:199]
 ds_read_b128 a[108:111], v3 offset:21504
 v_mfma_f32_16x16x32_bf16 v[196:199], a[72:75], v[20:23], v[196:199]
 v_permlane32_swap_b32 v7, v72
 v_permlane32_swap_b32 v8, v73
 v_mfma_f32_16x16x32_bf16 v[136:139], a[80:83], v[16:19], v[136:139]
 ds_read_b128 a[112:115], v3 offset:6144
 v_mfma_f32_16x16x32_bf16 v[136:139], a[84:87], v[24:27], v[136:139]
 buffer_load_dwordx4 v[36:39], v1, s[12:15], s55 offen offset:1024 sc1
 v_mfma_f32_16x16x32_bf16 v[200:203], a[84:87], v[28:31], v[200:203]
 ds_read_b128 a[116:119], v3 offset:22528
 v_mfma_f32_16x16x32_bf16 v[200:203], a[80:83], v[20:23], v[200:203]
 v_add_f32 v7, v7, v72
 v_add_f32 v8, v8, v73
 v_mfma_f32_16x16x32_bf16 v[140:143], a[88:91], v[16:19], v[140:143]
 ds_read_b128 a[120:123], v3 offset:7168
 v_mfma_f32_16x16x32_bf16 v[140:143], a[92:95], v[24:27], v[140:143]
 buffer_load_dwordx4 v[100:103], v1, s[12:15], s56 offen offset:1024 sc1
 v_mfma_f32_16x16x32_bf16 v[204:207], a[92:95], v[28:31], v[204:207]
 ds_read_b128 a[124:127], v3 offset:23552
 v_mfma_f32_16x16x32_bf16 v[204:207], a[88:91], v[20:23], v[204:207]
 s_waitcnt lgkmcnt(6)
 v_mov_b32 v72, v7
 v_mov_b32 v73, v8
 v_mfma_f32_16x16x32_bf16 v[144:147], a[96:99], v[16:19], v[144:147]
 ds_read_b128 a[64:67], v3 offset:8192
 v_mfma_f32_16x16x32_bf16 v[144:147], a[100:103], v[24:27], v[144:147]
 buffer_load_dwordx4 v[40:43], v1, s[12:15], s55 offen offset:2048 sc1
 v_mfma_f32_16x16x32_bf16 v[208:211], a[100:103], v[28:31], v[208:211]
 ds_read_b128 a[68:71], v3 offset:24576
 v_mfma_f32_16x16x32_bf16 v[208:211], a[96:99], v[20:23], v[208:211]
 s_waitcnt lgkmcnt(6)
 v_permlane16_swap_b32 v7, v72
 v_permlane16_swap_b32 v8, v73
 v_mfma_f32_16x16x32_bf16 v[148:151], a[104:107], v[16:19], v[148:151]
 ds_read_b128 a[72:75], v3 offset:9216
 v_mfma_f32_16x16x32_bf16 v[148:151], a[108:111], v[24:27], v[148:151]
 buffer_load_dwordx4 v[104:107], v1, s[12:15], s56 offen offset:2048 sc1
 v_mfma_f32_16x16x32_bf16 v[212:215], a[108:111], v[28:31], v[212:215]
 ds_read_b128 a[76:79], v3 offset:25600
 v_mfma_f32_16x16x32_bf16 v[212:215], a[104:107], v[20:23], v[212:215]
 s_waitcnt lgkmcnt(6)
 v_add_f32 v7, v7, v72
 v_add_f32 v8, v8, v73
 v_mfma_f32_16x16x32_bf16 v[152:155], a[112:115], v[16:19], v[152:155]
 ds_read_b128 a[80:83], v3 offset:10240
 v_mfma_f32_16x16x32_bf16 v[152:155], a[116:119], v[24:27], v[152:155]
 buffer_load_dwordx4 v[44:47], v1, s[12:15], s55 offen offset:3072 sc1
 v_mfma_f32_16x16x32_bf16 v[216:219], a[116:119], v[28:31], v[216:219]
 ds_read_b128 a[84:87], v3 offset:26624
 v_mfma_f32_16x16x32_bf16 v[216:219], a[112:115], v[20:23], v[216:219]
 s_waitcnt lgkmcnt(6)
 v_mfma_f32_16x16x32_bf16 v[156:159], a[120:123], v[16:19], v[156:159]
 ds_read_b128 a[88:91], v3 offset:11264
 v_mfma_f32_16x16x32_bf16 v[156:159], a[124:127], v[24:27], v[156:159]
 buffer_load_dwordx4 v[108:111], v1, s[12:15], s56 offen offset:3072 sc1
 v_mfma_f32_16x16x32_bf16 v[220:223], a[124:127], v[28:31], v[220:223]
 ds_read_b128 a[92:95], v3 offset:27648
 v_mfma_f32_16x16x32_bf16 v[220:223], a[120:123], v[20:23], v[220:223]
 s_waitcnt lgkmcnt(6)
 v_mfma_f32_16x16x32_bf16 v[160:163], a[64:67], v[16:19], v[160:163]
 ds_read_b128 a[96:99], v3 offset:12288
 v_mfma_f32_16x16x32_bf16 v[160:163], a[68:71], v[24:27], v[160:163]
 buffer_load_dwordx4 v[48:51], v4, s[12:15], s55 offen offset:0 sc1
 v_mfma_f32_16x16x32_bf16 v[224:227], a[68:71], v[28:31], v[224:227]
 ds_read_b128 a[100:103], v3 offset:28672
 v_mfma_f32_16x16x32_bf16 v[224:227], a[64:67], v[20:23], v[224:227]
 s_waitcnt lgkmcnt(6)
 v_mfma_f32_16x16x32_bf16 v[164:167], a[72:75], v[16:19], v[164:167]
 ds_read_b128 a[104:107], v3 offset:13312
 v_mfma_f32_16x16x32_bf16 v[164:167], a[76:79], v[24:27], v[164:167]
 buffer_load_dwordx4 v[112:115], v4, s[12:15], s56 offen offset:0 sc1
 v_mfma_f32_16x16x32_bf16 v[228:231], a[76:79], v[28:31], v[228:231]
 ds_read_b128 a[108:111], v3 offset:29696
 v_mfma_f32_16x16x32_bf16 v[228:231], a[72:75], v[20:23], v[228:231]
 s_waitcnt lgkmcnt(6)
 v_mfma_f32_16x16x32_bf16 v[168:171], a[80:83], v[16:19], v[168:171]
 ds_read_b128 a[112:115], v3 offset:14336
 v_mfma_f32_16x16x32_bf16 v[168:171], a[84:87], v[24:27], v[168:171]
 buffer_load_dwordx4 v[52:55], v4, s[12:15], s55 offen offset:1024 sc1
 v_mfma_f32_16x16x32_bf16 v[232:235], a[84:87], v[28:31], v[232:235]
 ds_read_b128 a[116:119], v3 offset:30720
 v_mfma_f32_16x16x32_bf16 v[232:235], a[80:83], v[20:23], v[232:235]
 s_waitcnt lgkmcnt(6)
 v_mfma_f32_16x16x32_bf16 v[172:175], a[88:91], v[16:19], v[172:175]
 ds_read_b128 a[120:123], v3 offset:15360
 v_mfma_f32_16x16x32_bf16 v[172:175], a[92:95], v[24:27], v[172:175]
 buffer_load_dwordx4 v[116:119], v4, s[12:15], s56 offen offset:1024 sc1
 v_mfma_f32_16x16x32_bf16 v[236:239], a[92:95], v[28:31], v[236:239]
 ds_read_b128 a[124:127], v3 offset:31744
 v_mfma_f32_16x16x32_bf16 v[236:239], a[88:91], v[20:23], v[236:239]
 s_waitcnt lgkmcnt(6)
 v_mfma_f32_16x16x32_bf16 v[176:179], a[96:99], v[16:19], v[176:179]
 v_mfma_f32_16x16x32_bf16 v[176:179], a[100:103], v[24:27], v[176:179]
 buffer_load_dwordx4 v[56:59], v4, s[12:15], s55 offen offset:2048 sc1
 v_mfma_f32_16x16x32_bf16 v[240:243], a[100:103], v[28:31], v[240:243]
 v_mfma_f32_16x16x32_bf16 v[240:243], a[96:99], v[20:23], v[240:243]
 s_waitcnt lgkmcnt(4)
 v_mfma_f32_16x16x32_bf16 v[180:183], a[104:107], v[16:19], v[180:183]
 v_mfma_f32_16x16x32_bf16 v[180:183], a[108:111], v[24:27], v[180:183]
 buffer_load_dwordx4 v[120:123], v4, s[12:15], s56 offen offset:2048 sc1
 v_mfma_f32_16x16x32_bf16 v[244:247], a[108:111], v[28:31], v[244:247]
 v_mfma_f32_16x16x32_bf16 v[244:247], a[104:107], v[20:23], v[244:247]
 s_waitcnt lgkmcnt(2)
 v_mfma_f32_16x16x32_bf16 v[184:187], a[112:115], v[16:19], v[184:187]
 v_mfma_f32_16x16x32_bf16 v[184:187], a[116:119], v[24:27], v[184:187]
 buffer_load_dwordx4 v[60:63], v4, s[12:15], s55 offen offset:3072 sc1
 v_mfma_f32_16x16x32_bf16 v[248:251], a[116:119], v[28:31], v[248:251]
 v_mfma_f32_16x16x32_bf16 v[248:251], a[112:115], v[20:23], v[248:251]
 s_waitcnt lgkmcnt(0)
 v_mfma_f32_16x16x32_bf16 v[188:191], a[120:123], v[16:19], v[188:191]
 v_mfma_f32_16x16x32_bf16 v[188:191], a[124:127], v[24:27], v[188:191]
 v_mfma_f32_16x16x32_bf16 v[252:255], a[124:127], v[28:31], v[252:255]
 v_mfma_f32_16x16x32_bf16 v[252:255], a[120:123], v[20:23], v[252:255]
 buffer_load_dwordx4 v[124:127], v4, s[12:15], s56 offen offset:3072 sc1
 s_cmp_eq_u32 s58, 0
 s_cbranch_scc1 L_merge2
 v_and_b32 v11, 0, v0
 v_lshlrev_b32 v11, 2, v11
 s_mov_b32 s32, 0
L_poll5:
 buffer_load_dword v12, v11, s[12:15], s94 offen sc1
 s_waitcnt vmcnt(0)
 v_cmp_ne_u32 vcc, 0, v12
 s_cbranch_vccz L_poll5_ok
 s_sleep 8
 s_add_u32 s32, s32, 1
 s_cmp_lt_u32 s32, 0x80000
 s_cbranch_scc1 L_poll5
L_poll5_ok:
 s_mov_b32 s55, s52
 s_mov_b32 s57, s53
 s_add_u32 s56, s55, 0x2000
 buffer_load_dwordx4 v[68:71], v1, s[12:15], s57 offen sc1
 buffer_load_dwordx4 v[32:35], v1, s[12:15], s55 offen offset:0 sc1
 buffer_load_dwordx4 v[96:99], v1, s[12:15], s56 offen offset:0 sc1
 buffer_load_dwordx4 v[36:39], v1, s[12:15], s55 offen offset:1024 sc1
 buffer_load_dwordx4 v[100:103], v1, s[12:15], s56 offen offset:1024 sc1
 buffer_load_dwordx4 v[40:43], v1, s[12:15], s55 offen offset:2048 sc1
 buffer_load_dwordx4 v[104:107], v1, s[12:15], s56 offen offset:2048 sc1
 buffer_load_dwordx4 v[44:47], v1, s[12:15], s55 offen offset:3072 sc1
 buffer_load_dwordx4 v[108:111], v1, s[12:15], s56 offen offset:3072 sc1
 buffer_load_dwordx4 v[48:51], v4, s[12:15], s55 offen offset:0 sc1
 buffer_load_dwordx4 v[112:115], v4, s[12:15], s56 offen offset:0 sc1
 buffer_load_dwordx4 v[52:55], v4, s[12:15], s55 offen offset:1024 sc1
 buffer_load_dwordx4 v[116:119], v4, s[12:15], s56 offen offset:1024 sc1
 buffer_load_dwordx4 v[56:59], v4, s[12:15], s55 offen offset:2048 sc1
 buffer_load_dwordx4 v[120:123], v4, s[12:15], s56 offen offset:2048 sc1
 buffer_load_dwordx4 v[60:63], v4, s[12:15], s55 offen offset:3072 sc1
 buffer_load_dwordx4 v[124:127], v4, s[12:15], s56 offen offset:3072 sc1
L_merge2:
 s_waitcnt vmcnt(14)
 v_cmp_neq_f32 vcc, v70, v9
 v_cmp_neq_f32 s[20:21], v71, v10
 s_or_b64 vcc, vcc, s[20:21]
 s_cbranch_vccnz L_mslow
 v_mfma_f32_16x16x32_bf16 v[128:131], a[198:201], v[32:35], v[128:131]
 s_add_u32 m0, s29, 0
 v_add_f32 v7, v7, v68
 v_add_f32 v8, v8, v69
 v_mfma_f32_16x16x32_bf16 v[132:135], a[196:199], v[32:35], v[132:135]
 buffer_load_dwordx4 v2, s[8:11], s78 offen lds
 v_mfma_f32_16x16x32_bf16 v[192:195], a[198:201], v[96:99], v[192:195]
 v_rcp_f32 v64, v7
 v_mfma_f32_16x16x32_bf16 v[196:199], a[196:199], v[96:99], v[196:199]
 s_waitcnt vmcnt(13)
 v_rcp_f32 v65, v8
 v_mfma_f32_16x16x32_bf16 v[136:139], a[198:201], v[36:39], v[136:139]
 s_add_u32 m0, s29, 4096
 v_mfma_f32_16x16x32_bf16 v[140:143], a[196:199], v[36:39], v[140:143]
 buffer_load_dwordx4 v2, s[8:11], s79 offen lds
 v_mfma_f32_16x16x32_bf16 v[200:203], a[198:201], v[100:103], v[200:203]
 v_cvt_pk_bf16_f32 v128, v128, v129
 v_cvt_pk_bf16_f32 v129, v130, v131
 v_mfma_f32_16x16x32_bf16 v[204:207], a[196:199], v[100:103], v[204:207]
 s_waitcnt vmcnt(12)
 v_cvt_pk_bf16_f32 v130, v132, v133
 v_cvt_pk_bf16_f32 v131, v134, v135
 v_mfma_f32_16x16x32_bf16 v[144:147], a[198:201], v[40:43], v[144:147]
 s_add_u32 m0, s29, 8192
 v_cvt_pk_bf16_f32 v192, v192, v193
 v_cvt_pk_bf16_f32 v193, v194, v195
 v_mfma_f32_16x16x32_bf16 v[148:151], a[196:199], v[40:43], v[148:151]
 buffer_load_dwordx4 v2, s[8:11], s80 offen lds
 v_mfma_f32_16x16x32_bf16 v[208:211], a[198:201], v[104:107], v[208:211]
 v_cvt_pk_bf16_f32 v194, v196, v197
 v_cvt_pk_bf16_f32 v195, v198, v199
 v_mfma_f32_16x16x32_bf16 v[212:215], a[196:199], v[104:107], v[212:215]
 s_waitcnt vmcnt(11)
 v_cvt_pk_bf16_f32 v136, v136, v137
 v_cvt_pk_bf16_f32 v137, v138, v139
 v_mfma_f32_16x16x32_bf16 v[152:155], a[198:201], v[44:47], v[152:155]
 s_add_u32 m0, s29, 12288
 v_cvt_pk_bf16_f32 v138, v140, v141
 v_cvt_pk_bf16_f32 v139, v142, v143
 v_mfma_f32_16x16x32_bf16 v[156:159], a[196:199], v[44:47], v[156:159]
 buffer_load_dwordx4 v2, s[8:11], s81 offen lds
 v_mfma_f32_16x16x32_bf16 v[216:219], a[198:201], v[108:111], v[216:219]
 v_cvt_pk_bf16_f32 v200, v200, v201
 v_cvt_pk_bf16_f32 v201, v202, v203
 v_mfma_f32_16x16x32_bf16 v[220:223], a[196:199], v[108:111], v[220:223]
 s_waitcnt vmcnt(10)
 v_cvt_pk_bf16_f32 v202, v204, v205
 v_cvt_pk_bf16_f32 v203, v206, v207
 v_mfma_f32_16x16x32_bf16 v[160:163], a[198:201], v[48:51], v[160:163]
 s_add_u32 m0, s29, 16384
 v_cvt_pk_bf16_f32 v144, v144, v145
 v_cvt_pk_bf16_f32 v145, v146, v147
 v_mfma_f32_16x16x32_bf16 v[164:167], a[196:199], v[48:51], v[164:167]
 buffer_load_dwordx4 v2, s[8:11], s82 offen lds
 v_mfma_f32_16x16x32_bf16 v[224:227], a[198:201], v[112:115], v[224:227]
 v_cvt_pk_bf16_f32 v146, v148, v149
 v_cvt_pk_bf16_f32 v147, v150, v151
 v_mfma_f32_16x16x32_bf16 v[228:231], a[196:199], v[112:115], v[228:231]
 s_waitcnt vmcnt(9)
 v_cvt_pk_bf16_f32 v208, v208, v209
 v_cvt_pk_bf16_f32 v209, v210, v211
 v_mfma_f32_16x16x32_bf16 v[168:171], a[198:201], v[52:55], v[168:171]
 s_add_u32 m0, s29, 20480
 v_cvt_pk_bf16_f32 v210, v212, v213
 v_cvt_pk_bf16_f32 v211, v214, v215
 v_mfma_f32_16x16x32_bf16 v[172:175], a[196:199], v[52:55], v[172:175]
 buffer_load_dwordx4 v2, s[8:11], s83 offen lds
 v_mfma_f32_16x16x32_bf16 v[232:235], a[198:201], v[116:119], v[232:235]
 v_cvt_pk_bf16_f32 v152, v152, v153
 v_cvt_pk_bf16_f32 v153, v154, v155
 v_mfma_f32_16x16x32_bf16 v[236:239], a[196:199], v[116:119], v[236:239]
 s_waitcnt vmcnt(8)
 v_cvt_pk_bf16_f32 v154, v156, v157
 v_cvt_pk_bf16_f32 v155, v158, v159
 v_mfma_f32_16x16x32_bf16 v[176:179], a[198:201], v[56:59], v[176:179]
 s_add_u32 m0, s29, 24576
 v_cvt_pk_bf16_f32 v216, v216, v217
 v_cvt_pk_bf16_f32 v217, v218, v219
 v_mfma_f32_16x16x32_bf16 v[180:183], a[196:199], v[56:59], v[180:183]
 buffer_load_dwordx4 v2, s[8:11], s84 offen lds
 v_mfma_f32_16x16x32_bf16 v[240:243], a[198:201], v[120:123], v[240:243]
 v_cvt_pk_bf16_f32 v218, v220, v221
 v_cvt_pk_bf16_f32 v219, v222, v223
 v_mfma_f32_16x16x32_bf16 v[244:247], a[196:199], v[120:123], v[244:247]
 s_waitcnt vmcnt(7)
 v_cvt_pk_bf16_f32 v160, v160, v161
 v_cvt_pk_bf16_f32 v161, v162, v163
 v_mfma_f32_16x16x32_bf16 v[184:187], a[198:201], v[60:63], v[184:187]
 s_add_u32 m0, s29, 28672
 v_cvt_pk_bf16_f32 v162, v164, v165
 v_cvt_pk_bf16_f32 v163, v166, v167
 v_mfma_f32_16x16x32_bf16 v[188:191], a[196:199], v[60:63], v[188:191]
 buffer_load_dwordx4 v2, s[8:11], s85 offen lds
 v_mfma_f32_16x16x32_bf16 v[248:251], a[198:201], v[124:127], v[248:251]
 v_cvt_pk_bf16_f32 v224, v224, v225
 v_cvt_pk_bf16_f32 v225, v226, v227
 v_mfma_f32_16x16x32_bf16 v[252:255], a[196:199], v[124:127], v[252:255]
 v_cvt_pk_bf16_f32 v226, v228, v229
 v_cvt_pk_bf16_f32 v227, v230, v231
 v_add_u32 v2, 128, v2
 v_cvt_pk_bf16_f32 v168, v168, v169
 v_cvt_pk_bf16_f32 v169, v170, v171
 v_cvt_pk_bf16_f32 v170, v172, v173
 v_cvt_pk_bf16_f32 v171, v174, v175
 v_cvt_pk_bf16_f32 v232, v232, v233
 v_cvt_pk_bf16_f32 v233, v234, v235
 v_cvt_pk_bf16_f32 v234, v236, v237
 v_cvt_pk_bf16_f32 v235, v238, v239
 v_cvt_pk_bf16_f32 v176, v176, v177
 v_cvt_pk_bf16_f32 v177, v178, v179
 v_cvt_pk_bf16_f32 v178, v180, v181
 v_cvt_pk_bf16_f32 v179, v182, v183
 v_cvt_pk_bf16_f32 v240, v240, v241
 v_cvt_pk_bf16_f32 v241, v242, v243
 v_cvt_pk_bf16_f32 v242, v244, v245
 v_cvt_pk_bf16_f32 v243, v246, v247
 v_cvt_pk_bf16_f32 v184, v184, v185
 v_cvt_pk_bf16_f32 v185, v186, v187
 v_cvt_pk_bf16_f32 v186, v188, v189
 v_cvt_pk_bf16_f32 v187, v190, v191
 v_cvt_pk_bf16_f32 v248, v248, v249
 v_cvt_pk_bf16_f32 v249, v250, v251
 v_cvt_pk_bf16_f32 v250, v252, v253
 v_cvt_pk_bf16_f32 v251, v254, v255
 s_waitcnt vmcnt(0)
 s_branch L_attdone
L_mslow:
 s_add_u32 m0, s29, 0
 s_nop 0
 buffer_load_dwordx4 v2, s[8:11], s78 offen lds
 s_add_u32 m0, s29, 4096
 s_nop 0
 buffer_load_dwordx4 v2, s[8:11], s79 offen lds
 s_add_u32 m0, s29, 8192
 s_nop 0
 buffer_load_dwordx4 v2, s[8:11], s80 offen lds
 s_add_u32 m0, s29, 12288
 s_nop 0
 buffer_load_dwordx4 v2, s[8:11], s81 offen lds
 s_add_u32 m0, s29, 16384
 s_nop 0
 buffer_load_dwordx4 v2, s[8:11], s82 offen lds
 s_add_u32 m0, s29, 20480
 s_nop 0
 buffer_load_dwordx4 v2, s[8:11], s83 offen lds
 s_add_u32 m0, s29, 24576
 s_nop 0
 buffer_load_dwordx4 v2, s[8:11], s84 offen lds
 s_add_u32 m0, s29, 28672
 s_nop 0
 buffer_load_dwordx4 v2, s[8:11], s85 offen lds
 v_add_u32 v2, 128, v2
 s_mov_b32 s58, 0xffff0000
 s_waitcnt vmcnt(0)
 v_min_f32 v20, v70, v9
 v_sub_f32 v21, v20, v9
 v_sub_f32 v22, v20, v70
 v_exp_f32 v16, v21
 v_exp_f32 v18, v22
 s_nop 0
 v_mul_f32 v7, v7, v16
 v_fmac_f32 v7, v68, v18
 v_rcp_f32 v64, v7
 v_min_f32 v20, v71, v10
 v_sub_f32 v21, v20, v10
 v_sub_f32 v22, v20, v71
 v_exp_f32 v17, v21
 v_exp_f32 v19, v22
 s_nop 0
 v_mul_f32 v8, v8, v17
 v_fmac_f32 v8, v69, v19
 v_rcp_f32 v65, v8
 v_lshlrev_b32 v24, 16, v32
 v_and_b32 v25, s58, v32
 v_pk_mul_f32 v[24:25], v[24:25], v[18:19] op_sel:[0,0] op_sel_hi:[1,0]
 v_pk_fma_f32 v[128:129], v[128:129], v[16:17], v[24:25] op_sel:[0,0,0] op_sel_hi:[1,0,1]
 v_lshlrev_b32 v26, 16, v33
 v_and_b32 v27, s58, v33
 v_pk_mul_f32 v[26:27], v[26:27], v[18:19] op_sel:[0,0] op_sel_hi:[1,0]
 v_pk_fma_f32 v[130:131], v[130:131], v[16:17], v[26:27] op_sel:[0,0,0] op_sel_hi:[1,0,1]
 v_lshlrev_b32 v28, 16, v34
 v_and_b32 v29, s58, v34
 v_pk_mul_f32 v[28:29], v[28:29], v[18:19] op_sel:[0,0] op_sel_hi:[1,0]
 v_pk_fma_f32 v[132:133], v[132:133], v[16:17], v[28:29] op_sel:[0,0,0] op_sel_hi:[1,0,1]
 v_lshlrev_b32 v30, 16, v35
 v_and_b32 v31, s58, v35
 v_pk_mul_f32 v[30:31], v[30:31], v[18:19] op_sel:[0,0] op_sel_hi:[1,0]
 v_pk_fma_f32 v[134:135], v[134:135], v[16:17], v[30:31] op_sel:[0,0,0] op_sel_hi:[1,0,1]
 v_cvt_pk_bf16_f32 v128, v128, v129
 v_cvt_pk_bf16_f32 v129, v130, v131
 v_cvt_pk_bf16_f32 v130, v132, v133
 v_cvt_pk_bf16_f32 v131, v134, v135
 v_lshlrev_b32 v24, 16, v36
 v_and_b32 v25, s58, v36
 v_pk_mul_f32 v[24:25], v[24:25], v[18:19] op_sel:[0,0] op_sel_hi:[1,0]
 v_pk_fma_f32 v[136:137], v[136:137], v[16:17], v[24:25] op_sel:[0,0,0] op_sel_hi:[1,0,1]
 v_lshlrev_b32 v26, 16, v37
 v_and_b32 v27, s58, v37
 v_pk_mul_f32 v[26:27], v[26:27], v[18:19] op_sel:[0,0] op_sel_hi:[1,0]
 v_pk_fma_f32 v[138:139], v[138:139], v[16:17], v[26:27] op_sel:[0,0,0] op_sel_hi:[1,0,1]
 v_lshlrev_b32 v28, 16, v38
 v_and_b32 v29, s58, v38
 v_pk_mul_f32 v[28:29], v[28:29], v[18:19] op_sel:[0,0] op_sel_hi:[1,0]
 v_pk_fma_f32 v[140:141], v[140:141], v[16:17], v[28:29] op_sel:[0,0,0] op_sel_hi:[1,0,1]
 v_lshlrev_b32 v30, 16, v39
 v_and_b32 v31, s58, v39
 v_pk_mul_f32 v[30:31], v[30:31], v[18:19] op_sel:[0,0] op_sel_hi:[1,0]
 v_pk_fma_f32 v[142:143], v[142:143], v[16:17], v[30:31] op_sel:[0,0,0] op_sel_hi:[1,0,1]
 v_cvt_pk_bf16_f32 v136, v136, v137
 v_cvt_pk_bf16_f32 v137, v138, v139
 v_cvt_pk_bf16_f32 v138, v140, v141
 v_cvt_pk_bf16_f32 v139, v142, v143
 v_lshlrev_b32 v24, 16, v40
 v_and_b32 v25, s58, v40
 v_pk_mul_f32 v[24:25], v[24:25], v[18:19] op_sel:[0,0] op_sel_hi:[1,0]
 v_pk_fma_f32 v[144:145], v[144:145], v[16:17], v[24:25] op_sel:[0,0,0] op_sel_hi:[1,0,1]
 v_lshlrev_b32 v26, 16, v41
 v_and_b32 v27, s58, v41
 v_pk_mul_f32 v[26:27], v[26:27], v[18:19] op_sel:[0,0] op_sel_hi:[1,0]
 v_pk_fma_f32 v[146:147], v[146:147], v[16:17], v[26:27] op_sel:[0,0,0] op_sel_hi:[1,0,1]
 v_lshlrev_b32 v28, 16, v42
 v_and_b32 v29, s58, v42
 v_pk_mul_f32 v[28:29], v[28:29], v[18:19] op_sel:[0,0] op_sel_hi:[1,0]
 v_pk_fma_f32 v[148:149], v[148:149], v[16:17], v[28:29] op_sel:[0,0,0] op_sel_hi:[1,0,1]
 v_lshlrev_b32 v30, 16, v43
 v_and_b32 v31, s58, v43
 v_pk_mul_f32 v[30:31], v[30:31], v[18:19] op_sel:[0,0] op_sel_hi:[1,0]
 v_pk_fma_f32 v[150:151], v[150:151], v[16:17], v[30:31] op_sel:[0,0,0] op_sel_hi:[1,0,1]
 v_cvt_pk_bf16_f32 v144, v144, v145
 v_cvt_pk_bf16_f32 v145, v146, v147
 v_cvt_pk_bf16_f32 v146, v148, v149
 v_cvt_pk_bf16_f32 v147, v150, v151
 v_lshlrev_b32 v24, 16, v44
 v_and_b32 v25, s58, v44
 v_pk_mul_f32 v[24:25], v[24:25], v[18:19] op_sel:[0,0] op_sel_hi:[1,0]
 v_pk_fma_f32 v[152:153], v[152:153], v[16:17], v[24:25] op_sel:[0,0,0] op_sel_hi:[1,0,1]
 v_lshlrev_b32 v26, 16, v45
 v_and_b32 v27, s58, v45
 v_pk_mul_f32 v[26:27], v[26:27], v[18:19] op_sel:[0,0] op_sel_hi:[1,0]
 v_pk_fma_f32 v[154:155], v[154:155], v[16:17], v[26:27] op_sel:[0,0,0] op_sel_hi:[1,0,1]
 v_lshlrev_b32 v28, 16, v46
 v_and_b32 v29, s58, v46
 v_pk_mul_f32 v[28:29], v[28:29], v[18:19] op_sel:[0,0] op_sel_hi:[1,0]
 v_pk_fma_f32 v[156:157], v[156:157], v[16:17], v[28:29] op_sel:[0,0,0] op_sel_hi:[1,0,1]
 v_lshlrev_b32 v30, 16, v47
 v_and_b32 v31, s58, v47
 v_pk_mul_f32 v[30:31], v[30:31], v[18:19] op_sel:[0,0] op_sel_hi:[1,0]
 v_pk_fma_f32 v[158:159], v[158:159], v[16:17], v[30:31] op_sel:[0,0,0] op_sel_hi:[1,0,1]
 v_cvt_pk_bf16_f32 v152, v152, v153
 v_cvt_pk_bf16_f32 v153, v154, v155
 v_cvt_pk_bf16_f32 v154, v156, v157
 v_cvt_pk_bf16_f32 v155, v158, v159
 v_lshlrev_b32 v24, 16, v48
 v_and_b32 v25, s58, v48
 v_pk_mul_f32 v[24:25], v[24:25], v[18:19] op_sel:[0,0] op_sel_hi:[1,0]
 v_pk_fma_f32 v[160:161], v[160:161], v[16:17], v[24:25] op_sel:[0,0,0] op_sel_hi:[1,0,1]
 v_lshlrev_b32 v26, 16, v49
 v_and_b32 v27, s58, v49
 v_pk_mul_f32 v[26:27], v[26:27], v[18:19] op_sel:[0,0] op_sel_hi:[1,0]
 v_pk_fma_f32 v[162:163], v[162:163], v[16:17], v[26:27] op_sel:[0,0,0] op_sel_hi:[1,0,1]
 v_lshlrev_b32 v28, 16, v50
 v_and_b32 v29, s58, v50
 v_pk_mul_f32 v[28:29], v[28:29], v[18:19] op_sel:[0,0] op_sel_hi:[1,0]
 v_pk_fma_f32 v[164:165], v[164:165], v[16:17], v[28:29] op_sel:[0,0,0] op_sel_hi:[1,0,1]
 v_lshlrev_b32 v30, 16, v51
 v_and_b32 v31, s58, v51
 v_pk_mul_f32 v[30:31], v[30:31], v[18:19] op_sel:[0,0] op_sel_hi:[1,0]
 v_pk_fma_f32 v[166:167], v[166:167], v[16:17], v[30:31] op_sel:[0,0,0] op_sel_hi:[1,0,1]
 v_cvt_pk_bf16_f32 v160, v160, v161
 v_cvt_pk_bf16_f32 v161, v162, v163
 v_cvt_pk_bf16_f32 v162, v164, v165
 v_cvt_pk_bf16_f32 v163, v166, v167
 v_lshlrev_b32 v24, 16, v52
 v_and_b32 v25, s58, v52
 v_pk_mul_f32 v[24:25], v[24:25], v[18:19] op_sel:[0,0] op_sel_hi:[1,0]
 v_pk_fma_f32 v[168:169], v[168:169], v[16:17], v[24:25] op_sel:[0,0,0] op_sel_hi:[1,0,1]
 v_lshlrev_b32 v26, 16, v53
 v_and_b32 v27, s58, v53
 v_pk_mul_f32 v[26:27], v[26:27], v[18:19] op_sel:[0,0] op_sel_hi:[1,0]
 v_pk_fma_f32 v[170:171], v[170:171], v[16:17], v[26:27] op_sel:[0,0,0] op_sel_hi:[1,0,1]
 v_lshlrev_b32 v28, 16, v54
 v_and_b32 v29, s58, v54
 v_pk_mul_f32 v[28:29], v[28:29], v[18:19] op_sel:[0,0] op_sel_hi:[1,0]
 v_pk_fma_f32 v[172:173], v[172:173], v[16:17], v[28:29] op_sel:[0,0,0] op_sel_hi:[1,0,1]
 v_lshlrev_b32 v30, 16, v55
 v_and_b32 v31, s58, v55
 v_pk_mul_f32 v[30:31], v[30:31], v[18:19] op_sel:[0,0] op_sel_hi:[1,0]
 v_pk_fma_f32 v[174:175], v[174:175], v[16:17], v[30:31] op_sel:[0,0,0] op_sel_hi:[1,0,1]
 v_cvt_pk_bf16_f32 v168, v168, v169
 v_cvt_pk_bf16_f32 v169, v170, v171
 v_cvt_pk_bf16_f32 v170, v172, v173
 v_cvt_pk_bf16_f32 v171, v174, v175
 v_lshlrev_b32 v24, 16, v56
 v_and_b32 v25, s58, v56
 v_pk_mul_f32 v[24:25], v[24:25], v[18:19] op_sel:[0,0] op_sel_hi:[1,0]
 v_pk_fma_f32 v[176:177], v[176:177], v[16:17], v[24:25] op_sel:[0,0,0] op_sel_hi:[1,0,1]
 v_lshlrev_b32 v26, 16, v57
 v_and_b32 v27, s58, v57
 v_pk_mul_f32 v[26:27], v[26:27], v[18:19] op_sel:[0,0] op_sel_hi:[1,0]
 v_pk_fma_f32 v[178:179], v[178:179], v[16:17], v[26:27] op_sel:[0,0,0] op_sel_hi:[1,0,1]
 v_lshlrev_b32 v28, 16, v58
 v_and_b32 v29, s58, v58
 v_pk_mul_f32 v[28:29], v[28:29], v[18:19] op_sel:[0,0] op_sel_hi:[1,0]
 v_pk_fma_f32 v[180:181], v[180:181], v[16:17], v[28:29] op_sel:[0,0,0] op_sel_hi:[1,0,1]
 v_lshlrev_b32 v30, 16, v59
 v_and_b32 v31, s58, v59
 v_pk_mul_f32 v[30:31], v[30:31], v[18:19] op_sel:[0,0] op_sel_hi:[1,0]
 v_pk_fma_f32 v[182:183], v[182:183], v[16:17], v[30:31] op_sel:[0,0,0] op_sel_hi:[1,0,1]
 v_cvt_pk_bf16_f32 v176, v176, v177
 v_cvt_pk_bf16_f32 v177, v178, v179
 v_cvt_pk_bf16_f32 v178, v180, v181
 v_cvt_pk_bf16_f32 v179, v182, v183
 v_lshlrev_b32 v24, 16, v60
 v_and_b32 v25, s58, v60
 v_pk_mul_f32 v[24:25], v[24:25], v[18:19] op_sel:[0,0] op_sel_hi:[1,0]
 v_pk_fma_f32 v[184:185], v[184:185], v[16:17], v[24:25] op_sel:[0,0,0] op_sel_hi:[1,0,1]
 v_lshlrev_b32 v26, 16, v61
 v_and_b32 v27, s58, v61
 v_pk_mul_f32 v[26:27], v[26:27], v[18:19] op_sel:[0,0] op_sel_hi:[1,0]
 v_pk_fma_f32 v[186:187], v[186:187], v[16:17], v[26:27] op_sel:[0,0,0] op_sel_hi:[1,0,1]
 v_lshlrev_b32 v28, 16, v62
 v_and_b32 v29, s58, v62
 v_pk_mul_f32 v[28:29], v[28:29], v[18:19] op_sel:[0,0] op_sel_hi:[1,0]
 v_pk_fma_f32 v[188:189], v[188:189], v[16:17], v[28:29] op_sel:[0,0,0] op_sel_hi:[1,0,1]
 v_lshlrev_b32 v30, 16, v63
 v_and_b32 v31, s58, v63
 v_pk_mul_f32 v[30:31], v[30:31], v[18:19] op_sel:[0,0] op_sel_hi:[1,0]
 v_pk_fma_f32 v[190:191], v[190:191], v[16:17], v[30:31] op_sel:[0,0,0] op_sel_hi:[1,0,1]
 v_cvt_pk_bf16_f32 v184, v184, v185
 v_cvt_pk_bf16_f32 v185, v186, v187
 v_cvt_pk_bf16_f32 v186, v188, v189
 v_cvt_pk_bf16_f32 v187, v190, v191
 v_lshlrev_b32 v24, 16, v96
 v_and_b32 v25, s58, v96
 v_pk_mul_f32 v[24:25], v[24:25], v[18:19] op_sel:[0,1] op_sel_hi:[1,1]
 v_pk_fma_f32 v[192:193], v[192:193], v[16:17], v[24:25] op_sel:[0,1,0] op_sel_hi:[1,1,1]
 v_lshlrev_b32 v26, 16, v97
 v_and_b32 v27, s58, v97
 v_pk_mul_f32 v[26:27], v[26:27], v[18:19] op_sel:[0,1] op_sel_hi:[1,1]
 v_pk_fma_f32 v[194:195], v[194:195], v[16:17], v[26:27] op_sel:[0,1,0] op_sel_hi:[1,1,1]
 v_lshlrev_b32 v28, 16, v98
 v_and_b32 v29, s58, v98
 v_pk_mul_f32 v[28:29], v[28:29], v[18:19] op_sel:[0,1] op_sel_hi:[1,1]
 v_pk_fma_f32 v[196:197], v[196:197], v[16:17], v[28:29] op_sel:[0,1,0] op_sel_hi:[1,1,1]
 v_lshlrev_b32 v30, 16, v99
 v_and_b32 v31, s58, v99
 v_pk_mul_f32 v[30:31], v[30:31], v[18:19] op_sel:[0,1] op_sel_hi:[1,1]
 v_pk_fma_f32 v[198:199], v[198:199], v[16:17], v[30:31] op_sel:[0,1,0] op_sel_hi:[1,1,1]
 v_cvt_pk_bf16_f32 v192, v192, v193
 v_cvt_pk_bf16_f32 v193, v194, v195
 v_cvt_pk_bf16_f32 v194, v196, v197
 v_cvt_pk_bf16_f32 v195, v198, v199
 v_lshlrev_b32 v24, 16, v100
 v_and_b32 v25, s58, v100
 v_pk_mul_f32 v[24:25], v[24:25], v[18:19] op_sel:[0,1] op_sel_hi:[1,1]
 v_pk_fma_f32 v[200:201], v[200:201], v[16:17], v[24:25] op_sel:[0,1,0] op_sel_hi:[1,1,1]
 v_lshlrev_b32 v26, 16, v101
 v_and_b32 v27, s58, v101
 v_pk_mul_f32 v[26:27], v[26:27], v[18:19] op_sel:[0,1] op_sel_hi:[1,1]
 v_pk_fma_f32 v[202:203], v[202:203], v[16:17], v[26:27] op_sel:[0,1,0] op_sel_hi:[1,1,1]
 v_lshlrev_b32 v28, 16, v102
 v_and_b32 v29, s58, v102
 v_pk_mul_f32 v[28:29], v[28:29], v[18:19] op_sel:[0,1] op_sel_hi:[1,1]
 v_pk_fma_f32 v[204:205], v[204:205], v[16:17], v[28:29] op_sel:[0,1,0] op_sel_hi:[1,1,1]
 v_lshlrev_b32 v30, 16, v103
 v_and_b32 v31, s58, v103
 v_pk_mul_f32 v[30:31], v[30:31], v[18:19] op_sel:[0,1] op_sel_hi:[1,1]
 v_pk_fma_f32 v[206:207], v[206:207], v[16:17], v[30:31] op_sel:[0,1,0] op_sel_hi:[1,1,1]
 v_cvt_pk_bf16_f32 v200, v200, v201
 v_cvt_pk_bf16_f32 v201, v202, v203
 v_cvt_pk_bf16_f32 v202, v204, v205
 v_cvt_pk_bf16_f32 v203, v206, v207
 v_lshlrev_b32 v24, 16, v104
 v_and_b32 v25, s58, v104
 v_pk_mul_f32 v[24:25], v[24:25], v[18:19] op_sel:[0,1] op_sel_hi:[1,1]
 v_pk_fma_f32 v[208:209], v[208:209], v[16:17], v[24:25] op_sel:[0,1,0] op_sel_hi:[1,1,1]
 v_lshlrev_b32 v26, 16, v105
 v_and_b32 v27, s58, v105
 v_pk_mul_f32 v[26:27], v[26:27], v[18:19] op_sel:[0,1] op_sel_hi:[1,1]
 v_pk_fma_f32 v[210:211], v[210:211], v[16:17], v[26:27] op_sel:[0,1,0] op_sel_hi:[1,1,1]
 v_lshlrev_b32 v28, 16, v106
 v_and_b32 v29, s58, v106
 v_pk_mul_f32 v[28:29], v[28:29], v[18:19] op_sel:[0,1] op_sel_hi:[1,1]
 v_pk_fma_f32 v[212:213], v[212:213], v[16:17], v[28:29] op_sel:[0,1,0] op_sel_hi:[1,1,1]
 v_lshlrev_b32 v30, 16, v107
 v_and_b32 v31, s58, v107
 v_pk_mul_f32 v[30:31], v[30:31], v[18:19] op_sel:[0,1] op_sel_hi:[1,1]
 v_pk_fma_f32 v[214:215], v[214:215], v[16:17], v[30:31] op_sel:[0,1,0] op_sel_hi:[1,1,1]
 v_cvt_pk_bf16_f32 v208, v208, v209
 v_cvt_pk_bf16_f32 v209, v210, v211
 v_cvt_pk_bf16_f32 v210, v212, v213
 v_cvt_pk_bf16_f32 v211, v214, v215
 v_lshlrev_b32 v24, 16, v108
 v_and_b32 v25, s58, v108
 v_pk_mul_f32 v[24:25], v[24:25], v[18:19] op_sel:[0,1] op_sel_hi:[1,1]
 v_pk_fma_f32 v[216:217], v[216:217], v[16:17], v[24:25] op_sel:[0,1,0] op_sel_hi:[1,1,1]
 v_lshlrev_b32 v26, 16, v109
 v_and_b32 v27, s58, v109
 v_pk_mul_f32 v[26:27], v[26:27], v[18:19] op_sel:[0,1] op_sel_hi:[1,1]
 v_pk_fma_f32 v[218:219], v[218:219], v[16:17], v[26:27] op_sel:[0,1,0] op_sel_hi:[1,1,1]
 v_lshlrev_b32 v28, 16, v110
 v_and_b32 v29, s58, v110
 v_pk_mul_f32 v[28:29], v[28:29], v[18:19] op_sel:[0,1] op_sel_hi:[1,1]
 v_pk_fma_f32 v[220:221], v[220:221], v[16:17], v[28:29] op_sel:[0,1,0] op_sel_hi:[1,1,1]
 v_lshlrev_b32 v30, 16, v111
 v_and_b32 v31, s58, v111
 v_pk_mul_f32 v[30:31], v[30:31], v[18:19] op_sel:[0,1] op_sel_hi:[1,1]
 v_pk_fma_f32 v[222:223], v[222:223], v[16:17], v[30:31] op_sel:[0,1,0] op_sel_hi:[1,1,1]
 v_cvt_pk_bf16_f32 v216, v216, v217
 v_cvt_pk_bf16_f32 v217, v218, v219
 v_cvt_pk_bf16_f32 v218, v220, v221
 v_cvt_pk_bf16_f32 v219, v222, v223
 v_lshlrev_b32 v24, 16, v112
 v_and_b32 v25, s58, v112
 v_pk_mul_f32 v[24:25], v[24:25], v[18:19] op_sel:[0,1] op_sel_hi:[1,1]
 v_pk_fma_f32 v[224:225], v[224:225], v[16:17], v[24:25] op_sel:[0,1,0] op_sel_hi:[1,1,1]
 v_lshlrev_b32 v26, 16, v113
 v_and_b32 v27, s58, v113
 v_pk_mul_f32 v[26:27], v[26:27], v[18:19] op_sel:[0,1] op_sel_hi:[1,1]
 v_pk_fma_f32 v[226:227], v[226:227], v[16:17], v[26:27] op_sel:[0,1,0] op_sel_hi:[1,1,1]
 v_lshlrev_b32 v28, 16, v114
 v_and_b32 v29, s58, v114
 v_pk_mul_f32 v[28:29], v[28:29], v[18:19] op_sel:[0,1] op_sel_hi:[1,1]
 v_pk_fma_f32 v[228:229], v[228:229], v[16:17], v[28:29] op_sel:[0,1,0] op_sel_hi:[1,1,1]
 v_lshlrev_b32 v30, 16, v115
 v_and_b32 v31, s58, v115
 v_pk_mul_f32 v[30:31], v[30:31], v[18:19] op_sel:[0,1] op_sel_hi:[1,1]
 v_pk_fma_f32 v[230:231], v[230:231], v[16:17], v[30:31] op_sel:[0,1,0] op_sel_hi:[1,1,1]
 v_cvt_pk_bf16_f32 v224, v224, v225
 v_cvt_pk_bf16_f32 v225, v226, v227
 v_cvt_pk_bf16_f32 v226, v228, v229
 v_cvt_pk_bf16_f32 v227, v230, v231
 v_lshlrev_b32 v24, 16, v116
 v_and_b32 v25, s58, v116
 v_pk_mul_f32 v[24:25], v[24:25], v[18:19] op_sel:[0,1] op_sel_hi:[1,1]
 v_pk_fma_f32 v[232:233], v[232:233], v[16:17], v[24:25] op_sel:[0,1,0] op_sel_hi:[1,1,1]
 v_lshlrev_b32 v26, 16, v117
 v_and_b32 v27, s58, v117
 v_pk_mul_f32 v[26:27], v[26:27], v[18:19] op_sel:[0,1] op_sel_hi:[1,1]
 v_pk_fma_f32 v[234:235], v[234:235], v[16:17], v[26:27] op_sel:[0,1,0] op_sel_hi:[1,1,1]
 v_lshlrev_b32 v28, 16, v118
 v_and_b32 v29, s58, v118
 v_pk_mul_f32 v[28:29], v[28:29], v[18:19] op_sel:[0,1] op_sel_hi:[1,1]
 v_pk_fma_f32 v[236:237], v[236:237], v[16:17], v[28:29] op_sel:[0,1,0] op_sel_hi:[1,1,1]
 v_lshlrev_b32 v30, 16, v119
 v_and_b32 v31, s58, v119
 v_pk_mul_f32 v[30:31], v[30:31], v[18:19] op_sel:[0,1] op_sel_hi:[1,1]
 v_pk_fma_f32 v[238:239], v[238:239], v[16:17], v[30:31] op_sel:[0,1,0] op_sel_hi:[1,1,1]
 v_cvt_pk_bf16_f32 v232, v232, v233
 v_cvt_pk_bf16_f32 v233, v234, v235
 v_cvt_pk_bf16_f32 v234, v236, v237
 v_cvt_pk_bf16_f32 v235, v238, v239
 v_lshlrev_b32 v24, 16, v120
 v_and_b32 v25, s58, v120
 v_pk_mul_f32 v[24:25], v[24:25], v[18:19] op_sel:[0,1] op_sel_hi:[1,1]
 v_pk_fma_f32 v[240:241], v[240:241], v[16:17], v[24:25] op_sel:[0,1,0] op_sel_hi:[1,1,1]
 v_lshlrev_b32 v26, 16, v121
 v_and_b32 v27, s58, v121
 v_pk_mul_f32 v[26:27], v[26:27], v[18:19] op_sel:[0,1] op_sel_hi:[1,1]
 v_pk_fma_f32 v[242:243], v[242:243], v[16:17], v[26:27] op_sel:[0,1,0] op_sel_hi:[1,1,1]
 v_lshlrev_b32 v28, 16, v122
 v_and_b32 v29, s58, v122
 v_pk_mul_f32 v[28:29], v[28:29], v[18:19] op_sel:[0,1] op_sel_hi:[1,1]
 v_pk_fma_f32 v[244:245], v[244:245], v[16:17], v[28:29] op_sel:[0,1,0] op_sel_hi:[1,1,1]
 v_lshlrev_b32 v30, 16, v123
 v_and_b32 v31, s58, v123
 v_pk_mul_f32 v[30:31], v[30:31], v[18:19] op_sel:[0,1] op_sel_hi:[1,1]
 v_pk_fma_f32 v[246:247], v[246:247], v[16:17], v[30:31] op_sel:[0,1,0] op_sel_hi:[1,1,1]
 v_cvt_pk_bf16_f32 v240, v240, v241
 v_cvt_pk_bf16_f32 v241, v242, v243
 v_cvt_pk_bf16_f32 v242, v244, v245
 v_cvt_pk_bf16_f32 v243, v246, v247
 v_lshlrev_b32 v24, 16, v124
 v_and_b32 v25, s58, v124
 v_pk_mul_f32 v[24:25], v[24:25], v[18:19] op_sel:[0,1] op_sel_hi:[1,1]
 v_pk_fma_f32 v[248:249], v[248:249], v[16:17], v[24:25] op_sel:[0,1,0] op_sel_hi:[1,1,1]
 v_lshlrev_b32 v26, 16, v125
 v_and_b32 v27, s58, v125
 v_pk_mul_f32 v[26:27], v[26:27], v[18:19] op_sel:[0,1] op_sel_hi:[1,1]
 v_pk_fma_f32 v[250:251], v[250:251], v[16:17], v[26:27] op_sel:[0,1,0] op_sel_hi:[1,1,1]
 v_lshlrev_b32 v28, 16, v126
 v_and_b32 v29, s58, v126
 v_pk_mul_f32 v[28:29], v[28:29], v[18:19] op_sel:[0,1] op_sel_hi:[1,1]
 v_pk_fma_f32 v[252:253], v[252:253], v[16:17], v[28:29] op_sel:[0,1,0] op_sel_hi:[1,1,1]
 v_lshlrev_b32 v30, 16, v127
 v_and_b32 v31, s58, v127
 v_pk_mul_f32 v[30:31], v[30:31], v[18:19] op_sel:[0,1] op_sel_hi:[1,1]
 v_pk_fma_f32 v[254:255], v[254:255], v[16:17], v[30:31] op_sel:[0,1,0] op_sel_hi:[1,1,1]
 v_cvt_pk_bf16_f32 v248, v248, v249
 v_cvt_pk_bf16_f32 v249, v250, v251
 v_cvt_pk_bf16_f32 v250, v252, v253
 v_cvt_pk_bf16_f32 v251, v254, v255
L_attdone:
 v_lshrrev_b32 v8, 2, v0
 v_lshlrev_b32 v4, 7, v8
 v_bfe_u32 v8, v8, 1, 2
 v_lshl_add_u32 v4, v8, 5, v4
 v_and_b32 v8, 3, v0
 v_lshl_add_u32 v4, v8, 3, v4
 v_add_u32 v4, 131072, v4
 s_barrier
 ds_read_b64_tr_b16 a[0:1], v4 offset:0
 ds_read_b64_tr_b16 a[2:3], v4 offset:2048
 ds_read_b64_tr_b16 a[4:5], v4 offset:4096
 ds_read_b64_tr_b16 a[6:7], v4 offset:6144
 ds_read_b64_tr_b16 a[8:9], v4 offset:8192
 ds_read_b64_tr_b16 a[10:11], v4 offset:10240
 ds_read_b64_tr_b16 a[12:13], v4 offset:12288
 ds_read_b64_tr_b16 a[14:15], v4 offset:14336
 ds_read_b64_tr_b16 a[16:17], v4 offset:16384
 ds_read_b64_tr_b16 a[18:19], v4 offset:18432
 ds_read_b64_tr_b16 a[20:21], v4 offset:20480
 ds_read_b64_tr_b16 a[22:23], v4 offset:22528
 ds_read_b64_tr_b16 a[24:25], v4 offset:24576
 ds_read_b64_tr_b16 a[26:27], v4 offset:26624
 v_xor_b32 v5, 32, v4
 v_xor_b32 v6, 64, v4
 v_xor_b32 v7, 96, v4
 v_and_b32 v10, 15, v0
 v_lshlrev_b32 v10, 2, v10
 s_cmp_lt_u32 s28, 14
 s_cselect_b32 s52, 0, 1
 s_mov_b32 s53, 0
 v_accvgpr_read_b32 v9, a245
 s_lshl_b32 s48, s63, 3
 s_add_u32 s48, s48, s3
 s_mul_i32 s48, s48, 243712
 s_lshl_b32 s58, s26, 10
 s_add_u32 s48, s48, s58
 s_add_u32 s48, s48, 117440512
 s_waitcnt lgkmcnt(7)
 v_mfma_f32_16x16x32_bf16 v[72:75], a[0:3], v[128:131], 0
 ds_read_b64_tr_b16 a[28:29], v4 offset:28672
 v_mfma_f32_16x16x32_bf16 v[72:75], a[4:7], v[136:139], v[72:75]
 ds_read_b64_tr_b16 a[30:31], v4 offset:30720
 v_mfma_f32_16x16x32_bf16 v[72:75], a[8:11], v[144:147], v[72:75]
 s_waitcnt lgkmcnt(4)
 ds_read_b64_tr_b16 a[32:33], v5 offset:0
 v_mfma_f32_16x16x32_bf16 v[72:75], a[12:15], v[152:155], v[72:75]
 s_add_u32 m0, s29, 32768
 ds_read_b64_tr_b16 a[34:35], v5 offset:2048
 v_mfma_f32_16x16x32_bf16 v[72:75], a[16:19], v[160:163], v[72:75]
 ds_read_b64_tr_b16 a[36:37], v5 offset:4096
 buffer_load_dwordx4 v2, s[8:11], s78 offen lds
 v_mfma_f32_16x16x32_bf16 v[72:75], a[20:23], v[168:171], v[72:75]
 s_waitcnt lgkmcnt(3)
 ds_read_b64_tr_b16 a[38:39], v5 offset:6144
 v_mfma_f32_16x16x32_bf16 v[72:75], a[24:27], v[176:179], v[72:75]
 ds_read_b64_tr_b16 a[40:41], v5 offset:8192
 v_mfma_f32_16x16x32_bf16 v[72:75], a[28:31], v[184:187], v[72:75]
 ds_read_b64_tr_b16 a[42:43], v5 offset:10240
 v_mfma_f32_16x16x32_bf16 v[80:83], a[0:3], v[192:195], 0
 ds_read_b64_tr_b16 a[44:45], v5 offset:12288
 v_mfma_f32_16x16x32_bf16 v[80:83], a[4:7], v[200:203], v[80:83]
 ds_read_b64_tr_b16 a[46:47], v5 offset:14336
 v_mfma_f32_16x16x32_bf16 v[80:83], a[8:11], v[208:211], v[80:83]
 s_add_u32 m0, s29, 36864
 ds_read_b64_tr_b16 a[48:49], v5 offset:16384
 v_mfma_f32_16x16x32_bf16 v[80:83], a[12:15], v[216:219], v[80:83]
 ds_read_b64_tr_b16 a[50:51], v5 offset:18432
 buffer_load_dwordx4 v2, s[8:11], s79 offen lds
 v_mfma_f32_16x16x32_bf16 v[80:83], a[16:19], v[224:227], v[80:83]
 ds_read_b64_tr_b16 a[52:53], v5 offset:20480
 v_mul_f32 v72, v72, v64
 v_mfma_f32_16x16x32_bf16 v[80:83], a[20:23], v[232:235], v[80:83]
 ds_read_b64_tr_b16 a[54:55], v5 offset:22528
 v_mul_f32 v73, v73, v64
 v_mfma_f32_16x16x32_bf16 v[80:83], a[24:27], v[240:243], v[80:83]
 ds_read_b64_tr_b16 a[56:57], v5 offset:24576
 v_mul_f32 v74, v74, v64
 v_mfma_f32_16x16x32_bf16 v[80:83], a[28:31], v[248:251], v[80:83]
 s_waitcnt lgkmcnt(7)
 ds_read_b64_tr_b16 a[58:59], v5 offset:26624
 v_mul_f32 v75, v75, v64
 v_mfma_f32_16x16x32_bf16 v[76:79], a[32:35], v[128:131], 0
 ds_read_b64_tr_b16 a[60:61], v5 offset:28672
 v_mfma_f32_16x16x32_bf16 v[76:79], a[36:39], v[136:139], v[76:79]
 s_add_u32 m0, s29, 40960
 ds_read_b64_tr_b16 a[62:63], v5 offset:30720
 v_mfma_f32_16x16x32_bf16 v[76:79], a[40:43], v[144:147], v[76:79]
 s_waitcnt lgkmcnt(4)
 ds_read_b64_tr_b16 a[0:1], v6 offset:0
 buffer_load_dwordx4 v2, s[8:11], s80 offen lds
 v_mfma_f32_16x16x32_bf16 v[76:79], a[44:47], v[152:155], v[76:79]
 ds_read_b64_tr_b16 a[2:3], v6 offset:2048
 v_mfma_f32_16x16x32_bf16 v[76:79], a[48:51], v[160:163], v[76:79]
 ds_read_b64_tr_b16 a[4:5], v6 offset:4096
 v_mul_f32 v80, v80, v65
 v_mfma_f32_16x16x32_bf16 v[76:79], a[52:55], v[168:171], v[76:79]
 s_waitcnt lgkmcnt(3)
 ds_read_b64_tr_b16 a[6:7], v6 offset:6144
 v_mul_f32 v81, v81, v65
 v_mfma_f32_16x16x32_bf16 v[76:79], a[56:59], v[176:179], v[76:79]
 ds_read_b64_tr_b16 a[8:9], v6 offset:8192
 v_mul_f32 v82, v82, v65
 v_mfma_f32_16x16x32_bf16 v[76:79], a[60:63], v[184:187], v[76:79]
 ds_read_b64_tr_b16 a[10:11], v6 offset:10240
 v_mul_f32 v83, v83, v65
 v_mfma_f32_16x16x32_bf16 v[84:87], a[32:35], v[192:195], 0
 s_add_u32 m0, s29, 45056
 ds_read_b64_tr_b16 a[12:13], v6 offset:12288
 v_mfma_f32_16x16x32_bf16 v[84:87], a[36:39], v[200:203], v[84:87]
 ds_read_b64_tr_b16 a[14:15], v6 offset:14336
 buffer_load_dwordx4 v2, s[8:11], s81 offen lds
 v_mfma_f32_16x16x32_bf16 v[84:87], a[40:43], v[208:211], v[84:87]
 ds_read_b64_tr_b16 a[16:17], v6 offset:16384
 v_mfma_f32_16x16x32_bf16 v[84:87], a[44:47], v[216:219], v[84:87]
 ds_read_b64_tr_b16 a[18:19], v6 offset:18432
 v_mfma_f32_16x16x32_bf16 v[84:87], a[48:51], v[224:227], v[84:87]
 ds_read_b64_tr_b16 a[20:21], v6 offset:20480
 v_mul_f32 v76, v76, v64
 v_mfma_f32_16x16x32_bf16 v[84:87], a[52:55], v[232:235], v[84:87]
 ds_read_b64_tr_b16 a[22:23], v6 offset:22528
 v_mul_f32 v77, v77, v64
 v_mfma_f32_16x16x32_bf16 v[84:87], a[56:59], v[240:243], v[84:87]
 s_add_u32 m0, s29, 49152
 ds_read_b64_tr_b16 a[24:25], v6 offset:24576
 v_mul_f32 v78, v78, v64
 v_mfma_f32_16x16x32_bf16 v[84:87], a[60:63], v[248:251], v[84:87]
 s_waitcnt lgkmcnt(7)
 ds_read_b64_tr_b16 a[26:27], v6 offset:26624
 v_mul_f32 v79, v79, v64
 v_mfma_f32_16x16x32_bf16 v[88:91], a[0:3], v[128:131], 0
 ds_read_b64_tr_b16 a[28:29], v6 offset:28672
 buffer_load_dwordx4 v2, s[8:11], s82 offen lds
 v_mfma_f32_16x16x32_bf16 v[88:91], a[4:7], v[136:139], v[88:91]
 s_lshl_b32 s44, s24, 7
 ds_read_b64_tr_b16 a[30:31], v6 offset:30720
 v_cvt_pk_bf16_f32 v72, v72, v73
 v_mfma_f32_16x16x32_bf16 v[88:91], a[8:11], v[144:147], v[88:91]
 s_waitcnt lgkmcnt(4)
 ds_read_b64_tr_b16 a[32:33], v7 offset:0
 v_cvt_pk_bf16_f32 v73, v74, v75
 v_mfma_f32_16x16x32_bf16 v[88:91], a[12:15], v[152:155], v[88:91]
 s_add_u32 s44, s44, 84938752
 ds_read_b64_tr_b16 a[34:35], v7 offset:2048
 v_cvt_pk_bf16_f32 v74, v76, v77
 v_mfma_f32_16x16x32_bf16 v[88:91], a[16:19], v[160:163], v[88:91]
 s_add_u32 s58, s48, 0
 ds_read_b64_tr_b16 a[36:37], v7 offset:4096
 v_cvt_pk_bf16_f32 v75, v78, v79
 v_mfma_f32_16x16x32_bf16 v[88:91], a[20:23], v[168:171], v[88:91]
 s_waitcnt lgkmcnt(3)
 ds_read_b64_tr_b16 a[38:39], v7 offset:6144
 buffer_store_dwordx4 v[72:75], v1, s[12:15], s58 offen sc1
 v_mfma_f32_16x16x32_bf16 v[88:91], a[24:27], v[176:179], v[88:91]
 s_add_u32 m0, s29, 53248
 ds_read_b64_tr_b16 a[40:41], v7 offset:8192
 v_mul_f32 v84, v84, v65
 v_mfma_f32_16x16x32_bf16 v[88:91], a[28:31], v[184:187], v[88:91]
 ds_read_b64_tr_b16 a[42:43], v7 offset:10240
 buffer_load_dwordx4 v2, s[8:11], s83 offen lds
 v_mfma_f32_16x16x32_bf16 v[96:99], a[0:3], v[192:195], 0
 s_lshl_b32 s40, s24, 1
 ds_read_b64_tr_b16 a[44:45], v7 offset:12288
 v_mul_f32 v85, v85, v65
 v_mfma_f32_16x16x32_bf16 v[96:99], a[4:7], v[200:203], v[96:99]
 s_and_b32 s41, s28, 1
 ds_read_b64_tr_b16 a[46:47], v7 offset:14336
 v_mul_f32 v86, v86, v65
 v_mfma_f32_16x16x32_bf16 v[96:99], a[8:11], v[208:211], v[96:99]
 s_add_u32 s40, s40, s41
 ds_read_b64_tr_b16 a[48:49], v7 offset:16384
 v_mul_f32 v87, v87, v65
 v_mfma_f32_16x16x32_bf16 v[96:99], a[12:15], v[216:219], v[96:99]
 s_lshr_b32 s41, s28, 1
 ds_read_b64_tr_b16 a[50:51], v7 offset:18432
 v_cvt_pk_bf16_f32 v80, v80, v81
 v_mfma_f32_16x16x32_bf16 v[96:99], a[16:19], v[224:227], v[96:99]
 s_lshl_b32 s42, s40, 2
 ds_read_b64_tr_b16 a[52:53], v7 offset:20480
 v_cvt_pk_bf16_f32 v81, v82, v83
 v_mfma_f32_16x16x32_bf16 v[96:99], a[20:23], v[232:235], v[96:99]
 s_add_u32 m0, s29, 57344
 ds_read_b64_tr_b16 a[54:55], v7 offset:22528
 v_cvt_pk_bf16_f32 v82, v84, v85
 v_mfma_f32_16x16x32_bf16 v[96:99], a[24:27], v[240:243], v[96:99]
 ds_read_b64_tr_b16 a[56:57], v7 offset:24576
 buffer_load_dwordx4 v2, s[8:11], s84 offen lds
 v_mfma_f32_16x16x32_bf16 v[96:99], a[28:31], v[248:251], v[96:99]
 s_waitcnt lgkmcnt(7)
 ds_read_b64_tr_b16 a[58:59], v7 offset:26624
 v_cvt_pk_bf16_f32 v83, v86, v87
 v_mfma_f32_16x16x32_bf16 v[92:95], a[32:35], v[128:131], 0
 s_add_u32 s42, s42, s3
 ds_read_b64_tr_b16 a[60:61], v7 offset:28672
 v_mul_f32 v88, v88, v64
 v_mfma_f32_16x16x32_bf16 v[92:95], a[36:39], v[136:139], v[92:95]
 s_add_u32 s58, s48, 974848
 ds_read_b64_tr_b16 a[62:63], v7 offset:30720
 v_xor_b32 v4, 0x20000, v4
 v_mfma_f32_16x16x32_bf16 v[92:95], a[40:43], v[144:147], v[92:95]
 s_waitcnt lgkmcnt(4)
 ds_read_b64_tr_b16 a[0:1], v4 offset:0
 buffer_store_dwordx4 v[80:83], v1, s[12:15], s58 offen sc1
 v_mfma_f32_16x16x32_bf16 v[92:95], a[44:47], v[152:155], v[92:95]
 s_mul_i32 s37, s42, 243712
 ds_read_b64_tr_b16 a[2:3], v4 offset:2048
 v_mul_f32 v89, v89, v64
 v_mfma_f32_16x16x32_bf16 v[92:95], a[48:51], v[160:163], v[92:95]
 s_add_u32 m0, s29, 61440
 ds_read_b64_tr_b16 a[4:5], v4 offset:4096
 v_mul_f32 v90, v90, v64
 v_mfma_f32_16x16x32_bf16 v[92:95], a[52:55], v[168:171], v[92:95]
 s_waitcnt lgkmcnt(3)
 ds_read_b64_tr_b16 a[6:7], v4 offset:6144
 buffer_load_dwordx4 v2, s[8:11], s85 offen lds
 v_mfma_f32_16x16x32_bf16 v[92:95], a[56:59], v[176:179], v[92:95]
 s_mul_i32 s43, s41, 17408
 ds_read_b64_tr_b16 a[8:9], v4 offset:8192
 v_add_u32 v2, 128, v2
 v_mfma_f32_16x16x32_bf16 v[92:95], a[60:63], v[184:187], v[92:95]
 s_add_u32 s37, s37, s43
 ds_read_b64_tr_b16 a[10:11], v4 offset:10240
 v_mul_f32 v91, v91, v64
 v_mfma_f32_16x16x32_bf16 v[100:103], a[32:35], v[192:195], 0
 s_add_u32 s37, s37, 117440512
 ds_read_b64_tr_b16 a[12:13], v4 offset:12288
 v_mul_f32 v96, v96, v65
 v_mfma_f32_16x16x32_bf16 v[100:103], a[36:39], v[200:203], v[100:103]
 s_add_u32 s38, s37, 121856
 ds_read_b64_tr_b16 a[14:15], v4 offset:14336
 v_mul_f32 v97, v97, v65
 v_mfma_f32_16x16x32_bf16 v[100:103], a[40:43], v[208:211], v[100:103]
 ds_read_b64_tr_b16 a[16:17], v4 offset:16384
 v_mul_f32 v98, v98, v65
 v_mfma_f32_16x16x32_bf16 v[100:103], a[44:47], v[216:219], v[100:103]
 ds_read_b64_tr_b16 a[18:19], v4 offset:18432
 v_mul_f32 v99, v99, v65
 v_mfma_f32_16x16x32_bf16 v[100:103], a[48:51], v[224:227], v[100:103]
 ds_read_b64_tr_b16 a[20:21], v4 offset:20480
 v_mul_f32 v92, v92, v64
 v_mfma_f32_16x16x32_bf16 v[100:103], a[52:55], v[232:235], v[100:103]
 ds_read_b64_tr_b16 a[22:23], v4 offset:22528
 v_mul_f32 v93, v93, v64
 v_mfma_f32_16x16x32_bf16 v[100:103], a[56:59], v[240:243], v[100:103]
 ds_read_b64_tr_b16 a[24:25], v4 offset:24576
 v_mul_f32 v94, v94, v64
 v_mfma_f32_16x16x32_bf16 v[100:103], a[60:63], v[248:251], v[100:103]
 s_waitcnt lgkmcnt(7)
 ds_read_b64_tr_b16 a[26:27], v4 offset:26624
 v_mul_f32 v95, v95, v64
 v_mfma_f32_16x16x32_bf16 v[104:107], a[0:3], v[128:131], 0
 ds_read_b64_tr_b16 a[28:29], v4 offset:28672
 v_cvt_pk_bf16_f32 v88, v88, v89
 v_mfma_f32_16x16x32_bf16 v[104:107], a[4:7], v[136:139], v[104:107]
 ds_read_b64_tr_b16 a[30:31], v4 offset:30720
 v_xor_b32 v5, 0x20000, v5
 v_mfma_f32_16x16x32_bf16 v[104:107], a[8:11], v[144:147], v[104:107]
 s_waitcnt lgkmcnt(4)
 ds_read_b64_tr_b16 a[32:33], v5 offset:0
 v_cvt_pk_bf16_f32 v89, v90, v91
 v_mfma_f32_16x16x32_bf16 v[104:107], a[12:15], v[152:155], v[104:107]
 s_add_u32 m0, s29, 65536
 ds_read_b64_tr_b16 a[34:35], v5 offset:2048
 v_cvt_pk_bf16_f32 v90, v92, v93
 v_mfma_f32_16x16x32_bf16 v[104:107], a[16:19], v[160:163], v[104:107]
 ds_read_b64_tr_b16 a[36:37], v5 offset:4096
 buffer_load_dwordx4 v2, s[8:11], s78 offen lds
 v_mfma_f32_16x16x32_bf16 v[104:107], a[20:23], v[168:171], v[104:107]
 s_waitcnt lgkmcnt(3)
 ds_read_b64_tr_b16 a[38:39], v5 offset:6144
 v_cvt_pk_bf16_f32 v91, v94, v95
 v_mfma_f32_16x16x32_bf16 v[104:107], a[24:27], v[176:179], v[104:107]
 s_add_u32 s58, s48, 17408
 ds_read_b64_tr_b16 a[40:41], v5 offset:8192
 v_mul_f32 v100, v100, v65
 v_mfma_f32_16x16x32_bf16 v[104:107], a[28:31], v[184:187], v[104:107]
 ds_read_b64_tr_b16 a[42:43], v5 offset:10240
 buffer_store_dwordx4 v[88:91], v1, s[12:15], s58 offen sc1
 v_mfma_f32_16x16x32_bf16 v[112:115], a[0:3], v[192:195], 0
 ds_read_b64_tr_b16 a[44:45], v5 offset:12288
 v_mul_f32 v101, v101, v65
 v_mfma_f32_16x16x32_bf16 v[112:115], a[4:7], v[200:203], v[112:115]
 ds_read_b64_tr_b16 a[46:47], v5 offset:14336
 v_mul_f32 v102, v102, v65
 v_mfma_f32_16x16x32_bf16 v[112:115], a[8:11], v[208:211], v[112:115]
 s_add_u32 m0, s29, 69632
 ds_read_b64_tr_b16 a[48:49], v5 offset:16384
 v_mul_f32 v103, v103, v65
 v_mfma_f32_16x16x32_bf16 v[112:115], a[12:15], v[216:219], v[112:115]
 ds_read_b64_tr_b16 a[50:51], v5 offset:18432
 buffer_load_dwordx4 v2, s[8:11], s79 offen lds
 v_mfma_f32_16x16x32_bf16 v[112:115], a[16:19], v[224:227], v[112:115]
 ds_read_b64_tr_b16 a[52:53], v5 offset:20480
 v_cvt_pk_bf16_f32 v96, v96, v97
 v_mfma_f32_16x16x32_bf16 v[112:115], a[20:23], v[232:235], v[112:115]
 ds_read_b64_tr_b16 a[54:55], v5 offset:22528
 v_cvt_pk_bf16_f32 v97, v98, v99
 v_mfma_f32_16x16x32_bf16 v[112:115], a[24:27], v[240:243], v[112:115]
 s_add_u32 s58, s48, 992256
 ds_read_b64_tr_b16 a[56:57], v5 offset:24576
 v_cvt_pk_bf16_f32 v98, v100, v101
 v_mfma_f32_16x16x32_bf16 v[112:115], a[28:31], v[248:251], v[112:115]
 s_waitcnt lgkmcnt(7)
 ds_read_b64_tr_b16 a[58:59], v5 offset:26624
 v_cvt_pk_bf16_f32 v99, v102, v103
 v_mfma_f32_16x16x32_bf16 v[108:111], a[32:35], v[128:131], 0
 ds_read_b64_tr_b16 a[60:61], v5 offset:28672
 buffer_store_dwordx4 v[96:99], v1, s[12:15], s58 offen sc1
 v_mfma_f32_16x16x32_bf16 v[108:111], a[36:39], v[136:139], v[108:111]
 s_add_u32 m0, s29, 73728
 ds_read_b64_tr_b16 a[62:63], v5 offset:30720
 v_xor_b32 v6, 0x20000, v6
 v_mfma_f32_16x16x32_bf16 v[108:111], a[40:43], v[144:147], v[108:111]
 s_waitcnt lgkmcnt(4)
 ds_read_b64_tr_b16 a[0:1], v6 offset:0
 buffer_load_dwordx4 v2, s[8:11], s80 offen lds
 v_mfma_f32_16x16x32_bf16 v[108:111], a[44:47], v[152:155], v[108:111]
 ds_read_b64_tr_b16 a[2:3], v6 offset:2048
 v_mul_f32 v104, v104, v64
 v_mfma_f32_16x16x32_bf16 v[108:111], a[48:51], v[160:163], v[108:111]
 ds_read_b64_tr_b16 a[4:5], v6 offset:4096
 v_mul_f32 v105, v105, v64
 v_mfma_f32_16x16x32_bf16 v[108:111], a[52:55], v[168:171], v[108:111]
 s_waitcnt lgkmcnt(3)
 ds_read_b64_tr_b16 a[6:7], v6 offset:6144
 v_mul_f32 v106, v106, v64
 v_mfma_f32_16x16x32_bf16 v[108:111], a[56:59], v[176:179], v[108:111]
 ds_read_b64_tr_b16 a[8:9], v6 offset:8192
 v_mul_f32 v107, v107, v64
 v_mfma_f32_16x16x32_bf16 v[108:111], a[60:63], v[184:187], v[108:111]
 ds_read_b64_tr_b16 a[10:11], v6 offset:10240
 v_mul_f32 v112, v112, v65
 v_mfma_f32_16x16x32_bf16 v[116:119], a[32:35], v[192:195], 0
 s_add_u32 m0, s29, 77824
 ds_read_b64_tr_b16 a[12:13], v6 offset:12288
 v_mul_f32 v113, v113, v65
 v_mfma_f32_16x16x32_bf16 v[116:119], a[36:39], v[200:203], v[116:119]
 ds_read_b64_tr_b16 a[14:15], v6 offset:14336
 buffer_load_dwordx4 v2, s[8:11], s81 offen lds
 v_mfma_f32_16x16x32_bf16 v[116:119], a[40:43], v[208:211], v[116:119]
 ds_read_b64_tr_b16 a[16:17], v6 offset:16384
 v_mul_f32 v114, v114, v65
 v_mfma_f32_16x16x32_bf16 v[116:119], a[44:47], v[216:219], v[116:119]
 ds_read_b64_tr_b16 a[18:19], v6 offset:18432
 v_mul_f32 v115, v115, v65
 v_mfma_f32_16x16x32_bf16 v[116:119], a[48:51], v[224:227], v[116:119]
 ds_read_b64_tr_b16 a[20:21], v6 offset:20480
 v_mul_f32 v108, v108, v64
 v_mfma_f32_16x16x32_bf16 v[116:119], a[52:55], v[232:235], v[116:119]
 ds_read_b64_tr_b16 a[22:23], v6 offset:22528
 v_mul_f32 v109, v109, v64
 v_mfma_f32_16x16x32_bf16 v[116:119], a[56:59], v[240:243], v[116:119]
 s_add_u32 m0, s29, 81920
 ds_read_b64_tr_b16 a[24:25], v6 offset:24576
 v_mul_f32 v110, v110, v64
 v_mfma_f32_16x16x32_bf16 v[116:119], a[60:63], v[248:251], v[116:119]
 s_waitcnt lgkmcnt(7)
 ds_read_b64_tr_b16 a[26:27], v6 offset:26624
 v_mul_f32 v111, v111, v64
 v_mfma_f32_16x16x32_bf16 v[72:75], a[0:3], v[128:131], 0
 ds_read_b64_tr_b16 a[28:29], v6 offset:28672
 buffer_load_dwordx4 v2, s[8:11], s82 offen lds
 v_mfma_f32_16x16x32_bf16 v[72:75], a[4:7], v[136:139], v[72:75]
 ds_read_b64_tr_b16 a[30:31], v6 offset:30720
 v_xor_b32 v7, 0x20000, v7
 v_mfma_f32_16x16x32_bf16 v[72:75], a[8:11], v[144:147], v[72:75]
 s_waitcnt lgkmcnt(4)
 ds_read_b64_tr_b16 a[32:33], v7 offset:0
 v_cvt_pk_bf16_f32 v104, v104, v105
 v_mfma_f32_16x16x32_bf16 v[72:75], a[12:15], v[152:155], v[72:75]
 ds_read_b64_tr_b16 a[34:35], v7 offset:2048
 v_cvt_pk_bf16_f32 v105, v106, v107
 v_mfma_f32_16x16x32_bf16 v[72:75], a[16:19], v[160:163], v[72:75]
 ds_read_b64_tr_b16 a[36:37], v7 offset:4096
 v_cvt_pk_bf16_f32 v106, v108, v109
 v_mfma_f32_16x16x32_bf16 v[72:75], a[20:23], v[168:171], v[72:75]
 s_waitcnt lgkmcnt(3)
 ds_read_b64_tr_b16 a[38:39], v7 offset:6144
 v_cvt_pk_bf16_f32 v107, v110, v111
 v_mfma_f32_16x16x32_bf16 v[72:75], a[24:27], v[176:179], v[72:75]
 s_add_u32 m0, s29, 86016
 ds_read_b64_tr_b16 a[40:41], v7 offset:8192
 v_mul_f32 v116, v116, v65
 v_mfma_f32_16x16x32_bf16 v[72:75], a[28:31], v[184:187], v[72:75]
 ds_read_b64_tr_b16 a[42:43], v7 offset:10240
 buffer_load_dwordx4 v2, s[8:11], s83 offen lds
 v_mfma_f32_16x16x32_bf16 v[80:83], a[0:3], v[192:195], 0
 s_add_u32 s58, s48, 34816
 ds_read_b64_tr_b16 a[44:45], v7 offset:12288
 v_mul_f32 v117, v117, v65
 v_mfma_f32_16x16x32_bf16 v[80:83], a[4:7], v[200:203], v[80:83]
 ds_read_b64_tr_b16 a[46:47], v7 offset:14336
 buffer_store_dwordx4 v[104:107], v1, s[12:15], s58 offen sc1
 v_mfma_f32_16x16x32_bf16 v[80:83], a[8:11], v[208:211], v[80:83]
 ds_read_b64_tr_b16 a[48:49], v7 offset:16384
 v_mul_f32 v118, v118, v65
 v_mfma_f32_16x16x32_bf16 v[80:83], a[12:15], v[216:219], v[80:83]
 ds_read_b64_tr_b16 a[50:51], v7 offset:18432
 v_mul_f32 v119, v119, v65
 v_mfma_f32_16x16x32_bf16 v[80:83], a[16:19], v[224:227], v[80:83]
 ds_read_b64_tr_b16 a[52:53], v7 offset:20480
 v_cvt_pk_bf16_f32 v112, v112, v113
 v_mfma_f32_16x16x32_bf16 v[80:83], a[20:23], v[232:235], v[80:83]
 s_add_u32 m0, s29, 90112
 ds_read_b64_tr_b16 a[54:55], v7 offset:22528
 v_cvt_pk_bf16_f32 v113, v114, v115
 v_mfma_f32_16x16x32_bf16 v[80:83], a[24:27], v[240:243], v[80:83]
 ds_read_b64_tr_b16 a[56:57], v7 offset:24576
 buffer_load_dwordx4 v2, s[8:11], s84 offen lds
 v_mfma_f32_16x16x32_bf16 v[80:83], a[28:31], v[248:251], v[80:83]
 s_waitcnt lgkmcnt(7)
 ds_read_b64_tr_b16 a[58:59], v7 offset:26624
 v_cvt_pk_bf16_f32 v114, v116, v117
 v_mfma_f32_16x16x32_bf16 v[76:79], a[32:35], v[128:131], 0
 s_waitcnt vmcnt(10)
 ds_read_b64_tr_b16 a[60:61], v7 offset:28672
 v_cvt_pk_bf16_f32 v115, v118, v119
 v_mfma_f32_16x16x32_bf16 v[76:79], a[36:39], v[136:139], v[76:79]
 s_barrier
 ds_read_b64_tr_b16 a[62:63], v7 offset:30720
 v_mul_f32 v72, v72, v64
 v_mfma_f32_16x16x32_bf16 v[76:79], a[40:43], v[144:147], v[76:79]
 s_waitcnt lgkmcnt(4)
 ds_read_b64_tr_b16 a[0:1], v4 offset:32768
 v_mul_f32 v73, v73, v64
 v_mfma_f32_16x16x32_bf16 v[76:79], a[44:47], v[152:155], v[76:79]
 ds_read_b64_tr_b16 a[2:3], v4 offset:34816
 v_mul_f32 v74, v74, v64
 v_mfma_f32_16x16x32_bf16 v[76:79], a[48:51], v[160:163], v[76:79]
 s_add_u32 m0, s29, 94208
 ds_read_b64_tr_b16 a[4:5], v4 offset:36864
 v_mul_f32 v75, v75, v64
 v_mfma_f32_16x16x32_bf16 v[76:79], a[52:55], v[168:171], v[76:79]
 s_waitcnt lgkmcnt(3)
 ds_read_b64_tr_b16 a[6:7], v4 offset:38912
 buffer_load_dwordx4 v2, s[8:11], s85 offen lds
 v_mfma_f32_16x16x32_bf16 v[76:79], a[56:59], v[176:179], v[76:79]
 s_add_u32 s58, s48, 1009664
 ds_read_b64_tr_b16 a[8:9], v4 offset:40960
 v_add_u32 v2, 128, v2
 v_mfma_f32_16x16x32_bf16 v[76:79], a[60:63], v[184:187], v[76:79]
 ds_read_b64_tr_b16 a[10:11], v4 offset:43008
 buffer_store_dwordx4 v[112:115], v1, s[12:15], s58 offen sc1
 v_mfma_f32_16x16x32_bf16 v[84:87], a[32:35], v[192:195], 0
 ds_read_b64_tr_b16 a[12:13], v4 offset:45056
 v_mul_f32 v80, v80, v65
 v_mfma_f32_16x16x32_bf16 v[84:87], a[36:39], v[200:203], v[84:87]
 ds_read_b64_tr_b16 a[14:15], v4 offset:47104
 v_mul_f32 v81, v81, v65
 v_mfma_f32_16x16x32_bf16 v[84:87], a[40:43], v[208:211], v[84:87]
 ds_read_b64_tr_b16 a[16:17], v4 offset:49152
 v_mul_f32 v82, v82, v65
 v_mfma_f32_16x16x32_bf16 v[84:87], a[44:47], v[216:219], v[84:87]
 ds_read_b64_tr_b16 a[18:19], v4 offset:51200
 v_mul_f32 v83, v83, v65
 v_mfma_f32_16x16x32_bf16 v[84:87], a[48:51], v[224:227], v[84:87]
 ds_read_b64_tr_b16 a[20:21], v4 offset:53248
 v_mul_f32 v76, v76, v64
 v_mfma_f32_16x16x32_bf16 v[84:87], a[52:55], v[232:235], v[84:87]
 ds_read_b64_tr_b16 a[22:23], v4 offset:55296
 v_mul_f32 v77, v77, v64
 v_mfma_f32_16x16x32_bf16 v[84:87], a[56:59], v[240:243], v[84:87]
 ds_read_b64_tr_b16 a[24:25], v4 offset:57344
 v_mul_f32 v78, v78, v64
 v_mfma_f32_16x16x32_bf16 v[84:87], a[60:63], v[248:251], v[84:87]
 s_waitcnt lgkmcnt(7)
 ds_read_b64_tr_b16 a[26:27], v4 offset:59392
 v_mul_f32 v79, v79, v64
 v_mfma_f32_16x16x32_bf16 v[88:91], a[0:3], v[128:131], 0
 ds_read_b64_tr_b16 a[28:29], v4 offset:61440
 v_cvt_pk_bf16_f32 v72, v72, v73
 v_mfma_f32_16x16x32_bf16 v[88:91], a[4:7], v[136:139], v[88:91]
 ds_read_b64_tr_b16 a[30:31], v4 offset:63488
 v_cvt_pk_bf16_f32 v73, v74, v75
 v_mfma_f32_16x16x32_bf16 v[88:91], a[8:11], v[144:147], v[88:91]
 s_waitcnt lgkmcnt(4)
 ds_read_b64_tr_b16 a[32:33], v5 offset:32768
 v_cvt_pk_bf16_f32 v74, v76, v77
 v_mfma_f32_16x16x32_bf16 v[88:91], a[12:15], v[152:155], v[88:91]
 s_add_u32 m0, s29, 98304
 ds_read_b64_tr_b16 a[34:35], v5 offset:34816
 v_cvt_pk_bf16_f32 v75, v78, v79
 v_mfma_f32_16x16x32_bf16 v[88:91], a[16:19], v[160:163], v[88:91]
 ds_read_b64_tr_b16 a[36:37], v5 offset:36864
 buffer_load_dwordx4 v2, s[8:11], s78 offen lds
 v_mfma_f32_16x16x32_bf16 v[88:91], a[20:23], v[168:171], v[88:91]
 s_waitcnt lgkmcnt(3)
 ds_read_b64_tr_b16 a[38:39], v5 offset:38912
 v_mul_f32 v84, v84, v65
 v_mfma_f32_16x16x32_bf16 v[88:91], a[24:27], v[176:179], v[88:91]
 s_add_u32 s58, s48, 52224
 ds_read_b64_tr_b16 a[40:41], v5 offset:40960
 v_mul_f32 v85, v85, v65
 v_mfma_f32_16x16x32_bf16 v[88:91], a[28:31], v[184:187], v[88:91]
 ds_read_b64_tr_b16 a[42:43], v5 offset:43008
 buffer_store_dwordx4 v[72:75], v1, s[12:15], s58 offen sc1
 v_mfma_f32_16x16x32_bf16 v[96:99], a[0:3], v[192:195], 0
 ds_read_b64_tr_b16 a[44:45], v5 offset:45056
 v_mul_f32 v86, v86, v65
 v_mfma_f32_16x16x32_bf16 v[96:99], a[4:7], v[200:203], v[96:99]
 ds_read_b64_tr_b16 a[46:47], v5 offset:47104
 v_mul_f32 v87, v87, v65
 v_mfma_f32_16x16x32_bf16 v[96:99], a[8:11], v[208:211], v[96:99]
 s_add_u32 m0, s29, 102400
 ds_read_b64_tr_b16 a[48:49], v5 offset:49152
 v_cvt_pk_bf16_f32 v80, v80, v81
 v_mfma_f32_16x16x32_bf16 v[96:99], a[12:15], v[216:219], v[96:99]
 ds_read_b64_tr_b16 a[50:51], v5 offset:51200
 buffer_load_dwordx4 v2, s[8:11], s79 offen lds
 v_mfma_f32_16x16x32_bf16 v[96:99], a[16:19], v[224:227], v[96:99]
 ds_read_b64_tr_b16 a[52:53], v5 offset:53248
 v_cvt_pk_bf16_f32 v81, v82, v83
 v_mfma_f32_16x16x32_bf16 v[96:99], a[20:23], v[232:235], v[96:99]
 ds_read_b64_tr_b16 a[54:55], v5 offset:55296
 v_cvt_pk_bf16_f32 v82, v84, v85
 v_mfma_f32_16x16x32_bf16 v[96:99], a[24:27], v[240:243], v[96:99]
 s_add_u32 s58, s48, 1027072
 ds_read_b64_tr_b16 a[56:57], v5 offset:57344
 v_cvt_pk_bf16_f32 v83, v86, v87
 v_mfma_f32_16x16x32_bf16 v[96:99], a[28:31], v[248:251], v[96:99]
 s_waitcnt lgkmcnt(7)
 ds_read_b64_tr_b16 a[58:59], v5 offset:59392
 buffer_store_dwordx4 v[80:83], v1, s[12:15], s58 offen sc1
 v_mfma_f32_16x16x32_bf16 v[92:95], a[32:35], v[128:131], 0
 ds_read_b64_tr_b16 a[60:61], v5 offset:61440
 v_mul_f32 v88, v88, v64
 v_mfma_f32_16x16x32_bf16 v[92:95], a[36:39], v[136:139], v[92:95]
 s_add_u32 m0, s29, 106496
 ds_read_b64_tr_b16 a[62:63], v5 offset:63488
 v_mul_f32 v89, v89, v64
 v_mfma_f32_16x16x32_bf16 v[92:95], a[40:43], v[144:147], v[92:95]
 s_waitcnt lgkmcnt(4)
 ds_read_b64_tr_b16 a[0:1], v6 offset:32768
 buffer_load_dwordx4 v2, s[8:11], s80 offen lds
 v_mfma_f32_16x16x32_bf16 v[92:95], a[44:47], v[152:155], v[92:95]
 ds_read_b64_tr_b16 a[2:3], v6 offset:34816
 v_mul_f32 v90, v90, v64
 v_mfma_f32_16x16x32_bf16 v[92:95], a[48:51], v[160:163], v[92:95]
 ds_read_b64_tr_b16 a[4:5], v6 offset:36864
 v_mul_f32 v91, v91, v64
 v_mfma_f32_16x16x32_bf16 v[92:95], a[52:55], v[168:171], v[92:95]
 s_waitcnt lgkmcnt(3)
 ds_read_b64_tr_b16 a[6:7], v6 offset:38912
 v_mul_f32 v96, v96, v65
 v_mfma_f32_16x16x32_bf16 v[92:95], a[56:59], v[176:179], v[92:95]
 ds_read_b64_tr_b16 a[8:9], v6 offset:40960
 v_mul_f32 v97, v97, v65
 v_mfma_f32_16x16x32_bf16 v[92:95], a[60:63], v[184:187], v[92:95]
 ds_read_b64_tr_b16 a[10:11], v6 offset:43008
 v_mul_f32 v98, v98, v65
 v_mfma_f32_16x16x32_bf16 v[100:103], a[32:35], v[192:195], 0
 s_add_u32 m0, s29, 110592
 ds_read_b64_tr_b16 a[12:13], v6 offset:45056
 v_mul_f32 v99, v99, v65
 v_mfma_f32_16x16x32_bf16 v[100:103], a[36:39], v[200:203], v[100:103]
 ds_read_b64_tr_b16 a[14:15], v6 offset:47104
 buffer_load_dwordx4 v2, s[8:11], s81 offen lds
 v_mfma_f32_16x16x32_bf16 v[100:103], a[40:43], v[208:211], v[100:103]
 ds_read_b64_tr_b16 a[16:17], v6 offset:49152
 v_mfma_f32_16x16x32_bf16 v[100:103], a[44:47], v[216:219], v[100:103]
 ds_read_b64_tr_b16 a[18:19], v6 offset:51200
 v_mfma_f32_16x16x32_bf16 v[100:103], a[48:51], v[224:227], v[100:103]
 ds_read_b64_tr_b16 a[20:21], v6 offset:53248
 v_mul_f32 v92, v92, v64
 v_mfma_f32_16x16x32_bf16 v[100:103], a[52:55], v[232:235], v[100:103]
 ds_read_b64_tr_b16 a[22:23], v6 offset:55296
 v_mul_f32 v93, v93, v64
 v_mfma_f32_16x16x32_bf16 v[100:103], a[56:59], v[240:243], v[100:103]
 s_add_u32 m0, s29, 114688
 ds_read_b64_tr_b16 a[24:25], v6 offset:57344
 v_mul_f32 v94, v94, v64
 v_mfma_f32_16x16x32_bf16 v[100:103], a[60:63], v[248:251], v[100:103]
 s_waitcnt lgkmcnt(7)
 ds_read_b64_tr_b16 a[26:27], v6 offset:59392
 v_mul_f32 v95, v95, v64
 v_mfma_f32_16x16x32_bf16 v[104:107], a[0:3], v[128:131], 0
 ds_read_b64_tr_b16 a[28:29], v6 offset:61440
 buffer_load_dwordx4 v2, s[8:11], s82 offen lds
 v_mfma_f32_16x16x32_bf16 v[104:107], a[4:7], v[136:139], v[104:107]
 ds_read_b64_tr_b16 a[30:31], v6 offset:63488
 v_cvt_pk_bf16_f32 v88, v88, v89
 v_mfma_f32_16x16x32_bf16 v[104:107], a[8:11], v[144:147], v[104:107]
 s_waitcnt lgkmcnt(4)
 ds_read_b64_tr_b16 a[32:33], v7 offset:32768
 v_cvt_pk_bf16_f32 v89, v90, v91
 v_mfma_f32_16x16x32_bf16 v[104:107], a[12:15], v[152:155], v[104:107]
 ds_read_b64_tr_b16 a[34:35], v7 offset:34816
 v_cvt_pk_bf16_f32 v90, v92, v93
 v_mfma_f32_16x16x32_bf16 v[104:107], a[16:19], v[160:163], v[104:107]
 s_add_u32 s58, s48, 69632
 ds_read_b64_tr_b16 a[36:37], v7 offset:36864
 v_cvt_pk_bf16_f32 v91, v94, v95
 v_mfma_f32_16x16x32_bf16 v[104:107], a[20:23], v[168:171], v[104:107]
 s_waitcnt lgkmcnt(3)
 ds_read_b64_tr_b16 a[38:39], v7 offset:38912
 buffer_store_dwordx4 v[88:91], v1, s[12:15], s58 offen sc1
 v_mfma_f32_16x16x32_bf16 v[104:107], a[24:27], v[176:179], v[104:107]
 s_add_u32 m0, s29, 118784
 ds_read_b64_tr_b16 a[40:41], v7 offset:40960
 v_mul_f32 v100, v100, v65
 v_mfma_f32_16x16x32_bf16 v[104:107], a[28:31], v[184:187], v[104:107]
 ds_read_b64_tr_b16 a[42:43], v7 offset:43008
 buffer_load_dwordx4 v2, s[8:11], s83 offen lds
 v_mfma_f32_16x16x32_bf16 v[112:115], a[0:3], v[192:195], 0
 ds_read_b64_tr_b16 a[44:45], v7 offset:45056
 v_mul_f32 v101, v101, v65
 v_mfma_f32_16x16x32_bf16 v[112:115], a[4:7], v[200:203], v[112:115]
 ds_read_b64_tr_b16 a[46:47], v7 offset:47104
 v_mul_f32 v102, v102, v65
 v_mfma_f32_16x16x32_bf16 v[112:115], a[8:11], v[208:211], v[112:115]
 ds_read_b64_tr_b16 a[48:49], v7 offset:49152
 v_mul_f32 v103, v103, v65
 v_mfma_f32_16x16x32_bf16 v[112:115], a[12:15], v[216:219], v[112:115]
 ds_read_b64_tr_b16 a[50:51], v7 offset:51200
 v_cvt_pk_bf16_f32 v96, v96, v97
 v_mfma_f32_16x16x32_bf16 v[112:115], a[16:19], v[224:227], v[112:115]
 ds_read_b64_tr_b16 a[52:53], v7 offset:53248
 v_cvt_pk_bf16_f32 v97, v98, v99
 v_mfma_f32_16x16x32_bf16 v[112:115], a[20:23], v[232:235], v[112:115]
 s_add_u32 m0, s29, 122880
 ds_read_b64_tr_b16 a[54:55], v7 offset:55296
 v_cvt_pk_bf16_f32 v98, v100, v101
 v_mfma_f32_16x16x32_bf16 v[112:115], a[24:27], v[240:243], v[112:115]
 ds_read_b64_tr_b16 a[56:57], v7 offset:57344
 buffer_load_dwordx4 v2, s[8:11], s84 offen lds
 v_mfma_f32_16x16x32_bf16 v[112:115], a[28:31], v[248:251], v[112:115]
 s_waitcnt lgkmcnt(7)
 ds_read_b64_tr_b16 a[58:59], v7 offset:59392
 v_cvt_pk_bf16_f32 v99, v102, v103
 v_mfma_f32_16x16x32_bf16 v[108:111], a[32:35], v[128:131], 0
 s_waitcnt vmcnt(11)
 ds_read_b64_tr_b16 a[60:61], v7 offset:61440
 v_mul_f32 v104, v104, v64
 v_mfma_f32_16x16x32_bf16 v[108:111], a[36:39], v[136:139], v[108:111]
 s_barrier
 ds_read_b64_tr_b16 a[62:63], v7 offset:63488
 v_xor_b32 v4, 0x10000, v4
 v_mfma_f32_16x16x32_bf16 v[108:111], a[40:43], v[144:147], v[108:111]
 s_waitcnt lgkmcnt(4)
 ds_read_b64_tr_b16 a[0:1], v4 offset:0
 v_mul_f32 v105, v105, v64
 v_mfma_f32_16x16x32_bf16 v[108:111], a[44:47], v[152:155], v[108:111]
 ds_read_b64_tr_b16 a[2:3], v4 offset:2048
 v_mul_f32 v106, v106, v64
 v_mfma_f32_16x16x32_bf16 v[108:111], a[48:51], v[160:163], v[108:111]
 s_add_u32 m0, s29, 126976
 ds_read_b64_tr_b16 a[4:5], v4 offset:4096
 v_mul_f32 v107, v107, v64
 v_mfma_f32_16x16x32_bf16 v[108:111], a[52:55], v[168:171], v[108:111]
 s_waitcnt lgkmcnt(3)
 ds_read_b64_tr_b16 a[6:7], v4 offset:6144
 buffer_load_dwordx4 v2, s[8:11], s85 offen lds
 v_mfma_f32_16x16x32_bf16 v[108:111], a[56:59], v[176:179], v[108:111]
 s_add_u32 s58, s48, 1044480
 ds_read_b64_tr_b16 a[8:9], v4 offset:8192
 v_add_u32 v2, 128, v2
 v_mfma_f32_16x16x32_bf16 v[108:111], a[60:63], v[184:187], v[108:111]
 ds_read_b64_tr_b16 a[10:11], v4 offset:10240
 buffer_store_dwordx4 v[96:99], v1, s[12:15], s58 offen sc1
 v_mfma_f32_16x16x32_bf16 v[116:119], a[32:35], v[192:195], 0
 ds_read_b64_tr_b16 a[12:13], v4 offset:12288
 v_mul_f32 v112, v112, v65
 v_mfma_f32_16x16x32_bf16 v[116:119], a[36:39], v[200:203], v[116:119]
 ds_read_b64_tr_b16 a[14:15], v4 offset:14336
 v_mul_f32 v113, v113, v65
 v_mfma_f32_16x16x32_bf16 v[116:119], a[40:43], v[208:211], v[116:119]
 ds_read_b64_tr_b16 a[16:17], v4 offset:16384
 v_mul_f32 v114, v114, v65
 v_mfma_f32_16x16x32_bf16 v[116:119], a[44:47], v[216:219], v[116:119]
 ds_read_b64_tr_b16 a[18:19], v4 offset:18432
 v_mul_f32 v115, v115, v65
 v_mfma_f32_16x16x32_bf16 v[116:119], a[48:51], v[224:227], v[116:119]
 ds_read_b64_tr_b16 a[20:21], v4 offset:20480
 v_mul_f32 v108, v108, v64
 v_mfma_f32_16x16x32_bf16 v[116:119], a[52:55], v[232:235], v[116:119]
 ds_read_b64_tr_b16 a[22:23], v4 offset:22528
 v_mul_f32 v109, v109, v64
 v_mfma_f32_16x16x32_bf16 v[116:119], a[56:59], v[240:243], v[116:119]
 ds_read_b64_tr_b16 a[24:25], v4 offset:24576
 v_mul_f32 v110, v110, v64
 v_mfma_f32_16x16x32_bf16 v[116:119], a[60:63], v[248:251], v[116:119]
 s_waitcnt lgkmcnt(7)
 ds_read_b64_tr_b16 a[26:27], v4 offset:26624
 v_mul_f32 v111, v111, v64
 v_mfma_f32_16x16x32_bf16 v[72:75], a[0:3], v[128:131], 0
 ds_read_b64_tr_b16 a[28:29], v4 offset:28672
 v_cvt_pk_bf16_f32 v104, v104, v105
 v_mfma_f32_16x16x32_bf16 v[72:75], a[4:7], v[136:139], v[72:75]
 ds_read_b64_tr_b16 a[30:31], v4 offset:30720
 v_xor_b32 v5, 0x10000, v5
 v_mfma_f32_16x16x32_bf16 v[72:75], a[8:11], v[144:147], v[72:75]
 s_waitcnt lgkmcnt(4)
 ds_read_b64_tr_b16 a[32:33], v5 offset:0
 v_cvt_pk_bf16_f32 v105, v106, v107
 v_mfma_f32_16x16x32_bf16 v[72:75], a[12:15], v[152:155], v[72:75]
 s_add_u32 m0, s29, 131072
 ds_read_b64_tr_b16 a[34:35], v5 offset:2048
 v_cvt_pk_bf16_f32 v106, v108, v109
 v_mfma_f32_16x16x32_bf16 v[72:75], a[16:19], v[160:163], v[72:75]
 ds_read_b64_tr_b16 a[36:37], v5 offset:4096
 buffer_load_dwordx4 v2, s[8:11], s78 offen lds
 v_mfma_f32_16x16x32_bf16 v[72:75], a[20:23], v[168:171], v[72:75]
 s_waitcnt lgkmcnt(3)
 ds_read_b64_tr_b16 a[38:39], v5 offset:6144
 v_cvt_pk_bf16_f32 v107, v110, v111
 v_mfma_f32_16x16x32_bf16 v[72:75], a[24:27], v[176:179], v[72:75]
 s_add_u32 s58, s48, 87040
 ds_read_b64_tr_b16 a[40:41], v5 offset:8192
 v_mul_f32 v116, v116, v65
 v_mfma_f32_16x16x32_bf16 v[72:75], a[28:31], v[184:187], v[72:75]
 ds_read_b64_tr_b16 a[42:43], v5 offset:10240
 buffer_store_dwordx4 v[104:107], v1, s[12:15], s58 offen sc1
 v_mfma_f32_16x16x32_bf16 v[80:83], a[0:3], v[192:195], 0
 ds_read_b64_tr_b16 a[44:45], v5 offset:12288
 v_mul_f32 v117, v117, v65
 v_mfma_f32_16x16x32_bf16 v[80:83], a[4:7], v[200:203], v[80:83]
 ds_read_b64_tr_b16 a[46:47], v5 offset:14336
 v_mul_f32 v118, v118, v65
 v_mfma_f32_16x16x32_bf16 v[80:83], a[8:11], v[208:211], v[80:83]
 s_add_u32 m0, s29, 135168
 ds_read_b64_tr_b16 a[48:49], v5 offset:16384
 v_mul_f32 v119, v119, v65
 v_mfma_f32_16x16x32_bf16 v[80:83], a[12:15], v[216:219], v[80:83]
 ds_read_b64_tr_b16 a[50:51], v5 offset:18432
 buffer_load_dwordx4 v2, s[8:11], s79 offen lds
 v_mfma_f32_16x16x32_bf16 v[80:83], a[16:19], v[224:227], v[80:83]
 ds_read_b64_tr_b16 a[52:53], v5 offset:20480
 v_cvt_pk_bf16_f32 v112, v112, v113
 v_mfma_f32_16x16x32_bf16 v[80:83], a[20:23], v[232:235], v[80:83]
 ds_read_b64_tr_b16 a[54:55], v5 offset:22528
 v_cvt_pk_bf16_f32 v113, v114, v115
 v_mfma_f32_16x16x32_bf16 v[80:83], a[24:27], v[240:243], v[80:83]
 s_add_u32 s58, s48, 1061888
 ds_read_b64_tr_b16 a[56:57], v5 offset:24576
 v_cvt_pk_bf16_f32 v114, v116, v117
 v_mfma_f32_16x16x32_bf16 v[80:83], a[28:31], v[248:251], v[80:83]
 s_waitcnt lgkmcnt(7)
 ds_read_b64_tr_b16 a[58:59], v5 offset:26624
 v_cvt_pk_bf16_f32 v115, v118, v119
 v_mfma_f32_16x16x32_bf16 v[76:79], a[32:35], v[128:131], 0
 ds_read_b64_tr_b16 a[60:61], v5 offset:28672
 buffer_store_dwordx4 v[112:115], v1, s[12:15], s58 offen sc1
 v_mfma_f32_16x16x32_bf16 v[76:79], a[36:39], v[136:139], v[76:79]
 s_add_u32 m0, s29, 139264
 ds_read_b64_tr_b16 a[62:63], v5 offset:30720
 v_xor_b32 v6, 0x10000, v6
 v_mfma_f32_16x16x32_bf16 v[76:79], a[40:43], v[144:147], v[76:79]
 s_waitcnt lgkmcnt(4)
 ds_read_b64_tr_b16 a[0:1], v6 offset:0
 buffer_load_dwordx4 v2, s[8:11], s80 offen lds
 v_mfma_f32_16x16x32_bf16 v[76:79], a[44:47], v[152:155], v[76:79]
 ds_read_b64_tr_b16 a[2:3], v6 offset:2048
 v_mul_f32 v72, v72, v64
 v_mfma_f32_16x16x32_bf16 v[76:79], a[48:51], v[160:163], v[76:79]
 ds_read_b64_tr_b16 a[4:5], v6 offset:4096
 v_mul_f32 v73, v73, v64
 v_mfma_f32_16x16x32_bf16 v[76:79], a[52:55], v[168:171], v[76:79]
 s_waitcnt lgkmcnt(3)
 ds_read_b64_tr_b16 a[6:7], v6 offset:6144
 v_mul_f32 v74, v74, v64
 v_mfma_f32_16x16x32_bf16 v[76:79], a[56:59], v[176:179], v[76:79]
 ds_read_b64_tr_b16 a[8:9], v6 offset:8192
 v_mul_f32 v75, v75, v64
 v_mfma_f32_16x16x32_bf16 v[76:79], a[60:63], v[184:187], v[76:79]
 ds_read_b64_tr_b16 a[10:11], v6 offset:10240
 v_mul_f32 v80, v80, v65
 v_mfma_f32_16x16x32_bf16 v[84:87], a[32:35], v[192:195], 0
 s_add_u32 m0, s29, 143360
 ds_read_b64_tr_b16 a[12:13], v6 offset:12288
 v_mul_f32 v81, v81, v65
 v_mfma_f32_16x16x32_bf16 v[84:87], a[36:39], v[200:203], v[84:87]
 ds_read_b64_tr_b16 a[14:15], v6 offset:14336
 buffer_load_dwordx4 v2, s[8:11], s81 offen lds
 v_mfma_f32_16x16x32_bf16 v[84:87], a[40:43], v[208:211], v[84:87]
 ds_read_b64_tr_b16 a[16:17], v6 offset:16384
 v_mul_f32 v82, v82, v65
 v_mfma_f32_16x16x32_bf16 v[84:87], a[44:47], v[216:219], v[84:87]
 ds_read_b64_tr_b16 a[18:19], v6 offset:18432
 v_mul_f32 v83, v83, v65
 v_mfma_f32_16x16x32_bf16 v[84:87], a[48:51], v[224:227], v[84:87]
 ds_read_b64_tr_b16 a[20:21], v6 offset:20480
 v_mul_f32 v76, v76, v64
 v_mfma_f32_16x16x32_bf16 v[84:87], a[52:55], v[232:235], v[84:87]
 ds_read_b64_tr_b16 a[22:23], v6 offset:22528
 v_mul_f32 v77, v77, v64
 v_mfma_f32_16x16x32_bf16 v[84:87], a[56:59], v[240:243], v[84:87]
 s_add_u32 m0, s29, 147456
 ds_read_b64_tr_b16 a[24:25], v6 offset:24576
 v_mul_f32 v78, v78, v64
 v_mfma_f32_16x16x32_bf16 v[84:87], a[60:63], v[248:251], v[84:87]
 s_waitcnt lgkmcnt(7)
 ds_read_b64_tr_b16 a[26:27], v6 offset:26624
 v_mul_f32 v79, v79, v64
 v_mfma_f32_16x16x32_bf16 v[88:91], a[0:3], v[128:131], 0
 ds_read_b64_tr_b16 a[28:29], v6 offset:28672
 buffer_load_dwordx4 v2, s[8:11], s82 offen lds
 v_mfma_f32_16x16x32_bf16 v[88:91], a[4:7], v[136:139], v[88:91]
 ds_read_b64_tr_b16 a[30:31], v6 offset:30720
 v_xor_b32 v7, 0x10000, v7
 v_mfma_f32_16x16x32_bf16 v[88:91], a[8:11], v[144:147], v[88:91]
 s_waitcnt lgkmcnt(4)
 ds_read_b64_tr_b16 a[32:33], v7 offset:0
 v_cvt_pk_bf16_f32 v72, v72, v73
 v_mfma_f32_16x16x32_bf16 v[88:91], a[12:15], v[152:155], v[88:91]
 ds_read_b64_tr_b16 a[34:35], v7 offset:2048
 v_cvt_pk_bf16_f32 v73, v74, v75
 v_mfma_f32_16x16x32_bf16 v[88:91], a[16:19], v[160:163], v[88:91]
 ds_read_b64_tr_b16 a[36:37], v7 offset:4096
 v_cvt_pk_bf16_f32 v74, v76, v77
 v_mfma_f32_16x16x32_bf16 v[88:91], a[20:23], v[168:171], v[88:91]
 s_waitcnt lgkmcnt(3)
 ds_read_b64_tr_b16 a[38:39], v7 offset:6144
 v_cvt_pk_bf16_f32 v75, v78, v79
 v_mfma_f32_16x16x32_bf16 v[88:91], a[24:27], v[176:179], v[88:91]
 s_add_u32 m0, s29, 151552
 ds_read_b64_tr_b16 a[40:41], v7 offset:8192
 v_mul_f32 v84, v84, v65
 v_mfma_f32_16x16x32_bf16 v[88:91], a[28:31], v[184:187], v[88:91]
 ds_read_b64_tr_b16 a[42:43], v7 offset:10240
 buffer_load_dwordx4 v2, s[8:11], s83 offen lds
 v_mfma_f32_16x16x32_bf16 v[96:99], a[0:3], v[192:195], 0
 s_add_u32 s58, s48, 104448
 ds_read_b64_tr_b16 a[44:45], v7 offset:12288
 v_mul_f32 v85, v85, v65
 v_mfma_f32_16x16x32_bf16 v[96:99], a[4:7], v[200:203], v[96:99]
 ds_read_b64_tr_b16 a[46:47], v7 offset:14336
 buffer_store_dwordx4 v[72:75], v1, s[12:15], s58 offen sc1
 v_mfma_f32_16x16x32_bf16 v[96:99], a[8:11], v[208:211], v[96:99]
 ds_read_b64_tr_b16 a[48:49], v7 offset:16384
 v_mul_f32 v86, v86, v65
 v_mfma_f32_16x16x32_bf16 v[96:99], a[12:15], v[216:219], v[96:99]
 ds_read_b64_tr_b16 a[50:51], v7 offset:18432
 v_mul_f32 v87, v87, v65
 v_mfma_f32_16x16x32_bf16 v[96:99], a[16:19], v[224:227], v[96:99]
 ds_read_b64_tr_b16 a[52:53], v7 offset:20480
 v_cvt_pk_bf16_f32 v80, v80, v81
 v_mfma_f32_16x16x32_bf16 v[96:99], a[20:23], v[232:235], v[96:99]
 s_add_u32 m0, s29, 155648
 ds_read_b64_tr_b16 a[54:55], v7 offset:22528
 v_cvt_pk_bf16_f32 v81, v82, v83
 v_mfma_f32_16x16x32_bf16 v[96:99], a[24:27], v[240:243], v[96:99]
 ds_read_b64_tr_b16 a[56:57], v7 offset:24576
 buffer_load_dwordx4 v2, s[8:11], s84 offen lds
 v_mfma_f32_16x16x32_bf16 v[96:99], a[28:31], v[248:251], v[96:99]
 s_waitcnt lgkmcnt(7)
 ds_read_b64_tr_b16 a[58:59], v7 offset:26624
 v_cvt_pk_bf16_f32 v82, v84, v85
 v_mfma_f32_16x16x32_bf16 v[92:95], a[32:35], v[128:131], 0
 s_waitcnt vmcnt(11)
 ds_read_b64_tr_b16 a[60:61], v7 offset:28672
 v_cvt_pk_bf16_f32 v83, v86, v87
 v_mfma_f32_16x16x32_bf16 v[92:95], a[36:39], v[136:139], v[92:95]
 s_barrier
 ds_read_b64_tr_b16 a[62:63], v7 offset:30720
 v_mul_f32 v88, v88, v64
 v_mfma_f32_16x16x32_bf16 v[92:95], a[40:43], v[144:147], v[92:95]
 s_waitcnt lgkmcnt(4)
 ds_read_b64_tr_b16 a[0:1], v4 offset:32768
 v_mul_f32 v89, v89, v64
 v_mfma_f32_16x16x32_bf16 v[92:95], a[44:47], v[152:155], v[92:95]
 ds_read_b64_tr_b16 a[2:3], v4 offset:34816
 v_mul_f32 v90, v90, v64
 v_mfma_f32_16x16x32_bf16 v[92:95], a[48:51], v[160:163], v[92:95]
 s_add_u32 m0, s29, 159744
 ds_read_b64_tr_b16 a[4:5], v4 offset:36864
 v_mul_f32 v91, v91, v64
 v_mfma_f32_16x16x32_bf16 v[92:95], a[52:55], v[168:171], v[92:95]
 s_waitcnt lgkmcnt(3)
 ds_read_b64_tr_b16 a[6:7], v4 offset:38912
 buffer_load_dwordx4 v2, s[8:11], s85 offen lds
 v_mfma_f32_16x16x32_bf16 v[92:95], a[56:59], v[176:179], v[92:95]
 s_add_u32 s58, s48, 1079296
 ds_read_b64_tr_b16 a[8:9], v4 offset:40960
 v_add_u32 v2, 128, v2
 v_mfma_f32_16x16x32_bf16 v[92:95], a[60:63], v[184:187], v[92:95]
 ds_read_b64_tr_b16 a[10:11], v4 offset:43008
 buffer_store_dwordx4 v[80:83], v1, s[12:15], s58 offen sc1
 v_mfma_f32_16x16x32_bf16 v[100:103], a[32:35], v[192:195], 0
 ds_read_b64_tr_b16 a[12:13], v4 offset:45056
 v_mul_f32 v96, v96, v65
 v_mfma_f32_16x16x32_bf16 v[100:103], a[36:39], v[200:203], v[100:103]
 ds_read_b64_tr_b16 a[14:15], v4 offset:47104
 v_mul_f32 v97, v97, v65
 v_mfma_f32_16x16x32_bf16 v[100:103], a[40:43], v[208:211], v[100:103]
 ds_read_b64_tr_b16 a[16:17], v4 offset:49152
 v_mul_f32 v98, v98, v65
 v_mfma_f32_16x16x32_bf16 v[100:103], a[44:47], v[216:219], v[100:103]
 ds_read_b64_tr_b16 a[18:19], v4 offset:51200
 v_mul_f32 v99, v99, v65
 v_mfma_f32_16x16x32_bf16 v[100:103], a[48:51], v[224:227], v[100:103]
 ds_read_b64_tr_b16 a[20:21], v4 offset:53248
 v_mul_f32 v92, v92, v64
 v_mfma_f32_16x16x32_bf16 v[100:103], a[52:55], v[232:235], v[100:103]
 ds_read_b64_tr_b16 a[22:23], v4 offset:55296
 v_mul_f32 v93, v93, v64
 v_mfma_f32_16x16x32_bf16 v[100:103], a[56:59], v[240:243], v[100:103]
 ds_read_b64_tr_b16 a[24:25], v4 offset:57344
 v_mul_f32 v94, v94, v64
 v_mfma_f32_16x16x32_bf16 v[100:103], a[60:63], v[248:251], v[100:103]
 s_waitcnt lgkmcnt(7)
 ds_read_b64_tr_b16 a[26:27], v4 offset:59392
 v_mul_f32 v95, v95, v64
 v_mfma_f32_16x16x32_bf16 v[104:107], a[0:3], v[128:131], 0
 ds_read_b64_tr_b16 a[28:29], v4 offset:61440
 v_cvt_pk_bf16_f32 v88, v88, v89
 v_mfma_f32_16x16x32_bf16 v[104:107], a[4:7], v[136:139], v[104:107]
 ds_read_b64_tr_b16 a[30:31], v4 offset:63488
 v_cvt_pk_bf16_f32 v89, v90, v91
 v_mfma_f32_16x16x32_bf16 v[104:107], a[8:11], v[144:147], v[104:107]
 s_waitcnt lgkmcnt(4)
 ds_read_b64_tr_b16 a[32:33], v5 offset:32768
 v_cvt_pk_bf16_f32 v90, v92, v93
 v_mfma_f32_16x16x32_bf16 v[104:107], a[12:15], v[152:155], v[104:107]
 s_add_u32 m0, s29, 0
 ds_read_b64_tr_b16 a[34:35], v5 offset:34816
 v_cvt_pk_bf16_f32 v91, v94, v95
 v_mfma_f32_16x16x32_bf16 v[104:107], a[16:19], v[160:163], v[104:107]
 ds_read_b64_tr_b16 a[36:37], v5 offset:36864
 buffer_load_dwordx4 v2, s[8:11], s78 offen lds
 v_mfma_f32_16x16x32_bf16 v[104:107], a[20:23], v[168:171], v[104:107]
 s_waitcnt lgkmcnt(3)
 ds_read_b64_tr_b16 a[38:39], v5 offset:38912
 v_mul_f32 v100, v100, v65
 v_mfma_f32_16x16x32_bf16 v[104:107], a[24:27], v[176:179], v[104:107]
 s_add_u32 s58, s48, 121856
 ds_read_b64_tr_b16 a[40:41], v5 offset:40960
 v_mul_f32 v101, v101, v65
 v_mfma_f32_16x16x32_bf16 v[104:107], a[28:31], v[184:187], v[104:107]
 ds_read_b64_tr_b16 a[42:43], v5 offset:43008
 buffer_store_dwordx4 v[88:91], v1, s[12:15], s58 offen sc1
 v_mfma_f32_16x16x32_bf16 v[112:115], a[0:3], v[192:195], 0
 ds_read_b64_tr_b16 a[44:45], v5 offset:45056
 v_mul_f32 v102, v102, v65
 v_mfma_f32_16x16x32_bf16 v[112:115], a[4:7], v[200:203], v[112:115]
 ds_read_b64_tr_b16 a[46:47], v5 offset:47104
 v_mul_f32 v103, v103, v65
 v_mfma_f32_16x16x32_bf16 v[112:115], a[8:11], v[208:211], v[112:115]
 s_add_u32 m0, s29, 4096
 ds_read_b64_tr_b16 a[48:49], v5 offset:49152
 v_cvt_pk_bf16_f32 v96, v96, v97
 v_mfma_f32_16x16x32_bf16 v[112:115], a[12:15], v[216:219], v[112:115]
 ds_read_b64_tr_b16 a[50:51], v5 offset:51200
 buffer_load_dwordx4 v2, s[8:11], s79 offen lds
 v_mfma_f32_16x16x32_bf16 v[112:115], a[16:19], v[224:227], v[112:115]
 ds_read_b64_tr_b16 a[52:53], v5 offset:53248
 v_cvt_pk_bf16_f32 v97, v98, v99
 v_mfma_f32_16x16x32_bf16 v[112:115], a[20:23], v[232:235], v[112:115]
 ds_read_b64_tr_b16 a[54:55], v5 offset:55296
 v_cvt_pk_bf16_f32 v98, v100, v101
 v_mfma_f32_16x16x32_bf16 v[112:115], a[24:27], v[240:243], v[112:115]
 s_add_u32 s58, s48, 1096704
 ds_read_b64_tr_b16 a[56:57], v5 offset:57344
 v_cvt_pk_bf16_f32 v99, v102, v103
 v_mfma_f32_16x16x32_bf16 v[112:115], a[28:31], v[248:251], v[112:115]
 s_waitcnt lgkmcnt(7)
 ds_read_b64_tr_b16 a[58:59], v5 offset:59392
 buffer_store_dwordx4 v[96:99], v1, s[12:15], s58 offen sc1
 v_mfma_f32_16x16x32_bf16 v[108:111], a[32:35], v[128:131], 0
 ds_read_b64_tr_b16 a[60:61], v5 offset:61440
 v_mul_f32 v104, v104, v64
 v_mfma_f32_16x16x32_bf16 v[108:111], a[36:39], v[136:139], v[108:111]
 s_add_u32 m0, s29, 8192
 ds_read_b64_tr_b16 a[62:63], v5 offset:63488
 v_mul_f32 v105, v105, v64
 v_mfma_f32_16x16x32_bf16 v[108:111], a[40:43], v[144:147], v[108:111]
 s_waitcnt lgkmcnt(4)
 ds_read_b64_tr_b16 a[0:1], v6 offset:32768
 buffer_load_dwordx4 v2, s[8:11], s80 offen lds
 v_mfma_f32_16x16x32_bf16 v[108:111], a[44:47], v[152:155], v[108:111]
 ds_read_b64_tr_b16 a[2:3], v6 offset:34816
 v_mul_f32 v106, v106, v64
 v_mfma_f32_16x16x32_bf16 v[108:111], a[48:51], v[160:163], v[108:111]
 ds_read_b64_tr_b16 a[4:5], v6 offset:36864
 v_mul_f32 v107, v107, v64
 v_mfma_f32_16x16x32_bf16 v[108:111], a[52:55], v[168:171], v[108:111]
 s_waitcnt lgkmcnt(3)
 ds_read_b64_tr_b16 a[6:7], v6 offset:38912
 v_mul_f32 v112, v112, v65
 v_mfma_f32_16x16x32_bf16 v[108:111], a[56:59], v[176:179], v[108:111]
 ds_read_b64_tr_b16 a[8:9], v6 offset:40960
 v_mul_f32 v113, v113, v65
 v_mfma_f32_16x16x32_bf16 v[108:111], a[60:63], v[184:187], v[108:111]
 ds_read_b64_tr_b16 a[10:11], v6 offset:43008
 v_mul_f32 v114, v114, v65
 v_mfma_f32_16x16x32_bf16 v[116:119], a[32:35], v[192:195], 0
 s_add_u32 m0, s29, 12288
 ds_read_b64_tr_b16 a[12:13], v6 offset:45056
 v_mul_f32 v115, v115, v65
 v_mfma_f32_16x16x32_bf16 v[116:119], a[36:39], v[200:203], v[116:119]
 ds_read_b64_tr_b16 a[14:15], v6 offset:47104
 buffer_load_dwordx4 v2, s[8:11], s81 offen lds
 v_mfma_f32_16x16x32_bf16 v[116:119], a[40:43], v[208:211], v[116:119]
 ds_read_b64_tr_b16 a[16:17], v6 offset:49152
 v_mfma_f32_16x16x32_bf16 v[116:119], a[44:47], v[216:219], v[116:119]
 ds_read_b64_tr_b16 a[18:19], v6 offset:51200
 v_mfma_f32_16x16x32_bf16 v[116:119], a[48:51], v[224:227], v[116:119]
 ds_read_b64_tr_b16 a[20:21], v6 offset:53248
 v_mul_f32 v108, v108, v64
 v_mfma_f32_16x16x32_bf16 v[116:119], a[52:55], v[232:235], v[116:119]
 ds_read_b64_tr_b16 a[22:23], v6 offset:55296
 v_mul_f32 v109, v109, v64
 v_mfma_f32_16x16x32_bf16 v[116:119], a[56:59], v[240:243], v[116:119]
 s_add_u32 m0, s29, 16384
 ds_read_b64_tr_b16 a[24:25], v6 offset:57344
 v_mul_f32 v110, v110, v64
 v_mfma_f32_16x16x32_bf16 v[116:119], a[60:63], v[248:251], v[116:119]
 s_waitcnt lgkmcnt(7)
 ds_read_b64_tr_b16 a[26:27], v6 offset:59392
 v_mul_f32 v111, v111, v64
 v_mfma_f32_16x16x32_bf16 v[72:75], a[0:3], v[128:131], 0
 ds_read_b64_tr_b16 a[28:29], v6 offset:61440
 buffer_load_dwordx4 v2, s[8:11], s82 offen lds
 v_mfma_f32_16x16x32_bf16 v[72:75], a[4:7], v[136:139], v[72:75]
 ds_read_b64_tr_b16 a[30:31], v6 offset:63488
 v_cvt_pk_bf16_f32 v104, v104, v105
 v_mfma_f32_16x16x32_bf16 v[72:75], a[8:11], v[144:147], v[72:75]
 s_waitcnt lgkmcnt(4)
 ds_read_b64_tr_b16 a[32:33], v7 offset:32768
 v_cvt_pk_bf16_f32 v105, v106, v107
 v_mfma_f32_16x16x32_bf16 v[72:75], a[12:15], v[152:155], v[72:75]
 ds_read_b64_tr_b16 a[34:35], v7 offset:34816
 v_cvt_pk_bf16_f32 v106, v108, v109
 v_mfma_f32_16x16x32_bf16 v[72:75], a[16:19], v[160:163], v[72:75]
 s_add_u32 s58, s48, 139264
 ds_read_b64_tr_b16 a[36:37], v7 offset:36864
 v_cvt_pk_bf16_f32 v107, v110, v111
 v_mfma_f32_16x16x32_bf16 v[72:75], a[20:23], v[168:171], v[72:75]
 s_waitcnt lgkmcnt(3)
 ds_read_b64_tr_b16 a[38:39], v7 offset:38912
 buffer_store_dwordx4 v[104:107], v1, s[12:15], s58 offen sc1
 v_mfma_f32_16x16x32_bf16 v[72:75], a[24:27], v[176:179], v[72:75]
 s_add_u32 m0, s29, 20480
 ds_read_b64_tr_b16 a[40:41], v7 offset:40960
 v_mul_f32 v116, v116, v65
 v_mfma_f32_16x16x32_bf16 v[72:75], a[28:31], v[184:187], v[72:75]
 ds_read_b64_tr_b16 a[42:43], v7 offset:43008
 buffer_load_dwordx4 v2, s[8:11], s83 offen lds
 v_mfma_f32_16x16x32_bf16 v[80:83], a[0:3], v[192:195], 0
 ds_read_b64_tr_b16 a[44:45], v7 offset:45056
 v_mul_f32 v117, v117, v65
 v_mfma_f32_16x16x32_bf16 v[80:83], a[4:7], v[200:203], v[80:83]
 ds_read_b64_tr_b16 a[46:47], v7 offset:47104
 v_mul_f32 v118, v118, v65
 v_mfma_f32_16x16x32_bf16 v[80:83], a[8:11], v[208:211], v[80:83]
 ds_read_b64_tr_b16 a[48:49], v7 offset:49152
 v_mul_f32 v119, v119, v65
 v_mfma_f32_16x16x32_bf16 v[80:83], a[12:15], v[216:219], v[80:83]
 ds_read_b64_tr_b16 a[50:51], v7 offset:51200
 v_cvt_pk_bf16_f32 v112, v112, v113
 v_mfma_f32_16x16x32_bf16 v[80:83], a[16:19], v[224:227], v[80:83]
 ds_read_b64_tr_b16 a[52:53], v7 offset:53248
 v_cvt_pk_bf16_f32 v113, v114, v115
 v_mfma_f32_16x16x32_bf16 v[80:83], a[20:23], v[232:235], v[80:83]
 s_add_u32 m0, s29, 24576
 ds_read_b64_tr_b16 a[54:55], v7 offset:55296
 v_cvt_pk_bf16_f32 v114, v116, v117
 v_mfma_f32_16x16x32_bf16 v[80:83], a[24:27], v[240:243], v[80:83]
 ds_read_b64_tr_b16 a[56:57], v7 offset:57344
 buffer_load_dwordx4 v2, s[8:11], s84 offen lds
 v_mfma_f32_16x16x32_bf16 v[80:83], a[28:31], v[248:251], v[80:83]
 s_waitcnt lgkmcnt(7)
 ds_read_b64_tr_b16 a[58:59], v7 offset:59392
 v_cvt_pk_bf16_f32 v115, v118, v119
 v_mfma_f32_16x16x32_bf16 v[76:79], a[32:35], v[128:131], 0
 s_waitcnt vmcnt(10)
 ds_read_b64_tr_b16 a[60:61], v7 offset:61440
 v_mul_f32 v72, v72, v64
 v_mfma_f32_16x16x32_bf16 v[76:79], a[36:39], v[136:139], v[76:79]
 s_barrier
 ds_read_b64_tr_b16 a[62:63], v7 offset:63488
 v_xor_b32 v4, 0x30000, v4
 v_mfma_f32_16x16x32_bf16 v[76:79], a[40:43], v[144:147], v[76:79]
 s_waitcnt lgkmcnt(4)
 ds_read_b64_tr_b16 a[0:1], v4 offset:0
 buffer_store_dword v9, v9, s[12:15], s93 offen offset:64 sc1
 v_mfma_f32_16x16x32_bf16 v[76:79], a[44:47], v[152:155], v[76:79]
 ds_read_b64_tr_b16 a[2:3], v4 offset:2048
 v_mul_f32 v73, v73, v64
 v_mfma_f32_16x16x32_bf16 v[76:79], a[48:51], v[160:163], v[76:79]
 s_add_u32 m0, s29, 28672
 ds_read_b64_tr_b16 a[4:5], v4 offset:4096
 v_mul_f32 v74, v74, v64
 v_mfma_f32_16x16x32_bf16 v[76:79], a[52:55], v[168:171], v[76:79]
 s_waitcnt lgkmcnt(3)
 ds_read_b64_tr_b16 a[6:7], v4 offset:6144
 buffer_load_dwordx4 v2, s[8:11], s85 offen lds
 v_mfma_f32_16x16x32_bf16 v[76:79], a[56:59], v[176:179], v[76:79]
 s_add_u32 s58, s48, 1114112
 ds_read_b64_tr_b16 a[8:9], v4 offset:8192
 v_add_u32 v2, 128, v2
 v_mfma_f32_16x16x32_bf16 v[76:79], a[60:63], v[184:187], v[76:79]
 ds_read_b64_tr_b16 a[10:11], v4 offset:10240
 buffer_store_dwordx4 v[112:115], v1, s[12:15], s58 offen sc1
 v_mfma_f32_16x16x32_bf16 v[84:87], a[32:35], v[192:195], 0
 ds_read_b64_tr_b16 a[12:13], v4 offset:12288
 v_mul_f32 v75, v75, v64
 v_mfma_f32_16x16x32_bf16 v[84:87], a[36:39], v[200:203], v[84:87]
 ds_read_b64_tr_b16 a[14:15], v4 offset:14336
 v_mul_f32 v80, v80, v65
 v_mfma_f32_16x16x32_bf16 v[84:87], a[40:43], v[208:211], v[84:87]
 ds_read_b64_tr_b16 a[16:17], v4 offset:16384
 v_mul_f32 v81, v81, v65
 v_mfma_f32_16x16x32_bf16 v[84:87], a[44:47], v[216:219], v[84:87]
 ds_read_b64_tr_b16 a[18:19], v4 offset:18432
 v_mul_f32 v82, v82, v65
 v_mfma_f32_16x16x32_bf16 v[84:87], a[48:51], v[224:227], v[84:87]
 ds_read_b64_tr_b16 a[20:21], v4 offset:20480
 v_mul_f32 v76, v76, v64
 v_mfma_f32_16x16x32_bf16 v[84:87], a[52:55], v[232:235], v[84:87]
 ds_read_b64_tr_b16 a[22:23], v4 offset:22528
 v_mul_f32 v77, v77, v64
 v_mfma_f32_16x16x32_bf16 v[84:87], a[56:59], v[240:243], v[84:87]
 ds_read_b64_tr_b16 a[24:25], v4 offset:24576
 v_mul_f32 v78, v78, v64
 v_mfma_f32_16x16x32_bf16 v[84:87], a[60:63], v[248:251], v[84:87]
 s_waitcnt lgkmcnt(7)
 ds_read_b64_tr_b16 a[26:27], v4 offset:26624
 v_mul_f32 v79, v79, v64
 v_mfma_f32_16x16x32_bf16 v[88:91], a[0:3], v[128:131], 0
 ds_read_b64_tr_b16 a[28:29], v4 offset:28672
 v_cvt_pk_bf16_f32 v72, v72, v73
 v_mfma_f32_16x16x32_bf16 v[88:91], a[4:7], v[136:139], v[88:91]
 ds_read_b64_tr_b16 a[30:31], v4 offset:30720
 v_xor_b32 v5, 0x30000, v5
 v_mfma_f32_16x16x32_bf16 v[88:91], a[8:11], v[144:147], v[88:91]
 s_waitcnt lgkmcnt(4)
 ds_read_b64_tr_b16 a[32:33], v5 offset:0
 v_cvt_pk_bf16_f32 v73, v74, v75
 v_mfma_f32_16x16x32_bf16 v[88:91], a[12:15], v[152:155], v[88:91]
 ds_read_b64_tr_b16 a[34:35], v5 offset:2048
 v_cvt_pk_bf16_f32 v74, v76, v77
 v_mfma_f32_16x16x32_bf16 v[88:91], a[16:19], v[160:163], v[88:91]
 s_add_u32 s58, s48, 156672
 ds_read_b64_tr_b16 a[36:37], v5 offset:4096
 v_cvt_pk_bf16_f32 v75, v78, v79
 v_mfma_f32_16x16x32_bf16 v[88:91], a[20:23], v[168:171], v[88:91]
 s_waitcnt lgkmcnt(3)
 ds_read_b64_tr_b16 a[38:39], v5 offset:6144
 buffer_store_dwordx4 v[72:75], v1, s[12:15], s58 offen sc1
 v_mfma_f32_16x16x32_bf16 v[88:91], a[24:27], v[176:179], v[88:91]
 ds_read_b64_tr_b16 a[40:41], v5 offset:8192
 v_mul_f32 v83, v83, v65
 v_mfma_f32_16x16x32_bf16 v[88:91], a[28:31], v[184:187], v[88:91]
 ds_read_b64_tr_b16 a[42:43], v5 offset:10240
 v_mul_f32 v84, v84, v65
 v_mfma_f32_16x16x32_bf16 v[96:99], a[0:3], v[192:195], 0
 ds_read_b64_tr_b16 a[44:45], v5 offset:12288
 v_mul_f32 v85, v85, v65
 v_mfma_f32_16x16x32_bf16 v[96:99], a[4:7], v[200:203], v[96:99]
 ds_read_b64_tr_b16 a[46:47], v5 offset:14336
 v_mul_f32 v86, v86, v65
 v_mfma_f32_16x16x32_bf16 v[96:99], a[8:11], v[208:211], v[96:99]
 ds_read_b64_tr_b16 a[48:49], v5 offset:16384
 v_mul_f32 v87, v87, v65
 v_mfma_f32_16x16x32_bf16 v[96:99], a[12:15], v[216:219], v[96:99]
 ds_read_b64_tr_b16 a[50:51], v5 offset:18432
 v_cvt_pk_bf16_f32 v80, v80, v81
 v_mfma_f32_16x16x32_bf16 v[96:99], a[16:19], v[224:227], v[96:99]
 ds_read_b64_tr_b16 a[52:53], v5 offset:20480
 v_cvt_pk_bf16_f32 v81, v82, v83
 v_mfma_f32_16x16x32_bf16 v[96:99], a[20:23], v[232:235], v[96:99]
 ds_read_b64_tr_b16 a[54:55], v5 offset:22528
 v_cvt_pk_bf16_f32 v82, v84, v85
 v_mfma_f32_16x16x32_bf16 v[96:99], a[24:27], v[240:243], v[96:99]
 s_add_u32 s58, s48, 1131520
 ds_read_b64_tr_b16 a[56:57], v5 offset:24576
 v_cvt_pk_bf16_f32 v83, v86, v87
 v_mfma_f32_16x16x32_bf16 v[96:99], a[28:31], v[248:251], v[96:99]
 s_waitcnt lgkmcnt(7)
 ds_read_b64_tr_b16 a[58:59], v5 offset:26624
 buffer_store_dwordx4 v[80:83], v1, s[12:15], s58 offen sc1
 v_mfma_f32_16x16x32_bf16 v[92:95], a[32:35], v[128:131], 0
 ds_read_b64_tr_b16 a[60:61], v5 offset:28672
 v_mul_f32 v88, v88, v64
 v_mfma_f32_16x16x32_bf16 v[92:95], a[36:39], v[136:139], v[92:95]
 ds_read_b64_tr_b16 a[62:63], v5 offset:30720
 v_xor_b32 v6, 0x30000, v6
 v_mfma_f32_16x16x32_bf16 v[92:95], a[40:43], v[144:147], v[92:95]
 s_waitcnt lgkmcnt(4)
 ds_read_b64_tr_b16 a[0:1], v6 offset:0
 v_mul_f32 v89, v89, v64
 v_mfma_f32_16x16x32_bf16 v[92:95], a[44:47], v[152:155], v[92:95]
 ds_read_b64_tr_b16 a[2:3], v6 offset:2048
 v_mul_f32 v90, v90, v64
 v_mfma_f32_16x16x32_bf16 v[92:95], a[48:51], v[160:163], v[92:95]
 ds_read_b64_tr_b16 a[4:5], v6 offset:4096
 v_mul_f32 v91, v91, v64
 v_mfma_f32_16x16x32_bf16 v[92:95], a[52:55], v[168:171], v[92:95]
 s_waitcnt lgkmcnt(3)
 ds_read_b64_tr_b16 a[6:7], v6 offset:6144
 v_mul_f32 v96, v96, v65
 v_mfma_f32_16x16x32_bf16 v[92:95], a[56:59], v[176:179], v[92:95]
 ds_read_b64_tr_b16 a[8:9], v6 offset:8192
 v_mul_f32 v97, v97, v65
 v_mfma_f32_16x16x32_bf16 v[92:95], a[60:63], v[184:187], v[92:95]
 ds_read_b64_tr_b16 a[10:11], v6 offset:10240
 v_mul_f32 v98, v98, v65
 v_mfma_f32_16x16x32_bf16 v[100:103], a[32:35], v[192:195], 0
 ds_read_b64_tr_b16 a[12:13], v6 offset:12288
 v_mul_f32 v99, v99, v65
 v_mfma_f32_16x16x32_bf16 v[100:103], a[36:39], v[200:203], v[100:103]
 ds_read_b64_tr_b16 a[14:15], v6 offset:14336
 v_mfma_f32_16x16x32_bf16 v[100:103], a[40:43], v[208:211], v[100:103]
 ds_read_b64_tr_b16 a[16:17], v6 offset:16384
 v_mfma_f32_16x16x32_bf16 v[100:103], a[44:47], v[216:219], v[100:103]
 ds_read_b64_tr_b16 a[18:19], v6 offset:18432
 v_mfma_f32_16x16x32_bf16 v[100:103], a[48:51], v[224:227], v[100:103]
 ds_read_b64_tr_b16 a[20:21], v6 offset:20480
 v_mul_f32 v92, v92, v64
 v_mfma_f32_16x16x32_bf16 v[100:103], a[52:55], v[232:235], v[100:103]
 ds_read_b64_tr_b16 a[22:23], v6 offset:22528
 v_mul_f32 v93, v93, v64
 v_mfma_f32_16x16x32_bf16 v[100:103], a[56:59], v[240:243], v[100:103]
 ds_read_b64_tr_b16 a[24:25], v6 offset:24576
 v_mul_f32 v94, v94, v64
 v_mfma_f32_16x16x32_bf16 v[100:103], a[60:63], v[248:251], v[100:103]
 s_waitcnt lgkmcnt(7)
 ds_read_b64_tr_b16 a[26:27], v6 offset:26624
 v_mul_f32 v95, v95, v64
 v_mfma_f32_16x16x32_bf16 v[104:107], a[0:3], v[128:131], 0
 ds_read_b64_tr_b16 a[28:29], v6 offset:28672
 v_cvt_pk_bf16_f32 v88, v88, v89
 v_mfma_f32_16x16x32_bf16 v[104:107], a[4:7], v[136:139], v[104:107]
 ds_read_b64_tr_b16 a[30:31], v6 offset:30720
 v_xor_b32 v7, 0x30000, v7
 v_mfma_f32_16x16x32_bf16 v[104:107], a[8:11], v[144:147], v[104:107]
 s_waitcnt lgkmcnt(4)
 ds_read_b64_tr_b16 a[32:33], v7 offset:0
 v_cvt_pk_bf16_f32 v89, v90, v91
 v_mfma_f32_16x16x32_bf16 v[104:107], a[12:15], v[152:155], v[104:107]
 ds_read_b64_tr_b16 a[34:35], v7 offset:2048
 v_cvt_pk_bf16_f32 v90, v92, v93
 v_mfma_f32_16x16x32_bf16 v[104:107], a[16:19], v[160:163], v[104:107]
 s_add_u32 s58, s48, 174080
 ds_read_b64_tr_b16 a[36:37], v7 offset:4096
 v_cvt_pk_bf16_f32 v91, v94, v95
 v_mfma_f32_16x16x32_bf16 v[104:107], a[20:23], v[168:171], v[104:107]
 s_waitcnt lgkmcnt(3)
 ds_read_b64_tr_b16 a[38:39], v7 offset:6144
 buffer_store_dwordx4 v[88:91], v1, s[12:15], s58 offen sc1
 v_mfma_f32_16x16x32_bf16 v[104:107], a[24:27], v[176:179], v[104:107]
 ds_read_b64_tr_b16 a[40:41], v7 offset:8192
 v_mul_f32 v100, v100, v65
 v_mfma_f32_16x16x32_bf16 v[104:107], a[28:31], v[184:187], v[104:107]
 ds_read_b64_tr_b16 a[42:43], v7 offset:10240
 v_mul_f32 v101, v101, v65
 v_mfma_f32_16x16x32_bf16 v[112:115], a[0:3], v[192:195], 0
 ds_read_b64_tr_b16 a[44:45], v7 offset:12288
 v_mul_f32 v102, v102, v65
 v_mfma_f32_16x16x32_bf16 v[112:115], a[4:7], v[200:203], v[112:115]
 ds_read_b64_tr_b16 a[46:47], v7 offset:14336
 v_mul_f32 v103, v103, v65
 v_mfma_f32_16x16x32_bf16 v[112:115], a[8:11], v[208:211], v[112:115]
 ds_read_b64_tr_b16 a[48:49], v7 offset:16384
 v_cvt_pk_bf16_f32 v96, v96, v97
 v_mfma_f32_16x16x32_bf16 v[112:115], a[12:15], v[216:219], v[112:115]
 ds_read_b64_tr_b16 a[50:51], v7 offset:18432
 v_cvt_pk_bf16_f32 v97, v98, v99
 v_mfma_f32_16x16x32_bf16 v[112:115], a[16:19], v[224:227], v[112:115]
 ds_read_b64_tr_b16 a[52:53], v7 offset:20480
 v_cvt_pk_bf16_f32 v98, v100, v101
 v_mfma_f32_16x16x32_bf16 v[112:115], a[20:23], v[232:235], v[112:115]
 s_add_u32 s58, s48, 1148928
 ds_read_b64_tr_b16 a[54:55], v7 offset:22528
 v_cvt_pk_bf16_f32 v99, v102, v103
 v_mfma_f32_16x16x32_bf16 v[112:115], a[24:27], v[240:243], v[112:115]
 ds_read_b64_tr_b16 a[56:57], v7 offset:24576
 buffer_store_dwordx4 v[96:99], v1, s[12:15], s58 offen sc1
 v_mfma_f32_16x16x32_bf16 v[112:115], a[28:31], v[248:251], v[112:115]
 s_waitcnt lgkmcnt(7)
 ds_read_b64_tr_b16 a[58:59], v7 offset:26624
 v_mul_f32 v104, v104, v64
 v_mfma_f32_16x16x32_bf16 v[108:111], a[32:35], v[128:131], 0
 s_waitcnt vmcnt(5)
 ds_read_b64_tr_b16 a[60:61], v7 offset:28672
 v_mul_f32 v105, v105, v64
 v_mfma_f32_16x16x32_bf16 v[108:111], a[36:39], v[136:139], v[108:111]
 s_barrier
 ds_read_b64_tr_b16 a[62:63], v7 offset:30720
 v_xor_b32 v4, 0x20000, v4
 v_mfma_f32_16x16x32_bf16 v[108:111], a[40:43], v[144:147], v[108:111]
 s_waitcnt lgkmcnt(4)
 ds_read_b64_tr_b16 a[0:1], v4 offset:0
 v_mul_f32 v106, v106, v64
 v_mfma_f32_16x16x32_bf16 v[108:111], a[44:47], v[152:155], v[108:111]
 ds_read_b64_tr_b16 a[2:3], v4 offset:2048
 v_mul_f32 v107, v107, v64
 v_mfma_f32_16x16x32_bf16 v[108:111], a[48:51], v[160:163], v[108:111]
 ds_read_b64_tr_b16 a[4:5], v4 offset:4096
 v_mul_f32 v112, v112, v65
 v_mfma_f32_16x16x32_bf16 v[108:111], a[52:55], v[168:171], v[108:111]
 s_waitcnt lgkmcnt(3)
 ds_read_b64_tr_b16 a[6:7], v4 offset:6144
 v_mul_f32 v113, v113, v65
 v_mfma_f32_16x16x32_bf16 v[108:111], a[56:59], v[176:179], v[108:111]
 ds_read_b64_tr_b16 a[8:9], v4 offset:8192
 v_mul_f32 v114, v114, v65
 v_mfma_f32_16x16x32_bf16 v[108:111], a[60:63], v[184:187], v[108:111]
 ds_read_b64_tr_b16 a[10:11], v4 offset:10240
 v_mul_f32 v115, v115, v65
 v_mfma_f32_16x16x32_bf16 v[116:119], a[32:35], v[192:195], 0
 ds_read_b64_tr_b16 a[12:13], v4 offset:12288
 v_mfma_f32_16x16x32_bf16 v[116:119], a[36:39], v[200:203], v[116:119]
 ds_read_b64_tr_b16 a[14:15], v4 offset:14336
 v_mfma_f32_16x16x32_bf16 v[116:119], a[40:43], v[208:211], v[116:119]
 ds_read_b64_tr_b16 a[16:17], v4 offset:16384
 v_mfma_f32_16x16x32_bf16 v[116:119], a[44:47], v[216:219], v[116:119]
 ds_read_b64_tr_b16 a[18:19], v4 offset:18432
 v_mfma_f32_16x16x32_bf16 v[116:119], a[48:51], v[224:227], v[116:119]
 ds_read_b64_tr_b16 a[20:21], v4 offset:20480
 v_mul_f32 v108, v108, v64
 v_mfma_f32_16x16x32_bf16 v[116:119], a[52:55], v[232:235], v[116:119]
 ds_read_b64_tr_b16 a[22:23], v4 offset:22528
 v_mul_f32 v109, v109, v64
 v_mfma_f32_16x16x32_bf16 v[116:119], a[56:59], v[240:243], v[116:119]
 ds_read_b64_tr_b16 a[24:25], v4 offset:24576
 v_mul_f32 v110, v110, v64
 v_mfma_f32_16x16x32_bf16 v[116:119], a[60:63], v[248:251], v[116:119]
 s_waitcnt lgkmcnt(7)
 ds_read_b64_tr_b16 a[26:27], v4 offset:26624
 v_mul_f32 v111, v111, v64
 v_mfma_f32_16x16x32_bf16 v[72:75], a[0:3], v[128:131], 0
 ds_read_b64_tr_b16 a[28:29], v4 offset:28672
 v_cvt_pk_bf16_f32 v104, v104, v105
 v_mfma_f32_16x16x32_bf16 v[72:75], a[4:7], v[136:139], v[72:75]
 ds_read_b64_tr_b16 a[30:31], v4 offset:30720
 v_xor_b32 v5, 0x20000, v5
 v_mfma_f32_16x16x32_bf16 v[72:75], a[8:11], v[144:147], v[72:75]
 s_waitcnt lgkmcnt(4)
 ds_read_b64_tr_b16 a[32:33], v5 offset:0
 v_cvt_pk_bf16_f32 v105, v106, v107
 v_mfma_f32_16x16x32_bf16 v[72:75], a[12:15], v[152:155], v[72:75]
 ds_read_b64_tr_b16 a[34:35], v5 offset:2048
 v_cvt_pk_bf16_f32 v106, v108, v109
 v_mfma_f32_16x16x32_bf16 v[72:75], a[16:19], v[160:163], v[72:75]
 s_add_u32 s58, s48, 191488
 ds_read_b64_tr_b16 a[36:37], v5 offset:4096
 v_cvt_pk_bf16_f32 v107, v110, v111
 v_mfma_f32_16x16x32_bf16 v[72:75], a[20:23], v[168:171], v[72:75]
 s_waitcnt lgkmcnt(3)
 ds_read_b64_tr_b16 a[38:39], v5 offset:6144
 buffer_store_dwordx4 v[104:107], v1, s[12:15], s58 offen sc1
 v_mfma_f32_16x16x32_bf16 v[72:75], a[24:27], v[176:179], v[72:75]
 ds_read_b64_tr_b16 a[40:41], v5 offset:8192
 v_mul_f32 v116, v116, v65
 v_mfma_f32_16x16x32_bf16 v[72:75], a[28:31], v[184:187], v[72:75]
 ds_read_b64_tr_b16 a[42:43], v5 offset:10240
 v_mul_f32 v117, v117, v65
 v_mfma_f32_16x16x32_bf16 v[80:83], a[0:3], v[192:195], 0
 ds_read_b64_tr_b16 a[44:45], v5 offset:12288
 v_mul_f32 v118, v118, v65
 v_mfma_f32_16x16x32_bf16 v[80:83], a[4:7], v[200:203], v[80:83]
 ds_read_b64_tr_b16 a[46:47], v5 offset:14336
 v_mul_f32 v119, v119, v65
 v_mfma_f32_16x16x32_bf16 v[80:83], a[8:11], v[208:211], v[80:83]
 ds_read_b64_tr_b16 a[48:49], v5 offset:16384
 v_cvt_pk_bf16_f32 v112, v112, v113
 v_mfma_f32_16x16x32_bf16 v[80:83], a[12:15], v[216:219], v[80:83]
 ds_read_b64_tr_b16 a[50:51], v5 offset:18432
 v_cvt_pk_bf16_f32 v113, v114, v115
 v_mfma_f32_16x16x32_bf16 v[80:83], a[16:19], v[224:227], v[80:83]
 ds_read_b64_tr_b16 a[52:53], v5 offset:20480
 v_cvt_pk_bf16_f32 v114, v116, v117
 v_mfma_f32_16x16x32_bf16 v[80:83], a[20:23], v[232:235], v[80:83]
 s_add_u32 s58, s48, 1166336
 ds_read_b64_tr_b16 a[54:55], v5 offset:22528
 v_cvt_pk_bf16_f32 v115, v118, v119
 v_mfma_f32_16x16x32_bf16 v[80:83], a[24:27], v[240:243], v[80:83]
 ds_read_b64_tr_b16 a[56:57], v5 offset:24576
 buffer_store_dwordx4 v[112:115], v1, s[12:15], s58 offen sc1
 v_mfma_f32_16x16x32_bf16 v[80:83], a[28:31], v[248:251], v[80:83]
 s_waitcnt lgkmcnt(7)
 ds_read_b64_tr_b16 a[58:59], v5 offset:26624
 v_mul_f32 v72, v72, v64
 v_mfma_f32_16x16x32_bf16 v[76:79], a[32:35], v[128:131], 0
 ds_read_b64_tr_b16 a[60:61], v5 offset:28672
 v_mul_f32 v73, v73, v64
 v_mfma_f32_16x16x32_bf16 v[76:79], a[36:39], v[136:139], v[76:79]
 ds_read_b64_tr_b16 a[62:63], v5 offset:30720
 v_xor_b32 v6, 0x20000, v6
 v_mfma_f32_16x16x32_bf16 v[76:79], a[40:43], v[144:147], v[76:79]
 s_waitcnt lgkmcnt(4)
 ds_read_b64_tr_b16 a[0:1], v6 offset:0
 v_mul_f32 v74, v74, v64
 v_mfma_f32_16x16x32_bf16 v[76:79], a[44:47], v[152:155], v[76:79]
 ds_read_b64_tr_b16 a[2:3], v6 offset:2048
 v_mul_f32 v75, v75, v64
 v_mfma_f32_16x16x32_bf16 v[76:79], a[48:51], v[160:163], v[76:79]
 ds_read_b64_tr_b16 a[4:5], v6 offset:4096
 v_mul_f32 v80, v80, v65
 v_mfma_f32_16x16x32_bf16 v[76:79], a[52:55], v[168:171], v[76:79]
 s_waitcnt lgkmcnt(3)
 ds_read_b64_tr_b16 a[6:7], v6 offset:6144
 v_mul_f32 v81, v81, v65
 v_mfma_f32_16x16x32_bf16 v[76:79], a[56:59], v[176:179], v[76:79]
 ds_read_b64_tr_b16 a[8:9], v6 offset:8192
 v_mul_f32 v82, v82, v65
 v_mfma_f32_16x16x32_bf16 v[76:79], a[60:63], v[184:187], v[76:79]
 ds_read_b64_tr_b16 a[10:11], v6 offset:10240
 v_mul_f32 v83, v83, v65
 v_mfma_f32_16x16x32_bf16 v[84:87], a[32:35], v[192:195], 0
 ds_read_b64_tr_b16 a[12:13], v6 offset:12288
 buffer_load_dword v12, v10, s[12:15], s44 offen sc1
 v_mfma_f32_16x16x32_bf16 v[84:87], a[36:39], v[200:203], v[84:87]
 ds_read_b64_tr_b16 a[14:15], v6 offset:14336
 v_mfma_f32_16x16x32_bf16 v[84:87], a[40:43], v[208:211], v[84:87]
 ds_read_b64_tr_b16 a[16:17], v6 offset:16384
 v_mfma_f32_16x16x32_bf16 v[84:87], a[44:47], v[216:219], v[84:87]
 ds_read_b64_tr_b16 a[18:19], v6 offset:18432
 v_mfma_f32_16x16x32_bf16 v[84:87], a[48:51], v[224:227], v[84:87]
 ds_read_b64_tr_b16 a[20:21], v6 offset:20480
 v_mul_f32 v76, v76, v64
 v_mfma_f32_16x16x32_bf16 v[84:87], a[52:55], v[232:235], v[84:87]
 ds_read_b64_tr_b16 a[22:23], v6 offset:22528
 v_mul_f32 v77, v77, v64
 v_mfma_f32_16x16x32_bf16 v[84:87], a[56:59], v[240:243], v[84:87]
 ds_read_b64_tr_b16 a[24:25], v6 offset:24576
 v_mul_f32 v78, v78, v64
 v_mfma_f32_16x16x32_bf16 v[84:87], a[60:63], v[248:251], v[84:87]
 s_waitcnt lgkmcnt(7)
 ds_read_b64_tr_b16 a[26:27], v6 offset:26624
 v_mul_f32 v79, v79, v64
 v_mfma_f32_16x16x32_bf16 v[88:91], a[0:3], v[128:131], 0
 ds_read_b64_tr_b16 a[28:29], v6 offset:28672
 v_cvt_pk_bf16_f32 v72, v72, v73
 v_mfma_f32_16x16x32_bf16 v[88:91], a[4:7], v[136:139], v[88:91]
 ds_read_b64_tr_b16 a[30:31], v6 offset:30720
 v_xor_b32 v7, 0x20000, v7
 v_mfma_f32_16x16x32_bf16 v[88:91], a[8:11], v[144:147], v[88:91]
 s_waitcnt lgkmcnt(4)
 ds_read_b64_tr_b16 a[32:33], v7 offset:0
 v_cvt_pk_bf16_f32 v73, v74, v75
 v_mfma_f32_16x16x32_bf16 v[88:91], a[12:15], v[152:155], v[88:91]
 ds_read_b64_tr_b16 a[34:35], v7 offset:2048
 v_cvt_pk_bf16_f32 v74, v76, v77
 v_mfma_f32_16x16x32_bf16 v[88:91], a[16:19], v[160:163], v[88:91]
 s_add_u32 s58, s48, 208896
 ds_read_b64_tr_b16 a[36:37], v7 offset:4096
 v_cvt_pk_bf16_f32 v75, v78, v79
 v_mfma_f32_16x16x32_bf16 v[88:91], a[20:23], v[168:171], v[88:91]
 s_waitcnt lgkmcnt(3)
 ds_read_b64_tr_b16 a[38:39], v7 offset:6144
 buffer_store_dwordx4 v[72:75], v1, s[12:15], s58 offen sc1
 v_mfma_f32_16x16x32_bf16 v[88:91], a[24:27], v[176:179], v[88:91]
 ds_read_b64_tr_b16 a[40:41], v7 offset:8192
 v_mul_f32 v84, v84, v65
 v_mfma_f32_16x16x32_bf16 v[88:91], a[28:31], v[184:187], v[88:91]
 ds_read_b64_tr_b16 a[42:43], v7 offset:10240
 v_mul_f32 v85, v85, v65
 v_mfma_f32_16x16x32_bf16 v[96:99], a[0:3], v[192:195], 0
 ds_read_b64_tr_b16 a[44:45], v7 offset:12288
 v_mul_f32 v86, v86, v65
 v_mfma_f32_16x16x32_bf16 v[96:99], a[4:7], v[200:203], v[96:99]
 ds_read_b64_tr_b16 a[46:47], v7 offset:14336
 v_mul_f32 v87, v87, v65
 v_mfma_f32_16x16x32_bf16 v[96:99], a[8:11], v[208:211], v[96:99]
 ds_read_b64_tr_b16 a[48:49], v7 offset:16384
 v_cvt_pk_bf16_f32 v80, v80, v81
 v_mfma_f32_16x16x32_bf16 v[96:99], a[12:15], v[216:219], v[96:99]
 ds_read_b64_tr_b16 a[50:51], v7 offset:18432
 v_cvt_pk_bf16_f32 v81, v82, v83
 v_mfma_f32_16x16x32_bf16 v[96:99], a[16:19], v[224:227], v[96:99]
 ds_read_b64_tr_b16 a[52:53], v7 offset:20480
 v_cvt_pk_bf16_f32 v82, v84, v85
 v_mfma_f32_16x16x32_bf16 v[96:99], a[20:23], v[232:235], v[96:99]
 s_add_u32 s58, s48, 1183744
 ds_read_b64_tr_b16 a[54:55], v7 offset:22528
 v_cvt_pk_bf16_f32 v83, v86, v87
 v_mfma_f32_16x16x32_bf16 v[96:99], a[24:27], v[240:243], v[96:99]
 ds_read_b64_tr_b16 a[56:57], v7 offset:24576
 buffer_store_dwordx4 v[80:83], v1, s[12:15], s58 offen sc1
 v_mfma_f32_16x16x32_bf16 v[96:99], a[28:31], v[248:251], v[96:99]
 s_waitcnt lgkmcnt(7)
 ds_read_b64_tr_b16 a[58:59], v7 offset:26624
 v_mul_f32 v88, v88, v64
 v_mfma_f32_16x16x32_bf16 v[92:95], a[32:35], v[128:131], 0
 ds_read_b64_tr_b16 a[60:61], v7 offset:28672
 v_mul_f32 v89, v89, v64
 v_mfma_f32_16x16x32_bf16 v[92:95], a[36:39], v[136:139], v[92:95]
 ds_read_b64_tr_b16 a[62:63], v7 offset:30720
 v_mul_f32 v90, v90, v64
 v_mfma_f32_16x16x32_bf16 v[92:95], a[40:43], v[144:147], v[92:95]
 s_waitcnt lgkmcnt(4)
 v_mul_f32 v91, v91, v64
 v_mfma_f32_16x16x32_bf16 v[92:95], a[44:47], v[152:155], v[92:95]
 v_mfma_f32_16x16x32_bf16 v[92:95], a[48:51], v[160:163], v[92:95]
 v_mul_f32 v96, v96, v65
 v_mul_f32 v97, v97, v65
 v_mfma_f32_16x16x32_bf16 v[92:95], a[52:55], v[168:171], v[92:95]
 s_waitcnt lgkmcnt(0)
 v_mul_f32 v98, v98, v65
 v_mul_f32 v99, v99, v65
 v_mfma_f32_16x16x32_bf16 v[92:95], a[56:59], v[176:179], v[92:95]
 v_mfma_f32_16x16x32_bf16 v[92:95], a[60:63], v[184:187], v[92:95]
 v_mfma_f32_16x16x32_bf16 v[100:103], a[32:35], v[192:195], 0
 v_mfma_f32_16x16x32_bf16 v[100:103], a[36:39], v[200:203], v[100:103]
 v_mfma_f32_16x16x32_bf16 v[100:103], a[40:43], v[208:211], v[100:103]
 v_mfma_f32_16x16x32_bf16 v[100:103], a[44:47], v[216:219], v[100:103]
 v_mfma_f32_16x16x32_bf16 v[100:103], a[48:51], v[224:227], v[100:103]
 v_mfma_f32_16x16x32_bf16 v[100:103], a[52:55], v[232:235], v[100:103]
 v_mfma_f32_16x16x32_bf16 v[100:103], a[56:59], v[240:243], v[100:103]
 v_mfma_f32_16x16x32_bf16 v[100:103], a[60:63], v[248:251], v[100:103]
 s_nop 4
 v_mul_f32 v92, v92, v64
 v_mul_f32 v93, v93, v64
 v_mul_f32 v94, v94, v64
 v_mul_f32 v95, v95, v64
 v_cvt_pk_bf16_f32 v88, v88, v89
 v_cvt_pk_bf16_f32 v89, v90, v91
 v_cvt_pk_bf16_f32 v90, v92, v93
 v_cvt_pk_bf16_f32 v91, v94, v95
 s_add_u32 s58, s48, 226304
 buffer_store_dwordx4 v[88:91], v1, s[12:15], s58 offen sc1
 v_mul_f32 v100, v100, v65
 v_mul_f32 v101, v101, v65
 v_mul_f32 v102, v102, v65
 v_mul_f32 v103, v103, v65
 v_cvt_pk_bf16_f32 v96, v96, v97
 v_cvt_pk_bf16_f32 v97, v98, v99
 v_cvt_pk_bf16_f32 v98, v100, v101
 v_cvt_pk_bf16_f32 v99, v102, v103
 s_add_u32 s58, s48, 1201152
 buffer_store_dwordx4 v[96:99], v1, s[12:15], s58 offen sc1
 s_cmp_ge_u32 s28, 14
 s_cbranch_scc1 L_idle
 s_waitcnt vmcnt(4)
 v_cmp_ne_u32 vcc, 0, v12
 s_cmp_eq_u64 vcc, 0
 s_cselect_b32 s50, 1, 0
 s_cselect_b32 s51, s38, 2.0
 s_lshl_b32 s42, s42, 4
 s_lshl_b32 s36, s41, 6
 s_add_u32 s36, s36, 896
 s_add_u32 s35, s36, 1835008
 s_add_u32 s39, s37, 15597568
 s_mov_b32 s8, s88
 s_mov_b32 s9, s89
 s_mov_b32 s10, 3670016
 s_mov_b32 s11, 0x20000
 v_and_b32 v2, 15, v0
 v_add_u32 v2, s42, v2
 v_mul_u32_u24 v7, 896, v2
 v_lshrrev_b32 v3, 4, v0
 v_lshlrev_b32 v8, 4, v3
 v_lshl_add_u32 v2, v7, 1, v8
 v_add_u32 v7, v7, v8
 v_and_b32 v4, 1, v0
 v_lshlrev_b32 v4, 4, v4
 v_mov_b32 v5, 0x3f80
 v_lshlrev_b32 v4, v4, v5
 v_bfe_u32 v5, v0, 3, 1
 v_bfe_u32 v6, v0, 1, 1
 v_lshl_add_u32 v5, v5, 1, v6
 v_bfe_u32 v6, v0, 2, 1
 v_lshlrev_b32 v6, 1, v6
 v_sub_u32 v6, v3, v6
 v_lshl_add_u32 v5, v6, 2, v5
 v_cmp_eq_u32 s[16:17], 0, v5
 v_cmp_eq_u32 s[18:19], 1, v5
 v_cmp_eq_u32 s[20:21], 2, v5
 v_cmp_eq_u32 s[22:23], 3, v5
 v_cndmask_b32 v24, 0, v4, s[16:17]
 v_cndmask_b32 v25, 0, v4, s[18:19]
 v_cndmask_b32 v26, 0, v4, s[20:21]
 v_cndmask_b32 v27, 0, v4, s[22:23]
 v_cmp_eq_u32 s[16:17], 4, v5
 v_cmp_eq_u32 s[18:19], 5, v5
 v_cmp_eq_u32 s[20:21], 6, v5
 v_cmp_eq_u32 s[22:23], 7, v5
 v_cndmask_b32 v28, 0, v4, s[16:17]
 v_cndmask_b32 v29, 0, v4, s[18:19]
 v_cndmask_b32 v30, 0, v4, s[20:21]
 v_cndmask_b32 v31, 0, v4, s[22:23]
 s_add_u32 s45, s44, 1024
 s_add_u32 s39, s39, 121856
 s_waitcnt vmcnt(0)
 s_barrier
 buffer_store_dword v9, v9, s[12:15], s93 offen sc1
 buffer_load_dwordx4 a[128:131], v1, s[12:15], s51 offen offset:0 sc1
 buffer_load_dwordx4 a[132:135], v1, s[12:15], s51 offen offset:1024 sc1
 buffer_load_dwordx4 a[136:139], v1, s[12:15], s51 offen offset:2048 sc1
 buffer_load_dwordx4 a[140:143], v1, s[12:15], s51 offen offset:3072 sc1
 s_add_u32 s51, s51, 4096
 buffer_load_dwordx4 a[144:147], v1, s[12:15], s51 offen offset:0 sc1
 buffer_load_dwordx4 a[148:151], v1, s[12:15], s51 offen offset:1024 sc1
 buffer_load_dwordx4 a[152:155], v1, s[12:15], s51 offen offset:2048 sc1
 buffer_load_dwordx4 a[156:159], v1, s[12:15], s51 offen offset:3072 sc1
 s_add_u32 s51, s51, 4096
 buffer_load_dwordx4 a[160:163], v1, s[12:15], s51 offen offset:0 sc1
 buffer_load_dwordx4 a[164:167], v1, s[12:15], s51 offen offset:1024 sc1
 buffer_load_dwordx4 a[168:171], v1, s[12:15], s51 offen offset:2048 sc1
 buffer_load_dwordx4 a[172:175], v1, s[12:15], s51 offen offset:3072 sc1
 s_add_u32 s51, s51, 4096
 buffer_load_dwordx4 a[176:179], v1, s[12:15], s51 offen offset:0 sc1
 buffer_load_dwordx4 a[180:183], v1, s[12:15], s51 offen offset:1024 sc1
 buffer_load_dwordx4 a[184:187], v1, s[12:15], s51 offen offset:2048 sc1
 buffer_load_dwordx4 a[188:191], v1, s[12:15], s51 offen offset:3072 sc1
 s_add_u32 s51, s51, 4096
 s_cmp_eq_u32 s50, 1
 s_cbranch_scc1 L_haveshort
 v_and_b32 v16, 15, v0
 v_lshlrev_b32 v16, 2, v16
 s_mov_b32 s32, 0
L_poll6:
 buffer_load_dword v17, v16, s[12:15], s44 offen sc1
 s_waitcnt vmcnt(0)
 v_cmp_ne_u32 vcc, 0, v17
 s_cbranch_vccz L_poll6_ok
 s_sleep 8
 s_add_u32 s32, s32, 1
 s_cmp_lt_u32 s32, 0x80000
 s_cbranch_scc1 L_poll6
L_poll6_ok:
 buffer_load_dwordx4 a[128:131], v1, s[12:15], s38 offen offset:0 sc1
 buffer_load_dwordx4 a[132:135], v1, s[12:15], s38 offen offset:1024 sc1
 buffer_load_dwordx4 a[136:139], v1, s[12:15], s38 offen offset:2048 sc1
 buffer_load_dwordx4 a[140:143], v1, s[12:15], s38 offen offset:3072 sc1
 s_add_u32 s38, s38, 4096
 buffer_load_dwordx4 a[144:147], v1, s[12:15], s38 offen offset:0 sc1
 buffer_load_dwordx4 a[148:151], v1, s[12:15], s38 offen offset:1024 sc1
 buffer_load_dwordx4 a[152:155], v1, s[12:15], s38 offen offset:2048 sc1
 buffer_load_dwordx4 a[156:159], v1, s[12:15], s38 offen offset:3072 sc1
 s_add_u32 s38, s38, 4096
 buffer_load_dwordx4 a[160:163], v1, s[12:15], s38 offen offset:0 sc1
 buffer_load_dwordx4 a[164:167], v1, s[12:15], s38 offen offset:1024 sc1
 buffer_load_dwordx4 a[168:171], v1, s[12:15], s38 offen offset:2048 sc1
 buffer_load_dwordx4 a[172:175], v1, s[12:15], s38 offen offset:3072 sc1
 s_add_u32 s38, s38, 4096
 buffer_load_dwordx4 a[176:179], v1, s[12:15], s38 offen offset:0 sc1
 buffer_load_dwordx4 a[180:183], v1, s[12:15], s38 offen offset:1024 sc1
 buffer_load_dwordx4 a[184:187], v1, s[12:15], s38 offen offset:2048 sc1
 buffer_load_dwordx4 a[188:191], v1, s[12:15], s38 offen offset:3072 sc1
 s_add_u32 s38, s38, 4096
L_haveshort:
 v_and_b32 v17, 15, v0
 v_lshlrev_b32 v17, 2, v17
 buffer_load_dword a246, v17, s[12:15], s45 offen sc1
 s_waitcnt vmcnt(16)
 v_mfma_f32_16x16x32_bf16 v[40:43], v[24:27], a[128:131], 0
 v_mfma_f32_16x16x32_bf16 v[44:47], v[28:31], a[128:131], 0
 s_waitcnt vmcnt(15)
 v_mfma_f32_16x16x32_bf16 v[40:43], v[24:27], a[132:135], v[40:43]
 v_mfma_f32_16x16x32_bf16 v[44:47], v[28:31], a[132:135], v[44:47]
 s_waitcnt vmcnt(14)
 v_mfma_f32_16x16x32_bf16 v[40:43], v[24:27], a[136:139], v[40:43]
 v_mfma_f32_16x16x32_bf16 v[44:47], v[28:31], a[136:139], v[44:47]
 s_waitcnt vmcnt(13)
 v_mfma_f32_16x16x32_bf16 v[40:43], v[24:27], a[140:143], v[40:43]
 v_mfma_f32_16x16x32_bf16 v[44:47], v[28:31], a[140:143], v[44:47]
 s_waitcnt vmcnt(12)
 v_mfma_f32_16x16x32_bf16 v[40:43], v[24:27], a[144:147], v[40:43]
 v_mfma_f32_16x16x32_bf16 v[44:47], v[28:31], a[144:147], v[44:47]
 s_waitcnt vmcnt(11)
 v_mfma_f32_16x16x32_bf16 v[40:43], v[24:27], a[148:151], v[40:43]
 v_mfma_f32_16x16x32_bf16 v[44:47], v[28:31], a[148:151], v[44:47]
 s_waitcnt vmcnt(10)
 v_mfma_f32_16x16x32_bf16 v[40:43], v[24:27], a[152:155], v[40:43]
 v_mfma_f32_16x16x32_bf16 v[44:47], v[28:31], a[152:155], v[44:47]
 s_waitcnt vmcnt(9)
 v_mfma_f32_16x16x32_bf16 v[40:43], v[24:27], a[156:159], v[40:43]
 v_mfma_f32_16x16x32_bf16 v[44:47], v[28:31], a[156:159], v[44:47]
 s_waitcnt vmcnt(8)
 v_mfma_f32_16x16x32_bf16 v[40:43], v[24:27], a[160:163], v[40:43]
 v_mfma_f32_16x16x32_bf16 v[44:47], v[28:31], a[160:163], v[44:47]
 s_waitcnt vmcnt(7)
 v_mfma_f32_16x16x32_bf16 v[40:43], v[24:27], a[164:167], v[40:43]
 v_mfma_f32_16x16x32_bf16 v[44:47], v[28:31], a[164:167], v[44:47]
 s_waitcnt vmcnt(6)
 v_mfma_f32_16x16x32_bf16 v[40:43], v[24:27], a[168:171], v[40:43]
 v_mfma_f32_16x16x32_bf16 v[44:47], v[28:31], a[168:171], v[44:47]
 s_waitcnt vmcnt(5)
 v_mfma_f32_16x16x32_bf16 v[40:43], v[24:27], a[172:175], v[40:43]
 v_mfma_f32_16x16x32_bf16 v[44:47], v[28:31], a[172:175], v[44:47]
 s_waitcnt vmcnt(4)
 v_mfma_f32_16x16x32_bf16 v[40:43], v[24:27], a[176:179], v[40:43]
 v_mfma_f32_16x16x32_bf16 v[44:47], v[28:31], a[176:179], v[44:47]
 s_waitcnt vmcnt(3)
 v_mfma_f32_16x16x32_bf16 v[40:43], v[24:27], a[180:183], v[40:43]
 v_mfma_f32_16x16x32_bf16 v[44:47], v[28:31], a[180:183], v[44:47]
 s_waitcnt vmcnt(2)
 v_mfma_f32_16x16x32_bf16 v[40:43], v[24:27], a[184:187], v[40:43]
 v_mfma_f32_16x16x32_bf16 v[44:47], v[28:31], a[184:187], v[44:47]
 s_waitcnt vmcnt(1)
 v_mfma_f32_16x16x32_bf16 v[40:43], v[24:27], a[188:191], v[40:43]
 v_mfma_f32_16x16x32_bf16 v[44:47], v[28:31], a[188:191], v[44:47]
 s_nop 7
 v_cvt_pk_bf16_f32 v40, v40, v41
 v_cvt_pk_bf16_f32 v41, v42, v43
 v_cvt_pk_bf16_f32 v42, v44, v45
 v_cvt_pk_bf16_f32 v43, v46, v47
 buffer_store_dwordx4 v[40:43], v2, s[8:11], s36 offen offset:448
 s_waitcnt vmcnt(1)
 s_waitcnt vmcnt(2)
 v_accvgpr_read_b32 v17, a246
 v_cmp_ne_u32 vcc, 0, v17
 s_cbranch_vccz L_poll7_ok
 v_and_b32 v16, 15, v0
 v_lshlrev_b32 v16, 2, v16
 s_mov_b32 s32, 0
L_poll7:
 buffer_load_dword v17, v16, s[12:15], s45 offen sc1
 s_waitcnt vmcnt(0)
 v_cmp_ne_u32 vcc, 0, v17
 s_cbranch_vccz L_poll7_ok
 s_sleep 8
 s_add_u32 s32, s32, 1
 s_cmp_lt_u32 s32, 0x80000
 s_cbranch_scc1 L_poll7
L_poll7_ok:
 buffer_load_dwordx4 a[0:3], v1, s[12:15], s39 offen offset:0 sc1
 buffer_load_dwordx4 a[4:7], v1, s[12:15], s39 offen offset:1024 sc1
 buffer_load_dwordx4 a[8:11], v1, s[12:15], s39 offen offset:2048 sc1
 buffer_load_dwordx4 a[12:15], v1, s[12:15], s39 offen offset:3072 sc1
 s_add_u32 s39, s39, 4096
 buffer_load_dwordx4 a[16:19], v1, s[12:15], s39 offen offset:0 sc1
 buffer_load_dwordx4 a[20:23], v1, s[12:15], s39 offen offset:1024 sc1
 buffer_load_dwordx4 a[24:27], v1, s[12:15], s39 offen offset:2048 sc1
 buffer_load_dwordx4 a[28:31], v1, s[12:15], s39 offen offset:3072 sc1
 s_add_u32 s39, s39, 4096
 buffer_load_dwordx4 a[32:35], v1, s[12:15], s39 offen offset:0 sc1
 buffer_load_dwordx4 a[36:39], v1, s[12:15], s39 offen offset:1024 sc1
 buffer_load_dwordx4 a[40:43], v1, s[12:15], s39 offen offset:2048 sc1
 buffer_load_dwordx4 a[44:47], v1, s[12:15], s39 offen offset:3072 sc1
 s_add_u32 s39, s39, 4096
 buffer_load_dwordx4 a[48:51], v1, s[12:15], s39 offen offset:0 sc1
 buffer_load_dwordx4 a[52:55], v1, s[12:15], s39 offen offset:1024 sc1
 buffer_load_dwordx4 a[56:59], v1, s[12:15], s39 offen offset:2048 sc1
 buffer_load_dwordx4 a[60:63], v1, s[12:15], s39 offen offset:3072 sc1
 s_add_u32 s39, s39, 4096
 s_waitcnt vmcnt(15)
 v_mfma_f32_16x16x32_bf16 v[48:51], v[24:27], a[0:3], 0
 v_mfma_f32_16x16x32_bf16 v[52:55], v[28:31], a[0:3], 0
 s_waitcnt vmcnt(14)
 v_mfma_f32_16x16x32_bf16 v[48:51], v[24:27], a[4:7], v[48:51]
 v_mfma_f32_16x16x32_bf16 v[52:55], v[28:31], a[4:7], v[52:55]
 s_waitcnt vmcnt(13)
 v_mfma_f32_16x16x32_bf16 v[48:51], v[24:27], a[8:11], v[48:51]
 v_mfma_f32_16x16x32_bf16 v[52:55], v[28:31], a[8:11], v[52:55]
 s_waitcnt vmcnt(12)
 v_mfma_f32_16x16x32_bf16 v[48:51], v[24:27], a[12:15], v[48:51]
 v_mfma_f32_16x16x32_bf16 v[52:55], v[28:31], a[12:15], v[52:55]
 s_waitcnt vmcnt(11)
 v_mfma_f32_16x16x32_bf16 v[48:51], v[24:27], a[16:19], v[48:51]
 v_mfma_f32_16x16x32_bf16 v[52:55], v[28:31], a[16:19], v[52:55]
 s_waitcnt vmcnt(10)
 v_mfma_f32_16x16x32_bf16 v[48:51], v[24:27], a[20:23], v[48:51]
 v_mfma_f32_16x16x32_bf16 v[52:55], v[28:31], a[20:23], v[52:55]
 s_waitcnt vmcnt(9)
 v_mfma_f32_16x16x32_bf16 v[48:51], v[24:27], a[24:27], v[48:51]
 v_mfma_f32_16x16x32_bf16 v[52:55], v[28:31], a[24:27], v[52:55]
 s_waitcnt vmcnt(8)
 v_mfma_f32_16x16x32_bf16 v[48:51], v[24:27], a[28:31], v[48:51]
 v_mfma_f32_16x16x32_bf16 v[52:55], v[28:31], a[28:31], v[52:55]
 s_waitcnt vmcnt(7)
 v_mfma_f32_16x16x32_bf16 v[48:51], v[24:27], a[32:35], v[48:51]
 v_mfma_f32_16x16x32_bf16 v[52:55], v[28:31], a[32:35], v[52:55]
 s_waitcnt vmcnt(6)
 v_mfma_f32_16x16x32_bf16 v[48:51], v[24:27], a[36:39], v[48:51]
 v_mfma_f32_16x16x32_bf16 v[52:55], v[28:31], a[36:39], v[52:55]
 s_waitcnt vmcnt(5)
 v_mfma_f32_16x16x32_bf16 v[48:51], v[24:27], a[40:43], v[48:51]
 v_mfma_f32_16x16x32_bf16 v[52:55], v[28:31], a[40:43], v[52:55]
 s_waitcnt vmcnt(4)
 v_mfma_f32_16x16x32_bf16 v[48:51], v[24:27], a[44:47], v[48:51]
 v_mfma_f32_16x16x32_bf16 v[52:55], v[28:31], a[44:47], v[52:55]
 s_waitcnt vmcnt(3)
 v_mfma_f32_16x16x32_bf16 v[48:51], v[24:27], a[48:51], v[48:51]
 v_mfma_f32_16x16x32_bf16 v[52:55], v[28:31], a[48:51], v[52:55]
 s_waitcnt vmcnt(2)
 v_mfma_f32_16x16x32_bf16 v[48:51], v[24:27], a[52:55], v[48:51]
 v_mfma_f32_16x16x32_bf16 v[52:55], v[28:31], a[52:55], v[52:55]
 s_waitcnt vmcnt(1)
 v_mfma_f32_16x16x32_bf16 v[48:51], v[24:27], a[56:59], v[48:51]
 v_mfma_f32_16x16x32_bf16 v[52:55], v[28:31], a[56:59], v[52:55]
 s_waitcnt vmcnt(0)
 v_mfma_f32_16x16x32_bf16 v[48:51], v[24:27], a[60:63], v[48:51]
 v_mfma_f32_16x16x32_bf16 v[52:55], v[28:31], a[60:63], v[52:55]
 s_nop 7
 v_cvt_pk_bf16_f32 v48, v48, v49
 v_cvt_pk_bf16_f32 v49, v50, v51
 v_cvt_pk_bf16_f32 v50, v52, v53
 v_cvt_pk_bf16_f32 v51, v54, v55
 buffer_store_dwordx4 v[48:51], v2, s[8:11], s35 offen offset:448
 s_branch L_fin
L_idle:
 s_waitcnt vmcnt(0)
 s_barrier
 s_cmp_lg_u32 s3, 0
 s_cbranch_scc1 L_pub8
 v_mov_b32 v11, 0
 s_mov_b64 exec, 1
 buffer_store_dword v11, v11, s[12:15], s93 offen sc1
 s_mov_b64 exec, -1
L_pub8:
 s_branch L_fin
L_opB:
 v_lshrrev_b32 v8, 2, v0
 v_lshlrev_b32 v4, 7, v8
 v_bfe_u32 v8, v8, 1, 2
 v_lshl_add_u32 v4, v8, 5, v4
 v_and_b32 v8, 3, v0
 v_lshl_add_u32 v4, v8, 3, v4
 v_add_u32 v4, 131072, v4
 s_barrier
 ds_read_b64_tr_b16 a[0:1], v4 offset:0
 ds_read_b64_tr_b16 a[2:3], v4 offset:2048
 ds_read_b64_tr_b16 a[4:5], v4 offset:4096
 ds_read_b64_tr_b16 a[6:7], v4 offset:6144
 ds_read_b64_tr_b16 a[8:9], v4 offset:8192
 ds_read_b64_tr_b16 a[10:11], v4 offset:10240
 ds_read_b64_tr_b16 a[12:13], v4 offset:12288
 ds_read_b64_tr_b16 a[14:15], v4 offset:14336
 ds_read_b64_tr_b16 a[16:17], v4 offset:16384
 ds_read_b64_tr_b16 a[18:19], v4 offset:18432
 ds_read_b64_tr_b16 a[20:21], v4 offset:20480
 ds_read_b64_tr_b16 a[22:23], v4 offset:22528
 ds_read_b64_tr_b16 a[24:25], v4 offset:24576
 ds_read_b64_tr_b16 a[26:27], v4 offset:26624
 v_xor_b32 v5, 32, v4
 v_xor_b32 v6, 64, v4
 v_xor_b32 v7, 96, v4
 s_lshl_b32 s34, s95, 2
 s_add_u32 s34, s34, s3
 s_mul_i32 s35, s34, 4096
 s_lshl_b32 s34, s34, 12
 s_cmp_eq_u32 s62, 0
 s_cmov_b32 s34, 2.0
 s_cmov_b32 s35, 2.0
 s_add_u32 s35, s35, 85983232
 s_mul_i32 s33, s3, 8736
 s_add_u32 s33, s33, 0x10000
 s_mov_b32 s4, s72
 s_mov_b32 s5, s73
 s_mov_b32 s6, 1835008
 s_mov_b32 s7, 0x20000
 v_lshrrev_b32 v10, 1, v0
 v_lshlrev_b32 v10, 7, v10
 v_and_b32 v11, 1, v0
 v_lshl_add_u32 v10, v11, 4, v10
 v_and_b32 v11, 31, v0
 v_lshl_add_u32 v11, v11, 2, s33
 v_and_b32 v12, 7, v0
 v_lshl_add_u32 v12, v12, 2, s33
 v_mov_b32 v13, 0
 v_accvgpr_read_b32 v9, a245
 s_lshl_b32 s48, s63, 3
 s_add_u32 s48, s48, s3
 s_mul_i32 s48, s48, 243712
 s_lshl_b32 s58, s26, 10
 s_add_u32 s48, s48, s58
 s_add_u32 s48, s48, 117440512
 s_waitcnt lgkmcnt(7)
 v_mfma_f32_16x16x32_bf16 v[72:75], a[0:3], a[128:131], 0
 ds_read_b64_tr_b16 a[28:29], v4 offset:28672
 buffer_store_dwordx4 v[68:71], v1, s[12:15], s57 offen sc1
 v_mfma_f32_16x16x32_bf16 v[72:75], a[4:7], a[132:135], v[72:75]
 ds_read_b64_tr_b16 a[30:31], v4 offset:30720
 v_mfma_f32_16x16x32_bf16 v[72:75], a[8:11], a[136:139], v[72:75]
 s_waitcnt lgkmcnt(4)
 ds_read_b64_tr_b16 a[32:33], v5 offset:0
 v_mfma_f32_16x16x32_bf16 v[72:75], a[12:15], a[140:143], v[72:75]
 ds_read_b64_tr_b16 a[34:35], v5 offset:2048
 buffer_store_dwordx4 v[168:171], v3, s[12:15], s55 offen offset:1024 sc1
 v_mfma_f32_16x16x32_bf16 v[72:75], a[16:19], a[144:147], v[72:75]
 ds_read_b64_tr_b16 a[36:37], v5 offset:4096
 v_mfma_f32_16x16x32_bf16 v[72:75], a[20:23], a[148:151], v[72:75]
 s_waitcnt lgkmcnt(3)
 ds_read_b64_tr_b16 a[38:39], v5 offset:6144
 v_mfma_f32_16x16x32_bf16 v[72:75], a[24:27], a[152:155], v[72:75]
 ds_read_b64_tr_b16 a[40:41], v5 offset:8192
 buffer_store_dwordx4 v[232:235], v3, s[12:15], s56 offen offset:1024 sc1
 v_mfma_f32_16x16x32_bf16 v[72:75], a[28:31], a[156:159], v[72:75]
 ds_read_b64_tr_b16 a[42:43], v5 offset:10240
 v_mfma_f32_16x16x32_bf16 v[80:83], a[0:3], a[160:163], 0
 ds_read_b64_tr_b16 a[44:45], v5 offset:12288
 v_mfma_f32_16x16x32_bf16 v[80:83], a[4:7], a[164:167], v[80:83]
 ds_read_b64_tr_b16 a[46:47], v5 offset:14336
 buffer_store_dwordx4 v[176:179], v3, s[12:15], s55 offen offset:2048 sc1
 v_mfma_f32_16x16x32_bf16 v[80:83], a[8:11], a[168:171], v[80:83]
 ds_read_b64_tr_b16 a[48:49], v5 offset:16384
 v_mfma_f32_16x16x32_bf16 v[80:83], a[12:15], a[172:175], v[80:83]
 ds_read_b64_tr_b16 a[50:51], v5 offset:18432
 v_mfma_f32_16x16x32_bf16 v[80:83], a[16:19], a[176:179], v[80:83]
 ds_read_b64_tr_b16 a[52:53], v5 offset:20480
 buffer_store_dwordx4 v[240:243], v3, s[12:15], s56 offen offset:2048 sc1
 v_mfma_f32_16x16x32_bf16 v[80:83], a[20:23], a[180:183], v[80:83]
 ds_read_b64_tr_b16 a[54:55], v5 offset:22528
 v_mul_f32 v72, v72, v64
 v_mfma_f32_16x16x32_bf16 v[80:83], a[24:27], a[184:187], v[80:83]
 ds_read_b64_tr_b16 a[56:57], v5 offset:24576
 v_mul_f32 v73, v73, v64
 v_mfma_f32_16x16x32_bf16 v[80:83], a[28:31], a[188:191], v[80:83]
 s_waitcnt lgkmcnt(7)
 ds_read_b64_tr_b16 a[58:59], v5 offset:26624
 buffer_store_dwordx4 v[184:187], v3, s[12:15], s55 offen offset:3072 sc1
 v_mfma_f32_16x16x32_bf16 v[76:79], a[32:35], a[128:131], 0
 ds_read_b64_tr_b16 a[60:61], v5 offset:28672
 v_mul_f32 v74, v74, v64
 v_mfma_f32_16x16x32_bf16 v[76:79], a[36:39], a[132:135], v[76:79]
 ds_read_b64_tr_b16 a[62:63], v5 offset:30720
 v_mul_f32 v75, v75, v64
 v_mfma_f32_16x16x32_bf16 v[76:79], a[40:43], a[136:139], v[76:79]
 s_waitcnt lgkmcnt(4)
 ds_read_b64_tr_b16 a[0:1], v6 offset:0
 buffer_store_dwordx4 v[248:251], v3, s[12:15], s56 offen offset:3072 sc1
 v_mfma_f32_16x16x32_bf16 v[76:79], a[44:47], a[140:143], v[76:79]
 ds_read_b64_tr_b16 a[2:3], v6 offset:2048
 v_mfma_f32_16x16x32_bf16 v[76:79], a[48:51], a[144:147], v[76:79]
 s_add_u32 m0, s29, 32768
 ds_read_b64_tr_b16 a[4:5], v6 offset:4096
 v_mul_f32 v80, v80, v65
 v_mfma_f32_16x16x32_bf16 v[76:79], a[52:55], a[148:151], v[76:79]
 s_waitcnt lgkmcnt(3)
 ds_read_b64_tr_b16 a[6:7], v6 offset:6144
 buffer_load_dwordx4 v2, s[8:11], s78 offen lds
 v_mfma_f32_16x16x32_bf16 v[76:79], a[56:59], a[152:155], v[76:79]
 ds_read_b64_tr_b16 a[8:9], v6 offset:8192
 v_mul_f32 v81, v81, v65
 v_mfma_f32_16x16x32_bf16 v[76:79], a[60:63], a[156:159], v[76:79]
 ds_read_b64_tr_b16 a[10:11], v6 offset:10240
 v_mul_f32 v82, v82, v65
 v_mfma_f32_16x16x32_bf16 v[84:87], a[32:35], a[160:163], 0
 ds_read_b64_tr_b16 a[12:13], v6 offset:12288
 v_mul_f32 v83, v83, v65
 v_mfma_f32_16x16x32_bf16 v[84:87], a[36:39], a[164:167], v[84:87]
 ds_read_b64_tr_b16 a[14:15], v6 offset:14336
 v_mfma_f32_16x16x32_bf16 v[84:87], a[40:43], a[168:171], v[84:87]
 ds_read_b64_tr_b16 a[16:17], v6 offset:16384
 v_mfma_f32_16x16x32_bf16 v[84:87], a[44:47], a[172:175], v[84:87]
 s_add_u32 m0, s29, 36864
 ds_read_b64_tr_b16 a[18:19], v6 offset:18432
 v_mfma_f32_16x16x32_bf16 v[84:87], a[48:51], a[176:179], v[84:87]
 ds_read_b64_tr_b16 a[20:21], v6 offset:20480
 buffer_load_dwordx4 v2, s[8:11], s79 offen lds
 v_mfma_f32_16x16x32_bf16 v[84:87], a[52:55], a[180:183], v[84:87]
 ds_read_b64_tr_b16 a[22:23], v6 offset:22528
 v_mul_f32 v76, v76, v64
 v_mfma_f32_16x16x32_bf16 v[84:87], a[56:59], a[184:187], v[84:87]
 s_lshl_b32 s44, s24, 7
 ds_read_b64_tr_b16 a[24:25], v6 offset:24576
 v_mul_f32 v77, v77, v64
 v_mfma_f32_16x16x32_bf16 v[84:87], a[60:63], a[188:191], v[84:87]
 s_waitcnt lgkmcnt(7)
 ds_read_b64_tr_b16 a[26:27], v6 offset:26624
 v_mul_f32 v78, v78, v64
 v_mfma_f32_16x16x32_bf16 v[88:91], a[0:3], a[128:131], 0
 s_add_u32 s44, s44, 84938752
 ds_read_b64_tr_b16 a[28:29], v6 offset:28672
 v_mul_f32 v79, v79, v64
 v_mfma_f32_16x16x32_bf16 v[88:91], a[4:7], a[132:135], v[88:91]
 s_add_u32 m0, s29, 40960
 ds_read_b64_tr_b16 a[30:31], v6 offset:30720
 v_cvt_pk_bf16_f32 v72, v72, v73
 v_mfma_f32_16x16x32_bf16 v[88:91], a[8:11], a[136:139], v[88:91]
 s_waitcnt lgkmcnt(4)
 ds_read_b64_tr_b16 a[32:33], v7 offset:0
 v_cvt_pk_bf16_f32 v73, v74, v75
 v_mfma_f32_16x16x32_bf16 v[88:91], a[12:15], a[140:143], v[88:91]
 ds_read_b64_tr_b16 a[34:35], v7 offset:2048
 buffer_load_dwordx4 v2, s[8:11], s80 offen lds
 v_mfma_f32_16x16x32_bf16 v[88:91], a[16:19], a[144:147], v[88:91]
 s_add_u32 s58, s48, 0
 ds_read_b64_tr_b16 a[36:37], v7 offset:4096
 v_cvt_pk_bf16_f32 v74, v76, v77
 v_mfma_f32_16x16x32_bf16 v[88:91], a[20:23], a[148:151], v[88:91]
 s_waitcnt lgkmcnt(3)
 ds_read_b64_tr_b16 a[38:39], v7 offset:6144
 v_cvt_pk_bf16_f32 v75, v78, v79
 v_mfma_f32_16x16x32_bf16 v[88:91], a[24:27], a[152:155], v[88:91]
 ds_read_b64_tr_b16 a[40:41], v7 offset:8192
 buffer_store_dwordx4 v[72:75], v1, s[12:15], s58 offen sc1
 v_mfma_f32_16x16x32_bf16 v[88:91], a[28:31], a[156:159], v[88:91]
 s_waitcnt vmcnt(4)
 ds_read_b64_tr_b16 a[42:43], v7 offset:10240
 v_mul_f32 v84, v84, v65
 v_mfma_f32_16x16x32_bf16 v[96:99], a[0:3], a[160:163], 0
 s_barrier
 ds_read_b64_tr_b16 a[44:45], v7 offset:12288
 v_mul_f32 v85, v85, v65
 v_mfma_f32_16x16x32_bf16 v[96:99], a[4:7], a[164:167], v[96:99]
 ds_read_b64_tr_b16 a[46:47], v7 offset:14336
 buffer_store_dword v9, v9, s[12:15], s59 offen sc1
 v_mfma_f32_16x16x32_bf16 v[96:99], a[8:11], a[168:171], v[96:99]
 s_add_u32 m0, s29, 45056
 ds_read_b64_tr_b16 a[48:49], v7 offset:16384
 v_mul_f32 v86, v86, v65
 v_mfma_f32_16x16x32_bf16 v[96:99], a[12:15], a[172:175], v[96:99]
 ds_read_b64_tr_b16 a[50:51], v7 offset:18432
 buffer_load_dwordx4 v2, s[8:11], s81 offen lds
 v_mfma_f32_16x16x32_bf16 v[96:99], a[16:19], a[176:179], v[96:99]
 s_lshl_b32 s40, s24, 1
 ds_read_b64_tr_b16 a[52:53], v7 offset:20480
 v_mul_f32 v87, v87, v65
 v_mfma_f32_16x16x32_bf16 v[96:99], a[20:23], a[180:183], v[96:99]
 s_and_b32 s41, s28, 1
 ds_read_b64_tr_b16 a[54:55], v7 offset:22528
 v_cvt_pk_bf16_f32 v80, v80, v81
 v_mfma_f32_16x16x32_bf16 v[96:99], a[24:27], a[184:187], v[96:99]
 s_add_u32 s40, s40, s41
 ds_read_b64_tr_b16 a[56:57], v7 offset:24576
 v_cvt_pk_bf16_f32 v81, v82, v83
 v_mfma_f32_16x16x32_bf16 v[96:99], a[28:31], a[188:191], v[96:99]
 s_waitcnt lgkmcnt(7)
 ds_read_b64_tr_b16 a[58:59], v7 offset:26624
 v_cvt_pk_bf16_f32 v82, v84, v85
 v_mfma_f32_16x16x32_bf16 v[92:95], a[32:35], a[128:131], 0
 s_lshr_b32 s41, s28, 1
 ds_read_b64_tr_b16 a[60:61], v7 offset:28672
 v_cvt_pk_bf16_f32 v83, v86, v87
 v_mfma_f32_16x16x32_bf16 v[92:95], a[36:39], a[132:135], v[92:95]
 s_add_u32 m0, s29, 49152
 ds_read_b64_tr_b16 a[62:63], v7 offset:30720
 v_xor_b32 v4, 0x20000, v4
 v_mfma_f32_16x16x32_bf16 v[92:95], a[40:43], a[136:139], v[92:95]
 s_waitcnt lgkmcnt(4)
 ds_read_b64_tr_b16 a[0:1], v4 offset:0
 buffer_load_dwordx4 v2, s[8:11], s82 offen lds
 v_mfma_f32_16x16x32_bf16 v[92:95], a[44:47], a[140:143], v[92:95]
 s_add_u32 s58, s48, 974848
 ds_read_b64_tr_b16 a[2:3], v4 offset:2048
 v_mul_f32 v88, v88, v64
 v_mfma_f32_16x16x32_bf16 v[92:95], a[48:51], a[144:147], v[92:95]
 ds_read_b64_tr_b16 a[4:5], v4 offset:4096
 buffer_store_dwordx4 v[80:83], v1, s[12:15], s58 offen sc1
 v_mfma_f32_16x16x32_bf16 v[92:95], a[52:55], a[148:151], v[92:95]
 s_waitcnt lgkmcnt(3)
 ds_read_b64_tr_b16 a[6:7], v4 offset:6144
 v_mul_f32 v89, v89, v64
 v_mfma_f32_16x16x32_bf16 v[92:95], a[56:59], a[152:155], v[92:95]
 s_lshl_b32 s42, s40, 2
 ds_read_b64_tr_b16 a[8:9], v4 offset:8192
 v_mul_f32 v90, v90, v64
 v_mfma_f32_16x16x32_bf16 v[92:95], a[60:63], a[156:159], v[92:95]
 s_add_u32 s42, s42, s3
 ds_read_b64_tr_b16 a[10:11], v4 offset:10240
 v_mul_f32 v91, v91, v64
 v_mfma_f32_16x16x32_bf16 v[100:103], a[32:35], a[160:163], 0
 s_add_u32 m0, s29, 53248
 ds_read_b64_tr_b16 a[12:13], v4 offset:12288
 v_mul_f32 v96, v96, v65
 v_mfma_f32_16x16x32_bf16 v[100:103], a[36:39], a[164:167], v[100:103]
 ds_read_b64_tr_b16 a[14:15], v4 offset:14336
 buffer_load_dwordx4 v2, s[8:11], s83 offen lds
 v_mfma_f32_16x16x32_bf16 v[100:103], a[40:43], a[168:171], v[100:103]
 s_mul_i32 s37, s42, 243712
 ds_read_b64_tr_b16 a[16:17], v4 offset:16384
 v_mul_f32 v97, v97, v65
 v_mfma_f32_16x16x32_bf16 v[100:103], a[44:47], a[172:175], v[100:103]
 s_mul_i32 s43, s41, 17408
 ds_read_b64_tr_b16 a[18:19], v4 offset:18432
 v_mul_f32 v98, v98, v65
 v_mfma_f32_16x16x32_bf16 v[100:103], a[48:51], a[176:179], v[100:103]
 s_add_u32 s37, s37, s43
 ds_read_b64_tr_b16 a[20:21], v4 offset:20480
 v_mul_f32 v92, v92, v64
 v_mfma_f32_16x16x32_bf16 v[100:103], a[52:55], a[180:183], v[100:103]
 s_add_u32 s37, s37, 117440512
 ds_read_b64_tr_b16 a[22:23], v4 offset:22528
 v_mul_f32 v93, v93, v64
 v_mfma_f32_16x16x32_bf16 v[100:103], a[56:59], a[184:187], v[100:103]
 s_add_u32 m0, s29, 57344
 ds_read_b64_tr_b16 a[24:25], v4 offset:24576
 v_mul_f32 v94, v94, v64
 v_mfma_f32_16x16x32_bf16 v[100:103], a[60:63], a[188:191], v[100:103]
 s_waitcnt lgkmcnt(7)
 ds_read_b64_tr_b16 a[26:27], v4 offset:26624
 v_mul_f32 v95, v95, v64
 v_mfma_f32_16x16x32_bf16 v[104:107], a[0:3], a[128:131], 0
 ds_read_b64_tr_b16 a[28:29], v4 offset:28672
 buffer_load_dwordx4 v2, s[8:11], s84 offen lds
 v_mfma_f32_16x16x32_bf16 v[104:107], a[4:7], a[132:135], v[104:107]
 s_add_u32 s38, s37, 121856
 ds_read_b64_tr_b16 a[30:31], v4 offset:30720
 v_xor_b32 v5, 0x20000, v5
 v_mfma_f32_16x16x32_bf16 v[104:107], a[8:11], a[136:139], v[104:107]
 s_waitcnt lgkmcnt(4)
 ds_read_b64_tr_b16 a[32:33], v5 offset:0
 v_cvt_pk_bf16_f32 v88, v88, v89
 v_mfma_f32_16x16x32_bf16 v[104:107], a[12:15], a[140:143], v[104:107]
 ds_read_b64_tr_b16 a[34:35], v5 offset:2048
 v_cvt_pk_bf16_f32 v89, v90, v91
 v_mfma_f32_16x16x32_bf16 v[104:107], a[16:19], a[144:147], v[104:107]
 ds_read_b64_tr_b16 a[36:37], v5 offset:4096
 v_cvt_pk_bf16_f32 v90, v92, v93
 v_mfma_f32_16x16x32_bf16 v[104:107], a[20:23], a[148:151], v[104:107]
 s_waitcnt lgkmcnt(3)
 ds_read_b64_tr_b16 a[38:39], v5 offset:6144
 v_cvt_pk_bf16_f32 v91, v94, v95
 v_mfma_f32_16x16x32_bf16 v[104:107], a[24:27], a[152:155], v[104:107]
 s_add_u32 m0, s29, 61440
 ds_read_b64_tr_b16 a[40:41], v5 offset:8192
 v_mul_f32 v99, v99, v65
 v_mfma_f32_16x16x32_bf16 v[104:107], a[28:31], a[156:159], v[104:107]
 ds_read_b64_tr_b16 a[42:43], v5 offset:10240
 buffer_load_dwordx4 v2, s[8:11], s85 offen lds
 v_mfma_f32_16x16x32_bf16 v[112:115], a[0:3], a[160:163], 0
 s_add_u32 s58, s48, 17408
 ds_read_b64_tr_b16 a[44:45], v5 offset:12288
 v_add_u32 v2, 128, v2
 v_mfma_f32_16x16x32_bf16 v[112:115], a[4:7], a[164:167], v[112:115]
 ds_read_b64_tr_b16 a[46:47], v5 offset:14336
 buffer_store_dwordx4 v[88:91], v1, s[12:15], s58 offen sc1
 v_mfma_f32_16x16x32_bf16 v[112:115], a[8:11], a[168:171], v[112:115]
 ds_read_b64_tr_b16 a[48:49], v5 offset:16384
 v_mul_f32 v100, v100, v65
 v_mfma_f32_16x16x32_bf16 v[112:115], a[12:15], a[172:175], v[112:115]
 ds_read_b64_tr_b16 a[50:51], v5 offset:18432
 v_mul_f32 v101, v101, v65
 v_mfma_f32_16x16x32_bf16 v[112:115], a[16:19], a[176:179], v[112:115]
 ds_read_b64_tr_b16 a[52:53], v5 offset:20480
 v_mul_f32 v102, v102, v65
 v_mfma_f32_16x16x32_bf16 v[112:115], a[20:23], a[180:183], v[112:115]
 s_add_u32 m0, s29, 65536
 ds_read_b64_tr_b16 a[54:55], v5 offset:22528
 v_mul_f32 v103, v103, v65
 v_mfma_f32_16x16x32_bf16 v[112:115], a[24:27], a[184:187], v[112:115]
 ds_read_b64_tr_b16 a[56:57], v5 offset:24576
 buffer_load_dwordx4 v2, s[8:11], s78 offen lds
 v_mfma_f32_16x16x32_bf16 v[112:115], a[28:31], a[188:191], v[112:115]
 s_waitcnt lgkmcnt(7)
 ds_read_b64_tr_b16 a[58:59], v5 offset:26624
 v_cvt_pk_bf16_f32 v96, v96, v97
 v_mfma_f32_16x16x32_bf16 v[108:111], a[32:35], a[128:131], 0
 ds_read_b64_tr_b16 a[60:61], v5 offset:28672
 v_cvt_pk_bf16_f32 v97, v98, v99
 v_mfma_f32_16x16x32_bf16 v[108:111], a[36:39], a[132:135], v[108:111]
 ds_read_b64_tr_b16 a[62:63], v5 offset:30720
 v_xor_b32 v6, 0x20000, v6
 v_mfma_f32_16x16x32_bf16 v[108:111], a[40:43], a[136:139], v[108:111]
 s_waitcnt lgkmcnt(4)
 ds_read_b64_tr_b16 a[0:1], v6 offset:0
 v_cvt_pk_bf16_f32 v98, v100, v101
 v_mfma_f32_16x16x32_bf16 v[108:111], a[44:47], a[140:143], v[108:111]
 ds_read_b64_tr_b16 a[2:3], v6 offset:2048
 v_cvt_pk_bf16_f32 v99, v102, v103
 v_mfma_f32_16x16x32_bf16 v[108:111], a[48:51], a[144:147], v[108:111]
 s_add_u32 m0, s29, 69632
 ds_read_b64_tr_b16 a[4:5], v6 offset:4096
 v_mul_f32 v104, v104, v64
 v_mfma_f32_16x16x32_bf16 v[108:111], a[52:55], a[148:151], v[108:111]
 s_waitcnt lgkmcnt(3)
 ds_read_b64_tr_b16 a[6:7], v6 offset:6144
 buffer_load_dwordx4 v2, s[8:11], s79 offen lds
 v_mfma_f32_16x16x32_bf16 v[108:111], a[56:59], a[152:155], v[108:111]
 s_add_u32 s58, s48, 992256
 ds_read_b64_tr_b16 a[8:9], v6 offset:8192
 v_mul_f32 v105, v105, v64
 v_mfma_f32_16x16x32_bf16 v[108:111], a[60:63], a[156:159], v[108:111]
 ds_read_b64_tr_b16 a[10:11], v6 offset:10240
 buffer_store_dwordx4 v[96:99], v1, s[12:15], s58 offen sc1
 v_mfma_f32_16x16x32_bf16 v[116:119], a[32:35], a[160:163], 0
 ds_read_b64_tr_b16 a[12:13], v6 offset:12288
 v_mul_f32 v106, v106, v64
 v_mfma_f32_16x16x32_bf16 v[116:119], a[36:39], a[164:167], v[116:119]
 ds_read_b64_tr_b16 a[14:15], v6 offset:14336
 v_mul_f32 v107, v107, v64
 v_mfma_f32_16x16x32_bf16 v[116:119], a[40:43], a[168:171], v[116:119]
 ds_read_b64_tr_b16 a[16:17], v6 offset:16384
 v_mul_f32 v112, v112, v65
 v_mfma_f32_16x16x32_bf16 v[116:119], a[44:47], a[172:175], v[116:119]
 s_add_u32 m0, s29, 73728
 ds_read_b64_tr_b16 a[18:19], v6 offset:18432
 v_mul_f32 v113, v113, v65
 v_mfma_f32_16x16x32_bf16 v[116:119], a[48:51], a[176:179], v[116:119]
 ds_read_b64_tr_b16 a[20:21], v6 offset:20480
 buffer_load_dwordx4 v2, s[8:11], s80 offen lds
 v_mfma_f32_16x16x32_bf16 v[116:119], a[52:55], a[180:183], v[116:119]
 ds_read_b64_tr_b16 a[22:23], v6 offset:22528
 v_mul_f32 v108, v108, v64
 v_mfma_f32_16x16x32_bf16 v[116:119], a[56:59], a[184:187], v[116:119]
 ds_read_b64_tr_b16 a[24:25], v6 offset:24576
 v_mul_f32 v109, v109, v64
 v_mfma_f32_16x16x32_bf16 v[116:119], a[60:63], a[188:191], v[116:119]
 s_waitcnt lgkmcnt(7)
 ds_read_b64_tr_b16 a[26:27], v6 offset:26624
 v_mul_f32 v110, v110, v64
 v_mfma_f32_16x16x32_bf16 v[72:75], a[0:3], a[128:131], 0
 ds_read_b64_tr_b16 a[28:29], v6 offset:28672
 v_mul_f32 v111, v111, v64
 v_mfma_f32_16x16x32_bf16 v[72:75], a[4:7], a[132:135], v[72:75]
 s_add_u32 m0, s29, 77824
 ds_read_b64_tr_b16 a[30:31], v6 offset:30720
 v_xor_b32 v7, 0x20000, v7
 v_mfma_f32_16x16x32_bf16 v[72:75], a[8:11], a[136:139], v[72:75]
 s_waitcnt lgkmcnt(4)
 ds_read_b64_tr_b16 a[32:33], v7 offset:0
 v_cvt_pk_bf16_f32 v104, v104, v105
 v_mfma_f32_16x16x32_bf16 v[72:75], a[12:15], a[140:143], v[72:75]
 ds_read_b64_tr_b16 a[34:35], v7 offset:2048
 buffer_load_dwordx4 v2, s[8:11], s81 offen lds
 v_mfma_f32_16x16x32_bf16 v[72:75], a[16:19], a[144:147], v[72:75]
 ds_read_b64_tr_b16 a[36:37], v7 offset:4096
 v_cvt_pk_bf16_f32 v105, v106, v107
 v_mfma_f32_16x16x32_bf16 v[72:75], a[20:23], a[148:151], v[72:75]
 s_waitcnt lgkmcnt(3)
 ds_read_b64_tr_b16 a[38:39], v7 offset:6144
 v_cvt_pk_bf16_f32 v106, v108, v109
 v_mfma_f32_16x16x32_bf16 v[72:75], a[24:27], a[152:155], v[72:75]
 s_add_u32 s58, s48, 34816
 ds_read_b64_tr_b16 a[40:41], v7 offset:8192
 v_cvt_pk_bf16_f32 v107, v110, v111
 v_mfma_f32_16x16x32_bf16 v[72:75], a[28:31], a[156:159], v[72:75]
 ds_read_b64_tr_b16 a[42:43], v7 offset:10240
 buffer_store_dwordx4 v[104:107], v1, s[12:15], s58 offen sc1
 v_mfma_f32_16x16x32_bf16 v[80:83], a[0:3], a[160:163], 0
 ds_read_b64_tr_b16 a[44:45], v7 offset:12288
 v_mul_f32 v114, v114, v65
 v_mfma_f32_16x16x32_bf16 v[80:83], a[4:7], a[164:167], v[80:83]
 s_add_u32 m0, s29, 81920
 ds_read_b64_tr_b16 a[46:47], v7 offset:14336
 v_mul_f32 v115, v115, v65
 v_mfma_f32_16x16x32_bf16 v[80:83], a[8:11], a[168:171], v[80:83]
 ds_read_b64_tr_b16 a[48:49], v7 offset:16384
 buffer_load_dwordx4 v2, s[8:11], s82 offen lds
 v_mfma_f32_16x16x32_bf16 v[80:83], a[12:15], a[172:175], v[80:83]
 ds_read_b64_tr_b16 a[50:51], v7 offset:18432
 v_mul_f32 v116, v116, v65
 v_mfma_f32_16x16x32_bf16 v[80:83], a[16:19], a[176:179], v[80:83]
 ds_read_b64_tr_b16 a[52:53], v7 offset:20480
 v_mul_f32 v117, v117, v65
 v_mfma_f32_16x16x32_bf16 v[80:83], a[20:23], a[180:183], v[80:83]
 ds_read_b64_tr_b16 a[54:55], v7 offset:22528
 v_mul_f32 v118, v118, v65
 v_mfma_f32_16x16x32_bf16 v[80:83], a[24:27], a[184:187], v[80:83]
 ds_read_b64_tr_b16 a[56:57], v7 offset:24576
 v_mul_f32 v119, v119, v65
 v_mfma_f32_16x16x32_bf16 v[80:83], a[28:31], a[188:191], v[80:83]
 s_waitcnt lgkmcnt(7)
 ds_read_b64_tr_b16 a[58:59], v7 offset:26624
 v_cvt_pk_bf16_f32 v112, v112, v113
 v_mfma_f32_16x16x32_bf16 v[76:79], a[32:35], a[128:131], 0
 s_waitcnt vmcnt(8)
 ds_read_b64_tr_b16 a[60:61], v7 offset:28672
 v_cvt_pk_bf16_f32 v113, v114, v115
 v_mfma_f32_16x16x32_bf16 v[76:79], a[36:39], a[132:135], v[76:79]
 s_barrier
 ds_read_b64_tr_b16 a[62:63], v7 offset:30720
 v_cvt_pk_bf16_f32 v114, v116, v117
 v_mfma_f32_16x16x32_bf16 v[76:79], a[40:43], a[136:139], v[76:79]
 s_waitcnt lgkmcnt(4)
 ds_read_b64_tr_b16 a[0:1], v4 offset:32768
 v_cvt_pk_bf16_f32 v115, v118, v119
 v_mfma_f32_16x16x32_bf16 v[76:79], a[44:47], a[140:143], v[76:79]
 s_add_u32 m0, s29, 86016
 ds_read_b64_tr_b16 a[2:3], v4 offset:34816
 v_mul_f32 v72, v72, v64
 v_mfma_f32_16x16x32_bf16 v[76:79], a[48:51], a[144:147], v[76:79]
 ds_read_b64_tr_b16 a[4:5], v4 offset:36864
 buffer_load_dwordx4 v2, s[8:11], s83 offen lds
 v_mfma_f32_16x16x32_bf16 v[76:79], a[52:55], a[148:151], v[76:79]
 s_waitcnt lgkmcnt(3)
 ds_read_b64_tr_b16 a[6:7], v4 offset:38912
 v_mul_f32 v73, v73, v64
 v_mfma_f32_16x16x32_bf16 v[76:79], a[56:59], a[152:155], v[76:79]
 s_add_u32 s58, s48, 1009664
 ds_read_b64_tr_b16 a[8:9], v4 offset:40960
 v_mul_f32 v74, v74, v64
 v_mfma_f32_16x16x32_bf16 v[76:79], a[60:63], a[156:159], v[76:79]
 ds_read_b64_tr_b16 a[10:11], v4 offset:43008
 buffer_store_dwordx4 v[112:115], v1, s[12:15], s58 offen sc1
 v_mfma_f32_16x16x32_bf16 v[84:87], a[32:35], a[160:163], 0
 ds_read_b64_tr_b16 a[12:13], v4 offset:45056
 v_mul_f32 v75, v75, v64
 v_mfma_f32_16x16x32_bf16 v[84:87], a[36:39], a[164:167], v[84:87]
 ds_read_b64_tr_b16 a[14:15], v4 offset:47104
 v_mul_f32 v80, v80, v65
 v_mfma_f32_16x16x32_bf16 v[84:87], a[40:43], a[168:171], v[84:87]
 s_add_u32 m0, s29, 90112
 ds_read_b64_tr_b16 a[16:17], v4 offset:49152
 v_mul_f32 v81, v81, v65
 v_mfma_f32_16x16x32_bf16 v[84:87], a[44:47], a[172:175], v[84:87]
 ds_read_b64_tr_b16 a[18:19], v4 offset:51200
 buffer_load_dwordx4 v2, s[8:11], s84 offen lds
 v_mfma_f32_16x16x32_bf16 v[84:87], a[48:51], a[176:179], v[84:87]
 ds_read_b64_tr_b16 a[20:21], v4 offset:53248
 v_mul_f32 v76, v76, v64
 v_mfma_f32_16x16x32_bf16 v[84:87], a[52:55], a[180:183], v[84:87]
 ds_read_b64_tr_b16 a[22:23], v4 offset:55296
 v_mul_f32 v77, v77, v64
 v_mfma_f32_16x16x32_bf16 v[84:87], a[56:59], a[184:187], v[84:87]
 ds_read_b64_tr_b16 a[24:25], v4 offset:57344
 v_mul_f32 v78, v78, v64
 v_mfma_f32_16x16x32_bf16 v[84:87], a[60:63], a[188:191], v[84:87]
 s_waitcnt lgkmcnt(7)
 ds_read_b64_tr_b16 a[26:27], v4 offset:59392
 v_mul_f32 v79, v79, v64
 v_mfma_f32_16x16x32_bf16 v[88:91], a[0:3], a[128:131], 0
 ds_read_b64_tr_b16 a[28:29], v4 offset:61440
 v_cvt_pk_bf16_f32 v72, v72, v73
 v_mfma_f32_16x16x32_bf16 v[88:91], a[4:7], a[132:135], v[88:91]
 s_add_u32 m0, s29, 94208
 ds_read_b64_tr_b16 a[30:31], v4 offset:63488
 v_cvt_pk_bf16_f32 v73, v74, v75
 v_mfma_f32_16x16x32_bf16 v[88:91], a[8:11], a[136:139], v[88:91]
 s_waitcnt lgkmcnt(4)
 ds_read_b64_tr_b16 a[32:33], v5 offset:32768
 buffer_load_dwordx4 v2, s[8:11], s85 offen lds
 v_mfma_f32_16x16x32_bf16 v[88:91], a[12:15], a[140:143], v[88:91]
 ds_read_b64_tr_b16 a[34:35], v5 offset:34816
 v_add_u32 v2, 128, v2
 v_mfma_f32_16x16x32_bf16 v[88:91], a[16:19], a[144:147], v[88:91]
 s_add_u32 s58, s48, 52224
 ds_read_b64_tr_b16 a[36:37], v5 offset:36864
 v_cvt_pk_bf16_f32 v74, v76, v77
 v_mfma_f32_16x16x32_bf16 v[88:91], a[20:23], a[148:151], v[88:91]
 s_waitcnt lgkmcnt(3)
 ds_read_b64_tr_b16 a[38:39], v5 offset:38912
 v_cvt_pk_bf16_f32 v75, v78, v79
 v_mfma_f32_16x16x32_bf16 v[88:91], a[24:27], a[152:155], v[88:91]
 ds_read_b64_tr_b16 a[40:41], v5 offset:40960
 buffer_store_dwordx4 v[72:75], v1, s[12:15], s58 offen sc1
 v_mfma_f32_16x16x32_bf16 v[88:91], a[28:31], a[156:159], v[88:91]
 ds_read_b64_tr_b16 a[42:43], v5 offset:43008
 v_mul_f32 v82, v82, v65
 v_mfma_f32_16x16x32_bf16 v[96:99], a[0:3], a[160:163], 0
 s_add_u32 m0, s29, 98304
 ds_read_b64_tr_b16 a[44:45], v5 offset:45056
 v_mul_f32 v83, v83, v65
 v_mfma_f32_16x16x32_bf16 v[96:99], a[4:7], a[164:167], v[96:99]
 ds_read_b64_tr_b16 a[46:47], v5 offset:47104
 buffer_load_dwordx4 v2, s[8:11], s78 offen lds
 v_mfma_f32_16x16x32_bf16 v[96:99], a[8:11], a[168:171], v[96:99]
 ds_read_b64_tr_b16 a[48:49], v5 offset:49152
 v_mul_f32 v84, v84, v65
 v_mfma_f32_16x16x32_bf16 v[96:99], a[12:15], a[172:175], v[96:99]
 ds_read_b64_tr_b16 a[50:51], v5 offset:51200
 v_mul_f32 v85, v85, v65
 v_mfma_f32_16x16x32_bf16 v[96:99], a[16:19], a[176:179], v[96:99]
 ds_read_b64_tr_b16 a[52:53], v5 offset:53248
 v_mul_f32 v86, v86, v65
 v_mfma_f32_16x16x32_bf16 v[96:99], a[20:23], a[180:183], v[96:99]
 ds_read_b64_tr_b16 a[54:55], v5 offset:55296
 v_mul_f32 v87, v87, v65
 v_mfma_f32_16x16x32_bf16 v[96:99], a[24:27], a[184:187], v[96:99]
 s_add_u32 m0, s29, 102400
 ds_read_b64_tr_b16 a[56:57], v5 offset:57344
 v_cvt_pk_bf16_f32 v80, v80, v81
 v_mfma_f32_16x16x32_bf16 v[96:99], a[28:31], a[188:191], v[96:99]
 s_waitcnt lgkmcnt(7)
 ds_read_b64_tr_b16 a[58:59], v5 offset:59392
 v_cvt_pk_bf16_f32 v81, v82, v83
 v_mfma_f32_16x16x32_bf16 v[92:95], a[32:35], a[128:131], 0
 ds_read_b64_tr_b16 a[60:61], v5 offset:61440
 buffer_load_dwordx4 v2, s[8:11], s79 offen lds
 v_mfma_f32_16x16x32_bf16 v[92:95], a[36:39], a[132:135], v[92:95]
 s_add_u32 s58, s48, 1027072
 ds_read_b64_tr_b16 a[62:63], v5 offset:63488
 v_cvt_pk_bf16_f32 v82, v84, v85
 v_mfma_f32_16x16x32_bf16 v[92:95], a[40:43], a[136:139], v[92:95]
 s_waitcnt lgkmcnt(4)
 ds_read_b64_tr_b16 a[0:1], v6 offset:32768
 v_cvt_pk_bf16_f32 v83, v86, v87
 v_mfma_f32_16x16x32_bf16 v[92:95], a[44:47], a[140:143], v[92:95]
 ds_read_b64_tr_b16 a[2:3], v6 offset:34816
 buffer_store_dwordx4 v[80:83], v1, s[12:15], s58 offen sc1
 v_mfma_f32_16x16x32_bf16 v[92:95], a[48:51], a[144:147], v[92:95]
 ds_read_b64_tr_b16 a[4:5], v6 offset:36864
 v_mul_f32 v88, v88, v64
 v_mfma_f32_16x16x32_bf16 v[92:95], a[52:55], a[148:151], v[92:95]
 s_waitcnt lgkmcnt(3)
 ds_read_b64_tr_b16 a[6:7], v6 offset:38912
 v_mul_f32 v89, v89, v64
 v_mfma_f32_16x16x32_bf16 v[92:95], a[56:59], a[152:155], v[92:95]
 s_add_u32 m0, s29, 106496
 ds_read_b64_tr_b16 a[8:9], v6 offset:40960
 v_mul_f32 v90, v90, v64
 v_mfma_f32_16x16x32_bf16 v[92:95], a[60:63], a[156:159], v[92:95]
 ds_read_b64_tr_b16 a[10:11], v6 offset:43008
 buffer_load_dwordx4 v2, s[8:11], s80 offen lds
 v_mfma_f32_16x16x32_bf16 v[100:103], a[32:35], a[160:163], 0
 ds_read_b64_tr_b16 a[12:13], v6 offset:45056
 v_mul_f32 v91, v91, v64
 v_mfma_f32_16x16x32_bf16 v[100:103], a[36:39], a[164:167], v[100:103]
 ds_read_b64_tr_b16 a[14:15], v6 offset:47104
 v_mul_f32 v96, v96, v65
 v_mfma_f32_16x16x32_bf16 v[100:103], a[40:43], a[168:171], v[100:103]
 ds_read_b64_tr_b16 a[16:17], v6 offset:49152
 v_mul_f32 v97, v97, v65
 v_mfma_f32_16x16x32_bf16 v[100:103], a[44:47], a[172:175], v[100:103]
 ds_read_b64_tr_b16 a[18:19], v6 offset:51200
 v_mul_f32 v98, v98, v65
 v_mfma_f32_16x16x32_bf16 v[100:103], a[48:51], a[176:179], v[100:103]
 ds_read_b64_tr_b16 a[20:21], v6 offset:53248
 v_mul_f32 v92, v92, v64
 v_mfma_f32_16x16x32_bf16 v[100:103], a[52:55], a[180:183], v[100:103]
 s_add_u32 m0, s29, 110592
 ds_read_b64_tr_b16 a[22:23], v6 offset:55296
 v_mul_f32 v93, v93, v64
 v_mfma_f32_16x16x32_bf16 v[100:103], a[56:59], a[184:187], v[100:103]
 ds_read_b64_tr_b16 a[24:25], v6 offset:57344
 buffer_load_dwordx4 v2, s[8:11], s81 offen lds
 v_mfma_f32_16x16x32_bf16 v[100:103], a[60:63], a[188:191], v[100:103]
 s_waitcnt lgkmcnt(7)
 ds_read_b64_tr_b16 a[26:27], v6 offset:59392
 v_mul_f32 v94, v94, v64
 v_mfma_f32_16x16x32_bf16 v[104:107], a[0:3], a[128:131], 0
 ds_read_b64_tr_b16 a[28:29], v6 offset:61440
 v_mul_f32 v95, v95, v64
 v_mfma_f32_16x16x32_bf16 v[104:107], a[4:7], a[132:135], v[104:107]
 ds_read_b64_tr_b16 a[30:31], v6 offset:63488
 v_cvt_pk_bf16_f32 v88, v88, v89
 v_mfma_f32_16x16x32_bf16 v[104:107], a[8:11], a[136:139], v[104:107]
 s_waitcnt lgkmcnt(4)
 ds_read_b64_tr_b16 a[32:33], v7 offset:32768
 v_cvt_pk_bf16_f32 v89, v90, v91
 v_mfma_f32_16x16x32_bf16 v[104:107], a[12:15], a[140:143], v[104:107]
 ds_read_b64_tr_b16 a[34:35], v7 offset:34816
 v_cvt_pk_bf16_f32 v90, v92, v93
 v_mfma_f32_16x16x32_bf16 v[104:107], a[16:19], a[144:147], v[104:107]
 s_add_u32 m0, s29, 114688
 ds_read_b64_tr_b16 a[36:37], v7 offset:36864
 v_cvt_pk_bf16_f32 v91, v94, v95
 v_mfma_f32_16x16x32_bf16 v[104:107], a[20:23], a[148:151], v[104:107]
 s_waitcnt lgkmcnt(3)
 ds_read_b64_tr_b16 a[38:39], v7 offset:38912
 buffer_load_dwordx4 v2, s[8:11], s82 offen lds
 v_mfma_f32_16x16x32_bf16 v[104:107], a[24:27], a[152:155], v[104:107]
 s_add_u32 s58, s48, 69632
 ds_read_b64_tr_b16 a[40:41], v7 offset:40960
 v_mul_f32 v99, v99, v65
 v_mfma_f32_16x16x32_bf16 v[104:107], a[28:31], a[156:159], v[104:107]
 ds_read_b64_tr_b16 a[42:43], v7 offset:43008
 buffer_store_dwordx4 v[88:91], v1, s[12:15], s58 offen sc1
 v_mfma_f32_16x16x32_bf16 v[112:115], a[0:3], a[160:163], 0
 ds_read_b64_tr_b16 a[44:45], v7 offset:45056
 v_mul_f32 v100, v100, v65
 v_mfma_f32_16x16x32_bf16 v[112:115], a[4:7], a[164:167], v[112:115]
 ds_read_b64_tr_b16 a[46:47], v7 offset:47104
 v_mul_f32 v101, v101, v65
 v_mfma_f32_16x16x32_bf16 v[112:115], a[8:11], a[168:171], v[112:115]
 ds_read_b64_tr_b16 a[48:49], v7 offset:49152
 v_mul_f32 v102, v102, v65
 v_mfma_f32_16x16x32_bf16 v[112:115], a[12:15], a[172:175], v[112:115]
 s_add_u32 m0, s29, 118784
 ds_read_b64_tr_b16 a[50:51], v7 offset:51200
 v_mul_f32 v103, v103, v65
 v_mfma_f32_16x16x32_bf16 v[112:115], a[16:19], a[176:179], v[112:115]
 ds_read_b64_tr_b16 a[52:53], v7 offset:53248
 buffer_load_dwordx4 v2, s[8:11], s83 offen lds
 v_mfma_f32_16x16x32_bf16 v[112:115], a[20:23], a[180:183], v[112:115]
 ds_read_b64_tr_b16 a[54:55], v7 offset:55296
 v_cvt_pk_bf16_f32 v96, v96, v97
 v_mfma_f32_16x16x32_bf16 v[112:115], a[24:27], a[184:187], v[112:115]
 ds_read_b64_tr_b16 a[56:57], v7 offset:57344
 v_cvt_pk_bf16_f32 v97, v98, v99
 v_mfma_f32_16x16x32_bf16 v[112:115], a[28:31], a[188:191], v[112:115]
 s_waitcnt lgkmcnt(7)
 ds_read_b64_tr_b16 a[58:59], v7 offset:59392
 v_cvt_pk_bf16_f32 v98, v100, v101
 v_mfma_f32_16x16x32_bf16 v[108:111], a[32:35], a[128:131], 0
 s_waitcnt vmcnt(9)
 ds_read_b64_tr_b16 a[60:61], v7 offset:61440
 v_cvt_pk_bf16_f32 v99, v102, v103
 v_mfma_f32_16x16x32_bf16 v[108:111], a[36:39], a[132:135], v[108:111]
 s_barrier
 ds_read_b64_tr_b16 a[62:63], v7 offset:63488
 v_xor_b32 v4, 0x10000, v4
 v_mfma_f32_16x16x32_bf16 v[108:111], a[40:43], a[136:139], v[108:111]
 s_waitcnt lgkmcnt(4)
 ds_read_b64_tr_b16 a[0:1], v4 offset:0
 v_mul_f32 v104, v104, v64
 v_mfma_f32_16x16x32_bf16 v[108:111], a[44:47], a[140:143], v[108:111]
 s_add_u32 m0, s29, 122880
 ds_read_b64_tr_b16 a[2:3], v4 offset:2048
 v_mul_f32 v105, v105, v64
 v_mfma_f32_16x16x32_bf16 v[108:111], a[48:51], a[144:147], v[108:111]
 ds_read_b64_tr_b16 a[4:5], v4 offset:4096
 buffer_load_dwordx4 v2, s[8:11], s84 offen lds
 v_mfma_f32_16x16x32_bf16 v[108:111], a[52:55], a[148:151], v[108:111]
 s_waitcnt lgkmcnt(3)
 ds_read_b64_tr_b16 a[6:7], v4 offset:6144
 v_mul_f32 v106, v106, v64
 v_mfma_f32_16x16x32_bf16 v[108:111], a[56:59], a[152:155], v[108:111]
 s_add_u32 s58, s48, 1044480
 ds_read_b64_tr_b16 a[8:9], v4 offset:8192
 v_mul_f32 v107, v107, v64
 v_mfma_f32_16x16x32_bf16 v[108:111], a[60:63], a[156:159], v[108:111]
 ds_read_b64_tr_b16 a[10:11], v4 offset:10240
 buffer_store_dwordx4 v[96:99], v1, s[12:15], s58 offen sc1
 v_mfma_f32_16x16x32_bf16 v[116:119], a[32:35], a[160:163], 0
 ds_read_b64_tr_b16 a[12:13], v4 offset:12288
 v_mul_f32 v112, v112, v65
 v_mfma_f32_16x16x32_bf16 v[116:119], a[36:39], a[164:167], v[116:119]
 ds_read_b64_tr_b16 a[14:15], v4 offset:14336
 v_mul_f32 v113, v113, v65
 v_mfma_f32_16x16x32_bf16 v[116:119], a[40:43], a[168:171], v[116:119]
 s_add_u32 m0, s29, 126976
 ds_read_b64_tr_b16 a[16:17], v4 offset:16384
 v_mul_f32 v114, v114, v65
 v_mfma_f32_16x16x32_bf16 v[116:119], a[44:47], a[172:175], v[116:119]
 ds_read_b64_tr_b16 a[18:19], v4 offset:18432
 buffer_load_dwordx4 v2, s[8:11], s85 offen lds
 v_mfma_f32_16x16x32_bf16 v[116:119], a[48:51], a[176:179], v[116:119]
 ds_read_b64_tr_b16 a[20:21], v4 offset:20480
 v_add_u32 v2, 128, v2
 v_mfma_f32_16x16x32_bf16 v[116:119], a[52:55], a[180:183], v[116:119]
 ds_read_b64_tr_b16 a[22:23], v4 offset:22528
 v_mul_f32 v108, v108, v64
 v_mfma_f32_16x16x32_bf16 v[116:119], a[56:59], a[184:187], v[116:119]
 ds_read_b64_tr_b16 a[24:25], v4 offset:24576
 v_mul_f32 v109, v109, v64
 v_mfma_f32_16x16x32_bf16 v[116:119], a[60:63], a[188:191], v[116:119]
 s_waitcnt lgkmcnt(7)
 ds_read_b64_tr_b16 a[26:27], v4 offset:26624
 v_mul_f32 v110, v110, v64
 v_mfma_f32_16x16x32_bf16 v[72:75], a[0:3], a[128:131], 0
 ds_read_b64_tr_b16 a[28:29], v4 offset:28672
 v_mul_f32 v111, v111, v64
 v_mfma_f32_16x16x32_bf16 v[72:75], a[4:7], a[132:135], v[72:75]
 ds_read_b64_tr_b16 a[30:31], v4 offset:30720
 v_xor_b32 v5, 0x10000, v5
 v_mfma_f32_16x16x32_bf16 v[72:75], a[8:11], a[136:139], v[72:75]
 s_waitcnt lgkmcnt(4)
 ds_read_b64_tr_b16 a[32:33], v5 offset:0
 v_cvt_pk_bf16_f32 v104, v104, v105
 v_mfma_f32_16x16x32_bf16 v[72:75], a[12:15], a[140:143], v[72:75]
 s_add_u32 m0, s29, 131072
 ds_read_b64_tr_b16 a[34:35], v5 offset:2048
 v_cvt_pk_bf16_f32 v105, v106, v107
 v_mfma_f32_16x16x32_bf16 v[72:75], a[16:19], a[144:147], v[72:75]
 ds_read_b64_tr_b16 a[36:37], v5 offset:4096
 buffer_load_dwordx4 v2, s[8:11], s78 offen lds
 v_mfma_f32_16x16x32_bf16 v[72:75], a[20:23], a[148:151], v[72:75]
 s_waitcnt lgkmcnt(3)
 ds_read_b64_tr_b16 a[38:39], v5 offset:6144
 v_cvt_pk_bf16_f32 v106, v108, v109
 v_mfma_f32_16x16x32_bf16 v[72:75], a[24:27], a[152:155], v[72:75]
 s_add_u32 s58, s48, 87040
 ds_read_b64_tr_b16 a[40:41], v5 offset:8192
 v_cvt_pk_bf16_f32 v107, v110, v111
 v_mfma_f32_16x16x32_bf16 v[72:75], a[28:31], a[156:159], v[72:75]
 ds_read_b64_tr_b16 a[42:43], v5 offset:10240
 buffer_store_dwordx4 v[104:107], v1, s[12:15], s58 offen sc1
 v_mfma_f32_16x16x32_bf16 v[80:83], a[0:3], a[160:163], 0
 ds_read_b64_tr_b16 a[44:45], v5 offset:12288
 v_mul_f32 v115, v115, v65
 v_mfma_f32_16x16x32_bf16 v[80:83], a[4:7], a[164:167], v[80:83]
 ds_read_b64_tr_b16 a[46:47], v5 offset:14336
 v_mul_f32 v116, v116, v65
 v_mfma_f32_16x16x32_bf16 v[80:83], a[8:11], a[168:171], v[80:83]
 s_add_u32 m0, s29, 135168
 ds_read_b64_tr_b16 a[48:49], v5 offset:16384
 v_mul_f32 v117, v117, v65
 v_mfma_f32_16x16x32_bf16 v[80:83], a[12:15], a[172:175], v[80:83]
 ds_read_b64_tr_b16 a[50:51], v5 offset:18432
 buffer_load_dwordx4 v2, s[8:11], s79 offen lds
 v_mfma_f32_16x16x32_bf16 v[80:83], a[16:19], a[176:179], v[80:83]
 ds_read_b64_tr_b16 a[52:53], v5 offset:20480
 v_mul_f32 v118, v118, v65
 v_mfma_f32_16x16x32_bf16 v[80:83], a[20:23], a[180:183], v[80:83]
 ds_read_b64_tr_b16 a[54:55], v5 offset:22528
 v_mul_f32 v119, v119, v65
 v_mfma_f32_16x16x32_bf16 v[80:83], a[24:27], a[184:187], v[80:83]
 ds_read_b64_tr_b16 a[56:57], v5 offset:24576
 v_cvt_pk_bf16_f32 v112, v112, v113
 v_mfma_f32_16x16x32_bf16 v[80:83], a[28:31], a[188:191], v[80:83]
 s_waitcnt lgkmcnt(7)
 ds_read_b64_tr_b16 a[58:59], v5 offset:26624
 v_cvt_pk_bf16_f32 v113, v114, v115
 v_mfma_f32_16x16x32_bf16 v[76:79], a[32:35], a[128:131], 0
 ds_read_b64_tr_b16 a[60:61], v5 offset:28672
 v_cvt_pk_bf16_f32 v114, v116, v117
 v_mfma_f32_16x16x32_bf16 v[76:79], a[36:39], a[132:135], v[76:79]
 s_add_u32 m0, s29, 139264
 ds_read_b64_tr_b16 a[62:63], v5 offset:30720
 v_xor_b32 v6, 0x10000, v6
 v_mfma_f32_16x16x32_bf16 v[76:79], a[40:43], a[136:139], v[76:79]
 s_waitcnt lgkmcnt(4)
 ds_read_b64_tr_b16 a[0:1], v6 offset:0
 buffer_load_dwordx4 v2, s[8:11], s80 offen lds
 v_mfma_f32_16x16x32_bf16 v[76:79], a[44:47], a[140:143], v[76:79]
 s_add_u32 s58, s48, 1061888
 ds_read_b64_tr_b16 a[2:3], v6 offset:2048
 v_cvt_pk_bf16_f32 v115, v118, v119
 v_mfma_f32_16x16x32_bf16 v[76:79], a[48:51], a[144:147], v[76:79]
 ds_read_b64_tr_b16 a[4:5], v6 offset:4096
 buffer_store_dwordx4 v[112:115], v1, s[12:15], s58 offen sc1
 v_mfma_f32_16x16x32_bf16 v[76:79], a[52:55], a[148:151], v[76:79]
 s_waitcnt lgkmcnt(3)
 ds_read_b64_tr_b16 a[6:7], v6 offset:6144
 v_mul_f32 v72, v72, v64
 v_mfma_f32_16x16x32_bf16 v[76:79], a[56:59], a[152:155], v[76:79]
 ds_read_b64_tr_b16 a[8:9], v6 offset:8192
 v_mul_f32 v73, v73, v64
 v_mfma_f32_16x16x32_bf16 v[76:79], a[60:63], a[156:159], v[76:79]
 ds_read_b64_tr_b16 a[10:11], v6 offset:10240
 v_mul_f32 v74, v74, v64
 v_mfma_f32_16x16x32_bf16 v[84:87], a[32:35], a[160:163], 0
 s_add_u32 m0, s29, 143360
 ds_read_b64_tr_b16 a[12:13], v6 offset:12288
 v_mul_f32 v75, v75, v64
 v_mfma_f32_16x16x32_bf16 v[84:87], a[36:39], a[164:167], v[84:87]
 ds_read_b64_tr_b16 a[14:15], v6 offset:14336
 buffer_load_dwordx4 v2, s[8:11], s81 offen lds
 v_mfma_f32_16x16x32_bf16 v[84:87], a[40:43], a[168:171], v[84:87]
 ds_read_b64_tr_b16 a[16:17], v6 offset:16384
 v_mul_f32 v80, v80, v65
 v_mfma_f32_16x16x32_bf16 v[84:87], a[44:47], a[172:175], v[84:87]
 ds_read_b64_tr_b16 a[18:19], v6 offset:18432
 v_mul_f32 v81, v81, v65
 v_mfma_f32_16x16x32_bf16 v[84:87], a[48:51], a[176:179], v[84:87]
 ds_read_b64_tr_b16 a[20:21], v6 offset:20480
 v_mul_f32 v76, v76, v64
 v_mfma_f32_16x16x32_bf16 v[84:87], a[52:55], a[180:183], v[84:87]
 ds_read_b64_tr_b16 a[22:23], v6 offset:22528
 v_mul_f32 v77, v77, v64
 v_mfma_f32_16x16x32_bf16 v[84:87], a[56:59], a[184:187], v[84:87]
 s_add_u32 m0, s29, 147456
 ds_read_b64_tr_b16 a[24:25], v6 offset:24576
 v_mul_f32 v78, v78, v64
 v_mfma_f32_16x16x32_bf16 v[84:87], a[60:63], a[188:191], v[84:87]
 s_waitcnt lgkmcnt(7)
 ds_read_b64_tr_b16 a[26:27], v6 offset:26624
 v_mul_f32 v79, v79, v64
 v_mfma_f32_16x16x32_bf16 v[88:91], a[0:3], a[128:131], 0
 ds_read_b64_tr_b16 a[28:29], v6 offset:28672
 buffer_load_dwordx4 v2, s[8:11], s82 offen lds
 v_mfma_f32_16x16x32_bf16 v[88:91], a[4:7], a[132:135], v[88:91]
 ds_read_b64_tr_b16 a[30:31], v6 offset:30720
 v_xor_b32 v7, 0x10000, v7
 v_mfma_f32_16x16x32_bf16 v[88:91], a[8:11], a[136:139], v[88:91]
 s_waitcnt lgkmcnt(4)
 ds_read_b64_tr_b16 a[32:33], v7 offset:0
 v_cvt_pk_bf16_f32 v72, v72, v73
 v_mfma_f32_16x16x32_bf16 v[88:91], a[12:15], a[140:143], v[88:91]
 ds_read_b64_tr_b16 a[34:35], v7 offset:2048
 v_cvt_pk_bf16_f32 v73, v74, v75
 v_mfma_f32_16x16x32_bf16 v[88:91], a[16:19], a[144:147], v[88:91]
 ds_read_b64_tr_b16 a[36:37], v7 offset:4096
 v_cvt_pk_bf16_f32 v74, v76, v77
 v_mfma_f32_16x16x32_bf16 v[88:91], a[20:23], a[148:151], v[88:91]
 s_waitcnt lgkmcnt(3)
 ds_read_b64_tr_b16 a[38:39], v7 offset:6144
 v_cvt_pk_bf16_f32 v75, v78, v79
 v_mfma_f32_16x16x32_bf16 v[88:91], a[24:27], a[152:155], v[88:91]
 s_add_u32 m0, s29, 151552
 ds_read_b64_tr_b16 a[40:41], v7 offset:8192
 v_mul_f32 v82, v82, v65
 v_mfma_f32_16x16x32_bf16 v[88:91], a[28:31], a[156:159], v[88:91]
 ds_read_b64_tr_b16 a[42:43], v7 offset:10240
 buffer_load_dwordx4 v2, s[8:11], s83 offen lds
 v_mfma_f32_16x16x32_bf16 v[96:99], a[0:3], a[160:163], 0
 s_add_u32 s58, s48, 104448
 ds_read_b64_tr_b16 a[44:45], v7 offset:12288
 v_mul_f32 v83, v83, v65
 v_mfma_f32_16x16x32_bf16 v[96:99], a[4:7], a[164:167], v[96:99]
 ds_read_b64_tr_b16 a[46:47], v7 offset:14336
 buffer_store_dwordx4 v[72:75], v1, s[12:15], s58 offen sc1
 v_mfma_f32_16x16x32_bf16 v[96:99], a[8:11], a[168:171], v[96:99]
 ds_read_b64_tr_b16 a[48:49], v7 offset:16384
 v_mul_f32 v84, v84, v65
 v_mfma_f32_16x16x32_bf16 v[96:99], a[12:15], a[172:175], v[96:99]
 ds_read_b64_tr_b16 a[50:51], v7 offset:18432
 v_mul_f32 v85, v85, v65
 v_mfma_f32_16x16x32_bf16 v[96:99], a[16:19], a[176:179], v[96:99]
 ds_read_b64_tr_b16 a[52:53], v7 offset:20480
 v_mul_f32 v86, v86, v65
 v_mfma_f32_16x16x32_bf16 v[96:99], a[20:23], a[180:183], v[96:99]
 s_add_u32 m0, s29, 155648
 ds_read_b64_tr_b16 a[54:55], v7 offset:22528
 v_mul_f32 v87, v87, v65
 v_mfma_f32_16x16x32_bf16 v[96:99], a[24:27], a[184:187], v[96:99]
 ds_read_b64_tr_b16 a[56:57], v7 offset:24576
 buffer_load_dwordx4 v2, s[8:11], s84 offen lds
 v_mfma_f32_16x16x32_bf16 v[96:99], a[28:31], a[188:191], v[96:99]
 s_waitcnt lgkmcnt(7)
 ds_read_b64_tr_b16 a[58:59], v7 offset:26624
 v_cvt_pk_bf16_f32 v80, v80, v81
 v_mfma_f32_16x16x32_bf16 v[92:95], a[32:35], a[128:131], 0
 s_waitcnt vmcnt(10)
 ds_read_b64_tr_b16 a[60:61], v7 offset:28672
 v_cvt_pk_bf16_f32 v81, v82, v83
 v_mfma_f32_16x16x32_bf16 v[92:95], a[36:39], a[132:135], v[92:95]
 s_barrier
 ds_read_b64_tr_b16 a[62:63], v7 offset:30720
 v_cvt_pk_bf16_f32 v82, v84, v85
 v_mfma_f32_16x16x32_bf16 v[92:95], a[40:43], a[136:139], v[92:95]
 s_waitcnt lgkmcnt(4)
 ds_read_b64_tr_b16 a[0:1], v4 offset:32768
 v_cvt_pk_bf16_f32 v83, v86, v87
 v_mfma_f32_16x16x32_bf16 v[92:95], a[44:47], a[140:143], v[92:95]
 ds_read_b64_tr_b16 a[2:3], v4 offset:34816
 v_mul_f32 v88, v88, v64
 v_mfma_f32_16x16x32_bf16 v[92:95], a[48:51], a[144:147], v[92:95]
 s_add_u32 m0, s29, 159744
 ds_read_b64_tr_b16 a[4:5], v4 offset:36864
 v_mul_f32 v89, v89, v64
 v_mfma_f32_16x16x32_bf16 v[92:95], a[52:55], a[148:151], v[92:95]
 s_waitcnt lgkmcnt(3)
 ds_read_b64_tr_b16 a[6:7], v4 offset:38912
 buffer_load_dwordx4 v2, s[8:11], s85 offen lds
 v_mfma_f32_16x16x32_bf16 v[92:95], a[56:59], a[152:155], v[92:95]
 s_add_u32 s58, s48, 1079296
 ds_read_b64_tr_b16 a[8:9], v4 offset:40960
 v_add_u32 v2, 128, v2
 v_mfma_f32_16x16x32_bf16 v[92:95], a[60:63], a[156:159], v[92:95]
 ds_read_b64_tr_b16 a[10:11], v4 offset:43008
 buffer_store_dwordx4 v[80:83], v1, s[12:15], s58 offen sc1
 v_mfma_f32_16x16x32_bf16 v[100:103], a[32:35], a[160:163], 0
 ds_read_b64_tr_b16 a[12:13], v4 offset:45056
 v_mul_f32 v90, v90, v64
 v_mfma_f32_16x16x32_bf16 v[100:103], a[36:39], a[164:167], v[100:103]
 ds_read_b64_tr_b16 a[14:15], v4 offset:47104
 v_mul_f32 v91, v91, v64
 v_mfma_f32_16x16x32_bf16 v[100:103], a[40:43], a[168:171], v[100:103]
 ds_read_b64_tr_b16 a[16:17], v4 offset:49152
 v_mul_f32 v96, v96, v65
 v_mfma_f32_16x16x32_bf16 v[100:103], a[44:47], a[172:175], v[100:103]
 ds_read_b64_tr_b16 a[18:19], v4 offset:51200
 v_mul_f32 v97, v97, v65
 v_mfma_f32_16x16x32_bf16 v[100:103], a[48:51], a[176:179], v[100:103]
 ds_read_b64_tr_b16 a[20:21], v4 offset:53248
 v_mul_f32 v92, v92, v64
 v_mfma_f32_16x16x32_bf16 v[100:103], a[52:55], a[180:183], v[100:103]
 ds_read_b64_tr_b16 a[22:23], v4 offset:55296
 v_mul_f32 v93, v93, v64
 v_mfma_f32_16x16x32_bf16 v[100:103], a[56:59], a[184:187], v[100:103]
 ds_read_b64_tr_b16 a[24:25], v4 offset:57344
 v_mul_f32 v94, v94, v64
 v_mfma_f32_16x16x32_bf16 v[100:103], a[60:63], a[188:191], v[100:103]
 s_waitcnt lgkmcnt(7)
 ds_read_b64_tr_b16 a[26:27], v4 offset:59392
 v_mul_f32 v95, v95, v64
 v_mfma_f32_16x16x32_bf16 v[104:107], a[0:3], a[128:131], 0
 ds_read_b64_tr_b16 a[28:29], v4 offset:61440
 v_cvt_pk_bf16_f32 v88, v88, v89
 v_mfma_f32_16x16x32_bf16 v[104:107], a[4:7], a[132:135], v[104:107]
 ds_read_b64_tr_b16 a[30:31], v4 offset:63488
 v_cvt_pk_bf16_f32 v89, v90, v91
 v_mfma_f32_16x16x32_bf16 v[104:107], a[8:11], a[136:139], v[104:107]
 s_waitcnt lgkmcnt(4)
 ds_read_b64_tr_b16 a[32:33], v5 offset:32768
 v_cvt_pk_bf16_f32 v90, v92, v93
 v_mfma_f32_16x16x32_bf16 v[104:107], a[12:15], a[140:143], v[104:107]
 s_add_u32 m0, s29, 0
 ds_read_b64_tr_b16 a[34:35], v5 offset:34816
 v_cvt_pk_bf16_f32 v91, v94, v95
 v_mfma_f32_16x16x32_bf16 v[104:107], a[16:19], a[144:147], v[104:107]
 ds_read_b64_tr_b16 a[36:37], v5 offset:36864
 buffer_load_dwordx4 v2, s[8:11], s78 offen lds
 v_mfma_f32_16x16x32_bf16 v[104:107], a[20:23], a[148:151], v[104:107]
 s_waitcnt lgkmcnt(3)
 ds_read_b64_tr_b16 a[38:39], v5 offset:38912
 v_mul_f32 v98, v98, v65
 v_mfma_f32_16x16x32_bf16 v[104:107], a[24:27], a[152:155], v[104:107]
 s_add_u32 s58, s48, 121856
 ds_read_b64_tr_b16 a[40:41], v5 offset:40960
 v_mul_f32 v99, v99, v65
 v_mfma_f32_16x16x32_bf16 v[104:107], a[28:31], a[156:159], v[104:107]
 ds_read_b64_tr_b16 a[42:43], v5 offset:43008
 buffer_store_dwordx4 v[88:91], v1, s[12:15], s58 offen sc1
 v_mfma_f32_16x16x32_bf16 v[112:115], a[0:3], a[160:163], 0
 ds_read_b64_tr_b16 a[44:45], v5 offset:45056
 v_mul_f32 v100, v100, v65
 v_mfma_f32_16x16x32_bf16 v[112:115], a[4:7], a[164:167], v[112:115]
 ds_read_b64_tr_b16 a[46:47], v5 offset:47104
 v_mul_f32 v101, v101, v65
 v_mfma_f32_16x16x32_bf16 v[112:115], a[8:11], a[168:171], v[112:115]
 s_add_u32 m0, s29, 4096
 ds_read_b64_tr_b16 a[48:49], v5 offset:49152
 v_mul_f32 v102, v102, v65
 v_mfma_f32_16x16x32_bf16 v[112:115], a[12:15], a[172:175], v[112:115]
 ds_read_b64_tr_b16 a[50:51], v5 offset:51200
 buffer_load_dwordx4 v2, s[8:11], s79 offen lds
 v_mfma_f32_16x16x32_bf16 v[112:115], a[16:19], a[176:179], v[112:115]
 ds_read_b64_tr_b16 a[52:53], v5 offset:53248
 v_mul_f32 v103, v103, v65
 v_mfma_f32_16x16x32_bf16 v[112:115], a[20:23], a[180:183], v[112:115]
 ds_read_b64_tr_b16 a[54:55], v5 offset:55296
 v_cvt_pk_bf16_f32 v96, v96, v97
 v_mfma_f32_16x16x32_bf16 v[112:115], a[24:27], a[184:187], v[112:115]
 ds_read_b64_tr_b16 a[56:57], v5 offset:57344
 v_cvt_pk_bf16_f32 v97, v98, v99
 v_mfma_f32_16x16x32_bf16 v[112:115], a[28:31], a[188:191], v[112:115]
 s_waitcnt lgkmcnt(7)
 ds_read_b64_tr_b16 a[58:59], v5 offset:59392
 v_cvt_pk_bf16_f32 v98, v100, v101
 v_mfma_f32_16x16x32_bf16 v[108:111], a[32:35], a[128:131], 0
 ds_read_b64_tr_b16 a[60:61], v5 offset:61440
 v_cvt_pk_bf16_f32 v99, v102, v103
 v_mfma_f32_16x16x32_bf16 v[108:111], a[36:39], a[132:135], v[108:111]
 s_add_u32 m0, s29, 8192
 ds_read_b64_tr_b16 a[62:63], v5 offset:63488
 v_mul_f32 v104, v104, v64
 v_mfma_f32_16x16x32_bf16 v[108:111], a[40:43], a[136:139], v[108:111]
 s_waitcnt lgkmcnt(4)
 ds_read_b64_tr_b16 a[0:1], v6 offset:32768
 buffer_load_dwordx4 v2, s[8:11], s80 offen lds
 v_mfma_f32_16x16x32_bf16 v[108:111], a[44:47], a[140:143], v[108:111]
 s_add_u32 s58, s48, 1096704
 ds_read_b64_tr_b16 a[2:3], v6 offset:34816
 v_mul_f32 v105, v105, v64
 v_mfma_f32_16x16x32_bf16 v[108:111], a[48:51], a[144:147], v[108:111]
 ds_read_b64_tr_b16 a[4:5], v6 offset:36864
 buffer_store_dwordx4 v[96:99], v1, s[12:15], s58 offen sc1
 v_mfma_f32_16x16x32_bf16 v[108:111], a[52:55], a[148:151], v[108:111]
 s_waitcnt lgkmcnt(3)
 ds_read_b64_tr_b16 a[6:7], v6 offset:38912
 v_mul_f32 v106, v106, v64
 v_mfma_f32_16x16x32_bf16 v[108:111], a[56:59], a[152:155], v[108:111]
 ds_read_b64_tr_b16 a[8:9], v6 offset:40960
 v_mul_f32 v107, v107, v64
 v_mfma_f32_16x16x32_bf16 v[108:111], a[60:63], a[156:159], v[108:111]
 ds_read_b64_tr_b16 a[10:11], v6 offset:43008
 v_mul_f32 v112, v112, v65
 v_mfma_f32_16x16x32_bf16 v[116:119], a[32:35], a[160:163], 0
 s_add_u32 m0, s29, 12288
 ds_read_b64_tr_b16 a[12:13], v6 offset:45056
 v_mul_f32 v113, v113, v65
 v_mfma_f32_16x16x32_bf16 v[116:119], a[36:39], a[164:167], v[116:119]
 ds_read_b64_tr_b16 a[14:15], v6 offset:47104
 buffer_load_dwordx4 v2, s[8:11], s81 offen lds
 v_mfma_f32_16x16x32_bf16 v[116:119], a[40:43], a[168:171], v[116:119]
 ds_read_b64_tr_b16 a[16:17], v6 offset:49152
 v_mul_f32 v114, v114, v65
 v_mfma_f32_16x16x32_bf16 v[116:119], a[44:47], a[172:175], v[116:119]
 ds_read_b64_tr_b16 a[18:19], v6 offset:51200
 v_mul_f32 v115, v115, v65
 v_mfma_f32_16x16x32_bf16 v[116:119], a[48:51], a[176:179], v[116:119]
 ds_read_b64_tr_b16 a[20:21], v6 offset:53248
 v_mul_f32 v108, v108, v64
 v_mfma_f32_16x16x32_bf16 v[116:119], a[52:55], a[180:183], v[116:119]
 ds_read_b64_tr_b16 a[22:23], v6 offset:55296
 v_mul_f32 v109, v109, v64
 v_mfma_f32_16x16x32_bf16 v[116:119], a[56:59], a[184:187], v[116:119]
 s_add_u32 m0, s29, 16384
 ds_read_b64_tr_b16 a[24:25], v6 offset:57344
 v_mul_f32 v110, v110, v64
 v_mfma_f32_16x16x32_bf16 v[116:119], a[60:63], a[188:191], v[116:119]
 s_waitcnt lgkmcnt(7)
 ds_read_b64_tr_b16 a[26:27], v6 offset:59392
 v_mul_f32 v111, v111, v64
 v_mfma_f32_16x16x32_bf16 v[72:75], a[0:3], a[128:131], 0
 ds_read_b64_tr_b16 a[28:29], v6 offset:61440
 buffer_load_dwordx4 v2, s[8:11], s82 offen lds
 v_mfma_f32_16x16x32_bf16 v[72:75], a[4:7], a[132:135], v[72:75]
 ds_read_b64_tr_b16 a[30:31], v6 offset:63488
 v_cvt_pk_bf16_f32 v104, v104, v105
 v_mfma_f32_16x16x32_bf16 v[72:75], a[8:11], a[136:139], v[72:75]
 s_waitcnt lgkmcnt(4)
 ds_read_b64_tr_b16 a[32:33], v7 offset:32768
 v_cvt_pk_bf16_f32 v105, v106, v107
 v_mfma_f32_16x16x32_bf16 v[72:75], a[12:15], a[140:143], v[72:75]
 ds_read_b64_tr_b16 a[34:35], v7 offset:34816
 v_cvt_pk_bf16_f32 v106, v108, v109
 v_mfma_f32_16x16x32_bf16 v[72:75], a[16:19], a[144:147], v[72:75]
 s_add_u32 s58, s48, 139264
 ds_read_b64_tr_b16 a[36:37], v7 offset:36864
 v_cvt_pk_bf16_f32 v107, v110, v111
 v_mfma_f32_16x16x32_bf16 v[72:75], a[20:23], a[148:151], v[72:75]
 s_waitcnt lgkmcnt(3)
 ds_read_b64_tr_b16 a[38:39], v7 offset:38912
 buffer_store_dwordx4 v[104:107], v1, s[12:15], s58 offen sc1
 v_mfma_f32_16x16x32_bf16 v[72:75], a[24:27], a[152:155], v[72:75]
 s_add_u32 m0, s29, 20480
 ds_read_b64_tr_b16 a[40:41], v7 offset:40960
 v_mul_f32 v116, v116, v65
 v_mfma_f32_16x16x32_bf16 v[72:75], a[28:31], a[156:159], v[72:75]
 ds_read_b64_tr_b16 a[42:43], v7 offset:43008
 buffer_load_dwordx4 v2, s[8:11], s83 offen lds
 v_mfma_f32_16x16x32_bf16 v[80:83], a[0:3], a[160:163], 0
 ds_read_b64_tr_b16 a[44:45], v7 offset:45056
 v_mul_f32 v117, v117, v65
 v_mfma_f32_16x16x32_bf16 v[80:83], a[4:7], a[164:167], v[80:83]
 ds_read_b64_tr_b16 a[46:47], v7 offset:47104
 v_mul_f32 v118, v118, v65
 v_mfma_f32_16x16x32_bf16 v[80:83], a[8:11], a[168:171], v[80:83]
 ds_read_b64_tr_b16 a[48:49], v7 offset:49152
 v_mul_f32 v119, v119, v65
 v_mfma_f32_16x16x32_bf16 v[80:83], a[12:15], a[172:175], v[80:83]
 ds_read_b64_tr_b16 a[50:51], v7 offset:51200
 v_cvt_pk_bf16_f32 v112, v112, v113
 v_mfma_f32_16x16x32_bf16 v[80:83], a[16:19], a[176:179], v[80:83]
 ds_read_b64_tr_b16 a[52:53], v7 offset:53248
 v_cvt_pk_bf16_f32 v113, v114, v115
 v_mfma_f32_16x16x32_bf16 v[80:83], a[20:23], a[180:183], v[80:83]
 s_add_u32 m0, s29, 24576
 ds_read_b64_tr_b16 a[54:55], v7 offset:55296
 v_cvt_pk_bf16_f32 v114, v116, v117
 v_mfma_f32_16x16x32_bf16 v[80:83], a[24:27], a[184:187], v[80:83]
 ds_read_b64_tr_b16 a[56:57], v7 offset:57344
 buffer_load_dwordx4 v2, s[8:11], s84 offen lds
 v_mfma_f32_16x16x32_bf16 v[80:83], a[28:31], a[188:191], v[80:83]
 s_waitcnt lgkmcnt(7)
 ds_read_b64_tr_b16 a[58:59], v7 offset:59392
 v_cvt_pk_bf16_f32 v115, v118, v119
 v_mfma_f32_16x16x32_bf16 v[76:79], a[32:35], a[128:131], 0
 s_waitcnt vmcnt(10)
 ds_read_b64_tr_b16 a[60:61], v7 offset:61440
 v_mul_f32 v72, v72, v64
 v_mfma_f32_16x16x32_bf16 v[76:79], a[36:39], a[132:135], v[76:79]
 s_barrier
 ds_read_b64_tr_b16 a[62:63], v7 offset:63488
 v_xor_b32 v4, 0x30000, v4
 v_mfma_f32_16x16x32_bf16 v[76:79], a[40:43], a[136:139], v[76:79]
 s_waitcnt lgkmcnt(4)
 ds_read_b64_tr_b16 a[0:1], v4 offset:0
 buffer_store_dword v9, v9, s[12:15], s93 offen offset:64 sc1
 v_mfma_f32_16x16x32_bf16 v[76:79], a[44:47], a[140:143], v[76:79]
 ds_read_b64_tr_b16 a[2:3], v4 offset:2048
 v_mul_f32 v73, v73, v64
 v_mfma_f32_16x16x32_bf16 v[76:79], a[48:51], a[144:147], v[76:79]
 s_add_u32 m0, s29, 28672
 ds_read_b64_tr_b16 a[4:5], v4 offset:4096
 v_mul_f32 v74, v74, v64
 v_mfma_f32_16x16x32_bf16 v[76:79], a[52:55], a[148:151], v[76:79]
 s_waitcnt lgkmcnt(3)
 ds_read_b64_tr_b16 a[6:7], v4 offset:6144
 buffer_load_dwordx4 v2, s[8:11], s85 offen lds
 v_mfma_f32_16x16x32_bf16 v[76:79], a[56:59], a[152:155], v[76:79]
 s_add_u32 s58, s48, 1114112
 ds_read_b64_tr_b16 a[8:9], v4 offset:8192
 v_add_u32 v2, 128, v2
 v_mfma_f32_16x16x32_bf16 v[76:79], a[60:63], a[156:159], v[76:79]
 ds_read_b64_tr_b16 a[10:11], v4 offset:10240
 buffer_store_dwordx4 v[112:115], v1, s[12:15], s58 offen sc1
 v_mfma_f32_16x16x32_bf16 v[84:87], a[32:35], a[160:163], 0
 ds_read_b64_tr_b16 a[12:13], v4 offset:12288
 v_mul_f32 v75, v75, v64
 v_mfma_f32_16x16x32_bf16 v[84:87], a[36:39], a[164:167], v[84:87]
 ds_read_b64_tr_b16 a[14:15], v4 offset:14336
 v_mul_f32 v80, v80, v65
 v_mfma_f32_16x16x32_bf16 v[84:87], a[40:43], a[168:171], v[84:87]
 ds_read_b64_tr_b16 a[16:17], v4 offset:16384
 v_mul_f32 v81, v81, v65
 v_mfma_f32_16x16x32_bf16 v[84:87], a[44:47], a[172:175], v[84:87]
 s_waitcnt lgkmcnt(9)
 ds_read_b64_tr_b16 a[18:19], v4 offset:18432
 v_mul_f32 v82, v82, v65
 v_mfma_f32_16x16x32_bf16 v[84:87], a[48:51], a[176:179], v[84:87]
 s_barrier
 ds_read_b64_tr_b16 a[20:21], v4 offset:20480
 v_mul_f32 v76, v76, v64
 v_mfma_f32_16x16x32_bf16 v[84:87], a[52:55], a[180:183], v[84:87]
 s_add_u32 m0, s33, 4640
 ds_read_b64_tr_b16 a[22:23], v4 offset:22528
 v_mul_f32 v77, v77, v64
 v_mfma_f32_16x16x32_bf16 v[84:87], a[56:59], a[184:187], v[84:87]
 ds_read_b64_tr_b16 a[24:25], v4 offset:24576
 buffer_load_dwordx4 v1, s[4:7], s34 offen offset:0 lds
 v_mfma_f32_16x16x32_bf16 v[84:87], a[60:63], a[188:191], v[84:87]
 s_waitcnt lgkmcnt(7)
 ds_read_b64_tr_b16 a[26:27], v4 offset:26624
 v_mul_f32 v78, v78, v64
 v_mfma_f32_16x16x32_bf16 v[88:91], a[0:3], a[128:131], 0
 ds_read_b64_tr_b16 a[28:29], v4 offset:28672
 v_mul_f32 v79, v79, v64
 v_mfma_f32_16x16x32_bf16 v[88:91], a[4:7], a[132:135], v[88:91]
 ds_read_b64_tr_b16 a[30:31], v4 offset:30720
 v_xor_b32 v5, 0x30000, v5
 v_mfma_f32_16x16x32_bf16 v[88:91], a[8:11], a[136:139], v[88:91]
 s_waitcnt lgkmcnt(4)
 ds_read_b64_tr_b16 a[32:33], v5 offset:0
 v_cvt_pk_bf16_f32 v72, v72, v73
 v_mfma_f32_16x16x32_bf16 v[88:91], a[12:15], a[140:143], v[88:91]
 ds_read_b64_tr_b16 a[34:35], v5 offset:2048
 v_cvt_pk_bf16_f32 v73, v74, v75
 v_mfma_f32_16x16x32_bf16 v[88:91], a[16:19], a[144:147], v[88:91]
 ds_read_b64_tr_b16 a[36:37], v5 offset:4096
 v_cvt_pk_bf16_f32 v74, v76, v77
 v_mfma_f32_16x16x32_bf16 v[88:91], a[20:23], a[148:151], v[88:91]
 s_waitcnt lgkmcnt(3)
 ds_read_b64_tr_b16 a[38:39], v5 offset:6144
 buffer_load_dwordx4 v1, s[4:7], s34 offen offset:1024 lds
 v_mfma_f32_16x16x32_bf16 v[88:91], a[24:27], a[152:155], v[88:91]
 s_add_u32 s58, s48, 156672
 ds_read_b64_tr_b16 a[40:41], v5 offset:8192
 v_cvt_pk_bf16_f32 v75, v78, v79
 v_mfma_f32_16x16x32_bf16 v[88:91], a[28:31], a[156:159], v[88:91]
 ds_read_b64_tr_b16 a[42:43], v5 offset:10240
 buffer_store_dwordx4 v[72:75], v1, s[12:15], s58 offen sc1
 v_mfma_f32_16x16x32_bf16 v[96:99], a[0:3], a[160:163], 0
 ds_read_b64_tr_b16 a[44:45], v5 offset:12288
 v_mul_f32 v83, v83, v65
 v_mfma_f32_16x16x32_bf16 v[96:99], a[4:7], a[164:167], v[96:99]
 ds_read_b64_tr_b16 a[46:47], v5 offset:14336
 v_mul_f32 v84, v84, v65
 v_mfma_f32_16x16x32_bf16 v[96:99], a[8:11], a[168:171], v[96:99]
 ds_read_b64_tr_b16 a[48:49], v5 offset:16384
 v_mul_f32 v85, v85, v65
 v_mfma_f32_16x16x32_bf16 v[96:99], a[12:15], a[172:175], v[96:99]
 ds_read_b64_tr_b16 a[50:51], v5 offset:18432
 v_mul_f32 v86, v86, v65
 v_mfma_f32_16x16x32_bf16 v[96:99], a[16:19], a[176:179], v[96:99]
 ds_read_b64_tr_b16 a[52:53], v5 offset:20480
 buffer_load_dwordx4 v1, s[4:7], s34 offen offset:2048 lds
 v_mfma_f32_16x16x32_bf16 v[96:99], a[20:23], a[180:183], v[96:99]
 ds_read_b64_tr_b16 a[54:55], v5 offset:22528
 v_mul_f32 v87, v87, v65
 v_mfma_f32_16x16x32_bf16 v[96:99], a[24:27], a[184:187], v[96:99]
 ds_read_b64_tr_b16 a[56:57], v5 offset:24576
 v_cvt_pk_bf16_f32 v80, v80, v81
 v_mfma_f32_16x16x32_bf16 v[96:99], a[28:31], a[188:191], v[96:99]
 s_waitcnt lgkmcnt(7)
 ds_read_b64_tr_b16 a[58:59], v5 offset:26624
 v_cvt_pk_bf16_f32 v81, v82, v83
 v_mfma_f32_16x16x32_bf16 v[92:95], a[32:35], a[128:131], 0
 ds_read_b64_tr_b16 a[60:61], v5 offset:28672
 v_cvt_pk_bf16_f32 v82, v84, v85
 v_mfma_f32_16x16x32_bf16 v[92:95], a[36:39], a[132:135], v[92:95]
 ds_read_b64_tr_b16 a[62:63], v5 offset:30720
 v_xor_b32 v6, 0x30000, v6
 v_mfma_f32_16x16x32_bf16 v[92:95], a[40:43], a[136:139], v[92:95]
 s_waitcnt lgkmcnt(4)
 ds_read_b64_tr_b16 a[0:1], v6 offset:0
 v_cvt_pk_bf16_f32 v83, v86, v87
 v_mfma_f32_16x16x32_bf16 v[92:95], a[44:47], a[140:143], v[92:95]
 ds_read_b64_tr_b16 a[2:3], v6 offset:2048
 buffer_load_dwordx4 v1, s[4:7], s34 offen offset:3072 lds
 v_mfma_f32_16x16x32_bf16 v[92:95], a[48:51], a[144:147], v[92:95]
 s_add_u32 s58, s48, 1131520
 ds_read_b64_tr_b16 a[4:5], v6 offset:4096
 v_mul_f32 v88, v88, v64
 v_mfma_f32_16x16x32_bf16 v[92:95], a[52:55], a[148:151], v[92:95]
 s_waitcnt lgkmcnt(3)
 ds_read_b64_tr_b16 a[6:7], v6 offset:6144
 buffer_store_dwordx4 v[80:83], v1, s[12:15], s58 offen sc1
 v_mfma_f32_16x16x32_bf16 v[92:95], a[56:59], a[152:155], v[92:95]
 ds_read_b64_tr_b16 a[8:9], v6 offset:8192
 v_mul_f32 v89, v89, v64
 v_mfma_f32_16x16x32_bf16 v[92:95], a[60:63], a[156:159], v[92:95]
 ds_read_b64_tr_b16 a[10:11], v6 offset:10240
 v_mul_f32 v90, v90, v64
 v_mfma_f32_16x16x32_bf16 v[100:103], a[32:35], a[160:163], 0
 ds_read_b64_tr_b16 a[12:13], v6 offset:12288
 v_mul_f32 v91, v91, v64
 v_mfma_f32_16x16x32_bf16 v[100:103], a[36:39], a[164:167], v[100:103]
 s_add_u32 m0, s33, 128
 ds_read_b64_tr_b16 a[14:15], v6 offset:14336
 v_mul_f32 v96, v96, v65
 v_mfma_f32_16x16x32_bf16 v[100:103], a[40:43], a[168:171], v[100:103]
 ds_read_b64_tr_b16 a[16:17], v6 offset:16384
 buffer_load_dwordx4 v10, s[12:15], s35 offen offset:0 sc1 lds
 v_mfma_f32_16x16x32_bf16 v[100:103], a[44:47], a[172:175], v[100:103]
 ds_read_b64_tr_b16 a[18:19], v6 offset:18432
 v_mul_f32 v97, v97, v65
 v_mfma_f32_16x16x32_bf16 v[100:103], a[48:51], a[176:179], v[100:103]
 ds_read_b64_tr_b16 a[20:21], v6 offset:20480
 v_mul_f32 v92, v92, v64
 v_mfma_f32_16x16x32_bf16 v[100:103], a[52:55], a[180:183], v[100:103]
 ds_read_b64_tr_b16 a[22:23], v6 offset:22528
 v_mul_f32 v93, v93, v64
 v_mfma_f32_16x16x32_bf16 v[100:103], a[56:59], a[184:187], v[100:103]
 ds_read_b64_tr_b16 a[24:25], v6 offset:24576
 v_mul_f32 v94, v94, v64
 v_mfma_f32_16x16x32_bf16 v[100:103], a[60:63], a[188:191], v[100:103]
 s_waitcnt lgkmcnt(7)
 ds_read_b64_tr_b16 a[26:27], v6 offset:26624
 v_mul_f32 v95, v95, v64
 v_mfma_f32_16x16x32_bf16 v[104:107], a[0:3], a[128:131], 0
 ds_read_b64_tr_b16 a[28:29], v6 offset:28672
 v_cvt_pk_bf16_f32 v88, v88, v89
 v_mfma_f32_16x16x32_bf16 v[104:107], a[4:7], a[132:135], v[104:107]
 s_add_u32 m0, s33, 1248
 ds_read_b64_tr_b16 a[30:31], v6 offset:30720
 v_xor_b32 v7, 0x30000, v7
 v_mfma_f32_16x16x32_bf16 v[104:107], a[8:11], a[136:139], v[104:107]
 s_waitcnt lgkmcnt(4)
 ds_read_b64_tr_b16 a[32:33], v7 offset:0
 buffer_load_dwordx4 v10, s[12:15], s35 offen offset:32 sc1 lds
 v_mfma_f32_16x16x32_bf16 v[104:107], a[12:15], a[140:143], v[104:107]
 ds_read_b64_tr_b16 a[34:35], v7 offset:2048
 v_cvt_pk_bf16_f32 v89, v90, v91
 v_mfma_f32_16x16x32_bf16 v[104:107], a[16:19], a[144:147], v[104:107]
 s_add_u32 s58, s48, 174080
 ds_read_b64_tr_b16 a[36:37], v7 offset:4096
 v_cvt_pk_bf16_f32 v90, v92, v93
 v_mfma_f32_16x16x32_bf16 v[104:107], a[20:23], a[148:151], v[104:107]
 s_waitcnt lgkmcnt(3)
 ds_read_b64_tr_b16 a[38:39], v7 offset:6144
 v_cvt_pk_bf16_f32 v91, v94, v95
 v_mfma_f32_16x16x32_bf16 v[104:107], a[24:27], a[152:155], v[104:107]
 ds_read_b64_tr_b16 a[40:41], v7 offset:8192
 buffer_store_dwordx4 v[88:91], v1, s[12:15], s58 offen sc1
 v_mfma_f32_16x16x32_bf16 v[104:107], a[28:31], a[156:159], v[104:107]
 ds_read_b64_tr_b16 a[42:43], v7 offset:10240
 v_mul_f32 v98, v98, v65
 v_mfma_f32_16x16x32_bf16 v[112:115], a[0:3], a[160:163], 0
 s_add_u32 m0, s33, 2368
 ds_read_b64_tr_b16 a[44:45], v7 offset:12288
 v_mul_f32 v99, v99, v65
 v_mfma_f32_16x16x32_bf16 v[112:115], a[4:7], a[164:167], v[112:115]
 ds_read_b64_tr_b16 a[46:47], v7 offset:14336
 buffer_load_dwordx4 v10, s[12:15], s35 offen offset:64 sc1 lds
 v_mfma_f32_16x16x32_bf16 v[112:115], a[8:11], a[168:171], v[112:115]
 ds_read_b64_tr_b16 a[48:49], v7 offset:16384
 v_mul_f32 v100, v100, v65
 v_mfma_f32_16x16x32_bf16 v[112:115], a[12:15], a[172:175], v[112:115]
 ds_read_b64_tr_b16 a[50:51], v7 offset:18432
 v_mul_f32 v101, v101, v65
 v_mfma_f32_16x16x32_bf16 v[112:115], a[16:19], a[176:179], v[112:115]
 ds_read_b64_tr_b16 a[52:53], v7 offset:20480
 v_mul_f32 v102, v102, v65
 v_mfma_f32_16x16x32_bf16 v[112:115], a[20:23], a[180:183], v[112:115]
 ds_read_b64_tr_b16 a[54:55], v7 offset:22528
 v_mul_f32 v103, v103, v65
 v_mfma_f32_16x16x32_bf16 v[112:115], a[24:27], a[184:187], v[112:115]
 s_add_u32 m0, s33, 3488
 ds_read_b64_tr_b16 a[56:57], v7 offset:24576
 v_cvt_pk_bf16_f32 v96, v96, v97
 v_mfma_f32_16x16x32_bf16 v[112:115], a[28:31], a[188:191], v[112:115]
 s_waitcnt lgkmcnt(7)
 ds_read_b64_tr_b16 a[58:59], v7 offset:26624
 v_cvt_pk_bf16_f32 v97, v98, v99
 v_mfma_f32_16x16x32_bf16 v[108:111], a[32:35], a[128:131], 0
 s_waitcnt vmcnt(11)
 ds_read_b64_tr_b16 a[60:61], v7 offset:28672
 buffer_load_dwordx4 v10, s[12:15], s35 offen offset:96 sc1 lds
 v_mfma_f32_16x16x32_bf16 v[108:111], a[36:39], a[132:135], v[108:111]
 s_barrier
 ds_read_b64_tr_b16 a[62:63], v7 offset:30720
 v_xor_b32 v4, 0x20000, v4
 v_mfma_f32_16x16x32_bf16 v[108:111], a[40:43], a[136:139], v[108:111]
 s_waitcnt lgkmcnt(4)
 ds_read_b64_tr_b16 a[0:1], v4 offset:0
 v_cvt_pk_bf16_f32 v98, v100, v101
 v_mfma_f32_16x16x32_bf16 v[108:111], a[44:47], a[140:143], v[108:111]
 s_add_u32 s58, s48, 1148928
 ds_read_b64_tr_b16 a[2:3], v4 offset:2048
 v_cvt_pk_bf16_f32 v99, v102, v103
 v_mfma_f32_16x16x32_bf16 v[108:111], a[48:51], a[144:147], v[108:111]
 ds_read_b64_tr_b16 a[4:5], v4 offset:4096
 buffer_store_dwordx4 v[96:99], v1, s[12:15], s58 offen sc1
 v_mfma_f32_16x16x32_bf16 v[108:111], a[52:55], a[148:151], v[108:111]
 s_waitcnt lgkmcnt(3)
 ds_read_b64_tr_b16 a[6:7], v4 offset:6144
 v_mul_f32 v104, v104, v64
 v_mfma_f32_16x16x32_bf16 v[108:111], a[56:59], a[152:155], v[108:111]
 ds_read_b64_tr_b16 a[8:9], v4 offset:8192
 v_mul_f32 v105, v105, v64
 v_mfma_f32_16x16x32_bf16 v[108:111], a[60:63], a[156:159], v[108:111]
 ds_read_b64_tr_b16 a[10:11], v4 offset:10240
 v_mul_f32 v106, v106, v64
 v_mfma_f32_16x16x32_bf16 v[116:119], a[32:35], a[160:163], 0
 ds_read_b64_tr_b16 a[12:13], v4 offset:12288
 v_mul_f32 v107, v107, v64
 v_mfma_f32_16x16x32_bf16 v[116:119], a[36:39], a[164:167], v[116:119]
 ds_read_b64_tr_b16 a[14:15], v4 offset:14336
 v_mul_f32 v112, v112, v65
 v_mfma_f32_16x16x32_bf16 v[116:119], a[40:43], a[168:171], v[116:119]
 ds_read_b64_tr_b16 a[16:17], v4 offset:16384
 v_mul_f32 v113, v113, v65
 v_mfma_f32_16x16x32_bf16 v[116:119], a[44:47], a[172:175], v[116:119]
 ds_read_b64_tr_b16 a[18:19], v4 offset:18432
 v_mul_f32 v114, v114, v65
 v_mfma_f32_16x16x32_bf16 v[116:119], a[48:51], a[176:179], v[116:119]
 ds_read_b64_tr_b16 a[20:21], v4 offset:20480
 v_mul_f32 v108, v108, v64
 v_mfma_f32_16x16x32_bf16 v[116:119], a[52:55], a[180:183], v[116:119]
 ds_read_b64_tr_b16 a[22:23], v4 offset:22528
 v_mul_f32 v109, v109, v64
 v_mfma_f32_16x16x32_bf16 v[116:119], a[56:59], a[184:187], v[116:119]
 ds_read_b64_tr_b16 a[24:25], v4 offset:24576
 v_mul_f32 v110, v110, v64
 v_mfma_f32_16x16x32_bf16 v[116:119], a[60:63], a[188:191], v[116:119]
 s_waitcnt lgkmcnt(7)
 ds_read_b64_tr_b16 a[26:27], v4 offset:26624
 v_mul_f32 v111, v111, v64
 v_mfma_f32_16x16x32_bf16 v[72:75], a[0:3], a[128:131], 0
 ds_read_b64_tr_b16 a[28:29], v4 offset:28672
 v_cvt_pk_bf16_f32 v104, v104, v105
 v_mfma_f32_16x16x32_bf16 v[72:75], a[4:7], a[132:135], v[72:75]
 ds_read_b64_tr_b16 a[30:31], v4 offset:30720
 v_xor_b32 v5, 0x20000, v5
 v_mfma_f32_16x16x32_bf16 v[72:75], a[8:11], a[136:139], v[72:75]
 s_waitcnt lgkmcnt(4)
 ds_read_b64_tr_b16 a[32:33], v5 offset:0
 v_cvt_pk_bf16_f32 v105, v106, v107
 v_mfma_f32_16x16x32_bf16 v[72:75], a[12:15], a[140:143], v[72:75]
 ds_read_b64_tr_b16 a[34:35], v5 offset:2048
 v_cvt_pk_bf16_f32 v106, v108, v109
 v_mfma_f32_16x16x32_bf16 v[72:75], a[16:19], a[144:147], v[72:75]
 s_add_u32 s58, s48, 191488
 ds_read_b64_tr_b16 a[36:37], v5 offset:4096
 v_cvt_pk_bf16_f32 v107, v110, v111
 v_mfma_f32_16x16x32_bf16 v[72:75], a[20:23], a[148:151], v[72:75]
 s_waitcnt lgkmcnt(3)
 ds_read_b64_tr_b16 a[38:39], v5 offset:6144
 buffer_store_dwordx4 v[104:107], v1, s[12:15], s58 offen sc1
 v_mfma_f32_16x16x32_bf16 v[72:75], a[24:27], a[152:155], v[72:75]
 ds_read_b64_tr_b16 a[40:41], v5 offset:8192
 v_mul_f32 v115, v115, v65
 v_mfma_f32_16x16x32_bf16 v[72:75], a[28:31], a[156:159], v[72:75]
 ds_read_b64_tr_b16 a[42:43], v5 offset:10240
 v_mul_f32 v116, v116, v65
 v_mfma_f32_16x16x32_bf16 v[80:83], a[0:3], a[160:163], 0
 ds_read_b64_tr_b16 a[44:45], v5 offset:12288
 v_mul_f32 v117, v117, v65
 v_mfma_f32_16x16x32_bf16 v[80:83], a[4:7], a[164:167], v[80:83]
 ds_read_b64_tr_b16 a[46:47], v5 offset:14336
 v_mul_f32 v118, v118, v65
 v_mfma_f32_16x16x32_bf16 v[80:83], a[8:11], a[168:171], v[80:83]
 ds_read_b64_tr_b16 a[48:49], v5 offset:16384
 v_mul_f32 v119, v119, v65
 v_mfma_f32_16x16x32_bf16 v[80:83], a[12:15], a[172:175], v[80:83]
 ds_read_b64_tr_b16 a[50:51], v5 offset:18432
 v_cvt_pk_bf16_f32 v112, v112, v113
 v_mfma_f32_16x16x32_bf16 v[80:83], a[16:19], a[176:179], v[80:83]
 ds_read_b64_tr_b16 a[52:53], v5 offset:20480
 v_cvt_pk_bf16_f32 v113, v114, v115
 v_mfma_f32_16x16x32_bf16 v[80:83], a[20:23], a[180:183], v[80:83]
 ds_read_b64_tr_b16 a[54:55], v5 offset:22528
 v_cvt_pk_bf16_f32 v114, v116, v117
 v_mfma_f32_16x16x32_bf16 v[80:83], a[24:27], a[184:187], v[80:83]
 s_add_u32 s58, s48, 1166336
 ds_read_b64_tr_b16 a[56:57], v5 offset:24576
 v_cvt_pk_bf16_f32 v115, v118, v119
 v_mfma_f32_16x16x32_bf16 v[80:83], a[28:31], a[188:191], v[80:83]
 s_waitcnt lgkmcnt(7)
 ds_read_b64_tr_b16 a[58:59], v5 offset:26624
 buffer_store_dwordx4 v[112:115], v1, s[12:15], s58 offen sc1
 v_mfma_f32_16x16x32_bf16 v[76:79], a[32:35], a[128:131], 0
 ds_read_b64_tr_b16 a[60:61], v5 offset:28672
 v_mul_f32 v72, v72, v64
 v_mfma_f32_16x16x32_bf16 v[76:79], a[36:39], a[132:135], v[76:79]
 ds_read_b64_tr_b16 a[62:63], v5 offset:30720
 v_xor_b32 v6, 0x20000, v6
 v_mfma_f32_16x16x32_bf16 v[76:79], a[40:43], a[136:139], v[76:79]
 s_waitcnt lgkmcnt(4)
 ds_read_b64_tr_b16 a[0:1], v6 offset:0
 v_mul_f32 v73, v73, v64
 v_mfma_f32_16x16x32_bf16 v[76:79], a[44:47], a[140:143], v[76:79]
 ds_read_b64_tr_b16 a[2:3], v6 offset:2048
 v_mul_f32 v74, v74, v64
 v_mfma_f32_16x16x32_bf16 v[76:79], a[48:51], a[144:147], v[76:79]
 ds_read_b64_tr_b16 a[4:5], v6 offset:4096
 v_mul_f32 v75, v75, v64
 v_mfma_f32_16x16x32_bf16 v[76:79], a[52:55], a[148:151], v[76:79]
 s_waitcnt lgkmcnt(3)
 ds_read_b64_tr_b16 a[6:7], v6 offset:6144
 v_mul_f32 v80, v80, v65
 v_mfma_f32_16x16x32_bf16 v[76:79], a[56:59], a[152:155], v[76:79]
 ds_read_b64_tr_b16 a[8:9], v6 offset:8192
 v_mul_f32 v81, v81, v65
 v_mfma_f32_16x16x32_bf16 v[76:79], a[60:63], a[156:159], v[76:79]
 ds_read_b64_tr_b16 a[10:11], v6 offset:10240
 v_mul_f32 v82, v82, v65
 v_mfma_f32_16x16x32_bf16 v[84:87], a[32:35], a[160:163], 0
 ds_read_b64_tr_b16 a[12:13], v6 offset:12288
 v_mul_f32 v83, v83, v65
 v_mfma_f32_16x16x32_bf16 v[84:87], a[36:39], a[164:167], v[84:87]
 ds_read_b64_tr_b16 a[14:15], v6 offset:14336
 v_mfma_f32_16x16x32_bf16 v[84:87], a[40:43], a[168:171], v[84:87]
 ds_read_b64_tr_b16 a[16:17], v6 offset:16384
 v_mfma_f32_16x16x32_bf16 v[84:87], a[44:47], a[172:175], v[84:87]
 ds_read_b64_tr_b16 a[18:19], v6 offset:18432
 v_mfma_f32_16x16x32_bf16 v[84:87], a[48:51], a[176:179], v[84:87]
 ds_read_b64_tr_b16 a[20:21], v6 offset:20480
 v_mul_f32 v76, v76, v64
 v_mfma_f32_16x16x32_bf16 v[84:87], a[52:55], a[180:183], v[84:87]
 ds_read_b64_tr_b16 a[22:23], v6 offset:22528
 v_mul_f32 v77, v77, v64
 v_mfma_f32_16x16x32_bf16 v[84:87], a[56:59], a[184:187], v[84:87]
 ds_read_b64_tr_b16 a[24:25], v6 offset:24576
 v_mul_f32 v78, v78, v64
 v_mfma_f32_16x16x32_bf16 v[84:87], a[60:63], a[188:191], v[84:87]
 s_waitcnt lgkmcnt(7)
 ds_read_b64_tr_b16 a[26:27], v6 offset:26624
 v_mul_f32 v79, v79, v64
 v_mfma_f32_16x16x32_bf16 v[88:91], a[0:3], a[128:131], 0
 ds_read_b64_tr_b16 a[28:29], v6 offset:28672
 v_cvt_pk_bf16_f32 v72, v72, v73
 v_mfma_f32_16x16x32_bf16 v[88:91], a[4:7], a[132:135], v[88:91]
 ds_read_b64_tr_b16 a[30:31], v6 offset:30720
 v_xor_b32 v7, 0x20000, v7
 v_mfma_f32_16x16x32_bf16 v[88:91], a[8:11], a[136:139], v[88:91]
 s_waitcnt lgkmcnt(4)
 ds_read_b64_tr_b16 a[32:33], v7 offset:0
 v_cvt_pk_bf16_f32 v73, v74, v75
 v_mfma_f32_16x16x32_bf16 v[88:91], a[12:15], a[140:143], v[88:91]
 ds_read_b64_tr_b16 a[34:35], v7 offset:2048
 v_cvt_pk_bf16_f32 v74, v76, v77
 v_mfma_f32_16x16x32_bf16 v[88:91], a[16:19], a[144:147], v[88:91]
 s_add_u32 s58, s48, 208896
 ds_read_b64_tr_b16 a[36:37], v7 offset:4096
 v_cvt_pk_bf16_f32 v75, v78, v79
 v_mfma_f32_16x16x32_bf16 v[88:91], a[20:23], a[148:151], v[88:91]
 s_waitcnt lgkmcnt(3)
 ds_read_b64_tr_b16 a[38:39], v7 offset:6144
 buffer_store_dwordx4 v[72:75], v1, s[12:15], s58 offen sc1
 v_mfma_f32_16x16x32_bf16 v[88:91], a[24:27], a[152:155], v[88:91]
 ds_read_b64_tr_b16 a[40:41], v7 offset:8192
 v_mul_f32 v84, v84, v65
 v_mfma_f32_16x16x32_bf16 v[88:91], a[28:31], a[156:159], v[88:91]
 ds_read_b64_tr_b16 a[42:43], v7 offset:10240
 v_mul_f32 v85, v85, v65
 v_mfma_f32_16x16x32_bf16 v[96:99], a[0:3], a[160:163], 0
 ds_read_b64_tr_b16 a[44:45], v7 offset:12288
 v_mul_f32 v86, v86, v65
 v_mfma_f32_16x16x32_bf16 v[96:99], a[4:7], a[164:167], v[96:99]
 ds_read_b64_tr_b16 a[46:47], v7 offset:14336
 v_mul_f32 v87, v87, v65
 v_mfma_f32_16x16x32_bf16 v[96:99], a[8:11], a[168:171], v[96:99]
 ds_read_b64_tr_b16 a[48:49], v7 offset:16384
 v_cvt_pk_bf16_f32 v80, v80, v81
 v_mfma_f32_16x16x32_bf16 v[96:99], a[12:15], a[172:175], v[96:99]
 ds_read_b64_tr_b16 a[50:51], v7 offset:18432
 v_cvt_pk_bf16_f32 v81, v82, v83
 v_mfma_f32_16x16x32_bf16 v[96:99], a[16:19], a[176:179], v[96:99]
 ds_read_b64_tr_b16 a[52:53], v7 offset:20480
 v_cvt_pk_bf16_f32 v82, v84, v85
 v_mfma_f32_16x16x32_bf16 v[96:99], a[20:23], a[180:183], v[96:99]
 s_add_u32 s58, s48, 1183744
 ds_read_b64_tr_b16 a[54:55], v7 offset:22528
 v_cvt_pk_bf16_f32 v83, v86, v87
 v_mfma_f32_16x16x32_bf16 v[96:99], a[24:27], a[184:187], v[96:99]
 ds_read_b64_tr_b16 a[56:57], v7 offset:24576
 buffer_store_dwordx4 v[80:83], v1, s[12:15], s58 offen sc1
 v_mfma_f32_16x16x32_bf16 v[96:99], a[28:31], a[188:191], v[96:99]
 s_waitcnt lgkmcnt(7)
 ds_read_b64_tr_b16 a[58:59], v7 offset:26624
 v_mul_f32 v88, v88, v64
 v_mfma_f32_16x16x32_bf16 v[92:95], a[32:35], a[128:131], 0
 ds_read_b64_tr_b16 a[60:61], v7 offset:28672
 v_mul_f32 v89, v89, v64
 v_mfma_f32_16x16x32_bf16 v[92:95], a[36:39], a[132:135], v[92:95]
 ds_read_b64_tr_b16 a[62:63], v7 offset:30720
 v_mul_f32 v90, v90, v64
 v_mfma_f32_16x16x32_bf16 v[92:95], a[40:43], a[136:139], v[92:95]
 s_waitcnt lgkmcnt(4)
 v_mul_f32 v91, v91, v64
 v_mfma_f32_16x16x32_bf16 v[92:95], a[44:47], a[140:143], v[92:95]
 ds_write_b32 v11, v13 offset:0
 v_mfma_f32_16x16x32_bf16 v[92:95], a[48:51], a[144:147], v[92:95]
 ds_write_b32 v11, v13 offset:1152
 v_mul_f32 v96, v96, v65
 v_mul_f32 v97, v97, v65
 v_mfma_f32_16x16x32_bf16 v[92:95], a[52:55], a[148:151], v[92:95]
 s_waitcnt lgkmcnt(0)
 ds_write_b32 v11, v13 offset:2304
 v_mul_f32 v98, v98, v65
 v_mul_f32 v99, v99, v65
 v_mfma_f32_16x16x32_bf16 v[92:95], a[56:59], a[152:155], v[92:95]
 ds_write_b32 v11, v13 offset:3456
 v_mfma_f32_16x16x32_bf16 v[92:95], a[60:63], a[156:159], v[92:95]
 ds_write_b32 v12, v13 offset:4608
 v_mfma_f32_16x16x32_bf16 v[100:103], a[32:35], a[160:163], 0
 v_mfma_f32_16x16x32_bf16 v[100:103], a[36:39], a[164:167], v[100:103]
 v_mfma_f32_16x16x32_bf16 v[100:103], a[40:43], a[168:171], v[100:103]
 v_mfma_f32_16x16x32_bf16 v[100:103], a[44:47], a[172:175], v[100:103]
 v_mfma_f32_16x16x32_bf16 v[100:103], a[48:51], a[176:179], v[100:103]
 v_mfma_f32_16x16x32_bf16 v[100:103], a[52:55], a[180:183], v[100:103]
 v_mfma_f32_16x16x32_bf16 v[100:103], a[56:59], a[184:187], v[100:103]
 v_mfma_f32_16x16x32_bf16 v[100:103], a[60:63], a[188:191], v[100:103]
 s_nop 4
 v_mul_f32 v92, v92, v64
 v_mul_f32 v93, v93, v64
 v_mul_f32 v94, v94, v64
 v_mul_f32 v95, v95, v64
 v_cvt_pk_bf16_f32 v88, v88, v89
 v_cvt_pk_bf16_f32 v89, v90, v91
 v_cvt_pk_bf16_f32 v90, v92, v93
 v_cvt_pk_bf16_f32 v91, v94, v95
 s_add_u32 s58, s48, 226304
 buffer_store_dwordx4 v[88:91], v1, s[12:15], s58 offen sc1
 v_mul_f32 v100, v100, v65
 v_mul_f32 v101, v101, v65
 v_mul_f32 v102, v102, v65
 v_mul_f32 v103, v103, v65
 v_cvt_pk_bf16_f32 v96, v96, v97
 v_cvt_pk_bf16_f32 v97, v98, v99
 v_cvt_pk_bf16_f32 v98, v100, v101
 v_cvt_pk_bf16_f32 v99, v102, v103
 s_add_u32 s58, s48, 1201152
 buffer_store_dwordx4 v[96:99], v1, s[12:15], s58 offen sc1
 s_cmp_ge_u32 s28, 14
 s_cbranch_scc1 L_idle
 v_and_b32 v22, 15, v0
 v_lshrrev_b32 v23, 4, v0
 v_lshl_add_u32 v18, v22, 3, s33
 v_lshl_add_u32 v16, v23, 4, v18
 v_lshl_add_u32 v18, v23, 1, v18
 v_and_b32 v17, 3, v0
 v_bfe_u32 v24, v0, 2, 2
 v_sub_u32 v17, v17, v24
 v_lshlrev_b32 v24, 3, v23
 v_sub_u32 v17, v17, v24
 v_add_u32 v17, 32, v17
 v_lshl_add_u32 v17, v17, 3, s33
 v_lshlrev_b32 v20, 5, v22
 v_lshl_add_u32 v20, v23, 3, v20
 v_add_u32 v24, -1, v0
 v_and_b32 v24, 15, v24
 v_add_u32 v24, 48, v24
 v_add_u32 v19, -16, v0
 v_cmp_gt_u32 vcc, 16, v0
 v_accvgpr_read_b32 v21, a245
 s_add_u32 s34, s35, 4194304
 v_cndmask_b32 v19, v19, v24, vcc
 v_lshlrev_b32 v19, 2, v19
 v_cmp_eq_u32 vcc, 63, v0
 s_lshl_b32 s30, s31, 16
 s_and_b32 s31, s31, 0xffff0000
 s_bitcmp1_b32 s3, 0
 s_cselect_b32 s31, s31, s30
 v_mov_b64 v[224:225], 0
 v_mov_b64 v[226:227], 0
 v_mov_b64 v[228:229], 0
 v_mov_b64 v[230:231], 0
 v_mov_b64 v[232:233], 0
 v_mov_b64 v[234:235], 0
 v_mov_b64 v[236:237], 0
 v_mov_b64 v[238:239], 0
 v_mov_b64 v[240:241], 0
 v_mov_b64 v[242:243], 0
 v_mov_b64 v[244:245], 0
 v_mov_b64 v[246:247], 0
 v_mov_b64 v[248:249], 0
 v_mov_b64 v[250:251], 0
 v_mov_b64 v[252:253], 0
 v_mov_b64 v[254:255], 0
 s_waitcnt vmcnt(7) lgkmcnt(0)
 ds_read_b64_tr_b16 v[160:161], v17 offset:4608
 ds_read_b64_tr_b16 v[162:163], v17 offset:4576
 ds_read_b64_tr_b16 v[164:165], v17 offset:4864
 ds_read_b64_tr_b16 v[166:167], v17 offset:4832
 ds_read_b64 a[4:5], v16 offset:72
 ds_read_b64 a[6:7], v16 offset:80
 ds_read_b64 a[0:1], v16 offset:8
 ds_read_b64 a[2:3], v16 offset:16
 s_waitcnt lgkmcnt(6)
 ds_read_b64 a[68:69], v16 offset:1224
 ds_read_b64 a[70:71], v16 offset:1232
 ds_read_b64 a[64:65], v16 offset:1160
 ds_read_b64 a[66:67], v16 offset:1168
 ds_read_b64 a[132:133], v16 offset:2376
 ds_read_b64 a[134:135], v16 offset:2384
 ds_read_b64 a[128:129], v16 offset:2312
 ds_read_b64 a[130:131], v16 offset:2320
 s_waitcnt lgkmcnt(6)
 ds_read_b64 a[196:197], v16 offset:3528
 ds_read_b64 a[198:199], v16 offset:3536
 ds_read_b64 a[192:193], v16 offset:3464
 ds_read_b64 a[194:195], v16 offset:3472
 ds_read_b64_tr_b16 v[168:169], v17 offset:5120
 ds_read_b64_tr_b16 v[170:171], v17 offset:5088
 ds_read_b64_tr_b16 v[172:173], v17 offset:5376
 ds_read_b64_tr_b16 v[174:175], v17 offset:5344
 s_waitcnt lgkmcnt(6)
 ds_read_b64 a[12:13], v16 offset:200
 ds_read_b64 a[14:15], v16 offset:208
 ds_read_b64 a[8:9], v16 offset:136
 ds_read_b64 a[10:11], v16 offset:144
 ds_read_b64 a[76:77], v16 offset:1352
 ds_read_b64 a[78:79], v16 offset:1360
 ds_read_b64 a[72:73], v16 offset:1288
 ds_read_b64 a[74:75], v16 offset:1296
 s_waitcnt lgkmcnt(6)
 ds_read_b64 a[140:141], v16 offset:2504
 ds_read_b64 a[142:143], v16 offset:2512
 ds_read_b64 a[136:137], v16 offset:2440
 ds_read_b64 a[138:139], v16 offset:2448
 ds_read_b64 a[204:205], v16 offset:3656
 ds_read_b64 a[206:207], v16 offset:3664
 ds_read_b64 a[200:201], v16 offset:3592
 ds_read_b64 a[202:203], v16 offset:3600
 s_waitcnt lgkmcnt(6)
 ds_read_b64_tr_b16 v[176:177], v17 offset:5632
 ds_read_b64_tr_b16 v[178:179], v17 offset:5600
 ds_read_b64_tr_b16 v[180:181], v17 offset:5888
 ds_read_b64_tr_b16 v[182:183], v17 offset:5856
 s_waitcnt lgkmcnt(0)
 v_lshlrev_b32 v11, 2, v22
 s_add_u32 s45, s44, 1088
 v_mfma_f32_16x16x32_bf16 v[32:35], v[160:163], a[4:7], 0
 ds_read_b64 a[20:21], v16 offset:328
 v_mfma_f32_16x16x32_bf16 v[32:35], v[164:167], a[0:3], v[32:35]
 ds_read_b64 a[22:23], v16 offset:336
 v_mfma_f32_16x16x32_bf16 v[36:39], v[160:163], a[68:71], 0
 ds_read_b64 a[16:17], v16 offset:264
 v_mfma_f32_16x16x32_bf16 v[36:39], v[164:167], a[64:67], v[36:39]
 ds_read_b64 a[18:19], v16 offset:272
 v_mfma_f32_16x16x32_bf16 v[40:43], v[160:163], a[132:135], 0
 ds_read_b64 a[84:85], v16 offset:1480
 v_mfma_f32_16x16x32_bf16 v[40:43], v[164:167], a[128:131], v[40:43]
 s_waitcnt vmcnt(0)
 ds_read_b64 a[86:87], v16 offset:1488
 v_mfma_f32_16x16x32_bf16 v[44:47], v[160:163], a[196:199], 0
 s_barrier
 ds_read_b64 a[80:81], v16 offset:1416
 v_mfma_f32_16x16x32_bf16 v[44:47], v[164:167], a[192:195], v[44:47]
 ds_read_b64 a[82:83], v16 offset:1424
 buffer_store_dword v21, v21, s[12:15], s93 offen sc1
 v_mfma_f32_16x16x32_bf16 v[48:51], v[160:163], a[12:15], 0
 ds_read_b64 a[148:149], v16 offset:2632
 v_mfma_f32_16x16x32_bf16 v[48:51], v[164:167], a[8:11], v[48:51]
 ds_read_b64 a[150:151], v16 offset:2640
 v_mfma_f32_16x16x32_bf16 v[48:51], v[168:171], a[4:7], v[48:51]
 ds_read_b64 a[144:145], v16 offset:2568
 v_mfma_f32_16x16x32_bf16 v[48:51], v[172:175], a[0:3], v[48:51]
 s_lshl_b32 s42, s42, 4
 ds_read_b64 a[146:147], v16 offset:2576
 v_mfma_f32_16x16x32_bf16 v[52:55], v[160:163], a[76:79], 0
 s_lshl_b32 s36, s41, 6
 ds_read_b64 a[212:213], v16 offset:3784
 v_mfma_f32_16x16x32_bf16 v[52:55], v[164:167], a[72:75], v[52:55]
 s_add_u32 s36, s36, 896
 ds_read_b64 a[214:215], v16 offset:3792
 v_mfma_f32_16x16x32_bf16 v[52:55], v[168:171], a[68:71], v[52:55]
 s_add_u32 s35, s36, 1835008
 ds_read_b64 a[208:209], v16 offset:3720
 v_mfma_f32_16x16x32_bf16 v[52:55], v[172:175], a[64:67], v[52:55]
 s_add_u32 s39, s37, 15597568
 ds_read_b64 a[210:211], v16 offset:3728
 v_mfma_f32_16x16x32_bf16 v[56:59], v[160:163], a[140:143], 0
 s_mov_b32 s8, s88
 ds_read_b64_tr_b16 v[184:185], v17 offset:6144
 v_mfma_f32_16x16x32_bf16 v[56:59], v[164:167], a[136:139], v[56:59]
 s_mov_b32 s9, s89
 ds_read_b64_tr_b16 v[186:187], v17 offset:6112
 v_mfma_f32_16x16x32_bf16 v[56:59], v[168:171], a[132:135], v[56:59]
 s_mov_b32 s10, 3670016
 ds_read_b64_tr_b16 v[188:189], v17 offset:6400
 v_mfma_f32_16x16x32_bf16 v[56:59], v[172:175], a[128:131], v[56:59]
 s_mov_b32 s11, 0x20000
 ds_read_b64_tr_b16 v[190:191], v17 offset:6368
 v_and_b32 v2, 15, v0
 v_mfma_f32_16x16x32_bf16 v[60:63], v[160:163], a[204:207], 0
 ds_read_b64 a[28:29], v16 offset:456
 v_add_u32 v2, s42, v2
 v_mfma_f32_16x16x32_bf16 v[60:63], v[164:167], a[200:203], v[60:63]
 ds_read_b64 a[30:31], v16 offset:464
 v_mul_u32_u24 v7, 896, v2
 v_mfma_f32_16x16x32_bf16 v[60:63], v[168:171], a[196:199], v[60:63]
 ds_read_b64 a[24:25], v16 offset:392
 v_lshrrev_b32 v3, 4, v0
 v_mfma_f32_16x16x32_bf16 v[60:63], v[172:175], a[192:195], v[60:63]
 s_waitcnt lgkmcnt(15)
 ds_read_b64 a[26:27], v16 offset:400
 v_lshlrev_b32 v8, 4, v3
 v_mfma_f32_16x16x32_bf16 v[64:67], v[160:163], a[20:23], 0
 ds_read_b64 a[92:93], v16 offset:1608
 v_lshl_add_u32 v2, v7, 1, v8
 v_mfma_f32_16x16x32_bf16 v[64:67], v[164:167], a[16:19], v[64:67]
 ds_read_b64 a[94:95], v16 offset:1616
 v_add_u32 v7, v7, v8
 v_mfma_f32_16x16x32_bf16 v[64:67], v[168:171], a[12:15], v[64:67]
 ds_read_b64 a[88:89], v16 offset:1544
 v_and_b32 v4, 1, v0
 v_mfma_f32_16x16x32_bf16 v[64:67], v[172:175], a[8:11], v[64:67]
 ds_read_b64 a[90:91], v16 offset:1552
 v_lshlrev_b32 v4, 4, v4
 v_mfma_f32_16x16x32_bf16 v[64:67], v[176:179], a[4:7], v[64:67]
 ds_read_b64 a[156:157], v16 offset:2760
 v_mov_b32 v5, 0x3f80
 v_mfma_f32_16x16x32_bf16 v[64:67], v[180:183], a[0:3], v[64:67]
 ds_read_b64 a[158:159], v16 offset:2768
 v_lshlrev_b32 v4, v4, v5
 v_mfma_f32_16x16x32_bf16 v[68:71], v[160:163], a[84:87], 0
 ds_read_b64 a[152:153], v16 offset:2696
 v_bfe_u32 v5, v0, 3, 1
 v_mfma_f32_16x16x32_bf16 v[68:71], v[164:167], a[80:83], v[68:71]
 ds_read_b64 a[154:155], v16 offset:2704
 v_bfe_u32 v6, v0, 1, 1
 v_mfma_f32_16x16x32_bf16 v[68:71], v[168:171], a[76:79], v[68:71]
 ds_read_b64 a[220:221], v16 offset:3912
 v_lshl_add_u32 v5, v5, 1, v6
 v_mfma_f32_16x16x32_bf16 v[68:71], v[172:175], a[72:75], v[68:71]
 ds_read_b64 a[222:223], v16 offset:3920
 v_bfe_u32 v6, v0, 2, 1
 v_mfma_f32_16x16x32_bf16 v[68:71], v[176:179], a[68:71], v[68:71]
 ds_read_b64 a[216:217], v16 offset:3848
 v_lshlrev_b32 v6, 1, v6
 v_mfma_f32_16x16x32_bf16 v[68:71], v[180:183], a[64:67], v[68:71]
 s_waitcnt lgkmcnt(15)
 ds_read_b64 a[218:219], v16 offset:3856
 v_sub_u32 v6, v3, v6
 v_mfma_f32_16x16x32_bf16 v[72:75], v[160:163], a[148:151], 0
 ds_read_b64_tr_b16 v[192:193], v17 offset:6656
 v_lshl_add_u32 v5, v6, 2, v5
 v_mfma_f32_16x16x32_bf16 v[72:75], v[164:167], a[144:147], v[72:75]
 ds_read_b64_tr_b16 v[194:195], v17 offset:6624
 v_cmp_eq_u32 s[16:17], 0, v5
 v_mfma_f32_16x16x32_bf16 v[72:75], v[168:171], a[140:143], v[72:75]
 ds_read_b64_tr_b16 v[196:197], v17 offset:6912
 v_cmp_eq_u32 s[18:19], 1, v5
 v_mfma_f32_16x16x32_bf16 v[72:75], v[172:175], a[136:139], v[72:75]
 ds_read_b64_tr_b16 v[198:199], v17 offset:6880
 v_cmp_eq_u32 s[20:21], 2, v5
 v_mfma_f32_16x16x32_bf16 v[72:75], v[176:179], a[132:135], v[72:75]
 ds_read_b64 a[36:37], v16 offset:584
 v_cmp_eq_u32 s[22:23], 3, v5
 v_mfma_f32_16x16x32_bf16 v[72:75], v[180:183], a[128:131], v[72:75]
 ds_read_b64 a[38:39], v16 offset:592
 v_cndmask_b32 v24, 0, v4, s[16:17]
 v_mfma_f32_16x16x32_bf16 v[76:79], v[160:163], a[212:215], 0
 ds_read_b64 a[32:33], v16 offset:520
 v_cndmask_b32 v25, 0, v4, s[18:19]
 v_mfma_f32_16x16x32_bf16 v[76:79], v[164:167], a[208:211], v[76:79]
 ds_read_b64 a[34:35], v16 offset:528
 v_cndmask_b32 v26, 0, v4, s[20:21]
 v_mfma_f32_16x16x32_bf16 v[76:79], v[168:171], a[204:207], v[76:79]
 ds_read_b64 a[100:101], v16 offset:1736
 v_cndmask_b32 v27, 0, v4, s[22:23]
 v_mfma_f32_16x16x32_bf16 v[76:79], v[172:175], a[200:203], v[76:79]
 ds_read_b64 a[102:103], v16 offset:1744
 v_cmp_eq_u32 s[16:17], 4, v5
 v_mfma_f32_16x16x32_bf16 v[76:79], v[176:179], a[196:199], v[76:79]
 ds_read_b64 a[96:97], v16 offset:1672
 v_cmp_eq_u32 s[18:19], 5, v5
 v_mfma_f32_16x16x32_bf16 v[76:79], v[180:183], a[192:195], v[76:79]
 s_waitcnt lgkmcnt(15)
 ds_read_b64 a[98:99], v16 offset:1680
 v_cmp_eq_u32 s[20:21], 6, v5
 v_mfma_f32_16x16x32_bf16 v[80:83], v[160:163], a[28:31], 0
 ds_read_b64 a[164:165], v16 offset:2888
 v_cmp_eq_u32 s[22:23], 7, v5
 v_mfma_f32_16x16x32_bf16 v[80:83], v[164:167], a[24:27], v[80:83]
 ds_read_b64 a[166:167], v16 offset:2896
 buffer_load_dword v23, v11, s[12:15], s44 offen offset:64 sc1
 v_mfma_f32_16x16x32_bf16 v[80:83], v[168:171], a[20:23], v[80:83]
 ds_read_b64 a[160:161], v16 offset:2824
 v_cndmask_b32 v28, 0, v4, s[16:17]
 v_mfma_f32_16x16x32_bf16 v[80:83], v[172:175], a[16:19], v[80:83]
 ds_read_b64 a[162:163], v16 offset:2832
 v_cndmask_b32 v29, 0, v4, s[18:19]
 v_mfma_f32_16x16x32_bf16 v[80:83], v[176:179], a[12:15], v[80:83]
 ds_read_b64 a[228:229], v16 offset:4040
 v_cndmask_b32 v30, 0, v4, s[20:21]
 v_mfma_f32_16x16x32_bf16 v[80:83], v[180:183], a[8:11], v[80:83]
 ds_read_b64 a[230:231], v16 offset:4048
 v_cndmask_b32 v31, 0, v4, s[22:23]
 v_mfma_f32_16x16x32_bf16 v[80:83], v[184:187], a[4:7], v[80:83]
 s_mov_b32 s16, s64
 ds_read_b64 a[224:225], v16 offset:3976
 v_mfma_f32_16x16x32_bf16 v[80:83], v[188:191], a[0:3], v[80:83]
 s_mov_b32 s17, s65
 ds_read_b64 a[226:227], v16 offset:3984
 v_mfma_f32_16x16x32_bf16 v[84:87], v[160:163], a[92:95], 0
 s_mov_b32 s18, 1835008
 ds_read_b64_tr_b16 v[200:201], v17 offset:7168
 v_mfma_f32_16x16x32_bf16 v[84:87], v[164:167], a[88:91], v[84:87]
 s_mov_b32 s19, 0x20000
 ds_read_b64_tr_b16 v[202:203], v17 offset:7136
 v_mfma_f32_16x16x32_bf16 v[84:87], v[168:171], a[84:87], v[84:87]
 s_lshl_b32 s93, s95, 2
 ds_read_b64_tr_b16 v[204:205], v17 offset:7424
 v_mfma_f32_16x16x32_bf16 v[84:87], v[172:175], a[80:83], v[84:87]
 s_add_u32 s93, s93, 84963328
 ds_read_b64_tr_b16 v[206:207], v17 offset:7392
 v_mfma_f32_16x16x32_bf16 v[84:87], v[176:179], a[76:79], v[84:87]
 s_lshl_b32 s43, s41, 6
 ds_read_b64 a[44:45], v16 offset:712
 v_mfma_f32_16x16x32_bf16 v[84:87], v[180:183], a[72:75], v[84:87]
 s_add_u32 s43, s43, 84963328
 ds_read_b64 a[46:47], v16 offset:720
 v_mfma_f32_16x16x32_bf16 v[84:87], v[184:187], a[68:71], v[84:87]
 s_lshl_b32 s46, s41, 7
 ds_read_b64 a[40:41], v16 offset:648
 v_mfma_f32_16x16x32_bf16 v[84:87], v[188:191], a[64:67], v[84:87]
 s_add_u32 s54, s46, 917504
 ds_read_b64 a[42:43], v16 offset:656
 v_mfma_f32_16x16x32_bf16 v[88:91], v[160:163], a[156:159], 0
 s_add_u32 s55, s46, 1835008
 ds_read_b64 a[108:109], v16 offset:1864
 v_mfma_f32_16x16x32_bf16 v[88:91], v[164:167], a[152:155], v[88:91]
 s_lshl_b32 s56, s42, 1
 ds_read_b64 a[110:111], v16 offset:1872
 v_mfma_f32_16x16x32_bf16 v[88:91], v[168:171], a[148:151], v[88:91]
 s_mul_i32 s57, s41, 262144
 ds_read_b64 a[104:105], v16 offset:1800
 v_mfma_f32_16x16x32_bf16 v[88:91], v[172:175], a[144:147], v[88:91]
 s_add_u32 s56, s56, s57
 ds_read_b64 a[106:107], v16 offset:1808
 v_mfma_f32_16x16x32_bf16 v[88:91], v[176:179], a[140:143], v[88:91]
 s_add_u32 s56, s56, 90177536
 ds_read_b64 a[172:173], v16 offset:3016
 v_mfma_f32_16x16x32_bf16 v[88:91], v[180:183], a[136:139], v[88:91]
 s_add_u32 s57, s56, 131072
 ds_read_b64 a[174:175], v16 offset:3024
 v_mfma_f32_16x16x32_bf16 v[88:91], v[184:187], a[132:135], v[88:91]
 s_lshl_b32 s58, s3, 12
 ds_read_b64 a[168:169], v16 offset:2952
 v_mfma_f32_16x16x32_bf16 v[88:91], v[188:191], a[128:131], v[88:91]
 s_waitcnt lgkmcnt(15)
 ds_read_b64 a[170:171], v16 offset:2960
 v_mfma_f32_16x16x32_bf16 v[92:95], v[160:163], a[220:223], 0
 s_add_u32 s58, s58, 0x20000
 ds_read_b64 a[236:237], v16 offset:4168
 v_mfma_f32_16x16x32_bf16 v[92:95], v[164:167], a[216:219], v[92:95]
 s_mov_b32 s59, 0xffff0000
 ds_read_b64 a[238:239], v16 offset:4176
 v_mfma_f32_16x16x32_bf16 v[92:95], v[168:171], a[212:215], v[92:95]
 s_lshl_b32 s47, s3, 14
 ds_read_b64 a[232:233], v16 offset:4104
 v_lshrrev_b32 v8, 1, v0
 v_mfma_f32_16x16x32_bf16 v[92:95], v[172:175], a[208:211], v[92:95]
 ds_read_b64 a[234:235], v16 offset:4112
 v_mul_u32_u24 v8, 4096, v8
 v_mfma_f32_16x16x32_bf16 v[92:95], v[176:179], a[204:207], v[92:95]
 ds_read_b64_tr_b16 v[208:209], v17 offset:7680
 v_and_b32 v9, 1, v0
 v_mfma_f32_16x16x32_bf16 v[92:95], v[180:183], a[200:203], v[92:95]
 ds_read_b64_tr_b16 v[210:211], v17 offset:7648
 v_lshl_add_u32 v8, v9, 4, v8
 v_mfma_f32_16x16x32_bf16 v[92:95], v[184:187], a[196:199], v[92:95]
 ds_read_b64_tr_b16 v[212:213], v17 offset:7936
 v_lshlrev_b32 v10, 3, v3
 v_mfma_f32_16x16x32_bf16 v[92:95], v[188:191], a[192:195], v[92:95]
 ds_read_b64_tr_b16 v[214:215], v17 offset:7904
 v_bfe_u32 v6, v0, 2, 2
 v_mfma_f32_16x16x32_bf16 v[96:99], v[160:163], a[36:39], 0
 ds_read_b64 a[52:53], v16 offset:840
 v_add_u32 v10, v10, v6
 v_mfma_f32_16x16x32_bf16 v[96:99], v[164:167], a[32:35], v[96:99]
 ds_read_b64 a[54:55], v16 offset:848
 v_lshlrev_b32 v10, 5, v10
 v_mfma_f32_16x16x32_bf16 v[96:99], v[168:171], a[28:31], v[96:99]
 ds_read_b64 a[48:49], v16 offset:776
 v_and_b32 v6, 3, v0
 v_mfma_f32_16x16x32_bf16 v[96:99], v[172:175], a[24:27], v[96:99]
 ds_read_b64 a[50:51], v16 offset:784
 v_lshl_add_u32 v10, v6, 3, v10
 v_mfma_f32_16x16x32_bf16 v[96:99], v[176:179], a[20:23], v[96:99]
 ds_read_b64 a[116:117], v16 offset:1992
 v_add_u32 v10, s58, v10
 v_mfma_f32_16x16x32_bf16 v[96:99], v[180:183], a[16:19], v[96:99]
 ds_read_b64 a[118:119], v16 offset:2000
 v_add_u32 v9, s47, v1
 v_mfma_f32_16x16x32_bf16 v[96:99], v[184:187], a[12:15], v[96:99]
 ds_read_b64 a[112:113], v16 offset:1928
 v_add_f32 v39, v39, v42
 v_mfma_f32_16x16x32_bf16 v[96:99], v[188:191], a[8:11], v[96:99]
 ds_read_b64 a[114:115], v16 offset:1936
 v_add_f32 v43, v43, v46
 v_mfma_f32_16x16x32_bf16 v[96:99], v[192:195], a[4:7], v[96:99]
 ds_read_b64 a[180:181], v16 offset:3144
 v_add_f32 v39, v39, v45
 v_mfma_f32_16x16x32_bf16 v[96:99], v[196:199], a[0:3], v[96:99]
 ds_read_b64 a[182:183], v16 offset:3152
 v_cndmask_b32_e64 v224, v39, 0, vcc
 v_mfma_f32_16x16x32_bf16 v[100:103], v[160:163], a[100:103], 0
 s_waitcnt vmcnt(0)
 ds_read_b64 a[176:177], v16 offset:3080
 v_cmp_ne_u32 s[52:53], 0, v23
 v_mfma_f32_16x16x32_bf16 v[100:103], v[164:167], a[96:99], v[100:103]
 s_cmp_eq_u64 s[52:53], 0
 s_cselect_b32 s49, 1, 0
 s_cselect_b32 s51, s37, 2.0
 ds_read_b64 a[178:179], v16 offset:3088
 v_mfma_f32_16x16x32_bf16 v[100:103], v[168:171], a[92:95], v[100:103]
 s_lshl_b32 m0, s3, 14
 ds_read_b64 a[244:245], v16 offset:4296
 v_cndmask_b32_e64 v225, v43, 0, vcc
 v_mfma_f32_16x16x32_bf16 v[100:103], v[172:175], a[88:91], v[100:103]
 ds_read_b64 a[246:247], v16 offset:4304
 v_cndmask_b32_e64 v226, v47, 0, vcc
 v_mfma_f32_16x16x32_bf16 v[100:103], v[176:179], a[84:87], v[100:103]
 ds_read_b64 a[240:241], v16 offset:4232
 buffer_load_dwordx4 v1, s[12:15], s51 offen offset:0 sc1 lds
 v_mfma_f32_16x16x32_bf16 v[100:103], v[180:183], a[80:83], v[100:103]
 ds_read_b64 a[242:243], v16 offset:4240
 v_add_f32 v33, v33, v36
 v_mfma_f32_16x16x32_bf16 v[100:103], v[184:187], a[76:79], v[100:103]
 ds_read_b64_tr_b16 v[216:217], v17 offset:8192
 v_add_f32 v34, v34, v37
 v_mfma_f32_16x16x32_bf16 v[100:103], v[188:191], a[72:75], v[100:103]
 ds_read_b64_tr_b16 v[218:219], v17 offset:8160
 v_add_f32 v35, v35, v38
 v_mfma_f32_16x16x32_bf16 v[100:103], v[192:195], a[68:71], v[100:103]
 ds_read_b64_tr_b16 v[220:221], v17 offset:8448
 v_add_f32 v34, v34, v40
 v_mfma_f32_16x16x32_bf16 v[100:103], v[196:199], a[64:67], v[100:103]
 ds_read_b64_tr_b16 v[222:223], v17 offset:8416
 v_add_f32 v35, v35, v41
 v_mfma_f32_16x16x32_bf16 v[104:107], v[160:163], a[164:167], 0
 ds_read_b64 a[60:61], v16 offset:968
 v_add_f32 v35, v35, v44
 v_mfma_f32_16x16x32_bf16 v[104:107], v[164:167], a[160:163], v[104:107]
 ds_read_b64 a[62:63], v16 offset:976
 v_add_f32 v55, v55, v58
 v_mfma_f32_16x16x32_bf16 v[104:107], v[168:171], a[156:159], v[104:107]
 ds_read_b64 a[56:57], v16 offset:904
 buffer_load_dwordx4 v1, s[12:15], s51 offen offset:1024 sc1 lds
 v_mfma_f32_16x16x32_bf16 v[104:107], v[172:175], a[152:155], v[104:107]
 ds_read_b64 a[58:59], v16 offset:912
 v_add_f32 v59, v59, v62
 v_mfma_f32_16x16x32_bf16 v[104:107], v[176:179], a[148:151], v[104:107]
 ds_read_b64 a[124:125], v16 offset:2120
 v_add_f32 v55, v55, v61
 v_mfma_f32_16x16x32_bf16 v[104:107], v[180:183], a[144:147], v[104:107]
 ds_read_b64 a[126:127], v16 offset:2128
 v_cndmask_b32_e64 v232, v55, v39, vcc
 v_mfma_f32_16x16x32_bf16 v[104:107], v[184:187], a[140:143], v[104:107]
 ds_read_b64 a[120:121], v16 offset:2056
 v_cndmask_b32_e64 v233, v59, v43, vcc
 v_mfma_f32_16x16x32_bf16 v[104:107], v[188:191], a[136:139], v[104:107]
 ds_read_b64 a[122:123], v16 offset:2064
 v_cndmask_b32_e64 v234, v63, v47, vcc
 v_mfma_f32_16x16x32_bf16 v[104:107], v[192:195], a[132:135], v[104:107]
 ds_read_b64 a[188:189], v16 offset:3272
 v_add_f32 v49, v49, v52
 v_mfma_f32_16x16x32_bf16 v[104:107], v[196:199], a[128:131], v[104:107]
 ds_read_b64 a[190:191], v16 offset:3280
 v_add_f32 v50, v50, v53
 v_mfma_f32_16x16x32_bf16 v[108:111], v[160:163], a[228:231], 0
 ds_read_b64 a[184:185], v16 offset:3208
 buffer_load_dwordx4 v1, s[12:15], s51 offen offset:2048 sc1 lds
 v_mfma_f32_16x16x32_bf16 v[108:111], v[164:167], a[224:227], v[108:111]
 ds_read_b64 a[186:187], v16 offset:3216
 v_add_f32 v51, v51, v54
 v_mfma_f32_16x16x32_bf16 v[108:111], v[168:171], a[220:223], v[108:111]
 ds_read_b64 v[12:13], v16 offset:4424
 v_add_f32 v50, v50, v56
 v_mfma_f32_16x16x32_bf16 v[108:111], v[172:175], a[216:219], v[108:111]
 ds_read_b64 v[14:15], v16 offset:4432
 v_add_f32 v51, v51, v57
 v_mfma_f32_16x16x32_bf16 v[108:111], v[176:179], a[212:215], v[108:111]
 ds_read_b64 a[248:249], v16 offset:4360
 v_add_f32 v51, v51, v60
 v_mfma_f32_16x16x32_bf16 v[108:111], v[180:183], a[208:211], v[108:111]
 ds_read_b64 a[250:251], v16 offset:4368
 v_add_f32 v71, v71, v74
 v_mfma_f32_16x16x32_bf16 v[108:111], v[184:187], a[204:207], v[108:111]
 ds_bpermute_b32 v224, v19, v224
 v_add_f32 v75, v75, v78
 v_mfma_f32_16x16x32_bf16 v[108:111], v[188:191], a[200:203], v[108:111]
 ds_bpermute_b32 v225, v19, v225
 v_add_f32 v71, v71, v77
 v_mfma_f32_16x16x32_bf16 v[108:111], v[192:195], a[196:199], v[108:111]
 buffer_load_dwordx4 v1, s[12:15], s51 offen offset:3072 sc1 lds
 v_mfma_f32_16x16x32_bf16 v[108:111], v[196:199], a[192:195], v[108:111]
 s_waitcnt lgkmcnt(15)
 ds_bpermute_b32 v226, v19, v226
 v_cndmask_b32_e64 v240, v71, v55, vcc
 v_mfma_f32_16x16x32_bf16 v[112:115], v[160:163], a[44:47], 0
 ds_read_u16_d16_hi v228, v18 offset:128
 v_cndmask_b32_e64 v241, v75, v59, vcc
 v_mfma_f32_16x16x32_bf16 v[112:115], v[164:167], a[40:43], v[112:115]
 ds_read_u16_d16_hi v229, v18 offset:1280
 v_cndmask_b32_e64 v242, v79, v63, vcc
 v_mfma_f32_16x16x32_bf16 v[112:115], v[168:171], a[36:39], v[112:115]
 ds_read_u16_d16_hi v230, v18 offset:2432
 v_add_f32 v65, v65, v68
 v_mfma_f32_16x16x32_bf16 v[112:115], v[172:175], a[32:35], v[112:115]
 ds_read_u16_d16_hi v231, v18 offset:3584
 v_add_f32 v66, v66, v69
 v_mfma_f32_16x16x32_bf16 v[112:115], v[176:179], a[28:31], v[112:115]
 s_add_u32 m0, m0, 4096
 ds_bpermute_b32 v232, v19, v232
 v_add_f32 v67, v67, v70
 v_mfma_f32_16x16x32_bf16 v[112:115], v[180:183], a[24:27], v[112:115]
 s_add_u32 s51, s51, 4096
 ds_bpermute_b32 v233, v19, v233
 v_add_f32 v66, v66, v72
 v_mfma_f32_16x16x32_bf16 v[112:115], v[184:187], a[20:23], v[112:115]
 buffer_load_dwordx4 v1, s[12:15], s51 offen offset:0 sc1 lds
 v_mfma_f32_16x16x32_bf16 v[112:115], v[188:191], a[16:19], v[112:115]
 ds_bpermute_b32 v234, v19, v234
 v_add_f32 v67, v67, v73
 v_mfma_f32_16x16x32_bf16 v[112:115], v[192:195], a[12:15], v[112:115]
 ds_read_u16_d16_hi v236, v18 offset:256
 v_add_f32 v67, v67, v76
 v_mfma_f32_16x16x32_bf16 v[112:115], v[196:199], a[8:11], v[112:115]
 s_waitcnt lgkmcnt(9)
 v_add_f32 v32, v32, v224
 v_add_f32 v33, v33, v225
 v_mfma_f32_16x16x32_bf16 v[112:115], v[200:203], a[4:7], v[112:115]
 s_waitcnt lgkmcnt(7)
 v_add_f32 v34, v34, v226
 v_fmac_f32 v32, s31, v228
 v_mfma_f32_16x16x32_bf16 v[112:115], v[204:207], a[0:3], v[112:115]
 s_waitcnt lgkmcnt(5)
 v_fmac_f32 v33, s31, v229
 v_fmac_f32 v34, s31, v230
 v_mfma_f32_16x16x32_bf16 v[116:119], v[160:163], a[108:111], 0
 s_waitcnt lgkmcnt(4)
 v_fmac_f32 v35, s31, v231
 v_cvt_pk_bf16_f32 v32, v32, v33
 v_mfma_f32_16x16x32_bf16 v[116:119], v[164:167], a[104:107], v[116:119]
 ds_read_u16_d16_hi v237, v18 offset:1408
 v_cvt_pk_bf16_f32 v33, v34, v35
 v_mfma_f32_16x16x32_bf16 v[116:119], v[168:171], a[100:103], v[116:119]
 buffer_load_dwordx4 v1, s[12:15], s51 offen offset:1024 sc1 lds
 v_mfma_f32_16x16x32_bf16 v[116:119], v[172:175], a[96:99], v[116:119]
 buffer_store_dwordx2 v[32:33], v20, s[12:15], s34 offen offset:0 sc1
 v_mfma_f32_16x16x32_bf16 v[116:119], v[176:179], a[92:95], v[116:119]
 ds_read_u16_d16_hi v238, v18 offset:2560
 v_add_f32 v87, v87, v90
 v_mfma_f32_16x16x32_bf16 v[116:119], v[180:183], a[88:91], v[116:119]
 ds_read_u16_d16_hi v239, v18 offset:3712
 v_add_f32 v91, v91, v94
 v_mfma_f32_16x16x32_bf16 v[116:119], v[184:187], a[84:87], v[116:119]
 ds_bpermute_b32 v240, v19, v240
 v_add_f32 v87, v87, v93
 v_mfma_f32_16x16x32_bf16 v[116:119], v[188:191], a[80:83], v[116:119]
 ds_bpermute_b32 v241, v19, v241
 v_cndmask_b32_e64 v248, v87, v71, vcc
 v_mfma_f32_16x16x32_bf16 v[116:119], v[192:195], a[76:79], v[116:119]
 ds_bpermute_b32 v242, v19, v242
 v_cndmask_b32_e64 v249, v91, v75, vcc
 v_mfma_f32_16x16x32_bf16 v[116:119], v[196:199], a[72:75], v[116:119]
 ds_read_u16_d16_hi v244, v18 offset:384
 v_cndmask_b32_e64 v250, v95, v79, vcc
 v_mfma_f32_16x16x32_bf16 v[116:119], v[200:203], a[68:71], v[116:119]
 buffer_load_dwordx4 v1, s[12:15], s51 offen offset:2048 sc1 lds
 v_mfma_f32_16x16x32_bf16 v[116:119], v[204:207], a[64:67], v[116:119]
 s_waitcnt lgkmcnt(9)
 v_add_f32 v48, v48, v232
 v_add_f32 v49, v49, v233
 v_mfma_f32_16x16x32_bf16 v[120:123], v[160:163], a[172:175], 0
 s_waitcnt lgkmcnt(7)
 v_add_f32 v50, v50, v234
 v_fmac_f32 v48, s31, v236
 v_mfma_f32_16x16x32_bf16 v[120:123], v[164:167], a[168:171], v[120:123]
 s_waitcnt lgkmcnt(5)
 v_fmac_f32 v49, s31, v237
 v_fmac_f32 v50, s31, v238
 v_mfma_f32_16x16x32_bf16 v[120:123], v[168:171], a[164:167], v[120:123]
 s_waitcnt lgkmcnt(4)
 v_fmac_f32 v51, s31, v239
 v_cvt_pk_bf16_f32 v48, v48, v49
 v_mfma_f32_16x16x32_bf16 v[120:123], v[172:175], a[160:163], v[120:123]
 ds_read_u16_d16_hi v245, v18 offset:1536
 v_cvt_pk_bf16_f32 v49, v50, v51
 v_mfma_f32_16x16x32_bf16 v[120:123], v[176:179], a[156:159], v[120:123]
 buffer_store_dwordx2 v[48:49], v20, s[12:15], s34 offen offset:512 sc1
 v_mfma_f32_16x16x32_bf16 v[120:123], v[180:183], a[152:155], v[120:123]
 ds_read_u16_d16_hi v246, v18 offset:2688
 v_add_f32 v81, v81, v84
 v_mfma_f32_16x16x32_bf16 v[120:123], v[184:187], a[148:151], v[120:123]
 buffer_load_dwordx4 v1, s[12:15], s51 offen offset:3072 sc1 lds
 v_mfma_f32_16x16x32_bf16 v[120:123], v[188:191], a[144:147], v[120:123]
 ds_read_u16_d16_hi v247, v18 offset:3840
 v_add_f32 v82, v82, v85
 v_mfma_f32_16x16x32_bf16 v[120:123], v[192:195], a[140:143], v[120:123]
 ds_bpermute_b32 v248, v19, v248
 v_add_f32 v83, v83, v86
 v_mfma_f32_16x16x32_bf16 v[120:123], v[196:199], a[136:139], v[120:123]
 ds_bpermute_b32 v249, v19, v249
 v_add_f32 v82, v82, v88
 v_mfma_f32_16x16x32_bf16 v[120:123], v[200:203], a[132:135], v[120:123]
 ds_bpermute_b32 v250, v19, v250
 v_add_f32 v83, v83, v89
 v_mfma_f32_16x16x32_bf16 v[120:123], v[204:207], a[128:131], v[120:123]
 ds_read_u16_d16_hi v252, v18 offset:512
 v_add_f32 v83, v83, v92
 v_mfma_f32_16x16x32_bf16 v[124:127], v[160:163], a[236:239], 0
 s_add_u32 m0, m0, 4096
 ds_read_u16_d16_hi v253, v18 offset:1664
 v_add_f32 v103, v103, v106
 v_mfma_f32_16x16x32_bf16 v[124:127], v[164:167], a[232:235], v[124:127]
 s_waitcnt lgkmcnt(10)
 s_add_u32 s51, s51, 4096
 v_add_f32 v64, v64, v240
 v_add_f32 v65, v65, v241
 v_mfma_f32_16x16x32_bf16 v[124:127], v[168:171], a[228:231], v[124:127]
 buffer_load_dwordx4 v1, s[12:15], s51 offen offset:0 sc1 lds
 v_mfma_f32_16x16x32_bf16 v[124:127], v[172:175], a[224:227], v[124:127]
 s_waitcnt lgkmcnt(8)
 v_add_f32 v66, v66, v242
 v_fmac_f32 v64, s31, v244
 v_mfma_f32_16x16x32_bf16 v[124:127], v[176:179], a[220:223], v[124:127]
 s_waitcnt lgkmcnt(6)
 v_fmac_f32 v65, s31, v245
 v_fmac_f32 v66, s31, v246
 v_mfma_f32_16x16x32_bf16 v[124:127], v[180:183], a[216:219], v[124:127]
 s_waitcnt lgkmcnt(5)
 v_fmac_f32 v67, s31, v247
 v_cvt_pk_bf16_f32 v64, v64, v65
 v_mfma_f32_16x16x32_bf16 v[124:127], v[184:187], a[212:215], v[124:127]
 ds_read_u16_d16_hi v254, v18 offset:2816
 v_cvt_pk_bf16_f32 v65, v66, v67
 v_mfma_f32_16x16x32_bf16 v[124:127], v[188:191], a[208:211], v[124:127]
 buffer_store_dwordx2 v[64:65], v20, s[12:15], s34 offen offset:1024 sc1
 v_mfma_f32_16x16x32_bf16 v[124:127], v[192:195], a[204:207], v[124:127]
 ds_read_u16_d16_hi v255, v18 offset:3968
 v_add_f32 v107, v107, v110
 v_mfma_f32_16x16x32_bf16 v[124:127], v[196:199], a[200:203], v[124:127]
 v_add_f32 v103, v103, v109
 v_cndmask_b32_e64 v224, v103, v87, vcc
 v_mfma_f32_16x16x32_bf16 v[124:127], v[200:203], a[196:199], v[124:127]
 buffer_load_dwordx4 v1, s[12:15], s51 offen offset:1024 sc1 lds
 v_mfma_f32_16x16x32_bf16 v[124:127], v[204:207], a[192:195], v[124:127]
 v_cndmask_b32_e64 v225, v107, v91, vcc
 v_cndmask_b32_e64 v226, v111, v95, vcc
 v_mfma_f32_16x16x32_bf16 v[128:131], v[160:163], a[52:55], 0
 ds_bpermute_b32 v224, v19, v224
 v_add_f32 v97, v97, v100
 v_mfma_f32_16x16x32_bf16 v[128:131], v[164:167], a[48:51], v[128:131]
 ds_bpermute_b32 v225, v19, v225
 v_add_f32 v98, v98, v101
 v_mfma_f32_16x16x32_bf16 v[128:131], v[168:171], a[44:47], v[128:131]
 s_waitcnt lgkmcnt(7)
 v_add_f32 v80, v80, v248
 v_add_f32 v81, v81, v249
 v_mfma_f32_16x16x32_bf16 v[128:131], v[172:175], a[40:43], v[128:131]
 s_waitcnt lgkmcnt(5)
 v_add_f32 v82, v82, v250
 v_fmac_f32 v80, s31, v252
 v_mfma_f32_16x16x32_bf16 v[128:131], v[176:179], a[36:39], v[128:131]
 s_waitcnt lgkmcnt(3)
 v_fmac_f32 v81, s31, v253
 v_fmac_f32 v82, s31, v254
 v_mfma_f32_16x16x32_bf16 v[128:131], v[180:183], a[32:35], v[128:131]
 s_waitcnt lgkmcnt(2)
 v_fmac_f32 v83, s31, v255
 v_cvt_pk_bf16_f32 v80, v80, v81
 v_mfma_f32_16x16x32_bf16 v[128:131], v[184:187], a[28:31], v[128:131]
 buffer_load_dwordx4 v1, s[12:15], s51 offen offset:2048 sc1 lds
 v_mfma_f32_16x16x32_bf16 v[128:131], v[188:191], a[24:27], v[128:131]
 ds_bpermute_b32 v226, v19, v226
 v_cvt_pk_bf16_f32 v81, v82, v83
 v_mfma_f32_16x16x32_bf16 v[128:131], v[192:195], a[20:23], v[128:131]
 buffer_store_dwordx2 v[80:81], v20, s[12:15], s34 offen offset:1536 sc1
 v_mfma_f32_16x16x32_bf16 v[128:131], v[196:199], a[16:19], v[128:131]
 ds_read_u16_d16_hi v228, v18 offset:640
 v_add_f32 v99, v99, v102
 v_mfma_f32_16x16x32_bf16 v[128:131], v[200:203], a[12:15], v[128:131]
 ds_read_u16_d16_hi v229, v18 offset:1792
 v_add_f32 v98, v98, v104
 v_mfma_f32_16x16x32_bf16 v[128:131], v[204:207], a[8:11], v[128:131]
 ds_read_u16_d16_hi v230, v18 offset:2944
 v_add_f32 v99, v99, v105
 v_mfma_f32_16x16x32_bf16 v[128:131], v[208:211], a[4:7], v[128:131]
 ds_read_u16_d16_hi v231, v18 offset:4096
 v_add_f32 v99, v99, v108
 v_mfma_f32_16x16x32_bf16 v[128:131], v[212:215], a[0:3], v[128:131]
 v_add_f32 v119, v119, v122
 v_add_f32 v123, v123, v126
 v_mfma_f32_16x16x32_bf16 v[132:135], v[160:163], a[116:119], 0
 buffer_load_dwordx4 v1, s[12:15], s51 offen offset:3072 sc1 lds
 v_mfma_f32_16x16x32_bf16 v[132:135], v[164:167], a[112:115], v[132:135]
 v_add_f32 v119, v119, v125
 v_cndmask_b32_e64 v232, v119, v103, vcc
 v_mfma_f32_16x16x32_bf16 v[132:135], v[168:171], a[108:111], v[132:135]
 v_cndmask_b32_e64 v233, v123, v107, vcc
 v_cndmask_b32_e64 v234, v127, v111, vcc
 v_mfma_f32_16x16x32_bf16 v[132:135], v[172:175], a[104:107], v[132:135]
 ds_bpermute_b32 v232, v19, v232
 v_add_f32 v113, v113, v116
 v_mfma_f32_16x16x32_bf16 v[132:135], v[176:179], a[100:103], v[132:135]
 s_waitcnt lgkmcnt(6)
 v_add_f32 v96, v96, v224
 v_add_f32 v97, v97, v225
 v_mfma_f32_16x16x32_bf16 v[132:135], v[180:183], a[96:99], v[132:135]
 s_waitcnt lgkmcnt(4)
 v_add_f32 v98, v98, v226
 v_fmac_f32 v96, s31, v228
 v_mfma_f32_16x16x32_bf16 v[132:135], v[184:187], a[92:95], v[132:135]
 s_waitcnt lgkmcnt(2)
 s_add_u32 m0, m0, 4096
 v_fmac_f32 v97, s31, v229
 v_fmac_f32 v98, s31, v230
 v_mfma_f32_16x16x32_bf16 v[132:135], v[188:191], a[88:91], v[132:135]
 s_waitcnt lgkmcnt(1)
 s_add_u32 s51, s51, 4096
 v_fmac_f32 v99, s31, v231
 v_cvt_pk_bf16_f32 v96, v96, v97
 v_mfma_f32_16x16x32_bf16 v[132:135], v[192:195], a[84:87], v[132:135]
 buffer_load_dwordx4 v1, s[12:15], s51 offen offset:0 sc1 lds
 v_mfma_f32_16x16x32_bf16 v[132:135], v[196:199], a[80:83], v[132:135]
 ds_bpermute_b32 v233, v19, v233
 v_cvt_pk_bf16_f32 v97, v98, v99
 v_mfma_f32_16x16x32_bf16 v[132:135], v[200:203], a[76:79], v[132:135]
 buffer_store_dwordx2 v[96:97], v20, s[12:15], s34 offen offset:2048 sc1
 v_mfma_f32_16x16x32_bf16 v[132:135], v[204:207], a[72:75], v[132:135]
 ds_bpermute_b32 v234, v19, v234
 v_add_f32 v114, v114, v117
 v_mfma_f32_16x16x32_bf16 v[132:135], v[208:211], a[68:71], v[132:135]
 ds_read_u16_d16_hi v236, v18 offset:768
 v_add_f32 v115, v115, v118
 v_mfma_f32_16x16x32_bf16 v[132:135], v[212:215], a[64:67], v[132:135]
 ds_read_u16_d16_hi v237, v18 offset:1920
 v_add_f32 v114, v114, v120
 v_mfma_f32_16x16x32_bf16 v[136:139], v[160:163], a[180:183], 0
 ds_read_u16_d16_hi v238, v18 offset:3072
 v_add_f32 v115, v115, v121
 v_mfma_f32_16x16x32_bf16 v[136:139], v[164:167], a[176:179], v[136:139]
 ds_read_u16_d16_hi v239, v18 offset:4224
 v_add_f32 v115, v115, v124
 v_mfma_f32_16x16x32_bf16 v[136:139], v[168:171], a[172:175], v[136:139]
 buffer_load_dwordx4 v1, s[12:15], s51 offen offset:1024 sc1 lds
 v_mfma_f32_16x16x32_bf16 v[136:139], v[172:175], a[168:171], v[136:139]
 buffer_load_dwordx4 v[48:51], v7, s[16:19], s46 offen offset:0
 v_mfma_f32_16x16x32_bf16 v[136:139], v[176:179], a[164:167], v[136:139]
 v_mfma_f32_16x16x32_bf16 v[136:139], v[180:183], a[160:163], v[136:139]
 v_mfma_f32_16x16x32_bf16 v[136:139], v[184:187], a[156:159], v[136:139]
 v_mfma_f32_16x16x32_bf16 v[136:139], v[188:191], a[152:155], v[136:139]
 s_waitcnt lgkmcnt(5)
 v_add_f32 v112, v112, v232
 v_add_f32 v113, v113, v233
 v_mfma_f32_16x16x32_bf16 v[136:139], v[192:195], a[148:151], v[136:139]
 s_waitcnt lgkmcnt(3)
 v_add_f32 v114, v114, v234
 v_fmac_f32 v112, s31, v236
 v_mfma_f32_16x16x32_bf16 v[136:139], v[196:199], a[144:147], v[136:139]
 s_waitcnt lgkmcnt(1)
 v_fmac_f32 v113, s31, v237
 v_fmac_f32 v114, s31, v238
 v_mfma_f32_16x16x32_bf16 v[136:139], v[200:203], a[140:143], v[136:139]
 buffer_load_dwordx4 v1, s[12:15], s51 offen offset:2048 sc1 lds
 v_mfma_f32_16x16x32_bf16 v[136:139], v[204:207], a[136:139], v[136:139]
 s_waitcnt lgkmcnt(0)
 v_fmac_f32 v115, s31, v239
 v_cvt_pk_bf16_f32 v112, v112, v113
 v_mfma_f32_16x16x32_bf16 v[136:139], v[208:211], a[132:135], v[136:139]
 v_cvt_pk_bf16_f32 v113, v114, v115
 v_mfma_f32_16x16x32_bf16 v[136:139], v[212:215], a[128:131], v[136:139]
 buffer_store_dwordx2 v[112:113], v20, s[12:15], s34 offen offset:2560 sc1
 v_mfma_f32_16x16x32_bf16 v[140:143], v[160:163], a[244:247], 0
 v_mfma_f32_16x16x32_bf16 v[140:143], v[164:167], a[240:243], v[140:143]
 buffer_load_dwordx4 v[52:55], v7, s[16:19], s46 offen offset:64
 v_mfma_f32_16x16x32_bf16 v[140:143], v[168:171], a[236:239], v[140:143]
 v_mfma_f32_16x16x32_bf16 v[140:143], v[172:175], a[232:235], v[140:143]
 v_mfma_f32_16x16x32_bf16 v[140:143], v[176:179], a[228:231], v[140:143]
 buffer_load_dwordx4 v1, s[12:15], s51 offen offset:3072 sc1 lds
 v_mfma_f32_16x16x32_bf16 v[140:143], v[180:183], a[224:227], v[140:143]
 v_mfma_f32_16x16x32_bf16 v[140:143], v[184:187], a[220:223], v[140:143]
 v_mfma_f32_16x16x32_bf16 v[140:143], v[188:191], a[216:219], v[140:143]
 v_mfma_f32_16x16x32_bf16 v[140:143], v[192:195], a[212:215], v[140:143]
 v_mfma_f32_16x16x32_bf16 v[140:143], v[196:199], a[208:211], v[140:143]
 v_mfma_f32_16x16x32_bf16 v[140:143], v[200:203], a[204:207], v[140:143]
 v_mfma_f32_16x16x32_bf16 v[140:143], v[204:207], a[200:203], v[140:143]
 v_mfma_f32_16x16x32_bf16 v[140:143], v[208:211], a[196:199], v[140:143]
 v_mfma_f32_16x16x32_bf16 v[140:143], v[212:215], a[192:195], v[140:143]
 buffer_load_dwordx4 v[56:59], v7, s[16:19], s54 offen offset:0
 v_mfma_f32_16x16x32_bf16 v[144:147], v[160:163], a[60:63], 0
 v_mfma_f32_16x16x32_bf16 v[144:147], v[164:167], a[56:59], v[144:147]
 v_mfma_f32_16x16x32_bf16 v[144:147], v[168:171], a[52:55], v[144:147]
 v_mfma_f32_16x16x32_bf16 v[144:147], v[172:175], a[48:51], v[144:147]
 v_mfma_f32_16x16x32_bf16 v[144:147], v[176:179], a[44:47], v[144:147]
 v_mfma_f32_16x16x32_bf16 v[144:147], v[180:183], a[40:43], v[144:147]
 v_mfma_f32_16x16x32_bf16 v[144:147], v[184:187], a[36:39], v[144:147]
 v_mfma_f32_16x16x32_bf16 v[144:147], v[188:191], a[32:35], v[144:147]
 v_add_f32 v135, v135, v138
 v_add_f32 v139, v139, v142
 v_mfma_f32_16x16x32_bf16 v[144:147], v[192:195], a[28:31], v[144:147]
 v_add_f32 v135, v135, v141
 v_cndmask_b32_e64 v240, v135, v119, vcc
 v_mfma_f32_16x16x32_bf16 v[144:147], v[196:199], a[24:27], v[144:147]
 v_cndmask_b32_e64 v241, v139, v123, vcc
 v_cndmask_b32_e64 v242, v143, v127, vcc
 v_mfma_f32_16x16x32_bf16 v[144:147], v[200:203], a[20:23], v[144:147]
 ds_bpermute_b32 v240, v19, v240
 v_add_f32 v129, v129, v132
 v_mfma_f32_16x16x32_bf16 v[144:147], v[204:207], a[16:19], v[144:147]
 ds_bpermute_b32 v241, v19, v241
 v_add_f32 v130, v130, v133
 v_mfma_f32_16x16x32_bf16 v[144:147], v[208:211], a[12:15], v[144:147]
 ds_bpermute_b32 v242, v19, v242
 v_add_f32 v131, v131, v134
 v_mfma_f32_16x16x32_bf16 v[144:147], v[212:215], a[8:11], v[144:147]
 ds_read_u16_d16_hi v244, v18 offset:896
 v_add_f32 v130, v130, v136
 v_mfma_f32_16x16x32_bf16 v[144:147], v[216:219], a[4:7], v[144:147]
 ds_read_u16_d16_hi v245, v18 offset:2048
 v_add_f32 v131, v131, v137
 v_mfma_f32_16x16x32_bf16 v[144:147], v[220:223], a[0:3], v[144:147]
 ds_read_u16_d16_hi v246, v18 offset:3200
 v_add_f32 v131, v131, v140
 v_mfma_f32_16x16x32_bf16 v[148:151], v[160:163], a[124:127], 0
 ds_read_u16_d16_hi v247, v18 offset:4352
 v_mfma_f32_16x16x32_bf16 v[148:151], v[164:167], a[120:123], v[148:151]
 buffer_load_dwordx4 v[60:63], v7, s[16:19], s54 offen offset:64
 v_mfma_f32_16x16x32_bf16 v[148:151], v[168:171], a[116:119], v[148:151]
 v_mfma_f32_16x16x32_bf16 v[148:151], v[172:175], a[112:115], v[148:151]
 v_mfma_f32_16x16x32_bf16 v[148:151], v[176:179], a[108:111], v[148:151]
 v_mfma_f32_16x16x32_bf16 v[148:151], v[180:183], a[104:107], v[148:151]
 v_mfma_f32_16x16x32_bf16 v[148:151], v[184:187], a[100:103], v[148:151]
 s_waitcnt lgkmcnt(5)
 v_add_f32 v128, v128, v240
 v_add_f32 v129, v129, v241
 v_mfma_f32_16x16x32_bf16 v[148:151], v[188:191], a[96:99], v[148:151]
 s_waitcnt lgkmcnt(3)
 v_add_f32 v130, v130, v242
 v_fmac_f32 v128, s31, v244
 v_mfma_f32_16x16x32_bf16 v[148:151], v[192:195], a[92:95], v[148:151]
 buffer_load_dword v23, v11, s[12:15], s45 offen sc1
 v_mfma_f32_16x16x32_bf16 v[148:151], v[196:199], a[88:91], v[148:151]
 s_waitcnt lgkmcnt(1)
 v_fmac_f32 v129, s31, v245
 v_fmac_f32 v130, s31, v246
 v_mfma_f32_16x16x32_bf16 v[148:151], v[200:203], a[84:87], v[148:151]
 s_waitcnt lgkmcnt(0)
 v_fmac_f32 v131, s31, v247
 v_cvt_pk_bf16_f32 v128, v128, v129
 v_mfma_f32_16x16x32_bf16 v[148:151], v[204:207], a[80:83], v[148:151]
 v_cvt_pk_bf16_f32 v129, v130, v131
 v_mfma_f32_16x16x32_bf16 v[148:151], v[208:211], a[76:79], v[148:151]
 buffer_store_dwordx2 v[128:129], v20, s[12:15], s34 offen offset:3072 sc1
 v_mfma_f32_16x16x32_bf16 v[148:151], v[212:215], a[72:75], v[148:151]
 v_mfma_f32_16x16x32_bf16 v[148:151], v[216:219], a[68:71], v[148:151]
 v_mfma_f32_16x16x32_bf16 v[148:151], v[220:223], a[64:67], v[148:151]
 v_mfma_f32_16x16x32_bf16 v[152:155], v[160:163], a[188:191], 0
 v_mfma_f32_16x16x32_bf16 v[152:155], v[164:167], a[184:187], v[152:155]
 v_mfma_f32_16x16x32_bf16 v[152:155], v[168:171], a[180:183], v[152:155]
 v_mfma_f32_16x16x32_bf16 v[152:155], v[172:175], a[176:179], v[152:155]
 v_mfma_f32_16x16x32_bf16 v[152:155], v[176:179], a[172:175], v[152:155]
 v_mfma_f32_16x16x32_bf16 v[152:155], v[180:183], a[168:171], v[152:155]
 v_mfma_f32_16x16x32_bf16 v[152:155], v[184:187], a[164:167], v[152:155]
 v_mfma_f32_16x16x32_bf16 v[152:155], v[188:191], a[160:163], v[152:155]
 v_mfma_f32_16x16x32_bf16 v[152:155], v[192:195], a[156:159], v[152:155]
 v_mfma_f32_16x16x32_bf16 v[152:155], v[196:199], a[152:155], v[152:155]
 v_mfma_f32_16x16x32_bf16 v[152:155], v[200:203], a[148:151], v[152:155]
 v_mfma_f32_16x16x32_bf16 v[152:155], v[204:207], a[144:147], v[152:155]
 v_mfma_f32_16x16x32_bf16 v[152:155], v[208:211], a[140:143], v[152:155]
 v_mfma_f32_16x16x32_bf16 v[152:155], v[212:215], a[136:139], v[152:155]
 v_mfma_f32_16x16x32_bf16 v[152:155], v[216:219], a[132:135], v[152:155]
 v_mfma_f32_16x16x32_bf16 v[152:155], v[220:223], a[128:131], v[152:155]
 v_mfma_f32_16x16x32_bf16 v[156:159], v[160:163], v[12:15], 0
 v_mfma_f32_16x16x32_bf16 v[156:159], v[164:167], a[248:251], v[156:159]
 v_mfma_f32_16x16x32_bf16 v[156:159], v[168:171], a[244:247], v[156:159]
 v_mfma_f32_16x16x32_bf16 v[156:159], v[172:175], a[240:243], v[156:159]
 v_mfma_f32_16x16x32_bf16 v[156:159], v[176:179], a[236:239], v[156:159]
 v_mfma_f32_16x16x32_bf16 v[156:159], v[180:183], a[232:235], v[156:159]
 v_mfma_f32_16x16x32_bf16 v[156:159], v[184:187], a[228:231], v[156:159]
 v_mfma_f32_16x16x32_bf16 v[156:159], v[188:191], a[224:227], v[156:159]
 v_mfma_f32_16x16x32_bf16 v[156:159], v[192:195], a[220:223], v[156:159]
 v_mfma_f32_16x16x32_bf16 v[156:159], v[196:199], a[216:219], v[156:159]
 v_mfma_f32_16x16x32_bf16 v[156:159], v[200:203], a[212:215], v[156:159]
 v_mfma_f32_16x16x32_bf16 v[156:159], v[204:207], a[208:211], v[156:159]
 v_mfma_f32_16x16x32_bf16 v[156:159], v[208:211], a[204:207], v[156:159]
 v_mfma_f32_16x16x32_bf16 v[156:159], v[212:215], a[200:203], v[156:159]
 v_mfma_f32_16x16x32_bf16 v[156:159], v[216:219], a[196:199], v[156:159]
 v_mfma_f32_16x16x32_bf16 v[156:159], v[220:223], a[192:195], v[156:159]
 s_nop 7
 v_add_f32 v151, v151, v154
 v_add_f32 v155, v155, v158
 v_add_f32 v151, v151, v157
 v_cndmask_b32_e64 v248, v151, v135, vcc
 v_cndmask_b32_e64 v249, v155, v139, vcc
 v_cndmask_b32_e64 v250, v159, v143, vcc
 ds_bpermute_b32 v248, v19, v248
 ds_bpermute_b32 v249, v19, v249
 ds_bpermute_b32 v250, v19, v250
 ds_read_u16_d16_hi v252, v18 offset:1024
 ds_read_u16_d16_hi v253, v18 offset:2176
 ds_read_u16_d16_hi v254, v18 offset:3328
 ds_read_u16_d16_hi v255, v18 offset:4480
 v_add_f32 v145, v145, v148
 v_add_f32 v146, v146, v149
 v_add_f32 v147, v147, v150
 v_add_f32 v146, v146, v152
 v_add_f32 v147, v147, v153
 v_add_f32 v147, v147, v156
 s_waitcnt lgkmcnt(0)
 v_add_f32 v144, v144, v248
 v_add_f32 v145, v145, v249
 v_add_f32 v146, v146, v250
 v_fmac_f32 v144, s31, v252
 v_fmac_f32 v145, s31, v253
 v_fmac_f32 v146, s31, v254
 v_fmac_f32 v147, s31, v255
 v_cvt_pk_bf16_f32 v144, v144, v145
 v_cvt_pk_bf16_f32 v145, v146, v147
 buffer_store_dwordx2 v[144:145], v20, s[12:15], s34 offen offset:3584 sc1
 s_waitcnt vmcnt(2)
 v_cmp_ne_u32 vcc, 0, v23
 s_cmp_eq_u64 vcc, 0
 s_cselect_b32 s50, 1, 0
 s_cselect_b32 s51, s39, 2.0
 ds_read_b128 a[64:67], v9 offset:0
 ds_read_b128 a[68:71], v9 offset:1024
 ds_read_b128 a[72:75], v9 offset:2048
 ds_read_b128 a[76:79], v9 offset:3072
 ds_read_b128 a[80:83], v9 offset:4096
 ds_read_b128 a[84:87], v9 offset:5120
 ds_read_b128 a[88:91], v9 offset:6144
 ds_read_b128 a[92:95], v9 offset:7168
 ds_read_b128 a[96:99], v9 offset:8192
 ds_read_b128 a[100:103], v9 offset:9216
 ds_read_b128 a[104:107], v9 offset:10240
 ds_read_b128 a[108:111], v9 offset:11264
 ds_read_b128 a[112:115], v9 offset:12288
 ds_read_b128 a[116:119], v9 offset:13312
 ds_read_b128 a[120:123], v9 offset:14336
 ds_read_b128 a[124:127], v9 offset:15360
 s_waitcnt lgkmcnt(15)
 v_mfma_f32_16x16x32_bf16 v[40:43], v[24:27], a[64:67], 0
 v_mfma_f32_16x16x32_bf16 v[44:47], v[28:31], a[64:67], 0
 s_waitcnt lgkmcnt(14)
 v_mfma_f32_16x16x32_bf16 v[40:43], v[24:27], a[68:71], v[40:43]
 v_mfma_f32_16x16x32_bf16 v[44:47], v[28:31], a[68:71], v[44:47]
 s_waitcnt lgkmcnt(13)
 v_mfma_f32_16x16x32_bf16 v[40:43], v[24:27], a[72:75], v[40:43]
 v_mfma_f32_16x16x32_bf16 v[44:47], v[28:31], a[72:75], v[44:47]
 s_waitcnt lgkmcnt(12)
 v_mfma_f32_16x16x32_bf16 v[40:43], v[24:27], a[76:79], v[40:43]
 v_mfma_f32_16x16x32_bf16 v[44:47], v[28:31], a[76:79], v[44:47]
 s_waitcnt lgkmcnt(11)
 v_mfma_f32_16x16x32_bf16 v[40:43], v[24:27], a[80:83], v[40:43]
 v_mfma_f32_16x16x32_bf16 v[44:47], v[28:31], a[80:83], v[44:47]
 s_waitcnt lgkmcnt(10)
 v_mfma_f32_16x16x32_bf16 v[40:43], v[24:27], a[84:87], v[40:43]
 v_mfma_f32_16x16x32_bf16 v[44:47], v[28:31], a[84:87], v[44:47]
 s_waitcnt lgkmcnt(9)
 v_mfma_f32_16x16x32_bf16 v[40:43], v[24:27], a[88:91], v[40:43]
 v_mfma_f32_16x16x32_bf16 v[44:47], v[28:31], a[88:91], v[44:47]
 s_waitcnt lgkmcnt(8)
 v_mfma_f32_16x16x32_bf16 v[40:43], v[24:27], a[92:95], v[40:43]
 v_mfma_f32_16x16x32_bf16 v[44:47], v[28:31], a[92:95], v[44:47]
 s_waitcnt lgkmcnt(7)
 v_mfma_f32_16x16x32_bf16 v[40:43], v[24:27], a[96:99], v[40:43]
 v_mfma_f32_16x16x32_bf16 v[44:47], v[28:31], a[96:99], v[44:47]
 s_waitcnt lgkmcnt(6)
 v_mfma_f32_16x16x32_bf16 v[40:43], v[24:27], a[100:103], v[40:43]
 v_mfma_f32_16x16x32_bf16 v[44:47], v[28:31], a[100:103], v[44:47]
 s_waitcnt lgkmcnt(5)
 v_mfma_f32_16x16x32_bf16 v[40:43], v[24:27], a[104:107], v[40:43]
 v_mfma_f32_16x16x32_bf16 v[44:47], v[28:31], a[104:107], v[44:47]
 s_waitcnt lgkmcnt(4)
 v_mfma_f32_16x16x32_bf16 v[40:43], v[24:27], a[108:111], v[40:43]
 v_mfma_f32_16x16x32_bf16 v[44:47], v[28:31], a[108:111], v[44:47]
 s_waitcnt lgkmcnt(3)
 v_mfma_f32_16x16x32_bf16 v[40:43], v[24:27], a[112:115], v[40:43]
 v_mfma_f32_16x16x32_bf16 v[44:47], v[28:31], a[112:115], v[44:47]
 s_waitcnt lgkmcnt(2)
 v_mfma_f32_16x16x32_bf16 v[40:43], v[24:27], a[116:119], v[40:43]
 v_mfma_f32_16x16x32_bf16 v[44:47], v[28:31], a[116:119], v[44:47]
 s_waitcnt lgkmcnt(1)
 v_mfma_f32_16x16x32_bf16 v[40:43], v[24:27], a[120:123], v[40:43]
 v_mfma_f32_16x16x32_bf16 v[44:47], v[28:31], a[120:123], v[44:47]
 s_waitcnt lgkmcnt(0)
 v_mfma_f32_16x16x32_bf16 v[40:43], v[24:27], a[124:127], v[40:43]
 v_mfma_f32_16x16x32_bf16 v[44:47], v[28:31], a[124:127], v[44:47]
 s_waitcnt vmcnt(0)
 s_barrier
 buffer_store_dword v21, v21, s[12:15], s93 offen sc1
 s_cmp_eq_u32 s49, 1
 s_cbranch_scc1 L_havesh
 s_add_u32 s48, s44, 64
 s_mov_b32 s47, s51
 v_and_b32 v16, 15, v0
 v_lshlrev_b32 v16, 2, v16
 s_mov_b32 s32, 0
L_poll9:
 buffer_load_dword v17, v16, s[12:15], s48 offen sc1
 s_waitcnt vmcnt(0)
 v_cmp_ne_u32 vcc, 0, v17
 s_cbranch_vccz L_poll9_ok
 s_sleep 8
 s_add_u32 s32, s32, 1
 s_cmp_lt_u32 s32, 0x80000
 s_cbranch_scc1 L_poll9
L_poll9_ok:
 s_mov_b32 s51, s37
 s_lshl_b32 m0, s3, 14
 s_nop 0
 buffer_load_dwordx4 v1, s[12:15], s51 offen offset:0 sc1 lds
 s_nop 0
 buffer_load_dwordx4 v1, s[12:15], s51 offen offset:1024 sc1 lds
 s_nop 0
 buffer_load_dwordx4 v1, s[12:15], s51 offen offset:2048 sc1 lds
 s_nop 0
 buffer_load_dwordx4 v1, s[12:15], s51 offen offset:3072 sc1 lds
 s_add_u32 m0, m0, 4096
 s_add_u32 s51, s51, 4096
 s_nop 0
 buffer_load_dwordx4 v1, s[12:15], s51 offen offset:0 sc1 lds
 s_nop 0
 buffer_load_dwordx4 v1, s[12:15], s51 offen offset:1024 sc1 lds
 s_nop 0
 buffer_load_dwordx4 v1, s[12:15], s51 offen offset:2048 sc1 lds
 s_nop 0
 buffer_load_dwordx4 v1, s[12:15], s51 offen offset:3072 sc1 lds
 s_add_u32 m0, m0, 4096
 s_add_u32 s51, s51, 4096
 s_nop 0
 buffer_load_dwordx4 v1, s[12:15], s51 offen offset:0 sc1 lds
 s_nop 0
 buffer_load_dwordx4 v1, s[12:15], s51 offen offset:1024 sc1 lds
 s_nop 0
 buffer_load_dwordx4 v1, s[12:15], s51 offen offset:2048 sc1 lds
 s_nop 0
 buffer_load_dwordx4 v1, s[12:15], s51 offen offset:3072 sc1 lds
 s_add_u32 m0, m0, 4096
 s_add_u32 s51, s51, 4096
 s_nop 0
 buffer_load_dwordx4 v1, s[12:15], s51 offen offset:0 sc1 lds
 s_nop 0
 buffer_load_dwordx4 v1, s[12:15], s51 offen offset:1024 sc1 lds
 s_nop 0
 buffer_load_dwordx4 v1, s[12:15], s51 offen offset:2048 sc1 lds
 s_nop 0
 buffer_load_dwordx4 v1, s[12:15], s51 offen offset:3072 sc1 lds
 s_mov_b32 s51, s47
 s_waitcnt vmcnt(0)
 ds_read_b128 a[64:67], v9 offset:0
 ds_read_b128 a[68:71], v9 offset:1024
 ds_read_b128 a[72:75], v9 offset:2048
 ds_read_b128 a[76:79], v9 offset:3072
 ds_read_b128 a[80:83], v9 offset:4096
 ds_read_b128 a[84:87], v9 offset:5120
 ds_read_b128 a[88:91], v9 offset:6144
 ds_read_b128 a[92:95], v9 offset:7168
 ds_read_b128 a[96:99], v9 offset:8192
 ds_read_b128 a[100:103], v9 offset:9216
 ds_read_b128 a[104:107], v9 offset:10240
 ds_read_b128 a[108:111], v9 offset:11264
 ds_read_b128 a[112:115], v9 offset:12288
 ds_read_b128 a[116:119], v9 offset:13312
 ds_read_b128 a[120:123], v9 offset:14336
 ds_read_b128 a[124:127], v9 offset:15360
 s_waitcnt lgkmcnt(15)
 v_mfma_f32_16x16x32_bf16 v[40:43], v[24:27], a[64:67], 0
 v_mfma_f32_16x16x32_bf16 v[44:47], v[28:31], a[64:67], 0
 s_waitcnt lgkmcnt(14)
 v_mfma_f32_16x16x32_bf16 v[40:43], v[24:27], a[68:71], v[40:43]
 v_mfma_f32_16x16x32_bf16 v[44:47], v[28:31], a[68:71], v[44:47]
 s_waitcnt lgkmcnt(13)
 v_mfma_f32_16x16x32_bf16 v[40:43], v[24:27], a[72:75], v[40:43]
 v_mfma_f32_16x16x32_bf16 v[44:47], v[28:31], a[72:75], v[44:47]
 s_waitcnt lgkmcnt(12)
 v_mfma_f32_16x16x32_bf16 v[40:43], v[24:27], a[76:79], v[40:43]
 v_mfma_f32_16x16x32_bf16 v[44:47], v[28:31], a[76:79], v[44:47]
 s_waitcnt lgkmcnt(11)
 v_mfma_f32_16x16x32_bf16 v[40:43], v[24:27], a[80:83], v[40:43]
 v_mfma_f32_16x16x32_bf16 v[44:47], v[28:31], a[80:83], v[44:47]
 s_waitcnt lgkmcnt(10)
 v_mfma_f32_16x16x32_bf16 v[40:43], v[24:27], a[84:87], v[40:43]
 v_mfma_f32_16x16x32_bf16 v[44:47], v[28:31], a[84:87], v[44:47]
 s_waitcnt lgkmcnt(9)
 v_mfma_f32_16x16x32_bf16 v[40:43], v[24:27], a[88:91], v[40:43]
 v_mfma_f32_16x16x32_bf16 v[44:47], v[28:31], a[88:91], v[44:47]
 s_waitcnt lgkmcnt(8)
 v_mfma_f32_16x16x32_bf16 v[40:43], v[24:27], a[92:95], v[40:43]
 v_mfma_f32_16x16x32_bf16 v[44:47], v[28:31], a[92:95], v[44:47]
 s_waitcnt lgkmcnt(7)
 v_mfma_f32_16x16x32_bf16 v[40:43], v[24:27], a[96:99], v[40:43]
 v_mfma_f32_16x16x32_bf16 v[44:47], v[28:31], a[96:99], v[44:47]
 s_waitcnt lgkmcnt(6)
 v_mfma_f32_16x16x32_bf16 v[40:43], v[24:27], a[100:103], v[40:43]
 v_mfma_f32_16x16x32_bf16 v[44:47], v[28:31], a[100:103], v[44:47]
 s_waitcnt lgkmcnt(5)
 v_mfma_f32_16x16x32_bf16 v[40:43], v[24:27], a[104:107], v[40:43]
 v_mfma_f32_16x16x32_bf16 v[44:47], v[28:31], a[104:107], v[44:47]
 s_waitcnt lgkmcnt(4)
 v_mfma_f32_16x16x32_bf16 v[40:43], v[24:27], a[108:111], v[40:43]
 v_mfma_f32_16x16x32_bf16 v[44:47], v[28:31], a[108:111], v[44:47]
 s_waitcnt lgkmcnt(3)
 v_mfma_f32_16x16x32_bf16 v[40:43], v[24:27], a[112:115], v[40:43]
 v_mfma_f32_16x16x32_bf16 v[44:47], v[28:31], a[112:115], v[44:47]
 s_waitcnt lgkmcnt(2)
 v_mfma_f32_16x16x32_bf16 v[40:43], v[24:27], a[116:119], v[40:43]
 v_mfma_f32_16x16x32_bf16 v[44:47], v[28:31], a[116:119], v[44:47]
 s_waitcnt lgkmcnt(1)
 v_mfma_f32_16x16x32_bf16 v[40:43], v[24:27], a[120:123], v[40:43]
 v_mfma_f32_16x16x32_bf16 v[44:47], v[28:31], a[120:123], v[44:47]
 s_waitcnt lgkmcnt(0)
 v_mfma_f32_16x16x32_bf16 v[40:43], v[24:27], a[124:127], v[40:43]
 v_mfma_f32_16x16x32_bf16 v[44:47], v[28:31], a[124:127], v[44:47]
 s_nop 4
L_havesh:
 s_nop 2
 v_cvt_pk_bf16_f32 v40, v40, v41
 v_cvt_pk_bf16_f32 v41, v42, v43
 v_cvt_pk_bf16_f32 v42, v44, v45
 v_cvt_pk_bf16_f32 v43, v46, v47
 buffer_store_dwordx4 v[40:43], v2, s[8:11], s36 offen offset:0
 s_cmp_eq_u32 s50, 1
 s_cbranch_scc1 L_havelong
 v_and_b32 v16, 15, v0
 v_lshlrev_b32 v16, 2, v16
 s_mov_b32 s32, 0
L_poll10:
 buffer_load_dword v17, v16, s[12:15], s45 offen sc1
 s_waitcnt vmcnt(0)
 v_cmp_ne_u32 vcc, 0, v17
 s_cbranch_vccz L_poll10_ok
 s_sleep 8
 s_add_u32 s32, s32, 1
 s_cmp_lt_u32 s32, 0x80000
 s_cbranch_scc1 L_poll10
L_poll10_ok:
 s_mov_b32 s51, s39
L_havelong:
 buffer_load_dwordx4 a[0:3], v1, s[12:15], s51 offen offset:0 sc1
 buffer_load_dwordx4 a[4:7], v1, s[12:15], s51 offen offset:1024 sc1
 buffer_load_dwordx4 a[8:11], v1, s[12:15], s51 offen offset:2048 sc1
 buffer_load_dwordx4 a[12:15], v1, s[12:15], s51 offen offset:3072 sc1
 s_add_u32 s51, s51, 4096
 buffer_load_dwordx4 a[16:19], v1, s[12:15], s51 offen offset:0 sc1
 buffer_load_dwordx4 a[20:23], v1, s[12:15], s51 offen offset:1024 sc1
 buffer_load_dwordx4 a[24:27], v1, s[12:15], s51 offen offset:2048 sc1
 buffer_load_dwordx4 a[28:31], v1, s[12:15], s51 offen offset:3072 sc1
 s_add_u32 s51, s51, 4096
 buffer_load_dwordx4 a[32:35], v1, s[12:15], s51 offen offset:0 sc1
 buffer_load_dwordx4 a[36:39], v1, s[12:15], s51 offen offset:1024 sc1
 buffer_load_dwordx4 a[40:43], v1, s[12:15], s51 offen offset:2048 sc1
 buffer_load_dwordx4 a[44:47], v1, s[12:15], s51 offen offset:3072 sc1
 s_add_u32 s51, s51, 4096
 buffer_load_dword v23, v11, s[12:15], s43 offen sc1
 buffer_load_dwordx4 a[48:51], v1, s[12:15], s51 offen offset:0 sc1
 buffer_load_dwordx4 a[52:55], v1, s[12:15], s51 offen offset:1024 sc1
 buffer_load_dwordx4 a[56:59], v1, s[12:15], s51 offen offset:2048 sc1
 buffer_load_dwordx4 a[60:63], v1, s[12:15], s51 offen offset:3072 sc1
 s_add_u32 s51, s51, 4096
 s_waitcnt vmcnt(16)
 v_mfma_f32_16x16x32_bf16 v[32:35], v[24:27], a[0:3], 0
 v_mfma_f32_16x16x32_bf16 v[36:39], v[28:31], a[0:3], 0
 s_waitcnt vmcnt(15)
 v_mfma_f32_16x16x32_bf16 v[32:35], v[24:27], a[4:7], v[32:35]
 v_mfma_f32_16x16x32_bf16 v[36:39], v[28:31], a[4:7], v[36:39]
 s_waitcnt vmcnt(14)
 v_mfma_f32_16x16x32_bf16 v[32:35], v[24:27], a[8:11], v[32:35]
 v_mfma_f32_16x16x32_bf16 v[36:39], v[28:31], a[8:11], v[36:39]
 s_waitcnt vmcnt(13)
 v_mfma_f32_16x16x32_bf16 v[32:35], v[24:27], a[12:15], v[32:35]
 v_mfma_f32_16x16x32_bf16 v[36:39], v[28:31], a[12:15], v[36:39]
 s_waitcnt vmcnt(12)
 v_mfma_f32_16x16x32_bf16 v[32:35], v[24:27], a[16:19], v[32:35]
 v_mfma_f32_16x16x32_bf16 v[36:39], v[28:31], a[16:19], v[36:39]
 s_waitcnt vmcnt(11)
 v_mfma_f32_16x16x32_bf16 v[32:35], v[24:27], a[20:23], v[32:35]
 v_mfma_f32_16x16x32_bf16 v[36:39], v[28:31], a[20:23], v[36:39]
 s_waitcnt vmcnt(10)
 v_mfma_f32_16x16x32_bf16 v[32:35], v[24:27], a[24:27], v[32:35]
 v_mfma_f32_16x16x32_bf16 v[36:39], v[28:31], a[24:27], v[36:39]
 s_waitcnt vmcnt(9)
 v_mfma_f32_16x16x32_bf16 v[32:35], v[24:27], a[28:31], v[32:35]
 v_mfma_f32_16x16x32_bf16 v[36:39], v[28:31], a[28:31], v[36:39]
 s_waitcnt vmcnt(8)
 v_mfma_f32_16x16x32_bf16 v[32:35], v[24:27], a[32:35], v[32:35]
 v_mfma_f32_16x16x32_bf16 v[36:39], v[28:31], a[32:35], v[36:39]
 s_waitcnt vmcnt(7)
 v_mfma_f32_16x16x32_bf16 v[32:35], v[24:27], a[36:39], v[32:35]
 v_mfma_f32_16x16x32_bf16 v[36:39], v[28:31], a[36:39], v[36:39]
 s_waitcnt vmcnt(6)
 v_mfma_f32_16x16x32_bf16 v[32:35], v[24:27], a[40:43], v[32:35]
 v_mfma_f32_16x16x32_bf16 v[36:39], v[28:31], a[40:43], v[36:39]
 s_waitcnt vmcnt(5)
 v_mfma_f32_16x16x32_bf16 v[32:35], v[24:27], a[44:47], v[32:35]
 v_mfma_f32_16x16x32_bf16 v[36:39], v[28:31], a[44:47], v[36:39]
 s_waitcnt vmcnt(4)
 v_cmp_ne_u32 vcc, 0, v23
 s_cmp_eq_u64 vcc, 0
 s_cselect_b32 s50, 1, 0
 s_cselect_b32 s52, s56, 2.0
 s_cselect_b32 s53, s57, 2.0
 s_add_u32 m0, s58, 0
 s_nop 0
 buffer_load_dwordx4 v8, s[12:15], s52 offen offset:0 sc1 lds
 s_add_u32 m0, s58, 1024
 s_nop 0
 buffer_load_dwordx4 v8, s[12:15], s53 offen offset:0 sc1 lds
 s_add_u32 m0, s58, 0
 s_nop 0
 buffer_load_dwordx4 v8, s[12:15], s52 offen offset:2048 sc1 lds
 s_add_u32 m0, s58, 1024
 s_nop 0
 buffer_load_dwordx4 v8, s[12:15], s53 offen offset:2048 sc1 lds
 s_waitcnt vmcnt(7)
 v_mfma_f32_16x16x32_bf16 v[32:35], v[24:27], a[48:51], v[32:35]
 v_mfma_f32_16x16x32_bf16 v[36:39], v[28:31], a[48:51], v[36:39]
 s_waitcnt vmcnt(6)
 v_mfma_f32_16x16x32_bf16 v[32:35], v[24:27], a[52:55], v[32:35]
 v_mfma_f32_16x16x32_bf16 v[36:39], v[28:31], a[52:55], v[36:39]
 s_waitcnt vmcnt(5)
 v_mfma_f32_16x16x32_bf16 v[32:35], v[24:27], a[56:59], v[32:35]
 v_mfma_f32_16x16x32_bf16 v[36:39], v[28:31], a[56:59], v[36:39]
 s_waitcnt vmcnt(4)
 v_mfma_f32_16x16x32_bf16 v[32:35], v[24:27], a[60:63], v[32:35]
 v_mfma_f32_16x16x32_bf16 v[36:39], v[28:31], a[60:63], v[36:39]
 s_nop 7
 v_cvt_pk_bf16_f32 v32, v32, v33
 v_cvt_pk_bf16_f32 v33, v34, v35
 v_cvt_pk_bf16_f32 v34, v36, v37
 v_cvt_pk_bf16_f32 v35, v38, v39
 buffer_store_dwordx4 v[32:35], v2, s[8:11], s35 offen offset:0
 s_cmp_eq_u32 s50, 1
 s_cbranch_scc1 L_havey
 v_and_b32 v16, 15, v0
 v_lshlrev_b32 v16, 2, v16
 s_mov_b32 s32, 0
L_poll11:
 buffer_load_dword v17, v16, s[12:15], s43 offen sc1
 s_waitcnt vmcnt(0)
 v_cmp_ne_u32 vcc, 0, v17
 s_cbranch_vccz L_poll11_ok
 s_sleep 8
 s_add_u32 s32, s32, 1
 s_cmp_lt_u32 s32, 0x80000
 s_cbranch_scc1 L_poll11
L_poll11_ok:
 s_add_u32 m0, s58, 0
 s_nop 0
 buffer_load_dwordx4 v8, s[12:15], s56 offen offset:0 sc1 lds
 s_add_u32 m0, s58, 1024
 s_nop 0
 buffer_load_dwordx4 v8, s[12:15], s57 offen offset:0 sc1 lds
 s_add_u32 m0, s58, 0
 s_nop 0
 buffer_load_dwordx4 v8, s[12:15], s56 offen offset:2048 sc1 lds
 s_add_u32 m0, s58, 1024
 s_nop 0
 buffer_load_dwordx4 v8, s[12:15], s57 offen offset:2048 sc1 lds
 s_waitcnt vmcnt(0)
L_havey:
 s_waitcnt vmcnt(1)
 ds_read_b64_tr_b16 v[64:65], v10 offset:0
 ds_read_b64_tr_b16 v[66:67], v10 offset:128
 ds_read_b64_tr_b16 v[68:69], v10 offset:1024
 ds_read_b64_tr_b16 v[70:71], v10 offset:1152
 ds_read_b64_tr_b16 v[72:73], v10 offset:2048
 ds_read_b64_tr_b16 v[74:75], v10 offset:2176
 ds_read_b64_tr_b16 v[76:77], v10 offset:3072
 ds_read_b64_tr_b16 v[78:79], v10 offset:3200
 s_waitcnt lgkmcnt(6)
 v_lshlrev_b32 v16, 16, v48
 v_and_b32 v17, s59, v48
 v_lshlrev_b32 v18, 16, v64
 v_and_b32 v19, s59, v64
 v_pk_mul_f32 v[16:17], v[16:17], v[18:19]
 v_cvt_pk_bf16_f32 v48, v16, v17
 v_lshlrev_b32 v16, 16, v49
 v_and_b32 v17, s59, v49
 v_lshlrev_b32 v18, 16, v65
 v_and_b32 v19, s59, v65
 v_pk_mul_f32 v[16:17], v[16:17], v[18:19]
 v_cvt_pk_bf16_f32 v49, v16, v17
 v_lshlrev_b32 v16, 16, v50
 v_and_b32 v17, s59, v50
 v_lshlrev_b32 v18, 16, v66
 v_and_b32 v19, s59, v66
 v_pk_mul_f32 v[16:17], v[16:17], v[18:19]
 v_cvt_pk_bf16_f32 v50, v16, v17
 v_lshlrev_b32 v16, 16, v51
 v_and_b32 v17, s59, v51
 v_lshlrev_b32 v18, 16, v67
 v_and_b32 v19, s59, v67
 v_pk_mul_f32 v[16:17], v[16:17], v[18:19]
 v_cvt_pk_bf16_f32 v51, v16, v17
 buffer_store_dwordx4 v[48:51], v2, s[8:11], s46 offen offset:0
 s_waitcnt lgkmcnt(4)
 v_lshlrev_b32 v16, 16, v52
 v_and_b32 v17, s59, v52
 v_lshlrev_b32 v18, 16, v68
 v_and_b32 v19, s59, v68
 v_pk_mul_f32 v[16:17], v[16:17], v[18:19]
 v_cvt_pk_bf16_f32 v52, v16, v17
 v_lshlrev_b32 v16, 16, v53
 v_and_b32 v17, s59, v53
 v_lshlrev_b32 v18, 16, v69
 v_and_b32 v19, s59, v69
 v_pk_mul_f32 v[16:17], v[16:17], v[18:19]
 v_cvt_pk_bf16_f32 v53, v16, v17
 v_lshlrev_b32 v16, 16, v54
 v_and_b32 v17, s59, v54
 v_lshlrev_b32 v18, 16, v70
 v_and_b32 v19, s59, v70
 v_pk_mul_f32 v[16:17], v[16:17], v[18:19]
 v_cvt_pk_bf16_f32 v54, v16, v17
 v_lshlrev_b32 v16, 16, v55
 v_and_b32 v17, s59, v55
 v_lshlrev_b32 v18, 16, v71
 v_and_b32 v19, s59, v71
 v_pk_mul_f32 v[16:17], v[16:17], v[18:19]
 v_cvt_pk_bf16_f32 v55, v16, v17
 buffer_store_dwordx4 v[52:55], v2, s[8:11], s46 offen offset:64
 s_waitcnt lgkmcnt(2)
 v_lshlrev_b32 v16, 16, v56
 v_and_b32 v17, s59, v56
 v_lshlrev_b32 v18, 16, v72
 v_and_b32 v19, s59, v72
 v_pk_mul_f32 v[16:17], v[16:17], v[18:19]
 v_cvt_pk_bf16_f32 v56, v16, v17
 v_lshlrev_b32 v16, 16, v57
 v_and_b32 v17, s59, v57
 v_lshlrev_b32 v18, 16, v73
 v_and_b32 v19, s59, v73
 v_pk_mul_f32 v[16:17], v[16:17], v[18:19]
 v_cvt_pk_bf16_f32 v57, v16, v17
 v_lshlrev_b32 v16, 16, v58
 v_and_b32 v17, s59, v58
 v_lshlrev_b32 v18, 16, v74
 v_and_b32 v19, s59, v74
 v_pk_mul_f32 v[16:17], v[16:17], v[18:19]
 v_cvt_pk_bf16_f32 v58, v16, v17
 v_lshlrev_b32 v16, 16, v59
 v_and_b32 v17, s59, v59
 v_lshlrev_b32 v18, 16, v75
 v_and_b32 v19, s59, v75
 v_pk_mul_f32 v[16:17], v[16:17], v[18:19]
 v_cvt_pk_bf16_f32 v59, v16, v17
 buffer_store_dwordx4 v[56:59], v2, s[8:11], s55 offen offset:0
 s_waitcnt lgkmcnt(0)
 v_lshlrev_b32 v16, 16, v60
 v_and_b32 v17, s59, v60
 v_lshlrev_b32 v18, 16, v76
 v_and_b32 v19, s59, v76
 v_pk_mul_f32 v[16:17], v[16:17], v[18:19]
 v_cvt_pk_bf16_f32 v60, v16, v17
 v_lshlrev_b32 v16, 16, v61
 v_and_b32 v17, s59, v61
 v_lshlrev_b32 v18, 16, v77
 v_and_b32 v19, s59, v77
 v_pk_mul_f32 v[16:17], v[16:17], v[18:19]
 v_cvt_pk_bf16_f32 v61, v16, v17
 v_lshlrev_b32 v16, 16, v62
 v_and_b32 v17, s59, v62
 v_lshlrev_b32 v18, 16, v78
 v_and_b32 v19, s59, v78
 v_pk_mul_f32 v[16:17], v[16:17], v[18:19]
 v_cvt_pk_bf16_f32 v62, v16, v17
 v_lshlrev_b32 v16, 16, v63
 v_and_b32 v17, s59, v63
 v_lshlrev_b32 v18, 16, v79
 v_and_b32 v19, s59, v79
 v_pk_mul_f32 v[16:17], v[16:17], v[18:19]
 v_cvt_pk_bf16_f32 v63, v16, v17
 buffer_store_dwordx4 v[60:63], v2, s[8:11], s55 offen offset:64
L_fin:
 s_endpgm
L_codeend:
.section .rodata,"a"
.p2align 6
.amdhsa_kernel concat_heads__ssm_conv_h3__compressed_kv_cla__prompt_kernel
  .amdhsa_next_free_vgpr 512
  .amdhsa_next_free_sgpr 102
  .amdhsa_accum_offset 256
  .amdhsa_group_segment_fixed_size 0
  .amdhsa_kernarg_size 120
  .amdhsa_user_sgpr_count 2
  .amdhsa_user_sgpr_kernarg_segment_ptr 1
  .amdhsa_system_sgpr_workgroup_id_x 1
.end_amdhsa_kernel
```

```asm
; @launch grid=(256,1,1) block=(256,1,1) lds=163840
.amdgcn_target "amdgcn-amd-amdhsa--gfx950"
.text
.globl concat_heads__ssm_conv_h3__compressed_kv_cla__prompt_kernel
.p2align 8
.type concat_heads__ssm_conv_h3__compressed_kv_cla__prompt_kernel,@function
concat_heads__ssm_conv_h3__compressed_kv_cla__prompt_kernel:
 s_cmp_lt_u32 s2, 256
 s_cbranch_scc1 L_go
 s_endpgm
L_go:
 s_load_dwordx16 s[64:79], s[0:1], 0
 s_load_dwordx8 s[80:87], s[0:1], 64
 s_load_dwordx4 s[88:91], s[0:1], 96
 s_load_dwordx2 s[12:13], s[0:1], 112
 v_lshrrev_b32 v1, 6, v0
 v_and_b32 v0, 63, v0
 v_readfirstlane_b32 s3, v1
 s_and_b32 s24, s2, 7
 s_bfe_u32 s25, s2, 0x30003
 s_bfe_u32 s26, s2, 0x10006
 s_lshl_b32 s37, s24, 1
 s_add_u32 s26, s26, s37
 s_lshr_b32 s27, s2, 7
 s_bfe_u32 s28, s2, 0x40003
 s_lshl_b32 s29, s3, 10
 s_and_b32 s39, s3, 1
 s_lshr_b32 s40, s3, 1
 s_cmp_eq_u32 s27, 0
 s_cselect_b32 s37, 7, 7
 s_add_u32 s37, s37, s25
 s_and_b32 s37, s37, 7
 s_lshl_b32 s37, s37, 1
 s_lshr_b32 s28, s28, 3
 s_add_u32 s28, s28, s37
 s_getpc_b64 s[100:101]
L_pc:
 s_sub_u32 s100, s100, L_pc-L_go
 s_subb_u32 s101, s101, 0
 s_lshr_b32 s32, s2, 1
 s_and_b32 s32, s32, 124
 s_add_u32 s32, s32, s3
 s_mul_i32 s32, s32, 1152
 s_add_u32 s32, s32, 0
 v_min_u32 v14, 8, v0
 v_lshl_add_u32 v14, v14, 7, s32
 v_min_u32 v14, L_codeend-L_go-4, v14
 global_load_dword a243, v14, s[100:101]
 s_mov_b32 s41, 65536
 s_mov_b32 s48, 32768
 s_mov_b32 s42, 131072
 s_mov_b32 s49, 131072
 s_mov_b32 s43, 196608
 s_mov_b32 s50, 163840
 s_mov_b32 s44, 262144
 s_mov_b32 s51, 262144
 s_mov_b32 s45, 327680
 s_mov_b32 s52, 294912
 s_mov_b32 s46, 393216
 s_mov_b32 s53, 393216
 s_mov_b32 s47, 458752
 s_mov_b32 s54, 425984
 s_lshl_b32 s56, s39, 1
 s_lshl_b32 s57, s40, 3
 s_add_u32 s56, s56, s57
 s_lshl_b32 s60, s25, 8
 s_lshl_b32 s58, s3, 3
 s_add_u32 s58, s58, s60
 v_lshrrev_b32 v14, 3, v0
 v_add_u32 v14, s58, v14
 v_lshlrev_b32 v14, 11, v14
 s_lshl_b32 s58, s39, 2
 v_lshrrev_b32 v15, 4, v0
 v_add_u32 v15, s58, v15
 v_xor_b32 v15, v0, v15
 v_and_b32 v15, 7, v15
 v_lshl_add_u32 v1, v15, 4, v14
 v_lshrrev_b32 v14, 5, v0
 s_lshl_b32 s58, s3, 1
 v_add_u32 v15, s58, v14
 v_lshlrev_b32 v15, 1, v15
 v_xor_b32 v15, v0, v15
 v_and_b32 v15, 31, v15
 v_lshlrev_b32 v15, 4, v15
 v_add_u32 v14, s56, v14
 v_lshl_add_u32 v14, v14, 13, v15
 s_lshl_b32 s58, s26, 9
 v_add_u32 v2, s58, v14
 s_waitcnt lgkmcnt(0)
 s_cmp_eq_u32 s27, 0
 s_cselect_b32 s8, s82, s84
 s_cselect_b32 s9, s83, s85
 s_mov_b32 s10, 8388608
 s_mov_b32 s11, 0x20000
 s_mov_b32 s4, s78
 s_mov_b32 s5, s79
 s_mov_b32 s6, 4194304
 s_mov_b32 s7, 0x20000
 s_mov_b32 s14, 268435456
 s_mov_b32 s15, 0x20000
 s_add_u32 m0, s29, 65536
 s_nop 0
 buffer_load_dwordx4 v2, s[8:11], 0 offen  lds
 s_lshl_b32 s58, s27, 3
 s_add_u32 s59, s58, s25
 s_lshl_b32 s59, s59, 2
 s_lshl_b32 s92, s26, 7
 s_add_u32 s92, s92, s59
 s_add_u32 s92, s92, 84934656
 s_add_u32 s58, s58, s24
 s_mul_i32 s95, s58, 14
 s_add_u32 s95, s95, s28
 s_sub_u32 s63, 15, s25
 s_add_u32 m0, s29, 0
 s_nop 0
 buffer_load_dwordx4 v1, s[4:7], 0 offen  lds
 s_cmp_eq_u32 s27, 0
 s_cselect_b32 s63, s25, s63
 s_lshl_b32 s93, s63, 7
 s_lshl_b32 s59, s26, 2
 s_add_u32 s93, s93, s59
 s_add_u32 s93, s93, 84938752
 s_and_b32 s94, s2, 127
 s_lshl_b32 s94, s94, 7
 s_add_u32 s94, s94, 84942848
 s_add_u32 m0, s29, 69632
 s_nop 0
 buffer_load_dwordx4 v2, s[8:11], s48 offen  lds
 s_cmp_lg_u32 s3, 0
 s_cbranch_scc1 L_noclr
 s_lshl_b32 s58, s95, 2
 s_add_u32 s59, s58, 84963328
 s_add_u32 s58, s58, 84959232
 s_lshl_b32 s61, s27, 2
 s_add_u32 s61, s61, s94
 s_cmp_lt_u32 s28, 14
 s_cselect_b32 s58, s58, s92
 s_cselect_b32 s59, s59, s92
 v_mov_b32 v14, s92
 v_writelane_b32 v14, s93, 1
 v_writelane_b32 v14, s61, 2
 v_writelane_b32 v14, s58, 3
 v_writelane_b32 v14, s59, 4
 s_add_u32 s58, s93, 64
 v_writelane_b32 v14, s58, 5
 v_mov_b32 v15, 1
 s_mov_b64 exec, 63
 buffer_store_dword v15, v14, s[12:15], 0 offen sc1
 s_mov_b64 exec, -1
L_noclr:
 s_add_u32 m0, s29, 4096
 s_nop 0
 buffer_load_dwordx4 v1, s[4:7], s41 offen  lds
 s_add_u32 m0, s29, 73728
 s_nop 0
 buffer_load_dwordx4 v2, s[8:11], s49 offen  lds
 s_cmp_eq_u32 s3, 0
 s_cselect_b32 s58, 0, 0x80000000
 v_bfrev_b32 v14, 1
 v_writelane_b32 v14, s58, 0
 v_accvgpr_write_b32 a245, v14
 s_add_u32 m0, s29, 8192
 s_nop 0
 buffer_load_dwordx4 v1, s[4:7], s42 offen  lds
 s_lshl_b32 s58, s39, 7
 s_lshl_b32 s59, s40, 3
 v_and_b32 v14, 15, v0
 v_lshrrev_b32 v15, 4, v0
 s_lshl_b32 s60, s63, 7
 s_lshl_b32 s62, s3, 4
 s_add_u32 s60, s60, s62
 v_lshrrev_b32 v13, 3, v0
 v_lshlrev_b32 v13, 1, v13
 s_add_u32 m0, s29, 77824
 s_nop 0
 buffer_load_dwordx4 v2, s[8:11], s50 offen  lds
 v_add_u32 v12, s60, v13
 v_mul_u32_u24 v12, 896, v12
 v_lshrrev_b32 v13, 1, v13
 v_xor_b32 v13, v0, v13
 v_and_b32 v13, 7, v13
 v_lshl_add_u32 v13, v13, 4, v12
 v_accvgpr_write_b32 a240, v13
 v_lshrrev_b32 v13, 1, v14
 v_xor_b32 v12, v13, v15
 s_add_u32 m0, s29, 12288
 s_nop 0
 buffer_load_dwordx4 v1, s[4:7], s43 offen  lds
 v_lshlrev_b32 v12, 4, v12
 v_lshl_add_u32 v12, v13, 7, v12
 v_and_b32 v13, 1, v14
 v_lshl_add_u32 v12, v13, 10, v12
 s_lshl_b32 s33, s3, 13
 s_add_u32 s33, s33, 0x20000
 v_add_u32 v12, s33, v12
 v_accvgpr_write_b32 a242, v12
 v_lshrrev_b32 v5, 1, v14
 s_add_u32 m0, s29, 81920
 s_nop 0
 buffer_load_dwordx4 v2, s[8:11], s51 offen  lds
 v_xor_b32 v5, v5, v15
 v_add_u32 v14, s58, v14
 v_lshlrev_b32 v14, 7, v14
 v_lshl_add_u32 v4, v5, 4, v14
 v_xor_b32 v5, 64, v4
 v_bfe_u32 v14, v0, 2, 3
 v_lshrrev_b32 v15, 5, v0
 v_lshl_add_u32 v13, v15, 4, v14
 v_lshlrev_b32 v13, 9, v13
 s_add_u32 m0, s29, 16384
 s_nop 0
 buffer_load_dwordx4 v1, s[4:7], s44 offen  lds
 v_xor_b32 v14, s59, v14
 v_lshl_add_u32 v13, v14, 5, v13
 v_and_b32 v14, 3, v0
 v_lshl_add_u32 v13, v14, 3, v13
 v_add_u32 v6, 0x10000, v13
 v_xor_b32 v7, 32, v6
 v_xor_b32 v8, 64, v6
 v_xor_b32 v9, 96, v6
 v_xor_b32 v10, 128, v6
 s_add_u32 m0, s29, 86016
 s_nop 0
 buffer_load_dwordx4 v2, s[8:11], s52 offen  lds
 v_xor_b32 v11, 160, v6
 v_xor_b32 v12, 192, v6
 v_xor_b32 v13, 224, v6
 s_mov_b32 s16, s80
 s_mov_b32 s17, s81
 s_mov_b32 s18, 3670016
 s_mov_b32 s19, 0x20000
 s_mov_b32 s20, s76
 s_mov_b32 s21, s77
 s_add_u32 m0, s29, 20480
 s_nop 0
 buffer_load_dwordx4 v1, s[4:7], s45 offen  lds
 s_mov_b32 s22, 1835008
 s_mov_b32 s23, 0x20000
 s_and_b32 s62, s2, 127
 s_lshl_b32 s62, s62, 2
 s_add_u32 s62, s62, s3
 s_mul_i32 s62, s62, 17408
 s_add_u32 s62, s62, 50331648
 s_mul_i32 s58, s26, 1048576
 s_mul_i32 s59, s25, 131072
 s_add_u32 m0, s29, 90112
 s_nop 0
 buffer_load_dwordx4 v2, s[8:11], s53 offen  lds
 s_add_u32 s58, s58, s59
 s_mul_i32 s59, s39, 65536
 s_add_u32 s58, s58, s59
 s_lshl_b32 s59, s40, 12
 s_lshl_b32 s59, s59, s27
 s_add_u32 s58, s58, s59
 s_mul_i32 s59, s27, 16777216
 s_add_u32 s58, s58, s59
 s_mov_b32 s57, 57344
 s_add_u32 m0, s29, 24576
 s_nop 0
 buffer_load_dwordx4 v1, s[4:7], s46 offen  lds
 s_lshl_b32 s60, s40, 8
 s_add_u32 s60, s60, 0x10000
 s_mov_b32 s34, 0x3db8aa3b
 s_mov_b32 s35, 0x3db8aa3b
 s_mul_i32 s55, s25, 5
 s_lshr_b32 s55, s55, 3
 s_add_u32 s55, s55, 1
 s_cmp_lg_u32 s3, 0
 s_cmov_b32 s55, 6
 s_add_u32 m0, s29, 94208
 s_nop 0
 buffer_load_dwordx4 v2, s[8:11], s54 offen  lds
 v_mov_b32 v15, 1
 s_cmp_ge_u32 s25, 6
 s_cmov_b32 s62, 2.0
 v_mov_b32 v20, 0
 v_mov_b32 v21, 0
 v_mov_b32 v24, 0
 v_mov_b32 v25, 0
 v_and_b32 v26, 1, v0
 v_lshlrev_b32 v26, 4, v26
 s_add_u32 m0, s29, 28672
 s_nop 0
 buffer_load_dwordx4 v1, s[4:7], s47 offen  lds
 v_add_u32 v1, 128, v1
 v_add_u32 v2, 0x80000, v2
 v_mov_b32 v27, 0x3f80
 v_lshlrev_b32 v26, v26, v27
 v_bfe_u32 v27, v0, 1, 3
 v_lshrrev_b32 v28, 4, v0
 v_lshlrev_b32 v28, 1, v28
 v_sub_u32 v27, v27, v28
 v_cmp_eq_u32 s[0:1], 0, v27
 v_cmp_eq_u32 vcc, 1, v27
 v_lshrrev_b32 v31, 3, v0
 s_add_u32 m0, s29, 98304
 s_nop 0
 buffer_load_dwordx4 v2, s[8:11], 0 offen  lds
 s_lshl_b32 s31, s3, 6
 v_add_u32 v30, s31, v31
 v_mul_u32_u24 v30, 896, v30
 v_and_b32 v31, 6, v31
 v_xor_b32 v31, v31, v0
 v_and_b32 v31, 7, v31
 v_lshl_add_u32 v30, v31, 4, v30
 v_cndmask_b32 v22, 0, v26, s[0:1]
 v_cndmask_b32 v23, 0, v26, vcc
 s_add_u32 m0, s29, 32768
 s_nop 0
 buffer_load_dwordx4 v1, s[4:7], 0 offen  lds
 v_accvgpr_write_b32 a248, v20
 v_accvgpr_write_b32 a249, v21
 v_accvgpr_write_b32 a250, v22
 v_accvgpr_write_b32 a251, v23
 v_accvgpr_write_b32 a252, v24
 v_accvgpr_write_b32 a253, v25
 v_accvgpr_write_b32 a241, v30
 s_lshl_b32 s31, s27, 3
 s_add_u32 s31, s31, s25
 s_add_u32 m0, s29, 102400
 s_nop 0
 buffer_load_dwordx4 v2, s[8:11], s48 offen  lds
 s_cmp_lt_u32 s31, 6
 s_cselect_b64 vcc, -1, 0
 v_lshlrev_b32 v31, 4, v0
 v_cndmask_b32 v30, v30, v31, vcc
 v_accvgpr_write_b32 a244, v30
 s_lshl_b32 s31, s25, 16
 s_lshl_b32 s32, s26, 9
 s_add_u32 s31, s31, s32
 v_lshrrev_b32 v15, 3, v0
 s_add_u32 m0, s29, 36864
 s_nop 0
 buffer_load_dwordx4 v1, s[4:7], s41 offen  lds
 v_lshlrev_b32 v15, 13, v15
 v_and_b32 v14, 7, v0
 v_lshlrev_b32 v14, 6, v14
 v_add3_u32 v16, v14, v15, s31
 s_lshl_b32 s31, s25, 2
 s_lshr_b32 s32, s2, 6
 s_add_u32 s31, s31, s32
 s_lshl_b32 s31, s31, 17
 v_lshlrev_b32 v17, 11, v0
 s_add_u32 m0, s29, 106496
 s_nop 0
 buffer_load_dwordx4 v2, s[8:11], s49 offen  lds
 v_add_u32 v17, s31, v17
 s_mul_i32 s36, s2, 7282
 s_lshr_b32 s36, s36, 16
 s_mul_i32 s37, s36, 9
 s_sub_u32 s37, s2, s37
 s_lshl_b32 s38, s36, 16
 s_mov_b64 s[30:31], s[80:81]
 s_cmp_eq_u32 s37, 2
 s_cmov_b64 s[30:31], s[76:77]
 s_add_u32 m0, s29, 40960
 s_nop 0
 buffer_load_dwordx4 v1, s[4:7], s42 offen  lds
 s_cmp_eq_u32 s37, 3
 s_cmov_b64 s[30:31], s[66:67]
 s_cmp_eq_u32 s37, 4
 s_cmov_b64 s[30:31], s[68:69]
 s_cmp_eq_u32 s37, 5
 s_cmov_b64 s[30:31], s[86:87]
 s_cmp_eq_u32 s37, 6
 s_cmov_b64 s[30:31], s[86:87]
 s_cmp_eq_u32 s37, 7
 s_cmov_b64 s[30:31], s[72:73]
 s_add_u32 m0, s29, 110592
 s_nop 0
 buffer_load_dwordx4 v2, s[8:11], s50 offen  lds
 s_cmp_eq_u32 s37, 8
 s_cmov_b64 s[30:31], s[64:65]
 s_add_u32 s32, s38, 1835008
 s_cmp_eq_u32 s37, 1
 s_cmov_b32 s38, s32
 s_cmp_eq_u32 s37, 6
 s_cmov_b32 s38, s32
 s_lshl_b32 s32, s39, 15
 s_add_u32 m0, s29, 45056
 s_nop 0
 buffer_load_dwordx4 v1, s[4:7], s43 offen  lds
 s_add_u32 s38, s38, s32
 s_cmp_ge_u32 s37, 9
 s_cmov_b32 s36, 28
 s_cmp_lt_u32 s36, 28
 s_cselect_b32 s32, 0x8000, 0
 s_cselect_b32 s38, s38, 0
 s_add_u32 s36, s30, s38
 s_addc_u32 s37, s31, 0
 s_mov_b32 s38, s32
 s_add_u32 m0, s29, 114688
 s_nop 0
 buffer_load_dwordx4 v2, s[8:11], s51 offen  lds
 s_mov_b32 s39, 0x20000
 v_lshlrev_b32 v14, 6, v0
 s_mov_b32 s56, 0xffffd000
 s_movk_i32 s30, 0x1000
 s_cmp_ge_u32 s3, 2
 s_cbranch_scc1 L_pfset
 s_mov_b32 s38, 0
 s_cmp_eq_u32 s3, 0
 s_cselect_b64 s[36:37], s[8:9], s[4:5]
 s_cselect_b32 s38, s10, s6
 s_movk_i32 s30, 128
 s_cmov_b32 s30, 0x80000
 s_cselect_b64 vcc, -1, 0
 s_lshl_b32 s56, s30, 1
 v_cndmask_b32 v14, v17, v16, vcc
L_pfset:
 s_add_u32 m0, s29, 49152
 s_nop 0
 buffer_load_dwordx4 v1, s[4:7], s44 offen  lds
 v_mov_b32 v15, 1
 v_mov_b32 v3, 0
 s_mov_b32 s61, 0
 s_waitcnt vmcnt(10)
 s_barrier
 ds_read_b64_tr_b16 a[0:1], v6 offset:0
 ds_read_b64_tr_b16 a[2:3], v6 offset:4096
 ds_read_b128 a[64:67], v4 offset:0
 ds_read_b64_tr_b16 a[4:5], v6 offset:16384
 ds_read_b64_tr_b16 a[6:7], v6 offset:20480
 ds_read_b128 a[68:71], v5 offset:0
 ds_read_b128 a[76:79], v5 offset:2048
 ds_read_b128 a[72:75], v4 offset:2048
 ds_read_b128 a[80:83], v4 offset:4096
 ds_read_b128 a[84:87], v5 offset:4096
 ds_read_b128 a[92:95], v5 offset:6144
 ds_read_b128 a[88:91], v4 offset:6144
 ds_read_b64_tr_b16 a[8:9], v7 offset:0
 ds_read_b64_tr_b16 a[10:11], v7 offset:4096
 ds_read_b64_tr_b16 a[12:13], v7 offset:16384
 ds_read_b64_tr_b16 a[14:15], v7 offset:20480
 ds_read_b64_tr_b16 a[16:17], v8 offset:0
 ds_read_b64_tr_b16 a[18:19], v8 offset:4096
 ds_read_b64_tr_b16 a[20:21], v8 offset:16384
 ds_read_b64_tr_b16 a[22:23], v8 offset:20480
 s_cmp_eq_u32 s27, 0
 s_waitcnt lgkmcnt(0)
 s_cbranch_scc0 L_vloop_head
L_kloop_head:
 v_mfma_f32_16x16x32_bf16 v[88:91], a[0:3], a[64:67], 0
 s_add_u32 m0, s29, 118784
 ds_read_b64_tr_b16 a[24:25], v9 offset:0
 v_mfma_f32_16x16x32_bf16 v[88:91], a[4:7], a[68:71], v[88:91]
 ds_read_b64_tr_b16 a[26:27], v9 offset:4096
 buffer_load_dwordx4 v2, s[8:11], s52 offen  lds
 v_mfma_f32_16x16x32_bf16 v[80:83], a[4:7], a[76:79], 0
 ds_read_b64_tr_b16 a[28:29], v9 offset:16384
 v_mfma_f32_16x16x32_bf16 v[80:83], a[0:3], a[72:75], v[80:83]
 ds_read_b64_tr_b16 a[30:31], v9 offset:20480
 v_mfma_f32_16x16x32_bf16 v[72:75], a[0:3], a[80:83], 0
 s_add_u32 m0, s29, 53248
 ds_read_b128 a[96:99], v4 offset:8192
 v_mfma_f32_16x16x32_bf16 v[72:75], a[4:7], a[84:87], v[72:75]
 buffer_load_dwordx4 v1, s[4:7], s45 offen  lds
 v_mfma_f32_16x16x32_bf16 v[64:67], a[4:7], a[92:95], 0
 ds_read_b128 a[100:103], v5 offset:8192
 v_mfma_f32_16x16x32_bf16 v[64:67], a[0:3], a[88:91], v[64:67]
 v_mfma_f32_16x16x32_bf16 v[68:71], a[8:11], a[88:91], 0
 s_add_u32 m0, s29, 122880
 ds_read_b128 a[108:111], v5 offset:10240
 v_mfma_f32_16x16x32_bf16 v[68:71], a[12:15], a[92:95], v[68:71]
 buffer_load_dwordx4 v2, s[8:11], s53 offen  lds
 v_mfma_f32_16x16x32_bf16 v[76:79], a[12:15], a[84:87], 0
 ds_read_b128 a[104:107], v4 offset:10240
 v_mfma_f32_16x16x32_bf16 v[76:79], a[8:11], a[80:83], v[76:79]
 v_mfma_f32_16x16x32_bf16 v[84:87], a[8:11], a[72:75], 0
 s_add_u32 m0, s29, 57344
 ds_read_b128 a[112:115], v4 offset:12288
 v_mfma_f32_16x16x32_bf16 v[84:87], a[12:15], a[76:79], v[84:87]
 buffer_load_dwordx4 v1, s[4:7], s46 offen  lds
 v_mfma_f32_16x16x32_bf16 v[92:95], a[12:15], a[68:71], 0
 ds_read_b128 a[116:119], v5 offset:12288
 v_mfma_f32_16x16x32_bf16 v[92:95], a[8:11], a[64:67], v[92:95]
 v_mfma_f32_16x16x32_bf16 v[120:123], a[16:19], a[64:67], 0
 s_add_u32 m0, s29, 126976
 ds_read_b128 a[124:127], v5 offset:14336
 v_mfma_f32_16x16x32_bf16 v[120:123], a[20:23], a[68:71], v[120:123]
 buffer_load_dwordx4 v2, s[8:11], s54 offen  lds
 v_mfma_f32_16x16x32_bf16 v[112:115], a[20:23], a[76:79], 0
 ds_read_b128 a[120:123], v4 offset:14336
 v_mfma_f32_16x16x32_bf16 v[112:115], a[16:19], a[72:75], v[112:115]
 v_mfma_f32_16x16x32_bf16 v[104:107], a[16:19], a[80:83], 0
 s_add_u32 m0, s29, 61440
 ds_read_b64_tr_b16 a[32:33], v10 offset:0
 v_mfma_f32_16x16x32_bf16 v[104:107], a[20:23], a[84:87], v[104:107]
 ds_read_b64_tr_b16 a[34:35], v10 offset:4096
 buffer_load_dwordx4 v1, s[4:7], s47 offen  lds
 v_mfma_f32_16x16x32_bf16 v[96:99], a[20:23], a[92:95], 0
 ds_read_b64_tr_b16 a[36:37], v10 offset:16384
 v_add_u32 v1, 128, v1
 v_mfma_f32_16x16x32_bf16 v[96:99], a[16:19], a[88:91], v[96:99]
 s_waitcnt lgkmcnt(8)
 ds_read_b64_tr_b16 a[38:39], v10 offset:20480
 v_add_u32 v2, 0x80000, v2
 v_mfma_f32_16x16x32_bf16 v[100:103], a[24:27], a[88:91], 0
 ds_read_b64_tr_b16 a[40:41], v11 offset:0
 v_mfma_f32_16x16x32_bf16 v[100:103], a[28:31], a[92:95], v[100:103]
 ds_read_b64_tr_b16 a[42:43], v11 offset:4096
 v_mfma_f32_16x16x32_bf16 v[108:111], a[28:31], a[84:87], 0
 ds_read_b64_tr_b16 a[44:45], v11 offset:16384
 v_mfma_f32_16x16x32_bf16 v[108:111], a[24:27], a[80:83], v[108:111]
 ds_read_b64_tr_b16 a[46:47], v11 offset:20480
 v_mfma_f32_16x16x32_bf16 v[116:119], a[24:27], a[72:75], 0
 ds_read_b64_tr_b16 a[48:49], v12 offset:0
 v_mfma_f32_16x16x32_bf16 v[116:119], a[28:31], a[76:79], v[116:119]
 ds_read_b64_tr_b16 a[50:51], v12 offset:4096
 v_mfma_f32_16x16x32_bf16 v[124:127], a[28:31], a[68:71], 0
 ds_read_b64_tr_b16 a[52:53], v12 offset:16384
 v_mfma_f32_16x16x32_bf16 v[124:127], a[24:27], a[64:67], v[124:127]
 ds_read_b64_tr_b16 a[54:55], v12 offset:20480
 v_mfma_f32_16x16x32_bf16 a[232:235], a[0:3], a[96:99], 0
 ds_read_b64_tr_b16 a[56:57], v13 offset:0
 v_mfma_f32_16x16x32_bf16 a[232:235], a[4:7], a[100:103], a[232:235]
 ds_read_b64_tr_b16 a[58:59], v13 offset:4096
 v_mfma_f32_16x16x32_bf16 a[224:227], a[4:7], a[108:111], 0
 s_waitcnt lgkmcnt(8)
 ds_read_b64_tr_b16 a[60:61], v13 offset:16384
 v_mfma_f32_16x16x32_bf16 a[224:227], a[0:3], a[104:107], a[224:227]
 ds_read_b64_tr_b16 a[62:63], v13 offset:20480
 v_mfma_f32_16x16x32_bf16 v[24:27], a[0:3], a[112:115], 0
 v_mfma_f32_16x16x32_bf16 v[24:27], a[4:7], a[116:119], v[24:27]
 v_mfma_f32_16x16x32_bf16 v[16:19], a[4:7], a[124:127], 0
 v_mfma_f32_16x16x32_bf16 v[16:19], a[0:3], a[120:123], v[16:19]
 s_waitcnt lgkmcnt(0)
 v_mfma_f32_16x16x32_bf16 v[20:23], a[8:11], a[120:123], 0
 s_barrier
 v_mfma_f32_16x16x32_bf16 v[20:23], a[12:15], a[124:127], v[20:23]
 s_add_u32 m0, s29, 65536
 v_mfma_f32_16x16x32_bf16 v[28:31], a[12:15], a[116:119], 0
 buffer_load_dwordx4 v2, s[8:11], 0 offen  lds
 v_mfma_f32_16x16x32_bf16 v[28:31], a[8:11], a[112:115], v[28:31]
 v_mfma_f32_16x16x32_bf16 a[228:231], a[8:11], a[104:107], 0
 v_mfma_f32_16x16x32_bf16 a[228:231], a[12:15], a[108:111], a[228:231]
 v_mfma_f32_16x16x32_bf16 a[236:239], a[12:15], a[100:103], 0
 s_add_u32 m0, s29, 0
 v_mfma_f32_16x16x32_bf16 a[236:239], a[8:11], a[96:99], a[236:239]
 buffer_load_dwordx4 v1, s[4:7], 0 offen  lds
 v_mfma_f32_16x16x32_bf16 v[56:59], a[16:19], a[96:99], 0
 v_mfma_f32_16x16x32_bf16 v[56:59], a[20:23], a[100:103], v[56:59]
 v_mfma_f32_16x16x32_bf16 v[48:51], a[20:23], a[108:111], 0
 v_mfma_f32_16x16x32_bf16 v[48:51], a[16:19], a[104:107], v[48:51]
 s_add_u32 m0, s29, 69632
 v_mfma_f32_16x16x32_bf16 v[40:43], a[16:19], a[112:115], 0
 buffer_load_dwordx4 v2, s[8:11], s48 offen  lds
 v_mfma_f32_16x16x32_bf16 v[40:43], a[20:23], a[116:119], v[40:43]
 v_mfma_f32_16x16x32_bf16 v[32:35], a[20:23], a[124:127], 0
 v_mfma_f32_16x16x32_bf16 v[32:35], a[16:19], a[120:123], v[32:35]
 v_mfma_f32_16x16x32_bf16 v[36:39], a[24:27], a[120:123], 0
 s_add_u32 m0, s29, 4096
 v_mfma_f32_16x16x32_bf16 v[36:39], a[28:31], a[124:127], v[36:39]
 buffer_load_dwordx4 v1, s[4:7], s41 offen  lds
 v_mfma_f32_16x16x32_bf16 v[44:47], a[28:31], a[116:119], 0
 v_mfma_f32_16x16x32_bf16 v[44:47], a[24:27], a[112:115], v[44:47]
 v_mfma_f32_16x16x32_bf16 v[52:55], a[24:27], a[104:107], 0
 v_mfma_f32_16x16x32_bf16 v[52:55], a[28:31], a[108:111], v[52:55]
 s_add_u32 m0, s29, 73728
 v_mfma_f32_16x16x32_bf16 v[60:63], a[28:31], a[100:103], 0
 buffer_load_dwordx4 v2, s[8:11], s49 offen  lds
 v_mfma_f32_16x16x32_bf16 v[60:63], a[24:27], a[96:99], v[60:63]
 v_mfma_f32_16x16x32_bf16 v[216:219], a[32:35], a[96:99], 0
 v_mfma_f32_16x16x32_bf16 v[216:219], a[36:39], a[100:103], v[216:219]
 v_mfma_f32_16x16x32_bf16 v[208:211], a[36:39], a[108:111], 0
 s_add_u32 m0, s29, 8192
 v_mfma_f32_16x16x32_bf16 v[208:211], a[32:35], a[104:107], v[208:211]
 buffer_load_dwordx4 v1, s[4:7], s42 offen  lds
 v_mfma_f32_16x16x32_bf16 v[200:203], a[32:35], a[112:115], 0
 v_mfma_f32_16x16x32_bf16 v[200:203], a[36:39], a[116:119], v[200:203]
 v_mfma_f32_16x16x32_bf16 v[192:195], a[36:39], a[124:127], 0
 v_mfma_f32_16x16x32_bf16 v[192:195], a[32:35], a[120:123], v[192:195]
 s_add_u32 m0, s29, 77824
 v_mfma_f32_16x16x32_bf16 v[196:199], a[40:43], a[120:123], 0
 buffer_load_dwordx4 v2, s[8:11], s50 offen  lds
 v_mfma_f32_16x16x32_bf16 v[196:199], a[44:47], a[124:127], v[196:199]
 v_mfma_f32_16x16x32_bf16 v[204:207], a[44:47], a[116:119], 0
 v_mfma_f32_16x16x32_bf16 v[204:207], a[40:43], a[112:115], v[204:207]
 v_mfma_f32_16x16x32_bf16 v[212:215], a[40:43], a[104:107], 0
 s_add_u32 m0, s29, 12288
 v_mfma_f32_16x16x32_bf16 v[212:215], a[44:47], a[108:111], v[212:215]
 buffer_load_dwordx4 v1, s[4:7], s43 offen  lds
 v_mfma_f32_16x16x32_bf16 v[220:223], a[44:47], a[100:103], 0
 v_mfma_f32_16x16x32_bf16 v[220:223], a[40:43], a[96:99], v[220:223]
 v_mfma_f32_16x16x32_bf16 v[248:251], a[48:51], a[96:99], 0
 v_mfma_f32_16x16x32_bf16 v[248:251], a[52:55], a[100:103], v[248:251]
 s_add_u32 m0, s29, 81920
 v_mfma_f32_16x16x32_bf16 v[240:243], a[52:55], a[108:111], 0
 buffer_load_dwordx4 v2, s[8:11], s51 offen  lds
 v_mfma_f32_16x16x32_bf16 v[240:243], a[48:51], a[104:107], v[240:243]
 v_mfma_f32_16x16x32_bf16 v[232:235], a[48:51], a[112:115], 0
 v_mfma_f32_16x16x32_bf16 v[232:235], a[52:55], a[116:119], v[232:235]
 v_mfma_f32_16x16x32_bf16 v[224:227], a[52:55], a[124:127], 0
 s_add_u32 m0, s29, 16384
 v_mfma_f32_16x16x32_bf16 v[224:227], a[48:51], a[120:123], v[224:227]
 buffer_load_dwordx4 v1, s[4:7], s44 offen  lds
 v_mfma_f32_16x16x32_bf16 v[228:231], a[56:59], a[120:123], 0
 v_mfma_f32_16x16x32_bf16 v[228:231], a[60:63], a[124:127], v[228:231]
 v_mfma_f32_16x16x32_bf16 v[236:239], a[60:63], a[116:119], 0
 v_mfma_f32_16x16x32_bf16 v[236:239], a[56:59], a[112:115], v[236:239]
 s_add_u32 m0, s29, 86016
 v_mfma_f32_16x16x32_bf16 v[244:247], a[56:59], a[104:107], 0
 s_waitcnt vmcnt(10)
 buffer_load_dwordx4 v2, s[8:11], s52 offen  lds
 v_mfma_f32_16x16x32_bf16 v[244:247], a[60:63], a[108:111], v[244:247]
 s_barrier
 ds_read_b64_tr_b16 a[0:1], v6 offset:32768
 v_mfma_f32_16x16x32_bf16 v[252:255], a[60:63], a[100:103], 0
 ds_read_b64_tr_b16 a[2:3], v6 offset:36864
 v_mfma_f32_16x16x32_bf16 v[252:255], a[56:59], a[96:99], v[252:255]
 ds_read_b128 a[96:99], v4 offset:40960
 v_mfma_f32_16x16x32_bf16 v[152:155], a[32:35], a[64:67], 0
 s_add_u32 m0, s29, 20480
 v_mfma_f32_16x16x32_bf16 v[152:155], a[36:39], a[68:71], v[152:155]
 buffer_load_dwordx4 v1, s[4:7], s45 offen  lds
 v_mfma_f32_16x16x32_bf16 v[144:147], a[36:39], a[76:79], 0
 ds_read_b64_tr_b16 a[4:5], v6 offset:49152
 v_mfma_f32_16x16x32_bf16 v[144:147], a[32:35], a[72:75], v[144:147]
 ds_read_b64_tr_b16 a[6:7], v6 offset:53248
 v_mfma_f32_16x16x32_bf16 v[136:139], a[32:35], a[80:83], 0
 ds_read_b128 a[100:103], v5 offset:40960
 v_mfma_f32_16x16x32_bf16 v[136:139], a[36:39], a[84:87], v[136:139]
 s_add_u32 m0, s29, 90112
 v_mfma_f32_16x16x32_bf16 v[128:131], a[36:39], a[92:95], 0
 buffer_load_dwordx4 v2, s[8:11], s53 offen  lds
 v_mfma_f32_16x16x32_bf16 v[128:131], a[32:35], a[88:91], v[128:131]
 ds_read_b128 a[108:111], v5 offset:43008
 v_mfma_f32_16x16x32_bf16 v[132:135], a[40:43], a[88:91], 0
 v_mfma_f32_16x16x32_bf16 v[132:135], a[44:47], a[92:95], v[132:135]
 ds_read_b128 a[104:107], v4 offset:43008
 v_mfma_f32_16x16x32_bf16 v[140:143], a[44:47], a[84:87], 0
 s_add_u32 m0, s29, 24576
 v_mfma_f32_16x16x32_bf16 v[140:143], a[40:43], a[80:83], v[140:143]
 buffer_load_dwordx4 v1, s[4:7], s46 offen  lds
 v_mfma_f32_16x16x32_bf16 v[148:151], a[40:43], a[72:75], 0
 ds_read_b128 a[112:115], v4 offset:45056
 v_mfma_f32_16x16x32_bf16 v[148:151], a[44:47], a[76:79], v[148:151]
 v_mfma_f32_16x16x32_bf16 v[156:159], a[44:47], a[68:71], 0
 ds_read_b128 a[116:119], v5 offset:45056
 v_mfma_f32_16x16x32_bf16 v[156:159], a[40:43], a[64:67], v[156:159]
 s_add_u32 m0, s29, 94208
 v_mfma_f32_16x16x32_bf16 v[184:187], a[48:51], a[64:67], 0
 buffer_load_dwordx4 v2, s[8:11], s54 offen  lds
 v_mfma_f32_16x16x32_bf16 v[184:187], a[52:55], a[68:71], v[184:187]
 ds_read_b128 a[124:127], v5 offset:47104
 v_mfma_f32_16x16x32_bf16 v[176:179], a[52:55], a[76:79], 0
 v_mfma_f32_16x16x32_bf16 v[176:179], a[48:51], a[72:75], v[176:179]
 ds_read_b128 a[120:123], v4 offset:47104
 v_mfma_f32_16x16x32_bf16 v[168:171], a[48:51], a[80:83], 0
 s_add_u32 m0, s29, 28672
 v_mfma_f32_16x16x32_bf16 v[168:171], a[52:55], a[84:87], v[168:171]
 buffer_load_dwordx4 v1, s[4:7], s47 offen  lds
 v_mfma_f32_16x16x32_bf16 v[160:163], a[52:55], a[92:95], 0
 v_mfma_f32_16x16x32_bf16 v[160:163], a[48:51], a[88:91], v[160:163]
 ds_read_b64_tr_b16 a[8:9], v7 offset:32768
 v_mfma_f32_16x16x32_bf16 v[164:167], a[56:59], a[88:91], 0
 v_mfma_f32_16x16x32_bf16 v[164:167], a[60:63], a[92:95], v[164:167]
 ds_read_b64_tr_b16 a[10:11], v7 offset:36864
 v_mfma_f32_16x16x32_bf16 v[172:175], a[60:63], a[84:87], 0
 ds_read_b64_tr_b16 a[12:13], v7 offset:49152
 v_mfma_f32_16x16x32_bf16 v[172:175], a[56:59], a[80:83], v[172:175]
 ds_read_b64_tr_b16 a[14:15], v7 offset:53248
 v_mfma_f32_16x16x32_bf16 v[180:183], a[56:59], a[72:75], 0
 ds_read_b64_tr_b16 a[16:17], v8 offset:32768
 v_mfma_f32_16x16x32_bf16 v[180:183], a[60:63], a[76:79], v[180:183]
 ds_read_b64_tr_b16 a[18:19], v8 offset:36864
 v_mfma_f32_16x16x32_bf16 v[188:191], a[60:63], a[68:71], 0
 ds_read_b64_tr_b16 a[20:21], v8 offset:49152
 v_mfma_f32_16x16x32_bf16 v[188:191], a[56:59], a[64:67], v[188:191]
 s_waitcnt lgkmcnt(8)
 ds_read_b64_tr_b16 a[22:23], v8 offset:53248
 v_add_u32 v1, 128, v1
 v_add_u32 v2, 0x80000, v2
 s_add_u32 s56, s56, s30
 buffer_load_dword a243, v14, s[36:39], s56 offen
 s_add_u32 s56, s56, s30
 buffer_load_dword a243, v14, s[36:39], s56 offen
 s_add_u32 s56, s56, s30
 s_branch L_kloop_mid
.p2align 6
L_kloop:
 v_mfma_f32_16x16x32_bf16 v[88:91], a[0:3], a[64:67], v[88:91]
 ds_read_b64_tr_b16 a[24:25], v9 offset:0
 v_mfma_f32_16x16x32_bf16 v[88:91], a[4:7], a[68:71], v[88:91]
 ds_read_b64_tr_b16 a[26:27], v9 offset:4096
 v_mfma_f32_16x16x32_bf16 v[80:83], a[4:7], a[76:79], v[80:83]
 ds_read_b64_tr_b16 a[28:29], v9 offset:16384
 v_mfma_f32_16x16x32_bf16 v[80:83], a[0:3], a[72:75], v[80:83]
 ds_read_b64_tr_b16 a[30:31], v9 offset:20480
 v_mfma_f32_16x16x32_bf16 v[72:75], a[0:3], a[80:83], v[72:75]
 ds_read_b128 a[96:99], v4 offset:8192
 v_mfma_f32_16x16x32_bf16 v[72:75], a[4:7], a[84:87], v[72:75]
 v_mfma_f32_16x16x32_bf16 v[64:67], a[4:7], a[92:95], v[64:67]
 s_waitcnt lgkmcnt(8)
 ds_read_b128 a[100:103], v5 offset:8192
 v_mfma_f32_16x16x32_bf16 v[64:67], a[0:3], a[88:91], v[64:67]
 v_mfma_f32_16x16x32_bf16 v[68:71], a[8:11], a[88:91], v[68:71]
 ds_read_b128 a[108:111], v5 offset:10240
 v_mfma_f32_16x16x32_bf16 v[68:71], a[12:15], a[92:95], v[68:71]
 v_mfma_f32_16x16x32_bf16 v[76:79], a[12:15], a[84:87], v[76:79]
 ds_read_b128 a[104:107], v4 offset:10240
 v_mfma_f32_16x16x32_bf16 v[76:79], a[8:11], a[80:83], v[76:79]
 v_mfma_f32_16x16x32_bf16 v[84:87], a[8:11], a[72:75], v[84:87]
 ds_read_b128 a[112:115], v4 offset:12288
 v_mfma_f32_16x16x32_bf16 v[84:87], a[12:15], a[76:79], v[84:87]
 v_mfma_f32_16x16x32_bf16 v[92:95], a[12:15], a[68:71], v[92:95]
 ds_read_b128 a[116:119], v5 offset:12288
 v_mfma_f32_16x16x32_bf16 v[92:95], a[8:11], a[64:67], v[92:95]
 s_waitcnt lgkmcnt(8)
 v_mfma_f32_16x16x32_bf16 v[120:123], a[16:19], a[64:67], v[120:123]
 ds_read_b128 a[124:127], v5 offset:14336
 v_mfma_f32_16x16x32_bf16 v[120:123], a[20:23], a[68:71], v[120:123]
 v_mfma_f32_16x16x32_bf16 v[112:115], a[20:23], a[76:79], v[112:115]
 ds_read_b128 a[120:123], v4 offset:14336
 v_mfma_f32_16x16x32_bf16 v[112:115], a[16:19], a[72:75], v[112:115]
 v_mfma_f32_16x16x32_bf16 v[104:107], a[16:19], a[80:83], v[104:107]
 ds_read_b64_tr_b16 a[32:33], v10 offset:0
 v_mfma_f32_16x16x32_bf16 v[104:107], a[20:23], a[84:87], v[104:107]
 ds_read_b64_tr_b16 a[34:35], v10 offset:4096
 v_mfma_f32_16x16x32_bf16 v[96:99], a[20:23], a[92:95], v[96:99]
 ds_read_b64_tr_b16 a[36:37], v10 offset:16384
 v_mfma_f32_16x16x32_bf16 v[96:99], a[16:19], a[88:91], v[96:99]
 ds_read_b64_tr_b16 a[38:39], v10 offset:20480
 v_mfma_f32_16x16x32_bf16 v[100:103], a[24:27], a[88:91], v[100:103]
 s_waitcnt lgkmcnt(8)
 ds_read_b64_tr_b16 a[40:41], v11 offset:0
 v_mfma_f32_16x16x32_bf16 v[100:103], a[28:31], a[92:95], v[100:103]
 ds_read_b64_tr_b16 a[42:43], v11 offset:4096
 v_mfma_f32_16x16x32_bf16 v[108:111], a[28:31], a[84:87], v[108:111]
 ds_read_b64_tr_b16 a[44:45], v11 offset:16384
 v_mfma_f32_16x16x32_bf16 v[108:111], a[24:27], a[80:83], v[108:111]
 ds_read_b64_tr_b16 a[46:47], v11 offset:20480
 v_mfma_f32_16x16x32_bf16 v[116:119], a[24:27], a[72:75], v[116:119]
 ds_read_b64_tr_b16 a[48:49], v12 offset:0
 v_mfma_f32_16x16x32_bf16 v[116:119], a[28:31], a[76:79], v[116:119]
 ds_read_b64_tr_b16 a[50:51], v12 offset:4096
 v_mfma_f32_16x16x32_bf16 v[124:127], a[28:31], a[68:71], v[124:127]
 ds_read_b64_tr_b16 a[52:53], v12 offset:16384
 v_mfma_f32_16x16x32_bf16 v[124:127], a[24:27], a[64:67], v[124:127]
 ds_read_b64_tr_b16 a[54:55], v12 offset:20480
 v_mfma_f32_16x16x32_bf16 a[232:235], a[0:3], a[96:99], a[232:235]
 ds_read_b64_tr_b16 a[56:57], v13 offset:0
 v_mfma_f32_16x16x32_bf16 a[232:235], a[4:7], a[100:103], a[232:235]
 ds_read_b64_tr_b16 a[58:59], v13 offset:4096
 v_mfma_f32_16x16x32_bf16 a[224:227], a[4:7], a[108:111], a[224:227]
 ds_read_b64_tr_b16 a[60:61], v13 offset:16384
 v_mfma_f32_16x16x32_bf16 a[224:227], a[0:3], a[104:107], a[224:227]
 s_waitcnt lgkmcnt(8)
 ds_read_b64_tr_b16 a[62:63], v13 offset:20480
 v_mfma_f32_16x16x32_bf16 v[24:27], a[0:3], a[112:115], v[24:27]
 v_mfma_f32_16x16x32_bf16 v[24:27], a[4:7], a[116:119], v[24:27]
 v_mfma_f32_16x16x32_bf16 v[16:19], a[4:7], a[124:127], v[16:19]
 v_mfma_f32_16x16x32_bf16 v[16:19], a[0:3], a[120:123], v[16:19]
 s_waitcnt lgkmcnt(0)
 v_mfma_f32_16x16x32_bf16 v[20:23], a[8:11], a[120:123], v[20:23]
 s_barrier
 v_mfma_f32_16x16x32_bf16 v[20:23], a[12:15], a[124:127], v[20:23]
 s_add_u32 m0, s29, 65536
 v_mfma_f32_16x16x32_bf16 v[28:31], a[12:15], a[116:119], v[28:31]
 buffer_load_dwordx4 v2, s[8:11], 0 offen  lds
 v_mfma_f32_16x16x32_bf16 v[28:31], a[8:11], a[112:115], v[28:31]
 v_mfma_f32_16x16x32_bf16 a[228:231], a[8:11], a[104:107], a[228:231]
 v_mfma_f32_16x16x32_bf16 a[228:231], a[12:15], a[108:111], a[228:231]
 v_mfma_f32_16x16x32_bf16 a[236:239], a[12:15], a[100:103], a[236:239]
 s_add_u32 m0, s29, 0
 v_mfma_f32_16x16x32_bf16 a[236:239], a[8:11], a[96:99], a[236:239]
 buffer_load_dwordx4 v1, s[4:7], 0 offen  lds
 v_mfma_f32_16x16x32_bf16 v[56:59], a[16:19], a[96:99], v[56:59]
 v_mfma_f32_16x16x32_bf16 v[56:59], a[20:23], a[100:103], v[56:59]
 v_mfma_f32_16x16x32_bf16 v[48:51], a[20:23], a[108:111], v[48:51]
 v_mfma_f32_16x16x32_bf16 v[48:51], a[16:19], a[104:107], v[48:51]
 s_add_u32 m0, s29, 69632
 v_mfma_f32_16x16x32_bf16 v[40:43], a[16:19], a[112:115], v[40:43]
 buffer_load_dwordx4 v2, s[8:11], s48 offen  lds
 v_mfma_f32_16x16x32_bf16 v[40:43], a[20:23], a[116:119], v[40:43]
 v_mfma_f32_16x16x32_bf16 v[32:35], a[20:23], a[124:127], v[32:35]
 v_mfma_f32_16x16x32_bf16 v[32:35], a[16:19], a[120:123], v[32:35]
 v_mfma_f32_16x16x32_bf16 v[36:39], a[24:27], a[120:123], v[36:39]
 s_add_u32 m0, s29, 4096
 v_mfma_f32_16x16x32_bf16 v[36:39], a[28:31], a[124:127], v[36:39]
 buffer_load_dwordx4 v1, s[4:7], s41 offen  lds
 v_mfma_f32_16x16x32_bf16 v[44:47], a[28:31], a[116:119], v[44:47]
 v_mfma_f32_16x16x32_bf16 v[44:47], a[24:27], a[112:115], v[44:47]
 v_mfma_f32_16x16x32_bf16 v[52:55], a[24:27], a[104:107], v[52:55]
 v_mfma_f32_16x16x32_bf16 v[52:55], a[28:31], a[108:111], v[52:55]
 s_add_u32 m0, s29, 73728
 v_mfma_f32_16x16x32_bf16 v[60:63], a[28:31], a[100:103], v[60:63]
 buffer_load_dwordx4 v2, s[8:11], s49 offen  lds
 v_mfma_f32_16x16x32_bf16 v[60:63], a[24:27], a[96:99], v[60:63]
 v_mfma_f32_16x16x32_bf16 v[216:219], a[32:35], a[96:99], v[216:219]
 v_mfma_f32_16x16x32_bf16 v[216:219], a[36:39], a[100:103], v[216:219]
 v_mfma_f32_16x16x32_bf16 v[208:211], a[36:39], a[108:111], v[208:211]
 s_add_u32 m0, s29, 8192
 v_mfma_f32_16x16x32_bf16 v[208:211], a[32:35], a[104:107], v[208:211]
 buffer_load_dwordx4 v1, s[4:7], s42 offen  lds
 v_mfma_f32_16x16x32_bf16 v[200:203], a[32:35], a[112:115], v[200:203]
 v_mfma_f32_16x16x32_bf16 v[200:203], a[36:39], a[116:119], v[200:203]
 v_mfma_f32_16x16x32_bf16 v[192:195], a[36:39], a[124:127], v[192:195]
 v_mfma_f32_16x16x32_bf16 v[192:195], a[32:35], a[120:123], v[192:195]
 s_add_u32 m0, s29, 77824
 v_mfma_f32_16x16x32_bf16 v[196:199], a[40:43], a[120:123], v[196:199]
 buffer_load_dwordx4 v2, s[8:11], s50 offen  lds
 v_mfma_f32_16x16x32_bf16 v[196:199], a[44:47], a[124:127], v[196:199]
 v_mfma_f32_16x16x32_bf16 v[204:207], a[44:47], a[116:119], v[204:207]
 v_mfma_f32_16x16x32_bf16 v[204:207], a[40:43], a[112:115], v[204:207]
 v_mfma_f32_16x16x32_bf16 v[212:215], a[40:43], a[104:107], v[212:215]
 s_add_u32 m0, s29, 12288
 v_mfma_f32_16x16x32_bf16 v[212:215], a[44:47], a[108:111], v[212:215]
 buffer_load_dwordx4 v1, s[4:7], s43 offen  lds
 v_mfma_f32_16x16x32_bf16 v[220:223], a[44:47], a[100:103], v[220:223]
 v_mfma_f32_16x16x32_bf16 v[220:223], a[40:43], a[96:99], v[220:223]
 v_mfma_f32_16x16x32_bf16 v[248:251], a[48:51], a[96:99], v[248:251]
 v_mfma_f32_16x16x32_bf16 v[248:251], a[52:55], a[100:103], v[248:251]
 s_add_u32 m0, s29, 81920
 v_mfma_f32_16x16x32_bf16 v[240:243], a[52:55], a[108:111], v[240:243]
 buffer_load_dwordx4 v2, s[8:11], s51 offen  lds
 v_mfma_f32_16x16x32_bf16 v[240:243], a[48:51], a[104:107], v[240:243]
 v_mfma_f32_16x16x32_bf16 v[232:235], a[48:51], a[112:115], v[232:235]
 v_mfma_f32_16x16x32_bf16 v[232:235], a[52:55], a[116:119], v[232:235]
 v_mfma_f32_16x16x32_bf16 v[224:227], a[52:55], a[124:127], v[224:227]
 s_add_u32 m0, s29, 16384
 v_mfma_f32_16x16x32_bf16 v[224:227], a[48:51], a[120:123], v[224:227]
 buffer_load_dwordx4 v1, s[4:7], s44 offen  lds
 v_mfma_f32_16x16x32_bf16 v[228:231], a[56:59], a[120:123], v[228:231]
 v_mfma_f32_16x16x32_bf16 v[228:231], a[60:63], a[124:127], v[228:231]
 v_mfma_f32_16x16x32_bf16 v[236:239], a[60:63], a[116:119], v[236:239]
 v_mfma_f32_16x16x32_bf16 v[236:239], a[56:59], a[112:115], v[236:239]
 s_add_u32 m0, s29, 86016
 v_mfma_f32_16x16x32_bf16 v[244:247], a[56:59], a[104:107], v[244:247]
 s_waitcnt vmcnt(11)
 buffer_load_dwordx4 v2, s[8:11], s52 offen  lds
 v_mfma_f32_16x16x32_bf16 v[244:247], a[60:63], a[108:111], v[244:247]
 s_barrier
 ds_read_b64_tr_b16 a[0:1], v6 offset:32768
 v_mfma_f32_16x16x32_bf16 v[252:255], a[60:63], a[100:103], v[252:255]
 ds_read_b64_tr_b16 a[2:3], v6 offset:36864
 v_mfma_f32_16x16x32_bf16 v[252:255], a[56:59], a[96:99], v[252:255]
 ds_read_b128 a[96:99], v4 offset:40960
 v_mfma_f32_16x16x32_bf16 v[152:155], a[32:35], a[64:67], v[152:155]
 s_add_u32 m0, s29, 20480
 v_mfma_f32_16x16x32_bf16 v[152:155], a[36:39], a[68:71], v[152:155]
 buffer_load_dwordx4 v1, s[4:7], s45 offen  lds
 v_mfma_f32_16x16x32_bf16 v[144:147], a[36:39], a[76:79], v[144:147]
 ds_read_b64_tr_b16 a[4:5], v6 offset:49152
 v_mfma_f32_16x16x32_bf16 v[144:147], a[32:35], a[72:75], v[144:147]
 ds_read_b64_tr_b16 a[6:7], v6 offset:53248
 v_mfma_f32_16x16x32_bf16 v[136:139], a[32:35], a[80:83], v[136:139]
 ds_read_b128 a[100:103], v5 offset:40960
 v_mfma_f32_16x16x32_bf16 v[136:139], a[36:39], a[84:87], v[136:139]
 s_add_u32 m0, s29, 90112
 v_mfma_f32_16x16x32_bf16 v[128:131], a[36:39], a[92:95], v[128:131]
 buffer_load_dwordx4 v2, s[8:11], s53 offen  lds
 v_mfma_f32_16x16x32_bf16 v[128:131], a[32:35], a[88:91], v[128:131]
 ds_read_b128 a[108:111], v5 offset:43008
 v_mfma_f32_16x16x32_bf16 v[132:135], a[40:43], a[88:91], v[132:135]
 v_mfma_f32_16x16x32_bf16 v[132:135], a[44:47], a[92:95], v[132:135]
 ds_read_b128 a[104:107], v4 offset:43008
 v_mfma_f32_16x16x32_bf16 v[140:143], a[44:47], a[84:87], v[140:143]
 s_add_u32 m0, s29, 24576
 v_mfma_f32_16x16x32_bf16 v[140:143], a[40:43], a[80:83], v[140:143]
 buffer_load_dwordx4 v1, s[4:7], s46 offen  lds
 v_mfma_f32_16x16x32_bf16 v[148:151], a[40:43], a[72:75], v[148:151]
 ds_read_b128 a[112:115], v4 offset:45056
 v_mfma_f32_16x16x32_bf16 v[148:151], a[44:47], a[76:79], v[148:151]
 v_mfma_f32_16x16x32_bf16 v[156:159], a[44:47], a[68:71], v[156:159]
 ds_read_b128 a[116:119], v5 offset:45056
 v_mfma_f32_16x16x32_bf16 v[156:159], a[40:43], a[64:67], v[156:159]
 s_add_u32 m0, s29, 94208
 v_mfma_f32_16x16x32_bf16 v[184:187], a[48:51], a[64:67], v[184:187]
 buffer_load_dwordx4 v2, s[8:11], s54 offen  lds
 v_mfma_f32_16x16x32_bf16 v[184:187], a[52:55], a[68:71], v[184:187]
 ds_read_b128 a[124:127], v5 offset:47104
 v_mfma_f32_16x16x32_bf16 v[176:179], a[52:55], a[76:79], v[176:179]
 v_mfma_f32_16x16x32_bf16 v[176:179], a[48:51], a[72:75], v[176:179]
 ds_read_b128 a[120:123], v4 offset:47104
 v_mfma_f32_16x16x32_bf16 v[168:171], a[48:51], a[80:83], v[168:171]
 s_add_u32 m0, s29, 28672
 v_mfma_f32_16x16x32_bf16 v[168:171], a[52:55], a[84:87], v[168:171]
 buffer_load_dwordx4 v1, s[4:7], s47 offen  lds
 v_mfma_f32_16x16x32_bf16 v[160:163], a[52:55], a[92:95], v[160:163]
 v_add_u32 v1, 128, v1
 v_add_u32 v2, 0x80000, v2
 v_mfma_f32_16x16x32_bf16 v[160:163], a[48:51], a[88:91], v[160:163]
 ds_read_b64_tr_b16 a[8:9], v7 offset:32768
 v_mfma_f32_16x16x32_bf16 v[164:167], a[56:59], a[88:91], v[164:167]
 buffer_load_dword a243, v14, s[36:39], s56 offen
 v_mfma_f32_16x16x32_bf16 v[164:167], a[60:63], a[92:95], v[164:167]
 s_add_u32 s56, s56, s30
 ds_read_b64_tr_b16 a[10:11], v7 offset:36864
 v_mfma_f32_16x16x32_bf16 v[172:175], a[60:63], a[84:87], v[172:175]
 ds_read_b64_tr_b16 a[12:13], v7 offset:49152
 v_mfma_f32_16x16x32_bf16 v[172:175], a[56:59], a[80:83], v[172:175]
 ds_read_b64_tr_b16 a[14:15], v7 offset:53248
 v_mfma_f32_16x16x32_bf16 v[180:183], a[56:59], a[72:75], v[180:183]
 ds_read_b64_tr_b16 a[16:17], v8 offset:32768
 v_mfma_f32_16x16x32_bf16 v[180:183], a[60:63], a[76:79], v[180:183]
 ds_read_b64_tr_b16 a[18:19], v8 offset:36864
 v_mfma_f32_16x16x32_bf16 v[188:191], a[60:63], a[68:71], v[188:191]
 ds_read_b64_tr_b16 a[20:21], v8 offset:49152
 v_mfma_f32_16x16x32_bf16 v[188:191], a[56:59], a[64:67], v[188:191]
 s_waitcnt lgkmcnt(8)
 ds_read_b64_tr_b16 a[22:23], v8 offset:53248
L_kloop_mid:
 v_mfma_f32_16x16x32_bf16 a[232:235], a[0:3], a[96:99], a[232:235]
 ds_read_b64_tr_b16 a[24:25], v9 offset:32768
 v_mfma_f32_16x16x32_bf16 a[232:235], a[4:7], a[100:103], a[232:235]
 ds_read_b64_tr_b16 a[26:27], v9 offset:36864
 v_mfma_f32_16x16x32_bf16 a[224:227], a[4:7], a[108:111], a[224:227]
 ds_read_b64_tr_b16 a[28:29], v9 offset:49152
 v_mfma_f32_16x16x32_bf16 a[224:227], a[0:3], a[104:107], a[224:227]
 ds_read_b64_tr_b16 a[30:31], v9 offset:53248
 v_mfma_f32_16x16x32_bf16 v[24:27], a[0:3], a[112:115], v[24:27]
 ds_read_b128 a[64:67], v4 offset:32768
 v_mfma_f32_16x16x32_bf16 v[24:27], a[4:7], a[116:119], v[24:27]
 v_mfma_f32_16x16x32_bf16 v[16:19], a[4:7], a[124:127], v[16:19]
 s_waitcnt lgkmcnt(8)
 ds_read_b128 a[68:71], v5 offset:32768
 v_mfma_f32_16x16x32_bf16 v[16:19], a[0:3], a[120:123], v[16:19]
 v_mfma_f32_16x16x32_bf16 v[20:23], a[8:11], a[120:123], v[20:23]
 ds_read_b128 a[76:79], v5 offset:34816
 v_mfma_f32_16x16x32_bf16 v[20:23], a[12:15], a[124:127], v[20:23]
 v_mfma_f32_16x16x32_bf16 v[28:31], a[12:15], a[116:119], v[28:31]
 ds_read_b128 a[72:75], v4 offset:34816
 v_mfma_f32_16x16x32_bf16 v[28:31], a[8:11], a[112:115], v[28:31]
 v_mfma_f32_16x16x32_bf16 a[228:231], a[8:11], a[104:107], a[228:231]
 ds_read_b128 a[80:83], v4 offset:36864
 v_mfma_f32_16x16x32_bf16 a[228:231], a[12:15], a[108:111], a[228:231]
 v_mfma_f32_16x16x32_bf16 a[236:239], a[12:15], a[100:103], a[236:239]
 ds_read_b128 a[84:87], v5 offset:36864
 v_mfma_f32_16x16x32_bf16 a[236:239], a[8:11], a[96:99], a[236:239]
 s_waitcnt lgkmcnt(8)
 v_mfma_f32_16x16x32_bf16 v[56:59], a[16:19], a[96:99], v[56:59]
 ds_read_b128 a[92:95], v5 offset:38912
 v_mfma_f32_16x16x32_bf16 v[56:59], a[20:23], a[100:103], v[56:59]
 v_mfma_f32_16x16x32_bf16 v[48:51], a[20:23], a[108:111], v[48:51]
 ds_read_b128 a[88:91], v4 offset:38912
 v_mfma_f32_16x16x32_bf16 v[48:51], a[16:19], a[104:107], v[48:51]
 v_mfma_f32_16x16x32_bf16 v[40:43], a[16:19], a[112:115], v[40:43]
 ds_read_b64_tr_b16 a[32:33], v10 offset:32768
 v_mfma_f32_16x16x32_bf16 v[40:43], a[20:23], a[116:119], v[40:43]
 ds_read_b64_tr_b16 a[34:35], v10 offset:36864
 v_mfma_f32_16x16x32_bf16 v[32:35], a[20:23], a[124:127], v[32:35]
 ds_read_b64_tr_b16 a[36:37], v10 offset:49152
 v_mfma_f32_16x16x32_bf16 v[32:35], a[16:19], a[120:123], v[32:35]
 ds_read_b64_tr_b16 a[38:39], v10 offset:53248
 v_mfma_f32_16x16x32_bf16 v[36:39], a[24:27], a[120:123], v[36:39]
 s_waitcnt lgkmcnt(8)
 ds_read_b64_tr_b16 a[40:41], v11 offset:32768
 v_mfma_f32_16x16x32_bf16 v[36:39], a[28:31], a[124:127], v[36:39]
 ds_read_b64_tr_b16 a[42:43], v11 offset:36864
 v_mfma_f32_16x16x32_bf16 v[44:47], a[28:31], a[116:119], v[44:47]
 ds_read_b64_tr_b16 a[44:45], v11 offset:49152
 v_mfma_f32_16x16x32_bf16 v[44:47], a[24:27], a[112:115], v[44:47]
 ds_read_b64_tr_b16 a[46:47], v11 offset:53248
 v_mfma_f32_16x16x32_bf16 v[52:55], a[24:27], a[104:107], v[52:55]
 ds_read_b64_tr_b16 a[48:49], v12 offset:32768
 v_mfma_f32_16x16x32_bf16 v[52:55], a[28:31], a[108:111], v[52:55]
 ds_read_b64_tr_b16 a[50:51], v12 offset:36864
 v_mfma_f32_16x16x32_bf16 v[60:63], a[28:31], a[100:103], v[60:63]
 ds_read_b64_tr_b16 a[52:53], v12 offset:49152
 v_mfma_f32_16x16x32_bf16 v[60:63], a[24:27], a[96:99], v[60:63]
 ds_read_b64_tr_b16 a[54:55], v12 offset:53248
 v_mfma_f32_16x16x32_bf16 v[88:91], a[0:3], a[64:67], v[88:91]
 ds_read_b64_tr_b16 a[56:57], v13 offset:32768
 v_mfma_f32_16x16x32_bf16 v[88:91], a[4:7], a[68:71], v[88:91]
 ds_read_b64_tr_b16 a[58:59], v13 offset:36864
 v_mfma_f32_16x16x32_bf16 v[80:83], a[4:7], a[76:79], v[80:83]
 ds_read_b64_tr_b16 a[60:61], v13 offset:49152
 v_mfma_f32_16x16x32_bf16 v[80:83], a[0:3], a[72:75], v[80:83]
 s_waitcnt lgkmcnt(8)
 ds_read_b64_tr_b16 a[62:63], v13 offset:53248
 v_mfma_f32_16x16x32_bf16 v[72:75], a[0:3], a[80:83], v[72:75]
 v_mfma_f32_16x16x32_bf16 v[72:75], a[4:7], a[84:87], v[72:75]
 v_mfma_f32_16x16x32_bf16 v[64:67], a[4:7], a[92:95], v[64:67]
 v_mfma_f32_16x16x32_bf16 v[64:67], a[0:3], a[88:91], v[64:67]
 s_waitcnt lgkmcnt(0)
 v_mfma_f32_16x16x32_bf16 v[68:71], a[8:11], a[88:91], v[68:71]
 s_barrier
 v_mfma_f32_16x16x32_bf16 v[68:71], a[12:15], a[92:95], v[68:71]
 s_add_u32 m0, s29, 98304
 v_mfma_f32_16x16x32_bf16 v[76:79], a[12:15], a[84:87], v[76:79]
 buffer_load_dwordx4 v2, s[8:11], 0 offen  lds
 v_mfma_f32_16x16x32_bf16 v[76:79], a[8:11], a[80:83], v[76:79]
 v_mfma_f32_16x16x32_bf16 v[84:87], a[8:11], a[72:75], v[84:87]
 v_mfma_f32_16x16x32_bf16 v[84:87], a[12:15], a[76:79], v[84:87]
 v_mfma_f32_16x16x32_bf16 v[92:95], a[12:15], a[68:71], v[92:95]
 s_add_u32 m0, s29, 32768
 v_mfma_f32_16x16x32_bf16 v[92:95], a[8:11], a[64:67], v[92:95]
 buffer_load_dwordx4 v1, s[4:7], 0 offen  lds
 v_mfma_f32_16x16x32_bf16 v[120:123], a[16:19], a[64:67], v[120:123]
 v_mfma_f32_16x16x32_bf16 v[120:123], a[20:23], a[68:71], v[120:123]
 v_mfma_f32_16x16x32_bf16 v[112:115], a[20:23], a[76:79], v[112:115]
 v_mfma_f32_16x16x32_bf16 v[112:115], a[16:19], a[72:75], v[112:115]
 s_add_u32 m0, s29, 102400
 v_mfma_f32_16x16x32_bf16 v[104:107], a[16:19], a[80:83], v[104:107]
 buffer_load_dwordx4 v2, s[8:11], s48 offen  lds
 v_mfma_f32_16x16x32_bf16 v[104:107], a[20:23], a[84:87], v[104:107]
 v_mfma_f32_16x16x32_bf16 v[96:99], a[20:23], a[92:95], v[96:99]
 v_mfma_f32_16x16x32_bf16 v[96:99], a[16:19], a[88:91], v[96:99]
 v_mfma_f32_16x16x32_bf16 v[100:103], a[24:27], a[88:91], v[100:103]
 s_add_u32 m0, s29, 36864
 v_mfma_f32_16x16x32_bf16 v[100:103], a[28:31], a[92:95], v[100:103]
 buffer_load_dwordx4 v1, s[4:7], s41 offen  lds
 v_mfma_f32_16x16x32_bf16 v[108:111], a[28:31], a[84:87], v[108:111]
 v_mfma_f32_16x16x32_bf16 v[108:111], a[24:27], a[80:83], v[108:111]
 v_mfma_f32_16x16x32_bf16 v[116:119], a[24:27], a[72:75], v[116:119]
 v_mfma_f32_16x16x32_bf16 v[116:119], a[28:31], a[76:79], v[116:119]
 s_add_u32 m0, s29, 106496
 v_mfma_f32_16x16x32_bf16 v[124:127], a[28:31], a[68:71], v[124:127]
 buffer_load_dwordx4 v2, s[8:11], s49 offen  lds
 v_mfma_f32_16x16x32_bf16 v[124:127], a[24:27], a[64:67], v[124:127]
 v_mfma_f32_16x16x32_bf16 v[152:155], a[32:35], a[64:67], v[152:155]
 v_mfma_f32_16x16x32_bf16 v[152:155], a[36:39], a[68:71], v[152:155]
 v_mfma_f32_16x16x32_bf16 v[144:147], a[36:39], a[76:79], v[144:147]
 s_add_u32 m0, s29, 40960
 v_mfma_f32_16x16x32_bf16 v[144:147], a[32:35], a[72:75], v[144:147]
 buffer_load_dwordx4 v1, s[4:7], s42 offen  lds
 v_mfma_f32_16x16x32_bf16 v[136:139], a[32:35], a[80:83], v[136:139]
 v_mfma_f32_16x16x32_bf16 v[136:139], a[36:39], a[84:87], v[136:139]
 v_mfma_f32_16x16x32_bf16 v[128:131], a[36:39], a[92:95], v[128:131]
 v_mfma_f32_16x16x32_bf16 v[128:131], a[32:35], a[88:91], v[128:131]
 s_add_u32 m0, s29, 110592
 v_mfma_f32_16x16x32_bf16 v[132:135], a[40:43], a[88:91], v[132:135]
 buffer_load_dwordx4 v2, s[8:11], s50 offen  lds
 v_mfma_f32_16x16x32_bf16 v[132:135], a[44:47], a[92:95], v[132:135]
 v_mfma_f32_16x16x32_bf16 v[140:143], a[44:47], a[84:87], v[140:143]
 v_mfma_f32_16x16x32_bf16 v[140:143], a[40:43], a[80:83], v[140:143]
 v_mfma_f32_16x16x32_bf16 v[148:151], a[40:43], a[72:75], v[148:151]
 s_add_u32 m0, s29, 45056
 v_mfma_f32_16x16x32_bf16 v[148:151], a[44:47], a[76:79], v[148:151]
 buffer_load_dwordx4 v1, s[4:7], s43 offen  lds
 v_mfma_f32_16x16x32_bf16 v[156:159], a[44:47], a[68:71], v[156:159]
 v_mfma_f32_16x16x32_bf16 v[156:159], a[40:43], a[64:67], v[156:159]
 v_mfma_f32_16x16x32_bf16 v[184:187], a[48:51], a[64:67], v[184:187]
 v_mfma_f32_16x16x32_bf16 v[184:187], a[52:55], a[68:71], v[184:187]
 s_add_u32 m0, s29, 114688
 v_mfma_f32_16x16x32_bf16 v[176:179], a[52:55], a[76:79], v[176:179]
 buffer_load_dwordx4 v2, s[8:11], s51 offen  lds
 v_mfma_f32_16x16x32_bf16 v[176:179], a[48:51], a[72:75], v[176:179]
 v_mfma_f32_16x16x32_bf16 v[168:171], a[48:51], a[80:83], v[168:171]
 v_mfma_f32_16x16x32_bf16 v[168:171], a[52:55], a[84:87], v[168:171]
 v_mfma_f32_16x16x32_bf16 v[160:163], a[52:55], a[92:95], v[160:163]
 s_add_u32 m0, s29, 49152
 v_mfma_f32_16x16x32_bf16 v[160:163], a[48:51], a[88:91], v[160:163]
 buffer_load_dwordx4 v1, s[4:7], s44 offen  lds
 v_mfma_f32_16x16x32_bf16 v[164:167], a[56:59], a[88:91], v[164:167]
 v_mfma_f32_16x16x32_bf16 v[164:167], a[60:63], a[92:95], v[164:167]
 v_mfma_f32_16x16x32_bf16 v[172:175], a[60:63], a[84:87], v[172:175]
 v_mfma_f32_16x16x32_bf16 v[172:175], a[56:59], a[80:83], v[172:175]
 s_add_u32 m0, s29, 118784
 v_mfma_f32_16x16x32_bf16 v[180:183], a[56:59], a[72:75], v[180:183]
 s_waitcnt vmcnt(11)
 buffer_load_dwordx4 v2, s[8:11], s52 offen  lds
 v_mfma_f32_16x16x32_bf16 v[180:183], a[60:63], a[76:79], v[180:183]
 s_barrier
 ds_read_b64_tr_b16 a[0:1], v6 offset:0
 v_mfma_f32_16x16x32_bf16 v[188:191], a[60:63], a[68:71], v[188:191]
 ds_read_b64_tr_b16 a[2:3], v6 offset:4096
 v_mfma_f32_16x16x32_bf16 v[188:191], a[56:59], a[64:67], v[188:191]
 ds_read_b128 a[64:67], v4 offset:0
 v_mfma_f32_16x16x32_bf16 v[216:219], a[32:35], a[96:99], v[216:219]
 s_add_u32 m0, s29, 53248
 v_mfma_f32_16x16x32_bf16 v[216:219], a[36:39], a[100:103], v[216:219]
 buffer_load_dwordx4 v1, s[4:7], s45 offen  lds
 v_mfma_f32_16x16x32_bf16 v[208:211], a[36:39], a[108:111], v[208:211]
 ds_read_b64_tr_b16 a[4:5], v6 offset:16384
 v_mfma_f32_16x16x32_bf16 v[208:211], a[32:35], a[104:107], v[208:211]
 ds_read_b64_tr_b16 a[6:7], v6 offset:20480
 v_mfma_f32_16x16x32_bf16 v[200:203], a[32:35], a[112:115], v[200:203]
 ds_read_b128 a[68:71], v5 offset:0
 v_mfma_f32_16x16x32_bf16 v[200:203], a[36:39], a[116:119], v[200:203]
 s_add_u32 m0, s29, 122880
 v_mfma_f32_16x16x32_bf16 v[192:195], a[36:39], a[124:127], v[192:195]
 buffer_load_dwordx4 v2, s[8:11], s53 offen  lds
 v_mfma_f32_16x16x32_bf16 v[192:195], a[32:35], a[120:123], v[192:195]
 ds_read_b128 a[76:79], v5 offset:2048
 v_mfma_f32_16x16x32_bf16 v[196:199], a[40:43], a[120:123], v[196:199]
 v_mfma_f32_16x16x32_bf16 v[196:199], a[44:47], a[124:127], v[196:199]
 ds_read_b128 a[72:75], v4 offset:2048
 v_mfma_f32_16x16x32_bf16 v[204:207], a[44:47], a[116:119], v[204:207]
 s_add_u32 m0, s29, 57344
 v_mfma_f32_16x16x32_bf16 v[204:207], a[40:43], a[112:115], v[204:207]
 buffer_load_dwordx4 v1, s[4:7], s46 offen  lds
 v_mfma_f32_16x16x32_bf16 v[212:215], a[40:43], a[104:107], v[212:215]
 ds_read_b128 a[80:83], v4 offset:4096
 v_mfma_f32_16x16x32_bf16 v[212:215], a[44:47], a[108:111], v[212:215]
 v_mfma_f32_16x16x32_bf16 v[220:223], a[44:47], a[100:103], v[220:223]
 ds_read_b128 a[84:87], v5 offset:4096
 v_mfma_f32_16x16x32_bf16 v[220:223], a[40:43], a[96:99], v[220:223]
 s_add_u32 m0, s29, 126976
 v_mfma_f32_16x16x32_bf16 v[248:251], a[48:51], a[96:99], v[248:251]
 buffer_load_dwordx4 v2, s[8:11], s54 offen  lds
 v_mfma_f32_16x16x32_bf16 v[248:251], a[52:55], a[100:103], v[248:251]
 ds_read_b128 a[92:95], v5 offset:6144
 v_mfma_f32_16x16x32_bf16 v[240:243], a[52:55], a[108:111], v[240:243]
 v_mfma_f32_16x16x32_bf16 v[240:243], a[48:51], a[104:107], v[240:243]
 ds_read_b128 a[88:91], v4 offset:6144
 v_mfma_f32_16x16x32_bf16 v[232:235], a[48:51], a[112:115], v[232:235]
 s_add_u32 m0, s29, 61440
 v_mfma_f32_16x16x32_bf16 v[232:235], a[52:55], a[116:119], v[232:235]
 buffer_load_dwordx4 v1, s[4:7], s47 offen  lds
 v_mfma_f32_16x16x32_bf16 v[224:227], a[52:55], a[124:127], v[224:227]
 v_add_u32 v1, 128, v1
 v_add_u32 v2, 0x80000, v2
 v_mfma_f32_16x16x32_bf16 v[224:227], a[48:51], a[120:123], v[224:227]
 ds_read_b64_tr_b16 a[8:9], v7 offset:0
 v_mfma_f32_16x16x32_bf16 v[228:231], a[56:59], a[120:123], v[228:231]
 buffer_load_dword a243, v14, s[36:39], s56 offen
 v_mfma_f32_16x16x32_bf16 v[228:231], a[60:63], a[124:127], v[228:231]
 s_add_u32 s56, s56, s30
 ds_read_b64_tr_b16 a[10:11], v7 offset:4096
 v_mfma_f32_16x16x32_bf16 v[236:239], a[60:63], a[116:119], v[236:239]
 ds_read_b64_tr_b16 a[12:13], v7 offset:16384
 v_mfma_f32_16x16x32_bf16 v[236:239], a[56:59], a[112:115], v[236:239]
 ds_read_b64_tr_b16 a[14:15], v7 offset:20480
 v_mfma_f32_16x16x32_bf16 v[244:247], a[56:59], a[104:107], v[244:247]
 ds_read_b64_tr_b16 a[16:17], v8 offset:0
 v_mfma_f32_16x16x32_bf16 v[244:247], a[60:63], a[108:111], v[244:247]
 s_add_u32 s61, s61, 1
 ds_read_b64_tr_b16 a[18:19], v8 offset:4096
 v_mfma_f32_16x16x32_bf16 v[252:255], a[60:63], a[100:103], v[252:255]
 s_cmp_lt_u32 s61, s55
 ds_read_b64_tr_b16 a[20:21], v8 offset:16384
 v_mfma_f32_16x16x32_bf16 v[252:255], a[56:59], a[96:99], v[252:255]
 s_waitcnt lgkmcnt(8)
 ds_read_b64_tr_b16 a[22:23], v8 offset:20480
 s_cbranch_scc1 L_kloop
 s_cmp_lt_u32 s61, 6
 s_cbranch_scc1 L_kloop_side
 v_mfma_f32_16x16x32_bf16 v[88:91], a[0:3], a[64:67], v[88:91]
 ds_read_b64_tr_b16 a[24:25], v9 offset:0
 v_accvgpr_read_b32 v15, a240
 v_mfma_f32_16x16x32_bf16 v[88:91], a[4:7], a[68:71], v[88:91]
 ds_read_b64_tr_b16 a[26:27], v9 offset:4096
 v_accvgpr_read_b32 v14, a242
 v_mfma_f32_16x16x32_bf16 v[80:83], a[4:7], a[76:79], v[80:83]
 s_waitcnt lgkmcnt(12)
 ds_read_b64_tr_b16 a[28:29], v9 offset:16384
 v_xor_b32 v3, 64, v14
 v_mfma_f32_16x16x32_bf16 v[80:83], a[0:3], a[72:75], v[80:83]
 ds_read_b64_tr_b16 a[30:31], v9 offset:20480
 v_mfma_f32_16x16x32_bf16 v[72:75], a[0:3], a[80:83], v[72:75]
 s_add_u32 m0, s33, 0x0
 ds_read_b128 a[96:99], v4 offset:8192
 v_mfma_f32_16x16x32_bf16 v[72:75], a[4:7], a[84:87], v[72:75]
 s_waitcnt lgkmcnt(11)
 v_mfma_f32_16x16x32_bf16 v[64:67], a[4:7], a[92:95], v[64:67]
 ds_read_b128 a[100:103], v5 offset:8192
 buffer_load_dwordx4 v15, s[20:23], 0 offen offset:0 lds
 v_mfma_f32_16x16x32_bf16 v[64:67], a[0:3], a[88:91], v[64:67]
 v_mfma_f32_16x16x32_bf16 v[68:71], a[8:11], a[88:91], v[68:71]
 s_waitcnt lgkmcnt(10)
 ds_read_b128 a[108:111], v5 offset:10240
 v_mfma_f32_16x16x32_bf16 v[68:71], a[12:15], a[92:95], v[68:71]
 s_add_u32 m0, s33, 0x80
 v_mfma_f32_16x16x32_bf16 v[76:79], a[12:15], a[84:87], v[76:79]
 ds_read_b128 a[104:107], v4 offset:10240
 buffer_load_dwordx4 v15, s[20:23], 0 offen offset:896 lds
 v_mfma_f32_16x16x32_bf16 v[76:79], a[8:11], a[80:83], v[76:79]
 v_mfma_f32_16x16x32_bf16 v[84:87], a[8:11], a[72:75], v[84:87]
 ds_read_b128 a[112:115], v4 offset:12288
 v_mfma_f32_16x16x32_bf16 v[84:87], a[12:15], a[76:79], v[84:87]
 s_add_u32 m0, s33, 0x800
 v_mfma_f32_16x16x32_bf16 v[92:95], a[12:15], a[68:71], v[92:95]
 ds_read_b128 a[116:119], v5 offset:12288
 buffer_load_dwordx4 v15, s[20:23], s57 offen offset:0 lds
 v_mfma_f32_16x16x32_bf16 v[92:95], a[8:11], a[64:67], v[92:95]
 s_waitcnt lgkmcnt(10)
 v_mfma_f32_16x16x32_bf16 v[120:123], a[16:19], a[64:67], v[120:123]
 ds_read_b128 a[124:127], v5 offset:14336
 v_mfma_f32_16x16x32_bf16 v[120:123], a[20:23], a[68:71], v[120:123]
 s_add_u32 m0, s33, 0x880
 v_mfma_f32_16x16x32_bf16 v[112:115], a[20:23], a[76:79], v[112:115]
 ds_read_b128 a[120:123], v4 offset:14336
 buffer_load_dwordx4 v15, s[20:23], s57 offen offset:896 lds
 v_mfma_f32_16x16x32_bf16 v[112:115], a[16:19], a[72:75], v[112:115]
 v_mfma_f32_16x16x32_bf16 v[104:107], a[16:19], a[80:83], v[104:107]
 ds_read_b64_tr_b16 a[32:33], v10 offset:0
 v_mfma_f32_16x16x32_bf16 v[104:107], a[20:23], a[84:87], v[104:107]
 s_add_u32 m0, s33, 0xf80
 ds_read_b64_tr_b16 a[34:35], v10 offset:4096
 v_mfma_f32_16x16x32_bf16 v[96:99], a[20:23], a[92:95], v[96:99]
 ds_read_b64_tr_b16 a[36:37], v10 offset:16384
 buffer_load_dwordx4 v15, s[20:23], 0 offen offset:128 lds
 v_mfma_f32_16x16x32_bf16 v[96:99], a[16:19], a[88:91], v[96:99]
 s_waitcnt lgkmcnt(11)
 ds_read_b64_tr_b16 a[38:39], v10 offset:20480
 v_mfma_f32_16x16x32_bf16 v[100:103], a[24:27], a[88:91], v[100:103]
 ds_read_b64_tr_b16 a[40:41], v11 offset:0
 v_mfma_f32_16x16x32_bf16 v[100:103], a[28:31], a[92:95], v[100:103]
 s_add_u32 m0, s33, 0x1000
 ds_read_b64_tr_b16 a[42:43], v11 offset:4096
 v_mfma_f32_16x16x32_bf16 v[108:111], a[28:31], a[84:87], v[108:111]
 ds_read_b64_tr_b16 a[44:45], v11 offset:16384
 buffer_load_dwordx4 v15, s[20:23], 0 offen offset:1024 lds
 v_mfma_f32_16x16x32_bf16 v[108:111], a[24:27], a[80:83], v[108:111]
 ds_read_b64_tr_b16 a[46:47], v11 offset:20480
 v_mfma_f32_16x16x32_bf16 v[116:119], a[24:27], a[72:75], v[116:119]
 ds_read_b64_tr_b16 a[48:49], v12 offset:0
 v_mfma_f32_16x16x32_bf16 v[116:119], a[28:31], a[76:79], v[116:119]
 s_add_u32 m0, s33, 0x1780
 ds_read_b64_tr_b16 a[50:51], v12 offset:4096
 v_mfma_f32_16x16x32_bf16 v[124:127], a[28:31], a[68:71], v[124:127]
 ds_read_b64_tr_b16 a[52:53], v12 offset:16384
 buffer_load_dwordx4 v15, s[20:23], s57 offen offset:128 lds
 v_mfma_f32_16x16x32_bf16 v[124:127], a[24:27], a[64:67], v[124:127]
 s_waitcnt lgkmcnt(15)
 ds_read_b64_tr_b16 a[54:55], v12 offset:20480
 v_mfma_f32_16x16x32_bf16 a[232:235], a[0:3], a[96:99], a[232:235]
 ds_read_b64_tr_b16 a[56:57], v13 offset:0
 v_mfma_f32_16x16x32_bf16 a[232:235], a[4:7], a[100:103], a[232:235]
 s_add_u32 m0, s33, 0x1800
 ds_read_b64_tr_b16 a[58:59], v13 offset:4096
 v_mfma_f32_16x16x32_bf16 a[224:227], a[4:7], a[108:111], a[224:227]
 ds_read_b64_tr_b16 a[60:61], v13 offset:16384
 buffer_load_dwordx4 v15, s[20:23], s57 offen offset:1024 lds
 v_mfma_f32_16x16x32_bf16 a[224:227], a[0:3], a[104:107], a[224:227]
 s_waitcnt lgkmcnt(15)
 ds_read_b64_tr_b16 a[62:63], v13 offset:20480
 v_mfma_f32_16x16x32_bf16 v[24:27], a[0:3], a[112:115], v[24:27]
 v_mfma_f32_16x16x32_bf16 v[24:27], a[4:7], a[116:119], v[24:27]
 v_mfma_f32_16x16x32_bf16 v[16:19], a[4:7], a[124:127], v[16:19]
 v_mfma_f32_16x16x32_bf16 v[16:19], a[0:3], a[120:123], v[16:19]
 s_waitcnt lgkmcnt(0)
 v_mfma_f32_16x16x32_bf16 v[20:23], a[8:11], a[120:123], v[20:23]
 s_barrier
 v_mfma_f32_16x16x32_bf16 v[20:23], a[12:15], a[124:127], v[20:23]
 s_add_u32 m0, s29, 65536
 v_mfma_f32_16x16x32_bf16 v[28:31], a[12:15], a[116:119], v[28:31]
 buffer_load_dwordx4 v2, s[8:11], 0 offen  lds
 v_mfma_f32_16x16x32_bf16 v[28:31], a[8:11], a[112:115], v[28:31]
 v_mfma_f32_16x16x32_bf16 a[228:231], a[8:11], a[104:107], a[228:231]
 v_mfma_f32_16x16x32_bf16 a[228:231], a[12:15], a[108:111], a[228:231]
 v_mfma_f32_16x16x32_bf16 a[236:239], a[12:15], a[100:103], a[236:239]
 s_add_u32 m0, s29, 0
 v_mfma_f32_16x16x32_bf16 a[236:239], a[8:11], a[96:99], a[236:239]
 buffer_load_dwordx4 v1, s[4:7], 0 offen  lds
 v_mfma_f32_16x16x32_bf16 v[56:59], a[16:19], a[96:99], v[56:59]
 v_mfma_f32_16x16x32_bf16 v[56:59], a[20:23], a[100:103], v[56:59]
 v_mfma_f32_16x16x32_bf16 v[48:51], a[20:23], a[108:111], v[48:51]
 v_mfma_f32_16x16x32_bf16 v[48:51], a[16:19], a[104:107], v[48:51]
 s_add_u32 m0, s29, 69632
 v_mfma_f32_16x16x32_bf16 v[40:43], a[16:19], a[112:115], v[40:43]
 buffer_load_dwordx4 v2, s[8:11], s48 offen  lds
 v_mfma_f32_16x16x32_bf16 v[40:43], a[20:23], a[116:119], v[40:43]
 v_mfma_f32_16x16x32_bf16 v[32:35], a[20:23], a[124:127], v[32:35]
 v_mfma_f32_16x16x32_bf16 v[32:35], a[16:19], a[120:123], v[32:35]
 v_mfma_f32_16x16x32_bf16 v[36:39], a[24:27], a[120:123], v[36:39]
 s_add_u32 m0, s29, 4096
 v_mfma_f32_16x16x32_bf16 v[36:39], a[28:31], a[124:127], v[36:39]
 buffer_load_dwordx4 v1, s[4:7], s41 offen  lds
 v_mfma_f32_16x16x32_bf16 v[44:47], a[28:31], a[116:119], v[44:47]
 v_mfma_f32_16x16x32_bf16 v[44:47], a[24:27], a[112:115], v[44:47]
 v_mfma_f32_16x16x32_bf16 v[52:55], a[24:27], a[104:107], v[52:55]
 v_mfma_f32_16x16x32_bf16 v[52:55], a[28:31], a[108:111], v[52:55]
 s_add_u32 m0, s29, 73728
 v_mfma_f32_16x16x32_bf16 v[60:63], a[28:31], a[100:103], v[60:63]
 buffer_load_dwordx4 v2, s[8:11], s49 offen  lds
 v_mfma_f32_16x16x32_bf16 v[60:63], a[24:27], a[96:99], v[60:63]
 v_mfma_f32_16x16x32_bf16 v[216:219], a[32:35], a[96:99], v[216:219]
 v_mfma_f32_16x16x32_bf16 v[216:219], a[36:39], a[100:103], v[216:219]
 v_mfma_f32_16x16x32_bf16 v[208:211], a[36:39], a[108:111], v[208:211]
 s_add_u32 m0, s29, 8192
 v_mfma_f32_16x16x32_bf16 v[208:211], a[32:35], a[104:107], v[208:211]
 buffer_load_dwordx4 v1, s[4:7], s42 offen  lds
 v_mfma_f32_16x16x32_bf16 v[200:203], a[32:35], a[112:115], v[200:203]
 v_mfma_f32_16x16x32_bf16 v[200:203], a[36:39], a[116:119], v[200:203]
 v_mfma_f32_16x16x32_bf16 v[192:195], a[36:39], a[124:127], v[192:195]
 v_mfma_f32_16x16x32_bf16 v[192:195], a[32:35], a[120:123], v[192:195]
 s_add_u32 m0, s29, 77824
 v_mfma_f32_16x16x32_bf16 v[196:199], a[40:43], a[120:123], v[196:199]
 buffer_load_dwordx4 v2, s[8:11], s50 offen  lds
 v_mfma_f32_16x16x32_bf16 v[196:199], a[44:47], a[124:127], v[196:199]
 v_mfma_f32_16x16x32_bf16 v[204:207], a[44:47], a[116:119], v[204:207]
 v_mfma_f32_16x16x32_bf16 v[204:207], a[40:43], a[112:115], v[204:207]
 v_mfma_f32_16x16x32_bf16 v[212:215], a[40:43], a[104:107], v[212:215]
 s_add_u32 m0, s29, 12288
 v_mfma_f32_16x16x32_bf16 v[212:215], a[44:47], a[108:111], v[212:215]
 buffer_load_dwordx4 v1, s[4:7], s43 offen  lds
 v_mfma_f32_16x16x32_bf16 v[220:223], a[44:47], a[100:103], v[220:223]
 v_mfma_f32_16x16x32_bf16 v[220:223], a[40:43], a[96:99], v[220:223]
 v_mfma_f32_16x16x32_bf16 v[248:251], a[48:51], a[96:99], v[248:251]
 v_mfma_f32_16x16x32_bf16 v[248:251], a[52:55], a[100:103], v[248:251]
 s_add_u32 m0, s29, 81920
 v_mfma_f32_16x16x32_bf16 v[240:243], a[52:55], a[108:111], v[240:243]
 buffer_load_dwordx4 v2, s[8:11], s51 offen  lds
 v_mfma_f32_16x16x32_bf16 v[240:243], a[48:51], a[104:107], v[240:243]
 v_mfma_f32_16x16x32_bf16 v[232:235], a[48:51], a[112:115], v[232:235]
 v_mfma_f32_16x16x32_bf16 v[232:235], a[52:55], a[116:119], v[232:235]
 v_mfma_f32_16x16x32_bf16 v[224:227], a[52:55], a[124:127], v[224:227]
 s_add_u32 m0, s29, 16384
 v_mfma_f32_16x16x32_bf16 v[224:227], a[48:51], a[120:123], v[224:227]
 buffer_load_dwordx4 v1, s[4:7], s44 offen  lds
 v_mfma_f32_16x16x32_bf16 v[228:231], a[56:59], a[120:123], v[228:231]
 v_mfma_f32_16x16x32_bf16 v[228:231], a[60:63], a[124:127], v[228:231]
 v_mfma_f32_16x16x32_bf16 v[236:239], a[60:63], a[116:119], v[236:239]
 v_mfma_f32_16x16x32_bf16 v[236:239], a[56:59], a[112:115], v[236:239]
 s_add_u32 m0, s29, 86016
 v_mfma_f32_16x16x32_bf16 v[244:247], a[56:59], a[104:107], v[244:247]
 s_waitcnt vmcnt(10)
 buffer_load_dwordx4 v2, s[8:11], s52 offen  lds
 v_mfma_f32_16x16x32_bf16 v[244:247], a[60:63], a[108:111], v[244:247]
 s_barrier
 ds_read_b64_tr_b16 a[0:1], v6 offset:32768
 v_mfma_f32_16x16x32_bf16 v[252:255], a[60:63], a[100:103], v[252:255]
 ds_read_b64_tr_b16 a[2:3], v6 offset:36864
 v_mfma_f32_16x16x32_bf16 v[252:255], a[56:59], a[96:99], v[252:255]
 ds_read_b128 a[96:99], v4 offset:40960
 v_mfma_f32_16x16x32_bf16 v[152:155], a[32:35], a[64:67], v[152:155]
 s_add_u32 m0, s29, 20480
 ds_read_b128 a[128:131], v14 offset:0
 v_mfma_f32_16x16x32_bf16 v[152:155], a[36:39], a[68:71], v[152:155]
 buffer_load_dwordx4 v1, s[4:7], s45 offen  lds
 v_mfma_f32_16x16x32_bf16 v[144:147], a[36:39], a[76:79], v[144:147]
 ds_read_b64_tr_b16 a[4:5], v6 offset:49152
 v_mfma_f32_16x16x32_bf16 v[144:147], a[32:35], a[72:75], v[144:147]
 ds_read_b64_tr_b16 a[6:7], v6 offset:53248
 v_mfma_f32_16x16x32_bf16 v[136:139], a[32:35], a[80:83], v[136:139]
 ds_read_b128 a[100:103], v5 offset:40960
 v_mfma_f32_16x16x32_bf16 v[136:139], a[36:39], a[84:87], v[136:139]
 s_add_u32 m0, s29, 90112
 ds_read_b128 a[136:139], v3 offset:0
 v_mfma_f32_16x16x32_bf16 v[128:131], a[36:39], a[92:95], v[128:131]
 buffer_load_dwordx4 v2, s[8:11], s53 offen  lds
 v_mfma_f32_16x16x32_bf16 v[128:131], a[32:35], a[88:91], v[128:131]
 ds_read_b128 a[108:111], v5 offset:43008
 v_mfma_f32_16x16x32_bf16 v[132:135], a[40:43], a[88:91], v[132:135]
 ds_read_b128 a[132:135], v14 offset:2048
 v_mfma_f32_16x16x32_bf16 v[132:135], a[44:47], a[92:95], v[132:135]
 ds_read_b128 a[104:107], v4 offset:43008
 v_mfma_f32_16x16x32_bf16 v[140:143], a[44:47], a[84:87], v[140:143]
 s_add_u32 m0, s29, 24576
 ds_read_b128 a[140:143], v3 offset:2048
 v_mfma_f32_16x16x32_bf16 v[140:143], a[40:43], a[80:83], v[140:143]
 buffer_load_dwordx4 v1, s[4:7], s46 offen  lds
 v_mfma_f32_16x16x32_bf16 v[148:151], a[40:43], a[72:75], v[148:151]
 ds_read_b128 a[112:115], v4 offset:45056
 v_mfma_f32_16x16x32_bf16 v[148:151], a[44:47], a[76:79], v[148:151]
 ds_read_b128 a[144:147], v14 offset:4096
 v_mfma_f32_16x16x32_bf16 v[156:159], a[44:47], a[68:71], v[156:159]
 ds_read_b128 a[116:119], v5 offset:45056
 v_mfma_f32_16x16x32_bf16 v[156:159], a[40:43], a[64:67], v[156:159]
 s_add_u32 m0, s29, 94208
 ds_read_b128 a[152:155], v3 offset:4096
 v_mfma_f32_16x16x32_bf16 v[184:187], a[48:51], a[64:67], v[184:187]
 buffer_load_dwordx4 v2, s[8:11], s54 offen  lds
 v_mfma_f32_16x16x32_bf16 v[184:187], a[52:55], a[68:71], v[184:187]
 ds_read_b128 a[124:127], v5 offset:47104
 v_mfma_f32_16x16x32_bf16 v[176:179], a[52:55], a[76:79], v[176:179]
 ds_read_b128 a[148:151], v14 offset:6144
 v_mfma_f32_16x16x32_bf16 v[176:179], a[48:51], a[72:75], v[176:179]
 ds_read_b128 a[120:123], v4 offset:47104
 v_mfma_f32_16x16x32_bf16 v[168:171], a[48:51], a[80:83], v[168:171]
 s_add_u32 m0, s29, 28672
 ds_read_b128 a[156:159], v3 offset:6144
 v_mfma_f32_16x16x32_bf16 v[168:171], a[52:55], a[84:87], v[168:171]
 buffer_load_dwordx4 v1, s[4:7], s47 offen  lds
 v_mfma_f32_16x16x32_bf16 v[160:163], a[52:55], a[92:95], v[160:163]
 v_add_u32 v1, 128, v1
 v_add_u32 v2, 0x80000, v2
 v_mfma_f32_16x16x32_bf16 v[160:163], a[48:51], a[88:91], v[160:163]
 ds_read_b64_tr_b16 a[8:9], v7 offset:32768
 v_mfma_f32_16x16x32_bf16 v[164:167], a[56:59], a[88:91], v[164:167]
 v_mfma_f32_16x16x32_bf16 v[164:167], a[60:63], a[92:95], v[164:167]
 ds_read_b64_tr_b16 a[10:11], v7 offset:36864
 v_mfma_f32_16x16x32_bf16 v[172:175], a[60:63], a[84:87], v[172:175]
 ds_read_b64_tr_b16 a[12:13], v7 offset:49152
 v_mfma_f32_16x16x32_bf16 v[172:175], a[56:59], a[80:83], v[172:175]
 ds_read_b64_tr_b16 a[14:15], v7 offset:53248
 v_mfma_f32_16x16x32_bf16 v[180:183], a[56:59], a[72:75], v[180:183]
 ds_read_b64_tr_b16 a[16:17], v8 offset:32768
 v_mfma_f32_16x16x32_bf16 v[180:183], a[60:63], a[76:79], v[180:183]
 ds_read_b64_tr_b16 a[18:19], v8 offset:36864
 v_mfma_f32_16x16x32_bf16 v[188:191], a[60:63], a[68:71], v[188:191]
 ds_read_b64_tr_b16 a[20:21], v8 offset:49152
 v_mfma_f32_16x16x32_bf16 v[188:191], a[56:59], a[64:67], v[188:191]
 s_waitcnt lgkmcnt(15)
 ds_read_b64_tr_b16 a[22:23], v8 offset:53248
 v_mfma_f32_16x16x32_bf16 a[232:235], a[0:3], a[96:99], a[232:235]
 ds_read_b64_tr_b16 a[24:25], v9 offset:32768
 v_mfma_f32_16x16x32_bf16 a[232:235], a[4:7], a[100:103], a[232:235]
 s_add_u32 m0, s33, 0xffffff00
 ds_read_b64_tr_b16 a[26:27], v9 offset:36864
 v_mfma_f32_16x16x32_bf16 a[224:227], a[4:7], a[108:111], a[224:227]
 s_waitcnt lgkmcnt(10)
 ds_read_b64_tr_b16 a[28:29], v9 offset:49152
 v_mfma_f32_16x16x32_bf16 a[224:227], a[0:3], a[104:107], a[224:227]
 ds_read_b64_tr_b16 a[30:31], v9 offset:53248
 buffer_load_dwordx4 v15, s[20:23], 0 offen offset:256 lds
 v_mfma_f32_16x16x32_bf16 v[24:27], a[0:3], a[112:115], v[24:27]
 ds_read_b128 a[64:67], v4 offset:32768
 v_mfma_f32_16x16x32_bf16 v[24:27], a[4:7], a[116:119], v[24:27]
 v_mfma_f32_16x16x32_bf16 v[16:19], a[4:7], a[124:127], v[16:19]
 s_add_u32 m0, s33, 0xffffff80
 ds_read_b128 a[68:71], v5 offset:32768
 v_mfma_f32_16x16x32_bf16 v[16:19], a[0:3], a[120:123], v[16:19]
 s_waitcnt lgkmcnt(10)
 buffer_load_dwordx4 v15, s[20:23], 0 offen offset:1152 lds
 v_mfma_f32_16x16x32_bf16 v[20:23], a[8:11], a[120:123], v[20:23]
 ds_read_b128 a[76:79], v5 offset:34816
 v_mfma_f32_16x16x32_bf16 v[20:23], a[12:15], a[124:127], v[20:23]
 v_mfma_f32_16x16x32_bf16 v[28:31], a[12:15], a[116:119], v[28:31]
 s_add_u32 m0, s33, 0x700
 ds_read_b128 a[72:75], v4 offset:34816
 v_mfma_f32_16x16x32_bf16 v[28:31], a[8:11], a[112:115], v[28:31]
 buffer_load_dwordx4 v15, s[20:23], s57 offen offset:256 lds
 v_mfma_f32_16x16x32_bf16 a[228:231], a[8:11], a[104:107], a[228:231]
 ds_read_b128 a[80:83], v4 offset:36864
 v_mfma_f32_16x16x32_bf16 a[228:231], a[12:15], a[108:111], a[228:231]
 v_mfma_f32_16x16x32_bf16 a[236:239], a[12:15], a[100:103], a[236:239]
 s_add_u32 m0, s33, 0x780
 ds_read_b128 a[84:87], v5 offset:36864
 v_mfma_f32_16x16x32_bf16 a[236:239], a[8:11], a[96:99], a[236:239]
 s_waitcnt lgkmcnt(10)
 buffer_load_dwordx4 v15, s[20:23], s57 offen offset:1152 lds
 v_mfma_f32_16x16x32_bf16 v[56:59], a[16:19], a[96:99], v[56:59]
 ds_read_b128 a[92:95], v5 offset:38912
 v_mfma_f32_16x16x32_bf16 v[56:59], a[20:23], a[100:103], v[56:59]
 v_mfma_f32_16x16x32_bf16 v[48:51], a[20:23], a[108:111], v[48:51]
 s_add_u32 m0, s33, 0xe80
 ds_read_b128 a[88:91], v4 offset:38912
 v_mfma_f32_16x16x32_bf16 v[48:51], a[16:19], a[104:107], v[48:51]
 buffer_load_dwordx4 v15, s[20:23], 0 offen offset:384 lds
 v_mfma_f32_16x16x32_bf16 v[40:43], a[16:19], a[112:115], v[40:43]
 ds_read_b64_tr_b16 a[32:33], v10 offset:32768
 v_mfma_f32_16x16x32_bf16 v[40:43], a[20:23], a[116:119], v[40:43]
 ds_read_b64_tr_b16 a[34:35], v10 offset:36864
 v_mfma_f32_16x16x32_bf16 v[32:35], a[20:23], a[124:127], v[32:35]
 s_add_u32 m0, s33, 0xf00
 ds_read_b64_tr_b16 a[36:37], v10 offset:49152
 v_mfma_f32_16x16x32_bf16 v[32:35], a[16:19], a[120:123], v[32:35]
 s_waitcnt lgkmcnt(11)
 ds_read_b64_tr_b16 a[38:39], v10 offset:53248
 buffer_load_dwordx4 v15, s[20:23], 0 offen offset:1280 lds
 v_mfma_f32_16x16x32_bf16 v[36:39], a[24:27], a[120:123], v[36:39]
 ds_read_b64_tr_b16 a[40:41], v11 offset:32768
 v_mfma_f32_16x16x32_bf16 v[36:39], a[28:31], a[124:127], v[36:39]
 ds_read_b64_tr_b16 a[42:43], v11 offset:36864
 v_mfma_f32_16x16x32_bf16 v[44:47], a[28:31], a[116:119], v[44:47]
 s_add_u32 m0, s33, 0x1680
 ds_read_b64_tr_b16 a[44:45], v11 offset:49152
 v_mfma_f32_16x16x32_bf16 v[44:47], a[24:27], a[112:115], v[44:47]
 ds_read_b64_tr_b16 a[46:47], v11 offset:53248
 buffer_load_dwordx4 v15, s[20:23], s57 offen offset:384 lds
 v_mfma_f32_16x16x32_bf16 v[52:55], a[24:27], a[104:107], v[52:55]
 ds_read_b64_tr_b16 a[48:49], v12 offset:32768
 v_mfma_f32_16x16x32_bf16 v[52:55], a[28:31], a[108:111], v[52:55]
 ds_read_b64_tr_b16 a[50:51], v12 offset:36864
 v_mfma_f32_16x16x32_bf16 v[60:63], a[28:31], a[100:103], v[60:63]
 s_add_u32 m0, s33, 0x1700
 ds_read_b64_tr_b16 a[52:53], v12 offset:49152
 v_mfma_f32_16x16x32_bf16 v[60:63], a[24:27], a[96:99], v[60:63]
 s_waitcnt lgkmcnt(15)
 ds_read_b64_tr_b16 a[54:55], v12 offset:53248
 buffer_load_dwordx4 v15, s[20:23], s57 offen offset:1280 lds
 v_mfma_f32_16x16x32_bf16 v[88:91], a[0:3], a[64:67], v[88:91]
 ds_read_b64_tr_b16 a[56:57], v13 offset:32768
 v_mfma_f32_16x16x32_bf16 v[88:91], a[4:7], a[68:71], v[88:91]
 ds_read_b64_tr_b16 a[58:59], v13 offset:36864
 v_mfma_f32_16x16x32_bf16 v[80:83], a[4:7], a[76:79], v[80:83]
 ds_read_b64_tr_b16 a[60:61], v13 offset:49152
 v_mfma_f32_16x16x32_bf16 v[80:83], a[0:3], a[72:75], v[80:83]
 s_waitcnt lgkmcnt(15)
 ds_read_b64_tr_b16 a[62:63], v13 offset:53248
 v_mfma_f32_16x16x32_bf16 v[72:75], a[0:3], a[80:83], v[72:75]
 v_mfma_f32_16x16x32_bf16 v[72:75], a[4:7], a[84:87], v[72:75]
 v_mfma_f32_16x16x32_bf16 v[64:67], a[4:7], a[92:95], v[64:67]
 v_mfma_f32_16x16x32_bf16 v[64:67], a[0:3], a[88:91], v[64:67]
 s_waitcnt lgkmcnt(0)
 v_mfma_f32_16x16x32_bf16 v[68:71], a[8:11], a[88:91], v[68:71]
 s_barrier
 v_mfma_f32_16x16x32_bf16 v[68:71], a[12:15], a[92:95], v[68:71]
 s_add_u32 m0, s29, 98304
 v_mfma_f32_16x16x32_bf16 v[76:79], a[12:15], a[84:87], v[76:79]
 buffer_load_dwordx4 v2, s[8:11], 0 offen  lds
 v_mfma_f32_16x16x32_bf16 v[76:79], a[8:11], a[80:83], v[76:79]
 v_mfma_f32_16x16x32_bf16 v[84:87], a[8:11], a[72:75], v[84:87]
 v_mfma_f32_16x16x32_bf16 v[84:87], a[12:15], a[76:79], v[84:87]
 v_mfma_f32_16x16x32_bf16 v[92:95], a[12:15], a[68:71], v[92:95]
 s_add_u32 m0, s29, 32768
 v_mfma_f32_16x16x32_bf16 v[92:95], a[8:11], a[64:67], v[92:95]
 buffer_load_dwordx4 v1, s[4:7], 0 offen  lds
 v_mfma_f32_16x16x32_bf16 v[120:123], a[16:19], a[64:67], v[120:123]
 v_mfma_f32_16x16x32_bf16 v[120:123], a[20:23], a[68:71], v[120:123]
 v_mfma_f32_16x16x32_bf16 v[112:115], a[20:23], a[76:79], v[112:115]
 v_mfma_f32_16x16x32_bf16 v[112:115], a[16:19], a[72:75], v[112:115]
 s_add_u32 m0, s29, 102400
 v_mfma_f32_16x16x32_bf16 v[104:107], a[16:19], a[80:83], v[104:107]
 buffer_load_dwordx4 v2, s[8:11], s48 offen  lds
 v_mfma_f32_16x16x32_bf16 v[104:107], a[20:23], a[84:87], v[104:107]
 v_mfma_f32_16x16x32_bf16 v[96:99], a[20:23], a[92:95], v[96:99]
 v_mfma_f32_16x16x32_bf16 v[96:99], a[16:19], a[88:91], v[96:99]
 v_mfma_f32_16x16x32_bf16 v[100:103], a[24:27], a[88:91], v[100:103]
 s_add_u32 m0, s29, 36864
 v_mfma_f32_16x16x32_bf16 v[100:103], a[28:31], a[92:95], v[100:103]
 buffer_load_dwordx4 v1, s[4:7], s41 offen  lds
 v_mfma_f32_16x16x32_bf16 v[108:111], a[28:31], a[84:87], v[108:111]
 v_mfma_f32_16x16x32_bf16 v[108:111], a[24:27], a[80:83], v[108:111]
 v_mfma_f32_16x16x32_bf16 v[116:119], a[24:27], a[72:75], v[116:119]
 v_mfma_f32_16x16x32_bf16 v[116:119], a[28:31], a[76:79], v[116:119]
 s_add_u32 m0, s29, 106496
 v_mfma_f32_16x16x32_bf16 v[124:127], a[28:31], a[68:71], v[124:127]
 buffer_load_dwordx4 v2, s[8:11], s49 offen  lds
 v_mfma_f32_16x16x32_bf16 v[124:127], a[24:27], a[64:67], v[124:127]
 v_mfma_f32_16x16x32_bf16 v[152:155], a[32:35], a[64:67], v[152:155]
 v_mfma_f32_16x16x32_bf16 v[152:155], a[36:39], a[68:71], v[152:155]
 v_mfma_f32_16x16x32_bf16 v[144:147], a[36:39], a[76:79], v[144:147]
 s_add_u32 m0, s29, 40960
 v_mfma_f32_16x16x32_bf16 v[144:147], a[32:35], a[72:75], v[144:147]
 buffer_load_dwordx4 v1, s[4:7], s42 offen  lds
 v_mfma_f32_16x16x32_bf16 v[136:139], a[32:35], a[80:83], v[136:139]
 v_mfma_f32_16x16x32_bf16 v[136:139], a[36:39], a[84:87], v[136:139]
 v_mfma_f32_16x16x32_bf16 v[128:131], a[36:39], a[92:95], v[128:131]
 v_mfma_f32_16x16x32_bf16 v[128:131], a[32:35], a[88:91], v[128:131]
 s_add_u32 m0, s29, 110592
 v_mfma_f32_16x16x32_bf16 v[132:135], a[40:43], a[88:91], v[132:135]
 buffer_load_dwordx4 v2, s[8:11], s50 offen  lds
 v_mfma_f32_16x16x32_bf16 v[132:135], a[44:47], a[92:95], v[132:135]
 v_mfma_f32_16x16x32_bf16 v[140:143], a[44:47], a[84:87], v[140:143]
 v_mfma_f32_16x16x32_bf16 v[140:143], a[40:43], a[80:83], v[140:143]
 v_mfma_f32_16x16x32_bf16 v[148:151], a[40:43], a[72:75], v[148:151]
 s_add_u32 m0, s29, 45056
 v_mfma_f32_16x16x32_bf16 v[148:151], a[44:47], a[76:79], v[148:151]
 buffer_load_dwordx4 v1, s[4:7], s43 offen  lds
 v_mfma_f32_16x16x32_bf16 v[156:159], a[44:47], a[68:71], v[156:159]
 v_mfma_f32_16x16x32_bf16 v[156:159], a[40:43], a[64:67], v[156:159]
 v_mfma_f32_16x16x32_bf16 v[184:187], a[48:51], a[64:67], v[184:187]
 v_mfma_f32_16x16x32_bf16 v[184:187], a[52:55], a[68:71], v[184:187]
 s_add_u32 m0, s29, 114688
 v_mfma_f32_16x16x32_bf16 v[176:179], a[52:55], a[76:79], v[176:179]
 buffer_load_dwordx4 v2, s[8:11], s51 offen  lds
 v_mfma_f32_16x16x32_bf16 v[176:179], a[48:51], a[72:75], v[176:179]
 v_mfma_f32_16x16x32_bf16 v[168:171], a[48:51], a[80:83], v[168:171]
 v_mfma_f32_16x16x32_bf16 v[168:171], a[52:55], a[84:87], v[168:171]
 v_mfma_f32_16x16x32_bf16 v[160:163], a[52:55], a[92:95], v[160:163]
 s_add_u32 m0, s29, 49152
 v_mfma_f32_16x16x32_bf16 v[160:163], a[48:51], a[88:91], v[160:163]
 buffer_load_dwordx4 v1, s[4:7], s44 offen  lds
 v_mfma_f32_16x16x32_bf16 v[164:167], a[56:59], a[88:91], v[164:167]
 v_mfma_f32_16x16x32_bf16 v[164:167], a[60:63], a[92:95], v[164:167]
 v_mfma_f32_16x16x32_bf16 v[172:175], a[60:63], a[84:87], v[172:175]
 v_mfma_f32_16x16x32_bf16 v[172:175], a[56:59], a[80:83], v[172:175]
 s_add_u32 m0, s29, 118784
 v_mfma_f32_16x16x32_bf16 v[180:183], a[56:59], a[72:75], v[180:183]
 s_waitcnt vmcnt(10)
 buffer_load_dwordx4 v2, s[8:11], s52 offen  lds
 v_mfma_f32_16x16x32_bf16 v[180:183], a[60:63], a[76:79], v[180:183]
 s_barrier
 ds_read_b64_tr_b16 a[0:1], v6 offset:0
 v_mfma_f32_16x16x32_bf16 v[188:191], a[60:63], a[68:71], v[188:191]
 ds_read_b64_tr_b16 a[2:3], v6 offset:4096
 v_mfma_f32_16x16x32_bf16 v[188:191], a[56:59], a[64:67], v[188:191]
 ds_read_b128 a[64:67], v4 offset:0
 v_mfma_f32_16x16x32_bf16 v[216:219], a[32:35], a[96:99], v[216:219]
 s_add_u32 m0, s29, 53248
 ds_read_b128 a[160:163], v14 offset:0
 v_mfma_f32_16x16x32_bf16 v[216:219], a[36:39], a[100:103], v[216:219]
 buffer_load_dwordx4 v1, s[4:7], s45 offen  lds
 v_mfma_f32_16x16x32_bf16 v[208:211], a[36:39], a[108:111], v[208:211]
 ds_read_b64_tr_b16 a[4:5], v6 offset:16384
 v_mfma_f32_16x16x32_bf16 v[208:211], a[32:35], a[104:107], v[208:211]
 ds_read_b64_tr_b16 a[6:7], v6 offset:20480
 v_mfma_f32_16x16x32_bf16 v[200:203], a[32:35], a[112:115], v[200:203]
 ds_read_b128 a[68:71], v5 offset:0
 v_mfma_f32_16x16x32_bf16 v[200:203], a[36:39], a[116:119], v[200:203]
 s_add_u32 m0, s29, 122880
 ds_read_b128 a[168:171], v3 offset:0
 v_mfma_f32_16x16x32_bf16 v[192:195], a[36:39], a[124:127], v[192:195]
 buffer_load_dwordx4 v2, s[8:11], s53 offen  lds
 v_mfma_f32_16x16x32_bf16 v[192:195], a[32:35], a[120:123], v[192:195]
 ds_read_b128 a[76:79], v5 offset:2048
 v_mfma_f32_16x16x32_bf16 v[196:199], a[40:43], a[120:123], v[196:199]
 ds_read_b128 a[164:167], v14 offset:2048
 v_mfma_f32_16x16x32_bf16 v[196:199], a[44:47], a[124:127], v[196:199]
 ds_read_b128 a[72:75], v4 offset:2048
 v_mfma_f32_16x16x32_bf16 v[204:207], a[44:47], a[116:119], v[204:207]
 s_add_u32 m0, s29, 57344
 ds_read_b128 a[172:175], v3 offset:2048
 v_mfma_f32_16x16x32_bf16 v[204:207], a[40:43], a[112:115], v[204:207]
 buffer_load_dwordx4 v1, s[4:7], s46 offen  lds
 v_mfma_f32_16x16x32_bf16 v[212:215], a[40:43], a[104:107], v[212:215]
 ds_read_b128 a[80:83], v4 offset:4096
 v_mfma_f32_16x16x32_bf16 v[212:215], a[44:47], a[108:111], v[212:215]
 ds_read_b128 a[176:179], v14 offset:4096
 v_mfma_f32_16x16x32_bf16 v[220:223], a[44:47], a[100:103], v[220:223]
 ds_read_b128 a[84:87], v5 offset:4096
 v_mfma_f32_16x16x32_bf16 v[220:223], a[40:43], a[96:99], v[220:223]
 s_add_u32 m0, s29, 126976
 ds_read_b128 a[184:187], v3 offset:4096
 v_mfma_f32_16x16x32_bf16 v[248:251], a[48:51], a[96:99], v[248:251]
 buffer_load_dwordx4 v2, s[8:11], s54 offen  lds
 v_mfma_f32_16x16x32_bf16 v[248:251], a[52:55], a[100:103], v[248:251]
 ds_read_b128 a[92:95], v5 offset:6144
 v_mfma_f32_16x16x32_bf16 v[240:243], a[52:55], a[108:111], v[240:243]
 ds_read_b128 a[180:183], v14 offset:6144
 v_mfma_f32_16x16x32_bf16 v[240:243], a[48:51], a[104:107], v[240:243]
 ds_read_b128 a[88:91], v4 offset:6144
 v_mfma_f32_16x16x32_bf16 v[232:235], a[48:51], a[112:115], v[232:235]
 s_add_u32 m0, s29, 61440
 ds_read_b128 a[188:191], v3 offset:6144
 v_mfma_f32_16x16x32_bf16 v[232:235], a[52:55], a[116:119], v[232:235]
 buffer_load_dwordx4 v1, s[4:7], s47 offen  lds
 v_mfma_f32_16x16x32_bf16 v[224:227], a[52:55], a[124:127], v[224:227]
 v_add_u32 v1, 128, v1
 v_add_u32 v2, 0x80000, v2
 v_mfma_f32_16x16x32_bf16 v[224:227], a[48:51], a[120:123], v[224:227]
 ds_read_b64_tr_b16 a[8:9], v7 offset:0
 v_mfma_f32_16x16x32_bf16 v[228:231], a[56:59], a[120:123], v[228:231]
 v_mfma_f32_16x16x32_bf16 v[228:231], a[60:63], a[124:127], v[228:231]
 ds_read_b64_tr_b16 a[10:11], v7 offset:4096
 v_mfma_f32_16x16x32_bf16 v[236:239], a[60:63], a[116:119], v[236:239]
 ds_read_b64_tr_b16 a[12:13], v7 offset:16384
 v_mfma_f32_16x16x32_bf16 v[236:239], a[56:59], a[112:115], v[236:239]
 ds_read_b64_tr_b16 a[14:15], v7 offset:20480
 v_mfma_f32_16x16x32_bf16 v[244:247], a[56:59], a[104:107], v[244:247]
 ds_read_b64_tr_b16 a[16:17], v8 offset:0
 v_mfma_f32_16x16x32_bf16 v[244:247], a[60:63], a[108:111], v[244:247]
 ds_read_b64_tr_b16 a[18:19], v8 offset:4096
 v_mfma_f32_16x16x32_bf16 v[252:255], a[60:63], a[100:103], v[252:255]
 ds_read_b64_tr_b16 a[20:21], v8 offset:16384
 v_mfma_f32_16x16x32_bf16 v[252:255], a[56:59], a[96:99], v[252:255]
 s_waitcnt lgkmcnt(15)
 ds_read_b64_tr_b16 a[22:23], v8 offset:20480
 v_mfma_f32_16x16x32_bf16 v[88:91], a[0:3], a[64:67], v[88:91]
 ds_read_b64_tr_b16 a[24:25], v9 offset:0
 v_lshlrev_b32 v1, 4, v0
 v_mfma_f32_16x16x32_bf16 v[88:91], a[4:7], a[68:71], v[88:91]
 s_add_u32 m0, s33, 0xfffffe00
 ds_read_b64_tr_b16 a[26:27], v9 offset:4096
 v_mfma_f32_16x16x32_bf16 v[80:83], a[4:7], a[76:79], v[80:83]
 s_waitcnt lgkmcnt(10)
 ds_read_b64_tr_b16 a[28:29], v9 offset:16384
 v_mfma_f32_16x16x32_bf16 v[80:83], a[0:3], a[72:75], v[80:83]
 ds_read_b64_tr_b16 a[30:31], v9 offset:20480
 buffer_load_dwordx4 v15, s[20:23], 0 offen offset:512 lds
 v_mfma_f32_16x16x32_bf16 v[72:75], a[0:3], a[80:83], v[72:75]
 ds_read_b128 a[96:99], v4 offset:8192
 v_mfma_f32_16x16x32_bf16 v[72:75], a[4:7], a[84:87], v[72:75]
 v_mfma_f32_16x16x32_bf16 v[64:67], a[4:7], a[92:95], v[64:67]
 s_add_u32 m0, s33, 0xfffffe80
 ds_read_b128 a[100:103], v5 offset:8192
 v_mfma_f32_16x16x32_bf16 v[64:67], a[0:3], a[88:91], v[64:67]
 s_waitcnt lgkmcnt(10)
 buffer_load_dwordx4 v15, s[20:23], 0 offen offset:1408 lds
 v_mfma_f32_16x16x32_bf16 v[68:71], a[8:11], a[88:91], v[68:71]
 ds_read_b128 a[108:111], v5 offset:10240
 v_mfma_f32_16x16x32_bf16 v[68:71], a[12:15], a[92:95], v[68:71]
 v_mfma_f32_16x16x32_bf16 v[76:79], a[12:15], a[84:87], v[76:79]
 s_add_u32 m0, s33, 0x600
 ds_read_b128 a[104:107], v4 offset:10240
 v_mfma_f32_16x16x32_bf16 v[76:79], a[8:11], a[80:83], v[76:79]
 buffer_load_dwordx4 v15, s[20:23], s57 offen offset:512 lds
 v_mfma_f32_16x16x32_bf16 v[84:87], a[8:11], a[72:75], v[84:87]
 ds_read_b128 a[112:115], v4 offset:12288
 v_mfma_f32_16x16x32_bf16 v[84:87], a[12:15], a[76:79], v[84:87]
 v_mfma_f32_16x16x32_bf16 v[92:95], a[12:15], a[68:71], v[92:95]
 s_add_u32 m0, s33, 0x680
 ds_read_b128 a[116:119], v5 offset:12288
 v_mfma_f32_16x16x32_bf16 v[92:95], a[8:11], a[64:67], v[92:95]
 s_waitcnt lgkmcnt(10)
 buffer_load_dwordx4 v15, s[20:23], s57 offen offset:1408 lds
 v_mfma_f32_16x16x32_bf16 v[120:123], a[16:19], a[64:67], v[120:123]
 ds_read_b128 a[124:127], v5 offset:14336
 v_mfma_f32_16x16x32_bf16 v[120:123], a[20:23], a[68:71], v[120:123]
 v_mfma_f32_16x16x32_bf16 v[112:115], a[20:23], a[76:79], v[112:115]
 s_add_u32 m0, s33, 0xd80
 ds_read_b128 a[120:123], v4 offset:14336
 v_mfma_f32_16x16x32_bf16 v[112:115], a[16:19], a[72:75], v[112:115]
 buffer_load_dwordx4 v15, s[20:23], 0 offen offset:640 lds
 v_mfma_f32_16x16x32_bf16 v[104:107], a[16:19], a[80:83], v[104:107]
 ds_read_b64_tr_b16 a[32:33], v10 offset:0
 v_mfma_f32_16x16x32_bf16 v[104:107], a[20:23], a[84:87], v[104:107]
 ds_read_b64_tr_b16 a[34:35], v10 offset:4096
 v_mfma_f32_16x16x32_bf16 v[96:99], a[20:23], a[92:95], v[96:99]
 s_add_u32 m0, s33, 0xe00
 ds_read_b64_tr_b16 a[36:37], v10 offset:16384
 v_mfma_f32_16x16x32_bf16 v[96:99], a[16:19], a[88:91], v[96:99]
 s_waitcnt lgkmcnt(11)
 ds_read_b64_tr_b16 a[38:39], v10 offset:20480
 buffer_load_dwordx4 v15, s[20:23], 0 offen offset:1536 lds
 v_mfma_f32_16x16x32_bf16 v[100:103], a[24:27], a[88:91], v[100:103]
 ds_read_b64_tr_b16 a[40:41], v11 offset:0
 v_mfma_f32_16x16x32_bf16 v[100:103], a[28:31], a[92:95], v[100:103]
 ds_read_b64_tr_b16 a[42:43], v11 offset:4096
 v_mfma_f32_16x16x32_bf16 v[108:111], a[28:31], a[84:87], v[108:111]
 s_add_u32 m0, s33, 0x1580
 ds_read_b64_tr_b16 a[44:45], v11 offset:16384
 v_mfma_f32_16x16x32_bf16 v[108:111], a[24:27], a[80:83], v[108:111]
 ds_read_b64_tr_b16 a[46:47], v11 offset:20480
 buffer_load_dwordx4 v15, s[20:23], s57 offen offset:640 lds
 v_mfma_f32_16x16x32_bf16 v[116:119], a[24:27], a[72:75], v[116:119]
 ds_read_b64_tr_b16 a[48:49], v12 offset:0
 v_mfma_f32_16x16x32_bf16 v[116:119], a[28:31], a[76:79], v[116:119]
 ds_read_b64_tr_b16 a[50:51], v12 offset:4096
 v_mfma_f32_16x16x32_bf16 v[124:127], a[28:31], a[68:71], v[124:127]
 s_add_u32 m0, s33, 0x1600
 ds_read_b64_tr_b16 a[52:53], v12 offset:16384
 v_mfma_f32_16x16x32_bf16 v[124:127], a[24:27], a[64:67], v[124:127]
 s_waitcnt lgkmcnt(15)
 ds_read_b64_tr_b16 a[54:55], v12 offset:20480
 buffer_load_dwordx4 v15, s[20:23], s57 offen offset:1536 lds
 v_mfma_f32_16x16x32_bf16 a[232:235], a[0:3], a[96:99], a[232:235]
 ds_read_b64_tr_b16 a[56:57], v13 offset:0
 v_mfma_f32_16x16x32_bf16 a[232:235], a[4:7], a[100:103], a[232:235]
 ds_read_b64_tr_b16 a[58:59], v13 offset:4096
 v_mfma_f32_16x16x32_bf16 a[224:227], a[4:7], a[108:111], a[224:227]
 ds_read_b64_tr_b16 a[60:61], v13 offset:16384
 v_mfma_f32_16x16x32_bf16 a[224:227], a[0:3], a[104:107], a[224:227]
 s_waitcnt lgkmcnt(15)
 ds_read_b64_tr_b16 a[62:63], v13 offset:20480
 v_mfma_f32_16x16x32_bf16 v[24:27], a[0:3], a[112:115], v[24:27]
 v_mfma_f32_16x16x32_bf16 v[24:27], a[4:7], a[116:119], v[24:27]
 v_mfma_f32_16x16x32_bf16 v[16:19], a[4:7], a[124:127], v[16:19]
 v_mfma_f32_16x16x32_bf16 v[16:19], a[0:3], a[120:123], v[16:19]
 s_waitcnt lgkmcnt(0)
 v_mfma_f32_16x16x32_bf16 v[20:23], a[8:11], a[120:123], v[20:23]
 s_barrier
 v_mfma_f32_16x16x32_bf16 v[20:23], a[12:15], a[124:127], v[20:23]
 s_add_u32 m0, s29, 0
 v_add_u32 v2, 0xff800000, v2
 v_mfma_f32_16x16x32_bf16 v[28:31], a[12:15], a[116:119], v[28:31]
 buffer_load_dwordx4 v2, s[16:19], 0 offen lds
 v_mfma_f32_16x16x32_bf16 v[28:31], a[8:11], a[112:115], v[28:31]
 v_mfma_f32_16x16x32_bf16 a[228:231], a[8:11], a[104:107], a[228:231]
 v_mfma_f32_16x16x32_bf16 a[228:231], a[12:15], a[108:111], a[228:231]
 v_mfma_f32_16x16x32_bf16 a[236:239], a[12:15], a[100:103], a[236:239]
 s_add_u32 m0, s29, 4096
 v_mfma_f32_16x16x32_bf16 a[236:239], a[8:11], a[96:99], a[236:239]
 buffer_load_dwordx4 v2, s[16:19], s48 offen lds
 v_mfma_f32_16x16x32_bf16 v[56:59], a[16:19], a[96:99], v[56:59]
 v_mfma_f32_16x16x32_bf16 v[56:59], a[20:23], a[100:103], v[56:59]
 v_mfma_f32_16x16x32_bf16 v[48:51], a[20:23], a[108:111], v[48:51]
 v_mfma_f32_16x16x32_bf16 v[48:51], a[16:19], a[104:107], v[48:51]
 s_add_u32 m0, s29, 8192
 v_mfma_f32_16x16x32_bf16 v[40:43], a[16:19], a[112:115], v[40:43]
 buffer_load_dwordx4 v2, s[16:19], s49 offen lds
 v_mfma_f32_16x16x32_bf16 v[40:43], a[20:23], a[116:119], v[40:43]
 v_mfma_f32_16x16x32_bf16 v[32:35], a[20:23], a[124:127], v[32:35]
 v_mfma_f32_16x16x32_bf16 v[32:35], a[16:19], a[120:123], v[32:35]
 v_mfma_f32_16x16x32_bf16 v[36:39], a[24:27], a[120:123], v[36:39]
 s_add_u32 m0, s29, 12288
 v_mfma_f32_16x16x32_bf16 v[36:39], a[28:31], a[124:127], v[36:39]
 buffer_load_dwordx4 v2, s[16:19], s50 offen lds
 v_mfma_f32_16x16x32_bf16 v[44:47], a[28:31], a[116:119], v[44:47]
 v_mfma_f32_16x16x32_bf16 v[44:47], a[24:27], a[112:115], v[44:47]
 v_mfma_f32_16x16x32_bf16 v[52:55], a[24:27], a[104:107], v[52:55]
 v_mfma_f32_16x16x32_bf16 v[52:55], a[28:31], a[108:111], v[52:55]
 s_add_u32 m0, s29, 16384
 v_mfma_f32_16x16x32_bf16 v[60:63], a[28:31], a[100:103], v[60:63]
 buffer_load_dwordx4 v2, s[16:19], s51 offen lds
 v_mfma_f32_16x16x32_bf16 v[60:63], a[24:27], a[96:99], v[60:63]
 v_mfma_f32_16x16x32_bf16 v[216:219], a[32:35], a[96:99], v[216:219]
 v_mfma_f32_16x16x32_bf16 v[216:219], a[36:39], a[100:103], v[216:219]
 v_mfma_f32_16x16x32_bf16 v[208:211], a[36:39], a[108:111], v[208:211]
 s_add_u32 m0, s29, 20480
 v_mfma_f32_16x16x32_bf16 v[208:211], a[32:35], a[104:107], v[208:211]
 buffer_load_dwordx4 v2, s[16:19], s52 offen lds
 v_mfma_f32_16x16x32_bf16 v[200:203], a[32:35], a[112:115], v[200:203]
 v_mfma_f32_16x16x32_bf16 v[200:203], a[36:39], a[116:119], v[200:203]
 v_mfma_f32_16x16x32_bf16 v[192:195], a[36:39], a[124:127], v[192:195]
 v_mfma_f32_16x16x32_bf16 v[192:195], a[32:35], a[120:123], v[192:195]
 s_add_u32 m0, s29, 24576
 v_mfma_f32_16x16x32_bf16 v[196:199], a[40:43], a[120:123], v[196:199]
 buffer_load_dwordx4 v2, s[16:19], s53 offen lds
 v_mfma_f32_16x16x32_bf16 v[196:199], a[44:47], a[124:127], v[196:199]
 v_mfma_f32_16x16x32_bf16 v[204:207], a[44:47], a[116:119], v[204:207]
 v_mfma_f32_16x16x32_bf16 v[204:207], a[40:43], a[112:115], v[204:207]
 v_mfma_f32_16x16x32_bf16 v[212:215], a[40:43], a[104:107], v[212:215]
 s_add_u32 m0, s29, 28672
 v_mfma_f32_16x16x32_bf16 v[212:215], a[44:47], a[108:111], v[212:215]
 buffer_load_dwordx4 v2, s[16:19], s54 offen lds
 v_mfma_f32_16x16x32_bf16 v[220:223], a[44:47], a[100:103], v[220:223]
 v_mfma_f32_16x16x32_bf16 v[220:223], a[40:43], a[96:99], v[220:223]
 v_mfma_f32_16x16x32_bf16 v[248:251], a[48:51], a[96:99], v[248:251]
 s_add_u32 m0, s29, 65536
 v_add_u32 v2, 0x80000, v2
 v_mfma_f32_16x16x32_bf16 v[248:251], a[52:55], a[100:103], v[248:251]
 buffer_load_dwordx4 v2, s[16:19], 0 offen lds
 v_mfma_f32_16x16x32_bf16 v[240:243], a[52:55], a[108:111], v[240:243]
 v_mfma_f32_16x16x32_bf16 v[240:243], a[48:51], a[104:107], v[240:243]
 v_mfma_f32_16x16x32_bf16 v[232:235], a[48:51], a[112:115], v[232:235]
 v_mfma_f32_16x16x32_bf16 v[232:235], a[52:55], a[116:119], v[232:235]
 s_add_u32 m0, s29, 69632
 v_mfma_f32_16x16x32_bf16 v[224:227], a[52:55], a[124:127], v[224:227]
 buffer_load_dwordx4 v2, s[16:19], s48 offen lds
 v_mfma_f32_16x16x32_bf16 v[224:227], a[48:51], a[120:123], v[224:227]
 v_mfma_f32_16x16x32_bf16 v[228:231], a[56:59], a[120:123], v[228:231]
 v_mfma_f32_16x16x32_bf16 v[228:231], a[60:63], a[124:127], v[228:231]
 v_mfma_f32_16x16x32_bf16 v[236:239], a[60:63], a[116:119], v[236:239]
 s_add_u32 m0, s29, 73728
 v_mfma_f32_16x16x32_bf16 v[236:239], a[56:59], a[112:115], v[236:239]
 buffer_load_dwordx4 v2, s[16:19], s49 offen lds
 v_mfma_f32_16x16x32_bf16 v[244:247], a[56:59], a[104:107], v[244:247]
 s_waitcnt vmcnt(11)
 v_mfma_f32_16x16x32_bf16 v[244:247], a[60:63], a[108:111], v[244:247]
 s_barrier
 ds_read_b64_tr_b16 a[0:1], v6 offset:32768
 v_mfma_f32_16x16x32_bf16 v[252:255], a[60:63], a[100:103], v[252:255]
 ds_read_b64_tr_b16 a[2:3], v6 offset:36864
 v_mfma_f32_16x16x32_bf16 v[252:255], a[56:59], a[96:99], v[252:255]
 s_add_u32 m0, s29, 77824
 ds_read_b128 a[96:99], v4 offset:40960
 v_mfma_f32_16x16x32_bf16 v[152:155], a[32:35], a[64:67], v[152:155]
 ds_read_b128 a[192:195], v14 offset:0
 buffer_load_dwordx4 v2, s[16:19], s50 offen lds
 v_mfma_f32_16x16x32_bf16 v[152:155], a[36:39], a[68:71], v[152:155]
 ds_read_b128 a[200:203], v3 offset:0
 v_mfma_f32_16x16x32_bf16 v[144:147], a[36:39], a[76:79], v[144:147]
 s_mov_b32 s56, s58
 ds_read_b64_tr_b16 a[4:5], v6 offset:49152
 v_mfma_f32_16x16x32_bf16 v[144:147], a[32:35], a[72:75], v[144:147]
 ds_read_b64_tr_b16 a[6:7], v6 offset:53248
 v_mfma_f32_16x16x32_bf16 v[136:139], a[32:35], a[80:83], v[136:139]
 s_add_u32 m0, s29, 81920
 ds_read_b128 a[100:103], v5 offset:40960
 v_mfma_f32_16x16x32_bf16 v[136:139], a[36:39], a[84:87], v[136:139]
 ds_read_b128 a[196:199], v14 offset:2048
 buffer_load_dwordx4 v2, s[16:19], s51 offen lds
 v_mfma_f32_16x16x32_bf16 v[128:131], a[36:39], a[92:95], v[128:131]
 ds_read_b128 a[204:207], v3 offset:2048
 v_mfma_f32_16x16x32_bf16 v[128:131], a[32:35], a[88:91], v[128:131]
 ds_read_b128 a[108:111], v5 offset:43008
 v_mfma_f32_16x16x32_bf16 v[132:135], a[40:43], a[88:91], v[132:135]
 ds_read_b128 a[208:211], v14 offset:4096
 v_mfma_f32_16x16x32_bf16 v[132:135], a[44:47], a[92:95], v[132:135]
 s_add_u32 m0, s29, 86016
 ds_read_b128 a[104:107], v4 offset:43008
 v_mfma_f32_16x16x32_bf16 v[140:143], a[44:47], a[84:87], v[140:143]
 ds_read_b128 a[216:219], v3 offset:4096
 buffer_load_dwordx4 v2, s[16:19], s52 offen lds
 v_mfma_f32_16x16x32_bf16 v[140:143], a[40:43], a[80:83], v[140:143]
 ds_read_b128 a[212:215], v14 offset:6144
 v_mfma_f32_16x16x32_bf16 v[148:151], a[40:43], a[72:75], v[148:151]
 s_cmp_lt_u32 s25, 4
 s_cselect_b32 s1, 2.0, s92
 ds_read_b128 a[112:115], v4 offset:45056
 v_mfma_f32_16x16x32_bf16 v[148:151], a[44:47], a[76:79], v[148:151]
 ds_read_b128 a[220:223], v3 offset:6144
 v_mfma_f32_16x16x32_bf16 v[156:159], a[44:47], a[68:71], v[156:159]
 s_add_u32 m0, s29, 90112
 ds_read_b128 a[116:119], v5 offset:45056
 v_mfma_f32_16x16x32_bf16 v[156:159], a[40:43], a[64:67], v[156:159]
 buffer_load_dwordx4 v2, s[16:19], s53 offen lds
 v_mfma_f32_16x16x32_bf16 v[184:187], a[48:51], a[64:67], v[184:187]
 v_mfma_f32_16x16x32_bf16 v[184:187], a[52:55], a[68:71], v[184:187]
 ds_read_b128 a[124:127], v5 offset:47104
 v_mfma_f32_16x16x32_bf16 v[176:179], a[52:55], a[76:79], v[176:179]
 v_mfma_f32_16x16x32_bf16 v[176:179], a[48:51], a[72:75], v[176:179]
 s_add_u32 m0, s29, 94208
 ds_read_b128 a[120:123], v4 offset:47104
 v_mfma_f32_16x16x32_bf16 v[168:171], a[48:51], a[80:83], v[168:171]
 buffer_load_dwordx4 v2, s[16:19], s54 offen lds
 v_mfma_f32_16x16x32_bf16 v[168:171], a[52:55], a[84:87], v[168:171]
 v_mfma_f32_16x16x32_bf16 v[160:163], a[52:55], a[92:95], v[160:163]
 v_mfma_f32_16x16x32_bf16 v[160:163], a[48:51], a[88:91], v[160:163]
 ds_read_b64_tr_b16 a[8:9], v7 offset:32768
 v_mfma_f32_16x16x32_bf16 v[164:167], a[56:59], a[88:91], v[164:167]
 v_mfma_f32_16x16x32_bf16 v[164:167], a[60:63], a[92:95], v[164:167]
 ds_read_b64_tr_b16 a[10:11], v7 offset:36864
 v_mfma_f32_16x16x32_bf16 v[172:175], a[60:63], a[84:87], v[172:175]
 ds_read_b64_tr_b16 a[12:13], v7 offset:49152
 v_mfma_f32_16x16x32_bf16 v[172:175], a[56:59], a[80:83], v[172:175]
 ds_read_b64_tr_b16 a[14:15], v7 offset:53248
 v_mfma_f32_16x16x32_bf16 v[180:183], a[56:59], a[72:75], v[180:183]
 ds_read_b64_tr_b16 a[16:17], v8 offset:32768
 v_mfma_f32_16x16x32_bf16 v[180:183], a[60:63], a[76:79], v[180:183]
 ds_read_b64_tr_b16 a[18:19], v8 offset:36864
 v_mfma_f32_16x16x32_bf16 v[188:191], a[60:63], a[68:71], v[188:191]
 ds_read_b64_tr_b16 a[20:21], v8 offset:49152
 v_mfma_f32_16x16x32_bf16 v[188:191], a[56:59], a[64:67], v[188:191]
 s_waitcnt lgkmcnt(15)
 ds_read_b64_tr_b16 a[22:23], v8 offset:53248
 s_cmp_ge_u32 s25, 4
 s_cbranch_scc1 L_late0
 v_mfma_f32_16x16x32_bf16 a[232:235], a[0:3], a[96:99], a[232:235]
 ds_read_b64_tr_b16 a[24:25], v9 offset:32768
 v_mfma_f32_16x16x32_bf16 a[232:235], a[4:7], a[100:103], a[232:235]
 s_add_u32 m0, s33, 0xfffffd00
 ds_read_b64_tr_b16 a[26:27], v9 offset:36864
 v_mfma_f32_16x16x32_bf16 a[224:227], a[4:7], a[108:111], a[224:227]
 s_waitcnt lgkmcnt(13)
 ds_read_b64_tr_b16 a[28:29], v9 offset:49152
 v_mfma_f32_16x16x32_bf16 a[224:227], a[0:3], a[104:107], a[224:227]
 ds_read_b64_tr_b16 a[30:31], v9 offset:53248
 buffer_load_dwordx4 v15, s[20:23], 0 offen offset:768 lds
 v_mfma_f32_16x16x32_bf16 v[24:27], a[0:3], a[112:115], v[24:27]
 s_waitcnt lgkmcnt(12)
 ds_read_b128 a[64:67], v4 offset:32768
 v_mfma_f32_16x16x32_bf16 v[24:27], a[4:7], a[116:119], v[24:27]
 v_mfma_f32_16x16x32_bf16 v[16:19], a[4:7], a[124:127], v[16:19]
 s_add_u32 m0, s33, 0xfffffd80
 ds_read_b128 a[68:71], v5 offset:32768
 v_mfma_f32_16x16x32_bf16 v[16:19], a[0:3], a[120:123], v[16:19]
 s_waitcnt lgkmcnt(10)
 buffer_load_dwordx4 v15, s[20:23], 0 offen offset:1664 lds
 v_mfma_f32_16x16x32_bf16 v[20:23], a[8:11], a[120:123], v[20:23]
 ds_read_b128 a[76:79], v5 offset:34816
 v_mfma_f32_16x16x32_bf16 v[20:23], a[12:15], a[124:127], v[20:23]
 v_mfma_f32_16x16x32_bf16 v[28:31], a[12:15], a[116:119], v[28:31]
 s_add_u32 m0, s33, 0x500
 ds_read_b128 a[72:75], v4 offset:34816
 v_mfma_f32_16x16x32_bf16 v[28:31], a[8:11], a[112:115], v[28:31]
 buffer_load_dwordx4 v15, s[20:23], s57 offen offset:768 lds
 v_mfma_f32_16x16x32_bf16 a[228:231], a[8:11], a[104:107], a[228:231]
 ds_read_b128 a[80:83], v4 offset:36864
 v_mfma_f32_16x16x32_bf16 a[228:231], a[12:15], a[108:111], a[228:231]
 v_mfma_f32_16x16x32_bf16 a[236:239], a[12:15], a[100:103], a[236:239]
 s_add_u32 m0, s33, 0x580
 ds_read_b128 a[84:87], v5 offset:36864
 v_mfma_f32_16x16x32_bf16 a[236:239], a[8:11], a[96:99], a[236:239]
 s_waitcnt lgkmcnt(10)
 buffer_load_dwordx4 v15, s[20:23], s57 offen offset:1664 lds
 v_mfma_f32_16x16x32_bf16 v[56:59], a[16:19], a[96:99], v[56:59]
 ds_read_b128 a[92:95], v5 offset:38912
 v_mfma_f32_16x16x32_bf16 v[56:59], a[20:23], a[100:103], v[56:59]
 v_cvt_pk_bf16_f32 v16, v16, v17
 v_cvt_pk_bf16_f32 v17, v18, v19
 v_mfma_f32_16x16x32_bf16 v[48:51], a[20:23], a[108:111], v[48:51]
 ds_read_b128 a[88:91], v4 offset:38912
 v_cvt_pk_bf16_f32 v18, v20, v21
 v_mfma_f32_16x16x32_bf16 v[48:51], a[16:19], a[104:107], v[48:51]
 v_cvt_pk_bf16_f32 v19, v22, v23
 v_cvt_pk_bf16_f32 v24, v24, v25
 v_mfma_f32_16x16x32_bf16 v[40:43], a[16:19], a[112:115], v[40:43]
 ds_read_b64_tr_b16 a[32:33], v10 offset:32768
 v_cvt_pk_bf16_f32 v25, v26, v27
 v_mfma_f32_16x16x32_bf16 v[40:43], a[20:23], a[116:119], v[40:43]
 ds_read_b64_tr_b16 a[34:35], v10 offset:36864
 v_cvt_pk_bf16_f32 v26, v28, v29
 v_mfma_f32_16x16x32_bf16 v[32:35], a[20:23], a[124:127], v[32:35]
 s_add_u32 s59, s56, 57344
 ds_read_b64_tr_b16 a[36:37], v10 offset:49152
 v_cvt_pk_bf16_f32 v27, v30, v31
 v_mfma_f32_16x16x32_bf16 v[32:35], a[16:19], a[120:123], v[32:35]
 s_waitcnt lgkmcnt(11)
 ds_read_b64_tr_b16 a[38:39], v10 offset:53248
 v_accvgpr_read_b32 v20, a224
 v_mfma_f32_16x16x32_bf16 v[36:39], a[24:27], a[120:123], v[36:39]
 ds_read_b64_tr_b16 a[40:41], v11 offset:32768
 buffer_store_dwordx4 v[16:19], v1, s[12:15], s59 offen offset:0 sc1
 v_mfma_f32_16x16x32_bf16 v[36:39], a[28:31], a[124:127], v[36:39]
 ds_read_b64_tr_b16 a[42:43], v11 offset:36864
 v_accvgpr_read_b32 v21, a225
 v_mfma_f32_16x16x32_bf16 v[44:47], a[28:31], a[116:119], v[44:47]
 ds_read_b64_tr_b16 a[44:45], v11 offset:49152
 v_accvgpr_read_b32 v22, a226
 v_mfma_f32_16x16x32_bf16 v[44:47], a[24:27], a[112:115], v[44:47]
 ds_read_b64_tr_b16 a[46:47], v11 offset:53248
 v_accvgpr_read_b32 v23, a227
 v_mfma_f32_16x16x32_bf16 v[52:55], a[24:27], a[104:107], v[52:55]
 ds_read_b64_tr_b16 a[48:49], v12 offset:32768
 v_accvgpr_read_b32 v28, a228
 v_mfma_f32_16x16x32_bf16 v[52:55], a[28:31], a[108:111], v[52:55]
 ds_read_b64_tr_b16 a[50:51], v12 offset:36864
 v_accvgpr_read_b32 v29, a229
 v_mfma_f32_16x16x32_bf16 v[60:63], a[28:31], a[100:103], v[60:63]
 s_add_u32 s59, s56, 49152
 ds_read_b64_tr_b16 a[52:53], v12 offset:49152
 v_accvgpr_read_b32 v30, a230
 v_mfma_f32_16x16x32_bf16 v[60:63], a[24:27], a[96:99], v[60:63]
 s_waitcnt lgkmcnt(15)
 ds_read_b64_tr_b16 a[54:55], v12 offset:53248
 buffer_store_dwordx4 v[24:27], v1, s[12:15], s59 offen offset:0 sc1
 v_mfma_f32_16x16x32_bf16 v[88:91], a[0:3], a[64:67], v[88:91]
 ds_read_b64_tr_b16 a[56:57], v13 offset:32768
 v_accvgpr_read_b32 v31, a231
 v_mfma_f32_16x16x32_bf16 v[88:91], a[4:7], a[68:71], v[88:91]
 ds_read_b64_tr_b16 a[58:59], v13 offset:36864
 v_cvt_pk_bf16_f32 v20, v20, v21
 v_mfma_f32_16x16x32_bf16 v[80:83], a[4:7], a[76:79], v[80:83]
 ds_read_b64_tr_b16 a[60:61], v13 offset:49152
 v_cvt_pk_bf16_f32 v21, v22, v23
 v_mfma_f32_16x16x32_bf16 v[80:83], a[0:3], a[72:75], v[80:83]
 s_waitcnt lgkmcnt(15)
 ds_read_b64_tr_b16 a[62:63], v13 offset:53248
 v_cvt_pk_bf16_f32 v22, v28, v29
 v_mfma_f32_16x16x32_bf16 v[72:75], a[0:3], a[80:83], v[72:75]
 v_cvt_pk_bf16_f32 v23, v30, v31
 v_cvt_pk_bf16_f32 v32, v32, v33
 v_mfma_f32_16x16x32_bf16 v[72:75], a[4:7], a[84:87], v[72:75]
 s_add_u32 s59, s56, 40960
 v_cvt_pk_bf16_f32 v33, v34, v35
 v_cvt_pk_bf16_f32 v34, v36, v37
 v_mfma_f32_16x16x32_bf16 v[64:67], a[4:7], a[92:95], v[64:67]
 buffer_store_dwordx4 v[20:23], v1, s[12:15], s59 offen offset:0 sc1
 v_mfma_f32_16x16x32_bf16 v[64:67], a[0:3], a[88:91], v[64:67]
 s_waitcnt lgkmcnt(0)
 v_cvt_pk_bf16_f32 v35, v38, v39
 v_cvt_pk_bf16_f32 v40, v40, v41
 v_mfma_f32_16x16x32_bf16 v[68:71], a[8:11], a[88:91], v[68:71]
 s_barrier
 v_xor_b32 v6, s60, v6
 v_cvt_pk_bf16_f32 v41, v42, v43
 v_mfma_f32_16x16x32_bf16 v[68:71], a[12:15], a[92:95], v[68:71]
 s_add_u32 m0, s29, 32768
 v_add_u32 v2, 0x80000, v2
 v_cvt_pk_bf16_f32 v42, v44, v45
 v_mfma_f32_16x16x32_bf16 v[76:79], a[12:15], a[84:87], v[76:79]
 buffer_load_dwordx4 v2, s[16:19], 0 offen lds
 v_mfma_f32_16x16x32_bf16 v[76:79], a[8:11], a[80:83], v[76:79]
 v_cvt_pk_bf16_f32 v43, v46, v47
 v_accvgpr_read_b32 v36, a232
 v_mfma_f32_16x16x32_bf16 v[84:87], a[8:11], a[72:75], v[84:87]
 s_add_u32 s59, s56, 57344
 v_accvgpr_read_b32 v37, a233
 v_accvgpr_read_b32 v38, a234
 v_mfma_f32_16x16x32_bf16 v[84:87], a[12:15], a[76:79], v[84:87]
 buffer_store_dwordx4 v[32:35], v1, s[12:15], s59 offen offset:1024 sc1
 v_mfma_f32_16x16x32_bf16 v[92:95], a[12:15], a[68:71], v[92:95]
 s_add_u32 m0, s29, 36864
 v_accvgpr_read_b32 v39, a235
 v_accvgpr_read_b32 v44, a236
 v_mfma_f32_16x16x32_bf16 v[92:95], a[8:11], a[64:67], v[92:95]
 buffer_load_dwordx4 v2, s[16:19], s48 offen lds
 v_mfma_f32_16x16x32_bf16 v[120:123], a[16:19], a[64:67], v[120:123]
 v_accvgpr_read_b32 v45, a237
 v_accvgpr_read_b32 v46, a238
 v_mfma_f32_16x16x32_bf16 v[120:123], a[20:23], a[68:71], v[120:123]
 v_accvgpr_read_b32 v47, a239
 v_cvt_pk_bf16_f32 v36, v36, v37
 v_mfma_f32_16x16x32_bf16 v[112:115], a[20:23], a[76:79], v[112:115]
 v_cvt_pk_bf16_f32 v37, v38, v39
 v_cvt_pk_bf16_f32 v38, v44, v45
 v_mfma_f32_16x16x32_bf16 v[112:115], a[16:19], a[72:75], v[112:115]
 s_add_u32 m0, s29, 40960
 v_cvt_pk_bf16_f32 v39, v46, v47
 v_cvt_pk_bf16_f32 v48, v48, v49
 v_mfma_f32_16x16x32_bf16 v[104:107], a[16:19], a[80:83], v[104:107]
 buffer_load_dwordx4 v2, s[16:19], s49 offen lds
 v_mfma_f32_16x16x32_bf16 v[104:107], a[20:23], a[84:87], v[104:107]
 s_add_u32 s59, s56, 49152
 v_cvt_pk_bf16_f32 v49, v50, v51
 v_cvt_pk_bf16_f32 v50, v52, v53
 v_mfma_f32_16x16x32_bf16 v[96:99], a[20:23], a[92:95], v[96:99]
 buffer_store_dwordx4 v[40:43], v1, s[12:15], s59 offen offset:1024 sc1
 v_mfma_f32_16x16x32_bf16 v[96:99], a[16:19], a[88:91], v[96:99]
 v_cvt_pk_bf16_f32 v51, v54, v55
 v_cvt_pk_bf16_f32 v56, v56, v57
 v_mfma_f32_16x16x32_bf16 v[100:103], a[24:27], a[88:91], v[100:103]
 s_add_u32 m0, s29, 45056
 v_cvt_pk_bf16_f32 v57, v58, v59
 v_cvt_pk_bf16_f32 v58, v60, v61
 v_mfma_f32_16x16x32_bf16 v[100:103], a[28:31], a[92:95], v[100:103]
 buffer_load_dwordx4 v2, s[16:19], s50 offen lds
 v_mfma_f32_16x16x32_bf16 v[108:111], a[28:31], a[84:87], v[108:111]
 v_cvt_pk_bf16_f32 v59, v62, v63
 v_cvt_pk_bf16_f32 v64, v64, v65
 v_mfma_f32_16x16x32_bf16 v[108:111], a[24:27], a[80:83], v[108:111]
 v_cvt_pk_bf16_f32 v65, v66, v67
 v_cvt_pk_bf16_f32 v66, v68, v69
 v_mfma_f32_16x16x32_bf16 v[116:119], a[24:27], a[72:75], v[116:119]
 v_cvt_pk_bf16_f32 v67, v70, v71
 v_cvt_pk_bf16_f32 v72, v72, v73
 v_mfma_f32_16x16x32_bf16 v[116:119], a[28:31], a[76:79], v[116:119]
 s_add_u32 m0, s29, 49152
 v_cvt_pk_bf16_f32 v73, v74, v75
 v_cvt_pk_bf16_f32 v74, v76, v77
 v_mfma_f32_16x16x32_bf16 v[124:127], a[28:31], a[68:71], v[124:127]
 buffer_load_dwordx4 v2, s[16:19], s51 offen lds
 v_mfma_f32_16x16x32_bf16 v[124:127], a[24:27], a[64:67], v[124:127]
 s_add_u32 s59, s56, 32768
 v_cvt_pk_bf16_f32 v75, v78, v79
 v_cvt_pk_bf16_f32 v80, v80, v81
 v_mfma_f32_16x16x32_bf16 v[152:155], a[32:35], a[64:67], v[152:155]
 buffer_store_dwordx4 v[36:39], v1, s[12:15], s59 offen offset:0 sc1
 v_mfma_f32_16x16x32_bf16 v[152:155], a[36:39], a[68:71], v[152:155]
 v_cvt_pk_bf16_f32 v81, v82, v83
 v_cvt_pk_bf16_f32 v82, v84, v85
 v_mfma_f32_16x16x32_bf16 v[144:147], a[36:39], a[76:79], v[144:147]
 s_add_u32 m0, s29, 53248
 v_cvt_pk_bf16_f32 v83, v86, v87
 v_cvt_pk_bf16_f32 v88, v88, v89
 v_mfma_f32_16x16x32_bf16 v[144:147], a[32:35], a[72:75], v[144:147]
 buffer_load_dwordx4 v2, s[16:19], s52 offen lds
 v_mfma_f32_16x16x32_bf16 v[136:139], a[32:35], a[80:83], v[136:139]
 v_cvt_pk_bf16_f32 v89, v90, v91
 v_cvt_pk_bf16_f32 v90, v92, v93
 v_mfma_f32_16x16x32_bf16 v[136:139], a[36:39], a[84:87], v[136:139]
 v_cvt_pk_bf16_f32 v91, v94, v95
 v_cvt_pk_bf16_f32 v96, v96, v97
 v_mfma_f32_16x16x32_bf16 v[128:131], a[36:39], a[92:95], v[128:131]
 v_cvt_pk_bf16_f32 v97, v98, v99
 v_cvt_pk_bf16_f32 v98, v100, v101
 v_mfma_f32_16x16x32_bf16 v[128:131], a[32:35], a[88:91], v[128:131]
 s_add_u32 m0, s29, 57344
 v_cvt_pk_bf16_f32 v99, v102, v103
 v_cvt_pk_bf16_f32 v104, v104, v105
 v_mfma_f32_16x16x32_bf16 v[132:135], a[40:43], a[88:91], v[132:135]
 buffer_load_dwordx4 v2, s[16:19], s53 offen lds
 v_mfma_f32_16x16x32_bf16 v[132:135], a[44:47], a[92:95], v[132:135]
 s_add_u32 s59, s56, 40960
 v_cvt_pk_bf16_f32 v105, v106, v107
 v_cvt_pk_bf16_f32 v106, v108, v109
 v_mfma_f32_16x16x32_bf16 v[140:143], a[44:47], a[84:87], v[140:143]
 buffer_store_dwordx4 v[48:51], v1, s[12:15], s59 offen offset:1024 sc1
 v_mfma_f32_16x16x32_bf16 v[140:143], a[40:43], a[80:83], v[140:143]
 v_cvt_pk_bf16_f32 v107, v110, v111
 v_cvt_pk_bf16_f32 v112, v112, v113
 v_mfma_f32_16x16x32_bf16 v[148:151], a[40:43], a[72:75], v[148:151]
 s_add_u32 m0, s29, 61440
 v_cvt_pk_bf16_f32 v113, v114, v115
 v_cvt_pk_bf16_f32 v114, v116, v117
 v_mfma_f32_16x16x32_bf16 v[148:151], a[44:47], a[76:79], v[148:151]
 buffer_load_dwordx4 v2, s[16:19], s54 offen lds
 v_mfma_f32_16x16x32_bf16 v[156:159], a[44:47], a[68:71], v[156:159]
 v_cvt_pk_bf16_f32 v115, v118, v119
 v_cvt_pk_bf16_f32 v120, v120, v121
 v_mfma_f32_16x16x32_bf16 v[156:159], a[40:43], a[64:67], v[156:159]
 v_cvt_pk_bf16_f32 v121, v122, v123
 v_cvt_pk_bf16_f32 v122, v124, v125
 v_mfma_f32_16x16x32_bf16 v[184:187], a[48:51], a[64:67], v[184:187]
 s_add_u32 m0, s29, 98304
 v_add_u32 v2, 0x80000, v2
 v_cvt_pk_bf16_f32 v123, v126, v127
 v_mfma_f32_16x16x32_bf16 v[184:187], a[52:55], a[68:71], v[184:187]
 buffer_load_dwordx4 v2, s[16:19], 0 offen lds
 v_mfma_f32_16x16x32_bf16 v[176:179], a[52:55], a[76:79], v[176:179]
 s_add_u32 s59, s56, 32768
 v_cvt_pk_bf16_f32 v128, v128, v129
 v_cvt_pk_bf16_f32 v129, v130, v131
 v_mfma_f32_16x16x32_bf16 v[176:179], a[48:51], a[72:75], v[176:179]
 buffer_store_dwordx4 v[56:59], v1, s[12:15], s59 offen offset:1024 sc1
 v_mfma_f32_16x16x32_bf16 v[168:171], a[48:51], a[80:83], v[168:171]
 v_cvt_pk_bf16_f32 v130, v132, v133
 v_cvt_pk_bf16_f32 v131, v134, v135
 v_mfma_f32_16x16x32_bf16 v[168:171], a[52:55], a[84:87], v[168:171]
 s_add_u32 m0, s29, 102400
 v_cvt_pk_bf16_f32 v136, v136, v137
 v_cvt_pk_bf16_f32 v137, v138, v139
 v_mfma_f32_16x16x32_bf16 v[160:163], a[52:55], a[92:95], v[160:163]
 buffer_load_dwordx4 v2, s[16:19], s48 offen lds
 v_mfma_f32_16x16x32_bf16 v[160:163], a[48:51], a[88:91], v[160:163]
 v_cvt_pk_bf16_f32 v138, v140, v141
 v_cvt_pk_bf16_f32 v139, v142, v143
 v_mfma_f32_16x16x32_bf16 v[164:167], a[56:59], a[88:91], v[164:167]
 v_cvt_pk_bf16_f32 v144, v144, v145
 v_cvt_pk_bf16_f32 v145, v146, v147
 v_mfma_f32_16x16x32_bf16 v[164:167], a[60:63], a[92:95], v[164:167]
 v_cvt_pk_bf16_f32 v146, v148, v149
 v_cvt_pk_bf16_f32 v147, v150, v151
 v_mfma_f32_16x16x32_bf16 v[172:175], a[60:63], a[84:87], v[172:175]
 s_add_u32 m0, s29, 106496
 v_cvt_pk_bf16_f32 v152, v152, v153
 v_cvt_pk_bf16_f32 v153, v154, v155
 v_mfma_f32_16x16x32_bf16 v[172:175], a[56:59], a[80:83], v[172:175]
 buffer_load_dwordx4 v2, s[16:19], s49 offen lds
 v_mfma_f32_16x16x32_bf16 v[180:183], a[56:59], a[72:75], v[180:183]
 s_add_u32 s59, s56, 24576
 v_cvt_pk_bf16_f32 v154, v156, v157
 v_cvt_pk_bf16_f32 v155, v158, v159
 v_mfma_f32_16x16x32_bf16 v[180:183], a[60:63], a[76:79], v[180:183]
 buffer_store_dwordx4 v[64:67], v1, s[12:15], s59 offen offset:0 sc1
 v_mfma_f32_16x16x32_bf16 v[188:191], a[60:63], a[68:71], v[188:191]
 v_mfma_f32_16x16x32_bf16 v[188:191], a[56:59], a[64:67], v[188:191]
 s_add_u32 m0, s29, 110592
 v_mfma_f32_16x16x32_bf16 v[216:219], a[32:35], a[96:99], v[216:219]
 buffer_load_dwordx4 v2, s[16:19], s50 offen lds
 v_mfma_f32_16x16x32_bf16 v[216:219], a[36:39], a[100:103], v[216:219]
 v_cvt_pk_bf16_f32 v160, v160, v161
 v_cvt_pk_bf16_f32 v161, v162, v163
 v_mfma_f32_16x16x32_bf16 v[208:211], a[36:39], a[108:111], v[208:211]
 v_cvt_pk_bf16_f32 v162, v164, v165
 v_cvt_pk_bf16_f32 v163, v166, v167
 v_mfma_f32_16x16x32_bf16 v[208:211], a[32:35], a[104:107], v[208:211]
 v_cvt_pk_bf16_f32 v168, v168, v169
 v_cvt_pk_bf16_f32 v169, v170, v171
 v_mfma_f32_16x16x32_bf16 v[200:203], a[32:35], a[112:115], v[200:203]
 s_add_u32 m0, s29, 114688
 v_cvt_pk_bf16_f32 v170, v172, v173
 v_cvt_pk_bf16_f32 v171, v174, v175
 v_mfma_f32_16x16x32_bf16 v[200:203], a[36:39], a[116:119], v[200:203]
 buffer_load_dwordx4 v2, s[16:19], s51 offen lds
 v_mfma_f32_16x16x32_bf16 v[192:195], a[36:39], a[124:127], v[192:195]
 s_add_u32 s59, s56, 16384
 v_cvt_pk_bf16_f32 v176, v176, v177
 v_cvt_pk_bf16_f32 v177, v178, v179
 v_mfma_f32_16x16x32_bf16 v[192:195], a[32:35], a[120:123], v[192:195]
 buffer_store_dwordx4 v[72:75], v1, s[12:15], s59 offen offset:0 sc1
 v_mfma_f32_16x16x32_bf16 v[196:199], a[40:43], a[120:123], v[196:199]
 v_cvt_pk_bf16_f32 v178, v180, v181
 v_cvt_pk_bf16_f32 v179, v182, v183
 v_mfma_f32_16x16x32_bf16 v[196:199], a[44:47], a[124:127], v[196:199]
 s_add_u32 m0, s29, 118784
 v_cvt_pk_bf16_f32 v184, v184, v185
 v_cvt_pk_bf16_f32 v185, v186, v187
 v_mfma_f32_16x16x32_bf16 v[204:207], a[44:47], a[116:119], v[204:207]
 buffer_load_dwordx4 v2, s[16:19], s52 offen lds
 v_mfma_f32_16x16x32_bf16 v[204:207], a[40:43], a[112:115], v[204:207]
 v_cvt_pk_bf16_f32 v186, v188, v189
 v_cvt_pk_bf16_f32 v187, v190, v191
 v_mfma_f32_16x16x32_bf16 v[212:215], a[40:43], a[104:107], v[212:215]
 v_mfma_f32_16x16x32_bf16 v[212:215], a[44:47], a[108:111], v[212:215]
 v_mfma_f32_16x16x32_bf16 v[220:223], a[44:47], a[100:103], v[220:223]
 s_add_u32 m0, s29, 122880
 v_mfma_f32_16x16x32_bf16 v[220:223], a[40:43], a[96:99], v[220:223]
 buffer_load_dwordx4 v2, s[16:19], s53 offen lds
 v_mfma_f32_16x16x32_bf16 v[248:251], a[48:51], a[96:99], v[248:251]
 s_add_u32 s59, s56, 8192
 v_mfma_f32_16x16x32_bf16 v[248:251], a[52:55], a[100:103], v[248:251]
 s_waitcnt vmcnt(25)
 buffer_store_dwordx4 v[80:83], v1, s[12:15], s59 offen offset:0 sc1
 v_mfma_f32_16x16x32_bf16 v[240:243], a[52:55], a[108:111], v[240:243]
 s_barrier
 v_xor_b32 v7, 0, v6
 v_cvt_pk_bf16_f32 v192, v192, v193
 v_mfma_f32_16x16x32_bf16 v[240:243], a[48:51], a[104:107], v[240:243]
 s_add_u32 m0, s29, 126976
 ds_read_b64_tr_b16 a[64:65], v7 offset:0
 v_cvt_pk_bf16_f32 v193, v194, v195
 v_mfma_f32_16x16x32_bf16 v[232:235], a[48:51], a[112:115], v[232:235]
 ds_read_b64_tr_b16 a[66:67], v7 offset:4096
 buffer_load_dwordx4 v2, s[16:19], s54 offen lds
 v_mfma_f32_16x16x32_bf16 v[232:235], a[52:55], a[116:119], v[232:235]
 ds_read_b64_tr_b16 a[68:69], v7 offset:16384
 v_cvt_pk_bf16_f32 v194, v196, v197
 v_mfma_f32_16x16x32_bf16 v[224:227], a[52:55], a[124:127], v[224:227]
 ds_read_b64_tr_b16 a[70:71], v7 offset:20480
 v_xor_b32 v8, 65536, v6
 v_mfma_f32_16x16x32_bf16 v[224:227], a[48:51], a[120:123], v[224:227]
 s_add_u32 s59, s56, 0
 ds_read_b64_tr_b16 a[72:73], v8 offset:0
 v_cvt_pk_bf16_f32 v195, v198, v199
 v_mfma_f32_16x16x32_bf16 v[228:231], a[56:59], a[120:123], v[228:231]
 ds_read_b64_tr_b16 a[74:75], v8 offset:4096
 buffer_store_dwordx4 v[88:91], v1, s[12:15], s59 offen offset:0 sc1
 v_mfma_f32_16x16x32_bf16 v[228:231], a[60:63], a[124:127], v[228:231]
 ds_read_b64_tr_b16 a[76:77], v8 offset:16384
 v_cvt_pk_bf16_f32 v200, v200, v201
 v_mfma_f32_16x16x32_bf16 v[236:239], a[60:63], a[116:119], v[236:239]
 ds_read_b64_tr_b16 a[78:79], v8 offset:20480
 v_xor_b32 v9, 32, v6
 v_mfma_f32_16x16x32_bf16 v[236:239], a[56:59], a[112:115], v[236:239]
 ds_read_b64_tr_b16 a[80:81], v9 offset:0
 v_cvt_pk_bf16_f32 v201, v202, v203
 v_mfma_f32_16x16x32_bf16 v[244:247], a[56:59], a[104:107], v[244:247]
 ds_read_b64_tr_b16 a[82:83], v9 offset:4096
 v_cvt_pk_bf16_f32 v202, v204, v205
 v_mfma_f32_16x16x32_bf16 v[244:247], a[60:63], a[108:111], v[244:247]
 ds_read_b64_tr_b16 a[84:85], v9 offset:16384
 v_cvt_pk_bf16_f32 v203, v206, v207
 v_mfma_f32_16x16x32_bf16 v[252:255], a[60:63], a[100:103], v[252:255]
 s_add_u32 s59, s56, 24576
 ds_read_b64_tr_b16 a[86:87], v9 offset:20480
 v_xor_b32 v10, 65568, v6
 v_mfma_f32_16x16x32_bf16 v[252:255], a[56:59], a[96:99], v[252:255]
 s_waitcnt lgkmcnt(6)
 ds_read_b64_tr_b16 a[88:89], v10 offset:0
 buffer_store_dwordx4 v[96:99], v1, s[12:15], s59 offen offset:1024 sc1
 v_mfma_f32_16x16x32_bf16 v[28:31], a[64:67], a[128:131], 0
 ds_read_b64_tr_b16 a[90:91], v10 offset:4096
 v_cvt_pk_bf16_f32 v208, v208, v209
 v_mfma_f32_16x16x32_bf16 v[28:31], a[68:71], a[136:139], v[28:31]
 ds_read_b64_tr_b16 a[92:93], v10 offset:16384
 v_xor_b32 v7, 64, v6
 v_mfma_f32_16x16x32_bf16 v[28:31], a[72:75], a[144:147], v[28:31]
 s_waitcnt lgkmcnt(7)
 ds_read_b128 a[112:115], v14 offset:0
 ds_read_b64_tr_b16 a[94:95], v10 offset:20480
 v_mfma_f32_16x16x32_bf16 v[28:31], a[76:79], a[152:155], v[28:31]
 ds_read_b64_tr_b16 a[96:97], v7 offset:0
 v_cvt_pk_bf16_f32 v209, v210, v211
 v_mfma_f32_16x16x32_bf16 v[44:47], a[64:67], a[132:135], 0
 ds_read_b128 a[120:123], v3 offset:0
 ds_read_b64_tr_b16 a[98:99], v7 offset:4096
 v_mfma_f32_16x16x32_bf16 v[44:47], a[68:71], a[140:143], v[44:47]
 s_add_u32 s59, s56, 16384
 ds_read_b64_tr_b16 a[100:101], v7 offset:16384
 v_xor_b32 v8, 65600, v6
 v_mfma_f32_16x16x32_bf16 v[44:47], a[72:75], a[148:151], v[44:47]
 ds_read_b128 a[116:119], v14 offset:2048
 ds_read_b64_tr_b16 a[102:103], v7 offset:20480
 buffer_store_dwordx4 v[104:107], v1, s[12:15], s59 offen offset:1024 sc1
 v_mfma_f32_16x16x32_bf16 v[44:47], a[76:79], a[156:159], v[44:47]
 s_waitcnt lgkmcnt(9)
 ds_read_b64_tr_b16 a[104:105], v8 offset:0
 v_cvt_pk_bf16_f32 v210, v212, v213
 v_mfma_f32_16x16x32_bf16 v[52:55], a[80:83], a[128:131], 0
 ds_read_b128 a[124:127], v3 offset:2048
 ds_read_b64_tr_b16 a[106:107], v8 offset:4096
 v_mfma_f32_16x16x32_bf16 v[52:55], a[84:87], a[136:139], v[52:55]
 ds_read_b64_tr_b16 a[108:109], v8 offset:16384
 v_cvt_pk_bf16_f32 v211, v214, v215
 v_mfma_f32_16x16x32_bf16 v[52:55], a[88:91], a[144:147], v[52:55]
 s_waitcnt lgkmcnt(10)
 ds_read_b64_tr_b16 a[110:111], v8 offset:20480
 v_xor_b32 v9, 96, v6
 v_mfma_f32_16x16x32_bf16 v[52:55], a[92:95], a[152:155], v[52:55]
 ds_read_b64_tr_b16 a[64:65], v9 offset:0
 v_cvt_pk_bf16_f32 v216, v216, v217
 v_mfma_f32_16x16x32_bf16 v[60:63], a[80:83], a[132:135], 0
 s_add_u32 s59, s56, 8192
 ds_read_b64_tr_b16 a[66:67], v9 offset:4096
 v_cvt_pk_bf16_f32 v217, v218, v219
 v_mfma_f32_16x16x32_bf16 v[60:63], a[84:87], a[140:143], v[60:63]
 ds_read_b64_tr_b16 a[68:69], v9 offset:16384
 buffer_store_dwordx4 v[112:115], v1, s[12:15], s59 offen offset:1024 sc1
 v_mfma_f32_16x16x32_bf16 v[60:63], a[88:91], a[148:151], v[60:63]
 ds_read_b64_tr_b16 a[70:71], v9 offset:20480
 v_xor_b32 v10, 65632, v6
 v_mfma_f32_16x16x32_bf16 v[60:63], a[92:95], a[156:159], v[60:63]
 s_waitcnt lgkmcnt(6)
 ds_read_b64_tr_b16 a[72:73], v10 offset:0
 v_cvt_pk_bf16_f32 v218, v220, v221
 v_mfma_f32_16x16x32_bf16 v[20:23], a[96:99], a[128:131], 0
 ds_read_b64_tr_b16 a[74:75], v10 offset:4096
 v_cvt_pk_bf16_f32 v219, v222, v223
 v_mfma_f32_16x16x32_bf16 v[20:23], a[100:103], a[136:139], v[20:23]
 s_waitcnt lgkmcnt(8)
 ds_read_b64_tr_b16 a[76:77], v10 offset:16384
 v_xor_b32 v7, 128, v6
 v_mfma_f32_16x16x32_bf16 v[20:23], a[104:107], a[144:147], v[20:23]
 s_waitcnt lgkmcnt(7)
 s_barrier
 ds_read_b64_tr_b16 a[78:79], v10 offset:20480
 v_mfma_f32_16x16x32_bf16 v[20:23], a[108:111], a[152:155], v[20:23]
 s_add_u32 m0, s29, 131072
 ds_read_b64_tr_b16 a[80:81], v7 offset:0
 v_add_u32 v2, 0x80000, v2
 v_mfma_f32_16x16x32_bf16 v[36:39], a[96:99], a[132:135], 0
 ds_read_b64_tr_b16 a[82:83], v7 offset:4096
 buffer_load_dwordx4 v2, s[16:19], 0 offen lds
 v_mfma_f32_16x16x32_bf16 v[36:39], a[100:103], a[140:143], v[36:39]
 ds_read_b64_tr_b16 a[84:85], v7 offset:16384
 v_cvt_pk_bf16_f32 v224, v224, v225
 v_mfma_f32_16x16x32_bf16 v[36:39], a[104:107], a[148:151], v[36:39]
 s_add_u32 s59, s56, 0
 ds_read_b64_tr_b16 a[86:87], v7 offset:20480
 v_xor_b32 v8, 65664, v6
 v_mfma_f32_16x16x32_bf16 v[36:39], a[108:111], a[156:159], v[36:39]
 s_waitcnt lgkmcnt(6)
 ds_read_b64_tr_b16 a[88:89], v8 offset:0
 buffer_store_dwordx4 v[120:123], v1, s[12:15], s59 offen offset:1024 sc1
 v_mfma_f32_16x16x32_bf16 v[68:71], a[64:67], a[128:131], 0
 ds_read_b64_tr_b16 a[90:91], v8 offset:4096
 v_cvt_pk_bf16_f32 v225, v226, v227
 v_mfma_f32_16x16x32_bf16 v[68:71], a[68:71], a[136:139], v[68:71]
 s_add_u32 m0, s29, 135168
 ds_read_b64_tr_b16 a[92:93], v8 offset:16384
 v_cvt_pk_bf16_f32 v226, v228, v229
 v_mfma_f32_16x16x32_bf16 v[68:71], a[72:75], a[144:147], v[68:71]
 s_waitcnt lgkmcnt(7)
 ds_read_b64_tr_b16 a[94:95], v8 offset:20480
 v_xor_b32 v9, 160, v6
 v_mfma_f32_16x16x32_bf16 v[68:71], a[76:79], a[152:155], v[68:71]
 ds_read_b64_tr_b16 a[96:97], v9 offset:0
 buffer_load_dwordx4 v2, s[16:19], s48 offen lds
 v_mfma_f32_16x16x32_bf16 v[76:79], a[64:67], a[132:135], 0
 ds_read_b64_tr_b16 a[98:99], v9 offset:4096
 v_cvt_pk_bf16_f32 v227, v230, v231
 v_mfma_f32_16x16x32_bf16 v[76:79], a[68:71], a[140:143], v[76:79]
 ds_read_b64_tr_b16 a[100:101], v9 offset:16384
 v_cvt_pk_bf16_f32 v232, v232, v233
 v_mfma_f32_16x16x32_bf16 v[76:79], a[72:75], a[148:151], v[76:79]
 s_add_u32 s59, s56, 24576
 ds_read_b64_tr_b16 a[102:103], v9 offset:20480
 v_xor_b32 v10, 65696, v6
 v_mfma_f32_16x16x32_bf16 v[76:79], a[76:79], a[156:159], v[76:79]
 s_waitcnt lgkmcnt(6)
 ds_read_b64_tr_b16 a[104:105], v10 offset:0
 buffer_store_dwordx4 v[128:131], v1, s[12:15], s59 offen offset:2048 sc1
 v_mfma_f32_16x16x32_bf16 v[84:87], a[80:83], a[128:131], 0
 s_add_u32 m0, s29, 139264
 ds_read_b64_tr_b16 a[106:107], v10 offset:4096
 v_cvt_pk_bf16_f32 v233, v234, v235
 v_mfma_f32_16x16x32_bf16 v[84:87], a[84:87], a[136:139], v[84:87]
 ds_read_b64_tr_b16 a[108:109], v10 offset:16384
 buffer_load_dwordx4 v2, s[16:19], s49 offen lds
 v_mfma_f32_16x16x32_bf16 v[84:87], a[88:91], a[144:147], v[84:87]
 s_waitcnt lgkmcnt(7)
 ds_read_b64_tr_b16 a[110:111], v10 offset:20480
 v_xor_b32 v7, 192, v6
 v_mfma_f32_16x16x32_bf16 v[84:87], a[92:95], a[152:155], v[84:87]
 ds_read_b64_tr_b16 a[64:65], v7 offset:0
 v_cvt_pk_bf16_f32 v234, v236, v237
 v_mfma_f32_16x16x32_bf16 v[92:95], a[80:83], a[132:135], 0
 ds_read_b64_tr_b16 a[66:67], v7 offset:4096
 v_cvt_pk_bf16_f32 v235, v238, v239
 v_mfma_f32_16x16x32_bf16 v[92:95], a[84:87], a[140:143], v[92:95]
 ds_read_b64_tr_b16 a[68:69], v7 offset:16384
 v_cvt_pk_bf16_f32 v240, v240, v241
 v_mfma_f32_16x16x32_bf16 v[92:95], a[88:91], a[148:151], v[92:95]
 s_add_u32 m0, s29, 143360
 ds_read_b64_tr_b16 a[70:71], v7 offset:20480
 v_xor_b32 v8, 65728, v6
 v_mfma_f32_16x16x32_bf16 v[92:95], a[92:95], a[156:159], v[92:95]
 s_waitcnt lgkmcnt(6)
 ds_read_b64_tr_b16 a[72:73], v8 offset:0
 buffer_load_dwordx4 v2, s[16:19], s50 offen lds
 v_mfma_f32_16x16x32_bf16 v[100:103], a[96:99], a[128:131], 0
 s_add_u32 s59, s56, 16384
 ds_read_b64_tr_b16 a[74:75], v8 offset:4096
 v_cvt_pk_bf16_f32 v241, v242, v243
 v_mfma_f32_16x16x32_bf16 v[100:103], a[100:103], a[136:139], v[100:103]
 ds_read_b64_tr_b16 a[76:77], v8 offset:16384
 buffer_store_dwordx4 v[136:139], v1, s[12:15], s59 offen offset:2048 sc1
 v_mfma_f32_16x16x32_bf16 v[100:103], a[104:107], a[144:147], v[100:103]
 s_waitcnt lgkmcnt(7)
 ds_read_b64_tr_b16 a[78:79], v8 offset:20480
 v_xor_b32 v9, 224, v6
 v_mfma_f32_16x16x32_bf16 v[100:103], a[108:111], a[152:155], v[100:103]
 s_and_b32 s36, s95, 31
 ds_read_b64_tr_b16 a[80:81], v9 offset:0
 v_cvt_pk_bf16_f32 v242, v244, v245
 v_mfma_f32_16x16x32_bf16 v[108:111], a[96:99], a[132:135], 0
 s_add_u32 m0, s29, 147456
 ds_read_b64_tr_b16 a[82:83], v9 offset:4096
 v_cvt_pk_bf16_f32 v243, v246, v247
 v_mfma_f32_16x16x32_bf16 v[108:111], a[100:103], a[140:143], v[108:111]
 ds_read_b64_tr_b16 a[84:85], v9 offset:16384
 buffer_load_dwordx4 v2, s[16:19], s51 offen lds
 v_mfma_f32_16x16x32_bf16 v[108:111], a[104:107], a[148:151], v[108:111]
 s_add_u32 s59, s56, 8192
 ds_read_b64_tr_b16 a[86:87], v9 offset:20480
 v_xor_b32 v10, 65760, v6
 v_mfma_f32_16x16x32_bf16 v[108:111], a[108:111], a[156:159], v[108:111]
 s_waitcnt lgkmcnt(6)
 ds_read_b64_tr_b16 a[88:89], v10 offset:0
 v_cvt_pk_bf16_f32 v248, v248, v249
 v_mfma_f32_16x16x32_bf16 v[116:119], a[64:67], a[128:131], 0
 ds_read_b64_tr_b16 a[90:91], v10 offset:4096
 buffer_store_dwordx4 v[144:147], v1, s[12:15], s59 offen offset:2048 sc1
 v_mfma_f32_16x16x32_bf16 v[116:119], a[68:71], a[136:139], v[116:119]
 s_add_u32 m0, s29, 151552
 ds_read_b64_tr_b16 a[92:93], v10 offset:16384
 v_cvt_pk_bf16_f32 v249, v250, v251
 v_mfma_f32_16x16x32_bf16 v[116:119], a[72:75], a[144:147], v[116:119]
 s_waitcnt lgkmcnt(7)
 ds_read_b64_tr_b16 a[94:95], v10 offset:20480
 v_xor_b32 v7, 256, v6
 v_mfma_f32_16x16x32_bf16 v[116:119], a[76:79], a[152:155], v[116:119]
 ds_read_b64_tr_b16 a[96:97], v7 offset:0
 buffer_load_dwordx4 v2, s[16:19], s52 offen lds
 v_mfma_f32_16x16x32_bf16 v[124:127], a[64:67], a[132:135], 0
 s_lshr_b32 s37, s95, 5
 ds_read_b64_tr_b16 a[98:99], v7 offset:4096
 v_cvt_pk_bf16_f32 v250, v252, v253
 v_mfma_f32_16x16x32_bf16 v[124:127], a[68:71], a[140:143], v[124:127]
 s_lshl_b32 s38, s3, 4
 ds_read_b64_tr_b16 a[100:101], v7 offset:16384
 v_cvt_pk_bf16_f32 v251, v254, v255
 v_mfma_f32_16x16x32_bf16 v[124:127], a[72:75], a[148:151], v[124:127]
 s_add_u32 s59, s56, 0
 ds_read_b64_tr_b16 a[102:103], v7 offset:20480
 v_xor_b32 v8, 65792, v6
 v_mfma_f32_16x16x32_bf16 v[124:127], a[76:79], a[156:159], v[124:127]
 s_waitcnt lgkmcnt(6)
 ds_read_b64_tr_b16 a[104:105], v8 offset:0
 buffer_store_dwordx4 v[152:155], v1, s[12:15], s59 offen offset:2048 sc1
 v_mfma_f32_16x16x32_bf16 v[132:135], a[80:83], a[128:131], 0
 s_add_u32 m0, s29, 155648
 ds_read_b64_tr_b16 a[106:107], v8 offset:4096
 v_accvgpr_read_b32 v11, a245
 v_mfma_f32_16x16x32_bf16 v[132:135], a[84:87], a[136:139], v[132:135]
 ds_read_b64_tr_b16 a[108:109], v8 offset:16384
 buffer_load_dwordx4 v2, s[16:19], s53 offen lds
 v_mfma_f32_16x16x32_bf16 v[132:135], a[88:91], a[144:147], v[132:135]
 s_waitcnt lgkmcnt(7)
 ds_read_b64_tr_b16 a[110:111], v8 offset:20480
 v_xor_b32 v9, 288, v6
 v_mfma_f32_16x16x32_bf16 v[132:135], a[92:95], a[152:155], v[132:135]
 s_lshl_b32 s39, s36, 6
 ds_read_b64_tr_b16 a[64:65], v9 offset:0
 v_mov_b32 v12, 0
 v_mfma_f32_16x16x32_bf16 v[140:143], a[80:83], a[132:135], 0
 ds_read_b64_tr_b16 a[66:67], v9 offset:4096
 global_load_dword v5, v12, s[90:91] offset:128 sc1
 v_mfma_f32_16x16x32_bf16 v[140:143], a[84:87], a[140:143], v[140:143]
 s_add_u32 s38, s38, s39
 ds_read_b64_tr_b16 a[68:69], v9 offset:16384
 v_and_b32 v12, 11, v0
 v_mfma_f32_16x16x32_bf16 v[140:143], a[88:91], a[148:151], v[140:143]
 s_add_u32 m0, s29, 159744
 ds_read_b64_tr_b16 a[70:71], v9 offset:20480
 v_xor_b32 v10, 65824, v6
 v_mfma_f32_16x16x32_bf16 v[140:143], a[92:95], a[156:159], v[140:143]
 s_waitcnt lgkmcnt(6)
 ds_read_b64_tr_b16 a[72:73], v10 offset:0
 buffer_load_dwordx4 v2, s[16:19], s54 offen lds
 v_mfma_f32_16x16x32_bf16 v[148:151], a[96:99], a[128:131], 0
 s_add_u32 s59, s56, 24576
 ds_read_b64_tr_b16 a[74:75], v10 offset:4096
 v_lshlrev_b32 v12, 2, v12
 v_mfma_f32_16x16x32_bf16 v[148:151], a[100:103], a[136:139], v[148:151]
 ds_read_b64_tr_b16 a[76:77], v10 offset:16384
 buffer_store_dwordx4 v[160:163], v1, s[12:15], s59 offen offset:3072 sc1
 v_mfma_f32_16x16x32_bf16 v[148:151], a[104:107], a[144:147], v[148:151]
 s_waitcnt lgkmcnt(7)
 ds_read_b64_tr_b16 a[78:79], v10 offset:20480
 v_xor_b32 v7, 320, v6
 v_mfma_f32_16x16x32_bf16 v[148:151], a[108:111], a[152:155], v[148:151]
 s_mul_i32 s38, s38, 896
 ds_read_b64_tr_b16 a[80:81], v7 offset:0
 v_and_b32 v14, 15, v0
 v_mfma_f32_16x16x32_bf16 v[156:159], a[96:99], a[132:135], 0
 s_lshl_b32 s39, s37, 7
 ds_read_b64_tr_b16 a[82:83], v7 offset:4096
 v_lshrrev_b32 v3, 4, v0
 v_mfma_f32_16x16x32_bf16 v[156:159], a[100:103], a[140:143], v[156:159]
 s_add_u32 s38, s38, s39
 ds_read_b64_tr_b16 a[84:85], v7 offset:16384
 v_lshlrev_b32 v3, 2, v3
 v_mfma_f32_16x16x32_bf16 v[156:159], a[104:107], a[148:151], v[156:159]
 s_add_u32 s59, s56, 16384
 ds_read_b64_tr_b16 a[86:87], v7 offset:20480
 v_xor_b32 v8, 65856, v6
 v_mfma_f32_16x16x32_bf16 v[156:159], a[108:111], a[156:159], v[156:159]
 s_waitcnt lgkmcnt(6)
 ds_read_b64_tr_b16 a[88:89], v8 offset:0
 v_sub_u32 v14, v14, v3
 v_mfma_f32_16x16x32_bf16 v[164:167], a[64:67], a[128:131], 0
 ds_read_b64_tr_b16 a[90:91], v8 offset:4096
 buffer_store_dwordx4 v[168:171], v1, s[12:15], s59 offen offset:3072 sc1
 v_mfma_f32_16x16x32_bf16 v[164:167], a[68:71], a[136:139], v[164:167]
 s_lshl_b32 s39, s37, 9
 ds_read_b64_tr_b16 a[92:93], v8 offset:16384
 v_lshrrev_b32_e64 v3, 6, s29
 v_mfma_f32_16x16x32_bf16 v[164:167], a[72:75], a[144:147], v[164:167]
 s_waitcnt lgkmcnt(7)
 ds_read_b64_tr_b16 a[94:95], v8 offset:20480
 v_xor_b32 v9, 352, v6
 v_mfma_f32_16x16x32_bf16 v[164:167], a[76:79], a[152:155], v[164:167]
 s_mov_b32 s4, s66
 ds_read_b64_tr_b16 a[96:97], v9 offset:0
 v_add_u32 v14, v3, v14
 v_mfma_f32_16x16x32_bf16 v[172:175], a[64:67], a[132:135], 0
 s_mov_b32 s5, s67
 ds_read_b64_tr_b16 a[98:99], v9 offset:4096
 v_mov_b32 v15, 0xf149f2ca
 v_mfma_f32_16x16x32_bf16 v[172:175], a[68:71], a[140:143], v[172:175]
 s_mov_b32 s6, 1835008
 ds_read_b64_tr_b16 a[100:101], v9 offset:16384
 v_cmp_gt_i32 vcc, 0, v14
 v_mfma_f32_16x16x32_bf16 v[172:175], a[72:75], a[148:151], v[172:175]
 s_add_u32 s59, s56, 8192
 ds_read_b64_tr_b16 a[102:103], v9 offset:20480
 v_xor_b32 v10, 65888, v6
 v_mfma_f32_16x16x32_bf16 v[172:175], a[76:79], a[156:159], v[172:175]
 s_waitcnt lgkmcnt(6)
 ds_read_b64_tr_b16 a[104:105], v10 offset:0
 buffer_store_dwordx4 v[176:179], v1, s[12:15], s59 offen offset:3072 sc1
 v_mfma_f32_16x16x32_bf16 v[180:183], a[80:83], a[128:131], 0
 s_mov_b32 s7, 0x20000
 ds_read_b64_tr_b16 a[106:107], v10 offset:4096
 v_cndmask_b32 v3, 0, v15, vcc
 v_mfma_f32_16x16x32_bf16 v[180:183], a[84:87], a[136:139], v[180:183]
 s_mov_b32 s8, s68
 ds_read_b64_tr_b16 a[108:109], v10 offset:16384
 v_accvgpr_write_b32 a224, v3
 v_mfma_f32_16x16x32_bf16 v[180:183], a[88:91], a[144:147], v[180:183]
 s_waitcnt lgkmcnt(7)
 ds_read_b64_tr_b16 a[110:111], v10 offset:20480
 v_xor_b32 v7, 384, v6
 v_mfma_f32_16x16x32_bf16 v[180:183], a[92:95], a[152:155], v[180:183]
 s_mov_b32 s9, s69
 ds_read_b64_tr_b16 a[64:65], v7 offset:0
 v_cmp_gt_i32 vcc, 1, v14
 v_mfma_f32_16x16x32_bf16 v[188:191], a[80:83], a[132:135], 0
 s_mov_b32 s10, 1835008
 ds_read_b64_tr_b16 a[66:67], v7 offset:4096
 v_cndmask_b32 v3, 0, v15, vcc
 v_mfma_f32_16x16x32_bf16 v[188:191], a[84:87], a[140:143], v[188:191]
 s_mov_b32 s11, 0x20000
 ds_read_b64_tr_b16 a[68:69], v7 offset:16384
 v_accvgpr_write_b32 a225, v3
 v_mfma_f32_16x16x32_bf16 v[188:191], a[88:91], a[148:151], v[188:191]
 s_add_u32 s59, s56, 0
 ds_read_b64_tr_b16 a[70:71], v7 offset:20480
 v_xor_b32 v8, 65920, v6
 v_mfma_f32_16x16x32_bf16 v[188:191], a[92:95], a[156:159], v[188:191]
 s_waitcnt lgkmcnt(6)
 ds_read_b64_tr_b16 a[72:73], v8 offset:0
 buffer_store_dwordx4 v[184:187], v1, s[12:15], s59 offen offset:3072 sc1
 v_mfma_f32_16x16x32_bf16 v[196:199], a[96:99], a[128:131], 0
 s_mov_b32 s20, s70
 ds_read_b64_tr_b16 a[74:75], v8 offset:4096
 v_cmp_gt_i32 vcc, 2, v14
 v_mfma_f32_16x16x32_bf16 v[196:199], a[100:103], a[136:139], v[196:199]
 s_mov_b32 s21, s71
 ds_read_b64_tr_b16 a[76:77], v8 offset:16384
 v_cndmask_b32 v3, 0, v15, vcc
 v_mfma_f32_16x16x32_bf16 v[196:199], a[104:107], a[144:147], v[196:199]
 s_waitcnt lgkmcnt(7)
 ds_read_b64_tr_b16 a[78:79], v8 offset:20480
 v_xor_b32 v9, 416, v6
 v_mfma_f32_16x16x32_bf16 v[196:199], a[108:111], a[152:155], v[196:199]
 s_mov_b32 s22, 3584
 ds_read_b64_tr_b16 a[80:81], v9 offset:0
 v_accvgpr_write_b32 a226, v3
 v_mfma_f32_16x16x32_bf16 v[204:207], a[96:99], a[132:135], 0
 s_mov_b32 s23, 0x20000
 ds_read_b64_tr_b16 a[82:83], v9 offset:4096
 v_cmp_gt_i32 vcc, 3, v14
 v_mfma_f32_16x16x32_bf16 v[204:207], a[100:103], a[140:143], v[204:207]
 ds_read_b64_tr_b16 a[84:85], v9 offset:16384
 v_lshrrev_b32 v120, 3, v0
 v_mfma_f32_16x16x32_bf16 v[204:207], a[104:107], a[148:151], v[204:207]
 s_add_u32 s59, s56, 57344
 ds_read_b64_tr_b16 a[86:87], v9 offset:20480
 v_xor_b32 v10, 65952, v6
 v_mfma_f32_16x16x32_bf16 v[204:207], a[108:111], a[156:159], v[204:207]
 s_waitcnt lgkmcnt(6)
 ds_read_b64_tr_b16 a[88:89], v10 offset:0
 buffer_store_dwordx4 v[192:195], v1, s[12:15], s59 offen offset:2048 sc1
 v_mfma_f32_16x16x32_bf16 v[212:215], a[64:67], a[128:131], 0
 ds_read_b64_tr_b16 a[90:91], v10 offset:4096
 v_mul_u32_u24 v120, 1792, v120
 v_mfma_f32_16x16x32_bf16 v[212:215], a[68:71], a[136:139], v[212:215]
 ds_read_b64_tr_b16 a[92:93], v10 offset:16384
 v_and_b32 v121, 7, v0
 v_mfma_f32_16x16x32_bf16 v[212:215], a[72:75], a[144:147], v[212:215]
 s_waitcnt lgkmcnt(7)
 ds_read_b64_tr_b16 a[94:95], v10 offset:20480
 v_xor_b32 v7, 448, v6
 v_mfma_f32_16x16x32_bf16 v[212:215], a[76:79], a[152:155], v[212:215]
 ds_read_b64_tr_b16 a[96:97], v7 offset:0
 v_lshl_add_u32 v120, v121, 4, v120
 v_mfma_f32_16x16x32_bf16 v[220:223], a[64:67], a[132:135], 0
 ds_read_b64_tr_b16 a[98:99], v7 offset:4096
 v_add_u32 v120, s38, v120
 v_mfma_f32_16x16x32_bf16 v[220:223], a[68:71], a[140:143], v[220:223]
 ds_read_b64_tr_b16 a[100:101], v7 offset:16384
 v_lshlrev_b32 v121, 6, v121
 v_mfma_f32_16x16x32_bf16 v[220:223], a[72:75], a[148:151], v[220:223]
 s_add_u32 s59, s56, 49152
 ds_read_b64_tr_b16 a[102:103], v7 offset:20480
 v_xor_b32 v8, 65984, v6
 v_mfma_f32_16x16x32_bf16 v[220:223], a[76:79], a[156:159], v[220:223]
 s_waitcnt lgkmcnt(6)
 ds_read_b64_tr_b16 a[104:105], v8 offset:0
 buffer_store_dwordx4 v[200:203], v1, s[12:15], s59 offen offset:2048 sc1
 v_mfma_f32_16x16x32_bf16 v[228:231], a[80:83], a[128:131], 0
 ds_read_b64_tr_b16 a[106:107], v8 offset:4096
 v_subrev_u32 v122, 2688, v120
 v_mfma_f32_16x16x32_bf16 v[228:231], a[84:87], a[136:139], v[228:231]
 ds_read_b64_tr_b16 a[108:109], v8 offset:16384
 v_subrev_u32 v123, 1792, v120
 v_mfma_f32_16x16x32_bf16 v[228:231], a[88:91], a[144:147], v[228:231]
 s_waitcnt lgkmcnt(7)
 ds_read_b64_tr_b16 a[110:111], v8 offset:20480
 v_xor_b32 v9, 480, v6
 v_mfma_f32_16x16x32_bf16 v[228:231], a[92:95], a[152:155], v[228:231]
 ds_read_b64_tr_b16 a[64:65], v9 offset:0
 v_subrev_u32 v128, 896, v120
 v_mfma_f32_16x16x32_bf16 v[236:239], a[80:83], a[132:135], 0
 ds_read_b64_tr_b16 a[66:67], v9 offset:4096
 v_cndmask_b32 v3, 0, v15, vcc
 v_mfma_f32_16x16x32_bf16 v[236:239], a[84:87], a[140:143], v[236:239]
 ds_read_b64_tr_b16 a[68:69], v9 offset:16384
 v_accvgpr_write_b32 a227, v3
 v_mfma_f32_16x16x32_bf16 v[236:239], a[88:91], a[148:151], v[236:239]
 s_add_u32 s59, s56, 40960
 ds_read_b64_tr_b16 a[70:71], v9 offset:20480
 v_xor_b32 v10, 66016, v6
 v_mfma_f32_16x16x32_bf16 v[236:239], a[92:95], a[156:159], v[236:239]
 s_waitcnt lgkmcnt(6)
 ds_read_b64_tr_b16 a[72:73], v10 offset:0
 buffer_store_dwordx4 v[208:211], v1, s[12:15], s59 offen offset:2048 sc1
 v_mfma_f32_16x16x32_bf16 v[244:247], a[96:99], a[128:131], 0
 ds_read_b64_tr_b16 a[74:75], v10 offset:4096
 v_cmp_gt_i32 vcc, 16, v14
 v_mfma_f32_16x16x32_bf16 v[244:247], a[100:103], a[136:139], v[244:247]
 s_waitcnt vmcnt(25)
 ds_read_b64_tr_b16 a[76:77], v10 offset:16384
 v_xor_b32 v7, 32768, v6
 v_mfma_f32_16x16x32_bf16 v[244:247], a[104:107], a[144:147], v[244:247]
 s_waitcnt lgkmcnt(7)
 s_barrier
 ds_read_b64_tr_b16 a[78:79], v10 offset:20480
 v_mfma_f32_16x16x32_bf16 v[244:247], a[108:111], a[152:155], v[244:247]
 ds_read_b64_tr_b16 a[80:81], v7 offset:0
 v_cndmask_b32 v3, 0, v15, vcc
 v_mfma_f32_16x16x32_bf16 v[252:255], a[96:99], a[132:135], 0
 ds_read_b64_tr_b16 a[82:83], v7 offset:4096
 v_accvgpr_write_b32 a228, v3
 v_mfma_f32_16x16x32_bf16 v[252:255], a[100:103], a[140:143], v[252:255]
 ds_read_b64_tr_b16 a[84:85], v7 offset:16384
 v_cmp_gt_i32 vcc, 17, v14
 v_mfma_f32_16x16x32_bf16 v[252:255], a[104:107], a[148:151], v[252:255]
 s_add_u32 s59, s56, 32768
 ds_read_b64_tr_b16 a[86:87], v7 offset:20480
 v_xor_b32 v8, 98304, v6
 v_mfma_f32_16x16x32_bf16 v[252:255], a[108:111], a[156:159], v[252:255]
 s_waitcnt lgkmcnt(6)
 ds_read_b64_tr_b16 a[88:89], v8 offset:0
 buffer_store_dwordx4 v[216:219], v1, s[12:15], s59 offen offset:2048 sc1
 v_mfma_f32_16x16x32_bf16 v[16:19], a[64:67], a[128:131], 0
 ds_read_b64_tr_b16 a[90:91], v8 offset:4096
 v_cndmask_b32 v3, 0, v15, vcc
 v_mfma_f32_16x16x32_bf16 v[16:19], a[68:71], a[136:139], v[16:19]
 ds_read_b64_tr_b16 a[92:93], v8 offset:16384
 v_accvgpr_write_b32 a229, v3
 v_mfma_f32_16x16x32_bf16 v[16:19], a[72:75], a[144:147], v[16:19]
 s_waitcnt lgkmcnt(7)
 ds_read_b64_tr_b16 a[94:95], v8 offset:20480
 v_xor_b32 v9, 32800, v6
 v_mfma_f32_16x16x32_bf16 v[16:19], a[76:79], a[152:155], v[16:19]
 ds_read_b64_tr_b16 a[96:97], v9 offset:0
 v_cmp_gt_i32 vcc, 18, v14
 v_mfma_f32_16x16x32_bf16 v[24:27], a[64:67], a[132:135], 0
 s_waitcnt lgkmcnt(9)
 ds_read_b64_tr_b16 a[98:99], v9 offset:4096
 v_cndmask_b32 v3, 0, v15, vcc
 v_mfma_f32_16x16x32_bf16 v[24:27], a[68:71], a[140:143], v[24:27]
 s_barrier
 ds_read_b64_tr_b16 a[100:101], v9 offset:16384
 v_accvgpr_write_b32 a230, v3
 v_mfma_f32_16x16x32_bf16 v[24:27], a[72:75], a[148:151], v[24:27]
 s_add_u32 m0, s29, 0
 ds_read_b64_tr_b16 a[102:103], v9 offset:20480
 v_xor_b32 v10, 98336, v6
 v_mfma_f32_16x16x32_bf16 v[24:27], a[76:79], a[156:159], v[24:27]
 s_waitcnt lgkmcnt(6)
 ds_read_b64_tr_b16 a[104:105], v10 offset:0
 v_add_u32 v2, 0x80000, v2
 v_mfma_f32_16x16x32_bf16 v[28:31], a[80:83], a[160:163], v[28:31]
 ds_read_b64_tr_b16 a[106:107], v10 offset:4096
 buffer_load_dwordx4 v2, s[16:19], 0 offen lds
 v_mfma_f32_16x16x32_bf16 v[28:31], a[84:87], a[168:171], v[28:31]
 s_add_u32 s59, s56, 57344
 ds_read_b64_tr_b16 a[108:109], v10 offset:16384
 v_cmp_gt_i32 vcc, 19, v14
 v_mfma_f32_16x16x32_bf16 v[28:31], a[88:91], a[176:179], v[28:31]
 s_waitcnt lgkmcnt(7)
 ds_read_b64_tr_b16 a[110:111], v10 offset:20480
 v_xor_b32 v7, 32832, v6
 v_mfma_f32_16x16x32_bf16 v[28:31], a[92:95], a[184:187], v[28:31]
 ds_read_b64_tr_b16 a[64:65], v7 offset:0
 buffer_store_dwordx4 v[224:227], v1, s[12:15], s59 offen offset:3072 sc1
 v_mfma_f32_16x16x32_bf16 v[44:47], a[80:83], a[164:167], v[44:47]
 s_add_u32 m0, s29, 4096
 ds_read_b64_tr_b16 a[66:67], v7 offset:4096
 v_add_u32 v4, 4096, v1
 v_mfma_f32_16x16x32_bf16 v[44:47], a[84:87], a[172:175], v[44:47]
 ds_read_b64_tr_b16 a[68:69], v7 offset:16384
 buffer_load_dwordx4 v2, s[16:19], s48 offen lds
 v_mfma_f32_16x16x32_bf16 v[44:47], a[88:91], a[180:183], v[44:47]
 ds_read_b64_tr_b16 a[70:71], v7 offset:20480
 v_xor_b32 v8, 98368, v6
 v_mfma_f32_16x16x32_bf16 v[44:47], a[92:95], a[188:191], v[44:47]
 s_waitcnt lgkmcnt(6)
 ds_read_b64_tr_b16 a[72:73], v8 offset:0
 v_cndmask_b32 v3, 0, v15, vcc
 v_mfma_f32_16x16x32_bf16 v[52:55], a[96:99], a[160:163], v[52:55]
 ds_read_b64_tr_b16 a[74:75], v8 offset:4096
 v_accvgpr_write_b32 a231, v3
 v_mfma_f32_16x16x32_bf16 v[52:55], a[100:103], a[168:171], v[52:55]
 s_add_u32 m0, s29, 8192
 ds_read_b64_tr_b16 a[76:77], v8 offset:16384
 v_cmp_gt_i32 vcc, 32, v14
 v_mfma_f32_16x16x32_bf16 v[52:55], a[104:107], a[176:179], v[52:55]
 s_waitcnt lgkmcnt(7)
 ds_read_b64_tr_b16 a[78:79], v8 offset:20480
 v_xor_b32 v9, 32864, v6
 v_mfma_f32_16x16x32_bf16 v[52:55], a[108:111], a[184:187], v[52:55]
 ds_read_b64_tr_b16 a[80:81], v9 offset:0
 buffer_load_dwordx4 v2, s[16:19], s49 offen lds
 v_mfma_f32_16x16x32_bf16 v[60:63], a[96:99], a[164:167], v[60:63]
 s_add_u32 s59, s56, 49152
 ds_read_b64_tr_b16 a[82:83], v9 offset:4096
 v_cndmask_b32 v3, 0, v15, vcc
 v_mfma_f32_16x16x32_bf16 v[60:63], a[100:103], a[172:175], v[60:63]
 ds_read_b64_tr_b16 a[84:85], v9 offset:16384
 buffer_store_dwordx4 v[232:235], v1, s[12:15], s59 offen offset:3072 sc1
 v_mfma_f32_16x16x32_bf16 v[60:63], a[104:107], a[180:183], v[60:63]
 s_add_u32 m0, s29, 12288
 ds_read_b64_tr_b16 a[86:87], v9 offset:20480
 v_xor_b32 v10, 98400, v6
 v_mfma_f32_16x16x32_bf16 v[60:63], a[108:111], a[188:191], v[60:63]
 s_waitcnt lgkmcnt(6)
 ds_read_b64_tr_b16 a[88:89], v10 offset:0
 v_accvgpr_write_b32 a232, v3
 v_mfma_f32_16x16x32_bf16 v[20:23], a[64:67], a[160:163], v[20:23]
 ds_read_b64_tr_b16 a[90:91], v10 offset:4096
 buffer_load_dwordx4 v2, s[16:19], s50 offen lds
 v_mfma_f32_16x16x32_bf16 v[20:23], a[68:71], a[168:171], v[20:23]
 ds_read_b64_tr_b16 a[92:93], v10 offset:16384
 v_cmp_gt_i32 vcc, 33, v14
 v_mfma_f32_16x16x32_bf16 v[20:23], a[72:75], a[176:179], v[20:23]
 s_waitcnt lgkmcnt(7)
 ds_read_b64_tr_b16 a[94:95], v10 offset:20480
 v_xor_b32 v7, 32896, v6
 v_mfma_f32_16x16x32_bf16 v[20:23], a[76:79], a[184:187], v[20:23]
 ds_read_b64_tr_b16 a[96:97], v7 offset:0
 v_cndmask_b32 v3, 0, v15, vcc
 v_mfma_f32_16x16x32_bf16 v[36:39], a[64:67], a[164:167], v[36:39]
 s_add_u32 m0, s29, 16384
 ds_read_b64_tr_b16 a[98:99], v7 offset:4096
 v_accvgpr_write_b32 a233, v3
 v_mfma_f32_16x16x32_bf16 v[36:39], a[68:71], a[172:175], v[36:39]
 ds_read_b64_tr_b16 a[100:101], v7 offset:16384
 buffer_load_dwordx4 v2, s[16:19], s51 offen lds
 v_mfma_f32_16x16x32_bf16 v[36:39], a[72:75], a[180:183], v[36:39]
 s_add_u32 s59, s56, 40960
 ds_read_b64_tr_b16 a[102:103], v7 offset:20480
 v_xor_b32 v8, 98432, v6
 v_mfma_f32_16x16x32_bf16 v[36:39], a[76:79], a[188:191], v[36:39]
 s_waitcnt lgkmcnt(6)
 ds_read_b64_tr_b16 a[104:105], v8 offset:0
 buffer_store_dwordx4 v[240:243], v1, s[12:15], s59 offen offset:3072 sc1
 v_mfma_f32_16x16x32_bf16 v[68:71], a[80:83], a[160:163], v[68:71]
 ds_read_b64_tr_b16 a[106:107], v8 offset:4096
 v_cmp_gt_i32 vcc, 34, v14
 v_mfma_f32_16x16x32_bf16 v[68:71], a[84:87], a[168:171], v[68:71]
 s_add_u32 m0, s29, 20480
 ds_read_b64_tr_b16 a[108:109], v8 offset:16384
 v_cndmask_b32 v3, 0, v15, vcc
 v_mfma_f32_16x16x32_bf16 v[68:71], a[88:91], a[176:179], v[68:71]
 s_waitcnt lgkmcnt(7)
 ds_read_b64_tr_b16 a[110:111], v8 offset:20480
 v_xor_b32 v9, 32928, v6
 v_mfma_f32_16x16x32_bf16 v[68:71], a[92:95], a[184:187], v[68:71]
 ds_read_b64_tr_b16 a[64:65], v9 offset:0
 buffer_load_dwordx4 v2, s[16:19], s52 offen lds
 v_mfma_f32_16x16x32_bf16 v[76:79], a[80:83], a[164:167], v[76:79]
 ds_read_b64_tr_b16 a[66:67], v9 offset:4096
 v_accvgpr_write_b32 a234, v3
 v_mfma_f32_16x16x32_bf16 v[76:79], a[84:87], a[172:175], v[76:79]
 ds_read_b64_tr_b16 a[68:69], v9 offset:16384
 v_cmp_gt_i32 vcc, 35, v14
 v_mfma_f32_16x16x32_bf16 v[76:79], a[88:91], a[180:183], v[76:79]
 s_add_u32 m0, s29, 24576
 ds_read_b64_tr_b16 a[70:71], v9 offset:20480
 v_xor_b32 v10, 98464, v6
 v_mfma_f32_16x16x32_bf16 v[76:79], a[92:95], a[188:191], v[76:79]
 s_waitcnt lgkmcnt(6)
 ds_read_b64_tr_b16 a[72:73], v10 offset:0
 v_cndmask_b32 v3, 0, v15, vcc
 v_mfma_f32_16x16x32_bf16 v[84:87], a[96:99], a[160:163], v[84:87]
 ds_read_b64_tr_b16 a[74:75], v10 offset:4096
 buffer_load_dwordx4 v2, s[16:19], s53 offen lds
 v_mfma_f32_16x16x32_bf16 v[84:87], a[100:103], a[168:171], v[84:87]
 s_add_u32 s59, s56, 32768
 ds_read_b64_tr_b16 a[76:77], v10 offset:16384
 v_accvgpr_write_b32 a235, v3
 v_mfma_f32_16x16x32_bf16 v[84:87], a[104:107], a[176:179], v[84:87]
 s_waitcnt lgkmcnt(7)
 ds_read_b64_tr_b16 a[78:79], v10 offset:20480
 v_xor_b32 v7, 32960, v6
 v_mfma_f32_16x16x32_bf16 v[84:87], a[108:111], a[184:187], v[84:87]
 ds_read_b64_tr_b16 a[80:81], v7 offset:0
 buffer_store_dwordx4 v[248:251], v1, s[12:15], s59 offen offset:3072 sc1
 v_mfma_f32_16x16x32_bf16 v[92:95], a[96:99], a[164:167], v[92:95]
 s_add_u32 m0, s29, 28672
 ds_read_b64_tr_b16 a[82:83], v7 offset:4096
 v_cmp_gt_i32 vcc, 48, v14
 v_mfma_f32_16x16x32_bf16 v[92:95], a[100:103], a[172:175], v[92:95]
 ds_read_b64_tr_b16 a[84:85], v7 offset:16384
 buffer_load_dwordx4 v2, s[16:19], s54 offen lds
 v_mfma_f32_16x16x32_bf16 v[92:95], a[104:107], a[180:183], v[92:95]
 ds_read_b64_tr_b16 a[86:87], v7 offset:20480
 v_xor_b32 v8, 98496, v6
 v_mfma_f32_16x16x32_bf16 v[92:95], a[108:111], a[188:191], v[92:95]
 s_waitcnt lgkmcnt(6)
 ds_read_b64_tr_b16 a[88:89], v8 offset:0
 v_cndmask_b32 v3, 0, v15, vcc
 v_mfma_f32_16x16x32_bf16 v[100:103], a[64:67], a[160:163], v[100:103]
 s_add_u32 m0, s29, 65536
 ds_read_b64_tr_b16 a[90:91], v8 offset:4096
 v_add_u32 v2, 0x80000, v2
 v_mfma_f32_16x16x32_bf16 v[100:103], a[68:71], a[168:171], v[100:103]
 ds_read_b64_tr_b16 a[92:93], v8 offset:16384
 buffer_load_dwordx4 v2, s[16:19], 0 offen lds
 v_mfma_f32_16x16x32_bf16 v[100:103], a[72:75], a[176:179], v[100:103]
 s_waitcnt lgkmcnt(7)
 ds_read_b64_tr_b16 a[94:95], v8 offset:20480
 v_xor_b32 v9, 32992, v6
 v_mfma_f32_16x16x32_bf16 v[100:103], a[76:79], a[184:187], v[100:103]
 ds_read_b64_tr_b16 a[96:97], v9 offset:0
 v_accvgpr_write_b32 a236, v3
 v_mfma_f32_16x16x32_bf16 v[108:111], a[64:67], a[164:167], v[108:111]
 ds_read_b64_tr_b16 a[98:99], v9 offset:4096
 v_cmp_gt_i32 vcc, 49, v14
 v_mfma_f32_16x16x32_bf16 v[108:111], a[68:71], a[172:175], v[108:111]
 ds_read_b64_tr_b16 a[100:101], v9 offset:16384
 v_cndmask_b32 v3, 0, v15, vcc
 v_mfma_f32_16x16x32_bf16 v[108:111], a[72:75], a[180:183], v[108:111]
 s_add_u32 m0, s29, 69632
 ds_read_b64_tr_b16 a[102:103], v9 offset:20480
 v_xor_b32 v10, 98528, v6
 v_mfma_f32_16x16x32_bf16 v[108:111], a[76:79], a[188:191], v[108:111]
 s_waitcnt lgkmcnt(6)
 ds_read_b64_tr_b16 a[104:105], v10 offset:0
 buffer_load_dwordx4 v2, s[16:19], s48 offen lds
 v_mfma_f32_16x16x32_bf16 v[116:119], a[80:83], a[160:163], v[116:119]
 ds_read_b64_tr_b16 a[106:107], v10 offset:4096
 v_accvgpr_write_b32 a237, v3
 v_mfma_f32_16x16x32_bf16 v[116:119], a[84:87], a[168:171], v[116:119]
 ds_read_b64_tr_b16 a[108:109], v10 offset:16384
 v_cmp_gt_i32 vcc, 50, v14
 v_mfma_f32_16x16x32_bf16 v[116:119], a[88:91], a[176:179], v[116:119]
 s_waitcnt lgkmcnt(7)
 ds_read_b64_tr_b16 a[110:111], v10 offset:20480
 v_xor_b32 v7, 33024, v6
 v_mfma_f32_16x16x32_bf16 v[116:119], a[92:95], a[184:187], v[116:119]
 s_add_u32 m0, s29, 73728
 ds_read_b64_tr_b16 a[64:65], v7 offset:0
 v_cndmask_b32 v3, 0, v15, vcc
 v_mfma_f32_16x16x32_bf16 v[124:127], a[80:83], a[164:167], v[124:127]
 ds_read_b64_tr_b16 a[66:67], v7 offset:4096
 buffer_load_dwordx4 v2, s[16:19], s49 offen lds
 v_mfma_f32_16x16x32_bf16 v[124:127], a[84:87], a[172:175], v[124:127]
 ds_read_b64_tr_b16 a[68:69], v7 offset:16384
 v_accvgpr_write_b32 a238, v3
 v_mfma_f32_16x16x32_bf16 v[124:127], a[88:91], a[180:183], v[124:127]
 ds_read_b64_tr_b16 a[70:71], v7 offset:20480
 v_xor_b32 v8, 98560, v6
 v_mfma_f32_16x16x32_bf16 v[124:127], a[92:95], a[188:191], v[124:127]
 s_waitcnt lgkmcnt(6)
 ds_read_b64_tr_b16 a[72:73], v8 offset:0
 v_cmp_gt_i32 vcc, 51, v14
 v_mfma_f32_16x16x32_bf16 v[132:135], a[96:99], a[160:163], v[132:135]
 s_add_u32 m0, s29, 77824
 ds_read_b64_tr_b16 a[74:75], v8 offset:4096
 v_cndmask_b32 v3, 0, v15, vcc
 v_mfma_f32_16x16x32_bf16 v[132:135], a[100:103], a[168:171], v[132:135]
 ds_read_b64_tr_b16 a[76:77], v8 offset:16384
 buffer_load_dwordx4 v2, s[16:19], s50 offen lds
 v_mfma_f32_16x16x32_bf16 v[132:135], a[104:107], a[176:179], v[132:135]
 s_waitcnt lgkmcnt(7)
 ds_read_b64_tr_b16 a[78:79], v8 offset:20480
 v_xor_b32 v9, 33056, v6
 v_mfma_f32_16x16x32_bf16 v[132:135], a[108:111], a[184:187], v[132:135]
 ds_read_b64_tr_b16 a[80:81], v9 offset:0
 v_accvgpr_write_b32 a239, v3
 v_mfma_f32_16x16x32_bf16 v[140:143], a[96:99], a[164:167], v[140:143]
 ds_read_b64_tr_b16 a[82:83], v9 offset:4096
 v_mfma_f32_16x16x32_bf16 v[140:143], a[100:103], a[172:175], v[140:143]
 ds_read_b64_tr_b16 a[84:85], v9 offset:16384
 v_mfma_f32_16x16x32_bf16 v[140:143], a[104:107], a[180:183], v[140:143]
 s_add_u32 m0, s29, 81920
 ds_read_b64_tr_b16 a[86:87], v9 offset:20480
 v_xor_b32 v10, 98592, v6
 v_mfma_f32_16x16x32_bf16 v[140:143], a[108:111], a[188:191], v[140:143]
 s_waitcnt lgkmcnt(6)
 ds_read_b64_tr_b16 a[88:89], v10 offset:0
 buffer_load_dwordx4 v2, s[16:19], s51 offen lds
 v_mfma_f32_16x16x32_bf16 v[148:151], a[64:67], a[160:163], v[148:151]
 ds_read_b64_tr_b16 a[90:91], v10 offset:4096
 v_mfma_f32_16x16x32_bf16 v[148:151], a[68:71], a[168:171], v[148:151]
 ds_read_b64_tr_b16 a[92:93], v10 offset:16384
 v_mfma_f32_16x16x32_bf16 v[148:151], a[72:75], a[176:179], v[148:151]
 s_waitcnt lgkmcnt(7)
 ds_read_b64_tr_b16 a[94:95], v10 offset:20480
 v_xor_b32 v7, 33088, v6
 v_mfma_f32_16x16x32_bf16 v[148:151], a[76:79], a[184:187], v[148:151]
 s_add_u32 m0, s29, 86016
 ds_read_b64_tr_b16 a[96:97], v7 offset:0
 v_mfma_f32_16x16x32_bf16 v[156:159], a[64:67], a[164:167], v[156:159]
 ds_read_b64_tr_b16 a[98:99], v7 offset:4096
 buffer_load_dwordx4 v2, s[16:19], s52 offen lds
 v_mfma_f32_16x16x32_bf16 v[156:159], a[68:71], a[172:175], v[156:159]
 ds_read_b64_tr_b16 a[100:101], v7 offset:16384
 v_mfma_f32_16x16x32_bf16 v[156:159], a[72:75], a[180:183], v[156:159]
 ds_read_b64_tr_b16 a[102:103], v7 offset:20480
 v_xor_b32 v8, 98624, v6
 v_mfma_f32_16x16x32_bf16 v[156:159], a[76:79], a[188:191], v[156:159]
 s_waitcnt lgkmcnt(6)
 ds_read_b64_tr_b16 a[104:105], v8 offset:0
 v_mfma_f32_16x16x32_bf16 v[164:167], a[80:83], a[160:163], v[164:167]
 s_add_u32 m0, s29, 90112
 ds_read_b64_tr_b16 a[106:107], v8 offset:4096
 v_mfma_f32_16x16x32_bf16 v[164:167], a[84:87], a[168:171], v[164:167]
 ds_read_b64_tr_b16 a[108:109], v8 offset:16384
 buffer_load_dwordx4 v2, s[16:19], s53 offen lds
 v_mfma_f32_16x16x32_bf16 v[164:167], a[88:91], a[176:179], v[164:167]
 s_waitcnt lgkmcnt(7)
 ds_read_b64_tr_b16 a[110:111], v8 offset:20480
 v_xor_b32 v9, 33120, v6
 v_mfma_f32_16x16x32_bf16 v[164:167], a[92:95], a[184:187], v[164:167]
 s_waitcnt vmcnt(8)
 ds_read_b64_tr_b16 a[64:65], v9 offset:0
 v_mfma_f32_16x16x32_bf16 v[172:175], a[80:83], a[164:167], v[172:175]
 s_barrier
 ds_read_b64_tr_b16 a[66:67], v9 offset:4096
 v_mfma_f32_16x16x32_bf16 v[172:175], a[84:87], a[172:175], v[172:175]
 ds_read_b64_tr_b16 a[68:69], v9 offset:16384
 buffer_store_dword v11, v11, s[12:15], s92 offen sc1
 v_mfma_f32_16x16x32_bf16 v[172:175], a[88:91], a[180:183], v[172:175]
 s_add_u32 m0, s29, 94208
 ds_read_b64_tr_b16 a[70:71], v9 offset:20480
 v_xor_b32 v10, 98656, v6
 v_mfma_f32_16x16x32_bf16 v[172:175], a[92:95], a[188:191], v[172:175]
 s_waitcnt lgkmcnt(6)
 ds_read_b64_tr_b16 a[72:73], v10 offset:0
 buffer_load_dwordx4 v2, s[16:19], s54 offen lds
 v_mfma_f32_16x16x32_bf16 v[180:183], a[96:99], a[160:163], v[180:183]
 ds_read_b64_tr_b16 a[74:75], v10 offset:4096
 v_mfma_f32_16x16x32_bf16 v[180:183], a[100:103], a[168:171], v[180:183]
 ds_read_b64_tr_b16 a[76:77], v10 offset:16384
 v_mfma_f32_16x16x32_bf16 v[180:183], a[104:107], a[176:179], v[180:183]
 s_waitcnt lgkmcnt(7)
 ds_read_b64_tr_b16 a[78:79], v10 offset:20480
 v_xor_b32 v7, 33152, v6
 v_mfma_f32_16x16x32_bf16 v[180:183], a[108:111], a[184:187], v[180:183]
 ds_read_b64_tr_b16 a[80:81], v7 offset:0
 v_mfma_f32_16x16x32_bf16 v[188:191], a[96:99], a[164:167], v[188:191]
 ds_read_b64_tr_b16 a[82:83], v7 offset:4096
 v_mfma_f32_16x16x32_bf16 v[188:191], a[100:103], a[172:175], v[188:191]
 ds_read_b64_tr_b16 a[84:85], v7 offset:16384
 v_mfma_f32_16x16x32_bf16 v[188:191], a[104:107], a[180:183], v[188:191]
 ds_read_b64_tr_b16 a[86:87], v7 offset:20480
 v_xor_b32 v8, 98688, v6
 v_mfma_f32_16x16x32_bf16 v[188:191], a[108:111], a[188:191], v[188:191]
 s_waitcnt lgkmcnt(6)
 ds_read_b64_tr_b16 a[88:89], v8 offset:0
 v_mfma_f32_16x16x32_bf16 v[196:199], a[64:67], a[160:163], v[196:199]
 s_and_b32 s58, s92, ~127
 ds_read_b64_tr_b16 a[90:91], v8 offset:4096
 v_mfma_f32_16x16x32_bf16 v[196:199], a[68:71], a[168:171], v[196:199]
 s_lshl_b32 s37, s25, 1
 ds_read_b64_tr_b16 a[92:93], v8 offset:16384
 v_mfma_f32_16x16x32_bf16 v[196:199], a[72:75], a[176:179], v[196:199]
 s_waitcnt lgkmcnt(7)
 ds_read_b64_tr_b16 a[94:95], v8 offset:20480
 v_xor_b32 v9, 33184, v6
 v_mfma_f32_16x16x32_bf16 v[196:199], a[76:79], a[184:187], v[196:199]
 s_sub_i32 s38, 12, s37
 ds_read_b64_tr_b16 a[96:97], v9 offset:0
 v_mfma_f32_16x16x32_bf16 v[204:207], a[64:67], a[164:167], v[204:207]
 s_max_i32 s38, s38, 0
 ds_read_b64_tr_b16 a[98:99], v9 offset:4096
 v_mfma_f32_16x16x32_bf16 v[204:207], a[68:71], a[172:175], v[204:207]
 s_mul_i32 s49, s26, 1048576
 ds_read_b64_tr_b16 a[100:101], v9 offset:16384
 v_mfma_f32_16x16x32_bf16 v[204:207], a[72:75], a[180:183], v[204:207]
 s_lshl_b32 s50, s3, 13
 ds_read_b64_tr_b16 a[102:103], v9 offset:20480
 v_xor_b32 v10, 98720, v6
 v_mfma_f32_16x16x32_bf16 v[204:207], a[76:79], a[188:191], v[204:207]
 s_waitcnt lgkmcnt(6)
 ds_read_b64_tr_b16 a[104:105], v10 offset:0
 v_mfma_f32_16x16x32_bf16 v[212:215], a[80:83], a[160:163], v[212:215]
 s_add_u32 s49, s49, s50
 ds_read_b64_tr_b16 a[106:107], v10 offset:4096
 v_mfma_f32_16x16x32_bf16 v[212:215], a[84:87], a[168:171], v[212:215]
 s_mov_b32 s54, 0
 ds_read_b64_tr_b16 a[108:109], v10 offset:16384
 v_mfma_f32_16x16x32_bf16 v[212:215], a[88:91], a[176:179], v[212:215]
 s_waitcnt lgkmcnt(7)
 ds_read_b64_tr_b16 a[110:111], v10 offset:20480
 v_xor_b32 v7, 33216, v6
 v_mfma_f32_16x16x32_bf16 v[212:215], a[92:95], a[184:187], v[212:215]
 s_add_u32 s44, s37, 1
 ds_read_b64_tr_b16 a[64:65], v7 offset:0
 v_mfma_f32_16x16x32_bf16 v[220:223], a[80:83], a[164:167], v[220:223]
 s_mov_b32 s42, s49
 ds_read_b64_tr_b16 a[66:67], v7 offset:4096
 v_mfma_f32_16x16x32_bf16 v[220:223], a[84:87], a[172:175], v[220:223]
 s_add_u32 s60, s94, 4
 ds_read_b64_tr_b16 a[68:69], v7 offset:16384
 v_mfma_f32_16x16x32_bf16 v[220:223], a[88:91], a[180:183], v[220:223]
 s_mov_b32 s45, 2
 ds_read_b64_tr_b16 a[70:71], v7 offset:20480
 v_xor_b32 v8, 98752, v6
 v_mfma_f32_16x16x32_bf16 v[220:223], a[92:95], a[188:191], v[220:223]
 s_waitcnt lgkmcnt(6)
 ds_read_b64_tr_b16 a[72:73], v8 offset:0
 buffer_load_dwordx4 v[32:35], v122, s[4:7], 0 offen
 v_mfma_f32_16x16x32_bf16 v[228:231], a[96:99], a[160:163], v[228:231]
 s_mov_b32 s66, 1
 ds_read_b64_tr_b16 a[74:75], v8 offset:4096
 v_mfma_f32_16x16x32_bf16 v[228:231], a[100:103], a[168:171], v[228:231]
 s_mov_b32 s68, 1
 ds_read_b64_tr_b16 a[76:77], v8 offset:16384
 v_mfma_f32_16x16x32_bf16 v[228:231], a[104:107], a[176:179], v[228:231]
 s_waitcnt lgkmcnt(7)
 ds_read_b64_tr_b16 a[78:79], v8 offset:20480
 v_xor_b32 v9, 33248, v6
 v_mfma_f32_16x16x32_bf16 v[228:231], a[108:111], a[184:187], v[228:231]
 ds_read_b64_tr_b16 a[80:81], v9 offset:0
 buffer_load_dwordx4 v[40:43], v123, s[4:7], 0 offen
 v_mfma_f32_16x16x32_bf16 v[236:239], a[96:99], a[164:167], v[236:239]
 s_mov_b32 s70, 32768
 ds_read_b64_tr_b16 a[82:83], v9 offset:4096
 v_mfma_f32_16x16x32_bf16 v[236:239], a[100:103], a[172:175], v[236:239]
 s_mov_b32 s71, s70
 ds_read_b64_tr_b16 a[84:85], v9 offset:16384
 v_mfma_f32_16x16x32_bf16 v[236:239], a[104:107], a[180:183], v[236:239]
 s_add_u32 s43, s42, 16777216
 ds_read_b64_tr_b16 a[86:87], v9 offset:20480
 v_xor_b32 v10, 98784, v6
 v_mfma_f32_16x16x32_bf16 v[236:239], a[108:111], a[188:191], v[236:239]
 s_waitcnt lgkmcnt(6)
 ds_read_b64_tr_b16 a[88:89], v10 offset:0
 buffer_load_dwordx4 v[48:51], v128, s[4:7], 0 offen
 v_mfma_f32_16x16x32_bf16 v[244:247], a[64:67], a[160:163], v[244:247]
 s_mov_b32 s40, s50
 ds_read_b64_tr_b16 a[90:91], v10 offset:4096
 v_mfma_f32_16x16x32_bf16 v[244:247], a[68:71], a[168:171], v[244:247]
 s_waitcnt vmcnt(3)
 ds_read_b64_tr_b16 a[92:93], v10 offset:16384
 v_xor_b32 v7, 131072, v6
 v_mfma_f32_16x16x32_bf16 v[244:247], a[72:75], a[176:179], v[244:247]
 s_waitcnt lgkmcnt(7)
 s_barrier
 ds_read_b64_tr_b16 a[94:95], v10 offset:20480
 v_mfma_f32_16x16x32_bf16 v[244:247], a[76:79], a[184:187], v[244:247]
 ds_read_b64_tr_b16 a[96:97], v7 offset:0
 buffer_load_dwordx4 v[56:59], v120, s[4:7], 0 offen offset:0
 v_mfma_f32_16x16x32_bf16 v[252:255], a[64:67], a[164:167], v[252:255]
 s_add_u32 s41, s50, 0x10000
 ds_read_b64_tr_b16 a[98:99], v7 offset:4096
 v_mfma_f32_16x16x32_bf16 v[252:255], a[68:71], a[172:175], v[252:255]
 s_lshr_b32 s61, s95, 4
 ds_read_b64_tr_b16 a[100:101], v7 offset:16384
 v_mfma_f32_16x16x32_bf16 v[252:255], a[72:75], a[180:183], v[252:255]
 s_lshl_b32 s61, s61, 7
 ds_read_b64_tr_b16 a[102:103], v7 offset:20480
 v_xor_b32 v8, 0, v6
 v_mfma_f32_16x16x32_bf16 v[252:255], a[76:79], a[188:191], v[252:255]
 s_waitcnt lgkmcnt(6)
 ds_read_b64_tr_b16 a[104:105], v8 offset:0
 buffer_load_dwordx4 v[64:67], v120, s[4:7], 0 offen offset:896
 v_mfma_f32_16x16x32_bf16 v[16:19], a[80:83], a[160:163], v[16:19]
 s_add_u32 s61, s61, 84959232
 ds_read_b64_tr_b16 a[106:107], v8 offset:4096
 v_mfma_f32_16x16x32_bf16 v[16:19], a[84:87], a[168:171], v[16:19]
 s_mov_b32 s47, 0x4b800000
 ds_read_b64_tr_b16 a[108:109], v8 offset:16384
 v_mfma_f32_16x16x32_bf16 v[16:19], a[88:91], a[176:179], v[16:19]
 s_waitcnt lgkmcnt(7)
 ds_read_b64_tr_b16 a[110:111], v8 offset:20480
 v_xor_b32 v9, 65536, v6
 v_mfma_f32_16x16x32_bf16 v[16:19], a[92:95], a[184:187], v[16:19]
 ds_read_b64_tr_b16 a[64:65], v9 offset:0
 buffer_load_dwordx4 v[72:75], v120, s[8:11], 0 offen offset:0
 v_mfma_f32_16x16x32_bf16 v[24:27], a[80:83], a[164:167], v[24:27]
 s_lshl_b32 s30, s95, 1
 ds_read_b64_tr_b16 a[66:67], v9 offset:4096
 v_mfma_f32_16x16x32_bf16 v[24:27], a[84:87], a[172:175], v[24:27]
 s_lshr_b32 s31, s3, 1
 ds_read_b64_tr_b16 a[68:69], v9 offset:16384
 v_mfma_f32_16x16x32_bf16 v[24:27], a[88:91], a[180:183], v[24:27]
 s_add_u32 s30, s30, s31
 ds_read_b64_tr_b16 a[70:71], v9 offset:20480
 v_xor_b32 v10, 131104, v6
 v_mfma_f32_16x16x32_bf16 v[24:27], a[92:95], a[188:191], v[24:27]
 s_waitcnt lgkmcnt(6)
 ds_read_b64_tr_b16 a[72:73], v10 offset:0
 buffer_load_dwordx4 v[80:83], v120, s[8:11], 0 offen offset:896
 v_mfma_f32_16x16x32_bf16 v[28:31], a[96:99], a[192:195], v[28:31]
 s_min_u32 s30, s30, 223
 ds_read_b64_tr_b16 a[74:75], v10 offset:4096
 v_mfma_f32_16x16x32_bf16 v[28:31], a[100:103], a[200:203], v[28:31]
 s_lshl_b32 s30, s30, 2
 ds_read_b64_tr_b16 a[76:77], v10 offset:16384
 v_mfma_f32_16x16x32_bf16 v[28:31], a[104:107], a[208:211], v[28:31]
 s_waitcnt lgkmcnt(3)
 ds_read_b64_tr_b16 a[78:79], v10 offset:20480
 v_xor_b32 v7, 32, v6
 v_mfma_f32_16x16x32_bf16 v[28:31], a[108:111], a[216:219], v[28:31]
 ds_read_b64_tr_b16 a[80:81], v7 offset:0
 buffer_load_dwordx4 v[88:91], v121, s[20:23], s39 offen offset:0
 v_mfma_f32_16x16x32_bf16 v[28:31], a[64:67], a[112:115], v[28:31]
 ds_read_b64_tr_b16 a[82:83], v7 offset:4096
 v_mfma_f32_16x16x32_bf16 v[28:31], a[68:71], a[120:123], v[28:31]
 ds_read_b64_tr_b16 a[84:85], v7 offset:16384
 v_mfma_f32_16x16x32_bf16 v[44:47], a[96:99], a[196:199], v[44:47]
 ds_read_b64_tr_b16 a[86:87], v7 offset:20480
 v_xor_b32 v8, 65568, v6
 v_mfma_f32_16x16x32_bf16 v[44:47], a[100:103], a[204:207], v[44:47]
 ds_read_b64_tr_b16 a[88:89], v8 offset:0
 buffer_load_dwordx4 v[96:99], v121, s[20:23], s39 offen offset:16
 v_mfma_f32_16x16x32_bf16 v[44:47], a[104:107], a[212:215], v[44:47]
 ds_read_b64_tr_b16 a[90:91], v8 offset:4096
 v_mfma_f32_16x16x32_bf16 v[44:47], a[108:111], a[220:223], v[44:47]
 ds_read_b64_tr_b16 a[92:93], v8 offset:16384
 v_mfma_f32_16x16x32_bf16 v[44:47], a[64:67], a[116:119], v[44:47]
 ds_read_b64_tr_b16 a[94:95], v8 offset:20480
 v_xor_b32 v9, 131136, v6
 v_mfma_f32_16x16x32_bf16 v[44:47], a[68:71], a[124:127], v[44:47]
 s_waitcnt lgkmcnt(6)
 ds_read_b64_tr_b16 a[96:97], v9 offset:0
 buffer_load_dwordx4 v[104:107], v121, s[20:23], s39 offen offset:32
 v_mfma_f32_16x16x32_bf16 v[52:55], a[72:75], a[192:195], v[52:55]
 ds_read_b64_tr_b16 a[98:99], v9 offset:4096
 v_mfma_f32_16x16x32_bf16 v[52:55], a[76:79], a[200:203], v[52:55]
 ds_read_b64_tr_b16 a[100:101], v9 offset:16384
 v_mfma_f32_16x16x32_bf16 v[52:55], a[80:83], a[208:211], v[52:55]
 s_waitcnt lgkmcnt(3)
 ds_read_b64_tr_b16 a[102:103], v9 offset:20480
 v_xor_b32 v10, 64, v6
 v_mfma_f32_16x16x32_bf16 v[52:55], a[84:87], a[216:219], v[52:55]
 ds_read_b64_tr_b16 a[104:105], v10 offset:0
 buffer_load_dwordx4 v[112:115], v121, s[20:23], s39 offen offset:48
 v_mfma_f32_16x16x32_bf16 v[52:55], a[88:91], a[112:115], v[52:55]
 ds_read_b64_tr_b16 a[106:107], v10 offset:4096
 v_mfma_f32_16x16x32_bf16 v[52:55], a[92:95], a[120:123], v[52:55]
 ds_read_b64_tr_b16 a[108:109], v10 offset:16384
 v_mfma_f32_16x16x32_bf16 v[60:63], a[72:75], a[196:199], v[60:63]
 ds_read_b64_tr_b16 a[110:111], v10 offset:20480
 v_xor_b32 v7, 65600, v6
 v_mfma_f32_16x16x32_bf16 v[60:63], a[76:79], a[204:207], v[60:63]
 ds_read_b64_tr_b16 a[64:65], v7 offset:0
 v_mfma_f32_16x16x32_bf16 v[60:63], a[80:83], a[212:215], v[60:63]
 s_and_b32 s4, s2, 127
 ds_read_b64_tr_b16 a[66:67], v7 offset:4096
 v_mfma_f32_16x16x32_bf16 v[60:63], a[84:87], a[220:223], v[60:63]
 s_lshl_b32 s4, s4, 2
 ds_read_b64_tr_b16 a[68:69], v7 offset:16384
 v_mfma_f32_16x16x32_bf16 v[60:63], a[88:91], a[116:119], v[60:63]
 s_add_u32 s4, s4, s3
 ds_read_b64_tr_b16 a[70:71], v7 offset:20480
 v_xor_b32 v8, 131168, v6
 v_mfma_f32_16x16x32_bf16 v[60:63], a[92:95], a[124:127], v[60:63]
 s_waitcnt lgkmcnt(6)
 ds_read_b64_tr_b16 a[72:73], v8 offset:0
 v_mfma_f32_16x16x32_bf16 v[20:23], a[96:99], a[192:195], v[20:23]
 s_mul_i32 s5, s4, 17408
 ds_read_b64_tr_b16 a[74:75], v8 offset:4096
 v_mfma_f32_16x16x32_bf16 v[20:23], a[100:103], a[200:203], v[20:23]
 s_add_u32 s5, s5, 50331648
 ds_read_b64_tr_b16 a[76:77], v8 offset:16384
 v_mul_f32 v28, s34, v28
 v_mfma_f32_16x16x32_bf16 v[20:23], a[104:107], a[208:211], v[20:23]
 s_waitcnt lgkmcnt(3)
 ds_read_b64_tr_b16 a[78:79], v8 offset:20480
 v_xor_b32 v9, 96, v6
 v_mfma_f32_16x16x32_bf16 v[20:23], a[108:111], a[216:219], v[20:23]
 s_add_u32 s4, s5, 0x2000
 ds_read_b64_tr_b16 a[80:81], v9 offset:0
 v_mul_f32 v29, s34, v29
 v_mfma_f32_16x16x32_bf16 v[20:23], a[64:67], a[112:115], v[20:23]
 s_mov_b32 s6, 2.0
 ds_read_b64_tr_b16 a[82:83], v9 offset:4096
 v_mul_f32 v30, s34, v30
 v_mfma_f32_16x16x32_bf16 v[20:23], a[68:71], a[120:123], v[20:23]
 s_min_u32 s7, s38, 1
 ds_read_b64_tr_b16 a[84:85], v9 offset:16384
 v_mul_f32 v31, s34, v31
 v_mfma_f32_16x16x32_bf16 v[36:39], a[96:99], a[196:199], v[36:39]
 s_cmp_eq_u32 s44, 1
 s_cselect_b32 s53, 1, 0
 ds_read_b64_tr_b16 a[86:87], v9 offset:20480
 v_xor_b32 v10, 65632, v6
 v_mfma_f32_16x16x32_bf16 v[36:39], a[100:103], a[204:207], v[36:39]
 s_cmp_eq_u32 s38, 0
 s_cmov_b32 s4, 2.0
 ds_read_b64_tr_b16 a[88:89], v10 offset:0
 v_mfma_f32_16x16x32_bf16 v[36:39], a[104:107], a[212:215], v[36:39]
 s_cmp_eq_u32 s38, 0
 s_cmov_b32 s5, 2.0
 ds_read_b64_tr_b16 a[90:91], v10 offset:4096
 v_mfma_f32_16x16x32_bf16 v[36:39], a[108:111], a[220:223], v[36:39]
 s_cmp_eq_u32 s38, 0
 s_cmov_b32 s60, s58
 ds_read_b64_tr_b16 a[92:93], v10 offset:16384
 v_mfma_f32_16x16x32_bf16 v[36:39], a[64:67], a[116:119], v[36:39]
 s_mov_b64 s[8:9], s[12:13]
 ds_read_b64_tr_b16 a[94:95], v10 offset:20480
 v_xor_b32 v7, 131200, v6
 v_mfma_f32_16x16x32_bf16 v[36:39], a[68:71], a[124:127], v[36:39]
 s_waitcnt lgkmcnt(6)
 ds_read_b64_tr_b16 a[96:97], v7 offset:0
 v_mul_f32 v52, s34, v52
 v_mfma_f32_16x16x32_bf16 v[68:71], a[72:75], a[192:195], v[68:71]
 s_mov_b32 s10, s14
 ds_read_b64_tr_b16 a[98:99], v7 offset:4096
 v_mul_f32 v53, s34, v53
 v_mfma_f32_16x16x32_bf16 v[68:71], a[76:79], a[200:203], v[68:71]
 s_mov_b32 s76, 0
 ds_read_b64_tr_b16 a[100:101], v7 offset:16384
 v_mul_f32 v54, s34, v54
 v_mfma_f32_16x16x32_bf16 v[68:71], a[80:83], a[208:211], v[68:71]
 s_waitcnt lgkmcnt(3)
 ds_read_b64_tr_b16 a[102:103], v7 offset:20480
 v_xor_b32 v8, 128, v6
 v_mfma_f32_16x16x32_bf16 v[68:71], a[84:87], a[216:219], v[68:71]
 s_movk_i32 s77, 0x1000
 ds_read_b64_tr_b16 a[104:105], v8 offset:0
 v_mul_f32 v55, s34, v55
 v_mfma_f32_16x16x32_bf16 v[68:71], a[88:91], a[112:115], v[68:71]
 s_mov_b32 s51, 0
 ds_read_b64_tr_b16 a[106:107], v8 offset:4096
 v_cvt_pk_bf16_f32 v28, v28, v29
 v_mfma_f32_16x16x32_bf16 v[68:71], a[92:95], a[120:123], v[68:71]
 s_mul_i32 s78, s26, 229376
 ds_read_b64_tr_b16 a[108:109], v8 offset:16384
 v_cvt_pk_bf16_f32 v29, v30, v31
 v_mfma_f32_16x16x32_bf16 v[76:79], a[72:75], a[196:199], v[76:79]
 s_add_u32 s79, s78, 28672
 ds_read_b64_tr_b16 a[110:111], v8 offset:20480
 v_xor_b32 v9, 65664, v6
 v_mfma_f32_16x16x32_bf16 v[76:79], a[76:79], a[204:207], v[76:79]
 s_add_u32 s80, s78, 57344
 ds_read_b64_tr_b16 a[64:65], v9 offset:0
 v_cvt_pk_bf16_f32 v30, v52, v53
 v_mfma_f32_16x16x32_bf16 v[76:79], a[80:83], a[212:215], v[76:79]
 s_add_u32 s81, s78, 86016
 ds_read_b64_tr_b16 a[66:67], v9 offset:4096
 v_cvt_pk_bf16_f32 v31, v54, v55
 v_mfma_f32_16x16x32_bf16 v[76:79], a[84:87], a[220:223], v[76:79]
 s_add_u32 s82, s78, 114688
 ds_read_b64_tr_b16 a[68:69], v9 offset:16384
 v_accvgpr_write_b32 a0, v28
 v_mfma_f32_16x16x32_bf16 v[76:79], a[88:91], a[116:119], v[76:79]
 s_add_u32 s83, s78, 143360
 ds_read_b64_tr_b16 a[70:71], v9 offset:20480
 v_xor_b32 v10, 131232, v6
 v_mfma_f32_16x16x32_bf16 v[76:79], a[92:95], a[124:127], v[76:79]
 s_waitcnt lgkmcnt(6)
 ds_read_b64_tr_b16 a[72:73], v10 offset:0
 v_accvgpr_write_b32 a1, v29
 v_mfma_f32_16x16x32_bf16 v[84:87], a[96:99], a[192:195], v[84:87]
 s_add_u32 s84, s78, 172032
 ds_read_b64_tr_b16 a[74:75], v10 offset:4096
 v_accvgpr_write_b32 a2, v30
 v_mfma_f32_16x16x32_bf16 v[84:87], a[100:103], a[200:203], v[84:87]
 s_add_u32 s85, s78, 200704
 ds_read_b64_tr_b16 a[76:77], v10 offset:16384
 v_accvgpr_write_b32 a3, v31
 v_mfma_f32_16x16x32_bf16 v[84:87], a[104:107], a[208:211], v[84:87]
 s_waitcnt lgkmcnt(3)
 ds_read_b64_tr_b16 a[78:79], v10 offset:20480
 v_xor_b32 v7, 160, v6
 v_mfma_f32_16x16x32_bf16 v[84:87], a[108:111], a[216:219], v[84:87]
 ds_read_b64_tr_b16 a[80:81], v7 offset:0
 v_mul_f32 v44, s34, v44
 v_mfma_f32_16x16x32_bf16 v[84:87], a[64:67], a[112:115], v[84:87]
 ds_read_b64_tr_b16 a[82:83], v7 offset:4096
 v_mul_f32 v45, s34, v45
 v_mfma_f32_16x16x32_bf16 v[84:87], a[68:71], a[120:123], v[84:87]
 ds_read_b64_tr_b16 a[84:85], v7 offset:16384
 v_mul_f32 v46, s34, v46
 v_mfma_f32_16x16x32_bf16 v[92:95], a[96:99], a[196:199], v[92:95]
 ds_read_b64_tr_b16 a[86:87], v7 offset:20480
 v_xor_b32 v8, 65696, v6
 v_mfma_f32_16x16x32_bf16 v[92:95], a[100:103], a[204:207], v[92:95]
 ds_read_b64_tr_b16 a[88:89], v8 offset:0
 v_mul_f32 v47, s34, v47
 v_mfma_f32_16x16x32_bf16 v[92:95], a[104:107], a[212:215], v[92:95]
 ds_read_b64_tr_b16 a[90:91], v8 offset:4096
 v_mul_f32 v60, s34, v60
 v_mfma_f32_16x16x32_bf16 v[92:95], a[108:111], a[220:223], v[92:95]
 ds_read_b64_tr_b16 a[92:93], v8 offset:16384
 v_mul_f32 v61, s34, v61
 v_mfma_f32_16x16x32_bf16 v[92:95], a[64:67], a[116:119], v[92:95]
 ds_read_b64_tr_b16 a[94:95], v8 offset:20480
 v_xor_b32 v9, 131264, v6
 v_mfma_f32_16x16x32_bf16 v[92:95], a[68:71], a[124:127], v[92:95]
 s_waitcnt lgkmcnt(6)
 ds_read_b64_tr_b16 a[96:97], v9 offset:0
 v_mul_f32 v62, s34, v62
 v_mfma_f32_16x16x32_bf16 v[100:103], a[72:75], a[192:195], v[100:103]
 ds_read_b64_tr_b16 a[98:99], v9 offset:4096
 v_mul_f32 v63, s34, v63
 v_mfma_f32_16x16x32_bf16 v[100:103], a[76:79], a[200:203], v[100:103]
 ds_read_b64_tr_b16 a[100:101], v9 offset:16384
 v_cvt_pk_bf16_f32 v44, v44, v45
 v_mfma_f32_16x16x32_bf16 v[100:103], a[80:83], a[208:211], v[100:103]
 s_waitcnt lgkmcnt(3)
 ds_read_b64_tr_b16 a[102:103], v9 offset:20480
 v_xor_b32 v10, 192, v6
 v_mfma_f32_16x16x32_bf16 v[100:103], a[84:87], a[216:219], v[100:103]
 ds_read_b64_tr_b16 a[104:105], v10 offset:0
 v_cvt_pk_bf16_f32 v45, v46, v47
 v_mfma_f32_16x16x32_bf16 v[100:103], a[88:91], a[112:115], v[100:103]
 ds_read_b64_tr_b16 a[106:107], v10 offset:4096
 v_cvt_pk_bf16_f32 v46, v60, v61
 v_mfma_f32_16x16x32_bf16 v[100:103], a[92:95], a[120:123], v[100:103]
 ds_read_b64_tr_b16 a[108:109], v10 offset:16384
 v_cvt_pk_bf16_f32 v47, v62, v63
 v_mfma_f32_16x16x32_bf16 v[108:111], a[72:75], a[196:199], v[108:111]
 ds_read_b64_tr_b16 a[110:111], v10 offset:20480
 v_xor_b32 v7, 65728, v6
 v_mfma_f32_16x16x32_bf16 v[108:111], a[76:79], a[204:207], v[108:111]
 ds_read_b64_tr_b16 a[64:65], v7 offset:0
 v_accvgpr_write_b32 a32, v44
 v_mfma_f32_16x16x32_bf16 v[108:111], a[80:83], a[212:215], v[108:111]
 ds_read_b64_tr_b16 a[66:67], v7 offset:4096
 v_accvgpr_write_b32 a33, v45
 v_mfma_f32_16x16x32_bf16 v[108:111], a[84:87], a[220:223], v[108:111]
 ds_read_b64_tr_b16 a[68:69], v7 offset:16384
 v_accvgpr_write_b32 a34, v46
 v_mfma_f32_16x16x32_bf16 v[108:111], a[88:91], a[116:119], v[108:111]
 ds_read_b64_tr_b16 a[70:71], v7 offset:20480
 v_xor_b32 v8, 131296, v6
 v_mfma_f32_16x16x32_bf16 v[108:111], a[92:95], a[124:127], v[108:111]
 s_waitcnt lgkmcnt(6)
 ds_read_b64_tr_b16 a[72:73], v8 offset:0
 v_accvgpr_write_b32 a35, v47
 v_mfma_f32_16x16x32_bf16 v[116:119], a[96:99], a[192:195], v[116:119]
 ds_read_b64_tr_b16 a[74:75], v8 offset:4096
 v_mul_f32 v20, s34, v20
 v_mfma_f32_16x16x32_bf16 v[116:119], a[100:103], a[200:203], v[116:119]
 ds_read_b64_tr_b16 a[76:77], v8 offset:16384
 v_mul_f32 v21, s34, v21
 v_mfma_f32_16x16x32_bf16 v[116:119], a[104:107], a[208:211], v[116:119]
 s_waitcnt lgkmcnt(3)
 ds_read_b64_tr_b16 a[78:79], v8 offset:20480
 v_xor_b32 v9, 224, v6
 v_mfma_f32_16x16x32_bf16 v[116:119], a[108:111], a[216:219], v[116:119]
 ds_read_b64_tr_b16 a[80:81], v9 offset:0
 v_mul_f32 v22, s34, v22
 v_mfma_f32_16x16x32_bf16 v[116:119], a[64:67], a[112:115], v[116:119]
 ds_read_b64_tr_b16 a[82:83], v9 offset:4096
 v_mul_f32 v23, s34, v23
 v_mfma_f32_16x16x32_bf16 v[116:119], a[68:71], a[120:123], v[116:119]
 ds_read_b64_tr_b16 a[84:85], v9 offset:16384
 v_mul_f32 v68, s34, v68
 v_mfma_f32_16x16x32_bf16 v[124:127], a[96:99], a[196:199], v[124:127]
 ds_read_b64_tr_b16 a[86:87], v9 offset:20480
 v_xor_b32 v10, 65760, v6
 v_mfma_f32_16x16x32_bf16 v[124:127], a[100:103], a[204:207], v[124:127]
 ds_read_b64_tr_b16 a[88:89], v10 offset:0
 v_mul_f32 v69, s34, v69
 v_mfma_f32_16x16x32_bf16 v[124:127], a[104:107], a[212:215], v[124:127]
 ds_read_b64_tr_b16 a[90:91], v10 offset:4096
 v_mul_f32 v70, s34, v70
 v_mfma_f32_16x16x32_bf16 v[124:127], a[108:111], a[220:223], v[124:127]
 ds_read_b64_tr_b16 a[92:93], v10 offset:16384
 v_mul_f32 v71, s34, v71
 v_mfma_f32_16x16x32_bf16 v[124:127], a[64:67], a[116:119], v[124:127]
 ds_read_b64_tr_b16 a[94:95], v10 offset:20480
 v_xor_b32 v7, 131328, v6
 v_mfma_f32_16x16x32_bf16 v[124:127], a[68:71], a[124:127], v[124:127]
 s_waitcnt lgkmcnt(6)
 ds_read_b64_tr_b16 a[96:97], v7 offset:0
 v_cvt_pk_bf16_f32 v20, v20, v21
 v_mfma_f32_16x16x32_bf16 v[132:135], a[72:75], a[192:195], v[132:135]
 ds_read_b64_tr_b16 a[98:99], v7 offset:4096
 v_cvt_pk_bf16_f32 v21, v22, v23
 v_mfma_f32_16x16x32_bf16 v[132:135], a[76:79], a[200:203], v[132:135]
 ds_read_b64_tr_b16 a[100:101], v7 offset:16384
 v_cvt_pk_bf16_f32 v22, v68, v69
 v_mfma_f32_16x16x32_bf16 v[132:135], a[80:83], a[208:211], v[132:135]
 s_waitcnt lgkmcnt(3)
 ds_read_b64_tr_b16 a[102:103], v7 offset:20480
 v_xor_b32 v8, 256, v6
 v_mfma_f32_16x16x32_bf16 v[132:135], a[84:87], a[216:219], v[132:135]
 ds_read_b64_tr_b16 a[104:105], v8 offset:0
 v_cvt_pk_bf16_f32 v23, v70, v71
 v_mfma_f32_16x16x32_bf16 v[132:135], a[88:91], a[112:115], v[132:135]
 ds_read_b64_tr_b16 a[106:107], v8 offset:4096
 v_accvgpr_write_b32 a4, v20
 v_mfma_f32_16x16x32_bf16 v[132:135], a[92:95], a[120:123], v[132:135]
 ds_read_b64_tr_b16 a[108:109], v8 offset:16384
 v_accvgpr_write_b32 a5, v21
 v_mfma_f32_16x16x32_bf16 v[140:143], a[72:75], a[196:199], v[140:143]
 ds_read_b64_tr_b16 a[110:111], v8 offset:20480
 v_xor_b32 v9, 65792, v6
 v_mfma_f32_16x16x32_bf16 v[140:143], a[76:79], a[204:207], v[140:143]
 ds_read_b64_tr_b16 a[64:65], v9 offset:0
 v_accvgpr_write_b32 a6, v22
 v_mfma_f32_16x16x32_bf16 v[140:143], a[80:83], a[212:215], v[140:143]
 ds_read_b64_tr_b16 a[66:67], v9 offset:4096
 v_accvgpr_write_b32 a7, v23
 v_mfma_f32_16x16x32_bf16 v[140:143], a[84:87], a[220:223], v[140:143]
 ds_read_b64_tr_b16 a[68:69], v9 offset:16384
 v_mul_f32 v36, s34, v36
 v_mfma_f32_16x16x32_bf16 v[140:143], a[88:91], a[116:119], v[140:143]
 ds_read_b64_tr_b16 a[70:71], v9 offset:20480
 v_xor_b32 v10, 131360, v6
 v_mfma_f32_16x16x32_bf16 v[140:143], a[92:95], a[124:127], v[140:143]
 s_waitcnt lgkmcnt(6)
 ds_read_b64_tr_b16 a[72:73], v10 offset:0
 v_mul_f32 v37, s34, v37
 v_mfma_f32_16x16x32_bf16 v[148:151], a[96:99], a[192:195], v[148:151]
 ds_read_b64_tr_b16 a[74:75], v10 offset:4096
 v_mul_f32 v38, s34, v38
 v_mfma_f32_16x16x32_bf16 v[148:151], a[100:103], a[200:203], v[148:151]
 ds_read_b64_tr_b16 a[76:77], v10 offset:16384
 v_mul_f32 v39, s34, v39
 v_mfma_f32_16x16x32_bf16 v[148:151], a[104:107], a[208:211], v[148:151]
 s_waitcnt lgkmcnt(3)
 ds_read_b64_tr_b16 a[78:79], v10 offset:20480
 v_xor_b32 v7, 288, v6
 v_mfma_f32_16x16x32_bf16 v[148:151], a[108:111], a[216:219], v[148:151]
 ds_read_b64_tr_b16 a[80:81], v7 offset:0
 v_mul_f32 v76, s34, v76
 v_mfma_f32_16x16x32_bf16 v[148:151], a[64:67], a[112:115], v[148:151]
 ds_read_b64_tr_b16 a[82:83], v7 offset:4096
 v_mul_f32 v77, s34, v77
 v_mfma_f32_16x16x32_bf16 v[148:151], a[68:71], a[120:123], v[148:151]
 ds_read_b64_tr_b16 a[84:85], v7 offset:16384
 v_mul_f32 v78, s34, v78
 v_mfma_f32_16x16x32_bf16 v[156:159], a[96:99], a[196:199], v[156:159]
 ds_read_b64_tr_b16 a[86:87], v7 offset:20480
 v_xor_b32 v8, 65824, v6
 v_mfma_f32_16x16x32_bf16 v[156:159], a[100:103], a[204:207], v[156:159]
 ds_read_b64_tr_b16 a[88:89], v8 offset:0
 v_mul_f32 v79, s34, v79
 v_mfma_f32_16x16x32_bf16 v[156:159], a[104:107], a[212:215], v[156:159]
 ds_read_b64_tr_b16 a[90:91], v8 offset:4096
 v_cvt_pk_bf16_f32 v36, v36, v37
 v_mfma_f32_16x16x32_bf16 v[156:159], a[108:111], a[220:223], v[156:159]
 ds_read_b64_tr_b16 a[92:93], v8 offset:16384
 v_cvt_pk_bf16_f32 v37, v38, v39
 v_mfma_f32_16x16x32_bf16 v[156:159], a[64:67], a[116:119], v[156:159]
 ds_read_b64_tr_b16 a[94:95], v8 offset:20480
 v_xor_b32 v9, 131392, v6
 v_mfma_f32_16x16x32_bf16 v[156:159], a[68:71], a[124:127], v[156:159]
 s_waitcnt lgkmcnt(6)
 ds_read_b64_tr_b16 a[96:97], v9 offset:0
 v_cvt_pk_bf16_f32 v38, v76, v77
 v_mfma_f32_16x16x32_bf16 v[164:167], a[72:75], a[192:195], v[164:167]
 ds_read_b64_tr_b16 a[98:99], v9 offset:4096
 v_cvt_pk_bf16_f32 v39, v78, v79
 v_mfma_f32_16x16x32_bf16 v[164:167], a[76:79], a[200:203], v[164:167]
 ds_read_b64_tr_b16 a[100:101], v9 offset:16384
 v_accvgpr_write_b32 a36, v36
 v_mfma_f32_16x16x32_bf16 v[164:167], a[80:83], a[208:211], v[164:167]
 s_waitcnt lgkmcnt(3)
 ds_read_b64_tr_b16 a[102:103], v9 offset:20480
 v_xor_b32 v10, 320, v6
 v_mfma_f32_16x16x32_bf16 v[164:167], a[84:87], a[216:219], v[164:167]
 ds_read_b64_tr_b16 a[104:105], v10 offset:0
 v_accvgpr_write_b32 a37, v37
 v_mfma_f32_16x16x32_bf16 v[164:167], a[88:91], a[112:115], v[164:167]
 ds_read_b64_tr_b16 a[106:107], v10 offset:4096
 v_accvgpr_write_b32 a38, v38
 v_mfma_f32_16x16x32_bf16 v[164:167], a[92:95], a[120:123], v[164:167]
 ds_read_b64_tr_b16 a[108:109], v10 offset:16384
 v_accvgpr_write_b32 a39, v39
 v_mfma_f32_16x16x32_bf16 v[172:175], a[72:75], a[196:199], v[172:175]
 ds_read_b64_tr_b16 a[110:111], v10 offset:20480
 v_xor_b32 v7, 65856, v6
 v_mfma_f32_16x16x32_bf16 v[172:175], a[76:79], a[204:207], v[172:175]
 ds_read_b64_tr_b16 a[64:65], v7 offset:0
 v_mul_f32 v84, s34, v84
 v_mfma_f32_16x16x32_bf16 v[172:175], a[80:83], a[212:215], v[172:175]
 ds_read_b64_tr_b16 a[66:67], v7 offset:4096
 v_mul_f32 v85, s34, v85
 v_mfma_f32_16x16x32_bf16 v[172:175], a[84:87], a[220:223], v[172:175]
 ds_read_b64_tr_b16 a[68:69], v7 offset:16384
 v_mul_f32 v86, s34, v86
 v_mfma_f32_16x16x32_bf16 v[172:175], a[88:91], a[116:119], v[172:175]
 ds_read_b64_tr_b16 a[70:71], v7 offset:20480
 v_xor_b32 v8, 131424, v6
 v_mfma_f32_16x16x32_bf16 v[172:175], a[92:95], a[124:127], v[172:175]
 s_waitcnt lgkmcnt(6)
 ds_read_b64_tr_b16 a[72:73], v8 offset:0
 v_mul_f32 v87, s34, v87
 v_mfma_f32_16x16x32_bf16 v[180:183], a[96:99], a[192:195], v[180:183]
 ds_read_b64_tr_b16 a[74:75], v8 offset:4096
 v_mul_f32 v100, s34, v100
 v_mfma_f32_16x16x32_bf16 v[180:183], a[100:103], a[200:203], v[180:183]
 ds_read_b64_tr_b16 a[76:77], v8 offset:16384
 v_mul_f32 v101, s34, v101
 v_mfma_f32_16x16x32_bf16 v[180:183], a[104:107], a[208:211], v[180:183]
 s_waitcnt lgkmcnt(3)
 ds_read_b64_tr_b16 a[78:79], v8 offset:20480
 v_xor_b32 v9, 352, v6
 v_mfma_f32_16x16x32_bf16 v[180:183], a[108:111], a[216:219], v[180:183]
 ds_read_b64_tr_b16 a[80:81], v9 offset:0
 v_mul_f32 v102, s34, v102
 v_mfma_f32_16x16x32_bf16 v[180:183], a[64:67], a[112:115], v[180:183]
 ds_read_b64_tr_b16 a[82:83], v9 offset:4096
 v_mul_f32 v103, s34, v103
 v_mfma_f32_16x16x32_bf16 v[180:183], a[68:71], a[120:123], v[180:183]
 ds_read_b64_tr_b16 a[84:85], v9 offset:16384
 v_cvt_pk_bf16_f32 v84, v84, v85
 v_mfma_f32_16x16x32_bf16 v[188:191], a[96:99], a[196:199], v[188:191]
 ds_read_b64_tr_b16 a[86:87], v9 offset:20480
 v_xor_b32 v10, 65888, v6
 v_mfma_f32_16x16x32_bf16 v[188:191], a[100:103], a[204:207], v[188:191]
 ds_read_b64_tr_b16 a[88:89], v10 offset:0
 v_cvt_pk_bf16_f32 v85, v86, v87
 v_mfma_f32_16x16x32_bf16 v[188:191], a[104:107], a[212:215], v[188:191]
 ds_read_b64_tr_b16 a[90:91], v10 offset:4096
 v_cvt_pk_bf16_f32 v86, v100, v101
 v_mfma_f32_16x16x32_bf16 v[188:191], a[108:111], a[220:223], v[188:191]
 ds_read_b64_tr_b16 a[92:93], v10 offset:16384
 v_cvt_pk_bf16_f32 v87, v102, v103
 v_mfma_f32_16x16x32_bf16 v[188:191], a[64:67], a[116:119], v[188:191]
 ds_read_b64_tr_b16 a[94:95], v10 offset:20480
 v_xor_b32 v7, 131456, v6
 v_mfma_f32_16x16x32_bf16 v[188:191], a[68:71], a[124:127], v[188:191]
 s_waitcnt lgkmcnt(6)
 ds_read_b64_tr_b16 a[96:97], v7 offset:0
 v_accvgpr_write_b32 a8, v84
 v_mfma_f32_16x16x32_bf16 v[196:199], a[72:75], a[192:195], v[196:199]
 ds_read_b64_tr_b16 a[98:99], v7 offset:4096
 v_accvgpr_write_b32 a9, v85
 v_mfma_f32_16x16x32_bf16 v[196:199], a[76:79], a[200:203], v[196:199]
 ds_read_b64_tr_b16 a[100:101], v7 offset:16384
 v_accvgpr_write_b32 a10, v86
 v_mfma_f32_16x16x32_bf16 v[196:199], a[80:83], a[208:211], v[196:199]
 s_waitcnt lgkmcnt(3)
 ds_read_b64_tr_b16 a[102:103], v7 offset:20480
 v_xor_b32 v8, 384, v6
 v_mfma_f32_16x16x32_bf16 v[196:199], a[84:87], a[216:219], v[196:199]
 ds_read_b64_tr_b16 a[104:105], v8 offset:0
 v_accvgpr_write_b32 a11, v87
 v_mfma_f32_16x16x32_bf16 v[196:199], a[88:91], a[112:115], v[196:199]
 ds_read_b64_tr_b16 a[106:107], v8 offset:4096
 v_mul_f32 v92, s34, v92
 v_mfma_f32_16x16x32_bf16 v[196:199], a[92:95], a[120:123], v[196:199]
 ds_read_b64_tr_b16 a[108:109], v8 offset:16384
 v_mul_f32 v93, s34, v93
 v_mfma_f32_16x16x32_bf16 v[204:207], a[72:75], a[196:199], v[204:207]
 ds_read_b64_tr_b16 a[110:111], v8 offset:20480
 v_xor_b32 v9, 65920, v6
 v_mfma_f32_16x16x32_bf16 v[204:207], a[76:79], a[204:207], v[204:207]
 ds_read_b64_tr_b16 a[64:65], v9 offset:0
 v_mul_f32 v94, s34, v94
 v_mfma_f32_16x16x32_bf16 v[204:207], a[80:83], a[212:215], v[204:207]
 ds_read_b64_tr_b16 a[66:67], v9 offset:4096
 v_mul_f32 v95, s34, v95
 v_mfma_f32_16x16x32_bf16 v[204:207], a[84:87], a[220:223], v[204:207]
 ds_read_b64_tr_b16 a[68:69], v9 offset:16384
 v_mul_f32 v108, s34, v108
 v_mfma_f32_16x16x32_bf16 v[204:207], a[88:91], a[116:119], v[204:207]
 ds_read_b64_tr_b16 a[70:71], v9 offset:20480
 v_xor_b32 v10, 131488, v6
 v_mfma_f32_16x16x32_bf16 v[204:207], a[92:95], a[124:127], v[204:207]
 s_waitcnt lgkmcnt(6)
 ds_read_b64_tr_b16 a[72:73], v10 offset:0
 v_mul_f32 v109, s34, v109
 v_mfma_f32_16x16x32_bf16 v[212:215], a[96:99], a[192:195], v[212:215]
 ds_read_b64_tr_b16 a[74:75], v10 offset:4096
 v_mul_f32 v110, s34, v110
 v_mfma_f32_16x16x32_bf16 v[212:215], a[100:103], a[200:203], v[212:215]
 ds_read_b64_tr_b16 a[76:77], v10 offset:16384
 v_mul_f32 v111, s34, v111
 v_mfma_f32_16x16x32_bf16 v[212:215], a[104:107], a[208:211], v[212:215]
 s_waitcnt lgkmcnt(3)
 ds_read_b64_tr_b16 a[78:79], v10 offset:20480
 v_xor_b32 v7, 416, v6
 v_mfma_f32_16x16x32_bf16 v[212:215], a[108:111], a[216:219], v[212:215]
 ds_read_b64_tr_b16 a[80:81], v7 offset:0
 v_cvt_pk_bf16_f32 v92, v92, v93
 v_mfma_f32_16x16x32_bf16 v[212:215], a[64:67], a[112:115], v[212:215]
 ds_read_b64_tr_b16 a[82:83], v7 offset:4096
 v_cvt_pk_bf16_f32 v93, v94, v95
 v_mfma_f32_16x16x32_bf16 v[212:215], a[68:71], a[120:123], v[212:215]
 ds_read_b64_tr_b16 a[84:85], v7 offset:16384
 v_cvt_pk_bf16_f32 v94, v108, v109
 v_mfma_f32_16x16x32_bf16 v[220:223], a[96:99], a[196:199], v[220:223]
 ds_read_b64_tr_b16 a[86:87], v7 offset:20480
 v_xor_b32 v8, 65952, v6
 v_mfma_f32_16x16x32_bf16 v[220:223], a[100:103], a[204:207], v[220:223]
 ds_read_b64_tr_b16 a[88:89], v8 offset:0
 v_cvt_pk_bf16_f32 v95, v110, v111
 v_mfma_f32_16x16x32_bf16 v[220:223], a[104:107], a[212:215], v[220:223]
 ds_read_b64_tr_b16 a[90:91], v8 offset:4096
 v_accvgpr_write_b32 a40, v92
 v_mfma_f32_16x16x32_bf16 v[220:223], a[108:111], a[220:223], v[220:223]
 ds_read_b64_tr_b16 a[92:93], v8 offset:16384
 v_accvgpr_write_b32 a41, v93
 v_mfma_f32_16x16x32_bf16 v[220:223], a[64:67], a[116:119], v[220:223]
 ds_read_b64_tr_b16 a[94:95], v8 offset:20480
 v_xor_b32 v9, 131520, v6
 v_mfma_f32_16x16x32_bf16 v[220:223], a[68:71], a[124:127], v[220:223]
 s_waitcnt lgkmcnt(6)
 ds_read_b64_tr_b16 a[96:97], v9 offset:0
 v_accvgpr_write_b32 a42, v94
 v_mfma_f32_16x16x32_bf16 v[228:231], a[72:75], a[192:195], v[228:231]
 ds_read_b64_tr_b16 a[98:99], v9 offset:4096
 v_accvgpr_write_b32 a43, v95
 v_mfma_f32_16x16x32_bf16 v[228:231], a[76:79], a[200:203], v[228:231]
 ds_read_b64_tr_b16 a[100:101], v9 offset:16384
 v_mul_f32 v116, s34, v116
 v_mfma_f32_16x16x32_bf16 v[228:231], a[80:83], a[208:211], v[228:231]
 s_waitcnt lgkmcnt(3)
 ds_read_b64_tr_b16 a[102:103], v9 offset:20480
 v_xor_b32 v10, 448, v6
 v_mfma_f32_16x16x32_bf16 v[228:231], a[84:87], a[216:219], v[228:231]
 ds_read_b64_tr_b16 a[104:105], v10 offset:0
 v_mul_f32 v117, s34, v117
 v_mfma_f32_16x16x32_bf16 v[228:231], a[88:91], a[112:115], v[228:231]
 ds_read_b64_tr_b16 a[106:107], v10 offset:4096
 v_mul_f32 v118, s34, v118
 v_mfma_f32_16x16x32_bf16 v[228:231], a[92:95], a[120:123], v[228:231]
 ds_read_b64_tr_b16 a[108:109], v10 offset:16384
 v_mul_f32 v119, s34, v119
 v_mfma_f32_16x16x32_bf16 v[236:239], a[72:75], a[196:199], v[236:239]
 ds_read_b64_tr_b16 a[110:111], v10 offset:20480
 v_xor_b32 v7, 65984, v6
 v_mfma_f32_16x16x32_bf16 v[236:239], a[76:79], a[204:207], v[236:239]
 ds_read_b64_tr_b16 a[64:65], v7 offset:0
 buffer_load_dword v13, v12, s[12:15], s58 offen sc1
 v_mfma_f32_16x16x32_bf16 v[236:239], a[80:83], a[212:215], v[236:239]
 ds_read_b64_tr_b16 a[66:67], v7 offset:4096
 v_mul_f32 v132, s34, v132
 v_mfma_f32_16x16x32_bf16 v[236:239], a[84:87], a[220:223], v[236:239]
 ds_read_b64_tr_b16 a[68:69], v7 offset:16384
 v_mul_f32 v133, s34, v133
 v_mfma_f32_16x16x32_bf16 v[236:239], a[88:91], a[116:119], v[236:239]
 ds_read_b64_tr_b16 a[70:71], v7 offset:20480
 v_xor_b32 v8, 131552, v6
 v_mfma_f32_16x16x32_bf16 v[236:239], a[92:95], a[124:127], v[236:239]
 s_waitcnt lgkmcnt(6)
 ds_read_b64_tr_b16 a[72:73], v8 offset:0
 v_mul_f32 v134, s34, v134
 v_mfma_f32_16x16x32_bf16 v[244:247], a[96:99], a[192:195], v[244:247]
 ds_read_b64_tr_b16 a[74:75], v8 offset:4096
 v_mul_f32 v135, s34, v135
 v_mfma_f32_16x16x32_bf16 v[244:247], a[100:103], a[200:203], v[244:247]
 ds_read_b64_tr_b16 a[76:77], v8 offset:16384
 v_cvt_pk_bf16_f32 v116, v116, v117
 v_mfma_f32_16x16x32_bf16 v[244:247], a[104:107], a[208:211], v[244:247]
 s_waitcnt lgkmcnt(3)
 ds_read_b64_tr_b16 a[78:79], v8 offset:20480
 v_xor_b32 v9, 480, v6
 v_mfma_f32_16x16x32_bf16 v[244:247], a[108:111], a[216:219], v[244:247]
 ds_read_b64_tr_b16 a[80:81], v9 offset:0
 v_cvt_pk_bf16_f32 v117, v118, v119
 v_mfma_f32_16x16x32_bf16 v[244:247], a[64:67], a[112:115], v[244:247]
 ds_read_b64_tr_b16 a[82:83], v9 offset:4096
 v_cvt_pk_bf16_f32 v118, v132, v133
 v_mfma_f32_16x16x32_bf16 v[244:247], a[68:71], a[120:123], v[244:247]
 ds_read_b64_tr_b16 a[84:85], v9 offset:16384
 v_cvt_pk_bf16_f32 v119, v134, v135
 v_mfma_f32_16x16x32_bf16 v[252:255], a[96:99], a[196:199], v[252:255]
 ds_read_b64_tr_b16 a[86:87], v9 offset:20480
 v_xor_b32 v10, 66016, v6
 v_mfma_f32_16x16x32_bf16 v[252:255], a[100:103], a[204:207], v[252:255]
 ds_read_b64_tr_b16 a[88:89], v10 offset:0
 v_accvgpr_write_b32 a12, v116
 v_mfma_f32_16x16x32_bf16 v[252:255], a[104:107], a[212:215], v[252:255]
 ds_read_b64_tr_b16 a[90:91], v10 offset:4096
 v_accvgpr_write_b32 a13, v117
 v_mfma_f32_16x16x32_bf16 v[252:255], a[108:111], a[220:223], v[252:255]
 ds_read_b64_tr_b16 a[92:93], v10 offset:16384
 v_accvgpr_write_b32 a14, v118
 v_mfma_f32_16x16x32_bf16 v[252:255], a[64:67], a[116:119], v[252:255]
 ds_read_b64_tr_b16 a[94:95], v10 offset:20480
 v_accvgpr_write_b32 a15, v119
 v_mfma_f32_16x16x32_bf16 v[252:255], a[68:71], a[124:127], v[252:255]
 s_waitcnt lgkmcnt(6)
 v_mfma_f32_16x16x32_bf16 v[16:19], a[72:75], a[192:195], v[16:19]
 v_mfma_f32_16x16x32_bf16 v[16:19], a[76:79], a[200:203], v[16:19]
 v_mfma_f32_16x16x32_bf16 v[16:19], a[80:83], a[208:211], v[16:19]
 s_waitcnt lgkmcnt(0)
 v_mfma_f32_16x16x32_bf16 v[16:19], a[84:87], a[216:219], v[16:19]
 v_mfma_f32_16x16x32_bf16 v[16:19], a[88:91], a[112:115], v[16:19]
 v_mfma_f32_16x16x32_bf16 v[16:19], a[92:95], a[120:123], v[16:19]
 v_mfma_f32_16x16x32_bf16 v[24:27], a[72:75], a[196:199], v[24:27]
 v_mfma_f32_16x16x32_bf16 v[24:27], a[76:79], a[204:207], v[24:27]
 v_mfma_f32_16x16x32_bf16 v[24:27], a[80:83], a[212:215], v[24:27]
 v_mfma_f32_16x16x32_bf16 v[24:27], a[84:87], a[220:223], v[24:27]
 s_waitcnt lgkmcnt(0)
 v_mfma_f32_16x16x32_bf16 v[24:27], a[88:91], a[116:119], v[24:27]
 s_barrier
 v_mfma_f32_16x16x32_bf16 v[24:27], a[92:95], a[124:127], v[24:27]
 s_waitcnt vmcnt(0)
 v_cmp_ne_u32 s[16:17], 0, v13
 v_cmp_gt_u32 vcc, 256, v5
 s_or_b64 vcc, vcc, s[16:17]
 s_mov_b32 m0, s40
 s_cselect_b32 s48, 0, 1
 s_cselect_b32 s52, 2.0, s42
 buffer_load_dwordx4 v1, s[12:15], s52 offen offset:0 sc1 lds
 v_pk_mul_f32 v[124:125], v[124:125], s[34:35]
 v_pk_mul_f32 v[126:127], v[126:127], s[34:35]
 v_pk_mul_f32 v[140:141], v[140:141], s[34:35]
 v_pk_mul_f32 v[142:143], v[142:143], s[34:35]
 v_cvt_pk_bf16_f32 v124, v124, v125
 v_cvt_pk_bf16_f32 v125, v126, v127
 v_cvt_pk_bf16_f32 v126, v140, v141
 v_cvt_pk_bf16_f32 v127, v142, v143
 v_accvgpr_write_b32 a44, v124
 v_accvgpr_write_b32 a45, v125
 v_accvgpr_write_b32 a46, v126
 v_accvgpr_write_b32 a47, v127
 v_pk_mul_f32 v[148:149], v[148:149], s[34:35]
 v_pk_mul_f32 v[150:151], v[150:151], s[34:35]
 buffer_load_dwordx4 v1, s[12:15], s52 offen offset:1024 sc1 lds
 v_pk_mul_f32 v[164:165], v[164:165], s[34:35]
 v_pk_mul_f32 v[166:167], v[166:167], s[34:35]
 v_cvt_pk_bf16_f32 v148, v148, v149
 v_cvt_pk_bf16_f32 v149, v150, v151
 v_cvt_pk_bf16_f32 v150, v164, v165
 v_cvt_pk_bf16_f32 v151, v166, v167
 v_accvgpr_write_b32 a16, v148
 v_accvgpr_write_b32 a17, v149
 v_accvgpr_write_b32 a18, v150
 v_accvgpr_write_b32 a19, v151
 v_pk_mul_f32 v[156:157], v[156:157], s[34:35]
 v_pk_mul_f32 v[158:159], v[158:159], s[34:35]
 v_pk_mul_f32 v[172:173], v[172:173], s[34:35]
 buffer_load_dwordx4 v1, s[12:15], s52 offen offset:2048 sc1 lds
 v_pk_mul_f32 v[174:175], v[174:175], s[34:35]
 v_cvt_pk_bf16_f32 v156, v156, v157
 v_cvt_pk_bf16_f32 v157, v158, v159
 v_cvt_pk_bf16_f32 v158, v172, v173
 v_cvt_pk_bf16_f32 v159, v174, v175
 v_accvgpr_write_b32 a48, v156
 v_accvgpr_write_b32 a49, v157
 v_accvgpr_write_b32 a50, v158
 v_accvgpr_write_b32 a51, v159
 v_pk_mul_f32 v[180:181], v[180:181], s[34:35]
 v_pk_mul_f32 v[182:183], v[182:183], s[34:35]
 v_pk_mul_f32 v[196:197], v[196:197], s[34:35]
 v_pk_mul_f32 v[198:199], v[198:199], s[34:35]
 v_cvt_pk_bf16_f32 v180, v180, v181
 buffer_load_dwordx4 v1, s[12:15], s52 offen offset:3072 sc1 lds
 v_cvt_pk_bf16_f32 v181, v182, v183
 v_cvt_pk_bf16_f32 v182, v196, v197
 v_cvt_pk_bf16_f32 v183, v198, v199
 v_accvgpr_write_b32 a20, v180
 v_accvgpr_write_b32 a21, v181
 v_accvgpr_write_b32 a22, v182
 v_accvgpr_write_b32 a23, v183
 v_pk_mul_f32 v[188:189], v[188:189], s[34:35]
 v_pk_mul_f32 v[190:191], v[190:191], s[34:35]
 v_pk_mul_f32 v[204:205], v[204:205], s[34:35]
 v_pk_mul_f32 v[206:207], v[206:207], s[34:35]
 v_cvt_pk_bf16_f32 v188, v188, v189
 v_cvt_pk_bf16_f32 v189, v190, v191
 s_bitset1_b32 m0, 12
 s_nop 0
 buffer_load_dwordx4 v4, s[12:15], s52 offen offset:0 sc1 lds
 v_cvt_pk_bf16_f32 v190, v204, v205
 v_cvt_pk_bf16_f32 v191, v206, v207
 v_accvgpr_write_b32 a52, v188
 v_accvgpr_write_b32 a53, v189
 v_accvgpr_write_b32 a54, v190
 v_accvgpr_write_b32 a55, v191
 v_pk_mul_f32 v[212:213], v[212:213], s[34:35]
 v_pk_mul_f32 v[214:215], v[214:215], s[34:35]
 v_pk_mul_f32 v[228:229], v[228:229], s[34:35]
 v_pk_mul_f32 v[230:231], v[230:231], s[34:35]
 v_cvt_pk_bf16_f32 v212, v212, v213
 v_cvt_pk_bf16_f32 v213, v214, v215
 v_cvt_pk_bf16_f32 v214, v228, v229
 v_cvt_pk_bf16_f32 v215, v230, v231
 buffer_load_dwordx4 v4, s[12:15], s52 offen offset:1024 sc1 lds
 v_accvgpr_write_b32 a24, v212
 v_accvgpr_write_b32 a25, v213
 v_accvgpr_write_b32 a26, v214
 v_accvgpr_write_b32 a27, v215
 v_pk_mul_f32 v[220:221], v[220:221], s[34:35]
 v_pk_mul_f32 v[222:223], v[222:223], s[34:35]
 v_pk_mul_f32 v[236:237], v[236:237], s[34:35]
 v_pk_mul_f32 v[238:239], v[238:239], s[34:35]
 v_cvt_pk_bf16_f32 v220, v220, v221
 v_cvt_pk_bf16_f32 v221, v222, v223
 v_cvt_pk_bf16_f32 v222, v236, v237
 v_cvt_pk_bf16_f32 v223, v238, v239
 v_accvgpr_write_b32 a56, v220
 buffer_load_dwordx4 v4, s[12:15], s52 offen offset:2048 sc1 lds
 v_accvgpr_write_b32 a57, v221
 v_accvgpr_write_b32 a58, v222
 v_accvgpr_write_b32 a59, v223
 v_pk_mul_f32 v[244:245], v[244:245], s[34:35]
 v_pk_mul_f32 v[246:247], v[246:247], s[34:35]
 v_pk_mul_f32 v[16:17], v[16:17], s[34:35]
 v_pk_mul_f32 v[18:19], v[18:19], s[34:35]
 v_cvt_pk_bf16_f32 v244, v244, v245
 v_cvt_pk_bf16_f32 v245, v246, v247
 v_cvt_pk_bf16_f32 v246, v16, v17
 v_cvt_pk_bf16_f32 v247, v18, v19
 v_accvgpr_write_b32 a28, v244
 v_accvgpr_write_b32 a29, v245
 v_accvgpr_write_b32 a30, v246
 buffer_load_dwordx4 v4, s[12:15], s52 offen offset:3072 sc1 lds
 v_accvgpr_write_b32 a31, v247
 v_pk_mul_f32 v[252:253], v[252:253], s[34:35]
 v_pk_mul_f32 v[254:255], v[254:255], s[34:35]
 v_pk_mul_f32 v[24:25], v[24:25], s[34:35]
 v_pk_mul_f32 v[26:27], v[26:27], s[34:35]
 v_cvt_pk_bf16_f32 v252, v252, v253
 v_cvt_pk_bf16_f32 v253, v254, v255
 v_cvt_pk_bf16_f32 v254, v24, v25
 v_cvt_pk_bf16_f32 v255, v26, v27
 v_accvgpr_write_b32 a60, v252
 v_accvgpr_write_b32 a61, v253
 v_accvgpr_write_b32 a62, v254
 v_accvgpr_write_b32 a63, v255
 s_branch L_kvdone
L_late0:
 v_mfma_f32_16x16x32_bf16 a[232:235], a[0:3], a[96:99], a[232:235]
 ds_read_b64_tr_b16 a[24:25], v9 offset:32768
 v_mfma_f32_16x16x32_bf16 a[232:235], a[4:7], a[100:103], a[232:235]
 s_add_u32 m0, s33, 0xfffffd00
 ds_read_b64_tr_b16 a[26:27], v9 offset:36864
 v_mfma_f32_16x16x32_bf16 a[224:227], a[4:7], a[108:111], a[224:227]
 s_waitcnt lgkmcnt(13)
 ds_read_b64_tr_b16 a[28:29], v9 offset:49152
 v_mfma_f32_16x16x32_bf16 a[224:227], a[0:3], a[104:107], a[224:227]
 ds_read_b64_tr_b16 a[30:31], v9 offset:53248
 buffer_load_dwordx4 v15, s[20:23], 0 offen offset:768 lds
 v_mfma_f32_16x16x32_bf16 v[24:27], a[0:3], a[112:115], v[24:27]
 s_waitcnt lgkmcnt(12)
 ds_read_b128 a[64:67], v4 offset:32768
 v_mfma_f32_16x16x32_bf16 v[24:27], a[4:7], a[116:119], v[24:27]
 v_mfma_f32_16x16x32_bf16 v[16:19], a[4:7], a[124:127], v[16:19]
 s_add_u32 m0, s33, 0xfffffd80
 ds_read_b128 a[68:71], v5 offset:32768
 v_mfma_f32_16x16x32_bf16 v[16:19], a[0:3], a[120:123], v[16:19]
 s_waitcnt lgkmcnt(10)
 buffer_load_dwordx4 v15, s[20:23], 0 offen offset:1664 lds
 v_mfma_f32_16x16x32_bf16 v[20:23], a[8:11], a[120:123], v[20:23]
 ds_read_b128 a[76:79], v5 offset:34816
 v_mfma_f32_16x16x32_bf16 v[20:23], a[12:15], a[124:127], v[20:23]
 v_mfma_f32_16x16x32_bf16 v[28:31], a[12:15], a[116:119], v[28:31]
 s_add_u32 m0, s33, 0x500
 ds_read_b128 a[72:75], v4 offset:34816
 v_mfma_f32_16x16x32_bf16 v[28:31], a[8:11], a[112:115], v[28:31]
 buffer_load_dwordx4 v15, s[20:23], s57 offen offset:768 lds
 v_mfma_f32_16x16x32_bf16 a[228:231], a[8:11], a[104:107], a[228:231]
 ds_read_b128 a[80:83], v4 offset:36864
 v_mfma_f32_16x16x32_bf16 a[228:231], a[12:15], a[108:111], a[228:231]
 v_mfma_f32_16x16x32_bf16 a[236:239], a[12:15], a[100:103], a[236:239]
 s_add_u32 m0, s33, 0x580
 ds_read_b128 a[84:87], v5 offset:36864
 v_mfma_f32_16x16x32_bf16 a[236:239], a[8:11], a[96:99], a[236:239]
 s_waitcnt lgkmcnt(10)
 buffer_load_dwordx4 v15, s[20:23], s57 offen offset:1664 lds
 v_mfma_f32_16x16x32_bf16 v[56:59], a[16:19], a[96:99], v[56:59]
 ds_read_b128 a[92:95], v5 offset:38912
 v_mfma_f32_16x16x32_bf16 v[56:59], a[20:23], a[100:103], v[56:59]
 v_cvt_pk_bf16_f32 v16, v16, v17
 v_cvt_pk_bf16_f32 v17, v18, v19
 v_mfma_f32_16x16x32_bf16 v[48:51], a[20:23], a[108:111], v[48:51]
 ds_read_b128 a[88:91], v4 offset:38912
 v_cvt_pk_bf16_f32 v18, v20, v21
 v_mfma_f32_16x16x32_bf16 v[48:51], a[16:19], a[104:107], v[48:51]
 v_cvt_pk_bf16_f32 v19, v22, v23
 v_cvt_pk_bf16_f32 v24, v24, v25
 v_mfma_f32_16x16x32_bf16 v[40:43], a[16:19], a[112:115], v[40:43]
 ds_read_b64_tr_b16 a[32:33], v10 offset:32768
 v_cvt_pk_bf16_f32 v25, v26, v27
 v_mfma_f32_16x16x32_bf16 v[40:43], a[20:23], a[116:119], v[40:43]
 ds_read_b64_tr_b16 a[34:35], v10 offset:36864
 v_cvt_pk_bf16_f32 v26, v28, v29
 v_mfma_f32_16x16x32_bf16 v[32:35], a[20:23], a[124:127], v[32:35]
 s_add_u32 s59, s56, 57344
 ds_read_b64_tr_b16 a[36:37], v10 offset:49152
 v_cvt_pk_bf16_f32 v27, v30, v31
 v_mfma_f32_16x16x32_bf16 v[32:35], a[16:19], a[120:123], v[32:35]
 s_waitcnt lgkmcnt(11)
 ds_read_b64_tr_b16 a[38:39], v10 offset:53248
 v_accvgpr_read_b32 v20, a224
 v_mfma_f32_16x16x32_bf16 v[36:39], a[24:27], a[120:123], v[36:39]
 ds_read_b64_tr_b16 a[40:41], v11 offset:32768
 buffer_store_dwordx4 v[16:19], v1, s[12:15], s59 offen offset:0 sc1
 v_mfma_f32_16x16x32_bf16 v[36:39], a[28:31], a[124:127], v[36:39]
 ds_read_b64_tr_b16 a[42:43], v11 offset:36864
 v_accvgpr_read_b32 v21, a225
 v_mfma_f32_16x16x32_bf16 v[44:47], a[28:31], a[116:119], v[44:47]
 ds_read_b64_tr_b16 a[44:45], v11 offset:49152
 v_accvgpr_read_b32 v22, a226
 v_mfma_f32_16x16x32_bf16 v[44:47], a[24:27], a[112:115], v[44:47]
 ds_read_b64_tr_b16 a[46:47], v11 offset:53248
 v_accvgpr_read_b32 v23, a227
 v_mfma_f32_16x16x32_bf16 v[52:55], a[24:27], a[104:107], v[52:55]
 ds_read_b64_tr_b16 a[48:49], v12 offset:32768
 v_accvgpr_read_b32 v28, a228
 v_mfma_f32_16x16x32_bf16 v[52:55], a[28:31], a[108:111], v[52:55]
 ds_read_b64_tr_b16 a[50:51], v12 offset:36864
 v_accvgpr_read_b32 v29, a229
 v_mfma_f32_16x16x32_bf16 v[60:63], a[28:31], a[100:103], v[60:63]
 s_add_u32 s59, s56, 49152
 ds_read_b64_tr_b16 a[52:53], v12 offset:49152
 v_accvgpr_read_b32 v30, a230
 v_mfma_f32_16x16x32_bf16 v[60:63], a[24:27], a[96:99], v[60:63]
 s_waitcnt lgkmcnt(15)
 ds_read_b64_tr_b16 a[54:55], v12 offset:53248
 buffer_store_dwordx4 v[24:27], v1, s[12:15], s59 offen offset:0 sc1
 v_mfma_f32_16x16x32_bf16 v[88:91], a[0:3], a[64:67], v[88:91]
 ds_read_b64_tr_b16 a[56:57], v13 offset:32768
 v_accvgpr_read_b32 v31, a231
 v_mfma_f32_16x16x32_bf16 v[88:91], a[4:7], a[68:71], v[88:91]
 ds_read_b64_tr_b16 a[58:59], v13 offset:36864
 v_cvt_pk_bf16_f32 v20, v20, v21
 v_mfma_f32_16x16x32_bf16 v[80:83], a[4:7], a[76:79], v[80:83]
 ds_read_b64_tr_b16 a[60:61], v13 offset:49152
 v_cvt_pk_bf16_f32 v21, v22, v23
 v_mfma_f32_16x16x32_bf16 v[80:83], a[0:3], a[72:75], v[80:83]
 s_waitcnt lgkmcnt(15)
 ds_read_b64_tr_b16 a[62:63], v13 offset:53248
 v_cvt_pk_bf16_f32 v22, v28, v29
 v_mfma_f32_16x16x32_bf16 v[72:75], a[0:3], a[80:83], v[72:75]
 v_cvt_pk_bf16_f32 v23, v30, v31
 v_cvt_pk_bf16_f32 v32, v32, v33
 v_mfma_f32_16x16x32_bf16 v[72:75], a[4:7], a[84:87], v[72:75]
 s_add_u32 s59, s56, 40960
 v_cvt_pk_bf16_f32 v33, v34, v35
 v_cvt_pk_bf16_f32 v34, v36, v37
 v_mfma_f32_16x16x32_bf16 v[64:67], a[4:7], a[92:95], v[64:67]
 buffer_store_dwordx4 v[20:23], v1, s[12:15], s59 offen offset:0 sc1
 v_mfma_f32_16x16x32_bf16 v[64:67], a[0:3], a[88:91], v[64:67]
 s_waitcnt lgkmcnt(0)
 v_cvt_pk_bf16_f32 v35, v38, v39
 v_cvt_pk_bf16_f32 v40, v40, v41
 v_mfma_f32_16x16x32_bf16 v[68:71], a[8:11], a[88:91], v[68:71]
 s_barrier
 v_xor_b32 v6, s60, v6
 v_cvt_pk_bf16_f32 v41, v42, v43
 v_mfma_f32_16x16x32_bf16 v[68:71], a[12:15], a[92:95], v[68:71]
 s_add_u32 m0, s29, 32768
 v_add_u32 v2, 0x80000, v2
 v_cvt_pk_bf16_f32 v42, v44, v45
 v_mfma_f32_16x16x32_bf16 v[76:79], a[12:15], a[84:87], v[76:79]
 buffer_load_dwordx4 v2, s[16:19], 0 offen lds
 v_mfma_f32_16x16x32_bf16 v[76:79], a[8:11], a[80:83], v[76:79]
 v_cvt_pk_bf16_f32 v43, v46, v47
 v_accvgpr_read_b32 v36, a232
 v_mfma_f32_16x16x32_bf16 v[84:87], a[8:11], a[72:75], v[84:87]
 v_accvgpr_read_b32 v37, a233
 v_accvgpr_read_b32 v38, a234
 v_mfma_f32_16x16x32_bf16 v[84:87], a[12:15], a[76:79], v[84:87]
 v_accvgpr_read_b32 v39, a235
 v_accvgpr_read_b32 v44, a236
 v_mfma_f32_16x16x32_bf16 v[92:95], a[12:15], a[68:71], v[92:95]
 s_add_u32 m0, s29, 36864
 v_accvgpr_read_b32 v45, a237
 v_accvgpr_read_b32 v46, a238
 v_mfma_f32_16x16x32_bf16 v[92:95], a[8:11], a[64:67], v[92:95]
 buffer_load_dwordx4 v2, s[16:19], s48 offen lds
 v_mfma_f32_16x16x32_bf16 v[120:123], a[16:19], a[64:67], v[120:123]
 v_accvgpr_read_b32 v47, a239
 v_cvt_pk_bf16_f32 v36, v36, v37
 v_mfma_f32_16x16x32_bf16 v[120:123], a[20:23], a[68:71], v[120:123]
 v_cvt_pk_bf16_f32 v37, v38, v39
 v_cvt_pk_bf16_f32 v38, v44, v45
 v_mfma_f32_16x16x32_bf16 v[112:115], a[20:23], a[76:79], v[112:115]
 v_cvt_pk_bf16_f32 v39, v46, v47
 v_cvt_pk_bf16_f32 v48, v48, v49
 v_mfma_f32_16x16x32_bf16 v[112:115], a[16:19], a[72:75], v[112:115]
 s_add_u32 m0, s29, 40960
 v_cvt_pk_bf16_f32 v49, v50, v51
 v_cvt_pk_bf16_f32 v50, v52, v53
 v_mfma_f32_16x16x32_bf16 v[104:107], a[16:19], a[80:83], v[104:107]
 buffer_load_dwordx4 v2, s[16:19], s49 offen lds
 v_mfma_f32_16x16x32_bf16 v[104:107], a[20:23], a[84:87], v[104:107]
 v_cvt_pk_bf16_f32 v51, v54, v55
 v_cvt_pk_bf16_f32 v56, v56, v57
 v_mfma_f32_16x16x32_bf16 v[96:99], a[20:23], a[92:95], v[96:99]
 v_cvt_pk_bf16_f32 v57, v58, v59
 v_cvt_pk_bf16_f32 v58, v60, v61
 v_mfma_f32_16x16x32_bf16 v[96:99], a[16:19], a[88:91], v[96:99]
 v_cvt_pk_bf16_f32 v59, v62, v63
 v_cvt_pk_bf16_f32 v64, v64, v65
 v_mfma_f32_16x16x32_bf16 v[100:103], a[24:27], a[88:91], v[100:103]
 s_add_u32 m0, s29, 45056
 v_cvt_pk_bf16_f32 v65, v66, v67
 v_cvt_pk_bf16_f32 v66, v68, v69
 v_mfma_f32_16x16x32_bf16 v[100:103], a[28:31], a[92:95], v[100:103]
 buffer_load_dwordx4 v2, s[16:19], s50 offen lds
 v_mfma_f32_16x16x32_bf16 v[108:111], a[28:31], a[84:87], v[108:111]
 s_add_u32 s59, s56, 32768
 v_cvt_pk_bf16_f32 v67, v70, v71
 v_cvt_pk_bf16_f32 v72, v72, v73
 v_mfma_f32_16x16x32_bf16 v[108:111], a[24:27], a[80:83], v[108:111]
 buffer_store_dwordx4 v[36:39], v1, s[12:15], s59 offen offset:0 sc1
 v_mfma_f32_16x16x32_bf16 v[116:119], a[24:27], a[72:75], v[116:119]
 v_cvt_pk_bf16_f32 v73, v74, v75
 v_cvt_pk_bf16_f32 v74, v76, v77
 v_mfma_f32_16x16x32_bf16 v[116:119], a[28:31], a[76:79], v[116:119]
 s_add_u32 m0, s29, 49152
 v_cvt_pk_bf16_f32 v75, v78, v79
 v_cvt_pk_bf16_f32 v80, v80, v81
 v_mfma_f32_16x16x32_bf16 v[124:127], a[28:31], a[68:71], v[124:127]
 buffer_load_dwordx4 v2, s[16:19], s51 offen lds
 v_mfma_f32_16x16x32_bf16 v[124:127], a[24:27], a[64:67], v[124:127]
 v_cvt_pk_bf16_f32 v81, v82, v83
 v_cvt_pk_bf16_f32 v82, v84, v85
 v_mfma_f32_16x16x32_bf16 v[152:155], a[32:35], a[64:67], v[152:155]
 v_cvt_pk_bf16_f32 v83, v86, v87
 v_cvt_pk_bf16_f32 v88, v88, v89
 v_mfma_f32_16x16x32_bf16 v[152:155], a[36:39], a[68:71], v[152:155]
 v_cvt_pk_bf16_f32 v89, v90, v91
 v_cvt_pk_bf16_f32 v90, v92, v93
 v_mfma_f32_16x16x32_bf16 v[144:147], a[36:39], a[76:79], v[144:147]
 s_add_u32 m0, s29, 53248
 v_cvt_pk_bf16_f32 v91, v94, v95
 v_cvt_pk_bf16_f32 v96, v96, v97
 v_mfma_f32_16x16x32_bf16 v[144:147], a[32:35], a[72:75], v[144:147]
 buffer_load_dwordx4 v2, s[16:19], s52 offen lds
 v_mfma_f32_16x16x32_bf16 v[136:139], a[32:35], a[80:83], v[136:139]
 v_cvt_pk_bf16_f32 v97, v98, v99
 v_cvt_pk_bf16_f32 v98, v100, v101
 v_mfma_f32_16x16x32_bf16 v[136:139], a[36:39], a[84:87], v[136:139]
 v_cvt_pk_bf16_f32 v99, v102, v103
 v_cvt_pk_bf16_f32 v104, v104, v105
 v_mfma_f32_16x16x32_bf16 v[128:131], a[36:39], a[92:95], v[128:131]
 v_cvt_pk_bf16_f32 v105, v106, v107
 v_cvt_pk_bf16_f32 v106, v108, v109
 v_mfma_f32_16x16x32_bf16 v[128:131], a[32:35], a[88:91], v[128:131]
 s_add_u32 m0, s29, 57344
 v_cvt_pk_bf16_f32 v107, v110, v111
 v_cvt_pk_bf16_f32 v112, v112, v113
 v_mfma_f32_16x16x32_bf16 v[132:135], a[40:43], a[88:91], v[132:135]
 buffer_load_dwordx4 v2, s[16:19], s53 offen lds
 v_mfma_f32_16x16x32_bf16 v[132:135], a[44:47], a[92:95], v[132:135]
 v_cvt_pk_bf16_f32 v113, v114, v115
 v_cvt_pk_bf16_f32 v114, v116, v117
 v_mfma_f32_16x16x32_bf16 v[140:143], a[44:47], a[84:87], v[140:143]
 v_cvt_pk_bf16_f32 v115, v118, v119
 v_cvt_pk_bf16_f32 v120, v120, v121
 v_mfma_f32_16x16x32_bf16 v[140:143], a[40:43], a[80:83], v[140:143]
 v_cvt_pk_bf16_f32 v121, v122, v123
 v_cvt_pk_bf16_f32 v122, v124, v125
 v_mfma_f32_16x16x32_bf16 v[148:151], a[40:43], a[72:75], v[148:151]
 s_add_u32 m0, s29, 61440
 v_cvt_pk_bf16_f32 v123, v126, v127
 v_mfma_f32_16x16x32_bf16 v[148:151], a[44:47], a[76:79], v[148:151]
 buffer_load_dwordx4 v2, s[16:19], s54 offen lds
 v_mfma_f32_16x16x32_bf16 v[156:159], a[44:47], a[68:71], v[156:159]
 v_mfma_f32_16x16x32_bf16 v[156:159], a[40:43], a[64:67], v[156:159]
 v_mfma_f32_16x16x32_bf16 v[184:187], a[48:51], a[64:67], v[184:187]
 s_add_u32 m0, s29, 98304
 v_add_u32 v2, 0x80000, v2
 v_mfma_f32_16x16x32_bf16 v[184:187], a[52:55], a[68:71], v[184:187]
 buffer_load_dwordx4 v2, s[16:19], 0 offen lds
 v_mfma_f32_16x16x32_bf16 v[176:179], a[52:55], a[76:79], v[176:179]
 v_cvt_pk_bf16_f32 v128, v128, v129
 v_cvt_pk_bf16_f32 v129, v130, v131
 v_mfma_f32_16x16x32_bf16 v[176:179], a[48:51], a[72:75], v[176:179]
 v_cvt_pk_bf16_f32 v130, v132, v133
 v_cvt_pk_bf16_f32 v131, v134, v135
 v_mfma_f32_16x16x32_bf16 v[168:171], a[48:51], a[80:83], v[168:171]
 v_cvt_pk_bf16_f32 v136, v136, v137
 v_cvt_pk_bf16_f32 v137, v138, v139
 v_mfma_f32_16x16x32_bf16 v[168:171], a[52:55], a[84:87], v[168:171]
 s_add_u32 m0, s29, 102400
 v_cvt_pk_bf16_f32 v138, v140, v141
 v_cvt_pk_bf16_f32 v139, v142, v143
 v_mfma_f32_16x16x32_bf16 v[160:163], a[52:55], a[92:95], v[160:163]
 buffer_load_dwordx4 v2, s[16:19], s48 offen lds
 v_mfma_f32_16x16x32_bf16 v[160:163], a[48:51], a[88:91], v[160:163]
 v_cvt_pk_bf16_f32 v144, v144, v145
 v_cvt_pk_bf16_f32 v145, v146, v147
 v_mfma_f32_16x16x32_bf16 v[164:167], a[56:59], a[88:91], v[164:167]
 v_cvt_pk_bf16_f32 v146, v148, v149
 v_cvt_pk_bf16_f32 v147, v150, v151
 v_mfma_f32_16x16x32_bf16 v[164:167], a[60:63], a[92:95], v[164:167]
 v_cvt_pk_bf16_f32 v152, v152, v153
 v_cvt_pk_bf16_f32 v153, v154, v155
 v_mfma_f32_16x16x32_bf16 v[172:175], a[60:63], a[84:87], v[172:175]
 s_add_u32 m0, s29, 106496
 v_cvt_pk_bf16_f32 v154, v156, v157
 v_cvt_pk_bf16_f32 v155, v158, v159
 v_mfma_f32_16x16x32_bf16 v[172:175], a[56:59], a[80:83], v[172:175]
 buffer_load_dwordx4 v2, s[16:19], s49 offen lds
 v_mfma_f32_16x16x32_bf16 v[180:183], a[56:59], a[72:75], v[180:183]
 v_mfma_f32_16x16x32_bf16 v[180:183], a[60:63], a[76:79], v[180:183]
 v_mfma_f32_16x16x32_bf16 v[188:191], a[60:63], a[68:71], v[188:191]
 v_mfma_f32_16x16x32_bf16 v[188:191], a[56:59], a[64:67], v[188:191]
 s_add_u32 m0, s29, 110592
 v_mfma_f32_16x16x32_bf16 v[216:219], a[32:35], a[96:99], v[216:219]
 buffer_load_dwordx4 v2, s[16:19], s50 offen lds
 v_mfma_f32_16x16x32_bf16 v[216:219], a[36:39], a[100:103], v[216:219]
 v_cvt_pk_bf16_f32 v160, v160, v161
 v_cvt_pk_bf16_f32 v161, v162, v163
 v_mfma_f32_16x16x32_bf16 v[208:211], a[36:39], a[108:111], v[208:211]
 v_cvt_pk_bf16_f32 v162, v164, v165
 v_cvt_pk_bf16_f32 v163, v166, v167
 v_mfma_f32_16x16x32_bf16 v[208:211], a[32:35], a[104:107], v[208:211]
 v_cvt_pk_bf16_f32 v168, v168, v169
 v_cvt_pk_bf16_f32 v169, v170, v171
 v_mfma_f32_16x16x32_bf16 v[200:203], a[32:35], a[112:115], v[200:203]
 s_add_u32 m0, s29, 114688
 v_cvt_pk_bf16_f32 v170, v172, v173
 v_cvt_pk_bf16_f32 v171, v174, v175
 v_mfma_f32_16x16x32_bf16 v[200:203], a[36:39], a[116:119], v[200:203]
 buffer_load_dwordx4 v2, s[16:19], s51 offen lds
 v_mfma_f32_16x16x32_bf16 v[192:195], a[36:39], a[124:127], v[192:195]
 v_cvt_pk_bf16_f32 v176, v176, v177
 v_cvt_pk_bf16_f32 v177, v178, v179
 v_mfma_f32_16x16x32_bf16 v[192:195], a[32:35], a[120:123], v[192:195]
 v_cvt_pk_bf16_f32 v178, v180, v181
 v_cvt_pk_bf16_f32 v179, v182, v183
 v_mfma_f32_16x16x32_bf16 v[196:199], a[40:43], a[120:123], v[196:199]
 v_cvt_pk_bf16_f32 v184, v184, v185
 v_cvt_pk_bf16_f32 v185, v186, v187
 v_mfma_f32_16x16x32_bf16 v[196:199], a[44:47], a[124:127], v[196:199]
 s_add_u32 m0, s29, 118784
 v_cvt_pk_bf16_f32 v186, v188, v189
 v_cvt_pk_bf16_f32 v187, v190, v191
 v_mfma_f32_16x16x32_bf16 v[204:207], a[44:47], a[116:119], v[204:207]
 buffer_load_dwordx4 v2, s[16:19], s52 offen lds
 v_mfma_f32_16x16x32_bf16 v[204:207], a[40:43], a[112:115], v[204:207]
 v_mfma_f32_16x16x32_bf16 v[212:215], a[40:43], a[104:107], v[212:215]
 v_mfma_f32_16x16x32_bf16 v[212:215], a[44:47], a[108:111], v[212:215]
 v_mfma_f32_16x16x32_bf16 v[220:223], a[44:47], a[100:103], v[220:223]
 s_add_u32 m0, s29, 122880
 v_mfma_f32_16x16x32_bf16 v[220:223], a[40:43], a[96:99], v[220:223]
 buffer_load_dwordx4 v2, s[16:19], s53 offen lds
 v_mfma_f32_16x16x32_bf16 v[248:251], a[48:51], a[96:99], v[248:251]
 v_mfma_f32_16x16x32_bf16 v[248:251], a[52:55], a[100:103], v[248:251]
 s_waitcnt vmcnt(19)
 v_cvt_pk_bf16_f32 v192, v192, v193
 v_cvt_pk_bf16_f32 v193, v194, v195
 v_mfma_f32_16x16x32_bf16 v[240:243], a[52:55], a[108:111], v[240:243]
 s_barrier
 v_xor_b32 v7, 0, v6
 v_cvt_pk_bf16_f32 v194, v196, v197
 v_mfma_f32_16x16x32_bf16 v[240:243], a[48:51], a[104:107], v[240:243]
 s_add_u32 m0, s29, 126976
 ds_read_b64_tr_b16 a[64:65], v7 offset:0
 v_cvt_pk_bf16_f32 v195, v198, v199
 v_mfma_f32_16x16x32_bf16 v[232:235], a[48:51], a[112:115], v[232:235]
 ds_read_b64_tr_b16 a[66:67], v7 offset:4096
 buffer_load_dwordx4 v2, s[16:19], s54 offen lds
 v_mfma_f32_16x16x32_bf16 v[232:235], a[52:55], a[116:119], v[232:235]
 ds_read_b64_tr_b16 a[68:69], v7 offset:16384
 v_cvt_pk_bf16_f32 v200, v200, v201
 v_mfma_f32_16x16x32_bf16 v[224:227], a[52:55], a[124:127], v[224:227]
 ds_read_b64_tr_b16 a[70:71], v7 offset:20480
 v_xor_b32 v8, 65536, v6
 v_mfma_f32_16x16x32_bf16 v[224:227], a[48:51], a[120:123], v[224:227]
 ds_read_b64_tr_b16 a[72:73], v8 offset:0
 v_cvt_pk_bf16_f32 v201, v202, v203
 v_mfma_f32_16x16x32_bf16 v[228:231], a[56:59], a[120:123], v[228:231]
 ds_read_b64_tr_b16 a[74:75], v8 offset:4096
 v_cvt_pk_bf16_f32 v202, v204, v205
 v_mfma_f32_16x16x32_bf16 v[228:231], a[60:63], a[124:127], v[228:231]
 ds_read_b64_tr_b16 a[76:77], v8 offset:16384
 v_cvt_pk_bf16_f32 v203, v206, v207
 v_mfma_f32_16x16x32_bf16 v[236:239], a[60:63], a[116:119], v[236:239]
 ds_read_b64_tr_b16 a[78:79], v8 offset:20480
 v_xor_b32 v9, 32, v6
 v_mfma_f32_16x16x32_bf16 v[236:239], a[56:59], a[112:115], v[236:239]
 ds_read_b64_tr_b16 a[80:81], v9 offset:0
 v_cvt_pk_bf16_f32 v208, v208, v209
 v_mfma_f32_16x16x32_bf16 v[244:247], a[56:59], a[104:107], v[244:247]
 ds_read_b64_tr_b16 a[82:83], v9 offset:4096
 v_cvt_pk_bf16_f32 v209, v210, v211
 v_mfma_f32_16x16x32_bf16 v[244:247], a[60:63], a[108:111], v[244:247]
 ds_read_b64_tr_b16 a[84:85], v9 offset:16384
 v_cvt_pk_bf16_f32 v210, v212, v213
 v_mfma_f32_16x16x32_bf16 v[252:255], a[60:63], a[100:103], v[252:255]
 ds_read_b64_tr_b16 a[86:87], v9 offset:20480
 v_xor_b32 v10, 65568, v6
 v_mfma_f32_16x16x32_bf16 v[252:255], a[56:59], a[96:99], v[252:255]
 s_waitcnt lgkmcnt(6)
 ds_read_b64_tr_b16 a[88:89], v10 offset:0
 v_cvt_pk_bf16_f32 v211, v214, v215
 v_mfma_f32_16x16x32_bf16 v[28:31], a[64:67], a[128:131], 0
 ds_read_b64_tr_b16 a[90:91], v10 offset:4096
 v_cvt_pk_bf16_f32 v216, v216, v217
 v_mfma_f32_16x16x32_bf16 v[28:31], a[68:71], a[136:139], v[28:31]
 ds_read_b64_tr_b16 a[92:93], v10 offset:16384
 v_xor_b32 v7, 64, v6
 v_mfma_f32_16x16x32_bf16 v[28:31], a[72:75], a[144:147], v[28:31]
 s_waitcnt lgkmcnt(7)
 ds_read_b128 a[112:115], v14 offset:0
 ds_read_b64_tr_b16 a[94:95], v10 offset:20480
 v_mfma_f32_16x16x32_bf16 v[28:31], a[76:79], a[152:155], v[28:31]
 ds_read_b64_tr_b16 a[96:97], v7 offset:0
 v_cvt_pk_bf16_f32 v217, v218, v219
 v_mfma_f32_16x16x32_bf16 v[44:47], a[64:67], a[132:135], 0
 ds_read_b128 a[120:123], v3 offset:0
 ds_read_b64_tr_b16 a[98:99], v7 offset:4096
 v_mfma_f32_16x16x32_bf16 v[44:47], a[68:71], a[140:143], v[44:47]
 ds_read_b64_tr_b16 a[100:101], v7 offset:16384
 v_xor_b32 v8, 65600, v6
 v_mfma_f32_16x16x32_bf16 v[44:47], a[72:75], a[148:151], v[44:47]
 ds_read_b128 a[116:119], v14 offset:2048
 ds_read_b64_tr_b16 a[102:103], v7 offset:20480
 v_mfma_f32_16x16x32_bf16 v[44:47], a[76:79], a[156:159], v[44:47]
 s_waitcnt lgkmcnt(9)
 ds_read_b64_tr_b16 a[104:105], v8 offset:0
 v_cvt_pk_bf16_f32 v218, v220, v221
 v_mfma_f32_16x16x32_bf16 v[52:55], a[80:83], a[128:131], 0
 ds_read_b128 a[124:127], v3 offset:2048
 ds_read_b64_tr_b16 a[106:107], v8 offset:4096
 v_mfma_f32_16x16x32_bf16 v[52:55], a[84:87], a[136:139], v[52:55]
 ds_read_b64_tr_b16 a[108:109], v8 offset:16384
 v_cvt_pk_bf16_f32 v219, v222, v223
 v_mfma_f32_16x16x32_bf16 v[52:55], a[88:91], a[144:147], v[52:55]
 s_waitcnt lgkmcnt(10)
 ds_read_b64_tr_b16 a[110:111], v8 offset:20480
 v_xor_b32 v9, 96, v6
 v_mfma_f32_16x16x32_bf16 v[52:55], a[92:95], a[152:155], v[52:55]
 ds_read_b64_tr_b16 a[64:65], v9 offset:0
 v_cvt_pk_bf16_f32 v224, v224, v225
 v_mfma_f32_16x16x32_bf16 v[60:63], a[80:83], a[132:135], 0
 ds_read_b64_tr_b16 a[66:67], v9 offset:4096
 v_cvt_pk_bf16_f32 v225, v226, v227
 v_mfma_f32_16x16x32_bf16 v[60:63], a[84:87], a[140:143], v[60:63]
 ds_read_b64_tr_b16 a[68:69], v9 offset:16384
 v_cvt_pk_bf16_f32 v226, v228, v229
 v_mfma_f32_16x16x32_bf16 v[60:63], a[88:91], a[148:151], v[60:63]
 ds_read_b64_tr_b16 a[70:71], v9 offset:20480
 v_xor_b32 v10, 65632, v6
 v_mfma_f32_16x16x32_bf16 v[60:63], a[92:95], a[156:159], v[60:63]
 s_waitcnt lgkmcnt(6)
 ds_read_b64_tr_b16 a[72:73], v10 offset:0
 v_cvt_pk_bf16_f32 v227, v230, v231
 v_mfma_f32_16x16x32_bf16 v[20:23], a[96:99], a[128:131], 0
 ds_read_b64_tr_b16 a[74:75], v10 offset:4096
 v_cvt_pk_bf16_f32 v232, v232, v233
 v_mfma_f32_16x16x32_bf16 v[20:23], a[100:103], a[136:139], v[20:23]
 s_waitcnt lgkmcnt(8)
 ds_read_b64_tr_b16 a[76:77], v10 offset:16384
 v_xor_b32 v7, 128, v6
 v_mfma_f32_16x16x32_bf16 v[20:23], a[104:107], a[144:147], v[20:23]
 s_waitcnt lgkmcnt(7)
 s_barrier
 ds_read_b64_tr_b16 a[78:79], v10 offset:20480
 v_mfma_f32_16x16x32_bf16 v[20:23], a[108:111], a[152:155], v[20:23]
 s_add_u32 m0, s29, 131072
 ds_read_b64_tr_b16 a[80:81], v7 offset:0
 v_add_u32 v2, 0x80000, v2
 v_mfma_f32_16x16x32_bf16 v[36:39], a[96:99], a[132:135], 0
 ds_read_b64_tr_b16 a[82:83], v7 offset:4096
 buffer_load_dwordx4 v2, s[16:19], 0 offen lds
 v_mfma_f32_16x16x32_bf16 v[36:39], a[100:103], a[140:143], v[36:39]
 ds_read_b64_tr_b16 a[84:85], v7 offset:16384
 v_cvt_pk_bf16_f32 v233, v234, v235
 v_mfma_f32_16x16x32_bf16 v[36:39], a[104:107], a[148:151], v[36:39]
 ds_read_b64_tr_b16 a[86:87], v7 offset:20480
 v_xor_b32 v8, 65664, v6
 v_mfma_f32_16x16x32_bf16 v[36:39], a[108:111], a[156:159], v[36:39]
 s_waitcnt lgkmcnt(6)
 ds_read_b64_tr_b16 a[88:89], v8 offset:0
 v_cvt_pk_bf16_f32 v234, v236, v237
 v_mfma_f32_16x16x32_bf16 v[68:71], a[64:67], a[128:131], 0
 ds_read_b64_tr_b16 a[90:91], v8 offset:4096
 v_cvt_pk_bf16_f32 v235, v238, v239
 v_mfma_f32_16x16x32_bf16 v[68:71], a[68:71], a[136:139], v[68:71]
 s_add_u32 m0, s29, 135168
 ds_read_b64_tr_b16 a[92:93], v8 offset:16384
 v_cvt_pk_bf16_f32 v240, v240, v241
 v_mfma_f32_16x16x32_bf16 v[68:71], a[72:75], a[144:147], v[68:71]
 s_waitcnt lgkmcnt(7)
 ds_read_b64_tr_b16 a[94:95], v8 offset:20480
 v_xor_b32 v9, 160, v6
 v_mfma_f32_16x16x32_bf16 v[68:71], a[76:79], a[152:155], v[68:71]
 ds_read_b64_tr_b16 a[96:97], v9 offset:0
 buffer_load_dwordx4 v2, s[16:19], s48 offen lds
 v_mfma_f32_16x16x32_bf16 v[76:79], a[64:67], a[132:135], 0
 ds_read_b64_tr_b16 a[98:99], v9 offset:4096
 v_cvt_pk_bf16_f32 v241, v242, v243
 v_mfma_f32_16x16x32_bf16 v[76:79], a[68:71], a[140:143], v[76:79]
 ds_read_b64_tr_b16 a[100:101], v9 offset:16384
 v_cvt_pk_bf16_f32 v242, v244, v245
 v_mfma_f32_16x16x32_bf16 v[76:79], a[72:75], a[148:151], v[76:79]
 ds_read_b64_tr_b16 a[102:103], v9 offset:20480
 v_xor_b32 v10, 65696, v6
 v_mfma_f32_16x16x32_bf16 v[76:79], a[76:79], a[156:159], v[76:79]
 s_waitcnt lgkmcnt(6)
 ds_read_b64_tr_b16 a[104:105], v10 offset:0
 v_cvt_pk_bf16_f32 v243, v246, v247
 v_mfma_f32_16x16x32_bf16 v[84:87], a[80:83], a[128:131], 0
 s_add_u32 m0, s29, 139264
 ds_read_b64_tr_b16 a[106:107], v10 offset:4096
 v_cvt_pk_bf16_f32 v248, v248, v249
 v_mfma_f32_16x16x32_bf16 v[84:87], a[84:87], a[136:139], v[84:87]
 ds_read_b64_tr_b16 a[108:109], v10 offset:16384
 buffer_load_dwordx4 v2, s[16:19], s49 offen lds
 v_mfma_f32_16x16x32_bf16 v[84:87], a[88:91], a[144:147], v[84:87]
 s_waitcnt lgkmcnt(7)
 ds_read_b64_tr_b16 a[110:111], v10 offset:20480
 v_xor_b32 v7, 192, v6
 v_mfma_f32_16x16x32_bf16 v[84:87], a[92:95], a[152:155], v[84:87]
 ds_read_b64_tr_b16 a[64:65], v7 offset:0
 v_cvt_pk_bf16_f32 v249, v250, v251
 v_mfma_f32_16x16x32_bf16 v[92:95], a[80:83], a[132:135], 0
 ds_read_b64_tr_b16 a[66:67], v7 offset:4096
 v_cvt_pk_bf16_f32 v250, v252, v253
 v_mfma_f32_16x16x32_bf16 v[92:95], a[84:87], a[140:143], v[92:95]
 ds_read_b64_tr_b16 a[68:69], v7 offset:16384
 v_cvt_pk_bf16_f32 v251, v254, v255
 v_mfma_f32_16x16x32_bf16 v[92:95], a[88:91], a[148:151], v[92:95]
 s_add_u32 m0, s29, 143360
 ds_read_b64_tr_b16 a[70:71], v7 offset:20480
 v_xor_b32 v8, 65728, v6
 v_mfma_f32_16x16x32_bf16 v[92:95], a[92:95], a[156:159], v[92:95]
 s_waitcnt lgkmcnt(6)
 ds_read_b64_tr_b16 a[72:73], v8 offset:0
 buffer_load_dwordx4 v2, s[16:19], s50 offen lds
 v_mfma_f32_16x16x32_bf16 v[100:103], a[96:99], a[128:131], 0
 ds_read_b64_tr_b16 a[74:75], v8 offset:4096
 v_mov_b32 v12, 0
 v_mfma_f32_16x16x32_bf16 v[100:103], a[100:103], a[136:139], v[100:103]
 ds_read_b64_tr_b16 a[76:77], v8 offset:16384
 global_load_dword v5, v12, s[90:91] offset:128 sc1
 v_mfma_f32_16x16x32_bf16 v[100:103], a[104:107], a[144:147], v[100:103]
 s_waitcnt lgkmcnt(7)
 ds_read_b64_tr_b16 a[78:79], v8 offset:20480
 v_xor_b32 v9, 224, v6
 v_mfma_f32_16x16x32_bf16 v[100:103], a[108:111], a[152:155], v[100:103]
 s_and_b32 s36, s95, 31
 ds_read_b64_tr_b16 a[80:81], v9 offset:0
 v_and_b32 v12, 11, v0
 v_mfma_f32_16x16x32_bf16 v[108:111], a[96:99], a[132:135], 0
 s_add_u32 m0, s29, 147456
 ds_read_b64_tr_b16 a[82:83], v9 offset:4096
 v_lshlrev_b32 v12, 2, v12
 v_mfma_f32_16x16x32_bf16 v[108:111], a[100:103], a[140:143], v[108:111]
 ds_read_b64_tr_b16 a[84:85], v9 offset:16384
 buffer_load_dwordx4 v2, s[16:19], s51 offen lds
 v_mfma_f32_16x16x32_bf16 v[108:111], a[104:107], a[148:151], v[108:111]
 s_lshr_b32 s37, s95, 5
 ds_read_b64_tr_b16 a[86:87], v9 offset:20480
 v_xor_b32 v10, 65760, v6
 v_mfma_f32_16x16x32_bf16 v[108:111], a[108:111], a[156:159], v[108:111]
 s_waitcnt lgkmcnt(6)
 ds_read_b64_tr_b16 a[88:89], v10 offset:0
 v_and_b32 v14, 15, v0
 v_mfma_f32_16x16x32_bf16 v[116:119], a[64:67], a[128:131], 0
 s_lshl_b32 s38, s3, 4
 ds_read_b64_tr_b16 a[90:91], v10 offset:4096
 v_lshrrev_b32 v3, 4, v0
 v_mfma_f32_16x16x32_bf16 v[116:119], a[68:71], a[136:139], v[116:119]
 s_add_u32 m0, s29, 151552
 ds_read_b64_tr_b16 a[92:93], v10 offset:16384
 v_lshlrev_b32 v3, 2, v3
 v_mfma_f32_16x16x32_bf16 v[116:119], a[72:75], a[144:147], v[116:119]
 s_waitcnt lgkmcnt(7)
 ds_read_b64_tr_b16 a[94:95], v10 offset:20480
 v_xor_b32 v7, 256, v6
 v_mfma_f32_16x16x32_bf16 v[116:119], a[76:79], a[152:155], v[116:119]
 ds_read_b64_tr_b16 a[96:97], v7 offset:0
 buffer_load_dwordx4 v2, s[16:19], s52 offen lds
 v_mfma_f32_16x16x32_bf16 v[124:127], a[64:67], a[132:135], 0
 s_lshl_b32 s39, s36, 6
 ds_read_b64_tr_b16 a[98:99], v7 offset:4096
 v_sub_u32 v14, v14, v3
 v_mfma_f32_16x16x32_bf16 v[124:127], a[68:71], a[140:143], v[124:127]
 s_add_u32 s38, s38, s39
 ds_read_b64_tr_b16 a[100:101], v7 offset:16384
 v_lshrrev_b32_e64 v3, 6, s29
 v_mfma_f32_16x16x32_bf16 v[124:127], a[72:75], a[148:151], v[124:127]
 s_mul_i32 s38, s38, 896
 ds_read_b64_tr_b16 a[102:103], v7 offset:20480
 v_xor_b32 v8, 65792, v6
 v_mfma_f32_16x16x32_bf16 v[124:127], a[76:79], a[156:159], v[124:127]
 s_waitcnt lgkmcnt(6)
 ds_read_b64_tr_b16 a[104:105], v8 offset:0
 v_add_u32 v14, v3, v14
 v_mfma_f32_16x16x32_bf16 v[132:135], a[80:83], a[128:131], 0
 s_add_u32 m0, s29, 155648
 ds_read_b64_tr_b16 a[106:107], v8 offset:4096
 v_mov_b32 v15, 0xf149f2ca
 v_mfma_f32_16x16x32_bf16 v[132:135], a[84:87], a[136:139], v[132:135]
 ds_read_b64_tr_b16 a[108:109], v8 offset:16384
 buffer_load_dwordx4 v2, s[16:19], s53 offen lds
 v_mfma_f32_16x16x32_bf16 v[132:135], a[88:91], a[144:147], v[132:135]
 s_waitcnt lgkmcnt(7)
 ds_read_b64_tr_b16 a[110:111], v8 offset:20480
 v_xor_b32 v9, 288, v6
 v_mfma_f32_16x16x32_bf16 v[132:135], a[92:95], a[152:155], v[132:135]
 s_lshl_b32 s39, s37, 7
 ds_read_b64_tr_b16 a[64:65], v9 offset:0
 v_cmp_gt_i32 vcc, 0, v14
 v_mfma_f32_16x16x32_bf16 v[140:143], a[80:83], a[132:135], 0
 s_add_u32 s38, s38, s39
 ds_read_b64_tr_b16 a[66:67], v9 offset:4096
 v_cndmask_b32 v3, 0, v15, vcc
 v_mfma_f32_16x16x32_bf16 v[140:143], a[84:87], a[140:143], v[140:143]
 s_lshl_b32 s39, s37, 9
 ds_read_b64_tr_b16 a[68:69], v9 offset:16384
 v_accvgpr_write_b32 a224, v3
 v_mfma_f32_16x16x32_bf16 v[140:143], a[88:91], a[148:151], v[140:143]
 s_add_u32 m0, s29, 159744
 ds_read_b64_tr_b16 a[70:71], v9 offset:20480
 v_xor_b32 v10, 65824, v6
 v_mfma_f32_16x16x32_bf16 v[140:143], a[92:95], a[156:159], v[140:143]
 s_waitcnt lgkmcnt(6)
 ds_read_b64_tr_b16 a[72:73], v10 offset:0
 buffer_load_dwordx4 v2, s[16:19], s54 offen lds
 v_mfma_f32_16x16x32_bf16 v[148:151], a[96:99], a[128:131], 0
 s_mov_b32 s4, s66
 ds_read_b64_tr_b16 a[74:75], v10 offset:4096
 v_cmp_gt_i32 vcc, 1, v14
 v_mfma_f32_16x16x32_bf16 v[148:151], a[100:103], a[136:139], v[148:151]
 s_mov_b32 s5, s67
 ds_read_b64_tr_b16 a[76:77], v10 offset:16384
 v_cndmask_b32 v3, 0, v15, vcc
 v_mfma_f32_16x16x32_bf16 v[148:151], a[104:107], a[144:147], v[148:151]
 s_waitcnt lgkmcnt(7)
 ds_read_b64_tr_b16 a[78:79], v10 offset:20480
 v_xor_b32 v7, 320, v6
 v_mfma_f32_16x16x32_bf16 v[148:151], a[108:111], a[152:155], v[148:151]
 s_mov_b32 s6, 1835008
 ds_read_b64_tr_b16 a[80:81], v7 offset:0
 v_accvgpr_write_b32 a225, v3
 v_mfma_f32_16x16x32_bf16 v[156:159], a[96:99], a[132:135], 0
 s_mov_b32 s7, 0x20000
 ds_read_b64_tr_b16 a[82:83], v7 offset:4096
 v_cmp_gt_i32 vcc, 2, v14
 v_mfma_f32_16x16x32_bf16 v[156:159], a[100:103], a[140:143], v[156:159]
 s_mov_b32 s8, s68
 ds_read_b64_tr_b16 a[84:85], v7 offset:16384
 v_cndmask_b32 v3, 0, v15, vcc
 v_mfma_f32_16x16x32_bf16 v[156:159], a[104:107], a[148:151], v[156:159]
 s_mov_b32 s9, s69
 ds_read_b64_tr_b16 a[86:87], v7 offset:20480
 v_xor_b32 v8, 65856, v6
 v_mfma_f32_16x16x32_bf16 v[156:159], a[108:111], a[156:159], v[156:159]
 s_waitcnt lgkmcnt(6)
 ds_read_b64_tr_b16 a[88:89], v8 offset:0
 v_accvgpr_write_b32 a226, v3
 v_mfma_f32_16x16x32_bf16 v[164:167], a[64:67], a[128:131], 0
 s_mov_b32 s10, 1835008
 ds_read_b64_tr_b16 a[90:91], v8 offset:4096
 v_cmp_gt_i32 vcc, 3, v14
 v_mfma_f32_16x16x32_bf16 v[164:167], a[68:71], a[136:139], v[164:167]
 s_mov_b32 s11, 0x20000
 ds_read_b64_tr_b16 a[92:93], v8 offset:16384
 v_cndmask_b32 v3, 0, v15, vcc
 v_mfma_f32_16x16x32_bf16 v[164:167], a[72:75], a[144:147], v[164:167]
 s_waitcnt lgkmcnt(7)
 ds_read_b64_tr_b16 a[94:95], v8 offset:20480
 v_xor_b32 v9, 352, v6
 v_mfma_f32_16x16x32_bf16 v[164:167], a[76:79], a[152:155], v[164:167]
 s_mov_b32 s20, s70
 ds_read_b64_tr_b16 a[96:97], v9 offset:0
 v_accvgpr_write_b32 a227, v3
 v_mfma_f32_16x16x32_bf16 v[172:175], a[64:67], a[132:135], 0
 s_mov_b32 s21, s71
 ds_read_b64_tr_b16 a[98:99], v9 offset:4096
 v_cmp_gt_i32 vcc, 16, v14
 v_mfma_f32_16x16x32_bf16 v[172:175], a[68:71], a[140:143], v[172:175]
 s_mov_b32 s22, 3584
 ds_read_b64_tr_b16 a[100:101], v9 offset:16384
 v_cndmask_b32 v3, 0, v15, vcc
 v_mfma_f32_16x16x32_bf16 v[172:175], a[72:75], a[148:151], v[172:175]
 s_mov_b32 s23, 0x20000
 ds_read_b64_tr_b16 a[102:103], v9 offset:20480
 v_xor_b32 v10, 65888, v6
 v_mfma_f32_16x16x32_bf16 v[172:175], a[76:79], a[156:159], v[172:175]
 s_waitcnt lgkmcnt(6)
 ds_read_b64_tr_b16 a[104:105], v10 offset:0
 v_accvgpr_write_b32 a228, v3
 v_mfma_f32_16x16x32_bf16 v[180:183], a[80:83], a[128:131], 0
 ds_read_b64_tr_b16 a[106:107], v10 offset:4096
 v_cmp_gt_i32 vcc, 17, v14
 v_mfma_f32_16x16x32_bf16 v[180:183], a[84:87], a[136:139], v[180:183]
 ds_read_b64_tr_b16 a[108:109], v10 offset:16384
 v_cndmask_b32 v3, 0, v15, vcc
 v_mfma_f32_16x16x32_bf16 v[180:183], a[88:91], a[144:147], v[180:183]
 s_waitcnt lgkmcnt(7)
 ds_read_b64_tr_b16 a[110:111], v10 offset:20480
 v_xor_b32 v7, 384, v6
 v_mfma_f32_16x16x32_bf16 v[180:183], a[92:95], a[152:155], v[180:183]
 ds_read_b64_tr_b16 a[64:65], v7 offset:0
 v_accvgpr_write_b32 a229, v3
 v_mfma_f32_16x16x32_bf16 v[188:191], a[80:83], a[132:135], 0
 ds_read_b64_tr_b16 a[66:67], v7 offset:4096
 v_cmp_gt_i32 vcc, 18, v14
 v_mfma_f32_16x16x32_bf16 v[188:191], a[84:87], a[140:143], v[188:191]
 ds_read_b64_tr_b16 a[68:69], v7 offset:16384
 v_cndmask_b32 v3, 0, v15, vcc
 v_mfma_f32_16x16x32_bf16 v[188:191], a[88:91], a[148:151], v[188:191]
 ds_read_b64_tr_b16 a[70:71], v7 offset:20480
 v_xor_b32 v8, 65920, v6
 v_mfma_f32_16x16x32_bf16 v[188:191], a[92:95], a[156:159], v[188:191]
 s_waitcnt lgkmcnt(6)
 ds_read_b64_tr_b16 a[72:73], v8 offset:0
 v_accvgpr_write_b32 a230, v3
 v_mfma_f32_16x16x32_bf16 v[196:199], a[96:99], a[128:131], 0
 ds_read_b64_tr_b16 a[74:75], v8 offset:4096
 v_cmp_gt_i32 vcc, 19, v14
 v_mfma_f32_16x16x32_bf16 v[196:199], a[100:103], a[136:139], v[196:199]
 ds_read_b64_tr_b16 a[76:77], v8 offset:16384
 v_cndmask_b32 v3, 0, v15, vcc
 v_mfma_f32_16x16x32_bf16 v[196:199], a[104:107], a[144:147], v[196:199]
 s_waitcnt lgkmcnt(7)
 ds_read_b64_tr_b16 a[78:79], v8 offset:20480
 v_xor_b32 v9, 416, v6
 v_mfma_f32_16x16x32_bf16 v[196:199], a[108:111], a[152:155], v[196:199]
 ds_read_b64_tr_b16 a[80:81], v9 offset:0
 v_accvgpr_write_b32 a231, v3
 v_mfma_f32_16x16x32_bf16 v[204:207], a[96:99], a[132:135], 0
 ds_read_b64_tr_b16 a[82:83], v9 offset:4096
 v_cmp_gt_i32 vcc, 32, v14
 v_mfma_f32_16x16x32_bf16 v[204:207], a[100:103], a[140:143], v[204:207]
 ds_read_b64_tr_b16 a[84:85], v9 offset:16384
 v_cndmask_b32 v3, 0, v15, vcc
 v_mfma_f32_16x16x32_bf16 v[204:207], a[104:107], a[148:151], v[204:207]
 ds_read_b64_tr_b16 a[86:87], v9 offset:20480
 v_xor_b32 v10, 65952, v6
 v_mfma_f32_16x16x32_bf16 v[204:207], a[108:111], a[156:159], v[204:207]
 s_waitcnt lgkmcnt(6)
 ds_read_b64_tr_b16 a[88:89], v10 offset:0
 v_accvgpr_write_b32 a232, v3
 v_mfma_f32_16x16x32_bf16 v[212:215], a[64:67], a[128:131], 0
 ds_read_b64_tr_b16 a[90:91], v10 offset:4096
 v_cmp_gt_i32 vcc, 33, v14
 v_mfma_f32_16x16x32_bf16 v[212:215], a[68:71], a[136:139], v[212:215]
 ds_read_b64_tr_b16 a[92:93], v10 offset:16384
 v_cndmask_b32 v3, 0, v15, vcc
 v_mfma_f32_16x16x32_bf16 v[212:215], a[72:75], a[144:147], v[212:215]
 s_waitcnt lgkmcnt(7)
 ds_read_b64_tr_b16 a[94:95], v10 offset:20480
 v_xor_b32 v7, 448, v6
 v_mfma_f32_16x16x32_bf16 v[212:215], a[76:79], a[152:155], v[212:215]
 s_add_u32 s59, s56, 57344
 ds_read_b64_tr_b16 a[96:97], v7 offset:0
 v_accvgpr_write_b32 a233, v3
 v_mfma_f32_16x16x32_bf16 v[220:223], a[64:67], a[132:135], 0
 ds_read_b64_tr_b16 a[98:99], v7 offset:4096
 buffer_store_dwordx4 v[32:35], v1, s[12:15], s59 offen offset:1024 sc1
 v_mfma_f32_16x16x32_bf16 v[220:223], a[68:71], a[140:143], v[220:223]
 ds_read_b64_tr_b16 a[100:101], v7 offset:16384
 v_cmp_gt_i32 vcc, 34, v14
 v_mfma_f32_16x16x32_bf16 v[220:223], a[72:75], a[148:151], v[220:223]
 ds_read_b64_tr_b16 a[102:103], v7 offset:20480
 v_xor_b32 v8, 65984, v6
 v_mfma_f32_16x16x32_bf16 v[220:223], a[76:79], a[156:159], v[220:223]
 s_waitcnt lgkmcnt(6)
 ds_read_b64_tr_b16 a[104:105], v8 offset:0
 v_cndmask_b32 v3, 0, v15, vcc
 v_mfma_f32_16x16x32_bf16 v[228:231], a[80:83], a[128:131], 0
 ds_read_b64_tr_b16 a[106:107], v8 offset:4096
 v_accvgpr_write_b32 a234, v3
 v_mfma_f32_16x16x32_bf16 v[228:231], a[84:87], a[136:139], v[228:231]
 ds_read_b64_tr_b16 a[108:109], v8 offset:16384
 v_cmp_gt_i32 vcc, 35, v14
 v_mfma_f32_16x16x32_bf16 v[228:231], a[88:91], a[144:147], v[228:231]
 s_waitcnt lgkmcnt(7)
 ds_read_b64_tr_b16 a[110:111], v8 offset:20480
 v_xor_b32 v9, 480, v6
 v_mfma_f32_16x16x32_bf16 v[228:231], a[92:95], a[152:155], v[228:231]
 ds_read_b64_tr_b16 a[64:65], v9 offset:0
 v_cndmask_b32 v3, 0, v15, vcc
 v_mfma_f32_16x16x32_bf16 v[236:239], a[80:83], a[132:135], 0
 ds_read_b64_tr_b16 a[66:67], v9 offset:4096
 v_accvgpr_write_b32 a235, v3
 v_mfma_f32_16x16x32_bf16 v[236:239], a[84:87], a[140:143], v[236:239]
 ds_read_b64_tr_b16 a[68:69], v9 offset:16384
 v_cmp_gt_i32 vcc, 48, v14
 v_mfma_f32_16x16x32_bf16 v[236:239], a[88:91], a[148:151], v[236:239]
 s_add_u32 s59, s56, 49152
 ds_read_b64_tr_b16 a[70:71], v9 offset:20480
 v_xor_b32 v10, 66016, v6
 v_mfma_f32_16x16x32_bf16 v[236:239], a[92:95], a[156:159], v[236:239]
 s_waitcnt lgkmcnt(6)
 ds_read_b64_tr_b16 a[72:73], v10 offset:0
 buffer_store_dwordx4 v[40:43], v1, s[12:15], s59 offen offset:1024 sc1
 v_mfma_f32_16x16x32_bf16 v[244:247], a[96:99], a[128:131], 0
 ds_read_b64_tr_b16 a[74:75], v10 offset:4096
 v_cndmask_b32 v3, 0, v15, vcc
 v_mfma_f32_16x16x32_bf16 v[244:247], a[100:103], a[136:139], v[244:247]
 s_waitcnt vmcnt(11)
 ds_read_b64_tr_b16 a[76:77], v10 offset:16384
 v_xor_b32 v7, 32768, v6
 v_mfma_f32_16x16x32_bf16 v[244:247], a[104:107], a[144:147], v[244:247]
 s_waitcnt lgkmcnt(7)
 s_barrier
 ds_read_b64_tr_b16 a[78:79], v10 offset:20480
 v_mfma_f32_16x16x32_bf16 v[244:247], a[108:111], a[152:155], v[244:247]
 ds_read_b64_tr_b16 a[80:81], v7 offset:0
 v_accvgpr_write_b32 a236, v3
 v_mfma_f32_16x16x32_bf16 v[252:255], a[96:99], a[132:135], 0
 ds_read_b64_tr_b16 a[82:83], v7 offset:4096
 v_cmp_gt_i32 vcc, 49, v14
 v_mfma_f32_16x16x32_bf16 v[252:255], a[100:103], a[140:143], v[252:255]
 ds_read_b64_tr_b16 a[84:85], v7 offset:16384
 v_cndmask_b32 v3, 0, v15, vcc
 v_mfma_f32_16x16x32_bf16 v[252:255], a[104:107], a[148:151], v[252:255]
 ds_read_b64_tr_b16 a[86:87], v7 offset:20480
 v_xor_b32 v8, 98304, v6
 v_mfma_f32_16x16x32_bf16 v[252:255], a[108:111], a[156:159], v[252:255]
 s_waitcnt lgkmcnt(6)
 ds_read_b64_tr_b16 a[88:89], v8 offset:0
 v_accvgpr_write_b32 a237, v3
 v_mfma_f32_16x16x32_bf16 v[16:19], a[64:67], a[128:131], 0
 s_add_u32 s59, s56, 40960
 ds_read_b64_tr_b16 a[90:91], v8 offset:4096
 v_cmp_gt_i32 vcc, 50, v14
 v_mfma_f32_16x16x32_bf16 v[16:19], a[68:71], a[136:139], v[16:19]
 ds_read_b64_tr_b16 a[92:93], v8 offset:16384
 buffer_store_dwordx4 v[48:51], v1, s[12:15], s59 offen offset:1024 sc1
 v_mfma_f32_16x16x32_bf16 v[16:19], a[72:75], a[144:147], v[16:19]
 s_waitcnt lgkmcnt(7)
 ds_read_b64_tr_b16 a[94:95], v8 offset:20480
 v_xor_b32 v9, 32800, v6
 v_mfma_f32_16x16x32_bf16 v[16:19], a[76:79], a[152:155], v[16:19]
 ds_read_b64_tr_b16 a[96:97], v9 offset:0
 v_cndmask_b32 v3, 0, v15, vcc
 v_mfma_f32_16x16x32_bf16 v[24:27], a[64:67], a[132:135], 0
 s_waitcnt lgkmcnt(9)
 ds_read_b64_tr_b16 a[98:99], v9 offset:4096
 v_accvgpr_write_b32 a238, v3
 v_mfma_f32_16x16x32_bf16 v[24:27], a[68:71], a[140:143], v[24:27]
 s_barrier
 ds_read_b64_tr_b16 a[100:101], v9 offset:16384
 v_cmp_gt_i32 vcc, 51, v14
 v_mfma_f32_16x16x32_bf16 v[24:27], a[72:75], a[148:151], v[24:27]
 s_add_u32 m0, s29, 0
 ds_read_b64_tr_b16 a[102:103], v9 offset:20480
 v_xor_b32 v10, 98336, v6
 v_mfma_f32_16x16x32_bf16 v[24:27], a[76:79], a[156:159], v[24:27]
 s_waitcnt lgkmcnt(6)
 ds_read_b64_tr_b16 a[104:105], v10 offset:0
 v_add_u32 v2, 0x80000, v2
 v_mfma_f32_16x16x32_bf16 v[28:31], a[80:83], a[160:163], v[28:31]
 ds_read_b64_tr_b16 a[106:107], v10 offset:4096
 buffer_load_dwordx4 v2, s[16:19], 0 offen lds
 v_mfma_f32_16x16x32_bf16 v[28:31], a[84:87], a[168:171], v[28:31]
 s_add_u32 s59, s56, 32768
 ds_read_b64_tr_b16 a[108:109], v10 offset:16384
 v_cndmask_b32 v3, 0, v15, vcc
 v_mfma_f32_16x16x32_bf16 v[28:31], a[88:91], a[176:179], v[28:31]
 s_waitcnt lgkmcnt(7)
 ds_read_b64_tr_b16 a[110:111], v10 offset:20480
 v_xor_b32 v7, 32832, v6
 v_mfma_f32_16x16x32_bf16 v[28:31], a[92:95], a[184:187], v[28:31]
 ds_read_b64_tr_b16 a[64:65], v7 offset:0
 buffer_store_dwordx4 v[56:59], v1, s[12:15], s59 offen offset:1024 sc1
 v_mfma_f32_16x16x32_bf16 v[44:47], a[80:83], a[164:167], v[44:47]
 s_add_u32 m0, s29, 4096
 ds_read_b64_tr_b16 a[66:67], v7 offset:4096
 v_add_u32 v4, 4096, v1
 v_mfma_f32_16x16x32_bf16 v[44:47], a[84:87], a[172:175], v[44:47]
 ds_read_b64_tr_b16 a[68:69], v7 offset:16384
 buffer_load_dwordx4 v2, s[16:19], s48 offen lds
 v_mfma_f32_16x16x32_bf16 v[44:47], a[88:91], a[180:183], v[44:47]
 ds_read_b64_tr_b16 a[70:71], v7 offset:20480
 v_xor_b32 v8, 98368, v6
 v_mfma_f32_16x16x32_bf16 v[44:47], a[92:95], a[188:191], v[44:47]
 s_waitcnt lgkmcnt(6)
 ds_read_b64_tr_b16 a[72:73], v8 offset:0
 v_accvgpr_write_b32 a239, v3
 v_mfma_f32_16x16x32_bf16 v[52:55], a[96:99], a[160:163], v[52:55]
 ds_read_b64_tr_b16 a[74:75], v8 offset:4096
 v_mfma_f32_16x16x32_bf16 v[52:55], a[100:103], a[168:171], v[52:55]
 s_add_u32 m0, s29, 8192
 ds_read_b64_tr_b16 a[76:77], v8 offset:16384
 v_mfma_f32_16x16x32_bf16 v[52:55], a[104:107], a[176:179], v[52:55]
 s_waitcnt lgkmcnt(7)
 ds_read_b64_tr_b16 a[78:79], v8 offset:20480
 v_xor_b32 v9, 32864, v6
 v_mfma_f32_16x16x32_bf16 v[52:55], a[108:111], a[184:187], v[52:55]
 ds_read_b64_tr_b16 a[80:81], v9 offset:0
 buffer_load_dwordx4 v2, s[16:19], s49 offen lds
 v_mfma_f32_16x16x32_bf16 v[60:63], a[96:99], a[164:167], v[60:63]
 s_add_u32 s59, s56, 24576
 ds_read_b64_tr_b16 a[82:83], v9 offset:4096
 v_mfma_f32_16x16x32_bf16 v[60:63], a[100:103], a[172:175], v[60:63]
 ds_read_b64_tr_b16 a[84:85], v9 offset:16384
 buffer_store_dwordx4 v[64:67], v1, s[12:15], s59 offen offset:0 sc1
 v_mfma_f32_16x16x32_bf16 v[60:63], a[104:107], a[180:183], v[60:63]
 s_add_u32 m0, s29, 12288
 ds_read_b64_tr_b16 a[86:87], v9 offset:20480
 v_xor_b32 v10, 98400, v6
 v_mfma_f32_16x16x32_bf16 v[60:63], a[108:111], a[188:191], v[60:63]
 s_waitcnt lgkmcnt(6)
 ds_read_b64_tr_b16 a[88:89], v10 offset:0
 v_mfma_f32_16x16x32_bf16 v[20:23], a[64:67], a[160:163], v[20:23]
 ds_read_b64_tr_b16 a[90:91], v10 offset:4096
 buffer_load_dwordx4 v2, s[16:19], s50 offen lds
 v_mfma_f32_16x16x32_bf16 v[20:23], a[68:71], a[168:171], v[20:23]
 ds_read_b64_tr_b16 a[92:93], v10 offset:16384
 v_mfma_f32_16x16x32_bf16 v[20:23], a[72:75], a[176:179], v[20:23]
 s_waitcnt lgkmcnt(7)
 ds_read_b64_tr_b16 a[94:95], v10 offset:20480
 v_xor_b32 v7, 32896, v6
 v_mfma_f32_16x16x32_bf16 v[20:23], a[76:79], a[184:187], v[20:23]
 ds_read_b64_tr_b16 a[96:97], v7 offset:0
 v_mfma_f32_16x16x32_bf16 v[36:39], a[64:67], a[164:167], v[36:39]
 s_add_u32 m0, s29, 16384
 ds_read_b64_tr_b16 a[98:99], v7 offset:4096
 v_mfma_f32_16x16x32_bf16 v[36:39], a[68:71], a[172:175], v[36:39]
 ds_read_b64_tr_b16 a[100:101], v7 offset:16384
 buffer_load_dwordx4 v2, s[16:19], s51 offen lds
 v_mfma_f32_16x16x32_bf16 v[36:39], a[72:75], a[180:183], v[36:39]
 s_add_u32 s59, s56, 16384
 ds_read_b64_tr_b16 a[102:103], v7 offset:20480
 v_xor_b32 v8, 98432, v6
 v_mfma_f32_16x16x32_bf16 v[36:39], a[76:79], a[188:191], v[36:39]
 s_waitcnt lgkmcnt(6)
 ds_read_b64_tr_b16 a[104:105], v8 offset:0
 buffer_store_dwordx4 v[72:75], v1, s[12:15], s59 offen offset:0 sc1
 v_mfma_f32_16x16x32_bf16 v[68:71], a[80:83], a[160:163], v[68:71]
 ds_read_b64_tr_b16 a[106:107], v8 offset:4096
 v_mfma_f32_16x16x32_bf16 v[68:71], a[84:87], a[168:171], v[68:71]
 s_add_u32 m0, s29, 20480
 ds_read_b64_tr_b16 a[108:109], v8 offset:16384
 v_mfma_f32_16x16x32_bf16 v[68:71], a[88:91], a[176:179], v[68:71]
 s_waitcnt lgkmcnt(7)
 ds_read_b64_tr_b16 a[110:111], v8 offset:20480
 v_xor_b32 v9, 32928, v6
 v_mfma_f32_16x16x32_bf16 v[68:71], a[92:95], a[184:187], v[68:71]
 ds_read_b64_tr_b16 a[64:65], v9 offset:0
 buffer_load_dwordx4 v2, s[16:19], s52 offen lds
 v_mfma_f32_16x16x32_bf16 v[76:79], a[80:83], a[164:167], v[76:79]
 ds_read_b64_tr_b16 a[66:67], v9 offset:4096
 v_mfma_f32_16x16x32_bf16 v[76:79], a[84:87], a[172:175], v[76:79]
 ds_read_b64_tr_b16 a[68:69], v9 offset:16384
 v_mfma_f32_16x16x32_bf16 v[76:79], a[88:91], a[180:183], v[76:79]
 s_add_u32 m0, s29, 24576
 ds_read_b64_tr_b16 a[70:71], v9 offset:20480
 v_xor_b32 v10, 98464, v6
 v_mfma_f32_16x16x32_bf16 v[76:79], a[92:95], a[188:191], v[76:79]
 s_waitcnt lgkmcnt(6)
 ds_read_b64_tr_b16 a[72:73], v10 offset:0
 v_mfma_f32_16x16x32_bf16 v[84:87], a[96:99], a[160:163], v[84:87]
 ds_read_b64_tr_b16 a[74:75], v10 offset:4096
 buffer_load_dwordx4 v2, s[16:19], s53 offen lds
 v_mfma_f32_16x16x32_bf16 v[84:87], a[100:103], a[168:171], v[84:87]
 s_add_u32 s59, s56, 8192
 ds_read_b64_tr_b16 a[76:77], v10 offset:16384
 v_mfma_f32_16x16x32_bf16 v[84:87], a[104:107], a[176:179], v[84:87]
 s_waitcnt lgkmcnt(7)
 ds_read_b64_tr_b16 a[78:79], v10 offset:20480
 v_xor_b32 v7, 32960, v6
 v_mfma_f32_16x16x32_bf16 v[84:87], a[108:111], a[184:187], v[84:87]
 ds_read_b64_tr_b16 a[80:81], v7 offset:0
 buffer_store_dwordx4 v[80:83], v1, s[12:15], s59 offen offset:0 sc1
 v_mfma_f32_16x16x32_bf16 v[92:95], a[96:99], a[164:167], v[92:95]
 s_add_u32 m0, s29, 28672
 ds_read_b64_tr_b16 a[82:83], v7 offset:4096
 v_mfma_f32_16x16x32_bf16 v[92:95], a[100:103], a[172:175], v[92:95]
 ds_read_b64_tr_b16 a[84:85], v7 offset:16384
 buffer_load_dwordx4 v2, s[16:19], s54 offen lds
 v_mfma_f32_16x16x32_bf16 v[92:95], a[104:107], a[180:183], v[92:95]
 ds_read_b64_tr_b16 a[86:87], v7 offset:20480
 v_xor_b32 v8, 98496, v6
 v_mfma_f32_16x16x32_bf16 v[92:95], a[108:111], a[188:191], v[92:95]
 s_waitcnt lgkmcnt(6)
 ds_read_b64_tr_b16 a[88:89], v8 offset:0
 v_mfma_f32_16x16x32_bf16 v[100:103], a[64:67], a[160:163], v[100:103]
 s_add_u32 m0, s29, 65536
 ds_read_b64_tr_b16 a[90:91], v8 offset:4096
 v_add_u32 v2, 0x80000, v2
 v_mfma_f32_16x16x32_bf16 v[100:103], a[68:71], a[168:171], v[100:103]
 ds_read_b64_tr_b16 a[92:93], v8 offset:16384
 buffer_load_dwordx4 v2, s[16:19], 0 offen lds
 v_mfma_f32_16x16x32_bf16 v[100:103], a[72:75], a[176:179], v[100:103]
 s_waitcnt lgkmcnt(7)
 ds_read_b64_tr_b16 a[94:95], v8 offset:20480
 v_xor_b32 v9, 32992, v6
 v_mfma_f32_16x16x32_bf16 v[100:103], a[76:79], a[184:187], v[100:103]
 ds_read_b64_tr_b16 a[96:97], v9 offset:0
 v_mfma_f32_16x16x32_bf16 v[108:111], a[64:67], a[164:167], v[108:111]
 s_add_u32 s59, s56, 0
 ds_read_b64_tr_b16 a[98:99], v9 offset:4096
 v_mfma_f32_16x16x32_bf16 v[108:111], a[68:71], a[172:175], v[108:111]
 ds_read_b64_tr_b16 a[100:101], v9 offset:16384
 buffer_store_dwordx4 v[88:91], v1, s[12:15], s59 offen offset:0 sc1
 v_mfma_f32_16x16x32_bf16 v[108:111], a[72:75], a[180:183], v[108:111]
 s_add_u32 m0, s29, 69632
 ds_read_b64_tr_b16 a[102:103], v9 offset:20480
 v_xor_b32 v10, 98528, v6
 v_mfma_f32_16x16x32_bf16 v[108:111], a[76:79], a[188:191], v[108:111]
 s_waitcnt lgkmcnt(6)
 ds_read_b64_tr_b16 a[104:105], v10 offset:0
 buffer_load_dwordx4 v2, s[16:19], s48 offen lds
 v_mfma_f32_16x16x32_bf16 v[116:119], a[80:83], a[160:163], v[116:119]
 ds_read_b64_tr_b16 a[106:107], v10 offset:4096
 v_mfma_f32_16x16x32_bf16 v[116:119], a[84:87], a[168:171], v[116:119]
 ds_read_b64_tr_b16 a[108:109], v10 offset:16384
 v_mfma_f32_16x16x32_bf16 v[116:119], a[88:91], a[176:179], v[116:119]
 s_waitcnt lgkmcnt(7)
 ds_read_b64_tr_b16 a[110:111], v10 offset:20480
 v_xor_b32 v7, 33024, v6
 v_mfma_f32_16x16x32_bf16 v[116:119], a[92:95], a[184:187], v[116:119]
 s_add_u32 m0, s29, 73728
 ds_read_b64_tr_b16 a[64:65], v7 offset:0
 v_mfma_f32_16x16x32_bf16 v[124:127], a[80:83], a[164:167], v[124:127]
 ds_read_b64_tr_b16 a[66:67], v7 offset:4096
 buffer_load_dwordx4 v2, s[16:19], s49 offen lds
 v_mfma_f32_16x16x32_bf16 v[124:127], a[84:87], a[172:175], v[124:127]
 ds_read_b64_tr_b16 a[68:69], v7 offset:16384
 v_mfma_f32_16x16x32_bf16 v[124:127], a[88:91], a[180:183], v[124:127]
 s_add_u32 s59, s56, 24576
 ds_read_b64_tr_b16 a[70:71], v7 offset:20480
 v_xor_b32 v8, 98560, v6
 v_mfma_f32_16x16x32_bf16 v[124:127], a[92:95], a[188:191], v[124:127]
 s_waitcnt lgkmcnt(6)
 ds_read_b64_tr_b16 a[72:73], v8 offset:0
 buffer_store_dwordx4 v[96:99], v1, s[12:15], s59 offen offset:1024 sc1
 v_mfma_f32_16x16x32_bf16 v[132:135], a[96:99], a[160:163], v[132:135]
 s_add_u32 m0, s29, 77824
 ds_read_b64_tr_b16 a[74:75], v8 offset:4096
 v_mfma_f32_16x16x32_bf16 v[132:135], a[100:103], a[168:171], v[132:135]
 ds_read_b64_tr_b16 a[76:77], v8 offset:16384
 buffer_load_dwordx4 v2, s[16:19], s50 offen lds
 v_mfma_f32_16x16x32_bf16 v[132:135], a[104:107], a[176:179], v[132:135]
 s_waitcnt lgkmcnt(7)
 ds_read_b64_tr_b16 a[78:79], v8 offset:20480
 v_xor_b32 v9, 33056, v6
 v_mfma_f32_16x16x32_bf16 v[132:135], a[108:111], a[184:187], v[132:135]
 ds_read_b64_tr_b16 a[80:81], v9 offset:0
 v_mfma_f32_16x16x32_bf16 v[140:143], a[96:99], a[164:167], v[140:143]
 ds_read_b64_tr_b16 a[82:83], v9 offset:4096
 v_mfma_f32_16x16x32_bf16 v[140:143], a[100:103], a[172:175], v[140:143]
 ds_read_b64_tr_b16 a[84:85], v9 offset:16384
 v_mfma_f32_16x16x32_bf16 v[140:143], a[104:107], a[180:183], v[140:143]
 s_add_u32 m0, s29, 81920
 ds_read_b64_tr_b16 a[86:87], v9 offset:20480
 v_xor_b32 v10, 98592, v6
 v_mfma_f32_16x16x32_bf16 v[140:143], a[108:111], a[188:191], v[140:143]
 s_waitcnt lgkmcnt(6)
 ds_read_b64_tr_b16 a[88:89], v10 offset:0
 buffer_load_dwordx4 v2, s[16:19], s51 offen lds
 v_mfma_f32_16x16x32_bf16 v[148:151], a[64:67], a[160:163], v[148:151]
 s_add_u32 s59, s56, 16384
 ds_read_b64_tr_b16 a[90:91], v10 offset:4096
 v_mfma_f32_16x16x32_bf16 v[148:151], a[68:71], a[168:171], v[148:151]
 ds_read_b64_tr_b16 a[92:93], v10 offset:16384
 buffer_store_dwordx4 v[104:107], v1, s[12:15], s59 offen offset:1024 sc1
 v_mfma_f32_16x16x32_bf16 v[148:151], a[72:75], a[176:179], v[148:151]
 s_waitcnt lgkmcnt(7)
 ds_read_b64_tr_b16 a[94:95], v10 offset:20480
 v_xor_b32 v7, 33088, v6
 v_mfma_f32_16x16x32_bf16 v[148:151], a[76:79], a[184:187], v[148:151]
 s_add_u32 m0, s29, 86016
 ds_read_b64_tr_b16 a[96:97], v7 offset:0
 v_mfma_f32_16x16x32_bf16 v[156:159], a[64:67], a[164:167], v[156:159]
 ds_read_b64_tr_b16 a[98:99], v7 offset:4096
 buffer_load_dwordx4 v2, s[16:19], s52 offen lds
 v_mfma_f32_16x16x32_bf16 v[156:159], a[68:71], a[172:175], v[156:159]
 ds_read_b64_tr_b16 a[100:101], v7 offset:16384
 v_mfma_f32_16x16x32_bf16 v[156:159], a[72:75], a[180:183], v[156:159]
 ds_read_b64_tr_b16 a[102:103], v7 offset:20480
 v_xor_b32 v8, 98624, v6
 v_mfma_f32_16x16x32_bf16 v[156:159], a[76:79], a[188:191], v[156:159]
 s_waitcnt lgkmcnt(6)
 ds_read_b64_tr_b16 a[104:105], v8 offset:0
 v_mfma_f32_16x16x32_bf16 v[164:167], a[80:83], a[160:163], v[164:167]
 s_add_u32 m0, s29, 90112
 ds_read_b64_tr_b16 a[106:107], v8 offset:4096
 v_mfma_f32_16x16x32_bf16 v[164:167], a[84:87], a[168:171], v[164:167]
 ds_read_b64_tr_b16 a[108:109], v8 offset:16384
 buffer_load_dwordx4 v2, s[16:19], s53 offen lds
 v_mfma_f32_16x16x32_bf16 v[164:167], a[88:91], a[176:179], v[164:167]
 s_waitcnt lgkmcnt(7)
 ds_read_b64_tr_b16 a[110:111], v8 offset:20480
 v_xor_b32 v9, 33120, v6
 v_mfma_f32_16x16x32_bf16 v[164:167], a[92:95], a[184:187], v[164:167]
 s_add_u32 s59, s56, 8192
 ds_read_b64_tr_b16 a[64:65], v9 offset:0
 v_mfma_f32_16x16x32_bf16 v[172:175], a[80:83], a[164:167], v[172:175]
 ds_read_b64_tr_b16 a[66:67], v9 offset:4096
 buffer_store_dwordx4 v[112:115], v1, s[12:15], s59 offen offset:1024 sc1
 v_mfma_f32_16x16x32_bf16 v[172:175], a[84:87], a[172:175], v[172:175]
 ds_read_b64_tr_b16 a[68:69], v9 offset:16384
 v_mfma_f32_16x16x32_bf16 v[172:175], a[88:91], a[180:183], v[172:175]
 s_add_u32 m0, s29, 94208
 ds_read_b64_tr_b16 a[70:71], v9 offset:20480
 v_xor_b32 v10, 98656, v6
 v_mfma_f32_16x16x32_bf16 v[172:175], a[92:95], a[188:191], v[172:175]
 s_waitcnt lgkmcnt(6)
 ds_read_b64_tr_b16 a[72:73], v10 offset:0
 buffer_load_dwordx4 v2, s[16:19], s54 offen lds
 v_mfma_f32_16x16x32_bf16 v[180:183], a[96:99], a[160:163], v[180:183]
 ds_read_b64_tr_b16 a[74:75], v10 offset:4096
 v_mfma_f32_16x16x32_bf16 v[180:183], a[100:103], a[168:171], v[180:183]
 ds_read_b64_tr_b16 a[76:77], v10 offset:16384
 v_mfma_f32_16x16x32_bf16 v[180:183], a[104:107], a[176:179], v[180:183]
 s_waitcnt lgkmcnt(7)
 ds_read_b64_tr_b16 a[78:79], v10 offset:20480
 v_xor_b32 v7, 33152, v6
 v_mfma_f32_16x16x32_bf16 v[180:183], a[108:111], a[184:187], v[180:183]
 ds_read_b64_tr_b16 a[80:81], v7 offset:0
 v_mfma_f32_16x16x32_bf16 v[188:191], a[96:99], a[164:167], v[188:191]
 ds_read_b64_tr_b16 a[82:83], v7 offset:4096
 v_mfma_f32_16x16x32_bf16 v[188:191], a[100:103], a[172:175], v[188:191]
 ds_read_b64_tr_b16 a[84:85], v7 offset:16384
 v_mfma_f32_16x16x32_bf16 v[188:191], a[104:107], a[180:183], v[188:191]
 s_add_u32 s59, s56, 0
 ds_read_b64_tr_b16 a[86:87], v7 offset:20480
 v_xor_b32 v8, 98688, v6
 v_mfma_f32_16x16x32_bf16 v[188:191], a[108:111], a[188:191], v[188:191]
 s_waitcnt lgkmcnt(6)
 ds_read_b64_tr_b16 a[88:89], v8 offset:0
 buffer_store_dwordx4 v[120:123], v1, s[12:15], s59 offen offset:1024 sc1
 v_mfma_f32_16x16x32_bf16 v[196:199], a[64:67], a[160:163], v[196:199]
 ds_read_b64_tr_b16 a[90:91], v8 offset:4096
 v_mfma_f32_16x16x32_bf16 v[196:199], a[68:71], a[168:171], v[196:199]
 ds_read_b64_tr_b16 a[92:93], v8 offset:16384
 v_mfma_f32_16x16x32_bf16 v[196:199], a[72:75], a[176:179], v[196:199]
 s_waitcnt lgkmcnt(7)
 ds_read_b64_tr_b16 a[94:95], v8 offset:20480
 v_xor_b32 v9, 33184, v6
 v_mfma_f32_16x16x32_bf16 v[196:199], a[76:79], a[184:187], v[196:199]
 ds_read_b64_tr_b16 a[96:97], v9 offset:0
 v_mfma_f32_16x16x32_bf16 v[204:207], a[64:67], a[164:167], v[204:207]
 ds_read_b64_tr_b16 a[98:99], v9 offset:4096
 v_mfma_f32_16x16x32_bf16 v[204:207], a[68:71], a[172:175], v[204:207]
 ds_read_b64_tr_b16 a[100:101], v9 offset:16384
 v_mfma_f32_16x16x32_bf16 v[204:207], a[72:75], a[180:183], v[204:207]
 ds_read_b64_tr_b16 a[102:103], v9 offset:20480
 v_xor_b32 v10, 98720, v6
 v_mfma_f32_16x16x32_bf16 v[204:207], a[76:79], a[188:191], v[204:207]
 s_waitcnt lgkmcnt(6)
 ds_read_b64_tr_b16 a[104:105], v10 offset:0
 v_mfma_f32_16x16x32_bf16 v[212:215], a[80:83], a[160:163], v[212:215]
 s_add_u32 s59, s56, 24576
 ds_read_b64_tr_b16 a[106:107], v10 offset:4096
 v_mfma_f32_16x16x32_bf16 v[212:215], a[84:87], a[168:171], v[212:215]
 ds_read_b64_tr_b16 a[108:109], v10 offset:16384
 buffer_store_dwordx4 v[128:131], v1, s[12:15], s59 offen offset:2048 sc1
 v_mfma_f32_16x16x32_bf16 v[212:215], a[88:91], a[176:179], v[212:215]
 s_waitcnt lgkmcnt(7)
 ds_read_b64_tr_b16 a[110:111], v10 offset:20480
 v_xor_b32 v7, 33216, v6
 v_mfma_f32_16x16x32_bf16 v[212:215], a[92:95], a[184:187], v[212:215]
 ds_read_b64_tr_b16 a[64:65], v7 offset:0
 v_lshrrev_b32 v120, 3, v0
 v_mfma_f32_16x16x32_bf16 v[220:223], a[80:83], a[164:167], v[220:223]
 ds_read_b64_tr_b16 a[66:67], v7 offset:4096
 v_mul_u32_u24 v120, 1792, v120
 v_mfma_f32_16x16x32_bf16 v[220:223], a[84:87], a[172:175], v[220:223]
 ds_read_b64_tr_b16 a[68:69], v7 offset:16384
 v_and_b32 v121, 7, v0
 v_mfma_f32_16x16x32_bf16 v[220:223], a[88:91], a[180:183], v[220:223]
 ds_read_b64_tr_b16 a[70:71], v7 offset:20480
 v_xor_b32 v8, 98752, v6
 v_mfma_f32_16x16x32_bf16 v[220:223], a[92:95], a[188:191], v[220:223]
 s_waitcnt lgkmcnt(6)
 ds_read_b64_tr_b16 a[72:73], v8 offset:0
 v_lshl_add_u32 v120, v121, 4, v120
 v_mfma_f32_16x16x32_bf16 v[228:231], a[96:99], a[160:163], v[228:231]
 ds_read_b64_tr_b16 a[74:75], v8 offset:4096
 v_add_u32 v120, s38, v120
 v_mfma_f32_16x16x32_bf16 v[228:231], a[100:103], a[168:171], v[228:231]
 s_add_u32 s59, s56, 16384
 ds_read_b64_tr_b16 a[76:77], v8 offset:16384
 v_lshlrev_b32 v121, 6, v121
 v_mfma_f32_16x16x32_bf16 v[228:231], a[104:107], a[176:179], v[228:231]
 s_waitcnt lgkmcnt(7)
 ds_read_b64_tr_b16 a[78:79], v8 offset:20480
 v_xor_b32 v9, 33248, v6
 v_mfma_f32_16x16x32_bf16 v[228:231], a[108:111], a[184:187], v[228:231]
 ds_read_b64_tr_b16 a[80:81], v9 offset:0
 buffer_store_dwordx4 v[136:139], v1, s[12:15], s59 offen offset:2048 sc1
 v_mfma_f32_16x16x32_bf16 v[236:239], a[96:99], a[164:167], v[236:239]
 ds_read_b64_tr_b16 a[82:83], v9 offset:4096
 v_subrev_u32 v122, 2688, v120
 v_mfma_f32_16x16x32_bf16 v[236:239], a[100:103], a[172:175], v[236:239]
 ds_read_b64_tr_b16 a[84:85], v9 offset:16384
 v_subrev_u32 v123, 1792, v120
 v_mfma_f32_16x16x32_bf16 v[236:239], a[104:107], a[180:183], v[236:239]
 ds_read_b64_tr_b16 a[86:87], v9 offset:20480
 v_xor_b32 v10, 98784, v6
 v_mfma_f32_16x16x32_bf16 v[236:239], a[108:111], a[188:191], v[236:239]
 s_waitcnt lgkmcnt(6)
 ds_read_b64_tr_b16 a[88:89], v10 offset:0
 v_subrev_u32 v128, 896, v120
 v_mfma_f32_16x16x32_bf16 v[244:247], a[64:67], a[160:163], v[244:247]
 ds_read_b64_tr_b16 a[90:91], v10 offset:4096
 buffer_load_dwordx4 v[32:35], v122, s[4:7], 0 offen
 v_mfma_f32_16x16x32_bf16 v[244:247], a[68:71], a[168:171], v[244:247]
 s_waitcnt vmcnt(4)
 ds_read_b64_tr_b16 a[92:93], v10 offset:16384
 v_xor_b32 v7, 131072, v6
 v_mfma_f32_16x16x32_bf16 v[244:247], a[72:75], a[176:179], v[244:247]
 s_waitcnt lgkmcnt(7)
 s_barrier
 ds_read_b64_tr_b16 a[94:95], v10 offset:20480
 v_mfma_f32_16x16x32_bf16 v[244:247], a[76:79], a[184:187], v[244:247]
 s_and_b32 s58, s92, ~127
 ds_read_b64_tr_b16 a[96:97], v7 offset:0
 v_mfma_f32_16x16x32_bf16 v[252:255], a[64:67], a[164:167], v[252:255]
 s_add_u32 s59, s56, 8192
 ds_read_b64_tr_b16 a[98:99], v7 offset:4096
 v_mfma_f32_16x16x32_bf16 v[252:255], a[68:71], a[172:175], v[252:255]
 ds_read_b64_tr_b16 a[100:101], v7 offset:16384
 buffer_store_dwordx4 v[144:147], v1, s[12:15], s59 offen offset:2048 sc1
 v_mfma_f32_16x16x32_bf16 v[252:255], a[72:75], a[180:183], v[252:255]
 s_lshl_b32 s37, s25, 1
 ds_read_b64_tr_b16 a[102:103], v7 offset:20480
 v_xor_b32 v8, 0, v6
 v_mfma_f32_16x16x32_bf16 v[252:255], a[76:79], a[188:191], v[252:255]
 s_waitcnt lgkmcnt(6)
 ds_read_b64_tr_b16 a[104:105], v8 offset:0
 buffer_load_dwordx4 v[40:43], v123, s[4:7], 0 offen
 v_mfma_f32_16x16x32_bf16 v[16:19], a[80:83], a[160:163], v[16:19]
 s_sub_i32 s38, 12, s37
 ds_read_b64_tr_b16 a[106:107], v8 offset:4096
 v_mfma_f32_16x16x32_bf16 v[16:19], a[84:87], a[168:171], v[16:19]
 s_max_i32 s38, s38, 0
 ds_read_b64_tr_b16 a[108:109], v8 offset:16384
 v_mfma_f32_16x16x32_bf16 v[16:19], a[88:91], a[176:179], v[16:19]
 s_waitcnt lgkmcnt(7)
 ds_read_b64_tr_b16 a[110:111], v8 offset:20480
 v_xor_b32 v9, 65536, v6
 v_mfma_f32_16x16x32_bf16 v[16:19], a[92:95], a[184:187], v[16:19]
 ds_read_b64_tr_b16 a[64:65], v9 offset:0
 buffer_load_dwordx4 v[48:51], v128, s[4:7], 0 offen
 v_mfma_f32_16x16x32_bf16 v[24:27], a[80:83], a[164:167], v[24:27]
 s_mul_i32 s49, s26, 1048576
 ds_read_b64_tr_b16 a[66:67], v9 offset:4096
 v_mfma_f32_16x16x32_bf16 v[24:27], a[84:87], a[172:175], v[24:27]
 s_lshl_b32 s50, s3, 13
 ds_read_b64_tr_b16 a[68:69], v9 offset:16384
 v_mfma_f32_16x16x32_bf16 v[24:27], a[88:91], a[180:183], v[24:27]
 s_add_u32 s59, s56, 0
 ds_read_b64_tr_b16 a[70:71], v9 offset:20480
 v_xor_b32 v10, 131104, v6
 v_mfma_f32_16x16x32_bf16 v[24:27], a[92:95], a[188:191], v[24:27]
 s_waitcnt lgkmcnt(6)
 ds_read_b64_tr_b16 a[72:73], v10 offset:0
 buffer_store_dwordx4 v[152:155], v1, s[12:15], s59 offen offset:2048 sc1
 v_mfma_f32_16x16x32_bf16 v[28:31], a[96:99], a[192:195], v[28:31]
 s_add_u32 s49, s49, s50
 ds_read_b64_tr_b16 a[74:75], v10 offset:4096
 v_mfma_f32_16x16x32_bf16 v[28:31], a[100:103], a[200:203], v[28:31]
 ds_read_b64_tr_b16 a[76:77], v10 offset:16384
 buffer_load_dwordx4 v[56:59], v120, s[4:7], 0 offen offset:0
 v_mfma_f32_16x16x32_bf16 v[28:31], a[104:107], a[208:211], v[28:31]
 s_waitcnt lgkmcnt(3)
 ds_read_b64_tr_b16 a[78:79], v10 offset:20480
 v_xor_b32 v7, 32, v6
 v_mfma_f32_16x16x32_bf16 v[28:31], a[108:111], a[216:219], v[28:31]
 s_mov_b32 s54, 0
 ds_read_b64_tr_b16 a[80:81], v7 offset:0
 v_mfma_f32_16x16x32_bf16 v[28:31], a[64:67], a[112:115], v[28:31]
 s_add_u32 s44, s37, 1
 ds_read_b64_tr_b16 a[82:83], v7 offset:4096
 v_mfma_f32_16x16x32_bf16 v[28:31], a[68:71], a[120:123], v[28:31]
 ds_read_b64_tr_b16 a[84:85], v7 offset:16384
 buffer_load_dwordx4 v[64:67], v120, s[4:7], 0 offen offset:896
 v_mfma_f32_16x16x32_bf16 v[44:47], a[96:99], a[196:199], v[44:47]
 s_mov_b32 s42, s49
 ds_read_b64_tr_b16 a[86:87], v7 offset:20480
 v_xor_b32 v8, 65568, v6
 v_mfma_f32_16x16x32_bf16 v[44:47], a[100:103], a[204:207], v[44:47]
 s_add_u32 s60, s94, 4
 ds_read_b64_tr_b16 a[88:89], v8 offset:0
 v_mfma_f32_16x16x32_bf16 v[44:47], a[104:107], a[212:215], v[44:47]
 s_add_u32 s59, s56, 24576
 ds_read_b64_tr_b16 a[90:91], v8 offset:4096
 v_mfma_f32_16x16x32_bf16 v[44:47], a[108:111], a[220:223], v[44:47]
 ds_read_b64_tr_b16 a[92:93], v8 offset:16384
 buffer_store_dwordx4 v[160:163], v1, s[12:15], s59 offen offset:3072 sc1
 v_mfma_f32_16x16x32_bf16 v[44:47], a[64:67], a[116:119], v[44:47]
 s_mov_b32 s45, 2
 ds_read_b64_tr_b16 a[94:95], v8 offset:20480
 v_xor_b32 v9, 131136, v6
 v_mfma_f32_16x16x32_bf16 v[44:47], a[68:71], a[124:127], v[44:47]
 s_waitcnt lgkmcnt(6)
 ds_read_b64_tr_b16 a[96:97], v9 offset:0
 buffer_load_dwordx4 v[72:75], v120, s[8:11], 0 offen offset:0
 v_mfma_f32_16x16x32_bf16 v[52:55], a[72:75], a[192:195], v[52:55]
 s_mov_b32 s66, 1
 ds_read_b64_tr_b16 a[98:99], v9 offset:4096
 v_mfma_f32_16x16x32_bf16 v[52:55], a[76:79], a[200:203], v[52:55]
 s_mov_b32 s68, 1
 ds_read_b64_tr_b16 a[100:101], v9 offset:16384
 v_mfma_f32_16x16x32_bf16 v[52:55], a[80:83], a[208:211], v[52:55]
 s_waitcnt lgkmcnt(3)
 ds_read_b64_tr_b16 a[102:103], v9 offset:20480
 v_xor_b32 v10, 64, v6
 v_mfma_f32_16x16x32_bf16 v[52:55], a[84:87], a[216:219], v[52:55]
 ds_read_b64_tr_b16 a[104:105], v10 offset:0
 buffer_load_dwordx4 v[80:83], v120, s[8:11], 0 offen offset:896
 v_mfma_f32_16x16x32_bf16 v[52:55], a[88:91], a[112:115], v[52:55]
 s_mov_b32 s70, 32768
 ds_read_b64_tr_b16 a[106:107], v10 offset:4096
 v_mfma_f32_16x16x32_bf16 v[52:55], a[92:95], a[120:123], v[52:55]
 s_mov_b32 s71, s70
 ds_read_b64_tr_b16 a[108:109], v10 offset:16384
 v_mfma_f32_16x16x32_bf16 v[60:63], a[72:75], a[196:199], v[60:63]
 s_add_u32 s59, s56, 16384
 ds_read_b64_tr_b16 a[110:111], v10 offset:20480
 v_xor_b32 v7, 65600, v6
 v_mfma_f32_16x16x32_bf16 v[60:63], a[76:79], a[204:207], v[60:63]
 ds_read_b64_tr_b16 a[64:65], v7 offset:0
 buffer_store_dwordx4 v[168:171], v1, s[12:15], s59 offen offset:3072 sc1
 v_mfma_f32_16x16x32_bf16 v[60:63], a[80:83], a[212:215], v[60:63]
 s_add_u32 s43, s42, 16777216
 ds_read_b64_tr_b16 a[66:67], v7 offset:4096
 v_mfma_f32_16x16x32_bf16 v[60:63], a[84:87], a[220:223], v[60:63]
 ds_read_b64_tr_b16 a[68:69], v7 offset:16384
 buffer_load_dwordx4 v[88:91], v121, s[20:23], s39 offen offset:0
 v_mfma_f32_16x16x32_bf16 v[60:63], a[88:91], a[116:119], v[60:63]
 s_mov_b32 s40, s50
 ds_read_b64_tr_b16 a[70:71], v7 offset:20480
 v_xor_b32 v8, 131168, v6
 v_mfma_f32_16x16x32_bf16 v[60:63], a[92:95], a[124:127], v[60:63]
 s_waitcnt lgkmcnt(6)
 ds_read_b64_tr_b16 a[72:73], v8 offset:0
 v_mfma_f32_16x16x32_bf16 v[20:23], a[96:99], a[192:195], v[20:23]
 s_add_u32 s41, s50, 0x10000
 ds_read_b64_tr_b16 a[74:75], v8 offset:4096
 v_mfma_f32_16x16x32_bf16 v[20:23], a[100:103], a[200:203], v[20:23]
 ds_read_b64_tr_b16 a[76:77], v8 offset:16384
 buffer_load_dwordx4 v[96:99], v121, s[20:23], s39 offen offset:16
 v_mfma_f32_16x16x32_bf16 v[20:23], a[104:107], a[208:211], v[20:23]
 s_waitcnt lgkmcnt(3)
 ds_read_b64_tr_b16 a[78:79], v8 offset:20480
 v_xor_b32 v9, 96, v6
 v_mfma_f32_16x16x32_bf16 v[20:23], a[108:111], a[216:219], v[20:23]
 s_lshr_b32 s61, s95, 4
 ds_read_b64_tr_b16 a[80:81], v9 offset:0
 v_mul_f32 v28, s34, v28
 v_mfma_f32_16x16x32_bf16 v[20:23], a[64:67], a[112:115], v[20:23]
 s_add_u32 s59, s56, 8192
 ds_read_b64_tr_b16 a[82:83], v9 offset:4096
 v_mul_f32 v29, s34, v29
 v_mfma_f32_16x16x32_bf16 v[20:23], a[68:71], a[120:123], v[20:23]
 ds_read_b64_tr_b16 a[84:85], v9 offset:16384
 buffer_store_dwordx4 v[176:179], v1, s[12:15], s59 offen offset:3072 sc1
 v_mfma_f32_16x16x32_bf16 v[36:39], a[96:99], a[196:199], v[36:39]
 s_lshl_b32 s61, s61, 7
 ds_read_b64_tr_b16 a[86:87], v9 offset:20480
 v_xor_b32 v10, 65632, v6
 v_mfma_f32_16x16x32_bf16 v[36:39], a[100:103], a[204:207], v[36:39]
 ds_read_b64_tr_b16 a[88:89], v10 offset:0
 buffer_load_dwordx4 v[104:107], v121, s[20:23], s39 offen offset:32
 v_mfma_f32_16x16x32_bf16 v[36:39], a[104:107], a[212:215], v[36:39]
 s_add_u32 s61, s61, 84959232
 ds_read_b64_tr_b16 a[90:91], v10 offset:4096
 v_mul_f32 v30, s34, v30
 v_mfma_f32_16x16x32_bf16 v[36:39], a[108:111], a[220:223], v[36:39]
 s_mov_b32 s47, 0x4b800000
 ds_read_b64_tr_b16 a[92:93], v10 offset:16384
 v_mul_f32 v31, s34, v31
 v_mfma_f32_16x16x32_bf16 v[36:39], a[64:67], a[116:119], v[36:39]
 s_lshl_b32 s30, s95, 1
 ds_read_b64_tr_b16 a[94:95], v10 offset:20480
 v_xor_b32 v7, 131200, v6
 v_mfma_f32_16x16x32_bf16 v[36:39], a[68:71], a[124:127], v[36:39]
 s_waitcnt lgkmcnt(6)
 ds_read_b64_tr_b16 a[96:97], v7 offset:0
 buffer_load_dwordx4 v[112:115], v121, s[20:23], s39 offen offset:48
 v_mfma_f32_16x16x32_bf16 v[68:71], a[72:75], a[192:195], v[68:71]
 s_lshr_b32 s31, s3, 1
 ds_read_b64_tr_b16 a[98:99], v7 offset:4096
 v_mul_f32 v52, s34, v52
 v_mfma_f32_16x16x32_bf16 v[68:71], a[76:79], a[200:203], v[68:71]
 s_add_u32 s59, s56, 0
 ds_read_b64_tr_b16 a[100:101], v7 offset:16384
 v_mul_f32 v53, s34, v53
 v_mfma_f32_16x16x32_bf16 v[68:71], a[80:83], a[208:211], v[68:71]
 s_waitcnt lgkmcnt(3)
 ds_read_b64_tr_b16 a[102:103], v7 offset:20480
 v_xor_b32 v8, 128, v6
 v_mfma_f32_16x16x32_bf16 v[68:71], a[84:87], a[216:219], v[68:71]
 ds_read_b64_tr_b16 a[104:105], v8 offset:0
 buffer_store_dwordx4 v[184:187], v1, s[12:15], s59 offen offset:3072 sc1
 v_mfma_f32_16x16x32_bf16 v[68:71], a[88:91], a[112:115], v[68:71]
 s_add_u32 s30, s30, s31
 ds_read_b64_tr_b16 a[106:107], v8 offset:4096
 v_mul_f32 v54, s34, v54
 v_mfma_f32_16x16x32_bf16 v[68:71], a[92:95], a[120:123], v[68:71]
 s_min_u32 s30, s30, 223
 ds_read_b64_tr_b16 a[108:109], v8 offset:16384
 v_mul_f32 v55, s34, v55
 v_mfma_f32_16x16x32_bf16 v[76:79], a[72:75], a[196:199], v[76:79]
 s_lshl_b32 s30, s30, 2
 ds_read_b64_tr_b16 a[110:111], v8 offset:20480
 v_xor_b32 v9, 65664, v6
 v_mfma_f32_16x16x32_bf16 v[76:79], a[76:79], a[204:207], v[76:79]
 s_and_b32 s4, s2, 127
 ds_read_b64_tr_b16 a[64:65], v9 offset:0
 v_cvt_pk_bf16_f32 v28, v28, v29
 v_mfma_f32_16x16x32_bf16 v[76:79], a[80:83], a[212:215], v[76:79]
 s_lshl_b32 s4, s4, 2
 ds_read_b64_tr_b16 a[66:67], v9 offset:4096
 v_cvt_pk_bf16_f32 v29, v30, v31
 v_mfma_f32_16x16x32_bf16 v[76:79], a[84:87], a[220:223], v[76:79]
 s_add_u32 s4, s4, s3
 ds_read_b64_tr_b16 a[68:69], v9 offset:16384
 v_cvt_pk_bf16_f32 v30, v52, v53
 v_mfma_f32_16x16x32_bf16 v[76:79], a[88:91], a[116:119], v[76:79]
 s_mul_i32 s5, s4, 17408
 ds_read_b64_tr_b16 a[70:71], v9 offset:20480
 v_xor_b32 v10, 131232, v6
 v_mfma_f32_16x16x32_bf16 v[76:79], a[92:95], a[124:127], v[76:79]
 s_waitcnt lgkmcnt(6)
 ds_read_b64_tr_b16 a[72:73], v10 offset:0
 v_cvt_pk_bf16_f32 v31, v54, v55
 v_mfma_f32_16x16x32_bf16 v[84:87], a[96:99], a[192:195], v[84:87]
 s_add_u32 s59, s56, 57344
 ds_read_b64_tr_b16 a[74:75], v10 offset:4096
 v_accvgpr_write_b32 a0, v28
 v_mfma_f32_16x16x32_bf16 v[84:87], a[100:103], a[200:203], v[84:87]
 ds_read_b64_tr_b16 a[76:77], v10 offset:16384
 buffer_store_dwordx4 v[192:195], v1, s[12:15], s59 offen offset:2048 sc1
 v_mfma_f32_16x16x32_bf16 v[84:87], a[104:107], a[208:211], v[84:87]
 s_waitcnt lgkmcnt(3)
 ds_read_b64_tr_b16 a[78:79], v10 offset:20480
 v_xor_b32 v7, 160, v6
 v_mfma_f32_16x16x32_bf16 v[84:87], a[108:111], a[216:219], v[84:87]
 s_add_u32 s5, s5, 50331648
 ds_read_b64_tr_b16 a[80:81], v7 offset:0
 v_accvgpr_write_b32 a1, v29
 v_mfma_f32_16x16x32_bf16 v[84:87], a[64:67], a[112:115], v[84:87]
 s_add_u32 s4, s5, 0x2000
 ds_read_b64_tr_b16 a[82:83], v7 offset:4096
 v_accvgpr_write_b32 a2, v30
 v_mfma_f32_16x16x32_bf16 v[84:87], a[68:71], a[120:123], v[84:87]
 s_mov_b32 s6, 2.0
 ds_read_b64_tr_b16 a[84:85], v7 offset:16384
 v_accvgpr_write_b32 a3, v31
 v_mfma_f32_16x16x32_bf16 v[92:95], a[96:99], a[196:199], v[92:95]
 s_min_u32 s7, s38, 1
 ds_read_b64_tr_b16 a[86:87], v7 offset:20480
 v_xor_b32 v8, 65696, v6
 v_mfma_f32_16x16x32_bf16 v[92:95], a[100:103], a[204:207], v[92:95]
 s_cmp_eq_u32 s44, 1
 s_cselect_b32 s53, 1, 0
 ds_read_b64_tr_b16 a[88:89], v8 offset:0
 v_mfma_f32_16x16x32_bf16 v[92:95], a[104:107], a[212:215], v[92:95]
 s_cmp_eq_u32 s38, 0
 s_cmov_b32 s4, 2.0
 ds_read_b64_tr_b16 a[90:91], v8 offset:4096
 v_mfma_f32_16x16x32_bf16 v[92:95], a[108:111], a[220:223], v[92:95]
 s_cmp_eq_u32 s38, 0
 s_cmov_b32 s5, 2.0
 ds_read_b64_tr_b16 a[92:93], v8 offset:16384
 v_mfma_f32_16x16x32_bf16 v[92:95], a[64:67], a[116:119], v[92:95]
 s_add_u32 s59, s56, 49152
 ds_read_b64_tr_b16 a[94:95], v8 offset:20480
 v_xor_b32 v9, 131264, v6
 v_mfma_f32_16x16x32_bf16 v[92:95], a[68:71], a[124:127], v[92:95]
 s_waitcnt lgkmcnt(6)
 ds_read_b64_tr_b16 a[96:97], v9 offset:0
 buffer_store_dwordx4 v[200:203], v1, s[12:15], s59 offen offset:2048 sc1
 v_mfma_f32_16x16x32_bf16 v[100:103], a[72:75], a[192:195], v[100:103]
 s_cmp_eq_u32 s38, 0
 s_cmov_b32 s60, s58
 ds_read_b64_tr_b16 a[98:99], v9 offset:4096
 v_mfma_f32_16x16x32_bf16 v[100:103], a[76:79], a[200:203], v[100:103]
 s_mov_b64 s[8:9], s[12:13]
 ds_read_b64_tr_b16 a[100:101], v9 offset:16384
 v_mul_f32 v44, s34, v44
 v_mfma_f32_16x16x32_bf16 v[100:103], a[80:83], a[208:211], v[100:103]
 s_waitcnt lgkmcnt(3)
 ds_read_b64_tr_b16 a[102:103], v9 offset:20480
 v_xor_b32 v10, 192, v6
 v_mfma_f32_16x16x32_bf16 v[100:103], a[84:87], a[216:219], v[100:103]
 s_mov_b32 s10, s14
 ds_read_b64_tr_b16 a[104:105], v10 offset:0
 v_mul_f32 v45, s34, v45
 v_mfma_f32_16x16x32_bf16 v[100:103], a[88:91], a[112:115], v[100:103]
 s_mov_b32 s76, 0
 ds_read_b64_tr_b16 a[106:107], v10 offset:4096
 v_mul_f32 v46, s34, v46
 v_mfma_f32_16x16x32_bf16 v[100:103], a[92:95], a[120:123], v[100:103]
 s_movk_i32 s77, 0x1000
 ds_read_b64_tr_b16 a[108:109], v10 offset:16384
 v_mul_f32 v47, s34, v47
 v_mfma_f32_16x16x32_bf16 v[108:111], a[72:75], a[196:199], v[108:111]
 s_mov_b32 s51, 0
 ds_read_b64_tr_b16 a[110:111], v10 offset:20480
 v_xor_b32 v7, 65728, v6
 v_mfma_f32_16x16x32_bf16 v[108:111], a[76:79], a[204:207], v[108:111]
 s_mul_i32 s78, s26, 229376
 ds_read_b64_tr_b16 a[64:65], v7 offset:0
 v_mul_f32 v60, s34, v60
 v_mfma_f32_16x16x32_bf16 v[108:111], a[80:83], a[212:215], v[108:111]
 s_add_u32 s59, s56, 40960
 ds_read_b64_tr_b16 a[66:67], v7 offset:4096
 v_mul_f32 v61, s34, v61
 v_mfma_f32_16x16x32_bf16 v[108:111], a[84:87], a[220:223], v[108:111]
 ds_read_b64_tr_b16 a[68:69], v7 offset:16384
 buffer_store_dwordx4 v[208:211], v1, s[12:15], s59 offen offset:2048 sc1
 v_mfma_f32_16x16x32_bf16 v[108:111], a[88:91], a[116:119], v[108:111]
 s_add_u32 s79, s78, 28672
 ds_read_b64_tr_b16 a[70:71], v7 offset:20480
 v_xor_b32 v8, 131296, v6
 v_mfma_f32_16x16x32_bf16 v[108:111], a[92:95], a[124:127], v[108:111]
 s_waitcnt lgkmcnt(6)
 ds_read_b64_tr_b16 a[72:73], v8 offset:0
 v_mul_f32 v62, s34, v62
 v_mfma_f32_16x16x32_bf16 v[116:119], a[96:99], a[192:195], v[116:119]
 s_add_u32 s80, s78, 57344
 ds_read_b64_tr_b16 a[74:75], v8 offset:4096
 v_mul_f32 v63, s34, v63
 v_mfma_f32_16x16x32_bf16 v[116:119], a[100:103], a[200:203], v[116:119]
 s_add_u32 s81, s78, 86016
 ds_read_b64_tr_b16 a[76:77], v8 offset:16384
 v_cvt_pk_bf16_f32 v44, v44, v45
 v_mfma_f32_16x16x32_bf16 v[116:119], a[104:107], a[208:211], v[116:119]
 s_waitcnt lgkmcnt(3)
 ds_read_b64_tr_b16 a[78:79], v8 offset:20480
 v_xor_b32 v9, 224, v6
 v_mfma_f32_16x16x32_bf16 v[116:119], a[108:111], a[216:219], v[116:119]
 s_add_u32 s82, s78, 114688
 ds_read_b64_tr_b16 a[80:81], v9 offset:0
 v_cvt_pk_bf16_f32 v45, v46, v47
 v_mfma_f32_16x16x32_bf16 v[116:119], a[64:67], a[112:115], v[116:119]
 s_add_u32 s83, s78, 143360
 ds_read_b64_tr_b16 a[82:83], v9 offset:4096
 v_cvt_pk_bf16_f32 v46, v60, v61
 v_mfma_f32_16x16x32_bf16 v[116:119], a[68:71], a[120:123], v[116:119]
 s_add_u32 s84, s78, 172032
 ds_read_b64_tr_b16 a[84:85], v9 offset:16384
 v_cvt_pk_bf16_f32 v47, v62, v63
 v_mfma_f32_16x16x32_bf16 v[124:127], a[96:99], a[196:199], v[124:127]
 s_add_u32 s59, s56, 32768
 ds_read_b64_tr_b16 a[86:87], v9 offset:20480
 v_xor_b32 v10, 65760, v6
 v_mfma_f32_16x16x32_bf16 v[124:127], a[100:103], a[204:207], v[124:127]
 ds_read_b64_tr_b16 a[88:89], v10 offset:0
 buffer_store_dwordx4 v[216:219], v1, s[12:15], s59 offen offset:2048 sc1
 v_mfma_f32_16x16x32_bf16 v[124:127], a[104:107], a[212:215], v[124:127]
 s_add_u32 s85, s78, 200704
 ds_read_b64_tr_b16 a[90:91], v10 offset:4096
 v_accvgpr_write_b32 a32, v44
 v_mfma_f32_16x16x32_bf16 v[124:127], a[108:111], a[220:223], v[124:127]
 ds_read_b64_tr_b16 a[92:93], v10 offset:16384
 v_accvgpr_write_b32 a33, v45
 v_mfma_f32_16x16x32_bf16 v[124:127], a[64:67], a[116:119], v[124:127]
 ds_read_b64_tr_b16 a[94:95], v10 offset:20480
 v_xor_b32 v7, 131328, v6
 v_mfma_f32_16x16x32_bf16 v[124:127], a[68:71], a[124:127], v[124:127]
 s_waitcnt lgkmcnt(6)
 ds_read_b64_tr_b16 a[96:97], v7 offset:0
 v_accvgpr_write_b32 a34, v46
 v_mfma_f32_16x16x32_bf16 v[132:135], a[72:75], a[192:195], v[132:135]
 ds_read_b64_tr_b16 a[98:99], v7 offset:4096
 v_accvgpr_write_b32 a35, v47
 v_mfma_f32_16x16x32_bf16 v[132:135], a[76:79], a[200:203], v[132:135]
 ds_read_b64_tr_b16 a[100:101], v7 offset:16384
 v_mul_f32 v20, s34, v20
 v_mfma_f32_16x16x32_bf16 v[132:135], a[80:83], a[208:211], v[132:135]
 s_waitcnt lgkmcnt(3)
 ds_read_b64_tr_b16 a[102:103], v7 offset:20480
 v_xor_b32 v8, 256, v6
 v_mfma_f32_16x16x32_bf16 v[132:135], a[84:87], a[216:219], v[132:135]
 ds_read_b64_tr_b16 a[104:105], v8 offset:0
 v_mul_f32 v21, s34, v21
 v_mfma_f32_16x16x32_bf16 v[132:135], a[88:91], a[112:115], v[132:135]
 s_add_u32 s59, s56, 57344
 ds_read_b64_tr_b16 a[106:107], v8 offset:4096
 v_mul_f32 v22, s34, v22
 v_mfma_f32_16x16x32_bf16 v[132:135], a[92:95], a[120:123], v[132:135]
 ds_read_b64_tr_b16 a[108:109], v8 offset:16384
 buffer_store_dwordx4 v[224:227], v1, s[12:15], s59 offen offset:3072 sc1
 v_mfma_f32_16x16x32_bf16 v[140:143], a[72:75], a[196:199], v[140:143]
 ds_read_b64_tr_b16 a[110:111], v8 offset:20480
 v_xor_b32 v9, 65792, v6
 v_mfma_f32_16x16x32_bf16 v[140:143], a[76:79], a[204:207], v[140:143]
 ds_read_b64_tr_b16 a[64:65], v9 offset:0
 v_mul_f32 v23, s34, v23
 v_mfma_f32_16x16x32_bf16 v[140:143], a[80:83], a[212:215], v[140:143]
 ds_read_b64_tr_b16 a[66:67], v9 offset:4096
 v_mul_f32 v68, s34, v68
 v_mfma_f32_16x16x32_bf16 v[140:143], a[84:87], a[220:223], v[140:143]
 ds_read_b64_tr_b16 a[68:69], v9 offset:16384
 v_mul_f32 v69, s34, v69
 v_mfma_f32_16x16x32_bf16 v[140:143], a[88:91], a[116:119], v[140:143]
 ds_read_b64_tr_b16 a[70:71], v9 offset:20480
 v_xor_b32 v10, 131360, v6
 v_mfma_f32_16x16x32_bf16 v[140:143], a[92:95], a[124:127], v[140:143]
 s_waitcnt lgkmcnt(6)
 ds_read_b64_tr_b16 a[72:73], v10 offset:0
 v_mul_f32 v70, s34, v70
 v_mfma_f32_16x16x32_bf16 v[148:151], a[96:99], a[192:195], v[148:151]
 ds_read_b64_tr_b16 a[74:75], v10 offset:4096
 v_mul_f32 v71, s34, v71
 v_mfma_f32_16x16x32_bf16 v[148:151], a[100:103], a[200:203], v[148:151]
 s_add_u32 s59, s56, 49152
 ds_read_b64_tr_b16 a[76:77], v10 offset:16384
 v_cvt_pk_bf16_f32 v20, v20, v21
 v_mfma_f32_16x16x32_bf16 v[148:151], a[104:107], a[208:211], v[148:151]
 s_waitcnt lgkmcnt(3)
 ds_read_b64_tr_b16 a[78:79], v10 offset:20480
 v_xor_b32 v7, 288, v6
 v_mfma_f32_16x16x32_bf16 v[148:151], a[108:111], a[216:219], v[148:151]
 ds_read_b64_tr_b16 a[80:81], v7 offset:0
 buffer_store_dwordx4 v[232:235], v1, s[12:15], s59 offen offset:3072 sc1
 v_mfma_f32_16x16x32_bf16 v[148:151], a[64:67], a[112:115], v[148:151]
 ds_read_b64_tr_b16 a[82:83], v7 offset:4096
 v_cvt_pk_bf16_f32 v21, v22, v23
 v_mfma_f32_16x16x32_bf16 v[148:151], a[68:71], a[120:123], v[148:151]
 ds_read_b64_tr_b16 a[84:85], v7 offset:16384
 v_cvt_pk_bf16_f32 v22, v68, v69
 v_mfma_f32_16x16x32_bf16 v[156:159], a[96:99], a[196:199], v[156:159]
 ds_read_b64_tr_b16 a[86:87], v7 offset:20480
 v_xor_b32 v8, 65824, v6
 v_mfma_f32_16x16x32_bf16 v[156:159], a[100:103], a[204:207], v[156:159]
 ds_read_b64_tr_b16 a[88:89], v8 offset:0
 v_cvt_pk_bf16_f32 v23, v70, v71
 v_mfma_f32_16x16x32_bf16 v[156:159], a[104:107], a[212:215], v[156:159]
 ds_read_b64_tr_b16 a[90:91], v8 offset:4096
 v_accvgpr_write_b32 a4, v20
 v_mfma_f32_16x16x32_bf16 v[156:159], a[108:111], a[220:223], v[156:159]
 ds_read_b64_tr_b16 a[92:93], v8 offset:16384
 v_accvgpr_write_b32 a5, v21
 v_mfma_f32_16x16x32_bf16 v[156:159], a[64:67], a[116:119], v[156:159]
 ds_read_b64_tr_b16 a[94:95], v8 offset:20480
 v_xor_b32 v9, 131392, v6
 v_mfma_f32_16x16x32_bf16 v[156:159], a[68:71], a[124:127], v[156:159]
 s_waitcnt lgkmcnt(6)
 ds_read_b64_tr_b16 a[96:97], v9 offset:0
 v_accvgpr_write_b32 a6, v22
 v_mfma_f32_16x16x32_bf16 v[164:167], a[72:75], a[192:195], v[164:167]
 s_add_u32 s59, s56, 40960
 ds_read_b64_tr_b16 a[98:99], v9 offset:4096
 v_accvgpr_write_b32 a7, v23
 v_mfma_f32_16x16x32_bf16 v[164:167], a[76:79], a[200:203], v[164:167]
 ds_read_b64_tr_b16 a[100:101], v9 offset:16384
 buffer_store_dwordx4 v[240:243], v1, s[12:15], s59 offen offset:3072 sc1
 v_mfma_f32_16x16x32_bf16 v[164:167], a[80:83], a[208:211], v[164:167]
 s_waitcnt lgkmcnt(3)
 ds_read_b64_tr_b16 a[102:103], v9 offset:20480
 v_xor_b32 v10, 320, v6
 v_mfma_f32_16x16x32_bf16 v[164:167], a[84:87], a[216:219], v[164:167]
 ds_read_b64_tr_b16 a[104:105], v10 offset:0
 v_mul_f32 v36, s34, v36
 v_mfma_f32_16x16x32_bf16 v[164:167], a[88:91], a[112:115], v[164:167]
 ds_read_b64_tr_b16 a[106:107], v10 offset:4096
 v_mul_f32 v37, s34, v37
 v_mfma_f32_16x16x32_bf16 v[164:167], a[92:95], a[120:123], v[164:167]
 ds_read_b64_tr_b16 a[108:109], v10 offset:16384
 v_mul_f32 v38, s34, v38
 v_mfma_f32_16x16x32_bf16 v[172:175], a[72:75], a[196:199], v[172:175]
 ds_read_b64_tr_b16 a[110:111], v10 offset:20480
 v_xor_b32 v7, 65856, v6
 v_mfma_f32_16x16x32_bf16 v[172:175], a[76:79], a[204:207], v[172:175]
 ds_read_b64_tr_b16 a[64:65], v7 offset:0
 v_mul_f32 v39, s34, v39
 v_mfma_f32_16x16x32_bf16 v[172:175], a[80:83], a[212:215], v[172:175]
 ds_read_b64_tr_b16 a[66:67], v7 offset:4096
 v_mul_f32 v76, s34, v76
 v_mfma_f32_16x16x32_bf16 v[172:175], a[84:87], a[220:223], v[172:175]
 ds_read_b64_tr_b16 a[68:69], v7 offset:16384
 v_mul_f32 v77, s34, v77
 v_mfma_f32_16x16x32_bf16 v[172:175], a[88:91], a[116:119], v[172:175]
 s_add_u32 s59, s56, 32768
 ds_read_b64_tr_b16 a[70:71], v7 offset:20480
 v_xor_b32 v8, 131424, v6
 v_mfma_f32_16x16x32_bf16 v[172:175], a[92:95], a[124:127], v[172:175]
 s_waitcnt lgkmcnt(6)
 ds_read_b64_tr_b16 a[72:73], v8 offset:0
 buffer_store_dwordx4 v[248:251], v1, s[12:15], s59 offen offset:3072 sc1
 v_mfma_f32_16x16x32_bf16 v[180:183], a[96:99], a[192:195], v[180:183]
 ds_read_b64_tr_b16 a[74:75], v8 offset:4096
 v_mul_f32 v78, s34, v78
 v_mfma_f32_16x16x32_bf16 v[180:183], a[100:103], a[200:203], v[180:183]
 ds_read_b64_tr_b16 a[76:77], v8 offset:16384
 v_mul_f32 v79, s34, v79
 v_mfma_f32_16x16x32_bf16 v[180:183], a[104:107], a[208:211], v[180:183]
 s_waitcnt lgkmcnt(3)
 ds_read_b64_tr_b16 a[78:79], v8 offset:20480
 v_xor_b32 v9, 352, v6
 v_mfma_f32_16x16x32_bf16 v[180:183], a[108:111], a[216:219], v[180:183]
 ds_read_b64_tr_b16 a[80:81], v9 offset:0
 v_cvt_pk_bf16_f32 v36, v36, v37
 v_mfma_f32_16x16x32_bf16 v[180:183], a[64:67], a[112:115], v[180:183]
 ds_read_b64_tr_b16 a[82:83], v9 offset:4096
 v_cvt_pk_bf16_f32 v37, v38, v39
 v_mfma_f32_16x16x32_bf16 v[180:183], a[68:71], a[120:123], v[180:183]
 ds_read_b64_tr_b16 a[84:85], v9 offset:16384
 v_cvt_pk_bf16_f32 v38, v76, v77
 v_mfma_f32_16x16x32_bf16 v[188:191], a[96:99], a[196:199], v[188:191]
 ds_read_b64_tr_b16 a[86:87], v9 offset:20480
 v_xor_b32 v10, 65888, v6
 v_mfma_f32_16x16x32_bf16 v[188:191], a[100:103], a[204:207], v[188:191]
 ds_read_b64_tr_b16 a[88:89], v10 offset:0
 v_cvt_pk_bf16_f32 v39, v78, v79
 v_mfma_f32_16x16x32_bf16 v[188:191], a[104:107], a[212:215], v[188:191]
 ds_read_b64_tr_b16 a[90:91], v10 offset:4096
 v_accvgpr_write_b32 a36, v36
 v_mfma_f32_16x16x32_bf16 v[188:191], a[108:111], a[220:223], v[188:191]
 ds_read_b64_tr_b16 a[92:93], v10 offset:16384
 v_accvgpr_write_b32 a37, v37
 v_mfma_f32_16x16x32_bf16 v[188:191], a[64:67], a[116:119], v[188:191]
 ds_read_b64_tr_b16 a[94:95], v10 offset:20480
 v_xor_b32 v7, 131456, v6
 v_mfma_f32_16x16x32_bf16 v[188:191], a[68:71], a[124:127], v[188:191]
 s_waitcnt lgkmcnt(6)
 ds_read_b64_tr_b16 a[96:97], v7 offset:0
 v_accvgpr_write_b32 a38, v38
 v_mfma_f32_16x16x32_bf16 v[196:199], a[72:75], a[192:195], v[196:199]
 ds_read_b64_tr_b16 a[98:99], v7 offset:4096
 v_accvgpr_write_b32 a39, v39
 v_mfma_f32_16x16x32_bf16 v[196:199], a[76:79], a[200:203], v[196:199]
 ds_read_b64_tr_b16 a[100:101], v7 offset:16384
 v_mul_f32 v84, s34, v84
 v_mfma_f32_16x16x32_bf16 v[196:199], a[80:83], a[208:211], v[196:199]
 s_waitcnt lgkmcnt(3)
 ds_read_b64_tr_b16 a[102:103], v7 offset:20480
 v_xor_b32 v8, 384, v6
 v_mfma_f32_16x16x32_bf16 v[196:199], a[84:87], a[216:219], v[196:199]
 ds_read_b64_tr_b16 a[104:105], v8 offset:0
 v_mul_f32 v85, s34, v85
 v_mfma_f32_16x16x32_bf16 v[196:199], a[88:91], a[112:115], v[196:199]
 ds_read_b64_tr_b16 a[106:107], v8 offset:4096
 v_mul_f32 v86, s34, v86
 v_mfma_f32_16x16x32_bf16 v[196:199], a[92:95], a[120:123], v[196:199]
 ds_read_b64_tr_b16 a[108:109], v8 offset:16384
 v_mul_f32 v87, s34, v87
 v_mfma_f32_16x16x32_bf16 v[204:207], a[72:75], a[196:199], v[204:207]
 ds_read_b64_tr_b16 a[110:111], v8 offset:20480
 v_xor_b32 v9, 65920, v6
 v_mfma_f32_16x16x32_bf16 v[204:207], a[76:79], a[204:207], v[204:207]
 ds_read_b64_tr_b16 a[64:65], v9 offset:0
 v_mul_f32 v100, s34, v100
 v_mfma_f32_16x16x32_bf16 v[204:207], a[80:83], a[212:215], v[204:207]
 ds_read_b64_tr_b16 a[66:67], v9 offset:4096
 v_mul_f32 v101, s34, v101
 v_mfma_f32_16x16x32_bf16 v[204:207], a[84:87], a[220:223], v[204:207]
 ds_read_b64_tr_b16 a[68:69], v9 offset:16384
 v_mul_f32 v102, s34, v102
 v_mfma_f32_16x16x32_bf16 v[204:207], a[88:91], a[116:119], v[204:207]
 ds_read_b64_tr_b16 a[70:71], v9 offset:20480
 v_xor_b32 v10, 131488, v6
 v_mfma_f32_16x16x32_bf16 v[204:207], a[92:95], a[124:127], v[204:207]
 s_waitcnt lgkmcnt(6)
 ds_read_b64_tr_b16 a[72:73], v10 offset:0
 v_mul_f32 v103, s34, v103
 v_mfma_f32_16x16x32_bf16 v[212:215], a[96:99], a[192:195], v[212:215]
 ds_read_b64_tr_b16 a[74:75], v10 offset:4096
 v_cvt_pk_bf16_f32 v84, v84, v85
 v_mfma_f32_16x16x32_bf16 v[212:215], a[100:103], a[200:203], v[212:215]
 ds_read_b64_tr_b16 a[76:77], v10 offset:16384
 v_cvt_pk_bf16_f32 v85, v86, v87
 v_mfma_f32_16x16x32_bf16 v[212:215], a[104:107], a[208:211], v[212:215]
 s_waitcnt lgkmcnt(3)
 ds_read_b64_tr_b16 a[78:79], v10 offset:20480
 v_xor_b32 v7, 416, v6
 v_mfma_f32_16x16x32_bf16 v[212:215], a[108:111], a[216:219], v[212:215]
 ds_read_b64_tr_b16 a[80:81], v7 offset:0
 v_cvt_pk_bf16_f32 v86, v100, v101
 v_mfma_f32_16x16x32_bf16 v[212:215], a[64:67], a[112:115], v[212:215]
 ds_read_b64_tr_b16 a[82:83], v7 offset:4096
 v_cvt_pk_bf16_f32 v87, v102, v103
 v_mfma_f32_16x16x32_bf16 v[212:215], a[68:71], a[120:123], v[212:215]
 ds_read_b64_tr_b16 a[84:85], v7 offset:16384
 v_accvgpr_write_b32 a8, v84
 v_mfma_f32_16x16x32_bf16 v[220:223], a[96:99], a[196:199], v[220:223]
 ds_read_b64_tr_b16 a[86:87], v7 offset:20480
 v_xor_b32 v8, 65952, v6
 v_mfma_f32_16x16x32_bf16 v[220:223], a[100:103], a[204:207], v[220:223]
 ds_read_b64_tr_b16 a[88:89], v8 offset:0
 v_accvgpr_write_b32 a9, v85
 v_mfma_f32_16x16x32_bf16 v[220:223], a[104:107], a[212:215], v[220:223]
 ds_read_b64_tr_b16 a[90:91], v8 offset:4096
 v_accvgpr_write_b32 a10, v86
 v_mfma_f32_16x16x32_bf16 v[220:223], a[108:111], a[220:223], v[220:223]
 ds_read_b64_tr_b16 a[92:93], v8 offset:16384
 v_accvgpr_write_b32 a11, v87
 v_mfma_f32_16x16x32_bf16 v[220:223], a[64:67], a[116:119], v[220:223]
 ds_read_b64_tr_b16 a[94:95], v8 offset:20480
 v_xor_b32 v9, 131520, v6
 v_mfma_f32_16x16x32_bf16 v[220:223], a[68:71], a[124:127], v[220:223]
 s_waitcnt lgkmcnt(6)
 ds_read_b64_tr_b16 a[96:97], v9 offset:0
 v_mul_f32 v92, s34, v92
 v_mfma_f32_16x16x32_bf16 v[228:231], a[72:75], a[192:195], v[228:231]
 ds_read_b64_tr_b16 a[98:99], v9 offset:4096
 v_mul_f32 v93, s34, v93
 v_mfma_f32_16x16x32_bf16 v[228:231], a[76:79], a[200:203], v[228:231]
 ds_read_b64_tr_b16 a[100:101], v9 offset:16384
 v_mul_f32 v94, s34, v94
 v_mfma_f32_16x16x32_bf16 v[228:231], a[80:83], a[208:211], v[228:231]
 s_waitcnt lgkmcnt(3)
 ds_read_b64_tr_b16 a[102:103], v9 offset:20480
 v_xor_b32 v10, 448, v6
 v_mfma_f32_16x16x32_bf16 v[228:231], a[84:87], a[216:219], v[228:231]
 ds_read_b64_tr_b16 a[104:105], v10 offset:0
 v_mul_f32 v95, s34, v95
 v_mfma_f32_16x16x32_bf16 v[228:231], a[88:91], a[112:115], v[228:231]
 ds_read_b64_tr_b16 a[106:107], v10 offset:4096
 v_mul_f32 v108, s34, v108
 v_mfma_f32_16x16x32_bf16 v[228:231], a[92:95], a[120:123], v[228:231]
 ds_read_b64_tr_b16 a[108:109], v10 offset:16384
 v_mul_f32 v109, s34, v109
 v_mfma_f32_16x16x32_bf16 v[236:239], a[72:75], a[196:199], v[236:239]
 ds_read_b64_tr_b16 a[110:111], v10 offset:20480
 v_xor_b32 v7, 65984, v6
 v_mfma_f32_16x16x32_bf16 v[236:239], a[76:79], a[204:207], v[236:239]
 ds_read_b64_tr_b16 a[64:65], v7 offset:0
 buffer_load_dword v13, v12, s[12:15], s58 offen sc1
 v_mfma_f32_16x16x32_bf16 v[236:239], a[80:83], a[212:215], v[236:239]
 ds_read_b64_tr_b16 a[66:67], v7 offset:4096
 v_mul_f32 v110, s34, v110
 v_mfma_f32_16x16x32_bf16 v[236:239], a[84:87], a[220:223], v[236:239]
 ds_read_b64_tr_b16 a[68:69], v7 offset:16384
 v_mul_f32 v111, s34, v111
 v_mfma_f32_16x16x32_bf16 v[236:239], a[88:91], a[116:119], v[236:239]
 ds_read_b64_tr_b16 a[70:71], v7 offset:20480
 v_xor_b32 v8, 131552, v6
 v_mfma_f32_16x16x32_bf16 v[236:239], a[92:95], a[124:127], v[236:239]
 s_waitcnt lgkmcnt(6)
 ds_read_b64_tr_b16 a[72:73], v8 offset:0
 v_cvt_pk_bf16_f32 v92, v92, v93
 v_mfma_f32_16x16x32_bf16 v[244:247], a[96:99], a[192:195], v[244:247]
 ds_read_b64_tr_b16 a[74:75], v8 offset:4096
 v_cvt_pk_bf16_f32 v93, v94, v95
 v_mfma_f32_16x16x32_bf16 v[244:247], a[100:103], a[200:203], v[244:247]
 ds_read_b64_tr_b16 a[76:77], v8 offset:16384
 v_cvt_pk_bf16_f32 v94, v108, v109
 v_mfma_f32_16x16x32_bf16 v[244:247], a[104:107], a[208:211], v[244:247]
 s_waitcnt lgkmcnt(3)
 ds_read_b64_tr_b16 a[78:79], v8 offset:20480
 v_xor_b32 v9, 480, v6
 v_mfma_f32_16x16x32_bf16 v[244:247], a[108:111], a[216:219], v[244:247]
 ds_read_b64_tr_b16 a[80:81], v9 offset:0
 v_cvt_pk_bf16_f32 v95, v110, v111
 v_mfma_f32_16x16x32_bf16 v[244:247], a[64:67], a[112:115], v[244:247]
 ds_read_b64_tr_b16 a[82:83], v9 offset:4096
 v_accvgpr_write_b32 a40, v92
 v_mfma_f32_16x16x32_bf16 v[244:247], a[68:71], a[120:123], v[244:247]
 ds_read_b64_tr_b16 a[84:85], v9 offset:16384
 v_accvgpr_write_b32 a41, v93
 v_mfma_f32_16x16x32_bf16 v[252:255], a[96:99], a[196:199], v[252:255]
 ds_read_b64_tr_b16 a[86:87], v9 offset:20480
 v_xor_b32 v10, 66016, v6
 v_mfma_f32_16x16x32_bf16 v[252:255], a[100:103], a[204:207], v[252:255]
 ds_read_b64_tr_b16 a[88:89], v10 offset:0
 v_accvgpr_write_b32 a42, v94
 v_mfma_f32_16x16x32_bf16 v[252:255], a[104:107], a[212:215], v[252:255]
 ds_read_b64_tr_b16 a[90:91], v10 offset:4096
 v_accvgpr_write_b32 a43, v95
 v_mfma_f32_16x16x32_bf16 v[252:255], a[108:111], a[220:223], v[252:255]
 ds_read_b64_tr_b16 a[92:93], v10 offset:16384
 v_mfma_f32_16x16x32_bf16 v[252:255], a[64:67], a[116:119], v[252:255]
 ds_read_b64_tr_b16 a[94:95], v10 offset:20480
 v_mfma_f32_16x16x32_bf16 v[252:255], a[68:71], a[124:127], v[252:255]
 s_waitcnt lgkmcnt(6)
 v_mfma_f32_16x16x32_bf16 v[16:19], a[72:75], a[192:195], v[16:19]
 v_mfma_f32_16x16x32_bf16 v[16:19], a[76:79], a[200:203], v[16:19]
 v_mfma_f32_16x16x32_bf16 v[16:19], a[80:83], a[208:211], v[16:19]
 s_waitcnt lgkmcnt(0)
 v_mfma_f32_16x16x32_bf16 v[16:19], a[84:87], a[216:219], v[16:19]
 v_mfma_f32_16x16x32_bf16 v[16:19], a[88:91], a[112:115], v[16:19]
 v_mfma_f32_16x16x32_bf16 v[16:19], a[92:95], a[120:123], v[16:19]
 v_mfma_f32_16x16x32_bf16 v[24:27], a[72:75], a[196:199], v[24:27]
 v_mfma_f32_16x16x32_bf16 v[24:27], a[76:79], a[204:207], v[24:27]
 v_mfma_f32_16x16x32_bf16 v[24:27], a[80:83], a[212:215], v[24:27]
 v_mfma_f32_16x16x32_bf16 v[24:27], a[84:87], a[220:223], v[24:27]
 s_waitcnt lgkmcnt(0)
 v_mfma_f32_16x16x32_bf16 v[24:27], a[88:91], a[116:119], v[24:27]
 s_barrier
 v_mfma_f32_16x16x32_bf16 v[24:27], a[92:95], a[124:127], v[24:27]
 s_waitcnt vmcnt(0)
 v_cmp_ne_u32 s[16:17], 0, v13
 v_cmp_gt_u32 vcc, 256, v5
 s_or_b64 vcc, vcc, s[16:17]
 s_mov_b32 m0, s40
 s_cselect_b32 s48, 0, 1
 s_cselect_b32 s52, 2.0, s42
 buffer_load_dwordx4 v1, s[12:15], s52 offen offset:0 sc1 lds
 v_pk_mul_f32 v[116:117], v[116:117], s[34:35]
 v_pk_mul_f32 v[118:119], v[118:119], s[34:35]
 v_pk_mul_f32 v[132:133], v[132:133], s[34:35]
 v_pk_mul_f32 v[134:135], v[134:135], s[34:35]
 v_cvt_pk_bf16_f32 v116, v116, v117
 v_cvt_pk_bf16_f32 v117, v118, v119
 v_cvt_pk_bf16_f32 v118, v132, v133
 v_cvt_pk_bf16_f32 v119, v134, v135
 v_accvgpr_write_b32 a12, v116
 v_accvgpr_write_b32 a13, v117
 v_accvgpr_write_b32 a14, v118
 v_accvgpr_write_b32 a15, v119
 v_pk_mul_f32 v[124:125], v[124:125], s[34:35]
 v_pk_mul_f32 v[126:127], v[126:127], s[34:35]
 v_pk_mul_f32 v[140:141], v[140:141], s[34:35]
 buffer_load_dwordx4 v1, s[12:15], s52 offen offset:1024 sc1 lds
 v_pk_mul_f32 v[142:143], v[142:143], s[34:35]
 v_cvt_pk_bf16_f32 v124, v124, v125
 v_cvt_pk_bf16_f32 v125, v126, v127
 v_cvt_pk_bf16_f32 v126, v140, v141
 v_cvt_pk_bf16_f32 v127, v142, v143
 v_accvgpr_write_b32 a44, v124
 v_accvgpr_write_b32 a45, v125
 v_accvgpr_write_b32 a46, v126
 v_accvgpr_write_b32 a47, v127
 v_pk_mul_f32 v[148:149], v[148:149], s[34:35]
 v_pk_mul_f32 v[150:151], v[150:151], s[34:35]
 v_pk_mul_f32 v[164:165], v[164:165], s[34:35]
 v_pk_mul_f32 v[166:167], v[166:167], s[34:35]
 v_cvt_pk_bf16_f32 v148, v148, v149
 v_cvt_pk_bf16_f32 v149, v150, v151
 buffer_load_dwordx4 v1, s[12:15], s52 offen offset:2048 sc1 lds
 v_cvt_pk_bf16_f32 v150, v164, v165
 v_cvt_pk_bf16_f32 v151, v166, v167
 v_accvgpr_write_b32 a16, v148
 v_accvgpr_write_b32 a17, v149
 v_accvgpr_write_b32 a18, v150
 v_accvgpr_write_b32 a19, v151
 v_pk_mul_f32 v[156:157], v[156:157], s[34:35]
 v_pk_mul_f32 v[158:159], v[158:159], s[34:35]
 v_pk_mul_f32 v[172:173], v[172:173], s[34:35]
 v_pk_mul_f32 v[174:175], v[174:175], s[34:35]
 v_cvt_pk_bf16_f32 v156, v156, v157
 v_cvt_pk_bf16_f32 v157, v158, v159
 v_cvt_pk_bf16_f32 v158, v172, v173
 v_cvt_pk_bf16_f32 v159, v174, v175
 v_accvgpr_write_b32 a48, v156
 buffer_load_dwordx4 v1, s[12:15], s52 offen offset:3072 sc1 lds
 v_accvgpr_write_b32 a49, v157
 v_accvgpr_write_b32 a50, v158
 v_accvgpr_write_b32 a51, v159
 v_pk_mul_f32 v[180:181], v[180:181], s[34:35]
 v_pk_mul_f32 v[182:183], v[182:183], s[34:35]
 v_pk_mul_f32 v[196:197], v[196:197], s[34:35]
 v_pk_mul_f32 v[198:199], v[198:199], s[34:35]
 v_cvt_pk_bf16_f32 v180, v180, v181
 v_cvt_pk_bf16_f32 v181, v182, v183
 v_cvt_pk_bf16_f32 v182, v196, v197
 v_cvt_pk_bf16_f32 v183, v198, v199
 v_accvgpr_write_b32 a20, v180
 v_accvgpr_write_b32 a21, v181
 v_accvgpr_write_b32 a22, v182
 v_accvgpr_write_b32 a23, v183
 s_bitset1_b32 m0, 12
 s_nop 0
 buffer_load_dwordx4 v4, s[12:15], s52 offen offset:0 sc1 lds
 v_pk_mul_f32 v[188:189], v[188:189], s[34:35]
 v_pk_mul_f32 v[190:191], v[190:191], s[34:35]
 v_pk_mul_f32 v[204:205], v[204:205], s[34:35]
 v_pk_mul_f32 v[206:207], v[206:207], s[34:35]
 v_cvt_pk_bf16_f32 v188, v188, v189
 v_cvt_pk_bf16_f32 v189, v190, v191
 v_cvt_pk_bf16_f32 v190, v204, v205
 v_cvt_pk_bf16_f32 v191, v206, v207
 v_accvgpr_write_b32 a52, v188
 v_accvgpr_write_b32 a53, v189
 v_accvgpr_write_b32 a54, v190
 v_accvgpr_write_b32 a55, v191
 v_pk_mul_f32 v[212:213], v[212:213], s[34:35]
 v_pk_mul_f32 v[214:215], v[214:215], s[34:35]
 v_pk_mul_f32 v[228:229], v[228:229], s[34:35]
 buffer_load_dwordx4 v4, s[12:15], s52 offen offset:1024 sc1 lds
 v_pk_mul_f32 v[230:231], v[230:231], s[34:35]
 v_cvt_pk_bf16_f32 v212, v212, v213
 v_cvt_pk_bf16_f32 v213, v214, v215
 v_cvt_pk_bf16_f32 v214, v228, v229
 v_cvt_pk_bf16_f32 v215, v230, v231
 v_accvgpr_write_b32 a24, v212
 v_accvgpr_write_b32 a25, v213
 v_accvgpr_write_b32 a26, v214
 v_accvgpr_write_b32 a27, v215
 v_pk_mul_f32 v[220:221], v[220:221], s[34:35]
 v_pk_mul_f32 v[222:223], v[222:223], s[34:35]
 v_pk_mul_f32 v[236:237], v[236:237], s[34:35]
 v_pk_mul_f32 v[238:239], v[238:239], s[34:35]
 v_cvt_pk_bf16_f32 v220, v220, v221
 v_cvt_pk_bf16_f32 v221, v222, v223
 buffer_load_dwordx4 v4, s[12:15], s52 offen offset:2048 sc1 lds
 v_cvt_pk_bf16_f32 v222, v236, v237
 v_cvt_pk_bf16_f32 v223, v238, v239
 v_accvgpr_write_b32 a56, v220
 v_accvgpr_write_b32 a57, v221
 v_accvgpr_write_b32 a58, v222
 v_accvgpr_write_b32 a59, v223
 v_pk_mul_f32 v[244:245], v[244:245], s[34:35]
 v_pk_mul_f32 v[246:247], v[246:247], s[34:35]
 v_pk_mul_f32 v[16:17], v[16:17], s[34:35]
 v_pk_mul_f32 v[18:19], v[18:19], s[34:35]
 v_cvt_pk_bf16_f32 v244, v244, v245
 v_cvt_pk_bf16_f32 v245, v246, v247
 v_cvt_pk_bf16_f32 v246, v16, v17
 v_cvt_pk_bf16_f32 v247, v18, v19
 v_accvgpr_write_b32 a28, v244
 buffer_load_dwordx4 v4, s[12:15], s52 offen offset:3072 sc1 lds
 v_accvgpr_write_b32 a29, v245
 v_accvgpr_write_b32 a30, v246
 v_accvgpr_write_b32 a31, v247
 v_pk_mul_f32 v[252:253], v[252:253], s[34:35]
 v_pk_mul_f32 v[254:255], v[254:255], s[34:35]
 v_pk_mul_f32 v[24:25], v[24:25], s[34:35]
 v_pk_mul_f32 v[26:27], v[26:27], s[34:35]
 v_cvt_pk_bf16_f32 v252, v252, v253
 v_cvt_pk_bf16_f32 v253, v254, v255
 v_cvt_pk_bf16_f32 v254, v24, v25
 v_cvt_pk_bf16_f32 v255, v26, v27
 v_accvgpr_write_b32 a60, v252
 v_accvgpr_write_b32 a61, v253
 v_accvgpr_write_b32 a62, v254
 v_accvgpr_write_b32 a63, v255
 s_branch L_kvdone
L_kloop_side:
 s_mov_b64 exec, 1
 global_atomic_add v3, v15, s[90:91] offset:128 sc1
 s_mov_b64 exec, -1
 s_mov_b32 s55, 6
 s_branch L_kloop
L_vloop_side:
 s_mov_b64 exec, 1
 global_atomic_add v3, v15, s[90:91] offset:128 sc1
 s_mov_b64 exec, -1
 s_mov_b32 s55, 6
 s_branch L_vloop
L_vloop_head:
 v_mfma_f32_16x16x32_bf16 v[64:67], a[64:67], a[0:3], 0
 s_add_u32 m0, s29, 118784
 ds_read_b64_tr_b16 a[24:25], v9 offset:0
 v_mfma_f32_16x16x32_bf16 v[64:67], a[68:71], a[4:7], v[64:67]
 ds_read_b64_tr_b16 a[26:27], v9 offset:4096
 buffer_load_dwordx4 v2, s[8:11], s52 offen  lds
 v_mfma_f32_16x16x32_bf16 v[68:71], a[76:79], a[4:7], 0
 ds_read_b64_tr_b16 a[28:29], v9 offset:16384
 v_mfma_f32_16x16x32_bf16 v[68:71], a[72:75], a[0:3], v[68:71]
 ds_read_b64_tr_b16 a[30:31], v9 offset:20480
 v_mfma_f32_16x16x32_bf16 v[72:75], a[80:83], a[0:3], 0
 s_add_u32 m0, s29, 53248
 ds_read_b128 a[96:99], v4 offset:8192
 v_mfma_f32_16x16x32_bf16 v[72:75], a[84:87], a[4:7], v[72:75]
 buffer_load_dwordx4 v1, s[4:7], s45 offen  lds
 v_mfma_f32_16x16x32_bf16 v[76:79], a[92:95], a[4:7], 0
 ds_read_b128 a[100:103], v5 offset:8192
 v_mfma_f32_16x16x32_bf16 v[76:79], a[88:91], a[0:3], v[76:79]
 v_mfma_f32_16x16x32_bf16 v[84:87], a[88:91], a[8:11], 0
 s_add_u32 m0, s29, 122880
 ds_read_b128 a[108:111], v5 offset:10240
 v_mfma_f32_16x16x32_bf16 v[84:87], a[92:95], a[12:15], v[84:87]
 buffer_load_dwordx4 v2, s[8:11], s53 offen  lds
 v_mfma_f32_16x16x32_bf16 v[80:83], a[84:87], a[12:15], 0
 ds_read_b128 a[104:107], v4 offset:10240
 v_mfma_f32_16x16x32_bf16 v[80:83], a[80:83], a[8:11], v[80:83]
 v_mfma_f32_16x16x32_bf16 v[92:95], a[72:75], a[8:11], 0
 s_add_u32 m0, s29, 57344
 ds_read_b128 a[112:115], v4 offset:12288
 v_mfma_f32_16x16x32_bf16 v[92:95], a[76:79], a[12:15], v[92:95]
 buffer_load_dwordx4 v1, s[4:7], s46 offen  lds
 v_mfma_f32_16x16x32_bf16 v[88:91], a[68:71], a[12:15], 0
 ds_read_b128 a[116:119], v5 offset:12288
 v_mfma_f32_16x16x32_bf16 v[88:91], a[64:67], a[8:11], v[88:91]
 v_mfma_f32_16x16x32_bf16 v[96:99], a[64:67], a[16:19], 0
 s_add_u32 m0, s29, 126976
 ds_read_b128 a[124:127], v5 offset:14336
 v_mfma_f32_16x16x32_bf16 v[96:99], a[68:71], a[20:23], v[96:99]
 buffer_load_dwordx4 v2, s[8:11], s54 offen  lds
 v_mfma_f32_16x16x32_bf16 v[100:103], a[76:79], a[20:23], 0
 ds_read_b128 a[120:123], v4 offset:14336
 v_mfma_f32_16x16x32_bf16 v[100:103], a[72:75], a[16:19], v[100:103]
 v_mfma_f32_16x16x32_bf16 v[104:107], a[80:83], a[16:19], 0
 s_add_u32 m0, s29, 61440
 ds_read_b64_tr_b16 a[32:33], v10 offset:0
 v_mfma_f32_16x16x32_bf16 v[104:107], a[84:87], a[20:23], v[104:107]
 ds_read_b64_tr_b16 a[34:35], v10 offset:4096
 buffer_load_dwordx4 v1, s[4:7], s47 offen  lds
 v_mfma_f32_16x16x32_bf16 v[108:111], a[92:95], a[20:23], 0
 ds_read_b64_tr_b16 a[36:37], v10 offset:16384
 v_add_u32 v1, 128, v1
 v_mfma_f32_16x16x32_bf16 v[108:111], a[88:91], a[16:19], v[108:111]
 s_waitcnt lgkmcnt(8)
 ds_read_b64_tr_b16 a[38:39], v10 offset:20480
 v_add_u32 v2, 0x80000, v2
 v_mfma_f32_16x16x32_bf16 v[116:119], a[88:91], a[24:27], 0
 ds_read_b64_tr_b16 a[40:41], v11 offset:0
 v_mfma_f32_16x16x32_bf16 v[116:119], a[92:95], a[28:31], v[116:119]
 ds_read_b64_tr_b16 a[42:43], v11 offset:4096
 v_mfma_f32_16x16x32_bf16 v[112:115], a[84:87], a[28:31], 0
 ds_read_b64_tr_b16 a[44:45], v11 offset:16384
 v_mfma_f32_16x16x32_bf16 v[112:115], a[80:83], a[24:27], v[112:115]
 ds_read_b64_tr_b16 a[46:47], v11 offset:20480
 v_mfma_f32_16x16x32_bf16 v[124:127], a[72:75], a[24:27], 0
 ds_read_b64_tr_b16 a[48:49], v12 offset:0
 v_mfma_f32_16x16x32_bf16 v[124:127], a[76:79], a[28:31], v[124:127]
 ds_read_b64_tr_b16 a[50:51], v12 offset:4096
 v_mfma_f32_16x16x32_bf16 v[120:123], a[68:71], a[28:31], 0
 ds_read_b64_tr_b16 a[52:53], v12 offset:16384
 v_mfma_f32_16x16x32_bf16 v[120:123], a[64:67], a[24:27], v[120:123]
 ds_read_b64_tr_b16 a[54:55], v12 offset:20480
 v_mfma_f32_16x16x32_bf16 v[16:19], a[96:99], a[0:3], 0
 ds_read_b64_tr_b16 a[56:57], v13 offset:0
 v_mfma_f32_16x16x32_bf16 v[16:19], a[100:103], a[4:7], v[16:19]
 ds_read_b64_tr_b16 a[58:59], v13 offset:4096
 v_mfma_f32_16x16x32_bf16 v[20:23], a[108:111], a[4:7], 0
 s_waitcnt lgkmcnt(8)
 ds_read_b64_tr_b16 a[60:61], v13 offset:16384
 v_mfma_f32_16x16x32_bf16 v[20:23], a[104:107], a[0:3], v[20:23]
 ds_read_b64_tr_b16 a[62:63], v13 offset:20480
 v_mfma_f32_16x16x32_bf16 v[24:27], a[112:115], a[0:3], 0
 v_mfma_f32_16x16x32_bf16 v[24:27], a[116:119], a[4:7], v[24:27]
 v_mfma_f32_16x16x32_bf16 v[28:31], a[124:127], a[4:7], 0
 v_mfma_f32_16x16x32_bf16 v[28:31], a[120:123], a[0:3], v[28:31]
 s_waitcnt lgkmcnt(0)
 v_mfma_f32_16x16x32_bf16 a[228:231], a[120:123], a[8:11], 0
 s_barrier
 v_mfma_f32_16x16x32_bf16 a[228:231], a[124:127], a[12:15], a[228:231]
 s_add_u32 m0, s29, 65536
 v_mfma_f32_16x16x32_bf16 a[224:227], a[116:119], a[12:15], 0
 buffer_load_dwordx4 v2, s[8:11], 0 offen  lds
 v_mfma_f32_16x16x32_bf16 a[224:227], a[112:115], a[8:11], a[224:227]
 v_mfma_f32_16x16x32_bf16 a[236:239], a[104:107], a[8:11], 0
 v_mfma_f32_16x16x32_bf16 a[236:239], a[108:111], a[12:15], a[236:239]
 v_mfma_f32_16x16x32_bf16 a[232:235], a[100:103], a[12:15], 0
 s_add_u32 m0, s29, 0
 v_mfma_f32_16x16x32_bf16 a[232:235], a[96:99], a[8:11], a[232:235]
 buffer_load_dwordx4 v1, s[4:7], 0 offen  lds
 v_mfma_f32_16x16x32_bf16 v[32:35], a[96:99], a[16:19], 0
 v_mfma_f32_16x16x32_bf16 v[32:35], a[100:103], a[20:23], v[32:35]
 v_mfma_f32_16x16x32_bf16 v[36:39], a[108:111], a[20:23], 0
 v_mfma_f32_16x16x32_bf16 v[36:39], a[104:107], a[16:19], v[36:39]
 s_add_u32 m0, s29, 69632
 v_mfma_f32_16x16x32_bf16 v[40:43], a[112:115], a[16:19], 0
 buffer_load_dwordx4 v2, s[8:11], s48 offen  lds
 v_mfma_f32_16x16x32_bf16 v[40:43], a[116:119], a[20:23], v[40:43]
 v_mfma_f32_16x16x32_bf16 v[44:47], a[124:127], a[20:23], 0
 v_mfma_f32_16x16x32_bf16 v[44:47], a[120:123], a[16:19], v[44:47]
 v_mfma_f32_16x16x32_bf16 v[52:55], a[120:123], a[24:27], 0
 s_add_u32 m0, s29, 4096
 v_mfma_f32_16x16x32_bf16 v[52:55], a[124:127], a[28:31], v[52:55]
 buffer_load_dwordx4 v1, s[4:7], s41 offen  lds
 v_mfma_f32_16x16x32_bf16 v[48:51], a[116:119], a[28:31], 0
 v_mfma_f32_16x16x32_bf16 v[48:51], a[112:115], a[24:27], v[48:51]
 v_mfma_f32_16x16x32_bf16 v[60:63], a[104:107], a[24:27], 0
 v_mfma_f32_16x16x32_bf16 v[60:63], a[108:111], a[28:31], v[60:63]
 s_add_u32 m0, s29, 73728
 v_mfma_f32_16x16x32_bf16 v[56:59], a[100:103], a[28:31], 0
 buffer_load_dwordx4 v2, s[8:11], s49 offen  lds
 v_mfma_f32_16x16x32_bf16 v[56:59], a[96:99], a[24:27], v[56:59]
 v_mfma_f32_16x16x32_bf16 v[192:195], a[96:99], a[32:35], 0
 v_mfma_f32_16x16x32_bf16 v[192:195], a[100:103], a[36:39], v[192:195]
 v_mfma_f32_16x16x32_bf16 v[196:199], a[108:111], a[36:39], 0
 s_add_u32 m0, s29, 8192
 v_mfma_f32_16x16x32_bf16 v[196:199], a[104:107], a[32:35], v[196:199]
 buffer_load_dwordx4 v1, s[4:7], s42 offen  lds
 v_mfma_f32_16x16x32_bf16 v[200:203], a[112:115], a[32:35], 0
 v_mfma_f32_16x16x32_bf16 v[200:203], a[116:119], a[36:39], v[200:203]
 v_mfma_f32_16x16x32_bf16 v[204:207], a[124:127], a[36:39], 0
 v_mfma_f32_16x16x32_bf16 v[204:207], a[120:123], a[32:35], v[204:207]
 s_add_u32 m0, s29, 77824
 v_mfma_f32_16x16x32_bf16 v[212:215], a[120:123], a[40:43], 0
 buffer_load_dwordx4 v2, s[8:11], s50 offen  lds
 v_mfma_f32_16x16x32_bf16 v[212:215], a[124:127], a[44:47], v[212:215]
 v_mfma_f32_16x16x32_bf16 v[208:211], a[116:119], a[44:47], 0
 v_mfma_f32_16x16x32_bf16 v[208:211], a[112:115], a[40:43], v[208:211]
 v_mfma_f32_16x16x32_bf16 v[220:223], a[104:107], a[40:43], 0
 s_add_u32 m0, s29, 12288
 v_mfma_f32_16x16x32_bf16 v[220:223], a[108:111], a[44:47], v[220:223]
 buffer_load_dwordx4 v1, s[4:7], s43 offen  lds
 v_mfma_f32_16x16x32_bf16 v[216:219], a[100:103], a[44:47], 0
 v_mfma_f32_16x16x32_bf16 v[216:219], a[96:99], a[40:43], v[216:219]
 v_mfma_f32_16x16x32_bf16 v[224:227], a[96:99], a[48:51], 0
 v_mfma_f32_16x16x32_bf16 v[224:227], a[100:103], a[52:55], v[224:227]
 s_add_u32 m0, s29, 81920
 v_mfma_f32_16x16x32_bf16 v[228:231], a[108:111], a[52:55], 0
 buffer_load_dwordx4 v2, s[8:11], s51 offen  lds
 v_mfma_f32_16x16x32_bf16 v[228:231], a[104:107], a[48:51], v[228:231]
 v_mfma_f32_16x16x32_bf16 v[232:235], a[112:115], a[48:51], 0
 v_mfma_f32_16x16x32_bf16 v[232:235], a[116:119], a[52:55], v[232:235]
 v_mfma_f32_16x16x32_bf16 v[236:239], a[124:127], a[52:55], 0
 s_add_u32 m0, s29, 16384
 v_mfma_f32_16x16x32_bf16 v[236:239], a[120:123], a[48:51], v[236:239]
 buffer_load_dwordx4 v1, s[4:7], s44 offen  lds
 v_mfma_f32_16x16x32_bf16 v[244:247], a[120:123], a[56:59], 0
 v_mfma_f32_16x16x32_bf16 v[244:247], a[124:127], a[60:63], v[244:247]
 v_mfma_f32_16x16x32_bf16 v[240:243], a[116:119], a[60:63], 0
 v_mfma_f32_16x16x32_bf16 v[240:243], a[112:115], a[56:59], v[240:243]
 s_add_u32 m0, s29, 86016
 v_mfma_f32_16x16x32_bf16 v[252:255], a[104:107], a[56:59], 0
 s_waitcnt vmcnt(10)
 buffer_load_dwordx4 v2, s[8:11], s52 offen  lds
 v_mfma_f32_16x16x32_bf16 v[252:255], a[108:111], a[60:63], v[252:255]
 s_barrier
 ds_read_b64_tr_b16 a[0:1], v6 offset:32768
 v_mfma_f32_16x16x32_bf16 v[248:251], a[100:103], a[60:63], 0
 ds_read_b64_tr_b16 a[2:3], v6 offset:36864
 v_mfma_f32_16x16x32_bf16 v[248:251], a[96:99], a[56:59], v[248:251]
 ds_read_b128 a[96:99], v4 offset:40960
 v_mfma_f32_16x16x32_bf16 v[128:131], a[64:67], a[32:35], 0
 s_add_u32 m0, s29, 20480
 v_mfma_f32_16x16x32_bf16 v[128:131], a[68:71], a[36:39], v[128:131]
 buffer_load_dwordx4 v1, s[4:7], s45 offen  lds
 v_mfma_f32_16x16x32_bf16 v[132:135], a[76:79], a[36:39], 0
 ds_read_b64_tr_b16 a[4:5], v6 offset:49152
 v_mfma_f32_16x16x32_bf16 v[132:135], a[72:75], a[32:35], v[132:135]
 ds_read_b64_tr_b16 a[6:7], v6 offset:53248
 v_mfma_f32_16x16x32_bf16 v[136:139], a[80:83], a[32:35], 0
 ds_read_b128 a[100:103], v5 offset:40960
 v_mfma_f32_16x16x32_bf16 v[136:139], a[84:87], a[36:39], v[136:139]
 s_add_u32 m0, s29, 90112
 v_mfma_f32_16x16x32_bf16 v[140:143], a[92:95], a[36:39], 0
 buffer_load_dwordx4 v2, s[8:11], s53 offen  lds
 v_mfma_f32_16x16x32_bf16 v[140:143], a[88:91], a[32:35], v[140:143]
 ds_read_b128 a[108:111], v5 offset:43008
 v_mfma_f32_16x16x32_bf16 v[148:151], a[88:91], a[40:43], 0
 v_mfma_f32_16x16x32_bf16 v[148:151], a[92:95], a[44:47], v[148:151]
 ds_read_b128 a[104:107], v4 offset:43008
 v_mfma_f32_16x16x32_bf16 v[144:147], a[84:87], a[44:47], 0
 s_add_u32 m0, s29, 24576
 v_mfma_f32_16x16x32_bf16 v[144:147], a[80:83], a[40:43], v[144:147]
 buffer_load_dwordx4 v1, s[4:7], s46 offen  lds
 v_mfma_f32_16x16x32_bf16 v[156:159], a[72:75], a[40:43], 0
 ds_read_b128 a[112:115], v4 offset:45056
 v_mfma_f32_16x16x32_bf16 v[156:159], a[76:79], a[44:47], v[156:159]
 v_mfma_f32_16x16x32_bf16 v[152:155], a[68:71], a[44:47], 0
 ds_read_b128 a[116:119], v5 offset:45056
 v_mfma_f32_16x16x32_bf16 v[152:155], a[64:67], a[40:43], v[152:155]
 s_add_u32 m0, s29, 94208
 v_mfma_f32_16x16x32_bf16 v[160:163], a[64:67], a[48:51], 0
 buffer_load_dwordx4 v2, s[8:11], s54 offen  lds
 v_mfma_f32_16x16x32_bf16 v[160:163], a[68:71], a[52:55], v[160:163]
 ds_read_b128 a[124:127], v5 offset:47104
 v_mfma_f32_16x16x32_bf16 v[164:167], a[76:79], a[52:55], 0
 v_mfma_f32_16x16x32_bf16 v[164:167], a[72:75], a[48:51], v[164:167]
 ds_read_b128 a[120:123], v4 offset:47104
 v_mfma_f32_16x16x32_bf16 v[168:171], a[80:83], a[48:51], 0
 s_add_u32 m0, s29, 28672
 v_mfma_f32_16x16x32_bf16 v[168:171], a[84:87], a[52:55], v[168:171]
 buffer_load_dwordx4 v1, s[4:7], s47 offen  lds
 v_mfma_f32_16x16x32_bf16 v[172:175], a[92:95], a[52:55], 0
 v_mfma_f32_16x16x32_bf16 v[172:175], a[88:91], a[48:51], v[172:175]
 ds_read_b64_tr_b16 a[8:9], v7 offset:32768
 v_mfma_f32_16x16x32_bf16 v[180:183], a[88:91], a[56:59], 0
 v_mfma_f32_16x16x32_bf16 v[180:183], a[92:95], a[60:63], v[180:183]
 ds_read_b64_tr_b16 a[10:11], v7 offset:36864
 v_mfma_f32_16x16x32_bf16 v[176:179], a[84:87], a[60:63], 0
 ds_read_b64_tr_b16 a[12:13], v7 offset:49152
 v_mfma_f32_16x16x32_bf16 v[176:179], a[80:83], a[56:59], v[176:179]
 ds_read_b64_tr_b16 a[14:15], v7 offset:53248
 v_mfma_f32_16x16x32_bf16 v[188:191], a[72:75], a[56:59], 0
 ds_read_b64_tr_b16 a[16:17], v8 offset:32768
 v_mfma_f32_16x16x32_bf16 v[188:191], a[76:79], a[60:63], v[188:191]
 ds_read_b64_tr_b16 a[18:19], v8 offset:36864
 v_mfma_f32_16x16x32_bf16 v[184:187], a[68:71], a[60:63], 0
 ds_read_b64_tr_b16 a[20:21], v8 offset:49152
 v_mfma_f32_16x16x32_bf16 v[184:187], a[64:67], a[56:59], v[184:187]
 s_waitcnt lgkmcnt(8)
 ds_read_b64_tr_b16 a[22:23], v8 offset:53248
 v_add_u32 v1, 128, v1
 v_add_u32 v2, 0x80000, v2
 s_add_u32 s56, s56, s30
 buffer_load_dword a243, v14, s[36:39], s56 offen
 s_add_u32 s56, s56, s30
 buffer_load_dword a243, v14, s[36:39], s56 offen
 s_add_u32 s56, s56, s30
 s_branch L_vloop_mid
.p2align 6
L_vloop:
 v_mfma_f32_16x16x32_bf16 v[64:67], a[64:67], a[0:3], v[64:67]
 ds_read_b64_tr_b16 a[24:25], v9 offset:0
 v_mfma_f32_16x16x32_bf16 v[64:67], a[68:71], a[4:7], v[64:67]
 ds_read_b64_tr_b16 a[26:27], v9 offset:4096
 v_mfma_f32_16x16x32_bf16 v[68:71], a[76:79], a[4:7], v[68:71]
 ds_read_b64_tr_b16 a[28:29], v9 offset:16384
 v_mfma_f32_16x16x32_bf16 v[68:71], a[72:75], a[0:3], v[68:71]
 ds_read_b64_tr_b16 a[30:31], v9 offset:20480
 v_mfma_f32_16x16x32_bf16 v[72:75], a[80:83], a[0:3], v[72:75]
 ds_read_b128 a[96:99], v4 offset:8192
 v_mfma_f32_16x16x32_bf16 v[72:75], a[84:87], a[4:7], v[72:75]
 v_mfma_f32_16x16x32_bf16 v[76:79], a[92:95], a[4:7], v[76:79]
 s_waitcnt lgkmcnt(8)
 ds_read_b128 a[100:103], v5 offset:8192
 v_mfma_f32_16x16x32_bf16 v[76:79], a[88:91], a[0:3], v[76:79]
 v_mfma_f32_16x16x32_bf16 v[84:87], a[88:91], a[8:11], v[84:87]
 ds_read_b128 a[108:111], v5 offset:10240
 v_mfma_f32_16x16x32_bf16 v[84:87], a[92:95], a[12:15], v[84:87]
 v_mfma_f32_16x16x32_bf16 v[80:83], a[84:87], a[12:15], v[80:83]
 ds_read_b128 a[104:107], v4 offset:10240
 v_mfma_f32_16x16x32_bf16 v[80:83], a[80:83], a[8:11], v[80:83]
 v_mfma_f32_16x16x32_bf16 v[92:95], a[72:75], a[8:11], v[92:95]
 ds_read_b128 a[112:115], v4 offset:12288
 v_mfma_f32_16x16x32_bf16 v[92:95], a[76:79], a[12:15], v[92:95]
 v_mfma_f32_16x16x32_bf16 v[88:91], a[68:71], a[12:15], v[88:91]
 ds_read_b128 a[116:119], v5 offset:12288
 v_mfma_f32_16x16x32_bf16 v[88:91], a[64:67], a[8:11], v[88:91]
 s_waitcnt lgkmcnt(8)
 v_mfma_f32_16x16x32_bf16 v[96:99], a[64:67], a[16:19], v[96:99]
 ds_read_b128 a[124:127], v5 offset:14336
 v_mfma_f32_16x16x32_bf16 v[96:99], a[68:71], a[20:23], v[96:99]
 v_mfma_f32_16x16x32_bf16 v[100:103], a[76:79], a[20:23], v[100:103]
 ds_read_b128 a[120:123], v4 offset:14336
 v_mfma_f32_16x16x32_bf16 v[100:103], a[72:75], a[16:19], v[100:103]
 v_mfma_f32_16x16x32_bf16 v[104:107], a[80:83], a[16:19], v[104:107]
 ds_read_b64_tr_b16 a[32:33], v10 offset:0
 v_mfma_f32_16x16x32_bf16 v[104:107], a[84:87], a[20:23], v[104:107]
 ds_read_b64_tr_b16 a[34:35], v10 offset:4096
 v_mfma_f32_16x16x32_bf16 v[108:111], a[92:95], a[20:23], v[108:111]
 ds_read_b64_tr_b16 a[36:37], v10 offset:16384
 v_mfma_f32_16x16x32_bf16 v[108:111], a[88:91], a[16:19], v[108:111]
 ds_read_b64_tr_b16 a[38:39], v10 offset:20480
 v_mfma_f32_16x16x32_bf16 v[116:119], a[88:91], a[24:27], v[116:119]
 s_waitcnt lgkmcnt(8)
 ds_read_b64_tr_b16 a[40:41], v11 offset:0
 v_mfma_f32_16x16x32_bf16 v[116:119], a[92:95], a[28:31], v[116:119]
 ds_read_b64_tr_b16 a[42:43], v11 offset:4096
 v_mfma_f32_16x16x32_bf16 v[112:115], a[84:87], a[28:31], v[112:115]
 ds_read_b64_tr_b16 a[44:45], v11 offset:16384
 v_mfma_f32_16x16x32_bf16 v[112:115], a[80:83], a[24:27], v[112:115]
 ds_read_b64_tr_b16 a[46:47], v11 offset:20480
 v_mfma_f32_16x16x32_bf16 v[124:127], a[72:75], a[24:27], v[124:127]
 ds_read_b64_tr_b16 a[48:49], v12 offset:0
 v_mfma_f32_16x16x32_bf16 v[124:127], a[76:79], a[28:31], v[124:127]
 ds_read_b64_tr_b16 a[50:51], v12 offset:4096
 v_mfma_f32_16x16x32_bf16 v[120:123], a[68:71], a[28:31], v[120:123]
 ds_read_b64_tr_b16 a[52:53], v12 offset:16384
 v_mfma_f32_16x16x32_bf16 v[120:123], a[64:67], a[24:27], v[120:123]
 ds_read_b64_tr_b16 a[54:55], v12 offset:20480
 v_mfma_f32_16x16x32_bf16 v[16:19], a[96:99], a[0:3], v[16:19]
 ds_read_b64_tr_b16 a[56:57], v13 offset:0
 v_mfma_f32_16x16x32_bf16 v[16:19], a[100:103], a[4:7], v[16:19]
 ds_read_b64_tr_b16 a[58:59], v13 offset:4096
 v_mfma_f32_16x16x32_bf16 v[20:23], a[108:111], a[4:7], v[20:23]
 ds_read_b64_tr_b16 a[60:61], v13 offset:16384
 v_mfma_f32_16x16x32_bf16 v[20:23], a[104:107], a[0:3], v[20:23]
 s_waitcnt lgkmcnt(8)
 ds_read_b64_tr_b16 a[62:63], v13 offset:20480
 v_mfma_f32_16x16x32_bf16 v[24:27], a[112:115], a[0:3], v[24:27]
 v_mfma_f32_16x16x32_bf16 v[24:27], a[116:119], a[4:7], v[24:27]
 v_mfma_f32_16x16x32_bf16 v[28:31], a[124:127], a[4:7], v[28:31]
 v_mfma_f32_16x16x32_bf16 v[28:31], a[120:123], a[0:3], v[28:31]
 s_waitcnt lgkmcnt(0)
 v_mfma_f32_16x16x32_bf16 a[228:231], a[120:123], a[8:11], a[228:231]
 s_barrier
 v_mfma_f32_16x16x32_bf16 a[228:231], a[124:127], a[12:15], a[228:231]
 s_add_u32 m0, s29, 65536
 v_mfma_f32_16x16x32_bf16 a[224:227], a[116:119], a[12:15], a[224:227]
 buffer_load_dwordx4 v2, s[8:11], 0 offen  lds
 v_mfma_f32_16x16x32_bf16 a[224:227], a[112:115], a[8:11], a[224:227]
 v_mfma_f32_16x16x32_bf16 a[236:239], a[104:107], a[8:11], a[236:239]
 v_mfma_f32_16x16x32_bf16 a[236:239], a[108:111], a[12:15], a[236:239]
 v_mfma_f32_16x16x32_bf16 a[232:235], a[100:103], a[12:15], a[232:235]
 s_add_u32 m0, s29, 0
 v_mfma_f32_16x16x32_bf16 a[232:235], a[96:99], a[8:11], a[232:235]
 buffer_load_dwordx4 v1, s[4:7], 0 offen  lds
 v_mfma_f32_16x16x32_bf16 v[32:35], a[96:99], a[16:19], v[32:35]
 v_mfma_f32_16x16x32_bf16 v[32:35], a[100:103], a[20:23], v[32:35]
 v_mfma_f32_16x16x32_bf16 v[36:39], a[108:111], a[20:23], v[36:39]
 v_mfma_f32_16x16x32_bf16 v[36:39], a[104:107], a[16:19], v[36:39]
 s_add_u32 m0, s29, 69632
 v_mfma_f32_16x16x32_bf16 v[40:43], a[112:115], a[16:19], v[40:43]
 buffer_load_dwordx4 v2, s[8:11], s48 offen  lds
 v_mfma_f32_16x16x32_bf16 v[40:43], a[116:119], a[20:23], v[40:43]
 v_mfma_f32_16x16x32_bf16 v[44:47], a[124:127], a[20:23], v[44:47]
 v_mfma_f32_16x16x32_bf16 v[44:47], a[120:123], a[16:19], v[44:47]
 v_mfma_f32_16x16x32_bf16 v[52:55], a[120:123], a[24:27], v[52:55]
 s_add_u32 m0, s29, 4096
 v_mfma_f32_16x16x32_bf16 v[52:55], a[124:127], a[28:31], v[52:55]
 buffer_load_dwordx4 v1, s[4:7], s41 offen  lds
 v_mfma_f32_16x16x32_bf16 v[48:51], a[116:119], a[28:31], v[48:51]
 v_mfma_f32_16x16x32_bf16 v[48:51], a[112:115], a[24:27], v[48:51]
 v_mfma_f32_16x16x32_bf16 v[60:63], a[104:107], a[24:27], v[60:63]
 v_mfma_f32_16x16x32_bf16 v[60:63], a[108:111], a[28:31], v[60:63]
 s_add_u32 m0, s29, 73728
 v_mfma_f32_16x16x32_bf16 v[56:59], a[100:103], a[28:31], v[56:59]
 buffer_load_dwordx4 v2, s[8:11], s49 offen  lds
 v_mfma_f32_16x16x32_bf16 v[56:59], a[96:99], a[24:27], v[56:59]
 v_mfma_f32_16x16x32_bf16 v[192:195], a[96:99], a[32:35], v[192:195]
 v_mfma_f32_16x16x32_bf16 v[192:195], a[100:103], a[36:39], v[192:195]
 v_mfma_f32_16x16x32_bf16 v[196:199], a[108:111], a[36:39], v[196:199]
 s_add_u32 m0, s29, 8192
 v_mfma_f32_16x16x32_bf16 v[196:199], a[104:107], a[32:35], v[196:199]
 buffer_load_dwordx4 v1, s[4:7], s42 offen  lds
 v_mfma_f32_16x16x32_bf16 v[200:203], a[112:115], a[32:35], v[200:203]
 v_mfma_f32_16x16x32_bf16 v[200:203], a[116:119], a[36:39], v[200:203]
 v_mfma_f32_16x16x32_bf16 v[204:207], a[124:127], a[36:39], v[204:207]
 v_mfma_f32_16x16x32_bf16 v[204:207], a[120:123], a[32:35], v[204:207]
 s_add_u32 m0, s29, 77824
 v_mfma_f32_16x16x32_bf16 v[212:215], a[120:123], a[40:43], v[212:215]
 buffer_load_dwordx4 v2, s[8:11], s50 offen  lds
 v_mfma_f32_16x16x32_bf16 v[212:215], a[124:127], a[44:47], v[212:215]
 v_mfma_f32_16x16x32_bf16 v[208:211], a[116:119], a[44:47], v[208:211]
 v_mfma_f32_16x16x32_bf16 v[208:211], a[112:115], a[40:43], v[208:211]
 v_mfma_f32_16x16x32_bf16 v[220:223], a[104:107], a[40:43], v[220:223]
 s_add_u32 m0, s29, 12288
 v_mfma_f32_16x16x32_bf16 v[220:223], a[108:111], a[44:47], v[220:223]
 buffer_load_dwordx4 v1, s[4:7], s43 offen  lds
 v_mfma_f32_16x16x32_bf16 v[216:219], a[100:103], a[44:47], v[216:219]
 v_mfma_f32_16x16x32_bf16 v[216:219], a[96:99], a[40:43], v[216:219]
 v_mfma_f32_16x16x32_bf16 v[224:227], a[96:99], a[48:51], v[224:227]
 v_mfma_f32_16x16x32_bf16 v[224:227], a[100:103], a[52:55], v[224:227]
 s_add_u32 m0, s29, 81920
 v_mfma_f32_16x16x32_bf16 v[228:231], a[108:111], a[52:55], v[228:231]
 buffer_load_dwordx4 v2, s[8:11], s51 offen  lds
 v_mfma_f32_16x16x32_bf16 v[228:231], a[104:107], a[48:51], v[228:231]
 v_mfma_f32_16x16x32_bf16 v[232:235], a[112:115], a[48:51], v[232:235]
 v_mfma_f32_16x16x32_bf16 v[232:235], a[116:119], a[52:55], v[232:235]
 v_mfma_f32_16x16x32_bf16 v[236:239], a[124:127], a[52:55], v[236:239]
 s_add_u32 m0, s29, 16384
 v_mfma_f32_16x16x32_bf16 v[236:239], a[120:123], a[48:51], v[236:239]
 buffer_load_dwordx4 v1, s[4:7], s44 offen  lds
 v_mfma_f32_16x16x32_bf16 v[244:247], a[120:123], a[56:59], v[244:247]
 v_mfma_f32_16x16x32_bf16 v[244:247], a[124:127], a[60:63], v[244:247]
 v_mfma_f32_16x16x32_bf16 v[240:243], a[116:119], a[60:63], v[240:243]
 v_mfma_f32_16x16x32_bf16 v[240:243], a[112:115], a[56:59], v[240:243]
 s_add_u32 m0, s29, 86016
 v_mfma_f32_16x16x32_bf16 v[252:255], a[104:107], a[56:59], v[252:255]
 s_waitcnt vmcnt(11)
 buffer_load_dwordx4 v2, s[8:11], s52 offen  lds
 v_mfma_f32_16x16x32_bf16 v[252:255], a[108:111], a[60:63], v[252:255]
 s_barrier
 ds_read_b64_tr_b16 a[0:1], v6 offset:32768
 v_mfma_f32_16x16x32_bf16 v[248:251], a[100:103], a[60:63], v[248:251]
 ds_read_b64_tr_b16 a[2:3], v6 offset:36864
 v_mfma_f32_16x16x32_bf16 v[248:251], a[96:99], a[56:59], v[248:251]
 ds_read_b128 a[96:99], v4 offset:40960
 v_mfma_f32_16x16x32_bf16 v[128:131], a[64:67], a[32:35], v[128:131]
 s_add_u32 m0, s29, 20480
 v_mfma_f32_16x16x32_bf16 v[128:131], a[68:71], a[36:39], v[128:131]
 buffer_load_dwordx4 v1, s[4:7], s45 offen  lds
 v_mfma_f32_16x16x32_bf16 v[132:135], a[76:79], a[36:39], v[132:135]
 ds_read_b64_tr_b16 a[4:5], v6 offset:49152
 v_mfma_f32_16x16x32_bf16 v[132:135], a[72:75], a[32:35], v[132:135]
 ds_read_b64_tr_b16 a[6:7], v6 offset:53248
 v_mfma_f32_16x16x32_bf16 v[136:139], a[80:83], a[32:35], v[136:139]
 ds_read_b128 a[100:103], v5 offset:40960
 v_mfma_f32_16x16x32_bf16 v[136:139], a[84:87], a[36:39], v[136:139]
 s_add_u32 m0, s29, 90112
 v_mfma_f32_16x16x32_bf16 v[140:143], a[92:95], a[36:39], v[140:143]
 buffer_load_dwordx4 v2, s[8:11], s53 offen  lds
 v_mfma_f32_16x16x32_bf16 v[140:143], a[88:91], a[32:35], v[140:143]
 ds_read_b128 a[108:111], v5 offset:43008
 v_mfma_f32_16x16x32_bf16 v[148:151], a[88:91], a[40:43], v[148:151]
 v_mfma_f32_16x16x32_bf16 v[148:151], a[92:95], a[44:47], v[148:151]
 ds_read_b128 a[104:107], v4 offset:43008
 v_mfma_f32_16x16x32_bf16 v[144:147], a[84:87], a[44:47], v[144:147]
 s_add_u32 m0, s29, 24576
 v_mfma_f32_16x16x32_bf16 v[144:147], a[80:83], a[40:43], v[144:147]
 buffer_load_dwordx4 v1, s[4:7], s46 offen  lds
 v_mfma_f32_16x16x32_bf16 v[156:159], a[72:75], a[40:43], v[156:159]
 ds_read_b128 a[112:115], v4 offset:45056
 v_mfma_f32_16x16x32_bf16 v[156:159], a[76:79], a[44:47], v[156:159]
 v_mfma_f32_16x16x32_bf16 v[152:155], a[68:71], a[44:47], v[152:155]
 ds_read_b128 a[116:119], v5 offset:45056
 v_mfma_f32_16x16x32_bf16 v[152:155], a[64:67], a[40:43], v[152:155]
 s_add_u32 m0, s29, 94208
 v_mfma_f32_16x16x32_bf16 v[160:163], a[64:67], a[48:51], v[160:163]
 buffer_load_dwordx4 v2, s[8:11], s54 offen  lds
 v_mfma_f32_16x16x32_bf16 v[160:163], a[68:71], a[52:55], v[160:163]
 ds_read_b128 a[124:127], v5 offset:47104
 v_mfma_f32_16x16x32_bf16 v[164:167], a[76:79], a[52:55], v[164:167]
 v_mfma_f32_16x16x32_bf16 v[164:167], a[72:75], a[48:51], v[164:167]
 ds_read_b128 a[120:123], v4 offset:47104
 v_mfma_f32_16x16x32_bf16 v[168:171], a[80:83], a[48:51], v[168:171]
 s_add_u32 m0, s29, 28672
 v_mfma_f32_16x16x32_bf16 v[168:171], a[84:87], a[52:55], v[168:171]
 buffer_load_dwordx4 v1, s[4:7], s47 offen  lds
 v_mfma_f32_16x16x32_bf16 v[172:175], a[92:95], a[52:55], v[172:175]
 v_add_u32 v1, 128, v1
 v_add_u32 v2, 0x80000, v2
 v_mfma_f32_16x16x32_bf16 v[172:175], a[88:91], a[48:51], v[172:175]
 ds_read_b64_tr_b16 a[8:9], v7 offset:32768
 v_mfma_f32_16x16x32_bf16 v[180:183], a[88:91], a[56:59], v[180:183]
 buffer_load_dword a243, v14, s[36:39], s56 offen
 v_mfma_f32_16x16x32_bf16 v[180:183], a[92:95], a[60:63], v[180:183]
 s_add_u32 s56, s56, s30
 ds_read_b64_tr_b16 a[10:11], v7 offset:36864
 v_mfma_f32_16x16x32_bf16 v[176:179], a[84:87], a[60:63], v[176:179]
 ds_read_b64_tr_b16 a[12:13], v7 offset:49152
 v_mfma_f32_16x16x32_bf16 v[176:179], a[80:83], a[56:59], v[176:179]
 ds_read_b64_tr_b16 a[14:15], v7 offset:53248
 v_mfma_f32_16x16x32_bf16 v[188:191], a[72:75], a[56:59], v[188:191]
 ds_read_b64_tr_b16 a[16:17], v8 offset:32768
 v_mfma_f32_16x16x32_bf16 v[188:191], a[76:79], a[60:63], v[188:191]
 ds_read_b64_tr_b16 a[18:19], v8 offset:36864
 v_mfma_f32_16x16x32_bf16 v[184:187], a[68:71], a[60:63], v[184:187]
 ds_read_b64_tr_b16 a[20:21], v8 offset:49152
 v_mfma_f32_16x16x32_bf16 v[184:187], a[64:67], a[56:59], v[184:187]
 s_waitcnt lgkmcnt(8)
 ds_read_b64_tr_b16 a[22:23], v8 offset:53248
L_vloop_mid:
 v_mfma_f32_16x16x32_bf16 v[16:19], a[96:99], a[0:3], v[16:19]
 ds_read_b64_tr_b16 a[24:25], v9 offset:32768
 v_mfma_f32_16x16x32_bf16 v[16:19], a[100:103], a[4:7], v[16:19]
 ds_read_b64_tr_b16 a[26:27], v9 offset:36864
 v_mfma_f32_16x16x32_bf16 v[20:23], a[108:111], a[4:7], v[20:23]
 ds_read_b64_tr_b16 a[28:29], v9 offset:49152
 v_mfma_f32_16x16x32_bf16 v[20:23], a[104:107], a[0:3], v[20:23]
 ds_read_b64_tr_b16 a[30:31], v9 offset:53248
 v_mfma_f32_16x16x32_bf16 v[24:27], a[112:115], a[0:3], v[24:27]
 ds_read_b128 a[64:67], v4 offset:32768
 v_mfma_f32_16x16x32_bf16 v[24:27], a[116:119], a[4:7], v[24:27]
 v_mfma_f32_16x16x32_bf16 v[28:31], a[124:127], a[4:7], v[28:31]
 s_waitcnt lgkmcnt(8)
 ds_read_b128 a[68:71], v5 offset:32768
 v_mfma_f32_16x16x32_bf16 v[28:31], a[120:123], a[0:3], v[28:31]
 v_mfma_f32_16x16x32_bf16 a[228:231], a[120:123], a[8:11], a[228:231]
 ds_read_b128 a[76:79], v5 offset:34816
 v_mfma_f32_16x16x32_bf16 a[228:231], a[124:127], a[12:15], a[228:231]
 v_mfma_f32_16x16x32_bf16 a[224:227], a[116:119], a[12:15], a[224:227]
 ds_read_b128 a[72:75], v4 offset:34816
 v_mfma_f32_16x16x32_bf16 a[224:227], a[112:115], a[8:11], a[224:227]
 v_mfma_f32_16x16x32_bf16 a[236:239], a[104:107], a[8:11], a[236:239]
 ds_read_b128 a[80:83], v4 offset:36864
 v_mfma_f32_16x16x32_bf16 a[236:239], a[108:111], a[12:15], a[236:239]
 v_mfma_f32_16x16x32_bf16 a[232:235], a[100:103], a[12:15], a[232:235]
 ds_read_b128 a[84:87], v5 offset:36864
 v_mfma_f32_16x16x32_bf16 a[232:235], a[96:99], a[8:11], a[232:235]
 s_waitcnt lgkmcnt(8)
 v_mfma_f32_16x16x32_bf16 v[32:35], a[96:99], a[16:19], v[32:35]
 ds_read_b128 a[92:95], v5 offset:38912
 v_mfma_f32_16x16x32_bf16 v[32:35], a[100:103], a[20:23], v[32:35]
 v_mfma_f32_16x16x32_bf16 v[36:39], a[108:111], a[20:23], v[36:39]
 ds_read_b128 a[88:91], v4 offset:38912
 v_mfma_f32_16x16x32_bf16 v[36:39], a[104:107], a[16:19], v[36:39]
 v_mfma_f32_16x16x32_bf16 v[40:43], a[112:115], a[16:19], v[40:43]
 ds_read_b64_tr_b16 a[32:33], v10 offset:32768
 v_mfma_f32_16x16x32_bf16 v[40:43], a[116:119], a[20:23], v[40:43]
 ds_read_b64_tr_b16 a[34:35], v10 offset:36864
 v_mfma_f32_16x16x32_bf16 v[44:47], a[124:127], a[20:23], v[44:47]
 ds_read_b64_tr_b16 a[36:37], v10 offset:49152
 v_mfma_f32_16x16x32_bf16 v[44:47], a[120:123], a[16:19], v[44:47]
 ds_read_b64_tr_b16 a[38:39], v10 offset:53248
 v_mfma_f32_16x16x32_bf16 v[52:55], a[120:123], a[24:27], v[52:55]
 s_waitcnt lgkmcnt(8)
 ds_read_b64_tr_b16 a[40:41], v11 offset:32768
 v_mfma_f32_16x16x32_bf16 v[52:55], a[124:127], a[28:31], v[52:55]
 ds_read_b64_tr_b16 a[42:43], v11 offset:36864
 v_mfma_f32_16x16x32_bf16 v[48:51], a[116:119], a[28:31], v[48:51]
 ds_read_b64_tr_b16 a[44:45], v11 offset:49152
 v_mfma_f32_16x16x32_bf16 v[48:51], a[112:115], a[24:27], v[48:51]
 ds_read_b64_tr_b16 a[46:47], v11 offset:53248
 v_mfma_f32_16x16x32_bf16 v[60:63], a[104:107], a[24:27], v[60:63]
 ds_read_b64_tr_b16 a[48:49], v12 offset:32768
 v_mfma_f32_16x16x32_bf16 v[60:63], a[108:111], a[28:31], v[60:63]
 ds_read_b64_tr_b16 a[50:51], v12 offset:36864
 v_mfma_f32_16x16x32_bf16 v[56:59], a[100:103], a[28:31], v[56:59]
 ds_read_b64_tr_b16 a[52:53], v12 offset:49152
 v_mfma_f32_16x16x32_bf16 v[56:59], a[96:99], a[24:27], v[56:59]
 ds_read_b64_tr_b16 a[54:55], v12 offset:53248
 v_mfma_f32_16x16x32_bf16 v[64:67], a[64:67], a[0:3], v[64:67]
 ds_read_b64_tr_b16 a[56:57], v13 offset:32768
 v_mfma_f32_16x16x32_bf16 v[64:67], a[68:71], a[4:7], v[64:67]
 ds_read_b64_tr_b16 a[58:59], v13 offset:36864
 v_mfma_f32_16x16x32_bf16 v[68:71], a[76:79], a[4:7], v[68:71]
 ds_read_b64_tr_b16 a[60:61], v13 offset:49152
 v_mfma_f32_16x16x32_bf16 v[68:71], a[72:75], a[0:3], v[68:71]
 s_waitcnt lgkmcnt(8)
 ds_read_b64_tr_b16 a[62:63], v13 offset:53248
 v_mfma_f32_16x16x32_bf16 v[72:75], a[80:83], a[0:3], v[72:75]
 v_mfma_f32_16x16x32_bf16 v[72:75], a[84:87], a[4:7], v[72:75]
 v_mfma_f32_16x16x32_bf16 v[76:79], a[92:95], a[4:7], v[76:79]
 v_mfma_f32_16x16x32_bf16 v[76:79], a[88:91], a[0:3], v[76:79]
 s_waitcnt lgkmcnt(0)
 v_mfma_f32_16x16x32_bf16 v[84:87], a[88:91], a[8:11], v[84:87]
 s_barrier
 v_mfma_f32_16x16x32_bf16 v[84:87], a[92:95], a[12:15], v[84:87]
 s_add_u32 m0, s29, 98304
 v_mfma_f32_16x16x32_bf16 v[80:83], a[84:87], a[12:15], v[80:83]
 buffer_load_dwordx4 v2, s[8:11], 0 offen  lds
 v_mfma_f32_16x16x32_bf16 v[80:83], a[80:83], a[8:11], v[80:83]
 v_mfma_f32_16x16x32_bf16 v[92:95], a[72:75], a[8:11], v[92:95]
 v_mfma_f32_16x16x32_bf16 v[92:95], a[76:79], a[12:15], v[92:95]
 v_mfma_f32_16x16x32_bf16 v[88:91], a[68:71], a[12:15], v[88:91]
 s_add_u32 m0, s29, 32768
 v_mfma_f32_16x16x32_bf16 v[88:91], a[64:67], a[8:11], v[88:91]
 buffer_load_dwordx4 v1, s[4:7], 0 offen  lds
 v_mfma_f32_16x16x32_bf16 v[96:99], a[64:67], a[16:19], v[96:99]
 v_mfma_f32_16x16x32_bf16 v[96:99], a[68:71], a[20:23], v[96:99]
 v_mfma_f32_16x16x32_bf16 v[100:103], a[76:79], a[20:23], v[100:103]
 v_mfma_f32_16x16x32_bf16 v[100:103], a[72:75], a[16:19], v[100:103]
 s_add_u32 m0, s29, 102400
 v_mfma_f32_16x16x32_bf16 v[104:107], a[80:83], a[16:19], v[104:107]
 buffer_load_dwordx4 v2, s[8:11], s48 offen  lds
 v_mfma_f32_16x16x32_bf16 v[104:107], a[84:87], a[20:23], v[104:107]
 v_mfma_f32_16x16x32_bf16 v[108:111], a[92:95], a[20:23], v[108:111]
 v_mfma_f32_16x16x32_bf16 v[108:111], a[88:91], a[16:19], v[108:111]
 v_mfma_f32_16x16x32_bf16 v[116:119], a[88:91], a[24:27], v[116:119]
 s_add_u32 m0, s29, 36864
 v_mfma_f32_16x16x32_bf16 v[116:119], a[92:95], a[28:31], v[116:119]
 buffer_load_dwordx4 v1, s[4:7], s41 offen  lds
 v_mfma_f32_16x16x32_bf16 v[112:115], a[84:87], a[28:31], v[112:115]
 v_mfma_f32_16x16x32_bf16 v[112:115], a[80:83], a[24:27], v[112:115]
 v_mfma_f32_16x16x32_bf16 v[124:127], a[72:75], a[24:27], v[124:127]
 v_mfma_f32_16x16x32_bf16 v[124:127], a[76:79], a[28:31], v[124:127]
 s_add_u32 m0, s29, 106496
 v_mfma_f32_16x16x32_bf16 v[120:123], a[68:71], a[28:31], v[120:123]
 buffer_load_dwordx4 v2, s[8:11], s49 offen  lds
 v_mfma_f32_16x16x32_bf16 v[120:123], a[64:67], a[24:27], v[120:123]
 v_mfma_f32_16x16x32_bf16 v[128:131], a[64:67], a[32:35], v[128:131]
 v_mfma_f32_16x16x32_bf16 v[128:131], a[68:71], a[36:39], v[128:131]
 v_mfma_f32_16x16x32_bf16 v[132:135], a[76:79], a[36:39], v[132:135]
 s_add_u32 m0, s29, 40960
 v_mfma_f32_16x16x32_bf16 v[132:135], a[72:75], a[32:35], v[132:135]
 buffer_load_dwordx4 v1, s[4:7], s42 offen  lds
 v_mfma_f32_16x16x32_bf16 v[136:139], a[80:83], a[32:35], v[136:139]
 v_mfma_f32_16x16x32_bf16 v[136:139], a[84:87], a[36:39], v[136:139]
 v_mfma_f32_16x16x32_bf16 v[140:143], a[92:95], a[36:39], v[140:143]
 v_mfma_f32_16x16x32_bf16 v[140:143], a[88:91], a[32:35], v[140:143]
 s_add_u32 m0, s29, 110592
 v_mfma_f32_16x16x32_bf16 v[148:151], a[88:91], a[40:43], v[148:151]
 buffer_load_dwordx4 v2, s[8:11], s50 offen  lds
 v_mfma_f32_16x16x32_bf16 v[148:151], a[92:95], a[44:47], v[148:151]
 v_mfma_f32_16x16x32_bf16 v[144:147], a[84:87], a[44:47], v[144:147]
 v_mfma_f32_16x16x32_bf16 v[144:147], a[80:83], a[40:43], v[144:147]
 v_mfma_f32_16x16x32_bf16 v[156:159], a[72:75], a[40:43], v[156:159]
 s_add_u32 m0, s29, 45056
 v_mfma_f32_16x16x32_bf16 v[156:159], a[76:79], a[44:47], v[156:159]
 buffer_load_dwordx4 v1, s[4:7], s43 offen  lds
 v_mfma_f32_16x16x32_bf16 v[152:155], a[68:71], a[44:47], v[152:155]
 v_mfma_f32_16x16x32_bf16 v[152:155], a[64:67], a[40:43], v[152:155]
 v_mfma_f32_16x16x32_bf16 v[160:163], a[64:67], a[48:51], v[160:163]
 v_mfma_f32_16x16x32_bf16 v[160:163], a[68:71], a[52:55], v[160:163]
 s_add_u32 m0, s29, 114688
 v_mfma_f32_16x16x32_bf16 v[164:167], a[76:79], a[52:55], v[164:167]
 buffer_load_dwordx4 v2, s[8:11], s51 offen  lds
 v_mfma_f32_16x16x32_bf16 v[164:167], a[72:75], a[48:51], v[164:167]
 v_mfma_f32_16x16x32_bf16 v[168:171], a[80:83], a[48:51], v[168:171]
 v_mfma_f32_16x16x32_bf16 v[168:171], a[84:87], a[52:55], v[168:171]
 v_mfma_f32_16x16x32_bf16 v[172:175], a[92:95], a[52:55], v[172:175]
 s_add_u32 m0, s29, 49152
 v_mfma_f32_16x16x32_bf16 v[172:175], a[88:91], a[48:51], v[172:175]
 buffer_load_dwordx4 v1, s[4:7], s44 offen  lds
 v_mfma_f32_16x16x32_bf16 v[180:183], a[88:91], a[56:59], v[180:183]
 v_mfma_f32_16x16x32_bf16 v[180:183], a[92:95], a[60:63], v[180:183]
 v_mfma_f32_16x16x32_bf16 v[176:179], a[84:87], a[60:63], v[176:179]
 v_mfma_f32_16x16x32_bf16 v[176:179], a[80:83], a[56:59], v[176:179]
 s_add_u32 m0, s29, 118784
 v_mfma_f32_16x16x32_bf16 v[188:191], a[72:75], a[56:59], v[188:191]
 s_waitcnt vmcnt(11)
 buffer_load_dwordx4 v2, s[8:11], s52 offen  lds
 v_mfma_f32_16x16x32_bf16 v[188:191], a[76:79], a[60:63], v[188:191]
 s_barrier
 ds_read_b64_tr_b16 a[0:1], v6 offset:0
 v_mfma_f32_16x16x32_bf16 v[184:187], a[68:71], a[60:63], v[184:187]
 ds_read_b64_tr_b16 a[2:3], v6 offset:4096
 v_mfma_f32_16x16x32_bf16 v[184:187], a[64:67], a[56:59], v[184:187]
 ds_read_b128 a[64:67], v4 offset:0
 v_mfma_f32_16x16x32_bf16 v[192:195], a[96:99], a[32:35], v[192:195]
 s_add_u32 m0, s29, 53248
 v_mfma_f32_16x16x32_bf16 v[192:195], a[100:103], a[36:39], v[192:195]
 buffer_load_dwordx4 v1, s[4:7], s45 offen  lds
 v_mfma_f32_16x16x32_bf16 v[196:199], a[108:111], a[36:39], v[196:199]
 ds_read_b64_tr_b16 a[4:5], v6 offset:16384
 v_mfma_f32_16x16x32_bf16 v[196:199], a[104:107], a[32:35], v[196:199]
 ds_read_b64_tr_b16 a[6:7], v6 offset:20480
 v_mfma_f32_16x16x32_bf16 v[200:203], a[112:115], a[32:35], v[200:203]
 ds_read_b128 a[68:71], v5 offset:0
 v_mfma_f32_16x16x32_bf16 v[200:203], a[116:119], a[36:39], v[200:203]
 s_add_u32 m0, s29, 122880
 v_mfma_f32_16x16x32_bf16 v[204:207], a[124:127], a[36:39], v[204:207]
 buffer_load_dwordx4 v2, s[8:11], s53 offen  lds
 v_mfma_f32_16x16x32_bf16 v[204:207], a[120:123], a[32:35], v[204:207]
 ds_read_b128 a[76:79], v5 offset:2048
 v_mfma_f32_16x16x32_bf16 v[212:215], a[120:123], a[40:43], v[212:215]
 v_mfma_f32_16x16x32_bf16 v[212:215], a[124:127], a[44:47], v[212:215]
 ds_read_b128 a[72:75], v4 offset:2048
 v_mfma_f32_16x16x32_bf16 v[208:211], a[116:119], a[44:47], v[208:211]
 s_add_u32 m0, s29, 57344
 v_mfma_f32_16x16x32_bf16 v[208:211], a[112:115], a[40:43], v[208:211]
 buffer_load_dwordx4 v1, s[4:7], s46 offen  lds
 v_mfma_f32_16x16x32_bf16 v[220:223], a[104:107], a[40:43], v[220:223]
 ds_read_b128 a[80:83], v4 offset:4096
 v_mfma_f32_16x16x32_bf16 v[220:223], a[108:111], a[44:47], v[220:223]
 v_mfma_f32_16x16x32_bf16 v[216:219], a[100:103], a[44:47], v[216:219]
 ds_read_b128 a[84:87], v5 offset:4096
 v_mfma_f32_16x16x32_bf16 v[216:219], a[96:99], a[40:43], v[216:219]
 s_add_u32 m0, s29, 126976
 v_mfma_f32_16x16x32_bf16 v[224:227], a[96:99], a[48:51], v[224:227]
 buffer_load_dwordx4 v2, s[8:11], s54 offen  lds
 v_mfma_f32_16x16x32_bf16 v[224:227], a[100:103], a[52:55], v[224:227]
 ds_read_b128 a[92:95], v5 offset:6144
 v_mfma_f32_16x16x32_bf16 v[228:231], a[108:111], a[52:55], v[228:231]
 v_mfma_f32_16x16x32_bf16 v[228:231], a[104:107], a[48:51], v[228:231]
 ds_read_b128 a[88:91], v4 offset:6144
 v_mfma_f32_16x16x32_bf16 v[232:235], a[112:115], a[48:51], v[232:235]
 s_add_u32 m0, s29, 61440
 v_mfma_f32_16x16x32_bf16 v[232:235], a[116:119], a[52:55], v[232:235]
 buffer_load_dwordx4 v1, s[4:7], s47 offen  lds
 v_mfma_f32_16x16x32_bf16 v[236:239], a[124:127], a[52:55], v[236:239]
 v_add_u32 v1, 128, v1
 v_add_u32 v2, 0x80000, v2
 v_mfma_f32_16x16x32_bf16 v[236:239], a[120:123], a[48:51], v[236:239]
 ds_read_b64_tr_b16 a[8:9], v7 offset:0
 v_mfma_f32_16x16x32_bf16 v[244:247], a[120:123], a[56:59], v[244:247]
 buffer_load_dword a243, v14, s[36:39], s56 offen
 v_mfma_f32_16x16x32_bf16 v[244:247], a[124:127], a[60:63], v[244:247]
 s_add_u32 s56, s56, s30
 ds_read_b64_tr_b16 a[10:11], v7 offset:4096
 v_mfma_f32_16x16x32_bf16 v[240:243], a[116:119], a[60:63], v[240:243]
 ds_read_b64_tr_b16 a[12:13], v7 offset:16384
 v_mfma_f32_16x16x32_bf16 v[240:243], a[112:115], a[56:59], v[240:243]
 ds_read_b64_tr_b16 a[14:15], v7 offset:20480
 v_mfma_f32_16x16x32_bf16 v[252:255], a[104:107], a[56:59], v[252:255]
 ds_read_b64_tr_b16 a[16:17], v8 offset:0
 v_mfma_f32_16x16x32_bf16 v[252:255], a[108:111], a[60:63], v[252:255]
 s_add_u32 s61, s61, 1
 ds_read_b64_tr_b16 a[18:19], v8 offset:4096
 v_mfma_f32_16x16x32_bf16 v[248:251], a[100:103], a[60:63], v[248:251]
 s_cmp_lt_u32 s61, s55
 ds_read_b64_tr_b16 a[20:21], v8 offset:16384
 v_mfma_f32_16x16x32_bf16 v[248:251], a[96:99], a[56:59], v[248:251]
 s_waitcnt lgkmcnt(8)
 ds_read_b64_tr_b16 a[22:23], v8 offset:20480
 s_cbranch_scc1 L_vloop
 s_cmp_lt_u32 s61, 6
 s_cbranch_scc1 L_vloop_side
 v_mfma_f32_16x16x32_bf16 v[64:67], a[64:67], a[0:3], v[64:67]
 ds_read_b64_tr_b16 a[24:25], v9 offset:0
 v_accvgpr_read_b32 v15, a240
 v_mfma_f32_16x16x32_bf16 v[64:67], a[68:71], a[4:7], v[64:67]
 ds_read_b64_tr_b16 a[26:27], v9 offset:4096
 v_accvgpr_read_b32 v14, a242
 v_mfma_f32_16x16x32_bf16 v[68:71], a[76:79], a[4:7], v[68:71]
 s_waitcnt lgkmcnt(12)
 ds_read_b64_tr_b16 a[28:29], v9 offset:16384
 v_xor_b32 v3, 64, v14
 v_mfma_f32_16x16x32_bf16 v[68:71], a[72:75], a[0:3], v[68:71]
 ds_read_b64_tr_b16 a[30:31], v9 offset:20480
 v_mfma_f32_16x16x32_bf16 v[72:75], a[80:83], a[0:3], v[72:75]
 s_add_u32 m0, s33, 0x0
 ds_read_b128 a[96:99], v4 offset:8192
 v_mfma_f32_16x16x32_bf16 v[72:75], a[84:87], a[4:7], v[72:75]
 s_waitcnt lgkmcnt(11)
 v_mfma_f32_16x16x32_bf16 v[76:79], a[92:95], a[4:7], v[76:79]
 ds_read_b128 a[100:103], v5 offset:8192
 buffer_load_dwordx4 v15, s[20:23], 0 offen offset:0 lds
 v_mfma_f32_16x16x32_bf16 v[76:79], a[88:91], a[0:3], v[76:79]
 v_mfma_f32_16x16x32_bf16 v[84:87], a[88:91], a[8:11], v[84:87]
 s_waitcnt lgkmcnt(10)
 ds_read_b128 a[108:111], v5 offset:10240
 v_mfma_f32_16x16x32_bf16 v[84:87], a[92:95], a[12:15], v[84:87]
 s_add_u32 m0, s33, 0x80
 v_mfma_f32_16x16x32_bf16 v[80:83], a[84:87], a[12:15], v[80:83]
 ds_read_b128 a[104:107], v4 offset:10240
 buffer_load_dwordx4 v15, s[20:23], 0 offen offset:896 lds
 v_mfma_f32_16x16x32_bf16 v[80:83], a[80:83], a[8:11], v[80:83]
 v_mfma_f32_16x16x32_bf16 v[92:95], a[72:75], a[8:11], v[92:95]
 ds_read_b128 a[112:115], v4 offset:12288
 v_mfma_f32_16x16x32_bf16 v[92:95], a[76:79], a[12:15], v[92:95]
 s_add_u32 m0, s33, 0x800
 v_mfma_f32_16x16x32_bf16 v[88:91], a[68:71], a[12:15], v[88:91]
 ds_read_b128 a[116:119], v5 offset:12288
 buffer_load_dwordx4 v15, s[20:23], s57 offen offset:0 lds
 v_mfma_f32_16x16x32_bf16 v[88:91], a[64:67], a[8:11], v[88:91]
 s_waitcnt lgkmcnt(10)
 v_mfma_f32_16x16x32_bf16 v[96:99], a[64:67], a[16:19], v[96:99]
 ds_read_b128 a[124:127], v5 offset:14336
 v_mfma_f32_16x16x32_bf16 v[96:99], a[68:71], a[20:23], v[96:99]
 s_add_u32 m0, s33, 0x880
 v_mfma_f32_16x16x32_bf16 v[100:103], a[76:79], a[20:23], v[100:103]
 ds_read_b128 a[120:123], v4 offset:14336
 buffer_load_dwordx4 v15, s[20:23], s57 offen offset:896 lds
 v_mfma_f32_16x16x32_bf16 v[100:103], a[72:75], a[16:19], v[100:103]
 v_mfma_f32_16x16x32_bf16 v[104:107], a[80:83], a[16:19], v[104:107]
 ds_read_b64_tr_b16 a[32:33], v10 offset:0
 v_mfma_f32_16x16x32_bf16 v[104:107], a[84:87], a[20:23], v[104:107]
 s_add_u32 m0, s33, 0xf80
 ds_read_b64_tr_b16 a[34:35], v10 offset:4096
 v_mfma_f32_16x16x32_bf16 v[108:111], a[92:95], a[20:23], v[108:111]
 ds_read_b64_tr_b16 a[36:37], v10 offset:16384
 buffer_load_dwordx4 v15, s[20:23], 0 offen offset:128 lds
 v_mfma_f32_16x16x32_bf16 v[108:111], a[88:91], a[16:19], v[108:111]
 s_waitcnt lgkmcnt(11)
 ds_read_b64_tr_b16 a[38:39], v10 offset:20480
 v_mfma_f32_16x16x32_bf16 v[116:119], a[88:91], a[24:27], v[116:119]
 ds_read_b64_tr_b16 a[40:41], v11 offset:0
 v_mfma_f32_16x16x32_bf16 v[116:119], a[92:95], a[28:31], v[116:119]
 s_add_u32 m0, s33, 0x1000
 ds_read_b64_tr_b16 a[42:43], v11 offset:4096
 v_mfma_f32_16x16x32_bf16 v[112:115], a[84:87], a[28:31], v[112:115]
 ds_read_b64_tr_b16 a[44:45], v11 offset:16384
 buffer_load_dwordx4 v15, s[20:23], 0 offen offset:1024 lds
 v_mfma_f32_16x16x32_bf16 v[112:115], a[80:83], a[24:27], v[112:115]
 ds_read_b64_tr_b16 a[46:47], v11 offset:20480
 v_mfma_f32_16x16x32_bf16 v[124:127], a[72:75], a[24:27], v[124:127]
 ds_read_b64_tr_b16 a[48:49], v12 offset:0
 v_mfma_f32_16x16x32_bf16 v[124:127], a[76:79], a[28:31], v[124:127]
 s_add_u32 m0, s33, 0x1780
 ds_read_b64_tr_b16 a[50:51], v12 offset:4096
 v_mfma_f32_16x16x32_bf16 v[120:123], a[68:71], a[28:31], v[120:123]
 ds_read_b64_tr_b16 a[52:53], v12 offset:16384
 buffer_load_dwordx4 v15, s[20:23], s57 offen offset:128 lds
 v_mfma_f32_16x16x32_bf16 v[120:123], a[64:67], a[24:27], v[120:123]
 s_waitcnt lgkmcnt(15)
 ds_read_b64_tr_b16 a[54:55], v12 offset:20480
 v_mfma_f32_16x16x32_bf16 v[16:19], a[96:99], a[0:3], v[16:19]
 ds_read_b64_tr_b16 a[56:57], v13 offset:0
 v_mfma_f32_16x16x32_bf16 v[16:19], a[100:103], a[4:7], v[16:19]
 s_add_u32 m0, s33, 0x1800
 ds_read_b64_tr_b16 a[58:59], v13 offset:4096
 v_mfma_f32_16x16x32_bf16 v[20:23], a[108:111], a[4:7], v[20:23]
 ds_read_b64_tr_b16 a[60:61], v13 offset:16384
 buffer_load_dwordx4 v15, s[20:23], s57 offen offset:1024 lds
 v_mfma_f32_16x16x32_bf16 v[20:23], a[104:107], a[0:3], v[20:23]
 s_waitcnt lgkmcnt(15)
 ds_read_b64_tr_b16 a[62:63], v13 offset:20480
 v_mfma_f32_16x16x32_bf16 v[24:27], a[112:115], a[0:3], v[24:27]
 v_mfma_f32_16x16x32_bf16 v[24:27], a[116:119], a[4:7], v[24:27]
 v_mfma_f32_16x16x32_bf16 v[28:31], a[124:127], a[4:7], v[28:31]
 v_mfma_f32_16x16x32_bf16 v[28:31], a[120:123], a[0:3], v[28:31]
 s_waitcnt lgkmcnt(0)
 v_mfma_f32_16x16x32_bf16 a[228:231], a[120:123], a[8:11], a[228:231]
 s_barrier
 v_mfma_f32_16x16x32_bf16 a[228:231], a[124:127], a[12:15], a[228:231]
 s_add_u32 m0, s29, 65536
 v_mfma_f32_16x16x32_bf16 a[224:227], a[116:119], a[12:15], a[224:227]
 buffer_load_dwordx4 v2, s[8:11], 0 offen  lds
 v_mfma_f32_16x16x32_bf16 a[224:227], a[112:115], a[8:11], a[224:227]
 v_mfma_f32_16x16x32_bf16 a[236:239], a[104:107], a[8:11], a[236:239]
 v_mfma_f32_16x16x32_bf16 a[236:239], a[108:111], a[12:15], a[236:239]
 v_mfma_f32_16x16x32_bf16 a[232:235], a[100:103], a[12:15], a[232:235]
 s_add_u32 m0, s29, 0
 v_mfma_f32_16x16x32_bf16 a[232:235], a[96:99], a[8:11], a[232:235]
 buffer_load_dwordx4 v1, s[4:7], 0 offen  lds
 v_mfma_f32_16x16x32_bf16 v[32:35], a[96:99], a[16:19], v[32:35]
 v_mfma_f32_16x16x32_bf16 v[32:35], a[100:103], a[20:23], v[32:35]
 v_mfma_f32_16x16x32_bf16 v[36:39], a[108:111], a[20:23], v[36:39]
 v_mfma_f32_16x16x32_bf16 v[36:39], a[104:107], a[16:19], v[36:39]
 s_add_u32 m0, s29, 69632
 v_mfma_f32_16x16x32_bf16 v[40:43], a[112:115], a[16:19], v[40:43]
 buffer_load_dwordx4 v2, s[8:11], s48 offen  lds
 v_mfma_f32_16x16x32_bf16 v[40:43], a[116:119], a[20:23], v[40:43]
 v_mfma_f32_16x16x32_bf16 v[44:47], a[124:127], a[20:23], v[44:47]
 v_mfma_f32_16x16x32_bf16 v[44:47], a[120:123], a[16:19], v[44:47]
 v_mfma_f32_16x16x32_bf16 v[52:55], a[120:123], a[24:27], v[52:55]
 s_add_u32 m0, s29, 4096
 v_mfma_f32_16x16x32_bf16 v[52:55], a[124:127], a[28:31], v[52:55]
 buffer_load_dwordx4 v1, s[4:7], s41 offen  lds
 v_mfma_f32_16x16x32_bf16 v[48:51], a[116:119], a[28:31], v[48:51]
 v_mfma_f32_16x16x32_bf16 v[48:51], a[112:115], a[24:27], v[48:51]
 v_mfma_f32_16x16x32_bf16 v[60:63], a[104:107], a[24:27], v[60:63]
 v_mfma_f32_16x16x32_bf16 v[60:63], a[108:111], a[28:31], v[60:63]
 s_add_u32 m0, s29, 73728
 v_mfma_f32_16x16x32_bf16 v[56:59], a[100:103], a[28:31], v[56:59]
 buffer_load_dwordx4 v2, s[8:11], s49 offen  lds
 v_mfma_f32_16x16x32_bf16 v[56:59], a[96:99], a[24:27], v[56:59]
 v_mfma_f32_16x16x32_bf16 v[192:195], a[96:99], a[32:35], v[192:195]
 v_mfma_f32_16x16x32_bf16 v[192:195], a[100:103], a[36:39], v[192:195]
 v_mfma_f32_16x16x32_bf16 v[196:199], a[108:111], a[36:39], v[196:199]
 s_add_u32 m0, s29, 8192
 v_mfma_f32_16x16x32_bf16 v[196:199], a[104:107], a[32:35], v[196:199]
 buffer_load_dwordx4 v1, s[4:7], s42 offen  lds
 v_mfma_f32_16x16x32_bf16 v[200:203], a[112:115], a[32:35], v[200:203]
 v_mfma_f32_16x16x32_bf16 v[200:203], a[116:119], a[36:39], v[200:203]
 v_mfma_f32_16x16x32_bf16 v[204:207], a[124:127], a[36:39], v[204:207]
 v_mfma_f32_16x16x32_bf16 v[204:207], a[120:123], a[32:35], v[204:207]
 s_add_u32 m0, s29, 77824
 v_mfma_f32_16x16x32_bf16 v[212:215], a[120:123], a[40:43], v[212:215]
 buffer_load_dwordx4 v2, s[8:11], s50 offen  lds
 v_mfma_f32_16x16x32_bf16 v[212:215], a[124:127], a[44:47], v[212:215]
 v_mfma_f32_16x16x32_bf16 v[208:211], a[116:119], a[44:47], v[208:211]
 v_mfma_f32_16x16x32_bf16 v[208:211], a[112:115], a[40:43], v[208:211]
 v_mfma_f32_16x16x32_bf16 v[220:223], a[104:107], a[40:43], v[220:223]
 s_add_u32 m0, s29, 12288
 v_mfma_f32_16x16x32_bf16 v[220:223], a[108:111], a[44:47], v[220:223]
 buffer_load_dwordx4 v1, s[4:7], s43 offen  lds
 v_mfma_f32_16x16x32_bf16 v[216:219], a[100:103], a[44:47], v[216:219]
 v_mfma_f32_16x16x32_bf16 v[216:219], a[96:99], a[40:43], v[216:219]
 v_mfma_f32_16x16x32_bf16 v[224:227], a[96:99], a[48:51], v[224:227]
 v_mfma_f32_16x16x32_bf16 v[224:227], a[100:103], a[52:55], v[224:227]
 s_add_u32 m0, s29, 81920
 v_mfma_f32_16x16x32_bf16 v[228:231], a[108:111], a[52:55], v[228:231]
 buffer_load_dwordx4 v2, s[8:11], s51 offen  lds
 v_mfma_f32_16x16x32_bf16 v[228:231], a[104:107], a[48:51], v[228:231]
 v_mfma_f32_16x16x32_bf16 v[232:235], a[112:115], a[48:51], v[232:235]
 v_mfma_f32_16x16x32_bf16 v[232:235], a[116:119], a[52:55], v[232:235]
 v_mfma_f32_16x16x32_bf16 v[236:239], a[124:127], a[52:55], v[236:239]
 s_add_u32 m0, s29, 16384
 v_mfma_f32_16x16x32_bf16 v[236:239], a[120:123], a[48:51], v[236:239]
 buffer_load_dwordx4 v1, s[4:7], s44 offen  lds
 v_mfma_f32_16x16x32_bf16 v[244:247], a[120:123], a[56:59], v[244:247]
 v_mfma_f32_16x16x32_bf16 v[244:247], a[124:127], a[60:63], v[244:247]
 v_mfma_f32_16x16x32_bf16 v[240:243], a[116:119], a[60:63], v[240:243]
 v_mfma_f32_16x16x32_bf16 v[240:243], a[112:115], a[56:59], v[240:243]
 s_add_u32 m0, s29, 86016
 v_mfma_f32_16x16x32_bf16 v[252:255], a[104:107], a[56:59], v[252:255]
 s_waitcnt vmcnt(10)
 buffer_load_dwordx4 v2, s[8:11], s52 offen  lds
 v_mfma_f32_16x16x32_bf16 v[252:255], a[108:111], a[60:63], v[252:255]
 s_barrier
 ds_read_b64_tr_b16 a[0:1], v6 offset:32768
 v_mfma_f32_16x16x32_bf16 v[248:251], a[100:103], a[60:63], v[248:251]
 ds_read_b64_tr_b16 a[2:3], v6 offset:36864
 v_mfma_f32_16x16x32_bf16 v[248:251], a[96:99], a[56:59], v[248:251]
 ds_read_b128 a[96:99], v4 offset:40960
 v_mfma_f32_16x16x32_bf16 v[128:131], a[64:67], a[32:35], v[128:131]
 s_add_u32 m0, s29, 20480
 ds_read_b128 a[128:131], v14 offset:0
 v_mfma_f32_16x16x32_bf16 v[128:131], a[68:71], a[36:39], v[128:131]
 buffer_load_dwordx4 v1, s[4:7], s45 offen  lds
 v_mfma_f32_16x16x32_bf16 v[132:135], a[76:79], a[36:39], v[132:135]
 ds_read_b64_tr_b16 a[4:5], v6 offset:49152
 v_mfma_f32_16x16x32_bf16 v[132:135], a[72:75], a[32:35], v[132:135]
 ds_read_b64_tr_b16 a[6:7], v6 offset:53248
 v_mfma_f32_16x16x32_bf16 v[136:139], a[80:83], a[32:35], v[136:139]
 ds_read_b128 a[100:103], v5 offset:40960
 v_mfma_f32_16x16x32_bf16 v[136:139], a[84:87], a[36:39], v[136:139]
 s_add_u32 m0, s29, 90112
 ds_read_b128 a[136:139], v3 offset:0
 v_mfma_f32_16x16x32_bf16 v[140:143], a[92:95], a[36:39], v[140:143]
 buffer_load_dwordx4 v2, s[8:11], s53 offen  lds
 v_mfma_f32_16x16x32_bf16 v[140:143], a[88:91], a[32:35], v[140:143]
 ds_read_b128 a[108:111], v5 offset:43008
 v_mfma_f32_16x16x32_bf16 v[148:151], a[88:91], a[40:43], v[148:151]
 ds_read_b128 a[132:135], v14 offset:2048
 v_mfma_f32_16x16x32_bf16 v[148:151], a[92:95], a[44:47], v[148:151]
 ds_read_b128 a[104:107], v4 offset:43008
 v_mfma_f32_16x16x32_bf16 v[144:147], a[84:87], a[44:47], v[144:147]
 s_add_u32 m0, s29, 24576
 ds_read_b128 a[140:143], v3 offset:2048
 v_mfma_f32_16x16x32_bf16 v[144:147], a[80:83], a[40:43], v[144:147]
 buffer_load_dwordx4 v1, s[4:7], s46 offen  lds
 v_mfma_f32_16x16x32_bf16 v[156:159], a[72:75], a[40:43], v[156:159]
 ds_read_b128 a[112:115], v4 offset:45056
 v_mfma_f32_16x16x32_bf16 v[156:159], a[76:79], a[44:47], v[156:159]
 ds_read_b128 a[144:147], v14 offset:4096
 v_mfma_f32_16x16x32_bf16 v[152:155], a[68:71], a[44:47], v[152:155]
 ds_read_b128 a[116:119], v5 offset:45056
 v_mfma_f32_16x16x32_bf16 v[152:155], a[64:67], a[40:43], v[152:155]
 s_add_u32 m0, s29, 94208
 ds_read_b128 a[152:155], v3 offset:4096
 v_mfma_f32_16x16x32_bf16 v[160:163], a[64:67], a[48:51], v[160:163]
 buffer_load_dwordx4 v2, s[8:11], s54 offen  lds
 v_mfma_f32_16x16x32_bf16 v[160:163], a[68:71], a[52:55], v[160:163]
 ds_read_b128 a[124:127], v5 offset:47104
 v_mfma_f32_16x16x32_bf16 v[164:167], a[76:79], a[52:55], v[164:167]
 ds_read_b128 a[148:151], v14 offset:6144
 v_mfma_f32_16x16x32_bf16 v[164:167], a[72:75], a[48:51], v[164:167]
 ds_read_b128 a[120:123], v4 offset:47104
 v_mfma_f32_16x16x32_bf16 v[168:171], a[80:83], a[48:51], v[168:171]
 s_add_u32 m0, s29, 28672
 ds_read_b128 a[156:159], v3 offset:6144
 v_mfma_f32_16x16x32_bf16 v[168:171], a[84:87], a[52:55], v[168:171]
 buffer_load_dwordx4 v1, s[4:7], s47 offen  lds
 v_mfma_f32_16x16x32_bf16 v[172:175], a[92:95], a[52:55], v[172:175]
 v_add_u32 v1, 128, v1
 v_add_u32 v2, 0x80000, v2
 v_mfma_f32_16x16x32_bf16 v[172:175], a[88:91], a[48:51], v[172:175]
 ds_read_b64_tr_b16 a[8:9], v7 offset:32768
 v_mfma_f32_16x16x32_bf16 v[180:183], a[88:91], a[56:59], v[180:183]
 v_mfma_f32_16x16x32_bf16 v[180:183], a[92:95], a[60:63], v[180:183]
 ds_read_b64_tr_b16 a[10:11], v7 offset:36864
 v_mfma_f32_16x16x32_bf16 v[176:179], a[84:87], a[60:63], v[176:179]
 ds_read_b64_tr_b16 a[12:13], v7 offset:49152
 v_mfma_f32_16x16x32_bf16 v[176:179], a[80:83], a[56:59], v[176:179]
 ds_read_b64_tr_b16 a[14:15], v7 offset:53248
 v_mfma_f32_16x16x32_bf16 v[188:191], a[72:75], a[56:59], v[188:191]
 ds_read_b64_tr_b16 a[16:17], v8 offset:32768
 v_mfma_f32_16x16x32_bf16 v[188:191], a[76:79], a[60:63], v[188:191]
 ds_read_b64_tr_b16 a[18:19], v8 offset:36864
 v_mfma_f32_16x16x32_bf16 v[184:187], a[68:71], a[60:63], v[184:187]
 ds_read_b64_tr_b16 a[20:21], v8 offset:49152
 v_mfma_f32_16x16x32_bf16 v[184:187], a[64:67], a[56:59], v[184:187]
 s_waitcnt lgkmcnt(15)
 ds_read_b64_tr_b16 a[22:23], v8 offset:53248
 v_mfma_f32_16x16x32_bf16 v[16:19], a[96:99], a[0:3], v[16:19]
 ds_read_b64_tr_b16 a[24:25], v9 offset:32768
 v_mfma_f32_16x16x32_bf16 v[16:19], a[100:103], a[4:7], v[16:19]
 s_add_u32 m0, s33, 0xffffff00
 ds_read_b64_tr_b16 a[26:27], v9 offset:36864
 v_mfma_f32_16x16x32_bf16 v[20:23], a[108:111], a[4:7], v[20:23]
 s_waitcnt lgkmcnt(10)
 ds_read_b64_tr_b16 a[28:29], v9 offset:49152
 v_mfma_f32_16x16x32_bf16 v[20:23], a[104:107], a[0:3], v[20:23]
 ds_read_b64_tr_b16 a[30:31], v9 offset:53248
 buffer_load_dwordx4 v15, s[20:23], 0 offen offset:256 lds
 v_mfma_f32_16x16x32_bf16 v[24:27], a[112:115], a[0:3], v[24:27]
 ds_read_b128 a[64:67], v4 offset:32768
 v_mfma_f32_16x16x32_bf16 v[24:27], a[116:119], a[4:7], v[24:27]
 v_mfma_f32_16x16x32_bf16 v[28:31], a[124:127], a[4:7], v[28:31]
 s_add_u32 m0, s33, 0xffffff80
 ds_read_b128 a[68:71], v5 offset:32768
 v_mfma_f32_16x16x32_bf16 v[28:31], a[120:123], a[0:3], v[28:31]
 s_waitcnt lgkmcnt(10)
 buffer_load_dwordx4 v15, s[20:23], 0 offen offset:1152 lds
 v_mfma_f32_16x16x32_bf16 a[228:231], a[120:123], a[8:11], a[228:231]
 ds_read_b128 a[76:79], v5 offset:34816
 v_mfma_f32_16x16x32_bf16 a[228:231], a[124:127], a[12:15], a[228:231]
 v_mfma_f32_16x16x32_bf16 a[224:227], a[116:119], a[12:15], a[224:227]
 s_add_u32 m0, s33, 0x700
 ds_read_b128 a[72:75], v4 offset:34816
 v_mfma_f32_16x16x32_bf16 a[224:227], a[112:115], a[8:11], a[224:227]
 buffer_load_dwordx4 v15, s[20:23], s57 offen offset:256 lds
 v_mfma_f32_16x16x32_bf16 a[236:239], a[104:107], a[8:11], a[236:239]
 ds_read_b128 a[80:83], v4 offset:36864
 v_mfma_f32_16x16x32_bf16 a[236:239], a[108:111], a[12:15], a[236:239]
 v_mfma_f32_16x16x32_bf16 a[232:235], a[100:103], a[12:15], a[232:235]
 s_add_u32 m0, s33, 0x780
 ds_read_b128 a[84:87], v5 offset:36864
 v_mfma_f32_16x16x32_bf16 a[232:235], a[96:99], a[8:11], a[232:235]
 s_waitcnt lgkmcnt(10)
 buffer_load_dwordx4 v15, s[20:23], s57 offen offset:1152 lds
 v_mfma_f32_16x16x32_bf16 v[32:35], a[96:99], a[16:19], v[32:35]
 ds_read_b128 a[92:95], v5 offset:38912
 v_mfma_f32_16x16x32_bf16 v[32:35], a[100:103], a[20:23], v[32:35]
 v_mfma_f32_16x16x32_bf16 v[36:39], a[108:111], a[20:23], v[36:39]
 s_add_u32 m0, s33, 0xe80
 ds_read_b128 a[88:91], v4 offset:38912
 v_mfma_f32_16x16x32_bf16 v[36:39], a[104:107], a[16:19], v[36:39]
 buffer_load_dwordx4 v15, s[20:23], 0 offen offset:384 lds
 v_mfma_f32_16x16x32_bf16 v[40:43], a[112:115], a[16:19], v[40:43]
 ds_read_b64_tr_b16 a[32:33], v10 offset:32768
 v_mfma_f32_16x16x32_bf16 v[40:43], a[116:119], a[20:23], v[40:43]
 ds_read_b64_tr_b16 a[34:35], v10 offset:36864
 v_mfma_f32_16x16x32_bf16 v[44:47], a[124:127], a[20:23], v[44:47]
 s_add_u32 m0, s33, 0xf00
 ds_read_b64_tr_b16 a[36:37], v10 offset:49152
 v_mfma_f32_16x16x32_bf16 v[44:47], a[120:123], a[16:19], v[44:47]
 s_waitcnt lgkmcnt(11)
 ds_read_b64_tr_b16 a[38:39], v10 offset:53248
 buffer_load_dwordx4 v15, s[20:23], 0 offen offset:1280 lds
 v_mfma_f32_16x16x32_bf16 v[52:55], a[120:123], a[24:27], v[52:55]
 ds_read_b64_tr_b16 a[40:41], v11 offset:32768
 v_mfma_f32_16x16x32_bf16 v[52:55], a[124:127], a[28:31], v[52:55]
 ds_read_b64_tr_b16 a[42:43], v11 offset:36864
 v_mfma_f32_16x16x32_bf16 v[48:51], a[116:119], a[28:31], v[48:51]
 s_add_u32 m0, s33, 0x1680
 ds_read_b64_tr_b16 a[44:45], v11 offset:49152
 v_mfma_f32_16x16x32_bf16 v[48:51], a[112:115], a[24:27], v[48:51]
 ds_read_b64_tr_b16 a[46:47], v11 offset:53248
 buffer_load_dwordx4 v15, s[20:23], s57 offen offset:384 lds
 v_mfma_f32_16x16x32_bf16 v[60:63], a[104:107], a[24:27], v[60:63]
 ds_read_b64_tr_b16 a[48:49], v12 offset:32768
 v_mfma_f32_16x16x32_bf16 v[60:63], a[108:111], a[28:31], v[60:63]
 ds_read_b64_tr_b16 a[50:51], v12 offset:36864
 v_mfma_f32_16x16x32_bf16 v[56:59], a[100:103], a[28:31], v[56:59]
 s_add_u32 m0, s33, 0x1700
 ds_read_b64_tr_b16 a[52:53], v12 offset:49152
 v_mfma_f32_16x16x32_bf16 v[56:59], a[96:99], a[24:27], v[56:59]
 s_waitcnt lgkmcnt(15)
 ds_read_b64_tr_b16 a[54:55], v12 offset:53248
 buffer_load_dwordx4 v15, s[20:23], s57 offen offset:1280 lds
 v_mfma_f32_16x16x32_bf16 v[64:67], a[64:67], a[0:3], v[64:67]
 ds_read_b64_tr_b16 a[56:57], v13 offset:32768
 v_mfma_f32_16x16x32_bf16 v[64:67], a[68:71], a[4:7], v[64:67]
 ds_read_b64_tr_b16 a[58:59], v13 offset:36864
 v_mfma_f32_16x16x32_bf16 v[68:71], a[76:79], a[4:7], v[68:71]
 ds_read_b64_tr_b16 a[60:61], v13 offset:49152
 v_mfma_f32_16x16x32_bf16 v[68:71], a[72:75], a[0:3], v[68:71]
 s_waitcnt lgkmcnt(15)
 ds_read_b64_tr_b16 a[62:63], v13 offset:53248
 v_mfma_f32_16x16x32_bf16 v[72:75], a[80:83], a[0:3], v[72:75]
 v_mfma_f32_16x16x32_bf16 v[72:75], a[84:87], a[4:7], v[72:75]
 v_mfma_f32_16x16x32_bf16 v[76:79], a[92:95], a[4:7], v[76:79]
 v_mfma_f32_16x16x32_bf16 v[76:79], a[88:91], a[0:3], v[76:79]
 s_waitcnt lgkmcnt(0)
 v_mfma_f32_16x16x32_bf16 v[84:87], a[88:91], a[8:11], v[84:87]
 s_barrier
 v_mfma_f32_16x16x32_bf16 v[84:87], a[92:95], a[12:15], v[84:87]
 s_add_u32 m0, s29, 98304
 v_mfma_f32_16x16x32_bf16 v[80:83], a[84:87], a[12:15], v[80:83]
 buffer_load_dwordx4 v2, s[8:11], 0 offen  lds
 v_mfma_f32_16x16x32_bf16 v[80:83], a[80:83], a[8:11], v[80:83]
 v_mfma_f32_16x16x32_bf16 v[92:95], a[72:75], a[8:11], v[92:95]
 v_mfma_f32_16x16x32_bf16 v[92:95], a[76:79], a[12:15], v[92:95]
 v_mfma_f32_16x16x32_bf16 v[88:91], a[68:71], a[12:15], v[88:91]
 s_add_u32 m0, s29, 32768
 v_mfma_f32_16x16x32_bf16 v[88:91], a[64:67], a[8:11], v[88:91]
 buffer_load_dwordx4 v1, s[4:7], 0 offen  lds
 v_mfma_f32_16x16x32_bf16 v[96:99], a[64:67], a[16:19], v[96:99]
 v_mfma_f32_16x16x32_bf16 v[96:99], a[68:71], a[20:23], v[96:99]
 v_mfma_f32_16x16x32_bf16 v[100:103], a[76:79], a[20:23], v[100:103]
 v_mfma_f32_16x16x32_bf16 v[100:103], a[72:75], a[16:19], v[100:103]
 s_add_u32 m0, s29, 102400
 v_mfma_f32_16x16x32_bf16 v[104:107], a[80:83], a[16:19], v[104:107]
 buffer_load_dwordx4 v2, s[8:11], s48 offen  lds
 v_mfma_f32_16x16x32_bf16 v[104:107], a[84:87], a[20:23], v[104:107]
 v_mfma_f32_16x16x32_bf16 v[108:111], a[92:95], a[20:23], v[108:111]
 v_mfma_f32_16x16x32_bf16 v[108:111], a[88:91], a[16:19], v[108:111]
 v_mfma_f32_16x16x32_bf16 v[116:119], a[88:91], a[24:27], v[116:119]
 s_add_u32 m0, s29, 36864
 v_mfma_f32_16x16x32_bf16 v[116:119], a[92:95], a[28:31], v[116:119]
 buffer_load_dwordx4 v1, s[4:7], s41 offen  lds
 v_mfma_f32_16x16x32_bf16 v[112:115], a[84:87], a[28:31], v[112:115]
 v_mfma_f32_16x16x32_bf16 v[112:115], a[80:83], a[24:27], v[112:115]
 v_mfma_f32_16x16x32_bf16 v[124:127], a[72:75], a[24:27], v[124:127]
 v_mfma_f32_16x16x32_bf16 v[124:127], a[76:79], a[28:31], v[124:127]
 s_add_u32 m0, s29, 106496
 v_mfma_f32_16x16x32_bf16 v[120:123], a[68:71], a[28:31], v[120:123]
 buffer_load_dwordx4 v2, s[8:11], s49 offen  lds
 v_mfma_f32_16x16x32_bf16 v[120:123], a[64:67], a[24:27], v[120:123]
 v_mfma_f32_16x16x32_bf16 v[128:131], a[64:67], a[32:35], v[128:131]
 v_mfma_f32_16x16x32_bf16 v[128:131], a[68:71], a[36:39], v[128:131]
 v_mfma_f32_16x16x32_bf16 v[132:135], a[76:79], a[36:39], v[132:135]
 s_add_u32 m0, s29, 40960
 v_mfma_f32_16x16x32_bf16 v[132:135], a[72:75], a[32:35], v[132:135]
 buffer_load_dwordx4 v1, s[4:7], s42 offen  lds
 v_mfma_f32_16x16x32_bf16 v[136:139], a[80:83], a[32:35], v[136:139]
 v_mfma_f32_16x16x32_bf16 v[136:139], a[84:87], a[36:39], v[136:139]
 v_mfma_f32_16x16x32_bf16 v[140:143], a[92:95], a[36:39], v[140:143]
 v_mfma_f32_16x16x32_bf16 v[140:143], a[88:91], a[32:35], v[140:143]
 s_add_u32 m0, s29, 110592
 v_mfma_f32_16x16x32_bf16 v[148:151], a[88:91], a[40:43], v[148:151]
 buffer_load_dwordx4 v2, s[8:11], s50 offen  lds
 v_mfma_f32_16x16x32_bf16 v[148:151], a[92:95], a[44:47], v[148:151]
 v_mfma_f32_16x16x32_bf16 v[144:147], a[84:87], a[44:47], v[144:147]
 v_mfma_f32_16x16x32_bf16 v[144:147], a[80:83], a[40:43], v[144:147]
 v_mfma_f32_16x16x32_bf16 v[156:159], a[72:75], a[40:43], v[156:159]
 s_add_u32 m0, s29, 45056
 v_mfma_f32_16x16x32_bf16 v[156:159], a[76:79], a[44:47], v[156:159]
 buffer_load_dwordx4 v1, s[4:7], s43 offen  lds
 v_mfma_f32_16x16x32_bf16 v[152:155], a[68:71], a[44:47], v[152:155]
 v_mfma_f32_16x16x32_bf16 v[152:155], a[64:67], a[40:43], v[152:155]
 v_mfma_f32_16x16x32_bf16 v[160:163], a[64:67], a[48:51], v[160:163]
 v_mfma_f32_16x16x32_bf16 v[160:163], a[68:71], a[52:55], v[160:163]
 s_add_u32 m0, s29, 114688
 v_mfma_f32_16x16x32_bf16 v[164:167], a[76:79], a[52:55], v[164:167]
 buffer_load_dwordx4 v2, s[8:11], s51 offen  lds
 v_mfma_f32_16x16x32_bf16 v[164:167], a[72:75], a[48:51], v[164:167]
 v_mfma_f32_16x16x32_bf16 v[168:171], a[80:83], a[48:51], v[168:171]
 v_mfma_f32_16x16x32_bf16 v[168:171], a[84:87], a[52:55], v[168:171]
 v_mfma_f32_16x16x32_bf16 v[172:175], a[92:95], a[52:55], v[172:175]
 s_add_u32 m0, s29, 49152
 v_mfma_f32_16x16x32_bf16 v[172:175], a[88:91], a[48:51], v[172:175]
 buffer_load_dwordx4 v1, s[4:7], s44 offen  lds
 v_mfma_f32_16x16x32_bf16 v[180:183], a[88:91], a[56:59], v[180:183]
 v_mfma_f32_16x16x32_bf16 v[180:183], a[92:95], a[60:63], v[180:183]
 v_mfma_f32_16x16x32_bf16 v[176:179], a[84:87], a[60:63], v[176:179]
 v_mfma_f32_16x16x32_bf16 v[176:179], a[80:83], a[56:59], v[176:179]
 s_add_u32 m0, s29, 118784
 v_mfma_f32_16x16x32_bf16 v[188:191], a[72:75], a[56:59], v[188:191]
 s_waitcnt vmcnt(10)
 buffer_load_dwordx4 v2, s[8:11], s52 offen  lds
 v_mfma_f32_16x16x32_bf16 v[188:191], a[76:79], a[60:63], v[188:191]
 s_barrier
 ds_read_b64_tr_b16 a[0:1], v6 offset:0
 v_mfma_f32_16x16x32_bf16 v[184:187], a[68:71], a[60:63], v[184:187]
 ds_read_b64_tr_b16 a[2:3], v6 offset:4096
 v_mfma_f32_16x16x32_bf16 v[184:187], a[64:67], a[56:59], v[184:187]
 ds_read_b128 a[64:67], v4 offset:0
 v_mfma_f32_16x16x32_bf16 v[192:195], a[96:99], a[32:35], v[192:195]
 s_add_u32 m0, s29, 53248
 ds_read_b128 a[160:163], v14 offset:0
 v_mfma_f32_16x16x32_bf16 v[192:195], a[100:103], a[36:39], v[192:195]
 buffer_load_dwordx4 v1, s[4:7], s45 offen  lds
 v_mfma_f32_16x16x32_bf16 v[196:199], a[108:111], a[36:39], v[196:199]
 ds_read_b64_tr_b16 a[4:5], v6 offset:16384
 v_mfma_f32_16x16x32_bf16 v[196:199], a[104:107], a[32:35], v[196:199]
 ds_read_b64_tr_b16 a[6:7], v6 offset:20480
 v_mfma_f32_16x16x32_bf16 v[200:203], a[112:115], a[32:35], v[200:203]
 ds_read_b128 a[68:71], v5 offset:0
 v_mfma_f32_16x16x32_bf16 v[200:203], a[116:119], a[36:39], v[200:203]
 s_add_u32 m0, s29, 122880
 ds_read_b128 a[168:171], v3 offset:0
 v_mfma_f32_16x16x32_bf16 v[204:207], a[124:127], a[36:39], v[204:207]
 buffer_load_dwordx4 v2, s[8:11], s53 offen  lds
 v_mfma_f32_16x16x32_bf16 v[204:207], a[120:123], a[32:35], v[204:207]
 ds_read_b128 a[76:79], v5 offset:2048
 v_mfma_f32_16x16x32_bf16 v[212:215], a[120:123], a[40:43], v[212:215]
 ds_read_b128 a[164:167], v14 offset:2048
 v_mfma_f32_16x16x32_bf16 v[212:215], a[124:127], a[44:47], v[212:215]
 ds_read_b128 a[72:75], v4 offset:2048
 v_mfma_f32_16x16x32_bf16 v[208:211], a[116:119], a[44:47], v[208:211]
 s_add_u32 m0, s29, 57344
 ds_read_b128 a[172:175], v3 offset:2048
 v_mfma_f32_16x16x32_bf16 v[208:211], a[112:115], a[40:43], v[208:211]
 buffer_load_dwordx4 v1, s[4:7], s46 offen  lds
 v_mfma_f32_16x16x32_bf16 v[220:223], a[104:107], a[40:43], v[220:223]
 ds_read_b128 a[80:83], v4 offset:4096
 v_mfma_f32_16x16x32_bf16 v[220:223], a[108:111], a[44:47], v[220:223]
 ds_read_b128 a[176:179], v14 offset:4096
 v_mfma_f32_16x16x32_bf16 v[216:219], a[100:103], a[44:47], v[216:219]
 ds_read_b128 a[84:87], v5 offset:4096
 v_mfma_f32_16x16x32_bf16 v[216:219], a[96:99], a[40:43], v[216:219]
 s_add_u32 m0, s29, 126976
 ds_read_b128 a[184:187], v3 offset:4096
 v_mfma_f32_16x16x32_bf16 v[224:227], a[96:99], a[48:51], v[224:227]
 buffer_load_dwordx4 v2, s[8:11], s54 offen  lds
 v_mfma_f32_16x16x32_bf16 v[224:227], a[100:103], a[52:55], v[224:227]
 ds_read_b128 a[92:95], v5 offset:6144
 v_mfma_f32_16x16x32_bf16 v[228:231], a[108:111], a[52:55], v[228:231]
 ds_read_b128 a[180:183], v14 offset:6144
 v_mfma_f32_16x16x32_bf16 v[228:231], a[104:107], a[48:51], v[228:231]
 ds_read_b128 a[88:91], v4 offset:6144
 v_mfma_f32_16x16x32_bf16 v[232:235], a[112:115], a[48:51], v[232:235]
 s_add_u32 m0, s29, 61440
 ds_read_b128 a[188:191], v3 offset:6144
 v_mfma_f32_16x16x32_bf16 v[232:235], a[116:119], a[52:55], v[232:235]
 buffer_load_dwordx4 v1, s[4:7], s47 offen  lds
 v_mfma_f32_16x16x32_bf16 v[236:239], a[124:127], a[52:55], v[236:239]
 v_add_u32 v1, 128, v1
 v_add_u32 v2, 0x80000, v2
 v_mfma_f32_16x16x32_bf16 v[236:239], a[120:123], a[48:51], v[236:239]
 ds_read_b64_tr_b16 a[8:9], v7 offset:0
 v_mfma_f32_16x16x32_bf16 v[244:247], a[120:123], a[56:59], v[244:247]
 v_mfma_f32_16x16x32_bf16 v[244:247], a[124:127], a[60:63], v[244:247]
 ds_read_b64_tr_b16 a[10:11], v7 offset:4096
 v_mfma_f32_16x16x32_bf16 v[240:243], a[116:119], a[60:63], v[240:243]
 ds_read_b64_tr_b16 a[12:13], v7 offset:16384
 v_mfma_f32_16x16x32_bf16 v[240:243], a[112:115], a[56:59], v[240:243]
 ds_read_b64_tr_b16 a[14:15], v7 offset:20480
 v_mfma_f32_16x16x32_bf16 v[252:255], a[104:107], a[56:59], v[252:255]
 ds_read_b64_tr_b16 a[16:17], v8 offset:0
 v_mfma_f32_16x16x32_bf16 v[252:255], a[108:111], a[60:63], v[252:255]
 ds_read_b64_tr_b16 a[18:19], v8 offset:4096
 v_mfma_f32_16x16x32_bf16 v[248:251], a[100:103], a[60:63], v[248:251]
 ds_read_b64_tr_b16 a[20:21], v8 offset:16384
 v_mfma_f32_16x16x32_bf16 v[248:251], a[96:99], a[56:59], v[248:251]
 s_waitcnt lgkmcnt(15)
 ds_read_b64_tr_b16 a[22:23], v8 offset:20480
 v_mfma_f32_16x16x32_bf16 v[64:67], a[64:67], a[0:3], v[64:67]
 ds_read_b64_tr_b16 a[24:25], v9 offset:0
 v_lshlrev_b32 v1, 4, v0
 v_mfma_f32_16x16x32_bf16 v[64:67], a[68:71], a[4:7], v[64:67]
 s_add_u32 m0, s33, 0xfffffe00
 ds_read_b64_tr_b16 a[26:27], v9 offset:4096
 v_mfma_f32_16x16x32_bf16 v[68:71], a[76:79], a[4:7], v[68:71]
 s_waitcnt lgkmcnt(10)
 ds_read_b64_tr_b16 a[28:29], v9 offset:16384
 v_mfma_f32_16x16x32_bf16 v[68:71], a[72:75], a[0:3], v[68:71]
 ds_read_b64_tr_b16 a[30:31], v9 offset:20480
 buffer_load_dwordx4 v15, s[20:23], 0 offen offset:512 lds
 v_mfma_f32_16x16x32_bf16 v[72:75], a[80:83], a[0:3], v[72:75]
 ds_read_b128 a[96:99], v4 offset:8192
 v_mfma_f32_16x16x32_bf16 v[72:75], a[84:87], a[4:7], v[72:75]
 v_mfma_f32_16x16x32_bf16 v[76:79], a[92:95], a[4:7], v[76:79]
 s_add_u32 m0, s33, 0xfffffe80
 ds_read_b128 a[100:103], v5 offset:8192
 v_mfma_f32_16x16x32_bf16 v[76:79], a[88:91], a[0:3], v[76:79]
 s_waitcnt lgkmcnt(10)
 buffer_load_dwordx4 v15, s[20:23], 0 offen offset:1408 lds
 v_mfma_f32_16x16x32_bf16 v[84:87], a[88:91], a[8:11], v[84:87]
 ds_read_b128 a[108:111], v5 offset:10240
 v_mfma_f32_16x16x32_bf16 v[84:87], a[92:95], a[12:15], v[84:87]
 v_mfma_f32_16x16x32_bf16 v[80:83], a[84:87], a[12:15], v[80:83]
 s_add_u32 m0, s33, 0x600
 ds_read_b128 a[104:107], v4 offset:10240
 v_mfma_f32_16x16x32_bf16 v[80:83], a[80:83], a[8:11], v[80:83]
 buffer_load_dwordx4 v15, s[20:23], s57 offen offset:512 lds
 v_mfma_f32_16x16x32_bf16 v[92:95], a[72:75], a[8:11], v[92:95]
 ds_read_b128 a[112:115], v4 offset:12288
 v_mfma_f32_16x16x32_bf16 v[92:95], a[76:79], a[12:15], v[92:95]
 v_mfma_f32_16x16x32_bf16 v[88:91], a[68:71], a[12:15], v[88:91]
 s_add_u32 m0, s33, 0x680
 ds_read_b128 a[116:119], v5 offset:12288
 v_mfma_f32_16x16x32_bf16 v[88:91], a[64:67], a[8:11], v[88:91]
 s_waitcnt lgkmcnt(10)
 buffer_load_dwordx4 v15, s[20:23], s57 offen offset:1408 lds
 v_mfma_f32_16x16x32_bf16 v[96:99], a[64:67], a[16:19], v[96:99]
 ds_read_b128 a[124:127], v5 offset:14336
 v_mfma_f32_16x16x32_bf16 v[96:99], a[68:71], a[20:23], v[96:99]
 v_mfma_f32_16x16x32_bf16 v[100:103], a[76:79], a[20:23], v[100:103]
 s_add_u32 m0, s33, 0xd80
 ds_read_b128 a[120:123], v4 offset:14336
 v_mfma_f32_16x16x32_bf16 v[100:103], a[72:75], a[16:19], v[100:103]
 buffer_load_dwordx4 v15, s[20:23], 0 offen offset:640 lds
 v_mfma_f32_16x16x32_bf16 v[104:107], a[80:83], a[16:19], v[104:107]
 ds_read_b64_tr_b16 a[32:33], v10 offset:0
 v_mfma_f32_16x16x32_bf16 v[104:107], a[84:87], a[20:23], v[104:107]
 ds_read_b64_tr_b16 a[34:35], v10 offset:4096
 v_mfma_f32_16x16x32_bf16 v[108:111], a[92:95], a[20:23], v[108:111]
 s_add_u32 m0, s33, 0xe00
 ds_read_b64_tr_b16 a[36:37], v10 offset:16384
 v_mfma_f32_16x16x32_bf16 v[108:111], a[88:91], a[16:19], v[108:111]
 s_waitcnt lgkmcnt(11)
 ds_read_b64_tr_b16 a[38:39], v10 offset:20480
 buffer_load_dwordx4 v15, s[20:23], 0 offen offset:1536 lds
 v_mfma_f32_16x16x32_bf16 v[116:119], a[88:91], a[24:27], v[116:119]
 ds_read_b64_tr_b16 a[40:41], v11 offset:0
 v_mfma_f32_16x16x32_bf16 v[116:119], a[92:95], a[28:31], v[116:119]
 ds_read_b64_tr_b16 a[42:43], v11 offset:4096
 v_mfma_f32_16x16x32_bf16 v[112:115], a[84:87], a[28:31], v[112:115]
 s_add_u32 m0, s33, 0x1580
 ds_read_b64_tr_b16 a[44:45], v11 offset:16384
 v_mfma_f32_16x16x32_bf16 v[112:115], a[80:83], a[24:27], v[112:115]
 ds_read_b64_tr_b16 a[46:47], v11 offset:20480
 buffer_load_dwordx4 v15, s[20:23], s57 offen offset:640 lds
 v_mfma_f32_16x16x32_bf16 v[124:127], a[72:75], a[24:27], v[124:127]
 ds_read_b64_tr_b16 a[48:49], v12 offset:0
 v_mfma_f32_16x16x32_bf16 v[124:127], a[76:79], a[28:31], v[124:127]
 ds_read_b64_tr_b16 a[50:51], v12 offset:4096
 v_mfma_f32_16x16x32_bf16 v[120:123], a[68:71], a[28:31], v[120:123]
 s_add_u32 m0, s33, 0x1600
 ds_read_b64_tr_b16 a[52:53], v12 offset:16384
 v_mfma_f32_16x16x32_bf16 v[120:123], a[64:67], a[24:27], v[120:123]
 s_waitcnt lgkmcnt(15)
 ds_read_b64_tr_b16 a[54:55], v12 offset:20480
 buffer_load_dwordx4 v15, s[20:23], s57 offen offset:1536 lds
 v_mfma_f32_16x16x32_bf16 v[16:19], a[96:99], a[0:3], v[16:19]
 ds_read_b64_tr_b16 a[56:57], v13 offset:0
 v_mfma_f32_16x16x32_bf16 v[16:19], a[100:103], a[4:7], v[16:19]
 ds_read_b64_tr_b16 a[58:59], v13 offset:4096
 v_mfma_f32_16x16x32_bf16 v[20:23], a[108:111], a[4:7], v[20:23]
 ds_read_b64_tr_b16 a[60:61], v13 offset:16384
 v_mfma_f32_16x16x32_bf16 v[20:23], a[104:107], a[0:3], v[20:23]
 s_waitcnt lgkmcnt(15)
 ds_read_b64_tr_b16 a[62:63], v13 offset:20480
 v_mfma_f32_16x16x32_bf16 v[24:27], a[112:115], a[0:3], v[24:27]
 v_mfma_f32_16x16x32_bf16 v[24:27], a[116:119], a[4:7], v[24:27]
 v_mfma_f32_16x16x32_bf16 v[28:31], a[124:127], a[4:7], v[28:31]
 v_mfma_f32_16x16x32_bf16 v[28:31], a[120:123], a[0:3], v[28:31]
 s_waitcnt lgkmcnt(0)
 v_mfma_f32_16x16x32_bf16 a[228:231], a[120:123], a[8:11], a[228:231]
 s_barrier
 v_mfma_f32_16x16x32_bf16 a[228:231], a[124:127], a[12:15], a[228:231]
 s_add_u32 m0, s29, 0
 v_add_u32 v2, 0xff800000, v2
 v_mfma_f32_16x16x32_bf16 a[224:227], a[116:119], a[12:15], a[224:227]
 buffer_load_dwordx4 v2, s[16:19], 0 offen lds
 v_mfma_f32_16x16x32_bf16 a[224:227], a[112:115], a[8:11], a[224:227]
 v_mfma_f32_16x16x32_bf16 a[236:239], a[104:107], a[8:11], a[236:239]
 v_mfma_f32_16x16x32_bf16 a[236:239], a[108:111], a[12:15], a[236:239]
 v_mfma_f32_16x16x32_bf16 a[232:235], a[100:103], a[12:15], a[232:235]
 s_add_u32 m0, s29, 4096
 v_mfma_f32_16x16x32_bf16 a[232:235], a[96:99], a[8:11], a[232:235]
 buffer_load_dwordx4 v2, s[16:19], s48 offen lds
 v_mfma_f32_16x16x32_bf16 v[32:35], a[96:99], a[16:19], v[32:35]
 v_mfma_f32_16x16x32_bf16 v[32:35], a[100:103], a[20:23], v[32:35]
 v_mfma_f32_16x16x32_bf16 v[36:39], a[108:111], a[20:23], v[36:39]
 v_mfma_f32_16x16x32_bf16 v[36:39], a[104:107], a[16:19], v[36:39]
 s_add_u32 m0, s29, 8192
 v_mfma_f32_16x16x32_bf16 v[40:43], a[112:115], a[16:19], v[40:43]
 buffer_load_dwordx4 v2, s[16:19], s49 offen lds
 v_mfma_f32_16x16x32_bf16 v[40:43], a[116:119], a[20:23], v[40:43]
 v_mfma_f32_16x16x32_bf16 v[44:47], a[124:127], a[20:23], v[44:47]
 v_mfma_f32_16x16x32_bf16 v[44:47], a[120:123], a[16:19], v[44:47]
 v_mfma_f32_16x16x32_bf16 v[52:55], a[120:123], a[24:27], v[52:55]
 s_add_u32 m0, s29, 12288
 v_mfma_f32_16x16x32_bf16 v[52:55], a[124:127], a[28:31], v[52:55]
 buffer_load_dwordx4 v2, s[16:19], s50 offen lds
 v_mfma_f32_16x16x32_bf16 v[48:51], a[116:119], a[28:31], v[48:51]
 v_mfma_f32_16x16x32_bf16 v[48:51], a[112:115], a[24:27], v[48:51]
 v_mfma_f32_16x16x32_bf16 v[60:63], a[104:107], a[24:27], v[60:63]
 v_mfma_f32_16x16x32_bf16 v[60:63], a[108:111], a[28:31], v[60:63]
 s_add_u32 m0, s29, 16384
 v_mfma_f32_16x16x32_bf16 v[56:59], a[100:103], a[28:31], v[56:59]
 buffer_load_dwordx4 v2, s[16:19], s51 offen lds
 v_mfma_f32_16x16x32_bf16 v[56:59], a[96:99], a[24:27], v[56:59]
 v_mfma_f32_16x16x32_bf16 v[192:195], a[96:99], a[32:35], v[192:195]
 v_mfma_f32_16x16x32_bf16 v[192:195], a[100:103], a[36:39], v[192:195]
 v_mfma_f32_16x16x32_bf16 v[196:199], a[108:111], a[36:39], v[196:199]
 s_add_u32 m0, s29, 20480
 v_mfma_f32_16x16x32_bf16 v[196:199], a[104:107], a[32:35], v[196:199]
 buffer_load_dwordx4 v2, s[16:19], s52 offen lds
 v_mfma_f32_16x16x32_bf16 v[200:203], a[112:115], a[32:35], v[200:203]
 v_mfma_f32_16x16x32_bf16 v[200:203], a[116:119], a[36:39], v[200:203]
 v_mfma_f32_16x16x32_bf16 v[204:207], a[124:127], a[36:39], v[204:207]
 v_mfma_f32_16x16x32_bf16 v[204:207], a[120:123], a[32:35], v[204:207]
 s_add_u32 m0, s29, 24576
 v_mfma_f32_16x16x32_bf16 v[212:215], a[120:123], a[40:43], v[212:215]
 buffer_load_dwordx4 v2, s[16:19], s53 offen lds
 v_mfma_f32_16x16x32_bf16 v[212:215], a[124:127], a[44:47], v[212:215]
 v_mfma_f32_16x16x32_bf16 v[208:211], a[116:119], a[44:47], v[208:211]
 v_mfma_f32_16x16x32_bf16 v[208:211], a[112:115], a[40:43], v[208:211]
 v_mfma_f32_16x16x32_bf16 v[220:223], a[104:107], a[40:43], v[220:223]
 s_add_u32 m0, s29, 28672
 v_mfma_f32_16x16x32_bf16 v[220:223], a[108:111], a[44:47], v[220:223]
 buffer_load_dwordx4 v2, s[16:19], s54 offen lds
 v_mfma_f32_16x16x32_bf16 v[216:219], a[100:103], a[44:47], v[216:219]
 v_mfma_f32_16x16x32_bf16 v[216:219], a[96:99], a[40:43], v[216:219]
 v_mfma_f32_16x16x32_bf16 v[224:227], a[96:99], a[48:51], v[224:227]
 s_add_u32 m0, s29, 65536
 v_add_u32 v2, 0x80000, v2
 v_mfma_f32_16x16x32_bf16 v[224:227], a[100:103], a[52:55], v[224:227]
 buffer_load_dwordx4 v2, s[16:19], 0 offen lds
 v_mfma_f32_16x16x32_bf16 v[228:231], a[108:111], a[52:55], v[228:231]
 v_mfma_f32_16x16x32_bf16 v[228:231], a[104:107], a[48:51], v[228:231]
 v_mfma_f32_16x16x32_bf16 v[232:235], a[112:115], a[48:51], v[232:235]
 v_mfma_f32_16x16x32_bf16 v[232:235], a[116:119], a[52:55], v[232:235]
 s_add_u32 m0, s29, 69632
 v_mfma_f32_16x16x32_bf16 v[236:239], a[124:127], a[52:55], v[236:239]
 buffer_load_dwordx4 v2, s[16:19], s48 offen lds
 v_mfma_f32_16x16x32_bf16 v[236:239], a[120:123], a[48:51], v[236:239]
 v_mfma_f32_16x16x32_bf16 v[244:247], a[120:123], a[56:59], v[244:247]
 v_mfma_f32_16x16x32_bf16 v[244:247], a[124:127], a[60:63], v[244:247]
 v_mfma_f32_16x16x32_bf16 v[240:243], a[116:119], a[60:63], v[240:243]
 s_add_u32 m0, s29, 73728
 v_mfma_f32_16x16x32_bf16 v[240:243], a[112:115], a[56:59], v[240:243]
 buffer_load_dwordx4 v2, s[16:19], s49 offen lds
 v_mfma_f32_16x16x32_bf16 v[252:255], a[104:107], a[56:59], v[252:255]
 s_waitcnt vmcnt(11)
 v_mfma_f32_16x16x32_bf16 v[252:255], a[108:111], a[60:63], v[252:255]
 s_barrier
 ds_read_b64_tr_b16 a[0:1], v6 offset:32768
 v_mfma_f32_16x16x32_bf16 v[248:251], a[100:103], a[60:63], v[248:251]
 ds_read_b64_tr_b16 a[2:3], v6 offset:36864
 v_mfma_f32_16x16x32_bf16 v[248:251], a[96:99], a[56:59], v[248:251]
 s_add_u32 m0, s29, 77824
 ds_read_b128 a[96:99], v4 offset:40960
 v_mfma_f32_16x16x32_bf16 v[128:131], a[64:67], a[32:35], v[128:131]
 ds_read_b128 a[192:195], v14 offset:0
 buffer_load_dwordx4 v2, s[16:19], s50 offen lds
 v_mfma_f32_16x16x32_bf16 v[128:131], a[68:71], a[36:39], v[128:131]
 ds_read_b128 a[200:203], v3 offset:0
 v_mfma_f32_16x16x32_bf16 v[132:135], a[76:79], a[36:39], v[132:135]
 s_mov_b32 s56, s58
 ds_read_b64_tr_b16 a[4:5], v6 offset:49152
 v_mfma_f32_16x16x32_bf16 v[132:135], a[72:75], a[32:35], v[132:135]
 ds_read_b64_tr_b16 a[6:7], v6 offset:53248
 v_mfma_f32_16x16x32_bf16 v[136:139], a[80:83], a[32:35], v[136:139]
 s_add_u32 m0, s29, 81920
 ds_read_b128 a[100:103], v5 offset:40960
 v_mfma_f32_16x16x32_bf16 v[136:139], a[84:87], a[36:39], v[136:139]
 ds_read_b128 a[196:199], v14 offset:2048
 buffer_load_dwordx4 v2, s[16:19], s51 offen lds
 v_mfma_f32_16x16x32_bf16 v[140:143], a[92:95], a[36:39], v[140:143]
 ds_read_b128 a[204:207], v3 offset:2048
 v_mfma_f32_16x16x32_bf16 v[140:143], a[88:91], a[32:35], v[140:143]
 ds_read_b128 a[108:111], v5 offset:43008
 v_mfma_f32_16x16x32_bf16 v[148:151], a[88:91], a[40:43], v[148:151]
 ds_read_b128 a[208:211], v14 offset:4096
 v_mfma_f32_16x16x32_bf16 v[148:151], a[92:95], a[44:47], v[148:151]
 s_add_u32 m0, s29, 86016
 ds_read_b128 a[104:107], v4 offset:43008
 v_mfma_f32_16x16x32_bf16 v[144:147], a[84:87], a[44:47], v[144:147]
 ds_read_b128 a[216:219], v3 offset:4096
 buffer_load_dwordx4 v2, s[16:19], s52 offen lds
 v_mfma_f32_16x16x32_bf16 v[144:147], a[80:83], a[40:43], v[144:147]
 ds_read_b128 a[212:215], v14 offset:6144
 v_mfma_f32_16x16x32_bf16 v[156:159], a[72:75], a[40:43], v[156:159]
 s_cmp_lt_u32 s25, 4
 s_cselect_b32 s1, 2.0, s92
 ds_read_b128 a[112:115], v4 offset:45056
 v_mfma_f32_16x16x32_bf16 v[156:159], a[76:79], a[44:47], v[156:159]
 ds_read_b128 a[220:223], v3 offset:6144
 v_mfma_f32_16x16x32_bf16 v[152:155], a[68:71], a[44:47], v[152:155]
 s_add_u32 m0, s29, 90112
 ds_read_b128 a[116:119], v5 offset:45056
 v_mfma_f32_16x16x32_bf16 v[152:155], a[64:67], a[40:43], v[152:155]
 buffer_load_dwordx4 v2, s[16:19], s53 offen lds
 v_mfma_f32_16x16x32_bf16 v[160:163], a[64:67], a[48:51], v[160:163]
 v_mfma_f32_16x16x32_bf16 v[160:163], a[68:71], a[52:55], v[160:163]
 ds_read_b128 a[124:127], v5 offset:47104
 v_mfma_f32_16x16x32_bf16 v[164:167], a[76:79], a[52:55], v[164:167]
 v_mfma_f32_16x16x32_bf16 v[164:167], a[72:75], a[48:51], v[164:167]
 s_add_u32 m0, s29, 94208
 ds_read_b128 a[120:123], v4 offset:47104
 v_mfma_f32_16x16x32_bf16 v[168:171], a[80:83], a[48:51], v[168:171]
 buffer_load_dwordx4 v2, s[16:19], s54 offen lds
 v_mfma_f32_16x16x32_bf16 v[168:171], a[84:87], a[52:55], v[168:171]
 v_mfma_f32_16x16x32_bf16 v[172:175], a[92:95], a[52:55], v[172:175]
 v_mfma_f32_16x16x32_bf16 v[172:175], a[88:91], a[48:51], v[172:175]
 ds_read_b64_tr_b16 a[8:9], v7 offset:32768
 v_mfma_f32_16x16x32_bf16 v[180:183], a[88:91], a[56:59], v[180:183]
 v_mfma_f32_16x16x32_bf16 v[180:183], a[92:95], a[60:63], v[180:183]
 ds_read_b64_tr_b16 a[10:11], v7 offset:36864
 v_mfma_f32_16x16x32_bf16 v[176:179], a[84:87], a[60:63], v[176:179]
 ds_read_b64_tr_b16 a[12:13], v7 offset:49152
 v_mfma_f32_16x16x32_bf16 v[176:179], a[80:83], a[56:59], v[176:179]
 ds_read_b64_tr_b16 a[14:15], v7 offset:53248
 v_mfma_f32_16x16x32_bf16 v[188:191], a[72:75], a[56:59], v[188:191]
 ds_read_b64_tr_b16 a[16:17], v8 offset:32768
 v_mfma_f32_16x16x32_bf16 v[188:191], a[76:79], a[60:63], v[188:191]
 ds_read_b64_tr_b16 a[18:19], v8 offset:36864
 v_mfma_f32_16x16x32_bf16 v[184:187], a[68:71], a[60:63], v[184:187]
 ds_read_b64_tr_b16 a[20:21], v8 offset:49152
 v_mfma_f32_16x16x32_bf16 v[184:187], a[64:67], a[56:59], v[184:187]
 s_waitcnt lgkmcnt(15)
 ds_read_b64_tr_b16 a[22:23], v8 offset:53248
 s_cmp_ge_u32 s25, 4
 s_cbranch_scc1 L_late1
 v_mfma_f32_16x16x32_bf16 v[16:19], a[96:99], a[0:3], v[16:19]
 ds_read_b64_tr_b16 a[24:25], v9 offset:32768
 v_mfma_f32_16x16x32_bf16 v[16:19], a[100:103], a[4:7], v[16:19]
 s_add_u32 m0, s33, 0xfffffd00
 ds_read_b64_tr_b16 a[26:27], v9 offset:36864
 v_mfma_f32_16x16x32_bf16 v[20:23], a[108:111], a[4:7], v[20:23]
 s_waitcnt lgkmcnt(13)
 ds_read_b64_tr_b16 a[28:29], v9 offset:49152
 v_mfma_f32_16x16x32_bf16 v[20:23], a[104:107], a[0:3], v[20:23]
 ds_read_b64_tr_b16 a[30:31], v9 offset:53248
 buffer_load_dwordx4 v15, s[20:23], 0 offen offset:768 lds
 v_mfma_f32_16x16x32_bf16 v[24:27], a[112:115], a[0:3], v[24:27]
 s_waitcnt lgkmcnt(12)
 ds_read_b128 a[64:67], v4 offset:32768
 v_mfma_f32_16x16x32_bf16 v[24:27], a[116:119], a[4:7], v[24:27]
 v_mfma_f32_16x16x32_bf16 v[28:31], a[124:127], a[4:7], v[28:31]
 s_add_u32 m0, s33, 0xfffffd80
 ds_read_b128 a[68:71], v5 offset:32768
 v_mfma_f32_16x16x32_bf16 v[28:31], a[120:123], a[0:3], v[28:31]
 s_waitcnt lgkmcnt(10)
 buffer_load_dwordx4 v15, s[20:23], 0 offen offset:1664 lds
 v_mfma_f32_16x16x32_bf16 a[228:231], a[120:123], a[8:11], a[228:231]
 ds_read_b128 a[76:79], v5 offset:34816
 v_mfma_f32_16x16x32_bf16 a[228:231], a[124:127], a[12:15], a[228:231]
 v_mfma_f32_16x16x32_bf16 a[224:227], a[116:119], a[12:15], a[224:227]
 s_add_u32 m0, s33, 0x500
 ds_read_b128 a[72:75], v4 offset:34816
 v_mfma_f32_16x16x32_bf16 a[224:227], a[112:115], a[8:11], a[224:227]
 buffer_load_dwordx4 v15, s[20:23], s57 offen offset:768 lds
 v_mfma_f32_16x16x32_bf16 a[236:239], a[104:107], a[8:11], a[236:239]
 ds_read_b128 a[80:83], v4 offset:36864
 v_cvt_pk_bf16_f32 v16, v16, v17
 v_mfma_f32_16x16x32_bf16 a[236:239], a[108:111], a[12:15], a[236:239]
 v_cvt_pk_bf16_f32 v17, v18, v19
 v_cvt_pk_bf16_f32 v18, v20, v21
 v_mfma_f32_16x16x32_bf16 a[232:235], a[100:103], a[12:15], a[232:235]
 s_add_u32 m0, s33, 0x580
 ds_read_b128 a[84:87], v5 offset:36864
 v_cvt_pk_bf16_f32 v19, v22, v23
 v_mfma_f32_16x16x32_bf16 a[232:235], a[96:99], a[8:11], a[232:235]
 s_waitcnt lgkmcnt(10)
 buffer_load_dwordx4 v15, s[20:23], s57 offen offset:1664 lds
 v_mfma_f32_16x16x32_bf16 v[32:35], a[96:99], a[16:19], v[32:35]
 ds_read_b128 a[92:95], v5 offset:38912
 v_cvt_pk_bf16_f32 v24, v24, v25
 v_mfma_f32_16x16x32_bf16 v[32:35], a[100:103], a[20:23], v[32:35]
 v_cvt_pk_bf16_f32 v25, v26, v27
 v_cvt_pk_bf16_f32 v26, v28, v29
 v_mfma_f32_16x16x32_bf16 v[36:39], a[108:111], a[20:23], v[36:39]
 ds_read_b128 a[88:91], v4 offset:38912
 v_cvt_pk_bf16_f32 v27, v30, v31
 v_mfma_f32_16x16x32_bf16 v[36:39], a[104:107], a[16:19], v[36:39]
 v_accvgpr_read_b32 v20, a224
 v_accvgpr_read_b32 v21, a225
 v_mfma_f32_16x16x32_bf16 v[40:43], a[112:115], a[16:19], v[40:43]
 ds_read_b64_tr_b16 a[32:33], v10 offset:32768
 v_accvgpr_read_b32 v22, a226
 v_mfma_f32_16x16x32_bf16 v[40:43], a[116:119], a[20:23], v[40:43]
 ds_read_b64_tr_b16 a[34:35], v10 offset:36864
 v_accvgpr_read_b32 v23, a227
 v_mfma_f32_16x16x32_bf16 v[44:47], a[124:127], a[20:23], v[44:47]
 s_add_u32 s59, s56, 32768
 ds_read_b64_tr_b16 a[36:37], v10 offset:49152
 v_accvgpr_read_b32 v28, a228
 v_mfma_f32_16x16x32_bf16 v[44:47], a[120:123], a[16:19], v[44:47]
 s_waitcnt lgkmcnt(11)
 ds_read_b64_tr_b16 a[38:39], v10 offset:53248
 v_accvgpr_read_b32 v29, a229
 v_mfma_f32_16x16x32_bf16 v[52:55], a[120:123], a[24:27], v[52:55]
 ds_read_b64_tr_b16 a[40:41], v11 offset:32768
 buffer_store_dwordx4 v[16:19], v1, s[12:15], s59 offen offset:0 sc1
 v_mfma_f32_16x16x32_bf16 v[52:55], a[124:127], a[28:31], v[52:55]
 ds_read_b64_tr_b16 a[42:43], v11 offset:36864
 v_accvgpr_read_b32 v30, a230
 v_mfma_f32_16x16x32_bf16 v[48:51], a[116:119], a[28:31], v[48:51]
 ds_read_b64_tr_b16 a[44:45], v11 offset:49152
 v_accvgpr_read_b32 v31, a231
 v_mfma_f32_16x16x32_bf16 v[48:51], a[112:115], a[24:27], v[48:51]
 ds_read_b64_tr_b16 a[46:47], v11 offset:53248
 v_cvt_pk_bf16_f32 v20, v20, v21
 v_mfma_f32_16x16x32_bf16 v[60:63], a[104:107], a[24:27], v[60:63]
 ds_read_b64_tr_b16 a[48:49], v12 offset:32768
 v_cvt_pk_bf16_f32 v21, v22, v23
 v_mfma_f32_16x16x32_bf16 v[60:63], a[108:111], a[28:31], v[60:63]
 ds_read_b64_tr_b16 a[50:51], v12 offset:36864
 v_cvt_pk_bf16_f32 v22, v28, v29
 v_mfma_f32_16x16x32_bf16 v[56:59], a[100:103], a[28:31], v[56:59]
 s_add_u32 s59, s56, 49152
 ds_read_b64_tr_b16 a[52:53], v12 offset:49152
 v_cvt_pk_bf16_f32 v23, v30, v31
 v_mfma_f32_16x16x32_bf16 v[56:59], a[96:99], a[24:27], v[56:59]
 s_waitcnt lgkmcnt(15)
 ds_read_b64_tr_b16 a[54:55], v12 offset:53248
 buffer_store_dwordx4 v[24:27], v1, s[12:15], s59 offen offset:0 sc1
 v_mfma_f32_16x16x32_bf16 v[64:67], a[64:67], a[0:3], v[64:67]
 ds_read_b64_tr_b16 a[56:57], v13 offset:32768
 v_cvt_pk_bf16_f32 v32, v32, v33
 v_mfma_f32_16x16x32_bf16 v[64:67], a[68:71], a[4:7], v[64:67]
 ds_read_b64_tr_b16 a[58:59], v13 offset:36864
 v_cvt_pk_bf16_f32 v33, v34, v35
 v_mfma_f32_16x16x32_bf16 v[68:71], a[76:79], a[4:7], v[68:71]
 ds_read_b64_tr_b16 a[60:61], v13 offset:49152
 v_cvt_pk_bf16_f32 v34, v36, v37
 v_mfma_f32_16x16x32_bf16 v[68:71], a[72:75], a[0:3], v[68:71]
 s_waitcnt lgkmcnt(15)
 ds_read_b64_tr_b16 a[62:63], v13 offset:53248
 v_cvt_pk_bf16_f32 v35, v38, v39
 v_mfma_f32_16x16x32_bf16 v[72:75], a[80:83], a[0:3], v[72:75]
 v_cvt_pk_bf16_f32 v40, v40, v41
 v_cvt_pk_bf16_f32 v41, v42, v43
 v_mfma_f32_16x16x32_bf16 v[72:75], a[84:87], a[4:7], v[72:75]
 s_add_u32 s59, s56, 49152
 v_cvt_pk_bf16_f32 v42, v44, v45
 v_cvt_pk_bf16_f32 v43, v46, v47
 v_mfma_f32_16x16x32_bf16 v[76:79], a[92:95], a[4:7], v[76:79]
 buffer_store_dwordx4 v[20:23], v1, s[12:15], s59 offen offset:1024 sc1
 v_mfma_f32_16x16x32_bf16 v[76:79], a[88:91], a[0:3], v[76:79]
 s_waitcnt lgkmcnt(0)
 v_accvgpr_read_b32 v36, a232
 v_accvgpr_read_b32 v37, a233
 v_mfma_f32_16x16x32_bf16 v[84:87], a[88:91], a[8:11], v[84:87]
 s_barrier
 v_xor_b32 v6, s60, v6
 v_accvgpr_read_b32 v38, a234
 v_mfma_f32_16x16x32_bf16 v[84:87], a[92:95], a[12:15], v[84:87]
 s_add_u32 m0, s29, 32768
 v_add_u32 v2, 0x80000, v2
 v_accvgpr_read_b32 v39, a235
 v_mfma_f32_16x16x32_bf16 v[80:83], a[84:87], a[12:15], v[80:83]
 buffer_load_dwordx4 v2, s[16:19], 0 offen lds
 v_mfma_f32_16x16x32_bf16 v[80:83], a[80:83], a[8:11], v[80:83]
 v_accvgpr_read_b32 v44, a236
 v_accvgpr_read_b32 v45, a237
 v_mfma_f32_16x16x32_bf16 v[92:95], a[72:75], a[8:11], v[92:95]
 s_add_u32 s59, s56, 32768
 v_accvgpr_read_b32 v46, a238
 v_accvgpr_read_b32 v47, a239
 v_mfma_f32_16x16x32_bf16 v[92:95], a[76:79], a[12:15], v[92:95]
 buffer_store_dwordx4 v[32:35], v1, s[12:15], s59 offen offset:2048 sc1
 v_mfma_f32_16x16x32_bf16 v[88:91], a[68:71], a[12:15], v[88:91]
 s_add_u32 m0, s29, 36864
 v_cvt_pk_bf16_f32 v36, v36, v37
 v_cvt_pk_bf16_f32 v37, v38, v39
 v_mfma_f32_16x16x32_bf16 v[88:91], a[64:67], a[8:11], v[88:91]
 buffer_load_dwordx4 v2, s[16:19], s48 offen lds
 v_mfma_f32_16x16x32_bf16 v[96:99], a[64:67], a[16:19], v[96:99]
 v_cvt_pk_bf16_f32 v38, v44, v45
 v_cvt_pk_bf16_f32 v39, v46, v47
 v_mfma_f32_16x16x32_bf16 v[96:99], a[68:71], a[20:23], v[96:99]
 v_cvt_pk_bf16_f32 v48, v48, v49
 v_cvt_pk_bf16_f32 v49, v50, v51
 v_mfma_f32_16x16x32_bf16 v[100:103], a[76:79], a[20:23], v[100:103]
 v_cvt_pk_bf16_f32 v50, v52, v53
 v_cvt_pk_bf16_f32 v51, v54, v55
 v_mfma_f32_16x16x32_bf16 v[100:103], a[72:75], a[16:19], v[100:103]
 s_add_u32 m0, s29, 40960
 v_cvt_pk_bf16_f32 v56, v56, v57
 v_cvt_pk_bf16_f32 v57, v58, v59
 v_mfma_f32_16x16x32_bf16 v[104:107], a[80:83], a[16:19], v[104:107]
 buffer_load_dwordx4 v2, s[16:19], s49 offen lds
 v_mfma_f32_16x16x32_bf16 v[104:107], a[84:87], a[20:23], v[104:107]
 s_add_u32 s59, s56, 49152
 v_cvt_pk_bf16_f32 v58, v60, v61
 v_cvt_pk_bf16_f32 v59, v62, v63
 v_mfma_f32_16x16x32_bf16 v[108:111], a[92:95], a[20:23], v[108:111]
 buffer_store_dwordx4 v[40:43], v1, s[12:15], s59 offen offset:2048 sc1
 v_mfma_f32_16x16x32_bf16 v[108:111], a[88:91], a[16:19], v[108:111]
 v_cvt_pk_bf16_f32 v64, v64, v65
 v_cvt_pk_bf16_f32 v65, v66, v67
 v_mfma_f32_16x16x32_bf16 v[116:119], a[88:91], a[24:27], v[116:119]
 s_add_u32 m0, s29, 45056
 v_cvt_pk_bf16_f32 v66, v68, v69
 v_cvt_pk_bf16_f32 v67, v70, v71
 v_mfma_f32_16x16x32_bf16 v[116:119], a[92:95], a[28:31], v[116:119]
 buffer_load_dwordx4 v2, s[16:19], s50 offen lds
 v_mfma_f32_16x16x32_bf16 v[112:115], a[84:87], a[28:31], v[112:115]
 v_cvt_pk_bf16_f32 v72, v72, v73
 v_cvt_pk_bf16_f32 v73, v74, v75
 v_mfma_f32_16x16x32_bf16 v[112:115], a[80:83], a[24:27], v[112:115]
 v_cvt_pk_bf16_f32 v74, v76, v77
 v_cvt_pk_bf16_f32 v75, v78, v79
 v_mfma_f32_16x16x32_bf16 v[124:127], a[72:75], a[24:27], v[124:127]
 v_cvt_pk_bf16_f32 v80, v80, v81
 v_cvt_pk_bf16_f32 v81, v82, v83
 v_mfma_f32_16x16x32_bf16 v[124:127], a[76:79], a[28:31], v[124:127]
 s_add_u32 m0, s29, 49152
 v_cvt_pk_bf16_f32 v82, v84, v85
 v_cvt_pk_bf16_f32 v83, v86, v87
 v_mfma_f32_16x16x32_bf16 v[120:123], a[68:71], a[28:31], v[120:123]
 buffer_load_dwordx4 v2, s[16:19], s51 offen lds
 v_mfma_f32_16x16x32_bf16 v[120:123], a[64:67], a[24:27], v[120:123]
 s_add_u32 s59, s56, 32768
 v_cvt_pk_bf16_f32 v88, v88, v89
 v_cvt_pk_bf16_f32 v89, v90, v91
 v_mfma_f32_16x16x32_bf16 v[128:131], a[64:67], a[32:35], v[128:131]
 buffer_store_dwordx4 v[36:39], v1, s[12:15], s59 offen offset:1024 sc1
 v_mfma_f32_16x16x32_bf16 v[128:131], a[68:71], a[36:39], v[128:131]
 v_cvt_pk_bf16_f32 v90, v92, v93
 v_cvt_pk_bf16_f32 v91, v94, v95
 v_mfma_f32_16x16x32_bf16 v[132:135], a[76:79], a[36:39], v[132:135]
 s_add_u32 m0, s29, 53248
 v_cvt_pk_bf16_f32 v96, v96, v97
 v_cvt_pk_bf16_f32 v97, v98, v99
 v_mfma_f32_16x16x32_bf16 v[132:135], a[72:75], a[32:35], v[132:135]
 buffer_load_dwordx4 v2, s[16:19], s52 offen lds
 v_mfma_f32_16x16x32_bf16 v[136:139], a[80:83], a[32:35], v[136:139]
 v_cvt_pk_bf16_f32 v98, v100, v101
 v_cvt_pk_bf16_f32 v99, v102, v103
 v_mfma_f32_16x16x32_bf16 v[136:139], a[84:87], a[36:39], v[136:139]
 v_cvt_pk_bf16_f32 v104, v104, v105
 v_cvt_pk_bf16_f32 v105, v106, v107
 v_mfma_f32_16x16x32_bf16 v[140:143], a[92:95], a[36:39], v[140:143]
 v_cvt_pk_bf16_f32 v106, v108, v109
 v_cvt_pk_bf16_f32 v107, v110, v111
 v_mfma_f32_16x16x32_bf16 v[140:143], a[88:91], a[32:35], v[140:143]
 s_add_u32 m0, s29, 57344
 v_cvt_pk_bf16_f32 v112, v112, v113
 v_cvt_pk_bf16_f32 v113, v114, v115
 v_mfma_f32_16x16x32_bf16 v[148:151], a[88:91], a[40:43], v[148:151]
 buffer_load_dwordx4 v2, s[16:19], s53 offen lds
 v_mfma_f32_16x16x32_bf16 v[148:151], a[92:95], a[44:47], v[148:151]
 s_add_u32 s59, s56, 49152
 v_cvt_pk_bf16_f32 v114, v116, v117
 v_cvt_pk_bf16_f32 v115, v118, v119
 v_mfma_f32_16x16x32_bf16 v[144:147], a[84:87], a[44:47], v[144:147]
 buffer_store_dwordx4 v[48:51], v1, s[12:15], s59 offen offset:3072 sc1
 v_mfma_f32_16x16x32_bf16 v[144:147], a[80:83], a[40:43], v[144:147]
 v_cvt_pk_bf16_f32 v120, v120, v121
 v_cvt_pk_bf16_f32 v121, v122, v123
 v_mfma_f32_16x16x32_bf16 v[156:159], a[72:75], a[40:43], v[156:159]
 s_add_u32 m0, s29, 61440
 v_cvt_pk_bf16_f32 v122, v124, v125
 v_cvt_pk_bf16_f32 v123, v126, v127
 v_mfma_f32_16x16x32_bf16 v[156:159], a[76:79], a[44:47], v[156:159]
 buffer_load_dwordx4 v2, s[16:19], s54 offen lds
 v_mfma_f32_16x16x32_bf16 v[152:155], a[68:71], a[44:47], v[152:155]
 v_cvt_pk_bf16_f32 v128, v128, v129
 v_cvt_pk_bf16_f32 v129, v130, v131
 v_mfma_f32_16x16x32_bf16 v[152:155], a[64:67], a[40:43], v[152:155]
 v_cvt_pk_bf16_f32 v130, v132, v133
 v_cvt_pk_bf16_f32 v131, v134, v135
 v_mfma_f32_16x16x32_bf16 v[160:163], a[64:67], a[48:51], v[160:163]
 s_add_u32 m0, s29, 98304
 v_add_u32 v2, 0x80000, v2
 v_cvt_pk_bf16_f32 v136, v136, v137
 v_mfma_f32_16x16x32_bf16 v[160:163], a[68:71], a[52:55], v[160:163]
 buffer_load_dwordx4 v2, s[16:19], 0 offen lds
 v_mfma_f32_16x16x32_bf16 v[164:167], a[76:79], a[52:55], v[164:167]
 s_add_u32 s59, s56, 32768
 v_cvt_pk_bf16_f32 v137, v138, v139
 v_cvt_pk_bf16_f32 v138, v140, v141
 v_mfma_f32_16x16x32_bf16 v[164:167], a[72:75], a[48:51], v[164:167]
 buffer_store_dwordx4 v[56:59], v1, s[12:15], s59 offen offset:3072 sc1
 v_mfma_f32_16x16x32_bf16 v[168:171], a[80:83], a[48:51], v[168:171]
 v_cvt_pk_bf16_f32 v139, v142, v143
 v_cvt_pk_bf16_f32 v144, v144, v145
 v_mfma_f32_16x16x32_bf16 v[168:171], a[84:87], a[52:55], v[168:171]
 s_add_u32 m0, s29, 102400
 v_cvt_pk_bf16_f32 v145, v146, v147
 v_cvt_pk_bf16_f32 v146, v148, v149
 v_mfma_f32_16x16x32_bf16 v[172:175], a[92:95], a[52:55], v[172:175]
 buffer_load_dwordx4 v2, s[16:19], s48 offen lds
 v_mfma_f32_16x16x32_bf16 v[172:175], a[88:91], a[48:51], v[172:175]
 v_cvt_pk_bf16_f32 v147, v150, v151
 v_cvt_pk_bf16_f32 v152, v152, v153
 v_mfma_f32_16x16x32_bf16 v[180:183], a[88:91], a[56:59], v[180:183]
 v_cvt_pk_bf16_f32 v153, v154, v155
 v_cvt_pk_bf16_f32 v154, v156, v157
 v_mfma_f32_16x16x32_bf16 v[180:183], a[92:95], a[60:63], v[180:183]
 v_cvt_pk_bf16_f32 v155, v158, v159
 v_mfma_f32_16x16x32_bf16 v[176:179], a[84:87], a[60:63], v[176:179]
 s_add_u32 m0, s29, 106496
 v_mfma_f32_16x16x32_bf16 v[176:179], a[80:83], a[56:59], v[176:179]
 buffer_load_dwordx4 v2, s[16:19], s49 offen lds
 v_mfma_f32_16x16x32_bf16 v[188:191], a[72:75], a[56:59], v[188:191]
 s_add_u32 s59, s56, 0
 v_cvt_pk_bf16_f32 v160, v160, v161
 v_cvt_pk_bf16_f32 v161, v162, v163
 v_mfma_f32_16x16x32_bf16 v[188:191], a[76:79], a[60:63], v[188:191]
 buffer_store_dwordx4 v[64:67], v1, s[12:15], s59 offen offset:0 sc1
 v_mfma_f32_16x16x32_bf16 v[184:187], a[68:71], a[60:63], v[184:187]
 v_cvt_pk_bf16_f32 v162, v164, v165
 v_cvt_pk_bf16_f32 v163, v166, v167
 v_mfma_f32_16x16x32_bf16 v[184:187], a[64:67], a[56:59], v[184:187]
 s_add_u32 m0, s29, 110592
 v_cvt_pk_bf16_f32 v168, v168, v169
 v_cvt_pk_bf16_f32 v169, v170, v171
 v_mfma_f32_16x16x32_bf16 v[192:195], a[96:99], a[32:35], v[192:195]
 buffer_load_dwordx4 v2, s[16:19], s50 offen lds
 v_mfma_f32_16x16x32_bf16 v[192:195], a[100:103], a[36:39], v[192:195]
 v_cvt_pk_bf16_f32 v170, v172, v173
 v_cvt_pk_bf16_f32 v171, v174, v175
 v_mfma_f32_16x16x32_bf16 v[196:199], a[108:111], a[36:39], v[196:199]
 v_mfma_f32_16x16x32_bf16 v[196:199], a[104:107], a[32:35], v[196:199]
 v_cvt_pk_bf16_f32 v176, v176, v177
 v_cvt_pk_bf16_f32 v177, v178, v179
 v_mfma_f32_16x16x32_bf16 v[200:203], a[112:115], a[32:35], v[200:203]
 s_add_u32 m0, s29, 114688
 v_cvt_pk_bf16_f32 v178, v180, v181
 v_cvt_pk_bf16_f32 v179, v182, v183
 v_mfma_f32_16x16x32_bf16 v[200:203], a[116:119], a[36:39], v[200:203]
 buffer_load_dwordx4 v2, s[16:19], s51 offen lds
 v_mfma_f32_16x16x32_bf16 v[204:207], a[124:127], a[36:39], v[204:207]
 s_add_u32 s59, s56, 16384
 v_mfma_f32_16x16x32_bf16 v[204:207], a[120:123], a[32:35], v[204:207]
 buffer_store_dwordx4 v[72:75], v1, s[12:15], s59 offen offset:0 sc1
 v_mfma_f32_16x16x32_bf16 v[212:215], a[120:123], a[40:43], v[212:215]
 v_cvt_pk_bf16_f32 v184, v184, v185
 v_cvt_pk_bf16_f32 v185, v186, v187
 v_mfma_f32_16x16x32_bf16 v[212:215], a[124:127], a[44:47], v[212:215]
 s_add_u32 m0, s29, 118784
 v_cvt_pk_bf16_f32 v186, v188, v189
 v_cvt_pk_bf16_f32 v187, v190, v191
 v_mfma_f32_16x16x32_bf16 v[208:211], a[116:119], a[44:47], v[208:211]
 buffer_load_dwordx4 v2, s[16:19], s52 offen lds
 v_mfma_f32_16x16x32_bf16 v[208:211], a[112:115], a[40:43], v[208:211]
 v_cvt_pk_bf16_f32 v192, v192, v193
 v_cvt_pk_bf16_f32 v193, v194, v195
 v_mfma_f32_16x16x32_bf16 v[220:223], a[104:107], a[40:43], v[220:223]
 v_cvt_pk_bf16_f32 v194, v196, v197
 v_cvt_pk_bf16_f32 v195, v198, v199
 v_mfma_f32_16x16x32_bf16 v[220:223], a[108:111], a[44:47], v[220:223]
 v_mfma_f32_16x16x32_bf16 v[216:219], a[100:103], a[44:47], v[216:219]
 s_add_u32 m0, s29, 122880
 v_mfma_f32_16x16x32_bf16 v[216:219], a[96:99], a[40:43], v[216:219]
 buffer_load_dwordx4 v2, s[16:19], s53 offen lds
 v_mfma_f32_16x16x32_bf16 v[224:227], a[96:99], a[48:51], v[224:227]
 s_add_u32 s59, s56, 16384
 v_cvt_pk_bf16_f32 v200, v200, v201
 v_cvt_pk_bf16_f32 v201, v202, v203
 v_mfma_f32_16x16x32_bf16 v[224:227], a[100:103], a[52:55], v[224:227]
 s_waitcnt vmcnt(25)
 buffer_store_dwordx4 v[80:83], v1, s[12:15], s59 offen offset:1024 sc1
 v_mfma_f32_16x16x32_bf16 v[228:231], a[108:111], a[52:55], v[228:231]
 s_barrier
 v_xor_b32 v7, 0, v6
 v_cvt_pk_bf16_f32 v202, v204, v205
 v_mfma_f32_16x16x32_bf16 v[228:231], a[104:107], a[48:51], v[228:231]
 s_add_u32 m0, s29, 126976
 ds_read_b64_tr_b16 a[64:65], v7 offset:0
 v_cvt_pk_bf16_f32 v203, v206, v207
 v_mfma_f32_16x16x32_bf16 v[232:235], a[112:115], a[48:51], v[232:235]
 ds_read_b64_tr_b16 a[66:67], v7 offset:4096
 buffer_load_dwordx4 v2, s[16:19], s54 offen lds
 v_mfma_f32_16x16x32_bf16 v[232:235], a[116:119], a[52:55], v[232:235]
 ds_read_b64_tr_b16 a[68:69], v7 offset:16384
 v_cvt_pk_bf16_f32 v208, v208, v209
 v_mfma_f32_16x16x32_bf16 v[236:239], a[124:127], a[52:55], v[236:239]
 ds_read_b64_tr_b16 a[70:71], v7 offset:20480
 v_xor_b32 v8, 65536, v6
 v_mfma_f32_16x16x32_bf16 v[236:239], a[120:123], a[48:51], v[236:239]
 s_add_u32 s59, s56, 0
 ds_read_b64_tr_b16 a[72:73], v8 offset:0
 v_cvt_pk_bf16_f32 v209, v210, v211
 v_mfma_f32_16x16x32_bf16 v[244:247], a[120:123], a[56:59], v[244:247]
 ds_read_b64_tr_b16 a[74:75], v8 offset:4096
 buffer_store_dwordx4 v[88:91], v1, s[12:15], s59 offen offset:1024 sc1
 v_mfma_f32_16x16x32_bf16 v[244:247], a[124:127], a[60:63], v[244:247]
 ds_read_b64_tr_b16 a[76:77], v8 offset:16384
 v_cvt_pk_bf16_f32 v210, v212, v213
 v_mfma_f32_16x16x32_bf16 v[240:243], a[116:119], a[60:63], v[240:243]
 ds_read_b64_tr_b16 a[78:79], v8 offset:20480
 v_xor_b32 v9, 32, v6
 v_mfma_f32_16x16x32_bf16 v[240:243], a[112:115], a[56:59], v[240:243]
 ds_read_b64_tr_b16 a[80:81], v9 offset:0
 v_cvt_pk_bf16_f32 v211, v214, v215
 v_mfma_f32_16x16x32_bf16 v[252:255], a[104:107], a[56:59], v[252:255]
 ds_read_b64_tr_b16 a[82:83], v9 offset:4096
 v_cvt_pk_bf16_f32 v216, v216, v217
 v_mfma_f32_16x16x32_bf16 v[252:255], a[108:111], a[60:63], v[252:255]
 ds_read_b64_tr_b16 a[84:85], v9 offset:16384
 v_cvt_pk_bf16_f32 v217, v218, v219
 v_mfma_f32_16x16x32_bf16 v[248:251], a[100:103], a[60:63], v[248:251]
 s_add_u32 s59, s56, 0
 ds_read_b64_tr_b16 a[86:87], v9 offset:20480
 v_xor_b32 v10, 65568, v6
 v_mfma_f32_16x16x32_bf16 v[248:251], a[96:99], a[56:59], v[248:251]
 s_waitcnt lgkmcnt(6)
 ds_read_b64_tr_b16 a[88:89], v10 offset:0
 buffer_store_dwordx4 v[96:99], v1, s[12:15], s59 offen offset:2048 sc1
 v_mfma_f32_16x16x32_bf16 v[28:31], a[64:67], a[128:131], 0
 ds_read_b64_tr_b16 a[90:91], v10 offset:4096
 v_cvt_pk_bf16_f32 v218, v220, v221
 v_mfma_f32_16x16x32_bf16 v[28:31], a[68:71], a[136:139], v[28:31]
 ds_read_b64_tr_b16 a[92:93], v10 offset:16384
 v_xor_b32 v7, 64, v6
 v_mfma_f32_16x16x32_bf16 v[28:31], a[72:75], a[144:147], v[28:31]
 s_waitcnt lgkmcnt(7)
 ds_read_b128 a[112:115], v14 offset:0
 ds_read_b64_tr_b16 a[94:95], v10 offset:20480
 v_mfma_f32_16x16x32_bf16 v[28:31], a[76:79], a[152:155], v[28:31]
 ds_read_b64_tr_b16 a[96:97], v7 offset:0
 v_cvt_pk_bf16_f32 v219, v222, v223
 v_mfma_f32_16x16x32_bf16 v[44:47], a[64:67], a[132:135], 0
 ds_read_b128 a[120:123], v3 offset:0
 ds_read_b64_tr_b16 a[98:99], v7 offset:4096
 v_mfma_f32_16x16x32_bf16 v[44:47], a[68:71], a[140:143], v[44:47]
 s_add_u32 s59, s56, 16384
 ds_read_b64_tr_b16 a[100:101], v7 offset:16384
 v_xor_b32 v8, 65600, v6
 v_mfma_f32_16x16x32_bf16 v[44:47], a[72:75], a[148:151], v[44:47]
 ds_read_b128 a[116:119], v14 offset:2048
 ds_read_b64_tr_b16 a[102:103], v7 offset:20480
 buffer_store_dwordx4 v[104:107], v1, s[12:15], s59 offen offset:2048 sc1
 v_mfma_f32_16x16x32_bf16 v[44:47], a[76:79], a[156:159], v[44:47]
 s_waitcnt lgkmcnt(9)
 ds_read_b64_tr_b16 a[104:105], v8 offset:0
 v_cvt_pk_bf16_f32 v224, v224, v225
 v_mfma_f32_16x16x32_bf16 v[52:55], a[80:83], a[128:131], 0
 ds_read_b128 a[124:127], v3 offset:2048
 ds_read_b64_tr_b16 a[106:107], v8 offset:4096
 v_mfma_f32_16x16x32_bf16 v[52:55], a[84:87], a[136:139], v[52:55]
 ds_read_b64_tr_b16 a[108:109], v8 offset:16384
 v_cvt_pk_bf16_f32 v225, v226, v227
 v_mfma_f32_16x16x32_bf16 v[52:55], a[88:91], a[144:147], v[52:55]
 s_waitcnt lgkmcnt(10)
 ds_read_b64_tr_b16 a[110:111], v8 offset:20480
 v_xor_b32 v9, 96, v6
 v_mfma_f32_16x16x32_bf16 v[52:55], a[92:95], a[152:155], v[52:55]
 ds_read_b64_tr_b16 a[64:65], v9 offset:0
 v_cvt_pk_bf16_f32 v226, v228, v229
 v_mfma_f32_16x16x32_bf16 v[60:63], a[80:83], a[132:135], 0
 s_add_u32 s59, s56, 16384
 ds_read_b64_tr_b16 a[66:67], v9 offset:4096
 v_cvt_pk_bf16_f32 v227, v230, v231
 v_mfma_f32_16x16x32_bf16 v[60:63], a[84:87], a[140:143], v[60:63]
 ds_read_b64_tr_b16 a[68:69], v9 offset:16384
 buffer_store_dwordx4 v[112:115], v1, s[12:15], s59 offen offset:3072 sc1
 v_mfma_f32_16x16x32_bf16 v[60:63], a[88:91], a[148:151], v[60:63]
 ds_read_b64_tr_b16 a[70:71], v9 offset:20480
 v_xor_b32 v10, 65632, v6
 v_mfma_f32_16x16x32_bf16 v[60:63], a[92:95], a[156:159], v[60:63]
 s_waitcnt lgkmcnt(6)
 ds_read_b64_tr_b16 a[72:73], v10 offset:0
 v_cvt_pk_bf16_f32 v232, v232, v233
 v_mfma_f32_16x16x32_bf16 v[20:23], a[96:99], a[128:131], 0
 ds_read_b64_tr_b16 a[74:75], v10 offset:4096
 v_cvt_pk_bf16_f32 v233, v234, v235
 v_mfma_f32_16x16x32_bf16 v[20:23], a[100:103], a[136:139], v[20:23]
 s_waitcnt lgkmcnt(8)
 ds_read_b64_tr_b16 a[76:77], v10 offset:16384
 v_xor_b32 v7, 128, v6
 v_mfma_f32_16x16x32_bf16 v[20:23], a[104:107], a[144:147], v[20:23]
 s_waitcnt lgkmcnt(7)
 s_barrier
 ds_read_b64_tr_b16 a[78:79], v10 offset:20480
 v_mfma_f32_16x16x32_bf16 v[20:23], a[108:111], a[152:155], v[20:23]
 s_add_u32 m0, s29, 131072
 ds_read_b64_tr_b16 a[80:81], v7 offset:0
 v_add_u32 v2, 0x80000, v2
 v_mfma_f32_16x16x32_bf16 v[36:39], a[96:99], a[132:135], 0
 ds_read_b64_tr_b16 a[82:83], v7 offset:4096
 buffer_load_dwordx4 v2, s[16:19], 0 offen lds
 v_mfma_f32_16x16x32_bf16 v[36:39], a[100:103], a[140:143], v[36:39]
 ds_read_b64_tr_b16 a[84:85], v7 offset:16384
 v_cvt_pk_bf16_f32 v234, v236, v237
 v_mfma_f32_16x16x32_bf16 v[36:39], a[104:107], a[148:151], v[36:39]
 s_add_u32 s59, s56, 0
 ds_read_b64_tr_b16 a[86:87], v7 offset:20480
 v_xor_b32 v8, 65664, v6
 v_mfma_f32_16x16x32_bf16 v[36:39], a[108:111], a[156:159], v[36:39]
 s_waitcnt lgkmcnt(6)
 ds_read_b64_tr_b16 a[88:89], v8 offset:0
 buffer_store_dwordx4 v[120:123], v1, s[12:15], s59 offen offset:3072 sc1
 v_mfma_f32_16x16x32_bf16 v[68:71], a[64:67], a[128:131], 0
 ds_read_b64_tr_b16 a[90:91], v8 offset:4096
 v_cvt_pk_bf16_f32 v235, v238, v239
 v_mfma_f32_16x16x32_bf16 v[68:71], a[68:71], a[136:139], v[68:71]
 s_add_u32 m0, s29, 135168
 ds_read_b64_tr_b16 a[92:93], v8 offset:16384
 v_cvt_pk_bf16_f32 v240, v240, v241
 v_mfma_f32_16x16x32_bf16 v[68:71], a[72:75], a[144:147], v[68:71]
 s_waitcnt lgkmcnt(7)
 ds_read_b64_tr_b16 a[94:95], v8 offset:20480
 v_xor_b32 v9, 160, v6
 v_mfma_f32_16x16x32_bf16 v[68:71], a[76:79], a[152:155], v[68:71]
 ds_read_b64_tr_b16 a[96:97], v9 offset:0
 buffer_load_dwordx4 v2, s[16:19], s48 offen lds
 v_mfma_f32_16x16x32_bf16 v[76:79], a[64:67], a[132:135], 0
 ds_read_b64_tr_b16 a[98:99], v9 offset:4096
 v_cvt_pk_bf16_f32 v241, v242, v243
 v_mfma_f32_16x16x32_bf16 v[76:79], a[68:71], a[140:143], v[76:79]
 ds_read_b64_tr_b16 a[100:101], v9 offset:16384
 v_cvt_pk_bf16_f32 v242, v244, v245
 v_mfma_f32_16x16x32_bf16 v[76:79], a[72:75], a[148:151], v[76:79]
 s_add_u32 s59, s56, 4096
 ds_read_b64_tr_b16 a[102:103], v9 offset:20480
 v_xor_b32 v10, 65696, v6
 v_mfma_f32_16x16x32_bf16 v[76:79], a[76:79], a[156:159], v[76:79]
 s_waitcnt lgkmcnt(6)
 ds_read_b64_tr_b16 a[104:105], v10 offset:0
 buffer_store_dwordx4 v[128:131], v1, s[12:15], s59 offen offset:0 sc1
 v_mfma_f32_16x16x32_bf16 v[84:87], a[80:83], a[128:131], 0
 s_add_u32 m0, s29, 139264
 ds_read_b64_tr_b16 a[106:107], v10 offset:4096
 v_cvt_pk_bf16_f32 v243, v246, v247
 v_mfma_f32_16x16x32_bf16 v[84:87], a[84:87], a[136:139], v[84:87]
 ds_read_b64_tr_b16 a[108:109], v10 offset:16384
 buffer_load_dwordx4 v2, s[16:19], s49 offen lds
 v_mfma_f32_16x16x32_bf16 v[84:87], a[88:91], a[144:147], v[84:87]
 s_waitcnt lgkmcnt(7)
 ds_read_b64_tr_b16 a[110:111], v10 offset:20480
 v_xor_b32 v7, 192, v6
 v_mfma_f32_16x16x32_bf16 v[84:87], a[92:95], a[152:155], v[84:87]
 ds_read_b64_tr_b16 a[64:65], v7 offset:0
 v_cvt_pk_bf16_f32 v248, v248, v249
 v_mfma_f32_16x16x32_bf16 v[92:95], a[80:83], a[132:135], 0
 ds_read_b64_tr_b16 a[66:67], v7 offset:4096
 v_cvt_pk_bf16_f32 v249, v250, v251
 v_mfma_f32_16x16x32_bf16 v[92:95], a[84:87], a[140:143], v[92:95]
 ds_read_b64_tr_b16 a[68:69], v7 offset:16384
 v_cvt_pk_bf16_f32 v250, v252, v253
 v_mfma_f32_16x16x32_bf16 v[92:95], a[88:91], a[148:151], v[92:95]
 s_add_u32 m0, s29, 143360
 ds_read_b64_tr_b16 a[70:71], v7 offset:20480
 v_xor_b32 v8, 65728, v6
 v_mfma_f32_16x16x32_bf16 v[92:95], a[92:95], a[156:159], v[92:95]
 s_waitcnt lgkmcnt(6)
 ds_read_b64_tr_b16 a[72:73], v8 offset:0
 buffer_load_dwordx4 v2, s[16:19], s50 offen lds
 v_mfma_f32_16x16x32_bf16 v[100:103], a[96:99], a[128:131], 0
 s_add_u32 s59, s56, 20480
 ds_read_b64_tr_b16 a[74:75], v8 offset:4096
 v_cvt_pk_bf16_f32 v251, v254, v255
 v_mfma_f32_16x16x32_bf16 v[100:103], a[100:103], a[136:139], v[100:103]
 ds_read_b64_tr_b16 a[76:77], v8 offset:16384
 buffer_store_dwordx4 v[136:139], v1, s[12:15], s59 offen offset:0 sc1
 v_mfma_f32_16x16x32_bf16 v[100:103], a[104:107], a[144:147], v[100:103]
 s_waitcnt lgkmcnt(7)
 ds_read_b64_tr_b16 a[78:79], v8 offset:20480
 v_xor_b32 v9, 224, v6
 v_mfma_f32_16x16x32_bf16 v[100:103], a[108:111], a[152:155], v[100:103]
 s_and_b32 s36, s95, 31
 ds_read_b64_tr_b16 a[80:81], v9 offset:0
 v_accvgpr_read_b32 v11, a245
 v_mfma_f32_16x16x32_bf16 v[108:111], a[96:99], a[132:135], 0
 s_add_u32 m0, s29, 147456
 ds_read_b64_tr_b16 a[82:83], v9 offset:4096
 v_mov_b32 v12, 0
 v_mfma_f32_16x16x32_bf16 v[108:111], a[100:103], a[140:143], v[108:111]
 ds_read_b64_tr_b16 a[84:85], v9 offset:16384
 buffer_load_dwordx4 v2, s[16:19], s51 offen lds
 v_mfma_f32_16x16x32_bf16 v[108:111], a[104:107], a[148:151], v[108:111]
 s_add_u32 s59, s56, 20480
 ds_read_b64_tr_b16 a[86:87], v9 offset:20480
 v_xor_b32 v10, 65760, v6
 v_mfma_f32_16x16x32_bf16 v[108:111], a[108:111], a[156:159], v[108:111]
 s_waitcnt lgkmcnt(6)
 ds_read_b64_tr_b16 a[88:89], v10 offset:0
 v_and_b32 v14, 15, v0
 v_mfma_f32_16x16x32_bf16 v[116:119], a[64:67], a[128:131], 0
 ds_read_b64_tr_b16 a[90:91], v10 offset:4096
 buffer_store_dwordx4 v[144:147], v1, s[12:15], s59 offen offset:1024 sc1
 v_mfma_f32_16x16x32_bf16 v[116:119], a[68:71], a[136:139], v[116:119]
 s_add_u32 m0, s29, 151552
 ds_read_b64_tr_b16 a[92:93], v10 offset:16384
 v_lshrrev_b32 v3, 4, v0
 v_mfma_f32_16x16x32_bf16 v[116:119], a[72:75], a[144:147], v[116:119]
 s_waitcnt lgkmcnt(7)
 ds_read_b64_tr_b16 a[94:95], v10 offset:20480
 v_xor_b32 v7, 256, v6
 v_mfma_f32_16x16x32_bf16 v[116:119], a[76:79], a[152:155], v[116:119]
 ds_read_b64_tr_b16 a[96:97], v7 offset:0
 buffer_load_dwordx4 v2, s[16:19], s52 offen lds
 v_mfma_f32_16x16x32_bf16 v[124:127], a[64:67], a[132:135], 0
 s_lshr_b32 s37, s95, 5
 ds_read_b64_tr_b16 a[98:99], v7 offset:4096
 v_lshlrev_b32 v3, 2, v3
 v_mfma_f32_16x16x32_bf16 v[124:127], a[68:71], a[140:143], v[124:127]
 ds_read_b64_tr_b16 a[100:101], v7 offset:16384
 global_load_dword v5, v12, s[90:91] offset:128 sc1
 v_mfma_f32_16x16x32_bf16 v[124:127], a[72:75], a[148:151], v[124:127]
 s_add_u32 s59, s56, 4096
 ds_read_b64_tr_b16 a[102:103], v7 offset:20480
 v_xor_b32 v8, 65792, v6
 v_mfma_f32_16x16x32_bf16 v[124:127], a[76:79], a[156:159], v[124:127]
 s_waitcnt lgkmcnt(6)
 ds_read_b64_tr_b16 a[104:105], v8 offset:0
 buffer_store_dwordx4 v[152:155], v1, s[12:15], s59 offen offset:1024 sc1
 v_mfma_f32_16x16x32_bf16 v[132:135], a[80:83], a[128:131], 0
 s_add_u32 m0, s29, 155648
 ds_read_b64_tr_b16 a[106:107], v8 offset:4096
 v_and_b32 v12, 11, v0
 v_mfma_f32_16x16x32_bf16 v[132:135], a[84:87], a[136:139], v[132:135]
 ds_read_b64_tr_b16 a[108:109], v8 offset:16384
 buffer_load_dwordx4 v2, s[16:19], s53 offen lds
 v_mfma_f32_16x16x32_bf16 v[132:135], a[88:91], a[144:147], v[132:135]
 s_waitcnt lgkmcnt(7)
 ds_read_b64_tr_b16 a[110:111], v8 offset:20480
 v_xor_b32 v9, 288, v6
 v_mfma_f32_16x16x32_bf16 v[132:135], a[92:95], a[152:155], v[132:135]
 s_lshl_b32 s38, s3, 4
 ds_read_b64_tr_b16 a[64:65], v9 offset:0
 v_lshlrev_b32 v12, 2, v12
 v_mfma_f32_16x16x32_bf16 v[140:143], a[80:83], a[132:135], 0
 s_lshl_b32 s39, s36, 6
 ds_read_b64_tr_b16 a[66:67], v9 offset:4096
 v_sub_u32 v14, v14, v3
 v_mfma_f32_16x16x32_bf16 v[140:143], a[84:87], a[140:143], v[140:143]
 s_add_u32 s38, s38, s39
 ds_read_b64_tr_b16 a[68:69], v9 offset:16384
 v_lshrrev_b32_e64 v3, 6, s29
 v_mfma_f32_16x16x32_bf16 v[140:143], a[88:91], a[148:151], v[140:143]
 s_add_u32 m0, s29, 159744
 ds_read_b64_tr_b16 a[70:71], v9 offset:20480
 v_xor_b32 v10, 65824, v6
 v_mfma_f32_16x16x32_bf16 v[140:143], a[92:95], a[156:159], v[140:143]
 s_waitcnt lgkmcnt(6)
 ds_read_b64_tr_b16 a[72:73], v10 offset:0
 buffer_load_dwordx4 v2, s[16:19], s54 offen lds
 v_mfma_f32_16x16x32_bf16 v[148:151], a[96:99], a[128:131], 0
 s_add_u32 s59, s56, 4096
 ds_read_b64_tr_b16 a[74:75], v10 offset:4096
 v_add_u32 v14, v3, v14
 v_mfma_f32_16x16x32_bf16 v[148:151], a[100:103], a[136:139], v[148:151]
 ds_read_b64_tr_b16 a[76:77], v10 offset:16384
 buffer_store_dwordx4 v[160:163], v1, s[12:15], s59 offen offset:2048 sc1
 v_mfma_f32_16x16x32_bf16 v[148:151], a[104:107], a[144:147], v[148:151]
 s_waitcnt lgkmcnt(7)
 ds_read_b64_tr_b16 a[78:79], v10 offset:20480
 v_xor_b32 v7, 320, v6
 v_mfma_f32_16x16x32_bf16 v[148:151], a[108:111], a[152:155], v[148:151]
 s_mul_i32 s38, s38, 896
 ds_read_b64_tr_b16 a[80:81], v7 offset:0
 v_mov_b32 v15, 0xf149f2ca
 v_mfma_f32_16x16x32_bf16 v[156:159], a[96:99], a[132:135], 0
 s_lshl_b32 s39, s37, 7
 ds_read_b64_tr_b16 a[82:83], v7 offset:4096
 v_cmp_gt_i32 vcc, 0, v14
 v_mfma_f32_16x16x32_bf16 v[156:159], a[100:103], a[140:143], v[156:159]
 s_add_u32 s38, s38, s39
 ds_read_b64_tr_b16 a[84:85], v7 offset:16384
 v_cndmask_b32 v3, 0, v15, vcc
 v_mfma_f32_16x16x32_bf16 v[156:159], a[104:107], a[148:151], v[156:159]
 s_add_u32 s59, s56, 20480
 ds_read_b64_tr_b16 a[86:87], v7 offset:20480
 v_xor_b32 v8, 65856, v6
 v_mfma_f32_16x16x32_bf16 v[156:159], a[108:111], a[156:159], v[156:159]
 s_waitcnt lgkmcnt(6)
 ds_read_b64_tr_b16 a[88:89], v8 offset:0
 v_accvgpr_write_b32 a224, v3
 v_mfma_f32_16x16x32_bf16 v[164:167], a[64:67], a[128:131], 0
 ds_read_b64_tr_b16 a[90:91], v8 offset:4096
 buffer_store_dwordx4 v[168:171], v1, s[12:15], s59 offen offset:2048 sc1
 v_mfma_f32_16x16x32_bf16 v[164:167], a[68:71], a[136:139], v[164:167]
 s_lshl_b32 s39, s37, 9
 ds_read_b64_tr_b16 a[92:93], v8 offset:16384
 v_cmp_gt_i32 vcc, 1, v14
 v_mfma_f32_16x16x32_bf16 v[164:167], a[72:75], a[144:147], v[164:167]
 s_waitcnt lgkmcnt(7)
 ds_read_b64_tr_b16 a[94:95], v8 offset:20480
 v_xor_b32 v9, 352, v6
 v_mfma_f32_16x16x32_bf16 v[164:167], a[76:79], a[152:155], v[164:167]
 s_mov_b32 s4, s66
 ds_read_b64_tr_b16 a[96:97], v9 offset:0
 v_cndmask_b32 v3, 0, v15, vcc
 v_mfma_f32_16x16x32_bf16 v[172:175], a[64:67], a[132:135], 0
 s_mov_b32 s5, s67
 ds_read_b64_tr_b16 a[98:99], v9 offset:4096
 v_accvgpr_write_b32 a225, v3
 v_mfma_f32_16x16x32_bf16 v[172:175], a[68:71], a[140:143], v[172:175]
 s_mov_b32 s6, 1835008
 ds_read_b64_tr_b16 a[100:101], v9 offset:16384
 v_cmp_gt_i32 vcc, 2, v14
 v_mfma_f32_16x16x32_bf16 v[172:175], a[72:75], a[148:151], v[172:175]
 s_add_u32 s59, s56, 20480
 ds_read_b64_tr_b16 a[102:103], v9 offset:20480
 v_xor_b32 v10, 65888, v6
 v_mfma_f32_16x16x32_bf16 v[172:175], a[76:79], a[156:159], v[172:175]
 s_waitcnt lgkmcnt(6)
 ds_read_b64_tr_b16 a[104:105], v10 offset:0
 buffer_store_dwordx4 v[176:179], v1, s[12:15], s59 offen offset:3072 sc1
 v_mfma_f32_16x16x32_bf16 v[180:183], a[80:83], a[128:131], 0
 s_mov_b32 s7, 0x20000
 ds_read_b64_tr_b16 a[106:107], v10 offset:4096
 v_cndmask_b32 v3, 0, v15, vcc
 v_mfma_f32_16x16x32_bf16 v[180:183], a[84:87], a[136:139], v[180:183]
 s_mov_b32 s8, s68
 ds_read_b64_tr_b16 a[108:109], v10 offset:16384
 v_accvgpr_write_b32 a226, v3
 v_mfma_f32_16x16x32_bf16 v[180:183], a[88:91], a[144:147], v[180:183]
 s_waitcnt lgkmcnt(7)
 ds_read_b64_tr_b16 a[110:111], v10 offset:20480
 v_xor_b32 v7, 384, v6
 v_mfma_f32_16x16x32_bf16 v[180:183], a[92:95], a[152:155], v[180:183]
 s_mov_b32 s9, s69
 ds_read_b64_tr_b16 a[64:65], v7 offset:0
 v_cmp_gt_i32 vcc, 3, v14
 v_mfma_f32_16x16x32_bf16 v[188:191], a[80:83], a[132:135], 0
 s_mov_b32 s10, 1835008
 ds_read_b64_tr_b16 a[66:67], v7 offset:4096
 v_cndmask_b32 v3, 0, v15, vcc
 v_mfma_f32_16x16x32_bf16 v[188:191], a[84:87], a[140:143], v[188:191]
 s_mov_b32 s11, 0x20000
 ds_read_b64_tr_b16 a[68:69], v7 offset:16384
 v_accvgpr_write_b32 a227, v3
 v_mfma_f32_16x16x32_bf16 v[188:191], a[88:91], a[148:151], v[188:191]
 s_add_u32 s59, s56, 4096
 ds_read_b64_tr_b16 a[70:71], v7 offset:20480
 v_xor_b32 v8, 65920, v6
 v_mfma_f32_16x16x32_bf16 v[188:191], a[92:95], a[156:159], v[188:191]
 s_waitcnt lgkmcnt(6)
 ds_read_b64_tr_b16 a[72:73], v8 offset:0
 buffer_store_dwordx4 v[184:187], v1, s[12:15], s59 offen offset:3072 sc1
 v_mfma_f32_16x16x32_bf16 v[196:199], a[96:99], a[128:131], 0
 s_mov_b32 s20, s70
 ds_read_b64_tr_b16 a[74:75], v8 offset:4096
 v_cmp_gt_i32 vcc, 16, v14
 v_mfma_f32_16x16x32_bf16 v[196:199], a[100:103], a[136:139], v[196:199]
 s_mov_b32 s21, s71
 ds_read_b64_tr_b16 a[76:77], v8 offset:16384
 v_cndmask_b32 v3, 0, v15, vcc
 v_mfma_f32_16x16x32_bf16 v[196:199], a[104:107], a[144:147], v[196:199]
 s_waitcnt lgkmcnt(7)
 ds_read_b64_tr_b16 a[78:79], v8 offset:20480
 v_xor_b32 v9, 416, v6
 v_mfma_f32_16x16x32_bf16 v[196:199], a[108:111], a[152:155], v[196:199]
 s_mov_b32 s22, 3584
 ds_read_b64_tr_b16 a[80:81], v9 offset:0
 v_accvgpr_write_b32 a228, v3
 v_mfma_f32_16x16x32_bf16 v[204:207], a[96:99], a[132:135], 0
 s_mov_b32 s23, 0x20000
 ds_read_b64_tr_b16 a[82:83], v9 offset:4096
 v_cmp_gt_i32 vcc, 17, v14
 v_mfma_f32_16x16x32_bf16 v[204:207], a[100:103], a[140:143], v[204:207]
 ds_read_b64_tr_b16 a[84:85], v9 offset:16384
 v_lshrrev_b32 v120, 3, v0
 v_mfma_f32_16x16x32_bf16 v[204:207], a[104:107], a[148:151], v[204:207]
 s_add_u32 s59, s56, 36864
 ds_read_b64_tr_b16 a[86:87], v9 offset:20480
 v_xor_b32 v10, 65952, v6
 v_mfma_f32_16x16x32_bf16 v[204:207], a[108:111], a[156:159], v[204:207]
 s_waitcnt lgkmcnt(6)
 ds_read_b64_tr_b16 a[88:89], v10 offset:0
 buffer_store_dwordx4 v[192:195], v1, s[12:15], s59 offen offset:0 sc1
 v_mfma_f32_16x16x32_bf16 v[212:215], a[64:67], a[128:131], 0
 ds_read_b64_tr_b16 a[90:91], v10 offset:4096
 v_mul_u32_u24 v120, 1792, v120
 v_mfma_f32_16x16x32_bf16 v[212:215], a[68:71], a[136:139], v[212:215]
 ds_read_b64_tr_b16 a[92:93], v10 offset:16384
 v_and_b32 v121, 7, v0
 v_mfma_f32_16x16x32_bf16 v[212:215], a[72:75], a[144:147], v[212:215]
 s_waitcnt lgkmcnt(7)
 ds_read_b64_tr_b16 a[94:95], v10 offset:20480
 v_xor_b32 v7, 448, v6
 v_mfma_f32_16x16x32_bf16 v[212:215], a[76:79], a[152:155], v[212:215]
 ds_read_b64_tr_b16 a[96:97], v7 offset:0
 v_lshl_add_u32 v120, v121, 4, v120
 v_mfma_f32_16x16x32_bf16 v[220:223], a[64:67], a[132:135], 0
 ds_read_b64_tr_b16 a[98:99], v7 offset:4096
 v_add_u32 v120, s38, v120
 v_mfma_f32_16x16x32_bf16 v[220:223], a[68:71], a[140:143], v[220:223]
 ds_read_b64_tr_b16 a[100:101], v7 offset:16384
 v_lshlrev_b32 v121, 6, v121
 v_mfma_f32_16x16x32_bf16 v[220:223], a[72:75], a[148:151], v[220:223]
 s_add_u32 s59, s56, 53248
 ds_read_b64_tr_b16 a[102:103], v7 offset:20480
 v_xor_b32 v8, 65984, v6
 v_mfma_f32_16x16x32_bf16 v[220:223], a[76:79], a[156:159], v[220:223]
 s_waitcnt lgkmcnt(6)
 ds_read_b64_tr_b16 a[104:105], v8 offset:0
 buffer_store_dwordx4 v[200:203], v1, s[12:15], s59 offen offset:0 sc1
 v_mfma_f32_16x16x32_bf16 v[228:231], a[80:83], a[128:131], 0
 ds_read_b64_tr_b16 a[106:107], v8 offset:4096
 v_subrev_u32 v122, 2688, v120
 v_mfma_f32_16x16x32_bf16 v[228:231], a[84:87], a[136:139], v[228:231]
 ds_read_b64_tr_b16 a[108:109], v8 offset:16384
 v_subrev_u32 v123, 1792, v120
 v_mfma_f32_16x16x32_bf16 v[228:231], a[88:91], a[144:147], v[228:231]
 s_waitcnt lgkmcnt(7)
 ds_read_b64_tr_b16 a[110:111], v8 offset:20480
 v_xor_b32 v9, 480, v6
 v_mfma_f32_16x16x32_bf16 v[228:231], a[92:95], a[152:155], v[228:231]
 ds_read_b64_tr_b16 a[64:65], v9 offset:0
 v_subrev_u32 v128, 896, v120
 v_mfma_f32_16x16x32_bf16 v[236:239], a[80:83], a[132:135], 0
 ds_read_b64_tr_b16 a[66:67], v9 offset:4096
 v_cndmask_b32 v3, 0, v15, vcc
 v_mfma_f32_16x16x32_bf16 v[236:239], a[84:87], a[140:143], v[236:239]
 ds_read_b64_tr_b16 a[68:69], v9 offset:16384
 v_accvgpr_write_b32 a229, v3
 v_mfma_f32_16x16x32_bf16 v[236:239], a[88:91], a[148:151], v[236:239]
 s_add_u32 s59, s56, 53248
 ds_read_b64_tr_b16 a[70:71], v9 offset:20480
 v_xor_b32 v10, 66016, v6
 v_mfma_f32_16x16x32_bf16 v[236:239], a[92:95], a[156:159], v[236:239]
 s_waitcnt lgkmcnt(6)
 ds_read_b64_tr_b16 a[72:73], v10 offset:0
 buffer_store_dwordx4 v[208:211], v1, s[12:15], s59 offen offset:1024 sc1
 v_mfma_f32_16x16x32_bf16 v[244:247], a[96:99], a[128:131], 0
 ds_read_b64_tr_b16 a[74:75], v10 offset:4096
 v_cmp_gt_i32 vcc, 18, v14
 v_mfma_f32_16x16x32_bf16 v[244:247], a[100:103], a[136:139], v[244:247]
 s_waitcnt vmcnt(25)
 ds_read_b64_tr_b16 a[76:77], v10 offset:16384
 v_xor_b32 v7, 32768, v6
 v_mfma_f32_16x16x32_bf16 v[244:247], a[104:107], a[144:147], v[244:247]
 s_waitcnt lgkmcnt(7)
 s_barrier
 ds_read_b64_tr_b16 a[78:79], v10 offset:20480
 v_mfma_f32_16x16x32_bf16 v[244:247], a[108:111], a[152:155], v[244:247]
 ds_read_b64_tr_b16 a[80:81], v7 offset:0
 v_cndmask_b32 v3, 0, v15, vcc
 v_mfma_f32_16x16x32_bf16 v[252:255], a[96:99], a[132:135], 0
 ds_read_b64_tr_b16 a[82:83], v7 offset:4096
 v_accvgpr_write_b32 a230, v3
 v_mfma_f32_16x16x32_bf16 v[252:255], a[100:103], a[140:143], v[252:255]
 ds_read_b64_tr_b16 a[84:85], v7 offset:16384
 v_cmp_gt_i32 vcc, 19, v14
 v_mfma_f32_16x16x32_bf16 v[252:255], a[104:107], a[148:151], v[252:255]
 s_add_u32 s59, s56, 36864
 ds_read_b64_tr_b16 a[86:87], v7 offset:20480
 v_xor_b32 v8, 98304, v6
 v_mfma_f32_16x16x32_bf16 v[252:255], a[108:111], a[156:159], v[252:255]
 s_waitcnt lgkmcnt(6)
 ds_read_b64_tr_b16 a[88:89], v8 offset:0
 buffer_store_dwordx4 v[216:219], v1, s[12:15], s59 offen offset:1024 sc1
 v_mfma_f32_16x16x32_bf16 v[16:19], a[64:67], a[128:131], 0
 ds_read_b64_tr_b16 a[90:91], v8 offset:4096
 v_cndmask_b32 v3, 0, v15, vcc
 v_mfma_f32_16x16x32_bf16 v[16:19], a[68:71], a[136:139], v[16:19]
 ds_read_b64_tr_b16 a[92:93], v8 offset:16384
 v_accvgpr_write_b32 a231, v3
 v_mfma_f32_16x16x32_bf16 v[16:19], a[72:75], a[144:147], v[16:19]
 s_waitcnt lgkmcnt(7)
 ds_read_b64_tr_b16 a[94:95], v8 offset:20480
 v_xor_b32 v9, 32800, v6
 v_mfma_f32_16x16x32_bf16 v[16:19], a[76:79], a[152:155], v[16:19]
 ds_read_b64_tr_b16 a[96:97], v9 offset:0
 v_cmp_gt_i32 vcc, 32, v14
 v_mfma_f32_16x16x32_bf16 v[24:27], a[64:67], a[132:135], 0
 s_waitcnt lgkmcnt(9)
 ds_read_b64_tr_b16 a[98:99], v9 offset:4096
 v_cndmask_b32 v3, 0, v15, vcc
 v_mfma_f32_16x16x32_bf16 v[24:27], a[68:71], a[140:143], v[24:27]
 s_barrier
 ds_read_b64_tr_b16 a[100:101], v9 offset:16384
 v_accvgpr_write_b32 a232, v3
 v_mfma_f32_16x16x32_bf16 v[24:27], a[72:75], a[148:151], v[24:27]
 s_add_u32 m0, s29, 0
 ds_read_b64_tr_b16 a[102:103], v9 offset:20480
 v_xor_b32 v10, 98336, v6
 v_mfma_f32_16x16x32_bf16 v[24:27], a[76:79], a[156:159], v[24:27]
 s_waitcnt lgkmcnt(6)
 ds_read_b64_tr_b16 a[104:105], v10 offset:0
 v_add_u32 v2, 0x80000, v2
 v_mfma_f32_16x16x32_bf16 v[28:31], a[80:83], a[160:163], v[28:31]
 ds_read_b64_tr_b16 a[106:107], v10 offset:4096
 buffer_load_dwordx4 v2, s[16:19], 0 offen lds
 v_mfma_f32_16x16x32_bf16 v[28:31], a[84:87], a[168:171], v[28:31]
 s_add_u32 s59, s56, 36864
 ds_read_b64_tr_b16 a[108:109], v10 offset:16384
 v_cmp_gt_i32 vcc, 33, v14
 v_mfma_f32_16x16x32_bf16 v[28:31], a[88:91], a[176:179], v[28:31]
 s_waitcnt lgkmcnt(7)
 ds_read_b64_tr_b16 a[110:111], v10 offset:20480
 v_xor_b32 v7, 32832, v6
 v_mfma_f32_16x16x32_bf16 v[28:31], a[92:95], a[184:187], v[28:31]
 ds_read_b64_tr_b16 a[64:65], v7 offset:0
 buffer_store_dwordx4 v[224:227], v1, s[12:15], s59 offen offset:2048 sc1
 v_mfma_f32_16x16x32_bf16 v[44:47], a[80:83], a[164:167], v[44:47]
 s_add_u32 m0, s29, 4096
 ds_read_b64_tr_b16 a[66:67], v7 offset:4096
 v_add_u32 v4, 4096, v1
 v_mfma_f32_16x16x32_bf16 v[44:47], a[84:87], a[172:175], v[44:47]
 ds_read_b64_tr_b16 a[68:69], v7 offset:16384
 buffer_load_dwordx4 v2, s[16:19], s48 offen lds
 v_mfma_f32_16x16x32_bf16 v[44:47], a[88:91], a[180:183], v[44:47]
 ds_read_b64_tr_b16 a[70:71], v7 offset:20480
 v_xor_b32 v8, 98368, v6
 v_mfma_f32_16x16x32_bf16 v[44:47], a[92:95], a[188:191], v[44:47]
 s_waitcnt lgkmcnt(6)
 ds_read_b64_tr_b16 a[72:73], v8 offset:0
 v_cndmask_b32 v3, 0, v15, vcc
 v_mfma_f32_16x16x32_bf16 v[52:55], a[96:99], a[160:163], v[52:55]
 ds_read_b64_tr_b16 a[74:75], v8 offset:4096
 v_accvgpr_write_b32 a233, v3
 v_mfma_f32_16x16x32_bf16 v[52:55], a[100:103], a[168:171], v[52:55]
 s_add_u32 m0, s29, 8192
 ds_read_b64_tr_b16 a[76:77], v8 offset:16384
 v_cmp_gt_i32 vcc, 34, v14
 v_mfma_f32_16x16x32_bf16 v[52:55], a[104:107], a[176:179], v[52:55]
 s_waitcnt lgkmcnt(7)
 ds_read_b64_tr_b16 a[78:79], v8 offset:20480
 v_xor_b32 v9, 32864, v6
 v_mfma_f32_16x16x32_bf16 v[52:55], a[108:111], a[184:187], v[52:55]
 ds_read_b64_tr_b16 a[80:81], v9 offset:0
 buffer_load_dwordx4 v2, s[16:19], s49 offen lds
 v_mfma_f32_16x16x32_bf16 v[60:63], a[96:99], a[164:167], v[60:63]
 s_add_u32 s59, s56, 53248
 ds_read_b64_tr_b16 a[82:83], v9 offset:4096
 v_cndmask_b32 v3, 0, v15, vcc
 v_mfma_f32_16x16x32_bf16 v[60:63], a[100:103], a[172:175], v[60:63]
 ds_read_b64_tr_b16 a[84:85], v9 offset:16384
 buffer_store_dwordx4 v[232:235], v1, s[12:15], s59 offen offset:2048 sc1
 v_mfma_f32_16x16x32_bf16 v[60:63], a[104:107], a[180:183], v[60:63]
 s_add_u32 m0, s29, 12288
 ds_read_b64_tr_b16 a[86:87], v9 offset:20480
 v_xor_b32 v10, 98400, v6
 v_mfma_f32_16x16x32_bf16 v[60:63], a[108:111], a[188:191], v[60:63]
 s_waitcnt lgkmcnt(6)
 ds_read_b64_tr_b16 a[88:89], v10 offset:0
 v_accvgpr_write_b32 a234, v3
 v_mfma_f32_16x16x32_bf16 v[20:23], a[64:67], a[160:163], v[20:23]
 ds_read_b64_tr_b16 a[90:91], v10 offset:4096
 buffer_load_dwordx4 v2, s[16:19], s50 offen lds
 v_mfma_f32_16x16x32_bf16 v[20:23], a[68:71], a[168:171], v[20:23]
 ds_read_b64_tr_b16 a[92:93], v10 offset:16384
 v_cmp_gt_i32 vcc, 35, v14
 v_mfma_f32_16x16x32_bf16 v[20:23], a[72:75], a[176:179], v[20:23]
 s_waitcnt lgkmcnt(7)
 ds_read_b64_tr_b16 a[94:95], v10 offset:20480
 v_xor_b32 v7, 32896, v6
 v_mfma_f32_16x16x32_bf16 v[20:23], a[76:79], a[184:187], v[20:23]
 ds_read_b64_tr_b16 a[96:97], v7 offset:0
 v_cndmask_b32 v3, 0, v15, vcc
 v_mfma_f32_16x16x32_bf16 v[36:39], a[64:67], a[164:167], v[36:39]
 s_add_u32 m0, s29, 16384
 ds_read_b64_tr_b16 a[98:99], v7 offset:4096
 v_accvgpr_write_b32 a235, v3
 v_mfma_f32_16x16x32_bf16 v[36:39], a[68:71], a[172:175], v[36:39]
 ds_read_b64_tr_b16 a[100:101], v7 offset:16384
 buffer_load_dwordx4 v2, s[16:19], s51 offen lds
 v_mfma_f32_16x16x32_bf16 v[36:39], a[72:75], a[180:183], v[36:39]
 s_add_u32 s59, s56, 53248
 ds_read_b64_tr_b16 a[102:103], v7 offset:20480
 v_xor_b32 v8, 98432, v6
 v_mfma_f32_16x16x32_bf16 v[36:39], a[76:79], a[188:191], v[36:39]
 s_waitcnt lgkmcnt(6)
 ds_read_b64_tr_b16 a[104:105], v8 offset:0
 buffer_store_dwordx4 v[240:243], v1, s[12:15], s59 offen offset:3072 sc1
 v_mfma_f32_16x16x32_bf16 v[68:71], a[80:83], a[160:163], v[68:71]
 ds_read_b64_tr_b16 a[106:107], v8 offset:4096
 v_cmp_gt_i32 vcc, 48, v14
 v_mfma_f32_16x16x32_bf16 v[68:71], a[84:87], a[168:171], v[68:71]
 s_add_u32 m0, s29, 20480
 ds_read_b64_tr_b16 a[108:109], v8 offset:16384
 v_cndmask_b32 v3, 0, v15, vcc
 v_mfma_f32_16x16x32_bf16 v[68:71], a[88:91], a[176:179], v[68:71]
 s_waitcnt lgkmcnt(7)
 ds_read_b64_tr_b16 a[110:111], v8 offset:20480
 v_xor_b32 v9, 32928, v6
 v_mfma_f32_16x16x32_bf16 v[68:71], a[92:95], a[184:187], v[68:71]
 ds_read_b64_tr_b16 a[64:65], v9 offset:0
 buffer_load_dwordx4 v2, s[16:19], s52 offen lds
 v_mfma_f32_16x16x32_bf16 v[76:79], a[80:83], a[164:167], v[76:79]
 ds_read_b64_tr_b16 a[66:67], v9 offset:4096
 v_accvgpr_write_b32 a236, v3
 v_mfma_f32_16x16x32_bf16 v[76:79], a[84:87], a[172:175], v[76:79]
 ds_read_b64_tr_b16 a[68:69], v9 offset:16384
 v_cmp_gt_i32 vcc, 49, v14
 v_mfma_f32_16x16x32_bf16 v[76:79], a[88:91], a[180:183], v[76:79]
 s_add_u32 m0, s29, 24576
 ds_read_b64_tr_b16 a[70:71], v9 offset:20480
 v_xor_b32 v10, 98464, v6
 v_mfma_f32_16x16x32_bf16 v[76:79], a[92:95], a[188:191], v[76:79]
 s_waitcnt lgkmcnt(6)
 ds_read_b64_tr_b16 a[72:73], v10 offset:0
 v_cndmask_b32 v3, 0, v15, vcc
 v_mfma_f32_16x16x32_bf16 v[84:87], a[96:99], a[160:163], v[84:87]
 ds_read_b64_tr_b16 a[74:75], v10 offset:4096
 buffer_load_dwordx4 v2, s[16:19], s53 offen lds
 v_mfma_f32_16x16x32_bf16 v[84:87], a[100:103], a[168:171], v[84:87]
 s_add_u32 s59, s56, 36864
 ds_read_b64_tr_b16 a[76:77], v10 offset:16384
 v_accvgpr_write_b32 a237, v3
 v_mfma_f32_16x16x32_bf16 v[84:87], a[104:107], a[176:179], v[84:87]
 s_waitcnt lgkmcnt(7)
 ds_read_b64_tr_b16 a[78:79], v10 offset:20480
 v_xor_b32 v7, 32960, v6
 v_mfma_f32_16x16x32_bf16 v[84:87], a[108:111], a[184:187], v[84:87]
 ds_read_b64_tr_b16 a[80:81], v7 offset:0
 buffer_store_dwordx4 v[248:251], v1, s[12:15], s59 offen offset:3072 sc1
 v_mfma_f32_16x16x32_bf16 v[92:95], a[96:99], a[164:167], v[92:95]
 s_add_u32 m0, s29, 28672
 ds_read_b64_tr_b16 a[82:83], v7 offset:4096
 v_cmp_gt_i32 vcc, 50, v14
 v_mfma_f32_16x16x32_bf16 v[92:95], a[100:103], a[172:175], v[92:95]
 ds_read_b64_tr_b16 a[84:85], v7 offset:16384
 buffer_load_dwordx4 v2, s[16:19], s54 offen lds
 v_mfma_f32_16x16x32_bf16 v[92:95], a[104:107], a[180:183], v[92:95]
 ds_read_b64_tr_b16 a[86:87], v7 offset:20480
 v_xor_b32 v8, 98496, v6
 v_mfma_f32_16x16x32_bf16 v[92:95], a[108:111], a[188:191], v[92:95]
 s_waitcnt lgkmcnt(6)
 ds_read_b64_tr_b16 a[88:89], v8 offset:0
 v_cndmask_b32 v3, 0, v15, vcc
 v_mfma_f32_16x16x32_bf16 v[100:103], a[64:67], a[160:163], v[100:103]
 s_add_u32 m0, s29, 65536
 ds_read_b64_tr_b16 a[90:91], v8 offset:4096
 v_add_u32 v2, 0x80000, v2
 v_mfma_f32_16x16x32_bf16 v[100:103], a[68:71], a[168:171], v[100:103]
 ds_read_b64_tr_b16 a[92:93], v8 offset:16384
 buffer_load_dwordx4 v2, s[16:19], 0 offen lds
 v_mfma_f32_16x16x32_bf16 v[100:103], a[72:75], a[176:179], v[100:103]
 s_waitcnt lgkmcnt(7)
 ds_read_b64_tr_b16 a[94:95], v8 offset:20480
 v_xor_b32 v9, 32992, v6
 v_mfma_f32_16x16x32_bf16 v[100:103], a[76:79], a[184:187], v[100:103]
 ds_read_b64_tr_b16 a[96:97], v9 offset:0
 v_accvgpr_write_b32 a238, v3
 v_mfma_f32_16x16x32_bf16 v[108:111], a[64:67], a[164:167], v[108:111]
 ds_read_b64_tr_b16 a[98:99], v9 offset:4096
 v_cmp_gt_i32 vcc, 51, v14
 v_mfma_f32_16x16x32_bf16 v[108:111], a[68:71], a[172:175], v[108:111]
 ds_read_b64_tr_b16 a[100:101], v9 offset:16384
 v_cndmask_b32 v3, 0, v15, vcc
 v_mfma_f32_16x16x32_bf16 v[108:111], a[72:75], a[180:183], v[108:111]
 s_add_u32 m0, s29, 69632
 ds_read_b64_tr_b16 a[102:103], v9 offset:20480
 v_xor_b32 v10, 98528, v6
 v_mfma_f32_16x16x32_bf16 v[108:111], a[76:79], a[188:191], v[108:111]
 s_waitcnt lgkmcnt(6)
 ds_read_b64_tr_b16 a[104:105], v10 offset:0
 buffer_load_dwordx4 v2, s[16:19], s48 offen lds
 v_mfma_f32_16x16x32_bf16 v[116:119], a[80:83], a[160:163], v[116:119]
 ds_read_b64_tr_b16 a[106:107], v10 offset:4096
 v_accvgpr_write_b32 a239, v3
 v_mfma_f32_16x16x32_bf16 v[116:119], a[84:87], a[168:171], v[116:119]
 ds_read_b64_tr_b16 a[108:109], v10 offset:16384
 v_mfma_f32_16x16x32_bf16 v[116:119], a[88:91], a[176:179], v[116:119]
 s_waitcnt lgkmcnt(7)
 ds_read_b64_tr_b16 a[110:111], v10 offset:20480
 v_xor_b32 v7, 33024, v6
 v_mfma_f32_16x16x32_bf16 v[116:119], a[92:95], a[184:187], v[116:119]
 s_add_u32 m0, s29, 73728
 ds_read_b64_tr_b16 a[64:65], v7 offset:0
 v_mfma_f32_16x16x32_bf16 v[124:127], a[80:83], a[164:167], v[124:127]
 ds_read_b64_tr_b16 a[66:67], v7 offset:4096
 buffer_load_dwordx4 v2, s[16:19], s49 offen lds
 v_mfma_f32_16x16x32_bf16 v[124:127], a[84:87], a[172:175], v[124:127]
 ds_read_b64_tr_b16 a[68:69], v7 offset:16384
 v_mfma_f32_16x16x32_bf16 v[124:127], a[88:91], a[180:183], v[124:127]
 ds_read_b64_tr_b16 a[70:71], v7 offset:20480
 v_xor_b32 v8, 98560, v6
 v_mfma_f32_16x16x32_bf16 v[124:127], a[92:95], a[188:191], v[124:127]
 s_waitcnt lgkmcnt(6)
 ds_read_b64_tr_b16 a[72:73], v8 offset:0
 v_mfma_f32_16x16x32_bf16 v[132:135], a[96:99], a[160:163], v[132:135]
 s_add_u32 m0, s29, 77824
 ds_read_b64_tr_b16 a[74:75], v8 offset:4096
 v_mfma_f32_16x16x32_bf16 v[132:135], a[100:103], a[168:171], v[132:135]
 ds_read_b64_tr_b16 a[76:77], v8 offset:16384
 buffer_load_dwordx4 v2, s[16:19], s50 offen lds
 v_mfma_f32_16x16x32_bf16 v[132:135], a[104:107], a[176:179], v[132:135]
 s_waitcnt lgkmcnt(7)
 ds_read_b64_tr_b16 a[78:79], v8 offset:20480
 v_xor_b32 v9, 33056, v6
 v_mfma_f32_16x16x32_bf16 v[132:135], a[108:111], a[184:187], v[132:135]
 ds_read_b64_tr_b16 a[80:81], v9 offset:0
 v_mfma_f32_16x16x32_bf16 v[140:143], a[96:99], a[164:167], v[140:143]
 ds_read_b64_tr_b16 a[82:83], v9 offset:4096
 v_mfma_f32_16x16x32_bf16 v[140:143], a[100:103], a[172:175], v[140:143]
 ds_read_b64_tr_b16 a[84:85], v9 offset:16384
 v_mfma_f32_16x16x32_bf16 v[140:143], a[104:107], a[180:183], v[140:143]
 s_add_u32 m0, s29, 81920
 ds_read_b64_tr_b16 a[86:87], v9 offset:20480
 v_xor_b32 v10, 98592, v6
 v_mfma_f32_16x16x32_bf16 v[140:143], a[108:111], a[188:191], v[140:143]
 s_waitcnt lgkmcnt(6)
 ds_read_b64_tr_b16 a[88:89], v10 offset:0
 buffer_load_dwordx4 v2, s[16:19], s51 offen lds
 v_mfma_f32_16x16x32_bf16 v[148:151], a[64:67], a[160:163], v[148:151]
 ds_read_b64_tr_b16 a[90:91], v10 offset:4096
 v_mfma_f32_16x16x32_bf16 v[148:151], a[68:71], a[168:171], v[148:151]
 ds_read_b64_tr_b16 a[92:93], v10 offset:16384
 v_mfma_f32_16x16x32_bf16 v[148:151], a[72:75], a[176:179], v[148:151]
 s_waitcnt lgkmcnt(7)
 ds_read_b64_tr_b16 a[94:95], v10 offset:20480
 v_xor_b32 v7, 33088, v6
 v_mfma_f32_16x16x32_bf16 v[148:151], a[76:79], a[184:187], v[148:151]
 s_add_u32 m0, s29, 86016
 ds_read_b64_tr_b16 a[96:97], v7 offset:0
 v_mfma_f32_16x16x32_bf16 v[156:159], a[64:67], a[164:167], v[156:159]
 ds_read_b64_tr_b16 a[98:99], v7 offset:4096
 buffer_load_dwordx4 v2, s[16:19], s52 offen lds
 v_mfma_f32_16x16x32_bf16 v[156:159], a[68:71], a[172:175], v[156:159]
 ds_read_b64_tr_b16 a[100:101], v7 offset:16384
 v_mfma_f32_16x16x32_bf16 v[156:159], a[72:75], a[180:183], v[156:159]
 ds_read_b64_tr_b16 a[102:103], v7 offset:20480
 v_xor_b32 v8, 98624, v6
 v_mfma_f32_16x16x32_bf16 v[156:159], a[76:79], a[188:191], v[156:159]
 s_waitcnt lgkmcnt(6)
 ds_read_b64_tr_b16 a[104:105], v8 offset:0
 v_mfma_f32_16x16x32_bf16 v[164:167], a[80:83], a[160:163], v[164:167]
 s_add_u32 m0, s29, 90112
 ds_read_b64_tr_b16 a[106:107], v8 offset:4096
 v_mfma_f32_16x16x32_bf16 v[164:167], a[84:87], a[168:171], v[164:167]
 ds_read_b64_tr_b16 a[108:109], v8 offset:16384
 buffer_load_dwordx4 v2, s[16:19], s53 offen lds
 v_mfma_f32_16x16x32_bf16 v[164:167], a[88:91], a[176:179], v[164:167]
 s_waitcnt lgkmcnt(7)
 ds_read_b64_tr_b16 a[110:111], v8 offset:20480
 v_xor_b32 v9, 33120, v6
 v_mfma_f32_16x16x32_bf16 v[164:167], a[92:95], a[184:187], v[164:167]
 s_waitcnt vmcnt(8)
 ds_read_b64_tr_b16 a[64:65], v9 offset:0
 v_mfma_f32_16x16x32_bf16 v[172:175], a[80:83], a[164:167], v[172:175]
 s_barrier
 ds_read_b64_tr_b16 a[66:67], v9 offset:4096
 v_mfma_f32_16x16x32_bf16 v[172:175], a[84:87], a[172:175], v[172:175]
 ds_read_b64_tr_b16 a[68:69], v9 offset:16384
 buffer_store_dword v11, v11, s[12:15], s92 offen sc1
 v_mfma_f32_16x16x32_bf16 v[172:175], a[88:91], a[180:183], v[172:175]
 s_add_u32 m0, s29, 94208
 ds_read_b64_tr_b16 a[70:71], v9 offset:20480
 v_xor_b32 v10, 98656, v6
 v_mfma_f32_16x16x32_bf16 v[172:175], a[92:95], a[188:191], v[172:175]
 s_waitcnt lgkmcnt(6)
 ds_read_b64_tr_b16 a[72:73], v10 offset:0
 buffer_load_dwordx4 v2, s[16:19], s54 offen lds
 v_mfma_f32_16x16x32_bf16 v[180:183], a[96:99], a[160:163], v[180:183]
 ds_read_b64_tr_b16 a[74:75], v10 offset:4096
 v_mfma_f32_16x16x32_bf16 v[180:183], a[100:103], a[168:171], v[180:183]
 ds_read_b64_tr_b16 a[76:77], v10 offset:16384
 v_mfma_f32_16x16x32_bf16 v[180:183], a[104:107], a[176:179], v[180:183]
 s_waitcnt lgkmcnt(7)
 ds_read_b64_tr_b16 a[78:79], v10 offset:20480
 v_xor_b32 v7, 33152, v6
 v_mfma_f32_16x16x32_bf16 v[180:183], a[108:111], a[184:187], v[180:183]
 ds_read_b64_tr_b16 a[80:81], v7 offset:0
 v_mfma_f32_16x16x32_bf16 v[188:191], a[96:99], a[164:167], v[188:191]
 ds_read_b64_tr_b16 a[82:83], v7 offset:4096
 v_mfma_f32_16x16x32_bf16 v[188:191], a[100:103], a[172:175], v[188:191]
 ds_read_b64_tr_b16 a[84:85], v7 offset:16384
 v_mfma_f32_16x16x32_bf16 v[188:191], a[104:107], a[180:183], v[188:191]
 ds_read_b64_tr_b16 a[86:87], v7 offset:20480
 v_xor_b32 v8, 98688, v6
 v_mfma_f32_16x16x32_bf16 v[188:191], a[108:111], a[188:191], v[188:191]
 s_waitcnt lgkmcnt(6)
 ds_read_b64_tr_b16 a[88:89], v8 offset:0
 v_mfma_f32_16x16x32_bf16 v[196:199], a[64:67], a[160:163], v[196:199]
 s_and_b32 s58, s92, ~127
 ds_read_b64_tr_b16 a[90:91], v8 offset:4096
 v_mfma_f32_16x16x32_bf16 v[196:199], a[68:71], a[168:171], v[196:199]
 s_lshl_b32 s37, s25, 1
 ds_read_b64_tr_b16 a[92:93], v8 offset:16384
 v_mfma_f32_16x16x32_bf16 v[196:199], a[72:75], a[176:179], v[196:199]
 s_waitcnt lgkmcnt(7)
 ds_read_b64_tr_b16 a[94:95], v8 offset:20480
 v_xor_b32 v9, 33184, v6
 v_mfma_f32_16x16x32_bf16 v[196:199], a[76:79], a[184:187], v[196:199]
 s_sub_i32 s38, 12, s37
 ds_read_b64_tr_b16 a[96:97], v9 offset:0
 v_mfma_f32_16x16x32_bf16 v[204:207], a[64:67], a[164:167], v[204:207]
 s_max_i32 s38, s38, 0
 ds_read_b64_tr_b16 a[98:99], v9 offset:4096
 v_mfma_f32_16x16x32_bf16 v[204:207], a[68:71], a[172:175], v[204:207]
 s_mul_i32 s49, s26, 1048576
 ds_read_b64_tr_b16 a[100:101], v9 offset:16384
 v_mfma_f32_16x16x32_bf16 v[204:207], a[72:75], a[180:183], v[204:207]
 s_lshl_b32 s50, s3, 13
 ds_read_b64_tr_b16 a[102:103], v9 offset:20480
 v_xor_b32 v10, 98720, v6
 v_mfma_f32_16x16x32_bf16 v[204:207], a[76:79], a[188:191], v[204:207]
 s_waitcnt lgkmcnt(6)
 ds_read_b64_tr_b16 a[104:105], v10 offset:0
 v_mfma_f32_16x16x32_bf16 v[212:215], a[80:83], a[160:163], v[212:215]
 s_add_u32 s49, s49, s50
 ds_read_b64_tr_b16 a[106:107], v10 offset:4096
 v_mfma_f32_16x16x32_bf16 v[212:215], a[84:87], a[168:171], v[212:215]
 s_mov_b32 s54, 2
 ds_read_b64_tr_b16 a[108:109], v10 offset:16384
 v_mfma_f32_16x16x32_bf16 v[212:215], a[88:91], a[176:179], v[212:215]
 s_waitcnt lgkmcnt(7)
 ds_read_b64_tr_b16 a[110:111], v10 offset:20480
 v_xor_b32 v7, 33216, v6
 v_mfma_f32_16x16x32_bf16 v[212:215], a[92:95], a[184:187], v[212:215]
 s_sub_u32 s44, 31, s37
 ds_read_b64_tr_b16 a[64:65], v7 offset:0
 v_mfma_f32_16x16x32_bf16 v[220:223], a[80:83], a[164:167], v[220:223]
 s_sub_u32 s44, s44, s38
 ds_read_b64_tr_b16 a[66:67], v7 offset:4096
 v_mfma_f32_16x16x32_bf16 v[220:223], a[84:87], a[172:175], v[220:223]
 s_mul_i32 s55, s38, 32768
 ds_read_b64_tr_b16 a[68:69], v7 offset:16384
 v_mfma_f32_16x16x32_bf16 v[220:223], a[88:91], a[180:183], v[220:223]
 s_add_u32 s42, s55, s49
 ds_read_b64_tr_b16 a[70:71], v7 offset:20480
 v_xor_b32 v8, 98752, v6
 v_mfma_f32_16x16x32_bf16 v[220:223], a[92:95], a[188:191], v[220:223]
 s_waitcnt lgkmcnt(6)
 ds_read_b64_tr_b16 a[72:73], v8 offset:0
 buffer_load_dwordx4 v[32:35], v122, s[4:7], 0 offen
 v_mfma_f32_16x16x32_bf16 v[228:231], a[96:99], a[160:163], v[228:231]
 s_add_u32 s60, s58, 16
 ds_read_b64_tr_b16 a[74:75], v8 offset:4096
 v_mfma_f32_16x16x32_bf16 v[228:231], a[100:103], a[168:171], v[228:231]
 s_sub_u32 s45, 17, s37
 ds_read_b64_tr_b16 a[76:77], v8 offset:16384
 v_mfma_f32_16x16x32_bf16 v[228:231], a[104:107], a[176:179], v[228:231]
 s_waitcnt lgkmcnt(7)
 ds_read_b64_tr_b16 a[78:79], v8 offset:20480
 v_xor_b32 v9, 33248, v6
 v_mfma_f32_16x16x32_bf16 v[228:231], a[108:111], a[184:187], v[228:231]
 ds_read_b64_tr_b16 a[80:81], v9 offset:0
 buffer_load_dwordx4 v[40:43], v123, s[4:7], 0 offen
 v_mfma_f32_16x16x32_bf16 v[236:239], a[96:99], a[164:167], v[236:239]
 s_sub_u32 s66, s42, 32768
 ds_read_b64_tr_b16 a[82:83], v9 offset:4096
 v_mfma_f32_16x16x32_bf16 v[236:239], a[100:103], a[172:175], v[236:239]
 s_add_u32 s42, s49, 491520
 ds_read_b64_tr_b16 a[84:85], v9 offset:16384
 v_mfma_f32_16x16x32_bf16 v[236:239], a[104:107], a[180:183], v[236:239]
 s_add_u32 s67, s49, 524288
 ds_read_b64_tr_b16 a[86:87], v9 offset:20480
 v_xor_b32 v10, 98784, v6
 v_mfma_f32_16x16x32_bf16 v[236:239], a[108:111], a[188:191], v[236:239]
 s_waitcnt lgkmcnt(6)
 ds_read_b64_tr_b16 a[88:89], v10 offset:0
 buffer_load_dwordx4 v[48:51], v128, s[4:7], 0 offen
 v_mfma_f32_16x16x32_bf16 v[244:247], a[64:67], a[160:163], v[244:247]
 s_add_u32 s68, s66, 16777216
 ds_read_b64_tr_b16 a[90:91], v10 offset:4096
 v_mfma_f32_16x16x32_bf16 v[244:247], a[68:71], a[168:171], v[244:247]
 s_waitcnt vmcnt(3)
 ds_read_b64_tr_b16 a[92:93], v10 offset:16384
 v_xor_b32 v7, 131072, v6
 v_mfma_f32_16x16x32_bf16 v[244:247], a[72:75], a[176:179], v[244:247]
 s_waitcnt lgkmcnt(7)
 s_barrier
 ds_read_b64_tr_b16 a[94:95], v10 offset:20480
 v_mfma_f32_16x16x32_bf16 v[244:247], a[76:79], a[184:187], v[244:247]
 ds_read_b64_tr_b16 a[96:97], v7 offset:0
 buffer_load_dwordx4 v[56:59], v120, s[4:7], 0 offen offset:0
 v_mfma_f32_16x16x32_bf16 v[252:255], a[64:67], a[164:167], v[252:255]
 s_add_u32 s69, s67, 16777216
 ds_read_b64_tr_b16 a[98:99], v7 offset:4096
 v_mfma_f32_16x16x32_bf16 v[252:255], a[68:71], a[172:175], v[252:255]
 s_mov_b32 s70, 0xffff8000
 ds_read_b64_tr_b16 a[100:101], v7 offset:16384
 v_mfma_f32_16x16x32_bf16 v[252:255], a[72:75], a[180:183], v[252:255]
 s_mov_b32 s71, s70
 ds_read_b64_tr_b16 a[102:103], v7 offset:20480
 v_xor_b32 v8, 0, v6
 v_mfma_f32_16x16x32_bf16 v[252:255], a[76:79], a[188:191], v[252:255]
 s_waitcnt lgkmcnt(6)
 ds_read_b64_tr_b16 a[104:105], v8 offset:0
 buffer_load_dwordx4 v[64:67], v120, s[4:7], 0 offen offset:896
 v_mfma_f32_16x16x32_bf16 v[16:19], a[80:83], a[160:163], v[16:19]
 s_add_u32 s43, s42, 16777216
 ds_read_b64_tr_b16 a[106:107], v8 offset:4096
 v_mfma_f32_16x16x32_bf16 v[16:19], a[84:87], a[168:171], v[16:19]
 s_mov_b32 s40, s50
 ds_read_b64_tr_b16 a[108:109], v8 offset:16384
 v_mfma_f32_16x16x32_bf16 v[16:19], a[88:91], a[176:179], v[16:19]
 s_waitcnt lgkmcnt(7)
 ds_read_b64_tr_b16 a[110:111], v8 offset:20480
 v_xor_b32 v9, 65536, v6
 v_mfma_f32_16x16x32_bf16 v[16:19], a[92:95], a[184:187], v[16:19]
 ds_read_b64_tr_b16 a[64:65], v9 offset:0
 buffer_load_dwordx4 v[72:75], v120, s[8:11], 0 offen offset:0
 v_mfma_f32_16x16x32_bf16 v[24:27], a[80:83], a[164:167], v[24:27]
 s_add_u32 s41, s50, 0x10000
 ds_read_b64_tr_b16 a[66:67], v9 offset:4096
 v_mfma_f32_16x16x32_bf16 v[24:27], a[84:87], a[172:175], v[24:27]
 s_lshr_b32 s61, s95, 4
 ds_read_b64_tr_b16 a[68:69], v9 offset:16384
 v_mfma_f32_16x16x32_bf16 v[24:27], a[88:91], a[180:183], v[24:27]
 s_lshl_b32 s61, s61, 7
 ds_read_b64_tr_b16 a[70:71], v9 offset:20480
 v_xor_b32 v10, 131104, v6
 v_mfma_f32_16x16x32_bf16 v[24:27], a[92:95], a[188:191], v[24:27]
 s_waitcnt lgkmcnt(6)
 ds_read_b64_tr_b16 a[72:73], v10 offset:0
 buffer_load_dwordx4 v[80:83], v120, s[8:11], 0 offen offset:896
 v_mfma_f32_16x16x32_bf16 v[28:31], a[96:99], a[192:195], v[28:31]
 s_add_u32 s61, s61, 84959232
 ds_read_b64_tr_b16 a[74:75], v10 offset:4096
 v_mfma_f32_16x16x32_bf16 v[28:31], a[100:103], a[200:203], v[28:31]
 s_mov_b32 s47, 0x4b800000
 ds_read_b64_tr_b16 a[76:77], v10 offset:16384
 v_mfma_f32_16x16x32_bf16 v[28:31], a[104:107], a[208:211], v[28:31]
 s_waitcnt lgkmcnt(3)
 ds_read_b64_tr_b16 a[78:79], v10 offset:20480
 v_xor_b32 v7, 32, v6
 v_mfma_f32_16x16x32_bf16 v[28:31], a[108:111], a[216:219], v[28:31]
 ds_read_b64_tr_b16 a[80:81], v7 offset:0
 buffer_load_dwordx4 v[88:91], v121, s[20:23], s39 offen offset:0
 v_mfma_f32_16x16x32_bf16 v[28:31], a[64:67], a[112:115], v[28:31]
 s_lshl_b32 s30, s95, 1
 ds_read_b64_tr_b16 a[82:83], v7 offset:4096
 v_mfma_f32_16x16x32_bf16 v[28:31], a[68:71], a[120:123], v[28:31]
 s_lshr_b32 s31, s3, 1
 ds_read_b64_tr_b16 a[84:85], v7 offset:16384
 v_mfma_f32_16x16x32_bf16 v[44:47], a[96:99], a[196:199], v[44:47]
 s_add_u32 s30, s30, s31
 ds_read_b64_tr_b16 a[86:87], v7 offset:20480
 v_xor_b32 v8, 65568, v6
 v_mfma_f32_16x16x32_bf16 v[44:47], a[100:103], a[204:207], v[44:47]
 ds_read_b64_tr_b16 a[88:89], v8 offset:0
 buffer_load_dwordx4 v[96:99], v121, s[20:23], s39 offen offset:16
 v_mfma_f32_16x16x32_bf16 v[44:47], a[104:107], a[212:215], v[44:47]
 s_min_u32 s30, s30, 223
 ds_read_b64_tr_b16 a[90:91], v8 offset:4096
 v_mfma_f32_16x16x32_bf16 v[44:47], a[108:111], a[220:223], v[44:47]
 s_lshl_b32 s30, s30, 2
 ds_read_b64_tr_b16 a[92:93], v8 offset:16384
 v_mfma_f32_16x16x32_bf16 v[44:47], a[64:67], a[116:119], v[44:47]
 ds_read_b64_tr_b16 a[94:95], v8 offset:20480
 v_xor_b32 v9, 131136, v6
 v_mfma_f32_16x16x32_bf16 v[44:47], a[68:71], a[124:127], v[44:47]
 s_waitcnt lgkmcnt(6)
 ds_read_b64_tr_b16 a[96:97], v9 offset:0
 buffer_load_dwordx4 v[104:107], v121, s[20:23], s39 offen offset:32
 v_mfma_f32_16x16x32_bf16 v[52:55], a[72:75], a[192:195], v[52:55]
 ds_read_b64_tr_b16 a[98:99], v9 offset:4096
 v_mfma_f32_16x16x32_bf16 v[52:55], a[76:79], a[200:203], v[52:55]
 ds_read_b64_tr_b16 a[100:101], v9 offset:16384
 v_mfma_f32_16x16x32_bf16 v[52:55], a[80:83], a[208:211], v[52:55]
 s_waitcnt lgkmcnt(3)
 ds_read_b64_tr_b16 a[102:103], v9 offset:20480
 v_xor_b32 v10, 64, v6
 v_mfma_f32_16x16x32_bf16 v[52:55], a[84:87], a[216:219], v[52:55]
 ds_read_b64_tr_b16 a[104:105], v10 offset:0
 buffer_load_dwordx4 v[112:115], v121, s[20:23], s39 offen offset:48
 v_mfma_f32_16x16x32_bf16 v[52:55], a[88:91], a[112:115], v[52:55]
 ds_read_b64_tr_b16 a[106:107], v10 offset:4096
 v_mfma_f32_16x16x32_bf16 v[52:55], a[92:95], a[120:123], v[52:55]
 ds_read_b64_tr_b16 a[108:109], v10 offset:16384
 v_mfma_f32_16x16x32_bf16 v[60:63], a[72:75], a[196:199], v[60:63]
 ds_read_b64_tr_b16 a[110:111], v10 offset:20480
 v_xor_b32 v7, 65600, v6
 v_mfma_f32_16x16x32_bf16 v[60:63], a[76:79], a[204:207], v[60:63]
 ds_read_b64_tr_b16 a[64:65], v7 offset:0
 v_mfma_f32_16x16x32_bf16 v[60:63], a[80:83], a[212:215], v[60:63]
 s_and_b32 s4, s2, 127
 ds_read_b64_tr_b16 a[66:67], v7 offset:4096
 v_mfma_f32_16x16x32_bf16 v[60:63], a[84:87], a[220:223], v[60:63]
 s_lshl_b32 s4, s4, 2
 ds_read_b64_tr_b16 a[68:69], v7 offset:16384
 v_mfma_f32_16x16x32_bf16 v[60:63], a[88:91], a[116:119], v[60:63]
 s_add_u32 s4, s4, s3
 ds_read_b64_tr_b16 a[70:71], v7 offset:20480
 v_xor_b32 v8, 131168, v6
 v_mfma_f32_16x16x32_bf16 v[60:63], a[92:95], a[124:127], v[60:63]
 s_waitcnt lgkmcnt(6)
 ds_read_b64_tr_b16 a[72:73], v8 offset:0
 v_mfma_f32_16x16x32_bf16 v[20:23], a[96:99], a[192:195], v[20:23]
 s_lshl_b32 s6, s4, 10
 ds_read_b64_tr_b16 a[74:75], v8 offset:4096
 v_mfma_f32_16x16x32_bf16 v[20:23], a[100:103], a[200:203], v[20:23]
 s_add_u32 s6, s6, 83886080
 ds_read_b64_tr_b16 a[76:77], v8 offset:16384
 v_mul_f32 v28, s34, v28
 v_mfma_f32_16x16x32_bf16 v[20:23], a[104:107], a[208:211], v[20:23]
 s_waitcnt lgkmcnt(3)
 ds_read_b64_tr_b16 a[78:79], v8 offset:20480
 v_xor_b32 v9, 96, v6
 v_mfma_f32_16x16x32_bf16 v[20:23], a[108:111], a[216:219], v[20:23]
 s_mul_i32 s4, s4, 17408
 ds_read_b64_tr_b16 a[80:81], v9 offset:0
 v_mul_f32 v29, s34, v29
 v_mfma_f32_16x16x32_bf16 v[20:23], a[64:67], a[112:115], v[20:23]
 s_add_u32 s4, s4, 67108864
 ds_read_b64_tr_b16 a[82:83], v9 offset:4096
 v_mul_f32 v30, s34, v30
 v_mfma_f32_16x16x32_bf16 v[20:23], a[68:71], a[120:123], v[20:23]
 s_add_u32 s5, s4, 0x2000
 ds_read_b64_tr_b16 a[84:85], v9 offset:16384
 v_mul_f32 v31, s34, v31
 v_mfma_f32_16x16x32_bf16 v[36:39], a[96:99], a[196:199], v[36:39]
 s_mov_b32 s7, 0
 ds_read_b64_tr_b16 a[86:87], v9 offset:20480
 v_xor_b32 v10, 65632, v6
 v_mfma_f32_16x16x32_bf16 v[36:39], a[100:103], a[204:207], v[36:39]
 s_mov_b32 s53, 0
 ds_read_b64_tr_b16 a[88:89], v10 offset:0
 v_mul_f32 v52, s34, v52
 v_mfma_f32_16x16x32_bf16 v[36:39], a[104:107], a[212:215], v[36:39]
 s_cmp_eq_u32 s38, 0
 s_cmov_b32 s4, 2.0
 ds_read_b64_tr_b16 a[90:91], v10 offset:4096
 v_mfma_f32_16x16x32_bf16 v[36:39], a[108:111], a[220:223], v[36:39]
 s_cmp_eq_u32 s38, 0
 s_cmov_b32 s5, 2.0
 ds_read_b64_tr_b16 a[92:93], v10 offset:16384
 v_mfma_f32_16x16x32_bf16 v[36:39], a[64:67], a[116:119], v[36:39]
 s_cmp_eq_u32 s38, 0
 s_cmov_b32 s6, 2.0
 ds_read_b64_tr_b16 a[94:95], v10 offset:20480
 v_xor_b32 v7, 131200, v6
 v_mfma_f32_16x16x32_bf16 v[36:39], a[68:71], a[124:127], v[36:39]
 s_waitcnt lgkmcnt(6)
 ds_read_b64_tr_b16 a[96:97], v7 offset:0
 v_mul_f32 v53, s34, v53
 v_mfma_f32_16x16x32_bf16 v[68:71], a[72:75], a[192:195], v[68:71]
 s_mov_b64 s[8:9], s[12:13]
 ds_read_b64_tr_b16 a[98:99], v7 offset:4096
 v_mul_f32 v54, s34, v54
 v_mfma_f32_16x16x32_bf16 v[68:71], a[76:79], a[200:203], v[68:71]
 s_mov_b32 s10, s14
 ds_read_b64_tr_b16 a[100:101], v7 offset:16384
 v_mul_f32 v55, s34, v55
 v_mfma_f32_16x16x32_bf16 v[68:71], a[80:83], a[208:211], v[68:71]
 s_waitcnt lgkmcnt(3)
 ds_read_b64_tr_b16 a[102:103], v7 offset:20480
 v_xor_b32 v8, 128, v6
 v_mfma_f32_16x16x32_bf16 v[68:71], a[84:87], a[216:219], v[68:71]
 s_mov_b32 s76, 0
 ds_read_b64_tr_b16 a[104:105], v8 offset:0
 v_cvt_pk_bf16_f32 v28, v28, v29
 v_mfma_f32_16x16x32_bf16 v[68:71], a[88:91], a[112:115], v[68:71]
 s_movk_i32 s77, 0x1000
 ds_read_b64_tr_b16 a[106:107], v8 offset:4096
 v_cvt_pk_bf16_f32 v29, v30, v31
 v_mfma_f32_16x16x32_bf16 v[68:71], a[92:95], a[120:123], v[68:71]
 s_mov_b32 s51, 0
 ds_read_b64_tr_b16 a[108:109], v8 offset:16384
 v_cvt_pk_bf16_f32 v30, v52, v53
 v_mfma_f32_16x16x32_bf16 v[76:79], a[72:75], a[196:199], v[76:79]
 s_mul_i32 s78, s26, 229376
 ds_read_b64_tr_b16 a[110:111], v8 offset:20480
 v_xor_b32 v9, 65664, v6
 v_mfma_f32_16x16x32_bf16 v[76:79], a[76:79], a[204:207], v[76:79]
 s_add_u32 s79, s78, 28672
 ds_read_b64_tr_b16 a[64:65], v9 offset:0
 v_cvt_pk_bf16_f32 v31, v54, v55
 v_mfma_f32_16x16x32_bf16 v[76:79], a[80:83], a[212:215], v[76:79]
 s_add_u32 s80, s78, 57344
 ds_read_b64_tr_b16 a[66:67], v9 offset:4096
 v_accvgpr_write_b32 a0, v28
 v_mfma_f32_16x16x32_bf16 v[76:79], a[84:87], a[220:223], v[76:79]
 s_add_u32 s81, s78, 86016
 ds_read_b64_tr_b16 a[68:69], v9 offset:16384
 v_accvgpr_write_b32 a1, v29
 v_mfma_f32_16x16x32_bf16 v[76:79], a[88:91], a[116:119], v[76:79]
 s_add_u32 s82, s78, 114688
 ds_read_b64_tr_b16 a[70:71], v9 offset:20480
 v_xor_b32 v10, 131232, v6
 v_mfma_f32_16x16x32_bf16 v[76:79], a[92:95], a[124:127], v[76:79]
 s_waitcnt lgkmcnt(6)
 ds_read_b64_tr_b16 a[72:73], v10 offset:0
 v_accvgpr_write_b32 a2, v30
 v_mfma_f32_16x16x32_bf16 v[84:87], a[96:99], a[192:195], v[84:87]
 s_add_u32 s83, s78, 143360
 ds_read_b64_tr_b16 a[74:75], v10 offset:4096
 v_accvgpr_write_b32 a3, v31
 v_mfma_f32_16x16x32_bf16 v[84:87], a[100:103], a[200:203], v[84:87]
 s_add_u32 s84, s78, 172032
 ds_read_b64_tr_b16 a[76:77], v10 offset:16384
 v_mul_f32 v44, s34, v44
 v_mfma_f32_16x16x32_bf16 v[84:87], a[104:107], a[208:211], v[84:87]
 s_waitcnt lgkmcnt(3)
 ds_read_b64_tr_b16 a[78:79], v10 offset:20480
 v_xor_b32 v7, 160, v6
 v_mfma_f32_16x16x32_bf16 v[84:87], a[108:111], a[216:219], v[84:87]
 s_add_u32 s85, s78, 200704
 ds_read_b64_tr_b16 a[80:81], v7 offset:0
 v_mul_f32 v45, s34, v45
 v_mfma_f32_16x16x32_bf16 v[84:87], a[64:67], a[112:115], v[84:87]
 s_add_u32 s59, s62, 0
 ds_read_b64_tr_b16 a[82:83], v7 offset:4096
 v_mul_f32 v46, s34, v46
 v_mfma_f32_16x16x32_bf16 v[84:87], a[68:71], a[120:123], v[84:87]
 ds_read_b64_tr_b16 a[84:85], v7 offset:16384
 buffer_store_dwordx4 v[28:31], v1, s[12:15], s59 offen offset:0 sc1
 v_mfma_f32_16x16x32_bf16 v[92:95], a[96:99], a[196:199], v[92:95]
 ds_read_b64_tr_b16 a[86:87], v7 offset:20480
 v_xor_b32 v8, 65696, v6
 v_mfma_f32_16x16x32_bf16 v[92:95], a[100:103], a[204:207], v[92:95]
 ds_read_b64_tr_b16 a[88:89], v8 offset:0
 v_mul_f32 v47, s34, v47
 v_mfma_f32_16x16x32_bf16 v[92:95], a[104:107], a[212:215], v[92:95]
 ds_read_b64_tr_b16 a[90:91], v8 offset:4096
 v_mul_f32 v60, s34, v60
 v_mfma_f32_16x16x32_bf16 v[92:95], a[108:111], a[220:223], v[92:95]
 ds_read_b64_tr_b16 a[92:93], v8 offset:16384
 v_mul_f32 v61, s34, v61
 v_mfma_f32_16x16x32_bf16 v[92:95], a[64:67], a[116:119], v[92:95]
 ds_read_b64_tr_b16 a[94:95], v8 offset:20480
 v_xor_b32 v9, 131264, v6
 v_mfma_f32_16x16x32_bf16 v[92:95], a[68:71], a[124:127], v[92:95]
 s_waitcnt lgkmcnt(6)
 ds_read_b64_tr_b16 a[96:97], v9 offset:0
 v_mul_f32 v62, s34, v62
 v_mfma_f32_16x16x32_bf16 v[100:103], a[72:75], a[192:195], v[100:103]
 ds_read_b64_tr_b16 a[98:99], v9 offset:4096
 v_mul_f32 v63, s34, v63
 v_mfma_f32_16x16x32_bf16 v[100:103], a[76:79], a[200:203], v[100:103]
 ds_read_b64_tr_b16 a[100:101], v9 offset:16384
 v_cvt_pk_bf16_f32 v44, v44, v45
 v_mfma_f32_16x16x32_bf16 v[100:103], a[80:83], a[208:211], v[100:103]
 s_waitcnt lgkmcnt(3)
 ds_read_b64_tr_b16 a[102:103], v9 offset:20480
 v_xor_b32 v10, 192, v6
 v_mfma_f32_16x16x32_bf16 v[100:103], a[84:87], a[216:219], v[100:103]
 ds_read_b64_tr_b16 a[104:105], v10 offset:0
 v_cvt_pk_bf16_f32 v45, v46, v47
 v_mfma_f32_16x16x32_bf16 v[100:103], a[88:91], a[112:115], v[100:103]
 ds_read_b64_tr_b16 a[106:107], v10 offset:4096
 v_cvt_pk_bf16_f32 v46, v60, v61
 v_mfma_f32_16x16x32_bf16 v[100:103], a[92:95], a[120:123], v[100:103]
 ds_read_b64_tr_b16 a[108:109], v10 offset:16384
 v_cvt_pk_bf16_f32 v47, v62, v63
 v_mfma_f32_16x16x32_bf16 v[108:111], a[72:75], a[196:199], v[108:111]
 s_add_u32 s59, s62, 8192
 ds_read_b64_tr_b16 a[110:111], v10 offset:20480
 v_xor_b32 v7, 65728, v6
 v_mfma_f32_16x16x32_bf16 v[108:111], a[76:79], a[204:207], v[108:111]
 ds_read_b64_tr_b16 a[64:65], v7 offset:0
 buffer_store_dwordx4 v[44:47], v1, s[12:15], s59 offen offset:0 sc1
 v_mfma_f32_16x16x32_bf16 v[108:111], a[80:83], a[212:215], v[108:111]
 ds_read_b64_tr_b16 a[66:67], v7 offset:4096
 v_accvgpr_write_b32 a32, v44
 v_mfma_f32_16x16x32_bf16 v[108:111], a[84:87], a[220:223], v[108:111]
 ds_read_b64_tr_b16 a[68:69], v7 offset:16384
 v_accvgpr_write_b32 a33, v45
 v_mfma_f32_16x16x32_bf16 v[108:111], a[88:91], a[116:119], v[108:111]
 ds_read_b64_tr_b16 a[70:71], v7 offset:20480
 v_xor_b32 v8, 131296, v6
 v_mfma_f32_16x16x32_bf16 v[108:111], a[92:95], a[124:127], v[108:111]
 s_waitcnt lgkmcnt(6)
 ds_read_b64_tr_b16 a[72:73], v8 offset:0
 v_accvgpr_write_b32 a34, v46
 v_mfma_f32_16x16x32_bf16 v[116:119], a[96:99], a[192:195], v[116:119]
 ds_read_b64_tr_b16 a[74:75], v8 offset:4096
 v_accvgpr_write_b32 a35, v47
 v_mfma_f32_16x16x32_bf16 v[116:119], a[100:103], a[200:203], v[116:119]
 ds_read_b64_tr_b16 a[76:77], v8 offset:16384
 v_mul_f32 v20, s34, v20
 v_mfma_f32_16x16x32_bf16 v[116:119], a[104:107], a[208:211], v[116:119]
 s_waitcnt lgkmcnt(3)
 ds_read_b64_tr_b16 a[78:79], v8 offset:20480
 v_xor_b32 v9, 224, v6
 v_mfma_f32_16x16x32_bf16 v[116:119], a[108:111], a[216:219], v[116:119]
 ds_read_b64_tr_b16 a[80:81], v9 offset:0
 v_mul_f32 v21, s34, v21
 v_mfma_f32_16x16x32_bf16 v[116:119], a[64:67], a[112:115], v[116:119]
 ds_read_b64_tr_b16 a[82:83], v9 offset:4096
 v_mul_f32 v22, s34, v22
 v_mfma_f32_16x16x32_bf16 v[116:119], a[68:71], a[120:123], v[116:119]
 ds_read_b64_tr_b16 a[84:85], v9 offset:16384
 v_mul_f32 v23, s34, v23
 v_mfma_f32_16x16x32_bf16 v[124:127], a[96:99], a[196:199], v[124:127]
 ds_read_b64_tr_b16 a[86:87], v9 offset:20480
 v_xor_b32 v10, 65760, v6
 v_mfma_f32_16x16x32_bf16 v[124:127], a[100:103], a[204:207], v[124:127]
 ds_read_b64_tr_b16 a[88:89], v10 offset:0
 v_mul_f32 v68, s34, v68
 v_mfma_f32_16x16x32_bf16 v[124:127], a[104:107], a[212:215], v[124:127]
 ds_read_b64_tr_b16 a[90:91], v10 offset:4096
 v_mul_f32 v69, s34, v69
 v_mfma_f32_16x16x32_bf16 v[124:127], a[108:111], a[220:223], v[124:127]
 ds_read_b64_tr_b16 a[92:93], v10 offset:16384
 v_mul_f32 v70, s34, v70
 v_mfma_f32_16x16x32_bf16 v[124:127], a[64:67], a[116:119], v[124:127]
 ds_read_b64_tr_b16 a[94:95], v10 offset:20480
 v_xor_b32 v7, 131328, v6
 v_mfma_f32_16x16x32_bf16 v[124:127], a[68:71], a[124:127], v[124:127]
 s_waitcnt lgkmcnt(6)
 ds_read_b64_tr_b16 a[96:97], v7 offset:0
 v_mul_f32 v71, s34, v71
 v_mfma_f32_16x16x32_bf16 v[132:135], a[72:75], a[192:195], v[132:135]
 ds_read_b64_tr_b16 a[98:99], v7 offset:4096
 v_cvt_pk_bf16_f32 v20, v20, v21
 v_mfma_f32_16x16x32_bf16 v[132:135], a[76:79], a[200:203], v[132:135]
 ds_read_b64_tr_b16 a[100:101], v7 offset:16384
 v_cvt_pk_bf16_f32 v21, v22, v23
 v_mfma_f32_16x16x32_bf16 v[132:135], a[80:83], a[208:211], v[132:135]
 s_waitcnt lgkmcnt(3)
 ds_read_b64_tr_b16 a[102:103], v7 offset:20480
 v_xor_b32 v8, 256, v6
 v_mfma_f32_16x16x32_bf16 v[132:135], a[84:87], a[216:219], v[132:135]
 ds_read_b64_tr_b16 a[104:105], v8 offset:0
 v_cvt_pk_bf16_f32 v22, v68, v69
 v_mfma_f32_16x16x32_bf16 v[132:135], a[88:91], a[112:115], v[132:135]
 s_add_u32 s59, s62, 0
 ds_read_b64_tr_b16 a[106:107], v8 offset:4096
 v_cvt_pk_bf16_f32 v23, v70, v71
 v_mfma_f32_16x16x32_bf16 v[132:135], a[92:95], a[120:123], v[132:135]
 ds_read_b64_tr_b16 a[108:109], v8 offset:16384
 buffer_store_dwordx4 v[20:23], v1, s[12:15], s59 offen offset:1024 sc1
 v_mfma_f32_16x16x32_bf16 v[140:143], a[72:75], a[196:199], v[140:143]
 ds_read_b64_tr_b16 a[110:111], v8 offset:20480
 v_xor_b32 v9, 65792, v6
 v_mfma_f32_16x16x32_bf16 v[140:143], a[76:79], a[204:207], v[140:143]
 ds_read_b64_tr_b16 a[64:65], v9 offset:0
 v_accvgpr_write_b32 a4, v20
 v_mfma_f32_16x16x32_bf16 v[140:143], a[80:83], a[212:215], v[140:143]
 ds_read_b64_tr_b16 a[66:67], v9 offset:4096
 v_accvgpr_write_b32 a5, v21
 v_mfma_f32_16x16x32_bf16 v[140:143], a[84:87], a[220:223], v[140:143]
 ds_read_b64_tr_b16 a[68:69], v9 offset:16384
 v_accvgpr_write_b32 a6, v22
 v_mfma_f32_16x16x32_bf16 v[140:143], a[88:91], a[116:119], v[140:143]
 ds_read_b64_tr_b16 a[70:71], v9 offset:20480
 v_xor_b32 v10, 131360, v6
 v_mfma_f32_16x16x32_bf16 v[140:143], a[92:95], a[124:127], v[140:143]
 s_waitcnt lgkmcnt(6)
 ds_read_b64_tr_b16 a[72:73], v10 offset:0
 v_accvgpr_write_b32 a7, v23
 v_mfma_f32_16x16x32_bf16 v[148:151], a[96:99], a[192:195], v[148:151]
 ds_read_b64_tr_b16 a[74:75], v10 offset:4096
 v_mul_f32 v36, s34, v36
 v_mfma_f32_16x16x32_bf16 v[148:151], a[100:103], a[200:203], v[148:151]
 ds_read_b64_tr_b16 a[76:77], v10 offset:16384
 v_mul_f32 v37, s34, v37
 v_mfma_f32_16x16x32_bf16 v[148:151], a[104:107], a[208:211], v[148:151]
 s_waitcnt lgkmcnt(3)
 ds_read_b64_tr_b16 a[78:79], v10 offset:20480
 v_xor_b32 v7, 288, v6
 v_mfma_f32_16x16x32_bf16 v[148:151], a[108:111], a[216:219], v[148:151]
 ds_read_b64_tr_b16 a[80:81], v7 offset:0
 v_mul_f32 v38, s34, v38
 v_mfma_f32_16x16x32_bf16 v[148:151], a[64:67], a[112:115], v[148:151]
 ds_read_b64_tr_b16 a[82:83], v7 offset:4096
 v_mul_f32 v39, s34, v39
 v_mfma_f32_16x16x32_bf16 v[148:151], a[68:71], a[120:123], v[148:151]
 ds_read_b64_tr_b16 a[84:85], v7 offset:16384
 v_mul_f32 v76, s34, v76
 v_mfma_f32_16x16x32_bf16 v[156:159], a[96:99], a[196:199], v[156:159]
 ds_read_b64_tr_b16 a[86:87], v7 offset:20480
 v_xor_b32 v8, 65824, v6
 v_mfma_f32_16x16x32_bf16 v[156:159], a[100:103], a[204:207], v[156:159]
 ds_read_b64_tr_b16 a[88:89], v8 offset:0
 v_mul_f32 v77, s34, v77
 v_mfma_f32_16x16x32_bf16 v[156:159], a[104:107], a[212:215], v[156:159]
 ds_read_b64_tr_b16 a[90:91], v8 offset:4096
 v_mul_f32 v78, s34, v78
 v_mfma_f32_16x16x32_bf16 v[156:159], a[108:111], a[220:223], v[156:159]
 ds_read_b64_tr_b16 a[92:93], v8 offset:16384
 v_mul_f32 v79, s34, v79
 v_mfma_f32_16x16x32_bf16 v[156:159], a[64:67], a[116:119], v[156:159]
 ds_read_b64_tr_b16 a[94:95], v8 offset:20480
 v_xor_b32 v9, 131392, v6
 v_mfma_f32_16x16x32_bf16 v[156:159], a[68:71], a[124:127], v[156:159]
 s_waitcnt lgkmcnt(6)
 ds_read_b64_tr_b16 a[96:97], v9 offset:0
 v_cvt_pk_bf16_f32 v36, v36, v37
 v_mfma_f32_16x16x32_bf16 v[164:167], a[72:75], a[192:195], v[164:167]
 ds_read_b64_tr_b16 a[98:99], v9 offset:4096
 v_cvt_pk_bf16_f32 v37, v38, v39
 v_mfma_f32_16x16x32_bf16 v[164:167], a[76:79], a[200:203], v[164:167]
 ds_read_b64_tr_b16 a[100:101], v9 offset:16384
 v_cvt_pk_bf16_f32 v38, v76, v77
 v_mfma_f32_16x16x32_bf16 v[164:167], a[80:83], a[208:211], v[164:167]
 s_waitcnt lgkmcnt(3)
 ds_read_b64_tr_b16 a[102:103], v9 offset:20480
 v_xor_b32 v10, 320, v6
 v_mfma_f32_16x16x32_bf16 v[164:167], a[84:87], a[216:219], v[164:167]
 s_add_u32 s59, s62, 8192
 ds_read_b64_tr_b16 a[104:105], v10 offset:0
 v_cvt_pk_bf16_f32 v39, v78, v79
 v_mfma_f32_16x16x32_bf16 v[164:167], a[88:91], a[112:115], v[164:167]
 ds_read_b64_tr_b16 a[106:107], v10 offset:4096
 buffer_store_dwordx4 v[36:39], v1, s[12:15], s59 offen offset:1024 sc1
 v_mfma_f32_16x16x32_bf16 v[164:167], a[92:95], a[120:123], v[164:167]
 ds_read_b64_tr_b16 a[108:109], v10 offset:16384
 v_accvgpr_write_b32 a36, v36
 v_mfma_f32_16x16x32_bf16 v[172:175], a[72:75], a[196:199], v[172:175]
 ds_read_b64_tr_b16 a[110:111], v10 offset:20480
 v_xor_b32 v7, 65856, v6
 v_mfma_f32_16x16x32_bf16 v[172:175], a[76:79], a[204:207], v[172:175]
 ds_read_b64_tr_b16 a[64:65], v7 offset:0
 v_accvgpr_write_b32 a37, v37
 v_mfma_f32_16x16x32_bf16 v[172:175], a[80:83], a[212:215], v[172:175]
 ds_read_b64_tr_b16 a[66:67], v7 offset:4096
 v_accvgpr_write_b32 a38, v38
 v_mfma_f32_16x16x32_bf16 v[172:175], a[84:87], a[220:223], v[172:175]
 ds_read_b64_tr_b16 a[68:69], v7 offset:16384
 v_accvgpr_write_b32 a39, v39
 v_mfma_f32_16x16x32_bf16 v[172:175], a[88:91], a[116:119], v[172:175]
 ds_read_b64_tr_b16 a[70:71], v7 offset:20480
 v_xor_b32 v8, 131424, v6
 v_mfma_f32_16x16x32_bf16 v[172:175], a[92:95], a[124:127], v[172:175]
 s_waitcnt lgkmcnt(6)
 ds_read_b64_tr_b16 a[72:73], v8 offset:0
 v_mul_f32 v84, s34, v84
 v_mfma_f32_16x16x32_bf16 v[180:183], a[96:99], a[192:195], v[180:183]
 ds_read_b64_tr_b16 a[74:75], v8 offset:4096
 v_mul_f32 v85, s34, v85
 v_mfma_f32_16x16x32_bf16 v[180:183], a[100:103], a[200:203], v[180:183]
 ds_read_b64_tr_b16 a[76:77], v8 offset:16384
 v_mul_f32 v86, s34, v86
 v_mfma_f32_16x16x32_bf16 v[180:183], a[104:107], a[208:211], v[180:183]
 s_waitcnt lgkmcnt(3)
 ds_read_b64_tr_b16 a[78:79], v8 offset:20480
 v_xor_b32 v9, 352, v6
 v_mfma_f32_16x16x32_bf16 v[180:183], a[108:111], a[216:219], v[180:183]
 ds_read_b64_tr_b16 a[80:81], v9 offset:0
 v_mul_f32 v87, s34, v87
 v_mfma_f32_16x16x32_bf16 v[180:183], a[64:67], a[112:115], v[180:183]
 ds_read_b64_tr_b16 a[82:83], v9 offset:4096
 v_mul_f32 v100, s34, v100
 v_mfma_f32_16x16x32_bf16 v[180:183], a[68:71], a[120:123], v[180:183]
 ds_read_b64_tr_b16 a[84:85], v9 offset:16384
 v_mul_f32 v101, s34, v101
 v_mfma_f32_16x16x32_bf16 v[188:191], a[96:99], a[196:199], v[188:191]
 ds_read_b64_tr_b16 a[86:87], v9 offset:20480
 v_xor_b32 v10, 65888, v6
 v_mfma_f32_16x16x32_bf16 v[188:191], a[100:103], a[204:207], v[188:191]
 ds_read_b64_tr_b16 a[88:89], v10 offset:0
 v_mul_f32 v102, s34, v102
 v_mfma_f32_16x16x32_bf16 v[188:191], a[104:107], a[212:215], v[188:191]
 ds_read_b64_tr_b16 a[90:91], v10 offset:4096
 v_mul_f32 v103, s34, v103
 v_mfma_f32_16x16x32_bf16 v[188:191], a[108:111], a[220:223], v[188:191]
 ds_read_b64_tr_b16 a[92:93], v10 offset:16384
 v_cvt_pk_bf16_f32 v84, v84, v85
 v_mfma_f32_16x16x32_bf16 v[188:191], a[64:67], a[116:119], v[188:191]
 ds_read_b64_tr_b16 a[94:95], v10 offset:20480
 v_xor_b32 v7, 131456, v6
 v_mfma_f32_16x16x32_bf16 v[188:191], a[68:71], a[124:127], v[188:191]
 s_waitcnt lgkmcnt(6)
 ds_read_b64_tr_b16 a[96:97], v7 offset:0
 v_cvt_pk_bf16_f32 v85, v86, v87
 v_mfma_f32_16x16x32_bf16 v[196:199], a[72:75], a[192:195], v[196:199]
 ds_read_b64_tr_b16 a[98:99], v7 offset:4096
 v_cvt_pk_bf16_f32 v86, v100, v101
 v_mfma_f32_16x16x32_bf16 v[196:199], a[76:79], a[200:203], v[196:199]
 s_add_u32 s59, s62, 0
 ds_read_b64_tr_b16 a[100:101], v7 offset:16384
 v_cvt_pk_bf16_f32 v87, v102, v103
 v_mfma_f32_16x16x32_bf16 v[196:199], a[80:83], a[208:211], v[196:199]
 s_waitcnt lgkmcnt(3)
 ds_read_b64_tr_b16 a[102:103], v7 offset:20480
 v_xor_b32 v8, 384, v6
 v_mfma_f32_16x16x32_bf16 v[196:199], a[84:87], a[216:219], v[196:199]
 ds_read_b64_tr_b16 a[104:105], v8 offset:0
 buffer_store_dwordx4 v[84:87], v1, s[12:15], s59 offen offset:2048 sc1
 v_mfma_f32_16x16x32_bf16 v[196:199], a[88:91], a[112:115], v[196:199]
 ds_read_b64_tr_b16 a[106:107], v8 offset:4096
 v_accvgpr_write_b32 a8, v84
 v_mfma_f32_16x16x32_bf16 v[196:199], a[92:95], a[120:123], v[196:199]
 ds_read_b64_tr_b16 a[108:109], v8 offset:16384
 v_accvgpr_write_b32 a9, v85
 v_mfma_f32_16x16x32_bf16 v[204:207], a[72:75], a[196:199], v[204:207]
 ds_read_b64_tr_b16 a[110:111], v8 offset:20480
 v_xor_b32 v9, 65920, v6
 v_mfma_f32_16x16x32_bf16 v[204:207], a[76:79], a[204:207], v[204:207]
 ds_read_b64_tr_b16 a[64:65], v9 offset:0
 v_accvgpr_write_b32 a10, v86
 v_mfma_f32_16x16x32_bf16 v[204:207], a[80:83], a[212:215], v[204:207]
 ds_read_b64_tr_b16 a[66:67], v9 offset:4096
 v_accvgpr_write_b32 a11, v87
 v_mfma_f32_16x16x32_bf16 v[204:207], a[84:87], a[220:223], v[204:207]
 ds_read_b64_tr_b16 a[68:69], v9 offset:16384
 v_mul_f32 v92, s34, v92
 v_mfma_f32_16x16x32_bf16 v[204:207], a[88:91], a[116:119], v[204:207]
 ds_read_b64_tr_b16 a[70:71], v9 offset:20480
 v_xor_b32 v10, 131488, v6
 v_mfma_f32_16x16x32_bf16 v[204:207], a[92:95], a[124:127], v[204:207]
 s_waitcnt lgkmcnt(6)
 ds_read_b64_tr_b16 a[72:73], v10 offset:0
 v_mul_f32 v93, s34, v93
 v_mfma_f32_16x16x32_bf16 v[212:215], a[96:99], a[192:195], v[212:215]
 ds_read_b64_tr_b16 a[74:75], v10 offset:4096
 v_mul_f32 v94, s34, v94
 v_mfma_f32_16x16x32_bf16 v[212:215], a[100:103], a[200:203], v[212:215]
 ds_read_b64_tr_b16 a[76:77], v10 offset:16384
 v_mul_f32 v95, s34, v95
 v_mfma_f32_16x16x32_bf16 v[212:215], a[104:107], a[208:211], v[212:215]
 s_waitcnt lgkmcnt(3)
 ds_read_b64_tr_b16 a[78:79], v10 offset:20480
 v_xor_b32 v7, 416, v6
 v_mfma_f32_16x16x32_bf16 v[212:215], a[108:111], a[216:219], v[212:215]
 ds_read_b64_tr_b16 a[80:81], v7 offset:0
 v_mul_f32 v108, s34, v108
 v_mfma_f32_16x16x32_bf16 v[212:215], a[64:67], a[112:115], v[212:215]
 ds_read_b64_tr_b16 a[82:83], v7 offset:4096
 v_mul_f32 v109, s34, v109
 v_mfma_f32_16x16x32_bf16 v[212:215], a[68:71], a[120:123], v[212:215]
 ds_read_b64_tr_b16 a[84:85], v7 offset:16384
 v_mul_f32 v110, s34, v110
 v_mfma_f32_16x16x32_bf16 v[220:223], a[96:99], a[196:199], v[220:223]
 ds_read_b64_tr_b16 a[86:87], v7 offset:20480
 v_xor_b32 v8, 65952, v6
 v_mfma_f32_16x16x32_bf16 v[220:223], a[100:103], a[204:207], v[220:223]
 ds_read_b64_tr_b16 a[88:89], v8 offset:0
 v_mul_f32 v111, s34, v111
 v_mfma_f32_16x16x32_bf16 v[220:223], a[104:107], a[212:215], v[220:223]
 ds_read_b64_tr_b16 a[90:91], v8 offset:4096
 v_cvt_pk_bf16_f32 v92, v92, v93
 v_mfma_f32_16x16x32_bf16 v[220:223], a[108:111], a[220:223], v[220:223]
 ds_read_b64_tr_b16 a[92:93], v8 offset:16384
 v_cvt_pk_bf16_f32 v93, v94, v95
 v_mfma_f32_16x16x32_bf16 v[220:223], a[64:67], a[116:119], v[220:223]
 ds_read_b64_tr_b16 a[94:95], v8 offset:20480
 v_xor_b32 v9, 131520, v6
 v_mfma_f32_16x16x32_bf16 v[220:223], a[68:71], a[124:127], v[220:223]
 s_waitcnt lgkmcnt(6)
 ds_read_b64_tr_b16 a[96:97], v9 offset:0
 v_cvt_pk_bf16_f32 v94, v108, v109
 v_mfma_f32_16x16x32_bf16 v[228:231], a[72:75], a[192:195], v[228:231]
 s_add_u32 s59, s62, 8192
 ds_read_b64_tr_b16 a[98:99], v9 offset:4096
 v_cvt_pk_bf16_f32 v95, v110, v111
 v_mfma_f32_16x16x32_bf16 v[228:231], a[76:79], a[200:203], v[228:231]
 ds_read_b64_tr_b16 a[100:101], v9 offset:16384
 buffer_store_dwordx4 v[92:95], v1, s[12:15], s59 offen offset:2048 sc1
 v_mfma_f32_16x16x32_bf16 v[228:231], a[80:83], a[208:211], v[228:231]
 s_waitcnt lgkmcnt(3)
 ds_read_b64_tr_b16 a[102:103], v9 offset:20480
 v_xor_b32 v10, 448, v6
 v_mfma_f32_16x16x32_bf16 v[228:231], a[84:87], a[216:219], v[228:231]
 ds_read_b64_tr_b16 a[104:105], v10 offset:0
 v_accvgpr_write_b32 a40, v92
 v_mfma_f32_16x16x32_bf16 v[228:231], a[88:91], a[112:115], v[228:231]
 ds_read_b64_tr_b16 a[106:107], v10 offset:4096
 v_accvgpr_write_b32 a41, v93
 v_mfma_f32_16x16x32_bf16 v[228:231], a[92:95], a[120:123], v[228:231]
 ds_read_b64_tr_b16 a[108:109], v10 offset:16384
 v_accvgpr_write_b32 a42, v94
 v_mfma_f32_16x16x32_bf16 v[236:239], a[72:75], a[196:199], v[236:239]
 ds_read_b64_tr_b16 a[110:111], v10 offset:20480
 v_xor_b32 v7, 65984, v6
 v_mfma_f32_16x16x32_bf16 v[236:239], a[76:79], a[204:207], v[236:239]
 ds_read_b64_tr_b16 a[64:65], v7 offset:0
 buffer_load_dword v13, v12, s[12:15], s58 offen sc1
 v_mfma_f32_16x16x32_bf16 v[236:239], a[80:83], a[212:215], v[236:239]
 ds_read_b64_tr_b16 a[66:67], v7 offset:4096
 v_accvgpr_write_b32 a43, v95
 v_mfma_f32_16x16x32_bf16 v[236:239], a[84:87], a[220:223], v[236:239]
 ds_read_b64_tr_b16 a[68:69], v7 offset:16384
 v_mul_f32 v116, s34, v116
 v_mfma_f32_16x16x32_bf16 v[236:239], a[88:91], a[116:119], v[236:239]
 ds_read_b64_tr_b16 a[70:71], v7 offset:20480
 v_xor_b32 v8, 131552, v6
 v_mfma_f32_16x16x32_bf16 v[236:239], a[92:95], a[124:127], v[236:239]
 s_waitcnt lgkmcnt(6)
 ds_read_b64_tr_b16 a[72:73], v8 offset:0
 v_mul_f32 v117, s34, v117
 v_mfma_f32_16x16x32_bf16 v[244:247], a[96:99], a[192:195], v[244:247]
 ds_read_b64_tr_b16 a[74:75], v8 offset:4096
 v_mul_f32 v118, s34, v118
 v_mfma_f32_16x16x32_bf16 v[244:247], a[100:103], a[200:203], v[244:247]
 ds_read_b64_tr_b16 a[76:77], v8 offset:16384
 v_mul_f32 v119, s34, v119
 v_mfma_f32_16x16x32_bf16 v[244:247], a[104:107], a[208:211], v[244:247]
 s_waitcnt lgkmcnt(3)
 ds_read_b64_tr_b16 a[78:79], v8 offset:20480
 v_xor_b32 v9, 480, v6
 v_mfma_f32_16x16x32_bf16 v[244:247], a[108:111], a[216:219], v[244:247]
 ds_read_b64_tr_b16 a[80:81], v9 offset:0
 v_mul_f32 v132, s34, v132
 v_mfma_f32_16x16x32_bf16 v[244:247], a[64:67], a[112:115], v[244:247]
 ds_read_b64_tr_b16 a[82:83], v9 offset:4096
 v_mul_f32 v133, s34, v133
 v_mfma_f32_16x16x32_bf16 v[244:247], a[68:71], a[120:123], v[244:247]
 ds_read_b64_tr_b16 a[84:85], v9 offset:16384
 v_mul_f32 v134, s34, v134
 v_mfma_f32_16x16x32_bf16 v[252:255], a[96:99], a[196:199], v[252:255]
 ds_read_b64_tr_b16 a[86:87], v9 offset:20480
 v_xor_b32 v10, 66016, v6
 v_mfma_f32_16x16x32_bf16 v[252:255], a[100:103], a[204:207], v[252:255]
 ds_read_b64_tr_b16 a[88:89], v10 offset:0
 v_mul_f32 v135, s34, v135
 v_mfma_f32_16x16x32_bf16 v[252:255], a[104:107], a[212:215], v[252:255]
 ds_read_b64_tr_b16 a[90:91], v10 offset:4096
 v_cvt_pk_bf16_f32 v116, v116, v117
 v_mfma_f32_16x16x32_bf16 v[252:255], a[108:111], a[220:223], v[252:255]
 ds_read_b64_tr_b16 a[92:93], v10 offset:16384
 v_cvt_pk_bf16_f32 v117, v118, v119
 v_mfma_f32_16x16x32_bf16 v[252:255], a[64:67], a[116:119], v[252:255]
 s_add_u32 s59, s62, 0
 ds_read_b64_tr_b16 a[94:95], v10 offset:20480
 v_cvt_pk_bf16_f32 v118, v132, v133
 v_mfma_f32_16x16x32_bf16 v[252:255], a[68:71], a[124:127], v[252:255]
 s_waitcnt lgkmcnt(6)
 v_cvt_pk_bf16_f32 v119, v134, v135
 v_accvgpr_write_b32 a12, v116
 v_mfma_f32_16x16x32_bf16 v[16:19], a[72:75], a[192:195], v[16:19]
 buffer_store_dwordx4 v[116:119], v1, s[12:15], s59 offen offset:3072 sc1
 v_mfma_f32_16x16x32_bf16 v[16:19], a[76:79], a[200:203], v[16:19]
 v_accvgpr_write_b32 a13, v117
 v_accvgpr_write_b32 a14, v118
 v_mfma_f32_16x16x32_bf16 v[16:19], a[80:83], a[208:211], v[16:19]
 s_waitcnt lgkmcnt(0)
 v_accvgpr_write_b32 a15, v119
 v_mfma_f32_16x16x32_bf16 v[16:19], a[84:87], a[216:219], v[16:19]
 v_mfma_f32_16x16x32_bf16 v[16:19], a[88:91], a[112:115], v[16:19]
 v_mfma_f32_16x16x32_bf16 v[16:19], a[92:95], a[120:123], v[16:19]
 v_mfma_f32_16x16x32_bf16 v[24:27], a[72:75], a[196:199], v[24:27]
 v_mfma_f32_16x16x32_bf16 v[24:27], a[76:79], a[204:207], v[24:27]
 v_mfma_f32_16x16x32_bf16 v[24:27], a[80:83], a[212:215], v[24:27]
 v_mfma_f32_16x16x32_bf16 v[24:27], a[84:87], a[220:223], v[24:27]
 s_waitcnt lgkmcnt(0)
 v_mfma_f32_16x16x32_bf16 v[24:27], a[88:91], a[116:119], v[24:27]
 s_barrier
 v_mfma_f32_16x16x32_bf16 v[24:27], a[92:95], a[124:127], v[24:27]
 s_waitcnt vmcnt(1)
 v_cmp_ne_u32 s[16:17], 0, v13
 v_cmp_gt_u32 vcc, 256, v5
 s_or_b64 vcc, vcc, s[16:17]
 s_mov_b32 m0, s40
 s_cselect_b32 s48, 0, 1
 s_cselect_b32 s52, 2.0, s42
 buffer_load_dwordx4 v1, s[12:15], s52 offen offset:0 sc1 lds
 v_pk_mul_f32 v[124:125], v[124:125], s[34:35]
 v_pk_mul_f32 v[126:127], v[126:127], s[34:35]
 v_pk_mul_f32 v[140:141], v[140:141], s[34:35]
 v_pk_mul_f32 v[142:143], v[142:143], s[34:35]
 v_cvt_pk_bf16_f32 v124, v124, v125
 v_cvt_pk_bf16_f32 v125, v126, v127
 v_cvt_pk_bf16_f32 v126, v140, v141
 v_cvt_pk_bf16_f32 v127, v142, v143
 s_add_u32 s59, s62, 8192
 buffer_store_dwordx4 v[124:127], v1, s[12:15], s59 offen offset:3072 sc1
 v_accvgpr_write_b32 a44, v124
 v_accvgpr_write_b32 a45, v125
 v_accvgpr_write_b32 a46, v126
 v_accvgpr_write_b32 a47, v127
 v_pk_mul_f32 v[148:149], v[148:149], s[34:35]
 v_pk_mul_f32 v[150:151], v[150:151], s[34:35]
 buffer_load_dwordx4 v1, s[12:15], s52 offen offset:1024 sc1 lds
 v_pk_mul_f32 v[164:165], v[164:165], s[34:35]
 v_pk_mul_f32 v[166:167], v[166:167], s[34:35]
 v_cvt_pk_bf16_f32 v148, v148, v149
 v_cvt_pk_bf16_f32 v149, v150, v151
 v_cvt_pk_bf16_f32 v150, v164, v165
 v_cvt_pk_bf16_f32 v151, v166, v167
 s_add_u32 s59, s62, 4096
 buffer_store_dwordx4 v[148:151], v1, s[12:15], s59 offen offset:0 sc1
 v_accvgpr_write_b32 a16, v148
 v_accvgpr_write_b32 a17, v149
 v_accvgpr_write_b32 a18, v150
 v_accvgpr_write_b32 a19, v151
 v_pk_mul_f32 v[156:157], v[156:157], s[34:35]
 v_pk_mul_f32 v[158:159], v[158:159], s[34:35]
 v_pk_mul_f32 v[172:173], v[172:173], s[34:35]
 v_pk_mul_f32 v[174:175], v[174:175], s[34:35]
 buffer_load_dwordx4 v1, s[12:15], s52 offen offset:2048 sc1 lds
 v_cvt_pk_bf16_f32 v156, v156, v157
 v_cvt_pk_bf16_f32 v157, v158, v159
 v_cvt_pk_bf16_f32 v158, v172, v173
 v_cvt_pk_bf16_f32 v159, v174, v175
 s_add_u32 s59, s62, 12288
 buffer_store_dwordx4 v[156:159], v1, s[12:15], s59 offen offset:0 sc1
 v_accvgpr_write_b32 a48, v156
 v_accvgpr_write_b32 a49, v157
 v_accvgpr_write_b32 a50, v158
 v_accvgpr_write_b32 a51, v159
 v_pk_mul_f32 v[180:181], v[180:181], s[34:35]
 v_pk_mul_f32 v[182:183], v[182:183], s[34:35]
 v_pk_mul_f32 v[196:197], v[196:197], s[34:35]
 v_pk_mul_f32 v[198:199], v[198:199], s[34:35]
 v_cvt_pk_bf16_f32 v180, v180, v181
 v_cvt_pk_bf16_f32 v181, v182, v183
 buffer_load_dwordx4 v1, s[12:15], s52 offen offset:3072 sc1 lds
 v_cvt_pk_bf16_f32 v182, v196, v197
 v_cvt_pk_bf16_f32 v183, v198, v199
 s_add_u32 s59, s62, 4096
 buffer_store_dwordx4 v[180:183], v1, s[12:15], s59 offen offset:1024 sc1
 v_accvgpr_write_b32 a20, v180
 v_accvgpr_write_b32 a21, v181
 v_accvgpr_write_b32 a22, v182
 v_accvgpr_write_b32 a23, v183
 v_pk_mul_f32 v[188:189], v[188:189], s[34:35]
 v_pk_mul_f32 v[190:191], v[190:191], s[34:35]
 v_pk_mul_f32 v[204:205], v[204:205], s[34:35]
 v_pk_mul_f32 v[206:207], v[206:207], s[34:35]
 v_cvt_pk_bf16_f32 v188, v188, v189
 v_cvt_pk_bf16_f32 v189, v190, v191
 v_cvt_pk_bf16_f32 v190, v204, v205
 s_bitset1_b32 m0, 12
 s_nop 0
 buffer_load_dwordx4 v4, s[12:15], s52 offen offset:0 sc1 lds
 v_cvt_pk_bf16_f32 v191, v206, v207
 s_add_u32 s59, s62, 12288
 buffer_store_dwordx4 v[188:191], v1, s[12:15], s59 offen offset:1024 sc1
 v_accvgpr_write_b32 a52, v188
 v_accvgpr_write_b32 a53, v189
 v_accvgpr_write_b32 a54, v190
 v_accvgpr_write_b32 a55, v191
 v_pk_mul_f32 v[212:213], v[212:213], s[34:35]
 v_pk_mul_f32 v[214:215], v[214:215], s[34:35]
 v_pk_mul_f32 v[228:229], v[228:229], s[34:35]
 v_pk_mul_f32 v[230:231], v[230:231], s[34:35]
 v_cvt_pk_bf16_f32 v212, v212, v213
 v_cvt_pk_bf16_f32 v213, v214, v215
 v_cvt_pk_bf16_f32 v214, v228, v229
 v_cvt_pk_bf16_f32 v215, v230, v231
 s_add_u32 s59, s62, 4096
 buffer_load_dwordx4 v4, s[12:15], s52 offen offset:1024 sc1 lds
 buffer_store_dwordx4 v[212:215], v1, s[12:15], s59 offen offset:2048 sc1
 v_accvgpr_write_b32 a24, v212
 v_accvgpr_write_b32 a25, v213
 v_accvgpr_write_b32 a26, v214
 v_accvgpr_write_b32 a27, v215
 v_pk_mul_f32 v[220:221], v[220:221], s[34:35]
 v_pk_mul_f32 v[222:223], v[222:223], s[34:35]
 v_pk_mul_f32 v[236:237], v[236:237], s[34:35]
 v_pk_mul_f32 v[238:239], v[238:239], s[34:35]
 v_cvt_pk_bf16_f32 v220, v220, v221
 v_cvt_pk_bf16_f32 v221, v222, v223
 v_cvt_pk_bf16_f32 v222, v236, v237
 v_cvt_pk_bf16_f32 v223, v238, v239
 s_add_u32 s59, s62, 12288
 buffer_store_dwordx4 v[220:223], v1, s[12:15], s59 offen offset:2048 sc1
 v_accvgpr_write_b32 a56, v220
 buffer_load_dwordx4 v4, s[12:15], s52 offen offset:2048 sc1 lds
 v_accvgpr_write_b32 a57, v221
 v_accvgpr_write_b32 a58, v222
 v_accvgpr_write_b32 a59, v223
 v_pk_mul_f32 v[244:245], v[244:245], s[34:35]
 v_pk_mul_f32 v[246:247], v[246:247], s[34:35]
 v_pk_mul_f32 v[16:17], v[16:17], s[34:35]
 v_pk_mul_f32 v[18:19], v[18:19], s[34:35]
 v_cvt_pk_bf16_f32 v244, v244, v245
 v_cvt_pk_bf16_f32 v245, v246, v247
 v_cvt_pk_bf16_f32 v246, v16, v17
 v_cvt_pk_bf16_f32 v247, v18, v19
 s_add_u32 s59, s62, 4096
 buffer_store_dwordx4 v[244:247], v1, s[12:15], s59 offen offset:3072 sc1
 v_accvgpr_write_b32 a28, v244
 v_accvgpr_write_b32 a29, v245
 v_accvgpr_write_b32 a30, v246
 buffer_load_dwordx4 v4, s[12:15], s52 offen offset:3072 sc1 lds
 v_accvgpr_write_b32 a31, v247
 v_pk_mul_f32 v[252:253], v[252:253], s[34:35]
 v_pk_mul_f32 v[254:255], v[254:255], s[34:35]
 v_pk_mul_f32 v[24:25], v[24:25], s[34:35]
 v_pk_mul_f32 v[26:27], v[26:27], s[34:35]
 v_cvt_pk_bf16_f32 v252, v252, v253
 v_cvt_pk_bf16_f32 v253, v254, v255
 v_cvt_pk_bf16_f32 v254, v24, v25
 v_cvt_pk_bf16_f32 v255, v26, v27
 s_add_u32 s59, s62, 12288
 buffer_store_dwordx4 v[252:255], v1, s[12:15], s59 offen offset:3072 sc1
 v_accvgpr_write_b32 a60, v252
 v_accvgpr_write_b32 a61, v253
 v_accvgpr_write_b32 a62, v254
 v_accvgpr_write_b32 a63, v255
 s_branch L_kvdone
L_late1:
 v_mfma_f32_16x16x32_bf16 v[16:19], a[96:99], a[0:3], v[16:19]
 ds_read_b64_tr_b16 a[24:25], v9 offset:32768
 v_mfma_f32_16x16x32_bf16 v[16:19], a[100:103], a[4:7], v[16:19]
 s_add_u32 m0, s33, 0xfffffd00
 ds_read_b64_tr_b16 a[26:27], v9 offset:36864
 v_mfma_f32_16x16x32_bf16 v[20:23], a[108:111], a[4:7], v[20:23]
 s_waitcnt lgkmcnt(13)
 ds_read_b64_tr_b16 a[28:29], v9 offset:49152
 v_mfma_f32_16x16x32_bf16 v[20:23], a[104:107], a[0:3], v[20:23]
 ds_read_b64_tr_b16 a[30:31], v9 offset:53248
 buffer_load_dwordx4 v15, s[20:23], 0 offen offset:768 lds
 v_mfma_f32_16x16x32_bf16 v[24:27], a[112:115], a[0:3], v[24:27]
 s_waitcnt lgkmcnt(12)
 ds_read_b128 a[64:67], v4 offset:32768
 v_mfma_f32_16x16x32_bf16 v[24:27], a[116:119], a[4:7], v[24:27]
 v_mfma_f32_16x16x32_bf16 v[28:31], a[124:127], a[4:7], v[28:31]
 s_add_u32 m0, s33, 0xfffffd80
 ds_read_b128 a[68:71], v5 offset:32768
 v_mfma_f32_16x16x32_bf16 v[28:31], a[120:123], a[0:3], v[28:31]
 s_waitcnt lgkmcnt(10)
 buffer_load_dwordx4 v15, s[20:23], 0 offen offset:1664 lds
 v_mfma_f32_16x16x32_bf16 a[228:231], a[120:123], a[8:11], a[228:231]
 ds_read_b128 a[76:79], v5 offset:34816
 v_mfma_f32_16x16x32_bf16 a[228:231], a[124:127], a[12:15], a[228:231]
 v_mfma_f32_16x16x32_bf16 a[224:227], a[116:119], a[12:15], a[224:227]
 s_add_u32 m0, s33, 0x500
 ds_read_b128 a[72:75], v4 offset:34816
 v_mfma_f32_16x16x32_bf16 a[224:227], a[112:115], a[8:11], a[224:227]
 buffer_load_dwordx4 v15, s[20:23], s57 offen offset:768 lds
 v_mfma_f32_16x16x32_bf16 a[236:239], a[104:107], a[8:11], a[236:239]
 ds_read_b128 a[80:83], v4 offset:36864
 v_cvt_pk_bf16_f32 v16, v16, v17
 v_mfma_f32_16x16x32_bf16 a[236:239], a[108:111], a[12:15], a[236:239]
 v_cvt_pk_bf16_f32 v17, v18, v19
 v_cvt_pk_bf16_f32 v18, v20, v21
 v_mfma_f32_16x16x32_bf16 a[232:235], a[100:103], a[12:15], a[232:235]
 s_add_u32 m0, s33, 0x580
 ds_read_b128 a[84:87], v5 offset:36864
 v_cvt_pk_bf16_f32 v19, v22, v23
 v_mfma_f32_16x16x32_bf16 a[232:235], a[96:99], a[8:11], a[232:235]
 s_waitcnt lgkmcnt(10)
 buffer_load_dwordx4 v15, s[20:23], s57 offen offset:1664 lds
 v_mfma_f32_16x16x32_bf16 v[32:35], a[96:99], a[16:19], v[32:35]
 ds_read_b128 a[92:95], v5 offset:38912
 v_cvt_pk_bf16_f32 v24, v24, v25
 v_mfma_f32_16x16x32_bf16 v[32:35], a[100:103], a[20:23], v[32:35]
 v_cvt_pk_bf16_f32 v25, v26, v27
 v_cvt_pk_bf16_f32 v26, v28, v29
 v_mfma_f32_16x16x32_bf16 v[36:39], a[108:111], a[20:23], v[36:39]
 ds_read_b128 a[88:91], v4 offset:38912
 v_cvt_pk_bf16_f32 v27, v30, v31
 v_mfma_f32_16x16x32_bf16 v[36:39], a[104:107], a[16:19], v[36:39]
 v_accvgpr_read_b32 v20, a224
 v_accvgpr_read_b32 v21, a225
 v_mfma_f32_16x16x32_bf16 v[40:43], a[112:115], a[16:19], v[40:43]
 ds_read_b64_tr_b16 a[32:33], v10 offset:32768
 v_accvgpr_read_b32 v22, a226
 v_mfma_f32_16x16x32_bf16 v[40:43], a[116:119], a[20:23], v[40:43]
 ds_read_b64_tr_b16 a[34:35], v10 offset:36864
 v_accvgpr_read_b32 v23, a227
 v_mfma_f32_16x16x32_bf16 v[44:47], a[124:127], a[20:23], v[44:47]
 s_add_u32 s59, s56, 32768
 ds_read_b64_tr_b16 a[36:37], v10 offset:49152
 v_accvgpr_read_b32 v28, a228
 v_mfma_f32_16x16x32_bf16 v[44:47], a[120:123], a[16:19], v[44:47]
 s_waitcnt lgkmcnt(11)
 ds_read_b64_tr_b16 a[38:39], v10 offset:53248
 v_accvgpr_read_b32 v29, a229
 v_mfma_f32_16x16x32_bf16 v[52:55], a[120:123], a[24:27], v[52:55]
 ds_read_b64_tr_b16 a[40:41], v11 offset:32768
 buffer_store_dwordx4 v[16:19], v1, s[12:15], s59 offen offset:0 sc1
 v_mfma_f32_16x16x32_bf16 v[52:55], a[124:127], a[28:31], v[52:55]
 ds_read_b64_tr_b16 a[42:43], v11 offset:36864
 v_accvgpr_read_b32 v30, a230
 v_mfma_f32_16x16x32_bf16 v[48:51], a[116:119], a[28:31], v[48:51]
 ds_read_b64_tr_b16 a[44:45], v11 offset:49152
 v_accvgpr_read_b32 v31, a231
 v_mfma_f32_16x16x32_bf16 v[48:51], a[112:115], a[24:27], v[48:51]
 ds_read_b64_tr_b16 a[46:47], v11 offset:53248
 v_cvt_pk_bf16_f32 v20, v20, v21
 v_mfma_f32_16x16x32_bf16 v[60:63], a[104:107], a[24:27], v[60:63]
 ds_read_b64_tr_b16 a[48:49], v12 offset:32768
 v_cvt_pk_bf16_f32 v21, v22, v23
 v_mfma_f32_16x16x32_bf16 v[60:63], a[108:111], a[28:31], v[60:63]
 ds_read_b64_tr_b16 a[50:51], v12 offset:36864
 v_cvt_pk_bf16_f32 v22, v28, v29
 v_mfma_f32_16x16x32_bf16 v[56:59], a[100:103], a[28:31], v[56:59]
 s_add_u32 s59, s56, 49152
 ds_read_b64_tr_b16 a[52:53], v12 offset:49152
 v_cvt_pk_bf16_f32 v23, v30, v31
 v_mfma_f32_16x16x32_bf16 v[56:59], a[96:99], a[24:27], v[56:59]
 s_waitcnt lgkmcnt(15)
 ds_read_b64_tr_b16 a[54:55], v12 offset:53248
 buffer_store_dwordx4 v[24:27], v1, s[12:15], s59 offen offset:0 sc1
 v_mfma_f32_16x16x32_bf16 v[64:67], a[64:67], a[0:3], v[64:67]
 ds_read_b64_tr_b16 a[56:57], v13 offset:32768
 v_cvt_pk_bf16_f32 v32, v32, v33
 v_mfma_f32_16x16x32_bf16 v[64:67], a[68:71], a[4:7], v[64:67]
 ds_read_b64_tr_b16 a[58:59], v13 offset:36864
 v_cvt_pk_bf16_f32 v33, v34, v35
 v_mfma_f32_16x16x32_bf16 v[68:71], a[76:79], a[4:7], v[68:71]
 ds_read_b64_tr_b16 a[60:61], v13 offset:49152
 v_cvt_pk_bf16_f32 v34, v36, v37
 v_mfma_f32_16x16x32_bf16 v[68:71], a[72:75], a[0:3], v[68:71]
 s_waitcnt lgkmcnt(15)
 ds_read_b64_tr_b16 a[62:63], v13 offset:53248
 v_cvt_pk_bf16_f32 v35, v38, v39
 v_mfma_f32_16x16x32_bf16 v[72:75], a[80:83], a[0:3], v[72:75]
 v_cvt_pk_bf16_f32 v40, v40, v41
 v_cvt_pk_bf16_f32 v41, v42, v43
 v_mfma_f32_16x16x32_bf16 v[72:75], a[84:87], a[4:7], v[72:75]
 s_add_u32 s59, s56, 49152
 v_cvt_pk_bf16_f32 v42, v44, v45
 v_cvt_pk_bf16_f32 v43, v46, v47
 v_mfma_f32_16x16x32_bf16 v[76:79], a[92:95], a[4:7], v[76:79]
 buffer_store_dwordx4 v[20:23], v1, s[12:15], s59 offen offset:1024 sc1
 v_mfma_f32_16x16x32_bf16 v[76:79], a[88:91], a[0:3], v[76:79]
 s_waitcnt lgkmcnt(0)
 v_accvgpr_read_b32 v36, a232
 v_accvgpr_read_b32 v37, a233
 v_mfma_f32_16x16x32_bf16 v[84:87], a[88:91], a[8:11], v[84:87]
 s_barrier
 v_xor_b32 v6, s60, v6
 v_accvgpr_read_b32 v38, a234
 v_mfma_f32_16x16x32_bf16 v[84:87], a[92:95], a[12:15], v[84:87]
 s_add_u32 m0, s29, 32768
 v_add_u32 v2, 0x80000, v2
 v_accvgpr_read_b32 v39, a235
 v_mfma_f32_16x16x32_bf16 v[80:83], a[84:87], a[12:15], v[80:83]
 buffer_load_dwordx4 v2, s[16:19], 0 offen lds
 v_mfma_f32_16x16x32_bf16 v[80:83], a[80:83], a[8:11], v[80:83]
 v_accvgpr_read_b32 v44, a236
 v_accvgpr_read_b32 v45, a237
 v_mfma_f32_16x16x32_bf16 v[92:95], a[72:75], a[8:11], v[92:95]
 v_accvgpr_read_b32 v46, a238
 v_accvgpr_read_b32 v47, a239
 v_mfma_f32_16x16x32_bf16 v[92:95], a[76:79], a[12:15], v[92:95]
 v_cvt_pk_bf16_f32 v36, v36, v37
 v_cvt_pk_bf16_f32 v37, v38, v39
 v_mfma_f32_16x16x32_bf16 v[88:91], a[68:71], a[12:15], v[88:91]
 s_add_u32 m0, s29, 36864
 v_cvt_pk_bf16_f32 v38, v44, v45
 v_cvt_pk_bf16_f32 v39, v46, v47
 v_mfma_f32_16x16x32_bf16 v[88:91], a[64:67], a[8:11], v[88:91]
 buffer_load_dwordx4 v2, s[16:19], s48 offen lds
 v_mfma_f32_16x16x32_bf16 v[96:99], a[64:67], a[16:19], v[96:99]
 v_cvt_pk_bf16_f32 v48, v48, v49
 v_cvt_pk_bf16_f32 v49, v50, v51
 v_mfma_f32_16x16x32_bf16 v[96:99], a[68:71], a[20:23], v[96:99]
 v_cvt_pk_bf16_f32 v50, v52, v53
 v_cvt_pk_bf16_f32 v51, v54, v55
 v_mfma_f32_16x16x32_bf16 v[100:103], a[76:79], a[20:23], v[100:103]
 v_cvt_pk_bf16_f32 v56, v56, v57
 v_cvt_pk_bf16_f32 v57, v58, v59
 v_mfma_f32_16x16x32_bf16 v[100:103], a[72:75], a[16:19], v[100:103]
 s_add_u32 m0, s29, 40960
 v_cvt_pk_bf16_f32 v58, v60, v61
 v_cvt_pk_bf16_f32 v59, v62, v63
 v_mfma_f32_16x16x32_bf16 v[104:107], a[80:83], a[16:19], v[104:107]
 buffer_load_dwordx4 v2, s[16:19], s49 offen lds
 v_mfma_f32_16x16x32_bf16 v[104:107], a[84:87], a[20:23], v[104:107]
 v_cvt_pk_bf16_f32 v64, v64, v65
 v_cvt_pk_bf16_f32 v65, v66, v67
 v_mfma_f32_16x16x32_bf16 v[108:111], a[92:95], a[20:23], v[108:111]
 v_cvt_pk_bf16_f32 v66, v68, v69
 v_cvt_pk_bf16_f32 v67, v70, v71
 v_mfma_f32_16x16x32_bf16 v[108:111], a[88:91], a[16:19], v[108:111]
 v_cvt_pk_bf16_f32 v72, v72, v73
 v_cvt_pk_bf16_f32 v73, v74, v75
 v_mfma_f32_16x16x32_bf16 v[116:119], a[88:91], a[24:27], v[116:119]
 s_add_u32 m0, s29, 45056
 v_cvt_pk_bf16_f32 v74, v76, v77
 v_cvt_pk_bf16_f32 v75, v78, v79
 v_mfma_f32_16x16x32_bf16 v[116:119], a[92:95], a[28:31], v[116:119]
 buffer_load_dwordx4 v2, s[16:19], s50 offen lds
 v_mfma_f32_16x16x32_bf16 v[112:115], a[84:87], a[28:31], v[112:115]
 s_add_u32 s59, s56, 32768
 v_cvt_pk_bf16_f32 v80, v80, v81
 v_cvt_pk_bf16_f32 v81, v82, v83
 v_mfma_f32_16x16x32_bf16 v[112:115], a[80:83], a[24:27], v[112:115]
 buffer_store_dwordx4 v[36:39], v1, s[12:15], s59 offen offset:1024 sc1
 v_mfma_f32_16x16x32_bf16 v[124:127], a[72:75], a[24:27], v[124:127]
 v_cvt_pk_bf16_f32 v82, v84, v85
 v_cvt_pk_bf16_f32 v83, v86, v87
 v_mfma_f32_16x16x32_bf16 v[124:127], a[76:79], a[28:31], v[124:127]
 s_add_u32 m0, s29, 49152
 v_cvt_pk_bf16_f32 v88, v88, v89
 v_cvt_pk_bf16_f32 v89, v90, v91
 v_mfma_f32_16x16x32_bf16 v[120:123], a[68:71], a[28:31], v[120:123]
 buffer_load_dwordx4 v2, s[16:19], s51 offen lds
 v_mfma_f32_16x16x32_bf16 v[120:123], a[64:67], a[24:27], v[120:123]
 v_cvt_pk_bf16_f32 v90, v92, v93
 v_cvt_pk_bf16_f32 v91, v94, v95
 v_mfma_f32_16x16x32_bf16 v[128:131], a[64:67], a[32:35], v[128:131]
 v_cvt_pk_bf16_f32 v96, v96, v97
 v_cvt_pk_bf16_f32 v97, v98, v99
 v_mfma_f32_16x16x32_bf16 v[128:131], a[68:71], a[36:39], v[128:131]
 v_cvt_pk_bf16_f32 v98, v100, v101
 v_cvt_pk_bf16_f32 v99, v102, v103
 v_mfma_f32_16x16x32_bf16 v[132:135], a[76:79], a[36:39], v[132:135]
 s_add_u32 m0, s29, 53248
 v_cvt_pk_bf16_f32 v104, v104, v105
 v_cvt_pk_bf16_f32 v105, v106, v107
 v_mfma_f32_16x16x32_bf16 v[132:135], a[72:75], a[32:35], v[132:135]
 buffer_load_dwordx4 v2, s[16:19], s52 offen lds
 v_mfma_f32_16x16x32_bf16 v[136:139], a[80:83], a[32:35], v[136:139]
 v_cvt_pk_bf16_f32 v106, v108, v109
 v_cvt_pk_bf16_f32 v107, v110, v111
 v_mfma_f32_16x16x32_bf16 v[136:139], a[84:87], a[36:39], v[136:139]
 v_cvt_pk_bf16_f32 v112, v112, v113
 v_cvt_pk_bf16_f32 v113, v114, v115
 v_mfma_f32_16x16x32_bf16 v[140:143], a[92:95], a[36:39], v[140:143]
 v_cvt_pk_bf16_f32 v114, v116, v117
 v_cvt_pk_bf16_f32 v115, v118, v119
 v_mfma_f32_16x16x32_bf16 v[140:143], a[88:91], a[32:35], v[140:143]
 s_add_u32 m0, s29, 57344
 v_cvt_pk_bf16_f32 v120, v120, v121
 v_cvt_pk_bf16_f32 v121, v122, v123
 v_mfma_f32_16x16x32_bf16 v[148:151], a[88:91], a[40:43], v[148:151]
 buffer_load_dwordx4 v2, s[16:19], s53 offen lds
 v_mfma_f32_16x16x32_bf16 v[148:151], a[92:95], a[44:47], v[148:151]
 v_cvt_pk_bf16_f32 v122, v124, v125
 v_cvt_pk_bf16_f32 v123, v126, v127
 v_mfma_f32_16x16x32_bf16 v[144:147], a[84:87], a[44:47], v[144:147]
 v_mfma_f32_16x16x32_bf16 v[144:147], a[80:83], a[40:43], v[144:147]
 v_cvt_pk_bf16_f32 v128, v128, v129
 v_cvt_pk_bf16_f32 v129, v130, v131
 v_mfma_f32_16x16x32_bf16 v[156:159], a[72:75], a[40:43], v[156:159]
 s_add_u32 m0, s29, 61440
 v_cvt_pk_bf16_f32 v130, v132, v133
 v_cvt_pk_bf16_f32 v131, v134, v135
 v_mfma_f32_16x16x32_bf16 v[156:159], a[76:79], a[44:47], v[156:159]
 buffer_load_dwordx4 v2, s[16:19], s54 offen lds
 v_mfma_f32_16x16x32_bf16 v[152:155], a[68:71], a[44:47], v[152:155]
 v_mfma_f32_16x16x32_bf16 v[152:155], a[64:67], a[40:43], v[152:155]
 v_cvt_pk_bf16_f32 v136, v136, v137
 v_cvt_pk_bf16_f32 v137, v138, v139
 v_mfma_f32_16x16x32_bf16 v[160:163], a[64:67], a[48:51], v[160:163]
 s_add_u32 m0, s29, 98304
 v_add_u32 v2, 0x80000, v2
 v_cvt_pk_bf16_f32 v138, v140, v141
 v_mfma_f32_16x16x32_bf16 v[160:163], a[68:71], a[52:55], v[160:163]
 buffer_load_dwordx4 v2, s[16:19], 0 offen lds
 v_mfma_f32_16x16x32_bf16 v[164:167], a[76:79], a[52:55], v[164:167]
 v_cvt_pk_bf16_f32 v139, v142, v143
 v_mfma_f32_16x16x32_bf16 v[164:167], a[72:75], a[48:51], v[164:167]
 v_cvt_pk_bf16_f32 v144, v144, v145
 v_cvt_pk_bf16_f32 v145, v146, v147
 v_mfma_f32_16x16x32_bf16 v[168:171], a[80:83], a[48:51], v[168:171]
 v_cvt_pk_bf16_f32 v146, v148, v149
 v_cvt_pk_bf16_f32 v147, v150, v151
 v_mfma_f32_16x16x32_bf16 v[168:171], a[84:87], a[52:55], v[168:171]
 s_add_u32 m0, s29, 102400
 v_mfma_f32_16x16x32_bf16 v[172:175], a[92:95], a[52:55], v[172:175]
 buffer_load_dwordx4 v2, s[16:19], s48 offen lds
 v_mfma_f32_16x16x32_bf16 v[172:175], a[88:91], a[48:51], v[172:175]
 v_cvt_pk_bf16_f32 v152, v152, v153
 v_cvt_pk_bf16_f32 v153, v154, v155
 v_mfma_f32_16x16x32_bf16 v[180:183], a[88:91], a[56:59], v[180:183]
 v_cvt_pk_bf16_f32 v154, v156, v157
 v_cvt_pk_bf16_f32 v155, v158, v159
 v_mfma_f32_16x16x32_bf16 v[180:183], a[92:95], a[60:63], v[180:183]
 v_mfma_f32_16x16x32_bf16 v[176:179], a[84:87], a[60:63], v[176:179]
 s_add_u32 m0, s29, 106496
 v_mfma_f32_16x16x32_bf16 v[176:179], a[80:83], a[56:59], v[176:179]
 buffer_load_dwordx4 v2, s[16:19], s49 offen lds
 v_mfma_f32_16x16x32_bf16 v[188:191], a[72:75], a[56:59], v[188:191]
 v_cvt_pk_bf16_f32 v160, v160, v161
 v_cvt_pk_bf16_f32 v161, v162, v163
 v_mfma_f32_16x16x32_bf16 v[188:191], a[76:79], a[60:63], v[188:191]
 v_cvt_pk_bf16_f32 v162, v164, v165
 v_cvt_pk_bf16_f32 v163, v166, v167
 v_mfma_f32_16x16x32_bf16 v[184:187], a[68:71], a[60:63], v[184:187]
 v_mfma_f32_16x16x32_bf16 v[184:187], a[64:67], a[56:59], v[184:187]
 s_add_u32 m0, s29, 110592
 v_cvt_pk_bf16_f32 v168, v168, v169
 v_cvt_pk_bf16_f32 v169, v170, v171
 v_mfma_f32_16x16x32_bf16 v[192:195], a[96:99], a[32:35], v[192:195]
 buffer_load_dwordx4 v2, s[16:19], s50 offen lds
 v_mfma_f32_16x16x32_bf16 v[192:195], a[100:103], a[36:39], v[192:195]
 v_cvt_pk_bf16_f32 v170, v172, v173
 v_cvt_pk_bf16_f32 v171, v174, v175
 v_mfma_f32_16x16x32_bf16 v[196:199], a[108:111], a[36:39], v[196:199]
 v_mfma_f32_16x16x32_bf16 v[196:199], a[104:107], a[32:35], v[196:199]
 v_cvt_pk_bf16_f32 v176, v176, v177
 v_cvt_pk_bf16_f32 v177, v178, v179
 v_mfma_f32_16x16x32_bf16 v[200:203], a[112:115], a[32:35], v[200:203]
 s_add_u32 m0, s29, 114688
 v_cvt_pk_bf16_f32 v178, v180, v181
 v_cvt_pk_bf16_f32 v179, v182, v183
 v_mfma_f32_16x16x32_bf16 v[200:203], a[116:119], a[36:39], v[200:203]
 buffer_load_dwordx4 v2, s[16:19], s51 offen lds
 v_mfma_f32_16x16x32_bf16 v[204:207], a[124:127], a[36:39], v[204:207]
 v_mfma_f32_16x16x32_bf16 v[204:207], a[120:123], a[32:35], v[204:207]
 v_cvt_pk_bf16_f32 v184, v184, v185
 v_cvt_pk_bf16_f32 v185, v186, v187
 v_mfma_f32_16x16x32_bf16 v[212:215], a[120:123], a[40:43], v[212:215]
 v_cvt_pk_bf16_f32 v186, v188, v189
 v_cvt_pk_bf16_f32 v187, v190, v191
 v_mfma_f32_16x16x32_bf16 v[212:215], a[124:127], a[44:47], v[212:215]
 s_add_u32 m0, s29, 118784
 v_mfma_f32_16x16x32_bf16 v[208:211], a[116:119], a[44:47], v[208:211]
 buffer_load_dwordx4 v2, s[16:19], s52 offen lds
 v_mfma_f32_16x16x32_bf16 v[208:211], a[112:115], a[40:43], v[208:211]
 v_cvt_pk_bf16_f32 v192, v192, v193
 v_cvt_pk_bf16_f32 v193, v194, v195
 v_mfma_f32_16x16x32_bf16 v[220:223], a[104:107], a[40:43], v[220:223]
 v_cvt_pk_bf16_f32 v194, v196, v197
 v_cvt_pk_bf16_f32 v195, v198, v199
 v_mfma_f32_16x16x32_bf16 v[220:223], a[108:111], a[44:47], v[220:223]
 v_mfma_f32_16x16x32_bf16 v[216:219], a[100:103], a[44:47], v[216:219]
 s_add_u32 m0, s29, 122880
 v_mfma_f32_16x16x32_bf16 v[216:219], a[96:99], a[40:43], v[216:219]
 buffer_load_dwordx4 v2, s[16:19], s53 offen lds
 v_mfma_f32_16x16x32_bf16 v[224:227], a[96:99], a[48:51], v[224:227]
 v_cvt_pk_bf16_f32 v200, v200, v201
 v_cvt_pk_bf16_f32 v201, v202, v203
 v_mfma_f32_16x16x32_bf16 v[224:227], a[100:103], a[52:55], v[224:227]
 s_waitcnt vmcnt(19)
 v_cvt_pk_bf16_f32 v202, v204, v205
 v_cvt_pk_bf16_f32 v203, v206, v207
 v_mfma_f32_16x16x32_bf16 v[228:231], a[108:111], a[52:55], v[228:231]
 s_barrier
 v_xor_b32 v7, 0, v6
 v_mfma_f32_16x16x32_bf16 v[228:231], a[104:107], a[48:51], v[228:231]
 s_add_u32 m0, s29, 126976
 ds_read_b64_tr_b16 a[64:65], v7 offset:0
 v_cvt_pk_bf16_f32 v208, v208, v209
 v_mfma_f32_16x16x32_bf16 v[232:235], a[112:115], a[48:51], v[232:235]
 ds_read_b64_tr_b16 a[66:67], v7 offset:4096
 buffer_load_dwordx4 v2, s[16:19], s54 offen lds
 v_mfma_f32_16x16x32_bf16 v[232:235], a[116:119], a[52:55], v[232:235]
 ds_read_b64_tr_b16 a[68:69], v7 offset:16384
 v_cvt_pk_bf16_f32 v209, v210, v211
 v_mfma_f32_16x16x32_bf16 v[236:239], a[124:127], a[52:55], v[236:239]
 ds_read_b64_tr_b16 a[70:71], v7 offset:20480
 v_xor_b32 v8, 65536, v6
 v_mfma_f32_16x16x32_bf16 v[236:239], a[120:123], a[48:51], v[236:239]
 ds_read_b64_tr_b16 a[72:73], v8 offset:0
 v_cvt_pk_bf16_f32 v210, v212, v213
 v_mfma_f32_16x16x32_bf16 v[244:247], a[120:123], a[56:59], v[244:247]
 ds_read_b64_tr_b16 a[74:75], v8 offset:4096
 v_cvt_pk_bf16_f32 v211, v214, v215
 v_mfma_f32_16x16x32_bf16 v[244:247], a[124:127], a[60:63], v[244:247]
 ds_read_b64_tr_b16 a[76:77], v8 offset:16384
 v_cvt_pk_bf16_f32 v216, v216, v217
 v_mfma_f32_16x16x32_bf16 v[240:243], a[116:119], a[60:63], v[240:243]
 ds_read_b64_tr_b16 a[78:79], v8 offset:20480
 v_xor_b32 v9, 32, v6
 v_mfma_f32_16x16x32_bf16 v[240:243], a[112:115], a[56:59], v[240:243]
 ds_read_b64_tr_b16 a[80:81], v9 offset:0
 v_cvt_pk_bf16_f32 v217, v218, v219
 v_mfma_f32_16x16x32_bf16 v[252:255], a[104:107], a[56:59], v[252:255]
 ds_read_b64_tr_b16 a[82:83], v9 offset:4096
 v_cvt_pk_bf16_f32 v218, v220, v221
 v_mfma_f32_16x16x32_bf16 v[252:255], a[108:111], a[60:63], v[252:255]
 ds_read_b64_tr_b16 a[84:85], v9 offset:16384
 v_cvt_pk_bf16_f32 v219, v222, v223
 v_mfma_f32_16x16x32_bf16 v[248:251], a[100:103], a[60:63], v[248:251]
 ds_read_b64_tr_b16 a[86:87], v9 offset:20480
 v_xor_b32 v10, 65568, v6
 v_mfma_f32_16x16x32_bf16 v[248:251], a[96:99], a[56:59], v[248:251]
 s_waitcnt lgkmcnt(6)
 ds_read_b64_tr_b16 a[88:89], v10 offset:0
 v_cvt_pk_bf16_f32 v224, v224, v225
 v_mfma_f32_16x16x32_bf16 v[28:31], a[64:67], a[128:131], 0
 ds_read_b64_tr_b16 a[90:91], v10 offset:4096
 v_cvt_pk_bf16_f32 v225, v226, v227
 v_mfma_f32_16x16x32_bf16 v[28:31], a[68:71], a[136:139], v[28:31]
 ds_read_b64_tr_b16 a[92:93], v10 offset:16384
 v_xor_b32 v7, 64, v6
 v_mfma_f32_16x16x32_bf16 v[28:31], a[72:75], a[144:147], v[28:31]
 s_waitcnt lgkmcnt(7)
 ds_read_b128 a[112:115], v14 offset:0
 ds_read_b64_tr_b16 a[94:95], v10 offset:20480
 v_mfma_f32_16x16x32_bf16 v[28:31], a[76:79], a[152:155], v[28:31]
 ds_read_b64_tr_b16 a[96:97], v7 offset:0
 v_cvt_pk_bf16_f32 v226, v228, v229
 v_mfma_f32_16x16x32_bf16 v[44:47], a[64:67], a[132:135], 0
 ds_read_b128 a[120:123], v3 offset:0
 ds_read_b64_tr_b16 a[98:99], v7 offset:4096
 v_mfma_f32_16x16x32_bf16 v[44:47], a[68:71], a[140:143], v[44:47]
 ds_read_b64_tr_b16 a[100:101], v7 offset:16384
 v_xor_b32 v8, 65600, v6
 v_mfma_f32_16x16x32_bf16 v[44:47], a[72:75], a[148:151], v[44:47]
 ds_read_b128 a[116:119], v14 offset:2048
 ds_read_b64_tr_b16 a[102:103], v7 offset:20480
 v_mfma_f32_16x16x32_bf16 v[44:47], a[76:79], a[156:159], v[44:47]
 s_waitcnt lgkmcnt(9)
 ds_read_b64_tr_b16 a[104:105], v8 offset:0
 v_cvt_pk_bf16_f32 v227, v230, v231
 v_mfma_f32_16x16x32_bf16 v[52:55], a[80:83], a[128:131], 0
 ds_read_b128 a[124:127], v3 offset:2048
 ds_read_b64_tr_b16 a[106:107], v8 offset:4096
 v_mfma_f32_16x16x32_bf16 v[52:55], a[84:87], a[136:139], v[52:55]
 ds_read_b64_tr_b16 a[108:109], v8 offset:16384
 v_cvt_pk_bf16_f32 v232, v232, v233
 v_mfma_f32_16x16x32_bf16 v[52:55], a[88:91], a[144:147], v[52:55]
 s_waitcnt lgkmcnt(10)
 ds_read_b64_tr_b16 a[110:111], v8 offset:20480
 v_xor_b32 v9, 96, v6
 v_mfma_f32_16x16x32_bf16 v[52:55], a[92:95], a[152:155], v[52:55]
 ds_read_b64_tr_b16 a[64:65], v9 offset:0
 v_cvt_pk_bf16_f32 v233, v234, v235
 v_mfma_f32_16x16x32_bf16 v[60:63], a[80:83], a[132:135], 0
 ds_read_b64_tr_b16 a[66:67], v9 offset:4096
 v_cvt_pk_bf16_f32 v234, v236, v237
 v_mfma_f32_16x16x32_bf16 v[60:63], a[84:87], a[140:143], v[60:63]
 ds_read_b64_tr_b16 a[68:69], v9 offset:16384
 v_cvt_pk_bf16_f32 v235, v238, v239
 v_mfma_f32_16x16x32_bf16 v[60:63], a[88:91], a[148:151], v[60:63]
 ds_read_b64_tr_b16 a[70:71], v9 offset:20480
 v_xor_b32 v10, 65632, v6
 v_mfma_f32_16x16x32_bf16 v[60:63], a[92:95], a[156:159], v[60:63]
 s_waitcnt lgkmcnt(6)
 ds_read_b64_tr_b16 a[72:73], v10 offset:0
 v_cvt_pk_bf16_f32 v240, v240, v241
 v_mfma_f32_16x16x32_bf16 v[20:23], a[96:99], a[128:131], 0
 ds_read_b64_tr_b16 a[74:75], v10 offset:4096
 v_cvt_pk_bf16_f32 v241, v242, v243
 v_mfma_f32_16x16x32_bf16 v[20:23], a[100:103], a[136:139], v[20:23]
 s_waitcnt lgkmcnt(8)
 ds_read_b64_tr_b16 a[76:77], v10 offset:16384
 v_xor_b32 v7, 128, v6
 v_mfma_f32_16x16x32_bf16 v[20:23], a[104:107], a[144:147], v[20:23]
 s_waitcnt lgkmcnt(7)
 s_barrier
 ds_read_b64_tr_b16 a[78:79], v10 offset:20480
 v_mfma_f32_16x16x32_bf16 v[20:23], a[108:111], a[152:155], v[20:23]
 s_add_u32 m0, s29, 131072
 ds_read_b64_tr_b16 a[80:81], v7 offset:0
 v_add_u32 v2, 0x80000, v2
 v_mfma_f32_16x16x32_bf16 v[36:39], a[96:99], a[132:135], 0
 ds_read_b64_tr_b16 a[82:83], v7 offset:4096
 buffer_load_dwordx4 v2, s[16:19], 0 offen lds
 v_mfma_f32_16x16x32_bf16 v[36:39], a[100:103], a[140:143], v[36:39]
 ds_read_b64_tr_b16 a[84:85], v7 offset:16384
 v_cvt_pk_bf16_f32 v242, v244, v245
 v_mfma_f32_16x16x32_bf16 v[36:39], a[104:107], a[148:151], v[36:39]
 ds_read_b64_tr_b16 a[86:87], v7 offset:20480
 v_xor_b32 v8, 65664, v6
 v_mfma_f32_16x16x32_bf16 v[36:39], a[108:111], a[156:159], v[36:39]
 s_waitcnt lgkmcnt(6)
 ds_read_b64_tr_b16 a[88:89], v8 offset:0
 v_cvt_pk_bf16_f32 v243, v246, v247
 v_mfma_f32_16x16x32_bf16 v[68:71], a[64:67], a[128:131], 0
 ds_read_b64_tr_b16 a[90:91], v8 offset:4096
 v_cvt_pk_bf16_f32 v248, v248, v249
 v_mfma_f32_16x16x32_bf16 v[68:71], a[68:71], a[136:139], v[68:71]
 s_add_u32 m0, s29, 135168
 ds_read_b64_tr_b16 a[92:93], v8 offset:16384
 v_cvt_pk_bf16_f32 v249, v250, v251
 v_mfma_f32_16x16x32_bf16 v[68:71], a[72:75], a[144:147], v[68:71]
 s_waitcnt lgkmcnt(7)
 ds_read_b64_tr_b16 a[94:95], v8 offset:20480
 v_xor_b32 v9, 160, v6
 v_mfma_f32_16x16x32_bf16 v[68:71], a[76:79], a[152:155], v[68:71]
 ds_read_b64_tr_b16 a[96:97], v9 offset:0
 buffer_load_dwordx4 v2, s[16:19], s48 offen lds
 v_mfma_f32_16x16x32_bf16 v[76:79], a[64:67], a[132:135], 0
 ds_read_b64_tr_b16 a[98:99], v9 offset:4096
 v_cvt_pk_bf16_f32 v250, v252, v253
 v_mfma_f32_16x16x32_bf16 v[76:79], a[68:71], a[140:143], v[76:79]
 ds_read_b64_tr_b16 a[100:101], v9 offset:16384
 v_cvt_pk_bf16_f32 v251, v254, v255
 v_mfma_f32_16x16x32_bf16 v[76:79], a[72:75], a[148:151], v[76:79]
 ds_read_b64_tr_b16 a[102:103], v9 offset:20480
 v_xor_b32 v10, 65696, v6
 v_mfma_f32_16x16x32_bf16 v[76:79], a[76:79], a[156:159], v[76:79]
 s_waitcnt lgkmcnt(6)
 ds_read_b64_tr_b16 a[104:105], v10 offset:0
 v_mov_b32 v12, 0
 v_mfma_f32_16x16x32_bf16 v[84:87], a[80:83], a[128:131], 0
 s_add_u32 m0, s29, 139264
 ds_read_b64_tr_b16 a[106:107], v10 offset:4096
 v_mfma_f32_16x16x32_bf16 v[84:87], a[84:87], a[136:139], v[84:87]
 ds_read_b64_tr_b16 a[108:109], v10 offset:16384
 buffer_load_dwordx4 v2, s[16:19], s49 offen lds
 v_mfma_f32_16x16x32_bf16 v[84:87], a[88:91], a[144:147], v[84:87]
 s_waitcnt lgkmcnt(7)
 ds_read_b64_tr_b16 a[110:111], v10 offset:20480
 v_xor_b32 v7, 192, v6
 v_mfma_f32_16x16x32_bf16 v[84:87], a[92:95], a[152:155], v[84:87]
 ds_read_b64_tr_b16 a[64:65], v7 offset:0
 global_load_dword v5, v12, s[90:91] offset:128 sc1
 v_mfma_f32_16x16x32_bf16 v[92:95], a[80:83], a[132:135], 0
 ds_read_b64_tr_b16 a[66:67], v7 offset:4096
 v_and_b32 v12, 11, v0
 v_mfma_f32_16x16x32_bf16 v[92:95], a[84:87], a[140:143], v[92:95]
 ds_read_b64_tr_b16 a[68:69], v7 offset:16384
 v_lshlrev_b32 v12, 2, v12
 v_mfma_f32_16x16x32_bf16 v[92:95], a[88:91], a[148:151], v[92:95]
 s_add_u32 m0, s29, 143360
 ds_read_b64_tr_b16 a[70:71], v7 offset:20480
 v_xor_b32 v8, 65728, v6
 v_mfma_f32_16x16x32_bf16 v[92:95], a[92:95], a[156:159], v[92:95]
 s_waitcnt lgkmcnt(6)
 ds_read_b64_tr_b16 a[72:73], v8 offset:0
 buffer_load_dwordx4 v2, s[16:19], s50 offen lds
 v_mfma_f32_16x16x32_bf16 v[100:103], a[96:99], a[128:131], 0
 ds_read_b64_tr_b16 a[74:75], v8 offset:4096
 v_mfma_f32_16x16x32_bf16 v[100:103], a[100:103], a[136:139], v[100:103]
 s_and_b32 s36, s95, 31
 ds_read_b64_tr_b16 a[76:77], v8 offset:16384
 v_and_b32 v14, 15, v0
 v_mfma_f32_16x16x32_bf16 v[100:103], a[104:107], a[144:147], v[100:103]
 s_waitcnt lgkmcnt(7)
 ds_read_b64_tr_b16 a[78:79], v8 offset:20480
 v_xor_b32 v9, 224, v6
 v_mfma_f32_16x16x32_bf16 v[100:103], a[108:111], a[152:155], v[100:103]
 s_lshr_b32 s37, s95, 5
 ds_read_b64_tr_b16 a[80:81], v9 offset:0
 v_lshrrev_b32 v3, 4, v0
 v_mfma_f32_16x16x32_bf16 v[108:111], a[96:99], a[132:135], 0
 s_add_u32 m0, s29, 147456
 ds_read_b64_tr_b16 a[82:83], v9 offset:4096
 v_lshlrev_b32 v3, 2, v3
 v_mfma_f32_16x16x32_bf16 v[108:111], a[100:103], a[140:143], v[108:111]
 ds_read_b64_tr_b16 a[84:85], v9 offset:16384
 buffer_load_dwordx4 v2, s[16:19], s51 offen lds
 v_mfma_f32_16x16x32_bf16 v[108:111], a[104:107], a[148:151], v[108:111]
 s_lshl_b32 s38, s3, 4
 ds_read_b64_tr_b16 a[86:87], v9 offset:20480
 v_xor_b32 v10, 65760, v6
 v_mfma_f32_16x16x32_bf16 v[108:111], a[108:111], a[156:159], v[108:111]
 s_waitcnt lgkmcnt(6)
 ds_read_b64_tr_b16 a[88:89], v10 offset:0
 v_sub_u32 v14, v14, v3
 v_mfma_f32_16x16x32_bf16 v[116:119], a[64:67], a[128:131], 0
 s_lshl_b32 s39, s36, 6
 ds_read_b64_tr_b16 a[90:91], v10 offset:4096
 v_lshrrev_b32_e64 v3, 6, s29
 v_mfma_f32_16x16x32_bf16 v[116:119], a[68:71], a[136:139], v[116:119]
 s_add_u32 m0, s29, 151552
 ds_read_b64_tr_b16 a[92:93], v10 offset:16384
 v_add_u32 v14, v3, v14
 v_mfma_f32_16x16x32_bf16 v[116:119], a[72:75], a[144:147], v[116:119]
 s_waitcnt lgkmcnt(7)
 ds_read_b64_tr_b16 a[94:95], v10 offset:20480
 v_xor_b32 v7, 256, v6
 v_mfma_f32_16x16x32_bf16 v[116:119], a[76:79], a[152:155], v[116:119]
 ds_read_b64_tr_b16 a[96:97], v7 offset:0
 buffer_load_dwordx4 v2, s[16:19], s52 offen lds
 v_mfma_f32_16x16x32_bf16 v[124:127], a[64:67], a[132:135], 0
 s_add_u32 s38, s38, s39
 ds_read_b64_tr_b16 a[98:99], v7 offset:4096
 v_mov_b32 v15, 0xf149f2ca
 v_mfma_f32_16x16x32_bf16 v[124:127], a[68:71], a[140:143], v[124:127]
 s_mul_i32 s38, s38, 896
 ds_read_b64_tr_b16 a[100:101], v7 offset:16384
 v_cmp_gt_i32 vcc, 0, v14
 v_mfma_f32_16x16x32_bf16 v[124:127], a[72:75], a[148:151], v[124:127]
 s_lshl_b32 s39, s37, 7
 ds_read_b64_tr_b16 a[102:103], v7 offset:20480
 v_xor_b32 v8, 65792, v6
 v_mfma_f32_16x16x32_bf16 v[124:127], a[76:79], a[156:159], v[124:127]
 s_waitcnt lgkmcnt(6)
 ds_read_b64_tr_b16 a[104:105], v8 offset:0
 v_cndmask_b32 v3, 0, v15, vcc
 v_mfma_f32_16x16x32_bf16 v[132:135], a[80:83], a[128:131], 0
 s_add_u32 m0, s29, 155648
 ds_read_b64_tr_b16 a[106:107], v8 offset:4096
 v_accvgpr_write_b32 a224, v3
 v_mfma_f32_16x16x32_bf16 v[132:135], a[84:87], a[136:139], v[132:135]
 ds_read_b64_tr_b16 a[108:109], v8 offset:16384
 buffer_load_dwordx4 v2, s[16:19], s53 offen lds
 v_mfma_f32_16x16x32_bf16 v[132:135], a[88:91], a[144:147], v[132:135]
 s_waitcnt lgkmcnt(7)
 ds_read_b64_tr_b16 a[110:111], v8 offset:20480
 v_xor_b32 v9, 288, v6
 v_mfma_f32_16x16x32_bf16 v[132:135], a[92:95], a[152:155], v[132:135]
 s_add_u32 s38, s38, s39
 ds_read_b64_tr_b16 a[64:65], v9 offset:0
 v_cmp_gt_i32 vcc, 1, v14
 v_mfma_f32_16x16x32_bf16 v[140:143], a[80:83], a[132:135], 0
 s_lshl_b32 s39, s37, 9
 ds_read_b64_tr_b16 a[66:67], v9 offset:4096
 v_cndmask_b32 v3, 0, v15, vcc
 v_mfma_f32_16x16x32_bf16 v[140:143], a[84:87], a[140:143], v[140:143]
 s_mov_b32 s4, s66
 ds_read_b64_tr_b16 a[68:69], v9 offset:16384
 v_accvgpr_write_b32 a225, v3
 v_mfma_f32_16x16x32_bf16 v[140:143], a[88:91], a[148:151], v[140:143]
 s_add_u32 m0, s29, 159744
 ds_read_b64_tr_b16 a[70:71], v9 offset:20480
 v_xor_b32 v10, 65824, v6
 v_mfma_f32_16x16x32_bf16 v[140:143], a[92:95], a[156:159], v[140:143]
 s_waitcnt lgkmcnt(6)
 ds_read_b64_tr_b16 a[72:73], v10 offset:0
 buffer_load_dwordx4 v2, s[16:19], s54 offen lds
 v_mfma_f32_16x16x32_bf16 v[148:151], a[96:99], a[128:131], 0
 s_mov_b32 s5, s67
 ds_read_b64_tr_b16 a[74:75], v10 offset:4096
 v_cmp_gt_i32 vcc, 2, v14
 v_mfma_f32_16x16x32_bf16 v[148:151], a[100:103], a[136:139], v[148:151]
 s_mov_b32 s6, 1835008
 ds_read_b64_tr_b16 a[76:77], v10 offset:16384
 v_cndmask_b32 v3, 0, v15, vcc
 v_mfma_f32_16x16x32_bf16 v[148:151], a[104:107], a[144:147], v[148:151]
 s_waitcnt lgkmcnt(7)
 ds_read_b64_tr_b16 a[78:79], v10 offset:20480
 v_xor_b32 v7, 320, v6
 v_mfma_f32_16x16x32_bf16 v[148:151], a[108:111], a[152:155], v[148:151]
 s_mov_b32 s7, 0x20000
 ds_read_b64_tr_b16 a[80:81], v7 offset:0
 v_accvgpr_write_b32 a226, v3
 v_mfma_f32_16x16x32_bf16 v[156:159], a[96:99], a[132:135], 0
 s_mov_b32 s8, s68
 ds_read_b64_tr_b16 a[82:83], v7 offset:4096
 v_cmp_gt_i32 vcc, 3, v14
 v_mfma_f32_16x16x32_bf16 v[156:159], a[100:103], a[140:143], v[156:159]
 s_mov_b32 s9, s69
 ds_read_b64_tr_b16 a[84:85], v7 offset:16384
 v_cndmask_b32 v3, 0, v15, vcc
 v_mfma_f32_16x16x32_bf16 v[156:159], a[104:107], a[148:151], v[156:159]
 s_mov_b32 s10, 1835008
 ds_read_b64_tr_b16 a[86:87], v7 offset:20480
 v_xor_b32 v8, 65856, v6
 v_mfma_f32_16x16x32_bf16 v[156:159], a[108:111], a[156:159], v[156:159]
 s_waitcnt lgkmcnt(6)
 ds_read_b64_tr_b16 a[88:89], v8 offset:0
 v_accvgpr_write_b32 a227, v3
 v_mfma_f32_16x16x32_bf16 v[164:167], a[64:67], a[128:131], 0
 s_mov_b32 s11, 0x20000
 ds_read_b64_tr_b16 a[90:91], v8 offset:4096
 v_cmp_gt_i32 vcc, 16, v14
 v_mfma_f32_16x16x32_bf16 v[164:167], a[68:71], a[136:139], v[164:167]
 s_mov_b32 s20, s70
 ds_read_b64_tr_b16 a[92:93], v8 offset:16384
 v_cndmask_b32 v3, 0, v15, vcc
 v_mfma_f32_16x16x32_bf16 v[164:167], a[72:75], a[144:147], v[164:167]
 s_waitcnt lgkmcnt(7)
 ds_read_b64_tr_b16 a[94:95], v8 offset:20480
 v_xor_b32 v9, 352, v6
 v_mfma_f32_16x16x32_bf16 v[164:167], a[76:79], a[152:155], v[164:167]
 s_mov_b32 s21, s71
 ds_read_b64_tr_b16 a[96:97], v9 offset:0
 v_accvgpr_write_b32 a228, v3
 v_mfma_f32_16x16x32_bf16 v[172:175], a[64:67], a[132:135], 0
 s_mov_b32 s22, 3584
 ds_read_b64_tr_b16 a[98:99], v9 offset:4096
 v_cmp_gt_i32 vcc, 17, v14
 v_mfma_f32_16x16x32_bf16 v[172:175], a[68:71], a[140:143], v[172:175]
 s_mov_b32 s23, 0x20000
 ds_read_b64_tr_b16 a[100:101], v9 offset:16384
 v_cndmask_b32 v3, 0, v15, vcc
 v_mfma_f32_16x16x32_bf16 v[172:175], a[72:75], a[148:151], v[172:175]
 ds_read_b64_tr_b16 a[102:103], v9 offset:20480
 v_xor_b32 v10, 65888, v6
 v_mfma_f32_16x16x32_bf16 v[172:175], a[76:79], a[156:159], v[172:175]
 s_waitcnt lgkmcnt(6)
 ds_read_b64_tr_b16 a[104:105], v10 offset:0
 v_accvgpr_write_b32 a229, v3
 v_mfma_f32_16x16x32_bf16 v[180:183], a[80:83], a[128:131], 0
 ds_read_b64_tr_b16 a[106:107], v10 offset:4096
 v_cmp_gt_i32 vcc, 18, v14
 v_mfma_f32_16x16x32_bf16 v[180:183], a[84:87], a[136:139], v[180:183]
 ds_read_b64_tr_b16 a[108:109], v10 offset:16384
 v_cndmask_b32 v3, 0, v15, vcc
 v_mfma_f32_16x16x32_bf16 v[180:183], a[88:91], a[144:147], v[180:183]
 s_waitcnt lgkmcnt(7)
 ds_read_b64_tr_b16 a[110:111], v10 offset:20480
 v_xor_b32 v7, 384, v6
 v_mfma_f32_16x16x32_bf16 v[180:183], a[92:95], a[152:155], v[180:183]
 ds_read_b64_tr_b16 a[64:65], v7 offset:0
 v_accvgpr_write_b32 a230, v3
 v_mfma_f32_16x16x32_bf16 v[188:191], a[80:83], a[132:135], 0
 ds_read_b64_tr_b16 a[66:67], v7 offset:4096
 v_cmp_gt_i32 vcc, 19, v14
 v_mfma_f32_16x16x32_bf16 v[188:191], a[84:87], a[140:143], v[188:191]
 ds_read_b64_tr_b16 a[68:69], v7 offset:16384
 v_cndmask_b32 v3, 0, v15, vcc
 v_mfma_f32_16x16x32_bf16 v[188:191], a[88:91], a[148:151], v[188:191]
 ds_read_b64_tr_b16 a[70:71], v7 offset:20480
 v_xor_b32 v8, 65920, v6
 v_mfma_f32_16x16x32_bf16 v[188:191], a[92:95], a[156:159], v[188:191]
 s_waitcnt lgkmcnt(6)
 ds_read_b64_tr_b16 a[72:73], v8 offset:0
 v_accvgpr_write_b32 a231, v3
 v_mfma_f32_16x16x32_bf16 v[196:199], a[96:99], a[128:131], 0
 ds_read_b64_tr_b16 a[74:75], v8 offset:4096
 v_cmp_gt_i32 vcc, 32, v14
 v_mfma_f32_16x16x32_bf16 v[196:199], a[100:103], a[136:139], v[196:199]
 ds_read_b64_tr_b16 a[76:77], v8 offset:16384
 v_cndmask_b32 v3, 0, v15, vcc
 v_mfma_f32_16x16x32_bf16 v[196:199], a[104:107], a[144:147], v[196:199]
 s_waitcnt lgkmcnt(7)
 ds_read_b64_tr_b16 a[78:79], v8 offset:20480
 v_xor_b32 v9, 416, v6
 v_mfma_f32_16x16x32_bf16 v[196:199], a[108:111], a[152:155], v[196:199]
 ds_read_b64_tr_b16 a[80:81], v9 offset:0
 v_accvgpr_write_b32 a232, v3
 v_mfma_f32_16x16x32_bf16 v[204:207], a[96:99], a[132:135], 0
 ds_read_b64_tr_b16 a[82:83], v9 offset:4096
 v_cmp_gt_i32 vcc, 33, v14
 v_mfma_f32_16x16x32_bf16 v[204:207], a[100:103], a[140:143], v[204:207]
 ds_read_b64_tr_b16 a[84:85], v9 offset:16384
 v_cndmask_b32 v3, 0, v15, vcc
 v_mfma_f32_16x16x32_bf16 v[204:207], a[104:107], a[148:151], v[204:207]
 ds_read_b64_tr_b16 a[86:87], v9 offset:20480
 v_xor_b32 v10, 65952, v6
 v_mfma_f32_16x16x32_bf16 v[204:207], a[108:111], a[156:159], v[204:207]
 s_waitcnt lgkmcnt(6)
 ds_read_b64_tr_b16 a[88:89], v10 offset:0
 v_accvgpr_write_b32 a233, v3
 v_mfma_f32_16x16x32_bf16 v[212:215], a[64:67], a[128:131], 0
 ds_read_b64_tr_b16 a[90:91], v10 offset:4096
 v_cmp_gt_i32 vcc, 34, v14
 v_mfma_f32_16x16x32_bf16 v[212:215], a[68:71], a[136:139], v[212:215]
 ds_read_b64_tr_b16 a[92:93], v10 offset:16384
 v_cndmask_b32 v3, 0, v15, vcc
 v_mfma_f32_16x16x32_bf16 v[212:215], a[72:75], a[144:147], v[212:215]
 s_waitcnt lgkmcnt(7)
 ds_read_b64_tr_b16 a[94:95], v10 offset:20480
 v_xor_b32 v7, 448, v6
 v_mfma_f32_16x16x32_bf16 v[212:215], a[76:79], a[152:155], v[212:215]
 s_add_u32 s59, s56, 32768
 ds_read_b64_tr_b16 a[96:97], v7 offset:0
 v_accvgpr_write_b32 a234, v3
 v_mfma_f32_16x16x32_bf16 v[220:223], a[64:67], a[132:135], 0
 ds_read_b64_tr_b16 a[98:99], v7 offset:4096
 buffer_store_dwordx4 v[32:35], v1, s[12:15], s59 offen offset:2048 sc1
 v_mfma_f32_16x16x32_bf16 v[220:223], a[68:71], a[140:143], v[220:223]
 ds_read_b64_tr_b16 a[100:101], v7 offset:16384
 v_cmp_gt_i32 vcc, 35, v14
 v_mfma_f32_16x16x32_bf16 v[220:223], a[72:75], a[148:151], v[220:223]
 ds_read_b64_tr_b16 a[102:103], v7 offset:20480
 v_xor_b32 v8, 65984, v6
 v_mfma_f32_16x16x32_bf16 v[220:223], a[76:79], a[156:159], v[220:223]
 s_waitcnt lgkmcnt(6)
 ds_read_b64_tr_b16 a[104:105], v8 offset:0
 v_cndmask_b32 v3, 0, v15, vcc
 v_mfma_f32_16x16x32_bf16 v[228:231], a[80:83], a[128:131], 0
 ds_read_b64_tr_b16 a[106:107], v8 offset:4096
 v_accvgpr_write_b32 a235, v3
 v_mfma_f32_16x16x32_bf16 v[228:231], a[84:87], a[136:139], v[228:231]
 ds_read_b64_tr_b16 a[108:109], v8 offset:16384
 v_cmp_gt_i32 vcc, 48, v14
 v_mfma_f32_16x16x32_bf16 v[228:231], a[88:91], a[144:147], v[228:231]
 s_waitcnt lgkmcnt(7)
 ds_read_b64_tr_b16 a[110:111], v8 offset:20480
 v_xor_b32 v9, 480, v6
 v_mfma_f32_16x16x32_bf16 v[228:231], a[92:95], a[152:155], v[228:231]
 ds_read_b64_tr_b16 a[64:65], v9 offset:0
 v_cndmask_b32 v3, 0, v15, vcc
 v_mfma_f32_16x16x32_bf16 v[236:239], a[80:83], a[132:135], 0
 ds_read_b64_tr_b16 a[66:67], v9 offset:4096
 v_accvgpr_write_b32 a236, v3
 v_mfma_f32_16x16x32_bf16 v[236:239], a[84:87], a[140:143], v[236:239]
 ds_read_b64_tr_b16 a[68:69], v9 offset:16384
 v_cmp_gt_i32 vcc, 49, v14
 v_mfma_f32_16x16x32_bf16 v[236:239], a[88:91], a[148:151], v[236:239]
 s_add_u32 s59, s56, 49152
 ds_read_b64_tr_b16 a[70:71], v9 offset:20480
 v_xor_b32 v10, 66016, v6
 v_mfma_f32_16x16x32_bf16 v[236:239], a[92:95], a[156:159], v[236:239]
 s_waitcnt lgkmcnt(6)
 ds_read_b64_tr_b16 a[72:73], v10 offset:0
 buffer_store_dwordx4 v[40:43], v1, s[12:15], s59 offen offset:2048 sc1
 v_mfma_f32_16x16x32_bf16 v[244:247], a[96:99], a[128:131], 0
 ds_read_b64_tr_b16 a[74:75], v10 offset:4096
 v_cndmask_b32 v3, 0, v15, vcc
 v_mfma_f32_16x16x32_bf16 v[244:247], a[100:103], a[136:139], v[244:247]
 s_waitcnt vmcnt(11)
 ds_read_b64_tr_b16 a[76:77], v10 offset:16384
 v_xor_b32 v7, 32768, v6
 v_mfma_f32_16x16x32_bf16 v[244:247], a[104:107], a[144:147], v[244:247]
 s_waitcnt lgkmcnt(7)
 s_barrier
 ds_read_b64_tr_b16 a[78:79], v10 offset:20480
 v_mfma_f32_16x16x32_bf16 v[244:247], a[108:111], a[152:155], v[244:247]
 ds_read_b64_tr_b16 a[80:81], v7 offset:0
 v_accvgpr_write_b32 a237, v3
 v_mfma_f32_16x16x32_bf16 v[252:255], a[96:99], a[132:135], 0
 ds_read_b64_tr_b16 a[82:83], v7 offset:4096
 v_cmp_gt_i32 vcc, 50, v14
 v_mfma_f32_16x16x32_bf16 v[252:255], a[100:103], a[140:143], v[252:255]
 ds_read_b64_tr_b16 a[84:85], v7 offset:16384
 v_cndmask_b32 v3, 0, v15, vcc
 v_mfma_f32_16x16x32_bf16 v[252:255], a[104:107], a[148:151], v[252:255]
 ds_read_b64_tr_b16 a[86:87], v7 offset:20480
 v_xor_b32 v8, 98304, v6
 v_mfma_f32_16x16x32_bf16 v[252:255], a[108:111], a[156:159], v[252:255]
 s_waitcnt lgkmcnt(6)
 ds_read_b64_tr_b16 a[88:89], v8 offset:0
 v_accvgpr_write_b32 a238, v3
 v_mfma_f32_16x16x32_bf16 v[16:19], a[64:67], a[128:131], 0
 s_add_u32 s59, s56, 49152
 ds_read_b64_tr_b16 a[90:91], v8 offset:4096
 v_cmp_gt_i32 vcc, 51, v14
 v_mfma_f32_16x16x32_bf16 v[16:19], a[68:71], a[136:139], v[16:19]
 ds_read_b64_tr_b16 a[92:93], v8 offset:16384
 buffer_store_dwordx4 v[48:51], v1, s[12:15], s59 offen offset:3072 sc1
 v_mfma_f32_16x16x32_bf16 v[16:19], a[72:75], a[144:147], v[16:19]
 s_waitcnt lgkmcnt(7)
 ds_read_b64_tr_b16 a[94:95], v8 offset:20480
 v_xor_b32 v9, 32800, v6
 v_mfma_f32_16x16x32_bf16 v[16:19], a[76:79], a[152:155], v[16:19]
 ds_read_b64_tr_b16 a[96:97], v9 offset:0
 v_cndmask_b32 v3, 0, v15, vcc
 v_mfma_f32_16x16x32_bf16 v[24:27], a[64:67], a[132:135], 0
 s_waitcnt lgkmcnt(9)
 ds_read_b64_tr_b16 a[98:99], v9 offset:4096
 v_accvgpr_write_b32 a239, v3
 v_mfma_f32_16x16x32_bf16 v[24:27], a[68:71], a[140:143], v[24:27]
 s_barrier
 ds_read_b64_tr_b16 a[100:101], v9 offset:16384
 v_mfma_f32_16x16x32_bf16 v[24:27], a[72:75], a[148:151], v[24:27]
 s_add_u32 m0, s29, 0
 ds_read_b64_tr_b16 a[102:103], v9 offset:20480
 v_xor_b32 v10, 98336, v6
 v_mfma_f32_16x16x32_bf16 v[24:27], a[76:79], a[156:159], v[24:27]
 s_waitcnt lgkmcnt(6)
 ds_read_b64_tr_b16 a[104:105], v10 offset:0
 v_add_u32 v2, 0x80000, v2
 v_mfma_f32_16x16x32_bf16 v[28:31], a[80:83], a[160:163], v[28:31]
 ds_read_b64_tr_b16 a[106:107], v10 offset:4096
 buffer_load_dwordx4 v2, s[16:19], 0 offen lds
 v_mfma_f32_16x16x32_bf16 v[28:31], a[84:87], a[168:171], v[28:31]
 s_add_u32 s59, s56, 32768
 ds_read_b64_tr_b16 a[108:109], v10 offset:16384
 v_mfma_f32_16x16x32_bf16 v[28:31], a[88:91], a[176:179], v[28:31]
 s_waitcnt lgkmcnt(7)
 ds_read_b64_tr_b16 a[110:111], v10 offset:20480
 v_xor_b32 v7, 32832, v6
 v_mfma_f32_16x16x32_bf16 v[28:31], a[92:95], a[184:187], v[28:31]
 ds_read_b64_tr_b16 a[64:65], v7 offset:0
 buffer_store_dwordx4 v[56:59], v1, s[12:15], s59 offen offset:3072 sc1
 v_mfma_f32_16x16x32_bf16 v[44:47], a[80:83], a[164:167], v[44:47]
 s_add_u32 m0, s29, 4096
 ds_read_b64_tr_b16 a[66:67], v7 offset:4096
 v_add_u32 v4, 4096, v1
 v_mfma_f32_16x16x32_bf16 v[44:47], a[84:87], a[172:175], v[44:47]
 ds_read_b64_tr_b16 a[68:69], v7 offset:16384
 buffer_load_dwordx4 v2, s[16:19], s48 offen lds
 v_mfma_f32_16x16x32_bf16 v[44:47], a[88:91], a[180:183], v[44:47]
 ds_read_b64_tr_b16 a[70:71], v7 offset:20480
 v_xor_b32 v8, 98368, v6
 v_mfma_f32_16x16x32_bf16 v[44:47], a[92:95], a[188:191], v[44:47]
 s_waitcnt lgkmcnt(6)
 ds_read_b64_tr_b16 a[72:73], v8 offset:0
 v_mfma_f32_16x16x32_bf16 v[52:55], a[96:99], a[160:163], v[52:55]
 ds_read_b64_tr_b16 a[74:75], v8 offset:4096
 v_mfma_f32_16x16x32_bf16 v[52:55], a[100:103], a[168:171], v[52:55]
 s_add_u32 m0, s29, 8192
 ds_read_b64_tr_b16 a[76:77], v8 offset:16384
 v_mfma_f32_16x16x32_bf16 v[52:55], a[104:107], a[176:179], v[52:55]
 s_waitcnt lgkmcnt(7)
 ds_read_b64_tr_b16 a[78:79], v8 offset:20480
 v_xor_b32 v9, 32864, v6
 v_mfma_f32_16x16x32_bf16 v[52:55], a[108:111], a[184:187], v[52:55]
 ds_read_b64_tr_b16 a[80:81], v9 offset:0
 buffer_load_dwordx4 v2, s[16:19], s49 offen lds
 v_mfma_f32_16x16x32_bf16 v[60:63], a[96:99], a[164:167], v[60:63]
 s_add_u32 s59, s56, 0
 ds_read_b64_tr_b16 a[82:83], v9 offset:4096
 v_mfma_f32_16x16x32_bf16 v[60:63], a[100:103], a[172:175], v[60:63]
 ds_read_b64_tr_b16 a[84:85], v9 offset:16384
 buffer_store_dwordx4 v[64:67], v1, s[12:15], s59 offen offset:0 sc1
 v_mfma_f32_16x16x32_bf16 v[60:63], a[104:107], a[180:183], v[60:63]
 s_add_u32 m0, s29, 12288
 ds_read_b64_tr_b16 a[86:87], v9 offset:20480
 v_xor_b32 v10, 98400, v6
 v_mfma_f32_16x16x32_bf16 v[60:63], a[108:111], a[188:191], v[60:63]
 s_waitcnt lgkmcnt(6)
 ds_read_b64_tr_b16 a[88:89], v10 offset:0
 v_mfma_f32_16x16x32_bf16 v[20:23], a[64:67], a[160:163], v[20:23]
 ds_read_b64_tr_b16 a[90:91], v10 offset:4096
 buffer_load_dwordx4 v2, s[16:19], s50 offen lds
 v_mfma_f32_16x16x32_bf16 v[20:23], a[68:71], a[168:171], v[20:23]
 ds_read_b64_tr_b16 a[92:93], v10 offset:16384
 v_mfma_f32_16x16x32_bf16 v[20:23], a[72:75], a[176:179], v[20:23]
 s_waitcnt lgkmcnt(7)
 ds_read_b64_tr_b16 a[94:95], v10 offset:20480
 v_xor_b32 v7, 32896, v6
 v_mfma_f32_16x16x32_bf16 v[20:23], a[76:79], a[184:187], v[20:23]
 ds_read_b64_tr_b16 a[96:97], v7 offset:0
 v_mfma_f32_16x16x32_bf16 v[36:39], a[64:67], a[164:167], v[36:39]
 s_add_u32 m0, s29, 16384
 ds_read_b64_tr_b16 a[98:99], v7 offset:4096
 v_mfma_f32_16x16x32_bf16 v[36:39], a[68:71], a[172:175], v[36:39]
 ds_read_b64_tr_b16 a[100:101], v7 offset:16384
 buffer_load_dwordx4 v2, s[16:19], s51 offen lds
 v_mfma_f32_16x16x32_bf16 v[36:39], a[72:75], a[180:183], v[36:39]
 s_add_u32 s59, s56, 16384
 ds_read_b64_tr_b16 a[102:103], v7 offset:20480
 v_xor_b32 v8, 98432, v6
 v_mfma_f32_16x16x32_bf16 v[36:39], a[76:79], a[188:191], v[36:39]
 s_waitcnt lgkmcnt(6)
 ds_read_b64_tr_b16 a[104:105], v8 offset:0
 buffer_store_dwordx4 v[72:75], v1, s[12:15], s59 offen offset:0 sc1
 v_mfma_f32_16x16x32_bf16 v[68:71], a[80:83], a[160:163], v[68:71]
 ds_read_b64_tr_b16 a[106:107], v8 offset:4096
 v_mfma_f32_16x16x32_bf16 v[68:71], a[84:87], a[168:171], v[68:71]
 s_add_u32 m0, s29, 20480
 ds_read_b64_tr_b16 a[108:109], v8 offset:16384
 v_mfma_f32_16x16x32_bf16 v[68:71], a[88:91], a[176:179], v[68:71]
 s_waitcnt lgkmcnt(7)
 ds_read_b64_tr_b16 a[110:111], v8 offset:20480
 v_xor_b32 v9, 32928, v6
 v_mfma_f32_16x16x32_bf16 v[68:71], a[92:95], a[184:187], v[68:71]
 ds_read_b64_tr_b16 a[64:65], v9 offset:0
 buffer_load_dwordx4 v2, s[16:19], s52 offen lds
 v_mfma_f32_16x16x32_bf16 v[76:79], a[80:83], a[164:167], v[76:79]
 ds_read_b64_tr_b16 a[66:67], v9 offset:4096
 v_mfma_f32_16x16x32_bf16 v[76:79], a[84:87], a[172:175], v[76:79]
 ds_read_b64_tr_b16 a[68:69], v9 offset:16384
 v_mfma_f32_16x16x32_bf16 v[76:79], a[88:91], a[180:183], v[76:79]
 s_add_u32 m0, s29, 24576
 ds_read_b64_tr_b16 a[70:71], v9 offset:20480
 v_xor_b32 v10, 98464, v6
 v_mfma_f32_16x16x32_bf16 v[76:79], a[92:95], a[188:191], v[76:79]
 s_waitcnt lgkmcnt(6)
 ds_read_b64_tr_b16 a[72:73], v10 offset:0
 v_mfma_f32_16x16x32_bf16 v[84:87], a[96:99], a[160:163], v[84:87]
 ds_read_b64_tr_b16 a[74:75], v10 offset:4096
 buffer_load_dwordx4 v2, s[16:19], s53 offen lds
 v_mfma_f32_16x16x32_bf16 v[84:87], a[100:103], a[168:171], v[84:87]
 s_add_u32 s59, s56, 16384
 ds_read_b64_tr_b16 a[76:77], v10 offset:16384
 v_mfma_f32_16x16x32_bf16 v[84:87], a[104:107], a[176:179], v[84:87]
 s_waitcnt lgkmcnt(7)
 ds_read_b64_tr_b16 a[78:79], v10 offset:20480
 v_xor_b32 v7, 32960, v6
 v_mfma_f32_16x16x32_bf16 v[84:87], a[108:111], a[184:187], v[84:87]
 ds_read_b64_tr_b16 a[80:81], v7 offset:0
 buffer_store_dwordx4 v[80:83], v1, s[12:15], s59 offen offset:1024 sc1
 v_mfma_f32_16x16x32_bf16 v[92:95], a[96:99], a[164:167], v[92:95]
 s_add_u32 m0, s29, 28672
 ds_read_b64_tr_b16 a[82:83], v7 offset:4096
 v_mfma_f32_16x16x32_bf16 v[92:95], a[100:103], a[172:175], v[92:95]
 ds_read_b64_tr_b16 a[84:85], v7 offset:16384
 buffer_load_dwordx4 v2, s[16:19], s54 offen lds
 v_mfma_f32_16x16x32_bf16 v[92:95], a[104:107], a[180:183], v[92:95]
 ds_read_b64_tr_b16 a[86:87], v7 offset:20480
 v_xor_b32 v8, 98496, v6
 v_mfma_f32_16x16x32_bf16 v[92:95], a[108:111], a[188:191], v[92:95]
 s_waitcnt lgkmcnt(6)
 ds_read_b64_tr_b16 a[88:89], v8 offset:0
 v_mfma_f32_16x16x32_bf16 v[100:103], a[64:67], a[160:163], v[100:103]
 s_add_u32 m0, s29, 65536
 ds_read_b64_tr_b16 a[90:91], v8 offset:4096
 v_add_u32 v2, 0x80000, v2
 v_mfma_f32_16x16x32_bf16 v[100:103], a[68:71], a[168:171], v[100:103]
 ds_read_b64_tr_b16 a[92:93], v8 offset:16384
 buffer_load_dwordx4 v2, s[16:19], 0 offen lds
 v_mfma_f32_16x16x32_bf16 v[100:103], a[72:75], a[176:179], v[100:103]
 s_waitcnt lgkmcnt(7)
 ds_read_b64_tr_b16 a[94:95], v8 offset:20480
 v_xor_b32 v9, 32992, v6
 v_mfma_f32_16x16x32_bf16 v[100:103], a[76:79], a[184:187], v[100:103]
 ds_read_b64_tr_b16 a[96:97], v9 offset:0
 v_mfma_f32_16x16x32_bf16 v[108:111], a[64:67], a[164:167], v[108:111]
 s_add_u32 s59, s56, 0
 ds_read_b64_tr_b16 a[98:99], v9 offset:4096
 v_mfma_f32_16x16x32_bf16 v[108:111], a[68:71], a[172:175], v[108:111]
 ds_read_b64_tr_b16 a[100:101], v9 offset:16384
 buffer_store_dwordx4 v[88:91], v1, s[12:15], s59 offen offset:1024 sc1
 v_mfma_f32_16x16x32_bf16 v[108:111], a[72:75], a[180:183], v[108:111]
 s_add_u32 m0, s29, 69632
 ds_read_b64_tr_b16 a[102:103], v9 offset:20480
 v_xor_b32 v10, 98528, v6
 v_mfma_f32_16x16x32_bf16 v[108:111], a[76:79], a[188:191], v[108:111]
 s_waitcnt lgkmcnt(6)
 ds_read_b64_tr_b16 a[104:105], v10 offset:0
 buffer_load_dwordx4 v2, s[16:19], s48 offen lds
 v_mfma_f32_16x16x32_bf16 v[116:119], a[80:83], a[160:163], v[116:119]
 ds_read_b64_tr_b16 a[106:107], v10 offset:4096
 v_mfma_f32_16x16x32_bf16 v[116:119], a[84:87], a[168:171], v[116:119]
 ds_read_b64_tr_b16 a[108:109], v10 offset:16384
 v_mfma_f32_16x16x32_bf16 v[116:119], a[88:91], a[176:179], v[116:119]
 s_waitcnt lgkmcnt(7)
 ds_read_b64_tr_b16 a[110:111], v10 offset:20480
 v_xor_b32 v7, 33024, v6
 v_mfma_f32_16x16x32_bf16 v[116:119], a[92:95], a[184:187], v[116:119]
 s_add_u32 m0, s29, 73728
 ds_read_b64_tr_b16 a[64:65], v7 offset:0
 v_mfma_f32_16x16x32_bf16 v[124:127], a[80:83], a[164:167], v[124:127]
 ds_read_b64_tr_b16 a[66:67], v7 offset:4096
 buffer_load_dwordx4 v2, s[16:19], s49 offen lds
 v_mfma_f32_16x16x32_bf16 v[124:127], a[84:87], a[172:175], v[124:127]
 ds_read_b64_tr_b16 a[68:69], v7 offset:16384
 v_mfma_f32_16x16x32_bf16 v[124:127], a[88:91], a[180:183], v[124:127]
 s_add_u32 s59, s56, 0
 ds_read_b64_tr_b16 a[70:71], v7 offset:20480
 v_xor_b32 v8, 98560, v6
 v_mfma_f32_16x16x32_bf16 v[124:127], a[92:95], a[188:191], v[124:127]
 s_waitcnt lgkmcnt(6)
 ds_read_b64_tr_b16 a[72:73], v8 offset:0
 buffer_store_dwordx4 v[96:99], v1, s[12:15], s59 offen offset:2048 sc1
 v_mfma_f32_16x16x32_bf16 v[132:135], a[96:99], a[160:163], v[132:135]
 s_add_u32 m0, s29, 77824
 ds_read_b64_tr_b16 a[74:75], v8 offset:4096
 v_mfma_f32_16x16x32_bf16 v[132:135], a[100:103], a[168:171], v[132:135]
 ds_read_b64_tr_b16 a[76:77], v8 offset:16384
 buffer_load_dwordx4 v2, s[16:19], s50 offen lds
 v_mfma_f32_16x16x32_bf16 v[132:135], a[104:107], a[176:179], v[132:135]
 s_waitcnt lgkmcnt(7)
 ds_read_b64_tr_b16 a[78:79], v8 offset:20480
 v_xor_b32 v9, 33056, v6
 v_mfma_f32_16x16x32_bf16 v[132:135], a[108:111], a[184:187], v[132:135]
 ds_read_b64_tr_b16 a[80:81], v9 offset:0
 v_mfma_f32_16x16x32_bf16 v[140:143], a[96:99], a[164:167], v[140:143]
 ds_read_b64_tr_b16 a[82:83], v9 offset:4096
 v_mfma_f32_16x16x32_bf16 v[140:143], a[100:103], a[172:175], v[140:143]
 ds_read_b64_tr_b16 a[84:85], v9 offset:16384
 v_mfma_f32_16x16x32_bf16 v[140:143], a[104:107], a[180:183], v[140:143]
 s_add_u32 m0, s29, 81920
 ds_read_b64_tr_b16 a[86:87], v9 offset:20480
 v_xor_b32 v10, 98592, v6
 v_mfma_f32_16x16x32_bf16 v[140:143], a[108:111], a[188:191], v[140:143]
 s_waitcnt lgkmcnt(6)
 ds_read_b64_tr_b16 a[88:89], v10 offset:0
 buffer_load_dwordx4 v2, s[16:19], s51 offen lds
 v_mfma_f32_16x16x32_bf16 v[148:151], a[64:67], a[160:163], v[148:151]
 s_add_u32 s59, s56, 16384
 ds_read_b64_tr_b16 a[90:91], v10 offset:4096
 v_mfma_f32_16x16x32_bf16 v[148:151], a[68:71], a[168:171], v[148:151]
 ds_read_b64_tr_b16 a[92:93], v10 offset:16384
 buffer_store_dwordx4 v[104:107], v1, s[12:15], s59 offen offset:2048 sc1
 v_mfma_f32_16x16x32_bf16 v[148:151], a[72:75], a[176:179], v[148:151]
 s_waitcnt lgkmcnt(7)
 ds_read_b64_tr_b16 a[94:95], v10 offset:20480
 v_xor_b32 v7, 33088, v6
 v_mfma_f32_16x16x32_bf16 v[148:151], a[76:79], a[184:187], v[148:151]
 s_add_u32 m0, s29, 86016
 ds_read_b64_tr_b16 a[96:97], v7 offset:0
 v_mfma_f32_16x16x32_bf16 v[156:159], a[64:67], a[164:167], v[156:159]
 ds_read_b64_tr_b16 a[98:99], v7 offset:4096
 buffer_load_dwordx4 v2, s[16:19], s52 offen lds
 v_mfma_f32_16x16x32_bf16 v[156:159], a[68:71], a[172:175], v[156:159]
 ds_read_b64_tr_b16 a[100:101], v7 offset:16384
 v_mfma_f32_16x16x32_bf16 v[156:159], a[72:75], a[180:183], v[156:159]
 ds_read_b64_tr_b16 a[102:103], v7 offset:20480
 v_xor_b32 v8, 98624, v6
 v_mfma_f32_16x16x32_bf16 v[156:159], a[76:79], a[188:191], v[156:159]
 s_waitcnt lgkmcnt(6)
 ds_read_b64_tr_b16 a[104:105], v8 offset:0
 v_mfma_f32_16x16x32_bf16 v[164:167], a[80:83], a[160:163], v[164:167]
 s_add_u32 m0, s29, 90112
 ds_read_b64_tr_b16 a[106:107], v8 offset:4096
 v_mfma_f32_16x16x32_bf16 v[164:167], a[84:87], a[168:171], v[164:167]
 ds_read_b64_tr_b16 a[108:109], v8 offset:16384
 buffer_load_dwordx4 v2, s[16:19], s53 offen lds
 v_mfma_f32_16x16x32_bf16 v[164:167], a[88:91], a[176:179], v[164:167]
 s_waitcnt lgkmcnt(7)
 ds_read_b64_tr_b16 a[110:111], v8 offset:20480
 v_xor_b32 v9, 33120, v6
 v_mfma_f32_16x16x32_bf16 v[164:167], a[92:95], a[184:187], v[164:167]
 s_add_u32 s59, s56, 16384
 ds_read_b64_tr_b16 a[64:65], v9 offset:0
 v_mfma_f32_16x16x32_bf16 v[172:175], a[80:83], a[164:167], v[172:175]
 ds_read_b64_tr_b16 a[66:67], v9 offset:4096
 buffer_store_dwordx4 v[112:115], v1, s[12:15], s59 offen offset:3072 sc1
 v_mfma_f32_16x16x32_bf16 v[172:175], a[84:87], a[172:175], v[172:175]
 ds_read_b64_tr_b16 a[68:69], v9 offset:16384
 v_mfma_f32_16x16x32_bf16 v[172:175], a[88:91], a[180:183], v[172:175]
 s_add_u32 m0, s29, 94208
 ds_read_b64_tr_b16 a[70:71], v9 offset:20480
 v_xor_b32 v10, 98656, v6
 v_mfma_f32_16x16x32_bf16 v[172:175], a[92:95], a[188:191], v[172:175]
 s_waitcnt lgkmcnt(6)
 ds_read_b64_tr_b16 a[72:73], v10 offset:0
 buffer_load_dwordx4 v2, s[16:19], s54 offen lds
 v_mfma_f32_16x16x32_bf16 v[180:183], a[96:99], a[160:163], v[180:183]
 ds_read_b64_tr_b16 a[74:75], v10 offset:4096
 v_mfma_f32_16x16x32_bf16 v[180:183], a[100:103], a[168:171], v[180:183]
 ds_read_b64_tr_b16 a[76:77], v10 offset:16384
 v_mfma_f32_16x16x32_bf16 v[180:183], a[104:107], a[176:179], v[180:183]
 s_waitcnt lgkmcnt(7)
 ds_read_b64_tr_b16 a[78:79], v10 offset:20480
 v_xor_b32 v7, 33152, v6
 v_mfma_f32_16x16x32_bf16 v[180:183], a[108:111], a[184:187], v[180:183]
 ds_read_b64_tr_b16 a[80:81], v7 offset:0
 v_mfma_f32_16x16x32_bf16 v[188:191], a[96:99], a[164:167], v[188:191]
 ds_read_b64_tr_b16 a[82:83], v7 offset:4096
 v_mfma_f32_16x16x32_bf16 v[188:191], a[100:103], a[172:175], v[188:191]
 ds_read_b64_tr_b16 a[84:85], v7 offset:16384
 v_mfma_f32_16x16x32_bf16 v[188:191], a[104:107], a[180:183], v[188:191]
 s_add_u32 s59, s56, 0
 ds_read_b64_tr_b16 a[86:87], v7 offset:20480
 v_xor_b32 v8, 98688, v6
 v_mfma_f32_16x16x32_bf16 v[188:191], a[108:111], a[188:191], v[188:191]
 s_waitcnt lgkmcnt(6)
 ds_read_b64_tr_b16 a[88:89], v8 offset:0
 buffer_store_dwordx4 v[120:123], v1, s[12:15], s59 offen offset:3072 sc1
 v_mfma_f32_16x16x32_bf16 v[196:199], a[64:67], a[160:163], v[196:199]
 ds_read_b64_tr_b16 a[90:91], v8 offset:4096
 v_mfma_f32_16x16x32_bf16 v[196:199], a[68:71], a[168:171], v[196:199]
 ds_read_b64_tr_b16 a[92:93], v8 offset:16384
 v_mfma_f32_16x16x32_bf16 v[196:199], a[72:75], a[176:179], v[196:199]
 s_waitcnt lgkmcnt(7)
 ds_read_b64_tr_b16 a[94:95], v8 offset:20480
 v_xor_b32 v9, 33184, v6
 v_mfma_f32_16x16x32_bf16 v[196:199], a[76:79], a[184:187], v[196:199]
 ds_read_b64_tr_b16 a[96:97], v9 offset:0
 v_mfma_f32_16x16x32_bf16 v[204:207], a[64:67], a[164:167], v[204:207]
 ds_read_b64_tr_b16 a[98:99], v9 offset:4096
 v_mfma_f32_16x16x32_bf16 v[204:207], a[68:71], a[172:175], v[204:207]
 ds_read_b64_tr_b16 a[100:101], v9 offset:16384
 v_mfma_f32_16x16x32_bf16 v[204:207], a[72:75], a[180:183], v[204:207]
 ds_read_b64_tr_b16 a[102:103], v9 offset:20480
 v_xor_b32 v10, 98720, v6
 v_mfma_f32_16x16x32_bf16 v[204:207], a[76:79], a[188:191], v[204:207]
 s_waitcnt lgkmcnt(6)
 ds_read_b64_tr_b16 a[104:105], v10 offset:0
 v_mfma_f32_16x16x32_bf16 v[212:215], a[80:83], a[160:163], v[212:215]
 s_add_u32 s59, s56, 4096
 ds_read_b64_tr_b16 a[106:107], v10 offset:4096
 v_mfma_f32_16x16x32_bf16 v[212:215], a[84:87], a[168:171], v[212:215]
 ds_read_b64_tr_b16 a[108:109], v10 offset:16384
 buffer_store_dwordx4 v[128:131], v1, s[12:15], s59 offen offset:0 sc1
 v_mfma_f32_16x16x32_bf16 v[212:215], a[88:91], a[176:179], v[212:215]
 s_waitcnt lgkmcnt(7)
 ds_read_b64_tr_b16 a[110:111], v10 offset:20480
 v_xor_b32 v7, 33216, v6
 v_mfma_f32_16x16x32_bf16 v[212:215], a[92:95], a[184:187], v[212:215]
 ds_read_b64_tr_b16 a[64:65], v7 offset:0
 v_lshrrev_b32 v120, 3, v0
 v_mfma_f32_16x16x32_bf16 v[220:223], a[80:83], a[164:167], v[220:223]
 ds_read_b64_tr_b16 a[66:67], v7 offset:4096
 v_mul_u32_u24 v120, 1792, v120
 v_mfma_f32_16x16x32_bf16 v[220:223], a[84:87], a[172:175], v[220:223]
 ds_read_b64_tr_b16 a[68:69], v7 offset:16384
 v_and_b32 v121, 7, v0
 v_mfma_f32_16x16x32_bf16 v[220:223], a[88:91], a[180:183], v[220:223]
 ds_read_b64_tr_b16 a[70:71], v7 offset:20480
 v_xor_b32 v8, 98752, v6
 v_mfma_f32_16x16x32_bf16 v[220:223], a[92:95], a[188:191], v[220:223]
 s_waitcnt lgkmcnt(6)
 ds_read_b64_tr_b16 a[72:73], v8 offset:0
 v_lshl_add_u32 v120, v121, 4, v120
 v_mfma_f32_16x16x32_bf16 v[228:231], a[96:99], a[160:163], v[228:231]
 ds_read_b64_tr_b16 a[74:75], v8 offset:4096
 v_add_u32 v120, s38, v120
 v_mfma_f32_16x16x32_bf16 v[228:231], a[100:103], a[168:171], v[228:231]
 s_add_u32 s59, s56, 20480
 ds_read_b64_tr_b16 a[76:77], v8 offset:16384
 v_lshlrev_b32 v121, 6, v121
 v_mfma_f32_16x16x32_bf16 v[228:231], a[104:107], a[176:179], v[228:231]
 s_waitcnt lgkmcnt(7)
 ds_read_b64_tr_b16 a[78:79], v8 offset:20480
 v_xor_b32 v9, 33248, v6
 v_mfma_f32_16x16x32_bf16 v[228:231], a[108:111], a[184:187], v[228:231]
 ds_read_b64_tr_b16 a[80:81], v9 offset:0
 buffer_store_dwordx4 v[136:139], v1, s[12:15], s59 offen offset:0 sc1
 v_mfma_f32_16x16x32_bf16 v[236:239], a[96:99], a[164:167], v[236:239]
 ds_read_b64_tr_b16 a[82:83], v9 offset:4096
 v_subrev_u32 v122, 2688, v120
 v_mfma_f32_16x16x32_bf16 v[236:239], a[100:103], a[172:175], v[236:239]
 ds_read_b64_tr_b16 a[84:85], v9 offset:16384
 v_subrev_u32 v123, 1792, v120
 v_mfma_f32_16x16x32_bf16 v[236:239], a[104:107], a[180:183], v[236:239]
 ds_read_b64_tr_b16 a[86:87], v9 offset:20480
 v_xor_b32 v10, 98784, v6
 v_mfma_f32_16x16x32_bf16 v[236:239], a[108:111], a[188:191], v[236:239]
 s_waitcnt lgkmcnt(6)
 ds_read_b64_tr_b16 a[88:89], v10 offset:0
 v_subrev_u32 v128, 896, v120
 v_mfma_f32_16x16x32_bf16 v[244:247], a[64:67], a[160:163], v[244:247]
 ds_read_b64_tr_b16 a[90:91], v10 offset:4096
 buffer_load_dwordx4 v[32:35], v122, s[4:7], 0 offen
 v_mfma_f32_16x16x32_bf16 v[244:247], a[68:71], a[168:171], v[244:247]
 s_waitcnt vmcnt(4)
 ds_read_b64_tr_b16 a[92:93], v10 offset:16384
 v_xor_b32 v7, 131072, v6
 v_mfma_f32_16x16x32_bf16 v[244:247], a[72:75], a[176:179], v[244:247]
 s_waitcnt lgkmcnt(7)
 s_barrier
 ds_read_b64_tr_b16 a[94:95], v10 offset:20480
 v_mfma_f32_16x16x32_bf16 v[244:247], a[76:79], a[184:187], v[244:247]
 s_and_b32 s58, s92, ~127
 ds_read_b64_tr_b16 a[96:97], v7 offset:0
 v_mfma_f32_16x16x32_bf16 v[252:255], a[64:67], a[164:167], v[252:255]
 s_add_u32 s59, s56, 20480
 ds_read_b64_tr_b16 a[98:99], v7 offset:4096
 v_mfma_f32_16x16x32_bf16 v[252:255], a[68:71], a[172:175], v[252:255]
 ds_read_b64_tr_b16 a[100:101], v7 offset:16384
 buffer_store_dwordx4 v[144:147], v1, s[12:15], s59 offen offset:1024 sc1
 v_mfma_f32_16x16x32_bf16 v[252:255], a[72:75], a[180:183], v[252:255]
 s_lshl_b32 s37, s25, 1
 ds_read_b64_tr_b16 a[102:103], v7 offset:20480
 v_xor_b32 v8, 0, v6
 v_mfma_f32_16x16x32_bf16 v[252:255], a[76:79], a[188:191], v[252:255]
 s_waitcnt lgkmcnt(6)
 ds_read_b64_tr_b16 a[104:105], v8 offset:0
 buffer_load_dwordx4 v[40:43], v123, s[4:7], 0 offen
 v_mfma_f32_16x16x32_bf16 v[16:19], a[80:83], a[160:163], v[16:19]
 s_sub_i32 s38, 12, s37
 ds_read_b64_tr_b16 a[106:107], v8 offset:4096
 v_mfma_f32_16x16x32_bf16 v[16:19], a[84:87], a[168:171], v[16:19]
 s_max_i32 s38, s38, 0
 ds_read_b64_tr_b16 a[108:109], v8 offset:16384
 v_mfma_f32_16x16x32_bf16 v[16:19], a[88:91], a[176:179], v[16:19]
 s_waitcnt lgkmcnt(7)
 ds_read_b64_tr_b16 a[110:111], v8 offset:20480
 v_xor_b32 v9, 65536, v6
 v_mfma_f32_16x16x32_bf16 v[16:19], a[92:95], a[184:187], v[16:19]
 ds_read_b64_tr_b16 a[64:65], v9 offset:0
 buffer_load_dwordx4 v[48:51], v128, s[4:7], 0 offen
 v_mfma_f32_16x16x32_bf16 v[24:27], a[80:83], a[164:167], v[24:27]
 s_mul_i32 s49, s26, 1048576
 ds_read_b64_tr_b16 a[66:67], v9 offset:4096
 v_mfma_f32_16x16x32_bf16 v[24:27], a[84:87], a[172:175], v[24:27]
 s_lshl_b32 s50, s3, 13
 ds_read_b64_tr_b16 a[68:69], v9 offset:16384
 v_mfma_f32_16x16x32_bf16 v[24:27], a[88:91], a[180:183], v[24:27]
 s_add_u32 s59, s56, 4096
 ds_read_b64_tr_b16 a[70:71], v9 offset:20480
 v_xor_b32 v10, 131104, v6
 v_mfma_f32_16x16x32_bf16 v[24:27], a[92:95], a[188:191], v[24:27]
 s_waitcnt lgkmcnt(6)
 ds_read_b64_tr_b16 a[72:73], v10 offset:0
 buffer_store_dwordx4 v[152:155], v1, s[12:15], s59 offen offset:1024 sc1
 v_mfma_f32_16x16x32_bf16 v[28:31], a[96:99], a[192:195], v[28:31]
 s_add_u32 s49, s49, s50
 ds_read_b64_tr_b16 a[74:75], v10 offset:4096
 v_mfma_f32_16x16x32_bf16 v[28:31], a[100:103], a[200:203], v[28:31]
 ds_read_b64_tr_b16 a[76:77], v10 offset:16384
 buffer_load_dwordx4 v[56:59], v120, s[4:7], 0 offen offset:0
 v_mfma_f32_16x16x32_bf16 v[28:31], a[104:107], a[208:211], v[28:31]
 s_waitcnt lgkmcnt(3)
 ds_read_b64_tr_b16 a[78:79], v10 offset:20480
 v_xor_b32 v7, 32, v6
 v_mfma_f32_16x16x32_bf16 v[28:31], a[108:111], a[216:219], v[28:31]
 s_mov_b32 s54, 2
 ds_read_b64_tr_b16 a[80:81], v7 offset:0
 v_mfma_f32_16x16x32_bf16 v[28:31], a[64:67], a[112:115], v[28:31]
 s_sub_u32 s44, 31, s37
 ds_read_b64_tr_b16 a[82:83], v7 offset:4096
 v_mfma_f32_16x16x32_bf16 v[28:31], a[68:71], a[120:123], v[28:31]
 ds_read_b64_tr_b16 a[84:85], v7 offset:16384
 buffer_load_dwordx4 v[64:67], v120, s[4:7], 0 offen offset:896
 v_mfma_f32_16x16x32_bf16 v[44:47], a[96:99], a[196:199], v[44:47]
 s_sub_u32 s44, s44, s38
 ds_read_b64_tr_b16 a[86:87], v7 offset:20480
 v_xor_b32 v8, 65568, v6
 v_mfma_f32_16x16x32_bf16 v[44:47], a[100:103], a[204:207], v[44:47]
 s_mul_i32 s55, s38, 32768
 ds_read_b64_tr_b16 a[88:89], v8 offset:0
 v_mfma_f32_16x16x32_bf16 v[44:47], a[104:107], a[212:215], v[44:47]
 s_add_u32 s59, s56, 4096
 ds_read_b64_tr_b16 a[90:91], v8 offset:4096
 v_mfma_f32_16x16x32_bf16 v[44:47], a[108:111], a[220:223], v[44:47]
 ds_read_b64_tr_b16 a[92:93], v8 offset:16384
 buffer_store_dwordx4 v[160:163], v1, s[12:15], s59 offen offset:2048 sc1
 v_mfma_f32_16x16x32_bf16 v[44:47], a[64:67], a[116:119], v[44:47]
 s_add_u32 s42, s55, s49
 ds_read_b64_tr_b16 a[94:95], v8 offset:20480
 v_xor_b32 v9, 131136, v6
 v_mfma_f32_16x16x32_bf16 v[44:47], a[68:71], a[124:127], v[44:47]
 s_waitcnt lgkmcnt(6)
 ds_read_b64_tr_b16 a[96:97], v9 offset:0
 buffer_load_dwordx4 v[72:75], v120, s[8:11], 0 offen offset:0
 v_mfma_f32_16x16x32_bf16 v[52:55], a[72:75], a[192:195], v[52:55]
 s_add_u32 s60, s58, 16
 ds_read_b64_tr_b16 a[98:99], v9 offset:4096
 v_mfma_f32_16x16x32_bf16 v[52:55], a[76:79], a[200:203], v[52:55]
 s_sub_u32 s45, 17, s37
 ds_read_b64_tr_b16 a[100:101], v9 offset:16384
 v_mfma_f32_16x16x32_bf16 v[52:55], a[80:83], a[208:211], v[52:55]
 s_waitcnt lgkmcnt(3)
 ds_read_b64_tr_b16 a[102:103], v9 offset:20480
 v_xor_b32 v10, 64, v6
 v_mfma_f32_16x16x32_bf16 v[52:55], a[84:87], a[216:219], v[52:55]
 ds_read_b64_tr_b16 a[104:105], v10 offset:0
 buffer_load_dwordx4 v[80:83], v120, s[8:11], 0 offen offset:896
 v_mfma_f32_16x16x32_bf16 v[52:55], a[88:91], a[112:115], v[52:55]
 s_sub_u32 s66, s42, 32768
 ds_read_b64_tr_b16 a[106:107], v10 offset:4096
 v_mfma_f32_16x16x32_bf16 v[52:55], a[92:95], a[120:123], v[52:55]
 s_add_u32 s42, s49, 491520
 ds_read_b64_tr_b16 a[108:109], v10 offset:16384
 v_mfma_f32_16x16x32_bf16 v[60:63], a[72:75], a[196:199], v[60:63]
 s_add_u32 s59, s56, 20480
 ds_read_b64_tr_b16 a[110:111], v10 offset:20480
 v_xor_b32 v7, 65600, v6
 v_mfma_f32_16x16x32_bf16 v[60:63], a[76:79], a[204:207], v[60:63]
 ds_read_b64_tr_b16 a[64:65], v7 offset:0
 buffer_store_dwordx4 v[168:171], v1, s[12:15], s59 offen offset:2048 sc1
 v_mfma_f32_16x16x32_bf16 v[60:63], a[80:83], a[212:215], v[60:63]
 s_add_u32 s67, s49, 524288
 ds_read_b64_tr_b16 a[66:67], v7 offset:4096
 v_mfma_f32_16x16x32_bf16 v[60:63], a[84:87], a[220:223], v[60:63]
 ds_read_b64_tr_b16 a[68:69], v7 offset:16384
 buffer_load_dwordx4 v[88:91], v121, s[20:23], s39 offen offset:0
 v_mfma_f32_16x16x32_bf16 v[60:63], a[88:91], a[116:119], v[60:63]
 s_add_u32 s68, s66, 16777216
 ds_read_b64_tr_b16 a[70:71], v7 offset:20480
 v_xor_b32 v8, 131168, v6
 v_mfma_f32_16x16x32_bf16 v[60:63], a[92:95], a[124:127], v[60:63]
 s_waitcnt lgkmcnt(6)
 ds_read_b64_tr_b16 a[72:73], v8 offset:0
 v_mfma_f32_16x16x32_bf16 v[20:23], a[96:99], a[192:195], v[20:23]
 s_add_u32 s69, s67, 16777216
 ds_read_b64_tr_b16 a[74:75], v8 offset:4096
 v_mfma_f32_16x16x32_bf16 v[20:23], a[100:103], a[200:203], v[20:23]
 ds_read_b64_tr_b16 a[76:77], v8 offset:16384
 buffer_load_dwordx4 v[96:99], v121, s[20:23], s39 offen offset:16
 v_mfma_f32_16x16x32_bf16 v[20:23], a[104:107], a[208:211], v[20:23]
 s_waitcnt lgkmcnt(3)
 ds_read_b64_tr_b16 a[78:79], v8 offset:20480
 v_xor_b32 v9, 96, v6
 v_mfma_f32_16x16x32_bf16 v[20:23], a[108:111], a[216:219], v[20:23]
 s_mov_b32 s70, 0xffff8000
 ds_read_b64_tr_b16 a[80:81], v9 offset:0
 v_mul_f32 v28, s34, v28
 v_mfma_f32_16x16x32_bf16 v[20:23], a[64:67], a[112:115], v[20:23]
 s_add_u32 s59, s56, 20480
 ds_read_b64_tr_b16 a[82:83], v9 offset:4096
 v_mul_f32 v29, s34, v29
 v_mfma_f32_16x16x32_bf16 v[20:23], a[68:71], a[120:123], v[20:23]
 ds_read_b64_tr_b16 a[84:85], v9 offset:16384
 buffer_store_dwordx4 v[176:179], v1, s[12:15], s59 offen offset:3072 sc1
 v_mfma_f32_16x16x32_bf16 v[36:39], a[96:99], a[196:199], v[36:39]
 s_mov_b32 s71, s70
 ds_read_b64_tr_b16 a[86:87], v9 offset:20480
 v_xor_b32 v10, 65632, v6
 v_mfma_f32_16x16x32_bf16 v[36:39], a[100:103], a[204:207], v[36:39]
 ds_read_b64_tr_b16 a[88:89], v10 offset:0
 buffer_load_dwordx4 v[104:107], v121, s[20:23], s39 offen offset:32
 v_mfma_f32_16x16x32_bf16 v[36:39], a[104:107], a[212:215], v[36:39]
 s_add_u32 s43, s42, 16777216
 ds_read_b64_tr_b16 a[90:91], v10 offset:4096
 v_mul_f32 v30, s34, v30
 v_mfma_f32_16x16x32_bf16 v[36:39], a[108:111], a[220:223], v[36:39]
 s_mov_b32 s40, s50
 ds_read_b64_tr_b16 a[92:93], v10 offset:16384
 v_mul_f32 v31, s34, v31
 v_mfma_f32_16x16x32_bf16 v[36:39], a[64:67], a[116:119], v[36:39]
 s_add_u32 s41, s50, 0x10000
 ds_read_b64_tr_b16 a[94:95], v10 offset:20480
 v_xor_b32 v7, 131200, v6
 v_mfma_f32_16x16x32_bf16 v[36:39], a[68:71], a[124:127], v[36:39]
 s_waitcnt lgkmcnt(6)
 ds_read_b64_tr_b16 a[96:97], v7 offset:0
 buffer_load_dwordx4 v[112:115], v121, s[20:23], s39 offen offset:48
 v_mfma_f32_16x16x32_bf16 v[68:71], a[72:75], a[192:195], v[68:71]
 s_lshr_b32 s61, s95, 4
 ds_read_b64_tr_b16 a[98:99], v7 offset:4096
 v_mul_f32 v52, s34, v52
 v_mfma_f32_16x16x32_bf16 v[68:71], a[76:79], a[200:203], v[68:71]
 s_add_u32 s59, s56, 4096
 ds_read_b64_tr_b16 a[100:101], v7 offset:16384
 v_mul_f32 v53, s34, v53
 v_mfma_f32_16x16x32_bf16 v[68:71], a[80:83], a[208:211], v[68:71]
 s_waitcnt lgkmcnt(3)
 ds_read_b64_tr_b16 a[102:103], v7 offset:20480
 v_xor_b32 v8, 128, v6
 v_mfma_f32_16x16x32_bf16 v[68:71], a[84:87], a[216:219], v[68:71]
 ds_read_b64_tr_b16 a[104:105], v8 offset:0
 buffer_store_dwordx4 v[184:187], v1, s[12:15], s59 offen offset:3072 sc1
 v_mfma_f32_16x16x32_bf16 v[68:71], a[88:91], a[112:115], v[68:71]
 s_lshl_b32 s61, s61, 7
 ds_read_b64_tr_b16 a[106:107], v8 offset:4096
 v_mul_f32 v54, s34, v54
 v_mfma_f32_16x16x32_bf16 v[68:71], a[92:95], a[120:123], v[68:71]
 s_add_u32 s61, s61, 84959232
 ds_read_b64_tr_b16 a[108:109], v8 offset:16384
 v_mul_f32 v55, s34, v55
 v_mfma_f32_16x16x32_bf16 v[76:79], a[72:75], a[196:199], v[76:79]
 s_mov_b32 s47, 0x4b800000
 ds_read_b64_tr_b16 a[110:111], v8 offset:20480
 v_xor_b32 v9, 65664, v6
 v_mfma_f32_16x16x32_bf16 v[76:79], a[76:79], a[204:207], v[76:79]
 s_lshl_b32 s30, s95, 1
 ds_read_b64_tr_b16 a[64:65], v9 offset:0
 v_cvt_pk_bf16_f32 v28, v28, v29
 v_mfma_f32_16x16x32_bf16 v[76:79], a[80:83], a[212:215], v[76:79]
 s_lshr_b32 s31, s3, 1
 ds_read_b64_tr_b16 a[66:67], v9 offset:4096
 v_cvt_pk_bf16_f32 v29, v30, v31
 v_mfma_f32_16x16x32_bf16 v[76:79], a[84:87], a[220:223], v[76:79]
 s_add_u32 s30, s30, s31
 ds_read_b64_tr_b16 a[68:69], v9 offset:16384
 v_cvt_pk_bf16_f32 v30, v52, v53
 v_mfma_f32_16x16x32_bf16 v[76:79], a[88:91], a[116:119], v[76:79]
 s_min_u32 s30, s30, 223
 ds_read_b64_tr_b16 a[70:71], v9 offset:20480
 v_xor_b32 v10, 131232, v6
 v_mfma_f32_16x16x32_bf16 v[76:79], a[92:95], a[124:127], v[76:79]
 s_waitcnt lgkmcnt(6)
 ds_read_b64_tr_b16 a[72:73], v10 offset:0
 v_cvt_pk_bf16_f32 v31, v54, v55
 v_mfma_f32_16x16x32_bf16 v[84:87], a[96:99], a[192:195], v[84:87]
 s_add_u32 s59, s56, 36864
 ds_read_b64_tr_b16 a[74:75], v10 offset:4096
 v_accvgpr_write_b32 a0, v28
 v_mfma_f32_16x16x32_bf16 v[84:87], a[100:103], a[200:203], v[84:87]
 ds_read_b64_tr_b16 a[76:77], v10 offset:16384
 buffer_store_dwordx4 v[192:195], v1, s[12:15], s59 offen offset:0 sc1
 v_mfma_f32_16x16x32_bf16 v[84:87], a[104:107], a[208:211], v[84:87]
 s_waitcnt lgkmcnt(3)
 ds_read_b64_tr_b16 a[78:79], v10 offset:20480
 v_xor_b32 v7, 160, v6
 v_mfma_f32_16x16x32_bf16 v[84:87], a[108:111], a[216:219], v[84:87]
 s_lshl_b32 s30, s30, 2
 ds_read_b64_tr_b16 a[80:81], v7 offset:0
 v_accvgpr_write_b32 a1, v29
 v_mfma_f32_16x16x32_bf16 v[84:87], a[64:67], a[112:115], v[84:87]
 s_and_b32 s4, s2, 127
 ds_read_b64_tr_b16 a[82:83], v7 offset:4096
 v_accvgpr_write_b32 a2, v30
 v_mfma_f32_16x16x32_bf16 v[84:87], a[68:71], a[120:123], v[84:87]
 s_lshl_b32 s4, s4, 2
 ds_read_b64_tr_b16 a[84:85], v7 offset:16384
 v_accvgpr_write_b32 a3, v31
 v_mfma_f32_16x16x32_bf16 v[92:95], a[96:99], a[196:199], v[92:95]
 s_add_u32 s4, s4, s3
 ds_read_b64_tr_b16 a[86:87], v7 offset:20480
 v_xor_b32 v8, 65696, v6
 v_mfma_f32_16x16x32_bf16 v[92:95], a[100:103], a[204:207], v[92:95]
 s_lshl_b32 s6, s4, 10
 ds_read_b64_tr_b16 a[88:89], v8 offset:0
 v_mul_f32 v44, s34, v44
 v_mfma_f32_16x16x32_bf16 v[92:95], a[104:107], a[212:215], v[92:95]
 s_add_u32 s6, s6, 83886080
 ds_read_b64_tr_b16 a[90:91], v8 offset:4096
 v_mul_f32 v45, s34, v45
 v_mfma_f32_16x16x32_bf16 v[92:95], a[108:111], a[220:223], v[92:95]
 s_mul_i32 s4, s4, 17408
 ds_read_b64_tr_b16 a[92:93], v8 offset:16384
 v_mul_f32 v46, s34, v46
 v_mfma_f32_16x16x32_bf16 v[92:95], a[64:67], a[116:119], v[92:95]
 s_add_u32 s59, s56, 53248
 ds_read_b64_tr_b16 a[94:95], v8 offset:20480
 v_xor_b32 v9, 131264, v6
 v_mfma_f32_16x16x32_bf16 v[92:95], a[68:71], a[124:127], v[92:95]
 s_waitcnt lgkmcnt(6)
 ds_read_b64_tr_b16 a[96:97], v9 offset:0
 buffer_store_dwordx4 v[200:203], v1, s[12:15], s59 offen offset:0 sc1
 v_mfma_f32_16x16x32_bf16 v[100:103], a[72:75], a[192:195], v[100:103]
 s_add_u32 s4, s4, 67108864
 ds_read_b64_tr_b16 a[98:99], v9 offset:4096
 v_mul_f32 v47, s34, v47
 v_mfma_f32_16x16x32_bf16 v[100:103], a[76:79], a[200:203], v[100:103]
 s_add_u32 s5, s4, 0x2000
 ds_read_b64_tr_b16 a[100:101], v9 offset:16384
 v_mul_f32 v60, s34, v60
 v_mfma_f32_16x16x32_bf16 v[100:103], a[80:83], a[208:211], v[100:103]
 s_waitcnt lgkmcnt(3)
 ds_read_b64_tr_b16 a[102:103], v9 offset:20480
 v_xor_b32 v10, 192, v6
 v_mfma_f32_16x16x32_bf16 v[100:103], a[84:87], a[216:219], v[100:103]
 s_mov_b32 s7, 0
 ds_read_b64_tr_b16 a[104:105], v10 offset:0
 v_mul_f32 v61, s34, v61
 v_mfma_f32_16x16x32_bf16 v[100:103], a[88:91], a[112:115], v[100:103]
 s_mov_b32 s53, 0
 ds_read_b64_tr_b16 a[106:107], v10 offset:4096
 v_mul_f32 v62, s34, v62
 v_mfma_f32_16x16x32_bf16 v[100:103], a[92:95], a[120:123], v[100:103]
 s_cmp_eq_u32 s38, 0
 s_cmov_b32 s4, 2.0
 ds_read_b64_tr_b16 a[108:109], v10 offset:16384
 v_mfma_f32_16x16x32_bf16 v[108:111], a[72:75], a[196:199], v[108:111]
 s_cmp_eq_u32 s38, 0
 s_cmov_b32 s5, 2.0
 ds_read_b64_tr_b16 a[110:111], v10 offset:20480
 v_xor_b32 v7, 65728, v6
 v_mfma_f32_16x16x32_bf16 v[108:111], a[76:79], a[204:207], v[108:111]
 s_cmp_eq_u32 s38, 0
 s_cmov_b32 s6, 2.0
 ds_read_b64_tr_b16 a[64:65], v7 offset:0
 v_mfma_f32_16x16x32_bf16 v[108:111], a[80:83], a[212:215], v[108:111]
 s_add_u32 s59, s56, 53248
 ds_read_b64_tr_b16 a[66:67], v7 offset:4096
 v_mul_f32 v63, s34, v63
 v_mfma_f32_16x16x32_bf16 v[108:111], a[84:87], a[220:223], v[108:111]
 ds_read_b64_tr_b16 a[68:69], v7 offset:16384
 buffer_store_dwordx4 v[208:211], v1, s[12:15], s59 offen offset:1024 sc1
 v_mfma_f32_16x16x32_bf16 v[108:111], a[88:91], a[116:119], v[108:111]
 s_mov_b64 s[8:9], s[12:13]
 ds_read_b64_tr_b16 a[70:71], v7 offset:20480
 v_xor_b32 v8, 131296, v6
 v_mfma_f32_16x16x32_bf16 v[108:111], a[92:95], a[124:127], v[108:111]
 s_waitcnt lgkmcnt(6)
 ds_read_b64_tr_b16 a[72:73], v8 offset:0
 v_cvt_pk_bf16_f32 v44, v44, v45
 v_mfma_f32_16x16x32_bf16 v[116:119], a[96:99], a[192:195], v[116:119]
 s_mov_b32 s10, s14
 ds_read_b64_tr_b16 a[74:75], v8 offset:4096
 v_cvt_pk_bf16_f32 v45, v46, v47
 v_mfma_f32_16x16x32_bf16 v[116:119], a[100:103], a[200:203], v[116:119]
 s_mov_b32 s76, 0
 ds_read_b64_tr_b16 a[76:77], v8 offset:16384
 v_cvt_pk_bf16_f32 v46, v60, v61
 v_mfma_f32_16x16x32_bf16 v[116:119], a[104:107], a[208:211], v[116:119]
 s_waitcnt lgkmcnt(3)
 ds_read_b64_tr_b16 a[78:79], v8 offset:20480
 v_xor_b32 v9, 224, v6
 v_mfma_f32_16x16x32_bf16 v[116:119], a[108:111], a[216:219], v[116:119]
 s_movk_i32 s77, 0x1000
 ds_read_b64_tr_b16 a[80:81], v9 offset:0
 v_cvt_pk_bf16_f32 v47, v62, v63
 v_mfma_f32_16x16x32_bf16 v[116:119], a[64:67], a[112:115], v[116:119]
 s_mov_b32 s51, 0
 ds_read_b64_tr_b16 a[82:83], v9 offset:4096
 v_accvgpr_write_b32 a32, v44
 v_mfma_f32_16x16x32_bf16 v[116:119], a[68:71], a[120:123], v[116:119]
 s_mul_i32 s78, s26, 229376
 ds_read_b64_tr_b16 a[84:85], v9 offset:16384
 v_accvgpr_write_b32 a33, v45
 v_mfma_f32_16x16x32_bf16 v[124:127], a[96:99], a[196:199], v[124:127]
 s_add_u32 s59, s56, 36864
 ds_read_b64_tr_b16 a[86:87], v9 offset:20480
 v_xor_b32 v10, 65760, v6
 v_mfma_f32_16x16x32_bf16 v[124:127], a[100:103], a[204:207], v[124:127]
 ds_read_b64_tr_b16 a[88:89], v10 offset:0
 buffer_store_dwordx4 v[216:219], v1, s[12:15], s59 offen offset:1024 sc1
 v_mfma_f32_16x16x32_bf16 v[124:127], a[104:107], a[212:215], v[124:127]
 s_add_u32 s79, s78, 28672
 ds_read_b64_tr_b16 a[90:91], v10 offset:4096
 v_accvgpr_write_b32 a34, v46
 v_mfma_f32_16x16x32_bf16 v[124:127], a[108:111], a[220:223], v[124:127]
 s_add_u32 s80, s78, 57344
 ds_read_b64_tr_b16 a[92:93], v10 offset:16384
 v_accvgpr_write_b32 a35, v47
 v_mfma_f32_16x16x32_bf16 v[124:127], a[64:67], a[116:119], v[124:127]
 s_add_u32 s81, s78, 86016
 ds_read_b64_tr_b16 a[94:95], v10 offset:20480
 v_xor_b32 v7, 131328, v6
 v_mfma_f32_16x16x32_bf16 v[124:127], a[68:71], a[124:127], v[124:127]
 s_waitcnt lgkmcnt(6)
 ds_read_b64_tr_b16 a[96:97], v7 offset:0
 v_mul_f32 v20, s34, v20
 v_mfma_f32_16x16x32_bf16 v[132:135], a[72:75], a[192:195], v[132:135]
 s_add_u32 s82, s78, 114688
 ds_read_b64_tr_b16 a[98:99], v7 offset:4096
 v_mul_f32 v21, s34, v21
 v_mfma_f32_16x16x32_bf16 v[132:135], a[76:79], a[200:203], v[132:135]
 s_add_u32 s83, s78, 143360
 ds_read_b64_tr_b16 a[100:101], v7 offset:16384
 v_mul_f32 v22, s34, v22
 v_mfma_f32_16x16x32_bf16 v[132:135], a[80:83], a[208:211], v[132:135]
 s_waitcnt lgkmcnt(3)
 ds_read_b64_tr_b16 a[102:103], v7 offset:20480
 v_xor_b32 v8, 256, v6
 v_mfma_f32_16x16x32_bf16 v[132:135], a[84:87], a[216:219], v[132:135]
 s_add_u32 s84, s78, 172032
 ds_read_b64_tr_b16 a[104:105], v8 offset:0
 v_mul_f32 v23, s34, v23
 v_mfma_f32_16x16x32_bf16 v[132:135], a[88:91], a[112:115], v[132:135]
 s_add_u32 s59, s56, 36864
 ds_read_b64_tr_b16 a[106:107], v8 offset:4096
 v_mul_f32 v68, s34, v68
 v_mfma_f32_16x16x32_bf16 v[132:135], a[92:95], a[120:123], v[132:135]
 ds_read_b64_tr_b16 a[108:109], v8 offset:16384
 buffer_store_dwordx4 v[224:227], v1, s[12:15], s59 offen offset:2048 sc1
 v_mfma_f32_16x16x32_bf16 v[140:143], a[72:75], a[196:199], v[140:143]
 s_add_u32 s85, s78, 200704
 ds_read_b64_tr_b16 a[110:111], v8 offset:20480
 v_xor_b32 v9, 65792, v6
 v_mfma_f32_16x16x32_bf16 v[140:143], a[76:79], a[204:207], v[140:143]
 s_add_u32 s59, s62, 0
 ds_read_b64_tr_b16 a[64:65], v9 offset:0
 v_mul_f32 v69, s34, v69
 v_mfma_f32_16x16x32_bf16 v[140:143], a[80:83], a[212:215], v[140:143]
 ds_read_b64_tr_b16 a[66:67], v9 offset:4096
 buffer_store_dwordx4 v[28:31], v1, s[12:15], s59 offen offset:0 sc1
 v_mfma_f32_16x16x32_bf16 v[140:143], a[84:87], a[220:223], v[140:143]
 ds_read_b64_tr_b16 a[68:69], v9 offset:16384
 v_mul_f32 v70, s34, v70
 v_mfma_f32_16x16x32_bf16 v[140:143], a[88:91], a[116:119], v[140:143]
 s_add_u32 s59, s62, 8192
 ds_read_b64_tr_b16 a[70:71], v9 offset:20480
 v_xor_b32 v10, 131360, v6
 v_mfma_f32_16x16x32_bf16 v[140:143], a[92:95], a[124:127], v[140:143]
 s_waitcnt lgkmcnt(6)
 ds_read_b64_tr_b16 a[72:73], v10 offset:0
 buffer_store_dwordx4 v[44:47], v1, s[12:15], s59 offen offset:0 sc1
 v_mfma_f32_16x16x32_bf16 v[148:151], a[96:99], a[192:195], v[148:151]
 ds_read_b64_tr_b16 a[74:75], v10 offset:4096
 v_mul_f32 v71, s34, v71
 v_mfma_f32_16x16x32_bf16 v[148:151], a[100:103], a[200:203], v[148:151]
 s_add_u32 s59, s56, 53248
 ds_read_b64_tr_b16 a[76:77], v10 offset:16384
 v_cvt_pk_bf16_f32 v20, v20, v21
 v_mfma_f32_16x16x32_bf16 v[148:151], a[104:107], a[208:211], v[148:151]
 s_waitcnt lgkmcnt(3)
 ds_read_b64_tr_b16 a[78:79], v10 offset:20480
 v_xor_b32 v7, 288, v6
 v_mfma_f32_16x16x32_bf16 v[148:151], a[108:111], a[216:219], v[148:151]
 ds_read_b64_tr_b16 a[80:81], v7 offset:0
 buffer_store_dwordx4 v[232:235], v1, s[12:15], s59 offen offset:2048 sc1
 v_mfma_f32_16x16x32_bf16 v[148:151], a[64:67], a[112:115], v[148:151]
 ds_read_b64_tr_b16 a[82:83], v7 offset:4096
 v_cvt_pk_bf16_f32 v21, v22, v23
 v_mfma_f32_16x16x32_bf16 v[148:151], a[68:71], a[120:123], v[148:151]
 ds_read_b64_tr_b16 a[84:85], v7 offset:16384
 v_cvt_pk_bf16_f32 v22, v68, v69
 v_mfma_f32_16x16x32_bf16 v[156:159], a[96:99], a[196:199], v[156:159]
 ds_read_b64_tr_b16 a[86:87], v7 offset:20480
 v_xor_b32 v8, 65824, v6
 v_mfma_f32_16x16x32_bf16 v[156:159], a[100:103], a[204:207], v[156:159]
 s_add_u32 s59, s62, 0
 ds_read_b64_tr_b16 a[88:89], v8 offset:0
 v_cvt_pk_bf16_f32 v23, v70, v71
 v_mfma_f32_16x16x32_bf16 v[156:159], a[104:107], a[212:215], v[156:159]
 ds_read_b64_tr_b16 a[90:91], v8 offset:4096
 buffer_store_dwordx4 v[20:23], v1, s[12:15], s59 offen offset:1024 sc1
 v_mfma_f32_16x16x32_bf16 v[156:159], a[108:111], a[220:223], v[156:159]
 ds_read_b64_tr_b16 a[92:93], v8 offset:16384
 v_accvgpr_write_b32 a4, v20
 v_mfma_f32_16x16x32_bf16 v[156:159], a[64:67], a[116:119], v[156:159]
 ds_read_b64_tr_b16 a[94:95], v8 offset:20480
 v_xor_b32 v9, 131392, v6
 v_mfma_f32_16x16x32_bf16 v[156:159], a[68:71], a[124:127], v[156:159]
 s_waitcnt lgkmcnt(6)
 ds_read_b64_tr_b16 a[96:97], v9 offset:0
 v_accvgpr_write_b32 a5, v21
 v_mfma_f32_16x16x32_bf16 v[164:167], a[72:75], a[192:195], v[164:167]
 s_add_u32 s59, s56, 53248
 ds_read_b64_tr_b16 a[98:99], v9 offset:4096
 v_accvgpr_write_b32 a6, v22
 v_mfma_f32_16x16x32_bf16 v[164:167], a[76:79], a[200:203], v[164:167]
 ds_read_b64_tr_b16 a[100:101], v9 offset:16384
 buffer_store_dwordx4 v[240:243], v1, s[12:15], s59 offen offset:3072 sc1
 v_mfma_f32_16x16x32_bf16 v[164:167], a[80:83], a[208:211], v[164:167]
 s_waitcnt lgkmcnt(3)
 ds_read_b64_tr_b16 a[102:103], v9 offset:20480
 v_xor_b32 v10, 320, v6
 v_mfma_f32_16x16x32_bf16 v[164:167], a[84:87], a[216:219], v[164:167]
 ds_read_b64_tr_b16 a[104:105], v10 offset:0
 v_accvgpr_write_b32 a7, v23
 v_mfma_f32_16x16x32_bf16 v[164:167], a[88:91], a[112:115], v[164:167]
 ds_read_b64_tr_b16 a[106:107], v10 offset:4096
 v_mul_f32 v36, s34, v36
 v_mfma_f32_16x16x32_bf16 v[164:167], a[92:95], a[120:123], v[164:167]
 ds_read_b64_tr_b16 a[108:109], v10 offset:16384
 v_mul_f32 v37, s34, v37
 v_mfma_f32_16x16x32_bf16 v[172:175], a[72:75], a[196:199], v[172:175]
 ds_read_b64_tr_b16 a[110:111], v10 offset:20480
 v_xor_b32 v7, 65856, v6
 v_mfma_f32_16x16x32_bf16 v[172:175], a[76:79], a[204:207], v[172:175]
 ds_read_b64_tr_b16 a[64:65], v7 offset:0
 v_mul_f32 v38, s34, v38
 v_mfma_f32_16x16x32_bf16 v[172:175], a[80:83], a[212:215], v[172:175]
 ds_read_b64_tr_b16 a[66:67], v7 offset:4096
 v_mul_f32 v39, s34, v39
 v_mfma_f32_16x16x32_bf16 v[172:175], a[84:87], a[220:223], v[172:175]
 ds_read_b64_tr_b16 a[68:69], v7 offset:16384
 v_mul_f32 v76, s34, v76
 v_mfma_f32_16x16x32_bf16 v[172:175], a[88:91], a[116:119], v[172:175]
 s_add_u32 s59, s56, 36864
 ds_read_b64_tr_b16 a[70:71], v7 offset:20480
 v_xor_b32 v8, 131424, v6
 v_mfma_f32_16x16x32_bf16 v[172:175], a[92:95], a[124:127], v[172:175]
 s_waitcnt lgkmcnt(6)
 ds_read_b64_tr_b16 a[72:73], v8 offset:0
 buffer_store_dwordx4 v[248:251], v1, s[12:15], s59 offen offset:3072 sc1
 v_mfma_f32_16x16x32_bf16 v[180:183], a[96:99], a[192:195], v[180:183]
 ds_read_b64_tr_b16 a[74:75], v8 offset:4096
 v_mul_f32 v77, s34, v77
 v_mfma_f32_16x16x32_bf16 v[180:183], a[100:103], a[200:203], v[180:183]
 ds_read_b64_tr_b16 a[76:77], v8 offset:16384
 v_mul_f32 v78, s34, v78
 v_mfma_f32_16x16x32_bf16 v[180:183], a[104:107], a[208:211], v[180:183]
 s_waitcnt lgkmcnt(3)
 ds_read_b64_tr_b16 a[78:79], v8 offset:20480
 v_xor_b32 v9, 352, v6
 v_mfma_f32_16x16x32_bf16 v[180:183], a[108:111], a[216:219], v[180:183]
 ds_read_b64_tr_b16 a[80:81], v9 offset:0
 v_mul_f32 v79, s34, v79
 v_mfma_f32_16x16x32_bf16 v[180:183], a[64:67], a[112:115], v[180:183]
 ds_read_b64_tr_b16 a[82:83], v9 offset:4096
 v_cvt_pk_bf16_f32 v36, v36, v37
 v_mfma_f32_16x16x32_bf16 v[180:183], a[68:71], a[120:123], v[180:183]
 ds_read_b64_tr_b16 a[84:85], v9 offset:16384
 v_cvt_pk_bf16_f32 v37, v38, v39
 v_mfma_f32_16x16x32_bf16 v[188:191], a[96:99], a[196:199], v[188:191]
 ds_read_b64_tr_b16 a[86:87], v9 offset:20480
 v_xor_b32 v10, 65888, v6
 v_mfma_f32_16x16x32_bf16 v[188:191], a[100:103], a[204:207], v[188:191]
 ds_read_b64_tr_b16 a[88:89], v10 offset:0
 v_cvt_pk_bf16_f32 v38, v76, v77
 v_mfma_f32_16x16x32_bf16 v[188:191], a[104:107], a[212:215], v[188:191]
 s_add_u32 s59, s62, 8192
 ds_read_b64_tr_b16 a[90:91], v10 offset:4096
 v_cvt_pk_bf16_f32 v39, v78, v79
 v_mfma_f32_16x16x32_bf16 v[188:191], a[108:111], a[220:223], v[188:191]
 ds_read_b64_tr_b16 a[92:93], v10 offset:16384
 buffer_store_dwordx4 v[36:39], v1, s[12:15], s59 offen offset:1024 sc1
 v_mfma_f32_16x16x32_bf16 v[188:191], a[64:67], a[116:119], v[188:191]
 ds_read_b64_tr_b16 a[94:95], v10 offset:20480
 v_xor_b32 v7, 131456, v6
 v_mfma_f32_16x16x32_bf16 v[188:191], a[68:71], a[124:127], v[188:191]
 s_waitcnt lgkmcnt(6)
 ds_read_b64_tr_b16 a[96:97], v7 offset:0
 v_accvgpr_write_b32 a36, v36
 v_mfma_f32_16x16x32_bf16 v[196:199], a[72:75], a[192:195], v[196:199]
 ds_read_b64_tr_b16 a[98:99], v7 offset:4096
 v_accvgpr_write_b32 a37, v37
 v_mfma_f32_16x16x32_bf16 v[196:199], a[76:79], a[200:203], v[196:199]
 ds_read_b64_tr_b16 a[100:101], v7 offset:16384
 v_accvgpr_write_b32 a38, v38
 v_mfma_f32_16x16x32_bf16 v[196:199], a[80:83], a[208:211], v[196:199]
 s_waitcnt lgkmcnt(3)
 ds_read_b64_tr_b16 a[102:103], v7 offset:20480
 v_xor_b32 v8, 384, v6
 v_mfma_f32_16x16x32_bf16 v[196:199], a[84:87], a[216:219], v[196:199]
 ds_read_b64_tr_b16 a[104:105], v8 offset:0
 v_accvgpr_write_b32 a39, v39
 v_mfma_f32_16x16x32_bf16 v[196:199], a[88:91], a[112:115], v[196:199]
 ds_read_b64_tr_b16 a[106:107], v8 offset:4096
 v_mul_f32 v84, s34, v84
 v_mfma_f32_16x16x32_bf16 v[196:199], a[92:95], a[120:123], v[196:199]
 ds_read_b64_tr_b16 a[108:109], v8 offset:16384
 v_mul_f32 v85, s34, v85
 v_mfma_f32_16x16x32_bf16 v[204:207], a[72:75], a[196:199], v[204:207]
 ds_read_b64_tr_b16 a[110:111], v8 offset:20480
 v_xor_b32 v9, 65920, v6
 v_mfma_f32_16x16x32_bf16 v[204:207], a[76:79], a[204:207], v[204:207]
 ds_read_b64_tr_b16 a[64:65], v9 offset:0
 v_mul_f32 v86, s34, v86
 v_mfma_f32_16x16x32_bf16 v[204:207], a[80:83], a[212:215], v[204:207]
 ds_read_b64_tr_b16 a[66:67], v9 offset:4096
 v_mul_f32 v87, s34, v87
 v_mfma_f32_16x16x32_bf16 v[204:207], a[84:87], a[220:223], v[204:207]
 ds_read_b64_tr_b16 a[68:69], v9 offset:16384
 v_mul_f32 v100, s34, v100
 v_mfma_f32_16x16x32_bf16 v[204:207], a[88:91], a[116:119], v[204:207]
 ds_read_b64_tr_b16 a[70:71], v9 offset:20480
 v_xor_b32 v10, 131488, v6
 v_mfma_f32_16x16x32_bf16 v[204:207], a[92:95], a[124:127], v[204:207]
 s_waitcnt lgkmcnt(6)
 ds_read_b64_tr_b16 a[72:73], v10 offset:0
 v_mul_f32 v101, s34, v101
 v_mfma_f32_16x16x32_bf16 v[212:215], a[96:99], a[192:195], v[212:215]
 ds_read_b64_tr_b16 a[74:75], v10 offset:4096
 v_mul_f32 v102, s34, v102
 v_mfma_f32_16x16x32_bf16 v[212:215], a[100:103], a[200:203], v[212:215]
 ds_read_b64_tr_b16 a[76:77], v10 offset:16384
 v_mul_f32 v103, s34, v103
 v_mfma_f32_16x16x32_bf16 v[212:215], a[104:107], a[208:211], v[212:215]
 s_waitcnt lgkmcnt(3)
 ds_read_b64_tr_b16 a[78:79], v10 offset:20480
 v_xor_b32 v7, 416, v6
 v_mfma_f32_16x16x32_bf16 v[212:215], a[108:111], a[216:219], v[212:215]
 ds_read_b64_tr_b16 a[80:81], v7 offset:0
 v_cvt_pk_bf16_f32 v84, v84, v85
 v_mfma_f32_16x16x32_bf16 v[212:215], a[64:67], a[112:115], v[212:215]
 ds_read_b64_tr_b16 a[82:83], v7 offset:4096
 v_cvt_pk_bf16_f32 v85, v86, v87
 v_mfma_f32_16x16x32_bf16 v[212:215], a[68:71], a[120:123], v[212:215]
 ds_read_b64_tr_b16 a[84:85], v7 offset:16384
 v_cvt_pk_bf16_f32 v86, v100, v101
 v_mfma_f32_16x16x32_bf16 v[220:223], a[96:99], a[196:199], v[220:223]
 ds_read_b64_tr_b16 a[86:87], v7 offset:20480
 v_xor_b32 v8, 65952, v6
 v_mfma_f32_16x16x32_bf16 v[220:223], a[100:103], a[204:207], v[220:223]
 s_add_u32 s59, s62, 0
 ds_read_b64_tr_b16 a[88:89], v8 offset:0
 v_cvt_pk_bf16_f32 v87, v102, v103
 v_mfma_f32_16x16x32_bf16 v[220:223], a[104:107], a[212:215], v[220:223]
 ds_read_b64_tr_b16 a[90:91], v8 offset:4096
 buffer_store_dwordx4 v[84:87], v1, s[12:15], s59 offen offset:2048 sc1
 v_mfma_f32_16x16x32_bf16 v[220:223], a[108:111], a[220:223], v[220:223]
 ds_read_b64_tr_b16 a[92:93], v8 offset:16384
 v_accvgpr_write_b32 a8, v84
 v_mfma_f32_16x16x32_bf16 v[220:223], a[64:67], a[116:119], v[220:223]
 ds_read_b64_tr_b16 a[94:95], v8 offset:20480
 v_xor_b32 v9, 131520, v6
 v_mfma_f32_16x16x32_bf16 v[220:223], a[68:71], a[124:127], v[220:223]
 s_waitcnt lgkmcnt(6)
 ds_read_b64_tr_b16 a[96:97], v9 offset:0
 v_accvgpr_write_b32 a9, v85
 v_mfma_f32_16x16x32_bf16 v[228:231], a[72:75], a[192:195], v[228:231]
 ds_read_b64_tr_b16 a[98:99], v9 offset:4096
 v_accvgpr_write_b32 a10, v86
 v_mfma_f32_16x16x32_bf16 v[228:231], a[76:79], a[200:203], v[228:231]
 ds_read_b64_tr_b16 a[100:101], v9 offset:16384
 v_accvgpr_write_b32 a11, v87
 v_mfma_f32_16x16x32_bf16 v[228:231], a[80:83], a[208:211], v[228:231]
 s_waitcnt lgkmcnt(3)
 ds_read_b64_tr_b16 a[102:103], v9 offset:20480
 v_xor_b32 v10, 448, v6
 v_mfma_f32_16x16x32_bf16 v[228:231], a[84:87], a[216:219], v[228:231]
 ds_read_b64_tr_b16 a[104:105], v10 offset:0
 v_mul_f32 v92, s34, v92
 v_mfma_f32_16x16x32_bf16 v[228:231], a[88:91], a[112:115], v[228:231]
 ds_read_b64_tr_b16 a[106:107], v10 offset:4096
 v_mul_f32 v93, s34, v93
 v_mfma_f32_16x16x32_bf16 v[228:231], a[92:95], a[120:123], v[228:231]
 ds_read_b64_tr_b16 a[108:109], v10 offset:16384
 v_mul_f32 v94, s34, v94
 v_mfma_f32_16x16x32_bf16 v[236:239], a[72:75], a[196:199], v[236:239]
 ds_read_b64_tr_b16 a[110:111], v10 offset:20480
 v_xor_b32 v7, 65984, v6
 v_mfma_f32_16x16x32_bf16 v[236:239], a[76:79], a[204:207], v[236:239]
 ds_read_b64_tr_b16 a[64:65], v7 offset:0
 buffer_load_dword v13, v12, s[12:15], s58 offen sc1
 v_mfma_f32_16x16x32_bf16 v[236:239], a[80:83], a[212:215], v[236:239]
 ds_read_b64_tr_b16 a[66:67], v7 offset:4096
 v_mul_f32 v95, s34, v95
 v_mfma_f32_16x16x32_bf16 v[236:239], a[84:87], a[220:223], v[236:239]
 ds_read_b64_tr_b16 a[68:69], v7 offset:16384
 v_mul_f32 v108, s34, v108
 v_mfma_f32_16x16x32_bf16 v[236:239], a[88:91], a[116:119], v[236:239]
 ds_read_b64_tr_b16 a[70:71], v7 offset:20480
 v_xor_b32 v8, 131552, v6
 v_mfma_f32_16x16x32_bf16 v[236:239], a[92:95], a[124:127], v[236:239]
 s_waitcnt lgkmcnt(6)
 ds_read_b64_tr_b16 a[72:73], v8 offset:0
 v_mul_f32 v109, s34, v109
 v_mfma_f32_16x16x32_bf16 v[244:247], a[96:99], a[192:195], v[244:247]
 ds_read_b64_tr_b16 a[74:75], v8 offset:4096
 v_mul_f32 v110, s34, v110
 v_mfma_f32_16x16x32_bf16 v[244:247], a[100:103], a[200:203], v[244:247]
 ds_read_b64_tr_b16 a[76:77], v8 offset:16384
 v_mul_f32 v111, s34, v111
 v_mfma_f32_16x16x32_bf16 v[244:247], a[104:107], a[208:211], v[244:247]
 s_waitcnt lgkmcnt(3)
 ds_read_b64_tr_b16 a[78:79], v8 offset:20480
 v_xor_b32 v9, 480, v6
 v_mfma_f32_16x16x32_bf16 v[244:247], a[108:111], a[216:219], v[244:247]
 ds_read_b64_tr_b16 a[80:81], v9 offset:0
 v_cvt_pk_bf16_f32 v92, v92, v93
 v_mfma_f32_16x16x32_bf16 v[244:247], a[64:67], a[112:115], v[244:247]
 ds_read_b64_tr_b16 a[82:83], v9 offset:4096
 v_cvt_pk_bf16_f32 v93, v94, v95
 v_mfma_f32_16x16x32_bf16 v[244:247], a[68:71], a[120:123], v[244:247]
 ds_read_b64_tr_b16 a[84:85], v9 offset:16384
 v_cvt_pk_bf16_f32 v94, v108, v109
 v_mfma_f32_16x16x32_bf16 v[252:255], a[96:99], a[196:199], v[252:255]
 ds_read_b64_tr_b16 a[86:87], v9 offset:20480
 v_xor_b32 v10, 66016, v6
 v_mfma_f32_16x16x32_bf16 v[252:255], a[100:103], a[204:207], v[252:255]
 s_add_u32 s59, s62, 8192
 ds_read_b64_tr_b16 a[88:89], v10 offset:0
 v_cvt_pk_bf16_f32 v95, v110, v111
 v_mfma_f32_16x16x32_bf16 v[252:255], a[104:107], a[212:215], v[252:255]
 ds_read_b64_tr_b16 a[90:91], v10 offset:4096
 buffer_store_dwordx4 v[92:95], v1, s[12:15], s59 offen offset:2048 sc1
 v_mfma_f32_16x16x32_bf16 v[252:255], a[108:111], a[220:223], v[252:255]
 ds_read_b64_tr_b16 a[92:93], v10 offset:16384
 v_accvgpr_write_b32 a40, v92
 v_mfma_f32_16x16x32_bf16 v[252:255], a[64:67], a[116:119], v[252:255]
 ds_read_b64_tr_b16 a[94:95], v10 offset:20480
 v_accvgpr_write_b32 a41, v93
 v_mfma_f32_16x16x32_bf16 v[252:255], a[68:71], a[124:127], v[252:255]
 s_waitcnt lgkmcnt(6)
 v_accvgpr_write_b32 a42, v94
 v_accvgpr_write_b32 a43, v95
 v_mfma_f32_16x16x32_bf16 v[16:19], a[72:75], a[192:195], v[16:19]
 v_mfma_f32_16x16x32_bf16 v[16:19], a[76:79], a[200:203], v[16:19]
 v_mfma_f32_16x16x32_bf16 v[16:19], a[80:83], a[208:211], v[16:19]
 s_waitcnt lgkmcnt(0)
 v_mfma_f32_16x16x32_bf16 v[16:19], a[84:87], a[216:219], v[16:19]
 v_mfma_f32_16x16x32_bf16 v[16:19], a[88:91], a[112:115], v[16:19]
 v_mfma_f32_16x16x32_bf16 v[16:19], a[92:95], a[120:123], v[16:19]
 v_mfma_f32_16x16x32_bf16 v[24:27], a[72:75], a[196:199], v[24:27]
 v_mfma_f32_16x16x32_bf16 v[24:27], a[76:79], a[204:207], v[24:27]
 v_mfma_f32_16x16x32_bf16 v[24:27], a[80:83], a[212:215], v[24:27]
 v_mfma_f32_16x16x32_bf16 v[24:27], a[84:87], a[220:223], v[24:27]
 s_waitcnt lgkmcnt(0)
 v_mfma_f32_16x16x32_bf16 v[24:27], a[88:91], a[116:119], v[24:27]
 s_barrier
 v_mfma_f32_16x16x32_bf16 v[24:27], a[92:95], a[124:127], v[24:27]
 s_waitcnt vmcnt(1)
 v_cmp_ne_u32 s[16:17], 0, v13
 v_cmp_gt_u32 vcc, 256, v5
 s_or_b64 vcc, vcc, s[16:17]
 s_mov_b32 m0, s40
 s_cselect_b32 s48, 0, 1
 s_cselect_b32 s52, 2.0, s42
 buffer_load_dwordx4 v1, s[12:15], s52 offen offset:0 sc1 lds
 v_pk_mul_f32 v[116:117], v[116:117], s[34:35]
 v_pk_mul_f32 v[118:119], v[118:119], s[34:35]
 v_pk_mul_f32 v[132:133], v[132:133], s[34:35]
 v_pk_mul_f32 v[134:135], v[134:135], s[34:35]
 v_cvt_pk_bf16_f32 v116, v116, v117
 v_cvt_pk_bf16_f32 v117, v118, v119
 v_cvt_pk_bf16_f32 v118, v132, v133
 v_cvt_pk_bf16_f32 v119, v134, v135
 s_add_u32 s59, s62, 0
 buffer_store_dwordx4 v[116:119], v1, s[12:15], s59 offen offset:3072 sc1
 v_accvgpr_write_b32 a12, v116
 v_accvgpr_write_b32 a13, v117
 v_accvgpr_write_b32 a14, v118
 v_accvgpr_write_b32 a15, v119
 v_pk_mul_f32 v[124:125], v[124:125], s[34:35]
 v_pk_mul_f32 v[126:127], v[126:127], s[34:35]
 v_pk_mul_f32 v[140:141], v[140:141], s[34:35]
 v_pk_mul_f32 v[142:143], v[142:143], s[34:35]
 buffer_load_dwordx4 v1, s[12:15], s52 offen offset:1024 sc1 lds
 v_cvt_pk_bf16_f32 v124, v124, v125
 v_cvt_pk_bf16_f32 v125, v126, v127
 v_cvt_pk_bf16_f32 v126, v140, v141
 v_cvt_pk_bf16_f32 v127, v142, v143
 s_add_u32 s59, s62, 8192
 buffer_store_dwordx4 v[124:127], v1, s[12:15], s59 offen offset:3072 sc1
 v_accvgpr_write_b32 a44, v124
 v_accvgpr_write_b32 a45, v125
 v_accvgpr_write_b32 a46, v126
 v_accvgpr_write_b32 a47, v127
 v_pk_mul_f32 v[148:149], v[148:149], s[34:35]
 v_pk_mul_f32 v[150:151], v[150:151], s[34:35]
 v_pk_mul_f32 v[164:165], v[164:165], s[34:35]
 v_pk_mul_f32 v[166:167], v[166:167], s[34:35]
 v_cvt_pk_bf16_f32 v148, v148, v149
 v_cvt_pk_bf16_f32 v149, v150, v151
 v_cvt_pk_bf16_f32 v150, v164, v165
 buffer_load_dwordx4 v1, s[12:15], s52 offen offset:2048 sc1 lds
 v_cvt_pk_bf16_f32 v151, v166, v167
 s_add_u32 s59, s62, 4096
 buffer_store_dwordx4 v[148:151], v1, s[12:15], s59 offen offset:0 sc1
 v_accvgpr_write_b32 a16, v148
 v_accvgpr_write_b32 a17, v149
 v_accvgpr_write_b32 a18, v150
 v_accvgpr_write_b32 a19, v151
 v_pk_mul_f32 v[156:157], v[156:157], s[34:35]
 v_pk_mul_f32 v[158:159], v[158:159], s[34:35]
 v_pk_mul_f32 v[172:173], v[172:173], s[34:35]
 v_pk_mul_f32 v[174:175], v[174:175], s[34:35]
 v_cvt_pk_bf16_f32 v156, v156, v157
 v_cvt_pk_bf16_f32 v157, v158, v159
 v_cvt_pk_bf16_f32 v158, v172, v173
 v_cvt_pk_bf16_f32 v159, v174, v175
 s_add_u32 s59, s62, 12288
 buffer_store_dwordx4 v[156:159], v1, s[12:15], s59 offen offset:0 sc1
 v_accvgpr_write_b32 a48, v156
 buffer_load_dwordx4 v1, s[12:15], s52 offen offset:3072 sc1 lds
 v_accvgpr_write_b32 a49, v157
 v_accvgpr_write_b32 a50, v158
 v_accvgpr_write_b32 a51, v159
 v_pk_mul_f32 v[180:181], v[180:181], s[34:35]
 v_pk_mul_f32 v[182:183], v[182:183], s[34:35]
 v_pk_mul_f32 v[196:197], v[196:197], s[34:35]
 v_pk_mul_f32 v[198:199], v[198:199], s[34:35]
 v_cvt_pk_bf16_f32 v180, v180, v181
 v_cvt_pk_bf16_f32 v181, v182, v183
 v_cvt_pk_bf16_f32 v182, v196, v197
 v_cvt_pk_bf16_f32 v183, v198, v199
 s_add_u32 s59, s62, 4096
 buffer_store_dwordx4 v[180:183], v1, s[12:15], s59 offen offset:1024 sc1
 v_accvgpr_write_b32 a20, v180
 v_accvgpr_write_b32 a21, v181
 v_accvgpr_write_b32 a22, v182
 v_accvgpr_write_b32 a23, v183
 s_bitset1_b32 m0, 12
 s_nop 0
 buffer_load_dwordx4 v4, s[12:15], s52 offen offset:0 sc1 lds
 v_pk_mul_f32 v[188:189], v[188:189], s[34:35]
 v_pk_mul_f32 v[190:191], v[190:191], s[34:35]
 v_pk_mul_f32 v[204:205], v[204:205], s[34:35]
 v_pk_mul_f32 v[206:207], v[206:207], s[34:35]
 v_cvt_pk_bf16_f32 v188, v188, v189
 v_cvt_pk_bf16_f32 v189, v190, v191
 v_cvt_pk_bf16_f32 v190, v204, v205
 v_cvt_pk_bf16_f32 v191, v206, v207
 s_add_u32 s59, s62, 12288
 buffer_store_dwordx4 v[188:191], v1, s[12:15], s59 offen offset:1024 sc1
 v_accvgpr_write_b32 a52, v188
 v_accvgpr_write_b32 a53, v189
 v_accvgpr_write_b32 a54, v190
 v_accvgpr_write_b32 a55, v191
 v_pk_mul_f32 v[212:213], v[212:213], s[34:35]
 v_pk_mul_f32 v[214:215], v[214:215], s[34:35]
 v_pk_mul_f32 v[228:229], v[228:229], s[34:35]
 v_pk_mul_f32 v[230:231], v[230:231], s[34:35]
 buffer_load_dwordx4 v4, s[12:15], s52 offen offset:1024 sc1 lds
 v_cvt_pk_bf16_f32 v212, v212, v213
 v_cvt_pk_bf16_f32 v213, v214, v215
 v_cvt_pk_bf16_f32 v214, v228, v229
 v_cvt_pk_bf16_f32 v215, v230, v231
 s_add_u32 s59, s62, 4096
 buffer_store_dwordx4 v[212:215], v1, s[12:15], s59 offen offset:2048 sc1
 v_accvgpr_write_b32 a24, v212
 v_accvgpr_write_b32 a25, v213
 v_accvgpr_write_b32 a26, v214
 v_accvgpr_write_b32 a27, v215
 v_pk_mul_f32 v[220:221], v[220:221], s[34:35]
 v_pk_mul_f32 v[222:223], v[222:223], s[34:35]
 v_pk_mul_f32 v[236:237], v[236:237], s[34:35]
 v_pk_mul_f32 v[238:239], v[238:239], s[34:35]
 v_cvt_pk_bf16_f32 v220, v220, v221
 v_cvt_pk_bf16_f32 v221, v222, v223
 v_cvt_pk_bf16_f32 v222, v236, v237
 buffer_load_dwordx4 v4, s[12:15], s52 offen offset:2048 sc1 lds
 v_cvt_pk_bf16_f32 v223, v238, v239
 s_add_u32 s59, s62, 12288
 buffer_store_dwordx4 v[220:223], v1, s[12:15], s59 offen offset:2048 sc1
 v_accvgpr_write_b32 a56, v220
 v_accvgpr_write_b32 a57, v221
 v_accvgpr_write_b32 a58, v222
 v_accvgpr_write_b32 a59, v223
 v_pk_mul_f32 v[244:245], v[244:245], s[34:35]
 v_pk_mul_f32 v[246:247], v[246:247], s[34:35]
 v_pk_mul_f32 v[16:17], v[16:17], s[34:35]
 v_pk_mul_f32 v[18:19], v[18:19], s[34:35]
 v_cvt_pk_bf16_f32 v244, v244, v245
 v_cvt_pk_bf16_f32 v245, v246, v247
 v_cvt_pk_bf16_f32 v246, v16, v17
 v_cvt_pk_bf16_f32 v247, v18, v19
 s_add_u32 s59, s62, 4096
 buffer_store_dwordx4 v[244:247], v1, s[12:15], s59 offen offset:3072 sc1
 v_accvgpr_write_b32 a28, v244
 buffer_load_dwordx4 v4, s[12:15], s52 offen offset:3072 sc1 lds
 v_accvgpr_write_b32 a29, v245
 v_accvgpr_write_b32 a30, v246
 v_accvgpr_write_b32 a31, v247
 v_pk_mul_f32 v[252:253], v[252:253], s[34:35]
 v_pk_mul_f32 v[254:255], v[254:255], s[34:35]
 v_pk_mul_f32 v[24:25], v[24:25], s[34:35]
 v_pk_mul_f32 v[26:27], v[26:27], s[34:35]
 v_cvt_pk_bf16_f32 v252, v252, v253
 v_cvt_pk_bf16_f32 v253, v254, v255
 v_cvt_pk_bf16_f32 v254, v24, v25
 v_cvt_pk_bf16_f32 v255, v26, v27
 s_add_u32 s59, s62, 12288
 buffer_store_dwordx4 v[252:255], v1, s[12:15], s59 offen offset:3072 sc1
 v_accvgpr_write_b32 a60, v252
 v_accvgpr_write_b32 a61, v253
 v_accvgpr_write_b32 a62, v254
 v_accvgpr_write_b32 a63, v255
L_kvdone:
 s_load_dword s31, s[74:75], s30
 s_cmp_ge_u32 s28, 14
 s_cbranch_scc1 L_s1b
 s_mov_b32 s36, 0xffff0000
 s_and_b32 s33, s95, 31
 s_lshr_b32 s34, s95, 5
 v_lshlrev_b32 v128, 16, v32
 v_and_b32 v129, s36, v32
 v_lshlrev_b32 v130, 16, v40
 v_and_b32 v131, s36, v40
 v_lshlrev_b32 v132, 16, v48
 v_and_b32 v133, s36, v48
 v_lshlrev_b32 v134, 16, v56
 v_and_b32 v135, s36, v56
 v_lshlrev_b32 v136, 16, v64
 v_and_b32 v137, s36, v64
 v_lshlrev_b32 v138, 16, v72
 v_and_b32 v139, s36, v72
 v_lshlrev_b32 v140, 16, v80
 v_and_b32 v141, s36, v80
 v_lshlrev_b32 v142, 16, v88
 v_lshlrev_b32 v143, 16, v90
 v_and_b32 v144, s36, v88
 v_and_b32 v145, s36, v90
 v_lshlrev_b32 v146, 16, v89
 v_lshlrev_b32 v147, 16, v91
 v_and_b32 v148, s36, v89
 v_and_b32 v149, s36, v91
 v_pk_mul_f32 v[150:151], v[128:129], v[148:149]
 v_pk_fma_f32 v[150:151], v[130:131], v[146:147], v[150:151]
 v_pk_fma_f32 v[150:151], v[132:133], v[144:145], v[150:151]
 v_pk_fma_f32 v[150:151], v[134:135], v[142:143], v[150:151]
 v_pk_mul_f32 v[150:151], v[150:151], v[138:139]
 v_cvt_pk_bf16_f32 v16, v150, v151
 v_pk_mul_f32 v[152:153], v[130:131], v[148:149]
 v_pk_fma_f32 v[152:153], v[132:133], v[146:147], v[152:153]
 v_pk_fma_f32 v[152:153], v[134:135], v[144:145], v[152:153]
 v_pk_fma_f32 v[152:153], v[136:137], v[142:143], v[152:153]
 v_pk_mul_f32 v[152:153], v[152:153], v[140:141]
 v_cvt_pk_bf16_f32 v20, v152, v153
 v_lshlrev_b32 v128, 16, v33
 v_and_b32 v129, s36, v33
 v_lshlrev_b32 v130, 16, v41
 v_and_b32 v131, s36, v41
 v_lshlrev_b32 v132, 16, v49
 v_and_b32 v133, s36, v49
 v_lshlrev_b32 v134, 16, v57
 v_and_b32 v135, s36, v57
 v_lshlrev_b32 v136, 16, v65
 v_and_b32 v137, s36, v65
 v_lshlrev_b32 v138, 16, v73
 v_and_b32 v139, s36, v73
 v_lshlrev_b32 v140, 16, v81
 v_and_b32 v141, s36, v81
 v_lshlrev_b32 v142, 16, v96
 v_lshlrev_b32 v143, 16, v98
 v_and_b32 v144, s36, v96
 v_and_b32 v145, s36, v98
 v_lshlrev_b32 v146, 16, v97
 v_lshlrev_b32 v147, 16, v99
 v_and_b32 v148, s36, v97
 v_and_b32 v149, s36, v99
 v_pk_mul_f32 v[150:151], v[128:129], v[148:149]
 v_pk_fma_f32 v[150:151], v[130:131], v[146:147], v[150:151]
 v_pk_fma_f32 v[150:151], v[132:133], v[144:145], v[150:151]
 v_pk_fma_f32 v[150:151], v[134:135], v[142:143], v[150:151]
 v_pk_mul_f32 v[150:151], v[150:151], v[138:139]
 v_cvt_pk_bf16_f32 v17, v150, v151
 v_pk_mul_f32 v[152:153], v[130:131], v[148:149]
 v_pk_fma_f32 v[152:153], v[132:133], v[146:147], v[152:153]
 v_pk_fma_f32 v[152:153], v[134:135], v[144:145], v[152:153]
 v_pk_fma_f32 v[152:153], v[136:137], v[142:143], v[152:153]
 v_pk_mul_f32 v[152:153], v[152:153], v[140:141]
 v_cvt_pk_bf16_f32 v21, v152, v153
 v_lshlrev_b32 v128, 16, v34
 v_and_b32 v129, s36, v34
 v_lshlrev_b32 v130, 16, v42
 v_and_b32 v131, s36, v42
 v_lshlrev_b32 v132, 16, v50
 v_and_b32 v133, s36, v50
 v_lshlrev_b32 v134, 16, v58
 v_and_b32 v135, s36, v58
 v_lshlrev_b32 v136, 16, v66
 v_and_b32 v137, s36, v66
 v_lshlrev_b32 v138, 16, v74
 v_and_b32 v139, s36, v74
 v_lshlrev_b32 v140, 16, v82
 v_and_b32 v141, s36, v82
 v_lshlrev_b32 v142, 16, v104
 v_lshlrev_b32 v143, 16, v106
 v_and_b32 v144, s36, v104
 v_and_b32 v145, s36, v106
 v_lshlrev_b32 v146, 16, v105
 v_lshlrev_b32 v147, 16, v107
 v_and_b32 v148, s36, v105
 v_and_b32 v149, s36, v107
 v_pk_mul_f32 v[150:151], v[128:129], v[148:149]
 v_pk_fma_f32 v[150:151], v[130:131], v[146:147], v[150:151]
 v_pk_fma_f32 v[150:151], v[132:133], v[144:145], v[150:151]
 v_pk_fma_f32 v[150:151], v[134:135], v[142:143], v[150:151]
 v_pk_mul_f32 v[150:151], v[150:151], v[138:139]
 v_cvt_pk_bf16_f32 v18, v150, v151
 v_pk_mul_f32 v[152:153], v[130:131], v[148:149]
 v_pk_fma_f32 v[152:153], v[132:133], v[146:147], v[152:153]
 v_pk_fma_f32 v[152:153], v[134:135], v[144:145], v[152:153]
 v_pk_fma_f32 v[152:153], v[136:137], v[142:143], v[152:153]
 v_pk_mul_f32 v[152:153], v[152:153], v[140:141]
 v_cvt_pk_bf16_f32 v22, v152, v153
 v_lshlrev_b32 v128, 16, v35
 v_and_b32 v129, s36, v35
 v_lshlrev_b32 v130, 16, v43
 v_and_b32 v131, s36, v43
 v_lshlrev_b32 v132, 16, v51
 v_and_b32 v133, s36, v51
 v_lshlrev_b32 v134, 16, v59
 v_and_b32 v135, s36, v59
 v_lshlrev_b32 v136, 16, v67
 v_and_b32 v137, s36, v67
 v_lshlrev_b32 v138, 16, v75
 v_and_b32 v139, s36, v75
 v_lshlrev_b32 v140, 16, v83
 v_and_b32 v141, s36, v83
 v_lshlrev_b32 v142, 16, v112
 v_lshlrev_b32 v143, 16, v114
 v_and_b32 v144, s36, v112
 v_and_b32 v145, s36, v114
 v_lshlrev_b32 v146, 16, v113
 v_lshlrev_b32 v147, 16, v115
 v_and_b32 v148, s36, v113
 v_and_b32 v149, s36, v115
 v_pk_mul_f32 v[150:151], v[128:129], v[148:149]
 v_pk_fma_f32 v[150:151], v[130:131], v[146:147], v[150:151]
 v_pk_fma_f32 v[150:151], v[132:133], v[144:145], v[150:151]
 v_pk_fma_f32 v[150:151], v[134:135], v[142:143], v[150:151]
 v_pk_mul_f32 v[150:151], v[150:151], v[138:139]
 v_cvt_pk_bf16_f32 v19, v150, v151
 v_pk_mul_f32 v[152:153], v[130:131], v[148:149]
 v_pk_fma_f32 v[152:153], v[132:133], v[146:147], v[152:153]
 v_pk_fma_f32 v[152:153], v[134:135], v[144:145], v[152:153]
 v_pk_fma_f32 v[152:153], v[136:137], v[142:143], v[152:153]
 v_pk_mul_f32 v[152:153], v[152:153], v[140:141]
 v_cvt_pk_bf16_f32 v23, v152, v153
 v_lshrrev_b32 v26, 3, v0
 v_lshlrev_b32 v26, 8, v26
 v_and_b32 v25, 7, v0
 v_lshl_add_u32 v26, v25, 4, v26
 s_lshl_b32 s35, s3, 11
 s_add_u32 s35, s35, 0x20000
 v_add_u32 v26, s35, v26
 ds_write_b128 v26, v[16:19] offset:0
 ds_write_b128 v26, v[20:23] offset:128
 v_bfe_u32 v24, v0, 2, 2
 v_bfe_u32 v28, v0, 4, 1
 v_lshl_add_u32 v24, v28, 3, v24
 v_lshlrev_b32 v24, 2, v24
 v_lshrrev_b32 v28, 5, v0
 v_add_u32 v24, v24, v28
 v_lshlrev_b32 v24, 7, v24
 v_and_b32 v28, 3, v0
 v_lshl_add_u32 v24, v28, 3, v24
 s_lshl_b32 s35, s3, 5
 s_add_u32 s35, s35, 0x20000
 v_add_u32 v24, s35, v24
 v_and_b32 v25, 15, v0
 v_mul_u32_u24 v25, 4096, v25
 v_lshrrev_b32 v28, 4, v0
 v_lshl_add_u32 v25, v28, 4, v25
 s_lshl_b32 s35, s34, 2
 s_add_u32 s35, s35, s3
 s_mul_i32 s35, s35, 65536
 s_lshl_b32 s36, s33, 7
 s_add_u32 s35, s35, s36
 s_add_u32 s35, s35, 85983232
L_s1b:
 s_add_u32 s52, s52, s70
 s_or_b32 m0, s40, 0x8000
 s_nop 0
 buffer_load_dwordx4 v1, s[12:15], s52 offen offset:0 sc1 lds
 v_mov_b32 v2, v1
 v_add_u32 v3, 0x10000, v1
 v_mov_b64 v[96:97], 0
 v_mov_b64 v[98:99], 0
 v_mov_b64 v[100:101], 0
 v_mov_b64 v[102:103], 0
 v_mov_b64 v[104:105], 0
 v_mov_b64 v[106:107], 0
 v_mov_b64 v[108:109], 0
 v_mov_b64 v[110:111], 0
 v_mov_b64 v[112:113], 0
 v_mov_b64 v[114:115], 0
 buffer_load_dwordx4 v1, s[12:15], s52 offen offset:1024 sc1 lds
 v_mov_b64 v[116:117], 0
 v_mov_b64 v[118:119], 0
 v_mov_b64 v[120:121], 0
 v_mov_b64 v[122:123], 0
 v_mov_b64 v[124:125], 0
 v_mov_b64 v[126:127], 0
 v_mov_b64 v[128:129], 0
 v_mov_b64 v[130:131], 0
 v_mov_b64 v[132:133], 0
 v_mov_b64 v[134:135], 0
 v_mov_b64 v[136:137], 0
 v_mov_b64 v[138:139], 0
 buffer_load_dwordx4 v1, s[12:15], s52 offen offset:2048 sc1 lds
 v_mov_b64 v[140:141], 0
 v_mov_b64 v[142:143], 0
 v_mov_b64 v[144:145], 0
 v_mov_b64 v[146:147], 0
 v_mov_b64 v[148:149], 0
 v_mov_b64 v[150:151], 0
 v_mov_b64 v[152:153], 0
 v_mov_b64 v[154:155], 0
 v_mov_b64 v[156:157], 0
 v_mov_b64 v[158:159], 0
 v_mov_b64 v[160:161], 0
 buffer_load_dwordx4 v1, s[12:15], s52 offen offset:3072 sc1 lds
 v_mov_b64 v[162:163], 0
 v_mov_b64 v[164:165], 0
 v_mov_b64 v[166:167], 0
 v_mov_b64 v[168:169], 0
 v_mov_b64 v[170:171], 0
 v_mov_b64 v[172:173], 0
 v_mov_b64 v[174:175], 0
 v_mov_b64 v[176:177], 0
 v_mov_b64 v[178:179], 0
 v_mov_b64 v[180:181], 0
 v_mov_b64 v[182:183], 0
 v_mov_b64 v[184:185], 0
 s_bitset1_b32 m0, 12
 s_nop 0
 buffer_load_dwordx4 v4, s[12:15], s52 offen offset:0 sc1 lds
 v_mov_b64 v[186:187], 0
 v_mov_b64 v[188:189], 0
 v_mov_b64 v[190:191], 0
 v_mov_b64 v[192:193], 0
 v_mov_b64 v[194:195], 0
 v_mov_b64 v[196:197], 0
 v_mov_b64 v[198:199], 0
 v_mov_b64 v[200:201], 0
 v_mov_b64 v[202:203], 0
 v_mov_b64 v[204:205], 0
 v_mov_b64 v[206:207], 0
 v_mov_b64 v[208:209], 0
 buffer_load_dwordx4 v4, s[12:15], s52 offen offset:1024 sc1 lds
 v_mov_b64 v[210:211], 0
 v_mov_b64 v[212:213], 0
 v_mov_b64 v[214:215], 0
 v_mov_b64 v[216:217], 0
 v_mov_b64 v[218:219], 0
 v_mov_b64 v[220:221], 0
 v_mov_b64 v[222:223], 0
 v_mov_b64 v[224:225], 0
 v_mov_b64 v[226:227], 0
 v_mov_b64 v[228:229], 0
 v_mov_b64 v[230:231], 0
 buffer_load_dwordx4 v4, s[12:15], s52 offen offset:2048 sc1 lds
 v_mov_b64 v[232:233], 0
 v_mov_b64 v[234:235], 0
 v_mov_b64 v[236:237], 0
 v_mov_b64 v[238:239], 0
 v_mov_b64 v[240:241], 0
 v_mov_b64 v[242:243], 0
 v_mov_b64 v[244:245], 0
 v_mov_b64 v[246:247], 0
 v_mov_b64 v[248:249], 0
 v_mov_b64 v[250:251], 0
 v_mov_b64 v[252:253], 0
 v_mov_b64 v[254:255], 0
 buffer_load_dwordx4 v4, s[12:15], s52 offen offset:3072 sc1 lds
 v_mov_b32 v7, 0
 v_mov_b32 v8, 0
 v_mov_b32 v9, 0
 v_mov_b32 v10, 0
 v_mov_b32 v13, v1
 v_mul_u32_u24 v15, s27, v12
 v_accvgpr_write_b32 a246, 1
 v_accvgpr_write_b32 a247, 1
 s_cmp_lt_u32 s28, 14
 s_cselect_b32 s62, 1, 0
 s_andn2_b32 s62, s62, s27
 s_cmp_ge_u32 s44, 2
 s_cbranch_scc1 L_nomask0
 v_accvgpr_read_b32 v96, a224
 v_accvgpr_read_b32 v97, a225
 v_accvgpr_read_b32 v98, a226
 v_accvgpr_read_b32 v99, a227
 v_accvgpr_read_b32 v104, a228
 v_accvgpr_read_b32 v105, a229
 v_accvgpr_read_b32 v106, a230
 v_accvgpr_read_b32 v107, a231
 v_accvgpr_read_b32 v112, a232
 v_accvgpr_read_b32 v113, a233
 v_accvgpr_read_b32 v114, a234
 v_accvgpr_read_b32 v115, a235
 v_accvgpr_read_b32 v120, a236
 v_accvgpr_read_b32 v121, a237
 v_accvgpr_read_b32 v122, a238
 v_accvgpr_read_b32 v123, a239
L_nomask0:
 v_accvgpr_read_b32 v27, a245
 s_lshl_b32 s36, s95, 2
 s_add_u32 s36, s36, 84959232
 s_cmp_lt_u32 s28, 14
 s_cselect_b32 s36, s36, 2.0
 s_add_u32 s33, s94, 4
 s_cmp_eq_u32 s27, 1
 s_cselect_b32 s33, s33, 2.0
 s_cmp_eq_u32 s48, 0
 s_cbranch_scc1 L_kvlate
 s_add_u32 s42, s52, s70
L_kvok:
 s_waitcnt vmcnt(8) lgkmcnt(0)
 s_barrier
 ds_read_b128 a[64:67], v2 offset:0
 ds_read_b128 a[68:71], v2 offset:1024
 ds_read_b128 a[72:75], v2 offset:2048
 ds_read_b128 a[76:79], v2 offset:3072
 ds_read_b128 a[80:83], v2 offset:4096
 ds_read_b128 a[84:87], v2 offset:5120
 ds_read_b128 a[88:91], v2 offset:6144
 ds_read_b128 a[92:95], v2 offset:7168
 buffer_store_dword v27, v27, s[12:15], s1 offen sc1
 buffer_store_dword v27, v27, s[12:15], s33 offen sc1
 s_cmp_ge_u32 s28, 14
 s_cbranch_scc1 L_s1c
 ds_read_b64_tr_b16 v[16:17], v24 offset:0
 ds_read_b64_tr_b16 v[18:19], v24 offset:2048
 ds_read_b64_tr_b16 v[20:21], v24 offset:256
 ds_read_b64_tr_b16 v[22:23], v24 offset:2304
 s_waitcnt lgkmcnt(0)
 buffer_store_dwordx4 v[16:19], v25, s[12:15], s35 offen offset:0 sc1
 buffer_store_dwordx4 v[20:23], v25, s[12:15], s35 offen offset:64 sc1
L_s1c:
 s_mov_b32 m0, s41
 s_waitcnt lgkmcnt(0)
 v_mfma_f32_16x16x32_bf16 v[32:35], a[64:67], a[0:3], v[96:99]
 ds_read_b128 a[96:99], v2 offset:8192
 v_mfma_f32_16x16x32_bf16 v[32:35], a[68:71], a[4:7], v[32:35]
 buffer_load_dwordx4 v1, s[12:15], s43 offen offset:0 sc1 lds
 v_mfma_f32_16x16x32_bf16 v[32:35], a[72:75], a[8:11], v[32:35]
 ds_read_b128 a[100:103], v2 offset:9216
 v_mfma_f32_16x16x32_bf16 v[32:35], a[76:79], a[12:15], v[32:35]
 v_mfma_f32_16x16x32_bf16 v[32:35], a[80:83], a[16:19], v[32:35]
 ds_read_b128 a[104:107], v2 offset:10240
 v_mfma_f32_16x16x32_bf16 v[32:35], a[84:87], a[20:23], v[32:35]
 buffer_load_dwordx4 v1, s[12:15], s43 offen offset:1024 sc1 lds
 v_mfma_f32_16x16x32_bf16 v[32:35], a[88:91], a[24:27], v[32:35]
 ds_read_b128 a[108:111], v2 offset:11264
 v_mfma_f32_16x16x32_bf16 v[32:35], a[92:95], a[28:31], v[32:35]
 v_mfma_f32_16x16x32_bf16 v[36:39], a[64:67], a[32:35], v[100:103]
 ds_read_b128 a[112:115], v2 offset:12288
 v_mfma_f32_16x16x32_bf16 v[36:39], a[68:71], a[36:39], v[36:39]
 buffer_load_dwordx4 v1, s[12:15], s43 offen offset:2048 sc1 lds
 v_mfma_f32_16x16x32_bf16 v[36:39], a[72:75], a[40:43], v[36:39]
 ds_read_b128 a[116:119], v2 offset:13312
 v_mfma_f32_16x16x32_bf16 v[36:39], a[76:79], a[44:47], v[36:39]
 v_mfma_f32_16x16x32_bf16 v[36:39], a[80:83], a[48:51], v[36:39]
 ds_read_b128 a[120:123], v2 offset:14336
 v_mfma_f32_16x16x32_bf16 v[36:39], a[84:87], a[52:55], v[36:39]
 buffer_load_dwordx4 v1, s[12:15], s43 offen offset:3072 sc1 lds
 v_mfma_f32_16x16x32_bf16 v[36:39], a[88:91], a[56:59], v[36:39]
 ds_read_b128 a[124:127], v2 offset:15360
 v_mfma_f32_16x16x32_bf16 v[36:39], a[92:95], a[60:63], v[36:39]
 s_waitcnt lgkmcnt(6)
 v_exp_f32 v64, v32
 v_mfma_f32_16x16x32_bf16 v[40:43], a[96:99], a[0:3], v[104:107]
 s_bitset1_b32 m0, 12
 ds_read_b128 a[64:67], v2 offset:16384
 v_mfma_f32_16x16x32_bf16 v[40:43], a[100:103], a[4:7], v[40:43]
 s_waitcnt lgkmcnt(5)
 buffer_load_dwordx4 v4, s[12:15], s43 offen offset:0 sc1 lds
 v_mfma_f32_16x16x32_bf16 v[40:43], a[104:107], a[8:11], v[40:43]
 ds_read_b128 a[68:71], v2 offset:17408
 v_mfma_f32_16x16x32_bf16 v[40:43], a[108:111], a[12:15], v[40:43]
 s_waitcnt lgkmcnt(4)
 v_exp_f32 v65, v33
 v_mfma_f32_16x16x32_bf16 v[40:43], a[112:115], a[16:19], v[40:43]
 ds_read_b128 a[72:75], v2 offset:18432
 v_add_f32 v5, v64, v65
 v_mfma_f32_16x16x32_bf16 v[40:43], a[116:119], a[20:23], v[40:43]
 s_waitcnt lgkmcnt(3)
 buffer_load_dwordx4 v4, s[12:15], s43 offen offset:1024 sc1 lds
 v_mfma_f32_16x16x32_bf16 v[40:43], a[120:123], a[24:27], v[40:43]
 ds_read_b128 a[76:79], v2 offset:19456
 v_mfma_f32_16x16x32_bf16 v[40:43], a[124:127], a[28:31], v[40:43]
 v_exp_f32 v66, v34
 v_mfma_f32_16x16x32_bf16 v[44:47], a[96:99], a[32:35], v[108:111]
 ds_read_b128 a[80:83], v2 offset:20480
 v_add_f32 v5, v5, v66
 v_mfma_f32_16x16x32_bf16 v[44:47], a[100:103], a[36:39], v[44:47]
 buffer_load_dwordx4 v4, s[12:15], s43 offen offset:2048 sc1 lds
 v_mfma_f32_16x16x32_bf16 v[44:47], a[104:107], a[40:43], v[44:47]
 ds_read_b128 a[84:87], v2 offset:21504
 v_mfma_f32_16x16x32_bf16 v[44:47], a[108:111], a[44:47], v[44:47]
 v_exp_f32 v67, v35
 v_mfma_f32_16x16x32_bf16 v[44:47], a[112:115], a[48:51], v[44:47]
 ds_read_b128 a[88:91], v2 offset:22528
 v_add_f32 v5, v5, v67
 v_mfma_f32_16x16x32_bf16 v[44:47], a[116:119], a[52:55], v[44:47]
 buffer_load_dwordx4 v4, s[12:15], s43 offen offset:3072 sc1 lds
 v_mfma_f32_16x16x32_bf16 v[44:47], a[120:123], a[56:59], v[44:47]
 ds_read_b128 a[92:95], v2 offset:23552
 v_mfma_f32_16x16x32_bf16 v[44:47], a[124:127], a[60:63], v[44:47]
 s_waitcnt lgkmcnt(6)
 v_exp_f32 v68, v36
 v_mfma_f32_16x16x32_bf16 v[48:51], a[64:67], a[0:3], v[112:115]
 s_add_u32 s43, s43, s71
 ds_read_b128 a[96:99], v2 offset:24576
 v_mfma_f32_16x16x32_bf16 v[48:51], a[68:71], a[4:7], v[48:51]
 s_waitcnt lgkmcnt(5)
 v_exp_f32 v69, v37
 v_mfma_f32_16x16x32_bf16 v[48:51], a[72:75], a[8:11], v[48:51]
 s_xor_b32 s41, s41, 0x8000
 ds_read_b128 a[100:103], v2 offset:25600
 v_add_f32 v6, v68, v69
 v_mfma_f32_16x16x32_bf16 v[48:51], a[76:79], a[12:15], v[48:51]
 s_waitcnt lgkmcnt(4)
 v_exp_f32 v70, v38
 v_mfma_f32_16x16x32_bf16 v[48:51], a[80:83], a[16:19], v[48:51]
 ds_read_b128 a[104:107], v2 offset:26624
 v_add_f32 v6, v6, v70
 v_mfma_f32_16x16x32_bf16 v[48:51], a[84:87], a[20:23], v[48:51]
 s_waitcnt lgkmcnt(3)
 v_exp_f32 v71, v39
 v_mfma_f32_16x16x32_bf16 v[48:51], a[88:91], a[24:27], v[48:51]
 ds_read_b128 a[108:111], v2 offset:27648
 v_add_f32 v6, v6, v71
 v_mfma_f32_16x16x32_bf16 v[48:51], a[92:95], a[28:31], v[48:51]
 v_exp_f32 v72, v40
 v_mfma_f32_16x16x32_bf16 v[52:55], a[64:67], a[32:35], v[116:119]
 ds_read_b128 a[112:115], v2 offset:28672
 v_add_f32 v5, v5, v72
 v_mfma_f32_16x16x32_bf16 v[52:55], a[68:71], a[36:39], v[52:55]
 v_exp_f32 v73, v41
 v_mfma_f32_16x16x32_bf16 v[52:55], a[72:75], a[40:43], v[52:55]
 ds_read_b128 a[116:119], v2 offset:29696
 v_add_f32 v5, v5, v73
 v_mfma_f32_16x16x32_bf16 v[52:55], a[76:79], a[44:47], v[52:55]
 v_exp_f32 v74, v42
 v_mfma_f32_16x16x32_bf16 v[52:55], a[80:83], a[48:51], v[52:55]
 ds_read_b128 a[120:123], v2 offset:30720
 v_add_f32 v5, v5, v74
 v_mfma_f32_16x16x32_bf16 v[52:55], a[84:87], a[52:55], v[52:55]
 v_exp_f32 v75, v43
 v_mfma_f32_16x16x32_bf16 v[52:55], a[88:91], a[56:59], v[52:55]
 ds_read_b128 a[124:127], v2 offset:31744
 v_add_f32 v5, v5, v75
 v_mfma_f32_16x16x32_bf16 v[52:55], a[92:95], a[60:63], v[52:55]
 s_waitcnt lgkmcnt(6)
 v_exp_f32 v76, v44
 v_mfma_f32_16x16x32_bf16 v[56:59], a[96:99], a[0:3], v[120:123]
 v_exp_f32 v77, v45
 v_mfma_f32_16x16x32_bf16 v[56:59], a[100:103], a[4:7], v[56:59]
 s_waitcnt lgkmcnt(4)
 v_exp_f32 v78, v46
 v_mfma_f32_16x16x32_bf16 v[56:59], a[104:107], a[8:11], v[56:59]
 v_exp_f32 v79, v47
 v_mfma_f32_16x16x32_bf16 v[56:59], a[108:111], a[12:15], v[56:59]
 s_waitcnt lgkmcnt(2)
 v_exp_f32 v80, v48
 v_mfma_f32_16x16x32_bf16 v[56:59], a[112:115], a[16:19], v[56:59]
 v_exp_f32 v81, v49
 v_mfma_f32_16x16x32_bf16 v[56:59], a[116:119], a[20:23], v[56:59]
 s_waitcnt lgkmcnt(0)
 v_exp_f32 v82, v50
 v_mfma_f32_16x16x32_bf16 v[56:59], a[120:123], a[24:27], v[56:59]
 v_exp_f32 v83, v51
 v_mfma_f32_16x16x32_bf16 v[56:59], a[124:127], a[28:31], v[56:59]
 v_exp_f32 v84, v52
 v_mfma_f32_16x16x32_bf16 v[60:63], a[96:99], a[32:35], v[124:127]
 v_exp_f32 v85, v53
 v_mfma_f32_16x16x32_bf16 v[60:63], a[100:103], a[36:39], v[60:63]
 v_exp_f32 v86, v54
 v_mfma_f32_16x16x32_bf16 v[60:63], a[104:107], a[40:43], v[60:63]
 v_exp_f32 v87, v55
 v_mfma_f32_16x16x32_bf16 v[60:63], a[108:111], a[44:47], v[60:63]
 v_add_f32 v6, v6, v76
 v_mfma_f32_16x16x32_bf16 v[60:63], a[112:115], a[48:51], v[60:63]
 v_add_f32 v6, v6, v77
 v_mfma_f32_16x16x32_bf16 v[60:63], a[116:119], a[52:55], v[60:63]
 v_exp_f32 v88, v56
 v_mfma_f32_16x16x32_bf16 v[60:63], a[120:123], a[56:59], v[60:63]
 v_exp_f32 v89, v57
 v_mfma_f32_16x16x32_bf16 v[60:63], a[124:127], a[60:63], v[60:63]
 v_exp_f32 v90, v58
 v_xor_b32 v2, 0x8000, v2
 s_waitcnt vmcnt(8)
 s_barrier
 ds_read_b128 a[64:67], v2 offset:0
 ds_read_b128 a[68:71], v2 offset:1024
 ds_read_b128 a[72:75], v2 offset:2048
 ds_read_b128 a[76:79], v2 offset:3072
 ds_read_b128 a[80:83], v2 offset:4096
 ds_read_b128 a[84:87], v2 offset:5120
 ds_read_b128 a[88:91], v2 offset:6144
 ds_read_b128 a[92:95], v2 offset:7168
 buffer_store_dword v27, v27, s[12:15], s36 offen sc1
 v_exp_f32 v91, v59
 v_exp_f32 v92, v60
 v_exp_f32 v93, v61
 v_exp_f32 v94, v62
 v_exp_f32 v95, v63
 v_add_f32 v6, v6, v78
 v_add_f32 v6, v6, v79
 v_add_f32 v5, v5, v80
 v_add_f32 v5, v5, v81
 v_add_f32 v5, v5, v82
 v_add_f32 v5, v5, v83
 v_add_f32 v6, v6, v84
 v_add_f32 v6, v6, v85
 v_add_f32 v6, v6, v86
 v_add_f32 v6, v6, v87
 v_add_f32 v5, v5, v88
 v_add_f32 v5, v5, v89
 v_add_f32 v5, v5, v90
 v_add_f32 v5, v5, v91
 v_add_f32 v6, v6, v92
 v_add_f32 v6, v6, v93
 v_add_f32 v6, v6, v94
 v_add_f32 v6, v6, v95
L_first:
 v_add_f32 v11, v5, v6
 v_min_f32 v12, v5, v6
 v_cmp_nge_f32 vcc, s47, v11
 s_mov_b32 s46, 0xff800000
 s_cbranch_vccnz L_slow2
 v_cmp_gt_f32 vcc, 0x33800000, v12
 s_cbranch_vccnz L_rowchk
L_firstok:
 s_mov_b32 s46, 0
 s_waitcnt lgkmcnt(0)
 s_cmp_gt_u32 s44, s45
 s_cbranch_scc0 L_ret2
.p2align 6
L_loop:
 v_mfma_f32_16x16x32_bf16 v[32:35], a[64:67], a[0:3], v[96:99]
 s_mov_b32 m0, s40
 ds_read_b128 a[96:99], v2 offset:8192
 v_cvt_pk_bf16_f32 v16, v64, v65
 v_mfma_f32_16x16x32_bf16 v[32:35], a[68:71], a[4:7], v[32:35]
 s_waitcnt lgkmcnt(5)
 buffer_load_dwordx4 v13, s[8:11], s42 offen offset:0 sc1 lds
 v_mfma_f32_16x16x32_bf16 v[32:35], a[72:75], a[8:11], v[32:35]
 ds_read_b128 a[100:103], v2 offset:9216
 v_cvt_pk_bf16_f32 v17, v66, v67
 v_mfma_f32_16x16x32_bf16 v[32:35], a[76:79], a[12:15], v[32:35]
 s_waitcnt lgkmcnt(4)
 v_cvt_pk_bf16_f32 v20, v68, v69
 v_cvt_pk_bf16_f32 v21, v70, v71
 v_mfma_f32_16x16x32_bf16 v[32:35], a[80:83], a[16:19], v[32:35]
 s_add_u32 s39, s42, s76
 ds_read_b128 a[104:107], v2 offset:10240
 v_add_f32 v7, v7, v5
 v_mfma_f32_16x16x32_bf16 v[32:35], a[84:87], a[20:23], v[32:35]
 s_waitcnt lgkmcnt(3)
 v_add_f32 v8, v8, v6
 v_cvt_pk_bf16_f32 v18, v72, v73
 v_mfma_f32_16x16x32_bf16 v[32:35], a[88:91], a[24:27], v[32:35]
 ds_read_b128 a[108:111], v2 offset:11264
 v_cvt_pk_bf16_f32 v19, v74, v75
 v_mfma_f32_16x16x32_bf16 v[32:35], a[92:95], a[28:31], v[32:35]
 buffer_load_dwordx4 v13, s[8:11], s39 offen offset:1024 sc1 lds
 v_mfma_f32_16x16x32_bf16 v[36:39], a[64:67], a[32:35], v[100:103]
 ds_read_b128 a[112:115], v2 offset:12288
 v_cvt_pk_bf16_f32 v22, v76, v77
 v_mfma_f32_16x16x32_bf16 v[36:39], a[68:71], a[36:39], v[36:39]
 v_cvt_pk_bf16_f32 v23, v78, v79
 v_cvt_pk_bf16_f32 v24, v80, v81
 v_mfma_f32_16x16x32_bf16 v[36:39], a[72:75], a[40:43], v[36:39]
 s_add_u32 s39, s39, s76
 ds_read_b128 a[116:119], v2 offset:13312
 v_cvt_pk_bf16_f32 v25, v82, v83
 v_mfma_f32_16x16x32_bf16 v[36:39], a[76:79], a[44:47], v[36:39]
 v_cvt_pk_bf16_f32 v28, v84, v85
 v_cvt_pk_bf16_f32 v29, v86, v87
 v_mfma_f32_16x16x32_bf16 v[36:39], a[80:83], a[48:51], v[36:39]
 ds_read_b128 a[120:123], v2 offset:14336
 v_cvt_pk_bf16_f32 v26, v88, v89
 v_mfma_f32_16x16x32_bf16 v[36:39], a[84:87], a[52:55], v[36:39]
 buffer_load_dwordx4 v13, s[8:11], s39 offen offset:2048 sc1 lds
 v_mfma_f32_16x16x32_bf16 v[36:39], a[88:91], a[56:59], v[36:39]
 ds_read_b128 a[124:127], v2 offset:15360
 v_cvt_pk_bf16_f32 v27, v90, v91
 v_mfma_f32_16x16x32_bf16 v[36:39], a[92:95], a[60:63], v[36:39]
 s_waitcnt lgkmcnt(6)
 v_exp_f32 v64, v32
 v_mfma_f32_16x16x32_bf16 v[40:43], a[96:99], a[0:3], v[104:107]
 s_add_u32 s39, s39, s76
 ds_read_b128 a[64:67], v2 offset:16384
 v_cvt_pk_bf16_f32 v30, v92, v93
 v_mfma_f32_16x16x32_bf16 v[40:43], a[100:103], a[4:7], v[40:43]
 s_waitcnt lgkmcnt(5)
 v_exp_f32 v65, v33
 v_mfma_f32_16x16x32_bf16 v[40:43], a[104:107], a[8:11], v[40:43]
 ds_read_b128 a[68:71], v2 offset:17408
 v_cvt_pk_bf16_f32 v31, v94, v95
 v_mfma_f32_16x16x32_bf16 v[40:43], a[108:111], a[12:15], v[40:43]
 s_waitcnt lgkmcnt(4)
 buffer_load_dwordx4 v13, s[8:11], s39 offen offset:3072 sc1 lds
 v_mfma_f32_16x16x32_bf16 v[40:43], a[112:115], a[16:19], v[40:43]
 ds_read_b128 a[72:75], v2 offset:18432
 v_add_f32 v5, v64, v65
 v_mfma_f32_16x16x32_bf16 v[40:43], a[116:119], a[20:23], v[40:43]
 s_waitcnt lgkmcnt(3)
 v_exp_f32 v66, v34
 v_mfma_f32_16x16x32_bf16 v[40:43], a[120:123], a[24:27], v[40:43]
 s_add_u32 s39, s39, s77
 ds_read_b128 a[76:79], v2 offset:19456
 v_add_f32 v5, v5, v66
 v_mfma_f32_16x16x32_bf16 v[40:43], a[124:127], a[28:31], v[40:43]
 v_exp_f32 v67, v35
 v_mfma_f32_16x16x32_bf16 v[44:47], a[96:99], a[32:35], v[108:111]
 s_bitset1_b32 m0, 12
 ds_read_b128 a[80:83], v2 offset:20480
 v_add_f32 v5, v5, v67
 v_mfma_f32_16x16x32_bf16 v[44:47], a[100:103], a[36:39], v[44:47]
 buffer_load_dwordx4 v13, s[8:11], s39 offen offset:0 sc1 lds
 v_mfma_f32_16x16x32_bf16 v[44:47], a[104:107], a[40:43], v[44:47]
 ds_read_b128 a[84:87], v2 offset:21504
 v_mfma_f32_16x16x32_bf16 v[44:47], a[108:111], a[44:47], v[44:47]
 v_exp_f32 v68, v36
 v_mfma_f32_16x16x32_bf16 v[44:47], a[112:115], a[48:51], v[44:47]
 s_add_u32 s39, s39, s76
 ds_read_b128 a[88:91], v2 offset:22528
 v_mfma_f32_16x16x32_bf16 v[44:47], a[116:119], a[52:55], v[44:47]
 v_exp_f32 v69, v37
 v_mfma_f32_16x16x32_bf16 v[44:47], a[120:123], a[56:59], v[44:47]
 ds_read_b128 a[92:95], v2 offset:23552
 v_add_f32 v6, v68, v69
 v_mfma_f32_16x16x32_bf16 v[44:47], a[124:127], a[60:63], v[44:47]
 s_waitcnt lgkmcnt(6)
 buffer_load_dwordx4 v13, s[8:11], s39 offen offset:1024 sc1 lds
 v_mfma_f32_16x16x32_bf16 v[48:51], a[64:67], a[0:3], v[112:115]
 ds_read_b128 a[96:99], v2 offset:24576
 v_mfma_f32_16x16x32_bf16 v[48:51], a[68:71], a[4:7], v[48:51]
 s_waitcnt lgkmcnt(5)
 v_exp_f32 v70, v38
 v_mfma_f32_16x16x32_bf16 v[48:51], a[72:75], a[8:11], v[48:51]
 s_add_u32 s39, s39, s76
 ds_read_b128 a[100:103], v2 offset:25600
 v_add_f32 v6, v6, v70
 v_mfma_f32_16x16x32_bf16 v[48:51], a[76:79], a[12:15], v[48:51]
 s_waitcnt lgkmcnt(4)
 v_exp_f32 v71, v39
 v_mfma_f32_16x16x32_bf16 v[48:51], a[80:83], a[16:19], v[48:51]
 ds_read_b128 a[104:107], v2 offset:26624
 v_add_f32 v6, v6, v71
 v_mfma_f32_16x16x32_bf16 v[48:51], a[84:87], a[20:23], v[48:51]
 s_waitcnt lgkmcnt(3)
 buffer_load_dwordx4 v13, s[8:11], s39 offen offset:2048 sc1 lds
 v_mfma_f32_16x16x32_bf16 v[48:51], a[88:91], a[24:27], v[48:51]
 ds_read_b128 a[108:111], v2 offset:27648
 v_mfma_f32_16x16x32_bf16 v[48:51], a[92:95], a[28:31], v[48:51]
 v_exp_f32 v72, v40
 v_mfma_f32_16x16x32_bf16 v[52:55], a[64:67], a[32:35], v[116:119]
 s_add_u32 s39, s39, s76
 ds_read_b128 a[112:115], v2 offset:28672
 v_add_f32 v5, v5, v72
 v_mfma_f32_16x16x32_bf16 v[52:55], a[68:71], a[36:39], v[52:55]
 v_exp_f32 v73, v41
 v_mfma_f32_16x16x32_bf16 v[52:55], a[72:75], a[40:43], v[52:55]
 s_xor_b32 s40, s40, 0x8000
 ds_read_b128 a[116:119], v2 offset:29696
 v_add_f32 v5, v5, v73
 v_mfma_f32_16x16x32_bf16 v[52:55], a[76:79], a[44:47], v[52:55]
 buffer_load_dwordx4 v13, s[8:11], s39 offen offset:3072 sc1 lds
 v_mfma_f32_16x16x32_bf16 v[52:55], a[80:83], a[48:51], v[52:55]
 s_add_u32 s42, s42, s70
 ds_read_b128 a[120:123], v2 offset:30720
 v_mfma_f32_16x16x32_bf16 v[52:55], a[84:87], a[52:55], v[52:55]
 v_exp_f32 v74, v42
 v_mfma_f32_16x16x32_bf16 v[52:55], a[88:91], a[56:59], v[52:55]
 s_waitcnt vmcnt(8) lgkmcnt(5)
 ds_read_b128 a[124:127], v2 offset:31744
 v_add_f32 v5, v5, v74
 v_mfma_f32_16x16x32_bf16 v[52:55], a[92:95], a[60:63], v[52:55]
 s_barrier
 v_mfma_f32_16x16x32_bf16 v[56:59], a[96:99], a[0:3], v[120:123]
 s_mov_b32 m0, s41
 ds_read_b128 a[64:67], v3 offset:0
 v_xor_b32 v2, 0x8000, v2
 v_mfma_f32_16x16x32_bf16 v[56:59], a[100:103], a[4:7], v[56:59]
 s_waitcnt lgkmcnt(5)
 buffer_load_dwordx4 v1, s[12:15], s43 offen offset:0 sc1 lds
 v_mfma_f32_16x16x32_bf16 v[56:59], a[104:107], a[8:11], v[56:59]
 s_cmp_eq_u32 s42, s66
 ds_read_b128 a[68:71], v3 offset:16384
 v_mfma_f32_16x16x32_bf16 v[56:59], a[108:111], a[12:15], v[56:59]
 s_waitcnt lgkmcnt(4)
 v_exp_f32 v75, v43
 v_mfma_f32_16x16x32_bf16 v[56:59], a[112:115], a[16:19], v[56:59]
 s_cmov_b32 s42, s67
 ds_read_b128 a[72:75], v3 offset:1024
 v_add_f32 v5, v5, v75
 v_mfma_f32_16x16x32_bf16 v[56:59], a[116:119], a[20:23], v[56:59]
 s_waitcnt lgkmcnt(3)
 v_exp_f32 v76, v44
 v_mfma_f32_16x16x32_bf16 v[56:59], a[120:123], a[24:27], v[56:59]
 s_cmov_b32 s70, 32768
 ds_read_b128 a[76:79], v3 offset:17408
 v_add_f32 v6, v6, v76
 v_mfma_f32_16x16x32_bf16 v[56:59], a[124:127], a[28:31], v[56:59]
 buffer_load_dwordx4 v1, s[12:15], s43 offen offset:1024 sc1 lds
 v_mfma_f32_16x16x32_bf16 v[60:63], a[96:99], a[32:35], v[124:127]
 ds_read_b128 a[80:83], v3 offset:2048
 v_mfma_f32_16x16x32_bf16 v[60:63], a[100:103], a[36:39], v[60:63]
 v_exp_f32 v77, v45
 v_mfma_f32_16x16x32_bf16 v[60:63], a[104:107], a[40:43], v[60:63]
 ds_read_b128 a[84:87], v3 offset:18432
 v_add_f32 v6, v6, v77
 v_mfma_f32_16x16x32_bf16 v[60:63], a[108:111], a[44:47], v[60:63]
 v_exp_f32 v78, v46
 v_mfma_f32_16x16x32_bf16 v[60:63], a[112:115], a[48:51], v[60:63]
 ds_read_b128 a[88:91], v3 offset:3072
 v_add_f32 v6, v6, v78
 v_mfma_f32_16x16x32_bf16 v[60:63], a[116:119], a[52:55], v[60:63]
 buffer_load_dwordx4 v1, s[12:15], s43 offen offset:2048 sc1 lds
 v_mfma_f32_16x16x32_bf16 v[60:63], a[120:123], a[56:59], v[60:63]
 ds_read_b128 a[92:95], v3 offset:19456
 v_mfma_f32_16x16x32_bf16 v[60:63], a[124:127], a[60:63], v[60:63]
 s_waitcnt lgkmcnt(6)
 v_exp_f32 v79, v47
 v_mfma_f32_16x16x32_bf16 v[128:131], a[64:67], v[16:19], v[128:131]
 ds_read_b128 a[96:99], v3 offset:4096
 v_add_f32 v6, v6, v79
 v_mfma_f32_16x16x32_bf16 v[128:131], a[68:71], v[24:27], v[128:131]
 v_exp_f32 v80, v48
 v_mfma_f32_16x16x32_bf16 v[192:195], a[68:71], v[28:31], v[192:195]
 ds_read_b128 a[100:103], v3 offset:20480
 v_add_f32 v5, v5, v80
 v_mfma_f32_16x16x32_bf16 v[192:195], a[64:67], v[20:23], v[192:195]
 s_waitcnt lgkmcnt(6)
 buffer_load_dwordx4 v1, s[12:15], s43 offen offset:3072 sc1 lds
 v_mfma_f32_16x16x32_bf16 v[132:135], a[72:75], v[16:19], v[132:135]
 ds_read_b128 a[104:107], v3 offset:5120
 v_mfma_f32_16x16x32_bf16 v[132:135], a[76:79], v[24:27], v[132:135]
 v_exp_f32 v81, v49
 v_mfma_f32_16x16x32_bf16 v[196:199], a[76:79], v[28:31], v[196:199]
 ds_read_b128 a[108:111], v3 offset:21504
 v_add_f32 v5, v5, v81
 v_mfma_f32_16x16x32_bf16 v[196:199], a[72:75], v[20:23], v[196:199]
 s_waitcnt lgkmcnt(6)
 v_exp_f32 v82, v50
 v_mfma_f32_16x16x32_bf16 v[136:139], a[80:83], v[16:19], v[136:139]
 s_bitset1_b32 m0, 12
 ds_read_b128 a[112:115], v3 offset:6144
 v_add_f32 v5, v5, v82
 v_mfma_f32_16x16x32_bf16 v[136:139], a[84:87], v[24:27], v[136:139]
 buffer_load_dwordx4 v4, s[12:15], s43 offen offset:0 sc1 lds
 v_mfma_f32_16x16x32_bf16 v[200:203], a[84:87], v[28:31], v[200:203]
 ds_read_b128 a[116:119], v3 offset:22528
 v_mfma_f32_16x16x32_bf16 v[200:203], a[80:83], v[20:23], v[200:203]
 s_waitcnt lgkmcnt(6)
 v_exp_f32 v83, v51
 v_mfma_f32_16x16x32_bf16 v[140:143], a[88:91], v[16:19], v[140:143]
 ds_read_b128 a[120:123], v3 offset:7168
 v_add_f32 v5, v5, v83
 v_mfma_f32_16x16x32_bf16 v[140:143], a[92:95], v[24:27], v[140:143]
 v_exp_f32 v84, v52
 v_mfma_f32_16x16x32_bf16 v[204:207], a[92:95], v[28:31], v[204:207]
 ds_read_b128 a[124:127], v3 offset:23552
 v_add_f32 v6, v6, v84
 v_mfma_f32_16x16x32_bf16 v[204:207], a[88:91], v[20:23], v[204:207]
 s_waitcnt lgkmcnt(6)
 buffer_load_dwordx4 v4, s[12:15], s43 offen offset:1024 sc1 lds
 v_mfma_f32_16x16x32_bf16 v[144:147], a[96:99], v[16:19], v[144:147]
 ds_read_b128 a[64:67], v3 offset:8192
 v_mfma_f32_16x16x32_bf16 v[144:147], a[100:103], v[24:27], v[144:147]
 v_exp_f32 v85, v53
 v_mfma_f32_16x16x32_bf16 v[208:211], a[100:103], v[28:31], v[208:211]
 ds_read_b128 a[68:71], v3 offset:24576
 v_add_f32 v6, v6, v85
 v_mfma_f32_16x16x32_bf16 v[208:211], a[96:99], v[20:23], v[208:211]
 s_waitcnt lgkmcnt(6)
 v_exp_f32 v86, v54
 v_mfma_f32_16x16x32_bf16 v[148:151], a[104:107], v[16:19], v[148:151]
 ds_read_b128 a[72:75], v3 offset:9216
 v_add_f32 v6, v6, v86
 v_mfma_f32_16x16x32_bf16 v[148:151], a[108:111], v[24:27], v[148:151]
 buffer_load_dwordx4 v4, s[12:15], s43 offen offset:2048 sc1 lds
 v_mfma_f32_16x16x32_bf16 v[212:215], a[108:111], v[28:31], v[212:215]
 ds_read_b128 a[76:79], v3 offset:25600
 v_mfma_f32_16x16x32_bf16 v[212:215], a[104:107], v[20:23], v[212:215]
 s_waitcnt lgkmcnt(6)
 v_exp_f32 v87, v55
 v_mfma_f32_16x16x32_bf16 v[152:155], a[112:115], v[16:19], v[152:155]
 ds_read_b128 a[80:83], v3 offset:10240
 v_add_f32 v6, v6, v87
 v_mfma_f32_16x16x32_bf16 v[152:155], a[116:119], v[24:27], v[152:155]
 v_exp_f32 v88, v56
 v_mfma_f32_16x16x32_bf16 v[216:219], a[116:119], v[28:31], v[216:219]
 s_xor_b32 s41, s41, 0x8000
 ds_read_b128 a[84:87], v3 offset:26624
 v_add_f32 v5, v5, v88
 v_mfma_f32_16x16x32_bf16 v[216:219], a[112:115], v[20:23], v[216:219]
 s_waitcnt lgkmcnt(6)
 buffer_load_dwordx4 v4, s[12:15], s43 offen offset:3072 sc1 lds
 v_mfma_f32_16x16x32_bf16 v[156:159], a[120:123], v[16:19], v[156:159]
 s_add_u32 s43, s43, s71
 ds_read_b128 a[88:91], v3 offset:11264
 v_mfma_f32_16x16x32_bf16 v[156:159], a[124:127], v[24:27], v[156:159]
 v_exp_f32 v89, v57
 v_mfma_f32_16x16x32_bf16 v[220:223], a[124:127], v[28:31], v[220:223]
 s_cmp_eq_u32 s43, s68
 ds_read_b128 a[92:95], v3 offset:27648
 v_add_f32 v5, v5, v89
 v_mfma_f32_16x16x32_bf16 v[220:223], a[120:123], v[20:23], v[220:223]
 s_waitcnt lgkmcnt(6)
 v_exp_f32 v90, v58
 v_mfma_f32_16x16x32_bf16 v[160:163], a[64:67], v[16:19], v[160:163]
 s_cmov_b32 s43, s69
 ds_read_b128 a[96:99], v3 offset:12288
 v_add_f32 v5, v5, v90
 v_mfma_f32_16x16x32_bf16 v[160:163], a[68:71], v[24:27], v[160:163]
 s_cmov_b32 s71, 32768
 v_exp_f32 v91, v59
 v_mfma_f32_16x16x32_bf16 v[224:227], a[68:71], v[28:31], v[224:227]
 ds_read_b128 a[100:103], v3 offset:28672
 v_add_f32 v5, v5, v91
 v_mfma_f32_16x16x32_bf16 v[224:227], a[64:67], v[20:23], v[224:227]
 s_waitcnt lgkmcnt(6)
 v_exp_f32 v92, v60
 v_mfma_f32_16x16x32_bf16 v[164:167], a[72:75], v[16:19], v[164:167]
 ds_read_b128 a[104:107], v3 offset:13312
 v_add_f32 v6, v6, v92
 v_mfma_f32_16x16x32_bf16 v[164:167], a[76:79], v[24:27], v[164:167]
 v_exp_f32 v93, v61
 v_mfma_f32_16x16x32_bf16 v[228:231], a[76:79], v[28:31], v[228:231]
 ds_read_b128 a[108:111], v3 offset:29696
 v_add_f32 v6, v6, v93
 v_mfma_f32_16x16x32_bf16 v[228:231], a[72:75], v[20:23], v[228:231]
 s_waitcnt lgkmcnt(6)
 v_exp_f32 v94, v62
 v_mfma_f32_16x16x32_bf16 v[168:171], a[80:83], v[16:19], v[168:171]
 ds_read_b128 a[112:115], v3 offset:14336
 v_add_f32 v6, v6, v94
 v_mfma_f32_16x16x32_bf16 v[168:171], a[84:87], v[24:27], v[168:171]
 v_exp_f32 v95, v63
 v_mfma_f32_16x16x32_bf16 v[232:235], a[84:87], v[28:31], v[232:235]
 ds_read_b128 a[116:119], v3 offset:30720
 v_add_f32 v6, v6, v95
 v_mfma_f32_16x16x32_bf16 v[232:235], a[80:83], v[20:23], v[232:235]
 s_waitcnt lgkmcnt(6)
 v_add_f32 v11, v5, v6
 v_mfma_f32_16x16x32_bf16 v[172:175], a[88:91], v[16:19], v[172:175]
 ds_read_b128 a[120:123], v3 offset:15360
 v_cmp_nge_f32 vcc, s47, v11
 v_mfma_f32_16x16x32_bf16 v[172:175], a[92:95], v[24:27], v[172:175]
 buffer_load_dword a246, v15, s[12:15], s60 offen sc1
 v_mfma_f32_16x16x32_bf16 v[236:239], a[92:95], v[28:31], v[236:239]
 s_waitcnt vmcnt(9) lgkmcnt(5)
 ds_read_b128 a[124:127], v3 offset:31744
 v_mfma_f32_16x16x32_bf16 v[236:239], a[88:91], v[20:23], v[236:239]
 s_barrier
 v_mfma_f32_16x16x32_bf16 v[176:179], a[96:99], v[16:19], v[176:179]
 ds_read_b128 a[64:67], v2 offset:0
 v_xor_b32 v3, 0x8000, v3
 v_mfma_f32_16x16x32_bf16 v[176:179], a[100:103], v[24:27], v[176:179]
 v_mfma_f32_16x16x32_bf16 v[240:243], a[100:103], v[28:31], v[240:243]
 ds_read_b128 a[68:71], v2 offset:1024
 v_mfma_f32_16x16x32_bf16 v[240:243], a[96:99], v[20:23], v[240:243]
 s_waitcnt lgkmcnt(6)
 v_mfma_f32_16x16x32_bf16 v[180:183], a[104:107], v[16:19], v[180:183]
 ds_read_b128 a[72:75], v2 offset:2048
 v_mfma_f32_16x16x32_bf16 v[180:183], a[108:111], v[24:27], v[180:183]
 v_mfma_f32_16x16x32_bf16 v[244:247], a[108:111], v[28:31], v[244:247]
 ds_read_b128 a[76:79], v2 offset:3072
 v_mfma_f32_16x16x32_bf16 v[244:247], a[104:107], v[20:23], v[244:247]
 s_waitcnt lgkmcnt(6)
 v_mfma_f32_16x16x32_bf16 v[184:187], a[112:115], v[16:19], v[184:187]
 s_sub_u32 s44, s44, 1
 ds_read_b128 a[80:83], v2 offset:4096
 v_mfma_f32_16x16x32_bf16 v[184:187], a[116:119], v[24:27], v[184:187]
 v_mfma_f32_16x16x32_bf16 v[248:251], a[116:119], v[28:31], v[248:251]
 ds_read_b128 a[84:87], v2 offset:5120
 v_mfma_f32_16x16x32_bf16 v[248:251], a[112:115], v[20:23], v[248:251]
 s_waitcnt lgkmcnt(6)
 v_mfma_f32_16x16x32_bf16 v[188:191], a[120:123], v[16:19], v[188:191]
 s_cmp_gt_u32 s44, s45
 ds_read_b128 a[88:91], v2 offset:6144
 v_mfma_f32_16x16x32_bf16 v[188:191], a[124:127], v[24:27], v[188:191]
 s_cselect_b64 vcc, vcc, -1
 v_mfma_f32_16x16x32_bf16 v[252:255], a[124:127], v[28:31], v[252:255]
 s_waitcnt lgkmcnt(5)
 ds_read_b128 a[92:95], v2 offset:7168
 v_mfma_f32_16x16x32_bf16 v[252:255], a[120:123], v[20:23], v[252:255]
 s_cbranch_vccz L_loop
 v_cmp_nge_f32 vcc, s47, v11
 s_cbranch_vccnz L_slow
L_ret2:
 s_cmp_lg_u32 s44, 2
 s_cbranch_scc1 L_disp
 v_mfma_f32_16x16x32_bf16 v[36:39], a[64:67], a[32:35], v[100:103]
 s_mov_b32 m0, s40
 ds_read_b128 a[96:99], v2 offset:8192
 v_accvgpr_read_b32 v96, a224
 v_mfma_f32_16x16x32_bf16 v[36:39], a[68:71], a[36:39], v[36:39]
 s_waitcnt lgkmcnt(5)
 buffer_load_dwordx4 v1, s[12:15], s42 offen offset:0 sc1 lds
 v_mfma_f32_16x16x32_bf16 v[36:39], a[72:75], a[40:43], v[36:39]
 ds_read_b128 a[100:103], v2 offset:9216
 v_accvgpr_read_b32 v97, a225
 v_mfma_f32_16x16x32_bf16 v[36:39], a[76:79], a[44:47], v[36:39]
 s_waitcnt lgkmcnt(4)
 v_accvgpr_read_b32 v98, a226
 v_accvgpr_read_b32 v99, a227
 v_mfma_f32_16x16x32_bf16 v[36:39], a[80:83], a[48:51], v[36:39]
 ds_read_b128 a[104:107], v2 offset:10240
 v_cvt_pk_bf16_f32 v20, v68, v69
 v_mfma_f32_16x16x32_bf16 v[36:39], a[84:87], a[52:55], v[36:39]
 s_waitcnt lgkmcnt(3)
 v_cvt_pk_bf16_f32 v21, v70, v71
 v_cvt_pk_bf16_f32 v16, v64, v65
 v_mfma_f32_16x16x32_bf16 v[36:39], a[88:91], a[56:59], v[36:39]
 ds_read_b128 a[108:111], v2 offset:11264
 v_cvt_pk_bf16_f32 v17, v66, v67
 v_mfma_f32_16x16x32_bf16 v[36:39], a[92:95], a[60:63], v[36:39]
 buffer_load_dwordx4 v1, s[12:15], s42 offen offset:1024 sc1 lds
 v_mfma_f32_16x16x32_bf16 v[32:35], a[64:67], a[0:3], v[96:99]
 ds_read_b128 a[112:115], v2 offset:12288
 v_add_f32 v7, v7, v5
 v_mfma_f32_16x16x32_bf16 v[32:35], a[68:71], a[4:7], v[32:35]
 v_add_f32 v8, v8, v6
 v_accvgpr_read_b32 v104, a228
 v_mfma_f32_16x16x32_bf16 v[32:35], a[72:75], a[8:11], v[32:35]
 ds_read_b128 a[116:119], v2 offset:13312
 v_accvgpr_read_b32 v105, a229
 v_mfma_f32_16x16x32_bf16 v[32:35], a[76:79], a[12:15], v[32:35]
 v_accvgpr_read_b32 v106, a230
 v_accvgpr_read_b32 v107, a231
 v_mfma_f32_16x16x32_bf16 v[32:35], a[80:83], a[16:19], v[32:35]
 ds_read_b128 a[120:123], v2 offset:14336
 v_cvt_pk_bf16_f32 v22, v76, v77
 v_mfma_f32_16x16x32_bf16 v[32:35], a[84:87], a[20:23], v[32:35]
 buffer_load_dwordx4 v1, s[12:15], s42 offen offset:2048 sc1 lds
 v_mfma_f32_16x16x32_bf16 v[32:35], a[88:91], a[24:27], v[32:35]
 ds_read_b128 a[124:127], v2 offset:15360
 v_cvt_pk_bf16_f32 v23, v78, v79
 v_mfma_f32_16x16x32_bf16 v[32:35], a[92:95], a[28:31], v[32:35]
 s_waitcnt lgkmcnt(6)
 v_exp_f32 v68, v36
 v_mfma_f32_16x16x32_bf16 v[44:47], a[96:99], a[32:35], v[108:111]
 ds_read_b128 a[64:67], v2 offset:16384
 v_cvt_pk_bf16_f32 v18, v72, v73
 v_mfma_f32_16x16x32_bf16 v[44:47], a[100:103], a[36:39], v[44:47]
 s_waitcnt lgkmcnt(5)
 v_exp_f32 v69, v37
 v_mfma_f32_16x16x32_bf16 v[44:47], a[104:107], a[40:43], v[44:47]
 ds_read_b128 a[68:71], v2 offset:17408
 v_cvt_pk_bf16_f32 v19, v74, v75
 v_add_f32 v6, v68, v69
 v_mfma_f32_16x16x32_bf16 v[44:47], a[108:111], a[44:47], v[44:47]
 s_waitcnt lgkmcnt(4)
 buffer_load_dwordx4 v1, s[12:15], s42 offen offset:3072 sc1 lds
 v_mfma_f32_16x16x32_bf16 v[44:47], a[112:115], a[48:51], v[44:47]
 ds_read_b128 a[72:75], v2 offset:18432
 v_accvgpr_read_b32 v112, a232
 v_mfma_f32_16x16x32_bf16 v[44:47], a[116:119], a[52:55], v[44:47]
 s_waitcnt lgkmcnt(3)
 v_exp_f32 v70, v38
 v_mfma_f32_16x16x32_bf16 v[44:47], a[120:123], a[56:59], v[44:47]
 ds_read_b128 a[76:79], v2 offset:19456
 v_accvgpr_read_b32 v113, a233
 v_add_f32 v6, v6, v70
 v_mfma_f32_16x16x32_bf16 v[44:47], a[124:127], a[60:63], v[44:47]
 v_exp_f32 v71, v39
 v_mfma_f32_16x16x32_bf16 v[40:43], a[96:99], a[0:3], v[104:107]
 s_bitset1_b32 m0, 12
 ds_read_b128 a[80:83], v2 offset:20480
 v_accvgpr_read_b32 v114, a234
 v_add_f32 v6, v6, v71
 v_mfma_f32_16x16x32_bf16 v[40:43], a[100:103], a[4:7], v[40:43]
 buffer_load_dwordx4 v4, s[12:15], s42 offen offset:0 sc1 lds
 v_mfma_f32_16x16x32_bf16 v[40:43], a[104:107], a[8:11], v[40:43]
 ds_read_b128 a[84:87], v2 offset:21504
 v_accvgpr_read_b32 v115, a235
 v_mfma_f32_16x16x32_bf16 v[40:43], a[108:111], a[12:15], v[40:43]
 v_exp_f32 v64, v32
 v_mfma_f32_16x16x32_bf16 v[40:43], a[112:115], a[16:19], v[40:43]
 ds_read_b128 a[88:91], v2 offset:22528
 v_cvt_pk_bf16_f32 v28, v84, v85
 v_mfma_f32_16x16x32_bf16 v[40:43], a[116:119], a[20:23], v[40:43]
 v_exp_f32 v65, v33
 v_mfma_f32_16x16x32_bf16 v[40:43], a[120:123], a[24:27], v[40:43]
 ds_read_b128 a[92:95], v2 offset:23552
 v_cvt_pk_bf16_f32 v29, v86, v87
 v_add_f32 v5, v64, v65
 v_mfma_f32_16x16x32_bf16 v[40:43], a[124:127], a[28:31], v[40:43]
 s_waitcnt lgkmcnt(6)
 buffer_load_dwordx4 v4, s[12:15], s42 offen offset:1024 sc1 lds
 v_mfma_f32_16x16x32_bf16 v[52:55], a[64:67], a[32:35], v[116:119]
 ds_read_b128 a[96:99], v2 offset:24576
 v_cvt_pk_bf16_f32 v24, v80, v81
 v_mfma_f32_16x16x32_bf16 v[52:55], a[68:71], a[36:39], v[52:55]
 s_waitcnt lgkmcnt(5)
 v_exp_f32 v66, v34
 v_mfma_f32_16x16x32_bf16 v[52:55], a[72:75], a[40:43], v[52:55]
 ds_read_b128 a[100:103], v2 offset:25600
 v_cvt_pk_bf16_f32 v25, v82, v83
 v_add_f32 v5, v5, v66
 v_mfma_f32_16x16x32_bf16 v[52:55], a[76:79], a[44:47], v[52:55]
 s_waitcnt lgkmcnt(4)
 v_exp_f32 v67, v35
 v_mfma_f32_16x16x32_bf16 v[52:55], a[80:83], a[48:51], v[52:55]
 ds_read_b128 a[104:107], v2 offset:26624
 v_accvgpr_read_b32 v120, a236
 v_add_f32 v5, v5, v67
 v_mfma_f32_16x16x32_bf16 v[52:55], a[84:87], a[52:55], v[52:55]
 s_waitcnt lgkmcnt(3)
 buffer_load_dwordx4 v4, s[12:15], s42 offen offset:2048 sc1 lds
 v_mfma_f32_16x16x32_bf16 v[52:55], a[88:91], a[56:59], v[52:55]
 ds_read_b128 a[108:111], v2 offset:27648
 v_accvgpr_read_b32 v121, a237
 v_mfma_f32_16x16x32_bf16 v[52:55], a[92:95], a[60:63], v[52:55]
 v_exp_f32 v76, v44
 v_mfma_f32_16x16x32_bf16 v[48:51], a[64:67], a[0:3], v[112:115]
 ds_read_b128 a[112:115], v2 offset:28672
 v_accvgpr_read_b32 v122, a238
 v_add_f32 v6, v6, v76
 v_mfma_f32_16x16x32_bf16 v[48:51], a[68:71], a[4:7], v[48:51]
 v_exp_f32 v77, v45
 v_mfma_f32_16x16x32_bf16 v[48:51], a[72:75], a[8:11], v[48:51]
 ds_read_b128 a[116:119], v2 offset:29696
 v_accvgpr_read_b32 v123, a239
 v_add_f32 v6, v6, v77
 v_mfma_f32_16x16x32_bf16 v[48:51], a[76:79], a[12:15], v[48:51]
 buffer_load_dwordx4 v4, s[12:15], s42 offen offset:3072 sc1 lds
 v_mfma_f32_16x16x32_bf16 v[48:51], a[80:83], a[16:19], v[48:51]
 ds_read_b128 a[120:123], v2 offset:30720
 v_cvt_pk_bf16_f32 v30, v92, v93
 v_mfma_f32_16x16x32_bf16 v[48:51], a[84:87], a[20:23], v[48:51]
 v_exp_f32 v78, v46
 v_mfma_f32_16x16x32_bf16 v[48:51], a[88:91], a[24:27], v[48:51]
 s_waitcnt vmcnt(8)
 ds_read_b128 a[124:127], v2 offset:31744
 v_xor_b32 v2, 0x8000, v2
 v_add_f32 v6, v6, v78
 v_mfma_f32_16x16x32_bf16 v[48:51], a[92:95], a[28:31], v[48:51]
 s_waitcnt lgkmcnt(6)
 s_barrier
 v_exp_f32 v79, v47
 v_mfma_f32_16x16x32_bf16 v[60:63], a[96:99], a[32:35], v[124:127]
 s_mov_b32 m0, s41
 ds_read_b128 a[64:67], v3 offset:0
 v_accvgpr_read_b32 v12, a246
 v_add_f32 v6, v6, v79
 v_mfma_f32_16x16x32_bf16 v[60:63], a[100:103], a[36:39], v[60:63]
 s_waitcnt lgkmcnt(5)
 buffer_load_dwordx4 v1, s[12:15], s43 offen offset:0 sc1 lds
 v_mfma_f32_16x16x32_bf16 v[60:63], a[104:107], a[40:43], v[60:63]
 ds_read_b128 a[68:71], v3 offset:16384
 v_cmp_ne_u32 s[20:21], 0, v12
 v_mfma_f32_16x16x32_bf16 v[60:63], a[108:111], a[44:47], v[60:63]
 s_waitcnt lgkmcnt(4)
 v_exp_f32 v72, v40
 v_mfma_f32_16x16x32_bf16 v[60:63], a[112:115], a[48:51], v[60:63]
 s_cmp_eq_u64 s[20:21], 0
 ds_read_b128 a[72:75], v3 offset:1024
 v_cvt_pk_bf16_f32 v31, v94, v95
 v_add_f32 v5, v5, v72
 v_mfma_f32_16x16x32_bf16 v[60:63], a[116:119], a[52:55], v[60:63]
 s_waitcnt lgkmcnt(3)
 buffer_load_dwordx4 v1, s[12:15], s43 offen offset:1024 sc1 lds
 v_mfma_f32_16x16x32_bf16 v[60:63], a[120:123], a[56:59], v[60:63]
 s_cselect_b32 s51, 1, 0
 ds_read_b128 a[76:79], v3 offset:17408
 v_cvt_pk_bf16_f32 v26, v88, v89
 v_mfma_f32_16x16x32_bf16 v[60:63], a[124:127], a[60:63], v[60:63]
 s_cselect_b32 s55, s4, 2.0
 v_exp_f32 v73, v41
 v_mfma_f32_16x16x32_bf16 v[56:59], a[96:99], a[0:3], v[120:123]
 s_cselect_b32 s56, s5, 2.0
 ds_read_b128 a[80:83], v3 offset:2048
 v_cvt_pk_bf16_f32 v27, v90, v91
 v_mfma_f32_16x16x32_bf16 v[56:59], a[100:103], a[4:7], v[56:59]
 buffer_load_dwordx4 v1, s[12:15], s43 offen offset:2048 sc1 lds
 v_mfma_f32_16x16x32_bf16 v[56:59], a[104:107], a[8:11], v[56:59]
 s_cselect_b32 s57, s6, 2.0
 ds_read_b128 a[84:87], v3 offset:18432
 v_add_f32 v5, v5, v73
 v_mfma_f32_16x16x32_bf16 v[56:59], a[108:111], a[12:15], v[56:59]
 v_exp_f32 v74, v42
 v_mfma_f32_16x16x32_bf16 v[56:59], a[112:115], a[16:19], v[56:59]
 ds_read_b128 a[88:91], v3 offset:3072
 v_accvgpr_read_b32 v13, a244
 v_mfma_f32_16x16x32_bf16 v[56:59], a[116:119], a[20:23], v[56:59]
 buffer_load_dwordx4 v1, s[12:15], s43 offen offset:3072 sc1 lds
 v_mfma_f32_16x16x32_bf16 v[56:59], a[120:123], a[24:27], v[56:59]
 ds_read_b128 a[92:95], v3 offset:19456
 v_add_f32 v5, v5, v74
 v_mfma_f32_16x16x32_bf16 v[56:59], a[124:127], a[28:31], v[56:59]
 s_waitcnt lgkmcnt(6)
 v_exp_f32 v75, v43
 v_mfma_f32_16x16x32_bf16 v[128:131], a[64:67], v[16:19], v[128:131]
 s_bitset1_b32 m0, 12
 ds_read_b128 a[96:99], v3 offset:4096
 v_add_f32 v5, v5, v75
 v_mfma_f32_16x16x32_bf16 v[128:131], a[68:71], v[24:27], v[128:131]
 buffer_load_dwordx4 v4, s[12:15], s43 offen offset:0 sc1 lds
 v_mfma_f32_16x16x32_bf16 v[192:195], a[68:71], v[28:31], v[192:195]
 ds_read_b128 a[100:103], v3 offset:20480
 v_sub_f32 v12, v10, v9
 v_mfma_f32_16x16x32_bf16 v[192:195], a[64:67], v[20:23], v[192:195]
 s_waitcnt lgkmcnt(6)
 v_exp_f32 v84, v52
 v_add_f32 v127, v123, v12
 v_mfma_f32_16x16x32_bf16 v[132:135], a[72:75], v[16:19], v[132:135]
 ds_read_b128 a[104:107], v3 offset:5120
 v_add_f32 v6, v6, v84
 v_mfma_f32_16x16x32_bf16 v[132:135], a[76:79], v[24:27], v[132:135]
 buffer_load_dwordx4 v4, s[12:15], s43 offen offset:1024 sc1 lds
 v_mfma_f32_16x16x32_bf16 v[196:199], a[76:79], v[28:31], v[196:199]
 ds_read_b128 a[108:111], v3 offset:21504
 v_add_f32 v100, v96, v12
 v_mfma_f32_16x16x32_bf16 v[196:199], a[72:75], v[20:23], v[196:199]
 s_waitcnt lgkmcnt(6)
 v_exp_f32 v85, v53
 v_mfma_f32_16x16x32_bf16 v[136:139], a[80:83], v[16:19], v[136:139]
 ds_read_b128 a[112:115], v3 offset:6144
 v_add_f32 v6, v6, v85
 v_mfma_f32_16x16x32_bf16 v[136:139], a[84:87], v[24:27], v[136:139]
 buffer_load_dwordx4 v4, s[12:15], s43 offen offset:2048 sc1 lds
 v_mfma_f32_16x16x32_bf16 v[200:203], a[84:87], v[28:31], v[200:203]
 ds_read_b128 a[116:119], v3 offset:22528
 v_add_f32 v101, v97, v12
 v_mfma_f32_16x16x32_bf16 v[200:203], a[80:83], v[20:23], v[200:203]
 s_waitcnt lgkmcnt(6)
 v_exp_f32 v86, v54
 v_mfma_f32_16x16x32_bf16 v[140:143], a[88:91], v[16:19], v[140:143]
 ds_read_b128 a[120:123], v3 offset:7168
 v_add_f32 v6, v6, v86
 v_mfma_f32_16x16x32_bf16 v[140:143], a[92:95], v[24:27], v[140:143]
 buffer_load_dwordx4 v4, s[12:15], s43 offen offset:3072 sc1 lds
 v_mfma_f32_16x16x32_bf16 v[204:207], a[92:95], v[28:31], v[204:207]
 s_add_u32 s43, s43, 32768
 ds_read_b128 a[124:127], v3 offset:23552
 v_add_f32 v102, v98, v12
 v_mfma_f32_16x16x32_bf16 v[204:207], a[88:91], v[20:23], v[204:207]
 s_waitcnt lgkmcnt(6)
 v_exp_f32 v87, v55
 v_mfma_f32_16x16x32_bf16 v[144:147], a[96:99], v[16:19], v[144:147]
 s_xor_b32 s41, s41, 0x8000
 ds_read_b128 a[64:67], v3 offset:8192
 v_add_f32 v6, v6, v87
 v_mfma_f32_16x16x32_bf16 v[144:147], a[100:103], v[24:27], v[144:147]
 buffer_load_dwordx4 a[192:195], v1, s[12:15], s57 offen sc1
 v_mfma_f32_16x16x32_bf16 v[208:211], a[100:103], v[28:31], v[208:211]
 s_xor_b32 s40, s40, 0x8000
 ds_read_b128 a[68:71], v3 offset:24576
 v_add_f32 v103, v99, v12
 v_mfma_f32_16x16x32_bf16 v[208:211], a[96:99], v[20:23], v[208:211]
 s_waitcnt lgkmcnt(6)
 v_exp_f32 v80, v48
 v_mfma_f32_16x16x32_bf16 v[148:151], a[104:107], v[16:19], v[148:151]
 s_add_u32 s52, s50, 131072
 ds_read_b128 a[72:75], v3 offset:9216
 v_add_f32 v5, v5, v80
 v_mfma_f32_16x16x32_bf16 v[148:151], a[108:111], v[24:27], v[148:151]
 buffer_load_dwordx4 a[128:131], v1, s[12:15], s55 offen offset:0 sc1
 v_mfma_f32_16x16x32_bf16 v[212:215], a[108:111], v[28:31], v[212:215]
 s_mul_i32 s58, s3, 50176
 ds_read_b128 a[76:79], v3 offset:25600
 v_add_f32 v108, v104, v12
 v_mfma_f32_16x16x32_bf16 v[212:215], a[104:107], v[20:23], v[212:215]
 s_waitcnt lgkmcnt(6)
 v_exp_f32 v81, v49
 v_mfma_f32_16x16x32_bf16 v[152:155], a[112:115], v[16:19], v[152:155]
 s_sub_u32 s58, 128, s58
 ds_read_b128 a[80:83], v3 offset:10240
 v_add_f32 v5, v5, v81
 v_mfma_f32_16x16x32_bf16 v[152:155], a[116:119], v[24:27], v[152:155]
 buffer_load_dwordx4 a[132:135], v1, s[12:15], s55 offen offset:1024 sc1
 v_mfma_f32_16x16x32_bf16 v[216:219], a[116:119], v[28:31], v[216:219]
 s_cmp_eq_u32 s7, 0
 ds_read_b128 a[84:87], v3 offset:26624
 v_add_f32 v109, v105, v12
 v_mfma_f32_16x16x32_bf16 v[216:219], a[112:115], v[20:23], v[216:219]
 s_waitcnt lgkmcnt(6)
 v_exp_f32 v82, v50
 v_mfma_f32_16x16x32_bf16 v[156:159], a[120:123], v[16:19], v[156:159]
 s_cselect_b32 s42, s78, s49
 ds_read_b128 a[88:91], v3 offset:11264
 v_add_f32 v5, v5, v82
 v_mfma_f32_16x16x32_bf16 v[156:159], a[124:127], v[24:27], v[156:159]
 buffer_load_dwordx4 a[136:139], v1, s[12:15], s55 offen offset:2048 sc1
 v_mfma_f32_16x16x32_bf16 v[220:223], a[124:127], v[28:31], v[220:223]
 s_cmov_b32 s40, s52
 ds_read_b128 a[92:95], v3 offset:27648
 v_add_f32 v110, v106, v12
 v_mfma_f32_16x16x32_bf16 v[220:223], a[120:123], v[20:23], v[220:223]
 s_waitcnt lgkmcnt(6)
 v_exp_f32 v83, v51
 v_mfma_f32_16x16x32_bf16 v[160:163], a[64:67], v[16:19], v[160:163]
 s_cmov_b64 s[8:9], s[86:87]
 ds_read_b128 a[96:99], v3 offset:12288
 v_add_f32 v5, v5, v83
 v_mfma_f32_16x16x32_bf16 v[160:163], a[68:71], v[24:27], v[160:163]
 buffer_load_dwordx4 a[140:143], v1, s[12:15], s55 offen offset:3072 sc1
 v_mfma_f32_16x16x32_bf16 v[224:227], a[68:71], v[28:31], v[224:227]
 s_cmov_b32 s10, 3670016
 ds_read_b128 a[100:103], v3 offset:28672
 v_add_f32 v111, v107, v12
 v_mfma_f32_16x16x32_bf16 v[224:227], a[64:67], v[20:23], v[224:227]
 s_waitcnt lgkmcnt(6)
 v_exp_f32 v92, v60
 v_mfma_f32_16x16x32_bf16 v[164:167], a[72:75], v[16:19], v[164:167]
 s_cmov_b32 s76, 6144
 ds_read_b128 a[104:107], v3 offset:13312
 v_add_f32 v6, v6, v92
 v_mfma_f32_16x16x32_bf16 v[164:167], a[76:79], v[24:27], v[164:167]
 buffer_load_dwordx4 a[144:147], v4, s[12:15], s55 offen offset:0 sc1
 v_mfma_f32_16x16x32_bf16 v[228:231], a[76:79], v[28:31], v[228:231]
 s_cmov_b32 s77, 10240
 ds_read_b128 a[108:111], v3 offset:29696
 v_add_f32 v116, v112, v12
 v_mfma_f32_16x16x32_bf16 v[228:231], a[72:75], v[20:23], v[228:231]
 s_waitcnt lgkmcnt(6)
 v_exp_f32 v93, v61
 v_mfma_f32_16x16x32_bf16 v[168:171], a[80:83], v[16:19], v[168:171]
 s_mov_b32 s44, 1
 ds_read_b128 a[112:115], v3 offset:14336
 v_add_f32 v6, v6, v93
 v_mfma_f32_16x16x32_bf16 v[168:171], a[84:87], v[24:27], v[168:171]
 buffer_load_dwordx4 a[148:151], v4, s[12:15], s55 offen offset:1024 sc1
 v_mfma_f32_16x16x32_bf16 v[232:235], a[84:87], v[28:31], v[232:235]
 s_cmp_eq_u32 s51, 1
 ds_read_b128 a[116:119], v3 offset:30720
 v_add_f32 v117, v113, v12
 v_mfma_f32_16x16x32_bf16 v[232:235], a[80:83], v[20:23], v[232:235]
 s_waitcnt lgkmcnt(6)
 v_exp_f32 v94, v62
 v_mfma_f32_16x16x32_bf16 v[172:175], a[88:91], v[16:19], v[172:175]
 ds_read_b128 a[120:123], v3 offset:15360
 v_add_f32 v6, v6, v94
 v_mfma_f32_16x16x32_bf16 v[172:175], a[92:95], v[24:27], v[172:175]
 buffer_load_dwordx4 a[152:155], v4, s[12:15], s55 offen offset:2048 sc1
 v_mfma_f32_16x16x32_bf16 v[236:239], a[92:95], v[28:31], v[236:239]
 s_waitcnt vmcnt(16)
 ds_read_b128 a[124:127], v3 offset:31744
 v_xor_b32 v3, 0x8000, v3
 v_mfma_f32_16x16x32_bf16 v[236:239], a[88:91], v[20:23], v[236:239]
 s_waitcnt lgkmcnt(6)
 s_barrier
 v_exp_f32 v95, v63
 v_mfma_f32_16x16x32_bf16 v[176:179], a[96:99], v[16:19], v[176:179]
 ds_read_b128 a[64:67], v2 offset:0
 v_add_f32 v6, v6, v95
 v_mfma_f32_16x16x32_bf16 v[176:179], a[100:103], v[24:27], v[176:179]
 buffer_load_dwordx4 a[156:159], v4, s[12:15], s55 offen offset:3072 sc1
 v_mfma_f32_16x16x32_bf16 v[240:243], a[100:103], v[28:31], v[240:243]
 s_waitcnt vmcnt(9)
 ds_read_b128 a[68:71], v2 offset:1024
 v_add_f32 v118, v114, v12
 v_mfma_f32_16x16x32_bf16 v[240:243], a[96:99], v[20:23], v[240:243]
 s_waitcnt lgkmcnt(6)
 s_barrier
 v_exp_f32 v88, v56
 v_mfma_f32_16x16x32_bf16 v[180:183], a[104:107], v[16:19], v[180:183]
 ds_read_b128 a[72:75], v2 offset:2048
 v_exp_f32 v89, v57
 v_add_f32 v5, v5, v88
 v_mfma_f32_16x16x32_bf16 v[180:183], a[108:111], v[24:27], v[180:183]
 ds_read_b128 a[96:99], v3 offset:0
 v_exp_f32 v90, v58
 v_add_f32 v5, v5, v89
 v_mfma_f32_16x16x32_bf16 v[244:247], a[108:111], v[28:31], v[244:247]
 ds_read_b128 a[76:79], v2 offset:3072
 v_exp_f32 v91, v59
 v_mfma_f32_16x16x32_bf16 v[244:247], a[104:107], v[20:23], v[244:247]
 s_waitcnt lgkmcnt(7)
 ds_read_b128 a[100:103], v3 offset:16384
 v_add_f32 v5, v5, v90
 v_mfma_f32_16x16x32_bf16 v[184:187], a[112:115], v[16:19], v[184:187]
 ds_read_b128 a[80:83], v2 offset:4096
 v_add_f32 v5, v5, v91
 v_mfma_f32_16x16x32_bf16 v[184:187], a[116:119], v[24:27], v[184:187]
 ds_read_b128 a[104:107], v3 offset:1024
 v_add_f32 v11, v5, v6
 v_mfma_f32_16x16x32_bf16 v[248:251], a[116:119], v[28:31], v[248:251]
 ds_read_b128 a[84:87], v2 offset:5120
 v_cmp_nge_f32 vcc, s47, v11
 v_mfma_f32_16x16x32_bf16 v[248:251], a[112:115], v[20:23], v[248:251]
 s_waitcnt lgkmcnt(9)
 ds_read_b128 a[108:111], v3 offset:17408
 v_add_f32 v119, v115, v12
 v_mfma_f32_16x16x32_bf16 v[188:191], a[120:123], v[16:19], v[188:191]
 s_cselect_b64 vcc, vcc, -1
 ds_read_b128 a[88:91], v2 offset:6144
 v_add_f32 v124, v120, v12
 v_mfma_f32_16x16x32_bf16 v[188:191], a[124:127], v[24:27], v[188:191]
 ds_read_b128 a[112:115], v3 offset:2048
 v_add_f32 v125, v121, v12
 v_mfma_f32_16x16x32_bf16 v[252:255], a[124:127], v[28:31], v[252:255]
 ds_read_b128 a[92:95], v2 offset:7168
 v_add_f32 v126, v122, v12
 v_mfma_f32_16x16x32_bf16 v[252:255], a[120:123], v[20:23], v[252:255]
 s_waitcnt lgkmcnt(11)
 ds_read_b128 a[116:119], v3 offset:18432
 s_cbranch_vccnz L_g0x
L_p1:
 v_mfma_f32_16x16x32_bf16 v[36:39], a[64:67], a[32:35], v[100:103]
 s_mov_b32 m0, s40
 ds_read_b128 a[120:123], v3 offset:3072
 v_cvt_pk_bf16_f32 v16, v64, v65
 v_cvt_pk_bf16_f32 v24, v80, v81
 v_mfma_f32_16x16x32_bf16 v[36:39], a[68:71], a[36:39], v[36:39]
 s_waitcnt lgkmcnt(10)
 ds_read_b128 a[124:127], v3 offset:19456
 buffer_load_dwordx4 v13, s[8:11], s42 offen offset:0 sc1 lds
 v_mfma_f32_16x16x32_bf16 v[36:39], a[72:75], a[40:43], v[36:39]
 s_add_u32 s39, s42, s76
 ds_read_b128 a[64:67], v2 offset:8192
 v_cvt_pk_bf16_f32 v17, v66, v67
 v_cvt_pk_bf16_f32 v25, v82, v83
 v_mfma_f32_16x16x32_bf16 v[36:39], a[76:79], a[44:47], v[36:39]
 s_waitcnt lgkmcnt(8)
 ds_read_b128 a[68:71], v2 offset:9216
 v_cvt_pk_bf16_f32 v18, v72, v73
 v_cvt_pk_bf16_f32 v26, v88, v89
 v_mfma_f32_16x16x32_bf16 v[36:39], a[80:83], a[48:51], v[36:39]
 buffer_load_dwordx4 v13, s[8:11], s39 offen offset:1024 sc1 lds
 v_mfma_f32_16x16x32_bf16 v[36:39], a[84:87], a[52:55], v[36:39]
 s_waitcnt lgkmcnt(5)
 ds_read_b128 a[72:75], v2 offset:10240
 v_cvt_pk_bf16_f32 v19, v74, v75
 v_cvt_pk_bf16_f32 v27, v90, v91
 v_mfma_f32_16x16x32_bf16 v[36:39], a[88:91], a[56:59], v[36:39]
 ds_read_b128 a[76:79], v2 offset:11264
 v_cvt_pk_bf16_f32 v20, v68, v69
 v_mfma_f32_16x16x32_bf16 v[36:39], a[92:95], a[60:63], v[36:39]
 s_add_u32 s39, s39, s76
 v_cvt_pk_bf16_f32 v21, v70, v71
 v_cvt_pk_bf16_f32 v22, v76, v77
 v_mfma_f32_16x16x32_bf16 v[128:131], a[96:99], v[16:19], v[128:131]
 ds_read_b128 a[80:83], v2 offset:12288
 buffer_load_dwordx4 v13, s[8:11], s39 offen offset:2048 sc1 lds
 v_mfma_f32_16x16x32_bf16 v[128:131], a[100:103], v[24:27], v[128:131]
 ds_read_b128 a[84:87], v2 offset:13312
 v_cvt_pk_bf16_f32 v23, v78, v79
 v_mfma_f32_16x16x32_bf16 v[132:135], a[104:107], v[16:19], v[132:135]
 v_cvt_pk_bf16_f32 v28, v84, v85
 v_cvt_pk_bf16_f32 v29, v86, v87
 v_mfma_f32_16x16x32_bf16 v[132:135], a[108:111], v[24:27], v[132:135]
 s_add_u32 s39, s39, s76
 ds_read_b128 a[88:91], v2 offset:14336
 v_cvt_pk_bf16_f32 v30, v92, v93
 v_mfma_f32_16x16x32_bf16 v[136:139], a[112:115], v[16:19], v[136:139]
 s_waitcnt lgkmcnt(8)
 ds_read_b128 a[92:95], v2 offset:15360
 v_cvt_pk_bf16_f32 v31, v94, v95
 v_mfma_f32_16x16x32_bf16 v[136:139], a[116:119], v[24:27], v[136:139]
 buffer_load_dwordx4 v13, s[8:11], s39 offen offset:3072 sc1 lds
 v_mfma_f32_16x16x32_bf16 v[140:143], a[120:123], v[16:19], v[140:143]
 s_waitcnt lgkmcnt(8)
 v_add_f32 v7, v7, v5
 v_add_f32 v8, v8, v6
 v_mfma_f32_16x16x32_bf16 v[140:143], a[124:127], v[24:27], v[140:143]
 s_bitset1_b32 m0, 12
 v_exp_f32 v68, v36
 v_mfma_f32_16x16x32_bf16 v[192:195], a[96:99], v[20:23], v[192:195]
 s_add_u32 s39, s39, s77
 ds_read_b128 a[96:99], v3 offset:4096
 v_mfma_f32_16x16x32_bf16 v[192:195], a[100:103], v[28:31], v[192:195]
 ds_read_b128 a[100:103], v3 offset:20480
 buffer_load_dwordx4 v13, s[8:11], s39 offen offset:0 sc1 lds
 v_mfma_f32_16x16x32_bf16 v[196:199], a[104:107], v[20:23], v[196:199]
 s_add_u32 s39, s39, s76
 v_exp_f32 v69, v37
 v_mfma_f32_16x16x32_bf16 v[196:199], a[108:111], v[28:31], v[196:199]
 ds_read_b128 a[104:107], v3 offset:5120
 buffer_load_dwordx4 v13, s[8:11], s39 offen offset:1024 sc1 lds
 v_mfma_f32_16x16x32_bf16 v[200:203], a[112:115], v[20:23], v[200:203]
 ds_read_b128 a[108:111], v3 offset:21504
 v_add_f32 v6, v68, v69
 v_mfma_f32_16x16x32_bf16 v[200:203], a[116:119], v[28:31], v[200:203]
 v_exp_f32 v70, v38
 v_mfma_f32_16x16x32_bf16 v[204:207], a[120:123], v[20:23], v[204:207]
 s_add_u32 s39, s39, s76
 ds_read_b128 a[112:115], v3 offset:6144
 v_add_f32 v6, v6, v70
 v_mfma_f32_16x16x32_bf16 v[204:207], a[124:127], v[28:31], v[204:207]
 s_waitcnt lgkmcnt(11)
 ds_read_b128 a[116:119], v3 offset:22528
 v_exp_f32 v71, v39
 v_mfma_f32_16x16x32_bf16 v[44:47], a[64:67], a[32:35], v[108:111]
 buffer_load_dwordx4 v13, s[8:11], s39 offen offset:2048 sc1 lds
 v_mfma_f32_16x16x32_bf16 v[44:47], a[68:71], a[36:39], v[44:47]
 s_waitcnt lgkmcnt(10)
 ds_read_b128 a[120:123], v3 offset:7168
 v_add_f32 v6, v6, v71
 v_mfma_f32_16x16x32_bf16 v[44:47], a[72:75], a[40:43], v[44:47]
 s_barrier
 ds_read_b128 a[124:127], v3 offset:23552
 v_mfma_f32_16x16x32_bf16 v[44:47], a[76:79], a[44:47], v[44:47]
 s_waitcnt lgkmcnt(10)
 v_mfma_f32_16x16x32_bf16 v[44:47], a[80:83], a[48:51], v[44:47]
 s_add_u32 s39, s39, s76
 ds_read_b128 a[64:67], v2 offset:16384
 v_mfma_f32_16x16x32_bf16 v[44:47], a[84:87], a[52:55], v[44:47]
 s_waitcnt lgkmcnt(9)
 ds_read_b128 a[68:71], v2 offset:17408
 buffer_load_dwordx4 v13, s[8:11], s39 offen offset:3072 sc1 lds
 v_mfma_f32_16x16x32_bf16 v[44:47], a[88:91], a[56:59], v[44:47]
 v_mfma_f32_16x16x32_bf16 v[44:47], a[92:95], a[60:63], v[44:47]
 s_waitcnt lgkmcnt(8)
 ds_read_b128 a[72:75], v2 offset:18432
 buffer_load_dwordx4 a[0:3], v1, s[12:15], s56 offen offset:0 sc1
 v_mfma_f32_16x16x32_bf16 v[144:147], a[96:99], v[16:19], v[144:147]
 ds_read_b128 a[76:79], v2 offset:19456
 v_mfma_f32_16x16x32_bf16 v[144:147], a[100:103], v[24:27], v[144:147]
 v_mfma_f32_16x16x32_bf16 v[208:211], a[100:103], v[28:31], v[208:211]
 ds_read_b128 a[80:83], v2 offset:20480
 buffer_load_dwordx4 a[4:7], v1, s[12:15], s56 offen offset:1024 sc1
 v_mfma_f32_16x16x32_bf16 v[208:211], a[96:99], v[20:23], v[208:211]
 s_waitcnt lgkmcnt(9)
 ds_read_b128 a[84:87], v2 offset:21504
 v_mfma_f32_16x16x32_bf16 v[148:151], a[104:107], v[16:19], v[148:151]
 v_exp_f32 v76, v44
 v_mfma_f32_16x16x32_bf16 v[148:151], a[108:111], v[24:27], v[148:151]
 ds_read_b128 a[88:91], v2 offset:22528
 v_add_f32 v6, v6, v76
 v_mfma_f32_16x16x32_bf16 v[212:215], a[108:111], v[28:31], v[212:215]
 ds_read_b128 a[92:95], v2 offset:23552
 v_exp_f32 v77, v45
 v_mfma_f32_16x16x32_bf16 v[212:215], a[104:107], v[20:23], v[212:215]
 s_waitcnt lgkmcnt(10)
 buffer_load_dwordx4 a[8:11], v1, s[12:15], s56 offen offset:2048 sc1
 v_mfma_f32_16x16x32_bf16 v[152:155], a[112:115], v[16:19], v[152:155]
 ds_read_b128 a[96:99], v3 offset:8192
 v_add_f32 v6, v6, v77
 v_mfma_f32_16x16x32_bf16 v[152:155], a[116:119], v[24:27], v[152:155]
 ds_read_b128 a[100:103], v3 offset:24576
 v_exp_f32 v78, v46
 v_mfma_f32_16x16x32_bf16 v[216:219], a[116:119], v[28:31], v[216:219]
 buffer_load_dwordx4 a[12:15], v1, s[12:15], s56 offen offset:3072 sc1
 v_mfma_f32_16x16x32_bf16 v[216:219], a[112:115], v[20:23], v[216:219]
 s_waitcnt lgkmcnt(10)
 ds_read_b128 a[104:107], v3 offset:9216
 v_add_f32 v6, v6, v78
 v_mfma_f32_16x16x32_bf16 v[156:159], a[120:123], v[16:19], v[156:159]
 ds_read_b128 a[108:111], v3 offset:25600
 v_exp_f32 v79, v47
 v_mfma_f32_16x16x32_bf16 v[156:159], a[124:127], v[24:27], v[156:159]
 buffer_load_dwordx4 a[16:19], v4, s[12:15], s56 offen offset:0 sc1
 v_mfma_f32_16x16x32_bf16 v[220:223], a[124:127], v[28:31], v[220:223]
 ds_read_b128 a[112:115], v3 offset:10240
 v_add_f32 v6, v6, v79
 v_mfma_f32_16x16x32_bf16 v[220:223], a[120:123], v[20:23], v[220:223]
 s_waitcnt lgkmcnt(11)
 ds_read_b128 a[116:119], v3 offset:26624
 v_mfma_f32_16x16x32_bf16 v[52:55], a[64:67], a[32:35], v[116:119]
 v_mfma_f32_16x16x32_bf16 v[52:55], a[68:71], a[36:39], v[52:55]
 s_waitcnt lgkmcnt(10)
 ds_read_b128 a[120:123], v3 offset:11264
 buffer_load_dwordx4 a[20:23], v4, s[12:15], s56 offen offset:1024 sc1
 v_mfma_f32_16x16x32_bf16 v[52:55], a[72:75], a[40:43], v[52:55]
 ds_read_b128 a[124:127], v3 offset:27648
 v_mfma_f32_16x16x32_bf16 v[52:55], a[76:79], a[44:47], v[52:55]
 s_waitcnt lgkmcnt(10)
 v_mfma_f32_16x16x32_bf16 v[52:55], a[80:83], a[48:51], v[52:55]
 ds_read_b128 a[64:67], v2 offset:24576
 buffer_load_dwordx4 a[24:27], v4, s[12:15], s56 offen offset:2048 sc1
 v_mfma_f32_16x16x32_bf16 v[52:55], a[84:87], a[52:55], v[52:55]
 s_waitcnt lgkmcnt(9)
 ds_read_b128 a[68:71], v2 offset:25600
 v_mfma_f32_16x16x32_bf16 v[52:55], a[88:91], a[56:59], v[52:55]
 v_mfma_f32_16x16x32_bf16 v[52:55], a[92:95], a[60:63], v[52:55]
 s_waitcnt lgkmcnt(8)
 ds_read_b128 a[72:75], v2 offset:26624
 v_mfma_f32_16x16x32_bf16 v[160:163], a[96:99], v[16:19], v[160:163]
 ds_read_b128 a[76:79], v2 offset:27648
 v_mfma_f32_16x16x32_bf16 v[160:163], a[100:103], v[24:27], v[160:163]
 buffer_load_dwordx4 a[28:31], v4, s[12:15], s56 offen offset:3072 sc1
 v_mfma_f32_16x16x32_bf16 v[224:227], a[100:103], v[28:31], v[224:227]
 s_mov_b32 m0, s41
 ds_read_b128 a[80:83], v2 offset:28672
 v_mfma_f32_16x16x32_bf16 v[224:227], a[96:99], v[20:23], v[224:227]
 s_waitcnt lgkmcnt(9)
 ds_read_b128 a[84:87], v2 offset:29696
 v_mfma_f32_16x16x32_bf16 v[164:167], a[104:107], v[16:19], v[164:167]
 buffer_load_dwordx4 v1, s[12:15], s43 offen offset:0 sc1 lds
 v_mfma_f32_16x16x32_bf16 v[164:167], a[108:111], v[24:27], v[164:167]
 ds_read_b128 a[88:91], v2 offset:30720
 v_exp_f32 v84, v52
 v_mfma_f32_16x16x32_bf16 v[228:231], a[108:111], v[28:31], v[228:231]
 ds_read_b128 a[92:95], v2 offset:31744
 v_xor_b32 v2, 0x8000, v2
 v_add_f32 v6, v6, v84
 v_mfma_f32_16x16x32_bf16 v[228:231], a[104:107], v[20:23], v[228:231]
 s_waitcnt lgkmcnt(10)
 buffer_load_dwordx4 v1, s[12:15], s43 offen offset:1024 sc1 lds
 v_mfma_f32_16x16x32_bf16 v[168:171], a[112:115], v[16:19], v[168:171]
 ds_read_b128 a[96:99], v3 offset:12288
 v_exp_f32 v85, v53
 v_mfma_f32_16x16x32_bf16 v[168:171], a[116:119], v[24:27], v[168:171]
 ds_read_b128 a[100:103], v3 offset:28672
 v_add_f32 v6, v6, v85
 v_mfma_f32_16x16x32_bf16 v[232:235], a[116:119], v[28:31], v[232:235]
 v_exp_f32 v86, v54
 v_mfma_f32_16x16x32_bf16 v[232:235], a[112:115], v[20:23], v[232:235]
 s_waitcnt lgkmcnt(10)
 ds_read_b128 a[104:107], v3 offset:13312
 buffer_load_dwordx4 v1, s[12:15], s43 offen offset:2048 sc1 lds
 v_mfma_f32_16x16x32_bf16 v[172:175], a[120:123], v[16:19], v[172:175]
 ds_read_b128 a[108:111], v3 offset:29696
 v_add_f32 v6, v6, v86
 v_mfma_f32_16x16x32_bf16 v[172:175], a[124:127], v[24:27], v[172:175]
 v_exp_f32 v87, v55
 v_mfma_f32_16x16x32_bf16 v[236:239], a[124:127], v[28:31], v[236:239]
 s_mov_b32 s44, 0
 ds_read_b128 a[112:115], v3 offset:14336
 v_add_f32 v6, v6, v87
 v_mfma_f32_16x16x32_bf16 v[236:239], a[120:123], v[20:23], v[236:239]
 s_waitcnt lgkmcnt(11)
 ds_read_b128 a[116:119], v3 offset:30720
 v_mfma_f32_16x16x32_bf16 v[60:63], a[64:67], a[32:35], v[124:127]
 buffer_load_dwordx4 v1, s[12:15], s43 offen offset:3072 sc1 lds
 v_mfma_f32_16x16x32_bf16 v[60:63], a[68:71], a[36:39], v[60:63]
 s_waitcnt lgkmcnt(10)
 ds_read_b128 a[120:123], v3 offset:15360
 v_mfma_f32_16x16x32_bf16 v[60:63], a[72:75], a[40:43], v[60:63]
 s_bitset1_b32 m0, 12
 ds_read_b128 a[124:127], v3 offset:31744
 v_xor_b32 v3, 0x8000, v3
 v_mfma_f32_16x16x32_bf16 v[60:63], a[76:79], a[44:47], v[60:63]
 s_waitcnt lgkmcnt(10)
 buffer_load_dwordx4 v4, s[12:15], s43 offen offset:0 sc1 lds
 v_mfma_f32_16x16x32_bf16 v[60:63], a[80:83], a[48:51], v[60:63]
 v_mfma_f32_16x16x32_bf16 v[60:63], a[84:87], a[52:55], v[60:63]
 s_waitcnt lgkmcnt(8)
 v_mfma_f32_16x16x32_bf16 v[60:63], a[88:91], a[56:59], v[60:63]
 buffer_load_dwordx4 v4, s[12:15], s43 offen offset:1024 sc1 lds
 v_mfma_f32_16x16x32_bf16 v[60:63], a[92:95], a[60:63], v[60:63]
 s_waitcnt lgkmcnt(6)
 v_mfma_f32_16x16x32_bf16 v[176:179], a[96:99], v[16:19], v[176:179]
 s_waitcnt vmcnt(14)
 v_mfma_f32_16x16x32_bf16 v[176:179], a[100:103], v[24:27], v[176:179]
 s_barrier
 v_mfma_f32_16x16x32_bf16 v[240:243], a[100:103], v[28:31], v[240:243]
 ds_read_b128 a[64:67], v2 offset:0
 buffer_load_dwordx4 v4, s[12:15], s43 offen offset:2048 sc1 lds
 v_mfma_f32_16x16x32_bf16 v[240:243], a[96:99], v[20:23], v[240:243]
 s_waitcnt lgkmcnt(5)
 ds_read_b128 a[68:71], v2 offset:1024
 v_mfma_f32_16x16x32_bf16 v[180:183], a[104:107], v[16:19], v[180:183]
 v_exp_f32 v92, v60
 v_mfma_f32_16x16x32_bf16 v[180:183], a[108:111], v[24:27], v[180:183]
 ds_read_b128 a[72:75], v2 offset:2048
 v_add_f32 v6, v6, v92
 v_mfma_f32_16x16x32_bf16 v[244:247], a[108:111], v[28:31], v[244:247]
 ds_read_b128 a[76:79], v2 offset:3072
 v_exp_f32 v93, v61
 v_mfma_f32_16x16x32_bf16 v[244:247], a[104:107], v[20:23], v[244:247]
 s_waitcnt lgkmcnt(6)
 buffer_load_dwordx4 v4, s[12:15], s43 offen offset:3072 sc1 lds
 v_mfma_f32_16x16x32_bf16 v[184:187], a[112:115], v[16:19], v[184:187]
 ds_read_b128 a[80:83], v2 offset:4096
 v_add_f32 v6, v6, v93
 v_exp_f32 v94, v62
 v_mfma_f32_16x16x32_bf16 v[184:187], a[116:119], v[24:27], v[184:187]
 v_add_f32 v6, v6, v94
 v_exp_f32 v95, v63
 v_mfma_f32_16x16x32_bf16 v[248:251], a[116:119], v[28:31], v[248:251]
 ds_read_b128 a[84:87], v2 offset:5120
 v_add_f32 v6, v6, v95
 v_mfma_f32_16x16x32_bf16 v[248:251], a[112:115], v[20:23], v[248:251]
 s_waitcnt lgkmcnt(6)
 ds_read_b128 a[88:91], v2 offset:6144
 v_cmp_nge_f32 vcc, s47, v6
 v_mfma_f32_16x16x32_bf16 v[188:191], a[120:123], v[16:19], v[188:191]
 v_mfma_f32_16x16x32_bf16 v[188:191], a[124:127], v[24:27], v[188:191]
 ds_read_b128 a[92:95], v2 offset:7168
 v_mfma_f32_16x16x32_bf16 v[252:255], a[124:127], v[28:31], v[252:255]
 v_mfma_f32_16x16x32_bf16 v[252:255], a[120:123], v[20:23], v[252:255]
 s_cbranch_vccnz L_slow
L_p2:
 s_cmp_lg_u32 s7, 0
 s_cbranch_scc1 L_switch
 v_and_b32 v11, 31, v0
 v_lshlrev_b32 v11, 2, v11
 buffer_load_dword a247, v11, s[12:15], s61 offen sc1
 v_accvgpr_read_b32 v32, a192
 v_accvgpr_read_b32 v33, a193
 v_accvgpr_read_b32 v34, a194
 v_accvgpr_read_b32 v35, a195
 v_add_u32 v2, s58, v13
 v_cmp_neq_f32 vcc, v34, v9
 v_cmp_neq_f32 s[20:21], v35, v10
 s_or_b64 vcc, vcc, s[20:21]
 s_cmp_eq_u32 s51, 1
 s_cselect_b64 vcc, vcc, -1
 s_cmp_eq_u32 s38, 0
 s_cselect_b64 vcc, 0, vcc
 s_cbranch_vccnz L_fagen
 v_mfma_f32_16x16x32_bf16 v[128:131], a[250:253], a[128:131], v[128:131]
 v_cvt_pk_bf16_f32 v20, v68, v69
 v_cvt_pk_bf16_f32 v21, v70, v71
 v_mfma_f32_16x16x32_bf16 v[132:135], a[248:251], a[128:131], v[132:135]
 v_cvt_pk_bf16_f32 v22, v76, v77
 v_cvt_pk_bf16_f32 v23, v78, v79
 v_mfma_f32_16x16x32_bf16 v[136:139], a[250:253], a[132:135], v[136:139]
 v_cvt_pk_bf16_f32 v28, v84, v85
 v_cvt_pk_bf16_f32 v29, v86, v87
 v_mfma_f32_16x16x32_bf16 v[140:143], a[248:251], a[132:135], v[140:143]
 v_cvt_pk_bf16_f32 v30, v92, v93
 v_cvt_pk_bf16_f32 v31, v94, v95
 v_mfma_f32_16x16x32_bf16 v[144:147], a[250:253], a[136:139], v[144:147]
 s_waitcnt vmcnt(0)
 v_add_f32 v8, v8, v6
 v_mfma_f32_16x16x32_bf16 v[148:151], a[248:251], a[136:139], v[148:151]
 s_barrier
 ds_read_b128 a[64:67], v3 offset:0
 v_mfma_f32_16x16x32_bf16 v[152:155], a[250:253], a[140:143], v[152:155]
 s_add_u32 m0, s29, 0
 ds_read_b128 a[68:71], v3 offset:16384
 v_mov_b32 v40, v7
 v_mfma_f32_16x16x32_bf16 v[156:159], a[248:251], a[140:143], v[156:159]
 buffer_load_dwordx4 v2, s[8:11], s78 offen lds
 v_mfma_f32_16x16x32_bf16 v[160:163], a[250:253], a[144:147], v[160:163]
 ds_read_b128 a[72:75], v3 offset:1024
 v_mov_b32 v41, v8
 v_mfma_f32_16x16x32_bf16 v[164:167], a[248:251], a[144:147], v[164:167]
 ds_read_b128 a[76:79], v3 offset:17408
 v_cvt_pk_bf16_f32 v128, v128, v129
 v_mfma_f32_16x16x32_bf16 v[168:171], a[250:253], a[148:151], v[168:171]
 s_add_u32 m0, s29, 4096
 v_permlane32_swap_b32 v7, v40
 v_permlane32_swap_b32 v8, v41
 v_mfma_f32_16x16x32_bf16 v[172:175], a[248:251], a[148:151], v[172:175]
 ds_read_b128 a[80:83], v3 offset:2048
 buffer_load_dwordx4 v2, s[8:11], s79 offen lds
 v_mfma_f32_16x16x32_bf16 v[176:179], a[250:253], a[152:155], v[176:179]
 ds_read_b128 a[84:87], v3 offset:18432
 v_add_f32 v7, v7, v40
 v_mfma_f32_16x16x32_bf16 v[180:183], a[248:251], a[152:155], v[180:183]
 v_add_f32 v8, v8, v41
 v_cvt_pk_bf16_f32 v129, v130, v131
 v_mfma_f32_16x16x32_bf16 v[184:187], a[250:253], a[156:159], v[184:187]
 s_add_u32 m0, s29, 8192
 ds_read_b128 a[88:91], v3 offset:3072
 v_cvt_pk_bf16_f32 v130, v132, v133
 v_mfma_f32_16x16x32_bf16 v[188:191], a[248:251], a[156:159], v[188:191]
 s_waitcnt lgkmcnt(5)
 ds_read_b128 a[92:95], v3 offset:19456
 v_mov_b32 v40, v7
 v_mfma_f32_16x16x32_bf16 v[192:195], a[64:67], v[20:23], v[192:195]
 s_waitcnt vmcnt(10)
 buffer_load_dwordx4 v2, s[8:11], s80 offen lds
 v_mfma_f32_16x16x32_bf16 v[192:195], a[68:71], v[28:31], v[192:195]
 ds_read_b128 a[96:99], v3 offset:4096
 v_mov_b32 v41, v8
 v_mfma_f32_16x16x32_bf16 v[192:195], a[250:253], a[0:3], v[192:195]
 s_waitcnt lgkmcnt(5)
 ds_read_b128 a[100:103], v3 offset:20480
 v_cvt_pk_bf16_f32 v131, v134, v135
 v_mfma_f32_16x16x32_bf16 v[196:199], a[72:75], v[20:23], v[196:199]
 s_add_u32 m0, s29, 12288
 v_permlane16_swap_b32 v7, v40
 v_permlane16_swap_b32 v8, v41
 v_mfma_f32_16x16x32_bf16 v[196:199], a[76:79], v[28:31], v[196:199]
 ds_read_b128 a[104:107], v3 offset:5120
 buffer_load_dwordx4 v2, s[8:11], s81 offen lds
 v_mfma_f32_16x16x32_bf16 v[196:199], a[248:251], a[0:3], v[196:199]
 s_waitcnt lgkmcnt(5)
 ds_read_b128 a[108:111], v3 offset:21504
 v_add_f32 v7, v7, v40
 v_mfma_f32_16x16x32_bf16 v[200:203], a[80:83], v[20:23], v[200:203]
 v_add_f32 v8, v8, v41
 v_cvt_pk_bf16_f32 v136, v136, v137
 v_mfma_f32_16x16x32_bf16 v[200:203], a[84:87], v[28:31], v[200:203]
 s_add_u32 m0, s29, 16384
 ds_read_b128 a[112:115], v3 offset:6144
 v_cvt_pk_bf16_f32 v137, v138, v139
 v_mfma_f32_16x16x32_bf16 v[200:203], a[250:253], a[4:7], v[200:203]
 s_waitcnt lgkmcnt(5)
 ds_read_b128 a[116:119], v3 offset:22528
 v_add_f32 v7, v7, v32
 v_mfma_f32_16x16x32_bf16 v[204:207], a[88:91], v[20:23], v[204:207]
 buffer_load_dwordx4 v2, s[8:11], s82 offen lds
 v_mfma_f32_16x16x32_bf16 v[204:207], a[92:95], v[28:31], v[204:207]
 ds_read_b128 a[120:123], v3 offset:7168
 v_add_f32 v8, v8, v33
 v_mfma_f32_16x16x32_bf16 v[204:207], a[248:251], a[4:7], v[204:207]
 s_waitcnt lgkmcnt(5)
 ds_read_b128 a[124:127], v3 offset:23552
 v_cvt_pk_bf16_f32 v138, v140, v141
 v_mfma_f32_16x16x32_bf16 v[208:211], a[96:99], v[20:23], v[208:211]
 s_add_u32 m0, s29, 20480
 v_cvt_pk_bf16_f32 v139, v142, v143
 v_cvt_pk_bf16_f32 v144, v144, v145
 v_mfma_f32_16x16x32_bf16 v[208:211], a[100:103], v[28:31], v[208:211]
 ds_read_b128 a[64:67], v3 offset:8192
 buffer_load_dwordx4 v2, s[8:11], s83 offen lds
 v_mfma_f32_16x16x32_bf16 v[208:211], a[250:253], a[8:11], v[208:211]
 s_waitcnt lgkmcnt(5)
 ds_read_b128 a[68:71], v3 offset:24576
 v_cvt_pk_bf16_f32 v145, v146, v147
 v_mfma_f32_16x16x32_bf16 v[212:215], a[104:107], v[20:23], v[212:215]
 v_cvt_pk_bf16_f32 v146, v148, v149
 v_cvt_pk_bf16_f32 v147, v150, v151
 v_mfma_f32_16x16x32_bf16 v[212:215], a[108:111], v[28:31], v[212:215]
 s_add_u32 m0, s29, 24576
 ds_read_b128 a[72:75], v3 offset:9216
 v_cvt_pk_bf16_f32 v152, v152, v153
 v_mfma_f32_16x16x32_bf16 v[212:215], a[248:251], a[8:11], v[212:215]
 s_waitcnt lgkmcnt(5)
 ds_read_b128 a[76:79], v3 offset:25600
 v_cvt_pk_bf16_f32 v153, v154, v155
 v_mfma_f32_16x16x32_bf16 v[216:219], a[112:115], v[20:23], v[216:219]
 buffer_load_dwordx4 v2, s[8:11], s84 offen lds
 v_mfma_f32_16x16x32_bf16 v[216:219], a[116:119], v[28:31], v[216:219]
 ds_read_b128 a[80:83], v3 offset:10240
 v_cvt_pk_bf16_f32 v154, v156, v157
 v_mfma_f32_16x16x32_bf16 v[216:219], a[250:253], a[12:15], v[216:219]
 s_waitcnt lgkmcnt(5)
 ds_read_b128 a[84:87], v3 offset:26624
 v_cvt_pk_bf16_f32 v155, v158, v159
 v_mfma_f32_16x16x32_bf16 v[220:223], a[120:123], v[20:23], v[220:223]
 s_add_u32 m0, s29, 28672
 v_cvt_pk_bf16_f32 v160, v160, v161
 v_cvt_pk_bf16_f32 v161, v162, v163
 v_mfma_f32_16x16x32_bf16 v[220:223], a[124:127], v[28:31], v[220:223]
 ds_read_b128 a[88:91], v3 offset:11264
 buffer_load_dwordx4 v2, s[8:11], s85 offen lds
 v_mfma_f32_16x16x32_bf16 v[220:223], a[248:251], a[12:15], v[220:223]
 s_waitcnt lgkmcnt(5)
 ds_read_b128 a[92:95], v3 offset:27648
 v_add_u32 v2, 128, v2
 v_mfma_f32_16x16x32_bf16 v[224:227], a[64:67], v[20:23], v[224:227]
 v_cvt_pk_bf16_f32 v162, v164, v165
 v_cvt_pk_bf16_f32 v163, v166, v167
 v_mfma_f32_16x16x32_bf16 v[224:227], a[68:71], v[28:31], v[224:227]
 ds_read_b128 a[96:99], v3 offset:12288
 v_cvt_pk_bf16_f32 v168, v168, v169
 v_mfma_f32_16x16x32_bf16 v[224:227], a[250:253], a[16:19], v[224:227]
 s_waitcnt lgkmcnt(5)
 ds_read_b128 a[100:103], v3 offset:28672
 v_cvt_pk_bf16_f32 v169, v170, v171
 v_mfma_f32_16x16x32_bf16 v[228:231], a[72:75], v[20:23], v[228:231]
 v_cvt_pk_bf16_f32 v170, v172, v173
 v_cvt_pk_bf16_f32 v171, v174, v175
 v_mfma_f32_16x16x32_bf16 v[228:231], a[76:79], v[28:31], v[228:231]
 ds_read_b128 a[104:107], v3 offset:13312
 v_cvt_pk_bf16_f32 v176, v176, v177
 v_mfma_f32_16x16x32_bf16 v[228:231], a[248:251], a[16:19], v[228:231]
 s_waitcnt lgkmcnt(5)
 ds_read_b128 a[108:111], v3 offset:29696
 v_cvt_pk_bf16_f32 v177, v178, v179
 v_mfma_f32_16x16x32_bf16 v[232:235], a[80:83], v[20:23], v[232:235]
 v_cvt_pk_bf16_f32 v178, v180, v181
 v_cvt_pk_bf16_f32 v179, v182, v183
 v_mfma_f32_16x16x32_bf16 v[232:235], a[84:87], v[28:31], v[232:235]
 ds_read_b128 a[112:115], v3 offset:14336
 v_cvt_pk_bf16_f32 v184, v184, v185
 v_mfma_f32_16x16x32_bf16 v[232:235], a[250:253], a[20:23], v[232:235]
 s_waitcnt lgkmcnt(5)
 ds_read_b128 a[116:119], v3 offset:30720
 v_cvt_pk_bf16_f32 v185, v186, v187
 v_mfma_f32_16x16x32_bf16 v[236:239], a[88:91], v[20:23], v[236:239]
 v_cvt_pk_bf16_f32 v186, v188, v189
 v_cvt_pk_bf16_f32 v187, v190, v191
 v_mfma_f32_16x16x32_bf16 v[236:239], a[92:95], v[28:31], v[236:239]
 ds_read_b128 a[120:123], v3 offset:15360
 v_cvt_pk_bf16_f32 v192, v192, v193
 v_mfma_f32_16x16x32_bf16 v[236:239], a[248:251], a[20:23], v[236:239]
 s_waitcnt lgkmcnt(5)
 ds_read_b128 a[124:127], v3 offset:31744
 v_cvt_pk_bf16_f32 v193, v194, v195
 v_mfma_f32_16x16x32_bf16 v[240:243], a[96:99], v[20:23], v[240:243]
 v_cvt_pk_bf16_f32 v194, v196, v197
 v_cvt_pk_bf16_f32 v195, v198, v199
 v_mfma_f32_16x16x32_bf16 v[240:243], a[100:103], v[28:31], v[240:243]
 v_cvt_pk_bf16_f32 v200, v200, v201
 v_cvt_pk_bf16_f32 v201, v202, v203
 v_mfma_f32_16x16x32_bf16 v[240:243], a[250:253], a[24:27], v[240:243]
 s_waitcnt lgkmcnt(4)
 v_cvt_pk_bf16_f32 v202, v204, v205
 v_cvt_pk_bf16_f32 v203, v206, v207
 v_mfma_f32_16x16x32_bf16 v[244:247], a[104:107], v[20:23], v[244:247]
 v_cvt_pk_bf16_f32 v208, v208, v209
 v_cvt_pk_bf16_f32 v209, v210, v211
 v_mfma_f32_16x16x32_bf16 v[244:247], a[108:111], v[28:31], v[244:247]
 v_cvt_pk_bf16_f32 v210, v212, v213
 v_cvt_pk_bf16_f32 v211, v214, v215
 v_mfma_f32_16x16x32_bf16 v[244:247], a[248:251], a[24:27], v[244:247]
 s_waitcnt lgkmcnt(2)
 v_cvt_pk_bf16_f32 v216, v216, v217
 v_cvt_pk_bf16_f32 v217, v218, v219
 v_mfma_f32_16x16x32_bf16 v[248:251], a[112:115], v[20:23], v[248:251]
 v_cvt_pk_bf16_f32 v218, v220, v221
 v_cvt_pk_bf16_f32 v219, v222, v223
 v_mfma_f32_16x16x32_bf16 v[248:251], a[116:119], v[28:31], v[248:251]
 v_cvt_pk_bf16_f32 v224, v224, v225
 v_cvt_pk_bf16_f32 v225, v226, v227
 v_mfma_f32_16x16x32_bf16 v[248:251], a[250:253], a[28:31], v[248:251]
 s_waitcnt lgkmcnt(0)
 v_cvt_pk_bf16_f32 v226, v228, v229
 v_cvt_pk_bf16_f32 v227, v230, v231
 v_mfma_f32_16x16x32_bf16 v[252:255], a[120:123], v[20:23], v[252:255]
 v_cvt_pk_bf16_f32 v232, v232, v233
 v_cvt_pk_bf16_f32 v233, v234, v235
 v_mfma_f32_16x16x32_bf16 v[252:255], a[124:127], v[28:31], v[252:255]
 v_cvt_pk_bf16_f32 v234, v236, v237
 v_cvt_pk_bf16_f32 v235, v238, v239
 v_mfma_f32_16x16x32_bf16 v[252:255], a[248:251], a[28:31], v[252:255]
 v_cvt_pk_bf16_f32 v240, v240, v241
 v_cvt_pk_bf16_f32 v241, v242, v243
 s_nop 1
 v_rcp_f32 v64, v7
 v_rcp_f32 v65, v8
 v_cvt_pk_bf16_f32 v242, v244, v245
 v_cvt_pk_bf16_f32 v243, v246, v247
 v_cvt_pk_bf16_f32 v248, v248, v249
 v_cvt_pk_bf16_f32 v249, v250, v251
 v_cvt_pk_bf16_f32 v250, v252, v253
 v_cvt_pk_bf16_f32 v251, v254, v255
 s_waitcnt vmcnt(0)
 s_cmp_lg_u32 s27, 0
 s_cbranch_scc1 L_attdone
 s_mov_b32 s59, 2.0
 s_cmp_eq_u32 s62, 0
 s_cbranch_scc1 L_t1park
 v_accvgpr_read_b32 v12, a247
 v_cmp_ne_u32 vcc, 0, v12
 s_cbranch_vccz L_poll1_ok
 v_and_b32 v11, 31, v0
 v_lshlrev_b32 v11, 2, v11
 s_mov_b32 s32, 0
L_poll1:
 buffer_load_dword v12, v11, s[12:15], s61 offen sc1
 s_waitcnt vmcnt(0)
 v_cmp_ne_u32 vcc, 0, v12
 s_cbranch_vccz L_poll1_ok
 s_sleep 8
 s_add_u32 s32, s32, 1
 s_cmp_lt_u32 s32, 0x80000
 s_cbranch_scc1 L_poll1
L_poll1_ok:
 s_branch L_t1park
L_kvlate:
 v_cmp_gt_u32 vcc, 256, v5
 v_mov_b32 v29, 0
 s_mov_b32 s32, 0
 s_cbranch_vccz L_armed
L_pollA:
 global_load_dword v28, v29, s[90:91] offset:128 sc1
 s_add_u32 s32, s32, 1
 s_waitcnt vmcnt(0)
 v_cmp_gt_u32 vcc, 256, v28
 s_cmp_lt_u32 s32, 0x80000
 s_cselect_b64 vcc, vcc, 0
 s_cbranch_vccnz L_pollA
L_armed:
 v_and_b32 v28, 11, v0
 v_lshlrev_b32 v28, 2, v28
 s_mov_b32 s32, 0
L_poll0:
 buffer_load_dword v29, v28, s[12:15], s58 offen sc1
 s_waitcnt vmcnt(0)
 v_cmp_ne_u32 vcc, 0, v29
 s_cbranch_vccz L_poll0_ok
 s_sleep 8
 s_add_u32 s32, s32, 1
 s_cmp_lt_u32 s32, 0x80000
 s_cbranch_scc1 L_poll0
L_poll0_ok:
 s_mov_b32 m0, s40
 s_nop 0
 buffer_load_dwordx4 v1, s[12:15], s42 offen offset:0 sc1 lds
 buffer_load_dwordx4 v1, s[12:15], s42 offen offset:1024 sc1 lds
 buffer_load_dwordx4 v1, s[12:15], s42 offen offset:2048 sc1 lds
 buffer_load_dwordx4 v1, s[12:15], s42 offen offset:3072 sc1 lds
 s_bitset1_b32 m0, 12
 s_nop 0
 buffer_load_dwordx4 v4, s[12:15], s42 offen offset:0 sc1 lds
 buffer_load_dwordx4 v4, s[12:15], s42 offen offset:1024 sc1 lds
 buffer_load_dwordx4 v4, s[12:15], s42 offen offset:2048 sc1 lds
 buffer_load_dwordx4 v4, s[12:15], s42 offen offset:3072 sc1 lds
 s_add_u32 s42, s42, s70
 s_xor_b32 s40, s40, 0x8000
 s_mov_b32 m0, s40
 s_nop 0
 buffer_load_dwordx4 v1, s[12:15], s42 offen offset:0 sc1 lds
 buffer_load_dwordx4 v1, s[12:15], s42 offen offset:1024 sc1 lds
 buffer_load_dwordx4 v1, s[12:15], s42 offen offset:2048 sc1 lds
 buffer_load_dwordx4 v1, s[12:15], s42 offen offset:3072 sc1 lds
 s_bitset1_b32 m0, 12
 s_nop 0
 buffer_load_dwordx4 v4, s[12:15], s42 offen offset:0 sc1 lds
 buffer_load_dwordx4 v4, s[12:15], s42 offen offset:1024 sc1 lds
 buffer_load_dwordx4 v4, s[12:15], s42 offen offset:2048 sc1 lds
 buffer_load_dwordx4 v4, s[12:15], s42 offen offset:3072 sc1 lds
 s_add_u32 s42, s42, s70
 s_xor_b32 s40, s40, 0x8000
 s_branch L_kvok
L_rowchk:
 v_mov_b32 v16, v5
 v_mov_b32 v17, v6
 v_mov_b32 v18, v16
 v_mov_b32 v19, v17
 s_nop 0
 v_permlane32_swap_b32 v16, v18
 v_permlane32_swap_b32 v17, v19
 s_nop 0
 v_add_f32 v16, v16, v18
 v_add_f32 v17, v17, v19
 v_mov_b32 v18, v16
 v_mov_b32 v19, v17
 s_nop 0
 v_permlane16_swap_b32 v16, v18
 v_permlane16_swap_b32 v17, v19
 s_nop 0
 v_add_f32 v16, v16, v18
 v_add_f32 v17, v17, v19
 v_min_f32 v16, v16, v17
 v_cmp_gt_f32 vcc, 0x33800000, v16
 s_cbranch_vccz L_firstok
 s_branch L_slow2
L_slow:
 s_cmp_lg_u32 s47, 0x4b800000
 s_cbranch_scc1 L_switched
 s_nop 5
L_slow2:
 v_max3_f32 v11, v32, v33, v34
 v_max3_f32 v11, v11, v35, v40
 v_max3_f32 v11, v11, v41, v42
 v_max3_f32 v11, v11, v43, v48
 v_max3_f32 v11, v11, v49, v50
 v_max3_f32 v11, v11, v51, v56
 v_max3_f32 v11, v11, v57, v58
 v_max_f32 v11, v11, v59
 v_mov_b32 v16, v11
 s_nop 1
 v_permlane32_swap_b32 v11, v16
 s_nop 1
 v_max_f32 v11, v11, v16
 v_mov_b32 v16, v11
 s_nop 1
 v_permlane16_swap_b32 v11, v16
 s_nop 1
 v_max_f32 v11, v11, v16
 v_max_f32 v11, s46, v11
 v_sub_f32 v9, v9, v11
 v_sub_f32 v32, v32, v11
 v_sub_f32 v33, v33, v11
 v_sub_f32 v34, v34, v11
 v_sub_f32 v35, v35, v11
 v_sub_f32 v40, v40, v11
 v_sub_f32 v41, v41, v11
 v_sub_f32 v42, v42, v11
 v_sub_f32 v43, v43, v11
 v_sub_f32 v48, v48, v11
 v_sub_f32 v49, v49, v11
 v_sub_f32 v50, v50, v11
 v_sub_f32 v51, v51, v11
 v_sub_f32 v56, v56, v11
 v_sub_f32 v57, v57, v11
 v_sub_f32 v58, v58, v11
 v_sub_f32 v59, v59, v11
 v_exp_f32 v64, v32
 v_mov_b32 v96, v9
 v_exp_f32 v65, v33
 v_mov_b32 v97, v9
 v_exp_f32 v66, v34
 v_mov_b32 v98, v9
 v_exp_f32 v67, v35
 v_mov_b32 v99, v9
 v_exp_f32 v72, v40
 v_mov_b32 v104, v9
 v_exp_f32 v73, v41
 v_mov_b32 v105, v9
 v_exp_f32 v74, v42
 v_mov_b32 v106, v9
 v_exp_f32 v75, v43
 v_mov_b32 v107, v9
 v_exp_f32 v80, v48
 v_mov_b32 v112, v9
 v_exp_f32 v81, v49
 v_mov_b32 v113, v9
 v_exp_f32 v82, v50
 v_mov_b32 v114, v9
 v_exp_f32 v83, v51
 v_mov_b32 v115, v9
 v_exp_f32 v88, v56
 v_mov_b32 v120, v9
 v_exp_f32 v89, v57
 v_mov_b32 v121, v9
 v_exp_f32 v90, v58
 v_mov_b32 v122, v9
 v_exp_f32 v91, v59
 v_mov_b32 v123, v9
 v_add_f32 v5, v64, v65
 v_add_f32 v5, v5, v66
 v_add_f32 v5, v5, v67
 v_add_f32 v5, v5, v72
 v_add_f32 v5, v5, v73
 v_add_f32 v5, v5, v74
 v_add_f32 v5, v5, v75
 v_add_f32 v5, v5, v80
 v_add_f32 v5, v5, v81
 v_add_f32 v5, v5, v82
 v_add_f32 v5, v5, v83
 v_add_f32 v5, v5, v88
 v_add_f32 v5, v5, v89
 v_add_f32 v5, v5, v90
 v_add_f32 v5, v5, v91
 v_max3_f32 v12, v36, v37, v38
 v_max3_f32 v12, v12, v39, v44
 v_max3_f32 v12, v12, v45, v46
 v_max3_f32 v12, v12, v47, v52
 v_max3_f32 v12, v12, v53, v54
 v_max3_f32 v12, v12, v55, v60
 v_max3_f32 v12, v12, v61, v62
 v_max_f32 v12, v12, v63
 v_mov_b32 v16, v12
 s_nop 1
 v_permlane32_swap_b32 v12, v16
 s_nop 1
 v_max_f32 v12, v12, v16
 v_mov_b32 v16, v12
 s_nop 1
 v_permlane16_swap_b32 v12, v16
 s_nop 1
 v_max_f32 v12, v12, v16
 v_max_f32 v12, s46, v12
 v_sub_f32 v10, v10, v12
 v_sub_f32 v36, v36, v12
 v_sub_f32 v37, v37, v12
 v_sub_f32 v38, v38, v12
 v_sub_f32 v39, v39, v12
 v_sub_f32 v44, v44, v12
 v_sub_f32 v45, v45, v12
 v_sub_f32 v46, v46, v12
 v_sub_f32 v47, v47, v12
 v_sub_f32 v52, v52, v12
 v_sub_f32 v53, v53, v12
 v_sub_f32 v54, v54, v12
 v_sub_f32 v55, v55, v12
 v_sub_f32 v60, v60, v12
 v_sub_f32 v61, v61, v12
 v_sub_f32 v62, v62, v12
 v_sub_f32 v63, v63, v12
 v_exp_f32 v68, v36
 v_mov_b32 v100, v10
 v_exp_f32 v69, v37
 v_mov_b32 v101, v10
 v_exp_f32 v70, v38
 v_mov_b32 v102, v10
 v_exp_f32 v71, v39
 v_mov_b32 v103, v10
 v_exp_f32 v76, v44
 v_mov_b32 v108, v10
 v_exp_f32 v77, v45
 v_mov_b32 v109, v10
 v_exp_f32 v78, v46
 v_mov_b32 v110, v10
 v_exp_f32 v79, v47
 v_mov_b32 v111, v10
 v_exp_f32 v84, v52
 v_mov_b32 v116, v10
 v_exp_f32 v85, v53
 v_mov_b32 v117, v10
 v_exp_f32 v86, v54
 v_mov_b32 v118, v10
 v_exp_f32 v87, v55
 v_mov_b32 v119, v10
 v_exp_f32 v92, v60
 v_mov_b32 v124, v10
 v_exp_f32 v93, v61
 v_mov_b32 v125, v10
 v_exp_f32 v94, v62
 v_mov_b32 v126, v10
 v_exp_f32 v95, v63
 v_mov_b32 v127, v10
 v_add_f32 v6, v68, v69
 v_add_f32 v6, v6, v70
 v_add_f32 v6, v6, v71
 v_add_f32 v6, v6, v76
 v_add_f32 v6, v6, v77
 v_add_f32 v6, v6, v78
 v_add_f32 v6, v6, v79
 v_add_f32 v6, v6, v84
 v_add_f32 v6, v6, v85
 v_add_f32 v6, v6, v86
 v_add_f32 v6, v6, v87
 v_add_f32 v6, v6, v92
 v_add_f32 v6, v6, v93
 v_add_f32 v6, v6, v94
 v_add_f32 v6, v6, v95
 v_mov_b32 v16, 0xf149f2ca
 v_cmp_gt_i32 s[16:17], 0, v14
 v_cmp_gt_i32 s[18:19], 1, v14
 v_cmp_gt_i32 s[20:21], 2, v14
 v_cmp_gt_i32 s[22:23], 3, v14
 v_cndmask_b32 v20, v9, v16, s[16:17]
 v_cndmask_b32 v21, v9, v16, s[18:19]
 v_cndmask_b32 v22, v9, v16, s[20:21]
 v_cndmask_b32 v23, v9, v16, s[22:23]
 v_accvgpr_write_b32 a224, v20
 v_accvgpr_write_b32 a225, v21
 v_accvgpr_write_b32 a226, v22
 v_accvgpr_write_b32 a227, v23
 v_cmp_gt_i32 s[16:17], 16, v14
 v_cmp_gt_i32 s[18:19], 17, v14
 v_cmp_gt_i32 s[20:21], 18, v14
 v_cmp_gt_i32 s[22:23], 19, v14
 v_cndmask_b32 v20, v9, v16, s[16:17]
 v_cndmask_b32 v21, v9, v16, s[18:19]
 v_cndmask_b32 v22, v9, v16, s[20:21]
 v_cndmask_b32 v23, v9, v16, s[22:23]
 v_accvgpr_write_b32 a228, v20
 v_accvgpr_write_b32 a229, v21
 v_accvgpr_write_b32 a230, v22
 v_accvgpr_write_b32 a231, v23
 v_cmp_gt_i32 s[16:17], 32, v14
 v_cmp_gt_i32 s[18:19], 33, v14
 v_cmp_gt_i32 s[20:21], 34, v14
 v_cmp_gt_i32 s[22:23], 35, v14
 v_cndmask_b32 v20, v9, v16, s[16:17]
 v_cndmask_b32 v21, v9, v16, s[18:19]
 v_cndmask_b32 v22, v9, v16, s[20:21]
 v_cndmask_b32 v23, v9, v16, s[22:23]
 v_accvgpr_write_b32 a232, v20
 v_accvgpr_write_b32 a233, v21
 v_accvgpr_write_b32 a234, v22
 v_accvgpr_write_b32 a235, v23
 v_cmp_gt_i32 s[16:17], 48, v14
 v_cmp_gt_i32 s[18:19], 49, v14
 v_cmp_gt_i32 s[20:21], 50, v14
 v_cmp_gt_i32 s[22:23], 51, v14
 v_cndmask_b32 v20, v9, v16, s[16:17]
 v_cndmask_b32 v21, v9, v16, s[18:19]
 v_cndmask_b32 v22, v9, v16, s[20:21]
 v_cndmask_b32 v23, v9, v16, s[22:23]
 v_accvgpr_write_b32 a236, v20
 v_accvgpr_write_b32 a237, v21
 v_accvgpr_write_b32 a238, v22
 v_accvgpr_write_b32 a239, v23
 s_waitcnt lgkmcnt(0)
 s_cmp_lg_u32 s46, 0
 s_mov_b32 s46, 0
 s_cbranch_scc1 L_ret
 v_exp_f32 v11, -v11
 s_nop 0
 v_mul_f32 v7, v7, v11
 v_mul_f32 v128, v128, v11
 v_mul_f32 v129, v129, v11
 v_mul_f32 v130, v130, v11
 v_mul_f32 v131, v131, v11
 v_mul_f32 v132, v132, v11
 v_mul_f32 v133, v133, v11
 v_mul_f32 v134, v134, v11
 v_mul_f32 v135, v135, v11
 v_mul_f32 v136, v136, v11
 v_mul_f32 v137, v137, v11
 v_mul_f32 v138, v138, v11
 v_mul_f32 v139, v139, v11
 v_mul_f32 v140, v140, v11
 v_mul_f32 v141, v141, v11
 v_mul_f32 v142, v142, v11
 v_mul_f32 v143, v143, v11
 v_mul_f32 v144, v144, v11
 v_mul_f32 v145, v145, v11
 v_mul_f32 v146, v146, v11
 v_mul_f32 v147, v147, v11
 v_mul_f32 v148, v148, v11
 v_mul_f32 v149, v149, v11
 v_mul_f32 v150, v150, v11
 v_mul_f32 v151, v151, v11
 v_mul_f32 v152, v152, v11
 v_mul_f32 v153, v153, v11
 v_mul_f32 v154, v154, v11
 v_mul_f32 v155, v155, v11
 v_mul_f32 v156, v156, v11
 v_mul_f32 v157, v157, v11
 v_mul_f32 v158, v158, v11
 v_mul_f32 v159, v159, v11
 v_mul_f32 v160, v160, v11
 v_mul_f32 v161, v161, v11
 v_mul_f32 v162, v162, v11
 v_mul_f32 v163, v163, v11
 v_mul_f32 v164, v164, v11
 v_mul_f32 v165, v165, v11
 v_mul_f32 v166, v166, v11
 v_mul_f32 v167, v167, v11
 v_mul_f32 v168, v168, v11
 v_mul_f32 v169, v169, v11
 v_mul_f32 v170, v170, v11
 v_mul_f32 v171, v171, v11
 v_mul_f32 v172, v172, v11
 v_mul_f32 v173, v173, v11
 v_mul_f32 v174, v174, v11
 v_mul_f32 v175, v175, v11
 v_mul_f32 v176, v176, v11
 v_mul_f32 v177, v177, v11
 v_mul_f32 v178, v178, v11
 v_mul_f32 v179, v179, v11
 v_mul_f32 v180, v180, v11
 v_mul_f32 v181, v181, v11
 v_mul_f32 v182, v182, v11
 v_mul_f32 v183, v183, v11
 v_mul_f32 v184, v184, v11
 v_mul_f32 v185, v185, v11
 v_mul_f32 v186, v186, v11
 v_mul_f32 v187, v187, v11
 v_mul_f32 v188, v188, v11
 v_mul_f32 v189, v189, v11
 v_mul_f32 v190, v190, v11
 v_mul_f32 v191, v191, v11
 v_exp_f32 v12, -v12
 s_nop 0
 v_mul_f32 v8, v8, v12
 v_mul_f32 v192, v192, v12
 v_mul_f32 v193, v193, v12
 v_mul_f32 v194, v194, v12
 v_mul_f32 v195, v195, v12
 v_mul_f32 v196, v196, v12
 v_mul_f32 v197, v197, v12
 v_mul_f32 v198, v198, v12
 v_mul_f32 v199, v199, v12
 v_mul_f32 v200, v200, v12
 v_mul_f32 v201, v201, v12
 v_mul_f32 v202, v202, v12
 v_mul_f32 v203, v203, v12
 v_mul_f32 v204, v204, v12
 v_mul_f32 v205, v205, v12
 v_mul_f32 v206, v206, v12
 v_mul_f32 v207, v207, v12
 v_mul_f32 v208, v208, v12
 v_mul_f32 v209, v209, v12
 v_mul_f32 v210, v210, v12
 v_mul_f32 v211, v211, v12
 v_mul_f32 v212, v212, v12
 v_mul_f32 v213, v213, v12
 v_mul_f32 v214, v214, v12
 v_mul_f32 v215, v215, v12
 v_mul_f32 v216, v216, v12
 v_mul_f32 v217, v217, v12
 v_mul_f32 v218, v218, v12
 v_mul_f32 v219, v219, v12
 v_mul_f32 v220, v220, v12
 v_mul_f32 v221, v221, v12
 v_mul_f32 v222, v222, v12
 v_mul_f32 v223, v223, v12
 v_mul_f32 v224, v224, v12
 v_mul_f32 v225, v225, v12
 v_mul_f32 v226, v226, v12
 v_mul_f32 v227, v227, v12
 v_mul_f32 v228, v228, v12
 v_mul_f32 v229, v229, v12
 v_mul_f32 v230, v230, v12
 v_mul_f32 v231, v231, v12
 v_mul_f32 v232, v232, v12
 v_mul_f32 v233, v233, v12
 v_mul_f32 v234, v234, v12
 v_mul_f32 v235, v235, v12
 v_mul_f32 v236, v236, v12
 v_mul_f32 v237, v237, v12
 v_mul_f32 v238, v238, v12
 v_mul_f32 v239, v239, v12
 v_mul_f32 v240, v240, v12
 v_mul_f32 v241, v241, v12
 v_mul_f32 v242, v242, v12
 v_mul_f32 v243, v243, v12
 v_mul_f32 v244, v244, v12
 v_mul_f32 v245, v245, v12
 v_mul_f32 v246, v246, v12
 v_mul_f32 v247, v247, v12
 v_mul_f32 v248, v248, v12
 v_mul_f32 v249, v249, v12
 v_mul_f32 v250, v250, v12
 v_mul_f32 v251, v251, v12
 v_mul_f32 v252, v252, v12
 v_mul_f32 v253, v253, v12
 v_mul_f32 v254, v254, v12
 v_mul_f32 v255, v255, v12
 s_branch L_ret
L_ret:
 s_cmp_gt_u32 s44, s45
 s_cbranch_scc1 L_loop
 s_branch L_ret2
L_disp:
 s_cmp_lt_u32 s44, 2
 s_cbranch_scc1 L_d1
 s_waitcnt vmcnt(0)
 v_accvgpr_read_b32 v12, a246
 v_cmp_ne_u32 vcc, 0, v12
 s_cbranch_vccz L_poll2_ok
 v_and_b32 v11, 11, v0
 v_lshlrev_b32 v11, 2, v11
 s_mov_b32 s32, 0
L_poll2:
 buffer_load_dword v12, v11, s[12:15], s60 offen sc1
 s_waitcnt vmcnt(0)
 v_cmp_ne_u32 vcc, 0, v12
 s_cbranch_vccz L_poll2_ok
 s_sleep 8
 s_add_u32 s32, s32, 1
 s_cmp_lt_u32 s32, 0x80000
 s_cbranch_scc1 L_poll2
L_poll2_ok:
 s_cmp_eq_u32 s38, 0
 s_cselect_b32 s60, s60, s94
 v_mov_b32 v15, 0
 s_mov_b32 s45, 2
 s_branch L_loop
L_d1:
 s_cmp_eq_u32 s54, 1
 s_cbranch_scc1 L_seg2
 s_cmp_eq_u32 s44, 0
 s_cbranch_scc1 L_p2
 s_cmp_eq_u32 s53, 0
 s_cbranch_scc1 L_g0y
 s_mov_b32 s53, 0
 s_add_u32 s52, s50, 131072
 s_mul_i32 s58, s3, 50176
 s_sub_u32 s58, 128, s58
 s_cmp_eq_u32 s7, 0
 s_cselect_b32 s42, s78, s49
 s_cmov_b32 s40, s52
 s_cmov_b64 s[8:9], s[86:87]
 s_cmov_b32 s10, 3670016
 s_cmov_b32 s76, 6144
 s_cmov_b32 s77, 10240
 s_mov_b32 s44, 1
 s_waitcnt vmcnt(0)
 s_barrier
 ds_read_b128 a[96:99], v3 offset:0
 ds_read_b128 a[100:103], v3 offset:16384
 ds_read_b128 a[104:107], v3 offset:1024
 ds_read_b128 a[108:111], v3 offset:17408
 ds_read_b128 a[112:115], v3 offset:2048
 ds_read_b128 a[116:119], v3 offset:18432
 s_branch L_g0y
L_g0x:
 v_cmp_nge_f32 vcc, s47, v11
 s_cbranch_vccnz L_slow
L_g0y:
 v_mov_b32 v16, 0xf149f2ca
 v_cmp_gt_i32 s[16:17], 0, v14
 v_cmp_gt_i32 s[18:19], 1, v14
 v_cmp_gt_i32 s[20:21], 2, v14
 v_cmp_gt_i32 s[22:23], 3, v14
 v_cndmask_b32 v100, v10, v16, s[16:17]
 v_cndmask_b32 v101, v10, v16, s[18:19]
 v_cndmask_b32 v102, v10, v16, s[20:21]
 v_cndmask_b32 v103, v10, v16, s[22:23]
 v_cmp_gt_i32 s[16:17], 16, v14
 v_cmp_gt_i32 s[18:19], 17, v14
 v_cmp_gt_i32 s[20:21], 18, v14
 v_cmp_gt_i32 s[22:23], 19, v14
 v_cndmask_b32 v108, v10, v16, s[16:17]
 v_cndmask_b32 v109, v10, v16, s[18:19]
 v_cndmask_b32 v110, v10, v16, s[20:21]
 v_cndmask_b32 v111, v10, v16, s[22:23]
 v_cmp_gt_i32 s[16:17], 32, v14
 v_cmp_gt_i32 s[18:19], 33, v14
 v_cmp_gt_i32 s[20:21], 34, v14
 v_cmp_gt_i32 s[22:23], 35, v14
 v_cndmask_b32 v116, v10, v16, s[16:17]
 v_cndmask_b32 v117, v10, v16, s[18:19]
 v_cndmask_b32 v118, v10, v16, s[20:21]
 v_cndmask_b32 v119, v10, v16, s[22:23]
 v_cmp_gt_i32 s[16:17], 48, v14
 v_cmp_gt_i32 s[18:19], 49, v14
 v_cmp_gt_i32 s[20:21], 50, v14
 v_cmp_gt_i32 s[22:23], 51, v14
 v_cndmask_b32 v124, v10, v16, s[16:17]
 v_cndmask_b32 v125, v10, v16, s[18:19]
 v_cndmask_b32 v126, v10, v16, s[20:21]
 v_cndmask_b32 v127, v10, v16, s[22:23]
 s_waitcnt lgkmcnt(0)
 s_cmp_eq_u32 s51, 1
 s_cbranch_scc1 L_p1
 s_cmp_eq_u32 s7, 0
 s_cbranch_scc1 L_g0z
 v_and_b32 v11, 0, v0
 v_lshlrev_b32 v11, 2, v11
 s_mov_b32 s32, 0
L_poll3:
 buffer_load_dword v12, v11, s[12:15], s60 offen sc1
 s_waitcnt vmcnt(0)
 v_cmp_ne_u32 vcc, 0, v12
 s_cbranch_vccz L_poll3_ok
 s_sleep 1
 s_add_u32 s32, s32, 1
 s_cmp_lt_u32 s32, 0x80000
 s_cbranch_scc1 L_poll3
L_poll3_ok:
 s_branch L_g0w
L_g0z:
 buffer_load_dword v12, v15, s[12:15], s60 offen sc1
 s_waitcnt vmcnt(0)
 v_cmp_ne_u32 vcc, 0, v12
L_g0w:
 s_cmp_eq_u64 vcc, 0
 s_cselect_b32 s51, 1, 0
 s_cselect_b32 s55, s4, 2.0
 s_cselect_b32 s56, s5, 2.0
 s_cselect_b32 s57, s6, 2.0
 buffer_load_dwordx4 a[192:195], v1, s[12:15], s57 offen sc1
 buffer_load_dwordx4 a[128:131], v1, s[12:15], s55 offen offset:0 sc1
 buffer_load_dwordx4 a[132:135], v1, s[12:15], s55 offen offset:1024 sc1
 buffer_load_dwordx4 a[136:139], v1, s[12:15], s55 offen offset:2048 sc1
 buffer_load_dwordx4 a[140:143], v1, s[12:15], s55 offen offset:3072 sc1
 buffer_load_dwordx4 a[144:147], v4, s[12:15], s55 offen offset:0 sc1
 buffer_load_dwordx4 a[148:151], v4, s[12:15], s55 offen offset:1024 sc1
 buffer_load_dwordx4 a[152:155], v4, s[12:15], s55 offen offset:2048 sc1
 buffer_load_dwordx4 a[156:159], v4, s[12:15], s55 offen offset:3072 sc1
 s_branch L_p1
L_seg2:
 s_cmp_eq_u32 s44, 0
 s_cbranch_scc1 L_tail
L_last:
 v_and_b32 v11, 31, v0
 v_lshlrev_b32 v11, 2, v11
 buffer_load_dword a247, v11, s[12:15], s61 offen sc1
 v_accvgpr_read_b32 v13, a241
 s_mov_b64 s[8:9], s[86:87]
 s_mov_b32 s10, 3670016
 s_mov_b32 s42, s78
 s_add_u32 s40, s50, 131072
 s_movk_i32 s76, 6144
 s_movk_i32 s77, 10240
 s_branch L_loop
L_switch:
 v_accvgpr_mov_b32 a32, a128
 v_accvgpr_mov_b32 a33, a129
 v_accvgpr_mov_b32 a34, a130
 v_accvgpr_mov_b32 a35, a131
 v_accvgpr_mov_b32 a36, a132
 v_accvgpr_mov_b32 a37, a133
 v_accvgpr_mov_b32 a38, a134
 v_accvgpr_mov_b32 a39, a135
 v_accvgpr_mov_b32 a40, a136
 v_accvgpr_mov_b32 a41, a137
 v_accvgpr_mov_b32 a42, a138
 v_accvgpr_mov_b32 a43, a139
 v_accvgpr_mov_b32 a44, a140
 v_accvgpr_mov_b32 a45, a141
 v_accvgpr_mov_b32 a46, a142
 v_accvgpr_mov_b32 a47, a143
 v_accvgpr_mov_b32 a48, a144
 v_accvgpr_mov_b32 a49, a145
 v_accvgpr_mov_b32 a50, a146
 v_accvgpr_mov_b32 a51, a147
 v_accvgpr_mov_b32 a52, a148
 v_accvgpr_mov_b32 a53, a149
 v_accvgpr_mov_b32 a54, a150
 v_accvgpr_mov_b32 a55, a151
 v_accvgpr_mov_b32 a56, a152
 v_accvgpr_mov_b32 a57, a153
 v_accvgpr_mov_b32 a58, a154
 v_accvgpr_mov_b32 a59, a155
 v_accvgpr_mov_b32 a60, a156
 v_accvgpr_mov_b32 a61, a157
 v_accvgpr_mov_b32 a62, a158
 v_accvgpr_mov_b32 a63, a159
 v_mov_b64 v[96:97], 0
 v_mov_b64 v[98:99], 0
 v_mov_b64 v[100:101], 0
 v_mov_b64 v[102:103], 0
 v_mov_b64 v[104:105], 0
 v_mov_b64 v[106:107], 0
 v_mov_b64 v[108:109], 0
 v_mov_b64 v[110:111], 0
 v_mov_b64 v[112:113], 0
 v_mov_b64 v[114:115], 0
 v_mov_b64 v[116:117], 0
 v_mov_b64 v[118:119], 0
 v_mov_b64 v[120:121], 0
 v_mov_b64 v[122:123], 0
 v_mov_b64 v[124:125], 0
 v_mov_b64 v[126:127], 0
 v_mov_b64 v[64:65], 0
 v_mov_b64 v[66:67], 0
 v_mov_b64 v[72:73], 0
 v_mov_b64 v[74:75], 0
 v_mov_b64 v[80:81], 0
 v_mov_b64 v[82:83], 0
 v_mov_b64 v[88:89], 0
 v_mov_b64 v[90:91], 0
 v_mov_b32 v5, 0
 s_add_u32 s42, s49, 32768
 s_xor_b32 s40, s40, 0x8000
 s_xor_b32 s41, s41, 0x8000
 s_add_u32 s43, s49, 16777216
 s_mov_b32 s44, s38
 s_mov_b32 s45, 1
 s_mov_b32 s47, -1.0
 s_waitcnt vmcnt(8) lgkmcnt(0)
 s_cmp_eq_u32 s38, 1
 s_cbranch_scc1 L_last
 s_branch L_loop
L_switched:
 v_mov_b32 v18, v7
 v_mov_b32 v19, v8
 s_nop 0
 v_permlane32_swap_b32 v7, v18
 v_permlane32_swap_b32 v8, v19
 s_nop 0
 v_add_f32 v7, v7, v18
 v_add_f32 v8, v8, v19
 s_nop 0
 v_mov_b32 v18, v7
 v_mov_b32 v19, v8
 s_nop 0
 v_permlane16_swap_b32 v7, v18
 v_permlane16_swap_b32 v8, v19
 s_nop 0
 v_add_f32 v7, v7, v18
 v_add_f32 v8, v8, v19
 s_nop 0
 v_rcp_f32 v16, v7
 v_rcp_f32 v17, v8
 s_mov_b32 s47, 0x4b800000
 s_mov_b32 s54, 1
 v_accvgpr_write_b32 a200, v16
 v_cvt_pk_bf16_f32 v128, v128, v129
 v_cvt_pk_bf16_f32 v129, v130, v131
 v_cvt_pk_bf16_f32 v130, v132, v133
 v_cvt_pk_bf16_f32 v131, v134, v135
 v_accvgpr_write_b32 a128, v128
 v_accvgpr_write_b32 a129, v129
 v_accvgpr_write_b32 a130, v130
 v_accvgpr_write_b32 a131, v131
 v_cvt_pk_bf16_f32 v136, v136, v137
 v_cvt_pk_bf16_f32 v137, v138, v139
 v_cvt_pk_bf16_f32 v138, v140, v141
 v_cvt_pk_bf16_f32 v139, v142, v143
 v_accvgpr_write_b32 a132, v136
 v_accvgpr_write_b32 a133, v137
 v_accvgpr_write_b32 a134, v138
 v_accvgpr_write_b32 a135, v139
 v_cvt_pk_bf16_f32 v144, v144, v145
 v_cvt_pk_bf16_f32 v145, v146, v147
 v_cvt_pk_bf16_f32 v146, v148, v149
 v_cvt_pk_bf16_f32 v147, v150, v151
 v_accvgpr_write_b32 a136, v144
 v_accvgpr_write_b32 a137, v145
 v_accvgpr_write_b32 a138, v146
 v_accvgpr_write_b32 a139, v147
 v_cvt_pk_bf16_f32 v152, v152, v153
 v_cvt_pk_bf16_f32 v153, v154, v155
 v_cvt_pk_bf16_f32 v154, v156, v157
 v_cvt_pk_bf16_f32 v155, v158, v159
 v_accvgpr_write_b32 a140, v152
 v_accvgpr_write_b32 a141, v153
 v_accvgpr_write_b32 a142, v154
 v_accvgpr_write_b32 a143, v155
 v_cvt_pk_bf16_f32 v160, v160, v161
 v_cvt_pk_bf16_f32 v161, v162, v163
 v_cvt_pk_bf16_f32 v162, v164, v165
 v_cvt_pk_bf16_f32 v163, v166, v167
 v_accvgpr_write_b32 a144, v160
 v_accvgpr_write_b32 a145, v161
 v_accvgpr_write_b32 a146, v162
 v_accvgpr_write_b32 a147, v163
 v_cvt_pk_bf16_f32 v168, v168, v169
 v_cvt_pk_bf16_f32 v169, v170, v171
 v_cvt_pk_bf16_f32 v170, v172, v173
 v_cvt_pk_bf16_f32 v171, v174, v175
 v_accvgpr_write_b32 a148, v168
 v_accvgpr_write_b32 a149, v169
 v_accvgpr_write_b32 a150, v170
 v_accvgpr_write_b32 a151, v171
 v_cvt_pk_bf16_f32 v176, v176, v177
 v_cvt_pk_bf16_f32 v177, v178, v179
 v_cvt_pk_bf16_f32 v178, v180, v181
 v_cvt_pk_bf16_f32 v179, v182, v183
 v_accvgpr_write_b32 a152, v176
 v_accvgpr_write_b32 a153, v177
 v_accvgpr_write_b32 a154, v178
 v_accvgpr_write_b32 a155, v179
 v_cvt_pk_bf16_f32 v184, v184, v185
 v_cvt_pk_bf16_f32 v185, v186, v187
 v_cvt_pk_bf16_f32 v186, v188, v189
 v_cvt_pk_bf16_f32 v187, v190, v191
 v_accvgpr_write_b32 a156, v184
 v_accvgpr_write_b32 a157, v185
 v_accvgpr_write_b32 a158, v186
 v_accvgpr_write_b32 a159, v187
 v_accvgpr_write_b32 a201, v17
 v_cvt_pk_bf16_f32 v192, v192, v193
 v_cvt_pk_bf16_f32 v193, v194, v195
 v_cvt_pk_bf16_f32 v194, v196, v197
 v_cvt_pk_bf16_f32 v195, v198, v199
 v_accvgpr_write_b32 a160, v192
 v_accvgpr_write_b32 a161, v193
 v_accvgpr_write_b32 a162, v194
 v_accvgpr_write_b32 a163, v195
 v_cvt_pk_bf16_f32 v200, v200, v201
 v_cvt_pk_bf16_f32 v201, v202, v203
 v_cvt_pk_bf16_f32 v202, v204, v205
 v_cvt_pk_bf16_f32 v203, v206, v207
 v_accvgpr_write_b32 a164, v200
 v_accvgpr_write_b32 a165, v201
 v_accvgpr_write_b32 a166, v202
 v_accvgpr_write_b32 a167, v203
 v_cvt_pk_bf16_f32 v208, v208, v209
 v_cvt_pk_bf16_f32 v209, v210, v211
 v_cvt_pk_bf16_f32 v210, v212, v213
 v_cvt_pk_bf16_f32 v211, v214, v215
 v_accvgpr_write_b32 a168, v208
 v_accvgpr_write_b32 a169, v209
 v_accvgpr_write_b32 a170, v210
 v_accvgpr_write_b32 a171, v211
 v_cvt_pk_bf16_f32 v216, v216, v217
 v_cvt_pk_bf16_f32 v217, v218, v219
 v_cvt_pk_bf16_f32 v218, v220, v221
 v_cvt_pk_bf16_f32 v219, v222, v223
 v_accvgpr_write_b32 a172, v216
 v_accvgpr_write_b32 a173, v217
 v_accvgpr_write_b32 a174, v218
 v_accvgpr_write_b32 a175, v219
 v_cvt_pk_bf16_f32 v224, v224, v225
 v_cvt_pk_bf16_f32 v225, v226, v227
 v_cvt_pk_bf16_f32 v226, v228, v229
 v_cvt_pk_bf16_f32 v227, v230, v231
 v_accvgpr_write_b32 a176, v224
 v_accvgpr_write_b32 a177, v225
 v_accvgpr_write_b32 a178, v226
 v_accvgpr_write_b32 a179, v227
 v_cvt_pk_bf16_f32 v232, v232, v233
 v_cvt_pk_bf16_f32 v233, v234, v235
 v_cvt_pk_bf16_f32 v234, v236, v237
 v_cvt_pk_bf16_f32 v235, v238, v239
 v_accvgpr_write_b32 a180, v232
 v_accvgpr_write_b32 a181, v233
 v_accvgpr_write_b32 a182, v234
 v_accvgpr_write_b32 a183, v235
 v_cvt_pk_bf16_f32 v240, v240, v241
 v_cvt_pk_bf16_f32 v241, v242, v243
 v_cvt_pk_bf16_f32 v242, v244, v245
 v_cvt_pk_bf16_f32 v243, v246, v247
 v_accvgpr_write_b32 a184, v240
 v_accvgpr_write_b32 a185, v241
 v_accvgpr_write_b32 a186, v242
 v_accvgpr_write_b32 a187, v243
 v_cvt_pk_bf16_f32 v248, v248, v249
 v_cvt_pk_bf16_f32 v249, v250, v251
 v_cvt_pk_bf16_f32 v250, v252, v253
 v_cvt_pk_bf16_f32 v251, v254, v255
 v_accvgpr_write_b32 a188, v248
 v_accvgpr_write_b32 a189, v249
 v_accvgpr_write_b32 a190, v250
 v_accvgpr_write_b32 a191, v251
 v_mov_b64 v[128:129], 0
 v_mov_b64 v[130:131], 0
 v_mov_b64 v[132:133], 0
 v_mov_b64 v[134:135], 0
 v_mov_b64 v[136:137], 0
 v_mov_b64 v[138:139], 0
 v_mov_b64 v[140:141], 0
 v_mov_b64 v[142:143], 0
 v_mov_b64 v[144:145], 0
 v_mov_b64 v[146:147], 0
 v_mov_b64 v[148:149], 0
 v_mov_b64 v[150:151], 0
 v_mov_b64 v[152:153], 0
 v_mov_b64 v[154:155], 0
 v_mov_b64 v[156:157], 0
 v_mov_b64 v[158:159], 0
 v_mov_b64 v[160:161], 0
 v_mov_b64 v[162:163], 0
 v_mov_b64 v[164:165], 0
 v_mov_b64 v[166:167], 0
 v_mov_b64 v[168:169], 0
 v_mov_b64 v[170:171], 0
 v_mov_b64 v[172:173], 0
 v_mov_b64 v[174:175], 0
 v_mov_b64 v[176:177], 0
 v_mov_b64 v[178:179], 0
 v_mov_b64 v[180:181], 0
 v_mov_b64 v[182:183], 0
 v_mov_b64 v[184:185], 0
 v_mov_b64 v[186:187], 0
 v_mov_b64 v[188:189], 0
 v_mov_b64 v[190:191], 0
 v_mov_b64 v[192:193], 0
 v_mov_b64 v[194:195], 0
 v_mov_b64 v[196:197], 0
 v_mov_b64 v[198:199], 0
 v_mov_b64 v[200:201], 0
 v_mov_b64 v[202:203], 0
 v_mov_b64 v[204:205], 0
 v_mov_b64 v[206:207], 0
 v_mov_b64 v[208:209], 0
 v_mov_b64 v[210:211], 0
 v_mov_b64 v[212:213], 0
 v_mov_b64 v[214:215], 0
 v_mov_b64 v[216:217], 0
 v_mov_b64 v[218:219], 0
 v_mov_b64 v[220:221], 0
 v_mov_b64 v[222:223], 0
 v_mov_b64 v[224:225], 0
 v_mov_b64 v[226:227], 0
 v_mov_b64 v[228:229], 0
 v_mov_b64 v[230:231], 0
 v_mov_b64 v[232:233], 0
 v_mov_b64 v[234:235], 0
 v_mov_b64 v[236:237], 0
 v_mov_b64 v[238:239], 0
 v_mov_b64 v[240:241], 0
 v_mov_b64 v[242:243], 0
 v_mov_b64 v[244:245], 0
 v_mov_b64 v[246:247], 0
 v_mov_b64 v[248:249], 0
 v_mov_b64 v[250:251], 0
 v_mov_b64 v[252:253], 0
 v_mov_b64 v[254:255], 0
 v_mov_b32 v7, 0
 v_mov_b32 v8, 0
 v_mov_b32 v9, 0
 v_mov_b32 v10, 0
 s_branch L_first
L_fagen:
 v_mov_b32 v5, 0
 buffer_load_dword a246, v15, s[12:15], s60 offen sc1
 v_mov_b32 v64, 0
 v_mov_b32 v65, 0
 v_mov_b32 v66, 0
 v_mov_b32 v67, 0
 v_mov_b32 v72, 0
 v_mov_b32 v73, 0
 v_mov_b32 v74, 0
 v_mov_b32 v75, 0
 v_mov_b32 v80, 0
 v_mov_b32 v81, 0
 v_mov_b32 v82, 0
 v_mov_b32 v83, 0
 v_mov_b32 v88, 0
 v_mov_b32 v89, 0
 v_mov_b32 v90, 0
 v_mov_b32 v91, 0
L_tail:
 s_and_b32 s55, s2, 127
 s_lshl_b32 s57, s55, 2
 s_add_u32 s57, s57, s3
 s_mul_i32 s55, s57, 17408
 s_add_u32 s55, s55, 67108864
 s_lshl_b32 s57, s57, 10
 s_add_u32 s57, s57, 83886080
 s_mul_i32 s58, s3, 50176
 s_sub_u32 s58, 128, s58
 v_add_u32 v2, s58, v13
 v_cvt_pk_bf16_f32 v16, v64, v65
 v_cvt_pk_bf16_f32 v17, v66, v67
 v_cvt_pk_bf16_f32 v20, v68, v69
 v_cvt_pk_bf16_f32 v21, v70, v71
 v_cvt_pk_bf16_f32 v18, v72, v73
 v_cvt_pk_bf16_f32 v19, v74, v75
 v_cvt_pk_bf16_f32 v22, v76, v77
 v_cvt_pk_bf16_f32 v23, v78, v79
 v_cvt_pk_bf16_f32 v24, v80, v81
 v_cvt_pk_bf16_f32 v25, v82, v83
 v_cvt_pk_bf16_f32 v28, v84, v85
 v_cvt_pk_bf16_f32 v29, v86, v87
 v_cvt_pk_bf16_f32 v26, v88, v89
 v_cvt_pk_bf16_f32 v27, v90, v91
 v_cvt_pk_bf16_f32 v30, v92, v93
 v_cvt_pk_bf16_f32 v31, v94, v95
 v_add_f32 v7, v7, v5
 v_add_f32 v8, v8, v6
 s_waitcnt vmcnt(0) lgkmcnt(0)
 s_barrier
 ds_read_b128 a[64:67], v3 offset:0
 ds_read_b128 a[68:71], v3 offset:16384
 ds_read_b128 a[72:75], v3 offset:1024
 ds_read_b128 a[76:79], v3 offset:17408
 ds_read_b128 a[80:83], v3 offset:2048
 ds_read_b128 a[84:87], v3 offset:18432
 ds_read_b128 a[88:91], v3 offset:3072
 ds_read_b128 a[92:95], v3 offset:19456
 s_cmp_lg_u32 s38, 0
 s_cselect_b32 s58, s54, 0
 s_cmp_eq_u32 s58, 2
 s_cbranch_scc1 L_tail2
 s_cmp_eq_u32 s62, 0
 s_cbranch_scc1 L_nou
 v_accvgpr_read_b32 v12, a247
 v_cmp_ne_u32 vcc, 0, v12
 s_cbranch_vccz L_poll4_ok
 v_and_b32 v11, 31, v0
 v_lshlrev_b32 v11, 2, v11
 s_mov_b32 s32, 0
L_poll4:
 buffer_load_dword v12, v11, s[12:15], s61 offen sc1
 s_waitcnt vmcnt(0)
 v_cmp_ne_u32 vcc, 0, v12
 s_cbranch_vccz L_poll4_ok
 s_sleep 8
 s_add_u32 s32, s32, 1
 s_cmp_lt_u32 s32, 0x80000
 s_cbranch_scc1 L_poll4
L_poll4_ok:
L_nou:
 s_cmp_eq_u32 s54, 1
 s_cselect_b32 s55, s55, 2.0
 s_cselect_b32 s57, s57, 2.0
 s_cselect_b32 s59, s94, 2.0
 s_add_u32 s56, s55, 0x2000
 s_waitcnt lgkmcnt(0)
 v_mfma_f32_16x16x32_bf16 v[128:131], a[64:67], v[16:19], v[128:131]
 s_add_u32 m0, s29, 0
 ds_read_b128 a[96:99], v3 offset:4096
 v_mov_b32 v72, v7
 v_mfma_f32_16x16x32_bf16 v[128:131], a[68:71], v[24:27], v[128:131]
 buffer_load_dwordx4 v2, s[8:11], s78 offen lds
 v_mfma_f32_16x16x32_bf16 v[192:195], a[68:71], v[28:31], v[192:195]
 ds_read_b128 a[100:103], v3 offset:20480
 v_mov_b32 v73, v8
 v_mfma_f32_16x16x32_bf16 v[192:195], a[64:67], v[20:23], v[192:195]
 v_permlane32_swap_b32 v7, v72
 v_permlane32_swap_b32 v8, v73
 v_mfma_f32_16x16x32_bf16 v[132:135], a[72:75], v[16:19], v[132:135]
 s_add_u32 m0, s29, 4096
 ds_read_b128 a[104:107], v3 offset:5120
 v_mfma_f32_16x16x32_bf16 v[132:135], a[76:79], v[24:27], v[132:135]
 buffer_load_dwordx4 v2, s[8:11], s79 offen lds
 v_mfma_f32_16x16x32_bf16 v[196:199], a[76:79], v[28:31], v[196:199]
 ds_read_b128 a[108:111], v3 offset:21504
 v_add_f32 v7, v7, v72
 v_mfma_f32_16x16x32_bf16 v[196:199], a[72:75], v[20:23], v[196:199]
 v_add_f32 v8, v8, v73
 v_mfma_f32_16x16x32_bf16 v[136:139], a[80:83], v[16:19], v[136:139]
 s_add_u32 m0, s29, 8192
 ds_read_b128 a[112:115], v3 offset:6144
 v_mov_b32 v72, v7
 v_mfma_f32_16x16x32_bf16 v[136:139], a[84:87], v[24:27], v[136:139]
 buffer_load_dwordx4 v2, s[8:11], s80 offen lds
 v_mfma_f32_16x16x32_bf16 v[200:203], a[84:87], v[28:31], v[200:203]
 s_add_u32 m0, s29, 12288
 ds_read_b128 a[116:119], v3 offset:22528
 v_mov_b32 v73, v8
 v_mfma_f32_16x16x32_bf16 v[200:203], a[80:83], v[20:23], v[200:203]
 buffer_load_dwordx4 v2, s[8:11], s81 offen lds
 v_mfma_f32_16x16x32_bf16 v[140:143], a[88:91], v[16:19], v[140:143]
 s_add_u32 m0, s29, 16384
 ds_read_b128 a[120:123], v3 offset:7168
 v_mfma_f32_16x16x32_bf16 v[140:143], a[92:95], v[24:27], v[140:143]
 buffer_load_dwordx4 v2, s[8:11], s82 offen lds
 v_mfma_f32_16x16x32_bf16 v[204:207], a[92:95], v[28:31], v[204:207]
 ds_read_b128 a[124:127], v3 offset:23552
 v_permlane16_swap_b32 v7, v72
 v_mfma_f32_16x16x32_bf16 v[204:207], a[88:91], v[20:23], v[204:207]
 s_waitcnt lgkmcnt(6)
 v_permlane16_swap_b32 v8, v73
 v_cvt_pk_bf16_f32 v128, v128, v129
 v_mfma_f32_16x16x32_bf16 v[144:147], a[96:99], v[16:19], v[144:147]
 s_add_u32 m0, s29, 20480
 ds_read_b128 a[64:67], v3 offset:8192
 v_cvt_pk_bf16_f32 v129, v130, v131
 v_mfma_f32_16x16x32_bf16 v[144:147], a[100:103], v[24:27], v[144:147]
 buffer_load_dwordx4 v2, s[8:11], s83 offen lds
 v_mfma_f32_16x16x32_bf16 v[208:211], a[100:103], v[28:31], v[208:211]
 s_add_u32 m0, s29, 24576
 ds_read_b128 a[68:71], v3 offset:24576
 v_add_f32 v7, v7, v72
 v_mfma_f32_16x16x32_bf16 v[208:211], a[96:99], v[20:23], v[208:211]
 s_waitcnt lgkmcnt(6)
 buffer_load_dwordx4 v2, s[8:11], s84 offen lds
 v_mfma_f32_16x16x32_bf16 v[148:151], a[104:107], v[16:19], v[148:151]
 s_add_u32 m0, s29, 28672
 ds_read_b128 a[72:75], v3 offset:9216
 v_add_f32 v8, v8, v73
 v_mfma_f32_16x16x32_bf16 v[148:151], a[108:111], v[24:27], v[148:151]
 buffer_load_dwordx4 v2, s[8:11], s85 offen lds
 v_mfma_f32_16x16x32_bf16 v[212:215], a[108:111], v[28:31], v[212:215]
 ds_read_b128 a[76:79], v3 offset:25600
 v_add_u32 v2, 128, v2
 v_mfma_f32_16x16x32_bf16 v[212:215], a[104:107], v[20:23], v[212:215]
 s_waitcnt lgkmcnt(6)
 v_cvt_pk_bf16_f32 v130, v132, v133
 v_cvt_pk_bf16_f32 v131, v134, v135
 v_mfma_f32_16x16x32_bf16 v[152:155], a[112:115], v[16:19], v[152:155]
 ds_read_b128 a[80:83], v3 offset:10240
 v_cvt_pk_bf16_f32 v192, v192, v193
 v_mfma_f32_16x16x32_bf16 v[152:155], a[116:119], v[24:27], v[152:155]
 buffer_store_dwordx4 v[128:131], v1, s[12:15], s55 offen offset:0 sc1
 v_mfma_f32_16x16x32_bf16 v[216:219], a[116:119], v[28:31], v[216:219]
 ds_read_b128 a[84:87], v3 offset:26624
 v_cvt_pk_bf16_f32 v193, v194, v195
 v_mfma_f32_16x16x32_bf16 v[216:219], a[112:115], v[20:23], v[216:219]
 s_waitcnt lgkmcnt(6)
 v_cvt_pk_bf16_f32 v194, v196, v197
 v_cvt_pk_bf16_f32 v195, v198, v199
 v_mfma_f32_16x16x32_bf16 v[156:159], a[120:123], v[16:19], v[156:159]
 ds_read_b128 a[88:91], v3 offset:11264
 v_cvt_pk_bf16_f32 v136, v136, v137
 v_mfma_f32_16x16x32_bf16 v[156:159], a[124:127], v[24:27], v[156:159]
 buffer_store_dwordx4 v[192:195], v1, s[12:15], s56 offen offset:0 sc1
 v_mfma_f32_16x16x32_bf16 v[220:223], a[124:127], v[28:31], v[220:223]
 ds_read_b128 a[92:95], v3 offset:27648
 v_cvt_pk_bf16_f32 v137, v138, v139
 v_mfma_f32_16x16x32_bf16 v[220:223], a[120:123], v[20:23], v[220:223]
 s_waitcnt lgkmcnt(6)
 v_cvt_pk_bf16_f32 v138, v140, v141
 v_cvt_pk_bf16_f32 v139, v142, v143
 v_mfma_f32_16x16x32_bf16 v[160:163], a[64:67], v[16:19], v[160:163]
 ds_read_b128 a[96:99], v3 offset:12288
 v_cvt_pk_bf16_f32 v200, v200, v201
 v_mfma_f32_16x16x32_bf16 v[160:163], a[68:71], v[24:27], v[160:163]
 buffer_store_dwordx4 v[136:139], v1, s[12:15], s55 offen offset:1024 sc1
 v_mfma_f32_16x16x32_bf16 v[224:227], a[68:71], v[28:31], v[224:227]
 ds_read_b128 a[100:103], v3 offset:28672
 v_cvt_pk_bf16_f32 v201, v202, v203
 v_mfma_f32_16x16x32_bf16 v[224:227], a[64:67], v[20:23], v[224:227]
 s_waitcnt lgkmcnt(6)
 v_cvt_pk_bf16_f32 v202, v204, v205
 v_cvt_pk_bf16_f32 v203, v206, v207
 v_mfma_f32_16x16x32_bf16 v[164:167], a[72:75], v[16:19], v[164:167]
 ds_read_b128 a[104:107], v3 offset:13312
 v_cvt_pk_bf16_f32 v144, v144, v145
 v_mfma_f32_16x16x32_bf16 v[164:167], a[76:79], v[24:27], v[164:167]
 buffer_store_dwordx4 v[200:203], v1, s[12:15], s56 offen offset:1024 sc1
 v_mfma_f32_16x16x32_bf16 v[228:231], a[76:79], v[28:31], v[228:231]
 ds_read_b128 a[108:111], v3 offset:29696
 v_cvt_pk_bf16_f32 v145, v146, v147
 v_mfma_f32_16x16x32_bf16 v[228:231], a[72:75], v[20:23], v[228:231]
 s_waitcnt lgkmcnt(6)
 v_cvt_pk_bf16_f32 v146, v148, v149
 v_cvt_pk_bf16_f32 v147, v150, v151
 v_mfma_f32_16x16x32_bf16 v[168:171], a[80:83], v[16:19], v[168:171]
 ds_read_b128 a[112:115], v3 offset:14336
 v_cvt_pk_bf16_f32 v208, v208, v209
 v_mfma_f32_16x16x32_bf16 v[168:171], a[84:87], v[24:27], v[168:171]
 buffer_store_dwordx4 v[144:147], v1, s[12:15], s55 offen offset:2048 sc1
 v_mfma_f32_16x16x32_bf16 v[232:235], a[84:87], v[28:31], v[232:235]
 ds_read_b128 a[116:119], v3 offset:30720
 v_cvt_pk_bf16_f32 v209, v210, v211
 v_mfma_f32_16x16x32_bf16 v[232:235], a[80:83], v[20:23], v[232:235]
 s_waitcnt lgkmcnt(6)
 v_cvt_pk_bf16_f32 v210, v212, v213
 v_cvt_pk_bf16_f32 v211, v214, v215
 v_mfma_f32_16x16x32_bf16 v[172:175], a[88:91], v[16:19], v[172:175]
 ds_read_b128 a[120:123], v3 offset:15360
 v_cvt_pk_bf16_f32 v152, v152, v153
 v_mfma_f32_16x16x32_bf16 v[172:175], a[92:95], v[24:27], v[172:175]
 buffer_store_dwordx4 v[208:211], v1, s[12:15], s56 offen offset:2048 sc1
 v_mfma_f32_16x16x32_bf16 v[236:239], a[92:95], v[28:31], v[236:239]
 ds_read_b128 a[124:127], v3 offset:31744
 v_cvt_pk_bf16_f32 v153, v154, v155
 v_mfma_f32_16x16x32_bf16 v[236:239], a[88:91], v[20:23], v[236:239]
 s_waitcnt lgkmcnt(6)
 v_cvt_pk_bf16_f32 v154, v156, v157
 v_cvt_pk_bf16_f32 v155, v158, v159
 v_mfma_f32_16x16x32_bf16 v[176:179], a[96:99], v[16:19], v[176:179]
 v_cvt_pk_bf16_f32 v216, v216, v217
 v_cvt_pk_bf16_f32 v217, v218, v219
 v_mfma_f32_16x16x32_bf16 v[176:179], a[100:103], v[24:27], v[176:179]
 buffer_store_dwordx4 v[152:155], v1, s[12:15], s55 offen offset:3072 sc1
 v_mfma_f32_16x16x32_bf16 v[240:243], a[100:103], v[28:31], v[240:243]
 v_cvt_pk_bf16_f32 v218, v220, v221
 v_cvt_pk_bf16_f32 v219, v222, v223
 v_mfma_f32_16x16x32_bf16 v[240:243], a[96:99], v[20:23], v[240:243]
 s_waitcnt lgkmcnt(4)
 v_cvt_pk_bf16_f32 v160, v160, v161
 v_cvt_pk_bf16_f32 v161, v162, v163
 v_mfma_f32_16x16x32_bf16 v[180:183], a[104:107], v[16:19], v[180:183]
 v_cvt_pk_bf16_f32 v162, v164, v165
 v_cvt_pk_bf16_f32 v163, v166, v167
 v_mfma_f32_16x16x32_bf16 v[180:183], a[108:111], v[24:27], v[180:183]
 buffer_store_dwordx4 v[216:219], v1, s[12:15], s56 offen offset:3072 sc1
 v_mfma_f32_16x16x32_bf16 v[244:247], a[108:111], v[28:31], v[244:247]
 v_cvt_pk_bf16_f32 v224, v224, v225
 v_cvt_pk_bf16_f32 v225, v226, v227
 v_mfma_f32_16x16x32_bf16 v[244:247], a[104:107], v[20:23], v[244:247]
 s_waitcnt lgkmcnt(2)
 v_cvt_pk_bf16_f32 v226, v228, v229
 v_cvt_pk_bf16_f32 v227, v230, v231
 v_mfma_f32_16x16x32_bf16 v[184:187], a[112:115], v[16:19], v[184:187]
 v_cvt_pk_bf16_f32 v168, v168, v169
 v_cvt_pk_bf16_f32 v169, v170, v171
 v_mfma_f32_16x16x32_bf16 v[184:187], a[116:119], v[24:27], v[184:187]
 buffer_store_dwordx4 v[160:163], v4, s[12:15], s55 offen offset:0 sc1
 v_mfma_f32_16x16x32_bf16 v[248:251], a[116:119], v[28:31], v[248:251]
 v_cvt_pk_bf16_f32 v170, v172, v173
 v_cvt_pk_bf16_f32 v171, v174, v175
 v_mfma_f32_16x16x32_bf16 v[248:251], a[112:115], v[20:23], v[248:251]
 s_waitcnt lgkmcnt(0)
 v_cvt_pk_bf16_f32 v232, v232, v233
 v_cvt_pk_bf16_f32 v233, v234, v235
 v_mfma_f32_16x16x32_bf16 v[188:191], a[120:123], v[16:19], v[188:191]
 v_cvt_pk_bf16_f32 v234, v236, v237
 v_cvt_pk_bf16_f32 v235, v238, v239
 v_mfma_f32_16x16x32_bf16 v[188:191], a[124:127], v[24:27], v[188:191]
 buffer_store_dwordx4 v[224:227], v4, s[12:15], s56 offen offset:0 sc1
 v_mfma_f32_16x16x32_bf16 v[252:255], a[124:127], v[28:31], v[252:255]
 v_mfma_f32_16x16x32_bf16 v[252:255], a[120:123], v[20:23], v[252:255]
 v_mov_b32 v68, v7
 v_mov_b32 v69, v8
 v_mov_b32 v70, v9
 v_mov_b32 v71, v10
 v_rcp_f32 v64, v7
 v_rcp_f32 v65, v8
 v_cvt_pk_bf16_f32 v176, v176, v177
 v_cvt_pk_bf16_f32 v177, v178, v179
 v_cvt_pk_bf16_f32 v178, v180, v181
 v_cvt_pk_bf16_f32 v179, v182, v183
 v_cvt_pk_bf16_f32 v240, v240, v241
 v_cvt_pk_bf16_f32 v241, v242, v243
 v_cvt_pk_bf16_f32 v242, v244, v245
 v_cvt_pk_bf16_f32 v243, v246, v247
 v_cvt_pk_bf16_f32 v184, v184, v185
 v_cvt_pk_bf16_f32 v185, v186, v187
 v_cvt_pk_bf16_f32 v186, v188, v189
 v_cvt_pk_bf16_f32 v187, v190, v191
 v_cvt_pk_bf16_f32 v248, v248, v249
 v_cvt_pk_bf16_f32 v249, v250, v251
 v_cvt_pk_bf16_f32 v250, v252, v253
 v_cvt_pk_bf16_f32 v251, v254, v255
 s_waitcnt vmcnt(10)
 s_cmp_lg_u32 s27, 0
 s_cbranch_scc1 L_attdone
 v_mov_b32 v3, v4
 s_cmp_eq_u32 s54, 1
 s_cbranch_scc0 L_t1park
 v_accvgpr_read_b32 v64, a200
 v_accvgpr_read_b32 v65, a201
 s_branch L_opB
L_t1park:
 v_accvgpr_write_b32 a128, v128
 v_accvgpr_write_b32 a129, v129
 v_accvgpr_write_b32 a130, v130
 v_accvgpr_write_b32 a131, v131
 v_accvgpr_write_b32 a160, v192
 v_accvgpr_write_b32 a161, v193
 v_accvgpr_write_b32 a162, v194
 v_accvgpr_write_b32 a163, v195
 v_accvgpr_write_b32 a132, v136
 v_accvgpr_write_b32 a133, v137
 v_accvgpr_write_b32 a134, v138
 v_accvgpr_write_b32 a135, v139
 v_accvgpr_write_b32 a164, v200
 v_accvgpr_write_b32 a165, v201
 v_accvgpr_write_b32 a166, v202
 v_accvgpr_write_b32 a167, v203
 v_accvgpr_write_b32 a136, v144
 v_accvgpr_write_b32 a137, v145
 v_accvgpr_write_b32 a138, v146
 v_accvgpr_write_b32 a139, v147
 v_accvgpr_write_b32 a168, v208
 v_accvgpr_write_b32 a169, v209
 v_accvgpr_write_b32 a170, v210
 v_accvgpr_write_b32 a171, v211
 v_accvgpr_write_b32 a140, v152
 v_accvgpr_write_b32 a141, v153
 v_accvgpr_write_b32 a142, v154
 v_accvgpr_write_b32 a143, v155
 v_accvgpr_write_b32 a172, v216
 v_accvgpr_write_b32 a173, v217
 v_accvgpr_write_b32 a174, v218
 v_accvgpr_write_b32 a175, v219
 v_accvgpr_write_b32 a144, v160
 v_accvgpr_write_b32 a145, v161
 v_accvgpr_write_b32 a146, v162
 v_accvgpr_write_b32 a147, v163
 v_accvgpr_write_b32 a176, v224
 v_accvgpr_write_b32 a177, v225
 v_accvgpr_write_b32 a178, v226
 v_accvgpr_write_b32 a179, v227
 v_accvgpr_write_b32 a148, v168
 v_accvgpr_write_b32 a149, v169
 v_accvgpr_write_b32 a150, v170
 v_accvgpr_write_b32 a151, v171
 v_accvgpr_write_b32 a180, v232
 v_accvgpr_write_b32 a181, v233
 v_accvgpr_write_b32 a182, v234
 v_accvgpr_write_b32 a183, v235
 v_accvgpr_write_b32 a152, v176
 v_accvgpr_write_b32 a153, v177
 v_accvgpr_write_b32 a154, v178
 v_accvgpr_write_b32 a155, v179
 v_accvgpr_write_b32 a184, v240
 v_accvgpr_write_b32 a185, v241
 v_accvgpr_write_b32 a186, v242
 v_accvgpr_write_b32 a187, v243
 v_accvgpr_write_b32 a156, v184
 v_accvgpr_write_b32 a157, v185
 v_accvgpr_write_b32 a158, v186
 v_accvgpr_write_b32 a159, v187
 v_accvgpr_write_b32 a188, v248
 v_accvgpr_write_b32 a189, v249
 v_accvgpr_write_b32 a190, v250
 v_accvgpr_write_b32 a191, v251
 s_branch L_opB
L_tail2:
 v_accvgpr_read_b32 v11, a246
 s_mov_b32 s52, s55
 s_mov_b32 s53, s57
 v_readfirstlane_b32 s58, v11
 s_mov_b32 s59, 2.0
 s_nop 1
 s_cmp_eq_u32 s58, 0
 s_cselect_b32 s55, s55, 2.0
 s_cselect_b32 s57, s57, 2.0
 s_add_u32 s56, s55, 0x2000
 buffer_load_dwordx4 v[68:71], v1, s[12:15], s57 offen sc1
 s_waitcnt lgkmcnt(0)
 v_mfma_f32_16x16x32_bf16 v[128:131], a[64:67], v[16:19], v[128:131]
 ds_read_b128 a[96:99], v3 offset:4096
 v_mfma_f32_16x16x32_bf16 v[128:131], a[68:71], v[24:27], v[128:131]
 buffer_load_dwordx4 v[32:35], v1, s[12:15], s55 offen offset:0 sc1
 v_mfma_f32_16x16x32_bf16 v[192:195], a[68:71], v[28:31], v[192:195]
 ds_read_b128 a[100:103], v3 offset:20480
 v_mfma_f32_16x16x32_bf16 v[192:195], a[64:67], v[20:23], v[192:195]
 v_mov_b32 v72, v7
 v_mov_b32 v73, v8
 v_mfma_f32_16x16x32_bf16 v[132:135], a[72:75], v[16:19], v[132:135]
 ds_read_b128 a[104:107], v3 offset:5120
 v_mfma_f32_16x16x32_bf16 v[132:135], a[76:79], v[24:27], v[132:135]
 buffer_load_dwordx4 v[96:99], v1, s[12:15], s56 offen offset:0 sc1
 v_mfma_f32_16x16x32_bf16 v[196:199], a[76:79], v[28:31], v[196:199]
 ds_read_b128 a[108:111], v3 offset:21504
 v_mfma_f32_16x16x32_bf16 v[196:199], a[72:75], v[20:23], v[196:199]
 v_permlane32_swap_b32 v7, v72
 v_permlane32_swap_b32 v8, v73
 v_mfma_f32_16x16x32_bf16 v[136:139], a[80:83], v[16:19], v[136:139]
 ds_read_b128 a[112:115], v3 offset:6144
 v_mfma_f32_16x16x32_bf16 v[136:139], a[84:87], v[24:27], v[136:139]
 buffer_load_dwordx4 v[36:39], v1, s[12:15], s55 offen offset:1024 sc1
 v_mfma_f32_16x16x32_bf16 v[200:203], a[84:87], v[28:31], v[200:203]
 ds_read_b128 a[116:119], v3 offset:22528
 v_mfma_f32_16x16x32_bf16 v[200:203], a[80:83], v[20:23], v[200:203]
 v_add_f32 v7, v7, v72
 v_add_f32 v8, v8, v73
 v_mfma_f32_16x16x32_bf16 v[140:143], a[88:91], v[16:19], v[140:143]
 ds_read_b128 a[120:123], v3 offset:7168
 v_mfma_f32_16x16x32_bf16 v[140:143], a[92:95], v[24:27], v[140:143]
 buffer_load_dwordx4 v[100:103], v1, s[12:15], s56 offen offset:1024 sc1
 v_mfma_f32_16x16x32_bf16 v[204:207], a[92:95], v[28:31], v[204:207]
 ds_read_b128 a[124:127], v3 offset:23552
 v_mfma_f32_16x16x32_bf16 v[204:207], a[88:91], v[20:23], v[204:207]
 s_waitcnt lgkmcnt(6)
 v_mov_b32 v72, v7
 v_mov_b32 v73, v8
 v_mfma_f32_16x16x32_bf16 v[144:147], a[96:99], v[16:19], v[144:147]
 ds_read_b128 a[64:67], v3 offset:8192
 v_mfma_f32_16x16x32_bf16 v[144:147], a[100:103], v[24:27], v[144:147]
 buffer_load_dwordx4 v[40:43], v1, s[12:15], s55 offen offset:2048 sc1
 v_mfma_f32_16x16x32_bf16 v[208:211], a[100:103], v[28:31], v[208:211]
 ds_read_b128 a[68:71], v3 offset:24576
 v_mfma_f32_16x16x32_bf16 v[208:211], a[96:99], v[20:23], v[208:211]
 s_waitcnt lgkmcnt(6)
 v_permlane16_swap_b32 v7, v72
 v_permlane16_swap_b32 v8, v73
 v_mfma_f32_16x16x32_bf16 v[148:151], a[104:107], v[16:19], v[148:151]
 ds_read_b128 a[72:75], v3 offset:9216
 v_mfma_f32_16x16x32_bf16 v[148:151], a[108:111], v[24:27], v[148:151]
 buffer_load_dwordx4 v[104:107], v1, s[12:15], s56 offen offset:2048 sc1
 v_mfma_f32_16x16x32_bf16 v[212:215], a[108:111], v[28:31], v[212:215]
 ds_read_b128 a[76:79], v3 offset:25600
 v_mfma_f32_16x16x32_bf16 v[212:215], a[104:107], v[20:23], v[212:215]
 s_waitcnt lgkmcnt(6)
 v_add_f32 v7, v7, v72
 v_add_f32 v8, v8, v73
 v_mfma_f32_16x16x32_bf16 v[152:155], a[112:115], v[16:19], v[152:155]
 ds_read_b128 a[80:83], v3 offset:10240
 v_mfma_f32_16x16x32_bf16 v[152:155], a[116:119], v[24:27], v[152:155]
 buffer_load_dwordx4 v[44:47], v1, s[12:15], s55 offen offset:3072 sc1
 v_mfma_f32_16x16x32_bf16 v[216:219], a[116:119], v[28:31], v[216:219]
 ds_read_b128 a[84:87], v3 offset:26624
 v_mfma_f32_16x16x32_bf16 v[216:219], a[112:115], v[20:23], v[216:219]
 s_waitcnt lgkmcnt(6)
 v_mfma_f32_16x16x32_bf16 v[156:159], a[120:123], v[16:19], v[156:159]
 ds_read_b128 a[88:91], v3 offset:11264
 v_mfma_f32_16x16x32_bf16 v[156:159], a[124:127], v[24:27], v[156:159]
 buffer_load_dwordx4 v[108:111], v1, s[12:15], s56 offen offset:3072 sc1
 v_mfma_f32_16x16x32_bf16 v[220:223], a[124:127], v[28:31], v[220:223]
 ds_read_b128 a[92:95], v3 offset:27648
 v_mfma_f32_16x16x32_bf16 v[220:223], a[120:123], v[20:23], v[220:223]
 s_waitcnt lgkmcnt(6)
 v_mfma_f32_16x16x32_bf16 v[160:163], a[64:67], v[16:19], v[160:163]
 ds_read_b128 a[96:99], v3 offset:12288
 v_mfma_f32_16x16x32_bf16 v[160:163], a[68:71], v[24:27], v[160:163]
 buffer_load_dwordx4 v[48:51], v4, s[12:15], s55 offen offset:0 sc1
 v_mfma_f32_16x16x32_bf16 v[224:227], a[68:71], v[28:31], v[224:227]
 ds_read_b128 a[100:103], v3 offset:28672
 v_mfma_f32_16x16x32_bf16 v[224:227], a[64:67], v[20:23], v[224:227]
 s_waitcnt lgkmcnt(6)
 v_mfma_f32_16x16x32_bf16 v[164:167], a[72:75], v[16:19], v[164:167]
 ds_read_b128 a[104:107], v3 offset:13312
 v_mfma_f32_16x16x32_bf16 v[164:167], a[76:79], v[24:27], v[164:167]
 buffer_load_dwordx4 v[112:115], v4, s[12:15], s56 offen offset:0 sc1
 v_mfma_f32_16x16x32_bf16 v[228:231], a[76:79], v[28:31], v[228:231]
 ds_read_b128 a[108:111], v3 offset:29696
 v_mfma_f32_16x16x32_bf16 v[228:231], a[72:75], v[20:23], v[228:231]
 s_waitcnt lgkmcnt(6)
 v_mfma_f32_16x16x32_bf16 v[168:171], a[80:83], v[16:19], v[168:171]
 ds_read_b128 a[112:115], v3 offset:14336
 v_mfma_f32_16x16x32_bf16 v[168:171], a[84:87], v[24:27], v[168:171]
 buffer_load_dwordx4 v[52:55], v4, s[12:15], s55 offen offset:1024 sc1
 v_mfma_f32_16x16x32_bf16 v[232:235], a[84:87], v[28:31], v[232:235]
 ds_read_b128 a[116:119], v3 offset:30720
 v_mfma_f32_16x16x32_bf16 v[232:235], a[80:83], v[20:23], v[232:235]
 s_waitcnt lgkmcnt(6)
 v_mfma_f32_16x16x32_bf16 v[172:175], a[88:91], v[16:19], v[172:175]
 ds_read_b128 a[120:123], v3 offset:15360
 v_mfma_f32_16x16x32_bf16 v[172:175], a[92:95], v[24:27], v[172:175]
 buffer_load_dwordx4 v[116:119], v4, s[12:15], s56 offen offset:1024 sc1
 v_mfma_f32_16x16x32_bf16 v[236:239], a[92:95], v[28:31], v[236:239]
 ds_read_b128 a[124:127], v3 offset:31744
 v_mfma_f32_16x16x32_bf16 v[236:239], a[88:91], v[20:23], v[236:239]
 s_waitcnt lgkmcnt(6)
 v_mfma_f32_16x16x32_bf16 v[176:179], a[96:99], v[16:19], v[176:179]
 v_mfma_f32_16x16x32_bf16 v[176:179], a[100:103], v[24:27], v[176:179]
 buffer_load_dwordx4 v[56:59], v4, s[12:15], s55 offen offset:2048 sc1
 v_mfma_f32_16x16x32_bf16 v[240:243], a[100:103], v[28:31], v[240:243]
 v_mfma_f32_16x16x32_bf16 v[240:243], a[96:99], v[20:23], v[240:243]
 s_waitcnt lgkmcnt(4)
 v_mfma_f32_16x16x32_bf16 v[180:183], a[104:107], v[16:19], v[180:183]
 v_mfma_f32_16x16x32_bf16 v[180:183], a[108:111], v[24:27], v[180:183]
 buffer_load_dwordx4 v[120:123], v4, s[12:15], s56 offen offset:2048 sc1
 v_mfma_f32_16x16x32_bf16 v[244:247], a[108:111], v[28:31], v[244:247]
 v_mfma_f32_16x16x32_bf16 v[244:247], a[104:107], v[20:23], v[244:247]
 s_waitcnt lgkmcnt(2)
 v_mfma_f32_16x16x32_bf16 v[184:187], a[112:115], v[16:19], v[184:187]
 v_mfma_f32_16x16x32_bf16 v[184:187], a[116:119], v[24:27], v[184:187]
 buffer_load_dwordx4 v[60:63], v4, s[12:15], s55 offen offset:3072 sc1
 v_mfma_f32_16x16x32_bf16 v[248:251], a[116:119], v[28:31], v[248:251]
 v_mfma_f32_16x16x32_bf16 v[248:251], a[112:115], v[20:23], v[248:251]
 s_waitcnt lgkmcnt(0)
 v_mfma_f32_16x16x32_bf16 v[188:191], a[120:123], v[16:19], v[188:191]
 v_mfma_f32_16x16x32_bf16 v[188:191], a[124:127], v[24:27], v[188:191]
 v_mfma_f32_16x16x32_bf16 v[252:255], a[124:127], v[28:31], v[252:255]
 v_mfma_f32_16x16x32_bf16 v[252:255], a[120:123], v[20:23], v[252:255]
 buffer_load_dwordx4 v[124:127], v4, s[12:15], s56 offen offset:3072 sc1
 s_cmp_eq_u32 s58, 0
 s_cbranch_scc1 L_merge2
 v_and_b32 v11, 0, v0
 v_lshlrev_b32 v11, 2, v11
 s_mov_b32 s32, 0
L_poll5:
 buffer_load_dword v12, v11, s[12:15], s94 offen sc1
 s_waitcnt vmcnt(0)
 v_cmp_ne_u32 vcc, 0, v12
 s_cbranch_vccz L_poll5_ok
 s_sleep 8
 s_add_u32 s32, s32, 1
 s_cmp_lt_u32 s32, 0x80000
 s_cbranch_scc1 L_poll5
L_poll5_ok:
 s_mov_b32 s55, s52
 s_mov_b32 s57, s53
 s_add_u32 s56, s55, 0x2000
 buffer_load_dwordx4 v[68:71], v1, s[12:15], s57 offen sc1
 buffer_load_dwordx4 v[32:35], v1, s[12:15], s55 offen offset:0 sc1
 buffer_load_dwordx4 v[96:99], v1, s[12:15], s56 offen offset:0 sc1
 buffer_load_dwordx4 v[36:39], v1, s[12:15], s55 offen offset:1024 sc1
 buffer_load_dwordx4 v[100:103], v1, s[12:15], s56 offen offset:1024 sc1
 buffer_load_dwordx4 v[40:43], v1, s[12:15], s55 offen offset:2048 sc1
 buffer_load_dwordx4 v[104:107], v1, s[12:15], s56 offen offset:2048 sc1
 buffer_load_dwordx4 v[44:47], v1, s[12:15], s55 offen offset:3072 sc1
 buffer_load_dwordx4 v[108:111], v1, s[12:15], s56 offen offset:3072 sc1
 buffer_load_dwordx4 v[48:51], v4, s[12:15], s55 offen offset:0 sc1
 buffer_load_dwordx4 v[112:115], v4, s[12:15], s56 offen offset:0 sc1
 buffer_load_dwordx4 v[52:55], v4, s[12:15], s55 offen offset:1024 sc1
 buffer_load_dwordx4 v[116:119], v4, s[12:15], s56 offen offset:1024 sc1
 buffer_load_dwordx4 v[56:59], v4, s[12:15], s55 offen offset:2048 sc1
 buffer_load_dwordx4 v[120:123], v4, s[12:15], s56 offen offset:2048 sc1
 buffer_load_dwordx4 v[60:63], v4, s[12:15], s55 offen offset:3072 sc1
 buffer_load_dwordx4 v[124:127], v4, s[12:15], s56 offen offset:3072 sc1
L_merge2:
 s_waitcnt vmcnt(14)
 v_cmp_neq_f32 vcc, v70, v9
 v_cmp_neq_f32 s[20:21], v71, v10
 s_or_b64 vcc, vcc, s[20:21]
 s_cbranch_vccnz L_mslow
 v_mfma_f32_16x16x32_bf16 v[128:131], a[250:253], v[32:35], v[128:131]
 s_add_u32 m0, s29, 0
 v_add_f32 v7, v7, v68
 v_add_f32 v8, v8, v69
 v_mfma_f32_16x16x32_bf16 v[132:135], a[248:251], v[32:35], v[132:135]
 buffer_load_dwordx4 v2, s[8:11], s78 offen lds
 v_mfma_f32_16x16x32_bf16 v[192:195], a[250:253], v[96:99], v[192:195]
 v_rcp_f32 v64, v7
 v_mfma_f32_16x16x32_bf16 v[196:199], a[248:251], v[96:99], v[196:199]
 s_waitcnt vmcnt(13)
 v_rcp_f32 v65, v8
 v_mfma_f32_16x16x32_bf16 v[136:139], a[250:253], v[36:39], v[136:139]
 s_add_u32 m0, s29, 4096
 v_mfma_f32_16x16x32_bf16 v[140:143], a[248:251], v[36:39], v[140:143]
 buffer_load_dwordx4 v2, s[8:11], s79 offen lds
 v_mfma_f32_16x16x32_bf16 v[200:203], a[250:253], v[100:103], v[200:203]
 v_cvt_pk_bf16_f32 v128, v128, v129
 v_cvt_pk_bf16_f32 v129, v130, v131
 v_mfma_f32_16x16x32_bf16 v[204:207], a[248:251], v[100:103], v[204:207]
 s_waitcnt vmcnt(12)
 v_cvt_pk_bf16_f32 v130, v132, v133
 v_cvt_pk_bf16_f32 v131, v134, v135
 v_mfma_f32_16x16x32_bf16 v[144:147], a[250:253], v[40:43], v[144:147]
 s_add_u32 m0, s29, 8192
 v_cvt_pk_bf16_f32 v192, v192, v193
 v_cvt_pk_bf16_f32 v193, v194, v195
 v_mfma_f32_16x16x32_bf16 v[148:151], a[248:251], v[40:43], v[148:151]
 buffer_load_dwordx4 v2, s[8:11], s80 offen lds
 v_mfma_f32_16x16x32_bf16 v[208:211], a[250:253], v[104:107], v[208:211]
 v_cvt_pk_bf16_f32 v194, v196, v197
 v_cvt_pk_bf16_f32 v195, v198, v199
 v_mfma_f32_16x16x32_bf16 v[212:215], a[248:251], v[104:107], v[212:215]
 s_waitcnt vmcnt(11)
 v_cvt_pk_bf16_f32 v136, v136, v137
 v_cvt_pk_bf16_f32 v137, v138, v139
 v_mfma_f32_16x16x32_bf16 v[152:155], a[250:253], v[44:47], v[152:155]
 s_add_u32 m0, s29, 12288
 v_cvt_pk_bf16_f32 v138, v140, v141
 v_cvt_pk_bf16_f32 v139, v142, v143
 v_mfma_f32_16x16x32_bf16 v[156:159], a[248:251], v[44:47], v[156:159]
 buffer_load_dwordx4 v2, s[8:11], s81 offen lds
 v_mfma_f32_16x16x32_bf16 v[216:219], a[250:253], v[108:111], v[216:219]
 v_cvt_pk_bf16_f32 v200, v200, v201
 v_cvt_pk_bf16_f32 v201, v202, v203
 v_mfma_f32_16x16x32_bf16 v[220:223], a[248:251], v[108:111], v[220:223]
 s_waitcnt vmcnt(10)
 v_cvt_pk_bf16_f32 v202, v204, v205
 v_cvt_pk_bf16_f32 v203, v206, v207
 v_mfma_f32_16x16x32_bf16 v[160:163], a[250:253], v[48:51], v[160:163]
 s_add_u32 m0, s29, 16384
 v_cvt_pk_bf16_f32 v144, v144, v145
 v_cvt_pk_bf16_f32 v145, v146, v147
 v_mfma_f32_16x16x32_bf16 v[164:167], a[248:251], v[48:51], v[164:167]
 buffer_load_dwordx4 v2, s[8:11], s82 offen lds
 v_mfma_f32_16x16x32_bf16 v[224:227], a[250:253], v[112:115], v[224:227]
 v_cvt_pk_bf16_f32 v146, v148, v149
 v_cvt_pk_bf16_f32 v147, v150, v151
 v_mfma_f32_16x16x32_bf16 v[228:231], a[248:251], v[112:115], v[228:231]
 s_waitcnt vmcnt(9)
 v_cvt_pk_bf16_f32 v208, v208, v209
 v_cvt_pk_bf16_f32 v209, v210, v211
 v_mfma_f32_16x16x32_bf16 v[168:171], a[250:253], v[52:55], v[168:171]
 s_add_u32 m0, s29, 20480
 v_cvt_pk_bf16_f32 v210, v212, v213
 v_cvt_pk_bf16_f32 v211, v214, v215
 v_mfma_f32_16x16x32_bf16 v[172:175], a[248:251], v[52:55], v[172:175]
 buffer_load_dwordx4 v2, s[8:11], s83 offen lds
 v_mfma_f32_16x16x32_bf16 v[232:235], a[250:253], v[116:119], v[232:235]
 v_cvt_pk_bf16_f32 v152, v152, v153
 v_cvt_pk_bf16_f32 v153, v154, v155
 v_mfma_f32_16x16x32_bf16 v[236:239], a[248:251], v[116:119], v[236:239]
 s_waitcnt vmcnt(8)
 v_cvt_pk_bf16_f32 v154, v156, v157
 v_cvt_pk_bf16_f32 v155, v158, v159
 v_mfma_f32_16x16x32_bf16 v[176:179], a[250:253], v[56:59], v[176:179]
 s_add_u32 m0, s29, 24576
 v_cvt_pk_bf16_f32 v216, v216, v217
 v_cvt_pk_bf16_f32 v217, v218, v219
 v_mfma_f32_16x16x32_bf16 v[180:183], a[248:251], v[56:59], v[180:183]
 buffer_load_dwordx4 v2, s[8:11], s84 offen lds
 v_mfma_f32_16x16x32_bf16 v[240:243], a[250:253], v[120:123], v[240:243]
 v_cvt_pk_bf16_f32 v218, v220, v221
 v_cvt_pk_bf16_f32 v219, v222, v223
 v_mfma_f32_16x16x32_bf16 v[244:247], a[248:251], v[120:123], v[244:247]
 s_waitcnt vmcnt(7)
 v_cvt_pk_bf16_f32 v160, v160, v161
 v_cvt_pk_bf16_f32 v161, v162, v163
 v_mfma_f32_16x16x32_bf16 v[184:187], a[250:253], v[60:63], v[184:187]
 s_add_u32 m0, s29, 28672
 v_cvt_pk_bf16_f32 v162, v164, v165
 v_cvt_pk_bf16_f32 v163, v166, v167
 v_mfma_f32_16x16x32_bf16 v[188:191], a[248:251], v[60:63], v[188:191]
 buffer_load_dwordx4 v2, s[8:11], s85 offen lds
 v_mfma_f32_16x16x32_bf16 v[248:251], a[250:253], v[124:127], v[248:251]
 v_cvt_pk_bf16_f32 v224, v224, v225
 v_cvt_pk_bf16_f32 v225, v226, v227
 v_mfma_f32_16x16x32_bf16 v[252:255], a[248:251], v[124:127], v[252:255]
 v_cvt_pk_bf16_f32 v226, v228, v229
 v_cvt_pk_bf16_f32 v227, v230, v231
 v_add_u32 v2, 128, v2
 v_cvt_pk_bf16_f32 v168, v168, v169
 v_cvt_pk_bf16_f32 v169, v170, v171
 v_cvt_pk_bf16_f32 v170, v172, v173
 v_cvt_pk_bf16_f32 v171, v174, v175
 v_cvt_pk_bf16_f32 v232, v232, v233
 v_cvt_pk_bf16_f32 v233, v234, v235
 v_cvt_pk_bf16_f32 v234, v236, v237
 v_cvt_pk_bf16_f32 v235, v238, v239
 v_cvt_pk_bf16_f32 v176, v176, v177
 v_cvt_pk_bf16_f32 v177, v178, v179
 v_cvt_pk_bf16_f32 v178, v180, v181
 v_cvt_pk_bf16_f32 v179, v182, v183
 v_cvt_pk_bf16_f32 v240, v240, v241
 v_cvt_pk_bf16_f32 v241, v242, v243
 v_cvt_pk_bf16_f32 v242, v244, v245
 v_cvt_pk_bf16_f32 v243, v246, v247
 v_cvt_pk_bf16_f32 v184, v184, v185
 v_cvt_pk_bf16_f32 v185, v186, v187
 v_cvt_pk_bf16_f32 v186, v188, v189
 v_cvt_pk_bf16_f32 v187, v190, v191
 v_cvt_pk_bf16_f32 v248, v248, v249
 v_cvt_pk_bf16_f32 v249, v250, v251
 v_cvt_pk_bf16_f32 v250, v252, v253
 v_cvt_pk_bf16_f32 v251, v254, v255
 s_waitcnt vmcnt(0)
 s_branch L_attdone
L_mslow:
 s_add_u32 m0, s29, 0
 s_nop 0
 buffer_load_dwordx4 v2, s[8:11], s78 offen lds
 s_add_u32 m0, s29, 4096
 s_nop 0
 buffer_load_dwordx4 v2, s[8:11], s79 offen lds
 s_add_u32 m0, s29, 8192
 s_nop 0
 buffer_load_dwordx4 v2, s[8:11], s80 offen lds
 s_add_u32 m0, s29, 12288
 s_nop 0
 buffer_load_dwordx4 v2, s[8:11], s81 offen lds
 s_add_u32 m0, s29, 16384
 s_nop 0
 buffer_load_dwordx4 v2, s[8:11], s82 offen lds
 s_add_u32 m0, s29, 20480
 s_nop 0
 buffer_load_dwordx4 v2, s[8:11], s83 offen lds
 s_add_u32 m0, s29, 24576
 s_nop 0
 buffer_load_dwordx4 v2, s[8:11], s84 offen lds
 s_add_u32 m0, s29, 28672
 s_nop 0
 buffer_load_dwordx4 v2, s[8:11], s85 offen lds
 v_add_u32 v2, 128, v2
 s_mov_b32 s58, 0xffff0000
 s_waitcnt vmcnt(0)
 v_min_f32 v20, v70, v9
 v_sub_f32 v21, v20, v9
 v_sub_f32 v22, v20, v70
 v_exp_f32 v16, v21
 v_exp_f32 v18, v22
 s_nop 0
 v_mul_f32 v7, v7, v16
 v_fmac_f32 v7, v68, v18
 v_rcp_f32 v64, v7
 v_min_f32 v20, v71, v10
 v_sub_f32 v21, v20, v10
 v_sub_f32 v22, v20, v71
 v_exp_f32 v17, v21
 v_exp_f32 v19, v22
 s_nop 0
 v_mul_f32 v8, v8, v17
 v_fmac_f32 v8, v69, v19
 v_rcp_f32 v65, v8
 v_lshlrev_b32 v24, 16, v32
 v_and_b32 v25, s58, v32
 v_pk_mul_f32 v[24:25], v[24:25], v[18:19] op_sel:[0,0] op_sel_hi:[1,0]
 v_pk_fma_f32 v[128:129], v[128:129], v[16:17], v[24:25] op_sel:[0,0,0] op_sel_hi:[1,0,1]
 v_lshlrev_b32 v26, 16, v33
 v_and_b32 v27, s58, v33
 v_pk_mul_f32 v[26:27], v[26:27], v[18:19] op_sel:[0,0] op_sel_hi:[1,0]
 v_pk_fma_f32 v[130:131], v[130:131], v[16:17], v[26:27] op_sel:[0,0,0] op_sel_hi:[1,0,1]
 v_lshlrev_b32 v28, 16, v34
 v_and_b32 v29, s58, v34
 v_pk_mul_f32 v[28:29], v[28:29], v[18:19] op_sel:[0,0] op_sel_hi:[1,0]
 v_pk_fma_f32 v[132:133], v[132:133], v[16:17], v[28:29] op_sel:[0,0,0] op_sel_hi:[1,0,1]
 v_lshlrev_b32 v30, 16, v35
 v_and_b32 v31, s58, v35
 v_pk_mul_f32 v[30:31], v[30:31], v[18:19] op_sel:[0,0] op_sel_hi:[1,0]
 v_pk_fma_f32 v[134:135], v[134:135], v[16:17], v[30:31] op_sel:[0,0,0] op_sel_hi:[1,0,1]
 v_cvt_pk_bf16_f32 v128, v128, v129
 v_cvt_pk_bf16_f32 v129, v130, v131
 v_cvt_pk_bf16_f32 v130, v132, v133
 v_cvt_pk_bf16_f32 v131, v134, v135
 v_lshlrev_b32 v24, 16, v36
 v_and_b32 v25, s58, v36
 v_pk_mul_f32 v[24:25], v[24:25], v[18:19] op_sel:[0,0] op_sel_hi:[1,0]
 v_pk_fma_f32 v[136:137], v[136:137], v[16:17], v[24:25] op_sel:[0,0,0] op_sel_hi:[1,0,1]
 v_lshlrev_b32 v26, 16, v37
 v_and_b32 v27, s58, v37
 v_pk_mul_f32 v[26:27], v[26:27], v[18:19] op_sel:[0,0] op_sel_hi:[1,0]
 v_pk_fma_f32 v[138:139], v[138:139], v[16:17], v[26:27] op_sel:[0,0,0] op_sel_hi:[1,0,1]
 v_lshlrev_b32 v28, 16, v38
 v_and_b32 v29, s58, v38
 v_pk_mul_f32 v[28:29], v[28:29], v[18:19] op_sel:[0,0] op_sel_hi:[1,0]
 v_pk_fma_f32 v[140:141], v[140:141], v[16:17], v[28:29] op_sel:[0,0,0] op_sel_hi:[1,0,1]
 v_lshlrev_b32 v30, 16, v39
 v_and_b32 v31, s58, v39
 v_pk_mul_f32 v[30:31], v[30:31], v[18:19] op_sel:[0,0] op_sel_hi:[1,0]
 v_pk_fma_f32 v[142:143], v[142:143], v[16:17], v[30:31] op_sel:[0,0,0] op_sel_hi:[1,0,1]
 v_cvt_pk_bf16_f32 v136, v136, v137
 v_cvt_pk_bf16_f32 v137, v138, v139
 v_cvt_pk_bf16_f32 v138, v140, v141
 v_cvt_pk_bf16_f32 v139, v142, v143
 v_lshlrev_b32 v24, 16, v40
 v_and_b32 v25, s58, v40
 v_pk_mul_f32 v[24:25], v[24:25], v[18:19] op_sel:[0,0] op_sel_hi:[1,0]
 v_pk_fma_f32 v[144:145], v[144:145], v[16:17], v[24:25] op_sel:[0,0,0] op_sel_hi:[1,0,1]
 v_lshlrev_b32 v26, 16, v41
 v_and_b32 v27, s58, v41
 v_pk_mul_f32 v[26:27], v[26:27], v[18:19] op_sel:[0,0] op_sel_hi:[1,0]
 v_pk_fma_f32 v[146:147], v[146:147], v[16:17], v[26:27] op_sel:[0,0,0] op_sel_hi:[1,0,1]
 v_lshlrev_b32 v28, 16, v42
 v_and_b32 v29, s58, v42
 v_pk_mul_f32 v[28:29], v[28:29], v[18:19] op_sel:[0,0] op_sel_hi:[1,0]
 v_pk_fma_f32 v[148:149], v[148:149], v[16:17], v[28:29] op_sel:[0,0,0] op_sel_hi:[1,0,1]
 v_lshlrev_b32 v30, 16, v43
 v_and_b32 v31, s58, v43
 v_pk_mul_f32 v[30:31], v[30:31], v[18:19] op_sel:[0,0] op_sel_hi:[1,0]
 v_pk_fma_f32 v[150:151], v[150:151], v[16:17], v[30:31] op_sel:[0,0,0] op_sel_hi:[1,0,1]
 v_cvt_pk_bf16_f32 v144, v144, v145
 v_cvt_pk_bf16_f32 v145, v146, v147
 v_cvt_pk_bf16_f32 v146, v148, v149
 v_cvt_pk_bf16_f32 v147, v150, v151
 v_lshlrev_b32 v24, 16, v44
 v_and_b32 v25, s58, v44
 v_pk_mul_f32 v[24:25], v[24:25], v[18:19] op_sel:[0,0] op_sel_hi:[1,0]
 v_pk_fma_f32 v[152:153], v[152:153], v[16:17], v[24:25] op_sel:[0,0,0] op_sel_hi:[1,0,1]
 v_lshlrev_b32 v26, 16, v45
 v_and_b32 v27, s58, v45
 v_pk_mul_f32 v[26:27], v[26:27], v[18:19] op_sel:[0,0] op_sel_hi:[1,0]
 v_pk_fma_f32 v[154:155], v[154:155], v[16:17], v[26:27] op_sel:[0,0,0] op_sel_hi:[1,0,1]
 v_lshlrev_b32 v28, 16, v46
 v_and_b32 v29, s58, v46
 v_pk_mul_f32 v[28:29], v[28:29], v[18:19] op_sel:[0,0] op_sel_hi:[1,0]
 v_pk_fma_f32 v[156:157], v[156:157], v[16:17], v[28:29] op_sel:[0,0,0] op_sel_hi:[1,0,1]
 v_lshlrev_b32 v30, 16, v47
 v_and_b32 v31, s58, v47
 v_pk_mul_f32 v[30:31], v[30:31], v[18:19] op_sel:[0,0] op_sel_hi:[1,0]
 v_pk_fma_f32 v[158:159], v[158:159], v[16:17], v[30:31] op_sel:[0,0,0] op_sel_hi:[1,0,1]
 v_cvt_pk_bf16_f32 v152, v152, v153
 v_cvt_pk_bf16_f32 v153, v154, v155
 v_cvt_pk_bf16_f32 v154, v156, v157
 v_cvt_pk_bf16_f32 v155, v158, v159
 v_lshlrev_b32 v24, 16, v48
 v_and_b32 v25, s58, v48
 v_pk_mul_f32 v[24:25], v[24:25], v[18:19] op_sel:[0,0] op_sel_hi:[1,0]
 v_pk_fma_f32 v[160:161], v[160:161], v[16:17], v[24:25] op_sel:[0,0,0] op_sel_hi:[1,0,1]
 v_lshlrev_b32 v26, 16, v49
 v_and_b32 v27, s58, v49
 v_pk_mul_f32 v[26:27], v[26:27], v[18:19] op_sel:[0,0] op_sel_hi:[1,0]
 v_pk_fma_f32 v[162:163], v[162:163], v[16:17], v[26:27] op_sel:[0,0,0] op_sel_hi:[1,0,1]
 v_lshlrev_b32 v28, 16, v50
 v_and_b32 v29, s58, v50
 v_pk_mul_f32 v[28:29], v[28:29], v[18:19] op_sel:[0,0] op_sel_hi:[1,0]
 v_pk_fma_f32 v[164:165], v[164:165], v[16:17], v[28:29] op_sel:[0,0,0] op_sel_hi:[1,0,1]
 v_lshlrev_b32 v30, 16, v51
 v_and_b32 v31, s58, v51
 v_pk_mul_f32 v[30:31], v[30:31], v[18:19] op_sel:[0,0] op_sel_hi:[1,0]
 v_pk_fma_f32 v[166:167], v[166:167], v[16:17], v[30:31] op_sel:[0,0,0] op_sel_hi:[1,0,1]
 v_cvt_pk_bf16_f32 v160, v160, v161
 v_cvt_pk_bf16_f32 v161, v162, v163
 v_cvt_pk_bf16_f32 v162, v164, v165
 v_cvt_pk_bf16_f32 v163, v166, v167
 v_lshlrev_b32 v24, 16, v52
 v_and_b32 v25, s58, v52
 v_pk_mul_f32 v[24:25], v[24:25], v[18:19] op_sel:[0,0] op_sel_hi:[1,0]
 v_pk_fma_f32 v[168:169], v[168:169], v[16:17], v[24:25] op_sel:[0,0,0] op_sel_hi:[1,0,1]
 v_lshlrev_b32 v26, 16, v53
 v_and_b32 v27, s58, v53
 v_pk_mul_f32 v[26:27], v[26:27], v[18:19] op_sel:[0,0] op_sel_hi:[1,0]
 v_pk_fma_f32 v[170:171], v[170:171], v[16:17], v[26:27] op_sel:[0,0,0] op_sel_hi:[1,0,1]
 v_lshlrev_b32 v28, 16, v54
 v_and_b32 v29, s58, v54
 v_pk_mul_f32 v[28:29], v[28:29], v[18:19] op_sel:[0,0] op_sel_hi:[1,0]
 v_pk_fma_f32 v[172:173], v[172:173], v[16:17], v[28:29] op_sel:[0,0,0] op_sel_hi:[1,0,1]
 v_lshlrev_b32 v30, 16, v55
 v_and_b32 v31, s58, v55
 v_pk_mul_f32 v[30:31], v[30:31], v[18:19] op_sel:[0,0] op_sel_hi:[1,0]
 v_pk_fma_f32 v[174:175], v[174:175], v[16:17], v[30:31] op_sel:[0,0,0] op_sel_hi:[1,0,1]
 v_cvt_pk_bf16_f32 v168, v168, v169
 v_cvt_pk_bf16_f32 v169, v170, v171
 v_cvt_pk_bf16_f32 v170, v172, v173
 v_cvt_pk_bf16_f32 v171, v174, v175
 v_lshlrev_b32 v24, 16, v56
 v_and_b32 v25, s58, v56
 v_pk_mul_f32 v[24:25], v[24:25], v[18:19] op_sel:[0,0] op_sel_hi:[1,0]
 v_pk_fma_f32 v[176:177], v[176:177], v[16:17], v[24:25] op_sel:[0,0,0] op_sel_hi:[1,0,1]
 v_lshlrev_b32 v26, 16, v57
 v_and_b32 v27, s58, v57
 v_pk_mul_f32 v[26:27], v[26:27], v[18:19] op_sel:[0,0] op_sel_hi:[1,0]
 v_pk_fma_f32 v[178:179], v[178:179], v[16:17], v[26:27] op_sel:[0,0,0] op_sel_hi:[1,0,1]
 v_lshlrev_b32 v28, 16, v58
 v_and_b32 v29, s58, v58
 v_pk_mul_f32 v[28:29], v[28:29], v[18:19] op_sel:[0,0] op_sel_hi:[1,0]
 v_pk_fma_f32 v[180:181], v[180:181], v[16:17], v[28:29] op_sel:[0,0,0] op_sel_hi:[1,0,1]
 v_lshlrev_b32 v30, 16, v59
 v_and_b32 v31, s58, v59
 v_pk_mul_f32 v[30:31], v[30:31], v[18:19] op_sel:[0,0] op_sel_hi:[1,0]
 v_pk_fma_f32 v[182:183], v[182:183], v[16:17], v[30:31] op_sel:[0,0,0] op_sel_hi:[1,0,1]
 v_cvt_pk_bf16_f32 v176, v176, v177
 v_cvt_pk_bf16_f32 v177, v178, v179
 v_cvt_pk_bf16_f32 v178, v180, v181
 v_cvt_pk_bf16_f32 v179, v182, v183
 v_lshlrev_b32 v24, 16, v60
 v_and_b32 v25, s58, v60
 v_pk_mul_f32 v[24:25], v[24:25], v[18:19] op_sel:[0,0] op_sel_hi:[1,0]
 v_pk_fma_f32 v[184:185], v[184:185], v[16:17], v[24:25] op_sel:[0,0,0] op_sel_hi:[1,0,1]
 v_lshlrev_b32 v26, 16, v61
 v_and_b32 v27, s58, v61
 v_pk_mul_f32 v[26:27], v[26:27], v[18:19] op_sel:[0,0] op_sel_hi:[1,0]
 v_pk_fma_f32 v[186:187], v[186:187], v[16:17], v[26:27] op_sel:[0,0,0] op_sel_hi:[1,0,1]
 v_lshlrev_b32 v28, 16, v62
 v_and_b32 v29, s58, v62
 v_pk_mul_f32 v[28:29], v[28:29], v[18:19] op_sel:[0,0] op_sel_hi:[1,0]
 v_pk_fma_f32 v[188:189], v[188:189], v[16:17], v[28:29] op_sel:[0,0,0] op_sel_hi:[1,0,1]
 v_lshlrev_b32 v30, 16, v63
 v_and_b32 v31, s58, v63
 v_pk_mul_f32 v[30:31], v[30:31], v[18:19] op_sel:[0,0] op_sel_hi:[1,0]
 v_pk_fma_f32 v[190:191], v[190:191], v[16:17], v[30:31] op_sel:[0,0,0] op_sel_hi:[1,0,1]
 v_cvt_pk_bf16_f32 v184, v184, v185
 v_cvt_pk_bf16_f32 v185, v186, v187
 v_cvt_pk_bf16_f32 v186, v188, v189
 v_cvt_pk_bf16_f32 v187, v190, v191
 v_lshlrev_b32 v24, 16, v96
 v_and_b32 v25, s58, v96
 v_pk_mul_f32 v[24:25], v[24:25], v[18:19] op_sel:[0,1] op_sel_hi:[1,1]
 v_pk_fma_f32 v[192:193], v[192:193], v[16:17], v[24:25] op_sel:[0,1,0] op_sel_hi:[1,1,1]
 v_lshlrev_b32 v26, 16, v97
 v_and_b32 v27, s58, v97
 v_pk_mul_f32 v[26:27], v[26:27], v[18:19] op_sel:[0,1] op_sel_hi:[1,1]
 v_pk_fma_f32 v[194:195], v[194:195], v[16:17], v[26:27] op_sel:[0,1,0] op_sel_hi:[1,1,1]
 v_lshlrev_b32 v28, 16, v98
 v_and_b32 v29, s58, v98
 v_pk_mul_f32 v[28:29], v[28:29], v[18:19] op_sel:[0,1] op_sel_hi:[1,1]
 v_pk_fma_f32 v[196:197], v[196:197], v[16:17], v[28:29] op_sel:[0,1,0] op_sel_hi:[1,1,1]
 v_lshlrev_b32 v30, 16, v99
 v_and_b32 v31, s58, v99
 v_pk_mul_f32 v[30:31], v[30:31], v[18:19] op_sel:[0,1] op_sel_hi:[1,1]
 v_pk_fma_f32 v[198:199], v[198:199], v[16:17], v[30:31] op_sel:[0,1,0] op_sel_hi:[1,1,1]
 v_cvt_pk_bf16_f32 v192, v192, v193
 v_cvt_pk_bf16_f32 v193, v194, v195
 v_cvt_pk_bf16_f32 v194, v196, v197
 v_cvt_pk_bf16_f32 v195, v198, v199
 v_lshlrev_b32 v24, 16, v100
 v_and_b32 v25, s58, v100
 v_pk_mul_f32 v[24:25], v[24:25], v[18:19] op_sel:[0,1] op_sel_hi:[1,1]
 v_pk_fma_f32 v[200:201], v[200:201], v[16:17], v[24:25] op_sel:[0,1,0] op_sel_hi:[1,1,1]
 v_lshlrev_b32 v26, 16, v101
 v_and_b32 v27, s58, v101
 v_pk_mul_f32 v[26:27], v[26:27], v[18:19] op_sel:[0,1] op_sel_hi:[1,1]
 v_pk_fma_f32 v[202:203], v[202:203], v[16:17], v[26:27] op_sel:[0,1,0] op_sel_hi:[1,1,1]
 v_lshlrev_b32 v28, 16, v102
 v_and_b32 v29, s58, v102
 v_pk_mul_f32 v[28:29], v[28:29], v[18:19] op_sel:[0,1] op_sel_hi:[1,1]
 v_pk_fma_f32 v[204:205], v[204:205], v[16:17], v[28:29] op_sel:[0,1,0] op_sel_hi:[1,1,1]
 v_lshlrev_b32 v30, 16, v103
 v_and_b32 v31, s58, v103
 v_pk_mul_f32 v[30:31], v[30:31], v[18:19] op_sel:[0,1] op_sel_hi:[1,1]
 v_pk_fma_f32 v[206:207], v[206:207], v[16:17], v[30:31] op_sel:[0,1,0] op_sel_hi:[1,1,1]
 v_cvt_pk_bf16_f32 v200, v200, v201
 v_cvt_pk_bf16_f32 v201, v202, v203
 v_cvt_pk_bf16_f32 v202, v204, v205
 v_cvt_pk_bf16_f32 v203, v206, v207
 v_lshlrev_b32 v24, 16, v104
 v_and_b32 v25, s58, v104
 v_pk_mul_f32 v[24:25], v[24:25], v[18:19] op_sel:[0,1] op_sel_hi:[1,1]
 v_pk_fma_f32 v[208:209], v[208:209], v[16:17], v[24:25] op_sel:[0,1,0] op_sel_hi:[1,1,1]
 v_lshlrev_b32 v26, 16, v105
 v_and_b32 v27, s58, v105
 v_pk_mul_f32 v[26:27], v[26:27], v[18:19] op_sel:[0,1] op_sel_hi:[1,1]
 v_pk_fma_f32 v[210:211], v[210:211], v[16:17], v[26:27] op_sel:[0,1,0] op_sel_hi:[1,1,1]
 v_lshlrev_b32 v28, 16, v106
 v_and_b32 v29, s58, v106
 v_pk_mul_f32 v[28:29], v[28:29], v[18:19] op_sel:[0,1] op_sel_hi:[1,1]
 v_pk_fma_f32 v[212:213], v[212:213], v[16:17], v[28:29] op_sel:[0,1,0] op_sel_hi:[1,1,1]
 v_lshlrev_b32 v30, 16, v107
 v_and_b32 v31, s58, v107
 v_pk_mul_f32 v[30:31], v[30:31], v[18:19] op_sel:[0,1] op_sel_hi:[1,1]
 v_pk_fma_f32 v[214:215], v[214:215], v[16:17], v[30:31] op_sel:[0,1,0] op_sel_hi:[1,1,1]
 v_cvt_pk_bf16_f32 v208, v208, v209
 v_cvt_pk_bf16_f32 v209, v210, v211
 v_cvt_pk_bf16_f32 v210, v212, v213
 v_cvt_pk_bf16_f32 v211, v214, v215
 v_lshlrev_b32 v24, 16, v108
 v_and_b32 v25, s58, v108
 v_pk_mul_f32 v[24:25], v[24:25], v[18:19] op_sel:[0,1] op_sel_hi:[1,1]
 v_pk_fma_f32 v[216:217], v[216:217], v[16:17], v[24:25] op_sel:[0,1,0] op_sel_hi:[1,1,1]
 v_lshlrev_b32 v26, 16, v109
 v_and_b32 v27, s58, v109
 v_pk_mul_f32 v[26:27], v[26:27], v[18:19] op_sel:[0,1] op_sel_hi:[1,1]
 v_pk_fma_f32 v[218:219], v[218:219], v[16:17], v[26:27] op_sel:[0,1,0] op_sel_hi:[1,1,1]
 v_lshlrev_b32 v28, 16, v110
 v_and_b32 v29, s58, v110
 v_pk_mul_f32 v[28:29], v[28:29], v[18:19] op_sel:[0,1] op_sel_hi:[1,1]
 v_pk_fma_f32 v[220:221], v[220:221], v[16:17], v[28:29] op_sel:[0,1,0] op_sel_hi:[1,1,1]
 v_lshlrev_b32 v30, 16, v111
 v_and_b32 v31, s58, v111
 v_pk_mul_f32 v[30:31], v[30:31], v[18:19] op_sel:[0,1] op_sel_hi:[1,1]
 v_pk_fma_f32 v[222:223], v[222:223], v[16:17], v[30:31] op_sel:[0,1,0] op_sel_hi:[1,1,1]
 v_cvt_pk_bf16_f32 v216, v216, v217
 v_cvt_pk_bf16_f32 v217, v218, v219
 v_cvt_pk_bf16_f32 v218, v220, v221
 v_cvt_pk_bf16_f32 v219, v222, v223
 v_lshlrev_b32 v24, 16, v112
 v_and_b32 v25, s58, v112
 v_pk_mul_f32 v[24:25], v[24:25], v[18:19] op_sel:[0,1] op_sel_hi:[1,1]
 v_pk_fma_f32 v[224:225], v[224:225], v[16:17], v[24:25] op_sel:[0,1,0] op_sel_hi:[1,1,1]
 v_lshlrev_b32 v26, 16, v113
 v_and_b32 v27, s58, v113
 v_pk_mul_f32 v[26:27], v[26:27], v[18:19] op_sel:[0,1] op_sel_hi:[1,1]
 v_pk_fma_f32 v[226:227], v[226:227], v[16:17], v[26:27] op_sel:[0,1,0] op_sel_hi:[1,1,1]
 v_lshlrev_b32 v28, 16, v114
 v_and_b32 v29, s58, v114
 v_pk_mul_f32 v[28:29], v[28:29], v[18:19] op_sel:[0,1] op_sel_hi:[1,1]
 v_pk_fma_f32 v[228:229], v[228:229], v[16:17], v[28:29] op_sel:[0,1,0] op_sel_hi:[1,1,1]
 v_lshlrev_b32 v30, 16, v115
 v_and_b32 v31, s58, v115
 v_pk_mul_f32 v[30:31], v[30:31], v[18:19] op_sel:[0,1] op_sel_hi:[1,1]
 v_pk_fma_f32 v[230:231], v[230:231], v[16:17], v[30:31] op_sel:[0,1,0] op_sel_hi:[1,1,1]
 v_cvt_pk_bf16_f32 v224, v224, v225
 v_cvt_pk_bf16_f32 v225, v226, v227
 v_cvt_pk_bf16_f32 v226, v228, v229
 v_cvt_pk_bf16_f32 v227, v230, v231
 v_lshlrev_b32 v24, 16, v116
 v_and_b32 v25, s58, v116
 v_pk_mul_f32 v[24:25], v[24:25], v[18:19] op_sel:[0,1] op_sel_hi:[1,1]
 v_pk_fma_f32 v[232:233], v[232:233], v[16:17], v[24:25] op_sel:[0,1,0] op_sel_hi:[1,1,1]
 v_lshlrev_b32 v26, 16, v117
 v_and_b32 v27, s58, v117
 v_pk_mul_f32 v[26:27], v[26:27], v[18:19] op_sel:[0,1] op_sel_hi:[1,1]
 v_pk_fma_f32 v[234:235], v[234:235], v[16:17], v[26:27] op_sel:[0,1,0] op_sel_hi:[1,1,1]
 v_lshlrev_b32 v28, 16, v118
 v_and_b32 v29, s58, v118
 v_pk_mul_f32 v[28:29], v[28:29], v[18:19] op_sel:[0,1] op_sel_hi:[1,1]
 v_pk_fma_f32 v[236:237], v[236:237], v[16:17], v[28:29] op_sel:[0,1,0] op_sel_hi:[1,1,1]
 v_lshlrev_b32 v30, 16, v119
 v_and_b32 v31, s58, v119
 v_pk_mul_f32 v[30:31], v[30:31], v[18:19] op_sel:[0,1] op_sel_hi:[1,1]
 v_pk_fma_f32 v[238:239], v[238:239], v[16:17], v[30:31] op_sel:[0,1,0] op_sel_hi:[1,1,1]
 v_cvt_pk_bf16_f32 v232, v232, v233
 v_cvt_pk_bf16_f32 v233, v234, v235
 v_cvt_pk_bf16_f32 v234, v236, v237
 v_cvt_pk_bf16_f32 v235, v238, v239
 v_lshlrev_b32 v24, 16, v120
 v_and_b32 v25, s58, v120
 v_pk_mul_f32 v[24:25], v[24:25], v[18:19] op_sel:[0,1] op_sel_hi:[1,1]
 v_pk_fma_f32 v[240:241], v[240:241], v[16:17], v[24:25] op_sel:[0,1,0] op_sel_hi:[1,1,1]
 v_lshlrev_b32 v26, 16, v121
 v_and_b32 v27, s58, v121
 v_pk_mul_f32 v[26:27], v[26:27], v[18:19] op_sel:[0,1] op_sel_hi:[1,1]
 v_pk_fma_f32 v[242:243], v[242:243], v[16:17], v[26:27] op_sel:[0,1,0] op_sel_hi:[1,1,1]
 v_lshlrev_b32 v28, 16, v122
 v_and_b32 v29, s58, v122
 v_pk_mul_f32 v[28:29], v[28:29], v[18:19] op_sel:[0,1] op_sel_hi:[1,1]
 v_pk_fma_f32 v[244:245], v[244:245], v[16:17], v[28:29] op_sel:[0,1,0] op_sel_hi:[1,1,1]
 v_lshlrev_b32 v30, 16, v123
 v_and_b32 v31, s58, v123
 v_pk_mul_f32 v[30:31], v[30:31], v[18:19] op_sel:[0,1] op_sel_hi:[1,1]
 v_pk_fma_f32 v[246:247], v[246:247], v[16:17], v[30:31] op_sel:[0,1,0] op_sel_hi:[1,1,1]
 v_cvt_pk_bf16_f32 v240, v240, v241
 v_cvt_pk_bf16_f32 v241, v242, v243
 v_cvt_pk_bf16_f32 v242, v244, v245
 v_cvt_pk_bf16_f32 v243, v246, v247
 v_lshlrev_b32 v24, 16, v124
 v_and_b32 v25, s58, v124
 v_pk_mul_f32 v[24:25], v[24:25], v[18:19] op_sel:[0,1] op_sel_hi:[1,1]
 v_pk_fma_f32 v[248:249], v[248:249], v[16:17], v[24:25] op_sel:[0,1,0] op_sel_hi:[1,1,1]
 v_lshlrev_b32 v26, 16, v125
 v_and_b32 v27, s58, v125
 v_pk_mul_f32 v[26:27], v[26:27], v[18:19] op_sel:[0,1] op_sel_hi:[1,1]
 v_pk_fma_f32 v[250:251], v[250:251], v[16:17], v[26:27] op_sel:[0,1,0] op_sel_hi:[1,1,1]
 v_lshlrev_b32 v28, 16, v126
 v_and_b32 v29, s58, v126
 v_pk_mul_f32 v[28:29], v[28:29], v[18:19] op_sel:[0,1] op_sel_hi:[1,1]
 v_pk_fma_f32 v[252:253], v[252:253], v[16:17], v[28:29] op_sel:[0,1,0] op_sel_hi:[1,1,1]
 v_lshlrev_b32 v30, 16, v127
 v_and_b32 v31, s58, v127
 v_pk_mul_f32 v[30:31], v[30:31], v[18:19] op_sel:[0,1] op_sel_hi:[1,1]
 v_pk_fma_f32 v[254:255], v[254:255], v[16:17], v[30:31] op_sel:[0,1,0] op_sel_hi:[1,1,1]
 v_cvt_pk_bf16_f32 v248, v248, v249
 v_cvt_pk_bf16_f32 v249, v250, v251
 v_cvt_pk_bf16_f32 v250, v252, v253
 v_cvt_pk_bf16_f32 v251, v254, v255
L_attdone:
 v_lshrrev_b32 v8, 2, v0
 v_lshlrev_b32 v4, 7, v8
 v_bfe_u32 v8, v8, 1, 2
 v_lshl_add_u32 v4, v8, 5, v4
 v_and_b32 v8, 3, v0
 v_lshl_add_u32 v4, v8, 3, v4
 v_add_u32 v4, 131072, v4
 s_barrier
 ds_read_b64_tr_b16 a[0:1], v4 offset:0
 ds_read_b64_tr_b16 a[2:3], v4 offset:2048
 ds_read_b64_tr_b16 a[4:5], v4 offset:4096
 ds_read_b64_tr_b16 a[6:7], v4 offset:6144
 ds_read_b64_tr_b16 a[8:9], v4 offset:8192
 ds_read_b64_tr_b16 a[10:11], v4 offset:10240
 ds_read_b64_tr_b16 a[12:13], v4 offset:12288
 ds_read_b64_tr_b16 a[14:15], v4 offset:14336
 ds_read_b64_tr_b16 a[16:17], v4 offset:16384
 ds_read_b64_tr_b16 a[18:19], v4 offset:18432
 ds_read_b64_tr_b16 a[20:21], v4 offset:20480
 ds_read_b64_tr_b16 a[22:23], v4 offset:22528
 ds_read_b64_tr_b16 a[24:25], v4 offset:24576
 ds_read_b64_tr_b16 a[26:27], v4 offset:26624
 v_xor_b32 v5, 32, v4
 v_xor_b32 v6, 64, v4
 v_xor_b32 v7, 96, v4
 v_and_b32 v10, 15, v0
 v_lshlrev_b32 v10, 2, v10
 s_cmp_lt_u32 s28, 14
 s_cselect_b32 s52, 0, 1
 s_mov_b32 s53, 0
 v_accvgpr_read_b32 v9, a245
 s_lshl_b32 s48, s63, 3
 s_add_u32 s48, s48, s3
 s_mul_i32 s48, s48, 243712
 s_lshl_b32 s58, s26, 10
 s_add_u32 s48, s48, s58
 s_add_u32 s48, s48, 117440512
 s_waitcnt lgkmcnt(7)
 v_mfma_f32_16x16x32_bf16 v[72:75], a[0:3], v[128:131], 0
 ds_read_b64_tr_b16 a[28:29], v4 offset:28672
 v_mfma_f32_16x16x32_bf16 v[72:75], a[4:7], v[136:139], v[72:75]
 ds_read_b64_tr_b16 a[30:31], v4 offset:30720
 v_mfma_f32_16x16x32_bf16 v[72:75], a[8:11], v[144:147], v[72:75]
 s_waitcnt lgkmcnt(4)
 ds_read_b64_tr_b16 a[32:33], v5 offset:0
 v_mfma_f32_16x16x32_bf16 v[72:75], a[12:15], v[152:155], v[72:75]
 s_add_u32 m0, s29, 32768
 ds_read_b64_tr_b16 a[34:35], v5 offset:2048
 v_mfma_f32_16x16x32_bf16 v[72:75], a[16:19], v[160:163], v[72:75]
 ds_read_b64_tr_b16 a[36:37], v5 offset:4096
 buffer_load_dwordx4 v2, s[8:11], s78 offen lds
 v_mfma_f32_16x16x32_bf16 v[72:75], a[20:23], v[168:171], v[72:75]
 s_waitcnt lgkmcnt(3)
 ds_read_b64_tr_b16 a[38:39], v5 offset:6144
 v_mfma_f32_16x16x32_bf16 v[72:75], a[24:27], v[176:179], v[72:75]
 ds_read_b64_tr_b16 a[40:41], v5 offset:8192
 v_mfma_f32_16x16x32_bf16 v[72:75], a[28:31], v[184:187], v[72:75]
 ds_read_b64_tr_b16 a[42:43], v5 offset:10240
 v_mfma_f32_16x16x32_bf16 v[80:83], a[0:3], v[192:195], 0
 ds_read_b64_tr_b16 a[44:45], v5 offset:12288
 v_mfma_f32_16x16x32_bf16 v[80:83], a[4:7], v[200:203], v[80:83]
 ds_read_b64_tr_b16 a[46:47], v5 offset:14336
 v_mfma_f32_16x16x32_bf16 v[80:83], a[8:11], v[208:211], v[80:83]
 s_add_u32 m0, s29, 36864
 ds_read_b64_tr_b16 a[48:49], v5 offset:16384
 v_mfma_f32_16x16x32_bf16 v[80:83], a[12:15], v[216:219], v[80:83]
 ds_read_b64_tr_b16 a[50:51], v5 offset:18432
 buffer_load_dwordx4 v2, s[8:11], s79 offen lds
 v_mfma_f32_16x16x32_bf16 v[80:83], a[16:19], v[224:227], v[80:83]
 ds_read_b64_tr_b16 a[52:53], v5 offset:20480
 v_mul_f32 v72, v72, v64
 v_mfma_f32_16x16x32_bf16 v[80:83], a[20:23], v[232:235], v[80:83]
 ds_read_b64_tr_b16 a[54:55], v5 offset:22528
 v_mul_f32 v73, v73, v64
 v_mfma_f32_16x16x32_bf16 v[80:83], a[24:27], v[240:243], v[80:83]
 ds_read_b64_tr_b16 a[56:57], v5 offset:24576
 v_mul_f32 v74, v74, v64
 v_mfma_f32_16x16x32_bf16 v[80:83], a[28:31], v[248:251], v[80:83]
 s_waitcnt lgkmcnt(7)
 ds_read_b64_tr_b16 a[58:59], v5 offset:26624
 v_mul_f32 v75, v75, v64
 v_mfma_f32_16x16x32_bf16 v[76:79], a[32:35], v[128:131], 0
 ds_read_b64_tr_b16 a[60:61], v5 offset:28672
 v_mfma_f32_16x16x32_bf16 v[76:79], a[36:39], v[136:139], v[76:79]
 s_add_u32 m0, s29, 40960
 ds_read_b64_tr_b16 a[62:63], v5 offset:30720
 v_mfma_f32_16x16x32_bf16 v[76:79], a[40:43], v[144:147], v[76:79]
 s_waitcnt lgkmcnt(4)
 ds_read_b64_tr_b16 a[0:1], v6 offset:0
 buffer_load_dwordx4 v2, s[8:11], s80 offen lds
 v_mfma_f32_16x16x32_bf16 v[76:79], a[44:47], v[152:155], v[76:79]
 ds_read_b64_tr_b16 a[2:3], v6 offset:2048
 v_mfma_f32_16x16x32_bf16 v[76:79], a[48:51], v[160:163], v[76:79]
 ds_read_b64_tr_b16 a[4:5], v6 offset:4096
 v_mul_f32 v80, v80, v65
 v_mfma_f32_16x16x32_bf16 v[76:79], a[52:55], v[168:171], v[76:79]
 s_waitcnt lgkmcnt(3)
 ds_read_b64_tr_b16 a[6:7], v6 offset:6144
 v_mul_f32 v81, v81, v65
 v_mfma_f32_16x16x32_bf16 v[76:79], a[56:59], v[176:179], v[76:79]
 ds_read_b64_tr_b16 a[8:9], v6 offset:8192
 v_mul_f32 v82, v82, v65
 v_mfma_f32_16x16x32_bf16 v[76:79], a[60:63], v[184:187], v[76:79]
 ds_read_b64_tr_b16 a[10:11], v6 offset:10240
 v_mul_f32 v83, v83, v65
 v_mfma_f32_16x16x32_bf16 v[84:87], a[32:35], v[192:195], 0
 s_add_u32 m0, s29, 45056
 ds_read_b64_tr_b16 a[12:13], v6 offset:12288
 v_mfma_f32_16x16x32_bf16 v[84:87], a[36:39], v[200:203], v[84:87]
 ds_read_b64_tr_b16 a[14:15], v6 offset:14336
 buffer_load_dwordx4 v2, s[8:11], s81 offen lds
 v_mfma_f32_16x16x32_bf16 v[84:87], a[40:43], v[208:211], v[84:87]
 ds_read_b64_tr_b16 a[16:17], v6 offset:16384
 v_mfma_f32_16x16x32_bf16 v[84:87], a[44:47], v[216:219], v[84:87]
 ds_read_b64_tr_b16 a[18:19], v6 offset:18432
 v_mfma_f32_16x16x32_bf16 v[84:87], a[48:51], v[224:227], v[84:87]
 ds_read_b64_tr_b16 a[20:21], v6 offset:20480
 v_mul_f32 v76, v76, v64
 v_mfma_f32_16x16x32_bf16 v[84:87], a[52:55], v[232:235], v[84:87]
 ds_read_b64_tr_b16 a[22:23], v6 offset:22528
 v_mul_f32 v77, v77, v64
 v_mfma_f32_16x16x32_bf16 v[84:87], a[56:59], v[240:243], v[84:87]
 s_add_u32 m0, s29, 49152
 ds_read_b64_tr_b16 a[24:25], v6 offset:24576
 v_mul_f32 v78, v78, v64
 v_mfma_f32_16x16x32_bf16 v[84:87], a[60:63], v[248:251], v[84:87]
 s_waitcnt lgkmcnt(7)
 ds_read_b64_tr_b16 a[26:27], v6 offset:26624
 v_mul_f32 v79, v79, v64
 v_mfma_f32_16x16x32_bf16 v[88:91], a[0:3], v[128:131], 0
 ds_read_b64_tr_b16 a[28:29], v6 offset:28672
 buffer_load_dwordx4 v2, s[8:11], s82 offen lds
 v_mfma_f32_16x16x32_bf16 v[88:91], a[4:7], v[136:139], v[88:91]
 s_lshl_b32 s44, s24, 7
 ds_read_b64_tr_b16 a[30:31], v6 offset:30720
 v_cvt_pk_bf16_f32 v72, v72, v73
 v_mfma_f32_16x16x32_bf16 v[88:91], a[8:11], v[144:147], v[88:91]
 s_waitcnt lgkmcnt(4)
 ds_read_b64_tr_b16 a[32:33], v7 offset:0
 v_cvt_pk_bf16_f32 v73, v74, v75
 v_mfma_f32_16x16x32_bf16 v[88:91], a[12:15], v[152:155], v[88:91]
 s_add_u32 s44, s44, 84938752
 ds_read_b64_tr_b16 a[34:35], v7 offset:2048
 v_cvt_pk_bf16_f32 v74, v76, v77
 v_mfma_f32_16x16x32_bf16 v[88:91], a[16:19], v[160:163], v[88:91]
 s_add_u32 s58, s48, 0
 ds_read_b64_tr_b16 a[36:37], v7 offset:4096
 v_cvt_pk_bf16_f32 v75, v78, v79
 v_mfma_f32_16x16x32_bf16 v[88:91], a[20:23], v[168:171], v[88:91]
 s_waitcnt lgkmcnt(3)
 ds_read_b64_tr_b16 a[38:39], v7 offset:6144
 buffer_store_dwordx4 v[72:75], v1, s[12:15], s58 offen sc1
 v_mfma_f32_16x16x32_bf16 v[88:91], a[24:27], v[176:179], v[88:91]
 s_add_u32 m0, s29, 53248
 ds_read_b64_tr_b16 a[40:41], v7 offset:8192
 v_mul_f32 v84, v84, v65
 v_mfma_f32_16x16x32_bf16 v[88:91], a[28:31], v[184:187], v[88:91]
 ds_read_b64_tr_b16 a[42:43], v7 offset:10240
 buffer_load_dwordx4 v2, s[8:11], s83 offen lds
 v_mfma_f32_16x16x32_bf16 v[96:99], a[0:3], v[192:195], 0
 s_lshl_b32 s40, s24, 1
 ds_read_b64_tr_b16 a[44:45], v7 offset:12288
 v_mul_f32 v85, v85, v65
 v_mfma_f32_16x16x32_bf16 v[96:99], a[4:7], v[200:203], v[96:99]
 s_and_b32 s41, s28, 1
 ds_read_b64_tr_b16 a[46:47], v7 offset:14336
 v_mul_f32 v86, v86, v65
 v_mfma_f32_16x16x32_bf16 v[96:99], a[8:11], v[208:211], v[96:99]
 s_add_u32 s40, s40, s41
 ds_read_b64_tr_b16 a[48:49], v7 offset:16384
 v_mul_f32 v87, v87, v65
 v_mfma_f32_16x16x32_bf16 v[96:99], a[12:15], v[216:219], v[96:99]
 s_lshr_b32 s41, s28, 1
 ds_read_b64_tr_b16 a[50:51], v7 offset:18432
 v_cvt_pk_bf16_f32 v80, v80, v81
 v_mfma_f32_16x16x32_bf16 v[96:99], a[16:19], v[224:227], v[96:99]
 s_lshl_b32 s42, s40, 2
 ds_read_b64_tr_b16 a[52:53], v7 offset:20480
 v_cvt_pk_bf16_f32 v81, v82, v83
 v_mfma_f32_16x16x32_bf16 v[96:99], a[20:23], v[232:235], v[96:99]
 s_add_u32 m0, s29, 57344
 ds_read_b64_tr_b16 a[54:55], v7 offset:22528
 v_cvt_pk_bf16_f32 v82, v84, v85
 v_mfma_f32_16x16x32_bf16 v[96:99], a[24:27], v[240:243], v[96:99]
 ds_read_b64_tr_b16 a[56:57], v7 offset:24576
 buffer_load_dwordx4 v2, s[8:11], s84 offen lds
 v_mfma_f32_16x16x32_bf16 v[96:99], a[28:31], v[248:251], v[96:99]
 s_waitcnt lgkmcnt(7)
 ds_read_b64_tr_b16 a[58:59], v7 offset:26624
 v_cvt_pk_bf16_f32 v83, v86, v87
 v_mfma_f32_16x16x32_bf16 v[92:95], a[32:35], v[128:131], 0
 s_add_u32 s42, s42, s3
 ds_read_b64_tr_b16 a[60:61], v7 offset:28672
 v_mul_f32 v88, v88, v64
 v_mfma_f32_16x16x32_bf16 v[92:95], a[36:39], v[136:139], v[92:95]
 s_add_u32 s58, s48, 974848
 ds_read_b64_tr_b16 a[62:63], v7 offset:30720
 v_xor_b32 v4, 0x20000, v4
 v_mfma_f32_16x16x32_bf16 v[92:95], a[40:43], v[144:147], v[92:95]
 s_waitcnt lgkmcnt(4)
 ds_read_b64_tr_b16 a[0:1], v4 offset:0
 buffer_store_dwordx4 v[80:83], v1, s[12:15], s58 offen sc1
 v_mfma_f32_16x16x32_bf16 v[92:95], a[44:47], v[152:155], v[92:95]
 s_mul_i32 s37, s42, 243712
 ds_read_b64_tr_b16 a[2:3], v4 offset:2048
 v_mul_f32 v89, v89, v64
 v_mfma_f32_16x16x32_bf16 v[92:95], a[48:51], v[160:163], v[92:95]
 s_add_u32 m0, s29, 61440
 ds_read_b64_tr_b16 a[4:5], v4 offset:4096
 v_mul_f32 v90, v90, v64
 v_mfma_f32_16x16x32_bf16 v[92:95], a[52:55], v[168:171], v[92:95]
 s_waitcnt lgkmcnt(3)
 ds_read_b64_tr_b16 a[6:7], v4 offset:6144
 buffer_load_dwordx4 v2, s[8:11], s85 offen lds
 v_mfma_f32_16x16x32_bf16 v[92:95], a[56:59], v[176:179], v[92:95]
 s_mul_i32 s43, s41, 17408
 ds_read_b64_tr_b16 a[8:9], v4 offset:8192
 v_add_u32 v2, 128, v2
 v_mfma_f32_16x16x32_bf16 v[92:95], a[60:63], v[184:187], v[92:95]
 s_add_u32 s37, s37, s43
 ds_read_b64_tr_b16 a[10:11], v4 offset:10240
 v_mul_f32 v91, v91, v64
 v_mfma_f32_16x16x32_bf16 v[100:103], a[32:35], v[192:195], 0
 s_add_u32 s37, s37, 117440512
 ds_read_b64_tr_b16 a[12:13], v4 offset:12288
 v_mul_f32 v96, v96, v65
 v_mfma_f32_16x16x32_bf16 v[100:103], a[36:39], v[200:203], v[100:103]
 s_add_u32 s38, s37, 121856
 ds_read_b64_tr_b16 a[14:15], v4 offset:14336
 v_mul_f32 v97, v97, v65
 v_mfma_f32_16x16x32_bf16 v[100:103], a[40:43], v[208:211], v[100:103]
 ds_read_b64_tr_b16 a[16:17], v4 offset:16384
 v_mul_f32 v98, v98, v65
 v_mfma_f32_16x16x32_bf16 v[100:103], a[44:47], v[216:219], v[100:103]
 ds_read_b64_tr_b16 a[18:19], v4 offset:18432
 v_mul_f32 v99, v99, v65
 v_mfma_f32_16x16x32_bf16 v[100:103], a[48:51], v[224:227], v[100:103]
 ds_read_b64_tr_b16 a[20:21], v4 offset:20480
 v_mul_f32 v92, v92, v64
 v_mfma_f32_16x16x32_bf16 v[100:103], a[52:55], v[232:235], v[100:103]
 ds_read_b64_tr_b16 a[22:23], v4 offset:22528
 v_mul_f32 v93, v93, v64
 v_mfma_f32_16x16x32_bf16 v[100:103], a[56:59], v[240:243], v[100:103]
 ds_read_b64_tr_b16 a[24:25], v4 offset:24576
 v_mul_f32 v94, v94, v64
 v_mfma_f32_16x16x32_bf16 v[100:103], a[60:63], v[248:251], v[100:103]
 s_waitcnt lgkmcnt(7)
 ds_read_b64_tr_b16 a[26:27], v4 offset:26624
 v_mul_f32 v95, v95, v64
 v_mfma_f32_16x16x32_bf16 v[104:107], a[0:3], v[128:131], 0
 ds_read_b64_tr_b16 a[28:29], v4 offset:28672
 v_cvt_pk_bf16_f32 v88, v88, v89
 v_mfma_f32_16x16x32_bf16 v[104:107], a[4:7], v[136:139], v[104:107]
 ds_read_b64_tr_b16 a[30:31], v4 offset:30720
 v_xor_b32 v5, 0x20000, v5
 v_mfma_f32_16x16x32_bf16 v[104:107], a[8:11], v[144:147], v[104:107]
 s_waitcnt lgkmcnt(4)
 ds_read_b64_tr_b16 a[32:33], v5 offset:0
 v_cvt_pk_bf16_f32 v89, v90, v91
 v_mfma_f32_16x16x32_bf16 v[104:107], a[12:15], v[152:155], v[104:107]
 s_add_u32 m0, s29, 65536
 ds_read_b64_tr_b16 a[34:35], v5 offset:2048
 v_cvt_pk_bf16_f32 v90, v92, v93
 v_mfma_f32_16x16x32_bf16 v[104:107], a[16:19], v[160:163], v[104:107]
 ds_read_b64_tr_b16 a[36:37], v5 offset:4096
 buffer_load_dwordx4 v2, s[8:11], s78 offen lds
 v_mfma_f32_16x16x32_bf16 v[104:107], a[20:23], v[168:171], v[104:107]
 s_waitcnt lgkmcnt(3)
 ds_read_b64_tr_b16 a[38:39], v5 offset:6144
 v_cvt_pk_bf16_f32 v91, v94, v95
 v_mfma_f32_16x16x32_bf16 v[104:107], a[24:27], v[176:179], v[104:107]
 s_add_u32 s58, s48, 17408
 ds_read_b64_tr_b16 a[40:41], v5 offset:8192
 v_mul_f32 v100, v100, v65
 v_mfma_f32_16x16x32_bf16 v[104:107], a[28:31], v[184:187], v[104:107]
 ds_read_b64_tr_b16 a[42:43], v5 offset:10240
 buffer_store_dwordx4 v[88:91], v1, s[12:15], s58 offen sc1
 v_mfma_f32_16x16x32_bf16 v[112:115], a[0:3], v[192:195], 0
 ds_read_b64_tr_b16 a[44:45], v5 offset:12288
 v_mul_f32 v101, v101, v65
 v_mfma_f32_16x16x32_bf16 v[112:115], a[4:7], v[200:203], v[112:115]
 ds_read_b64_tr_b16 a[46:47], v5 offset:14336
 v_mul_f32 v102, v102, v65
 v_mfma_f32_16x16x32_bf16 v[112:115], a[8:11], v[208:211], v[112:115]
 s_add_u32 m0, s29, 69632
 ds_read_b64_tr_b16 a[48:49], v5 offset:16384
 v_mul_f32 v103, v103, v65
 v_mfma_f32_16x16x32_bf16 v[112:115], a[12:15], v[216:219], v[112:115]
 ds_read_b64_tr_b16 a[50:51], v5 offset:18432
 buffer_load_dwordx4 v2, s[8:11], s79 offen lds
 v_mfma_f32_16x16x32_bf16 v[112:115], a[16:19], v[224:227], v[112:115]
 ds_read_b64_tr_b16 a[52:53], v5 offset:20480
 v_cvt_pk_bf16_f32 v96, v96, v97
 v_mfma_f32_16x16x32_bf16 v[112:115], a[20:23], v[232:235], v[112:115]
 ds_read_b64_tr_b16 a[54:55], v5 offset:22528
 v_cvt_pk_bf16_f32 v97, v98, v99
 v_mfma_f32_16x16x32_bf16 v[112:115], a[24:27], v[240:243], v[112:115]
 s_add_u32 s58, s48, 992256
 ds_read_b64_tr_b16 a[56:57], v5 offset:24576
 v_cvt_pk_bf16_f32 v98, v100, v101
 v_mfma_f32_16x16x32_bf16 v[112:115], a[28:31], v[248:251], v[112:115]
 s_waitcnt lgkmcnt(7)
 ds_read_b64_tr_b16 a[58:59], v5 offset:26624
 v_cvt_pk_bf16_f32 v99, v102, v103
 v_mfma_f32_16x16x32_bf16 v[108:111], a[32:35], v[128:131], 0
 ds_read_b64_tr_b16 a[60:61], v5 offset:28672
 buffer_store_dwordx4 v[96:99], v1, s[12:15], s58 offen sc1
 v_mfma_f32_16x16x32_bf16 v[108:111], a[36:39], v[136:139], v[108:111]
 s_add_u32 m0, s29, 73728
 ds_read_b64_tr_b16 a[62:63], v5 offset:30720
 v_xor_b32 v6, 0x20000, v6
 v_mfma_f32_16x16x32_bf16 v[108:111], a[40:43], v[144:147], v[108:111]
 s_waitcnt lgkmcnt(4)
 ds_read_b64_tr_b16 a[0:1], v6 offset:0
 buffer_load_dwordx4 v2, s[8:11], s80 offen lds
 v_mfma_f32_16x16x32_bf16 v[108:111], a[44:47], v[152:155], v[108:111]
 ds_read_b64_tr_b16 a[2:3], v6 offset:2048
 v_mul_f32 v104, v104, v64
 v_mfma_f32_16x16x32_bf16 v[108:111], a[48:51], v[160:163], v[108:111]
 ds_read_b64_tr_b16 a[4:5], v6 offset:4096
 v_mul_f32 v105, v105, v64
 v_mfma_f32_16x16x32_bf16 v[108:111], a[52:55], v[168:171], v[108:111]
 s_waitcnt lgkmcnt(3)
 ds_read_b64_tr_b16 a[6:7], v6 offset:6144
 v_mul_f32 v106, v106, v64
 v_mfma_f32_16x16x32_bf16 v[108:111], a[56:59], v[176:179], v[108:111]
 ds_read_b64_tr_b16 a[8:9], v6 offset:8192
 v_mul_f32 v107, v107, v64
 v_mfma_f32_16x16x32_bf16 v[108:111], a[60:63], v[184:187], v[108:111]
 ds_read_b64_tr_b16 a[10:11], v6 offset:10240
 v_mul_f32 v112, v112, v65
 v_mfma_f32_16x16x32_bf16 v[116:119], a[32:35], v[192:195], 0
 s_add_u32 m0, s29, 77824
 ds_read_b64_tr_b16 a[12:13], v6 offset:12288
 v_mul_f32 v113, v113, v65
 v_mfma_f32_16x16x32_bf16 v[116:119], a[36:39], v[200:203], v[116:119]
 ds_read_b64_tr_b16 a[14:15], v6 offset:14336
 buffer_load_dwordx4 v2, s[8:11], s81 offen lds
 v_mfma_f32_16x16x32_bf16 v[116:119], a[40:43], v[208:211], v[116:119]
 ds_read_b64_tr_b16 a[16:17], v6 offset:16384
 v_mul_f32 v114, v114, v65
 v_mfma_f32_16x16x32_bf16 v[116:119], a[44:47], v[216:219], v[116:119]
 ds_read_b64_tr_b16 a[18:19], v6 offset:18432
 v_mul_f32 v115, v115, v65
 v_mfma_f32_16x16x32_bf16 v[116:119], a[48:51], v[224:227], v[116:119]
 ds_read_b64_tr_b16 a[20:21], v6 offset:20480
 v_mul_f32 v108, v108, v64
 v_mfma_f32_16x16x32_bf16 v[116:119], a[52:55], v[232:235], v[116:119]
 ds_read_b64_tr_b16 a[22:23], v6 offset:22528
 v_mul_f32 v109, v109, v64
 v_mfma_f32_16x16x32_bf16 v[116:119], a[56:59], v[240:243], v[116:119]
 s_add_u32 m0, s29, 81920
 ds_read_b64_tr_b16 a[24:25], v6 offset:24576
 v_mul_f32 v110, v110, v64
 v_mfma_f32_16x16x32_bf16 v[116:119], a[60:63], v[248:251], v[116:119]
 s_waitcnt lgkmcnt(7)
 ds_read_b64_tr_b16 a[26:27], v6 offset:26624
 v_mul_f32 v111, v111, v64
 v_mfma_f32_16x16x32_bf16 v[72:75], a[0:3], v[128:131], 0
 ds_read_b64_tr_b16 a[28:29], v6 offset:28672
 buffer_load_dwordx4 v2, s[8:11], s82 offen lds
 v_mfma_f32_16x16x32_bf16 v[72:75], a[4:7], v[136:139], v[72:75]
 ds_read_b64_tr_b16 a[30:31], v6 offset:30720
 v_xor_b32 v7, 0x20000, v7
 v_mfma_f32_16x16x32_bf16 v[72:75], a[8:11], v[144:147], v[72:75]
 s_waitcnt lgkmcnt(4)
 ds_read_b64_tr_b16 a[32:33], v7 offset:0
 v_cvt_pk_bf16_f32 v104, v104, v105
 v_mfma_f32_16x16x32_bf16 v[72:75], a[12:15], v[152:155], v[72:75]
 ds_read_b64_tr_b16 a[34:35], v7 offset:2048
 v_cvt_pk_bf16_f32 v105, v106, v107
 v_mfma_f32_16x16x32_bf16 v[72:75], a[16:19], v[160:163], v[72:75]
 ds_read_b64_tr_b16 a[36:37], v7 offset:4096
 v_cvt_pk_bf16_f32 v106, v108, v109
 v_mfma_f32_16x16x32_bf16 v[72:75], a[20:23], v[168:171], v[72:75]
 s_waitcnt lgkmcnt(3)
 ds_read_b64_tr_b16 a[38:39], v7 offset:6144
 v_cvt_pk_bf16_f32 v107, v110, v111
 v_mfma_f32_16x16x32_bf16 v[72:75], a[24:27], v[176:179], v[72:75]
 s_add_u32 m0, s29, 86016
 ds_read_b64_tr_b16 a[40:41], v7 offset:8192
 v_mul_f32 v116, v116, v65
 v_mfma_f32_16x16x32_bf16 v[72:75], a[28:31], v[184:187], v[72:75]
 ds_read_b64_tr_b16 a[42:43], v7 offset:10240
 buffer_load_dwordx4 v2, s[8:11], s83 offen lds
 v_mfma_f32_16x16x32_bf16 v[80:83], a[0:3], v[192:195], 0
 s_add_u32 s58, s48, 34816
 ds_read_b64_tr_b16 a[44:45], v7 offset:12288
 v_mul_f32 v117, v117, v65
 v_mfma_f32_16x16x32_bf16 v[80:83], a[4:7], v[200:203], v[80:83]
 ds_read_b64_tr_b16 a[46:47], v7 offset:14336
 buffer_store_dwordx4 v[104:107], v1, s[12:15], s58 offen sc1
 v_mfma_f32_16x16x32_bf16 v[80:83], a[8:11], v[208:211], v[80:83]
 ds_read_b64_tr_b16 a[48:49], v7 offset:16384
 v_mul_f32 v118, v118, v65
 v_mfma_f32_16x16x32_bf16 v[80:83], a[12:15], v[216:219], v[80:83]
 ds_read_b64_tr_b16 a[50:51], v7 offset:18432
 v_mul_f32 v119, v119, v65
 v_mfma_f32_16x16x32_bf16 v[80:83], a[16:19], v[224:227], v[80:83]
 ds_read_b64_tr_b16 a[52:53], v7 offset:20480
 v_cvt_pk_bf16_f32 v112, v112, v113
 v_mfma_f32_16x16x32_bf16 v[80:83], a[20:23], v[232:235], v[80:83]
 s_add_u32 m0, s29, 90112
 ds_read_b64_tr_b16 a[54:55], v7 offset:22528
 v_cvt_pk_bf16_f32 v113, v114, v115
 v_mfma_f32_16x16x32_bf16 v[80:83], a[24:27], v[240:243], v[80:83]
 ds_read_b64_tr_b16 a[56:57], v7 offset:24576
 buffer_load_dwordx4 v2, s[8:11], s84 offen lds
 v_mfma_f32_16x16x32_bf16 v[80:83], a[28:31], v[248:251], v[80:83]
 s_waitcnt lgkmcnt(7)
 ds_read_b64_tr_b16 a[58:59], v7 offset:26624
 v_cvt_pk_bf16_f32 v114, v116, v117
 v_mfma_f32_16x16x32_bf16 v[76:79], a[32:35], v[128:131], 0
 s_waitcnt vmcnt(10)
 ds_read_b64_tr_b16 a[60:61], v7 offset:28672
 v_cvt_pk_bf16_f32 v115, v118, v119
 v_mfma_f32_16x16x32_bf16 v[76:79], a[36:39], v[136:139], v[76:79]
 s_barrier
 ds_read_b64_tr_b16 a[62:63], v7 offset:30720
 v_mul_f32 v72, v72, v64
 v_mfma_f32_16x16x32_bf16 v[76:79], a[40:43], v[144:147], v[76:79]
 s_waitcnt lgkmcnt(4)
 ds_read_b64_tr_b16 a[0:1], v4 offset:32768
 v_mul_f32 v73, v73, v64
 v_mfma_f32_16x16x32_bf16 v[76:79], a[44:47], v[152:155], v[76:79]
 ds_read_b64_tr_b16 a[2:3], v4 offset:34816
 v_mul_f32 v74, v74, v64
 v_mfma_f32_16x16x32_bf16 v[76:79], a[48:51], v[160:163], v[76:79]
 s_add_u32 m0, s29, 94208
 ds_read_b64_tr_b16 a[4:5], v4 offset:36864
 v_mul_f32 v75, v75, v64
 v_mfma_f32_16x16x32_bf16 v[76:79], a[52:55], v[168:171], v[76:79]
 s_waitcnt lgkmcnt(3)
 ds_read_b64_tr_b16 a[6:7], v4 offset:38912
 buffer_load_dwordx4 v2, s[8:11], s85 offen lds
 v_mfma_f32_16x16x32_bf16 v[76:79], a[56:59], v[176:179], v[76:79]
 s_add_u32 s58, s48, 1009664
 ds_read_b64_tr_b16 a[8:9], v4 offset:40960
 v_add_u32 v2, 128, v2
 v_mfma_f32_16x16x32_bf16 v[76:79], a[60:63], v[184:187], v[76:79]
 ds_read_b64_tr_b16 a[10:11], v4 offset:43008
 buffer_store_dwordx4 v[112:115], v1, s[12:15], s58 offen sc1
 v_mfma_f32_16x16x32_bf16 v[84:87], a[32:35], v[192:195], 0
 ds_read_b64_tr_b16 a[12:13], v4 offset:45056
 v_mul_f32 v80, v80, v65
 v_mfma_f32_16x16x32_bf16 v[84:87], a[36:39], v[200:203], v[84:87]
 ds_read_b64_tr_b16 a[14:15], v4 offset:47104
 v_mul_f32 v81, v81, v65
 v_mfma_f32_16x16x32_bf16 v[84:87], a[40:43], v[208:211], v[84:87]
 ds_read_b64_tr_b16 a[16:17], v4 offset:49152
 v_mul_f32 v82, v82, v65
 v_mfma_f32_16x16x32_bf16 v[84:87], a[44:47], v[216:219], v[84:87]
 ds_read_b64_tr_b16 a[18:19], v4 offset:51200
 v_mul_f32 v83, v83, v65
 v_mfma_f32_16x16x32_bf16 v[84:87], a[48:51], v[224:227], v[84:87]
 ds_read_b64_tr_b16 a[20:21], v4 offset:53248
 v_mul_f32 v76, v76, v64
 v_mfma_f32_16x16x32_bf16 v[84:87], a[52:55], v[232:235], v[84:87]
 ds_read_b64_tr_b16 a[22:23], v4 offset:55296
 v_mul_f32 v77, v77, v64
 v_mfma_f32_16x16x32_bf16 v[84:87], a[56:59], v[240:243], v[84:87]
 ds_read_b64_tr_b16 a[24:25], v4 offset:57344
 v_mul_f32 v78, v78, v64
 v_mfma_f32_16x16x32_bf16 v[84:87], a[60:63], v[248:251], v[84:87]
 s_waitcnt lgkmcnt(7)
 ds_read_b64_tr_b16 a[26:27], v4 offset:59392
 v_mul_f32 v79, v79, v64
 v_mfma_f32_16x16x32_bf16 v[88:91], a[0:3], v[128:131], 0
 ds_read_b64_tr_b16 a[28:29], v4 offset:61440
 v_cvt_pk_bf16_f32 v72, v72, v73
 v_mfma_f32_16x16x32_bf16 v[88:91], a[4:7], v[136:139], v[88:91]
 ds_read_b64_tr_b16 a[30:31], v4 offset:63488
 v_cvt_pk_bf16_f32 v73, v74, v75
 v_mfma_f32_16x16x32_bf16 v[88:91], a[8:11], v[144:147], v[88:91]
 s_waitcnt lgkmcnt(4)
 ds_read_b64_tr_b16 a[32:33], v5 offset:32768
 v_cvt_pk_bf16_f32 v74, v76, v77
 v_mfma_f32_16x16x32_bf16 v[88:91], a[12:15], v[152:155], v[88:91]
 s_add_u32 m0, s29, 98304
 ds_read_b64_tr_b16 a[34:35], v5 offset:34816
 v_cvt_pk_bf16_f32 v75, v78, v79
 v_mfma_f32_16x16x32_bf16 v[88:91], a[16:19], v[160:163], v[88:91]
 ds_read_b64_tr_b16 a[36:37], v5 offset:36864
 buffer_load_dwordx4 v2, s[8:11], s78 offen lds
 v_mfma_f32_16x16x32_bf16 v[88:91], a[20:23], v[168:171], v[88:91]
 s_waitcnt lgkmcnt(3)
 ds_read_b64_tr_b16 a[38:39], v5 offset:38912
 v_mul_f32 v84, v84, v65
 v_mfma_f32_16x16x32_bf16 v[88:91], a[24:27], v[176:179], v[88:91]
 s_add_u32 s58, s48, 52224
 ds_read_b64_tr_b16 a[40:41], v5 offset:40960
 v_mul_f32 v85, v85, v65
 v_mfma_f32_16x16x32_bf16 v[88:91], a[28:31], v[184:187], v[88:91]
 ds_read_b64_tr_b16 a[42:43], v5 offset:43008
 buffer_store_dwordx4 v[72:75], v1, s[12:15], s58 offen sc1
 v_mfma_f32_16x16x32_bf16 v[96:99], a[0:3], v[192:195], 0
 ds_read_b64_tr_b16 a[44:45], v5 offset:45056
 v_mul_f32 v86, v86, v65
 v_mfma_f32_16x16x32_bf16 v[96:99], a[4:7], v[200:203], v[96:99]
 ds_read_b64_tr_b16 a[46:47], v5 offset:47104
 v_mul_f32 v87, v87, v65
 v_mfma_f32_16x16x32_bf16 v[96:99], a[8:11], v[208:211], v[96:99]
 s_add_u32 m0, s29, 102400
 ds_read_b64_tr_b16 a[48:49], v5 offset:49152
 v_cvt_pk_bf16_f32 v80, v80, v81
 v_mfma_f32_16x16x32_bf16 v[96:99], a[12:15], v[216:219], v[96:99]
 ds_read_b64_tr_b16 a[50:51], v5 offset:51200
 buffer_load_dwordx4 v2, s[8:11], s79 offen lds
 v_mfma_f32_16x16x32_bf16 v[96:99], a[16:19], v[224:227], v[96:99]
 ds_read_b64_tr_b16 a[52:53], v5 offset:53248
 v_cvt_pk_bf16_f32 v81, v82, v83
 v_mfma_f32_16x16x32_bf16 v[96:99], a[20:23], v[232:235], v[96:99]
 ds_read_b64_tr_b16 a[54:55], v5 offset:55296
 v_cvt_pk_bf16_f32 v82, v84, v85
 v_mfma_f32_16x16x32_bf16 v[96:99], a[24:27], v[240:243], v[96:99]
 s_add_u32 s58, s48, 1027072
 ds_read_b64_tr_b16 a[56:57], v5 offset:57344
 v_cvt_pk_bf16_f32 v83, v86, v87
 v_mfma_f32_16x16x32_bf16 v[96:99], a[28:31], v[248:251], v[96:99]
 s_waitcnt lgkmcnt(7)
 ds_read_b64_tr_b16 a[58:59], v5 offset:59392
 buffer_store_dwordx4 v[80:83], v1, s[12:15], s58 offen sc1
 v_mfma_f32_16x16x32_bf16 v[92:95], a[32:35], v[128:131], 0
 ds_read_b64_tr_b16 a[60:61], v5 offset:61440
 v_mul_f32 v88, v88, v64
 v_mfma_f32_16x16x32_bf16 v[92:95], a[36:39], v[136:139], v[92:95]
 s_add_u32 m0, s29, 106496
 ds_read_b64_tr_b16 a[62:63], v5 offset:63488
 v_mul_f32 v89, v89, v64
 v_mfma_f32_16x16x32_bf16 v[92:95], a[40:43], v[144:147], v[92:95]
 s_waitcnt lgkmcnt(4)
 ds_read_b64_tr_b16 a[0:1], v6 offset:32768
 buffer_load_dwordx4 v2, s[8:11], s80 offen lds
 v_mfma_f32_16x16x32_bf16 v[92:95], a[44:47], v[152:155], v[92:95]
 ds_read_b64_tr_b16 a[2:3], v6 offset:34816
 v_mul_f32 v90, v90, v64
 v_mfma_f32_16x16x32_bf16 v[92:95], a[48:51], v[160:163], v[92:95]
 ds_read_b64_tr_b16 a[4:5], v6 offset:36864
 v_mul_f32 v91, v91, v64
 v_mfma_f32_16x16x32_bf16 v[92:95], a[52:55], v[168:171], v[92:95]
 s_waitcnt lgkmcnt(3)
 ds_read_b64_tr_b16 a[6:7], v6 offset:38912
 v_mul_f32 v96, v96, v65
 v_mfma_f32_16x16x32_bf16 v[92:95], a[56:59], v[176:179], v[92:95]
 ds_read_b64_tr_b16 a[8:9], v6 offset:40960
 v_mul_f32 v97, v97, v65
 v_mfma_f32_16x16x32_bf16 v[92:95], a[60:63], v[184:187], v[92:95]
 ds_read_b64_tr_b16 a[10:11], v6 offset:43008
 v_mul_f32 v98, v98, v65
 v_mfma_f32_16x16x32_bf16 v[100:103], a[32:35], v[192:195], 0
 s_add_u32 m0, s29, 110592
 ds_read_b64_tr_b16 a[12:13], v6 offset:45056
 v_mul_f32 v99, v99, v65
 v_mfma_f32_16x16x32_bf16 v[100:103], a[36:39], v[200:203], v[100:103]
 ds_read_b64_tr_b16 a[14:15], v6 offset:47104
 buffer_load_dwordx4 v2, s[8:11], s81 offen lds
 v_mfma_f32_16x16x32_bf16 v[100:103], a[40:43], v[208:211], v[100:103]
 ds_read_b64_tr_b16 a[16:17], v6 offset:49152
 v_mfma_f32_16x16x32_bf16 v[100:103], a[44:47], v[216:219], v[100:103]
 ds_read_b64_tr_b16 a[18:19], v6 offset:51200
 v_mfma_f32_16x16x32_bf16 v[100:103], a[48:51], v[224:227], v[100:103]
 ds_read_b64_tr_b16 a[20:21], v6 offset:53248
 v_mul_f32 v92, v92, v64
 v_mfma_f32_16x16x32_bf16 v[100:103], a[52:55], v[232:235], v[100:103]
 ds_read_b64_tr_b16 a[22:23], v6 offset:55296
 v_mul_f32 v93, v93, v64
 v_mfma_f32_16x16x32_bf16 v[100:103], a[56:59], v[240:243], v[100:103]
 s_add_u32 m0, s29, 114688
 ds_read_b64_tr_b16 a[24:25], v6 offset:57344
 v_mul_f32 v94, v94, v64
 v_mfma_f32_16x16x32_bf16 v[100:103], a[60:63], v[248:251], v[100:103]
 s_waitcnt lgkmcnt(7)
 ds_read_b64_tr_b16 a[26:27], v6 offset:59392
 v_mul_f32 v95, v95, v64
 v_mfma_f32_16x16x32_bf16 v[104:107], a[0:3], v[128:131], 0
 ds_read_b64_tr_b16 a[28:29], v6 offset:61440
 buffer_load_dwordx4 v2, s[8:11], s82 offen lds
 v_mfma_f32_16x16x32_bf16 v[104:107], a[4:7], v[136:139], v[104:107]
 ds_read_b64_tr_b16 a[30:31], v6 offset:63488
 v_cvt_pk_bf16_f32 v88, v88, v89
 v_mfma_f32_16x16x32_bf16 v[104:107], a[8:11], v[144:147], v[104:107]
 s_waitcnt lgkmcnt(4)
 ds_read_b64_tr_b16 a[32:33], v7 offset:32768
 v_cvt_pk_bf16_f32 v89, v90, v91
 v_mfma_f32_16x16x32_bf16 v[104:107], a[12:15], v[152:155], v[104:107]
 ds_read_b64_tr_b16 a[34:35], v7 offset:34816
 v_cvt_pk_bf16_f32 v90, v92, v93
 v_mfma_f32_16x16x32_bf16 v[104:107], a[16:19], v[160:163], v[104:107]
 s_add_u32 s58, s48, 69632
 ds_read_b64_tr_b16 a[36:37], v7 offset:36864
 v_cvt_pk_bf16_f32 v91, v94, v95
 v_mfma_f32_16x16x32_bf16 v[104:107], a[20:23], v[168:171], v[104:107]
 s_waitcnt lgkmcnt(3)
 ds_read_b64_tr_b16 a[38:39], v7 offset:38912
 buffer_store_dwordx4 v[88:91], v1, s[12:15], s58 offen sc1
 v_mfma_f32_16x16x32_bf16 v[104:107], a[24:27], v[176:179], v[104:107]
 s_add_u32 m0, s29, 118784
 ds_read_b64_tr_b16 a[40:41], v7 offset:40960
 v_mul_f32 v100, v100, v65
 v_mfma_f32_16x16x32_bf16 v[104:107], a[28:31], v[184:187], v[104:107]
 ds_read_b64_tr_b16 a[42:43], v7 offset:43008
 buffer_load_dwordx4 v2, s[8:11], s83 offen lds
 v_mfma_f32_16x16x32_bf16 v[112:115], a[0:3], v[192:195], 0
 ds_read_b64_tr_b16 a[44:45], v7 offset:45056
 v_mul_f32 v101, v101, v65
 v_mfma_f32_16x16x32_bf16 v[112:115], a[4:7], v[200:203], v[112:115]
 ds_read_b64_tr_b16 a[46:47], v7 offset:47104
 v_mul_f32 v102, v102, v65
 v_mfma_f32_16x16x32_bf16 v[112:115], a[8:11], v[208:211], v[112:115]
 ds_read_b64_tr_b16 a[48:49], v7 offset:49152
 v_mul_f32 v103, v103, v65
 v_mfma_f32_16x16x32_bf16 v[112:115], a[12:15], v[216:219], v[112:115]
 ds_read_b64_tr_b16 a[50:51], v7 offset:51200
 v_cvt_pk_bf16_f32 v96, v96, v97
 v_mfma_f32_16x16x32_bf16 v[112:115], a[16:19], v[224:227], v[112:115]
 ds_read_b64_tr_b16 a[52:53], v7 offset:53248
 v_cvt_pk_bf16_f32 v97, v98, v99
 v_mfma_f32_16x16x32_bf16 v[112:115], a[20:23], v[232:235], v[112:115]
 s_add_u32 m0, s29, 122880
 ds_read_b64_tr_b16 a[54:55], v7 offset:55296
 v_cvt_pk_bf16_f32 v98, v100, v101
 v_mfma_f32_16x16x32_bf16 v[112:115], a[24:27], v[240:243], v[112:115]
 ds_read_b64_tr_b16 a[56:57], v7 offset:57344
 buffer_load_dwordx4 v2, s[8:11], s84 offen lds
 v_mfma_f32_16x16x32_bf16 v[112:115], a[28:31], v[248:251], v[112:115]
 s_waitcnt lgkmcnt(7)
 ds_read_b64_tr_b16 a[58:59], v7 offset:59392
 v_cvt_pk_bf16_f32 v99, v102, v103
 v_mfma_f32_16x16x32_bf16 v[108:111], a[32:35], v[128:131], 0
 s_waitcnt vmcnt(11)
 ds_read_b64_tr_b16 a[60:61], v7 offset:61440
 v_mul_f32 v104, v104, v64
 v_mfma_f32_16x16x32_bf16 v[108:111], a[36:39], v[136:139], v[108:111]
 s_barrier
 ds_read_b64_tr_b16 a[62:63], v7 offset:63488
 v_xor_b32 v4, 0x10000, v4
 v_mfma_f32_16x16x32_bf16 v[108:111], a[40:43], v[144:147], v[108:111]
 s_waitcnt lgkmcnt(4)
 ds_read_b64_tr_b16 a[0:1], v4 offset:0
 v_mul_f32 v105, v105, v64
 v_mfma_f32_16x16x32_bf16 v[108:111], a[44:47], v[152:155], v[108:111]
 ds_read_b64_tr_b16 a[2:3], v4 offset:2048
 v_mul_f32 v106, v106, v64
 v_mfma_f32_16x16x32_bf16 v[108:111], a[48:51], v[160:163], v[108:111]
 s_add_u32 m0, s29, 126976
 ds_read_b64_tr_b16 a[4:5], v4 offset:4096
 v_mul_f32 v107, v107, v64
 v_mfma_f32_16x16x32_bf16 v[108:111], a[52:55], v[168:171], v[108:111]
 s_waitcnt lgkmcnt(3)
 ds_read_b64_tr_b16 a[6:7], v4 offset:6144
 buffer_load_dwordx4 v2, s[8:11], s85 offen lds
 v_mfma_f32_16x16x32_bf16 v[108:111], a[56:59], v[176:179], v[108:111]
 s_add_u32 s58, s48, 1044480
 ds_read_b64_tr_b16 a[8:9], v4 offset:8192
 v_add_u32 v2, 128, v2
 v_mfma_f32_16x16x32_bf16 v[108:111], a[60:63], v[184:187], v[108:111]
 ds_read_b64_tr_b16 a[10:11], v4 offset:10240
 buffer_store_dwordx4 v[96:99], v1, s[12:15], s58 offen sc1
 v_mfma_f32_16x16x32_bf16 v[116:119], a[32:35], v[192:195], 0
 ds_read_b64_tr_b16 a[12:13], v4 offset:12288
 v_mul_f32 v112, v112, v65
 v_mfma_f32_16x16x32_bf16 v[116:119], a[36:39], v[200:203], v[116:119]
 ds_read_b64_tr_b16 a[14:15], v4 offset:14336
 v_mul_f32 v113, v113, v65
 v_mfma_f32_16x16x32_bf16 v[116:119], a[40:43], v[208:211], v[116:119]
 ds_read_b64_tr_b16 a[16:17], v4 offset:16384
 v_mul_f32 v114, v114, v65
 v_mfma_f32_16x16x32_bf16 v[116:119], a[44:47], v[216:219], v[116:119]
 ds_read_b64_tr_b16 a[18:19], v4 offset:18432
 v_mul_f32 v115, v115, v65
 v_mfma_f32_16x16x32_bf16 v[116:119], a[48:51], v[224:227], v[116:119]
 ds_read_b64_tr_b16 a[20:21], v4 offset:20480
 v_mul_f32 v108, v108, v64
 v_mfma_f32_16x16x32_bf16 v[116:119], a[52:55], v[232:235], v[116:119]
 ds_read_b64_tr_b16 a[22:23], v4 offset:22528
 v_mul_f32 v109, v109, v64
 v_mfma_f32_16x16x32_bf16 v[116:119], a[56:59], v[240:243], v[116:119]
 ds_read_b64_tr_b16 a[24:25], v4 offset:24576
 v_mul_f32 v110, v110, v64
 v_mfma_f32_16x16x32_bf16 v[116:119], a[60:63], v[248:251], v[116:119]
 s_waitcnt lgkmcnt(7)
 ds_read_b64_tr_b16 a[26:27], v4 offset:26624
 v_mul_f32 v111, v111, v64
 v_mfma_f32_16x16x32_bf16 v[72:75], a[0:3], v[128:131], 0
 ds_read_b64_tr_b16 a[28:29], v4 offset:28672
 v_cvt_pk_bf16_f32 v104, v104, v105
 v_mfma_f32_16x16x32_bf16 v[72:75], a[4:7], v[136:139], v[72:75]
 ds_read_b64_tr_b16 a[30:31], v4 offset:30720
 v_xor_b32 v5, 0x10000, v5
 v_mfma_f32_16x16x32_bf16 v[72:75], a[8:11], v[144:147], v[72:75]
 s_waitcnt lgkmcnt(4)
 ds_read_b64_tr_b16 a[32:33], v5 offset:0
 v_cvt_pk_bf16_f32 v105, v106, v107
 v_mfma_f32_16x16x32_bf16 v[72:75], a[12:15], v[152:155], v[72:75]
 s_add_u32 m0, s29, 131072
 ds_read_b64_tr_b16 a[34:35], v5 offset:2048
 v_cvt_pk_bf16_f32 v106, v108, v109
 v_mfma_f32_16x16x32_bf16 v[72:75], a[16:19], v[160:163], v[72:75]
 ds_read_b64_tr_b16 a[36:37], v5 offset:4096
 buffer_load_dwordx4 v2, s[8:11], s78 offen lds
 v_mfma_f32_16x16x32_bf16 v[72:75], a[20:23], v[168:171], v[72:75]
 s_waitcnt lgkmcnt(3)
 ds_read_b64_tr_b16 a[38:39], v5 offset:6144
 v_cvt_pk_bf16_f32 v107, v110, v111
 v_mfma_f32_16x16x32_bf16 v[72:75], a[24:27], v[176:179], v[72:75]
 s_add_u32 s58, s48, 87040
 ds_read_b64_tr_b16 a[40:41], v5 offset:8192
 v_mul_f32 v116, v116, v65
 v_mfma_f32_16x16x32_bf16 v[72:75], a[28:31], v[184:187], v[72:75]
 ds_read_b64_tr_b16 a[42:43], v5 offset:10240
 buffer_store_dwordx4 v[104:107], v1, s[12:15], s58 offen sc1
 v_mfma_f32_16x16x32_bf16 v[80:83], a[0:3], v[192:195], 0
 ds_read_b64_tr_b16 a[44:45], v5 offset:12288
 v_mul_f32 v117, v117, v65
 v_mfma_f32_16x16x32_bf16 v[80:83], a[4:7], v[200:203], v[80:83]
 ds_read_b64_tr_b16 a[46:47], v5 offset:14336
 v_mul_f32 v118, v118, v65
 v_mfma_f32_16x16x32_bf16 v[80:83], a[8:11], v[208:211], v[80:83]
 s_add_u32 m0, s29, 135168
 ds_read_b64_tr_b16 a[48:49], v5 offset:16384
 v_mul_f32 v119, v119, v65
 v_mfma_f32_16x16x32_bf16 v[80:83], a[12:15], v[216:219], v[80:83]
 ds_read_b64_tr_b16 a[50:51], v5 offset:18432
 buffer_load_dwordx4 v2, s[8:11], s79 offen lds
 v_mfma_f32_16x16x32_bf16 v[80:83], a[16:19], v[224:227], v[80:83]
 ds_read_b64_tr_b16 a[52:53], v5 offset:20480
 v_cvt_pk_bf16_f32 v112, v112, v113
 v_mfma_f32_16x16x32_bf16 v[80:83], a[20:23], v[232:235], v[80:83]
 ds_read_b64_tr_b16 a[54:55], v5 offset:22528
 v_cvt_pk_bf16_f32 v113, v114, v115
 v_mfma_f32_16x16x32_bf16 v[80:83], a[24:27], v[240:243], v[80:83]
 s_add_u32 s58, s48, 1061888
 ds_read_b64_tr_b16 a[56:57], v5 offset:24576
 v_cvt_pk_bf16_f32 v114, v116, v117
 v_mfma_f32_16x16x32_bf16 v[80:83], a[28:31], v[248:251], v[80:83]
 s_waitcnt lgkmcnt(7)
 ds_read_b64_tr_b16 a[58:59], v5 offset:26624
 v_cvt_pk_bf16_f32 v115, v118, v119
 v_mfma_f32_16x16x32_bf16 v[76:79], a[32:35], v[128:131], 0
 ds_read_b64_tr_b16 a[60:61], v5 offset:28672
 buffer_store_dwordx4 v[112:115], v1, s[12:15], s58 offen sc1
 v_mfma_f32_16x16x32_bf16 v[76:79], a[36:39], v[136:139], v[76:79]
 s_add_u32 m0, s29, 139264
 ds_read_b64_tr_b16 a[62:63], v5 offset:30720
 v_xor_b32 v6, 0x10000, v6
 v_mfma_f32_16x16x32_bf16 v[76:79], a[40:43], v[144:147], v[76:79]
 s_waitcnt lgkmcnt(4)
 ds_read_b64_tr_b16 a[0:1], v6 offset:0
 buffer_load_dwordx4 v2, s[8:11], s80 offen lds
 v_mfma_f32_16x16x32_bf16 v[76:79], a[44:47], v[152:155], v[76:79]
 ds_read_b64_tr_b16 a[2:3], v6 offset:2048
 v_mul_f32 v72, v72, v64
 v_mfma_f32_16x16x32_bf16 v[76:79], a[48:51], v[160:163], v[76:79]
 ds_read_b64_tr_b16 a[4:5], v6 offset:4096
 v_mul_f32 v73, v73, v64
 v_mfma_f32_16x16x32_bf16 v[76:79], a[52:55], v[168:171], v[76:79]
 s_waitcnt lgkmcnt(3)
 ds_read_b64_tr_b16 a[6:7], v6 offset:6144
 v_mul_f32 v74, v74, v64
 v_mfma_f32_16x16x32_bf16 v[76:79], a[56:59], v[176:179], v[76:79]
 ds_read_b64_tr_b16 a[8:9], v6 offset:8192
 v_mul_f32 v75, v75, v64
 v_mfma_f32_16x16x32_bf16 v[76:79], a[60:63], v[184:187], v[76:79]
 ds_read_b64_tr_b16 a[10:11], v6 offset:10240
 v_mul_f32 v80, v80, v65
 v_mfma_f32_16x16x32_bf16 v[84:87], a[32:35], v[192:195], 0
 s_add_u32 m0, s29, 143360
 ds_read_b64_tr_b16 a[12:13], v6 offset:12288
 v_mul_f32 v81, v81, v65
 v_mfma_f32_16x16x32_bf16 v[84:87], a[36:39], v[200:203], v[84:87]
 ds_read_b64_tr_b16 a[14:15], v6 offset:14336
 buffer_load_dwordx4 v2, s[8:11], s81 offen lds
 v_mfma_f32_16x16x32_bf16 v[84:87], a[40:43], v[208:211], v[84:87]
 ds_read_b64_tr_b16 a[16:17], v6 offset:16384
 v_mul_f32 v82, v82, v65
 v_mfma_f32_16x16x32_bf16 v[84:87], a[44:47], v[216:219], v[84:87]
 ds_read_b64_tr_b16 a[18:19], v6 offset:18432
 v_mul_f32 v83, v83, v65
 v_mfma_f32_16x16x32_bf16 v[84:87], a[48:51], v[224:227], v[84:87]
 ds_read_b64_tr_b16 a[20:21], v6 offset:20480
 v_mul_f32 v76, v76, v64
 v_mfma_f32_16x16x32_bf16 v[84:87], a[52:55], v[232:235], v[84:87]
 ds_read_b64_tr_b16 a[22:23], v6 offset:22528
 v_mul_f32 v77, v77, v64
 v_mfma_f32_16x16x32_bf16 v[84:87], a[56:59], v[240:243], v[84:87]
 s_add_u32 m0, s29, 147456
 ds_read_b64_tr_b16 a[24:25], v6 offset:24576
 v_mul_f32 v78, v78, v64
 v_mfma_f32_16x16x32_bf16 v[84:87], a[60:63], v[248:251], v[84:87]
 s_waitcnt lgkmcnt(7)
 ds_read_b64_tr_b16 a[26:27], v6 offset:26624
 v_mul_f32 v79, v79, v64
 v_mfma_f32_16x16x32_bf16 v[88:91], a[0:3], v[128:131], 0
 ds_read_b64_tr_b16 a[28:29], v6 offset:28672
 buffer_load_dwordx4 v2, s[8:11], s82 offen lds
 v_mfma_f32_16x16x32_bf16 v[88:91], a[4:7], v[136:139], v[88:91]
 ds_read_b64_tr_b16 a[30:31], v6 offset:30720
 v_xor_b32 v7, 0x10000, v7
 v_mfma_f32_16x16x32_bf16 v[88:91], a[8:11], v[144:147], v[88:91]
 s_waitcnt lgkmcnt(4)
 ds_read_b64_tr_b16 a[32:33], v7 offset:0
 v_cvt_pk_bf16_f32 v72, v72, v73
 v_mfma_f32_16x16x32_bf16 v[88:91], a[12:15], v[152:155], v[88:91]
 ds_read_b64_tr_b16 a[34:35], v7 offset:2048
 v_cvt_pk_bf16_f32 v73, v74, v75
 v_mfma_f32_16x16x32_bf16 v[88:91], a[16:19], v[160:163], v[88:91]
 ds_read_b64_tr_b16 a[36:37], v7 offset:4096
 v_cvt_pk_bf16_f32 v74, v76, v77
 v_mfma_f32_16x16x32_bf16 v[88:91], a[20:23], v[168:171], v[88:91]
 s_waitcnt lgkmcnt(3)
 ds_read_b64_tr_b16 a[38:39], v7 offset:6144
 v_cvt_pk_bf16_f32 v75, v78, v79
 v_mfma_f32_16x16x32_bf16 v[88:91], a[24:27], v[176:179], v[88:91]
 s_add_u32 m0, s29, 151552
 ds_read_b64_tr_b16 a[40:41], v7 offset:8192
 v_mul_f32 v84, v84, v65
 v_mfma_f32_16x16x32_bf16 v[88:91], a[28:31], v[184:187], v[88:91]
 ds_read_b64_tr_b16 a[42:43], v7 offset:10240
 buffer_load_dwordx4 v2, s[8:11], s83 offen lds
 v_mfma_f32_16x16x32_bf16 v[96:99], a[0:3], v[192:195], 0
 s_add_u32 s58, s48, 104448
 ds_read_b64_tr_b16 a[44:45], v7 offset:12288
 v_mul_f32 v85, v85, v65
 v_mfma_f32_16x16x32_bf16 v[96:99], a[4:7], v[200:203], v[96:99]
 ds_read_b64_tr_b16 a[46:47], v7 offset:14336
 buffer_store_dwordx4 v[72:75], v1, s[12:15], s58 offen sc1
 v_mfma_f32_16x16x32_bf16 v[96:99], a[8:11], v[208:211], v[96:99]
 ds_read_b64_tr_b16 a[48:49], v7 offset:16384
 v_mul_f32 v86, v86, v65
 v_mfma_f32_16x16x32_bf16 v[96:99], a[12:15], v[216:219], v[96:99]
 ds_read_b64_tr_b16 a[50:51], v7 offset:18432
 v_mul_f32 v87, v87, v65
 v_mfma_f32_16x16x32_bf16 v[96:99], a[16:19], v[224:227], v[96:99]
 ds_read_b64_tr_b16 a[52:53], v7 offset:20480
 v_cvt_pk_bf16_f32 v80, v80, v81
 v_mfma_f32_16x16x32_bf16 v[96:99], a[20:23], v[232:235], v[96:99]
 s_add_u32 m0, s29, 155648
 ds_read_b64_tr_b16 a[54:55], v7 offset:22528
 v_cvt_pk_bf16_f32 v81, v82, v83
 v_mfma_f32_16x16x32_bf16 v[96:99], a[24:27], v[240:243], v[96:99]
 ds_read_b64_tr_b16 a[56:57], v7 offset:24576
 buffer_load_dwordx4 v2, s[8:11], s84 offen lds
 v_mfma_f32_16x16x32_bf16 v[96:99], a[28:31], v[248:251], v[96:99]
 s_waitcnt lgkmcnt(7)
 ds_read_b64_tr_b16 a[58:59], v7 offset:26624
 v_cvt_pk_bf16_f32 v82, v84, v85
 v_mfma_f32_16x16x32_bf16 v[92:95], a[32:35], v[128:131], 0
 s_waitcnt vmcnt(11)
 ds_read_b64_tr_b16 a[60:61], v7 offset:28672
 v_cvt_pk_bf16_f32 v83, v86, v87
 v_mfma_f32_16x16x32_bf16 v[92:95], a[36:39], v[136:139], v[92:95]
 s_barrier
 ds_read_b64_tr_b16 a[62:63], v7 offset:30720
 v_mul_f32 v88, v88, v64
 v_mfma_f32_16x16x32_bf16 v[92:95], a[40:43], v[144:147], v[92:95]
 s_waitcnt lgkmcnt(4)
 ds_read_b64_tr_b16 a[0:1], v4 offset:32768
 v_mul_f32 v89, v89, v64
 v_mfma_f32_16x16x32_bf16 v[92:95], a[44:47], v[152:155], v[92:95]
 ds_read_b64_tr_b16 a[2:3], v4 offset:34816
 v_mul_f32 v90, v90, v64
 v_mfma_f32_16x16x32_bf16 v[92:95], a[48:51], v[160:163], v[92:95]
 s_add_u32 m0, s29, 159744
 ds_read_b64_tr_b16 a[4:5], v4 offset:36864
 v_mul_f32 v91, v91, v64
 v_mfma_f32_16x16x32_bf16 v[92:95], a[52:55], v[168:171], v[92:95]
 s_waitcnt lgkmcnt(3)
 ds_read_b64_tr_b16 a[6:7], v4 offset:38912
 buffer_load_dwordx4 v2, s[8:11], s85 offen lds
 v_mfma_f32_16x16x32_bf16 v[92:95], a[56:59], v[176:179], v[92:95]
 s_add_u32 s58, s48, 1079296
 ds_read_b64_tr_b16 a[8:9], v4 offset:40960
 v_add_u32 v2, 128, v2
 v_mfma_f32_16x16x32_bf16 v[92:95], a[60:63], v[184:187], v[92:95]
 ds_read_b64_tr_b16 a[10:11], v4 offset:43008
 buffer_store_dwordx4 v[80:83], v1, s[12:15], s58 offen sc1
 v_mfma_f32_16x16x32_bf16 v[100:103], a[32:35], v[192:195], 0
 ds_read_b64_tr_b16 a[12:13], v4 offset:45056
 v_mul_f32 v96, v96, v65
 v_mfma_f32_16x16x32_bf16 v[100:103], a[36:39], v[200:203], v[100:103]
 ds_read_b64_tr_b16 a[14:15], v4 offset:47104
 v_mul_f32 v97, v97, v65
 v_mfma_f32_16x16x32_bf16 v[100:103], a[40:43], v[208:211], v[100:103]
 ds_read_b64_tr_b16 a[16:17], v4 offset:49152
 v_mul_f32 v98, v98, v65
 v_mfma_f32_16x16x32_bf16 v[100:103], a[44:47], v[216:219], v[100:103]
 ds_read_b64_tr_b16 a[18:19], v4 offset:51200
 v_mul_f32 v99, v99, v65
 v_mfma_f32_16x16x32_bf16 v[100:103], a[48:51], v[224:227], v[100:103]
 ds_read_b64_tr_b16 a[20:21], v4 offset:53248
 v_mul_f32 v92, v92, v64
 v_mfma_f32_16x16x32_bf16 v[100:103], a[52:55], v[232:235], v[100:103]
 ds_read_b64_tr_b16 a[22:23], v4 offset:55296
 v_mul_f32 v93, v93, v64
 v_mfma_f32_16x16x32_bf16 v[100:103], a[56:59], v[240:243], v[100:103]
 ds_read_b64_tr_b16 a[24:25], v4 offset:57344
 v_mul_f32 v94, v94, v64
 v_mfma_f32_16x16x32_bf16 v[100:103], a[60:63], v[248:251], v[100:103]
 s_waitcnt lgkmcnt(7)
 ds_read_b64_tr_b16 a[26:27], v4 offset:59392
 v_mul_f32 v95, v95, v64
 v_mfma_f32_16x16x32_bf16 v[104:107], a[0:3], v[128:131], 0
 ds_read_b64_tr_b16 a[28:29], v4 offset:61440
 v_cvt_pk_bf16_f32 v88, v88, v89
 v_mfma_f32_16x16x32_bf16 v[104:107], a[4:7], v[136:139], v[104:107]
 ds_read_b64_tr_b16 a[30:31], v4 offset:63488
 v_cvt_pk_bf16_f32 v89, v90, v91
 v_mfma_f32_16x16x32_bf16 v[104:107], a[8:11], v[144:147], v[104:107]
 s_waitcnt lgkmcnt(4)
 ds_read_b64_tr_b16 a[32:33], v5 offset:32768
 v_cvt_pk_bf16_f32 v90, v92, v93
 v_mfma_f32_16x16x32_bf16 v[104:107], a[12:15], v[152:155], v[104:107]
 s_add_u32 m0, s29, 0
 ds_read_b64_tr_b16 a[34:35], v5 offset:34816
 v_cvt_pk_bf16_f32 v91, v94, v95
 v_mfma_f32_16x16x32_bf16 v[104:107], a[16:19], v[160:163], v[104:107]
 ds_read_b64_tr_b16 a[36:37], v5 offset:36864
 buffer_load_dwordx4 v2, s[8:11], s78 offen lds
 v_mfma_f32_16x16x32_bf16 v[104:107], a[20:23], v[168:171], v[104:107]
 s_waitcnt lgkmcnt(3)
 ds_read_b64_tr_b16 a[38:39], v5 offset:38912
 v_mul_f32 v100, v100, v65
 v_mfma_f32_16x16x32_bf16 v[104:107], a[24:27], v[176:179], v[104:107]
 s_add_u32 s58, s48, 121856
 ds_read_b64_tr_b16 a[40:41], v5 offset:40960
 v_mul_f32 v101, v101, v65
 v_mfma_f32_16x16x32_bf16 v[104:107], a[28:31], v[184:187], v[104:107]
 ds_read_b64_tr_b16 a[42:43], v5 offset:43008
 buffer_store_dwordx4 v[88:91], v1, s[12:15], s58 offen sc1
 v_mfma_f32_16x16x32_bf16 v[112:115], a[0:3], v[192:195], 0
 ds_read_b64_tr_b16 a[44:45], v5 offset:45056
 v_mul_f32 v102, v102, v65
 v_mfma_f32_16x16x32_bf16 v[112:115], a[4:7], v[200:203], v[112:115]
 ds_read_b64_tr_b16 a[46:47], v5 offset:47104
 v_mul_f32 v103, v103, v65
 v_mfma_f32_16x16x32_bf16 v[112:115], a[8:11], v[208:211], v[112:115]
 s_add_u32 m0, s29, 4096
 ds_read_b64_tr_b16 a[48:49], v5 offset:49152
 v_cvt_pk_bf16_f32 v96, v96, v97
 v_mfma_f32_16x16x32_bf16 v[112:115], a[12:15], v[216:219], v[112:115]
 ds_read_b64_tr_b16 a[50:51], v5 offset:51200
 buffer_load_dwordx4 v2, s[8:11], s79 offen lds
 v_mfma_f32_16x16x32_bf16 v[112:115], a[16:19], v[224:227], v[112:115]
 ds_read_b64_tr_b16 a[52:53], v5 offset:53248
 v_cvt_pk_bf16_f32 v97, v98, v99
 v_mfma_f32_16x16x32_bf16 v[112:115], a[20:23], v[232:235], v[112:115]
 ds_read_b64_tr_b16 a[54:55], v5 offset:55296
 v_cvt_pk_bf16_f32 v98, v100, v101
 v_mfma_f32_16x16x32_bf16 v[112:115], a[24:27], v[240:243], v[112:115]
 s_add_u32 s58, s48, 1096704
 ds_read_b64_tr_b16 a[56:57], v5 offset:57344
 v_cvt_pk_bf16_f32 v99, v102, v103
 v_mfma_f32_16x16x32_bf16 v[112:115], a[28:31], v[248:251], v[112:115]
 s_waitcnt lgkmcnt(7)
 ds_read_b64_tr_b16 a[58:59], v5 offset:59392
 buffer_store_dwordx4 v[96:99], v1, s[12:15], s58 offen sc1
 v_mfma_f32_16x16x32_bf16 v[108:111], a[32:35], v[128:131], 0
 ds_read_b64_tr_b16 a[60:61], v5 offset:61440
 v_mul_f32 v104, v104, v64
 v_mfma_f32_16x16x32_bf16 v[108:111], a[36:39], v[136:139], v[108:111]
 s_add_u32 m0, s29, 8192
 ds_read_b64_tr_b16 a[62:63], v5 offset:63488
 v_mul_f32 v105, v105, v64
 v_mfma_f32_16x16x32_bf16 v[108:111], a[40:43], v[144:147], v[108:111]
 s_waitcnt lgkmcnt(4)
 ds_read_b64_tr_b16 a[0:1], v6 offset:32768
 buffer_load_dwordx4 v2, s[8:11], s80 offen lds
 v_mfma_f32_16x16x32_bf16 v[108:111], a[44:47], v[152:155], v[108:111]
 ds_read_b64_tr_b16 a[2:3], v6 offset:34816
 v_mul_f32 v106, v106, v64
 v_mfma_f32_16x16x32_bf16 v[108:111], a[48:51], v[160:163], v[108:111]
 ds_read_b64_tr_b16 a[4:5], v6 offset:36864
 v_mul_f32 v107, v107, v64
 v_mfma_f32_16x16x32_bf16 v[108:111], a[52:55], v[168:171], v[108:111]
 s_waitcnt lgkmcnt(3)
 ds_read_b64_tr_b16 a[6:7], v6 offset:38912
 v_mul_f32 v112, v112, v65
 v_mfma_f32_16x16x32_bf16 v[108:111], a[56:59], v[176:179], v[108:111]
 ds_read_b64_tr_b16 a[8:9], v6 offset:40960
 v_mul_f32 v113, v113, v65
 v_mfma_f32_16x16x32_bf16 v[108:111], a[60:63], v[184:187], v[108:111]
 ds_read_b64_tr_b16 a[10:11], v6 offset:43008
 v_mul_f32 v114, v114, v65
 v_mfma_f32_16x16x32_bf16 v[116:119], a[32:35], v[192:195], 0
 s_add_u32 m0, s29, 12288
 ds_read_b64_tr_b16 a[12:13], v6 offset:45056
 v_mul_f32 v115, v115, v65
 v_mfma_f32_16x16x32_bf16 v[116:119], a[36:39], v[200:203], v[116:119]
 ds_read_b64_tr_b16 a[14:15], v6 offset:47104
 buffer_load_dwordx4 v2, s[8:11], s81 offen lds
 v_mfma_f32_16x16x32_bf16 v[116:119], a[40:43], v[208:211], v[116:119]
 ds_read_b64_tr_b16 a[16:17], v6 offset:49152
 v_mfma_f32_16x16x32_bf16 v[116:119], a[44:47], v[216:219], v[116:119]
 ds_read_b64_tr_b16 a[18:19], v6 offset:51200
 v_mfma_f32_16x16x32_bf16 v[116:119], a[48:51], v[224:227], v[116:119]
 ds_read_b64_tr_b16 a[20:21], v6 offset:53248
 v_mul_f32 v108, v108, v64
 v_mfma_f32_16x16x32_bf16 v[116:119], a[52:55], v[232:235], v[116:119]
 ds_read_b64_tr_b16 a[22:23], v6 offset:55296
 v_mul_f32 v109, v109, v64
 v_mfma_f32_16x16x32_bf16 v[116:119], a[56:59], v[240:243], v[116:119]
 s_add_u32 m0, s29, 16384
 ds_read_b64_tr_b16 a[24:25], v6 offset:57344
 v_mul_f32 v110, v110, v64
 v_mfma_f32_16x16x32_bf16 v[116:119], a[60:63], v[248:251], v[116:119]
 s_waitcnt lgkmcnt(7)
 ds_read_b64_tr_b16 a[26:27], v6 offset:59392
 v_mul_f32 v111, v111, v64
 v_mfma_f32_16x16x32_bf16 v[72:75], a[0:3], v[128:131], 0
 ds_read_b64_tr_b16 a[28:29], v6 offset:61440
 buffer_load_dwordx4 v2, s[8:11], s82 offen lds
 v_mfma_f32_16x16x32_bf16 v[72:75], a[4:7], v[136:139], v[72:75]
 ds_read_b64_tr_b16 a[30:31], v6 offset:63488
 v_cvt_pk_bf16_f32 v104, v104, v105
 v_mfma_f32_16x16x32_bf16 v[72:75], a[8:11], v[144:147], v[72:75]
 s_waitcnt lgkmcnt(4)
 ds_read_b64_tr_b16 a[32:33], v7 offset:32768
 v_cvt_pk_bf16_f32 v105, v106, v107
 v_mfma_f32_16x16x32_bf16 v[72:75], a[12:15], v[152:155], v[72:75]
 ds_read_b64_tr_b16 a[34:35], v7 offset:34816
 v_cvt_pk_bf16_f32 v106, v108, v109
 v_mfma_f32_16x16x32_bf16 v[72:75], a[16:19], v[160:163], v[72:75]
 s_add_u32 s58, s48, 139264
 ds_read_b64_tr_b16 a[36:37], v7 offset:36864
 v_cvt_pk_bf16_f32 v107, v110, v111
 v_mfma_f32_16x16x32_bf16 v[72:75], a[20:23], v[168:171], v[72:75]
 s_waitcnt lgkmcnt(3)
 ds_read_b64_tr_b16 a[38:39], v7 offset:38912
 buffer_store_dwordx4 v[104:107], v1, s[12:15], s58 offen sc1
 v_mfma_f32_16x16x32_bf16 v[72:75], a[24:27], v[176:179], v[72:75]
 s_add_u32 m0, s29, 20480
 ds_read_b64_tr_b16 a[40:41], v7 offset:40960
 v_mul_f32 v116, v116, v65
 v_mfma_f32_16x16x32_bf16 v[72:75], a[28:31], v[184:187], v[72:75]
 ds_read_b64_tr_b16 a[42:43], v7 offset:43008
 buffer_load_dwordx4 v2, s[8:11], s83 offen lds
 v_mfma_f32_16x16x32_bf16 v[80:83], a[0:3], v[192:195], 0
 ds_read_b64_tr_b16 a[44:45], v7 offset:45056
 v_mul_f32 v117, v117, v65
 v_mfma_f32_16x16x32_bf16 v[80:83], a[4:7], v[200:203], v[80:83]
 ds_read_b64_tr_b16 a[46:47], v7 offset:47104
 v_mul_f32 v118, v118, v65
 v_mfma_f32_16x16x32_bf16 v[80:83], a[8:11], v[208:211], v[80:83]
 ds_read_b64_tr_b16 a[48:49], v7 offset:49152
 v_mul_f32 v119, v119, v65
 v_mfma_f32_16x16x32_bf16 v[80:83], a[12:15], v[216:219], v[80:83]
 ds_read_b64_tr_b16 a[50:51], v7 offset:51200
 v_cvt_pk_bf16_f32 v112, v112, v113
 v_mfma_f32_16x16x32_bf16 v[80:83], a[16:19], v[224:227], v[80:83]
 ds_read_b64_tr_b16 a[52:53], v7 offset:53248
 v_cvt_pk_bf16_f32 v113, v114, v115
 v_mfma_f32_16x16x32_bf16 v[80:83], a[20:23], v[232:235], v[80:83]
 s_add_u32 m0, s29, 24576
 ds_read_b64_tr_b16 a[54:55], v7 offset:55296
 v_cvt_pk_bf16_f32 v114, v116, v117
 v_mfma_f32_16x16x32_bf16 v[80:83], a[24:27], v[240:243], v[80:83]
 ds_read_b64_tr_b16 a[56:57], v7 offset:57344
 buffer_load_dwordx4 v2, s[8:11], s84 offen lds
 v_mfma_f32_16x16x32_bf16 v[80:83], a[28:31], v[248:251], v[80:83]
 s_waitcnt lgkmcnt(7)
 ds_read_b64_tr_b16 a[58:59], v7 offset:59392
 v_cvt_pk_bf16_f32 v115, v118, v119
 v_mfma_f32_16x16x32_bf16 v[76:79], a[32:35], v[128:131], 0
 s_waitcnt vmcnt(10)
 ds_read_b64_tr_b16 a[60:61], v7 offset:61440
 v_mul_f32 v72, v72, v64
 v_mfma_f32_16x16x32_bf16 v[76:79], a[36:39], v[136:139], v[76:79]
 s_barrier
 ds_read_b64_tr_b16 a[62:63], v7 offset:63488
 v_xor_b32 v4, 0x30000, v4
 v_mfma_f32_16x16x32_bf16 v[76:79], a[40:43], v[144:147], v[76:79]
 s_waitcnt lgkmcnt(4)
 ds_read_b64_tr_b16 a[0:1], v4 offset:0
 buffer_store_dword v9, v9, s[12:15], s93 offen offset:64 sc1
 v_mfma_f32_16x16x32_bf16 v[76:79], a[44:47], v[152:155], v[76:79]
 ds_read_b64_tr_b16 a[2:3], v4 offset:2048
 v_mul_f32 v73, v73, v64
 v_mfma_f32_16x16x32_bf16 v[76:79], a[48:51], v[160:163], v[76:79]
 s_add_u32 m0, s29, 28672
 ds_read_b64_tr_b16 a[4:5], v4 offset:4096
 v_mul_f32 v74, v74, v64
 v_mfma_f32_16x16x32_bf16 v[76:79], a[52:55], v[168:171], v[76:79]
 s_waitcnt lgkmcnt(3)
 ds_read_b64_tr_b16 a[6:7], v4 offset:6144
 buffer_load_dwordx4 v2, s[8:11], s85 offen lds
 v_mfma_f32_16x16x32_bf16 v[76:79], a[56:59], v[176:179], v[76:79]
 s_add_u32 s58, s48, 1114112
 ds_read_b64_tr_b16 a[8:9], v4 offset:8192
 v_add_u32 v2, 128, v2
 v_mfma_f32_16x16x32_bf16 v[76:79], a[60:63], v[184:187], v[76:79]
 ds_read_b64_tr_b16 a[10:11], v4 offset:10240
 buffer_store_dwordx4 v[112:115], v1, s[12:15], s58 offen sc1
 v_mfma_f32_16x16x32_bf16 v[84:87], a[32:35], v[192:195], 0
 ds_read_b64_tr_b16 a[12:13], v4 offset:12288
 v_mul_f32 v75, v75, v64
 v_mfma_f32_16x16x32_bf16 v[84:87], a[36:39], v[200:203], v[84:87]
 ds_read_b64_tr_b16 a[14:15], v4 offset:14336
 v_mul_f32 v80, v80, v65
 v_mfma_f32_16x16x32_bf16 v[84:87], a[40:43], v[208:211], v[84:87]
 ds_read_b64_tr_b16 a[16:17], v4 offset:16384
 v_mul_f32 v81, v81, v65
 v_mfma_f32_16x16x32_bf16 v[84:87], a[44:47], v[216:219], v[84:87]
 ds_read_b64_tr_b16 a[18:19], v4 offset:18432
 v_mul_f32 v82, v82, v65
 v_mfma_f32_16x16x32_bf16 v[84:87], a[48:51], v[224:227], v[84:87]
 ds_read_b64_tr_b16 a[20:21], v4 offset:20480
 v_mul_f32 v76, v76, v64
 v_mfma_f32_16x16x32_bf16 v[84:87], a[52:55], v[232:235], v[84:87]
 ds_read_b64_tr_b16 a[22:23], v4 offset:22528
 v_mul_f32 v77, v77, v64
 v_mfma_f32_16x16x32_bf16 v[84:87], a[56:59], v[240:243], v[84:87]
 ds_read_b64_tr_b16 a[24:25], v4 offset:24576
 v_mul_f32 v78, v78, v64
 v_mfma_f32_16x16x32_bf16 v[84:87], a[60:63], v[248:251], v[84:87]
 s_waitcnt lgkmcnt(7)
 ds_read_b64_tr_b16 a[26:27], v4 offset:26624
 v_mul_f32 v79, v79, v64
 v_mfma_f32_16x16x32_bf16 v[88:91], a[0:3], v[128:131], 0
 ds_read_b64_tr_b16 a[28:29], v4 offset:28672
 v_cvt_pk_bf16_f32 v72, v72, v73
 v_mfma_f32_16x16x32_bf16 v[88:91], a[4:7], v[136:139], v[88:91]
 ds_read_b64_tr_b16 a[30:31], v4 offset:30720
 v_xor_b32 v5, 0x30000, v5
 v_mfma_f32_16x16x32_bf16 v[88:91], a[8:11], v[144:147], v[88:91]
 s_waitcnt lgkmcnt(4)
 ds_read_b64_tr_b16 a[32:33], v5 offset:0
 v_cvt_pk_bf16_f32 v73, v74, v75
 v_mfma_f32_16x16x32_bf16 v[88:91], a[12:15], v[152:155], v[88:91]
 ds_read_b64_tr_b16 a[34:35], v5 offset:2048
 v_cvt_pk_bf16_f32 v74, v76, v77
 v_mfma_f32_16x16x32_bf16 v[88:91], a[16:19], v[160:163], v[88:91]
 s_add_u32 s58, s48, 156672
 ds_read_b64_tr_b16 a[36:37], v5 offset:4096
 v_cvt_pk_bf16_f32 v75, v78, v79
 v_mfma_f32_16x16x32_bf16 v[88:91], a[20:23], v[168:171], v[88:91]
 s_waitcnt lgkmcnt(3)
 ds_read_b64_tr_b16 a[38:39], v5 offset:6144
 buffer_store_dwordx4 v[72:75], v1, s[12:15], s58 offen sc1
 v_mfma_f32_16x16x32_bf16 v[88:91], a[24:27], v[176:179], v[88:91]
 ds_read_b64_tr_b16 a[40:41], v5 offset:8192
 v_mul_f32 v83, v83, v65
 v_mfma_f32_16x16x32_bf16 v[88:91], a[28:31], v[184:187], v[88:91]
 ds_read_b64_tr_b16 a[42:43], v5 offset:10240
 v_mul_f32 v84, v84, v65
 v_mfma_f32_16x16x32_bf16 v[96:99], a[0:3], v[192:195], 0
 ds_read_b64_tr_b16 a[44:45], v5 offset:12288
 v_mul_f32 v85, v85, v65
 v_mfma_f32_16x16x32_bf16 v[96:99], a[4:7], v[200:203], v[96:99]
 ds_read_b64_tr_b16 a[46:47], v5 offset:14336
 v_mul_f32 v86, v86, v65
 v_mfma_f32_16x16x32_bf16 v[96:99], a[8:11], v[208:211], v[96:99]
 ds_read_b64_tr_b16 a[48:49], v5 offset:16384
 v_mul_f32 v87, v87, v65
 v_mfma_f32_16x16x32_bf16 v[96:99], a[12:15], v[216:219], v[96:99]
 ds_read_b64_tr_b16 a[50:51], v5 offset:18432
 v_cvt_pk_bf16_f32 v80, v80, v81
 v_mfma_f32_16x16x32_bf16 v[96:99], a[16:19], v[224:227], v[96:99]
 ds_read_b64_tr_b16 a[52:53], v5 offset:20480
 v_cvt_pk_bf16_f32 v81, v82, v83
 v_mfma_f32_16x16x32_bf16 v[96:99], a[20:23], v[232:235], v[96:99]
 ds_read_b64_tr_b16 a[54:55], v5 offset:22528
 v_cvt_pk_bf16_f32 v82, v84, v85
 v_mfma_f32_16x16x32_bf16 v[96:99], a[24:27], v[240:243], v[96:99]
 s_add_u32 s58, s48, 1131520
 ds_read_b64_tr_b16 a[56:57], v5 offset:24576
 v_cvt_pk_bf16_f32 v83, v86, v87
 v_mfma_f32_16x16x32_bf16 v[96:99], a[28:31], v[248:251], v[96:99]
 s_waitcnt lgkmcnt(7)
 ds_read_b64_tr_b16 a[58:59], v5 offset:26624
 buffer_store_dwordx4 v[80:83], v1, s[12:15], s58 offen sc1
 v_mfma_f32_16x16x32_bf16 v[92:95], a[32:35], v[128:131], 0
 ds_read_b64_tr_b16 a[60:61], v5 offset:28672
 v_mul_f32 v88, v88, v64
 v_mfma_f32_16x16x32_bf16 v[92:95], a[36:39], v[136:139], v[92:95]
 ds_read_b64_tr_b16 a[62:63], v5 offset:30720
 v_xor_b32 v6, 0x30000, v6
 v_mfma_f32_16x16x32_bf16 v[92:95], a[40:43], v[144:147], v[92:95]
 s_waitcnt lgkmcnt(4)
 ds_read_b64_tr_b16 a[0:1], v6 offset:0
 v_mul_f32 v89, v89, v64
 v_mfma_f32_16x16x32_bf16 v[92:95], a[44:47], v[152:155], v[92:95]
 ds_read_b64_tr_b16 a[2:3], v6 offset:2048
 v_mul_f32 v90, v90, v64
 v_mfma_f32_16x16x32_bf16 v[92:95], a[48:51], v[160:163], v[92:95]
 ds_read_b64_tr_b16 a[4:5], v6 offset:4096
 v_mul_f32 v91, v91, v64
 v_mfma_f32_16x16x32_bf16 v[92:95], a[52:55], v[168:171], v[92:95]
 s_waitcnt lgkmcnt(3)
 ds_read_b64_tr_b16 a[6:7], v6 offset:6144
 v_mul_f32 v96, v96, v65
 v_mfma_f32_16x16x32_bf16 v[92:95], a[56:59], v[176:179], v[92:95]
 ds_read_b64_tr_b16 a[8:9], v6 offset:8192
 v_mul_f32 v97, v97, v65
 v_mfma_f32_16x16x32_bf16 v[92:95], a[60:63], v[184:187], v[92:95]
 ds_read_b64_tr_b16 a[10:11], v6 offset:10240
 v_mul_f32 v98, v98, v65
 v_mfma_f32_16x16x32_bf16 v[100:103], a[32:35], v[192:195], 0
 ds_read_b64_tr_b16 a[12:13], v6 offset:12288
 v_mul_f32 v99, v99, v65
 v_mfma_f32_16x16x32_bf16 v[100:103], a[36:39], v[200:203], v[100:103]
 ds_read_b64_tr_b16 a[14:15], v6 offset:14336
 v_mfma_f32_16x16x32_bf16 v[100:103], a[40:43], v[208:211], v[100:103]
 ds_read_b64_tr_b16 a[16:17], v6 offset:16384
 v_mfma_f32_16x16x32_bf16 v[100:103], a[44:47], v[216:219], v[100:103]
 ds_read_b64_tr_b16 a[18:19], v6 offset:18432
 v_mfma_f32_16x16x32_bf16 v[100:103], a[48:51], v[224:227], v[100:103]
 ds_read_b64_tr_b16 a[20:21], v6 offset:20480
 v_mul_f32 v92, v92, v64
 v_mfma_f32_16x16x32_bf16 v[100:103], a[52:55], v[232:235], v[100:103]
 ds_read_b64_tr_b16 a[22:23], v6 offset:22528
 v_mul_f32 v93, v93, v64
 v_mfma_f32_16x16x32_bf16 v[100:103], a[56:59], v[240:243], v[100:103]
 ds_read_b64_tr_b16 a[24:25], v6 offset:24576
 v_mul_f32 v94, v94, v64
 v_mfma_f32_16x16x32_bf16 v[100:103], a[60:63], v[248:251], v[100:103]
 s_waitcnt lgkmcnt(7)
 ds_read_b64_tr_b16 a[26:27], v6 offset:26624
 v_mul_f32 v95, v95, v64
 v_mfma_f32_16x16x32_bf16 v[104:107], a[0:3], v[128:131], 0
 ds_read_b64_tr_b16 a[28:29], v6 offset:28672
 v_cvt_pk_bf16_f32 v88, v88, v89
 v_mfma_f32_16x16x32_bf16 v[104:107], a[4:7], v[136:139], v[104:107]
 ds_read_b64_tr_b16 a[30:31], v6 offset:30720
 v_xor_b32 v7, 0x30000, v7
 v_mfma_f32_16x16x32_bf16 v[104:107], a[8:11], v[144:147], v[104:107]
 s_waitcnt lgkmcnt(4)
 ds_read_b64_tr_b16 a[32:33], v7 offset:0
 v_cvt_pk_bf16_f32 v89, v90, v91
 v_mfma_f32_16x16x32_bf16 v[104:107], a[12:15], v[152:155], v[104:107]
 ds_read_b64_tr_b16 a[34:35], v7 offset:2048
 v_cvt_pk_bf16_f32 v90, v92, v93
 v_mfma_f32_16x16x32_bf16 v[104:107], a[16:19], v[160:163], v[104:107]
 s_add_u32 s58, s48, 174080
 ds_read_b64_tr_b16 a[36:37], v7 offset:4096
 v_cvt_pk_bf16_f32 v91, v94, v95
 v_mfma_f32_16x16x32_bf16 v[104:107], a[20:23], v[168:171], v[104:107]
 s_waitcnt lgkmcnt(3)
 ds_read_b64_tr_b16 a[38:39], v7 offset:6144
 buffer_store_dwordx4 v[88:91], v1, s[12:15], s58 offen sc1
 v_mfma_f32_16x16x32_bf16 v[104:107], a[24:27], v[176:179], v[104:107]
 ds_read_b64_tr_b16 a[40:41], v7 offset:8192
 v_mul_f32 v100, v100, v65
 v_mfma_f32_16x16x32_bf16 v[104:107], a[28:31], v[184:187], v[104:107]
 ds_read_b64_tr_b16 a[42:43], v7 offset:10240
 v_mul_f32 v101, v101, v65
 v_mfma_f32_16x16x32_bf16 v[112:115], a[0:3], v[192:195], 0
 ds_read_b64_tr_b16 a[44:45], v7 offset:12288
 v_mul_f32 v102, v102, v65
 v_mfma_f32_16x16x32_bf16 v[112:115], a[4:7], v[200:203], v[112:115]
 ds_read_b64_tr_b16 a[46:47], v7 offset:14336
 v_mul_f32 v103, v103, v65
 v_mfma_f32_16x16x32_bf16 v[112:115], a[8:11], v[208:211], v[112:115]
 ds_read_b64_tr_b16 a[48:49], v7 offset:16384
 v_cvt_pk_bf16_f32 v96, v96, v97
 v_mfma_f32_16x16x32_bf16 v[112:115], a[12:15], v[216:219], v[112:115]
 ds_read_b64_tr_b16 a[50:51], v7 offset:18432
 v_cvt_pk_bf16_f32 v97, v98, v99
 v_mfma_f32_16x16x32_bf16 v[112:115], a[16:19], v[224:227], v[112:115]
 ds_read_b64_tr_b16 a[52:53], v7 offset:20480
 v_cvt_pk_bf16_f32 v98, v100, v101
 v_mfma_f32_16x16x32_bf16 v[112:115], a[20:23], v[232:235], v[112:115]
 s_add_u32 s58, s48, 1148928
 ds_read_b64_tr_b16 a[54:55], v7 offset:22528
 v_cvt_pk_bf16_f32 v99, v102, v103
 v_mfma_f32_16x16x32_bf16 v[112:115], a[24:27], v[240:243], v[112:115]
 ds_read_b64_tr_b16 a[56:57], v7 offset:24576
 buffer_store_dwordx4 v[96:99], v1, s[12:15], s58 offen sc1
 v_mfma_f32_16x16x32_bf16 v[112:115], a[28:31], v[248:251], v[112:115]
 s_waitcnt lgkmcnt(7)
 ds_read_b64_tr_b16 a[58:59], v7 offset:26624
 v_mul_f32 v104, v104, v64
 v_mfma_f32_16x16x32_bf16 v[108:111], a[32:35], v[128:131], 0
 s_waitcnt vmcnt(5)
 ds_read_b64_tr_b16 a[60:61], v7 offset:28672
 v_mul_f32 v105, v105, v64
 v_mfma_f32_16x16x32_bf16 v[108:111], a[36:39], v[136:139], v[108:111]
 s_barrier
 ds_read_b64_tr_b16 a[62:63], v7 offset:30720
 v_xor_b32 v4, 0x20000, v4
 v_mfma_f32_16x16x32_bf16 v[108:111], a[40:43], v[144:147], v[108:111]
 s_waitcnt lgkmcnt(4)
 ds_read_b64_tr_b16 a[0:1], v4 offset:0
 v_mul_f32 v106, v106, v64
 v_mfma_f32_16x16x32_bf16 v[108:111], a[44:47], v[152:155], v[108:111]
 ds_read_b64_tr_b16 a[2:3], v4 offset:2048
 v_mul_f32 v107, v107, v64
 v_mfma_f32_16x16x32_bf16 v[108:111], a[48:51], v[160:163], v[108:111]
 ds_read_b64_tr_b16 a[4:5], v4 offset:4096
 v_mul_f32 v112, v112, v65
 v_mfma_f32_16x16x32_bf16 v[108:111], a[52:55], v[168:171], v[108:111]
 s_waitcnt lgkmcnt(3)
 ds_read_b64_tr_b16 a[6:7], v4 offset:6144
 v_mul_f32 v113, v113, v65
 v_mfma_f32_16x16x32_bf16 v[108:111], a[56:59], v[176:179], v[108:111]
 ds_read_b64_tr_b16 a[8:9], v4 offset:8192
 v_mul_f32 v114, v114, v65
 v_mfma_f32_16x16x32_bf16 v[108:111], a[60:63], v[184:187], v[108:111]
 ds_read_b64_tr_b16 a[10:11], v4 offset:10240
 v_mul_f32 v115, v115, v65
 v_mfma_f32_16x16x32_bf16 v[116:119], a[32:35], v[192:195], 0
 ds_read_b64_tr_b16 a[12:13], v4 offset:12288
 v_mfma_f32_16x16x32_bf16 v[116:119], a[36:39], v[200:203], v[116:119]
 ds_read_b64_tr_b16 a[14:15], v4 offset:14336
 v_mfma_f32_16x16x32_bf16 v[116:119], a[40:43], v[208:211], v[116:119]
 ds_read_b64_tr_b16 a[16:17], v4 offset:16384
 v_mfma_f32_16x16x32_bf16 v[116:119], a[44:47], v[216:219], v[116:119]
 ds_read_b64_tr_b16 a[18:19], v4 offset:18432
 v_mfma_f32_16x16x32_bf16 v[116:119], a[48:51], v[224:227], v[116:119]
 ds_read_b64_tr_b16 a[20:21], v4 offset:20480
 v_mul_f32 v108, v108, v64
 v_mfma_f32_16x16x32_bf16 v[116:119], a[52:55], v[232:235], v[116:119]
 ds_read_b64_tr_b16 a[22:23], v4 offset:22528
 v_mul_f32 v109, v109, v64
 v_mfma_f32_16x16x32_bf16 v[116:119], a[56:59], v[240:243], v[116:119]
 ds_read_b64_tr_b16 a[24:25], v4 offset:24576
 v_mul_f32 v110, v110, v64
 v_mfma_f32_16x16x32_bf16 v[116:119], a[60:63], v[248:251], v[116:119]
 s_waitcnt lgkmcnt(7)
 ds_read_b64_tr_b16 a[26:27], v4 offset:26624
 v_mul_f32 v111, v111, v64
 v_mfma_f32_16x16x32_bf16 v[72:75], a[0:3], v[128:131], 0
 ds_read_b64_tr_b16 a[28:29], v4 offset:28672
 v_cvt_pk_bf16_f32 v104, v104, v105
 v_mfma_f32_16x16x32_bf16 v[72:75], a[4:7], v[136:139], v[72:75]
 ds_read_b64_tr_b16 a[30:31], v4 offset:30720
 v_xor_b32 v5, 0x20000, v5
 v_mfma_f32_16x16x32_bf16 v[72:75], a[8:11], v[144:147], v[72:75]
 s_waitcnt lgkmcnt(4)
 ds_read_b64_tr_b16 a[32:33], v5 offset:0
 v_cvt_pk_bf16_f32 v105, v106, v107
 v_mfma_f32_16x16x32_bf16 v[72:75], a[12:15], v[152:155], v[72:75]
 ds_read_b64_tr_b16 a[34:35], v5 offset:2048
 v_cvt_pk_bf16_f32 v106, v108, v109
 v_mfma_f32_16x16x32_bf16 v[72:75], a[16:19], v[160:163], v[72:75]
 s_add_u32 s58, s48, 191488
 ds_read_b64_tr_b16 a[36:37], v5 offset:4096
 v_cvt_pk_bf16_f32 v107, v110, v111
 v_mfma_f32_16x16x32_bf16 v[72:75], a[20:23], v[168:171], v[72:75]
 s_waitcnt lgkmcnt(3)
 ds_read_b64_tr_b16 a[38:39], v5 offset:6144
 buffer_store_dwordx4 v[104:107], v1, s[12:15], s58 offen sc1
 v_mfma_f32_16x16x32_bf16 v[72:75], a[24:27], v[176:179], v[72:75]
 ds_read_b64_tr_b16 a[40:41], v5 offset:8192
 v_mul_f32 v116, v116, v65
 v_mfma_f32_16x16x32_bf16 v[72:75], a[28:31], v[184:187], v[72:75]
 ds_read_b64_tr_b16 a[42:43], v5 offset:10240
 v_mul_f32 v117, v117, v65
 v_mfma_f32_16x16x32_bf16 v[80:83], a[0:3], v[192:195], 0
 ds_read_b64_tr_b16 a[44:45], v5 offset:12288
 v_mul_f32 v118, v118, v65
 v_mfma_f32_16x16x32_bf16 v[80:83], a[4:7], v[200:203], v[80:83]
 ds_read_b64_tr_b16 a[46:47], v5 offset:14336
 v_mul_f32 v119, v119, v65
 v_mfma_f32_16x16x32_bf16 v[80:83], a[8:11], v[208:211], v[80:83]
 ds_read_b64_tr_b16 a[48:49], v5 offset:16384
 v_cvt_pk_bf16_f32 v112, v112, v113
 v_mfma_f32_16x16x32_bf16 v[80:83], a[12:15], v[216:219], v[80:83]
 ds_read_b64_tr_b16 a[50:51], v5 offset:18432
 v_cvt_pk_bf16_f32 v113, v114, v115
 v_mfma_f32_16x16x32_bf16 v[80:83], a[16:19], v[224:227], v[80:83]
 ds_read_b64_tr_b16 a[52:53], v5 offset:20480
 v_cvt_pk_bf16_f32 v114, v116, v117
 v_mfma_f32_16x16x32_bf16 v[80:83], a[20:23], v[232:235], v[80:83]
 s_add_u32 s58, s48, 1166336
 ds_read_b64_tr_b16 a[54:55], v5 offset:22528
 v_cvt_pk_bf16_f32 v115, v118, v119
 v_mfma_f32_16x16x32_bf16 v[80:83], a[24:27], v[240:243], v[80:83]
 ds_read_b64_tr_b16 a[56:57], v5 offset:24576
 buffer_store_dwordx4 v[112:115], v1, s[12:15], s58 offen sc1
 v_mfma_f32_16x16x32_bf16 v[80:83], a[28:31], v[248:251], v[80:83]
 s_waitcnt lgkmcnt(7)
 ds_read_b64_tr_b16 a[58:59], v5 offset:26624
 v_mul_f32 v72, v72, v64
 v_mfma_f32_16x16x32_bf16 v[76:79], a[32:35], v[128:131], 0
 ds_read_b64_tr_b16 a[60:61], v5 offset:28672
 v_mul_f32 v73, v73, v64
 v_mfma_f32_16x16x32_bf16 v[76:79], a[36:39], v[136:139], v[76:79]
 ds_read_b64_tr_b16 a[62:63], v5 offset:30720
 v_xor_b32 v6, 0x20000, v6
 v_mfma_f32_16x16x32_bf16 v[76:79], a[40:43], v[144:147], v[76:79]
 s_waitcnt lgkmcnt(4)
 ds_read_b64_tr_b16 a[0:1], v6 offset:0
 v_mul_f32 v74, v74, v64
 v_mfma_f32_16x16x32_bf16 v[76:79], a[44:47], v[152:155], v[76:79]
 ds_read_b64_tr_b16 a[2:3], v6 offset:2048
 v_mul_f32 v75, v75, v64
 v_mfma_f32_16x16x32_bf16 v[76:79], a[48:51], v[160:163], v[76:79]
 ds_read_b64_tr_b16 a[4:5], v6 offset:4096
 v_mul_f32 v80, v80, v65
 v_mfma_f32_16x16x32_bf16 v[76:79], a[52:55], v[168:171], v[76:79]
 s_waitcnt lgkmcnt(3)
 ds_read_b64_tr_b16 a[6:7], v6 offset:6144
 v_mul_f32 v81, v81, v65
 v_mfma_f32_16x16x32_bf16 v[76:79], a[56:59], v[176:179], v[76:79]
 ds_read_b64_tr_b16 a[8:9], v6 offset:8192
 v_mul_f32 v82, v82, v65
 v_mfma_f32_16x16x32_bf16 v[76:79], a[60:63], v[184:187], v[76:79]
 ds_read_b64_tr_b16 a[10:11], v6 offset:10240
 v_mul_f32 v83, v83, v65
 v_mfma_f32_16x16x32_bf16 v[84:87], a[32:35], v[192:195], 0
 ds_read_b64_tr_b16 a[12:13], v6 offset:12288
 buffer_load_dword v12, v10, s[12:15], s44 offen sc1
 v_mfma_f32_16x16x32_bf16 v[84:87], a[36:39], v[200:203], v[84:87]
 ds_read_b64_tr_b16 a[14:15], v6 offset:14336
 v_mfma_f32_16x16x32_bf16 v[84:87], a[40:43], v[208:211], v[84:87]
 ds_read_b64_tr_b16 a[16:17], v6 offset:16384
 v_mfma_f32_16x16x32_bf16 v[84:87], a[44:47], v[216:219], v[84:87]
 ds_read_b64_tr_b16 a[18:19], v6 offset:18432
 v_mfma_f32_16x16x32_bf16 v[84:87], a[48:51], v[224:227], v[84:87]
 ds_read_b64_tr_b16 a[20:21], v6 offset:20480
 v_mul_f32 v76, v76, v64
 v_mfma_f32_16x16x32_bf16 v[84:87], a[52:55], v[232:235], v[84:87]
 ds_read_b64_tr_b16 a[22:23], v6 offset:22528
 v_mul_f32 v77, v77, v64
 v_mfma_f32_16x16x32_bf16 v[84:87], a[56:59], v[240:243], v[84:87]
 ds_read_b64_tr_b16 a[24:25], v6 offset:24576
 v_mul_f32 v78, v78, v64
 v_mfma_f32_16x16x32_bf16 v[84:87], a[60:63], v[248:251], v[84:87]
 s_waitcnt lgkmcnt(7)
 ds_read_b64_tr_b16 a[26:27], v6 offset:26624
 v_mul_f32 v79, v79, v64
 v_mfma_f32_16x16x32_bf16 v[88:91], a[0:3], v[128:131], 0
 ds_read_b64_tr_b16 a[28:29], v6 offset:28672
 v_cvt_pk_bf16_f32 v72, v72, v73
 v_mfma_f32_16x16x32_bf16 v[88:91], a[4:7], v[136:139], v[88:91]
 ds_read_b64_tr_b16 a[30:31], v6 offset:30720
 v_xor_b32 v7, 0x20000, v7
 v_mfma_f32_16x16x32_bf16 v[88:91], a[8:11], v[144:147], v[88:91]
 s_waitcnt lgkmcnt(4)
 ds_read_b64_tr_b16 a[32:33], v7 offset:0
 v_cvt_pk_bf16_f32 v73, v74, v75
 v_mfma_f32_16x16x32_bf16 v[88:91], a[12:15], v[152:155], v[88:91]
 ds_read_b64_tr_b16 a[34:35], v7 offset:2048
 v_cvt_pk_bf16_f32 v74, v76, v77
 v_mfma_f32_16x16x32_bf16 v[88:91], a[16:19], v[160:163], v[88:91]
 s_add_u32 s58, s48, 208896
 ds_read_b64_tr_b16 a[36:37], v7 offset:4096
 v_cvt_pk_bf16_f32 v75, v78, v79
 v_mfma_f32_16x16x32_bf16 v[88:91], a[20:23], v[168:171], v[88:91]
 s_waitcnt lgkmcnt(3)
 ds_read_b64_tr_b16 a[38:39], v7 offset:6144
 buffer_store_dwordx4 v[72:75], v1, s[12:15], s58 offen sc1
 v_mfma_f32_16x16x32_bf16 v[88:91], a[24:27], v[176:179], v[88:91]
 ds_read_b64_tr_b16 a[40:41], v7 offset:8192
 v_mul_f32 v84, v84, v65
 v_mfma_f32_16x16x32_bf16 v[88:91], a[28:31], v[184:187], v[88:91]
 ds_read_b64_tr_b16 a[42:43], v7 offset:10240
 v_mul_f32 v85, v85, v65
 v_mfma_f32_16x16x32_bf16 v[96:99], a[0:3], v[192:195], 0
 ds_read_b64_tr_b16 a[44:45], v7 offset:12288
 v_mul_f32 v86, v86, v65
 v_mfma_f32_16x16x32_bf16 v[96:99], a[4:7], v[200:203], v[96:99]
 ds_read_b64_tr_b16 a[46:47], v7 offset:14336
 v_mul_f32 v87, v87, v65
 v_mfma_f32_16x16x32_bf16 v[96:99], a[8:11], v[208:211], v[96:99]
 ds_read_b64_tr_b16 a[48:49], v7 offset:16384
 v_cvt_pk_bf16_f32 v80, v80, v81
 v_mfma_f32_16x16x32_bf16 v[96:99], a[12:15], v[216:219], v[96:99]
 ds_read_b64_tr_b16 a[50:51], v7 offset:18432
 v_cvt_pk_bf16_f32 v81, v82, v83
 v_mfma_f32_16x16x32_bf16 v[96:99], a[16:19], v[224:227], v[96:99]
 ds_read_b64_tr_b16 a[52:53], v7 offset:20480
 v_cvt_pk_bf16_f32 v82, v84, v85
 v_mfma_f32_16x16x32_bf16 v[96:99], a[20:23], v[232:235], v[96:99]
 s_add_u32 s58, s48, 1183744
 ds_read_b64_tr_b16 a[54:55], v7 offset:22528
 v_cvt_pk_bf16_f32 v83, v86, v87
 v_mfma_f32_16x16x32_bf16 v[96:99], a[24:27], v[240:243], v[96:99]
 ds_read_b64_tr_b16 a[56:57], v7 offset:24576
 buffer_store_dwordx4 v[80:83], v1, s[12:15], s58 offen sc1
 v_mfma_f32_16x16x32_bf16 v[96:99], a[28:31], v[248:251], v[96:99]
 s_waitcnt lgkmcnt(7)
 ds_read_b64_tr_b16 a[58:59], v7 offset:26624
 v_mul_f32 v88, v88, v64
 v_mfma_f32_16x16x32_bf16 v[92:95], a[32:35], v[128:131], 0
 ds_read_b64_tr_b16 a[60:61], v7 offset:28672
 v_mul_f32 v89, v89, v64
 v_mfma_f32_16x16x32_bf16 v[92:95], a[36:39], v[136:139], v[92:95]
 ds_read_b64_tr_b16 a[62:63], v7 offset:30720
 v_mul_f32 v90, v90, v64
 v_mfma_f32_16x16x32_bf16 v[92:95], a[40:43], v[144:147], v[92:95]
 s_waitcnt lgkmcnt(4)
 v_mul_f32 v91, v91, v64
 v_mfma_f32_16x16x32_bf16 v[92:95], a[44:47], v[152:155], v[92:95]
 v_mfma_f32_16x16x32_bf16 v[92:95], a[48:51], v[160:163], v[92:95]
 v_mul_f32 v96, v96, v65
 v_mul_f32 v97, v97, v65
 v_mfma_f32_16x16x32_bf16 v[92:95], a[52:55], v[168:171], v[92:95]
 s_waitcnt lgkmcnt(0)
 v_mul_f32 v98, v98, v65
 v_mul_f32 v99, v99, v65
 v_mfma_f32_16x16x32_bf16 v[92:95], a[56:59], v[176:179], v[92:95]
 v_mfma_f32_16x16x32_bf16 v[92:95], a[60:63], v[184:187], v[92:95]
 v_mfma_f32_16x16x32_bf16 v[100:103], a[32:35], v[192:195], 0
 v_mfma_f32_16x16x32_bf16 v[100:103], a[36:39], v[200:203], v[100:103]
 v_mfma_f32_16x16x32_bf16 v[100:103], a[40:43], v[208:211], v[100:103]
 v_mfma_f32_16x16x32_bf16 v[100:103], a[44:47], v[216:219], v[100:103]
 v_mfma_f32_16x16x32_bf16 v[100:103], a[48:51], v[224:227], v[100:103]
 v_mfma_f32_16x16x32_bf16 v[100:103], a[52:55], v[232:235], v[100:103]
 v_mfma_f32_16x16x32_bf16 v[100:103], a[56:59], v[240:243], v[100:103]
 v_mfma_f32_16x16x32_bf16 v[100:103], a[60:63], v[248:251], v[100:103]
 s_nop 4
 v_mul_f32 v92, v92, v64
 v_mul_f32 v93, v93, v64
 v_mul_f32 v94, v94, v64
 v_mul_f32 v95, v95, v64
 v_cvt_pk_bf16_f32 v88, v88, v89
 v_cvt_pk_bf16_f32 v89, v90, v91
 v_cvt_pk_bf16_f32 v90, v92, v93
 v_cvt_pk_bf16_f32 v91, v94, v95
 s_add_u32 s58, s48, 226304
 buffer_store_dwordx4 v[88:91], v1, s[12:15], s58 offen sc1
 v_mul_f32 v100, v100, v65
 v_mul_f32 v101, v101, v65
 v_mul_f32 v102, v102, v65
 v_mul_f32 v103, v103, v65
 v_cvt_pk_bf16_f32 v96, v96, v97
 v_cvt_pk_bf16_f32 v97, v98, v99
 v_cvt_pk_bf16_f32 v98, v100, v101
 v_cvt_pk_bf16_f32 v99, v102, v103
 s_add_u32 s58, s48, 1201152
 buffer_store_dwordx4 v[96:99], v1, s[12:15], s58 offen sc1
 s_cmp_ge_u32 s28, 14
 s_cbranch_scc1 L_idle
 s_waitcnt vmcnt(4)
 v_cmp_ne_u32 vcc, 0, v12
 s_cmp_eq_u64 vcc, 0
 s_cselect_b32 s50, 1, 0
 s_cselect_b32 s51, s38, 2.0
 s_lshl_b32 s42, s42, 4
 s_lshl_b32 s36, s41, 6
 s_add_u32 s36, s36, 896
 s_add_u32 s35, s36, 1835008
 s_add_u32 s39, s37, 15597568
 s_mov_b32 s8, s88
 s_mov_b32 s9, s89
 s_mov_b32 s10, 3670016
 s_mov_b32 s11, 0x20000
 v_and_b32 v2, 15, v0
 v_add_u32 v2, s42, v2
 v_mul_u32_u24 v7, 896, v2
 v_lshrrev_b32 v3, 4, v0
 v_lshlrev_b32 v8, 4, v3
 v_lshl_add_u32 v2, v7, 1, v8
 v_add_u32 v7, v7, v8
 v_and_b32 v4, 1, v0
 v_lshlrev_b32 v4, 4, v4
 v_mov_b32 v5, 0x3f80
 v_lshlrev_b32 v4, v4, v5
 v_bfe_u32 v5, v0, 3, 1
 v_bfe_u32 v6, v0, 1, 1
 v_lshl_add_u32 v5, v5, 1, v6
 v_bfe_u32 v6, v0, 2, 1
 v_lshlrev_b32 v6, 1, v6
 v_sub_u32 v6, v3, v6
 v_lshl_add_u32 v5, v6, 2, v5
 v_cmp_eq_u32 s[16:17], 0, v5
 v_cmp_eq_u32 s[18:19], 1, v5
 v_cmp_eq_u32 s[20:21], 2, v5
 v_cmp_eq_u32 s[22:23], 3, v5
 v_cndmask_b32 v24, 0, v4, s[16:17]
 v_cndmask_b32 v25, 0, v4, s[18:19]
 v_cndmask_b32 v26, 0, v4, s[20:21]
 v_cndmask_b32 v27, 0, v4, s[22:23]
 v_cmp_eq_u32 s[16:17], 4, v5
 v_cmp_eq_u32 s[18:19], 5, v5
 v_cmp_eq_u32 s[20:21], 6, v5
 v_cmp_eq_u32 s[22:23], 7, v5
 v_cndmask_b32 v28, 0, v4, s[16:17]
 v_cndmask_b32 v29, 0, v4, s[18:19]
 v_cndmask_b32 v30, 0, v4, s[20:21]
 v_cndmask_b32 v31, 0, v4, s[22:23]
 s_add_u32 s45, s44, 1024
 s_add_u32 s39, s39, 121856
 s_waitcnt vmcnt(0)
 s_barrier
 buffer_store_dword v9, v9, s[12:15], s93 offen sc1
 buffer_load_dwordx4 a[128:131], v1, s[12:15], s51 offen offset:0 sc1
 buffer_load_dwordx4 a[132:135], v1, s[12:15], s51 offen offset:1024 sc1
 buffer_load_dwordx4 a[136:139], v1, s[12:15], s51 offen offset:2048 sc1
 buffer_load_dwordx4 a[140:143], v1, s[12:15], s51 offen offset:3072 sc1
 s_add_u32 s51, s51, 4096
 buffer_load_dwordx4 a[144:147], v1, s[12:15], s51 offen offset:0 sc1
 buffer_load_dwordx4 a[148:151], v1, s[12:15], s51 offen offset:1024 sc1
 buffer_load_dwordx4 a[152:155], v1, s[12:15], s51 offen offset:2048 sc1
 buffer_load_dwordx4 a[156:159], v1, s[12:15], s51 offen offset:3072 sc1
 s_add_u32 s51, s51, 4096
 buffer_load_dwordx4 a[160:163], v1, s[12:15], s51 offen offset:0 sc1
 buffer_load_dwordx4 a[164:167], v1, s[12:15], s51 offen offset:1024 sc1
 buffer_load_dwordx4 a[168:171], v1, s[12:15], s51 offen offset:2048 sc1
 buffer_load_dwordx4 a[172:175], v1, s[12:15], s51 offen offset:3072 sc1
 s_add_u32 s51, s51, 4096
 buffer_load_dwordx4 a[176:179], v1, s[12:15], s51 offen offset:0 sc1
 buffer_load_dwordx4 a[180:183], v1, s[12:15], s51 offen offset:1024 sc1
 buffer_load_dwordx4 a[184:187], v1, s[12:15], s51 offen offset:2048 sc1
 buffer_load_dwordx4 a[188:191], v1, s[12:15], s51 offen offset:3072 sc1
 s_add_u32 s51, s51, 4096
 s_cmp_eq_u32 s50, 1
 s_cbranch_scc1 L_haveshort
 v_and_b32 v16, 15, v0
 v_lshlrev_b32 v16, 2, v16
 s_mov_b32 s32, 0
L_poll6:
 buffer_load_dword v17, v16, s[12:15], s44 offen sc1
 s_waitcnt vmcnt(0)
 v_cmp_ne_u32 vcc, 0, v17
 s_cbranch_vccz L_poll6_ok
 s_sleep 8
 s_add_u32 s32, s32, 1
 s_cmp_lt_u32 s32, 0x80000
 s_cbranch_scc1 L_poll6
L_poll6_ok:
 buffer_load_dwordx4 a[128:131], v1, s[12:15], s38 offen offset:0 sc1
 buffer_load_dwordx4 a[132:135], v1, s[12:15], s38 offen offset:1024 sc1
 buffer_load_dwordx4 a[136:139], v1, s[12:15], s38 offen offset:2048 sc1
 buffer_load_dwordx4 a[140:143], v1, s[12:15], s38 offen offset:3072 sc1
 s_add_u32 s38, s38, 4096
 buffer_load_dwordx4 a[144:147], v1, s[12:15], s38 offen offset:0 sc1
 buffer_load_dwordx4 a[148:151], v1, s[12:15], s38 offen offset:1024 sc1
 buffer_load_dwordx4 a[152:155], v1, s[12:15], s38 offen offset:2048 sc1
 buffer_load_dwordx4 a[156:159], v1, s[12:15], s38 offen offset:3072 sc1
 s_add_u32 s38, s38, 4096
 buffer_load_dwordx4 a[160:163], v1, s[12:15], s38 offen offset:0 sc1
 buffer_load_dwordx4 a[164:167], v1, s[12:15], s38 offen offset:1024 sc1
 buffer_load_dwordx4 a[168:171], v1, s[12:15], s38 offen offset:2048 sc1
 buffer_load_dwordx4 a[172:175], v1, s[12:15], s38 offen offset:3072 sc1
 s_add_u32 s38, s38, 4096
 buffer_load_dwordx4 a[176:179], v1, s[12:15], s38 offen offset:0 sc1
 buffer_load_dwordx4 a[180:183], v1, s[12:15], s38 offen offset:1024 sc1
 buffer_load_dwordx4 a[184:187], v1, s[12:15], s38 offen offset:2048 sc1
 buffer_load_dwordx4 a[188:191], v1, s[12:15], s38 offen offset:3072 sc1
 s_add_u32 s38, s38, 4096
L_haveshort:
 v_and_b32 v17, 15, v0
 v_lshlrev_b32 v17, 2, v17
 buffer_load_dword a246, v17, s[12:15], s45 offen sc1
 s_waitcnt vmcnt(16)
 v_mfma_f32_16x16x32_bf16 v[40:43], v[24:27], a[128:131], 0
 v_mfma_f32_16x16x32_bf16 v[44:47], v[28:31], a[128:131], 0
 s_waitcnt vmcnt(15)
 v_mfma_f32_16x16x32_bf16 v[40:43], v[24:27], a[132:135], v[40:43]
 v_mfma_f32_16x16x32_bf16 v[44:47], v[28:31], a[132:135], v[44:47]
 s_waitcnt vmcnt(14)
 v_mfma_f32_16x16x32_bf16 v[40:43], v[24:27], a[136:139], v[40:43]
 v_mfma_f32_16x16x32_bf16 v[44:47], v[28:31], a[136:139], v[44:47]
 s_waitcnt vmcnt(13)
 v_mfma_f32_16x16x32_bf16 v[40:43], v[24:27], a[140:143], v[40:43]
 v_mfma_f32_16x16x32_bf16 v[44:47], v[28:31], a[140:143], v[44:47]
 s_waitcnt vmcnt(12)
 v_mfma_f32_16x16x32_bf16 v[40:43], v[24:27], a[144:147], v[40:43]
 v_mfma_f32_16x16x32_bf16 v[44:47], v[28:31], a[144:147], v[44:47]
 s_waitcnt vmcnt(11)
 v_mfma_f32_16x16x32_bf16 v[40:43], v[24:27], a[148:151], v[40:43]
 v_mfma_f32_16x16x32_bf16 v[44:47], v[28:31], a[148:151], v[44:47]
 s_waitcnt vmcnt(10)
 v_mfma_f32_16x16x32_bf16 v[40:43], v[24:27], a[152:155], v[40:43]
 v_mfma_f32_16x16x32_bf16 v[44:47], v[28:31], a[152:155], v[44:47]
 s_waitcnt vmcnt(9)
 v_mfma_f32_16x16x32_bf16 v[40:43], v[24:27], a[156:159], v[40:43]
 v_mfma_f32_16x16x32_bf16 v[44:47], v[28:31], a[156:159], v[44:47]
 s_waitcnt vmcnt(8)
 v_mfma_f32_16x16x32_bf16 v[40:43], v[24:27], a[160:163], v[40:43]
 v_mfma_f32_16x16x32_bf16 v[44:47], v[28:31], a[160:163], v[44:47]
 s_waitcnt vmcnt(7)
 v_mfma_f32_16x16x32_bf16 v[40:43], v[24:27], a[164:167], v[40:43]
 v_mfma_f32_16x16x32_bf16 v[44:47], v[28:31], a[164:167], v[44:47]
 s_waitcnt vmcnt(6)
 v_mfma_f32_16x16x32_bf16 v[40:43], v[24:27], a[168:171], v[40:43]
 v_mfma_f32_16x16x32_bf16 v[44:47], v[28:31], a[168:171], v[44:47]
 s_waitcnt vmcnt(5)
 v_mfma_f32_16x16x32_bf16 v[40:43], v[24:27], a[172:175], v[40:43]
 v_mfma_f32_16x16x32_bf16 v[44:47], v[28:31], a[172:175], v[44:47]
 s_waitcnt vmcnt(4)
 v_mfma_f32_16x16x32_bf16 v[40:43], v[24:27], a[176:179], v[40:43]
 v_mfma_f32_16x16x32_bf16 v[44:47], v[28:31], a[176:179], v[44:47]
 s_waitcnt vmcnt(3)
 v_mfma_f32_16x16x32_bf16 v[40:43], v[24:27], a[180:183], v[40:43]
 v_mfma_f32_16x16x32_bf16 v[44:47], v[28:31], a[180:183], v[44:47]
 s_waitcnt vmcnt(2)
 v_mfma_f32_16x16x32_bf16 v[40:43], v[24:27], a[184:187], v[40:43]
 v_mfma_f32_16x16x32_bf16 v[44:47], v[28:31], a[184:187], v[44:47]
 s_waitcnt vmcnt(1)
 v_mfma_f32_16x16x32_bf16 v[40:43], v[24:27], a[188:191], v[40:43]
 v_mfma_f32_16x16x32_bf16 v[44:47], v[28:31], a[188:191], v[44:47]
 s_nop 7
 v_cvt_pk_bf16_f32 v40, v40, v41
 v_cvt_pk_bf16_f32 v41, v42, v43
 v_cvt_pk_bf16_f32 v42, v44, v45
 v_cvt_pk_bf16_f32 v43, v46, v47
 buffer_store_dwordx4 v[40:43], v2, s[8:11], s36 offen offset:448
 s_waitcnt vmcnt(1)
 s_waitcnt vmcnt(2)
 v_accvgpr_read_b32 v17, a246
 v_cmp_ne_u32 vcc, 0, v17
 s_cbranch_vccz L_poll7_ok
 v_and_b32 v16, 15, v0
 v_lshlrev_b32 v16, 2, v16
 s_mov_b32 s32, 0
L_poll7:
 buffer_load_dword v17, v16, s[12:15], s45 offen sc1
 s_waitcnt vmcnt(0)
 v_cmp_ne_u32 vcc, 0, v17
 s_cbranch_vccz L_poll7_ok
 s_sleep 8
 s_add_u32 s32, s32, 1
 s_cmp_lt_u32 s32, 0x80000
 s_cbranch_scc1 L_poll7
L_poll7_ok:
 buffer_load_dwordx4 a[0:3], v1, s[12:15], s39 offen offset:0 sc1
 buffer_load_dwordx4 a[4:7], v1, s[12:15], s39 offen offset:1024 sc1
 buffer_load_dwordx4 a[8:11], v1, s[12:15], s39 offen offset:2048 sc1
 buffer_load_dwordx4 a[12:15], v1, s[12:15], s39 offen offset:3072 sc1
 s_add_u32 s39, s39, 4096
 buffer_load_dwordx4 a[16:19], v1, s[12:15], s39 offen offset:0 sc1
 buffer_load_dwordx4 a[20:23], v1, s[12:15], s39 offen offset:1024 sc1
 buffer_load_dwordx4 a[24:27], v1, s[12:15], s39 offen offset:2048 sc1
 buffer_load_dwordx4 a[28:31], v1, s[12:15], s39 offen offset:3072 sc1
 s_add_u32 s39, s39, 4096
 buffer_load_dwordx4 a[32:35], v1, s[12:15], s39 offen offset:0 sc1
 buffer_load_dwordx4 a[36:39], v1, s[12:15], s39 offen offset:1024 sc1
 buffer_load_dwordx4 a[40:43], v1, s[12:15], s39 offen offset:2048 sc1
 buffer_load_dwordx4 a[44:47], v1, s[12:15], s39 offen offset:3072 sc1
 s_add_u32 s39, s39, 4096
 buffer_load_dwordx4 a[48:51], v1, s[12:15], s39 offen offset:0 sc1
 buffer_load_dwordx4 a[52:55], v1, s[12:15], s39 offen offset:1024 sc1
 buffer_load_dwordx4 a[56:59], v1, s[12:15], s39 offen offset:2048 sc1
 buffer_load_dwordx4 a[60:63], v1, s[12:15], s39 offen offset:3072 sc1
 s_add_u32 s39, s39, 4096
 s_waitcnt vmcnt(15)
 v_mfma_f32_16x16x32_bf16 v[48:51], v[24:27], a[0:3], 0
 v_mfma_f32_16x16x32_bf16 v[52:55], v[28:31], a[0:3], 0
 s_waitcnt vmcnt(14)
 v_mfma_f32_16x16x32_bf16 v[48:51], v[24:27], a[4:7], v[48:51]
 v_mfma_f32_16x16x32_bf16 v[52:55], v[28:31], a[4:7], v[52:55]
 s_waitcnt vmcnt(13)
 v_mfma_f32_16x16x32_bf16 v[48:51], v[24:27], a[8:11], v[48:51]
 v_mfma_f32_16x16x32_bf16 v[52:55], v[28:31], a[8:11], v[52:55]
 s_waitcnt vmcnt(12)
 v_mfma_f32_16x16x32_bf16 v[48:51], v[24:27], a[12:15], v[48:51]
 v_mfma_f32_16x16x32_bf16 v[52:55], v[28:31], a[12:15], v[52:55]
 s_waitcnt vmcnt(11)
 v_mfma_f32_16x16x32_bf16 v[48:51], v[24:27], a[16:19], v[48:51]
 v_mfma_f32_16x16x32_bf16 v[52:55], v[28:31], a[16:19], v[52:55]
 s_waitcnt vmcnt(10)
 v_mfma_f32_16x16x32_bf16 v[48:51], v[24:27], a[20:23], v[48:51]
 v_mfma_f32_16x16x32_bf16 v[52:55], v[28:31], a[20:23], v[52:55]
 s_waitcnt vmcnt(9)
 v_mfma_f32_16x16x32_bf16 v[48:51], v[24:27], a[24:27], v[48:51]
 v_mfma_f32_16x16x32_bf16 v[52:55], v[28:31], a[24:27], v[52:55]
 s_waitcnt vmcnt(8)
 v_mfma_f32_16x16x32_bf16 v[48:51], v[24:27], a[28:31], v[48:51]
 v_mfma_f32_16x16x32_bf16 v[52:55], v[28:31], a[28:31], v[52:55]
 s_waitcnt vmcnt(7)
 v_mfma_f32_16x16x32_bf16 v[48:51], v[24:27], a[32:35], v[48:51]
 v_mfma_f32_16x16x32_bf16 v[52:55], v[28:31], a[32:35], v[52:55]
 s_waitcnt vmcnt(6)
 v_mfma_f32_16x16x32_bf16 v[48:51], v[24:27], a[36:39], v[48:51]
 v_mfma_f32_16x16x32_bf16 v[52:55], v[28:31], a[36:39], v[52:55]
 s_waitcnt vmcnt(5)
 v_mfma_f32_16x16x32_bf16 v[48:51], v[24:27], a[40:43], v[48:51]
 v_mfma_f32_16x16x32_bf16 v[52:55], v[28:31], a[40:43], v[52:55]
 s_waitcnt vmcnt(4)
 v_mfma_f32_16x16x32_bf16 v[48:51], v[24:27], a[44:47], v[48:51]
 v_mfma_f32_16x16x32_bf16 v[52:55], v[28:31], a[44:47], v[52:55]
 s_waitcnt vmcnt(3)
 v_mfma_f32_16x16x32_bf16 v[48:51], v[24:27], a[48:51], v[48:51]
 v_mfma_f32_16x16x32_bf16 v[52:55], v[28:31], a[48:51], v[52:55]
 s_waitcnt vmcnt(2)
 v_mfma_f32_16x16x32_bf16 v[48:51], v[24:27], a[52:55], v[48:51]
 v_mfma_f32_16x16x32_bf16 v[52:55], v[28:31], a[52:55], v[52:55]
 s_waitcnt vmcnt(1)
 v_mfma_f32_16x16x32_bf16 v[48:51], v[24:27], a[56:59], v[48:51]
 v_mfma_f32_16x16x32_bf16 v[52:55], v[28:31], a[56:59], v[52:55]
 s_waitcnt vmcnt(0)
 v_mfma_f32_16x16x32_bf16 v[48:51], v[24:27], a[60:63], v[48:51]
 v_mfma_f32_16x16x32_bf16 v[52:55], v[28:31], a[60:63], v[52:55]
 s_nop 7
 v_cvt_pk_bf16_f32 v48, v48, v49
 v_cvt_pk_bf16_f32 v49, v50, v51
 v_cvt_pk_bf16_f32 v50, v52, v53
 v_cvt_pk_bf16_f32 v51, v54, v55
 buffer_store_dwordx4 v[48:51], v2, s[8:11], s35 offen offset:448
 s_branch L_fin
L_idle:
 s_waitcnt vmcnt(0)
 s_barrier
 s_cmp_lg_u32 s3, 0
 s_cbranch_scc1 L_pub8
 v_mov_b32 v11, 0
 s_mov_b64 exec, 1
 buffer_store_dword v11, v11, s[12:15], s93 offen sc1
 s_mov_b64 exec, -1
L_pub8:
 s_branch L_fin
L_opB:
 v_lshrrev_b32 v8, 2, v0
 v_lshlrev_b32 v4, 7, v8
 v_bfe_u32 v8, v8, 1, 2
 v_lshl_add_u32 v4, v8, 5, v4
 v_and_b32 v8, 3, v0
 v_lshl_add_u32 v4, v8, 3, v4
 v_add_u32 v4, 131072, v4
 s_barrier
 ds_read_b64_tr_b16 a[0:1], v4 offset:0
 ds_read_b64_tr_b16 a[2:3], v4 offset:2048
 ds_read_b64_tr_b16 a[4:5], v4 offset:4096
 ds_read_b64_tr_b16 a[6:7], v4 offset:6144
 ds_read_b64_tr_b16 a[8:9], v4 offset:8192
 ds_read_b64_tr_b16 a[10:11], v4 offset:10240
 ds_read_b64_tr_b16 a[12:13], v4 offset:12288
 ds_read_b64_tr_b16 a[14:15], v4 offset:14336
 ds_read_b64_tr_b16 a[16:17], v4 offset:16384
 ds_read_b64_tr_b16 a[18:19], v4 offset:18432
 ds_read_b64_tr_b16 a[20:21], v4 offset:20480
 ds_read_b64_tr_b16 a[22:23], v4 offset:22528
 ds_read_b64_tr_b16 a[24:25], v4 offset:24576
 ds_read_b64_tr_b16 a[26:27], v4 offset:26624
 v_xor_b32 v5, 32, v4
 v_xor_b32 v6, 64, v4
 v_xor_b32 v7, 96, v4
 s_lshl_b32 s34, s95, 2
 s_add_u32 s34, s34, s3
 s_mul_i32 s35, s34, 4096
 s_lshl_b32 s34, s34, 12
 s_cmp_eq_u32 s62, 0
 s_cmov_b32 s34, 2.0
 s_cmov_b32 s35, 2.0
 s_add_u32 s35, s35, 85983232
 s_mul_i32 s33, s3, 8736
 s_add_u32 s33, s33, 0x10000
 s_mov_b32 s4, s72
 s_mov_b32 s5, s73
 s_mov_b32 s6, 1835008
 s_mov_b32 s7, 0x20000
 v_lshrrev_b32 v10, 1, v0
 v_lshlrev_b32 v10, 7, v10
 v_and_b32 v11, 1, v0
 v_lshl_add_u32 v10, v11, 4, v10
 v_and_b32 v11, 31, v0
 v_lshl_add_u32 v11, v11, 2, s33
 v_and_b32 v12, 7, v0
 v_lshl_add_u32 v12, v12, 2, s33
 v_mov_b32 v13, 0
 v_accvgpr_read_b32 v9, a245
 s_lshl_b32 s48, s63, 3
 s_add_u32 s48, s48, s3
 s_mul_i32 s48, s48, 243712
 s_lshl_b32 s58, s26, 10
 s_add_u32 s48, s48, s58
 s_add_u32 s48, s48, 117440512
 s_waitcnt lgkmcnt(7)
 v_mfma_f32_16x16x32_bf16 v[72:75], a[0:3], a[128:131], 0
 ds_read_b64_tr_b16 a[28:29], v4 offset:28672
 buffer_store_dwordx4 v[68:71], v1, s[12:15], s57 offen sc1
 v_mfma_f32_16x16x32_bf16 v[72:75], a[4:7], a[132:135], v[72:75]
 ds_read_b64_tr_b16 a[30:31], v4 offset:30720
 v_mfma_f32_16x16x32_bf16 v[72:75], a[8:11], a[136:139], v[72:75]
 s_waitcnt lgkmcnt(4)
 ds_read_b64_tr_b16 a[32:33], v5 offset:0
 v_mfma_f32_16x16x32_bf16 v[72:75], a[12:15], a[140:143], v[72:75]
 ds_read_b64_tr_b16 a[34:35], v5 offset:2048
 buffer_store_dwordx4 v[168:171], v3, s[12:15], s55 offen offset:1024 sc1
 v_mfma_f32_16x16x32_bf16 v[72:75], a[16:19], a[144:147], v[72:75]
 ds_read_b64_tr_b16 a[36:37], v5 offset:4096
 v_mfma_f32_16x16x32_bf16 v[72:75], a[20:23], a[148:151], v[72:75]
 s_waitcnt lgkmcnt(3)
 ds_read_b64_tr_b16 a[38:39], v5 offset:6144
 v_mfma_f32_16x16x32_bf16 v[72:75], a[24:27], a[152:155], v[72:75]
 ds_read_b64_tr_b16 a[40:41], v5 offset:8192
 buffer_store_dwordx4 v[232:235], v3, s[12:15], s56 offen offset:1024 sc1
 v_mfma_f32_16x16x32_bf16 v[72:75], a[28:31], a[156:159], v[72:75]
 ds_read_b64_tr_b16 a[42:43], v5 offset:10240
 v_mfma_f32_16x16x32_bf16 v[80:83], a[0:3], a[160:163], 0
 ds_read_b64_tr_b16 a[44:45], v5 offset:12288
 v_mfma_f32_16x16x32_bf16 v[80:83], a[4:7], a[164:167], v[80:83]
 ds_read_b64_tr_b16 a[46:47], v5 offset:14336
 buffer_store_dwordx4 v[176:179], v3, s[12:15], s55 offen offset:2048 sc1
 v_mfma_f32_16x16x32_bf16 v[80:83], a[8:11], a[168:171], v[80:83]
 ds_read_b64_tr_b16 a[48:49], v5 offset:16384
 v_mfma_f32_16x16x32_bf16 v[80:83], a[12:15], a[172:175], v[80:83]
 ds_read_b64_tr_b16 a[50:51], v5 offset:18432
 v_mfma_f32_16x16x32_bf16 v[80:83], a[16:19], a[176:179], v[80:83]
 ds_read_b64_tr_b16 a[52:53], v5 offset:20480
 buffer_store_dwordx4 v[240:243], v3, s[12:15], s56 offen offset:2048 sc1
 v_mfma_f32_16x16x32_bf16 v[80:83], a[20:23], a[180:183], v[80:83]
 ds_read_b64_tr_b16 a[54:55], v5 offset:22528
 v_mul_f32 v72, v72, v64
 v_mfma_f32_16x16x32_bf16 v[80:83], a[24:27], a[184:187], v[80:83]
 ds_read_b64_tr_b16 a[56:57], v5 offset:24576
 v_mul_f32 v73, v73, v64
 v_mfma_f32_16x16x32_bf16 v[80:83], a[28:31], a[188:191], v[80:83]
 s_waitcnt lgkmcnt(7)
 ds_read_b64_tr_b16 a[58:59], v5 offset:26624
 buffer_store_dwordx4 v[184:187], v3, s[12:15], s55 offen offset:3072 sc1
 v_mfma_f32_16x16x32_bf16 v[76:79], a[32:35], a[128:131], 0
 ds_read_b64_tr_b16 a[60:61], v5 offset:28672
 v_mul_f32 v74, v74, v64
 v_mfma_f32_16x16x32_bf16 v[76:79], a[36:39], a[132:135], v[76:79]
 ds_read_b64_tr_b16 a[62:63], v5 offset:30720
 v_mul_f32 v75, v75, v64
 v_mfma_f32_16x16x32_bf16 v[76:79], a[40:43], a[136:139], v[76:79]
 s_waitcnt lgkmcnt(4)
 ds_read_b64_tr_b16 a[0:1], v6 offset:0
 buffer_store_dwordx4 v[248:251], v3, s[12:15], s56 offen offset:3072 sc1
 v_mfma_f32_16x16x32_bf16 v[76:79], a[44:47], a[140:143], v[76:79]
 ds_read_b64_tr_b16 a[2:3], v6 offset:2048
 v_mfma_f32_16x16x32_bf16 v[76:79], a[48:51], a[144:147], v[76:79]
 s_add_u32 m0, s29, 32768
 ds_read_b64_tr_b16 a[4:5], v6 offset:4096
 v_mul_f32 v80, v80, v65
 v_mfma_f32_16x16x32_bf16 v[76:79], a[52:55], a[148:151], v[76:79]
 s_waitcnt lgkmcnt(3)
 ds_read_b64_tr_b16 a[6:7], v6 offset:6144
 buffer_load_dwordx4 v2, s[8:11], s78 offen lds
 v_mfma_f32_16x16x32_bf16 v[76:79], a[56:59], a[152:155], v[76:79]
 ds_read_b64_tr_b16 a[8:9], v6 offset:8192
 v_mul_f32 v81, v81, v65
 v_mfma_f32_16x16x32_bf16 v[76:79], a[60:63], a[156:159], v[76:79]
 ds_read_b64_tr_b16 a[10:11], v6 offset:10240
 v_mul_f32 v82, v82, v65
 v_mfma_f32_16x16x32_bf16 v[84:87], a[32:35], a[160:163], 0
 ds_read_b64_tr_b16 a[12:13], v6 offset:12288
 v_mul_f32 v83, v83, v65
 v_mfma_f32_16x16x32_bf16 v[84:87], a[36:39], a[164:167], v[84:87]
 ds_read_b64_tr_b16 a[14:15], v6 offset:14336
 v_mfma_f32_16x16x32_bf16 v[84:87], a[40:43], a[168:171], v[84:87]
 ds_read_b64_tr_b16 a[16:17], v6 offset:16384
 v_mfma_f32_16x16x32_bf16 v[84:87], a[44:47], a[172:175], v[84:87]
 s_add_u32 m0, s29, 36864
 ds_read_b64_tr_b16 a[18:19], v6 offset:18432
 v_mfma_f32_16x16x32_bf16 v[84:87], a[48:51], a[176:179], v[84:87]
 ds_read_b64_tr_b16 a[20:21], v6 offset:20480
 buffer_load_dwordx4 v2, s[8:11], s79 offen lds
 v_mfma_f32_16x16x32_bf16 v[84:87], a[52:55], a[180:183], v[84:87]
 ds_read_b64_tr_b16 a[22:23], v6 offset:22528
 v_mul_f32 v76, v76, v64
 v_mfma_f32_16x16x32_bf16 v[84:87], a[56:59], a[184:187], v[84:87]
 s_lshl_b32 s44, s24, 7
 ds_read_b64_tr_b16 a[24:25], v6 offset:24576
 v_mul_f32 v77, v77, v64
 v_mfma_f32_16x16x32_bf16 v[84:87], a[60:63], a[188:191], v[84:87]
 s_waitcnt lgkmcnt(7)
 ds_read_b64_tr_b16 a[26:27], v6 offset:26624
 v_mul_f32 v78, v78, v64
 v_mfma_f32_16x16x32_bf16 v[88:91], a[0:3], a[128:131], 0
 s_add_u32 s44, s44, 84938752
 ds_read_b64_tr_b16 a[28:29], v6 offset:28672
 v_mul_f32 v79, v79, v64
 v_mfma_f32_16x16x32_bf16 v[88:91], a[4:7], a[132:135], v[88:91]
 s_add_u32 m0, s29, 40960
 ds_read_b64_tr_b16 a[30:31], v6 offset:30720
 v_cvt_pk_bf16_f32 v72, v72, v73
 v_mfma_f32_16x16x32_bf16 v[88:91], a[8:11], a[136:139], v[88:91]
 s_waitcnt lgkmcnt(4)
 ds_read_b64_tr_b16 a[32:33], v7 offset:0
 v_cvt_pk_bf16_f32 v73, v74, v75
 v_mfma_f32_16x16x32_bf16 v[88:91], a[12:15], a[140:143], v[88:91]
 ds_read_b64_tr_b16 a[34:35], v7 offset:2048
 buffer_load_dwordx4 v2, s[8:11], s80 offen lds
 v_mfma_f32_16x16x32_bf16 v[88:91], a[16:19], a[144:147], v[88:91]
 s_add_u32 s58, s48, 0
 ds_read_b64_tr_b16 a[36:37], v7 offset:4096
 v_cvt_pk_bf16_f32 v74, v76, v77
 v_mfma_f32_16x16x32_bf16 v[88:91], a[20:23], a[148:151], v[88:91]
 s_waitcnt lgkmcnt(3)
 ds_read_b64_tr_b16 a[38:39], v7 offset:6144
 v_cvt_pk_bf16_f32 v75, v78, v79
 v_mfma_f32_16x16x32_bf16 v[88:91], a[24:27], a[152:155], v[88:91]
 ds_read_b64_tr_b16 a[40:41], v7 offset:8192
 buffer_store_dwordx4 v[72:75], v1, s[12:15], s58 offen sc1
 v_mfma_f32_16x16x32_bf16 v[88:91], a[28:31], a[156:159], v[88:91]
 s_waitcnt vmcnt(4)
 ds_read_b64_tr_b16 a[42:43], v7 offset:10240
 v_mul_f32 v84, v84, v65
 v_mfma_f32_16x16x32_bf16 v[96:99], a[0:3], a[160:163], 0
 s_barrier
 ds_read_b64_tr_b16 a[44:45], v7 offset:12288
 v_mul_f32 v85, v85, v65
 v_mfma_f32_16x16x32_bf16 v[96:99], a[4:7], a[164:167], v[96:99]
 ds_read_b64_tr_b16 a[46:47], v7 offset:14336
 buffer_store_dword v9, v9, s[12:15], s59 offen sc1
 v_mfma_f32_16x16x32_bf16 v[96:99], a[8:11], a[168:171], v[96:99]
 s_add_u32 m0, s29, 45056
 ds_read_b64_tr_b16 a[48:49], v7 offset:16384
 v_mul_f32 v86, v86, v65
 v_mfma_f32_16x16x32_bf16 v[96:99], a[12:15], a[172:175], v[96:99]
 ds_read_b64_tr_b16 a[50:51], v7 offset:18432
 buffer_load_dwordx4 v2, s[8:11], s81 offen lds
 v_mfma_f32_16x16x32_bf16 v[96:99], a[16:19], a[176:179], v[96:99]
 s_lshl_b32 s40, s24, 1
 ds_read_b64_tr_b16 a[52:53], v7 offset:20480
 v_mul_f32 v87, v87, v65
 v_mfma_f32_16x16x32_bf16 v[96:99], a[20:23], a[180:183], v[96:99]
 s_and_b32 s41, s28, 1
 ds_read_b64_tr_b16 a[54:55], v7 offset:22528
 v_cvt_pk_bf16_f32 v80, v80, v81
 v_mfma_f32_16x16x32_bf16 v[96:99], a[24:27], a[184:187], v[96:99]
 s_add_u32 s40, s40, s41
 ds_read_b64_tr_b16 a[56:57], v7 offset:24576
 v_cvt_pk_bf16_f32 v81, v82, v83
 v_mfma_f32_16x16x32_bf16 v[96:99], a[28:31], a[188:191], v[96:99]
 s_waitcnt lgkmcnt(7)
 ds_read_b64_tr_b16 a[58:59], v7 offset:26624
 v_cvt_pk_bf16_f32 v82, v84, v85
 v_mfma_f32_16x16x32_bf16 v[92:95], a[32:35], a[128:131], 0
 s_lshr_b32 s41, s28, 1
 ds_read_b64_tr_b16 a[60:61], v7 offset:28672
 v_cvt_pk_bf16_f32 v83, v86, v87
 v_mfma_f32_16x16x32_bf16 v[92:95], a[36:39], a[132:135], v[92:95]
 s_add_u32 m0, s29, 49152
 ds_read_b64_tr_b16 a[62:63], v7 offset:30720
 v_xor_b32 v4, 0x20000, v4
 v_mfma_f32_16x16x32_bf16 v[92:95], a[40:43], a[136:139], v[92:95]
 s_waitcnt lgkmcnt(4)
 ds_read_b64_tr_b16 a[0:1], v4 offset:0
 buffer_load_dwordx4 v2, s[8:11], s82 offen lds
 v_mfma_f32_16x16x32_bf16 v[92:95], a[44:47], a[140:143], v[92:95]
 s_add_u32 s58, s48, 974848
 ds_read_b64_tr_b16 a[2:3], v4 offset:2048
 v_mul_f32 v88, v88, v64
 v_mfma_f32_16x16x32_bf16 v[92:95], a[48:51], a[144:147], v[92:95]
 ds_read_b64_tr_b16 a[4:5], v4 offset:4096
 buffer_store_dwordx4 v[80:83], v1, s[12:15], s58 offen sc1
 v_mfma_f32_16x16x32_bf16 v[92:95], a[52:55], a[148:151], v[92:95]
 s_waitcnt lgkmcnt(3)
 ds_read_b64_tr_b16 a[6:7], v4 offset:6144
 v_mul_f32 v89, v89, v64
 v_mfma_f32_16x16x32_bf16 v[92:95], a[56:59], a[152:155], v[92:95]
 s_lshl_b32 s42, s40, 2
 ds_read_b64_tr_b16 a[8:9], v4 offset:8192
 v_mul_f32 v90, v90, v64
 v_mfma_f32_16x16x32_bf16 v[92:95], a[60:63], a[156:159], v[92:95]
 s_add_u32 s42, s42, s3
 ds_read_b64_tr_b16 a[10:11], v4 offset:10240
 v_mul_f32 v91, v91, v64
 v_mfma_f32_16x16x32_bf16 v[100:103], a[32:35], a[160:163], 0
 s_add_u32 m0, s29, 53248
 ds_read_b64_tr_b16 a[12:13], v4 offset:12288
 v_mul_f32 v96, v96, v65
 v_mfma_f32_16x16x32_bf16 v[100:103], a[36:39], a[164:167], v[100:103]
 ds_read_b64_tr_b16 a[14:15], v4 offset:14336
 buffer_load_dwordx4 v2, s[8:11], s83 offen lds
 v_mfma_f32_16x16x32_bf16 v[100:103], a[40:43], a[168:171], v[100:103]
 s_mul_i32 s37, s42, 243712
 ds_read_b64_tr_b16 a[16:17], v4 offset:16384
 v_mul_f32 v97, v97, v65
 v_mfma_f32_16x16x32_bf16 v[100:103], a[44:47], a[172:175], v[100:103]
 s_mul_i32 s43, s41, 17408
 ds_read_b64_tr_b16 a[18:19], v4 offset:18432
 v_mul_f32 v98, v98, v65
 v_mfma_f32_16x16x32_bf16 v[100:103], a[48:51], a[176:179], v[100:103]
 s_add_u32 s37, s37, s43
 ds_read_b64_tr_b16 a[20:21], v4 offset:20480
 v_mul_f32 v92, v92, v64
 v_mfma_f32_16x16x32_bf16 v[100:103], a[52:55], a[180:183], v[100:103]
 s_add_u32 s37, s37, 117440512
 ds_read_b64_tr_b16 a[22:23], v4 offset:22528
 v_mul_f32 v93, v93, v64
 v_mfma_f32_16x16x32_bf16 v[100:103], a[56:59], a[184:187], v[100:103]
 s_add_u32 m0, s29, 57344
 ds_read_b64_tr_b16 a[24:25], v4 offset:24576
 v_mul_f32 v94, v94, v64
 v_mfma_f32_16x16x32_bf16 v[100:103], a[60:63], a[188:191], v[100:103]
 s_waitcnt lgkmcnt(7)
 ds_read_b64_tr_b16 a[26:27], v4 offset:26624
 v_mul_f32 v95, v95, v64
 v_mfma_f32_16x16x32_bf16 v[104:107], a[0:3], a[128:131], 0
 ds_read_b64_tr_b16 a[28:29], v4 offset:28672
 buffer_load_dwordx4 v2, s[8:11], s84 offen lds
 v_mfma_f32_16x16x32_bf16 v[104:107], a[4:7], a[132:135], v[104:107]
 s_add_u32 s38, s37, 121856
 ds_read_b64_tr_b16 a[30:31], v4 offset:30720
 v_xor_b32 v5, 0x20000, v5
 v_mfma_f32_16x16x32_bf16 v[104:107], a[8:11], a[136:139], v[104:107]
 s_waitcnt lgkmcnt(4)
 ds_read_b64_tr_b16 a[32:33], v5 offset:0
 v_cvt_pk_bf16_f32 v88, v88, v89
 v_mfma_f32_16x16x32_bf16 v[104:107], a[12:15], a[140:143], v[104:107]
 ds_read_b64_tr_b16 a[34:35], v5 offset:2048
 v_cvt_pk_bf16_f32 v89, v90, v91
 v_mfma_f32_16x16x32_bf16 v[104:107], a[16:19], a[144:147], v[104:107]
 ds_read_b64_tr_b16 a[36:37], v5 offset:4096
 v_cvt_pk_bf16_f32 v90, v92, v93
 v_mfma_f32_16x16x32_bf16 v[104:107], a[20:23], a[148:151], v[104:107]
 s_waitcnt lgkmcnt(3)
 ds_read_b64_tr_b16 a[38:39], v5 offset:6144
 v_cvt_pk_bf16_f32 v91, v94, v95
 v_mfma_f32_16x16x32_bf16 v[104:107], a[24:27], a[152:155], v[104:107]
 s_add_u32 m0, s29, 61440
 ds_read_b64_tr_b16 a[40:41], v5 offset:8192
 v_mul_f32 v99, v99, v65
 v_mfma_f32_16x16x32_bf16 v[104:107], a[28:31], a[156:159], v[104:107]
 ds_read_b64_tr_b16 a[42:43], v5 offset:10240
 buffer_load_dwordx4 v2, s[8:11], s85 offen lds
 v_mfma_f32_16x16x32_bf16 v[112:115], a[0:3], a[160:163], 0
 s_add_u32 s58, s48, 17408
 ds_read_b64_tr_b16 a[44:45], v5 offset:12288
 v_add_u32 v2, 128, v2
 v_mfma_f32_16x16x32_bf16 v[112:115], a[4:7], a[164:167], v[112:115]
 ds_read_b64_tr_b16 a[46:47], v5 offset:14336
 buffer_store_dwordx4 v[88:91], v1, s[12:15], s58 offen sc1
 v_mfma_f32_16x16x32_bf16 v[112:115], a[8:11], a[168:171], v[112:115]
 ds_read_b64_tr_b16 a[48:49], v5 offset:16384
 v_mul_f32 v100, v100, v65
 v_mfma_f32_16x16x32_bf16 v[112:115], a[12:15], a[172:175], v[112:115]
 ds_read_b64_tr_b16 a[50:51], v5 offset:18432
 v_mul_f32 v101, v101, v65
 v_mfma_f32_16x16x32_bf16 v[112:115], a[16:19], a[176:179], v[112:115]
 ds_read_b64_tr_b16 a[52:53], v5 offset:20480
 v_mul_f32 v102, v102, v65
 v_mfma_f32_16x16x32_bf16 v[112:115], a[20:23], a[180:183], v[112:115]
 s_add_u32 m0, s29, 65536
 ds_read_b64_tr_b16 a[54:55], v5 offset:22528
 v_mul_f32 v103, v103, v65
 v_mfma_f32_16x16x32_bf16 v[112:115], a[24:27], a[184:187], v[112:115]
 ds_read_b64_tr_b16 a[56:57], v5 offset:24576
 buffer_load_dwordx4 v2, s[8:11], s78 offen lds
 v_mfma_f32_16x16x32_bf16 v[112:115], a[28:31], a[188:191], v[112:115]
 s_waitcnt lgkmcnt(7)
 ds_read_b64_tr_b16 a[58:59], v5 offset:26624
 v_cvt_pk_bf16_f32 v96, v96, v97
 v_mfma_f32_16x16x32_bf16 v[108:111], a[32:35], a[128:131], 0
 ds_read_b64_tr_b16 a[60:61], v5 offset:28672
 v_cvt_pk_bf16_f32 v97, v98, v99
 v_mfma_f32_16x16x32_bf16 v[108:111], a[36:39], a[132:135], v[108:111]
 ds_read_b64_tr_b16 a[62:63], v5 offset:30720
 v_xor_b32 v6, 0x20000, v6
 v_mfma_f32_16x16x32_bf16 v[108:111], a[40:43], a[136:139], v[108:111]
 s_waitcnt lgkmcnt(4)
 ds_read_b64_tr_b16 a[0:1], v6 offset:0
 v_cvt_pk_bf16_f32 v98, v100, v101
 v_mfma_f32_16x16x32_bf16 v[108:111], a[44:47], a[140:143], v[108:111]
 ds_read_b64_tr_b16 a[2:3], v6 offset:2048
 v_cvt_pk_bf16_f32 v99, v102, v103
 v_mfma_f32_16x16x32_bf16 v[108:111], a[48:51], a[144:147], v[108:111]
 s_add_u32 m0, s29, 69632
 ds_read_b64_tr_b16 a[4:5], v6 offset:4096
 v_mul_f32 v104, v104, v64
 v_mfma_f32_16x16x32_bf16 v[108:111], a[52:55], a[148:151], v[108:111]
 s_waitcnt lgkmcnt(3)
 ds_read_b64_tr_b16 a[6:7], v6 offset:6144
 buffer_load_dwordx4 v2, s[8:11], s79 offen lds
 v_mfma_f32_16x16x32_bf16 v[108:111], a[56:59], a[152:155], v[108:111]
 s_add_u32 s58, s48, 992256
 ds_read_b64_tr_b16 a[8:9], v6 offset:8192
 v_mul_f32 v105, v105, v64
 v_mfma_f32_16x16x32_bf16 v[108:111], a[60:63], a[156:159], v[108:111]
 ds_read_b64_tr_b16 a[10:11], v6 offset:10240
 buffer_store_dwordx4 v[96:99], v1, s[12:15], s58 offen sc1
 v_mfma_f32_16x16x32_bf16 v[116:119], a[32:35], a[160:163], 0
 ds_read_b64_tr_b16 a[12:13], v6 offset:12288
 v_mul_f32 v106, v106, v64
 v_mfma_f32_16x16x32_bf16 v[116:119], a[36:39], a[164:167], v[116:119]
 ds_read_b64_tr_b16 a[14:15], v6 offset:14336
 v_mul_f32 v107, v107, v64
 v_mfma_f32_16x16x32_bf16 v[116:119], a[40:43], a[168:171], v[116:119]
 ds_read_b64_tr_b16 a[16:17], v6 offset:16384
 v_mul_f32 v112, v112, v65
 v_mfma_f32_16x16x32_bf16 v[116:119], a[44:47], a[172:175], v[116:119]
 s_add_u32 m0, s29, 73728
 ds_read_b64_tr_b16 a[18:19], v6 offset:18432
 v_mul_f32 v113, v113, v65
 v_mfma_f32_16x16x32_bf16 v[116:119], a[48:51], a[176:179], v[116:119]
 ds_read_b64_tr_b16 a[20:21], v6 offset:20480
 buffer_load_dwordx4 v2, s[8:11], s80 offen lds
 v_mfma_f32_16x16x32_bf16 v[116:119], a[52:55], a[180:183], v[116:119]
 ds_read_b64_tr_b16 a[22:23], v6 offset:22528
 v_mul_f32 v108, v108, v64
 v_mfma_f32_16x16x32_bf16 v[116:119], a[56:59], a[184:187], v[116:119]
 ds_read_b64_tr_b16 a[24:25], v6 offset:24576
 v_mul_f32 v109, v109, v64
 v_mfma_f32_16x16x32_bf16 v[116:119], a[60:63], a[188:191], v[116:119]
 s_waitcnt lgkmcnt(7)
 ds_read_b64_tr_b16 a[26:27], v6 offset:26624
 v_mul_f32 v110, v110, v64
 v_mfma_f32_16x16x32_bf16 v[72:75], a[0:3], a[128:131], 0
 ds_read_b64_tr_b16 a[28:29], v6 offset:28672
 v_mul_f32 v111, v111, v64
 v_mfma_f32_16x16x32_bf16 v[72:75], a[4:7], a[132:135], v[72:75]
 s_add_u32 m0, s29, 77824
 ds_read_b64_tr_b16 a[30:31], v6 offset:30720
 v_xor_b32 v7, 0x20000, v7
 v_mfma_f32_16x16x32_bf16 v[72:75], a[8:11], a[136:139], v[72:75]
 s_waitcnt lgkmcnt(4)
 ds_read_b64_tr_b16 a[32:33], v7 offset:0
 v_cvt_pk_bf16_f32 v104, v104, v105
 v_mfma_f32_16x16x32_bf16 v[72:75], a[12:15], a[140:143], v[72:75]
 ds_read_b64_tr_b16 a[34:35], v7 offset:2048
 buffer_load_dwordx4 v2, s[8:11], s81 offen lds
 v_mfma_f32_16x16x32_bf16 v[72:75], a[16:19], a[144:147], v[72:75]
 ds_read_b64_tr_b16 a[36:37], v7 offset:4096
 v_cvt_pk_bf16_f32 v105, v106, v107
 v_mfma_f32_16x16x32_bf16 v[72:75], a[20:23], a[148:151], v[72:75]
 s_waitcnt lgkmcnt(3)
 ds_read_b64_tr_b16 a[38:39], v7 offset:6144
 v_cvt_pk_bf16_f32 v106, v108, v109
 v_mfma_f32_16x16x32_bf16 v[72:75], a[24:27], a[152:155], v[72:75]
 s_add_u32 s58, s48, 34816
 ds_read_b64_tr_b16 a[40:41], v7 offset:8192
 v_cvt_pk_bf16_f32 v107, v110, v111
 v_mfma_f32_16x16x32_bf16 v[72:75], a[28:31], a[156:159], v[72:75]
 ds_read_b64_tr_b16 a[42:43], v7 offset:10240
 buffer_store_dwordx4 v[104:107], v1, s[12:15], s58 offen sc1
 v_mfma_f32_16x16x32_bf16 v[80:83], a[0:3], a[160:163], 0
 ds_read_b64_tr_b16 a[44:45], v7 offset:12288
 v_mul_f32 v114, v114, v65
 v_mfma_f32_16x16x32_bf16 v[80:83], a[4:7], a[164:167], v[80:83]
 s_add_u32 m0, s29, 81920
 ds_read_b64_tr_b16 a[46:47], v7 offset:14336
 v_mul_f32 v115, v115, v65
 v_mfma_f32_16x16x32_bf16 v[80:83], a[8:11], a[168:171], v[80:83]
 ds_read_b64_tr_b16 a[48:49], v7 offset:16384
 buffer_load_dwordx4 v2, s[8:11], s82 offen lds
 v_mfma_f32_16x16x32_bf16 v[80:83], a[12:15], a[172:175], v[80:83]
 ds_read_b64_tr_b16 a[50:51], v7 offset:18432
 v_mul_f32 v116, v116, v65
 v_mfma_f32_16x16x32_bf16 v[80:83], a[16:19], a[176:179], v[80:83]
 ds_read_b64_tr_b16 a[52:53], v7 offset:20480
 v_mul_f32 v117, v117, v65
 v_mfma_f32_16x16x32_bf16 v[80:83], a[20:23], a[180:183], v[80:83]
 ds_read_b64_tr_b16 a[54:55], v7 offset:22528
 v_mul_f32 v118, v118, v65
 v_mfma_f32_16x16x32_bf16 v[80:83], a[24:27], a[184:187], v[80:83]
 ds_read_b64_tr_b16 a[56:57], v7 offset:24576
 v_mul_f32 v119, v119, v65
 v_mfma_f32_16x16x32_bf16 v[80:83], a[28:31], a[188:191], v[80:83]
 s_waitcnt lgkmcnt(7)
 ds_read_b64_tr_b16 a[58:59], v7 offset:26624
 v_cvt_pk_bf16_f32 v112, v112, v113
 v_mfma_f32_16x16x32_bf16 v[76:79], a[32:35], a[128:131], 0
 s_waitcnt vmcnt(8)
 ds_read_b64_tr_b16 a[60:61], v7 offset:28672
 v_cvt_pk_bf16_f32 v113, v114, v115
 v_mfma_f32_16x16x32_bf16 v[76:79], a[36:39], a[132:135], v[76:79]
 s_barrier
 ds_read_b64_tr_b16 a[62:63], v7 offset:30720
 v_cvt_pk_bf16_f32 v114, v116, v117
 v_mfma_f32_16x16x32_bf16 v[76:79], a[40:43], a[136:139], v[76:79]
 s_waitcnt lgkmcnt(4)
 ds_read_b64_tr_b16 a[0:1], v4 offset:32768
 v_cvt_pk_bf16_f32 v115, v118, v119
 v_mfma_f32_16x16x32_bf16 v[76:79], a[44:47], a[140:143], v[76:79]
 s_add_u32 m0, s29, 86016
 ds_read_b64_tr_b16 a[2:3], v4 offset:34816
 v_mul_f32 v72, v72, v64
 v_mfma_f32_16x16x32_bf16 v[76:79], a[48:51], a[144:147], v[76:79]
 ds_read_b64_tr_b16 a[4:5], v4 offset:36864
 buffer_load_dwordx4 v2, s[8:11], s83 offen lds
 v_mfma_f32_16x16x32_bf16 v[76:79], a[52:55], a[148:151], v[76:79]
 s_waitcnt lgkmcnt(3)
 ds_read_b64_tr_b16 a[6:7], v4 offset:38912
 v_mul_f32 v73, v73, v64
 v_mfma_f32_16x16x32_bf16 v[76:79], a[56:59], a[152:155], v[76:79]
 s_add_u32 s58, s48, 1009664
 ds_read_b64_tr_b16 a[8:9], v4 offset:40960
 v_mul_f32 v74, v74, v64
 v_mfma_f32_16x16x32_bf16 v[76:79], a[60:63], a[156:159], v[76:79]
 ds_read_b64_tr_b16 a[10:11], v4 offset:43008
 buffer_store_dwordx4 v[112:115], v1, s[12:15], s58 offen sc1
 v_mfma_f32_16x16x32_bf16 v[84:87], a[32:35], a[160:163], 0
 ds_read_b64_tr_b16 a[12:13], v4 offset:45056
 v_mul_f32 v75, v75, v64
 v_mfma_f32_16x16x32_bf16 v[84:87], a[36:39], a[164:167], v[84:87]
 ds_read_b64_tr_b16 a[14:15], v4 offset:47104
 v_mul_f32 v80, v80, v65
 v_mfma_f32_16x16x32_bf16 v[84:87], a[40:43], a[168:171], v[84:87]
 s_add_u32 m0, s29, 90112
 ds_read_b64_tr_b16 a[16:17], v4 offset:49152
 v_mul_f32 v81, v81, v65
 v_mfma_f32_16x16x32_bf16 v[84:87], a[44:47], a[172:175], v[84:87]
 ds_read_b64_tr_b16 a[18:19], v4 offset:51200
 buffer_load_dwordx4 v2, s[8:11], s84 offen lds
 v_mfma_f32_16x16x32_bf16 v[84:87], a[48:51], a[176:179], v[84:87]
 ds_read_b64_tr_b16 a[20:21], v4 offset:53248
 v_mul_f32 v76, v76, v64
 v_mfma_f32_16x16x32_bf16 v[84:87], a[52:55], a[180:183], v[84:87]
 ds_read_b64_tr_b16 a[22:23], v4 offset:55296
 v_mul_f32 v77, v77, v64
 v_mfma_f32_16x16x32_bf16 v[84:87], a[56:59], a[184:187], v[84:87]
 ds_read_b64_tr_b16 a[24:25], v4 offset:57344
 v_mul_f32 v78, v78, v64
 v_mfma_f32_16x16x32_bf16 v[84:87], a[60:63], a[188:191], v[84:87]
 s_waitcnt lgkmcnt(7)
 ds_read_b64_tr_b16 a[26:27], v4 offset:59392
 v_mul_f32 v79, v79, v64
 v_mfma_f32_16x16x32_bf16 v[88:91], a[0:3], a[128:131], 0
 ds_read_b64_tr_b16 a[28:29], v4 offset:61440
 v_cvt_pk_bf16_f32 v72, v72, v73
 v_mfma_f32_16x16x32_bf16 v[88:91], a[4:7], a[132:135], v[88:91]
 s_add_u32 m0, s29, 94208
 ds_read_b64_tr_b16 a[30:31], v4 offset:63488
 v_cvt_pk_bf16_f32 v73, v74, v75
 v_mfma_f32_16x16x32_bf16 v[88:91], a[8:11], a[136:139], v[88:91]
 s_waitcnt lgkmcnt(4)
 ds_read_b64_tr_b16 a[32:33], v5 offset:32768
 buffer_load_dwordx4 v2, s[8:11], s85 offen lds
 v_mfma_f32_16x16x32_bf16 v[88:91], a[12:15], a[140:143], v[88:91]
 ds_read_b64_tr_b16 a[34:35], v5 offset:34816
 v_add_u32 v2, 128, v2
 v_mfma_f32_16x16x32_bf16 v[88:91], a[16:19], a[144:147], v[88:91]
 s_add_u32 s58, s48, 52224
 ds_read_b64_tr_b16 a[36:37], v5 offset:36864
 v_cvt_pk_bf16_f32 v74, v76, v77
 v_mfma_f32_16x16x32_bf16 v[88:91], a[20:23], a[148:151], v[88:91]
 s_waitcnt lgkmcnt(3)
 ds_read_b64_tr_b16 a[38:39], v5 offset:38912
 v_cvt_pk_bf16_f32 v75, v78, v79
 v_mfma_f32_16x16x32_bf16 v[88:91], a[24:27], a[152:155], v[88:91]
 ds_read_b64_tr_b16 a[40:41], v5 offset:40960
 buffer_store_dwordx4 v[72:75], v1, s[12:15], s58 offen sc1
 v_mfma_f32_16x16x32_bf16 v[88:91], a[28:31], a[156:159], v[88:91]
 ds_read_b64_tr_b16 a[42:43], v5 offset:43008
 v_mul_f32 v82, v82, v65
 v_mfma_f32_16x16x32_bf16 v[96:99], a[0:3], a[160:163], 0
 s_add_u32 m0, s29, 98304
 ds_read_b64_tr_b16 a[44:45], v5 offset:45056
 v_mul_f32 v83, v83, v65
 v_mfma_f32_16x16x32_bf16 v[96:99], a[4:7], a[164:167], v[96:99]
 ds_read_b64_tr_b16 a[46:47], v5 offset:47104
 buffer_load_dwordx4 v2, s[8:11], s78 offen lds
 v_mfma_f32_16x16x32_bf16 v[96:99], a[8:11], a[168:171], v[96:99]
 ds_read_b64_tr_b16 a[48:49], v5 offset:49152
 v_mul_f32 v84, v84, v65
 v_mfma_f32_16x16x32_bf16 v[96:99], a[12:15], a[172:175], v[96:99]
 ds_read_b64_tr_b16 a[50:51], v5 offset:51200
 v_mul_f32 v85, v85, v65
 v_mfma_f32_16x16x32_bf16 v[96:99], a[16:19], a[176:179], v[96:99]
 ds_read_b64_tr_b16 a[52:53], v5 offset:53248
 v_mul_f32 v86, v86, v65
 v_mfma_f32_16x16x32_bf16 v[96:99], a[20:23], a[180:183], v[96:99]
 ds_read_b64_tr_b16 a[54:55], v5 offset:55296
 v_mul_f32 v87, v87, v65
 v_mfma_f32_16x16x32_bf16 v[96:99], a[24:27], a[184:187], v[96:99]
 s_add_u32 m0, s29, 102400
 ds_read_b64_tr_b16 a[56:57], v5 offset:57344
 v_cvt_pk_bf16_f32 v80, v80, v81
 v_mfma_f32_16x16x32_bf16 v[96:99], a[28:31], a[188:191], v[96:99]
 s_waitcnt lgkmcnt(7)
 ds_read_b64_tr_b16 a[58:59], v5 offset:59392
 v_cvt_pk_bf16_f32 v81, v82, v83
 v_mfma_f32_16x16x32_bf16 v[92:95], a[32:35], a[128:131], 0
 ds_read_b64_tr_b16 a[60:61], v5 offset:61440
 buffer_load_dwordx4 v2, s[8:11], s79 offen lds
 v_mfma_f32_16x16x32_bf16 v[92:95], a[36:39], a[132:135], v[92:95]
 s_add_u32 s58, s48, 1027072
 ds_read_b64_tr_b16 a[62:63], v5 offset:63488
 v_cvt_pk_bf16_f32 v82, v84, v85
 v_mfma_f32_16x16x32_bf16 v[92:95], a[40:43], a[136:139], v[92:95]
 s_waitcnt lgkmcnt(4)
 ds_read_b64_tr_b16 a[0:1], v6 offset:32768
 v_cvt_pk_bf16_f32 v83, v86, v87
 v_mfma_f32_16x16x32_bf16 v[92:95], a[44:47], a[140:143], v[92:95]
 ds_read_b64_tr_b16 a[2:3], v6 offset:34816
 buffer_store_dwordx4 v[80:83], v1, s[12:15], s58 offen sc1
 v_mfma_f32_16x16x32_bf16 v[92:95], a[48:51], a[144:147], v[92:95]
 ds_read_b64_tr_b16 a[4:5], v6 offset:36864
 v_mul_f32 v88, v88, v64
 v_mfma_f32_16x16x32_bf16 v[92:95], a[52:55], a[148:151], v[92:95]
 s_waitcnt lgkmcnt(3)
 ds_read_b64_tr_b16 a[6:7], v6 offset:38912
 v_mul_f32 v89, v89, v64
 v_mfma_f32_16x16x32_bf16 v[92:95], a[56:59], a[152:155], v[92:95]
 s_add_u32 m0, s29, 106496
 ds_read_b64_tr_b16 a[8:9], v6 offset:40960
 v_mul_f32 v90, v90, v64
 v_mfma_f32_16x16x32_bf16 v[92:95], a[60:63], a[156:159], v[92:95]
 ds_read_b64_tr_b16 a[10:11], v6 offset:43008
 buffer_load_dwordx4 v2, s[8:11], s80 offen lds
 v_mfma_f32_16x16x32_bf16 v[100:103], a[32:35], a[160:163], 0
 ds_read_b64_tr_b16 a[12:13], v6 offset:45056
 v_mul_f32 v91, v91, v64
 v_mfma_f32_16x16x32_bf16 v[100:103], a[36:39], a[164:167], v[100:103]
 ds_read_b64_tr_b16 a[14:15], v6 offset:47104
 v_mul_f32 v96, v96, v65
 v_mfma_f32_16x16x32_bf16 v[100:103], a[40:43], a[168:171], v[100:103]
 ds_read_b64_tr_b16 a[16:17], v6 offset:49152
 v_mul_f32 v97, v97, v65
 v_mfma_f32_16x16x32_bf16 v[100:103], a[44:47], a[172:175], v[100:103]
 ds_read_b64_tr_b16 a[18:19], v6 offset:51200
 v_mul_f32 v98, v98, v65
 v_mfma_f32_16x16x32_bf16 v[100:103], a[48:51], a[176:179], v[100:103]
 ds_read_b64_tr_b16 a[20:21], v6 offset:53248
 v_mul_f32 v92, v92, v64
 v_mfma_f32_16x16x32_bf16 v[100:103], a[52:55], a[180:183], v[100:103]
 s_add_u32 m0, s29, 110592
 ds_read_b64_tr_b16 a[22:23], v6 offset:55296
 v_mul_f32 v93, v93, v64
 v_mfma_f32_16x16x32_bf16 v[100:103], a[56:59], a[184:187], v[100:103]
 ds_read_b64_tr_b16 a[24:25], v6 offset:57344
 buffer_load_dwordx4 v2, s[8:11], s81 offen lds
 v_mfma_f32_16x16x32_bf16 v[100:103], a[60:63], a[188:191], v[100:103]
 s_waitcnt lgkmcnt(7)
 ds_read_b64_tr_b16 a[26:27], v6 offset:59392
 v_mul_f32 v94, v94, v64
 v_mfma_f32_16x16x32_bf16 v[104:107], a[0:3], a[128:131], 0
 ds_read_b64_tr_b16 a[28:29], v6 offset:61440
 v_mul_f32 v95, v95, v64
 v_mfma_f32_16x16x32_bf16 v[104:107], a[4:7], a[132:135], v[104:107]
 ds_read_b64_tr_b16 a[30:31], v6 offset:63488
 v_cvt_pk_bf16_f32 v88, v88, v89
 v_mfma_f32_16x16x32_bf16 v[104:107], a[8:11], a[136:139], v[104:107]
 s_waitcnt lgkmcnt(4)
 ds_read_b64_tr_b16 a[32:33], v7 offset:32768
 v_cvt_pk_bf16_f32 v89, v90, v91
 v_mfma_f32_16x16x32_bf16 v[104:107], a[12:15], a[140:143], v[104:107]
 ds_read_b64_tr_b16 a[34:35], v7 offset:34816
 v_cvt_pk_bf16_f32 v90, v92, v93
 v_mfma_f32_16x16x32_bf16 v[104:107], a[16:19], a[144:147], v[104:107]
 s_add_u32 m0, s29, 114688
 ds_read_b64_tr_b16 a[36:37], v7 offset:36864
 v_cvt_pk_bf16_f32 v91, v94, v95
 v_mfma_f32_16x16x32_bf16 v[104:107], a[20:23], a[148:151], v[104:107]
 s_waitcnt lgkmcnt(3)
 ds_read_b64_tr_b16 a[38:39], v7 offset:38912
 buffer_load_dwordx4 v2, s[8:11], s82 offen lds
 v_mfma_f32_16x16x32_bf16 v[104:107], a[24:27], a[152:155], v[104:107]
 s_add_u32 s58, s48, 69632
 ds_read_b64_tr_b16 a[40:41], v7 offset:40960
 v_mul_f32 v99, v99, v65
 v_mfma_f32_16x16x32_bf16 v[104:107], a[28:31], a[156:159], v[104:107]
 ds_read_b64_tr_b16 a[42:43], v7 offset:43008
 buffer_store_dwordx4 v[88:91], v1, s[12:15], s58 offen sc1
 v_mfma_f32_16x16x32_bf16 v[112:115], a[0:3], a[160:163], 0
 ds_read_b64_tr_b16 a[44:45], v7 offset:45056
 v_mul_f32 v100, v100, v65
 v_mfma_f32_16x16x32_bf16 v[112:115], a[4:7], a[164:167], v[112:115]
 ds_read_b64_tr_b16 a[46:47], v7 offset:47104
 v_mul_f32 v101, v101, v65
 v_mfma_f32_16x16x32_bf16 v[112:115], a[8:11], a[168:171], v[112:115]
 ds_read_b64_tr_b16 a[48:49], v7 offset:49152
 v_mul_f32 v102, v102, v65
 v_mfma_f32_16x16x32_bf16 v[112:115], a[12:15], a[172:175], v[112:115]
 s_add_u32 m0, s29, 118784
 ds_read_b64_tr_b16 a[50:51], v7 offset:51200
 v_mul_f32 v103, v103, v65
 v_mfma_f32_16x16x32_bf16 v[112:115], a[16:19], a[176:179], v[112:115]
 ds_read_b64_tr_b16 a[52:53], v7 offset:53248
 buffer_load_dwordx4 v2, s[8:11], s83 offen lds
 v_mfma_f32_16x16x32_bf16 v[112:115], a[20:23], a[180:183], v[112:115]
 ds_read_b64_tr_b16 a[54:55], v7 offset:55296
 v_cvt_pk_bf16_f32 v96, v96, v97
 v_mfma_f32_16x16x32_bf16 v[112:115], a[24:27], a[184:187], v[112:115]
 ds_read_b64_tr_b16 a[56:57], v7 offset:57344
 v_cvt_pk_bf16_f32 v97, v98, v99
 v_mfma_f32_16x16x32_bf16 v[112:115], a[28:31], a[188:191], v[112:115]
 s_waitcnt lgkmcnt(7)
 ds_read_b64_tr_b16 a[58:59], v7 offset:59392
 v_cvt_pk_bf16_f32 v98, v100, v101
 v_mfma_f32_16x16x32_bf16 v[108:111], a[32:35], a[128:131], 0
 s_waitcnt vmcnt(9)
 ds_read_b64_tr_b16 a[60:61], v7 offset:61440
 v_cvt_pk_bf16_f32 v99, v102, v103
 v_mfma_f32_16x16x32_bf16 v[108:111], a[36:39], a[132:135], v[108:111]
 s_barrier
 ds_read_b64_tr_b16 a[62:63], v7 offset:63488
 v_xor_b32 v4, 0x10000, v4
 v_mfma_f32_16x16x32_bf16 v[108:111], a[40:43], a[136:139], v[108:111]
 s_waitcnt lgkmcnt(4)
 ds_read_b64_tr_b16 a[0:1], v4 offset:0
 v_mul_f32 v104, v104, v64
 v_mfma_f32_16x16x32_bf16 v[108:111], a[44:47], a[140:143], v[108:111]
 s_add_u32 m0, s29, 122880
 ds_read_b64_tr_b16 a[2:3], v4 offset:2048
 v_mul_f32 v105, v105, v64
 v_mfma_f32_16x16x32_bf16 v[108:111], a[48:51], a[144:147], v[108:111]
 ds_read_b64_tr_b16 a[4:5], v4 offset:4096
 buffer_load_dwordx4 v2, s[8:11], s84 offen lds
 v_mfma_f32_16x16x32_bf16 v[108:111], a[52:55], a[148:151], v[108:111]
 s_waitcnt lgkmcnt(3)
 ds_read_b64_tr_b16 a[6:7], v4 offset:6144
 v_mul_f32 v106, v106, v64
 v_mfma_f32_16x16x32_bf16 v[108:111], a[56:59], a[152:155], v[108:111]
 s_add_u32 s58, s48, 1044480
 ds_read_b64_tr_b16 a[8:9], v4 offset:8192
 v_mul_f32 v107, v107, v64
 v_mfma_f32_16x16x32_bf16 v[108:111], a[60:63], a[156:159], v[108:111]
 ds_read_b64_tr_b16 a[10:11], v4 offset:10240
 buffer_store_dwordx4 v[96:99], v1, s[12:15], s58 offen sc1
 v_mfma_f32_16x16x32_bf16 v[116:119], a[32:35], a[160:163], 0
 ds_read_b64_tr_b16 a[12:13], v4 offset:12288
 v_mul_f32 v112, v112, v65
 v_mfma_f32_16x16x32_bf16 v[116:119], a[36:39], a[164:167], v[116:119]
 ds_read_b64_tr_b16 a[14:15], v4 offset:14336
 v_mul_f32 v113, v113, v65
 v_mfma_f32_16x16x32_bf16 v[116:119], a[40:43], a[168:171], v[116:119]
 s_add_u32 m0, s29, 126976
 ds_read_b64_tr_b16 a[16:17], v4 offset:16384
 v_mul_f32 v114, v114, v65
 v_mfma_f32_16x16x32_bf16 v[116:119], a[44:47], a[172:175], v[116:119]
 ds_read_b64_tr_b16 a[18:19], v4 offset:18432
 buffer_load_dwordx4 v2, s[8:11], s85 offen lds
 v_mfma_f32_16x16x32_bf16 v[116:119], a[48:51], a[176:179], v[116:119]
 ds_read_b64_tr_b16 a[20:21], v4 offset:20480
 v_add_u32 v2, 128, v2
 v_mfma_f32_16x16x32_bf16 v[116:119], a[52:55], a[180:183], v[116:119]
 ds_read_b64_tr_b16 a[22:23], v4 offset:22528
 v_mul_f32 v108, v108, v64
 v_mfma_f32_16x16x32_bf16 v[116:119], a[56:59], a[184:187], v[116:119]
 ds_read_b64_tr_b16 a[24:25], v4 offset:24576
 v_mul_f32 v109, v109, v64
 v_mfma_f32_16x16x32_bf16 v[116:119], a[60:63], a[188:191], v[116:119]
 s_waitcnt lgkmcnt(7)
 ds_read_b64_tr_b16 a[26:27], v4 offset:26624
 v_mul_f32 v110, v110, v64
 v_mfma_f32_16x16x32_bf16 v[72:75], a[0:3], a[128:131], 0
 ds_read_b64_tr_b16 a[28:29], v4 offset:28672
 v_mul_f32 v111, v111, v64
 v_mfma_f32_16x16x32_bf16 v[72:75], a[4:7], a[132:135], v[72:75]
 ds_read_b64_tr_b16 a[30:31], v4 offset:30720
 v_xor_b32 v5, 0x10000, v5
 v_mfma_f32_16x16x32_bf16 v[72:75], a[8:11], a[136:139], v[72:75]
 s_waitcnt lgkmcnt(4)
 ds_read_b64_tr_b16 a[32:33], v5 offset:0
 v_cvt_pk_bf16_f32 v104, v104, v105
 v_mfma_f32_16x16x32_bf16 v[72:75], a[12:15], a[140:143], v[72:75]
 s_add_u32 m0, s29, 131072
 ds_read_b64_tr_b16 a[34:35], v5 offset:2048
 v_cvt_pk_bf16_f32 v105, v106, v107
 v_mfma_f32_16x16x32_bf16 v[72:75], a[16:19], a[144:147], v[72:75]
 ds_read_b64_tr_b16 a[36:37], v5 offset:4096
 buffer_load_dwordx4 v2, s[8:11], s78 offen lds
 v_mfma_f32_16x16x32_bf16 v[72:75], a[20:23], a[148:151], v[72:75]
 s_waitcnt lgkmcnt(3)
 ds_read_b64_tr_b16 a[38:39], v5 offset:6144
 v_cvt_pk_bf16_f32 v106, v108, v109
 v_mfma_f32_16x16x32_bf16 v[72:75], a[24:27], a[152:155], v[72:75]
 s_add_u32 s58, s48, 87040
 ds_read_b64_tr_b16 a[40:41], v5 offset:8192
 v_cvt_pk_bf16_f32 v107, v110, v111
 v_mfma_f32_16x16x32_bf16 v[72:75], a[28:31], a[156:159], v[72:75]
 ds_read_b64_tr_b16 a[42:43], v5 offset:10240
 buffer_store_dwordx4 v[104:107], v1, s[12:15], s58 offen sc1
 v_mfma_f32_16x16x32_bf16 v[80:83], a[0:3], a[160:163], 0
 ds_read_b64_tr_b16 a[44:45], v5 offset:12288
 v_mul_f32 v115, v115, v65
 v_mfma_f32_16x16x32_bf16 v[80:83], a[4:7], a[164:167], v[80:83]
 ds_read_b64_tr_b16 a[46:47], v5 offset:14336
 v_mul_f32 v116, v116, v65
 v_mfma_f32_16x16x32_bf16 v[80:83], a[8:11], a[168:171], v[80:83]
 s_add_u32 m0, s29, 135168
 ds_read_b64_tr_b16 a[48:49], v5 offset:16384
 v_mul_f32 v117, v117, v65
 v_mfma_f32_16x16x32_bf16 v[80:83], a[12:15], a[172:175], v[80:83]
 ds_read_b64_tr_b16 a[50:51], v5 offset:18432
 buffer_load_dwordx4 v2, s[8:11], s79 offen lds
 v_mfma_f32_16x16x32_bf16 v[80:83], a[16:19], a[176:179], v[80:83]
 ds_read_b64_tr_b16 a[52:53], v5 offset:20480
 v_mul_f32 v118, v118, v65
 v_mfma_f32_16x16x32_bf16 v[80:83], a[20:23], a[180:183], v[80:83]
 ds_read_b64_tr_b16 a[54:55], v5 offset:22528
 v_mul_f32 v119, v119, v65
 v_mfma_f32_16x16x32_bf16 v[80:83], a[24:27], a[184:187], v[80:83]
 ds_read_b64_tr_b16 a[56:57], v5 offset:24576
 v_cvt_pk_bf16_f32 v112, v112, v113
 v_mfma_f32_16x16x32_bf16 v[80:83], a[28:31], a[188:191], v[80:83]
 s_waitcnt lgkmcnt(7)
 ds_read_b64_tr_b16 a[58:59], v5 offset:26624
 v_cvt_pk_bf16_f32 v113, v114, v115
 v_mfma_f32_16x16x32_bf16 v[76:79], a[32:35], a[128:131], 0
 ds_read_b64_tr_b16 a[60:61], v5 offset:28672
 v_cvt_pk_bf16_f32 v114, v116, v117
 v_mfma_f32_16x16x32_bf16 v[76:79], a[36:39], a[132:135], v[76:79]
 s_add_u32 m0, s29, 139264
 ds_read_b64_tr_b16 a[62:63], v5 offset:30720
 v_xor_b32 v6, 0x10000, v6
 v_mfma_f32_16x16x32_bf16 v[76:79], a[40:43], a[136:139], v[76:79]
 s_waitcnt lgkmcnt(4)
 ds_read_b64_tr_b16 a[0:1], v6 offset:0
 buffer_load_dwordx4 v2, s[8:11], s80 offen lds
 v_mfma_f32_16x16x32_bf16 v[76:79], a[44:47], a[140:143], v[76:79]
 s_add_u32 s58, s48, 1061888
 ds_read_b64_tr_b16 a[2:3], v6 offset:2048
 v_cvt_pk_bf16_f32 v115, v118, v119
 v_mfma_f32_16x16x32_bf16 v[76:79], a[48:51], a[144:147], v[76:79]
 ds_read_b64_tr_b16 a[4:5], v6 offset:4096
 buffer_store_dwordx4 v[112:115], v1, s[12:15], s58 offen sc1
 v_mfma_f32_16x16x32_bf16 v[76:79], a[52:55], a[148:151], v[76:79]
 s_waitcnt lgkmcnt(3)
 ds_read_b64_tr_b16 a[6:7], v6 offset:6144
 v_mul_f32 v72, v72, v64
 v_mfma_f32_16x16x32_bf16 v[76:79], a[56:59], a[152:155], v[76:79]
 ds_read_b64_tr_b16 a[8:9], v6 offset:8192
 v_mul_f32 v73, v73, v64
 v_mfma_f32_16x16x32_bf16 v[76:79], a[60:63], a[156:159], v[76:79]
 ds_read_b64_tr_b16 a[10:11], v6 offset:10240
 v_mul_f32 v74, v74, v64
 v_mfma_f32_16x16x32_bf16 v[84:87], a[32:35], a[160:163], 0
 s_add_u32 m0, s29, 143360
 ds_read_b64_tr_b16 a[12:13], v6 offset:12288
 v_mul_f32 v75, v75, v64
 v_mfma_f32_16x16x32_bf16 v[84:87], a[36:39], a[164:167], v[84:87]
 ds_read_b64_tr_b16 a[14:15], v6 offset:14336
 buffer_load_dwordx4 v2, s[8:11], s81 offen lds
 v_mfma_f32_16x16x32_bf16 v[84:87], a[40:43], a[168:171], v[84:87]
 ds_read_b64_tr_b16 a[16:17], v6 offset:16384
 v_mul_f32 v80, v80, v65
 v_mfma_f32_16x16x32_bf16 v[84:87], a[44:47], a[172:175], v[84:87]
 ds_read_b64_tr_b16 a[18:19], v6 offset:18432
 v_mul_f32 v81, v81, v65
 v_mfma_f32_16x16x32_bf16 v[84:87], a[48:51], a[176:179], v[84:87]
 ds_read_b64_tr_b16 a[20:21], v6 offset:20480
 v_mul_f32 v76, v76, v64
 v_mfma_f32_16x16x32_bf16 v[84:87], a[52:55], a[180:183], v[84:87]
 ds_read_b64_tr_b16 a[22:23], v6 offset:22528
 v_mul_f32 v77, v77, v64
 v_mfma_f32_16x16x32_bf16 v[84:87], a[56:59], a[184:187], v[84:87]
 s_add_u32 m0, s29, 147456
 ds_read_b64_tr_b16 a[24:25], v6 offset:24576
 v_mul_f32 v78, v78, v64
 v_mfma_f32_16x16x32_bf16 v[84:87], a[60:63], a[188:191], v[84:87]
 s_waitcnt lgkmcnt(7)
 ds_read_b64_tr_b16 a[26:27], v6 offset:26624
 v_mul_f32 v79, v79, v64
 v_mfma_f32_16x16x32_bf16 v[88:91], a[0:3], a[128:131], 0
 ds_read_b64_tr_b16 a[28:29], v6 offset:28672
 buffer_load_dwordx4 v2, s[8:11], s82 offen lds
 v_mfma_f32_16x16x32_bf16 v[88:91], a[4:7], a[132:135], v[88:91]
 ds_read_b64_tr_b16 a[30:31], v6 offset:30720
 v_xor_b32 v7, 0x10000, v7
 v_mfma_f32_16x16x32_bf16 v[88:91], a[8:11], a[136:139], v[88:91]
 s_waitcnt lgkmcnt(4)
 ds_read_b64_tr_b16 a[32:33], v7 offset:0
 v_cvt_pk_bf16_f32 v72, v72, v73
 v_mfma_f32_16x16x32_bf16 v[88:91], a[12:15], a[140:143], v[88:91]
 ds_read_b64_tr_b16 a[34:35], v7 offset:2048
 v_cvt_pk_bf16_f32 v73, v74, v75
 v_mfma_f32_16x16x32_bf16 v[88:91], a[16:19], a[144:147], v[88:91]
 ds_read_b64_tr_b16 a[36:37], v7 offset:4096
 v_cvt_pk_bf16_f32 v74, v76, v77
 v_mfma_f32_16x16x32_bf16 v[88:91], a[20:23], a[148:151], v[88:91]
 s_waitcnt lgkmcnt(3)
 ds_read_b64_tr_b16 a[38:39], v7 offset:6144
 v_cvt_pk_bf16_f32 v75, v78, v79
 v_mfma_f32_16x16x32_bf16 v[88:91], a[24:27], a[152:155], v[88:91]
 s_add_u32 m0, s29, 151552
 ds_read_b64_tr_b16 a[40:41], v7 offset:8192
 v_mul_f32 v82, v82, v65
 v_mfma_f32_16x16x32_bf16 v[88:91], a[28:31], a[156:159], v[88:91]
 ds_read_b64_tr_b16 a[42:43], v7 offset:10240
 buffer_load_dwordx4 v2, s[8:11], s83 offen lds
 v_mfma_f32_16x16x32_bf16 v[96:99], a[0:3], a[160:163], 0
 s_add_u32 s58, s48, 104448
 ds_read_b64_tr_b16 a[44:45], v7 offset:12288
 v_mul_f32 v83, v83, v65
 v_mfma_f32_16x16x32_bf16 v[96:99], a[4:7], a[164:167], v[96:99]
 ds_read_b64_tr_b16 a[46:47], v7 offset:14336
 buffer_store_dwordx4 v[72:75], v1, s[12:15], s58 offen sc1
 v_mfma_f32_16x16x32_bf16 v[96:99], a[8:11], a[168:171], v[96:99]
 ds_read_b64_tr_b16 a[48:49], v7 offset:16384
 v_mul_f32 v84, v84, v65
 v_mfma_f32_16x16x32_bf16 v[96:99], a[12:15], a[172:175], v[96:99]
 ds_read_b64_tr_b16 a[50:51], v7 offset:18432
 v_mul_f32 v85, v85, v65
 v_mfma_f32_16x16x32_bf16 v[96:99], a[16:19], a[176:179], v[96:99]
 ds_read_b64_tr_b16 a[52:53], v7 offset:20480
 v_mul_f32 v86, v86, v65
 v_mfma_f32_16x16x32_bf16 v[96:99], a[20:23], a[180:183], v[96:99]
 s_add_u32 m0, s29, 155648
 ds_read_b64_tr_b16 a[54:55], v7 offset:22528
 v_mul_f32 v87, v87, v65
 v_mfma_f32_16x16x32_bf16 v[96:99], a[24:27], a[184:187], v[96:99]
 ds_read_b64_tr_b16 a[56:57], v7 offset:24576
 buffer_load_dwordx4 v2, s[8:11], s84 offen lds
 v_mfma_f32_16x16x32_bf16 v[96:99], a[28:31], a[188:191], v[96:99]
 s_waitcnt lgkmcnt(7)
 ds_read_b64_tr_b16 a[58:59], v7 offset:26624
 v_cvt_pk_bf16_f32 v80, v80, v81
 v_mfma_f32_16x16x32_bf16 v[92:95], a[32:35], a[128:131], 0
 s_waitcnt vmcnt(10)
 ds_read_b64_tr_b16 a[60:61], v7 offset:28672
 v_cvt_pk_bf16_f32 v81, v82, v83
 v_mfma_f32_16x16x32_bf16 v[92:95], a[36:39], a[132:135], v[92:95]
 s_barrier
 ds_read_b64_tr_b16 a[62:63], v7 offset:30720
 v_cvt_pk_bf16_f32 v82, v84, v85
 v_mfma_f32_16x16x32_bf16 v[92:95], a[40:43], a[136:139], v[92:95]
 s_waitcnt lgkmcnt(4)
 ds_read_b64_tr_b16 a[0:1], v4 offset:32768
 v_cvt_pk_bf16_f32 v83, v86, v87
 v_mfma_f32_16x16x32_bf16 v[92:95], a[44:47], a[140:143], v[92:95]
 ds_read_b64_tr_b16 a[2:3], v4 offset:34816
 v_mul_f32 v88, v88, v64
 v_mfma_f32_16x16x32_bf16 v[92:95], a[48:51], a[144:147], v[92:95]
 s_add_u32 m0, s29, 159744
 ds_read_b64_tr_b16 a[4:5], v4 offset:36864
 v_mul_f32 v89, v89, v64
 v_mfma_f32_16x16x32_bf16 v[92:95], a[52:55], a[148:151], v[92:95]
 s_waitcnt lgkmcnt(3)
 ds_read_b64_tr_b16 a[6:7], v4 offset:38912
 buffer_load_dwordx4 v2, s[8:11], s85 offen lds
 v_mfma_f32_16x16x32_bf16 v[92:95], a[56:59], a[152:155], v[92:95]
 s_add_u32 s58, s48, 1079296
 ds_read_b64_tr_b16 a[8:9], v4 offset:40960
 v_add_u32 v2, 128, v2
 v_mfma_f32_16x16x32_bf16 v[92:95], a[60:63], a[156:159], v[92:95]
 ds_read_b64_tr_b16 a[10:11], v4 offset:43008
 buffer_store_dwordx4 v[80:83], v1, s[12:15], s58 offen sc1
 v_mfma_f32_16x16x32_bf16 v[100:103], a[32:35], a[160:163], 0
 ds_read_b64_tr_b16 a[12:13], v4 offset:45056
 v_mul_f32 v90, v90, v64
 v_mfma_f32_16x16x32_bf16 v[100:103], a[36:39], a[164:167], v[100:103]
 ds_read_b64_tr_b16 a[14:15], v4 offset:47104
 v_mul_f32 v91, v91, v64
 v_mfma_f32_16x16x32_bf16 v[100:103], a[40:43], a[168:171], v[100:103]
 ds_read_b64_tr_b16 a[16:17], v4 offset:49152
 v_mul_f32 v96, v96, v65
 v_mfma_f32_16x16x32_bf16 v[100:103], a[44:47], a[172:175], v[100:103]
 ds_read_b64_tr_b16 a[18:19], v4 offset:51200
 v_mul_f32 v97, v97, v65
 v_mfma_f32_16x16x32_bf16 v[100:103], a[48:51], a[176:179], v[100:103]
 ds_read_b64_tr_b16 a[20:21], v4 offset:53248
 v_mul_f32 v92, v92, v64
 v_mfma_f32_16x16x32_bf16 v[100:103], a[52:55], a[180:183], v[100:103]
 ds_read_b64_tr_b16 a[22:23], v4 offset:55296
 v_mul_f32 v93, v93, v64
 v_mfma_f32_16x16x32_bf16 v[100:103], a[56:59], a[184:187], v[100:103]
 ds_read_b64_tr_b16 a[24:25], v4 offset:57344
 v_mul_f32 v94, v94, v64
 v_mfma_f32_16x16x32_bf16 v[100:103], a[60:63], a[188:191], v[100:103]
 s_waitcnt lgkmcnt(7)
 ds_read_b64_tr_b16 a[26:27], v4 offset:59392
 v_mul_f32 v95, v95, v64
 v_mfma_f32_16x16x32_bf16 v[104:107], a[0:3], a[128:131], 0
 ds_read_b64_tr_b16 a[28:29], v4 offset:61440
 v_cvt_pk_bf16_f32 v88, v88, v89
 v_mfma_f32_16x16x32_bf16 v[104:107], a[4:7], a[132:135], v[104:107]
 ds_read_b64_tr_b16 a[30:31], v4 offset:63488
 v_cvt_pk_bf16_f32 v89, v90, v91
 v_mfma_f32_16x16x32_bf16 v[104:107], a[8:11], a[136:139], v[104:107]
 s_waitcnt lgkmcnt(4)
 ds_read_b64_tr_b16 a[32:33], v5 offset:32768
 v_cvt_pk_bf16_f32 v90, v92, v93
 v_mfma_f32_16x16x32_bf16 v[104:107], a[12:15], a[140:143], v[104:107]
 s_add_u32 m0, s29, 0
 ds_read_b64_tr_b16 a[34:35], v5 offset:34816
 v_cvt_pk_bf16_f32 v91, v94, v95
 v_mfma_f32_16x16x32_bf16 v[104:107], a[16:19], a[144:147], v[104:107]
 ds_read_b64_tr_b16 a[36:37], v5 offset:36864
 buffer_load_dwordx4 v2, s[8:11], s78 offen lds
 v_mfma_f32_16x16x32_bf16 v[104:107], a[20:23], a[148:151], v[104:107]
 s_waitcnt lgkmcnt(3)
 ds_read_b64_tr_b16 a[38:39], v5 offset:38912
 v_mul_f32 v98, v98, v65
 v_mfma_f32_16x16x32_bf16 v[104:107], a[24:27], a[152:155], v[104:107]
 s_add_u32 s58, s48, 121856
 ds_read_b64_tr_b16 a[40:41], v5 offset:40960
 v_mul_f32 v99, v99, v65
 v_mfma_f32_16x16x32_bf16 v[104:107], a[28:31], a[156:159], v[104:107]
 ds_read_b64_tr_b16 a[42:43], v5 offset:43008
 buffer_store_dwordx4 v[88:91], v1, s[12:15], s58 offen sc1
 v_mfma_f32_16x16x32_bf16 v[112:115], a[0:3], a[160:163], 0
 ds_read_b64_tr_b16 a[44:45], v5 offset:45056
 v_mul_f32 v100, v100, v65
 v_mfma_f32_16x16x32_bf16 v[112:115], a[4:7], a[164:167], v[112:115]
 ds_read_b64_tr_b16 a[46:47], v5 offset:47104
 v_mul_f32 v101, v101, v65
 v_mfma_f32_16x16x32_bf16 v[112:115], a[8:11], a[168:171], v[112:115]
 s_add_u32 m0, s29, 4096
 ds_read_b64_tr_b16 a[48:49], v5 offset:49152
 v_mul_f32 v102, v102, v65
 v_mfma_f32_16x16x32_bf16 v[112:115], a[12:15], a[172:175], v[112:115]
 ds_read_b64_tr_b16 a[50:51], v5 offset:51200
 buffer_load_dwordx4 v2, s[8:11], s79 offen lds
 v_mfma_f32_16x16x32_bf16 v[112:115], a[16:19], a[176:179], v[112:115]
 ds_read_b64_tr_b16 a[52:53], v5 offset:53248
 v_mul_f32 v103, v103, v65
 v_mfma_f32_16x16x32_bf16 v[112:115], a[20:23], a[180:183], v[112:115]
 ds_read_b64_tr_b16 a[54:55], v5 offset:55296
 v_cvt_pk_bf16_f32 v96, v96, v97
 v_mfma_f32_16x16x32_bf16 v[112:115], a[24:27], a[184:187], v[112:115]
 ds_read_b64_tr_b16 a[56:57], v5 offset:57344
 v_cvt_pk_bf16_f32 v97, v98, v99
 v_mfma_f32_16x16x32_bf16 v[112:115], a[28:31], a[188:191], v[112:115]
 s_waitcnt lgkmcnt(7)
 ds_read_b64_tr_b16 a[58:59], v5 offset:59392
 v_cvt_pk_bf16_f32 v98, v100, v101
 v_mfma_f32_16x16x32_bf16 v[108:111], a[32:35], a[128:131], 0
 ds_read_b64_tr_b16 a[60:61], v5 offset:61440
 v_cvt_pk_bf16_f32 v99, v102, v103
 v_mfma_f32_16x16x32_bf16 v[108:111], a[36:39], a[132:135], v[108:111]
 s_add_u32 m0, s29, 8192
 ds_read_b64_tr_b16 a[62:63], v5 offset:63488
 v_mul_f32 v104, v104, v64
 v_mfma_f32_16x16x32_bf16 v[108:111], a[40:43], a[136:139], v[108:111]
 s_waitcnt lgkmcnt(4)
 ds_read_b64_tr_b16 a[0:1], v6 offset:32768
 buffer_load_dwordx4 v2, s[8:11], s80 offen lds
 v_mfma_f32_16x16x32_bf16 v[108:111], a[44:47], a[140:143], v[108:111]
 s_add_u32 s58, s48, 1096704
 ds_read_b64_tr_b16 a[2:3], v6 offset:34816
 v_mul_f32 v105, v105, v64
 v_mfma_f32_16x16x32_bf16 v[108:111], a[48:51], a[144:147], v[108:111]
 ds_read_b64_tr_b16 a[4:5], v6 offset:36864
 buffer_store_dwordx4 v[96:99], v1, s[12:15], s58 offen sc1
 v_mfma_f32_16x16x32_bf16 v[108:111], a[52:55], a[148:151], v[108:111]
 s_waitcnt lgkmcnt(3)
 ds_read_b64_tr_b16 a[6:7], v6 offset:38912
 v_mul_f32 v106, v106, v64
 v_mfma_f32_16x16x32_bf16 v[108:111], a[56:59], a[152:155], v[108:111]
 ds_read_b64_tr_b16 a[8:9], v6 offset:40960
 v_mul_f32 v107, v107, v64
 v_mfma_f32_16x16x32_bf16 v[108:111], a[60:63], a[156:159], v[108:111]
 ds_read_b64_tr_b16 a[10:11], v6 offset:43008
 v_mul_f32 v112, v112, v65
 v_mfma_f32_16x16x32_bf16 v[116:119], a[32:35], a[160:163], 0
 s_add_u32 m0, s29, 12288
 ds_read_b64_tr_b16 a[12:13], v6 offset:45056
 v_mul_f32 v113, v113, v65
 v_mfma_f32_16x16x32_bf16 v[116:119], a[36:39], a[164:167], v[116:119]
 ds_read_b64_tr_b16 a[14:15], v6 offset:47104
 buffer_load_dwordx4 v2, s[8:11], s81 offen lds
 v_mfma_f32_16x16x32_bf16 v[116:119], a[40:43], a[168:171], v[116:119]
 ds_read_b64_tr_b16 a[16:17], v6 offset:49152
 v_mul_f32 v114, v114, v65
 v_mfma_f32_16x16x32_bf16 v[116:119], a[44:47], a[172:175], v[116:119]
 ds_read_b64_tr_b16 a[18:19], v6 offset:51200
 v_mul_f32 v115, v115, v65
 v_mfma_f32_16x16x32_bf16 v[116:119], a[48:51], a[176:179], v[116:119]
 ds_read_b64_tr_b16 a[20:21], v6 offset:53248
 v_mul_f32 v108, v108, v64
 v_mfma_f32_16x16x32_bf16 v[116:119], a[52:55], a[180:183], v[116:119]
 ds_read_b64_tr_b16 a[22:23], v6 offset:55296
 v_mul_f32 v109, v109, v64
 v_mfma_f32_16x16x32_bf16 v[116:119], a[56:59], a[184:187], v[116:119]
 s_add_u32 m0, s29, 16384
 ds_read_b64_tr_b16 a[24:25], v6 offset:57344
 v_mul_f32 v110, v110, v64
 v_mfma_f32_16x16x32_bf16 v[116:119], a[60:63], a[188:191], v[116:119]
 s_waitcnt lgkmcnt(7)
 ds_read_b64_tr_b16 a[26:27], v6 offset:59392
 v_mul_f32 v111, v111, v64
 v_mfma_f32_16x16x32_bf16 v[72:75], a[0:3], a[128:131], 0
 ds_read_b64_tr_b16 a[28:29], v6 offset:61440
 buffer_load_dwordx4 v2, s[8:11], s82 offen lds
 v_mfma_f32_16x16x32_bf16 v[72:75], a[4:7], a[132:135], v[72:75]
 ds_read_b64_tr_b16 a[30:31], v6 offset:63488
 v_cvt_pk_bf16_f32 v104, v104, v105
 v_mfma_f32_16x16x32_bf16 v[72:75], a[8:11], a[136:139], v[72:75]
 s_waitcnt lgkmcnt(4)
 ds_read_b64_tr_b16 a[32:33], v7 offset:32768
 v_cvt_pk_bf16_f32 v105, v106, v107
 v_mfma_f32_16x16x32_bf16 v[72:75], a[12:15], a[140:143], v[72:75]
 ds_read_b64_tr_b16 a[34:35], v7 offset:34816
 v_cvt_pk_bf16_f32 v106, v108, v109
 v_mfma_f32_16x16x32_bf16 v[72:75], a[16:19], a[144:147], v[72:75]
 s_add_u32 s58, s48, 139264
 ds_read_b64_tr_b16 a[36:37], v7 offset:36864
 v_cvt_pk_bf16_f32 v107, v110, v111
 v_mfma_f32_16x16x32_bf16 v[72:75], a[20:23], a[148:151], v[72:75]
 s_waitcnt lgkmcnt(3)
 ds_read_b64_tr_b16 a[38:39], v7 offset:38912
 buffer_store_dwordx4 v[104:107], v1, s[12:15], s58 offen sc1
 v_mfma_f32_16x16x32_bf16 v[72:75], a[24:27], a[152:155], v[72:75]
 s_add_u32 m0, s29, 20480
 ds_read_b64_tr_b16 a[40:41], v7 offset:40960
 v_mul_f32 v116, v116, v65
 v_mfma_f32_16x16x32_bf16 v[72:75], a[28:31], a[156:159], v[72:75]
 ds_read_b64_tr_b16 a[42:43], v7 offset:43008
 buffer_load_dwordx4 v2, s[8:11], s83 offen lds
 v_mfma_f32_16x16x32_bf16 v[80:83], a[0:3], a[160:163], 0
 ds_read_b64_tr_b16 a[44:45], v7 offset:45056
 v_mul_f32 v117, v117, v65
 v_mfma_f32_16x16x32_bf16 v[80:83], a[4:7], a[164:167], v[80:83]
 ds_read_b64_tr_b16 a[46:47], v7 offset:47104
 v_mul_f32 v118, v118, v65
 v_mfma_f32_16x16x32_bf16 v[80:83], a[8:11], a[168:171], v[80:83]
 ds_read_b64_tr_b16 a[48:49], v7 offset:49152
 v_mul_f32 v119, v119, v65
 v_mfma_f32_16x16x32_bf16 v[80:83], a[12:15], a[172:175], v[80:83]
 ds_read_b64_tr_b16 a[50:51], v7 offset:51200
 v_cvt_pk_bf16_f32 v112, v112, v113
 v_mfma_f32_16x16x32_bf16 v[80:83], a[16:19], a[176:179], v[80:83]
 ds_read_b64_tr_b16 a[52:53], v7 offset:53248
 v_cvt_pk_bf16_f32 v113, v114, v115
 v_mfma_f32_16x16x32_bf16 v[80:83], a[20:23], a[180:183], v[80:83]
 s_add_u32 m0, s29, 24576
 ds_read_b64_tr_b16 a[54:55], v7 offset:55296
 v_cvt_pk_bf16_f32 v114, v116, v117
 v_mfma_f32_16x16x32_bf16 v[80:83], a[24:27], a[184:187], v[80:83]
 ds_read_b64_tr_b16 a[56:57], v7 offset:57344
 buffer_load_dwordx4 v2, s[8:11], s84 offen lds
 v_mfma_f32_16x16x32_bf16 v[80:83], a[28:31], a[188:191], v[80:83]
 s_waitcnt lgkmcnt(7)
 ds_read_b64_tr_b16 a[58:59], v7 offset:59392
 v_cvt_pk_bf16_f32 v115, v118, v119
 v_mfma_f32_16x16x32_bf16 v[76:79], a[32:35], a[128:131], 0
 s_waitcnt vmcnt(10)
 ds_read_b64_tr_b16 a[60:61], v7 offset:61440
 v_mul_f32 v72, v72, v64
 v_mfma_f32_16x16x32_bf16 v[76:79], a[36:39], a[132:135], v[76:79]
 s_barrier
 ds_read_b64_tr_b16 a[62:63], v7 offset:63488
 v_xor_b32 v4, 0x30000, v4
 v_mfma_f32_16x16x32_bf16 v[76:79], a[40:43], a[136:139], v[76:79]
 s_waitcnt lgkmcnt(4)
 ds_read_b64_tr_b16 a[0:1], v4 offset:0
 buffer_store_dword v9, v9, s[12:15], s93 offen offset:64 sc1
 v_mfma_f32_16x16x32_bf16 v[76:79], a[44:47], a[140:143], v[76:79]
 ds_read_b64_tr_b16 a[2:3], v4 offset:2048
 v_mul_f32 v73, v73, v64
 v_mfma_f32_16x16x32_bf16 v[76:79], a[48:51], a[144:147], v[76:79]
 s_add_u32 m0, s29, 28672
 ds_read_b64_tr_b16 a[4:5], v4 offset:4096
 v_mul_f32 v74, v74, v64
 v_mfma_f32_16x16x32_bf16 v[76:79], a[52:55], a[148:151], v[76:79]
 s_waitcnt lgkmcnt(3)
 ds_read_b64_tr_b16 a[6:7], v4 offset:6144
 buffer_load_dwordx4 v2, s[8:11], s85 offen lds
 v_mfma_f32_16x16x32_bf16 v[76:79], a[56:59], a[152:155], v[76:79]
 s_add_u32 s58, s48, 1114112
 ds_read_b64_tr_b16 a[8:9], v4 offset:8192
 v_add_u32 v2, 128, v2
 v_mfma_f32_16x16x32_bf16 v[76:79], a[60:63], a[156:159], v[76:79]
 ds_read_b64_tr_b16 a[10:11], v4 offset:10240
 buffer_store_dwordx4 v[112:115], v1, s[12:15], s58 offen sc1
 v_mfma_f32_16x16x32_bf16 v[84:87], a[32:35], a[160:163], 0
 ds_read_b64_tr_b16 a[12:13], v4 offset:12288
 v_mul_f32 v75, v75, v64
 v_mfma_f32_16x16x32_bf16 v[84:87], a[36:39], a[164:167], v[84:87]
 ds_read_b64_tr_b16 a[14:15], v4 offset:14336
 v_mul_f32 v80, v80, v65
 v_mfma_f32_16x16x32_bf16 v[84:87], a[40:43], a[168:171], v[84:87]
 ds_read_b64_tr_b16 a[16:17], v4 offset:16384
 v_mul_f32 v81, v81, v65
 v_mfma_f32_16x16x32_bf16 v[84:87], a[44:47], a[172:175], v[84:87]
 s_waitcnt lgkmcnt(9)
 ds_read_b64_tr_b16 a[18:19], v4 offset:18432
 v_mul_f32 v82, v82, v65
 v_mfma_f32_16x16x32_bf16 v[84:87], a[48:51], a[176:179], v[84:87]
 s_barrier
 ds_read_b64_tr_b16 a[20:21], v4 offset:20480
 v_mul_f32 v76, v76, v64
 v_mfma_f32_16x16x32_bf16 v[84:87], a[52:55], a[180:183], v[84:87]
 s_add_u32 m0, s33, 4640
 ds_read_b64_tr_b16 a[22:23], v4 offset:22528
 v_mul_f32 v77, v77, v64
 v_mfma_f32_16x16x32_bf16 v[84:87], a[56:59], a[184:187], v[84:87]
 ds_read_b64_tr_b16 a[24:25], v4 offset:24576
 buffer_load_dwordx4 v1, s[4:7], s34 offen offset:0 lds
 v_mfma_f32_16x16x32_bf16 v[84:87], a[60:63], a[188:191], v[84:87]
 s_waitcnt lgkmcnt(7)
 ds_read_b64_tr_b16 a[26:27], v4 offset:26624
 v_mul_f32 v78, v78, v64
 v_mfma_f32_16x16x32_bf16 v[88:91], a[0:3], a[128:131], 0
 ds_read_b64_tr_b16 a[28:29], v4 offset:28672
 v_mul_f32 v79, v79, v64
 v_mfma_f32_16x16x32_bf16 v[88:91], a[4:7], a[132:135], v[88:91]
 ds_read_b64_tr_b16 a[30:31], v4 offset:30720
 v_xor_b32 v5, 0x30000, v5
 v_mfma_f32_16x16x32_bf16 v[88:91], a[8:11], a[136:139], v[88:91]
 s_waitcnt lgkmcnt(4)
 ds_read_b64_tr_b16 a[32:33], v5 offset:0
 v_cvt_pk_bf16_f32 v72, v72, v73
 v_mfma_f32_16x16x32_bf16 v[88:91], a[12:15], a[140:143], v[88:91]
 ds_read_b64_tr_b16 a[34:35], v5 offset:2048
 v_cvt_pk_bf16_f32 v73, v74, v75
 v_mfma_f32_16x16x32_bf16 v[88:91], a[16:19], a[144:147], v[88:91]
 ds_read_b64_tr_b16 a[36:37], v5 offset:4096
 v_cvt_pk_bf16_f32 v74, v76, v77
 v_mfma_f32_16x16x32_bf16 v[88:91], a[20:23], a[148:151], v[88:91]
 s_waitcnt lgkmcnt(3)
 ds_read_b64_tr_b16 a[38:39], v5 offset:6144
 buffer_load_dwordx4 v1, s[4:7], s34 offen offset:1024 lds
 v_mfma_f32_16x16x32_bf16 v[88:91], a[24:27], a[152:155], v[88:91]
 s_add_u32 s58, s48, 156672
 ds_read_b64_tr_b16 a[40:41], v5 offset:8192
 v_cvt_pk_bf16_f32 v75, v78, v79
 v_mfma_f32_16x16x32_bf16 v[88:91], a[28:31], a[156:159], v[88:91]
 ds_read_b64_tr_b16 a[42:43], v5 offset:10240
 buffer_store_dwordx4 v[72:75], v1, s[12:15], s58 offen sc1
 v_mfma_f32_16x16x32_bf16 v[96:99], a[0:3], a[160:163], 0
 ds_read_b64_tr_b16 a[44:45], v5 offset:12288
 v_mul_f32 v83, v83, v65
 v_mfma_f32_16x16x32_bf16 v[96:99], a[4:7], a[164:167], v[96:99]
 ds_read_b64_tr_b16 a[46:47], v5 offset:14336
 v_mul_f32 v84, v84, v65
 v_mfma_f32_16x16x32_bf16 v[96:99], a[8:11], a[168:171], v[96:99]
 ds_read_b64_tr_b16 a[48:49], v5 offset:16384
 v_mul_f32 v85, v85, v65
 v_mfma_f32_16x16x32_bf16 v[96:99], a[12:15], a[172:175], v[96:99]
 ds_read_b64_tr_b16 a[50:51], v5 offset:18432
 v_mul_f32 v86, v86, v65
 v_mfma_f32_16x16x32_bf16 v[96:99], a[16:19], a[176:179], v[96:99]
 ds_read_b64_tr_b16 a[52:53], v5 offset:20480
 buffer_load_dwordx4 v1, s[4:7], s34 offen offset:2048 lds
 v_mfma_f32_16x16x32_bf16 v[96:99], a[20:23], a[180:183], v[96:99]
 ds_read_b64_tr_b16 a[54:55], v5 offset:22528
 v_mul_f32 v87, v87, v65
 v_mfma_f32_16x16x32_bf16 v[96:99], a[24:27], a[184:187], v[96:99]
 ds_read_b64_tr_b16 a[56:57], v5 offset:24576
 v_cvt_pk_bf16_f32 v80, v80, v81
 v_mfma_f32_16x16x32_bf16 v[96:99], a[28:31], a[188:191], v[96:99]
 s_waitcnt lgkmcnt(7)
 ds_read_b64_tr_b16 a[58:59], v5 offset:26624
 v_cvt_pk_bf16_f32 v81, v82, v83
 v_mfma_f32_16x16x32_bf16 v[92:95], a[32:35], a[128:131], 0
 ds_read_b64_tr_b16 a[60:61], v5 offset:28672
 v_cvt_pk_bf16_f32 v82, v84, v85
 v_mfma_f32_16x16x32_bf16 v[92:95], a[36:39], a[132:135], v[92:95]
 ds_read_b64_tr_b16 a[62:63], v5 offset:30720
 v_xor_b32 v6, 0x30000, v6
 v_mfma_f32_16x16x32_bf16 v[92:95], a[40:43], a[136:139], v[92:95]
 s_waitcnt lgkmcnt(4)
 ds_read_b64_tr_b16 a[0:1], v6 offset:0
 v_cvt_pk_bf16_f32 v83, v86, v87
 v_mfma_f32_16x16x32_bf16 v[92:95], a[44:47], a[140:143], v[92:95]
 ds_read_b64_tr_b16 a[2:3], v6 offset:2048
 buffer_load_dwordx4 v1, s[4:7], s34 offen offset:3072 lds
 v_mfma_f32_16x16x32_bf16 v[92:95], a[48:51], a[144:147], v[92:95]
 s_add_u32 s58, s48, 1131520
 ds_read_b64_tr_b16 a[4:5], v6 offset:4096
 v_mul_f32 v88, v88, v64
 v_mfma_f32_16x16x32_bf16 v[92:95], a[52:55], a[148:151], v[92:95]
 s_waitcnt lgkmcnt(3)
 ds_read_b64_tr_b16 a[6:7], v6 offset:6144
 buffer_store_dwordx4 v[80:83], v1, s[12:15], s58 offen sc1
 v_mfma_f32_16x16x32_bf16 v[92:95], a[56:59], a[152:155], v[92:95]
 ds_read_b64_tr_b16 a[8:9], v6 offset:8192
 v_mul_f32 v89, v89, v64
 v_mfma_f32_16x16x32_bf16 v[92:95], a[60:63], a[156:159], v[92:95]
 ds_read_b64_tr_b16 a[10:11], v6 offset:10240
 v_mul_f32 v90, v90, v64
 v_mfma_f32_16x16x32_bf16 v[100:103], a[32:35], a[160:163], 0
 ds_read_b64_tr_b16 a[12:13], v6 offset:12288
 v_mul_f32 v91, v91, v64
 v_mfma_f32_16x16x32_bf16 v[100:103], a[36:39], a[164:167], v[100:103]
 s_add_u32 m0, s33, 128
 ds_read_b64_tr_b16 a[14:15], v6 offset:14336
 v_mul_f32 v96, v96, v65
 v_mfma_f32_16x16x32_bf16 v[100:103], a[40:43], a[168:171], v[100:103]
 ds_read_b64_tr_b16 a[16:17], v6 offset:16384
 buffer_load_dwordx4 v10, s[12:15], s35 offen offset:0 sc1 lds
 v_mfma_f32_16x16x32_bf16 v[100:103], a[44:47], a[172:175], v[100:103]
 ds_read_b64_tr_b16 a[18:19], v6 offset:18432
 v_mul_f32 v97, v97, v65
 v_mfma_f32_16x16x32_bf16 v[100:103], a[48:51], a[176:179], v[100:103]
 ds_read_b64_tr_b16 a[20:21], v6 offset:20480
 v_mul_f32 v92, v92, v64
 v_mfma_f32_16x16x32_bf16 v[100:103], a[52:55], a[180:183], v[100:103]
 ds_read_b64_tr_b16 a[22:23], v6 offset:22528
 v_mul_f32 v93, v93, v64
 v_mfma_f32_16x16x32_bf16 v[100:103], a[56:59], a[184:187], v[100:103]
 ds_read_b64_tr_b16 a[24:25], v6 offset:24576
 v_mul_f32 v94, v94, v64
 v_mfma_f32_16x16x32_bf16 v[100:103], a[60:63], a[188:191], v[100:103]
 s_waitcnt lgkmcnt(7)
 ds_read_b64_tr_b16 a[26:27], v6 offset:26624
 v_mul_f32 v95, v95, v64
 v_mfma_f32_16x16x32_bf16 v[104:107], a[0:3], a[128:131], 0
 ds_read_b64_tr_b16 a[28:29], v6 offset:28672
 v_cvt_pk_bf16_f32 v88, v88, v89
 v_mfma_f32_16x16x32_bf16 v[104:107], a[4:7], a[132:135], v[104:107]
 s_add_u32 m0, s33, 1248
 ds_read_b64_tr_b16 a[30:31], v6 offset:30720
 v_xor_b32 v7, 0x30000, v7
 v_mfma_f32_16x16x32_bf16 v[104:107], a[8:11], a[136:139], v[104:107]
 s_waitcnt lgkmcnt(4)
 ds_read_b64_tr_b16 a[32:33], v7 offset:0
 buffer_load_dwordx4 v10, s[12:15], s35 offen offset:32 sc1 lds
 v_mfma_f32_16x16x32_bf16 v[104:107], a[12:15], a[140:143], v[104:107]
 ds_read_b64_tr_b16 a[34:35], v7 offset:2048
 v_cvt_pk_bf16_f32 v89, v90, v91
 v_mfma_f32_16x16x32_bf16 v[104:107], a[16:19], a[144:147], v[104:107]
 s_add_u32 s58, s48, 174080
 ds_read_b64_tr_b16 a[36:37], v7 offset:4096
 v_cvt_pk_bf16_f32 v90, v92, v93
 v_mfma_f32_16x16x32_bf16 v[104:107], a[20:23], a[148:151], v[104:107]
 s_waitcnt lgkmcnt(3)
 ds_read_b64_tr_b16 a[38:39], v7 offset:6144
 v_cvt_pk_bf16_f32 v91, v94, v95
 v_mfma_f32_16x16x32_bf16 v[104:107], a[24:27], a[152:155], v[104:107]
 ds_read_b64_tr_b16 a[40:41], v7 offset:8192
 buffer_store_dwordx4 v[88:91], v1, s[12:15], s58 offen sc1
 v_mfma_f32_16x16x32_bf16 v[104:107], a[28:31], a[156:159], v[104:107]
 ds_read_b64_tr_b16 a[42:43], v7 offset:10240
 v_mul_f32 v98, v98, v65
 v_mfma_f32_16x16x32_bf16 v[112:115], a[0:3], a[160:163], 0
 s_add_u32 m0, s33, 2368
 ds_read_b64_tr_b16 a[44:45], v7 offset:12288
 v_mul_f32 v99, v99, v65
 v_mfma_f32_16x16x32_bf16 v[112:115], a[4:7], a[164:167], v[112:115]
 ds_read_b64_tr_b16 a[46:47], v7 offset:14336
 buffer_load_dwordx4 v10, s[12:15], s35 offen offset:64 sc1 lds
 v_mfma_f32_16x16x32_bf16 v[112:115], a[8:11], a[168:171], v[112:115]
 ds_read_b64_tr_b16 a[48:49], v7 offset:16384
 v_mul_f32 v100, v100, v65
 v_mfma_f32_16x16x32_bf16 v[112:115], a[12:15], a[172:175], v[112:115]
 ds_read_b64_tr_b16 a[50:51], v7 offset:18432
 v_mul_f32 v101, v101, v65
 v_mfma_f32_16x16x32_bf16 v[112:115], a[16:19], a[176:179], v[112:115]
 ds_read_b64_tr_b16 a[52:53], v7 offset:20480
 v_mul_f32 v102, v102, v65
 v_mfma_f32_16x16x32_bf16 v[112:115], a[20:23], a[180:183], v[112:115]
 ds_read_b64_tr_b16 a[54:55], v7 offset:22528
 v_mul_f32 v103, v103, v65
 v_mfma_f32_16x16x32_bf16 v[112:115], a[24:27], a[184:187], v[112:115]
 s_add_u32 m0, s33, 3488
 ds_read_b64_tr_b16 a[56:57], v7 offset:24576
 v_cvt_pk_bf16_f32 v96, v96, v97
 v_mfma_f32_16x16x32_bf16 v[112:115], a[28:31], a[188:191], v[112:115]
 s_waitcnt lgkmcnt(7)
 ds_read_b64_tr_b16 a[58:59], v7 offset:26624
 v_cvt_pk_bf16_f32 v97, v98, v99
 v_mfma_f32_16x16x32_bf16 v[108:111], a[32:35], a[128:131], 0
 s_waitcnt vmcnt(11)
 ds_read_b64_tr_b16 a[60:61], v7 offset:28672
 buffer_load_dwordx4 v10, s[12:15], s35 offen offset:96 sc1 lds
 v_mfma_f32_16x16x32_bf16 v[108:111], a[36:39], a[132:135], v[108:111]
 s_barrier
 ds_read_b64_tr_b16 a[62:63], v7 offset:30720
 v_xor_b32 v4, 0x20000, v4
 v_mfma_f32_16x16x32_bf16 v[108:111], a[40:43], a[136:139], v[108:111]
 s_waitcnt lgkmcnt(4)
 ds_read_b64_tr_b16 a[0:1], v4 offset:0
 v_cvt_pk_bf16_f32 v98, v100, v101
 v_mfma_f32_16x16x32_bf16 v[108:111], a[44:47], a[140:143], v[108:111]
 s_add_u32 s58, s48, 1148928
 ds_read_b64_tr_b16 a[2:3], v4 offset:2048
 v_cvt_pk_bf16_f32 v99, v102, v103
 v_mfma_f32_16x16x32_bf16 v[108:111], a[48:51], a[144:147], v[108:111]
 ds_read_b64_tr_b16 a[4:5], v4 offset:4096
 buffer_store_dwordx4 v[96:99], v1, s[12:15], s58 offen sc1
 v_mfma_f32_16x16x32_bf16 v[108:111], a[52:55], a[148:151], v[108:111]
 s_waitcnt lgkmcnt(3)
 ds_read_b64_tr_b16 a[6:7], v4 offset:6144
 v_mul_f32 v104, v104, v64
 v_mfma_f32_16x16x32_bf16 v[108:111], a[56:59], a[152:155], v[108:111]
 ds_read_b64_tr_b16 a[8:9], v4 offset:8192
 v_mul_f32 v105, v105, v64
 v_mfma_f32_16x16x32_bf16 v[108:111], a[60:63], a[156:159], v[108:111]
 ds_read_b64_tr_b16 a[10:11], v4 offset:10240
 v_mul_f32 v106, v106, v64
 v_mfma_f32_16x16x32_bf16 v[116:119], a[32:35], a[160:163], 0
 ds_read_b64_tr_b16 a[12:13], v4 offset:12288
 v_mul_f32 v107, v107, v64
 v_mfma_f32_16x16x32_bf16 v[116:119], a[36:39], a[164:167], v[116:119]
 ds_read_b64_tr_b16 a[14:15], v4 offset:14336
 v_mul_f32 v112, v112, v65
 v_mfma_f32_16x16x32_bf16 v[116:119], a[40:43], a[168:171], v[116:119]
 ds_read_b64_tr_b16 a[16:17], v4 offset:16384
 v_mul_f32 v113, v113, v65
 v_mfma_f32_16x16x32_bf16 v[116:119], a[44:47], a[172:175], v[116:119]
 ds_read_b64_tr_b16 a[18:19], v4 offset:18432
 v_mul_f32 v114, v114, v65
 v_mfma_f32_16x16x32_bf16 v[116:119], a[48:51], a[176:179], v[116:119]
 ds_read_b64_tr_b16 a[20:21], v4 offset:20480
 v_mul_f32 v108, v108, v64
 v_mfma_f32_16x16x32_bf16 v[116:119], a[52:55], a[180:183], v[116:119]
 ds_read_b64_tr_b16 a[22:23], v4 offset:22528
 v_mul_f32 v109, v109, v64
 v_mfma_f32_16x16x32_bf16 v[116:119], a[56:59], a[184:187], v[116:119]
 ds_read_b64_tr_b16 a[24:25], v4 offset:24576
 v_mul_f32 v110, v110, v64
 v_mfma_f32_16x16x32_bf16 v[116:119], a[60:63], a[188:191], v[116:119]
 s_waitcnt lgkmcnt(7)
 ds_read_b64_tr_b16 a[26:27], v4 offset:26624
 v_mul_f32 v111, v111, v64
 v_mfma_f32_16x16x32_bf16 v[72:75], a[0:3], a[128:131], 0
 ds_read_b64_tr_b16 a[28:29], v4 offset:28672
 v_cvt_pk_bf16_f32 v104, v104, v105
 v_mfma_f32_16x16x32_bf16 v[72:75], a[4:7], a[132:135], v[72:75]
 ds_read_b64_tr_b16 a[30:31], v4 offset:30720
 v_xor_b32 v5, 0x20000, v5
 v_mfma_f32_16x16x32_bf16 v[72:75], a[8:11], a[136:139], v[72:75]
 s_waitcnt lgkmcnt(4)
 ds_read_b64_tr_b16 a[32:33], v5 offset:0
 v_cvt_pk_bf16_f32 v105, v106, v107
 v_mfma_f32_16x16x32_bf16 v[72:75], a[12:15], a[140:143], v[72:75]
 ds_read_b64_tr_b16 a[34:35], v5 offset:2048
 v_cvt_pk_bf16_f32 v106, v108, v109
 v_mfma_f32_16x16x32_bf16 v[72:75], a[16:19], a[144:147], v[72:75]
 s_add_u32 s58, s48, 191488
 ds_read_b64_tr_b16 a[36:37], v5 offset:4096
 v_cvt_pk_bf16_f32 v107, v110, v111
 v_mfma_f32_16x16x32_bf16 v[72:75], a[20:23], a[148:151], v[72:75]
 s_waitcnt lgkmcnt(3)
 ds_read_b64_tr_b16 a[38:39], v5 offset:6144
 buffer_store_dwordx4 v[104:107], v1, s[12:15], s58 offen sc1
 v_mfma_f32_16x16x32_bf16 v[72:75], a[24:27], a[152:155], v[72:75]
 ds_read_b64_tr_b16 a[40:41], v5 offset:8192
 v_mul_f32 v115, v115, v65
 v_mfma_f32_16x16x32_bf16 v[72:75], a[28:31], a[156:159], v[72:75]
 ds_read_b64_tr_b16 a[42:43], v5 offset:10240
 v_mul_f32 v116, v116, v65
 v_mfma_f32_16x16x32_bf16 v[80:83], a[0:3], a[160:163], 0
 ds_read_b64_tr_b16 a[44:45], v5 offset:12288
 v_mul_f32 v117, v117, v65
 v_mfma_f32_16x16x32_bf16 v[80:83], a[4:7], a[164:167], v[80:83]
 ds_read_b64_tr_b16 a[46:47], v5 offset:14336
 v_mul_f32 v118, v118, v65
 v_mfma_f32_16x16x32_bf16 v[80:83], a[8:11], a[168:171], v[80:83]
 ds_read_b64_tr_b16 a[48:49], v5 offset:16384
 v_mul_f32 v119, v119, v65
 v_mfma_f32_16x16x32_bf16 v[80:83], a[12:15], a[172:175], v[80:83]
 ds_read_b64_tr_b16 a[50:51], v5 offset:18432
 v_cvt_pk_bf16_f32 v112, v112, v113
 v_mfma_f32_16x16x32_bf16 v[80:83], a[16:19], a[176:179], v[80:83]
 ds_read_b64_tr_b16 a[52:53], v5 offset:20480
 v_cvt_pk_bf16_f32 v113, v114, v115
 v_mfma_f32_16x16x32_bf16 v[80:83], a[20:23], a[180:183], v[80:83]
 ds_read_b64_tr_b16 a[54:55], v5 offset:22528
 v_cvt_pk_bf16_f32 v114, v116, v117
 v_mfma_f32_16x16x32_bf16 v[80:83], a[24:27], a[184:187], v[80:83]
 s_add_u32 s58, s48, 1166336
 ds_read_b64_tr_b16 a[56:57], v5 offset:24576
 v_cvt_pk_bf16_f32 v115, v118, v119
 v_mfma_f32_16x16x32_bf16 v[80:83], a[28:31], a[188:191], v[80:83]
 s_waitcnt lgkmcnt(7)
 ds_read_b64_tr_b16 a[58:59], v5 offset:26624
 buffer_store_dwordx4 v[112:115], v1, s[12:15], s58 offen sc1
 v_mfma_f32_16x16x32_bf16 v[76:79], a[32:35], a[128:131], 0
 ds_read_b64_tr_b16 a[60:61], v5 offset:28672
 v_mul_f32 v72, v72, v64
 v_mfma_f32_16x16x32_bf16 v[76:79], a[36:39], a[132:135], v[76:79]
 ds_read_b64_tr_b16 a[62:63], v5 offset:30720
 v_xor_b32 v6, 0x20000, v6
 v_mfma_f32_16x16x32_bf16 v[76:79], a[40:43], a[136:139], v[76:79]
 s_waitcnt lgkmcnt(4)
 ds_read_b64_tr_b16 a[0:1], v6 offset:0
 v_mul_f32 v73, v73, v64
 v_mfma_f32_16x16x32_bf16 v[76:79], a[44:47], a[140:143], v[76:79]
 ds_read_b64_tr_b16 a[2:3], v6 offset:2048
 v_mul_f32 v74, v74, v64
 v_mfma_f32_16x16x32_bf16 v[76:79], a[48:51], a[144:147], v[76:79]
 ds_read_b64_tr_b16 a[4:5], v6 offset:4096
 v_mul_f32 v75, v75, v64
 v_mfma_f32_16x16x32_bf16 v[76:79], a[52:55], a[148:151], v[76:79]
 s_waitcnt lgkmcnt(3)
 ds_read_b64_tr_b16 a[6:7], v6 offset:6144
 v_mul_f32 v80, v80, v65
 v_mfma_f32_16x16x32_bf16 v[76:79], a[56:59], a[152:155], v[76:79]
 ds_read_b64_tr_b16 a[8:9], v6 offset:8192
 v_mul_f32 v81, v81, v65
 v_mfma_f32_16x16x32_bf16 v[76:79], a[60:63], a[156:159], v[76:79]
 ds_read_b64_tr_b16 a[10:11], v6 offset:10240
 v_mul_f32 v82, v82, v65
 v_mfma_f32_16x16x32_bf16 v[84:87], a[32:35], a[160:163], 0
 ds_read_b64_tr_b16 a[12:13], v6 offset:12288
 v_mul_f32 v83, v83, v65
 v_mfma_f32_16x16x32_bf16 v[84:87], a[36:39], a[164:167], v[84:87]
 ds_read_b64_tr_b16 a[14:15], v6 offset:14336
 v_mfma_f32_16x16x32_bf16 v[84:87], a[40:43], a[168:171], v[84:87]
 ds_read_b64_tr_b16 a[16:17], v6 offset:16384
 v_mfma_f32_16x16x32_bf16 v[84:87], a[44:47], a[172:175], v[84:87]
 ds_read_b64_tr_b16 a[18:19], v6 offset:18432
 v_mfma_f32_16x16x32_bf16 v[84:87], a[48:51], a[176:179], v[84:87]
 ds_read_b64_tr_b16 a[20:21], v6 offset:20480
 v_mul_f32 v76, v76, v64
 v_mfma_f32_16x16x32_bf16 v[84:87], a[52:55], a[180:183], v[84:87]
 ds_read_b64_tr_b16 a[22:23], v6 offset:22528
 v_mul_f32 v77, v77, v64
 v_mfma_f32_16x16x32_bf16 v[84:87], a[56:59], a[184:187], v[84:87]
 ds_read_b64_tr_b16 a[24:25], v6 offset:24576
 v_mul_f32 v78, v78, v64
 v_mfma_f32_16x16x32_bf16 v[84:87], a[60:63], a[188:191], v[84:87]
 s_waitcnt lgkmcnt(7)
 ds_read_b64_tr_b16 a[26:27], v6 offset:26624
 v_mul_f32 v79, v79, v64
 v_mfma_f32_16x16x32_bf16 v[88:91], a[0:3], a[128:131], 0
 ds_read_b64_tr_b16 a[28:29], v6 offset:28672
 v_cvt_pk_bf16_f32 v72, v72, v73
 v_mfma_f32_16x16x32_bf16 v[88:91], a[4:7], a[132:135], v[88:91]
 ds_read_b64_tr_b16 a[30:31], v6 offset:30720
 v_xor_b32 v7, 0x20000, v7
 v_mfma_f32_16x16x32_bf16 v[88:91], a[8:11], a[136:139], v[88:91]
 s_waitcnt lgkmcnt(4)
 ds_read_b64_tr_b16 a[32:33], v7 offset:0
 v_cvt_pk_bf16_f32 v73, v74, v75
 v_mfma_f32_16x16x32_bf16 v[88:91], a[12:15], a[140:143], v[88:91]
 ds_read_b64_tr_b16 a[34:35], v7 offset:2048
 v_cvt_pk_bf16_f32 v74, v76, v77
 v_mfma_f32_16x16x32_bf16 v[88:91], a[16:19], a[144:147], v[88:91]
 s_add_u32 s58, s48, 208896
 ds_read_b64_tr_b16 a[36:37], v7 offset:4096
 v_cvt_pk_bf16_f32 v75, v78, v79
 v_mfma_f32_16x16x32_bf16 v[88:91], a[20:23], a[148:151], v[88:91]
 s_waitcnt lgkmcnt(3)
 ds_read_b64_tr_b16 a[38:39], v7 offset:6144
 buffer_store_dwordx4 v[72:75], v1, s[12:15], s58 offen sc1
 v_mfma_f32_16x16x32_bf16 v[88:91], a[24:27], a[152:155], v[88:91]
 ds_read_b64_tr_b16 a[40:41], v7 offset:8192
 v_mul_f32 v84, v84, v65
 v_mfma_f32_16x16x32_bf16 v[88:91], a[28:31], a[156:159], v[88:91]
 ds_read_b64_tr_b16 a[42:43], v7 offset:10240
 v_mul_f32 v85, v85, v65
 v_mfma_f32_16x16x32_bf16 v[96:99], a[0:3], a[160:163], 0
 ds_read_b64_tr_b16 a[44:45], v7 offset:12288
 v_mul_f32 v86, v86, v65
 v_mfma_f32_16x16x32_bf16 v[96:99], a[4:7], a[164:167], v[96:99]
 ds_read_b64_tr_b16 a[46:47], v7 offset:14336
 v_mul_f32 v87, v87, v65
 v_mfma_f32_16x16x32_bf16 v[96:99], a[8:11], a[168:171], v[96:99]
 ds_read_b64_tr_b16 a[48:49], v7 offset:16384
 v_cvt_pk_bf16_f32 v80, v80, v81
 v_mfma_f32_16x16x32_bf16 v[96:99], a[12:15], a[172:175], v[96:99]
 ds_read_b64_tr_b16 a[50:51], v7 offset:18432
 v_cvt_pk_bf16_f32 v81, v82, v83
 v_mfma_f32_16x16x32_bf16 v[96:99], a[16:19], a[176:179], v[96:99]
 ds_read_b64_tr_b16 a[52:53], v7 offset:20480
 v_cvt_pk_bf16_f32 v82, v84, v85
 v_mfma_f32_16x16x32_bf16 v[96:99], a[20:23], a[180:183], v[96:99]
 s_add_u32 s58, s48, 1183744
 ds_read_b64_tr_b16 a[54:55], v7 offset:22528
 v_cvt_pk_bf16_f32 v83, v86, v87
 v_mfma_f32_16x16x32_bf16 v[96:99], a[24:27], a[184:187], v[96:99]
 ds_read_b64_tr_b16 a[56:57], v7 offset:24576
 buffer_store_dwordx4 v[80:83], v1, s[12:15], s58 offen sc1
 v_mfma_f32_16x16x32_bf16 v[96:99], a[28:31], a[188:191], v[96:99]
 s_waitcnt lgkmcnt(7)
 ds_read_b64_tr_b16 a[58:59], v7 offset:26624
 v_mul_f32 v88, v88, v64
 v_mfma_f32_16x16x32_bf16 v[92:95], a[32:35], a[128:131], 0
 ds_read_b64_tr_b16 a[60:61], v7 offset:28672
 v_mul_f32 v89, v89, v64
 v_mfma_f32_16x16x32_bf16 v[92:95], a[36:39], a[132:135], v[92:95]
 ds_read_b64_tr_b16 a[62:63], v7 offset:30720
 v_mul_f32 v90, v90, v64
 v_mfma_f32_16x16x32_bf16 v[92:95], a[40:43], a[136:139], v[92:95]
 s_waitcnt lgkmcnt(4)
 v_mul_f32 v91, v91, v64
 v_mfma_f32_16x16x32_bf16 v[92:95], a[44:47], a[140:143], v[92:95]
 ds_write_b32 v11, v13 offset:0
 v_mfma_f32_16x16x32_bf16 v[92:95], a[48:51], a[144:147], v[92:95]
 ds_write_b32 v11, v13 offset:1152
 v_mul_f32 v96, v96, v65
 v_mul_f32 v97, v97, v65
 v_mfma_f32_16x16x32_bf16 v[92:95], a[52:55], a[148:151], v[92:95]
 s_waitcnt lgkmcnt(0)
 ds_write_b32 v11, v13 offset:2304
 v_mul_f32 v98, v98, v65
 v_mul_f32 v99, v99, v65
 v_mfma_f32_16x16x32_bf16 v[92:95], a[56:59], a[152:155], v[92:95]
 ds_write_b32 v11, v13 offset:3456
 v_mfma_f32_16x16x32_bf16 v[92:95], a[60:63], a[156:159], v[92:95]
 ds_write_b32 v12, v13 offset:4608
 v_mfma_f32_16x16x32_bf16 v[100:103], a[32:35], a[160:163], 0
 v_mfma_f32_16x16x32_bf16 v[100:103], a[36:39], a[164:167], v[100:103]
 v_mfma_f32_16x16x32_bf16 v[100:103], a[40:43], a[168:171], v[100:103]
 v_mfma_f32_16x16x32_bf16 v[100:103], a[44:47], a[172:175], v[100:103]
 v_mfma_f32_16x16x32_bf16 v[100:103], a[48:51], a[176:179], v[100:103]
 v_mfma_f32_16x16x32_bf16 v[100:103], a[52:55], a[180:183], v[100:103]
 v_mfma_f32_16x16x32_bf16 v[100:103], a[56:59], a[184:187], v[100:103]
 v_mfma_f32_16x16x32_bf16 v[100:103], a[60:63], a[188:191], v[100:103]
 s_nop 4
 v_mul_f32 v92, v92, v64
 v_mul_f32 v93, v93, v64
 v_mul_f32 v94, v94, v64
 v_mul_f32 v95, v95, v64
 v_cvt_pk_bf16_f32 v88, v88, v89
 v_cvt_pk_bf16_f32 v89, v90, v91
 v_cvt_pk_bf16_f32 v90, v92, v93
 v_cvt_pk_bf16_f32 v91, v94, v95
 s_add_u32 s58, s48, 226304
 buffer_store_dwordx4 v[88:91], v1, s[12:15], s58 offen sc1
 v_mul_f32 v100, v100, v65
 v_mul_f32 v101, v101, v65
 v_mul_f32 v102, v102, v65
 v_mul_f32 v103, v103, v65
 v_cvt_pk_bf16_f32 v96, v96, v97
 v_cvt_pk_bf16_f32 v97, v98, v99
 v_cvt_pk_bf16_f32 v98, v100, v101
 v_cvt_pk_bf16_f32 v99, v102, v103
 s_add_u32 s58, s48, 1201152
 buffer_store_dwordx4 v[96:99], v1, s[12:15], s58 offen sc1
 s_cmp_ge_u32 s28, 14
 s_cbranch_scc1 L_idle
 v_and_b32 v22, 15, v0
 v_lshrrev_b32 v23, 4, v0
 v_lshl_add_u32 v18, v22, 3, s33
 v_lshl_add_u32 v16, v23, 4, v18
 v_lshl_add_u32 v18, v23, 1, v18
 v_and_b32 v17, 3, v0
 v_bfe_u32 v24, v0, 2, 2
 v_sub_u32 v17, v17, v24
 v_lshlrev_b32 v24, 3, v23
 v_sub_u32 v17, v17, v24
 v_add_u32 v17, 32, v17
 v_lshl_add_u32 v17, v17, 3, s33
 v_lshlrev_b32 v20, 5, v22
 v_lshl_add_u32 v20, v23, 3, v20
 v_add_u32 v24, -1, v0
 v_and_b32 v24, 15, v24
 v_add_u32 v24, 48, v24
 v_add_u32 v19, -16, v0
 v_cmp_gt_u32 vcc, 16, v0
 v_accvgpr_read_b32 v21, a245
 s_add_u32 s34, s35, 4194304
 v_cndmask_b32 v19, v19, v24, vcc
 v_lshlrev_b32 v19, 2, v19
 v_cmp_eq_u32 vcc, 63, v0
 s_lshl_b32 s30, s31, 16
 s_and_b32 s31, s31, 0xffff0000
 s_bitcmp1_b32 s3, 0
 s_cselect_b32 s31, s31, s30
 v_mov_b64 v[224:225], 0
 v_mov_b64 v[226:227], 0
 v_mov_b64 v[228:229], 0
 v_mov_b64 v[230:231], 0
 v_mov_b64 v[232:233], 0
 v_mov_b64 v[234:235], 0
 v_mov_b64 v[236:237], 0
 v_mov_b64 v[238:239], 0
 v_mov_b64 v[240:241], 0
 v_mov_b64 v[242:243], 0
 v_mov_b64 v[244:245], 0
 v_mov_b64 v[246:247], 0
 v_mov_b64 v[248:249], 0
 v_mov_b64 v[250:251], 0
 v_mov_b64 v[252:253], 0
 v_mov_b64 v[254:255], 0
 s_waitcnt vmcnt(7) lgkmcnt(0)
 ds_read_b64_tr_b16 v[160:161], v17 offset:4608
 ds_read_b64_tr_b16 v[162:163], v17 offset:4576
 ds_read_b64_tr_b16 v[164:165], v17 offset:4864
 ds_read_b64_tr_b16 v[166:167], v17 offset:4832
 ds_read_b64 a[4:5], v16 offset:72
 ds_read_b64 a[6:7], v16 offset:80
 ds_read_b64 a[0:1], v16 offset:8
 ds_read_b64 a[2:3], v16 offset:16
 s_waitcnt lgkmcnt(6)
 ds_read_b64 a[68:69], v16 offset:1224
 ds_read_b64 a[70:71], v16 offset:1232
 ds_read_b64 a[64:65], v16 offset:1160
 ds_read_b64 a[66:67], v16 offset:1168
 ds_read_b64 a[132:133], v16 offset:2376
 ds_read_b64 a[134:135], v16 offset:2384
 ds_read_b64 a[128:129], v16 offset:2312
 ds_read_b64 a[130:131], v16 offset:2320
 s_waitcnt lgkmcnt(6)
 ds_read_b64 a[196:197], v16 offset:3528
 ds_read_b64 a[198:199], v16 offset:3536
 ds_read_b64 a[192:193], v16 offset:3464
 ds_read_b64 a[194:195], v16 offset:3472
 ds_read_b64_tr_b16 v[168:169], v17 offset:5120
 ds_read_b64_tr_b16 v[170:171], v17 offset:5088
 ds_read_b64_tr_b16 v[172:173], v17 offset:5376
 ds_read_b64_tr_b16 v[174:175], v17 offset:5344
 s_waitcnt lgkmcnt(6)
 ds_read_b64 a[12:13], v16 offset:200
 ds_read_b64 a[14:15], v16 offset:208
 ds_read_b64 a[8:9], v16 offset:136
 ds_read_b64 a[10:11], v16 offset:144
 ds_read_b64 a[76:77], v16 offset:1352
 ds_read_b64 a[78:79], v16 offset:1360
 ds_read_b64 a[72:73], v16 offset:1288
 ds_read_b64 a[74:75], v16 offset:1296
 s_waitcnt lgkmcnt(6)
 ds_read_b64 a[140:141], v16 offset:2504
 ds_read_b64 a[142:143], v16 offset:2512
 ds_read_b64 a[136:137], v16 offset:2440
 ds_read_b64 a[138:139], v16 offset:2448
 ds_read_b64 a[204:205], v16 offset:3656
 ds_read_b64 a[206:207], v16 offset:3664
 ds_read_b64 a[200:201], v16 offset:3592
 ds_read_b64 a[202:203], v16 offset:3600
 s_waitcnt lgkmcnt(6)
 ds_read_b64_tr_b16 v[176:177], v17 offset:5632
 ds_read_b64_tr_b16 v[178:179], v17 offset:5600
 ds_read_b64_tr_b16 v[180:181], v17 offset:5888
 ds_read_b64_tr_b16 v[182:183], v17 offset:5856
 s_waitcnt lgkmcnt(0)
 v_lshlrev_b32 v11, 2, v22
 s_add_u32 s45, s44, 1088
 v_mfma_f32_16x16x32_bf16 v[32:35], v[160:163], a[4:7], 0
 ds_read_b64 a[20:21], v16 offset:328
 v_mfma_f32_16x16x32_bf16 v[32:35], v[164:167], a[0:3], v[32:35]
 ds_read_b64 a[22:23], v16 offset:336
 v_mfma_f32_16x16x32_bf16 v[36:39], v[160:163], a[68:71], 0
 ds_read_b64 a[16:17], v16 offset:264
 v_mfma_f32_16x16x32_bf16 v[36:39], v[164:167], a[64:67], v[36:39]
 ds_read_b64 a[18:19], v16 offset:272
 v_mfma_f32_16x16x32_bf16 v[40:43], v[160:163], a[132:135], 0
 ds_read_b64 a[84:85], v16 offset:1480
 v_mfma_f32_16x16x32_bf16 v[40:43], v[164:167], a[128:131], v[40:43]
 s_waitcnt vmcnt(0)
 ds_read_b64 a[86:87], v16 offset:1488
 v_mfma_f32_16x16x32_bf16 v[44:47], v[160:163], a[196:199], 0
 s_barrier
 ds_read_b64 a[80:81], v16 offset:1416
 v_mfma_f32_16x16x32_bf16 v[44:47], v[164:167], a[192:195], v[44:47]
 ds_read_b64 a[82:83], v16 offset:1424
 buffer_store_dword v21, v21, s[12:15], s93 offen sc1
 v_mfma_f32_16x16x32_bf16 v[48:51], v[160:163], a[12:15], 0
 ds_read_b64 a[148:149], v16 offset:2632
 v_mfma_f32_16x16x32_bf16 v[48:51], v[164:167], a[8:11], v[48:51]
 ds_read_b64 a[150:151], v16 offset:2640
 v_mfma_f32_16x16x32_bf16 v[48:51], v[168:171], a[4:7], v[48:51]
 ds_read_b64 a[144:145], v16 offset:2568
 v_mfma_f32_16x16x32_bf16 v[48:51], v[172:175], a[0:3], v[48:51]
 s_lshl_b32 s42, s42, 4
 ds_read_b64 a[146:147], v16 offset:2576
 v_mfma_f32_16x16x32_bf16 v[52:55], v[160:163], a[76:79], 0
 s_lshl_b32 s36, s41, 6
 ds_read_b64 a[212:213], v16 offset:3784
 v_mfma_f32_16x16x32_bf16 v[52:55], v[164:167], a[72:75], v[52:55]
 s_add_u32 s36, s36, 896
 ds_read_b64 a[214:215], v16 offset:3792
 v_mfma_f32_16x16x32_bf16 v[52:55], v[168:171], a[68:71], v[52:55]
 s_add_u32 s35, s36, 1835008
 ds_read_b64 a[208:209], v16 offset:3720
 v_mfma_f32_16x16x32_bf16 v[52:55], v[172:175], a[64:67], v[52:55]
 s_add_u32 s39, s37, 15597568
 ds_read_b64 a[210:211], v16 offset:3728
 v_mfma_f32_16x16x32_bf16 v[56:59], v[160:163], a[140:143], 0
 s_mov_b32 s8, s88
 ds_read_b64_tr_b16 v[184:185], v17 offset:6144
 v_mfma_f32_16x16x32_bf16 v[56:59], v[164:167], a[136:139], v[56:59]
 s_mov_b32 s9, s89
 ds_read_b64_tr_b16 v[186:187], v17 offset:6112
 v_mfma_f32_16x16x32_bf16 v[56:59], v[168:171], a[132:135], v[56:59]
 s_mov_b32 s10, 3670016
 ds_read_b64_tr_b16 v[188:189], v17 offset:6400
 v_mfma_f32_16x16x32_bf16 v[56:59], v[172:175], a[128:131], v[56:59]
 s_mov_b32 s11, 0x20000
 ds_read_b64_tr_b16 v[190:191], v17 offset:6368
 v_and_b32 v2, 15, v0
 v_mfma_f32_16x16x32_bf16 v[60:63], v[160:163], a[204:207], 0
 ds_read_b64 a[28:29], v16 offset:456
 v_add_u32 v2, s42, v2
 v_mfma_f32_16x16x32_bf16 v[60:63], v[164:167], a[200:203], v[60:63]
 ds_read_b64 a[30:31], v16 offset:464
 v_mul_u32_u24 v7, 896, v2
 v_mfma_f32_16x16x32_bf16 v[60:63], v[168:171], a[196:199], v[60:63]
 ds_read_b64 a[24:25], v16 offset:392
 v_lshrrev_b32 v3, 4, v0
 v_mfma_f32_16x16x32_bf16 v[60:63], v[172:175], a[192:195], v[60:63]
 s_waitcnt lgkmcnt(15)
 ds_read_b64 a[26:27], v16 offset:400
 v_lshlrev_b32 v8, 4, v3
 v_mfma_f32_16x16x32_bf16 v[64:67], v[160:163], a[20:23], 0
 ds_read_b64 a[92:93], v16 offset:1608
 v_lshl_add_u32 v2, v7, 1, v8
 v_mfma_f32_16x16x32_bf16 v[64:67], v[164:167], a[16:19], v[64:67]
 ds_read_b64 a[94:95], v16 offset:1616
 v_add_u32 v7, v7, v8
 v_mfma_f32_16x16x32_bf16 v[64:67], v[168:171], a[12:15], v[64:67]
 ds_read_b64 a[88:89], v16 offset:1544
 v_and_b32 v4, 1, v0
 v_mfma_f32_16x16x32_bf16 v[64:67], v[172:175], a[8:11], v[64:67]
 ds_read_b64 a[90:91], v16 offset:1552
 v_lshlrev_b32 v4, 4, v4
 v_mfma_f32_16x16x32_bf16 v[64:67], v[176:179], a[4:7], v[64:67]
 ds_read_b64 a[156:157], v16 offset:2760
 v_mov_b32 v5, 0x3f80
 v_mfma_f32_16x16x32_bf16 v[64:67], v[180:183], a[0:3], v[64:67]
 ds_read_b64 a[158:159], v16 offset:2768
 v_lshlrev_b32 v4, v4, v5
 v_mfma_f32_16x16x32_bf16 v[68:71], v[160:163], a[84:87], 0
 ds_read_b64 a[152:153], v16 offset:2696
 v_bfe_u32 v5, v0, 3, 1
 v_mfma_f32_16x16x32_bf16 v[68:71], v[164:167], a[80:83], v[68:71]
 ds_read_b64 a[154:155], v16 offset:2704
 v_bfe_u32 v6, v0, 1, 1
 v_mfma_f32_16x16x32_bf16 v[68:71], v[168:171], a[76:79], v[68:71]
 ds_read_b64 a[220:221], v16 offset:3912
 v_lshl_add_u32 v5, v5, 1, v6
 v_mfma_f32_16x16x32_bf16 v[68:71], v[172:175], a[72:75], v[68:71]
 ds_read_b64 a[222:223], v16 offset:3920
 v_bfe_u32 v6, v0, 2, 1
 v_mfma_f32_16x16x32_bf16 v[68:71], v[176:179], a[68:71], v[68:71]
 ds_read_b64 a[216:217], v16 offset:3848
 v_lshlrev_b32 v6, 1, v6
 v_mfma_f32_16x16x32_bf16 v[68:71], v[180:183], a[64:67], v[68:71]
 s_waitcnt lgkmcnt(15)
 ds_read_b64 a[218:219], v16 offset:3856
 v_sub_u32 v6, v3, v6
 v_mfma_f32_16x16x32_bf16 v[72:75], v[160:163], a[148:151], 0
 ds_read_b64_tr_b16 v[192:193], v17 offset:6656
 v_lshl_add_u32 v5, v6, 2, v5
 v_mfma_f32_16x16x32_bf16 v[72:75], v[164:167], a[144:147], v[72:75]
 ds_read_b64_tr_b16 v[194:195], v17 offset:6624
 v_cmp_eq_u32 s[16:17], 0, v5
 v_mfma_f32_16x16x32_bf16 v[72:75], v[168:171], a[140:143], v[72:75]
 ds_read_b64_tr_b16 v[196:197], v17 offset:6912
 v_cmp_eq_u32 s[18:19], 1, v5
 v_mfma_f32_16x16x32_bf16 v[72:75], v[172:175], a[136:139], v[72:75]
 ds_read_b64_tr_b16 v[198:199], v17 offset:6880
 v_cmp_eq_u32 s[20:21], 2, v5
 v_mfma_f32_16x16x32_bf16 v[72:75], v[176:179], a[132:135], v[72:75]
 ds_read_b64 a[36:37], v16 offset:584
 v_cmp_eq_u32 s[22:23], 3, v5
 v_mfma_f32_16x16x32_bf16 v[72:75], v[180:183], a[128:131], v[72:75]
 ds_read_b64 a[38:39], v16 offset:592
 v_cndmask_b32 v24, 0, v4, s[16:17]
 v_mfma_f32_16x16x32_bf16 v[76:79], v[160:163], a[212:215], 0
 ds_read_b64 a[32:33], v16 offset:520
 v_cndmask_b32 v25, 0, v4, s[18:19]
 v_mfma_f32_16x16x32_bf16 v[76:79], v[164:167], a[208:211], v[76:79]
 ds_read_b64 a[34:35], v16 offset:528
 v_cndmask_b32 v26, 0, v4, s[20:21]
 v_mfma_f32_16x16x32_bf16 v[76:79], v[168:171], a[204:207], v[76:79]
 ds_read_b64 a[100:101], v16 offset:1736
 v_cndmask_b32 v27, 0, v4, s[22:23]
 v_mfma_f32_16x16x32_bf16 v[76:79], v[172:175], a[200:203], v[76:79]
 ds_read_b64 a[102:103], v16 offset:1744
 v_cmp_eq_u32 s[16:17], 4, v5
 v_mfma_f32_16x16x32_bf16 v[76:79], v[176:179], a[196:199], v[76:79]
 ds_read_b64 a[96:97], v16 offset:1672
 v_cmp_eq_u32 s[18:19], 5, v5
 v_mfma_f32_16x16x32_bf16 v[76:79], v[180:183], a[192:195], v[76:79]
 s_waitcnt lgkmcnt(15)
 ds_read_b64 a[98:99], v16 offset:1680
 v_cmp_eq_u32 s[20:21], 6, v5
 v_mfma_f32_16x16x32_bf16 v[80:83], v[160:163], a[28:31], 0
 ds_read_b64 a[164:165], v16 offset:2888
 v_cmp_eq_u32 s[22:23], 7, v5
 v_mfma_f32_16x16x32_bf16 v[80:83], v[164:167], a[24:27], v[80:83]
 ds_read_b64 a[166:167], v16 offset:2896
 buffer_load_dword v23, v11, s[12:15], s44 offen offset:64 sc1
 v_mfma_f32_16x16x32_bf16 v[80:83], v[168:171], a[20:23], v[80:83]
 ds_read_b64 a[160:161], v16 offset:2824
 v_cndmask_b32 v28, 0, v4, s[16:17]
 v_mfma_f32_16x16x32_bf16 v[80:83], v[172:175], a[16:19], v[80:83]
 ds_read_b64 a[162:163], v16 offset:2832
 v_cndmask_b32 v29, 0, v4, s[18:19]
 v_mfma_f32_16x16x32_bf16 v[80:83], v[176:179], a[12:15], v[80:83]
 ds_read_b64 a[228:229], v16 offset:4040
 v_cndmask_b32 v30, 0, v4, s[20:21]
 v_mfma_f32_16x16x32_bf16 v[80:83], v[180:183], a[8:11], v[80:83]
 ds_read_b64 a[230:231], v16 offset:4048
 v_cndmask_b32 v31, 0, v4, s[22:23]
 v_mfma_f32_16x16x32_bf16 v[80:83], v[184:187], a[4:7], v[80:83]
 s_mov_b32 s16, s64
 ds_read_b64 a[224:225], v16 offset:3976
 v_mfma_f32_16x16x32_bf16 v[80:83], v[188:191], a[0:3], v[80:83]
 s_mov_b32 s17, s65
 ds_read_b64 a[226:227], v16 offset:3984
 v_mfma_f32_16x16x32_bf16 v[84:87], v[160:163], a[92:95], 0
 s_mov_b32 s18, 1835008
 ds_read_b64_tr_b16 v[200:201], v17 offset:7168
 v_mfma_f32_16x16x32_bf16 v[84:87], v[164:167], a[88:91], v[84:87]
 s_mov_b32 s19, 0x20000
 ds_read_b64_tr_b16 v[202:203], v17 offset:7136
 v_mfma_f32_16x16x32_bf16 v[84:87], v[168:171], a[84:87], v[84:87]
 s_lshl_b32 s93, s95, 2
 ds_read_b64_tr_b16 v[204:205], v17 offset:7424
 v_mfma_f32_16x16x32_bf16 v[84:87], v[172:175], a[80:83], v[84:87]
 s_add_u32 s93, s93, 84963328
 ds_read_b64_tr_b16 v[206:207], v17 offset:7392
 v_mfma_f32_16x16x32_bf16 v[84:87], v[176:179], a[76:79], v[84:87]
 s_lshl_b32 s43, s41, 6
 ds_read_b64 a[44:45], v16 offset:712
 v_mfma_f32_16x16x32_bf16 v[84:87], v[180:183], a[72:75], v[84:87]
 s_add_u32 s43, s43, 84963328
 ds_read_b64 a[46:47], v16 offset:720
 v_mfma_f32_16x16x32_bf16 v[84:87], v[184:187], a[68:71], v[84:87]
 s_lshl_b32 s46, s41, 7
 ds_read_b64 a[40:41], v16 offset:648
 v_mfma_f32_16x16x32_bf16 v[84:87], v[188:191], a[64:67], v[84:87]
 s_add_u32 s54, s46, 917504
 ds_read_b64 a[42:43], v16 offset:656
 v_mfma_f32_16x16x32_bf16 v[88:91], v[160:163], a[156:159], 0
 s_add_u32 s55, s46, 1835008
 ds_read_b64 a[108:109], v16 offset:1864
 v_mfma_f32_16x16x32_bf16 v[88:91], v[164:167], a[152:155], v[88:91]
 s_lshl_b32 s56, s42, 1
 ds_read_b64 a[110:111], v16 offset:1872
 v_mfma_f32_16x16x32_bf16 v[88:91], v[168:171], a[148:151], v[88:91]
 s_mul_i32 s57, s41, 262144
 ds_read_b64 a[104:105], v16 offset:1800
 v_mfma_f32_16x16x32_bf16 v[88:91], v[172:175], a[144:147], v[88:91]
 s_add_u32 s56, s56, s57
 ds_read_b64 a[106:107], v16 offset:1808
 v_mfma_f32_16x16x32_bf16 v[88:91], v[176:179], a[140:143], v[88:91]
 s_add_u32 s56, s56, 90177536
 ds_read_b64 a[172:173], v16 offset:3016
 v_mfma_f32_16x16x32_bf16 v[88:91], v[180:183], a[136:139], v[88:91]
 s_add_u32 s57, s56, 131072
 ds_read_b64 a[174:175], v16 offset:3024
 v_mfma_f32_16x16x32_bf16 v[88:91], v[184:187], a[132:135], v[88:91]
 s_lshl_b32 s58, s3, 12
 ds_read_b64 a[168:169], v16 offset:2952
 v_mfma_f32_16x16x32_bf16 v[88:91], v[188:191], a[128:131], v[88:91]
 s_waitcnt lgkmcnt(15)
 ds_read_b64 a[170:171], v16 offset:2960
 v_mfma_f32_16x16x32_bf16 v[92:95], v[160:163], a[220:223], 0
 s_add_u32 s58, s58, 0x20000
 ds_read_b64 a[236:237], v16 offset:4168
 v_mfma_f32_16x16x32_bf16 v[92:95], v[164:167], a[216:219], v[92:95]
 s_mov_b32 s59, 0xffff0000
 ds_read_b64 a[238:239], v16 offset:4176
 v_mfma_f32_16x16x32_bf16 v[92:95], v[168:171], a[212:215], v[92:95]
 s_lshl_b32 s47, s3, 14
 ds_read_b64 a[232:233], v16 offset:4104
 v_lshrrev_b32 v8, 1, v0
 v_mfma_f32_16x16x32_bf16 v[92:95], v[172:175], a[208:211], v[92:95]
 ds_read_b64 a[234:235], v16 offset:4112
 v_mul_u32_u24 v8, 4096, v8
 v_mfma_f32_16x16x32_bf16 v[92:95], v[176:179], a[204:207], v[92:95]
 ds_read_b64_tr_b16 v[208:209], v17 offset:7680
 v_and_b32 v9, 1, v0
 v_mfma_f32_16x16x32_bf16 v[92:95], v[180:183], a[200:203], v[92:95]
 ds_read_b64_tr_b16 v[210:211], v17 offset:7648
 v_lshl_add_u32 v8, v9, 4, v8
 v_mfma_f32_16x16x32_bf16 v[92:95], v[184:187], a[196:199], v[92:95]
 ds_read_b64_tr_b16 v[212:213], v17 offset:7936
 v_lshlrev_b32 v10, 3, v3
 v_mfma_f32_16x16x32_bf16 v[92:95], v[188:191], a[192:195], v[92:95]
 ds_read_b64_tr_b16 v[214:215], v17 offset:7904
 v_bfe_u32 v6, v0, 2, 2
 v_mfma_f32_16x16x32_bf16 v[96:99], v[160:163], a[36:39], 0
 ds_read_b64 a[52:53], v16 offset:840
 v_add_u32 v10, v10, v6
 v_mfma_f32_16x16x32_bf16 v[96:99], v[164:167], a[32:35], v[96:99]
 ds_read_b64 a[54:55], v16 offset:848
 v_lshlrev_b32 v10, 5, v10
 v_mfma_f32_16x16x32_bf16 v[96:99], v[168:171], a[28:31], v[96:99]
 ds_read_b64 a[48:49], v16 offset:776
 v_and_b32 v6, 3, v0
 v_mfma_f32_16x16x32_bf16 v[96:99], v[172:175], a[24:27], v[96:99]
 ds_read_b64 a[50:51], v16 offset:784
 v_lshl_add_u32 v10, v6, 3, v10
 v_mfma_f32_16x16x32_bf16 v[96:99], v[176:179], a[20:23], v[96:99]
 ds_read_b64 a[116:117], v16 offset:1992
 v_add_u32 v10, s58, v10
 v_mfma_f32_16x16x32_bf16 v[96:99], v[180:183], a[16:19], v[96:99]
 ds_read_b64 a[118:119], v16 offset:2000
 v_add_u32 v9, s47, v1
 v_mfma_f32_16x16x32_bf16 v[96:99], v[184:187], a[12:15], v[96:99]
 ds_read_b64 a[112:113], v16 offset:1928
 v_add_f32 v39, v39, v42
 v_mfma_f32_16x16x32_bf16 v[96:99], v[188:191], a[8:11], v[96:99]
 ds_read_b64 a[114:115], v16 offset:1936
 v_add_f32 v43, v43, v46
 v_mfma_f32_16x16x32_bf16 v[96:99], v[192:195], a[4:7], v[96:99]
 ds_read_b64 a[180:181], v16 offset:3144
 v_add_f32 v39, v39, v45
 v_mfma_f32_16x16x32_bf16 v[96:99], v[196:199], a[0:3], v[96:99]
 ds_read_b64 a[182:183], v16 offset:3152
 v_cndmask_b32_e64 v224, v39, 0, vcc
 v_mfma_f32_16x16x32_bf16 v[100:103], v[160:163], a[100:103], 0
 s_waitcnt vmcnt(0)
 ds_read_b64 a[176:177], v16 offset:3080
 v_cmp_ne_u32 s[52:53], 0, v23
 v_mfma_f32_16x16x32_bf16 v[100:103], v[164:167], a[96:99], v[100:103]
 s_cmp_eq_u64 s[52:53], 0
 s_cselect_b32 s49, 1, 0
 s_cselect_b32 s51, s37, 2.0
 ds_read_b64 a[178:179], v16 offset:3088
 v_mfma_f32_16x16x32_bf16 v[100:103], v[168:171], a[92:95], v[100:103]
 s_lshl_b32 m0, s3, 14
 ds_read_b64 a[244:245], v16 offset:4296
 v_cndmask_b32_e64 v225, v43, 0, vcc
 v_mfma_f32_16x16x32_bf16 v[100:103], v[172:175], a[88:91], v[100:103]
 ds_read_b64 a[246:247], v16 offset:4304
 v_cndmask_b32_e64 v226, v47, 0, vcc
 v_mfma_f32_16x16x32_bf16 v[100:103], v[176:179], a[84:87], v[100:103]
 ds_read_b64 a[240:241], v16 offset:4232
 buffer_load_dwordx4 v1, s[12:15], s51 offen offset:0 sc1 lds
 v_mfma_f32_16x16x32_bf16 v[100:103], v[180:183], a[80:83], v[100:103]
 ds_read_b64 a[242:243], v16 offset:4240
 v_add_f32 v33, v33, v36
 v_mfma_f32_16x16x32_bf16 v[100:103], v[184:187], a[76:79], v[100:103]
 ds_read_b64_tr_b16 v[216:217], v17 offset:8192
 v_add_f32 v34, v34, v37
 v_mfma_f32_16x16x32_bf16 v[100:103], v[188:191], a[72:75], v[100:103]
 ds_read_b64_tr_b16 v[218:219], v17 offset:8160
 v_add_f32 v35, v35, v38
 v_mfma_f32_16x16x32_bf16 v[100:103], v[192:195], a[68:71], v[100:103]
 ds_read_b64_tr_b16 v[220:221], v17 offset:8448
 v_add_f32 v34, v34, v40
 v_mfma_f32_16x16x32_bf16 v[100:103], v[196:199], a[64:67], v[100:103]
 ds_read_b64_tr_b16 v[222:223], v17 offset:8416
 v_add_f32 v35, v35, v41
 v_mfma_f32_16x16x32_bf16 v[104:107], v[160:163], a[164:167], 0
 ds_read_b64 a[60:61], v16 offset:968
 v_add_f32 v35, v35, v44
 v_mfma_f32_16x16x32_bf16 v[104:107], v[164:167], a[160:163], v[104:107]
 ds_read_b64 a[62:63], v16 offset:976
 v_add_f32 v55, v55, v58
 v_mfma_f32_16x16x32_bf16 v[104:107], v[168:171], a[156:159], v[104:107]
 ds_read_b64 a[56:57], v16 offset:904
 buffer_load_dwordx4 v1, s[12:15], s51 offen offset:1024 sc1 lds
 v_mfma_f32_16x16x32_bf16 v[104:107], v[172:175], a[152:155], v[104:107]
 ds_read_b64 a[58:59], v16 offset:912
 v_add_f32 v59, v59, v62
 v_mfma_f32_16x16x32_bf16 v[104:107], v[176:179], a[148:151], v[104:107]
 ds_read_b64 a[124:125], v16 offset:2120
 v_add_f32 v55, v55, v61
 v_mfma_f32_16x16x32_bf16 v[104:107], v[180:183], a[144:147], v[104:107]
 ds_read_b64 a[126:127], v16 offset:2128
 v_cndmask_b32_e64 v232, v55, v39, vcc
 v_mfma_f32_16x16x32_bf16 v[104:107], v[184:187], a[140:143], v[104:107]
 ds_read_b64 a[120:121], v16 offset:2056
 v_cndmask_b32_e64 v233, v59, v43, vcc
 v_mfma_f32_16x16x32_bf16 v[104:107], v[188:191], a[136:139], v[104:107]
 ds_read_b64 a[122:123], v16 offset:2064
 v_cndmask_b32_e64 v234, v63, v47, vcc
 v_mfma_f32_16x16x32_bf16 v[104:107], v[192:195], a[132:135], v[104:107]
 ds_read_b64 a[188:189], v16 offset:3272
 v_add_f32 v49, v49, v52
 v_mfma_f32_16x16x32_bf16 v[104:107], v[196:199], a[128:131], v[104:107]
 ds_read_b64 a[190:191], v16 offset:3280
 v_add_f32 v50, v50, v53
 v_mfma_f32_16x16x32_bf16 v[108:111], v[160:163], a[228:231], 0
 ds_read_b64 a[184:185], v16 offset:3208
 buffer_load_dwordx4 v1, s[12:15], s51 offen offset:2048 sc1 lds
 v_mfma_f32_16x16x32_bf16 v[108:111], v[164:167], a[224:227], v[108:111]
 ds_read_b64 a[186:187], v16 offset:3216
 v_add_f32 v51, v51, v54
 v_mfma_f32_16x16x32_bf16 v[108:111], v[168:171], a[220:223], v[108:111]
 ds_read_b64 v[12:13], v16 offset:4424
 v_add_f32 v50, v50, v56
 v_mfma_f32_16x16x32_bf16 v[108:111], v[172:175], a[216:219], v[108:111]
 ds_read_b64 v[14:15], v16 offset:4432
 v_add_f32 v51, v51, v57
 v_mfma_f32_16x16x32_bf16 v[108:111], v[176:179], a[212:215], v[108:111]
 ds_read_b64 a[248:249], v16 offset:4360
 v_add_f32 v51, v51, v60
 v_mfma_f32_16x16x32_bf16 v[108:111], v[180:183], a[208:211], v[108:111]
 ds_read_b64 a[250:251], v16 offset:4368
 v_add_f32 v71, v71, v74
 v_mfma_f32_16x16x32_bf16 v[108:111], v[184:187], a[204:207], v[108:111]
 ds_bpermute_b32 v224, v19, v224
 v_add_f32 v75, v75, v78
 v_mfma_f32_16x16x32_bf16 v[108:111], v[188:191], a[200:203], v[108:111]
 ds_bpermute_b32 v225, v19, v225
 v_add_f32 v71, v71, v77
 v_mfma_f32_16x16x32_bf16 v[108:111], v[192:195], a[196:199], v[108:111]
 buffer_load_dwordx4 v1, s[12:15], s51 offen offset:3072 sc1 lds
 v_mfma_f32_16x16x32_bf16 v[108:111], v[196:199], a[192:195], v[108:111]
 s_waitcnt lgkmcnt(15)
 ds_bpermute_b32 v226, v19, v226
 v_cndmask_b32_e64 v240, v71, v55, vcc
 v_mfma_f32_16x16x32_bf16 v[112:115], v[160:163], a[44:47], 0
 ds_read_u16_d16_hi v228, v18 offset:128
 v_cndmask_b32_e64 v241, v75, v59, vcc
 v_mfma_f32_16x16x32_bf16 v[112:115], v[164:167], a[40:43], v[112:115]
 ds_read_u16_d16_hi v229, v18 offset:1280
 v_cndmask_b32_e64 v242, v79, v63, vcc
 v_mfma_f32_16x16x32_bf16 v[112:115], v[168:171], a[36:39], v[112:115]
 ds_read_u16_d16_hi v230, v18 offset:2432
 v_add_f32 v65, v65, v68
 v_mfma_f32_16x16x32_bf16 v[112:115], v[172:175], a[32:35], v[112:115]
 ds_read_u16_d16_hi v231, v18 offset:3584
 v_add_f32 v66, v66, v69
 v_mfma_f32_16x16x32_bf16 v[112:115], v[176:179], a[28:31], v[112:115]
 s_add_u32 m0, m0, 4096
 ds_bpermute_b32 v232, v19, v232
 v_add_f32 v67, v67, v70
 v_mfma_f32_16x16x32_bf16 v[112:115], v[180:183], a[24:27], v[112:115]
 s_add_u32 s51, s51, 4096
 ds_bpermute_b32 v233, v19, v233
 v_add_f32 v66, v66, v72
 v_mfma_f32_16x16x32_bf16 v[112:115], v[184:187], a[20:23], v[112:115]
 buffer_load_dwordx4 v1, s[12:15], s51 offen offset:0 sc1 lds
 v_mfma_f32_16x16x32_bf16 v[112:115], v[188:191], a[16:19], v[112:115]
 ds_bpermute_b32 v234, v19, v234
 v_add_f32 v67, v67, v73
 v_mfma_f32_16x16x32_bf16 v[112:115], v[192:195], a[12:15], v[112:115]
 ds_read_u16_d16_hi v236, v18 offset:256
 v_add_f32 v67, v67, v76
 v_mfma_f32_16x16x32_bf16 v[112:115], v[196:199], a[8:11], v[112:115]
 s_waitcnt lgkmcnt(9)
 v_add_f32 v32, v32, v224
 v_add_f32 v33, v33, v225
 v_mfma_f32_16x16x32_bf16 v[112:115], v[200:203], a[4:7], v[112:115]
 s_waitcnt lgkmcnt(7)
 v_add_f32 v34, v34, v226
 v_fmac_f32 v32, s31, v228
 v_mfma_f32_16x16x32_bf16 v[112:115], v[204:207], a[0:3], v[112:115]
 s_waitcnt lgkmcnt(5)
 v_fmac_f32 v33, s31, v229
 v_fmac_f32 v34, s31, v230
 v_mfma_f32_16x16x32_bf16 v[116:119], v[160:163], a[108:111], 0
 s_waitcnt lgkmcnt(4)
 v_fmac_f32 v35, s31, v231
 v_cvt_pk_bf16_f32 v32, v32, v33
 v_mfma_f32_16x16x32_bf16 v[116:119], v[164:167], a[104:107], v[116:119]
 ds_read_u16_d16_hi v237, v18 offset:1408
 v_cvt_pk_bf16_f32 v33, v34, v35
 v_mfma_f32_16x16x32_bf16 v[116:119], v[168:171], a[100:103], v[116:119]
 buffer_load_dwordx4 v1, s[12:15], s51 offen offset:1024 sc1 lds
 v_mfma_f32_16x16x32_bf16 v[116:119], v[172:175], a[96:99], v[116:119]
 buffer_store_dwordx2 v[32:33], v20, s[12:15], s34 offen offset:0 sc1
 v_mfma_f32_16x16x32_bf16 v[116:119], v[176:179], a[92:95], v[116:119]
 ds_read_u16_d16_hi v238, v18 offset:2560
 v_add_f32 v87, v87, v90
 v_mfma_f32_16x16x32_bf16 v[116:119], v[180:183], a[88:91], v[116:119]
 ds_read_u16_d16_hi v239, v18 offset:3712
 v_add_f32 v91, v91, v94
 v_mfma_f32_16x16x32_bf16 v[116:119], v[184:187], a[84:87], v[116:119]
 ds_bpermute_b32 v240, v19, v240
 v_add_f32 v87, v87, v93
 v_mfma_f32_16x16x32_bf16 v[116:119], v[188:191], a[80:83], v[116:119]
 ds_bpermute_b32 v241, v19, v241
 v_cndmask_b32_e64 v248, v87, v71, vcc
 v_mfma_f32_16x16x32_bf16 v[116:119], v[192:195], a[76:79], v[116:119]
 ds_bpermute_b32 v242, v19, v242
 v_cndmask_b32_e64 v249, v91, v75, vcc
 v_mfma_f32_16x16x32_bf16 v[116:119], v[196:199], a[72:75], v[116:119]
 ds_read_u16_d16_hi v244, v18 offset:384
 v_cndmask_b32_e64 v250, v95, v79, vcc
 v_mfma_f32_16x16x32_bf16 v[116:119], v[200:203], a[68:71], v[116:119]
 buffer_load_dwordx4 v1, s[12:15], s51 offen offset:2048 sc1 lds
 v_mfma_f32_16x16x32_bf16 v[116:119], v[204:207], a[64:67], v[116:119]
 s_waitcnt lgkmcnt(9)
 v_add_f32 v48, v48, v232
 v_add_f32 v49, v49, v233
 v_mfma_f32_16x16x32_bf16 v[120:123], v[160:163], a[172:175], 0
 s_waitcnt lgkmcnt(7)
 v_add_f32 v50, v50, v234
 v_fmac_f32 v48, s31, v236
 v_mfma_f32_16x16x32_bf16 v[120:123], v[164:167], a[168:171], v[120:123]
 s_waitcnt lgkmcnt(5)
 v_fmac_f32 v49, s31, v237
 v_fmac_f32 v50, s31, v238
 v_mfma_f32_16x16x32_bf16 v[120:123], v[168:171], a[164:167], v[120:123]
 s_waitcnt lgkmcnt(4)
 v_fmac_f32 v51, s31, v239
 v_cvt_pk_bf16_f32 v48, v48, v49
 v_mfma_f32_16x16x32_bf16 v[120:123], v[172:175], a[160:163], v[120:123]
 ds_read_u16_d16_hi v245, v18 offset:1536
 v_cvt_pk_bf16_f32 v49, v50, v51
 v_mfma_f32_16x16x32_bf16 v[120:123], v[176:179], a[156:159], v[120:123]
 buffer_store_dwordx2 v[48:49], v20, s[12:15], s34 offen offset:512 sc1
 v_mfma_f32_16x16x32_bf16 v[120:123], v[180:183], a[152:155], v[120:123]
 ds_read_u16_d16_hi v246, v18 offset:2688
 v_add_f32 v81, v81, v84
 v_mfma_f32_16x16x32_bf16 v[120:123], v[184:187], a[148:151], v[120:123]
 buffer_load_dwordx4 v1, s[12:15], s51 offen offset:3072 sc1 lds
 v_mfma_f32_16x16x32_bf16 v[120:123], v[188:191], a[144:147], v[120:123]
 ds_read_u16_d16_hi v247, v18 offset:3840
 v_add_f32 v82, v82, v85
 v_mfma_f32_16x16x32_bf16 v[120:123], v[192:195], a[140:143], v[120:123]
 ds_bpermute_b32 v248, v19, v248
 v_add_f32 v83, v83, v86
 v_mfma_f32_16x16x32_bf16 v[120:123], v[196:199], a[136:139], v[120:123]
 ds_bpermute_b32 v249, v19, v249
 v_add_f32 v82, v82, v88
 v_mfma_f32_16x16x32_bf16 v[120:123], v[200:203], a[132:135], v[120:123]
 ds_bpermute_b32 v250, v19, v250
 v_add_f32 v83, v83, v89
 v_mfma_f32_16x16x32_bf16 v[120:123], v[204:207], a[128:131], v[120:123]
 ds_read_u16_d16_hi v252, v18 offset:512
 v_add_f32 v83, v83, v92
 v_mfma_f32_16x16x32_bf16 v[124:127], v[160:163], a[236:239], 0
 s_add_u32 m0, m0, 4096
 ds_read_u16_d16_hi v253, v18 offset:1664
 v_add_f32 v103, v103, v106
 v_mfma_f32_16x16x32_bf16 v[124:127], v[164:167], a[232:235], v[124:127]
 s_waitcnt lgkmcnt(10)
 s_add_u32 s51, s51, 4096
 v_add_f32 v64, v64, v240
 v_add_f32 v65, v65, v241
 v_mfma_f32_16x16x32_bf16 v[124:127], v[168:171], a[228:231], v[124:127]
 buffer_load_dwordx4 v1, s[12:15], s51 offen offset:0 sc1 lds
 v_mfma_f32_16x16x32_bf16 v[124:127], v[172:175], a[224:227], v[124:127]
 s_waitcnt lgkmcnt(8)
 v_add_f32 v66, v66, v242
 v_fmac_f32 v64, s31, v244
 v_mfma_f32_16x16x32_bf16 v[124:127], v[176:179], a[220:223], v[124:127]
 s_waitcnt lgkmcnt(6)
 v_fmac_f32 v65, s31, v245
 v_fmac_f32 v66, s31, v246
 v_mfma_f32_16x16x32_bf16 v[124:127], v[180:183], a[216:219], v[124:127]
 s_waitcnt lgkmcnt(5)
 v_fmac_f32 v67, s31, v247
 v_cvt_pk_bf16_f32 v64, v64, v65
 v_mfma_f32_16x16x32_bf16 v[124:127], v[184:187], a[212:215], v[124:127]
 ds_read_u16_d16_hi v254, v18 offset:2816
 v_cvt_pk_bf16_f32 v65, v66, v67
 v_mfma_f32_16x16x32_bf16 v[124:127], v[188:191], a[208:211], v[124:127]
 buffer_store_dwordx2 v[64:65], v20, s[12:15], s34 offen offset:1024 sc1
 v_mfma_f32_16x16x32_bf16 v[124:127], v[192:195], a[204:207], v[124:127]
 ds_read_u16_d16_hi v255, v18 offset:3968
 v_add_f32 v107, v107, v110
 v_mfma_f32_16x16x32_bf16 v[124:127], v[196:199], a[200:203], v[124:127]
 v_add_f32 v103, v103, v109
 v_cndmask_b32_e64 v224, v103, v87, vcc
 v_mfma_f32_16x16x32_bf16 v[124:127], v[200:203], a[196:199], v[124:127]
 buffer_load_dwordx4 v1, s[12:15], s51 offen offset:1024 sc1 lds
 v_mfma_f32_16x16x32_bf16 v[124:127], v[204:207], a[192:195], v[124:127]
 v_cndmask_b32_e64 v225, v107, v91, vcc
 v_cndmask_b32_e64 v226, v111, v95, vcc
 v_mfma_f32_16x16x32_bf16 v[128:131], v[160:163], a[52:55], 0
 ds_bpermute_b32 v224, v19, v224
 v_add_f32 v97, v97, v100
 v_mfma_f32_16x16x32_bf16 v[128:131], v[164:167], a[48:51], v[128:131]
 ds_bpermute_b32 v225, v19, v225
 v_add_f32 v98, v98, v101
 v_mfma_f32_16x16x32_bf16 v[128:131], v[168:171], a[44:47], v[128:131]
 s_waitcnt lgkmcnt(7)
 v_add_f32 v80, v80, v248
 v_add_f32 v81, v81, v249
 v_mfma_f32_16x16x32_bf16 v[128:131], v[172:175], a[40:43], v[128:131]
 s_waitcnt lgkmcnt(5)
 v_add_f32 v82, v82, v250
 v_fmac_f32 v80, s31, v252
 v_mfma_f32_16x16x32_bf16 v[128:131], v[176:179], a[36:39], v[128:131]
 s_waitcnt lgkmcnt(3)
 v_fmac_f32 v81, s31, v253
 v_fmac_f32 v82, s31, v254
 v_mfma_f32_16x16x32_bf16 v[128:131], v[180:183], a[32:35], v[128:131]
 s_waitcnt lgkmcnt(2)
 v_fmac_f32 v83, s31, v255
 v_cvt_pk_bf16_f32 v80, v80, v81
 v_mfma_f32_16x16x32_bf16 v[128:131], v[184:187], a[28:31], v[128:131]
 buffer_load_dwordx4 v1, s[12:15], s51 offen offset:2048 sc1 lds
 v_mfma_f32_16x16x32_bf16 v[128:131], v[188:191], a[24:27], v[128:131]
 ds_bpermute_b32 v226, v19, v226
 v_cvt_pk_bf16_f32 v81, v82, v83
 v_mfma_f32_16x16x32_bf16 v[128:131], v[192:195], a[20:23], v[128:131]
 buffer_store_dwordx2 v[80:81], v20, s[12:15], s34 offen offset:1536 sc1
 v_mfma_f32_16x16x32_bf16 v[128:131], v[196:199], a[16:19], v[128:131]
 ds_read_u16_d16_hi v228, v18 offset:640
 v_add_f32 v99, v99, v102
 v_mfma_f32_16x16x32_bf16 v[128:131], v[200:203], a[12:15], v[128:131]
 ds_read_u16_d16_hi v229, v18 offset:1792
 v_add_f32 v98, v98, v104
 v_mfma_f32_16x16x32_bf16 v[128:131], v[204:207], a[8:11], v[128:131]
 ds_read_u16_d16_hi v230, v18 offset:2944
 v_add_f32 v99, v99, v105
 v_mfma_f32_16x16x32_bf16 v[128:131], v[208:211], a[4:7], v[128:131]
 ds_read_u16_d16_hi v231, v18 offset:4096
 v_add_f32 v99, v99, v108
 v_mfma_f32_16x16x32_bf16 v[128:131], v[212:215], a[0:3], v[128:131]
 v_add_f32 v119, v119, v122
 v_add_f32 v123, v123, v126
 v_mfma_f32_16x16x32_bf16 v[132:135], v[160:163], a[116:119], 0
 buffer_load_dwordx4 v1, s[12:15], s51 offen offset:3072 sc1 lds
 v_mfma_f32_16x16x32_bf16 v[132:135], v[164:167], a[112:115], v[132:135]
 v_add_f32 v119, v119, v125
 v_cndmask_b32_e64 v232, v119, v103, vcc
 v_mfma_f32_16x16x32_bf16 v[132:135], v[168:171], a[108:111], v[132:135]
 v_cndmask_b32_e64 v233, v123, v107, vcc
 v_cndmask_b32_e64 v234, v127, v111, vcc
 v_mfma_f32_16x16x32_bf16 v[132:135], v[172:175], a[104:107], v[132:135]
 ds_bpermute_b32 v232, v19, v232
 v_add_f32 v113, v113, v116
 v_mfma_f32_16x16x32_bf16 v[132:135], v[176:179], a[100:103], v[132:135]
 s_waitcnt lgkmcnt(6)
 v_add_f32 v96, v96, v224
 v_add_f32 v97, v97, v225
 v_mfma_f32_16x16x32_bf16 v[132:135], v[180:183], a[96:99], v[132:135]
 s_waitcnt lgkmcnt(4)
 v_add_f32 v98, v98, v226
 v_fmac_f32 v96, s31, v228
 v_mfma_f32_16x16x32_bf16 v[132:135], v[184:187], a[92:95], v[132:135]
 s_waitcnt lgkmcnt(2)
 s_add_u32 m0, m0, 4096
 v_fmac_f32 v97, s31, v229
 v_fmac_f32 v98, s31, v230
 v_mfma_f32_16x16x32_bf16 v[132:135], v[188:191], a[88:91], v[132:135]
 s_waitcnt lgkmcnt(1)
 s_add_u32 s51, s51, 4096
 v_fmac_f32 v99, s31, v231
 v_cvt_pk_bf16_f32 v96, v96, v97
 v_mfma_f32_16x16x32_bf16 v[132:135], v[192:195], a[84:87], v[132:135]
 buffer_load_dwordx4 v1, s[12:15], s51 offen offset:0 sc1 lds
 v_mfma_f32_16x16x32_bf16 v[132:135], v[196:199], a[80:83], v[132:135]
 ds_bpermute_b32 v233, v19, v233
 v_cvt_pk_bf16_f32 v97, v98, v99
 v_mfma_f32_16x16x32_bf16 v[132:135], v[200:203], a[76:79], v[132:135]
 buffer_store_dwordx2 v[96:97], v20, s[12:15], s34 offen offset:2048 sc1
 v_mfma_f32_16x16x32_bf16 v[132:135], v[204:207], a[72:75], v[132:135]
 ds_bpermute_b32 v234, v19, v234
 v_add_f32 v114, v114, v117
 v_mfma_f32_16x16x32_bf16 v[132:135], v[208:211], a[68:71], v[132:135]
 ds_read_u16_d16_hi v236, v18 offset:768
 v_add_f32 v115, v115, v118
 v_mfma_f32_16x16x32_bf16 v[132:135], v[212:215], a[64:67], v[132:135]
 ds_read_u16_d16_hi v237, v18 offset:1920
 v_add_f32 v114, v114, v120
 v_mfma_f32_16x16x32_bf16 v[136:139], v[160:163], a[180:183], 0
 ds_read_u16_d16_hi v238, v18 offset:3072
 v_add_f32 v115, v115, v121
 v_mfma_f32_16x16x32_bf16 v[136:139], v[164:167], a[176:179], v[136:139]
 ds_read_u16_d16_hi v239, v18 offset:4224
 v_add_f32 v115, v115, v124
 v_mfma_f32_16x16x32_bf16 v[136:139], v[168:171], a[172:175], v[136:139]
 buffer_load_dwordx4 v1, s[12:15], s51 offen offset:1024 sc1 lds
 v_mfma_f32_16x16x32_bf16 v[136:139], v[172:175], a[168:171], v[136:139]
 buffer_load_dwordx4 v[48:51], v7, s[16:19], s46 offen offset:0
 v_mfma_f32_16x16x32_bf16 v[136:139], v[176:179], a[164:167], v[136:139]
 v_mfma_f32_16x16x32_bf16 v[136:139], v[180:183], a[160:163], v[136:139]
 v_mfma_f32_16x16x32_bf16 v[136:139], v[184:187], a[156:159], v[136:139]
 v_mfma_f32_16x16x32_bf16 v[136:139], v[188:191], a[152:155], v[136:139]
 s_waitcnt lgkmcnt(5)
 v_add_f32 v112, v112, v232
 v_add_f32 v113, v113, v233
 v_mfma_f32_16x16x32_bf16 v[136:139], v[192:195], a[148:151], v[136:139]
 s_waitcnt lgkmcnt(3)
 v_add_f32 v114, v114, v234
 v_fmac_f32 v112, s31, v236
 v_mfma_f32_16x16x32_bf16 v[136:139], v[196:199], a[144:147], v[136:139]
 s_waitcnt lgkmcnt(1)
 v_fmac_f32 v113, s31, v237
 v_fmac_f32 v114, s31, v238
 v_mfma_f32_16x16x32_bf16 v[136:139], v[200:203], a[140:143], v[136:139]
 buffer_load_dwordx4 v1, s[12:15], s51 offen offset:2048 sc1 lds
 v_mfma_f32_16x16x32_bf16 v[136:139], v[204:207], a[136:139], v[136:139]
 s_waitcnt lgkmcnt(0)
 v_fmac_f32 v115, s31, v239
 v_cvt_pk_bf16_f32 v112, v112, v113
 v_mfma_f32_16x16x32_bf16 v[136:139], v[208:211], a[132:135], v[136:139]
 v_cvt_pk_bf16_f32 v113, v114, v115
 v_mfma_f32_16x16x32_bf16 v[136:139], v[212:215], a[128:131], v[136:139]
 buffer_store_dwordx2 v[112:113], v20, s[12:15], s34 offen offset:2560 sc1
 v_mfma_f32_16x16x32_bf16 v[140:143], v[160:163], a[244:247], 0
 v_mfma_f32_16x16x32_bf16 v[140:143], v[164:167], a[240:243], v[140:143]
 buffer_load_dwordx4 v[52:55], v7, s[16:19], s46 offen offset:64
 v_mfma_f32_16x16x32_bf16 v[140:143], v[168:171], a[236:239], v[140:143]
 v_mfma_f32_16x16x32_bf16 v[140:143], v[172:175], a[232:235], v[140:143]
 v_mfma_f32_16x16x32_bf16 v[140:143], v[176:179], a[228:231], v[140:143]
 buffer_load_dwordx4 v1, s[12:15], s51 offen offset:3072 sc1 lds
 v_mfma_f32_16x16x32_bf16 v[140:143], v[180:183], a[224:227], v[140:143]
 v_mfma_f32_16x16x32_bf16 v[140:143], v[184:187], a[220:223], v[140:143]
 v_mfma_f32_16x16x32_bf16 v[140:143], v[188:191], a[216:219], v[140:143]
 v_mfma_f32_16x16x32_bf16 v[140:143], v[192:195], a[212:215], v[140:143]
 v_mfma_f32_16x16x32_bf16 v[140:143], v[196:199], a[208:211], v[140:143]
 v_mfma_f32_16x16x32_bf16 v[140:143], v[200:203], a[204:207], v[140:143]
 v_mfma_f32_16x16x32_bf16 v[140:143], v[204:207], a[200:203], v[140:143]
 v_mfma_f32_16x16x32_bf16 v[140:143], v[208:211], a[196:199], v[140:143]
 v_mfma_f32_16x16x32_bf16 v[140:143], v[212:215], a[192:195], v[140:143]
 buffer_load_dwordx4 v[56:59], v7, s[16:19], s54 offen offset:0
 v_mfma_f32_16x16x32_bf16 v[144:147], v[160:163], a[60:63], 0
 v_mfma_f32_16x16x32_bf16 v[144:147], v[164:167], a[56:59], v[144:147]
 v_mfma_f32_16x16x32_bf16 v[144:147], v[168:171], a[52:55], v[144:147]
 v_mfma_f32_16x16x32_bf16 v[144:147], v[172:175], a[48:51], v[144:147]
 v_mfma_f32_16x16x32_bf16 v[144:147], v[176:179], a[44:47], v[144:147]
 v_mfma_f32_16x16x32_bf16 v[144:147], v[180:183], a[40:43], v[144:147]
 v_mfma_f32_16x16x32_bf16 v[144:147], v[184:187], a[36:39], v[144:147]
 v_mfma_f32_16x16x32_bf16 v[144:147], v[188:191], a[32:35], v[144:147]
 v_add_f32 v135, v135, v138
 v_add_f32 v139, v139, v142
 v_mfma_f32_16x16x32_bf16 v[144:147], v[192:195], a[28:31], v[144:147]
 v_add_f32 v135, v135, v141
 v_cndmask_b32_e64 v240, v135, v119, vcc
 v_mfma_f32_16x16x32_bf16 v[144:147], v[196:199], a[24:27], v[144:147]
 v_cndmask_b32_e64 v241, v139, v123, vcc
 v_cndmask_b32_e64 v242, v143, v127, vcc
 v_mfma_f32_16x16x32_bf16 v[144:147], v[200:203], a[20:23], v[144:147]
 ds_bpermute_b32 v240, v19, v240
 v_add_f32 v129, v129, v132
 v_mfma_f32_16x16x32_bf16 v[144:147], v[204:207], a[16:19], v[144:147]
 ds_bpermute_b32 v241, v19, v241
 v_add_f32 v130, v130, v133
 v_mfma_f32_16x16x32_bf16 v[144:147], v[208:211], a[12:15], v[144:147]
 ds_bpermute_b32 v242, v19, v242
 v_add_f32 v131, v131, v134
 v_mfma_f32_16x16x32_bf16 v[144:147], v[212:215], a[8:11], v[144:147]
 ds_read_u16_d16_hi v244, v18 offset:896
 v_add_f32 v130, v130, v136
 v_mfma_f32_16x16x32_bf16 v[144:147], v[216:219], a[4:7], v[144:147]
 ds_read_u16_d16_hi v245, v18 offset:2048
 v_add_f32 v131, v131, v137
 v_mfma_f32_16x16x32_bf16 v[144:147], v[220:223], a[0:3], v[144:147]
 ds_read_u16_d16_hi v246, v18 offset:3200
 v_add_f32 v131, v131, v140
 v_mfma_f32_16x16x32_bf16 v[148:151], v[160:163], a[124:127], 0
 ds_read_u16_d16_hi v247, v18 offset:4352
 v_mfma_f32_16x16x32_bf16 v[148:151], v[164:167], a[120:123], v[148:151]
 buffer_load_dwordx4 v[60:63], v7, s[16:19], s54 offen offset:64
 v_mfma_f32_16x16x32_bf16 v[148:151], v[168:171], a[116:119], v[148:151]
 v_mfma_f32_16x16x32_bf16 v[148:151], v[172:175], a[112:115], v[148:151]
 v_mfma_f32_16x16x32_bf16 v[148:151], v[176:179], a[108:111], v[148:151]
 v_mfma_f32_16x16x32_bf16 v[148:151], v[180:183], a[104:107], v[148:151]
 v_mfma_f32_16x16x32_bf16 v[148:151], v[184:187], a[100:103], v[148:151]
 s_waitcnt lgkmcnt(5)
 v_add_f32 v128, v128, v240
 v_add_f32 v129, v129, v241
 v_mfma_f32_16x16x32_bf16 v[148:151], v[188:191], a[96:99], v[148:151]
 s_waitcnt lgkmcnt(3)
 v_add_f32 v130, v130, v242
 v_fmac_f32 v128, s31, v244
 v_mfma_f32_16x16x32_bf16 v[148:151], v[192:195], a[92:95], v[148:151]
 buffer_load_dword v23, v11, s[12:15], s45 offen sc1
 v_mfma_f32_16x16x32_bf16 v[148:151], v[196:199], a[88:91], v[148:151]
 s_waitcnt lgkmcnt(1)
 v_fmac_f32 v129, s31, v245
 v_fmac_f32 v130, s31, v246
 v_mfma_f32_16x16x32_bf16 v[148:151], v[200:203], a[84:87], v[148:151]
 s_waitcnt lgkmcnt(0)
 v_fmac_f32 v131, s31, v247
 v_cvt_pk_bf16_f32 v128, v128, v129
 v_mfma_f32_16x16x32_bf16 v[148:151], v[204:207], a[80:83], v[148:151]
 v_cvt_pk_bf16_f32 v129, v130, v131
 v_mfma_f32_16x16x32_bf16 v[148:151], v[208:211], a[76:79], v[148:151]
 buffer_store_dwordx2 v[128:129], v20, s[12:15], s34 offen offset:3072 sc1
 v_mfma_f32_16x16x32_bf16 v[148:151], v[212:215], a[72:75], v[148:151]
 v_mfma_f32_16x16x32_bf16 v[148:151], v[216:219], a[68:71], v[148:151]
 v_mfma_f32_16x16x32_bf16 v[148:151], v[220:223], a[64:67], v[148:151]
 v_mfma_f32_16x16x32_bf16 v[152:155], v[160:163], a[188:191], 0
 v_mfma_f32_16x16x32_bf16 v[152:155], v[164:167], a[184:187], v[152:155]
 v_mfma_f32_16x16x32_bf16 v[152:155], v[168:171], a[180:183], v[152:155]
 v_mfma_f32_16x16x32_bf16 v[152:155], v[172:175], a[176:179], v[152:155]
 v_mfma_f32_16x16x32_bf16 v[152:155], v[176:179], a[172:175], v[152:155]
 v_mfma_f32_16x16x32_bf16 v[152:155], v[180:183], a[168:171], v[152:155]
 v_mfma_f32_16x16x32_bf16 v[152:155], v[184:187], a[164:167], v[152:155]
 v_mfma_f32_16x16x32_bf16 v[152:155], v[188:191], a[160:163], v[152:155]
 v_mfma_f32_16x16x32_bf16 v[152:155], v[192:195], a[156:159], v[152:155]
 v_mfma_f32_16x16x32_bf16 v[152:155], v[196:199], a[152:155], v[152:155]
 v_mfma_f32_16x16x32_bf16 v[152:155], v[200:203], a[148:151], v[152:155]
 v_mfma_f32_16x16x32_bf16 v[152:155], v[204:207], a[144:147], v[152:155]
 v_mfma_f32_16x16x32_bf16 v[152:155], v[208:211], a[140:143], v[152:155]
 v_mfma_f32_16x16x32_bf16 v[152:155], v[212:215], a[136:139], v[152:155]
 v_mfma_f32_16x16x32_bf16 v[152:155], v[216:219], a[132:135], v[152:155]
 v_mfma_f32_16x16x32_bf16 v[152:155], v[220:223], a[128:131], v[152:155]
 v_mfma_f32_16x16x32_bf16 v[156:159], v[160:163], v[12:15], 0
 v_mfma_f32_16x16x32_bf16 v[156:159], v[164:167], a[248:251], v[156:159]
 v_mfma_f32_16x16x32_bf16 v[156:159], v[168:171], a[244:247], v[156:159]
 v_mfma_f32_16x16x32_bf16 v[156:159], v[172:175], a[240:243], v[156:159]
 v_mfma_f32_16x16x32_bf16 v[156:159], v[176:179], a[236:239], v[156:159]
 v_mfma_f32_16x16x32_bf16 v[156:159], v[180:183], a[232:235], v[156:159]
 v_mfma_f32_16x16x32_bf16 v[156:159], v[184:187], a[228:231], v[156:159]
 v_mfma_f32_16x16x32_bf16 v[156:159], v[188:191], a[224:227], v[156:159]
 v_mfma_f32_16x16x32_bf16 v[156:159], v[192:195], a[220:223], v[156:159]
 v_mfma_f32_16x16x32_bf16 v[156:159], v[196:199], a[216:219], v[156:159]
 v_mfma_f32_16x16x32_bf16 v[156:159], v[200:203], a[212:215], v[156:159]
 v_mfma_f32_16x16x32_bf16 v[156:159], v[204:207], a[208:211], v[156:159]
 v_mfma_f32_16x16x32_bf16 v[156:159], v[208:211], a[204:207], v[156:159]
 v_mfma_f32_16x16x32_bf16 v[156:159], v[212:215], a[200:203], v[156:159]
 v_mfma_f32_16x16x32_bf16 v[156:159], v[216:219], a[196:199], v[156:159]
 v_mfma_f32_16x16x32_bf16 v[156:159], v[220:223], a[192:195], v[156:159]
 s_nop 7
 v_add_f32 v151, v151, v154
 v_add_f32 v155, v155, v158
 v_add_f32 v151, v151, v157
 v_cndmask_b32_e64 v248, v151, v135, vcc
 v_cndmask_b32_e64 v249, v155, v139, vcc
 v_cndmask_b32_e64 v250, v159, v143, vcc
 ds_bpermute_b32 v248, v19, v248
 ds_bpermute_b32 v249, v19, v249
 ds_bpermute_b32 v250, v19, v250
 ds_read_u16_d16_hi v252, v18 offset:1024
 ds_read_u16_d16_hi v253, v18 offset:2176
 ds_read_u16_d16_hi v254, v18 offset:3328
 ds_read_u16_d16_hi v255, v18 offset:4480
 v_add_f32 v145, v145, v148
 v_add_f32 v146, v146, v149
 v_add_f32 v147, v147, v150
 v_add_f32 v146, v146, v152
 v_add_f32 v147, v147, v153
 v_add_f32 v147, v147, v156
 s_waitcnt lgkmcnt(0)
 v_add_f32 v144, v144, v248
 v_add_f32 v145, v145, v249
 v_add_f32 v146, v146, v250
 v_fmac_f32 v144, s31, v252
 v_fmac_f32 v145, s31, v253
 v_fmac_f32 v146, s31, v254
 v_fmac_f32 v147, s31, v255
 v_cvt_pk_bf16_f32 v144, v144, v145
 v_cvt_pk_bf16_f32 v145, v146, v147
 buffer_store_dwordx2 v[144:145], v20, s[12:15], s34 offen offset:3584 sc1
 s_waitcnt vmcnt(2)
 v_cmp_ne_u32 vcc, 0, v23
 s_cmp_eq_u64 vcc, 0
 s_cselect_b32 s50, 1, 0
 s_cselect_b32 s51, s39, 2.0
 ds_read_b128 a[64:67], v9 offset:0
 ds_read_b128 a[68:71], v9 offset:1024
 ds_read_b128 a[72:75], v9 offset:2048
 ds_read_b128 a[76:79], v9 offset:3072
 ds_read_b128 a[80:83], v9 offset:4096
 ds_read_b128 a[84:87], v9 offset:5120
 ds_read_b128 a[88:91], v9 offset:6144
 ds_read_b128 a[92:95], v9 offset:7168
 ds_read_b128 a[96:99], v9 offset:8192
 ds_read_b128 a[100:103], v9 offset:9216
 ds_read_b128 a[104:107], v9 offset:10240
 ds_read_b128 a[108:111], v9 offset:11264
 ds_read_b128 a[112:115], v9 offset:12288
 ds_read_b128 a[116:119], v9 offset:13312
 ds_read_b128 a[120:123], v9 offset:14336
 ds_read_b128 a[124:127], v9 offset:15360
 s_waitcnt lgkmcnt(15)
 v_mfma_f32_16x16x32_bf16 v[40:43], v[24:27], a[64:67], 0
 v_mfma_f32_16x16x32_bf16 v[44:47], v[28:31], a[64:67], 0
 s_waitcnt lgkmcnt(14)
 v_mfma_f32_16x16x32_bf16 v[40:43], v[24:27], a[68:71], v[40:43]
 v_mfma_f32_16x16x32_bf16 v[44:47], v[28:31], a[68:71], v[44:47]
 s_waitcnt lgkmcnt(13)
 v_mfma_f32_16x16x32_bf16 v[40:43], v[24:27], a[72:75], v[40:43]
 v_mfma_f32_16x16x32_bf16 v[44:47], v[28:31], a[72:75], v[44:47]
 s_waitcnt lgkmcnt(12)
 v_mfma_f32_16x16x32_bf16 v[40:43], v[24:27], a[76:79], v[40:43]
 v_mfma_f32_16x16x32_bf16 v[44:47], v[28:31], a[76:79], v[44:47]
 s_waitcnt lgkmcnt(11)
 v_mfma_f32_16x16x32_bf16 v[40:43], v[24:27], a[80:83], v[40:43]
 v_mfma_f32_16x16x32_bf16 v[44:47], v[28:31], a[80:83], v[44:47]
 s_waitcnt lgkmcnt(10)
 v_mfma_f32_16x16x32_bf16 v[40:43], v[24:27], a[84:87], v[40:43]
 v_mfma_f32_16x16x32_bf16 v[44:47], v[28:31], a[84:87], v[44:47]
 s_waitcnt lgkmcnt(9)
 v_mfma_f32_16x16x32_bf16 v[40:43], v[24:27], a[88:91], v[40:43]
 v_mfma_f32_16x16x32_bf16 v[44:47], v[28:31], a[88:91], v[44:47]
 s_waitcnt lgkmcnt(8)
 v_mfma_f32_16x16x32_bf16 v[40:43], v[24:27], a[92:95], v[40:43]
 v_mfma_f32_16x16x32_bf16 v[44:47], v[28:31], a[92:95], v[44:47]
 s_waitcnt lgkmcnt(7)
 v_mfma_f32_16x16x32_bf16 v[40:43], v[24:27], a[96:99], v[40:43]
 v_mfma_f32_16x16x32_bf16 v[44:47], v[28:31], a[96:99], v[44:47]
 s_waitcnt lgkmcnt(6)
 v_mfma_f32_16x16x32_bf16 v[40:43], v[24:27], a[100:103], v[40:43]
 v_mfma_f32_16x16x32_bf16 v[44:47], v[28:31], a[100:103], v[44:47]
 s_waitcnt lgkmcnt(5)
 v_mfma_f32_16x16x32_bf16 v[40:43], v[24:27], a[104:107], v[40:43]
 v_mfma_f32_16x16x32_bf16 v[44:47], v[28:31], a[104:107], v[44:47]
 s_waitcnt lgkmcnt(4)
 v_mfma_f32_16x16x32_bf16 v[40:43], v[24:27], a[108:111], v[40:43]
 v_mfma_f32_16x16x32_bf16 v[44:47], v[28:31], a[108:111], v[44:47]
 s_waitcnt lgkmcnt(3)
 v_mfma_f32_16x16x32_bf16 v[40:43], v[24:27], a[112:115], v[40:43]
 v_mfma_f32_16x16x32_bf16 v[44:47], v[28:31], a[112:115], v[44:47]
 s_waitcnt lgkmcnt(2)
 v_mfma_f32_16x16x32_bf16 v[40:43], v[24:27], a[116:119], v[40:43]
 v_mfma_f32_16x16x32_bf16 v[44:47], v[28:31], a[116:119], v[44:47]
 s_waitcnt lgkmcnt(1)
 v_mfma_f32_16x16x32_bf16 v[40:43], v[24:27], a[120:123], v[40:43]
 v_mfma_f32_16x16x32_bf16 v[44:47], v[28:31], a[120:123], v[44:47]
 s_waitcnt lgkmcnt(0)
 v_mfma_f32_16x16x32_bf16 v[40:43], v[24:27], a[124:127], v[40:43]
 v_mfma_f32_16x16x32_bf16 v[44:47], v[28:31], a[124:127], v[44:47]
 s_waitcnt vmcnt(0)
 s_barrier
 buffer_store_dword v21, v21, s[12:15], s93 offen sc1
 s_cmp_eq_u32 s49, 1
 s_cbranch_scc1 L_havesh
 s_add_u32 s48, s44, 64
 s_mov_b32 s47, s51
 v_and_b32 v16, 15, v0
 v_lshlrev_b32 v16, 2, v16
 s_mov_b32 s32, 0
L_poll9:
 buffer_load_dword v17, v16, s[12:15], s48 offen sc1
 s_waitcnt vmcnt(0)
 v_cmp_ne_u32 vcc, 0, v17
 s_cbranch_vccz L_poll9_ok
 s_sleep 8
 s_add_u32 s32, s32, 1
 s_cmp_lt_u32 s32, 0x80000
 s_cbranch_scc1 L_poll9
L_poll9_ok:
 s_mov_b32 s51, s37
 s_lshl_b32 m0, s3, 14
 s_nop 0
 buffer_load_dwordx4 v1, s[12:15], s51 offen offset:0 sc1 lds
 s_nop 0
 buffer_load_dwordx4 v1, s[12:15], s51 offen offset:1024 sc1 lds
 s_nop 0
 buffer_load_dwordx4 v1, s[12:15], s51 offen offset:2048 sc1 lds
 s_nop 0
 buffer_load_dwordx4 v1, s[12:15], s51 offen offset:3072 sc1 lds
 s_add_u32 m0, m0, 4096
 s_add_u32 s51, s51, 4096
 s_nop 0
 buffer_load_dwordx4 v1, s[12:15], s51 offen offset:0 sc1 lds
 s_nop 0
 buffer_load_dwordx4 v1, s[12:15], s51 offen offset:1024 sc1 lds
 s_nop 0
 buffer_load_dwordx4 v1, s[12:15], s51 offen offset:2048 sc1 lds
 s_nop 0
 buffer_load_dwordx4 v1, s[12:15], s51 offen offset:3072 sc1 lds
 s_add_u32 m0, m0, 4096
 s_add_u32 s51, s51, 4096
 s_nop 0
 buffer_load_dwordx4 v1, s[12:15], s51 offen offset:0 sc1 lds
 s_nop 0
 buffer_load_dwordx4 v1, s[12:15], s51 offen offset:1024 sc1 lds
 s_nop 0
 buffer_load_dwordx4 v1, s[12:15], s51 offen offset:2048 sc1 lds
 s_nop 0
 buffer_load_dwordx4 v1, s[12:15], s51 offen offset:3072 sc1 lds
 s_add_u32 m0, m0, 4096
 s_add_u32 s51, s51, 4096
 s_nop 0
 buffer_load_dwordx4 v1, s[12:15], s51 offen offset:0 sc1 lds
 s_nop 0
 buffer_load_dwordx4 v1, s[12:15], s51 offen offset:1024 sc1 lds
 s_nop 0
 buffer_load_dwordx4 v1, s[12:15], s51 offen offset:2048 sc1 lds
 s_nop 0
 buffer_load_dwordx4 v1, s[12:15], s51 offen offset:3072 sc1 lds
 s_mov_b32 s51, s47
 s_waitcnt vmcnt(0)
 ds_read_b128 a[64:67], v9 offset:0
 ds_read_b128 a[68:71], v9 offset:1024
 ds_read_b128 a[72:75], v9 offset:2048
 ds_read_b128 a[76:79], v9 offset:3072
 ds_read_b128 a[80:83], v9 offset:4096
 ds_read_b128 a[84:87], v9 offset:5120
 ds_read_b128 a[88:91], v9 offset:6144
 ds_read_b128 a[92:95], v9 offset:7168
 ds_read_b128 a[96:99], v9 offset:8192
 ds_read_b128 a[100:103], v9 offset:9216
 ds_read_b128 a[104:107], v9 offset:10240
 ds_read_b128 a[108:111], v9 offset:11264
 ds_read_b128 a[112:115], v9 offset:12288
 ds_read_b128 a[116:119], v9 offset:13312
 ds_read_b128 a[120:123], v9 offset:14336
 ds_read_b128 a[124:127], v9 offset:15360
 s_waitcnt lgkmcnt(15)
 v_mfma_f32_16x16x32_bf16 v[40:43], v[24:27], a[64:67], 0
 v_mfma_f32_16x16x32_bf16 v[44:47], v[28:31], a[64:67], 0
 s_waitcnt lgkmcnt(14)
 v_mfma_f32_16x16x32_bf16 v[40:43], v[24:27], a[68:71], v[40:43]
 v_mfma_f32_16x16x32_bf16 v[44:47], v[28:31], a[68:71], v[44:47]
 s_waitcnt lgkmcnt(13)
 v_mfma_f32_16x16x32_bf16 v[40:43], v[24:27], a[72:75], v[40:43]
 v_mfma_f32_16x16x32_bf16 v[44:47], v[28:31], a[72:75], v[44:47]
 s_waitcnt lgkmcnt(12)
 v_mfma_f32_16x16x32_bf16 v[40:43], v[24:27], a[76:79], v[40:43]
 v_mfma_f32_16x16x32_bf16 v[44:47], v[28:31], a[76:79], v[44:47]
 s_waitcnt lgkmcnt(11)
 v_mfma_f32_16x16x32_bf16 v[40:43], v[24:27], a[80:83], v[40:43]
 v_mfma_f32_16x16x32_bf16 v[44:47], v[28:31], a[80:83], v[44:47]
 s_waitcnt lgkmcnt(10)
 v_mfma_f32_16x16x32_bf16 v[40:43], v[24:27], a[84:87], v[40:43]
 v_mfma_f32_16x16x32_bf16 v[44:47], v[28:31], a[84:87], v[44:47]
 s_waitcnt lgkmcnt(9)
 v_mfma_f32_16x16x32_bf16 v[40:43], v[24:27], a[88:91], v[40:43]
 v_mfma_f32_16x16x32_bf16 v[44:47], v[28:31], a[88:91], v[44:47]
 s_waitcnt lgkmcnt(8)
 v_mfma_f32_16x16x32_bf16 v[40:43], v[24:27], a[92:95], v[40:43]
 v_mfma_f32_16x16x32_bf16 v[44:47], v[28:31], a[92:95], v[44:47]
 s_waitcnt lgkmcnt(7)
 v_mfma_f32_16x16x32_bf16 v[40:43], v[24:27], a[96:99], v[40:43]
 v_mfma_f32_16x16x32_bf16 v[44:47], v[28:31], a[96:99], v[44:47]
 s_waitcnt lgkmcnt(6)
 v_mfma_f32_16x16x32_bf16 v[40:43], v[24:27], a[100:103], v[40:43]
 v_mfma_f32_16x16x32_bf16 v[44:47], v[28:31], a[100:103], v[44:47]
 s_waitcnt lgkmcnt(5)
 v_mfma_f32_16x16x32_bf16 v[40:43], v[24:27], a[104:107], v[40:43]
 v_mfma_f32_16x16x32_bf16 v[44:47], v[28:31], a[104:107], v[44:47]
 s_waitcnt lgkmcnt(4)
 v_mfma_f32_16x16x32_bf16 v[40:43], v[24:27], a[108:111], v[40:43]
 v_mfma_f32_16x16x32_bf16 v[44:47], v[28:31], a[108:111], v[44:47]
 s_waitcnt lgkmcnt(3)
 v_mfma_f32_16x16x32_bf16 v[40:43], v[24:27], a[112:115], v[40:43]
 v_mfma_f32_16x16x32_bf16 v[44:47], v[28:31], a[112:115], v[44:47]
 s_waitcnt lgkmcnt(2)
 v_mfma_f32_16x16x32_bf16 v[40:43], v[24:27], a[116:119], v[40:43]
 v_mfma_f32_16x16x32_bf16 v[44:47], v[28:31], a[116:119], v[44:47]
 s_waitcnt lgkmcnt(1)
 v_mfma_f32_16x16x32_bf16 v[40:43], v[24:27], a[120:123], v[40:43]
 v_mfma_f32_16x16x32_bf16 v[44:47], v[28:31], a[120:123], v[44:47]
 s_waitcnt lgkmcnt(0)
 v_mfma_f32_16x16x32_bf16 v[40:43], v[24:27], a[124:127], v[40:43]
 v_mfma_f32_16x16x32_bf16 v[44:47], v[28:31], a[124:127], v[44:47]
 s_nop 4
L_havesh:
 s_nop 2
 v_cvt_pk_bf16_f32 v40, v40, v41
 v_cvt_pk_bf16_f32 v41, v42, v43
 v_cvt_pk_bf16_f32 v42, v44, v45
 v_cvt_pk_bf16_f32 v43, v46, v47
 buffer_store_dwordx4 v[40:43], v2, s[8:11], s36 offen offset:0
 s_cmp_eq_u32 s50, 1
 s_cbranch_scc1 L_havelong
 v_and_b32 v16, 15, v0
 v_lshlrev_b32 v16, 2, v16
 s_mov_b32 s32, 0
L_poll10:
 buffer_load_dword v17, v16, s[12:15], s45 offen sc1
 s_waitcnt vmcnt(0)
 v_cmp_ne_u32 vcc, 0, v17
 s_cbranch_vccz L_poll10_ok
 s_sleep 8
 s_add_u32 s32, s32, 1
 s_cmp_lt_u32 s32, 0x80000
 s_cbranch_scc1 L_poll10
L_poll10_ok:
 s_mov_b32 s51, s39
L_havelong:
 buffer_load_dwordx4 a[0:3], v1, s[12:15], s51 offen offset:0 sc1
 buffer_load_dwordx4 a[4:7], v1, s[12:15], s51 offen offset:1024 sc1
 buffer_load_dwordx4 a[8:11], v1, s[12:15], s51 offen offset:2048 sc1
 buffer_load_dwordx4 a[12:15], v1, s[12:15], s51 offen offset:3072 sc1
 s_add_u32 s51, s51, 4096
 buffer_load_dwordx4 a[16:19], v1, s[12:15], s51 offen offset:0 sc1
 buffer_load_dwordx4 a[20:23], v1, s[12:15], s51 offen offset:1024 sc1
 buffer_load_dwordx4 a[24:27], v1, s[12:15], s51 offen offset:2048 sc1
 buffer_load_dwordx4 a[28:31], v1, s[12:15], s51 offen offset:3072 sc1
 s_add_u32 s51, s51, 4096
 buffer_load_dwordx4 a[32:35], v1, s[12:15], s51 offen offset:0 sc1
 buffer_load_dwordx4 a[36:39], v1, s[12:15], s51 offen offset:1024 sc1
 buffer_load_dwordx4 a[40:43], v1, s[12:15], s51 offen offset:2048 sc1
 buffer_load_dwordx4 a[44:47], v1, s[12:15], s51 offen offset:3072 sc1
 s_add_u32 s51, s51, 4096
 buffer_load_dword v23, v11, s[12:15], s43 offen sc1
 buffer_load_dwordx4 a[48:51], v1, s[12:15], s51 offen offset:0 sc1
 buffer_load_dwordx4 a[52:55], v1, s[12:15], s51 offen offset:1024 sc1
 buffer_load_dwordx4 a[56:59], v1, s[12:15], s51 offen offset:2048 sc1
 buffer_load_dwordx4 a[60:63], v1, s[12:15], s51 offen offset:3072 sc1
 s_add_u32 s51, s51, 4096
 s_waitcnt vmcnt(16)
 v_mfma_f32_16x16x32_bf16 v[32:35], v[24:27], a[0:3], 0
 v_mfma_f32_16x16x32_bf16 v[36:39], v[28:31], a[0:3], 0
 s_waitcnt vmcnt(15)
 v_mfma_f32_16x16x32_bf16 v[32:35], v[24:27], a[4:7], v[32:35]
 v_mfma_f32_16x16x32_bf16 v[36:39], v[28:31], a[4:7], v[36:39]
 s_waitcnt vmcnt(14)
 v_mfma_f32_16x16x32_bf16 v[32:35], v[24:27], a[8:11], v[32:35]
 v_mfma_f32_16x16x32_bf16 v[36:39], v[28:31], a[8:11], v[36:39]
 s_waitcnt vmcnt(13)
 v_mfma_f32_16x16x32_bf16 v[32:35], v[24:27], a[12:15], v[32:35]
 v_mfma_f32_16x16x32_bf16 v[36:39], v[28:31], a[12:15], v[36:39]
 s_waitcnt vmcnt(12)
 v_mfma_f32_16x16x32_bf16 v[32:35], v[24:27], a[16:19], v[32:35]
 v_mfma_f32_16x16x32_bf16 v[36:39], v[28:31], a[16:19], v[36:39]
 s_waitcnt vmcnt(11)
 v_mfma_f32_16x16x32_bf16 v[32:35], v[24:27], a[20:23], v[32:35]
 v_mfma_f32_16x16x32_bf16 v[36:39], v[28:31], a[20:23], v[36:39]
 s_waitcnt vmcnt(10)
 v_mfma_f32_16x16x32_bf16 v[32:35], v[24:27], a[24:27], v[32:35]
 v_mfma_f32_16x16x32_bf16 v[36:39], v[28:31], a[24:27], v[36:39]
 s_waitcnt vmcnt(9)
 v_mfma_f32_16x16x32_bf16 v[32:35], v[24:27], a[28:31], v[32:35]
 v_mfma_f32_16x16x32_bf16 v[36:39], v[28:31], a[28:31], v[36:39]
 s_waitcnt vmcnt(8)
 v_mfma_f32_16x16x32_bf16 v[32:35], v[24:27], a[32:35], v[32:35]
 v_mfma_f32_16x16x32_bf16 v[36:39], v[28:31], a[32:35], v[36:39]
 s_waitcnt vmcnt(7)
 v_mfma_f32_16x16x32_bf16 v[32:35], v[24:27], a[36:39], v[32:35]
 v_mfma_f32_16x16x32_bf16 v[36:39], v[28:31], a[36:39], v[36:39]
 s_waitcnt vmcnt(6)
 v_mfma_f32_16x16x32_bf16 v[32:35], v[24:27], a[40:43], v[32:35]
 v_mfma_f32_16x16x32_bf16 v[36:39], v[28:31], a[40:43], v[36:39]
 s_waitcnt vmcnt(5)
 v_mfma_f32_16x16x32_bf16 v[32:35], v[24:27], a[44:47], v[32:35]
 v_mfma_f32_16x16x32_bf16 v[36:39], v[28:31], a[44:47], v[36:39]
 s_waitcnt vmcnt(4)
 v_cmp_ne_u32 vcc, 0, v23
 s_cmp_eq_u64 vcc, 0
 s_cselect_b32 s50, 1, 0
 s_cselect_b32 s52, s56, 2.0
 s_cselect_b32 s53, s57, 2.0
 s_add_u32 m0, s58, 0
 s_nop 0
 buffer_load_dwordx4 v8, s[12:15], s52 offen offset:0 sc1 lds
 s_add_u32 m0, s58, 1024
 s_nop 0
 buffer_load_dwordx4 v8, s[12:15], s53 offen offset:0 sc1 lds
 s_add_u32 m0, s58, 0
 s_nop 0
 buffer_load_dwordx4 v8, s[12:15], s52 offen offset:2048 sc1 lds
 s_add_u32 m0, s58, 1024
 s_nop 0
 buffer_load_dwordx4 v8, s[12:15], s53 offen offset:2048 sc1 lds
 s_waitcnt vmcnt(7)
 v_mfma_f32_16x16x32_bf16 v[32:35], v[24:27], a[48:51], v[32:35]
 v_mfma_f32_16x16x32_bf16 v[36:39], v[28:31], a[48:51], v[36:39]
 s_waitcnt vmcnt(6)
 v_mfma_f32_16x16x32_bf16 v[32:35], v[24:27], a[52:55], v[32:35]
 v_mfma_f32_16x16x32_bf16 v[36:39], v[28:31], a[52:55], v[36:39]
 s_waitcnt vmcnt(5)
 v_mfma_f32_16x16x32_bf16 v[32:35], v[24:27], a[56:59], v[32:35]
 v_mfma_f32_16x16x32_bf16 v[36:39], v[28:31], a[56:59], v[36:39]
 s_waitcnt vmcnt(4)
 v_mfma_f32_16x16x32_bf16 v[32:35], v[24:27], a[60:63], v[32:35]
 v_mfma_f32_16x16x32_bf16 v[36:39], v[28:31], a[60:63], v[36:39]
 s_nop 7
 v_cvt_pk_bf16_f32 v32, v32, v33
 v_cvt_pk_bf16_f32 v33, v34, v35
 v_cvt_pk_bf16_f32 v34, v36, v37
 v_cvt_pk_bf16_f32 v35, v38, v39
 buffer_store_dwordx4 v[32:35], v2, s[8:11], s35 offen offset:0
 s_cmp_eq_u32 s50, 1
 s_cbranch_scc1 L_havey
 v_and_b32 v16, 15, v0
 v_lshlrev_b32 v16, 2, v16
 s_mov_b32 s32, 0
L_poll11:
 buffer_load_dword v17, v16, s[12:15], s43 offen sc1
 s_waitcnt vmcnt(0)
 v_cmp_ne_u32 vcc, 0, v17
 s_cbranch_vccz L_poll11_ok
 s_sleep 8
 s_add_u32 s32, s32, 1
 s_cmp_lt_u32 s32, 0x80000
 s_cbranch_scc1 L_poll11
L_poll11_ok:
 s_add_u32 m0, s58, 0
 s_nop 0
 buffer_load_dwordx4 v8, s[12:15], s56 offen offset:0 sc1 lds
 s_add_u32 m0, s58, 1024
 s_nop 0
 buffer_load_dwordx4 v8, s[12:15], s57 offen offset:0 sc1 lds
 s_add_u32 m0, s58, 0
 s_nop 0
 buffer_load_dwordx4 v8, s[12:15], s56 offen offset:2048 sc1 lds
 s_add_u32 m0, s58, 1024
 s_nop 0
 buffer_load_dwordx4 v8, s[12:15], s57 offen offset:2048 sc1 lds
 s_waitcnt vmcnt(0)
L_havey:
 s_waitcnt vmcnt(1)
 ds_read_b64_tr_b16 v[64:65], v10 offset:0
 ds_read_b64_tr_b16 v[66:67], v10 offset:128
 ds_read_b64_tr_b16 v[68:69], v10 offset:1024
 ds_read_b64_tr_b16 v[70:71], v10 offset:1152
 ds_read_b64_tr_b16 v[72:73], v10 offset:2048
 ds_read_b64_tr_b16 v[74:75], v10 offset:2176
 ds_read_b64_tr_b16 v[76:77], v10 offset:3072
 ds_read_b64_tr_b16 v[78:79], v10 offset:3200
 s_waitcnt lgkmcnt(6)
 v_lshlrev_b32 v16, 16, v48
 v_and_b32 v17, s59, v48
 v_lshlrev_b32 v18, 16, v64
 v_and_b32 v19, s59, v64
 v_pk_mul_f32 v[16:17], v[16:17], v[18:19]
 v_cvt_pk_bf16_f32 v48, v16, v17
 v_lshlrev_b32 v16, 16, v49
 v_and_b32 v17, s59, v49
 v_lshlrev_b32 v18, 16, v65
 v_and_b32 v19, s59, v65
 v_pk_mul_f32 v[16:17], v[16:17], v[18:19]
 v_cvt_pk_bf16_f32 v49, v16, v17
 v_lshlrev_b32 v16, 16, v50
 v_and_b32 v17, s59, v50
 v_lshlrev_b32 v18, 16, v66
 v_and_b32 v19, s59, v66
 v_pk_mul_f32 v[16:17], v[16:17], v[18:19]
 v_cvt_pk_bf16_f32 v50, v16, v17
 v_lshlrev_b32 v16, 16, v51
 v_and_b32 v17, s59, v51
 v_lshlrev_b32 v18, 16, v67
 v_and_b32 v19, s59, v67
 v_pk_mul_f32 v[16:17], v[16:17], v[18:19]
 v_cvt_pk_bf16_f32 v51, v16, v17
 buffer_store_dwordx4 v[48:51], v2, s[8:11], s46 offen offset:0
 s_waitcnt lgkmcnt(4)
 v_lshlrev_b32 v16, 16, v52
 v_and_b32 v17, s59, v52
 v_lshlrev_b32 v18, 16, v68
 v_and_b32 v19, s59, v68
 v_pk_mul_f32 v[16:17], v[16:17], v[18:19]
 v_cvt_pk_bf16_f32 v52, v16, v17
 v_lshlrev_b32 v16, 16, v53
 v_and_b32 v17, s59, v53
 v_lshlrev_b32 v18, 16, v69
 v_and_b32 v19, s59, v69
 v_pk_mul_f32 v[16:17], v[16:17], v[18:19]
 v_cvt_pk_bf16_f32 v53, v16, v17
 v_lshlrev_b32 v16, 16, v54
 v_and_b32 v17, s59, v54
 v_lshlrev_b32 v18, 16, v70
 v_and_b32 v19, s59, v70
 v_pk_mul_f32 v[16:17], v[16:17], v[18:19]
 v_cvt_pk_bf16_f32 v54, v16, v17
 v_lshlrev_b32 v16, 16, v55
 v_and_b32 v17, s59, v55
 v_lshlrev_b32 v18, 16, v71
 v_and_b32 v19, s59, v71
 v_pk_mul_f32 v[16:17], v[16:17], v[18:19]
 v_cvt_pk_bf16_f32 v55, v16, v17
 buffer_store_dwordx4 v[52:55], v2, s[8:11], s46 offen offset:64
 s_waitcnt lgkmcnt(2)
 v_lshlrev_b32 v16, 16, v56
 v_and_b32 v17, s59, v56
 v_lshlrev_b32 v18, 16, v72
 v_and_b32 v19, s59, v72
 v_pk_mul_f32 v[16:17], v[16:17], v[18:19]
 v_cvt_pk_bf16_f32 v56, v16, v17
 v_lshlrev_b32 v16, 16, v57
 v_and_b32 v17, s59, v57
 v_lshlrev_b32 v18, 16, v73
 v_and_b32 v19, s59, v73
 v_pk_mul_f32 v[16:17], v[16:17], v[18:19]
 v_cvt_pk_bf16_f32 v57, v16, v17
 v_lshlrev_b32 v16, 16, v58
 v_and_b32 v17, s59, v58
 v_lshlrev_b32 v18, 16, v74
 v_and_b32 v19, s59, v74
 v_pk_mul_f32 v[16:17], v[16:17], v[18:19]
 v_cvt_pk_bf16_f32 v58, v16, v17
 v_lshlrev_b32 v16, 16, v59
 v_and_b32 v17, s59, v59
 v_lshlrev_b32 v18, 16, v75
 v_and_b32 v19, s59, v75
 v_pk_mul_f32 v[16:17], v[16:17], v[18:19]
 v_cvt_pk_bf16_f32 v59, v16, v17
 buffer_store_dwordx4 v[56:59], v2, s[8:11], s55 offen offset:0
 s_waitcnt lgkmcnt(0)
 v_lshlrev_b32 v16, 16, v60
 v_and_b32 v17, s59, v60
 v_lshlrev_b32 v18, 16, v76
 v_and_b32 v19, s59, v76
 v_pk_mul_f32 v[16:17], v[16:17], v[18:19]
 v_cvt_pk_bf16_f32 v60, v16, v17
 v_lshlrev_b32 v16, 16, v61
 v_and_b32 v17, s59, v61
 v_lshlrev_b32 v18, 16, v77
 v_and_b32 v19, s59, v77
 v_pk_mul_f32 v[16:17], v[16:17], v[18:19]
 v_cvt_pk_bf16_f32 v61, v16, v17
 v_lshlrev_b32 v16, 16, v62
 v_and_b32 v17, s59, v62
 v_lshlrev_b32 v18, 16, v78
 v_and_b32 v19, s59, v78
 v_pk_mul_f32 v[16:17], v[16:17], v[18:19]
 v_cvt_pk_bf16_f32 v62, v16, v17
 v_lshlrev_b32 v16, 16, v63
 v_and_b32 v17, s59, v63
 v_lshlrev_b32 v18, 16, v79
 v_and_b32 v19, s59, v79
 v_pk_mul_f32 v[16:17], v[16:17], v[18:19]
 v_cvt_pk_bf16_f32 v63, v16, v17
 buffer_store_dwordx4 v[60:63], v2, s[8:11], s55 offen offset:64
L_fin:
 s_endpgm
L_codeend:
.section .rodata,"a"
.p2align 6
.amdhsa_kernel concat_heads__ssm_conv_h3__compressed_kv_cla__prompt_kernel
  .amdhsa_next_free_vgpr 512
  .amdhsa_next_free_sgpr 102
  .amdhsa_accum_offset 256
  .amdhsa_group_segment_fixed_size 0
  .amdhsa_kernarg_size 120
  .amdhsa_user_sgpr_count 2
  .amdhsa_user_sgpr_kernarg_segment_ptr 1
  .amdhsa_system_sgpr_workgroup_id_x 1
.end_amdhsa_kernel
```

```asm
; @launch grid=(256,1,1) block=(256,1,1) lds=163840
.amdgcn_target "amdgcn-amd-amdhsa--gfx950"
.text
.globl concat_heads__ssm_conv_h3__compressed_kv_cla__prompt_kernel
.p2align 8
.type concat_heads__ssm_conv_h3__compressed_kv_cla__prompt_kernel,@function
concat_heads__ssm_conv_h3__compressed_kv_cla__prompt_kernel:
 s_cmp_lt_u32 s2, 256
 s_cbranch_scc1 L_go
 s_endpgm
L_go:
 s_load_dwordx16 s[64:79], s[0:1], 0
 s_load_dwordx8 s[80:87], s[0:1], 64
 s_load_dwordx4 s[88:91], s[0:1], 96
 s_load_dwordx2 s[12:13], s[0:1], 112
 v_lshrrev_b32 v1, 6, v0
 v_and_b32 v0, 63, v0
 v_readfirstlane_b32 s3, v1
 s_and_b32 s24, s2, 7
 s_bfe_u32 s25, s2, 0x30003
 s_bfe_u32 s26, s2, 0x10006
 s_lshl_b32 s37, s24, 1
 s_add_u32 s26, s26, s37
 s_lshr_b32 s27, s2, 7
 s_bfe_u32 s28, s2, 0x40003
 s_lshl_b32 s29, s3, 10
 s_and_b32 s39, s3, 1
 s_lshr_b32 s40, s3, 1
 s_cmp_eq_u32 s27, 0
 s_cselect_b32 s37, 7, 7
 s_add_u32 s37, s37, s25
 s_and_b32 s37, s37, 7
 s_lshl_b32 s37, s37, 1
 s_lshr_b32 s28, s28, 3
 s_add_u32 s28, s28, s37
 s_getpc_b64 s[100:101]
L_pc:
 s_sub_u32 s100, s100, L_pc-L_go
 s_subb_u32 s101, s101, 0
 s_lshr_b32 s32, s2, 1
 s_and_b32 s32, s32, 124
 s_add_u32 s32, s32, s3
 s_mul_i32 s32, s32, 1152
 s_add_u32 s32, s32, 0
 v_min_u32 v14, 8, v0
 v_lshl_add_u32 v14, v14, 7, s32
 v_min_u32 v14, L_codeend-L_go-4, v14
 global_load_dword a243, v14, s[100:101]
 s_mov_b32 s41, 65536
 s_mov_b32 s48, 32768
 s_mov_b32 s42, 131072
 s_mov_b32 s49, 131072
 s_mov_b32 s43, 196608
 s_mov_b32 s50, 163840
 s_mov_b32 s44, 262144
 s_mov_b32 s51, 262144
 s_mov_b32 s45, 327680
 s_mov_b32 s52, 294912
 s_mov_b32 s46, 393216
 s_mov_b32 s53, 393216
 s_mov_b32 s47, 458752
 s_mov_b32 s54, 425984
 s_lshl_b32 s56, s39, 1
 s_lshl_b32 s57, s40, 3
 s_add_u32 s56, s56, s57
 s_lshl_b32 s60, s25, 8
 s_lshl_b32 s58, s3, 3
 s_add_u32 s58, s58, s60
 v_lshrrev_b32 v14, 3, v0
 v_add_u32 v14, s58, v14
 v_lshlrev_b32 v14, 11, v14
 s_lshl_b32 s58, s39, 2
 v_lshrrev_b32 v15, 4, v0
 v_add_u32 v15, s58, v15
 v_xor_b32 v15, v0, v15
 v_and_b32 v15, 7, v15
 v_lshl_add_u32 v1, v15, 4, v14
 v_lshrrev_b32 v14, 5, v0
 s_lshl_b32 s58, s3, 1
 v_add_u32 v15, s58, v14
 v_lshlrev_b32 v15, 1, v15
 v_xor_b32 v15, v0, v15
 v_and_b32 v15, 31, v15
 v_lshlrev_b32 v15, 4, v15
 v_add_u32 v14, s56, v14
 v_lshl_add_u32 v14, v14, 13, v15
 s_lshl_b32 s58, s26, 9
 v_add_u32 v2, s58, v14
 s_waitcnt lgkmcnt(0)
 s_cmp_eq_u32 s27, 0
 s_cselect_b32 s8, s82, s84
 s_cselect_b32 s9, s83, s85
 s_mov_b32 s10, 8388608
 s_mov_b32 s11, 0x20000
 s_mov_b32 s4, s78
 s_mov_b32 s5, s79
 s_mov_b32 s6, 4194304
 s_mov_b32 s7, 0x20000
 s_mov_b32 s14, 268435456
 s_mov_b32 s15, 0x20000
 s_add_u32 m0, s29, 65536
 s_nop 0
 buffer_load_dwordx4 v2, s[8:11], 0 offen  lds
 s_lshl_b32 s58, s27, 3
 s_add_u32 s59, s58, s25
 s_lshl_b32 s59, s59, 2
 s_lshl_b32 s92, s26, 7
 s_add_u32 s92, s92, s59
 s_add_u32 s92, s92, 84934656
 s_add_u32 s58, s58, s24
 s_mul_i32 s95, s58, 14
 s_add_u32 s95, s95, s28
 s_sub_u32 s63, 15, s25
 s_add_u32 m0, s29, 0
 s_nop 0
 buffer_load_dwordx4 v1, s[4:7], 0 offen  lds
 s_cmp_eq_u32 s27, 0
 s_cselect_b32 s63, s25, s63
 s_lshl_b32 s93, s63, 7
 s_lshl_b32 s59, s26, 2
 s_add_u32 s93, s93, s59
 s_add_u32 s93, s93, 84938752
 s_and_b32 s94, s2, 127
 s_lshl_b32 s94, s94, 7
 s_add_u32 s94, s94, 84942848
 s_add_u32 m0, s29, 69632
 s_nop 0
 buffer_load_dwordx4 v2, s[8:11], s48 offen  lds
 s_cmp_lg_u32 s3, 0
 s_cbranch_scc1 L_noclr
 s_lshl_b32 s58, s95, 2
 s_add_u32 s59, s58, 84963328
 s_add_u32 s58, s58, 84959232
 s_lshl_b32 s61, s27, 2
 s_add_u32 s61, s61, s94
 s_cmp_lt_u32 s28, 14
 s_cselect_b32 s58, s58, s92
 s_cselect_b32 s59, s59, s92
 v_mov_b32 v14, s92
 v_writelane_b32 v14, s93, 1
 v_writelane_b32 v14, s61, 2
 v_writelane_b32 v14, s58, 3
 v_writelane_b32 v14, s59, 4
 s_add_u32 s58, s93, 64
 v_writelane_b32 v14, s58, 5
 v_mov_b32 v15, 1
 s_mov_b64 exec, 63
 buffer_store_dword v15, v14, s[12:15], 0 offen sc1
 s_mov_b64 exec, -1
L_noclr:
 s_add_u32 m0, s29, 4096
 s_nop 0
 buffer_load_dwordx4 v1, s[4:7], s41 offen  lds
 s_add_u32 m0, s29, 73728
 s_nop 0
 buffer_load_dwordx4 v2, s[8:11], s49 offen  lds
 s_cmp_eq_u32 s3, 0
 s_cselect_b32 s58, 0, 0x80000000
 v_bfrev_b32 v14, 1
 v_writelane_b32 v14, s58, 0
 v_accvgpr_write_b32 a245, v14
 s_lshl_b32 s58, s39, 7
 s_add_u32 m0, s29, 8192
 s_nop 0
 buffer_load_dwordx4 v1, s[4:7], s42 offen  lds
 s_lshl_b32 s59, s40, 3
 v_and_b32 v14, 15, v0
 v_lshrrev_b32 v15, 4, v0
 s_lshl_b32 s60, s63, 7
 s_lshl_b32 s62, s3, 4
 s_add_u32 s60, s60, s62
 v_lshrrev_b32 v13, 3, v0
 v_lshlrev_b32 v13, 1, v13
 v_add_u32 v12, s60, v13
 v_mul_u32_u24 v12, 896, v12
 s_add_u32 m0, s29, 77824
 s_nop 0
 buffer_load_dwordx4 v2, s[8:11], s50 offen  lds
 v_lshrrev_b32 v13, 1, v13
 v_xor_b32 v13, v0, v13
 v_and_b32 v13, 7, v13
 v_lshl_add_u32 v13, v13, 4, v12
 v_accvgpr_write_b32 a240, v13
 v_lshrrev_b32 v13, 1, v14
 v_xor_b32 v12, v13, v15
 v_lshlrev_b32 v12, 4, v12
 v_lshl_add_u32 v12, v13, 7, v12
 s_add_u32 m0, s29, 12288
 s_nop 0
 buffer_load_dwordx4 v1, s[4:7], s43 offen  lds
 v_and_b32 v13, 1, v14
 v_lshl_add_u32 v12, v13, 10, v12
 s_lshl_b32 s33, s3, 13
 s_add_u32 s33, s33, 0x20000
 v_add_u32 v12, s33, v12
 v_accvgpr_write_b32 a242, v12
 v_lshrrev_b32 v5, 1, v14
 v_xor_b32 v5, v5, v15
 v_add_u32 v14, s58, v14
 s_add_u32 m0, s29, 81920
 s_nop 0
 buffer_load_dwordx4 v2, s[8:11], s51 offen  lds
 v_lshlrev_b32 v14, 7, v14
 v_lshl_add_u32 v4, v5, 4, v14
 v_xor_b32 v5, 64, v4
 v_bfe_u32 v14, v0, 2, 3
 v_lshrrev_b32 v15, 5, v0
 v_lshl_add_u32 v13, v15, 4, v14
 v_lshlrev_b32 v13, 9, v13
 v_xor_b32 v14, s59, v14
 v_lshl_add_u32 v13, v14, 5, v13
 v_and_b32 v14, 3, v0
 s_add_u32 m0, s29, 16384
 s_nop 0
 buffer_load_dwordx4 v1, s[4:7], s44 offen  lds
 v_lshl_add_u32 v13, v14, 3, v13
 v_add_u32 v6, 0x10000, v13
 v_xor_b32 v7, 32, v6
 v_xor_b32 v8, 64, v6
 v_xor_b32 v9, 96, v6
 v_xor_b32 v10, 128, v6
 v_xor_b32 v11, 160, v6
 v_xor_b32 v12, 192, v6
 v_xor_b32 v13, 224, v6
 s_add_u32 m0, s29, 86016
 s_nop 0
 buffer_load_dwordx4 v2, s[8:11], s52 offen  lds
 s_mov_b32 s16, s80
 s_mov_b32 s17, s81
 s_mov_b32 s18, 3670016
 s_mov_b32 s19, 0x20000
 s_mov_b32 s20, s76
 s_mov_b32 s21, s77
 s_mov_b32 s22, 1835008
 s_mov_b32 s23, 0x20000
 s_and_b32 s62, s2, 127
 s_add_u32 m0, s29, 20480
 s_nop 0
 buffer_load_dwordx4 v1, s[4:7], s45 offen  lds
 s_lshl_b32 s62, s62, 2
 s_add_u32 s62, s62, s3
 s_mul_i32 s62, s62, 17408
 s_add_u32 s62, s62, 50331648
 s_mul_i32 s58, s26, 1048576
 s_mul_i32 s59, s25, 131072
 s_add_u32 s58, s58, s59
 s_mul_i32 s59, s39, 65536
 s_add_u32 s58, s58, s59
 s_lshl_b32 s59, s40, 12
 s_add_u32 m0, s29, 90112
 s_nop 0
 buffer_load_dwordx4 v2, s[8:11], s53 offen  lds
 s_lshl_b32 s59, s59, s27
 s_add_u32 s58, s58, s59
 s_mul_i32 s59, s27, 16777216
 s_add_u32 s58, s58, s59
 s_mov_b32 s57, 57344
 s_lshl_b32 s60, s40, 8
 s_add_u32 s60, s60, 0x10000
 s_mov_b32 s34, 0x3db8aa3b
 s_mov_b32 s35, 0x3db8aa3b
 s_add_u32 m0, s29, 24576
 s_nop 0
 buffer_load_dwordx4 v1, s[4:7], s46 offen  lds
 s_mul_i32 s55, s25, 5
 s_lshr_b32 s55, s55, 3
 s_add_u32 s55, s55, 1
 s_cmp_lg_u32 s3, 0
 s_cmov_b32 s55, 6
 v_mov_b32 v15, 1
 s_cmp_ge_u32 s25, 6
 s_cmov_b32 s62, 2.0
 v_mov_b32 v20, 0
 s_add_u32 m0, s29, 94208
 s_nop 0
 buffer_load_dwordx4 v2, s[8:11], s54 offen  lds
 v_mov_b32 v21, 0
 v_mov_b32 v24, 0
 v_mov_b32 v25, 0
 v_and_b32 v26, 1, v0
 v_lshlrev_b32 v26, 4, v26
 v_mov_b32 v27, 0x3f80
 v_lshlrev_b32 v26, v26, v27
 v_bfe_u32 v27, v0, 1, 3
 v_lshrrev_b32 v28, 4, v0
 v_lshlrev_b32 v28, 1, v28
 s_add_u32 m0, s29, 28672
 s_nop 0
 buffer_load_dwordx4 v1, s[4:7], s47 offen  lds
 v_add_u32 v1, 128, v1
 v_add_u32 v2, 0x80000, v2
 v_sub_u32 v27, v27, v28
 v_cmp_eq_u32 s[0:1], 0, v27
 v_cmp_eq_u32 vcc, 1, v27
 v_lshrrev_b32 v31, 3, v0
 s_lshl_b32 s31, s3, 6
 v_add_u32 v30, s31, v31
 v_mul_u32_u24 v30, 896, v30
 v_and_b32 v31, 6, v31
 v_xor_b32 v31, v31, v0
 s_add_u32 m0, s29, 98304
 s_nop 0
 buffer_load_dwordx4 v2, s[8:11], 0 offen  lds
 v_and_b32 v31, 7, v31
 v_lshl_add_u32 v30, v31, 4, v30
 v_cndmask_b32 v22, 0, v26, s[0:1]
 v_cndmask_b32 v23, 0, v26, vcc
 v_accvgpr_write_b32 a248, v20
 v_accvgpr_write_b32 a249, v21
 v_accvgpr_write_b32 a250, v22
 v_accvgpr_write_b32 a251, v23
 v_accvgpr_write_b32 a252, v24
 s_add_u32 m0, s29, 32768
 s_nop 0
 buffer_load_dwordx4 v1, s[4:7], 0 offen  lds
 v_accvgpr_write_b32 a253, v25
 v_accvgpr_write_b32 a241, v30
 s_lshl_b32 s31, s27, 3
 s_add_u32 s31, s31, s25
 s_cmp_lt_u32 s31, 6
 s_cselect_b64 vcc, -1, 0
 v_lshlrev_b32 v31, 4, v0
 v_cndmask_b32 v30, v30, v31, vcc
 v_accvgpr_write_b32 a244, v30
 v_lshrrev_b32 v31, 2, v0
 s_add_u32 m0, s29, 102400
 s_nop 0
 buffer_load_dwordx4 v2, s[8:11], s48 offen  lds
 v_lshlrev_b32 v30, 7, v31
 v_bfe_u32 v31, v31, 1, 2
 v_lshl_add_u32 v30, v31, 5, v30
 v_and_b32 v31, 3, v0
 v_lshl_add_u32 v30, v31, 3, v30
 v_add_u32 v30, 131072, v30
 v_accvgpr_write_b32 a254, v30
 s_lshl_b32 s31, s25, 16
 s_lshl_b32 s32, s26, 9
 s_add_u32 m0, s29, 36864
 s_nop 0
 buffer_load_dwordx4 v1, s[4:7], s41 offen  lds
 s_add_u32 s31, s31, s32
 v_lshrrev_b32 v15, 3, v0
 v_lshlrev_b32 v15, 13, v15
 v_and_b32 v14, 7, v0
 v_lshlrev_b32 v14, 6, v14
 v_add3_u32 v16, v14, v15, s31
 s_lshl_b32 s31, s25, 2
 s_lshr_b32 s32, s2, 6
 s_add_u32 s31, s31, s32
 s_add_u32 m0, s29, 106496
 s_nop 0
 buffer_load_dwordx4 v2, s[8:11], s49 offen  lds
 s_lshl_b32 s31, s31, 17
 v_lshlrev_b32 v17, 11, v0
 v_add_u32 v17, s31, v17
 s_mul_i32 s36, s2, 7282
 s_lshr_b32 s36, s36, 16
 s_mul_i32 s37, s36, 9
 s_sub_u32 s37, s2, s37
 s_lshl_b32 s38, s36, 16
 s_mov_b64 s[30:31], s[80:81]
 s_cmp_eq_u32 s37, 2
 s_cmov_b64 s[30:31], s[76:77]
 s_add_u32 m0, s29, 40960
 s_nop 0
 buffer_load_dwordx4 v1, s[4:7], s42 offen  lds
 s_cmp_eq_u32 s37, 3
 s_cmov_b64 s[30:31], s[66:67]
 s_cmp_eq_u32 s37, 4
 s_cmov_b64 s[30:31], s[68:69]
 s_cmp_eq_u32 s37, 5
 s_cmov_b64 s[30:31], s[86:87]
 s_cmp_eq_u32 s37, 6
 s_cmov_b64 s[30:31], s[86:87]
 s_add_u32 m0, s29, 110592
 s_nop 0
 buffer_load_dwordx4 v2, s[8:11], s50 offen  lds
 s_cmp_eq_u32 s37, 7
 s_cmov_b64 s[30:31], s[72:73]
 s_cmp_eq_u32 s37, 8
 s_cmov_b64 s[30:31], s[64:65]
 s_add_u32 s32, s38, 1835008
 s_cmp_eq_u32 s37, 1
 s_cmov_b32 s38, s32
 s_cmp_eq_u32 s37, 6
 s_cmov_b32 s38, s32
 s_add_u32 m0, s29, 45056
 s_nop 0
 buffer_load_dwordx4 v1, s[4:7], s43 offen  lds
 s_lshl_b32 s32, s39, 15
 s_add_u32 s38, s38, s32
 s_cmp_ge_u32 s37, 9
 s_cmov_b32 s36, 28
 s_cmp_lt_u32 s36, 28
 s_cselect_b32 s32, 0x8000, 0
 s_cselect_b32 s38, s38, 0
 s_add_u32 s36, s30, s38
 s_addc_u32 s37, s31, 0
 s_mov_b32 s38, s32
 s_add_u32 m0, s29, 114688
 s_nop 0
 buffer_load_dwordx4 v2, s[8:11], s51 offen  lds
 s_mov_b32 s39, 0x20000
 v_lshlrev_b32 v14, 6, v0
 s_mov_b32 s56, 0xffffd000
 s_movk_i32 s30, 0x1000
 s_cmp_ge_u32 s3, 2
 s_cbranch_scc1 L_pfset
 s_mov_b32 s38, 0
 s_cmp_eq_u32 s3, 0
 s_cselect_b64 s[36:37], s[8:9], s[4:5]
 s_cselect_b32 s38, s10, s6
 s_movk_i32 s30, 128
 s_cmov_b32 s30, 0x80000
 s_cselect_b64 vcc, -1, 0
 s_lshl_b32 s56, s30, 1
 v_cndmask_b32 v14, v17, v16, vcc
L_pfset:
 s_add_u32 m0, s29, 49152
 s_nop 0
 buffer_load_dwordx4 v1, s[4:7], s44 offen  lds
 v_mov_b32 v15, 1
 v_mov_b32 v3, 0
 s_mov_b32 s61, 0
 s_waitcnt vmcnt(10)
 s_barrier
 ds_read_b64_tr_b16 a[0:1], v6 offset:0
 ds_read_b64_tr_b16 a[2:3], v6 offset:4096
 ds_read_b128 a[64:67], v4 offset:0
 ds_read_b64_tr_b16 a[4:5], v6 offset:16384
 ds_read_b64_tr_b16 a[6:7], v6 offset:20480
 ds_read_b128 a[68:71], v5 offset:0
 ds_read_b128 a[76:79], v5 offset:2048
 ds_read_b128 a[72:75], v4 offset:2048
 ds_read_b128 a[80:83], v4 offset:4096
 ds_read_b128 a[84:87], v5 offset:4096
 ds_read_b128 a[92:95], v5 offset:6144
 ds_read_b128 a[88:91], v4 offset:6144
 ds_read_b64_tr_b16 a[8:9], v7 offset:0
 ds_read_b64_tr_b16 a[10:11], v7 offset:4096
 ds_read_b64_tr_b16 a[12:13], v7 offset:16384
 ds_read_b64_tr_b16 a[14:15], v7 offset:20480
 ds_read_b64_tr_b16 a[16:17], v8 offset:0
 ds_read_b64_tr_b16 a[18:19], v8 offset:4096
 ds_read_b64_tr_b16 a[20:21], v8 offset:16384
 ds_read_b64_tr_b16 a[22:23], v8 offset:20480
 s_cmp_eq_u32 s27, 0
 s_waitcnt lgkmcnt(0)
 s_cbranch_scc0 L_vloop_head
L_kloop_head:
 v_mfma_f32_16x16x32_bf16 v[88:91], a[0:3], a[64:67], 0
 s_add_u32 m0, s29, 118784
 ds_read_b64_tr_b16 a[24:25], v9 offset:0
 v_mfma_f32_16x16x32_bf16 v[88:91], a[4:7], a[68:71], v[88:91]
 ds_read_b64_tr_b16 a[26:27], v9 offset:4096
 buffer_load_dwordx4 v2, s[8:11], s52 offen  lds
 v_mfma_f32_16x16x32_bf16 v[80:83], a[4:7], a[76:79], 0
 ds_read_b64_tr_b16 a[28:29], v9 offset:16384
 v_mfma_f32_16x16x32_bf16 v[80:83], a[0:3], a[72:75], v[80:83]
 ds_read_b64_tr_b16 a[30:31], v9 offset:20480
 v_mfma_f32_16x16x32_bf16 v[72:75], a[0:3], a[80:83], 0
 s_add_u32 m0, s29, 53248
 ds_read_b128 a[96:99], v4 offset:8192
 v_mfma_f32_16x16x32_bf16 v[72:75], a[4:7], a[84:87], v[72:75]
 buffer_load_dwordx4 v1, s[4:7], s45 offen  lds
 v_mfma_f32_16x16x32_bf16 v[64:67], a[4:7], a[92:95], 0
 ds_read_b128 a[100:103], v5 offset:8192
 v_mfma_f32_16x16x32_bf16 v[64:67], a[0:3], a[88:91], v[64:67]
 v_mfma_f32_16x16x32_bf16 v[68:71], a[8:11], a[88:91], 0
 s_add_u32 m0, s29, 122880
 ds_read_b128 a[108:111], v5 offset:10240
 v_mfma_f32_16x16x32_bf16 v[68:71], a[12:15], a[92:95], v[68:71]
 buffer_load_dwordx4 v2, s[8:11], s53 offen  lds
 v_mfma_f32_16x16x32_bf16 v[76:79], a[12:15], a[84:87], 0
 ds_read_b128 a[104:107], v4 offset:10240
 v_mfma_f32_16x16x32_bf16 v[76:79], a[8:11], a[80:83], v[76:79]
 v_mfma_f32_16x16x32_bf16 v[84:87], a[8:11], a[72:75], 0
 s_add_u32 m0, s29, 57344
 ds_read_b128 a[112:115], v4 offset:12288
 v_mfma_f32_16x16x32_bf16 v[84:87], a[12:15], a[76:79], v[84:87]
 buffer_load_dwordx4 v1, s[4:7], s46 offen  lds
 v_mfma_f32_16x16x32_bf16 v[92:95], a[12:15], a[68:71], 0
 ds_read_b128 a[116:119], v5 offset:12288
 v_mfma_f32_16x16x32_bf16 v[92:95], a[8:11], a[64:67], v[92:95]
 v_mfma_f32_16x16x32_bf16 v[120:123], a[16:19], a[64:67], 0
 s_add_u32 m0, s29, 126976
 ds_read_b128 a[124:127], v5 offset:14336
 v_mfma_f32_16x16x32_bf16 v[120:123], a[20:23], a[68:71], v[120:123]
 buffer_load_dwordx4 v2, s[8:11], s54 offen  lds
 v_mfma_f32_16x16x32_bf16 v[112:115], a[20:23], a[76:79], 0
 ds_read_b128 a[120:123], v4 offset:14336
 v_mfma_f32_16x16x32_bf16 v[112:115], a[16:19], a[72:75], v[112:115]
 v_mfma_f32_16x16x32_bf16 v[104:107], a[16:19], a[80:83], 0
 s_add_u32 m0, s29, 61440
 ds_read_b64_tr_b16 a[32:33], v10 offset:0
 v_mfma_f32_16x16x32_bf16 v[104:107], a[20:23], a[84:87], v[104:107]
 ds_read_b64_tr_b16 a[34:35], v10 offset:4096
 buffer_load_dwordx4 v1, s[4:7], s47 offen  lds
 v_mfma_f32_16x16x32_bf16 v[96:99], a[20:23], a[92:95], 0
 ds_read_b64_tr_b16 a[36:37], v10 offset:16384
 v_add_u32 v1, 128, v1
 v_mfma_f32_16x16x32_bf16 v[96:99], a[16:19], a[88:91], v[96:99]
 s_waitcnt lgkmcnt(8)
 ds_read_b64_tr_b16 a[38:39], v10 offset:20480
 v_add_u32 v2, 0x80000, v2
 v_mfma_f32_16x16x32_bf16 v[100:103], a[24:27], a[88:91], 0
 ds_read_b64_tr_b16 a[40:41], v11 offset:0
 v_mfma_f32_16x16x32_bf16 v[100:103], a[28:31], a[92:95], v[100:103]
 ds_read_b64_tr_b16 a[42:43], v11 offset:4096
 v_mfma_f32_16x16x32_bf16 v[108:111], a[28:31], a[84:87], 0
 ds_read_b64_tr_b16 a[44:45], v11 offset:16384
 v_mfma_f32_16x16x32_bf16 v[108:111], a[24:27], a[80:83], v[108:111]
 ds_read_b64_tr_b16 a[46:47], v11 offset:20480
 v_mfma_f32_16x16x32_bf16 v[116:119], a[24:27], a[72:75], 0
 ds_read_b64_tr_b16 a[48:49], v12 offset:0
 v_mfma_f32_16x16x32_bf16 v[116:119], a[28:31], a[76:79], v[116:119]
 ds_read_b64_tr_b16 a[50:51], v12 offset:4096
 v_mfma_f32_16x16x32_bf16 v[124:127], a[28:31], a[68:71], 0
 ds_read_b64_tr_b16 a[52:53], v12 offset:16384
 v_mfma_f32_16x16x32_bf16 v[124:127], a[24:27], a[64:67], v[124:127]
 ds_read_b64_tr_b16 a[54:55], v12 offset:20480
 v_mfma_f32_16x16x32_bf16 a[232:235], a[0:3], a[96:99], 0
 ds_read_b64_tr_b16 a[56:57], v13 offset:0
 v_mfma_f32_16x16x32_bf16 a[232:235], a[4:7], a[100:103], a[232:235]
 ds_read_b64_tr_b16 a[58:59], v13 offset:4096
 v_mfma_f32_16x16x32_bf16 a[224:227], a[4:7], a[108:111], 0
 s_waitcnt lgkmcnt(8)
 ds_read_b64_tr_b16 a[60:61], v13 offset:16384
 v_mfma_f32_16x16x32_bf16 a[224:227], a[0:3], a[104:107], a[224:227]
 ds_read_b64_tr_b16 a[62:63], v13 offset:20480
 v_mfma_f32_16x16x32_bf16 v[24:27], a[0:3], a[112:115], 0
 v_mfma_f32_16x16x32_bf16 v[24:27], a[4:7], a[116:119], v[24:27]
 v_mfma_f32_16x16x32_bf16 v[16:19], a[4:7], a[124:127], 0
 v_mfma_f32_16x16x32_bf16 v[16:19], a[0:3], a[120:123], v[16:19]
 s_waitcnt lgkmcnt(0)
 v_mfma_f32_16x16x32_bf16 v[20:23], a[8:11], a[120:123], 0
 s_barrier
 v_mfma_f32_16x16x32_bf16 v[20:23], a[12:15], a[124:127], v[20:23]
 s_add_u32 m0, s29, 65536
 v_mfma_f32_16x16x32_bf16 v[28:31], a[12:15], a[116:119], 0
 buffer_load_dwordx4 v2, s[8:11], 0 offen  lds
 v_mfma_f32_16x16x32_bf16 v[28:31], a[8:11], a[112:115], v[28:31]
 v_mfma_f32_16x16x32_bf16 a[228:231], a[8:11], a[104:107], 0
 v_mfma_f32_16x16x32_bf16 a[228:231], a[12:15], a[108:111], a[228:231]
 v_mfma_f32_16x16x32_bf16 a[236:239], a[12:15], a[100:103], 0
 s_add_u32 m0, s29, 0
 v_mfma_f32_16x16x32_bf16 a[236:239], a[8:11], a[96:99], a[236:239]
 buffer_load_dwordx4 v1, s[4:7], 0 offen  lds
 v_mfma_f32_16x16x32_bf16 v[56:59], a[16:19], a[96:99], 0
 v_mfma_f32_16x16x32_bf16 v[56:59], a[20:23], a[100:103], v[56:59]
 v_mfma_f32_16x16x32_bf16 v[48:51], a[20:23], a[108:111], 0
 v_mfma_f32_16x16x32_bf16 v[48:51], a[16:19], a[104:107], v[48:51]
 s_add_u32 m0, s29, 69632
 v_mfma_f32_16x16x32_bf16 v[40:43], a[16:19], a[112:115], 0
 buffer_load_dwordx4 v2, s[8:11], s48 offen  lds
 v_mfma_f32_16x16x32_bf16 v[40:43], a[20:23], a[116:119], v[40:43]
 v_mfma_f32_16x16x32_bf16 v[32:35], a[20:23], a[124:127], 0
 v_mfma_f32_16x16x32_bf16 v[32:35], a[16:19], a[120:123], v[32:35]
 v_mfma_f32_16x16x32_bf16 v[36:39], a[24:27], a[120:123], 0
 s_add_u32 m0, s29, 4096
 v_mfma_f32_16x16x32_bf16 v[36:39], a[28:31], a[124:127], v[36:39]
 buffer_load_dwordx4 v1, s[4:7], s41 offen  lds
 v_mfma_f32_16x16x32_bf16 v[44:47], a[28:31], a[116:119], 0
 v_mfma_f32_16x16x32_bf16 v[44:47], a[24:27], a[112:115], v[44:47]
 v_mfma_f32_16x16x32_bf16 v[52:55], a[24:27], a[104:107], 0
 v_mfma_f32_16x16x32_bf16 v[52:55], a[28:31], a[108:111], v[52:55]
 s_add_u32 m0, s29, 73728
 v_mfma_f32_16x16x32_bf16 v[60:63], a[28:31], a[100:103], 0
 buffer_load_dwordx4 v2, s[8:11], s49 offen  lds
 v_mfma_f32_16x16x32_bf16 v[60:63], a[24:27], a[96:99], v[60:63]
 v_mfma_f32_16x16x32_bf16 v[216:219], a[32:35], a[96:99], 0
 v_mfma_f32_16x16x32_bf16 v[216:219], a[36:39], a[100:103], v[216:219]
 v_mfma_f32_16x16x32_bf16 v[208:211], a[36:39], a[108:111], 0
 s_add_u32 m0, s29, 8192
 v_mfma_f32_16x16x32_bf16 v[208:211], a[32:35], a[104:107], v[208:211]
 buffer_load_dwordx4 v1, s[4:7], s42 offen  lds
 v_mfma_f32_16x16x32_bf16 v[200:203], a[32:35], a[112:115], 0
 v_mfma_f32_16x16x32_bf16 v[200:203], a[36:39], a[116:119], v[200:203]
 v_mfma_f32_16x16x32_bf16 v[192:195], a[36:39], a[124:127], 0
 v_mfma_f32_16x16x32_bf16 v[192:195], a[32:35], a[120:123], v[192:195]
 s_add_u32 m0, s29, 77824
 v_mfma_f32_16x16x32_bf16 v[196:199], a[40:43], a[120:123], 0
 buffer_load_dwordx4 v2, s[8:11], s50 offen  lds
 v_mfma_f32_16x16x32_bf16 v[196:199], a[44:47], a[124:127], v[196:199]
 v_mfma_f32_16x16x32_bf16 v[204:207], a[44:47], a[116:119], 0
 v_mfma_f32_16x16x32_bf16 v[204:207], a[40:43], a[112:115], v[204:207]
 v_mfma_f32_16x16x32_bf16 v[212:215], a[40:43], a[104:107], 0
 s_add_u32 m0, s29, 12288
 v_mfma_f32_16x16x32_bf16 v[212:215], a[44:47], a[108:111], v[212:215]
 buffer_load_dwordx4 v1, s[4:7], s43 offen  lds
 v_mfma_f32_16x16x32_bf16 v[220:223], a[44:47], a[100:103], 0
 v_mfma_f32_16x16x32_bf16 v[220:223], a[40:43], a[96:99], v[220:223]
 v_mfma_f32_16x16x32_bf16 v[248:251], a[48:51], a[96:99], 0
 v_mfma_f32_16x16x32_bf16 v[248:251], a[52:55], a[100:103], v[248:251]
 s_add_u32 m0, s29, 81920
 v_mfma_f32_16x16x32_bf16 v[240:243], a[52:55], a[108:111], 0
 buffer_load_dwordx4 v2, s[8:11], s51 offen  lds
 v_mfma_f32_16x16x32_bf16 v[240:243], a[48:51], a[104:107], v[240:243]
 v_mfma_f32_16x16x32_bf16 v[232:235], a[48:51], a[112:115], 0
 v_mfma_f32_16x16x32_bf16 v[232:235], a[52:55], a[116:119], v[232:235]
 v_mfma_f32_16x16x32_bf16 v[224:227], a[52:55], a[124:127], 0
 s_add_u32 m0, s29, 16384
 v_mfma_f32_16x16x32_bf16 v[224:227], a[48:51], a[120:123], v[224:227]
 buffer_load_dwordx4 v1, s[4:7], s44 offen  lds
 v_mfma_f32_16x16x32_bf16 v[228:231], a[56:59], a[120:123], 0
 v_mfma_f32_16x16x32_bf16 v[228:231], a[60:63], a[124:127], v[228:231]
 v_mfma_f32_16x16x32_bf16 v[236:239], a[60:63], a[116:119], 0
 v_mfma_f32_16x16x32_bf16 v[236:239], a[56:59], a[112:115], v[236:239]
 s_add_u32 m0, s29, 86016
 v_mfma_f32_16x16x32_bf16 v[244:247], a[56:59], a[104:107], 0
 s_waitcnt vmcnt(10)
 buffer_load_dwordx4 v2, s[8:11], s52 offen  lds
 v_mfma_f32_16x16x32_bf16 v[244:247], a[60:63], a[108:111], v[244:247]
 s_barrier
 ds_read_b64_tr_b16 a[0:1], v6 offset:32768
 v_mfma_f32_16x16x32_bf16 v[252:255], a[60:63], a[100:103], 0
 ds_read_b64_tr_b16 a[2:3], v6 offset:36864
 v_mfma_f32_16x16x32_bf16 v[252:255], a[56:59], a[96:99], v[252:255]
 ds_read_b128 a[96:99], v4 offset:40960
 v_mfma_f32_16x16x32_bf16 v[152:155], a[32:35], a[64:67], 0
 s_add_u32 m0, s29, 20480
 v_mfma_f32_16x16x32_bf16 v[152:155], a[36:39], a[68:71], v[152:155]
 buffer_load_dwordx4 v1, s[4:7], s45 offen  lds
 v_mfma_f32_16x16x32_bf16 v[144:147], a[36:39], a[76:79], 0
 ds_read_b64_tr_b16 a[4:5], v6 offset:49152
 v_mfma_f32_16x16x32_bf16 v[144:147], a[32:35], a[72:75], v[144:147]
 ds_read_b64_tr_b16 a[6:7], v6 offset:53248
 v_mfma_f32_16x16x32_bf16 v[136:139], a[32:35], a[80:83], 0
 ds_read_b128 a[100:103], v5 offset:40960
 v_mfma_f32_16x16x32_bf16 v[136:139], a[36:39], a[84:87], v[136:139]
 s_add_u32 m0, s29, 90112
 v_mfma_f32_16x16x32_bf16 v[128:131], a[36:39], a[92:95], 0
 buffer_load_dwordx4 v2, s[8:11], s53 offen  lds
 v_mfma_f32_16x16x32_bf16 v[128:131], a[32:35], a[88:91], v[128:131]
 ds_read_b128 a[108:111], v5 offset:43008
 v_mfma_f32_16x16x32_bf16 v[132:135], a[40:43], a[88:91], 0
 v_mfma_f32_16x16x32_bf16 v[132:135], a[44:47], a[92:95], v[132:135]
 ds_read_b128 a[104:107], v4 offset:43008
 v_mfma_f32_16x16x32_bf16 v[140:143], a[44:47], a[84:87], 0
 s_add_u32 m0, s29, 24576
 v_mfma_f32_16x16x32_bf16 v[140:143], a[40:43], a[80:83], v[140:143]
 buffer_load_dwordx4 v1, s[4:7], s46 offen  lds
 v_mfma_f32_16x16x32_bf16 v[148:151], a[40:43], a[72:75], 0
 ds_read_b128 a[112:115], v4 offset:45056
 v_mfma_f32_16x16x32_bf16 v[148:151], a[44:47], a[76:79], v[148:151]
 v_mfma_f32_16x16x32_bf16 v[156:159], a[44:47], a[68:71], 0
 ds_read_b128 a[116:119], v5 offset:45056
 v_mfma_f32_16x16x32_bf16 v[156:159], a[40:43], a[64:67], v[156:159]
 s_add_u32 m0, s29, 94208
 v_mfma_f32_16x16x32_bf16 v[184:187], a[48:51], a[64:67], 0
 buffer_load_dwordx4 v2, s[8:11], s54 offen  lds
 v_mfma_f32_16x16x32_bf16 v[184:187], a[52:55], a[68:71], v[184:187]
 ds_read_b128 a[124:127], v5 offset:47104
 v_mfma_f32_16x16x32_bf16 v[176:179], a[52:55], a[76:79], 0
 v_mfma_f32_16x16x32_bf16 v[176:179], a[48:51], a[72:75], v[176:179]
 ds_read_b128 a[120:123], v4 offset:47104
 v_mfma_f32_16x16x32_bf16 v[168:171], a[48:51], a[80:83], 0
 s_add_u32 m0, s29, 28672
 v_mfma_f32_16x16x32_bf16 v[168:171], a[52:55], a[84:87], v[168:171]
 buffer_load_dwordx4 v1, s[4:7], s47 offen  lds
 v_mfma_f32_16x16x32_bf16 v[160:163], a[52:55], a[92:95], 0
 v_mfma_f32_16x16x32_bf16 v[160:163], a[48:51], a[88:91], v[160:163]
 ds_read_b64_tr_b16 a[8:9], v7 offset:32768
 v_mfma_f32_16x16x32_bf16 v[164:167], a[56:59], a[88:91], 0
 v_mfma_f32_16x16x32_bf16 v[164:167], a[60:63], a[92:95], v[164:167]
 ds_read_b64_tr_b16 a[10:11], v7 offset:36864
 v_mfma_f32_16x16x32_bf16 v[172:175], a[60:63], a[84:87], 0
 ds_read_b64_tr_b16 a[12:13], v7 offset:49152
 v_mfma_f32_16x16x32_bf16 v[172:175], a[56:59], a[80:83], v[172:175]
 ds_read_b64_tr_b16 a[14:15], v7 offset:53248
 v_mfma_f32_16x16x32_bf16 v[180:183], a[56:59], a[72:75], 0
 ds_read_b64_tr_b16 a[16:17], v8 offset:32768
 v_mfma_f32_16x16x32_bf16 v[180:183], a[60:63], a[76:79], v[180:183]
 ds_read_b64_tr_b16 a[18:19], v8 offset:36864
 v_mfma_f32_16x16x32_bf16 v[188:191], a[60:63], a[68:71], 0
 ds_read_b64_tr_b16 a[20:21], v8 offset:49152
 v_mfma_f32_16x16x32_bf16 v[188:191], a[56:59], a[64:67], v[188:191]
 s_waitcnt lgkmcnt(8)
 ds_read_b64_tr_b16 a[22:23], v8 offset:53248
 v_add_u32 v1, 128, v1
 v_add_u32 v2, 0x80000, v2
 s_add_u32 s56, s56, s30
 buffer_load_dword a243, v14, s[36:39], s56 offen
 s_add_u32 s56, s56, s30
 buffer_load_dword a243, v14, s[36:39], s56 offen
 s_add_u32 s56, s56, s30
 s_branch L_kloop_mid
.p2align 6
L_kloop:
 v_mfma_f32_16x16x32_bf16 v[88:91], a[0:3], a[64:67], v[88:91]
 ds_read_b64_tr_b16 a[24:25], v9 offset:0
 v_mfma_f32_16x16x32_bf16 v[88:91], a[4:7], a[68:71], v[88:91]
 ds_read_b64_tr_b16 a[26:27], v9 offset:4096
 v_mfma_f32_16x16x32_bf16 v[80:83], a[4:7], a[76:79], v[80:83]
 ds_read_b64_tr_b16 a[28:29], v9 offset:16384
 v_mfma_f32_16x16x32_bf16 v[80:83], a[0:3], a[72:75], v[80:83]
 ds_read_b64_tr_b16 a[30:31], v9 offset:20480
 v_mfma_f32_16x16x32_bf16 v[72:75], a[0:3], a[80:83], v[72:75]
 ds_read_b128 a[96:99], v4 offset:8192
 v_mfma_f32_16x16x32_bf16 v[72:75], a[4:7], a[84:87], v[72:75]
 v_mfma_f32_16x16x32_bf16 v[64:67], a[4:7], a[92:95], v[64:67]
 s_waitcnt lgkmcnt(8)
 ds_read_b128 a[100:103], v5 offset:8192
 v_mfma_f32_16x16x32_bf16 v[64:67], a[0:3], a[88:91], v[64:67]
 v_mfma_f32_16x16x32_bf16 v[68:71], a[8:11], a[88:91], v[68:71]
 ds_read_b128 a[108:111], v5 offset:10240
 v_mfma_f32_16x16x32_bf16 v[68:71], a[12:15], a[92:95], v[68:71]
 v_mfma_f32_16x16x32_bf16 v[76:79], a[12:15], a[84:87], v[76:79]
 ds_read_b128 a[104:107], v4 offset:10240
 v_mfma_f32_16x16x32_bf16 v[76:79], a[8:11], a[80:83], v[76:79]
 v_mfma_f32_16x16x32_bf16 v[84:87], a[8:11], a[72:75], v[84:87]
 ds_read_b128 a[112:115], v4 offset:12288
 v_mfma_f32_16x16x32_bf16 v[84:87], a[12:15], a[76:79], v[84:87]
 v_mfma_f32_16x16x32_bf16 v[92:95], a[12:15], a[68:71], v[92:95]
 ds_read_b128 a[116:119], v5 offset:12288
 v_mfma_f32_16x16x32_bf16 v[92:95], a[8:11], a[64:67], v[92:95]
 s_waitcnt lgkmcnt(8)
 v_mfma_f32_16x16x32_bf16 v[120:123], a[16:19], a[64:67], v[120:123]
 ds_read_b128 a[124:127], v5 offset:14336
 v_mfma_f32_16x16x32_bf16 v[120:123], a[20:23], a[68:71], v[120:123]
 v_mfma_f32_16x16x32_bf16 v[112:115], a[20:23], a[76:79], v[112:115]
 ds_read_b128 a[120:123], v4 offset:14336
 v_mfma_f32_16x16x32_bf16 v[112:115], a[16:19], a[72:75], v[112:115]
 v_mfma_f32_16x16x32_bf16 v[104:107], a[16:19], a[80:83], v[104:107]
 ds_read_b64_tr_b16 a[32:33], v10 offset:0
 v_mfma_f32_16x16x32_bf16 v[104:107], a[20:23], a[84:87], v[104:107]
 ds_read_b64_tr_b16 a[34:35], v10 offset:4096
 v_mfma_f32_16x16x32_bf16 v[96:99], a[20:23], a[92:95], v[96:99]
 ds_read_b64_tr_b16 a[36:37], v10 offset:16384
 v_mfma_f32_16x16x32_bf16 v[96:99], a[16:19], a[88:91], v[96:99]
 ds_read_b64_tr_b16 a[38:39], v10 offset:20480
 v_mfma_f32_16x16x32_bf16 v[100:103], a[24:27], a[88:91], v[100:103]
 s_waitcnt lgkmcnt(8)
 ds_read_b64_tr_b16 a[40:41], v11 offset:0
 v_mfma_f32_16x16x32_bf16 v[100:103], a[28:31], a[92:95], v[100:103]
 ds_read_b64_tr_b16 a[42:43], v11 offset:4096
 v_mfma_f32_16x16x32_bf16 v[108:111], a[28:31], a[84:87], v[108:111]
 ds_read_b64_tr_b16 a[44:45], v11 offset:16384
 v_mfma_f32_16x16x32_bf16 v[108:111], a[24:27], a[80:83], v[108:111]
 ds_read_b64_tr_b16 a[46:47], v11 offset:20480
 v_mfma_f32_16x16x32_bf16 v[116:119], a[24:27], a[72:75], v[116:119]
 ds_read_b64_tr_b16 a[48:49], v12 offset:0
 v_mfma_f32_16x16x32_bf16 v[116:119], a[28:31], a[76:79], v[116:119]
 ds_read_b64_tr_b16 a[50:51], v12 offset:4096
 v_mfma_f32_16x16x32_bf16 v[124:127], a[28:31], a[68:71], v[124:127]
 ds_read_b64_tr_b16 a[52:53], v12 offset:16384
 v_mfma_f32_16x16x32_bf16 v[124:127], a[24:27], a[64:67], v[124:127]
 ds_read_b64_tr_b16 a[54:55], v12 offset:20480
 v_mfma_f32_16x16x32_bf16 a[232:235], a[0:3], a[96:99], a[232:235]
 ds_read_b64_tr_b16 a[56:57], v13 offset:0
 v_mfma_f32_16x16x32_bf16 a[232:235], a[4:7], a[100:103], a[232:235]
 ds_read_b64_tr_b16 a[58:59], v13 offset:4096
 v_mfma_f32_16x16x32_bf16 a[224:227], a[4:7], a[108:111], a[224:227]
 ds_read_b64_tr_b16 a[60:61], v13 offset:16384
 v_mfma_f32_16x16x32_bf16 a[224:227], a[0:3], a[104:107], a[224:227]
 s_waitcnt lgkmcnt(8)
 ds_read_b64_tr_b16 a[62:63], v13 offset:20480
 v_mfma_f32_16x16x32_bf16 v[24:27], a[0:3], a[112:115], v[24:27]
 v_mfma_f32_16x16x32_bf16 v[24:27], a[4:7], a[116:119], v[24:27]
 v_mfma_f32_16x16x32_bf16 v[16:19], a[4:7], a[124:127], v[16:19]
 v_mfma_f32_16x16x32_bf16 v[16:19], a[0:3], a[120:123], v[16:19]
 s_waitcnt lgkmcnt(0)
 v_mfma_f32_16x16x32_bf16 v[20:23], a[8:11], a[120:123], v[20:23]
 s_barrier
 v_mfma_f32_16x16x32_bf16 v[20:23], a[12:15], a[124:127], v[20:23]
 s_add_u32 m0, s29, 65536
 v_mfma_f32_16x16x32_bf16 v[28:31], a[12:15], a[116:119], v[28:31]
 buffer_load_dwordx4 v2, s[8:11], 0 offen  lds
 v_mfma_f32_16x16x32_bf16 v[28:31], a[8:11], a[112:115], v[28:31]
 v_mfma_f32_16x16x32_bf16 a[228:231], a[8:11], a[104:107], a[228:231]
 v_mfma_f32_16x16x32_bf16 a[228:231], a[12:15], a[108:111], a[228:231]
 v_mfma_f32_16x16x32_bf16 a[236:239], a[12:15], a[100:103], a[236:239]
 s_add_u32 m0, s29, 0
 v_mfma_f32_16x16x32_bf16 a[236:239], a[8:11], a[96:99], a[236:239]
 buffer_load_dwordx4 v1, s[4:7], 0 offen  lds
 v_mfma_f32_16x16x32_bf16 v[56:59], a[16:19], a[96:99], v[56:59]
 v_mfma_f32_16x16x32_bf16 v[56:59], a[20:23], a[100:103], v[56:59]
 v_mfma_f32_16x16x32_bf16 v[48:51], a[20:23], a[108:111], v[48:51]
 v_mfma_f32_16x16x32_bf16 v[48:51], a[16:19], a[104:107], v[48:51]
 s_add_u32 m0, s29, 69632
 v_mfma_f32_16x16x32_bf16 v[40:43], a[16:19], a[112:115], v[40:43]
 buffer_load_dwordx4 v2, s[8:11], s48 offen  lds
 v_mfma_f32_16x16x32_bf16 v[40:43], a[20:23], a[116:119], v[40:43]
 v_mfma_f32_16x16x32_bf16 v[32:35], a[20:23], a[124:127], v[32:35]
 v_mfma_f32_16x16x32_bf16 v[32:35], a[16:19], a[120:123], v[32:35]
 v_mfma_f32_16x16x32_bf16 v[36:39], a[24:27], a[120:123], v[36:39]
 s_add_u32 m0, s29, 4096
 v_mfma_f32_16x16x32_bf16 v[36:39], a[28:31], a[124:127], v[36:39]
 buffer_load_dwordx4 v1, s[4:7], s41 offen  lds
 v_mfma_f32_16x16x32_bf16 v[44:47], a[28:31], a[116:119], v[44:47]
 v_mfma_f32_16x16x32_bf16 v[44:47], a[24:27], a[112:115], v[44:47]
 v_mfma_f32_16x16x32_bf16 v[52:55], a[24:27], a[104:107], v[52:55]
 v_mfma_f32_16x16x32_bf16 v[52:55], a[28:31], a[108:111], v[52:55]
 s_add_u32 m0, s29, 73728
 v_mfma_f32_16x16x32_bf16 v[60:63], a[28:31], a[100:103], v[60:63]
 buffer_load_dwordx4 v2, s[8:11], s49 offen  lds
 v_mfma_f32_16x16x32_bf16 v[60:63], a[24:27], a[96:99], v[60:63]
 v_mfma_f32_16x16x32_bf16 v[216:219], a[32:35], a[96:99], v[216:219]
 v_mfma_f32_16x16x32_bf16 v[216:219], a[36:39], a[100:103], v[216:219]
 v_mfma_f32_16x16x32_bf16 v[208:211], a[36:39], a[108:111], v[208:211]
 s_add_u32 m0, s29, 8192
 v_mfma_f32_16x16x32_bf16 v[208:211], a[32:35], a[104:107], v[208:211]
 buffer_load_dwordx4 v1, s[4:7], s42 offen  lds
 v_mfma_f32_16x16x32_bf16 v[200:203], a[32:35], a[112:115], v[200:203]
 v_mfma_f32_16x16x32_bf16 v[200:203], a[36:39], a[116:119], v[200:203]
 v_mfma_f32_16x16x32_bf16 v[192:195], a[36:39], a[124:127], v[192:195]
 v_mfma_f32_16x16x32_bf16 v[192:195], a[32:35], a[120:123], v[192:195]
 s_add_u32 m0, s29, 77824
 v_mfma_f32_16x16x32_bf16 v[196:199], a[40:43], a[120:123], v[196:199]
 buffer_load_dwordx4 v2, s[8:11], s50 offen  lds
 v_mfma_f32_16x16x32_bf16 v[196:199], a[44:47], a[124:127], v[196:199]
 v_mfma_f32_16x16x32_bf16 v[204:207], a[44:47], a[116:119], v[204:207]
 v_mfma_f32_16x16x32_bf16 v[204:207], a[40:43], a[112:115], v[204:207]
 v_mfma_f32_16x16x32_bf16 v[212:215], a[40:43], a[104:107], v[212:215]
 s_add_u32 m0, s29, 12288
 v_mfma_f32_16x16x32_bf16 v[212:215], a[44:47], a[108:111], v[212:215]
 buffer_load_dwordx4 v1, s[4:7], s43 offen  lds
 v_mfma_f32_16x16x32_bf16 v[220:223], a[44:47], a[100:103], v[220:223]
 v_mfma_f32_16x16x32_bf16 v[220:223], a[40:43], a[96:99], v[220:223]
 v_mfma_f32_16x16x32_bf16 v[248:251], a[48:51], a[96:99], v[248:251]
 v_mfma_f32_16x16x32_bf16 v[248:251], a[52:55], a[100:103], v[248:251]
 s_add_u32 m0, s29, 81920
 v_mfma_f32_16x16x32_bf16 v[240:243], a[52:55], a[108:111], v[240:243]
 buffer_load_dwordx4 v2, s[8:11], s51 offen  lds
 v_mfma_f32_16x16x32_bf16 v[240:243], a[48:51], a[104:107], v[240:243]
 v_mfma_f32_16x16x32_bf16 v[232:235], a[48:51], a[112:115], v[232:235]
 v_mfma_f32_16x16x32_bf16 v[232:235], a[52:55], a[116:119], v[232:235]
 v_mfma_f32_16x16x32_bf16 v[224:227], a[52:55], a[124:127], v[224:227]
 s_add_u32 m0, s29, 16384
 v_mfma_f32_16x16x32_bf16 v[224:227], a[48:51], a[120:123], v[224:227]
 buffer_load_dwordx4 v1, s[4:7], s44 offen  lds
 v_mfma_f32_16x16x32_bf16 v[228:231], a[56:59], a[120:123], v[228:231]
 v_mfma_f32_16x16x32_bf16 v[228:231], a[60:63], a[124:127], v[228:231]
 v_mfma_f32_16x16x32_bf16 v[236:239], a[60:63], a[116:119], v[236:239]
 v_mfma_f32_16x16x32_bf16 v[236:239], a[56:59], a[112:115], v[236:239]
 s_add_u32 m0, s29, 86016
 v_mfma_f32_16x16x32_bf16 v[244:247], a[56:59], a[104:107], v[244:247]
 s_waitcnt vmcnt(11)
 buffer_load_dwordx4 v2, s[8:11], s52 offen  lds
 v_mfma_f32_16x16x32_bf16 v[244:247], a[60:63], a[108:111], v[244:247]
 s_barrier
 ds_read_b64_tr_b16 a[0:1], v6 offset:32768
 v_mfma_f32_16x16x32_bf16 v[252:255], a[60:63], a[100:103], v[252:255]
 ds_read_b64_tr_b16 a[2:3], v6 offset:36864
 v_mfma_f32_16x16x32_bf16 v[252:255], a[56:59], a[96:99], v[252:255]
 ds_read_b128 a[96:99], v4 offset:40960
 v_mfma_f32_16x16x32_bf16 v[152:155], a[32:35], a[64:67], v[152:155]
 s_add_u32 m0, s29, 20480
 v_mfma_f32_16x16x32_bf16 v[152:155], a[36:39], a[68:71], v[152:155]
 buffer_load_dwordx4 v1, s[4:7], s45 offen  lds
 v_mfma_f32_16x16x32_bf16 v[144:147], a[36:39], a[76:79], v[144:147]
 ds_read_b64_tr_b16 a[4:5], v6 offset:49152
 v_mfma_f32_16x16x32_bf16 v[144:147], a[32:35], a[72:75], v[144:147]
 ds_read_b64_tr_b16 a[6:7], v6 offset:53248
 v_mfma_f32_16x16x32_bf16 v[136:139], a[32:35], a[80:83], v[136:139]
 ds_read_b128 a[100:103], v5 offset:40960
 v_mfma_f32_16x16x32_bf16 v[136:139], a[36:39], a[84:87], v[136:139]
 s_add_u32 m0, s29, 90112
 v_mfma_f32_16x16x32_bf16 v[128:131], a[36:39], a[92:95], v[128:131]
 buffer_load_dwordx4 v2, s[8:11], s53 offen  lds
 v_mfma_f32_16x16x32_bf16 v[128:131], a[32:35], a[88:91], v[128:131]
 ds_read_b128 a[108:111], v5 offset:43008
 v_mfma_f32_16x16x32_bf16 v[132:135], a[40:43], a[88:91], v[132:135]
 v_mfma_f32_16x16x32_bf16 v[132:135], a[44:47], a[92:95], v[132:135]
 ds_read_b128 a[104:107], v4 offset:43008
 v_mfma_f32_16x16x32_bf16 v[140:143], a[44:47], a[84:87], v[140:143]
 s_add_u32 m0, s29, 24576
 v_mfma_f32_16x16x32_bf16 v[140:143], a[40:43], a[80:83], v[140:143]
 buffer_load_dwordx4 v1, s[4:7], s46 offen  lds
 v_mfma_f32_16x16x32_bf16 v[148:151], a[40:43], a[72:75], v[148:151]
 ds_read_b128 a[112:115], v4 offset:45056
 v_mfma_f32_16x16x32_bf16 v[148:151], a[44:47], a[76:79], v[148:151]
 v_mfma_f32_16x16x32_bf16 v[156:159], a[44:47], a[68:71], v[156:159]
 ds_read_b128 a[116:119], v5 offset:45056
 v_mfma_f32_16x16x32_bf16 v[156:159], a[40:43], a[64:67], v[156:159]
 s_add_u32 m0, s29, 94208
 v_mfma_f32_16x16x32_bf16 v[184:187], a[48:51], a[64:67], v[184:187]
 buffer_load_dwordx4 v2, s[8:11], s54 offen  lds
 v_mfma_f32_16x16x32_bf16 v[184:187], a[52:55], a[68:71], v[184:187]
 ds_read_b128 a[124:127], v5 offset:47104
 v_mfma_f32_16x16x32_bf16 v[176:179], a[52:55], a[76:79], v[176:179]
 v_mfma_f32_16x16x32_bf16 v[176:179], a[48:51], a[72:75], v[176:179]
 ds_read_b128 a[120:123], v4 offset:47104
 v_mfma_f32_16x16x32_bf16 v[168:171], a[48:51], a[80:83], v[168:171]
 s_add_u32 m0, s29, 28672
 v_mfma_f32_16x16x32_bf16 v[168:171], a[52:55], a[84:87], v[168:171]
 buffer_load_dwordx4 v1, s[4:7], s47 offen  lds
 v_mfma_f32_16x16x32_bf16 v[160:163], a[52:55], a[92:95], v[160:163]
 v_add_u32 v1, 128, v1
 v_add_u32 v2, 0x80000, v2
 v_mfma_f32_16x16x32_bf16 v[160:163], a[48:51], a[88:91], v[160:163]
 ds_read_b64_tr_b16 a[8:9], v7 offset:32768
 v_mfma_f32_16x16x32_bf16 v[164:167], a[56:59], a[88:91], v[164:167]
 buffer_load_dword a243, v14, s[36:39], s56 offen
 v_mfma_f32_16x16x32_bf16 v[164:167], a[60:63], a[92:95], v[164:167]
 s_add_u32 s56, s56, s30
 ds_read_b64_tr_b16 a[10:11], v7 offset:36864
 v_mfma_f32_16x16x32_bf16 v[172:175], a[60:63], a[84:87], v[172:175]
 ds_read_b64_tr_b16 a[12:13], v7 offset:49152
 v_mfma_f32_16x16x32_bf16 v[172:175], a[56:59], a[80:83], v[172:175]
 ds_read_b64_tr_b16 a[14:15], v7 offset:53248
 v_mfma_f32_16x16x32_bf16 v[180:183], a[56:59], a[72:75], v[180:183]
 ds_read_b64_tr_b16 a[16:17], v8 offset:32768
 v_mfma_f32_16x16x32_bf16 v[180:183], a[60:63], a[76:79], v[180:183]
 ds_read_b64_tr_b16 a[18:19], v8 offset:36864
 v_mfma_f32_16x16x32_bf16 v[188:191], a[60:63], a[68:71], v[188:191]
 ds_read_b64_tr_b16 a[20:21], v8 offset:49152
 v_mfma_f32_16x16x32_bf16 v[188:191], a[56:59], a[64:67], v[188:191]
 s_waitcnt lgkmcnt(8)
 ds_read_b64_tr_b16 a[22:23], v8 offset:53248
L_kloop_mid:
 v_mfma_f32_16x16x32_bf16 a[232:235], a[0:3], a[96:99], a[232:235]
 ds_read_b64_tr_b16 a[24:25], v9 offset:32768
 v_mfma_f32_16x16x32_bf16 a[232:235], a[4:7], a[100:103], a[232:235]
 ds_read_b64_tr_b16 a[26:27], v9 offset:36864
 v_mfma_f32_16x16x32_bf16 a[224:227], a[4:7], a[108:111], a[224:227]
 ds_read_b64_tr_b16 a[28:29], v9 offset:49152
 v_mfma_f32_16x16x32_bf16 a[224:227], a[0:3], a[104:107], a[224:227]
 ds_read_b64_tr_b16 a[30:31], v9 offset:53248
 v_mfma_f32_16x16x32_bf16 v[24:27], a[0:3], a[112:115], v[24:27]
 ds_read_b128 a[64:67], v4 offset:32768
 v_mfma_f32_16x16x32_bf16 v[24:27], a[4:7], a[116:119], v[24:27]
 v_mfma_f32_16x16x32_bf16 v[16:19], a[4:7], a[124:127], v[16:19]
 s_waitcnt lgkmcnt(8)
 ds_read_b128 a[68:71], v5 offset:32768
 v_mfma_f32_16x16x32_bf16 v[16:19], a[0:3], a[120:123], v[16:19]
 v_mfma_f32_16x16x32_bf16 v[20:23], a[8:11], a[120:123], v[20:23]
 ds_read_b128 a[76:79], v5 offset:34816
 v_mfma_f32_16x16x32_bf16 v[20:23], a[12:15], a[124:127], v[20:23]
 v_mfma_f32_16x16x32_bf16 v[28:31], a[12:15], a[116:119], v[28:31]
 ds_read_b128 a[72:75], v4 offset:34816
 v_mfma_f32_16x16x32_bf16 v[28:31], a[8:11], a[112:115], v[28:31]
 v_mfma_f32_16x16x32_bf16 a[228:231], a[8:11], a[104:107], a[228:231]
 ds_read_b128 a[80:83], v4 offset:36864
 v_mfma_f32_16x16x32_bf16 a[228:231], a[12:15], a[108:111], a[228:231]
 v_mfma_f32_16x16x32_bf16 a[236:239], a[12:15], a[100:103], a[236:239]
 ds_read_b128 a[84:87], v5 offset:36864
 v_mfma_f32_16x16x32_bf16 a[236:239], a[8:11], a[96:99], a[236:239]
 s_waitcnt lgkmcnt(8)
 v_mfma_f32_16x16x32_bf16 v[56:59], a[16:19], a[96:99], v[56:59]
 ds_read_b128 a[92:95], v5 offset:38912
 v_mfma_f32_16x16x32_bf16 v[56:59], a[20:23], a[100:103], v[56:59]
 v_mfma_f32_16x16x32_bf16 v[48:51], a[20:23], a[108:111], v[48:51]
 ds_read_b128 a[88:91], v4 offset:38912
 v_mfma_f32_16x16x32_bf16 v[48:51], a[16:19], a[104:107], v[48:51]
 v_mfma_f32_16x16x32_bf16 v[40:43], a[16:19], a[112:115], v[40:43]
 ds_read_b64_tr_b16 a[32:33], v10 offset:32768
 v_mfma_f32_16x16x32_bf16 v[40:43], a[20:23], a[116:119], v[40:43]
 ds_read_b64_tr_b16 a[34:35], v10 offset:36864
 v_mfma_f32_16x16x32_bf16 v[32:35], a[20:23], a[124:127], v[32:35]
 ds_read_b64_tr_b16 a[36:37], v10 offset:49152
 v_mfma_f32_16x16x32_bf16 v[32:35], a[16:19], a[120:123], v[32:35]
 ds_read_b64_tr_b16 a[38:39], v10 offset:53248
 v_mfma_f32_16x16x32_bf16 v[36:39], a[24:27], a[120:123], v[36:39]
 s_waitcnt lgkmcnt(8)
 ds_read_b64_tr_b16 a[40:41], v11 offset:32768
 v_mfma_f32_16x16x32_bf16 v[36:39], a[28:31], a[124:127], v[36:39]
 ds_read_b64_tr_b16 a[42:43], v11 offset:36864
 v_mfma_f32_16x16x32_bf16 v[44:47], a[28:31], a[116:119], v[44:47]
 ds_read_b64_tr_b16 a[44:45], v11 offset:49152
 v_mfma_f32_16x16x32_bf16 v[44:47], a[24:27], a[112:115], v[44:47]
 ds_read_b64_tr_b16 a[46:47], v11 offset:53248
 v_mfma_f32_16x16x32_bf16 v[52:55], a[24:27], a[104:107], v[52:55]
 ds_read_b64_tr_b16 a[48:49], v12 offset:32768
 v_mfma_f32_16x16x32_bf16 v[52:55], a[28:31], a[108:111], v[52:55]
 ds_read_b64_tr_b16 a[50:51], v12 offset:36864
 v_mfma_f32_16x16x32_bf16 v[60:63], a[28:31], a[100:103], v[60:63]
 ds_read_b64_tr_b16 a[52:53], v12 offset:49152
 v_mfma_f32_16x16x32_bf16 v[60:63], a[24:27], a[96:99], v[60:63]
 ds_read_b64_tr_b16 a[54:55], v12 offset:53248
 v_mfma_f32_16x16x32_bf16 v[88:91], a[0:3], a[64:67], v[88:91]
 ds_read_b64_tr_b16 a[56:57], v13 offset:32768
 v_mfma_f32_16x16x32_bf16 v[88:91], a[4:7], a[68:71], v[88:91]
 ds_read_b64_tr_b16 a[58:59], v13 offset:36864
 v_mfma_f32_16x16x32_bf16 v[80:83], a[4:7], a[76:79], v[80:83]
 ds_read_b64_tr_b16 a[60:61], v13 offset:49152
 v_mfma_f32_16x16x32_bf16 v[80:83], a[0:3], a[72:75], v[80:83]
 s_waitcnt lgkmcnt(8)
 ds_read_b64_tr_b16 a[62:63], v13 offset:53248
 v_mfma_f32_16x16x32_bf16 v[72:75], a[0:3], a[80:83], v[72:75]
 v_mfma_f32_16x16x32_bf16 v[72:75], a[4:7], a[84:87], v[72:75]
 v_mfma_f32_16x16x32_bf16 v[64:67], a[4:7], a[92:95], v[64:67]
 v_mfma_f32_16x16x32_bf16 v[64:67], a[0:3], a[88:91], v[64:67]
 s_waitcnt lgkmcnt(0)
 v_mfma_f32_16x16x32_bf16 v[68:71], a[8:11], a[88:91], v[68:71]
 s_barrier
 v_mfma_f32_16x16x32_bf16 v[68:71], a[12:15], a[92:95], v[68:71]
 s_add_u32 m0, s29, 98304
 v_mfma_f32_16x16x32_bf16 v[76:79], a[12:15], a[84:87], v[76:79]
 buffer_load_dwordx4 v2, s[8:11], 0 offen  lds
 v_mfma_f32_16x16x32_bf16 v[76:79], a[8:11], a[80:83], v[76:79]
 v_mfma_f32_16x16x32_bf16 v[84:87], a[8:11], a[72:75], v[84:87]
 v_mfma_f32_16x16x32_bf16 v[84:87], a[12:15], a[76:79], v[84:87]
 v_mfma_f32_16x16x32_bf16 v[92:95], a[12:15], a[68:71], v[92:95]
 s_add_u32 m0, s29, 32768
 v_mfma_f32_16x16x32_bf16 v[92:95], a[8:11], a[64:67], v[92:95]
 buffer_load_dwordx4 v1, s[4:7], 0 offen  lds
 v_mfma_f32_16x16x32_bf16 v[120:123], a[16:19], a[64:67], v[120:123]
 v_mfma_f32_16x16x32_bf16 v[120:123], a[20:23], a[68:71], v[120:123]
 v_mfma_f32_16x16x32_bf16 v[112:115], a[20:23], a[76:79], v[112:115]
 v_mfma_f32_16x16x32_bf16 v[112:115], a[16:19], a[72:75], v[112:115]
 s_add_u32 m0, s29, 102400
 v_mfma_f32_16x16x32_bf16 v[104:107], a[16:19], a[80:83], v[104:107]
 buffer_load_dwordx4 v2, s[8:11], s48 offen  lds
 v_mfma_f32_16x16x32_bf16 v[104:107], a[20:23], a[84:87], v[104:107]
 v_mfma_f32_16x16x32_bf16 v[96:99], a[20:23], a[92:95], v[96:99]
 v_mfma_f32_16x16x32_bf16 v[96:99], a[16:19], a[88:91], v[96:99]
 v_mfma_f32_16x16x32_bf16 v[100:103], a[24:27], a[88:91], v[100:103]
 s_add_u32 m0, s29, 36864
 v_mfma_f32_16x16x32_bf16 v[100:103], a[28:31], a[92:95], v[100:103]
 buffer_load_dwordx4 v1, s[4:7], s41 offen  lds
 v_mfma_f32_16x16x32_bf16 v[108:111], a[28:31], a[84:87], v[108:111]
 v_mfma_f32_16x16x32_bf16 v[108:111], a[24:27], a[80:83], v[108:111]
 v_mfma_f32_16x16x32_bf16 v[116:119], a[24:27], a[72:75], v[116:119]
 v_mfma_f32_16x16x32_bf16 v[116:119], a[28:31], a[76:79], v[116:119]
 s_add_u32 m0, s29, 106496
 v_mfma_f32_16x16x32_bf16 v[124:127], a[28:31], a[68:71], v[124:127]
 buffer_load_dwordx4 v2, s[8:11], s49 offen  lds
 v_mfma_f32_16x16x32_bf16 v[124:127], a[24:27], a[64:67], v[124:127]
 v_mfma_f32_16x16x32_bf16 v[152:155], a[32:35], a[64:67], v[152:155]
 v_mfma_f32_16x16x32_bf16 v[152:155], a[36:39], a[68:71], v[152:155]
 v_mfma_f32_16x16x32_bf16 v[144:147], a[36:39], a[76:79], v[144:147]
 s_add_u32 m0, s29, 40960
 v_mfma_f32_16x16x32_bf16 v[144:147], a[32:35], a[72:75], v[144:147]
 buffer_load_dwordx4 v1, s[4:7], s42 offen  lds
 v_mfma_f32_16x16x32_bf16 v[136:139], a[32:35], a[80:83], v[136:139]
 v_mfma_f32_16x16x32_bf16 v[136:139], a[36:39], a[84:87], v[136:139]
 v_mfma_f32_16x16x32_bf16 v[128:131], a[36:39], a[92:95], v[128:131]
 v_mfma_f32_16x16x32_bf16 v[128:131], a[32:35], a[88:91], v[128:131]
 s_add_u32 m0, s29, 110592
 v_mfma_f32_16x16x32_bf16 v[132:135], a[40:43], a[88:91], v[132:135]
 buffer_load_dwordx4 v2, s[8:11], s50 offen  lds
 v_mfma_f32_16x16x32_bf16 v[132:135], a[44:47], a[92:95], v[132:135]
 v_mfma_f32_16x16x32_bf16 v[140:143], a[44:47], a[84:87], v[140:143]
 v_mfma_f32_16x16x32_bf16 v[140:143], a[40:43], a[80:83], v[140:143]
 v_mfma_f32_16x16x32_bf16 v[148:151], a[40:43], a[72:75], v[148:151]
 s_add_u32 m0, s29, 45056
 v_mfma_f32_16x16x32_bf16 v[148:151], a[44:47], a[76:79], v[148:151]
 buffer_load_dwordx4 v1, s[4:7], s43 offen  lds
 v_mfma_f32_16x16x32_bf16 v[156:159], a[44:47], a[68:71], v[156:159]
 v_mfma_f32_16x16x32_bf16 v[156:159], a[40:43], a[64:67], v[156:159]
 v_mfma_f32_16x16x32_bf16 v[184:187], a[48:51], a[64:67], v[184:187]
 v_mfma_f32_16x16x32_bf16 v[184:187], a[52:55], a[68:71], v[184:187]
 s_add_u32 m0, s29, 114688
 v_mfma_f32_16x16x32_bf16 v[176:179], a[52:55], a[76:79], v[176:179]
 buffer_load_dwordx4 v2, s[8:11], s51 offen  lds
 v_mfma_f32_16x16x32_bf16 v[176:179], a[48:51], a[72:75], v[176:179]
 v_mfma_f32_16x16x32_bf16 v[168:171], a[48:51], a[80:83], v[168:171]
 v_mfma_f32_16x16x32_bf16 v[168:171], a[52:55], a[84:87], v[168:171]
 v_mfma_f32_16x16x32_bf16 v[160:163], a[52:55], a[92:95], v[160:163]
 s_add_u32 m0, s29, 49152
 v_mfma_f32_16x16x32_bf16 v[160:163], a[48:51], a[88:91], v[160:163]
 buffer_load_dwordx4 v1, s[4:7], s44 offen  lds
 v_mfma_f32_16x16x32_bf16 v[164:167], a[56:59], a[88:91], v[164:167]
 v_mfma_f32_16x16x32_bf16 v[164:167], a[60:63], a[92:95], v[164:167]
 v_mfma_f32_16x16x32_bf16 v[172:175], a[60:63], a[84:87], v[172:175]
 v_mfma_f32_16x16x32_bf16 v[172:175], a[56:59], a[80:83], v[172:175]
 s_add_u32 m0, s29, 118784
 v_mfma_f32_16x16x32_bf16 v[180:183], a[56:59], a[72:75], v[180:183]
 s_waitcnt vmcnt(11)
 buffer_load_dwordx4 v2, s[8:11], s52 offen  lds
 v_mfma_f32_16x16x32_bf16 v[180:183], a[60:63], a[76:79], v[180:183]
 s_barrier
 ds_read_b64_tr_b16 a[0:1], v6 offset:0
 v_mfma_f32_16x16x32_bf16 v[188:191], a[60:63], a[68:71], v[188:191]
 ds_read_b64_tr_b16 a[2:3], v6 offset:4096
 v_mfma_f32_16x16x32_bf16 v[188:191], a[56:59], a[64:67], v[188:191]
 ds_read_b128 a[64:67], v4 offset:0
 v_mfma_f32_16x16x32_bf16 v[216:219], a[32:35], a[96:99], v[216:219]
 s_add_u32 m0, s29, 53248
 v_mfma_f32_16x16x32_bf16 v[216:219], a[36:39], a[100:103], v[216:219]
 buffer_load_dwordx4 v1, s[4:7], s45 offen  lds
 v_mfma_f32_16x16x32_bf16 v[208:211], a[36:39], a[108:111], v[208:211]
 ds_read_b64_tr_b16 a[4:5], v6 offset:16384
 v_mfma_f32_16x16x32_bf16 v[208:211], a[32:35], a[104:107], v[208:211]
 ds_read_b64_tr_b16 a[6:7], v6 offset:20480
 v_mfma_f32_16x16x32_bf16 v[200:203], a[32:35], a[112:115], v[200:203]
 ds_read_b128 a[68:71], v5 offset:0
 v_mfma_f32_16x16x32_bf16 v[200:203], a[36:39], a[116:119], v[200:203]
 s_add_u32 m0, s29, 122880
 v_mfma_f32_16x16x32_bf16 v[192:195], a[36:39], a[124:127], v[192:195]
 buffer_load_dwordx4 v2, s[8:11], s53 offen  lds
 v_mfma_f32_16x16x32_bf16 v[192:195], a[32:35], a[120:123], v[192:195]
 ds_read_b128 a[76:79], v5 offset:2048
 v_mfma_f32_16x16x32_bf16 v[196:199], a[40:43], a[120:123], v[196:199]
 v_mfma_f32_16x16x32_bf16 v[196:199], a[44:47], a[124:127], v[196:199]
 ds_read_b128 a[72:75], v4 offset:2048
 v_mfma_f32_16x16x32_bf16 v[204:207], a[44:47], a[116:119], v[204:207]
 s_add_u32 m0, s29, 57344
 v_mfma_f32_16x16x32_bf16 v[204:207], a[40:43], a[112:115], v[204:207]
 buffer_load_dwordx4 v1, s[4:7], s46 offen  lds
 v_mfma_f32_16x16x32_bf16 v[212:215], a[40:43], a[104:107], v[212:215]
 ds_read_b128 a[80:83], v4 offset:4096
 v_mfma_f32_16x16x32_bf16 v[212:215], a[44:47], a[108:111], v[212:215]
 v_mfma_f32_16x16x32_bf16 v[220:223], a[44:47], a[100:103], v[220:223]
 ds_read_b128 a[84:87], v5 offset:4096
 v_mfma_f32_16x16x32_bf16 v[220:223], a[40:43], a[96:99], v[220:223]
 s_add_u32 m0, s29, 126976
 v_mfma_f32_16x16x32_bf16 v[248:251], a[48:51], a[96:99], v[248:251]
 buffer_load_dwordx4 v2, s[8:11], s54 offen  lds
 v_mfma_f32_16x16x32_bf16 v[248:251], a[52:55], a[100:103], v[248:251]
 ds_read_b128 a[92:95], v5 offset:6144
 v_mfma_f32_16x16x32_bf16 v[240:243], a[52:55], a[108:111], v[240:243]
 v_mfma_f32_16x16x32_bf16 v[240:243], a[48:51], a[104:107], v[240:243]
 ds_read_b128 a[88:91], v4 offset:6144
 v_mfma_f32_16x16x32_bf16 v[232:235], a[48:51], a[112:115], v[232:235]
 s_add_u32 m0, s29, 61440
 v_mfma_f32_16x16x32_bf16 v[232:235], a[52:55], a[116:119], v[232:235]
 buffer_load_dwordx4 v1, s[4:7], s47 offen  lds
 v_mfma_f32_16x16x32_bf16 v[224:227], a[52:55], a[124:127], v[224:227]
 v_add_u32 v1, 128, v1
 v_add_u32 v2, 0x80000, v2
 v_mfma_f32_16x16x32_bf16 v[224:227], a[48:51], a[120:123], v[224:227]
 ds_read_b64_tr_b16 a[8:9], v7 offset:0
 v_mfma_f32_16x16x32_bf16 v[228:231], a[56:59], a[120:123], v[228:231]
 buffer_load_dword a243, v14, s[36:39], s56 offen
 v_mfma_f32_16x16x32_bf16 v[228:231], a[60:63], a[124:127], v[228:231]
 s_add_u32 s56, s56, s30
 ds_read_b64_tr_b16 a[10:11], v7 offset:4096
 v_mfma_f32_16x16x32_bf16 v[236:239], a[60:63], a[116:119], v[236:239]
 ds_read_b64_tr_b16 a[12:13], v7 offset:16384
 v_mfma_f32_16x16x32_bf16 v[236:239], a[56:59], a[112:115], v[236:239]
 ds_read_b64_tr_b16 a[14:15], v7 offset:20480
 v_mfma_f32_16x16x32_bf16 v[244:247], a[56:59], a[104:107], v[244:247]
 ds_read_b64_tr_b16 a[16:17], v8 offset:0
 v_mfma_f32_16x16x32_bf16 v[244:247], a[60:63], a[108:111], v[244:247]
 s_add_u32 s61, s61, 1
 ds_read_b64_tr_b16 a[18:19], v8 offset:4096
 v_mfma_f32_16x16x32_bf16 v[252:255], a[60:63], a[100:103], v[252:255]
 s_cmp_lt_u32 s61, s55
 ds_read_b64_tr_b16 a[20:21], v8 offset:16384
 v_mfma_f32_16x16x32_bf16 v[252:255], a[56:59], a[96:99], v[252:255]
 s_waitcnt lgkmcnt(8)
 ds_read_b64_tr_b16 a[22:23], v8 offset:20480
 s_cbranch_scc1 L_kloop
 s_cmp_lt_u32 s61, 6
 s_cbranch_scc1 L_kloop_side
 v_mfma_f32_16x16x32_bf16 v[88:91], a[0:3], a[64:67], v[88:91]
 ds_read_b64_tr_b16 a[24:25], v9 offset:0
 v_accvgpr_read_b32 v15, a240
 v_mfma_f32_16x16x32_bf16 v[88:91], a[4:7], a[68:71], v[88:91]
 ds_read_b64_tr_b16 a[26:27], v9 offset:4096
 v_accvgpr_read_b32 v14, a242
 v_mfma_f32_16x16x32_bf16 v[80:83], a[4:7], a[76:79], v[80:83]
 s_waitcnt lgkmcnt(12)
 ds_read_b64_tr_b16 a[28:29], v9 offset:16384
 v_xor_b32 v3, 64, v14
 v_mfma_f32_16x16x32_bf16 v[80:83], a[0:3], a[72:75], v[80:83]
 ds_read_b64_tr_b16 a[30:31], v9 offset:20480
 v_mfma_f32_16x16x32_bf16 v[72:75], a[0:3], a[80:83], v[72:75]
 s_add_u32 m0, s33, 0x0
 ds_read_b128 a[96:99], v4 offset:8192
 v_mfma_f32_16x16x32_bf16 v[72:75], a[4:7], a[84:87], v[72:75]
 s_waitcnt lgkmcnt(11)
 v_mfma_f32_16x16x32_bf16 v[64:67], a[4:7], a[92:95], v[64:67]
 ds_read_b128 a[100:103], v5 offset:8192
 buffer_load_dwordx4 v15, s[20:23], 0 offen offset:0 lds
 v_mfma_f32_16x16x32_bf16 v[64:67], a[0:3], a[88:91], v[64:67]
 v_mfma_f32_16x16x32_bf16 v[68:71], a[8:11], a[88:91], v[68:71]
 s_waitcnt lgkmcnt(10)
 ds_read_b128 a[108:111], v5 offset:10240
 v_mfma_f32_16x16x32_bf16 v[68:71], a[12:15], a[92:95], v[68:71]
 s_add_u32 m0, s33, 0x80
 v_mfma_f32_16x16x32_bf16 v[76:79], a[12:15], a[84:87], v[76:79]
 ds_read_b128 a[104:107], v4 offset:10240
 buffer_load_dwordx4 v15, s[20:23], 0 offen offset:896 lds
 v_mfma_f32_16x16x32_bf16 v[76:79], a[8:11], a[80:83], v[76:79]
 v_mfma_f32_16x16x32_bf16 v[84:87], a[8:11], a[72:75], v[84:87]
 ds_read_b128 a[112:115], v4 offset:12288
 v_mfma_f32_16x16x32_bf16 v[84:87], a[12:15], a[76:79], v[84:87]
 s_add_u32 m0, s33, 0x800
 v_mfma_f32_16x16x32_bf16 v[92:95], a[12:15], a[68:71], v[92:95]
 ds_read_b128 a[116:119], v5 offset:12288
 buffer_load_dwordx4 v15, s[20:23], s57 offen offset:0 lds
 v_mfma_f32_16x16x32_bf16 v[92:95], a[8:11], a[64:67], v[92:95]
 s_waitcnt lgkmcnt(10)
 v_mfma_f32_16x16x32_bf16 v[120:123], a[16:19], a[64:67], v[120:123]
 ds_read_b128 a[124:127], v5 offset:14336
 v_mfma_f32_16x16x32_bf16 v[120:123], a[20:23], a[68:71], v[120:123]
 s_add_u32 m0, s33, 0x880
 v_mfma_f32_16x16x32_bf16 v[112:115], a[20:23], a[76:79], v[112:115]
 ds_read_b128 a[120:123], v4 offset:14336
 buffer_load_dwordx4 v15, s[20:23], s57 offen offset:896 lds
 v_mfma_f32_16x16x32_bf16 v[112:115], a[16:19], a[72:75], v[112:115]
 v_mfma_f32_16x16x32_bf16 v[104:107], a[16:19], a[80:83], v[104:107]
 ds_read_b64_tr_b16 a[32:33], v10 offset:0
 v_mfma_f32_16x16x32_bf16 v[104:107], a[20:23], a[84:87], v[104:107]
 s_add_u32 m0, s33, 0xf80
 ds_read_b64_tr_b16 a[34:35], v10 offset:4096
 v_mfma_f32_16x16x32_bf16 v[96:99], a[20:23], a[92:95], v[96:99]
 ds_read_b64_tr_b16 a[36:37], v10 offset:16384
 buffer_load_dwordx4 v15, s[20:23], 0 offen offset:128 lds
 v_mfma_f32_16x16x32_bf16 v[96:99], a[16:19], a[88:91], v[96:99]
 s_waitcnt lgkmcnt(11)
 ds_read_b64_tr_b16 a[38:39], v10 offset:20480
 v_mfma_f32_16x16x32_bf16 v[100:103], a[24:27], a[88:91], v[100:103]
 ds_read_b64_tr_b16 a[40:41], v11 offset:0
 v_mfma_f32_16x16x32_bf16 v[100:103], a[28:31], a[92:95], v[100:103]
 s_add_u32 m0, s33, 0x1000
 ds_read_b64_tr_b16 a[42:43], v11 offset:4096
 v_mfma_f32_16x16x32_bf16 v[108:111], a[28:31], a[84:87], v[108:111]
 ds_read_b64_tr_b16 a[44:45], v11 offset:16384
 buffer_load_dwordx4 v15, s[20:23], 0 offen offset:1024 lds
 v_mfma_f32_16x16x32_bf16 v[108:111], a[24:27], a[80:83], v[108:111]
 ds_read_b64_tr_b16 a[46:47], v11 offset:20480
 v_mfma_f32_16x16x32_bf16 v[116:119], a[24:27], a[72:75], v[116:119]
 ds_read_b64_tr_b16 a[48:49], v12 offset:0
 v_mfma_f32_16x16x32_bf16 v[116:119], a[28:31], a[76:79], v[116:119]
 s_add_u32 m0, s33, 0x1780
 ds_read_b64_tr_b16 a[50:51], v12 offset:4096
 v_mfma_f32_16x16x32_bf16 v[124:127], a[28:31], a[68:71], v[124:127]
 ds_read_b64_tr_b16 a[52:53], v12 offset:16384
 buffer_load_dwordx4 v15, s[20:23], s57 offen offset:128 lds
 v_mfma_f32_16x16x32_bf16 v[124:127], a[24:27], a[64:67], v[124:127]
 s_waitcnt lgkmcnt(15)
 ds_read_b64_tr_b16 a[54:55], v12 offset:20480
 v_mfma_f32_16x16x32_bf16 a[232:235], a[0:3], a[96:99], a[232:235]
 ds_read_b64_tr_b16 a[56:57], v13 offset:0
 v_mfma_f32_16x16x32_bf16 a[232:235], a[4:7], a[100:103], a[232:235]
 s_add_u32 m0, s33, 0x1800
 ds_read_b64_tr_b16 a[58:59], v13 offset:4096
 v_mfma_f32_16x16x32_bf16 a[224:227], a[4:7], a[108:111], a[224:227]
 ds_read_b64_tr_b16 a[60:61], v13 offset:16384
 buffer_load_dwordx4 v15, s[20:23], s57 offen offset:1024 lds
 v_mfma_f32_16x16x32_bf16 a[224:227], a[0:3], a[104:107], a[224:227]
 s_waitcnt lgkmcnt(15)
 ds_read_b64_tr_b16 a[62:63], v13 offset:20480
 v_mfma_f32_16x16x32_bf16 v[24:27], a[0:3], a[112:115], v[24:27]
 v_mfma_f32_16x16x32_bf16 v[24:27], a[4:7], a[116:119], v[24:27]
 v_mfma_f32_16x16x32_bf16 v[16:19], a[4:7], a[124:127], v[16:19]
 v_mfma_f32_16x16x32_bf16 v[16:19], a[0:3], a[120:123], v[16:19]
 s_waitcnt lgkmcnt(0)
 v_mfma_f32_16x16x32_bf16 v[20:23], a[8:11], a[120:123], v[20:23]
 s_barrier
 v_mfma_f32_16x16x32_bf16 v[20:23], a[12:15], a[124:127], v[20:23]
 s_add_u32 m0, s29, 65536
 v_mfma_f32_16x16x32_bf16 v[28:31], a[12:15], a[116:119], v[28:31]
 buffer_load_dwordx4 v2, s[8:11], 0 offen  lds
 v_mfma_f32_16x16x32_bf16 v[28:31], a[8:11], a[112:115], v[28:31]
 v_mfma_f32_16x16x32_bf16 a[228:231], a[8:11], a[104:107], a[228:231]
 v_mfma_f32_16x16x32_bf16 a[228:231], a[12:15], a[108:111], a[228:231]
 v_mfma_f32_16x16x32_bf16 a[236:239], a[12:15], a[100:103], a[236:239]
 s_add_u32 m0, s29, 0
 v_mfma_f32_16x16x32_bf16 a[236:239], a[8:11], a[96:99], a[236:239]
 buffer_load_dwordx4 v1, s[4:7], 0 offen  lds
 v_mfma_f32_16x16x32_bf16 v[56:59], a[16:19], a[96:99], v[56:59]
 v_mfma_f32_16x16x32_bf16 v[56:59], a[20:23], a[100:103], v[56:59]
 v_mfma_f32_16x16x32_bf16 v[48:51], a[20:23], a[108:111], v[48:51]
 v_mfma_f32_16x16x32_bf16 v[48:51], a[16:19], a[104:107], v[48:51]
 s_add_u32 m0, s29, 69632
 v_mfma_f32_16x16x32_bf16 v[40:43], a[16:19], a[112:115], v[40:43]
 buffer_load_dwordx4 v2, s[8:11], s48 offen  lds
 v_mfma_f32_16x16x32_bf16 v[40:43], a[20:23], a[116:119], v[40:43]
 v_mfma_f32_16x16x32_bf16 v[32:35], a[20:23], a[124:127], v[32:35]
 v_mfma_f32_16x16x32_bf16 v[32:35], a[16:19], a[120:123], v[32:35]
 v_mfma_f32_16x16x32_bf16 v[36:39], a[24:27], a[120:123], v[36:39]
 s_add_u32 m0, s29, 4096
 v_mfma_f32_16x16x32_bf16 v[36:39], a[28:31], a[124:127], v[36:39]
 buffer_load_dwordx4 v1, s[4:7], s41 offen  lds
 v_mfma_f32_16x16x32_bf16 v[44:47], a[28:31], a[116:119], v[44:47]
 v_mfma_f32_16x16x32_bf16 v[44:47], a[24:27], a[112:115], v[44:47]
 v_mfma_f32_16x16x32_bf16 v[52:55], a[24:27], a[104:107], v[52:55]
 v_mfma_f32_16x16x32_bf16 v[52:55], a[28:31], a[108:111], v[52:55]
 s_add_u32 m0, s29, 73728
 v_mfma_f32_16x16x32_bf16 v[60:63], a[28:31], a[100:103], v[60:63]
 buffer_load_dwordx4 v2, s[8:11], s49 offen  lds
 v_mfma_f32_16x16x32_bf16 v[60:63], a[24:27], a[96:99], v[60:63]
 v_mfma_f32_16x16x32_bf16 v[216:219], a[32:35], a[96:99], v[216:219]
 v_mfma_f32_16x16x32_bf16 v[216:219], a[36:39], a[100:103], v[216:219]
 v_mfma_f32_16x16x32_bf16 v[208:211], a[36:39], a[108:111], v[208:211]
 s_add_u32 m0, s29, 8192
 v_mfma_f32_16x16x32_bf16 v[208:211], a[32:35], a[104:107], v[208:211]
 buffer_load_dwordx4 v1, s[4:7], s42 offen  lds
 v_mfma_f32_16x16x32_bf16 v[200:203], a[32:35], a[112:115], v[200:203]
 v_mfma_f32_16x16x32_bf16 v[200:203], a[36:39], a[116:119], v[200:203]
 v_mfma_f32_16x16x32_bf16 v[192:195], a[36:39], a[124:127], v[192:195]
 v_mfma_f32_16x16x32_bf16 v[192:195], a[32:35], a[120:123], v[192:195]
 s_add_u32 m0, s29, 77824
 v_mfma_f32_16x16x32_bf16 v[196:199], a[40:43], a[120:123], v[196:199]
 buffer_load_dwordx4 v2, s[8:11], s50 offen  lds
 v_mfma_f32_16x16x32_bf16 v[196:199], a[44:47], a[124:127], v[196:199]
 v_mfma_f32_16x16x32_bf16 v[204:207], a[44:47], a[116:119], v[204:207]
 v_mfma_f32_16x16x32_bf16 v[204:207], a[40:43], a[112:115], v[204:207]
 v_mfma_f32_16x16x32_bf16 v[212:215], a[40:43], a[104:107], v[212:215]
 s_add_u32 m0, s29, 12288
 v_mfma_f32_16x16x32_bf16 v[212:215], a[44:47], a[108:111], v[212:215]
 buffer_load_dwordx4 v1, s[4:7], s43 offen  lds
 v_mfma_f32_16x16x32_bf16 v[220:223], a[44:47], a[100:103], v[220:223]
 v_mfma_f32_16x16x32_bf16 v[220:223], a[40:43], a[96:99], v[220:223]
 v_mfma_f32_16x16x32_bf16 v[248:251], a[48:51], a[96:99], v[248:251]
 v_mfma_f32_16x16x32_bf16 v[248:251], a[52:55], a[100:103], v[248:251]
 s_add_u32 m0, s29, 81920
 v_mfma_f32_16x16x32_bf16 v[240:243], a[52:55], a[108:111], v[240:243]
 buffer_load_dwordx4 v2, s[8:11], s51 offen  lds
 v_mfma_f32_16x16x32_bf16 v[240:243], a[48:51], a[104:107], v[240:243]
 v_mfma_f32_16x16x32_bf16 v[232:235], a[48:51], a[112:115], v[232:235]
 v_mfma_f32_16x16x32_bf16 v[232:235], a[52:55], a[116:119], v[232:235]
 v_mfma_f32_16x16x32_bf16 v[224:227], a[52:55], a[124:127], v[224:227]
 s_add_u32 m0, s29, 16384
 v_mfma_f32_16x16x32_bf16 v[224:227], a[48:51], a[120:123], v[224:227]
 buffer_load_dwordx4 v1, s[4:7], s44 offen  lds
 v_mfma_f32_16x16x32_bf16 v[228:231], a[56:59], a[120:123], v[228:231]
 v_mfma_f32_16x16x32_bf16 v[228:231], a[60:63], a[124:127], v[228:231]
 v_mfma_f32_16x16x32_bf16 v[236:239], a[60:63], a[116:119], v[236:239]
 v_mfma_f32_16x16x32_bf16 v[236:239], a[56:59], a[112:115], v[236:239]
 s_add_u32 m0, s29, 86016
 v_mfma_f32_16x16x32_bf16 v[244:247], a[56:59], a[104:107], v[244:247]
 s_waitcnt vmcnt(10)
 buffer_load_dwordx4 v2, s[8:11], s52 offen  lds
 v_mfma_f32_16x16x32_bf16 v[244:247], a[60:63], a[108:111], v[244:247]
 s_barrier
 ds_read_b64_tr_b16 a[0:1], v6 offset:32768
 v_mfma_f32_16x16x32_bf16 v[252:255], a[60:63], a[100:103], v[252:255]
 ds_read_b64_tr_b16 a[2:3], v6 offset:36864
 v_mfma_f32_16x16x32_bf16 v[252:255], a[56:59], a[96:99], v[252:255]
 ds_read_b128 a[96:99], v4 offset:40960
 v_mfma_f32_16x16x32_bf16 v[152:155], a[32:35], a[64:67], v[152:155]
 s_add_u32 m0, s29, 20480
 ds_read_b128 a[128:131], v14 offset:0
 v_mfma_f32_16x16x32_bf16 v[152:155], a[36:39], a[68:71], v[152:155]
 buffer_load_dwordx4 v1, s[4:7], s45 offen  lds
 v_mfma_f32_16x16x32_bf16 v[144:147], a[36:39], a[76:79], v[144:147]
 ds_read_b64_tr_b16 a[4:5], v6 offset:49152
 v_mfma_f32_16x16x32_bf16 v[144:147], a[32:35], a[72:75], v[144:147]
 ds_read_b64_tr_b16 a[6:7], v6 offset:53248
 v_mfma_f32_16x16x32_bf16 v[136:139], a[32:35], a[80:83], v[136:139]
 ds_read_b128 a[100:103], v5 offset:40960
 v_mfma_f32_16x16x32_bf16 v[136:139], a[36:39], a[84:87], v[136:139]
 s_add_u32 m0, s29, 90112
 ds_read_b128 a[136:139], v3 offset:0
 v_mfma_f32_16x16x32_bf16 v[128:131], a[36:39], a[92:95], v[128:131]
 buffer_load_dwordx4 v2, s[8:11], s53 offen  lds
 v_mfma_f32_16x16x32_bf16 v[128:131], a[32:35], a[88:91], v[128:131]
 ds_read_b128 a[108:111], v5 offset:43008
 v_mfma_f32_16x16x32_bf16 v[132:135], a[40:43], a[88:91], v[132:135]
 ds_read_b128 a[132:135], v14 offset:2048
 v_mfma_f32_16x16x32_bf16 v[132:135], a[44:47], a[92:95], v[132:135]
 ds_read_b128 a[104:107], v4 offset:43008
 v_mfma_f32_16x16x32_bf16 v[140:143], a[44:47], a[84:87], v[140:143]
 s_add_u32 m0, s29, 24576
 ds_read_b128 a[140:143], v3 offset:2048
 v_mfma_f32_16x16x32_bf16 v[140:143], a[40:43], a[80:83], v[140:143]
 buffer_load_dwordx4 v1, s[4:7], s46 offen  lds
 v_mfma_f32_16x16x32_bf16 v[148:151], a[40:43], a[72:75], v[148:151]
 ds_read_b128 a[112:115], v4 offset:45056
 v_mfma_f32_16x16x32_bf16 v[148:151], a[44:47], a[76:79], v[148:151]
 ds_read_b128 a[144:147], v14 offset:4096
 v_mfma_f32_16x16x32_bf16 v[156:159], a[44:47], a[68:71], v[156:159]
 ds_read_b128 a[116:119], v5 offset:45056
 v_mfma_f32_16x16x32_bf16 v[156:159], a[40:43], a[64:67], v[156:159]
 s_add_u32 m0, s29, 94208
 ds_read_b128 a[152:155], v3 offset:4096
 v_mfma_f32_16x16x32_bf16 v[184:187], a[48:51], a[64:67], v[184:187]
 buffer_load_dwordx4 v2, s[8:11], s54 offen  lds
 v_mfma_f32_16x16x32_bf16 v[184:187], a[52:55], a[68:71], v[184:187]
 ds_read_b128 a[124:127], v5 offset:47104
 v_mfma_f32_16x16x32_bf16 v[176:179], a[52:55], a[76:79], v[176:179]
 ds_read_b128 a[148:151], v14 offset:6144
 v_mfma_f32_16x16x32_bf16 v[176:179], a[48:51], a[72:75], v[176:179]
 ds_read_b128 a[120:123], v4 offset:47104
 v_mfma_f32_16x16x32_bf16 v[168:171], a[48:51], a[80:83], v[168:171]
 s_add_u32 m0, s29, 28672
 ds_read_b128 a[156:159], v3 offset:6144
 v_mfma_f32_16x16x32_bf16 v[168:171], a[52:55], a[84:87], v[168:171]
 buffer_load_dwordx4 v1, s[4:7], s47 offen  lds
 v_mfma_f32_16x16x32_bf16 v[160:163], a[52:55], a[92:95], v[160:163]
 v_add_u32 v1, 128, v1
 v_add_u32 v2, 0x80000, v2
 v_mfma_f32_16x16x32_bf16 v[160:163], a[48:51], a[88:91], v[160:163]
 ds_read_b64_tr_b16 a[8:9], v7 offset:32768
 v_mfma_f32_16x16x32_bf16 v[164:167], a[56:59], a[88:91], v[164:167]
 v_mfma_f32_16x16x32_bf16 v[164:167], a[60:63], a[92:95], v[164:167]
 ds_read_b64_tr_b16 a[10:11], v7 offset:36864
 v_mfma_f32_16x16x32_bf16 v[172:175], a[60:63], a[84:87], v[172:175]
 ds_read_b64_tr_b16 a[12:13], v7 offset:49152
 v_mfma_f32_16x16x32_bf16 v[172:175], a[56:59], a[80:83], v[172:175]
 ds_read_b64_tr_b16 a[14:15], v7 offset:53248
 v_mfma_f32_16x16x32_bf16 v[180:183], a[56:59], a[72:75], v[180:183]
 ds_read_b64_tr_b16 a[16:17], v8 offset:32768
 v_mfma_f32_16x16x32_bf16 v[180:183], a[60:63], a[76:79], v[180:183]
 ds_read_b64_tr_b16 a[18:19], v8 offset:36864
 v_mfma_f32_16x16x32_bf16 v[188:191], a[60:63], a[68:71], v[188:191]
 ds_read_b64_tr_b16 a[20:21], v8 offset:49152
 v_mfma_f32_16x16x32_bf16 v[188:191], a[56:59], a[64:67], v[188:191]
 s_waitcnt lgkmcnt(15)
 ds_read_b64_tr_b16 a[22:23], v8 offset:53248
 v_mfma_f32_16x16x32_bf16 a[232:235], a[0:3], a[96:99], a[232:235]
 ds_read_b64_tr_b16 a[24:25], v9 offset:32768
 v_mfma_f32_16x16x32_bf16 a[232:235], a[4:7], a[100:103], a[232:235]
 s_add_u32 m0, s33, 0xffffff00
 ds_read_b64_tr_b16 a[26:27], v9 offset:36864
 v_mfma_f32_16x16x32_bf16 a[224:227], a[4:7], a[108:111], a[224:227]
 s_waitcnt lgkmcnt(10)
 ds_read_b64_tr_b16 a[28:29], v9 offset:49152
 v_mfma_f32_16x16x32_bf16 a[224:227], a[0:3], a[104:107], a[224:227]
 ds_read_b64_tr_b16 a[30:31], v9 offset:53248
 buffer_load_dwordx4 v15, s[20:23], 0 offen offset:256 lds
 v_mfma_f32_16x16x32_bf16 v[24:27], a[0:3], a[112:115], v[24:27]
 ds_read_b128 a[64:67], v4 offset:32768
 v_mfma_f32_16x16x32_bf16 v[24:27], a[4:7], a[116:119], v[24:27]
 v_mfma_f32_16x16x32_bf16 v[16:19], a[4:7], a[124:127], v[16:19]
 s_add_u32 m0, s33, 0xffffff80
 ds_read_b128 a[68:71], v5 offset:32768
 v_mfma_f32_16x16x32_bf16 v[16:19], a[0:3], a[120:123], v[16:19]
 s_waitcnt lgkmcnt(10)
 buffer_load_dwordx4 v15, s[20:23], 0 offen offset:1152 lds
 v_mfma_f32_16x16x32_bf16 v[20:23], a[8:11], a[120:123], v[20:23]
 ds_read_b128 a[76:79], v5 offset:34816
 v_mfma_f32_16x16x32_bf16 v[20:23], a[12:15], a[124:127], v[20:23]
 v_mfma_f32_16x16x32_bf16 v[28:31], a[12:15], a[116:119], v[28:31]
 s_add_u32 m0, s33, 0x700
 ds_read_b128 a[72:75], v4 offset:34816
 v_mfma_f32_16x16x32_bf16 v[28:31], a[8:11], a[112:115], v[28:31]
 buffer_load_dwordx4 v15, s[20:23], s57 offen offset:256 lds
 v_mfma_f32_16x16x32_bf16 a[228:231], a[8:11], a[104:107], a[228:231]
 ds_read_b128 a[80:83], v4 offset:36864
 v_mfma_f32_16x16x32_bf16 a[228:231], a[12:15], a[108:111], a[228:231]
 v_mfma_f32_16x16x32_bf16 a[236:239], a[12:15], a[100:103], a[236:239]
 s_add_u32 m0, s33, 0x780
 ds_read_b128 a[84:87], v5 offset:36864
 v_mfma_f32_16x16x32_bf16 a[236:239], a[8:11], a[96:99], a[236:239]
 s_waitcnt lgkmcnt(10)
 buffer_load_dwordx4 v15, s[20:23], s57 offen offset:1152 lds
 v_mfma_f32_16x16x32_bf16 v[56:59], a[16:19], a[96:99], v[56:59]
 ds_read_b128 a[92:95], v5 offset:38912
 v_mfma_f32_16x16x32_bf16 v[56:59], a[20:23], a[100:103], v[56:59]
 v_mfma_f32_16x16x32_bf16 v[48:51], a[20:23], a[108:111], v[48:51]
 s_add_u32 m0, s33, 0xe80
 ds_read_b128 a[88:91], v4 offset:38912
 v_mfma_f32_16x16x32_bf16 v[48:51], a[16:19], a[104:107], v[48:51]
 buffer_load_dwordx4 v15, s[20:23], 0 offen offset:384 lds
 v_mfma_f32_16x16x32_bf16 v[40:43], a[16:19], a[112:115], v[40:43]
 ds_read_b64_tr_b16 a[32:33], v10 offset:32768
 v_mfma_f32_16x16x32_bf16 v[40:43], a[20:23], a[116:119], v[40:43]
 ds_read_b64_tr_b16 a[34:35], v10 offset:36864
 v_mfma_f32_16x16x32_bf16 v[32:35], a[20:23], a[124:127], v[32:35]
 s_add_u32 m0, s33, 0xf00
 ds_read_b64_tr_b16 a[36:37], v10 offset:49152
 v_mfma_f32_16x16x32_bf16 v[32:35], a[16:19], a[120:123], v[32:35]
 s_waitcnt lgkmcnt(11)
 ds_read_b64_tr_b16 a[38:39], v10 offset:53248
 buffer_load_dwordx4 v15, s[20:23], 0 offen offset:1280 lds
 v_mfma_f32_16x16x32_bf16 v[36:39], a[24:27], a[120:123], v[36:39]
 ds_read_b64_tr_b16 a[40:41], v11 offset:32768
 v_mfma_f32_16x16x32_bf16 v[36:39], a[28:31], a[124:127], v[36:39]
 ds_read_b64_tr_b16 a[42:43], v11 offset:36864
 v_mfma_f32_16x16x32_bf16 v[44:47], a[28:31], a[116:119], v[44:47]
 s_add_u32 m0, s33, 0x1680
 ds_read_b64_tr_b16 a[44:45], v11 offset:49152
 v_mfma_f32_16x16x32_bf16 v[44:47], a[24:27], a[112:115], v[44:47]
 ds_read_b64_tr_b16 a[46:47], v11 offset:53248
 buffer_load_dwordx4 v15, s[20:23], s57 offen offset:384 lds
 v_mfma_f32_16x16x32_bf16 v[52:55], a[24:27], a[104:107], v[52:55]
 ds_read_b64_tr_b16 a[48:49], v12 offset:32768
 v_mfma_f32_16x16x32_bf16 v[52:55], a[28:31], a[108:111], v[52:55]
 ds_read_b64_tr_b16 a[50:51], v12 offset:36864
 v_mfma_f32_16x16x32_bf16 v[60:63], a[28:31], a[100:103], v[60:63]
 s_add_u32 m0, s33, 0x1700
 ds_read_b64_tr_b16 a[52:53], v12 offset:49152
 v_mfma_f32_16x16x32_bf16 v[60:63], a[24:27], a[96:99], v[60:63]
 s_waitcnt lgkmcnt(15)
 ds_read_b64_tr_b16 a[54:55], v12 offset:53248
 buffer_load_dwordx4 v15, s[20:23], s57 offen offset:1280 lds
 v_mfma_f32_16x16x32_bf16 v[88:91], a[0:3], a[64:67], v[88:91]
 ds_read_b64_tr_b16 a[56:57], v13 offset:32768
 v_mfma_f32_16x16x32_bf16 v[88:91], a[4:7], a[68:71], v[88:91]
 ds_read_b64_tr_b16 a[58:59], v13 offset:36864
 v_mfma_f32_16x16x32_bf16 v[80:83], a[4:7], a[76:79], v[80:83]
 ds_read_b64_tr_b16 a[60:61], v13 offset:49152
 v_mfma_f32_16x16x32_bf16 v[80:83], a[0:3], a[72:75], v[80:83]
 s_waitcnt lgkmcnt(15)
 ds_read_b64_tr_b16 a[62:63], v13 offset:53248
 v_mfma_f32_16x16x32_bf16 v[72:75], a[0:3], a[80:83], v[72:75]
 v_mfma_f32_16x16x32_bf16 v[72:75], a[4:7], a[84:87], v[72:75]
 v_mfma_f32_16x16x32_bf16 v[64:67], a[4:7], a[92:95], v[64:67]
 v_mfma_f32_16x16x32_bf16 v[64:67], a[0:3], a[88:91], v[64:67]
 s_waitcnt lgkmcnt(0)
 v_mfma_f32_16x16x32_bf16 v[68:71], a[8:11], a[88:91], v[68:71]
 s_barrier
 v_mfma_f32_16x16x32_bf16 v[68:71], a[12:15], a[92:95], v[68:71]
 s_add_u32 m0, s29, 98304
 v_mfma_f32_16x16x32_bf16 v[76:79], a[12:15], a[84:87], v[76:79]
 buffer_load_dwordx4 v2, s[8:11], 0 offen  lds
 v_mfma_f32_16x16x32_bf16 v[76:79], a[8:11], a[80:83], v[76:79]
 v_mfma_f32_16x16x32_bf16 v[84:87], a[8:11], a[72:75], v[84:87]
 v_mfma_f32_16x16x32_bf16 v[84:87], a[12:15], a[76:79], v[84:87]
 v_mfma_f32_16x16x32_bf16 v[92:95], a[12:15], a[68:71], v[92:95]
 s_add_u32 m0, s29, 32768
 v_mfma_f32_16x16x32_bf16 v[92:95], a[8:11], a[64:67], v[92:95]
 buffer_load_dwordx4 v1, s[4:7], 0 offen  lds
 v_mfma_f32_16x16x32_bf16 v[120:123], a[16:19], a[64:67], v[120:123]
 v_mfma_f32_16x16x32_bf16 v[120:123], a[20:23], a[68:71], v[120:123]
 v_mfma_f32_16x16x32_bf16 v[112:115], a[20:23], a[76:79], v[112:115]
 v_mfma_f32_16x16x32_bf16 v[112:115], a[16:19], a[72:75], v[112:115]
 s_add_u32 m0, s29, 102400
 v_mfma_f32_16x16x32_bf16 v[104:107], a[16:19], a[80:83], v[104:107]
 buffer_load_dwordx4 v2, s[8:11], s48 offen  lds
 v_mfma_f32_16x16x32_bf16 v[104:107], a[20:23], a[84:87], v[104:107]
 v_mfma_f32_16x16x32_bf16 v[96:99], a[20:23], a[92:95], v[96:99]
 v_mfma_f32_16x16x32_bf16 v[96:99], a[16:19], a[88:91], v[96:99]
 v_mfma_f32_16x16x32_bf16 v[100:103], a[24:27], a[88:91], v[100:103]
 s_add_u32 m0, s29, 36864
 v_mfma_f32_16x16x32_bf16 v[100:103], a[28:31], a[92:95], v[100:103]
 buffer_load_dwordx4 v1, s[4:7], s41 offen  lds
 v_mfma_f32_16x16x32_bf16 v[108:111], a[28:31], a[84:87], v[108:111]
 v_mfma_f32_16x16x32_bf16 v[108:111], a[24:27], a[80:83], v[108:111]
 v_mfma_f32_16x16x32_bf16 v[116:119], a[24:27], a[72:75], v[116:119]
 v_mfma_f32_16x16x32_bf16 v[116:119], a[28:31], a[76:79], v[116:119]
 s_add_u32 m0, s29, 106496
 v_mfma_f32_16x16x32_bf16 v[124:127], a[28:31], a[68:71], v[124:127]
 buffer_load_dwordx4 v2, s[8:11], s49 offen  lds
 v_mfma_f32_16x16x32_bf16 v[124:127], a[24:27], a[64:67], v[124:127]
 v_mfma_f32_16x16x32_bf16 v[152:155], a[32:35], a[64:67], v[152:155]
 v_mfma_f32_16x16x32_bf16 v[152:155], a[36:39], a[68:71], v[152:155]
 v_mfma_f32_16x16x32_bf16 v[144:147], a[36:39], a[76:79], v[144:147]
 s_add_u32 m0, s29, 40960
 v_mfma_f32_16x16x32_bf16 v[144:147], a[32:35], a[72:75], v[144:147]
 buffer_load_dwordx4 v1, s[4:7], s42 offen  lds
 v_mfma_f32_16x16x32_bf16 v[136:139], a[32:35], a[80:83], v[136:139]
 v_mfma_f32_16x16x32_bf16 v[136:139], a[36:39], a[84:87], v[136:139]
 v_mfma_f32_16x16x32_bf16 v[128:131], a[36:39], a[92:95], v[128:131]
 v_mfma_f32_16x16x32_bf16 v[128:131], a[32:35], a[88:91], v[128:131]
 s_add_u32 m0, s29, 110592
 v_mfma_f32_16x16x32_bf16 v[132:135], a[40:43], a[88:91], v[132:135]
 buffer_load_dwordx4 v2, s[8:11], s50 offen  lds
 v_mfma_f32_16x16x32_bf16 v[132:135], a[44:47], a[92:95], v[132:135]
 v_mfma_f32_16x16x32_bf16 v[140:143], a[44:47], a[84:87], v[140:143]
 v_mfma_f32_16x16x32_bf16 v[140:143], a[40:43], a[80:83], v[140:143]
 v_mfma_f32_16x16x32_bf16 v[148:151], a[40:43], a[72:75], v[148:151]
 s_add_u32 m0, s29, 45056
 v_mfma_f32_16x16x32_bf16 v[148:151], a[44:47], a[76:79], v[148:151]
 buffer_load_dwordx4 v1, s[4:7], s43 offen  lds
 v_mfma_f32_16x16x32_bf16 v[156:159], a[44:47], a[68:71], v[156:159]
 v_mfma_f32_16x16x32_bf16 v[156:159], a[40:43], a[64:67], v[156:159]
 v_mfma_f32_16x16x32_bf16 v[184:187], a[48:51], a[64:67], v[184:187]
 v_mfma_f32_16x16x32_bf16 v[184:187], a[52:55], a[68:71], v[184:187]
 s_add_u32 m0, s29, 114688
 v_mfma_f32_16x16x32_bf16 v[176:179], a[52:55], a[76:79], v[176:179]
 buffer_load_dwordx4 v2, s[8:11], s51 offen  lds
 v_mfma_f32_16x16x32_bf16 v[176:179], a[48:51], a[72:75], v[176:179]
 v_mfma_f32_16x16x32_bf16 v[168:171], a[48:51], a[80:83], v[168:171]
 v_mfma_f32_16x16x32_bf16 v[168:171], a[52:55], a[84:87], v[168:171]
 v_mfma_f32_16x16x32_bf16 v[160:163], a[52:55], a[92:95], v[160:163]
 s_add_u32 m0, s29, 49152
 v_mfma_f32_16x16x32_bf16 v[160:163], a[48:51], a[88:91], v[160:163]
 buffer_load_dwordx4 v1, s[4:7], s44 offen  lds
 v_mfma_f32_16x16x32_bf16 v[164:167], a[56:59], a[88:91], v[164:167]
 v_mfma_f32_16x16x32_bf16 v[164:167], a[60:63], a[92:95], v[164:167]
 v_mfma_f32_16x16x32_bf16 v[172:175], a[60:63], a[84:87], v[172:175]
 v_mfma_f32_16x16x32_bf16 v[172:175], a[56:59], a[80:83], v[172:175]
 s_add_u32 m0, s29, 118784
 v_mfma_f32_16x16x32_bf16 v[180:183], a[56:59], a[72:75], v[180:183]
 s_waitcnt vmcnt(10)
 buffer_load_dwordx4 v2, s[8:11], s52 offen  lds
 v_mfma_f32_16x16x32_bf16 v[180:183], a[60:63], a[76:79], v[180:183]
 s_barrier
 ds_read_b64_tr_b16 a[0:1], v6 offset:0
 v_mfma_f32_16x16x32_bf16 v[188:191], a[60:63], a[68:71], v[188:191]
 ds_read_b64_tr_b16 a[2:3], v6 offset:4096
 v_mfma_f32_16x16x32_bf16 v[188:191], a[56:59], a[64:67], v[188:191]
 ds_read_b128 a[64:67], v4 offset:0
 v_mfma_f32_16x16x32_bf16 v[216:219], a[32:35], a[96:99], v[216:219]
 s_add_u32 m0, s29, 53248
 ds_read_b128 a[160:163], v14 offset:0
 v_mfma_f32_16x16x32_bf16 v[216:219], a[36:39], a[100:103], v[216:219]
 buffer_load_dwordx4 v1, s[4:7], s45 offen  lds
 v_mfma_f32_16x16x32_bf16 v[208:211], a[36:39], a[108:111], v[208:211]
 ds_read_b64_tr_b16 a[4:5], v6 offset:16384
 v_mfma_f32_16x16x32_bf16 v[208:211], a[32:35], a[104:107], v[208:211]
 ds_read_b64_tr_b16 a[6:7], v6 offset:20480
 v_mfma_f32_16x16x32_bf16 v[200:203], a[32:35], a[112:115], v[200:203]
 ds_read_b128 a[68:71], v5 offset:0
 v_mfma_f32_16x16x32_bf16 v[200:203], a[36:39], a[116:119], v[200:203]
 s_add_u32 m0, s29, 122880
 ds_read_b128 a[168:171], v3 offset:0
 v_mfma_f32_16x16x32_bf16 v[192:195], a[36:39], a[124:127], v[192:195]
 buffer_load_dwordx4 v2, s[8:11], s53 offen  lds
 v_mfma_f32_16x16x32_bf16 v[192:195], a[32:35], a[120:123], v[192:195]
 ds_read_b128 a[76:79], v5 offset:2048
 v_mfma_f32_16x16x32_bf16 v[196:199], a[40:43], a[120:123], v[196:199]
 ds_read_b128 a[164:167], v14 offset:2048
 v_mfma_f32_16x16x32_bf16 v[196:199], a[44:47], a[124:127], v[196:199]
 ds_read_b128 a[72:75], v4 offset:2048
 v_mfma_f32_16x16x32_bf16 v[204:207], a[44:47], a[116:119], v[204:207]
 s_add_u32 m0, s29, 57344
 ds_read_b128 a[172:175], v3 offset:2048
 v_mfma_f32_16x16x32_bf16 v[204:207], a[40:43], a[112:115], v[204:207]
 buffer_load_dwordx4 v1, s[4:7], s46 offen  lds
 v_mfma_f32_16x16x32_bf16 v[212:215], a[40:43], a[104:107], v[212:215]
 ds_read_b128 a[80:83], v4 offset:4096
 v_mfma_f32_16x16x32_bf16 v[212:215], a[44:47], a[108:111], v[212:215]
 ds_read_b128 a[176:179], v14 offset:4096
 v_mfma_f32_16x16x32_bf16 v[220:223], a[44:47], a[100:103], v[220:223]
 ds_read_b128 a[84:87], v5 offset:4096
 v_mfma_f32_16x16x32_bf16 v[220:223], a[40:43], a[96:99], v[220:223]
 s_add_u32 m0, s29, 126976
 ds_read_b128 a[184:187], v3 offset:4096
 v_mfma_f32_16x16x32_bf16 v[248:251], a[48:51], a[96:99], v[248:251]
 buffer_load_dwordx4 v2, s[8:11], s54 offen  lds
 v_mfma_f32_16x16x32_bf16 v[248:251], a[52:55], a[100:103], v[248:251]
 ds_read_b128 a[92:95], v5 offset:6144
 v_mfma_f32_16x16x32_bf16 v[240:243], a[52:55], a[108:111], v[240:243]
 ds_read_b128 a[180:183], v14 offset:6144
 v_mfma_f32_16x16x32_bf16 v[240:243], a[48:51], a[104:107], v[240:243]
 ds_read_b128 a[88:91], v4 offset:6144
 v_mfma_f32_16x16x32_bf16 v[232:235], a[48:51], a[112:115], v[232:235]
 s_add_u32 m0, s29, 61440
 ds_read_b128 a[188:191], v3 offset:6144
 v_mfma_f32_16x16x32_bf16 v[232:235], a[52:55], a[116:119], v[232:235]
 buffer_load_dwordx4 v1, s[4:7], s47 offen  lds
 v_mfma_f32_16x16x32_bf16 v[224:227], a[52:55], a[124:127], v[224:227]
 v_add_u32 v1, 128, v1
 v_add_u32 v2, 0x80000, v2
 v_mfma_f32_16x16x32_bf16 v[224:227], a[48:51], a[120:123], v[224:227]
 ds_read_b64_tr_b16 a[8:9], v7 offset:0
 v_mfma_f32_16x16x32_bf16 v[228:231], a[56:59], a[120:123], v[228:231]
 v_mfma_f32_16x16x32_bf16 v[228:231], a[60:63], a[124:127], v[228:231]
 ds_read_b64_tr_b16 a[10:11], v7 offset:4096
 v_mfma_f32_16x16x32_bf16 v[236:239], a[60:63], a[116:119], v[236:239]
 ds_read_b64_tr_b16 a[12:13], v7 offset:16384
 v_mfma_f32_16x16x32_bf16 v[236:239], a[56:59], a[112:115], v[236:239]
 ds_read_b64_tr_b16 a[14:15], v7 offset:20480
 v_mfma_f32_16x16x32_bf16 v[244:247], a[56:59], a[104:107], v[244:247]
 ds_read_b64_tr_b16 a[16:17], v8 offset:0
 v_mfma_f32_16x16x32_bf16 v[244:247], a[60:63], a[108:111], v[244:247]
 ds_read_b64_tr_b16 a[18:19], v8 offset:4096
 v_mfma_f32_16x16x32_bf16 v[252:255], a[60:63], a[100:103], v[252:255]
 ds_read_b64_tr_b16 a[20:21], v8 offset:16384
 v_mfma_f32_16x16x32_bf16 v[252:255], a[56:59], a[96:99], v[252:255]
 s_waitcnt lgkmcnt(15)
 ds_read_b64_tr_b16 a[22:23], v8 offset:20480
 v_mfma_f32_16x16x32_bf16 v[88:91], a[0:3], a[64:67], v[88:91]
 ds_read_b64_tr_b16 a[24:25], v9 offset:0
 v_lshlrev_b32 v1, 4, v0
 v_mfma_f32_16x16x32_bf16 v[88:91], a[4:7], a[68:71], v[88:91]
 s_add_u32 m0, s33, 0xfffffe00
 ds_read_b64_tr_b16 a[26:27], v9 offset:4096
 v_mfma_f32_16x16x32_bf16 v[80:83], a[4:7], a[76:79], v[80:83]
 s_waitcnt lgkmcnt(10)
 ds_read_b64_tr_b16 a[28:29], v9 offset:16384
 v_mfma_f32_16x16x32_bf16 v[80:83], a[0:3], a[72:75], v[80:83]
 ds_read_b64_tr_b16 a[30:31], v9 offset:20480
 buffer_load_dwordx4 v15, s[20:23], 0 offen offset:512 lds
 v_mfma_f32_16x16x32_bf16 v[72:75], a[0:3], a[80:83], v[72:75]
 ds_read_b128 a[96:99], v4 offset:8192
 v_mfma_f32_16x16x32_bf16 v[72:75], a[4:7], a[84:87], v[72:75]
 v_mfma_f32_16x16x32_bf16 v[64:67], a[4:7], a[92:95], v[64:67]
 s_add_u32 m0, s33, 0xfffffe80
 ds_read_b128 a[100:103], v5 offset:8192
 v_mfma_f32_16x16x32_bf16 v[64:67], a[0:3], a[88:91], v[64:67]
 s_waitcnt lgkmcnt(10)
 buffer_load_dwordx4 v15, s[20:23], 0 offen offset:1408 lds
 v_mfma_f32_16x16x32_bf16 v[68:71], a[8:11], a[88:91], v[68:71]
 ds_read_b128 a[108:111], v5 offset:10240
 v_mfma_f32_16x16x32_bf16 v[68:71], a[12:15], a[92:95], v[68:71]
 v_mfma_f32_16x16x32_bf16 v[76:79], a[12:15], a[84:87], v[76:79]
 s_add_u32 m0, s33, 0x600
 ds_read_b128 a[104:107], v4 offset:10240
 v_mfma_f32_16x16x32_bf16 v[76:79], a[8:11], a[80:83], v[76:79]
 buffer_load_dwordx4 v15, s[20:23], s57 offen offset:512 lds
 v_mfma_f32_16x16x32_bf16 v[84:87], a[8:11], a[72:75], v[84:87]
 ds_read_b128 a[112:115], v4 offset:12288
 v_mfma_f32_16x16x32_bf16 v[84:87], a[12:15], a[76:79], v[84:87]
 v_mfma_f32_16x16x32_bf16 v[92:95], a[12:15], a[68:71], v[92:95]
 s_add_u32 m0, s33, 0x680
 ds_read_b128 a[116:119], v5 offset:12288
 v_mfma_f32_16x16x32_bf16 v[92:95], a[8:11], a[64:67], v[92:95]
 s_waitcnt lgkmcnt(10)
 buffer_load_dwordx4 v15, s[20:23], s57 offen offset:1408 lds
 v_mfma_f32_16x16x32_bf16 v[120:123], a[16:19], a[64:67], v[120:123]
 ds_read_b128 a[124:127], v5 offset:14336
 v_mfma_f32_16x16x32_bf16 v[120:123], a[20:23], a[68:71], v[120:123]
 v_mfma_f32_16x16x32_bf16 v[112:115], a[20:23], a[76:79], v[112:115]
 s_add_u32 m0, s33, 0xd80
 ds_read_b128 a[120:123], v4 offset:14336
 v_mfma_f32_16x16x32_bf16 v[112:115], a[16:19], a[72:75], v[112:115]
 buffer_load_dwordx4 v15, s[20:23], 0 offen offset:640 lds
 v_mfma_f32_16x16x32_bf16 v[104:107], a[16:19], a[80:83], v[104:107]
 ds_read_b64_tr_b16 a[32:33], v10 offset:0
 v_mfma_f32_16x16x32_bf16 v[104:107], a[20:23], a[84:87], v[104:107]
 ds_read_b64_tr_b16 a[34:35], v10 offset:4096
 v_mfma_f32_16x16x32_bf16 v[96:99], a[20:23], a[92:95], v[96:99]
 s_add_u32 m0, s33, 0xe00
 ds_read_b64_tr_b16 a[36:37], v10 offset:16384
 v_mfma_f32_16x16x32_bf16 v[96:99], a[16:19], a[88:91], v[96:99]
 s_waitcnt lgkmcnt(11)
 ds_read_b64_tr_b16 a[38:39], v10 offset:20480
 buffer_load_dwordx4 v15, s[20:23], 0 offen offset:1536 lds
 v_mfma_f32_16x16x32_bf16 v[100:103], a[24:27], a[88:91], v[100:103]
 ds_read_b64_tr_b16 a[40:41], v11 offset:0
 v_mfma_f32_16x16x32_bf16 v[100:103], a[28:31], a[92:95], v[100:103]
 ds_read_b64_tr_b16 a[42:43], v11 offset:4096
 v_mfma_f32_16x16x32_bf16 v[108:111], a[28:31], a[84:87], v[108:111]
 s_add_u32 m0, s33, 0x1580
 ds_read_b64_tr_b16 a[44:45], v11 offset:16384
 v_mfma_f32_16x16x32_bf16 v[108:111], a[24:27], a[80:83], v[108:111]
 ds_read_b64_tr_b16 a[46:47], v11 offset:20480
 buffer_load_dwordx4 v15, s[20:23], s57 offen offset:640 lds
 v_mfma_f32_16x16x32_bf16 v[116:119], a[24:27], a[72:75], v[116:119]
 ds_read_b64_tr_b16 a[48:49], v12 offset:0
 v_mfma_f32_16x16x32_bf16 v[116:119], a[28:31], a[76:79], v[116:119]
 ds_read_b64_tr_b16 a[50:51], v12 offset:4096
 v_mfma_f32_16x16x32_bf16 v[124:127], a[28:31], a[68:71], v[124:127]
 s_add_u32 m0, s33, 0x1600
 ds_read_b64_tr_b16 a[52:53], v12 offset:16384
 v_mfma_f32_16x16x32_bf16 v[124:127], a[24:27], a[64:67], v[124:127]
 s_waitcnt lgkmcnt(15)
 ds_read_b64_tr_b16 a[54:55], v12 offset:20480
 buffer_load_dwordx4 v15, s[20:23], s57 offen offset:1536 lds
 v_mfma_f32_16x16x32_bf16 a[232:235], a[0:3], a[96:99], a[232:235]
 ds_read_b64_tr_b16 a[56:57], v13 offset:0
 v_mfma_f32_16x16x32_bf16 a[232:235], a[4:7], a[100:103], a[232:235]
 ds_read_b64_tr_b16 a[58:59], v13 offset:4096
 v_mfma_f32_16x16x32_bf16 a[224:227], a[4:7], a[108:111], a[224:227]
 ds_read_b64_tr_b16 a[60:61], v13 offset:16384
 v_mfma_f32_16x16x32_bf16 a[224:227], a[0:3], a[104:107], a[224:227]
 s_waitcnt lgkmcnt(15)
 ds_read_b64_tr_b16 a[62:63], v13 offset:20480
 v_mfma_f32_16x16x32_bf16 v[24:27], a[0:3], a[112:115], v[24:27]
 v_mfma_f32_16x16x32_bf16 v[24:27], a[4:7], a[116:119], v[24:27]
 v_mfma_f32_16x16x32_bf16 v[16:19], a[4:7], a[124:127], v[16:19]
 v_mfma_f32_16x16x32_bf16 v[16:19], a[0:3], a[120:123], v[16:19]
 s_waitcnt lgkmcnt(0)
 v_mfma_f32_16x16x32_bf16 v[20:23], a[8:11], a[120:123], v[20:23]
 s_barrier
 v_mfma_f32_16x16x32_bf16 v[20:23], a[12:15], a[124:127], v[20:23]
 s_add_u32 m0, s29, 0
 v_add_u32 v2, 0xff800000, v2
 v_mfma_f32_16x16x32_bf16 v[28:31], a[12:15], a[116:119], v[28:31]
 buffer_load_dwordx4 v2, s[16:19], 0 offen lds
 v_mfma_f32_16x16x32_bf16 v[28:31], a[8:11], a[112:115], v[28:31]
 v_mfma_f32_16x16x32_bf16 a[228:231], a[8:11], a[104:107], a[228:231]
 v_mfma_f32_16x16x32_bf16 a[228:231], a[12:15], a[108:111], a[228:231]
 v_mfma_f32_16x16x32_bf16 a[236:239], a[12:15], a[100:103], a[236:239]
 s_add_u32 m0, s29, 4096
 v_mfma_f32_16x16x32_bf16 a[236:239], a[8:11], a[96:99], a[236:239]
 buffer_load_dwordx4 v2, s[16:19], s48 offen lds
 v_mfma_f32_16x16x32_bf16 v[56:59], a[16:19], a[96:99], v[56:59]
 v_mfma_f32_16x16x32_bf16 v[56:59], a[20:23], a[100:103], v[56:59]
 v_mfma_f32_16x16x32_bf16 v[48:51], a[20:23], a[108:111], v[48:51]
 v_mfma_f32_16x16x32_bf16 v[48:51], a[16:19], a[104:107], v[48:51]
 s_add_u32 m0, s29, 8192
 v_mfma_f32_16x16x32_bf16 v[40:43], a[16:19], a[112:115], v[40:43]
 buffer_load_dwordx4 v2, s[16:19], s49 offen lds
 v_mfma_f32_16x16x32_bf16 v[40:43], a[20:23], a[116:119], v[40:43]
 v_mfma_f32_16x16x32_bf16 v[32:35], a[20:23], a[124:127], v[32:35]
 v_mfma_f32_16x16x32_bf16 v[32:35], a[16:19], a[120:123], v[32:35]
 v_mfma_f32_16x16x32_bf16 v[36:39], a[24:27], a[120:123], v[36:39]
 s_add_u32 m0, s29, 12288
 v_mfma_f32_16x16x32_bf16 v[36:39], a[28:31], a[124:127], v[36:39]
 buffer_load_dwordx4 v2, s[16:19], s50 offen lds
 v_mfma_f32_16x16x32_bf16 v[44:47], a[28:31], a[116:119], v[44:47]
 v_mfma_f32_16x16x32_bf16 v[44:47], a[24:27], a[112:115], v[44:47]
 v_mfma_f32_16x16x32_bf16 v[52:55], a[24:27], a[104:107], v[52:55]
 v_mfma_f32_16x16x32_bf16 v[52:55], a[28:31], a[108:111], v[52:55]
 s_add_u32 m0, s29, 16384
 v_mfma_f32_16x16x32_bf16 v[60:63], a[28:31], a[100:103], v[60:63]
 buffer_load_dwordx4 v2, s[16:19], s51 offen lds
 v_mfma_f32_16x16x32_bf16 v[60:63], a[24:27], a[96:99], v[60:63]
 v_mfma_f32_16x16x32_bf16 v[216:219], a[32:35], a[96:99], v[216:219]
 v_mfma_f32_16x16x32_bf16 v[216:219], a[36:39], a[100:103], v[216:219]
 v_mfma_f32_16x16x32_bf16 v[208:211], a[36:39], a[108:111], v[208:211]
 s_add_u32 m0, s29, 20480
 v_mfma_f32_16x16x32_bf16 v[208:211], a[32:35], a[104:107], v[208:211]
 buffer_load_dwordx4 v2, s[16:19], s52 offen lds
 v_mfma_f32_16x16x32_bf16 v[200:203], a[32:35], a[112:115], v[200:203]
 v_mfma_f32_16x16x32_bf16 v[200:203], a[36:39], a[116:119], v[200:203]
 v_mfma_f32_16x16x32_bf16 v[192:195], a[36:39], a[124:127], v[192:195]
 v_mfma_f32_16x16x32_bf16 v[192:195], a[32:35], a[120:123], v[192:195]
 s_add_u32 m0, s29, 24576
 v_mfma_f32_16x16x32_bf16 v[196:199], a[40:43], a[120:123], v[196:199]
 buffer_load_dwordx4 v2, s[16:19], s53 offen lds
 v_mfma_f32_16x16x32_bf16 v[196:199], a[44:47], a[124:127], v[196:199]
 v_mfma_f32_16x16x32_bf16 v[204:207], a[44:47], a[116:119], v[204:207]
 v_mfma_f32_16x16x32_bf16 v[204:207], a[40:43], a[112:115], v[204:207]
 v_mfma_f32_16x16x32_bf16 v[212:215], a[40:43], a[104:107], v[212:215]
 s_add_u32 m0, s29, 28672
 v_mfma_f32_16x16x32_bf16 v[212:215], a[44:47], a[108:111], v[212:215]
 buffer_load_dwordx4 v2, s[16:19], s54 offen lds
 v_mfma_f32_16x16x32_bf16 v[220:223], a[44:47], a[100:103], v[220:223]
 v_mfma_f32_16x16x32_bf16 v[220:223], a[40:43], a[96:99], v[220:223]
 v_mfma_f32_16x16x32_bf16 v[248:251], a[48:51], a[96:99], v[248:251]
 s_add_u32 m0, s29, 65536
 v_add_u32 v2, 0x80000, v2
 v_mfma_f32_16x16x32_bf16 v[248:251], a[52:55], a[100:103], v[248:251]
 buffer_load_dwordx4 v2, s[16:19], 0 offen lds
 v_mfma_f32_16x16x32_bf16 v[240:243], a[52:55], a[108:111], v[240:243]
 v_mfma_f32_16x16x32_bf16 v[240:243], a[48:51], a[104:107], v[240:243]
 v_mfma_f32_16x16x32_bf16 v[232:235], a[48:51], a[112:115], v[232:235]
 v_mfma_f32_16x16x32_bf16 v[232:235], a[52:55], a[116:119], v[232:235]
 s_add_u32 m0, s29, 69632
 v_mfma_f32_16x16x32_bf16 v[224:227], a[52:55], a[124:127], v[224:227]
 buffer_load_dwordx4 v2, s[16:19], s48 offen lds
 v_mfma_f32_16x16x32_bf16 v[224:227], a[48:51], a[120:123], v[224:227]
 v_mfma_f32_16x16x32_bf16 v[228:231], a[56:59], a[120:123], v[228:231]
 v_mfma_f32_16x16x32_bf16 v[228:231], a[60:63], a[124:127], v[228:231]
 v_mfma_f32_16x16x32_bf16 v[236:239], a[60:63], a[116:119], v[236:239]
 s_add_u32 m0, s29, 73728
 v_mfma_f32_16x16x32_bf16 v[236:239], a[56:59], a[112:115], v[236:239]
 buffer_load_dwordx4 v2, s[16:19], s49 offen lds
 v_mfma_f32_16x16x32_bf16 v[244:247], a[56:59], a[104:107], v[244:247]
 s_waitcnt vmcnt(11)
 v_mfma_f32_16x16x32_bf16 v[244:247], a[60:63], a[108:111], v[244:247]
 s_barrier
 ds_read_b64_tr_b16 a[0:1], v6 offset:32768
 v_mfma_f32_16x16x32_bf16 v[252:255], a[60:63], a[100:103], v[252:255]
 ds_read_b64_tr_b16 a[2:3], v6 offset:36864
 v_mfma_f32_16x16x32_bf16 v[252:255], a[56:59], a[96:99], v[252:255]
 s_add_u32 m0, s29, 77824
 ds_read_b128 a[96:99], v4 offset:40960
 v_mfma_f32_16x16x32_bf16 v[152:155], a[32:35], a[64:67], v[152:155]
 ds_read_b128 a[192:195], v14 offset:0
 buffer_load_dwordx4 v2, s[16:19], s50 offen lds
 v_mfma_f32_16x16x32_bf16 v[152:155], a[36:39], a[68:71], v[152:155]
 ds_read_b128 a[200:203], v3 offset:0
 v_mfma_f32_16x16x32_bf16 v[144:147], a[36:39], a[76:79], v[144:147]
 s_mov_b32 s56, s58
 ds_read_b64_tr_b16 a[4:5], v6 offset:49152
 v_mfma_f32_16x16x32_bf16 v[144:147], a[32:35], a[72:75], v[144:147]
 ds_read_b64_tr_b16 a[6:7], v6 offset:53248
 v_mfma_f32_16x16x32_bf16 v[136:139], a[32:35], a[80:83], v[136:139]
 s_add_u32 m0, s29, 81920
 ds_read_b128 a[100:103], v5 offset:40960
 v_mfma_f32_16x16x32_bf16 v[136:139], a[36:39], a[84:87], v[136:139]
 ds_read_b128 a[196:199], v14 offset:2048
 buffer_load_dwordx4 v2, s[16:19], s51 offen lds
 v_mfma_f32_16x16x32_bf16 v[128:131], a[36:39], a[92:95], v[128:131]
 ds_read_b128 a[204:207], v3 offset:2048
 v_mfma_f32_16x16x32_bf16 v[128:131], a[32:35], a[88:91], v[128:131]
 ds_read_b128 a[108:111], v5 offset:43008
 v_mfma_f32_16x16x32_bf16 v[132:135], a[40:43], a[88:91], v[132:135]
 ds_read_b128 a[208:211], v14 offset:4096
 v_mfma_f32_16x16x32_bf16 v[132:135], a[44:47], a[92:95], v[132:135]
 s_add_u32 m0, s29, 86016
 ds_read_b128 a[104:107], v4 offset:43008
 v_mfma_f32_16x16x32_bf16 v[140:143], a[44:47], a[84:87], v[140:143]
 ds_read_b128 a[216:219], v3 offset:4096
 buffer_load_dwordx4 v2, s[16:19], s52 offen lds
 v_mfma_f32_16x16x32_bf16 v[140:143], a[40:43], a[80:83], v[140:143]
 ds_read_b128 a[212:215], v14 offset:6144
 v_mfma_f32_16x16x32_bf16 v[148:151], a[40:43], a[72:75], v[148:151]
 s_cmp_lt_u32 s25, 4
 s_cselect_b32 s1, 2.0, s92
 ds_read_b128 a[112:115], v4 offset:45056
 v_mfma_f32_16x16x32_bf16 v[148:151], a[44:47], a[76:79], v[148:151]
 ds_read_b128 a[220:223], v3 offset:6144
 v_mfma_f32_16x16x32_bf16 v[156:159], a[44:47], a[68:71], v[156:159]
 s_add_u32 m0, s29, 90112
 ds_read_b128 a[116:119], v5 offset:45056
 v_mfma_f32_16x16x32_bf16 v[156:159], a[40:43], a[64:67], v[156:159]
 buffer_load_dwordx4 v2, s[16:19], s53 offen lds
 v_mfma_f32_16x16x32_bf16 v[184:187], a[48:51], a[64:67], v[184:187]
 v_mfma_f32_16x16x32_bf16 v[184:187], a[52:55], a[68:71], v[184:187]
 ds_read_b128 a[124:127], v5 offset:47104
 v_mfma_f32_16x16x32_bf16 v[176:179], a[52:55], a[76:79], v[176:179]
 v_mfma_f32_16x16x32_bf16 v[176:179], a[48:51], a[72:75], v[176:179]
 s_add_u32 m0, s29, 94208
 ds_read_b128 a[120:123], v4 offset:47104
 v_mfma_f32_16x16x32_bf16 v[168:171], a[48:51], a[80:83], v[168:171]
 buffer_load_dwordx4 v2, s[16:19], s54 offen lds
 v_mfma_f32_16x16x32_bf16 v[168:171], a[52:55], a[84:87], v[168:171]
 v_mfma_f32_16x16x32_bf16 v[160:163], a[52:55], a[92:95], v[160:163]
 v_mfma_f32_16x16x32_bf16 v[160:163], a[48:51], a[88:91], v[160:163]
 ds_read_b64_tr_b16 a[8:9], v7 offset:32768
 v_mfma_f32_16x16x32_bf16 v[164:167], a[56:59], a[88:91], v[164:167]
 v_mfma_f32_16x16x32_bf16 v[164:167], a[60:63], a[92:95], v[164:167]
 ds_read_b64_tr_b16 a[10:11], v7 offset:36864
 v_mfma_f32_16x16x32_bf16 v[172:175], a[60:63], a[84:87], v[172:175]
 ds_read_b64_tr_b16 a[12:13], v7 offset:49152
 v_mfma_f32_16x16x32_bf16 v[172:175], a[56:59], a[80:83], v[172:175]
 ds_read_b64_tr_b16 a[14:15], v7 offset:53248
 v_mfma_f32_16x16x32_bf16 v[180:183], a[56:59], a[72:75], v[180:183]
 ds_read_b64_tr_b16 a[16:17], v8 offset:32768
 v_mfma_f32_16x16x32_bf16 v[180:183], a[60:63], a[76:79], v[180:183]
 ds_read_b64_tr_b16 a[18:19], v8 offset:36864
 v_mfma_f32_16x16x32_bf16 v[188:191], a[60:63], a[68:71], v[188:191]
 ds_read_b64_tr_b16 a[20:21], v8 offset:49152
 v_mfma_f32_16x16x32_bf16 v[188:191], a[56:59], a[64:67], v[188:191]
 s_waitcnt lgkmcnt(15)
 ds_read_b64_tr_b16 a[22:23], v8 offset:53248
 s_cmp_ge_u32 s25, 4
 s_cbranch_scc1 L_late0
 v_mfma_f32_16x16x32_bf16 a[232:235], a[0:3], a[96:99], a[232:235]
 ds_read_b64_tr_b16 a[24:25], v9 offset:32768
 v_mfma_f32_16x16x32_bf16 a[232:235], a[4:7], a[100:103], a[232:235]
 s_add_u32 m0, s33, 0xfffffd00
 ds_read_b64_tr_b16 a[26:27], v9 offset:36864
 v_mfma_f32_16x16x32_bf16 a[224:227], a[4:7], a[108:111], a[224:227]
 s_waitcnt lgkmcnt(13)
 ds_read_b64_tr_b16 a[28:29], v9 offset:49152
 v_mfma_f32_16x16x32_bf16 a[224:227], a[0:3], a[104:107], a[224:227]
 ds_read_b64_tr_b16 a[30:31], v9 offset:53248
 buffer_load_dwordx4 v15, s[20:23], 0 offen offset:768 lds
 v_mfma_f32_16x16x32_bf16 v[24:27], a[0:3], a[112:115], v[24:27]
 s_waitcnt lgkmcnt(12)
 ds_read_b128 a[64:67], v4 offset:32768
 v_mfma_f32_16x16x32_bf16 v[24:27], a[4:7], a[116:119], v[24:27]
 v_mfma_f32_16x16x32_bf16 v[16:19], a[4:7], a[124:127], v[16:19]
 s_add_u32 m0, s33, 0xfffffd80
 ds_read_b128 a[68:71], v5 offset:32768
 v_mfma_f32_16x16x32_bf16 v[16:19], a[0:3], a[120:123], v[16:19]
 s_waitcnt lgkmcnt(10)
 buffer_load_dwordx4 v15, s[20:23], 0 offen offset:1664 lds
 v_mfma_f32_16x16x32_bf16 v[20:23], a[8:11], a[120:123], v[20:23]
 ds_read_b128 a[76:79], v5 offset:34816
 v_mfma_f32_16x16x32_bf16 v[20:23], a[12:15], a[124:127], v[20:23]
 v_mfma_f32_16x16x32_bf16 v[28:31], a[12:15], a[116:119], v[28:31]
 s_add_u32 m0, s33, 0x500
 ds_read_b128 a[72:75], v4 offset:34816
 v_mfma_f32_16x16x32_bf16 v[28:31], a[8:11], a[112:115], v[28:31]
 buffer_load_dwordx4 v15, s[20:23], s57 offen offset:768 lds
 v_mfma_f32_16x16x32_bf16 a[228:231], a[8:11], a[104:107], a[228:231]
 ds_read_b128 a[80:83], v4 offset:36864
 v_mfma_f32_16x16x32_bf16 a[228:231], a[12:15], a[108:111], a[228:231]
 v_mfma_f32_16x16x32_bf16 a[236:239], a[12:15], a[100:103], a[236:239]
 s_add_u32 m0, s33, 0x580
 ds_read_b128 a[84:87], v5 offset:36864
 v_mfma_f32_16x16x32_bf16 a[236:239], a[8:11], a[96:99], a[236:239]
 s_waitcnt lgkmcnt(10)
 buffer_load_dwordx4 v15, s[20:23], s57 offen offset:1664 lds
 v_mfma_f32_16x16x32_bf16 v[56:59], a[16:19], a[96:99], v[56:59]
 ds_read_b128 a[92:95], v5 offset:38912
 v_mfma_f32_16x16x32_bf16 v[56:59], a[20:23], a[100:103], v[56:59]
 v_cvt_pk_bf16_f32 v16, v16, v17
 v_cvt_pk_bf16_f32 v17, v18, v19
 v_mfma_f32_16x16x32_bf16 v[48:51], a[20:23], a[108:111], v[48:51]
 ds_read_b128 a[88:91], v4 offset:38912
 v_cvt_pk_bf16_f32 v18, v20, v21
 v_mfma_f32_16x16x32_bf16 v[48:51], a[16:19], a[104:107], v[48:51]
 v_cvt_pk_bf16_f32 v19, v22, v23
 v_cvt_pk_bf16_f32 v24, v24, v25
 v_mfma_f32_16x16x32_bf16 v[40:43], a[16:19], a[112:115], v[40:43]
 ds_read_b64_tr_b16 a[32:33], v10 offset:32768
 v_cvt_pk_bf16_f32 v25, v26, v27
 v_mfma_f32_16x16x32_bf16 v[40:43], a[20:23], a[116:119], v[40:43]
 ds_read_b64_tr_b16 a[34:35], v10 offset:36864
 v_cvt_pk_bf16_f32 v26, v28, v29
 v_mfma_f32_16x16x32_bf16 v[32:35], a[20:23], a[124:127], v[32:35]
 s_add_u32 s59, s56, 57344
 ds_read_b64_tr_b16 a[36:37], v10 offset:49152
 v_cvt_pk_bf16_f32 v27, v30, v31
 v_mfma_f32_16x16x32_bf16 v[32:35], a[16:19], a[120:123], v[32:35]
 s_waitcnt lgkmcnt(11)
 ds_read_b64_tr_b16 a[38:39], v10 offset:53248
 v_accvgpr_read_b32 v20, a224
 v_mfma_f32_16x16x32_bf16 v[36:39], a[24:27], a[120:123], v[36:39]
 ds_read_b64_tr_b16 a[40:41], v11 offset:32768
 buffer_store_dwordx4 v[16:19], v1, s[12:15], s59 offen offset:0 sc1
 v_mfma_f32_16x16x32_bf16 v[36:39], a[28:31], a[124:127], v[36:39]
 ds_read_b64_tr_b16 a[42:43], v11 offset:36864
 v_accvgpr_read_b32 v21, a225
 v_mfma_f32_16x16x32_bf16 v[44:47], a[28:31], a[116:119], v[44:47]
 ds_read_b64_tr_b16 a[44:45], v11 offset:49152
 v_accvgpr_read_b32 v22, a226
 v_mfma_f32_16x16x32_bf16 v[44:47], a[24:27], a[112:115], v[44:47]
 ds_read_b64_tr_b16 a[46:47], v11 offset:53248
 v_accvgpr_read_b32 v23, a227
 v_mfma_f32_16x16x32_bf16 v[52:55], a[24:27], a[104:107], v[52:55]
 ds_read_b64_tr_b16 a[48:49], v12 offset:32768
 v_accvgpr_read_b32 v28, a228
 v_mfma_f32_16x16x32_bf16 v[52:55], a[28:31], a[108:111], v[52:55]
 ds_read_b64_tr_b16 a[50:51], v12 offset:36864
 v_accvgpr_read_b32 v29, a229
 v_mfma_f32_16x16x32_bf16 v[60:63], a[28:31], a[100:103], v[60:63]
 s_add_u32 s59, s56, 49152
 ds_read_b64_tr_b16 a[52:53], v12 offset:49152
 v_accvgpr_read_b32 v30, a230
 v_mfma_f32_16x16x32_bf16 v[60:63], a[24:27], a[96:99], v[60:63]
 s_waitcnt lgkmcnt(15)
 ds_read_b64_tr_b16 a[54:55], v12 offset:53248
 buffer_store_dwordx4 v[24:27], v1, s[12:15], s59 offen offset:0 sc1
 v_mfma_f32_16x16x32_bf16 v[88:91], a[0:3], a[64:67], v[88:91]
 ds_read_b64_tr_b16 a[56:57], v13 offset:32768
 v_accvgpr_read_b32 v31, a231
 v_mfma_f32_16x16x32_bf16 v[88:91], a[4:7], a[68:71], v[88:91]
 ds_read_b64_tr_b16 a[58:59], v13 offset:36864
 v_cvt_pk_bf16_f32 v20, v20, v21
 v_mfma_f32_16x16x32_bf16 v[80:83], a[4:7], a[76:79], v[80:83]
 ds_read_b64_tr_b16 a[60:61], v13 offset:49152
 v_cvt_pk_bf16_f32 v21, v22, v23
 v_mfma_f32_16x16x32_bf16 v[80:83], a[0:3], a[72:75], v[80:83]
 s_waitcnt lgkmcnt(15)
 ds_read_b64_tr_b16 a[62:63], v13 offset:53248
 v_cvt_pk_bf16_f32 v22, v28, v29
 v_mfma_f32_16x16x32_bf16 v[72:75], a[0:3], a[80:83], v[72:75]
 v_cvt_pk_bf16_f32 v23, v30, v31
 v_cvt_pk_bf16_f32 v32, v32, v33
 v_mfma_f32_16x16x32_bf16 v[72:75], a[4:7], a[84:87], v[72:75]
 s_add_u32 s59, s56, 40960
 v_cvt_pk_bf16_f32 v33, v34, v35
 v_cvt_pk_bf16_f32 v34, v36, v37
 v_mfma_f32_16x16x32_bf16 v[64:67], a[4:7], a[92:95], v[64:67]
 buffer_store_dwordx4 v[20:23], v1, s[12:15], s59 offen offset:0 sc1
 v_mfma_f32_16x16x32_bf16 v[64:67], a[0:3], a[88:91], v[64:67]
 s_waitcnt lgkmcnt(0)
 v_cvt_pk_bf16_f32 v35, v38, v39
 v_cvt_pk_bf16_f32 v40, v40, v41
 v_mfma_f32_16x16x32_bf16 v[68:71], a[8:11], a[88:91], v[68:71]
 s_barrier
 v_xor_b32 v6, s60, v6
 v_cvt_pk_bf16_f32 v41, v42, v43
 v_mfma_f32_16x16x32_bf16 v[68:71], a[12:15], a[92:95], v[68:71]
 s_add_u32 m0, s29, 32768
 v_add_u32 v2, 0x80000, v2
 v_cvt_pk_bf16_f32 v42, v44, v45
 v_mfma_f32_16x16x32_bf16 v[76:79], a[12:15], a[84:87], v[76:79]
 buffer_load_dwordx4 v2, s[16:19], 0 offen lds
 v_mfma_f32_16x16x32_bf16 v[76:79], a[8:11], a[80:83], v[76:79]
 v_cvt_pk_bf16_f32 v43, v46, v47
 v_accvgpr_read_b32 v36, a232
 v_mfma_f32_16x16x32_bf16 v[84:87], a[8:11], a[72:75], v[84:87]
 s_add_u32 s59, s56, 57344
 v_accvgpr_read_b32 v37, a233
 v_accvgpr_read_b32 v38, a234
 v_mfma_f32_16x16x32_bf16 v[84:87], a[12:15], a[76:79], v[84:87]
 buffer_store_dwordx4 v[32:35], v1, s[12:15], s59 offen offset:1024 sc1
 v_mfma_f32_16x16x32_bf16 v[92:95], a[12:15], a[68:71], v[92:95]
 s_add_u32 m0, s29, 36864
 v_accvgpr_read_b32 v39, a235
 v_accvgpr_read_b32 v44, a236
 v_mfma_f32_16x16x32_bf16 v[92:95], a[8:11], a[64:67], v[92:95]
 buffer_load_dwordx4 v2, s[16:19], s48 offen lds
 v_mfma_f32_16x16x32_bf16 v[120:123], a[16:19], a[64:67], v[120:123]
 v_accvgpr_read_b32 v45, a237
 v_accvgpr_read_b32 v46, a238
 v_mfma_f32_16x16x32_bf16 v[120:123], a[20:23], a[68:71], v[120:123]
 v_accvgpr_read_b32 v47, a239
 v_cvt_pk_bf16_f32 v36, v36, v37
 v_mfma_f32_16x16x32_bf16 v[112:115], a[20:23], a[76:79], v[112:115]
 v_cvt_pk_bf16_f32 v37, v38, v39
 v_cvt_pk_bf16_f32 v38, v44, v45
 v_mfma_f32_16x16x32_bf16 v[112:115], a[16:19], a[72:75], v[112:115]
 s_add_u32 m0, s29, 40960
 v_cvt_pk_bf16_f32 v39, v46, v47
 v_cvt_pk_bf16_f32 v48, v48, v49
 v_mfma_f32_16x16x32_bf16 v[104:107], a[16:19], a[80:83], v[104:107]
 buffer_load_dwordx4 v2, s[16:19], s49 offen lds
 v_mfma_f32_16x16x32_bf16 v[104:107], a[20:23], a[84:87], v[104:107]
 s_add_u32 s59, s56, 49152
 v_cvt_pk_bf16_f32 v49, v50, v51
 v_cvt_pk_bf16_f32 v50, v52, v53
 v_mfma_f32_16x16x32_bf16 v[96:99], a[20:23], a[92:95], v[96:99]
 buffer_store_dwordx4 v[40:43], v1, s[12:15], s59 offen offset:1024 sc1
 v_mfma_f32_16x16x32_bf16 v[96:99], a[16:19], a[88:91], v[96:99]
 v_cvt_pk_bf16_f32 v51, v54, v55
 v_cvt_pk_bf16_f32 v56, v56, v57
 v_mfma_f32_16x16x32_bf16 v[100:103], a[24:27], a[88:91], v[100:103]
 s_add_u32 m0, s29, 45056
 v_cvt_pk_bf16_f32 v57, v58, v59
 v_cvt_pk_bf16_f32 v58, v60, v61
 v_mfma_f32_16x16x32_bf16 v[100:103], a[28:31], a[92:95], v[100:103]
 buffer_load_dwordx4 v2, s[16:19], s50 offen lds
 v_mfma_f32_16x16x32_bf16 v[108:111], a[28:31], a[84:87], v[108:111]
 v_cvt_pk_bf16_f32 v59, v62, v63
 v_cvt_pk_bf16_f32 v64, v64, v65
 v_mfma_f32_16x16x32_bf16 v[108:111], a[24:27], a[80:83], v[108:111]
 v_cvt_pk_bf16_f32 v65, v66, v67
 v_cvt_pk_bf16_f32 v66, v68, v69
 v_mfma_f32_16x16x32_bf16 v[116:119], a[24:27], a[72:75], v[116:119]
 v_cvt_pk_bf16_f32 v67, v70, v71
 v_cvt_pk_bf16_f32 v72, v72, v73
 v_mfma_f32_16x16x32_bf16 v[116:119], a[28:31], a[76:79], v[116:119]
 s_add_u32 m0, s29, 49152
 v_cvt_pk_bf16_f32 v73, v74, v75
 v_cvt_pk_bf16_f32 v74, v76, v77
 v_mfma_f32_16x16x32_bf16 v[124:127], a[28:31], a[68:71], v[124:127]
 buffer_load_dwordx4 v2, s[16:19], s51 offen lds
 v_mfma_f32_16x16x32_bf16 v[124:127], a[24:27], a[64:67], v[124:127]
 s_add_u32 s59, s56, 32768
 v_cvt_pk_bf16_f32 v75, v78, v79
 v_cvt_pk_bf16_f32 v80, v80, v81
 v_mfma_f32_16x16x32_bf16 v[152:155], a[32:35], a[64:67], v[152:155]
 buffer_store_dwordx4 v[36:39], v1, s[12:15], s59 offen offset:0 sc1
 v_mfma_f32_16x16x32_bf16 v[152:155], a[36:39], a[68:71], v[152:155]
 v_cvt_pk_bf16_f32 v81, v82, v83
 v_cvt_pk_bf16_f32 v82, v84, v85
 v_mfma_f32_16x16x32_bf16 v[144:147], a[36:39], a[76:79], v[144:147]
 s_add_u32 m0, s29, 53248
 v_cvt_pk_bf16_f32 v83, v86, v87
 v_cvt_pk_bf16_f32 v88, v88, v89
 v_mfma_f32_16x16x32_bf16 v[144:147], a[32:35], a[72:75], v[144:147]
 buffer_load_dwordx4 v2, s[16:19], s52 offen lds
 v_mfma_f32_16x16x32_bf16 v[136:139], a[32:35], a[80:83], v[136:139]
 v_cvt_pk_bf16_f32 v89, v90, v91
 v_cvt_pk_bf16_f32 v90, v92, v93
 v_mfma_f32_16x16x32_bf16 v[136:139], a[36:39], a[84:87], v[136:139]
 v_cvt_pk_bf16_f32 v91, v94, v95
 v_cvt_pk_bf16_f32 v96, v96, v97
 v_mfma_f32_16x16x32_bf16 v[128:131], a[36:39], a[92:95], v[128:131]
 v_cvt_pk_bf16_f32 v97, v98, v99
 v_cvt_pk_bf16_f32 v98, v100, v101
 v_mfma_f32_16x16x32_bf16 v[128:131], a[32:35], a[88:91], v[128:131]
 s_add_u32 m0, s29, 57344
 v_cvt_pk_bf16_f32 v99, v102, v103
 v_cvt_pk_bf16_f32 v104, v104, v105
 v_mfma_f32_16x16x32_bf16 v[132:135], a[40:43], a[88:91], v[132:135]
 buffer_load_dwordx4 v2, s[16:19], s53 offen lds
 v_mfma_f32_16x16x32_bf16 v[132:135], a[44:47], a[92:95], v[132:135]
 s_add_u32 s59, s56, 40960
 v_cvt_pk_bf16_f32 v105, v106, v107
 v_cvt_pk_bf16_f32 v106, v108, v109
 v_mfma_f32_16x16x32_bf16 v[140:143], a[44:47], a[84:87], v[140:143]
 buffer_store_dwordx4 v[48:51], v1, s[12:15], s59 offen offset:1024 sc1
 v_mfma_f32_16x16x32_bf16 v[140:143], a[40:43], a[80:83], v[140:143]
 v_cvt_pk_bf16_f32 v107, v110, v111
 v_cvt_pk_bf16_f32 v112, v112, v113
 v_mfma_f32_16x16x32_bf16 v[148:151], a[40:43], a[72:75], v[148:151]
 s_add_u32 m0, s29, 61440
 v_cvt_pk_bf16_f32 v113, v114, v115
 v_cvt_pk_bf16_f32 v114, v116, v117
 v_mfma_f32_16x16x32_bf16 v[148:151], a[44:47], a[76:79], v[148:151]
 buffer_load_dwordx4 v2, s[16:19], s54 offen lds
 v_mfma_f32_16x16x32_bf16 v[156:159], a[44:47], a[68:71], v[156:159]
 v_cvt_pk_bf16_f32 v115, v118, v119
 v_cvt_pk_bf16_f32 v120, v120, v121
 v_mfma_f32_16x16x32_bf16 v[156:159], a[40:43], a[64:67], v[156:159]
 v_cvt_pk_bf16_f32 v121, v122, v123
 v_cvt_pk_bf16_f32 v122, v124, v125
 v_mfma_f32_16x16x32_bf16 v[184:187], a[48:51], a[64:67], v[184:187]
 s_add_u32 m0, s29, 98304
 v_add_u32 v2, 0x80000, v2
 v_cvt_pk_bf16_f32 v123, v126, v127
 v_mfma_f32_16x16x32_bf16 v[184:187], a[52:55], a[68:71], v[184:187]
 buffer_load_dwordx4 v2, s[16:19], 0 offen lds
 v_mfma_f32_16x16x32_bf16 v[176:179], a[52:55], a[76:79], v[176:179]
 s_add_u32 s59, s56, 32768
 v_cvt_pk_bf16_f32 v128, v128, v129
 v_cvt_pk_bf16_f32 v129, v130, v131
 v_mfma_f32_16x16x32_bf16 v[176:179], a[48:51], a[72:75], v[176:179]
 buffer_store_dwordx4 v[56:59], v1, s[12:15], s59 offen offset:1024 sc1
 v_mfma_f32_16x16x32_bf16 v[168:171], a[48:51], a[80:83], v[168:171]
 v_cvt_pk_bf16_f32 v130, v132, v133
 v_cvt_pk_bf16_f32 v131, v134, v135
 v_mfma_f32_16x16x32_bf16 v[168:171], a[52:55], a[84:87], v[168:171]
 s_add_u32 m0, s29, 102400
 v_cvt_pk_bf16_f32 v136, v136, v137
 v_cvt_pk_bf16_f32 v137, v138, v139
 v_mfma_f32_16x16x32_bf16 v[160:163], a[52:55], a[92:95], v[160:163]
 buffer_load_dwordx4 v2, s[16:19], s48 offen lds
 v_mfma_f32_16x16x32_bf16 v[160:163], a[48:51], a[88:91], v[160:163]
 v_cvt_pk_bf16_f32 v138, v140, v141
 v_cvt_pk_bf16_f32 v139, v142, v143
 v_mfma_f32_16x16x32_bf16 v[164:167], a[56:59], a[88:91], v[164:167]
 v_cvt_pk_bf16_f32 v144, v144, v145
 v_cvt_pk_bf16_f32 v145, v146, v147
 v_mfma_f32_16x16x32_bf16 v[164:167], a[60:63], a[92:95], v[164:167]
 v_cvt_pk_bf16_f32 v146, v148, v149
 v_cvt_pk_bf16_f32 v147, v150, v151
 v_mfma_f32_16x16x32_bf16 v[172:175], a[60:63], a[84:87], v[172:175]
 s_add_u32 m0, s29, 106496
 v_cvt_pk_bf16_f32 v152, v152, v153
 v_cvt_pk_bf16_f32 v153, v154, v155
 v_mfma_f32_16x16x32_bf16 v[172:175], a[56:59], a[80:83], v[172:175]
 buffer_load_dwordx4 v2, s[16:19], s49 offen lds
 v_mfma_f32_16x16x32_bf16 v[180:183], a[56:59], a[72:75], v[180:183]
 s_add_u32 s59, s56, 24576
 v_cvt_pk_bf16_f32 v154, v156, v157
 v_cvt_pk_bf16_f32 v155, v158, v159
 v_mfma_f32_16x16x32_bf16 v[180:183], a[60:63], a[76:79], v[180:183]
 buffer_store_dwordx4 v[64:67], v1, s[12:15], s59 offen offset:0 sc1
 v_mfma_f32_16x16x32_bf16 v[188:191], a[60:63], a[68:71], v[188:191]
 v_mfma_f32_16x16x32_bf16 v[188:191], a[56:59], a[64:67], v[188:191]
 s_add_u32 m0, s29, 110592
 v_mfma_f32_16x16x32_bf16 v[216:219], a[32:35], a[96:99], v[216:219]
 buffer_load_dwordx4 v2, s[16:19], s50 offen lds
 v_mfma_f32_16x16x32_bf16 v[216:219], a[36:39], a[100:103], v[216:219]
 v_cvt_pk_bf16_f32 v160, v160, v161
 v_cvt_pk_bf16_f32 v161, v162, v163
 v_mfma_f32_16x16x32_bf16 v[208:211], a[36:39], a[108:111], v[208:211]
 v_cvt_pk_bf16_f32 v162, v164, v165
 v_cvt_pk_bf16_f32 v163, v166, v167
 v_mfma_f32_16x16x32_bf16 v[208:211], a[32:35], a[104:107], v[208:211]
 v_cvt_pk_bf16_f32 v168, v168, v169
 v_cvt_pk_bf16_f32 v169, v170, v171
 v_mfma_f32_16x16x32_bf16 v[200:203], a[32:35], a[112:115], v[200:203]
 s_add_u32 m0, s29, 114688
 v_cvt_pk_bf16_f32 v170, v172, v173
 v_cvt_pk_bf16_f32 v171, v174, v175
 v_mfma_f32_16x16x32_bf16 v[200:203], a[36:39], a[116:119], v[200:203]
 buffer_load_dwordx4 v2, s[16:19], s51 offen lds
 v_mfma_f32_16x16x32_bf16 v[192:195], a[36:39], a[124:127], v[192:195]
 s_add_u32 s59, s56, 16384
 v_cvt_pk_bf16_f32 v176, v176, v177
 v_cvt_pk_bf16_f32 v177, v178, v179
 v_mfma_f32_16x16x32_bf16 v[192:195], a[32:35], a[120:123], v[192:195]
 buffer_store_dwordx4 v[72:75], v1, s[12:15], s59 offen offset:0 sc1
 v_mfma_f32_16x16x32_bf16 v[196:199], a[40:43], a[120:123], v[196:199]
 v_cvt_pk_bf16_f32 v178, v180, v181
 v_cvt_pk_bf16_f32 v179, v182, v183
 v_mfma_f32_16x16x32_bf16 v[196:199], a[44:47], a[124:127], v[196:199]
 s_add_u32 m0, s29, 118784
 v_cvt_pk_bf16_f32 v184, v184, v185
 v_cvt_pk_bf16_f32 v185, v186, v187
 v_mfma_f32_16x16x32_bf16 v[204:207], a[44:47], a[116:119], v[204:207]
 buffer_load_dwordx4 v2, s[16:19], s52 offen lds
 v_mfma_f32_16x16x32_bf16 v[204:207], a[40:43], a[112:115], v[204:207]
 v_cvt_pk_bf16_f32 v186, v188, v189
 v_cvt_pk_bf16_f32 v187, v190, v191
 v_mfma_f32_16x16x32_bf16 v[212:215], a[40:43], a[104:107], v[212:215]
 v_mfma_f32_16x16x32_bf16 v[212:215], a[44:47], a[108:111], v[212:215]
 v_mfma_f32_16x16x32_bf16 v[220:223], a[44:47], a[100:103], v[220:223]
 s_add_u32 m0, s29, 122880
 v_mfma_f32_16x16x32_bf16 v[220:223], a[40:43], a[96:99], v[220:223]
 buffer_load_dwordx4 v2, s[16:19], s53 offen lds
 v_mfma_f32_16x16x32_bf16 v[248:251], a[48:51], a[96:99], v[248:251]
 s_add_u32 s59, s56, 8192
 v_mfma_f32_16x16x32_bf16 v[248:251], a[52:55], a[100:103], v[248:251]
 s_waitcnt vmcnt(25)
 buffer_store_dwordx4 v[80:83], v1, s[12:15], s59 offen offset:0 sc1
 v_mfma_f32_16x16x32_bf16 v[240:243], a[52:55], a[108:111], v[240:243]
 s_barrier
 v_xor_b32 v7, 0, v6
 v_cvt_pk_bf16_f32 v192, v192, v193
 v_mfma_f32_16x16x32_bf16 v[240:243], a[48:51], a[104:107], v[240:243]
 s_add_u32 m0, s29, 126976
 ds_read_b64_tr_b16 a[64:65], v7 offset:0
 v_cvt_pk_bf16_f32 v193, v194, v195
 v_mfma_f32_16x16x32_bf16 v[232:235], a[48:51], a[112:115], v[232:235]
 ds_read_b64_tr_b16 a[66:67], v7 offset:4096
 buffer_load_dwordx4 v2, s[16:19], s54 offen lds
 v_mfma_f32_16x16x32_bf16 v[232:235], a[52:55], a[116:119], v[232:235]
 ds_read_b64_tr_b16 a[68:69], v7 offset:16384
 v_cvt_pk_bf16_f32 v194, v196, v197
 v_mfma_f32_16x16x32_bf16 v[224:227], a[52:55], a[124:127], v[224:227]
 ds_read_b64_tr_b16 a[70:71], v7 offset:20480
 v_xor_b32 v8, 65536, v6
 v_mfma_f32_16x16x32_bf16 v[224:227], a[48:51], a[120:123], v[224:227]
 s_add_u32 s59, s56, 0
 ds_read_b64_tr_b16 a[72:73], v8 offset:0
 v_cvt_pk_bf16_f32 v195, v198, v199
 v_mfma_f32_16x16x32_bf16 v[228:231], a[56:59], a[120:123], v[228:231]
 ds_read_b64_tr_b16 a[74:75], v8 offset:4096
 buffer_store_dwordx4 v[88:91], v1, s[12:15], s59 offen offset:0 sc1
 v_mfma_f32_16x16x32_bf16 v[228:231], a[60:63], a[124:127], v[228:231]
 ds_read_b64_tr_b16 a[76:77], v8 offset:16384
 v_cvt_pk_bf16_f32 v200, v200, v201
 v_mfma_f32_16x16x32_bf16 v[236:239], a[60:63], a[116:119], v[236:239]
 ds_read_b64_tr_b16 a[78:79], v8 offset:20480
 v_xor_b32 v9, 32, v6
 v_mfma_f32_16x16x32_bf16 v[236:239], a[56:59], a[112:115], v[236:239]
 ds_read_b64_tr_b16 a[80:81], v9 offset:0
 v_cvt_pk_bf16_f32 v201, v202, v203
 v_mfma_f32_16x16x32_bf16 v[244:247], a[56:59], a[104:107], v[244:247]
 ds_read_b64_tr_b16 a[82:83], v9 offset:4096
 v_cvt_pk_bf16_f32 v202, v204, v205
 v_mfma_f32_16x16x32_bf16 v[244:247], a[60:63], a[108:111], v[244:247]
 ds_read_b64_tr_b16 a[84:85], v9 offset:16384
 v_cvt_pk_bf16_f32 v203, v206, v207
 v_mfma_f32_16x16x32_bf16 v[252:255], a[60:63], a[100:103], v[252:255]
 s_add_u32 s59, s56, 24576
 ds_read_b64_tr_b16 a[86:87], v9 offset:20480
 v_xor_b32 v10, 65568, v6
 v_mfma_f32_16x16x32_bf16 v[252:255], a[56:59], a[96:99], v[252:255]
 s_waitcnt lgkmcnt(6)
 ds_read_b64_tr_b16 a[88:89], v10 offset:0
 buffer_store_dwordx4 v[96:99], v1, s[12:15], s59 offen offset:1024 sc1
 v_mfma_f32_16x16x32_bf16 v[28:31], a[64:67], a[128:131], 0
 ds_read_b64_tr_b16 a[90:91], v10 offset:4096
 v_cvt_pk_bf16_f32 v208, v208, v209
 v_mfma_f32_16x16x32_bf16 v[28:31], a[68:71], a[136:139], v[28:31]
 ds_read_b64_tr_b16 a[92:93], v10 offset:16384
 v_xor_b32 v7, 64, v6
 v_mfma_f32_16x16x32_bf16 v[28:31], a[72:75], a[144:147], v[28:31]
 s_waitcnt lgkmcnt(7)
 ds_read_b128 a[112:115], v14 offset:0
 ds_read_b64_tr_b16 a[94:95], v10 offset:20480
 v_mfma_f32_16x16x32_bf16 v[28:31], a[76:79], a[152:155], v[28:31]
 ds_read_b64_tr_b16 a[96:97], v7 offset:0
 v_cvt_pk_bf16_f32 v209, v210, v211
 v_mfma_f32_16x16x32_bf16 v[44:47], a[64:67], a[132:135], 0
 ds_read_b128 a[120:123], v3 offset:0
 ds_read_b64_tr_b16 a[98:99], v7 offset:4096
 v_mfma_f32_16x16x32_bf16 v[44:47], a[68:71], a[140:143], v[44:47]
 s_add_u32 s59, s56, 16384
 ds_read_b64_tr_b16 a[100:101], v7 offset:16384
 v_xor_b32 v8, 65600, v6
 v_mfma_f32_16x16x32_bf16 v[44:47], a[72:75], a[148:151], v[44:47]
 ds_read_b128 a[116:119], v14 offset:2048
 ds_read_b64_tr_b16 a[102:103], v7 offset:20480
 buffer_store_dwordx4 v[104:107], v1, s[12:15], s59 offen offset:1024 sc1
 v_mfma_f32_16x16x32_bf16 v[44:47], a[76:79], a[156:159], v[44:47]
 s_waitcnt lgkmcnt(9)
 ds_read_b64_tr_b16 a[104:105], v8 offset:0
 v_cvt_pk_bf16_f32 v210, v212, v213
 v_mfma_f32_16x16x32_bf16 v[52:55], a[80:83], a[128:131], 0
 ds_read_b128 a[124:127], v3 offset:2048
 ds_read_b64_tr_b16 a[106:107], v8 offset:4096
 v_mfma_f32_16x16x32_bf16 v[52:55], a[84:87], a[136:139], v[52:55]
 ds_read_b64_tr_b16 a[108:109], v8 offset:16384
 v_cvt_pk_bf16_f32 v211, v214, v215
 v_mfma_f32_16x16x32_bf16 v[52:55], a[88:91], a[144:147], v[52:55]
 s_waitcnt lgkmcnt(10)
 ds_read_b64_tr_b16 a[110:111], v8 offset:20480
 v_xor_b32 v9, 96, v6
 v_mfma_f32_16x16x32_bf16 v[52:55], a[92:95], a[152:155], v[52:55]
 ds_read_b64_tr_b16 a[64:65], v9 offset:0
 v_cvt_pk_bf16_f32 v216, v216, v217
 v_mfma_f32_16x16x32_bf16 v[60:63], a[80:83], a[132:135], 0
 s_add_u32 s59, s56, 8192
 ds_read_b64_tr_b16 a[66:67], v9 offset:4096
 v_cvt_pk_bf16_f32 v217, v218, v219
 v_mfma_f32_16x16x32_bf16 v[60:63], a[84:87], a[140:143], v[60:63]
 ds_read_b64_tr_b16 a[68:69], v9 offset:16384
 buffer_store_dwordx4 v[112:115], v1, s[12:15], s59 offen offset:1024 sc1
 v_mfma_f32_16x16x32_bf16 v[60:63], a[88:91], a[148:151], v[60:63]
 ds_read_b64_tr_b16 a[70:71], v9 offset:20480
 v_xor_b32 v10, 65632, v6
 v_mfma_f32_16x16x32_bf16 v[60:63], a[92:95], a[156:159], v[60:63]
 s_waitcnt lgkmcnt(6)
 ds_read_b64_tr_b16 a[72:73], v10 offset:0
 v_cvt_pk_bf16_f32 v218, v220, v221
 v_mfma_f32_16x16x32_bf16 v[20:23], a[96:99], a[128:131], 0
 ds_read_b64_tr_b16 a[74:75], v10 offset:4096
 v_cvt_pk_bf16_f32 v219, v222, v223
 v_mfma_f32_16x16x32_bf16 v[20:23], a[100:103], a[136:139], v[20:23]
 s_waitcnt lgkmcnt(8)
 ds_read_b64_tr_b16 a[76:77], v10 offset:16384
 v_xor_b32 v7, 128, v6
 v_mfma_f32_16x16x32_bf16 v[20:23], a[104:107], a[144:147], v[20:23]
 s_waitcnt lgkmcnt(7)
 s_barrier
 ds_read_b64_tr_b16 a[78:79], v10 offset:20480
 v_mfma_f32_16x16x32_bf16 v[20:23], a[108:111], a[152:155], v[20:23]
 s_add_u32 m0, s29, 131072
 ds_read_b64_tr_b16 a[80:81], v7 offset:0
 v_add_u32 v2, 0x80000, v2
 v_mfma_f32_16x16x32_bf16 v[36:39], a[96:99], a[132:135], 0
 ds_read_b64_tr_b16 a[82:83], v7 offset:4096
 buffer_load_dwordx4 v2, s[16:19], 0 offen lds
 v_mfma_f32_16x16x32_bf16 v[36:39], a[100:103], a[140:143], v[36:39]
 ds_read_b64_tr_b16 a[84:85], v7 offset:16384
 v_cvt_pk_bf16_f32 v224, v224, v225
 v_mfma_f32_16x16x32_bf16 v[36:39], a[104:107], a[148:151], v[36:39]
 s_add_u32 s59, s56, 0
 ds_read_b64_tr_b16 a[86:87], v7 offset:20480
 v_xor_b32 v8, 65664, v6
 v_mfma_f32_16x16x32_bf16 v[36:39], a[108:111], a[156:159], v[36:39]
 s_waitcnt lgkmcnt(6)
 ds_read_b64_tr_b16 a[88:89], v8 offset:0
 buffer_store_dwordx4 v[120:123], v1, s[12:15], s59 offen offset:1024 sc1
 v_mfma_f32_16x16x32_bf16 v[68:71], a[64:67], a[128:131], 0
 ds_read_b64_tr_b16 a[90:91], v8 offset:4096
 v_cvt_pk_bf16_f32 v225, v226, v227
 v_mfma_f32_16x16x32_bf16 v[68:71], a[68:71], a[136:139], v[68:71]
 s_add_u32 m0, s29, 135168
 ds_read_b64_tr_b16 a[92:93], v8 offset:16384
 v_cvt_pk_bf16_f32 v226, v228, v229
 v_mfma_f32_16x16x32_bf16 v[68:71], a[72:75], a[144:147], v[68:71]
 s_waitcnt lgkmcnt(7)
 ds_read_b64_tr_b16 a[94:95], v8 offset:20480
 v_xor_b32 v9, 160, v6
 v_mfma_f32_16x16x32_bf16 v[68:71], a[76:79], a[152:155], v[68:71]
 ds_read_b64_tr_b16 a[96:97], v9 offset:0
 buffer_load_dwordx4 v2, s[16:19], s48 offen lds
 v_mfma_f32_16x16x32_bf16 v[76:79], a[64:67], a[132:135], 0
 ds_read_b64_tr_b16 a[98:99], v9 offset:4096
 v_cvt_pk_bf16_f32 v227, v230, v231
 v_mfma_f32_16x16x32_bf16 v[76:79], a[68:71], a[140:143], v[76:79]
 ds_read_b64_tr_b16 a[100:101], v9 offset:16384
 v_cvt_pk_bf16_f32 v232, v232, v233
 v_mfma_f32_16x16x32_bf16 v[76:79], a[72:75], a[148:151], v[76:79]
 s_add_u32 s59, s56, 24576
 ds_read_b64_tr_b16 a[102:103], v9 offset:20480
 v_xor_b32 v10, 65696, v6
 v_mfma_f32_16x16x32_bf16 v[76:79], a[76:79], a[156:159], v[76:79]
 s_waitcnt lgkmcnt(6)
 ds_read_b64_tr_b16 a[104:105], v10 offset:0
 buffer_store_dwordx4 v[128:131], v1, s[12:15], s59 offen offset:2048 sc1
 v_mfma_f32_16x16x32_bf16 v[84:87], a[80:83], a[128:131], 0
 s_add_u32 m0, s29, 139264
 ds_read_b64_tr_b16 a[106:107], v10 offset:4096
 v_cvt_pk_bf16_f32 v233, v234, v235
 v_mfma_f32_16x16x32_bf16 v[84:87], a[84:87], a[136:139], v[84:87]
 ds_read_b64_tr_b16 a[108:109], v10 offset:16384
 buffer_load_dwordx4 v2, s[16:19], s49 offen lds
 v_mfma_f32_16x16x32_bf16 v[84:87], a[88:91], a[144:147], v[84:87]
 s_waitcnt lgkmcnt(7)
 ds_read_b64_tr_b16 a[110:111], v10 offset:20480
 v_xor_b32 v7, 192, v6
 v_mfma_f32_16x16x32_bf16 v[84:87], a[92:95], a[152:155], v[84:87]
 ds_read_b64_tr_b16 a[64:65], v7 offset:0
 v_cvt_pk_bf16_f32 v234, v236, v237
 v_mfma_f32_16x16x32_bf16 v[92:95], a[80:83], a[132:135], 0
 ds_read_b64_tr_b16 a[66:67], v7 offset:4096
 v_cvt_pk_bf16_f32 v235, v238, v239
 v_mfma_f32_16x16x32_bf16 v[92:95], a[84:87], a[140:143], v[92:95]
 ds_read_b64_tr_b16 a[68:69], v7 offset:16384
 v_cvt_pk_bf16_f32 v240, v240, v241
 v_mfma_f32_16x16x32_bf16 v[92:95], a[88:91], a[148:151], v[92:95]
 s_add_u32 m0, s29, 143360
 ds_read_b64_tr_b16 a[70:71], v7 offset:20480
 v_xor_b32 v8, 65728, v6
 v_mfma_f32_16x16x32_bf16 v[92:95], a[92:95], a[156:159], v[92:95]
 s_waitcnt lgkmcnt(6)
 ds_read_b64_tr_b16 a[72:73], v8 offset:0
 buffer_load_dwordx4 v2, s[16:19], s50 offen lds
 v_mfma_f32_16x16x32_bf16 v[100:103], a[96:99], a[128:131], 0
 s_add_u32 s59, s56, 16384
 ds_read_b64_tr_b16 a[74:75], v8 offset:4096
 v_cvt_pk_bf16_f32 v241, v242, v243
 v_mfma_f32_16x16x32_bf16 v[100:103], a[100:103], a[136:139], v[100:103]
 ds_read_b64_tr_b16 a[76:77], v8 offset:16384
 buffer_store_dwordx4 v[136:139], v1, s[12:15], s59 offen offset:2048 sc1
 v_mfma_f32_16x16x32_bf16 v[100:103], a[104:107], a[144:147], v[100:103]
 s_waitcnt lgkmcnt(7)
 ds_read_b64_tr_b16 a[78:79], v8 offset:20480
 v_xor_b32 v9, 224, v6
 v_mfma_f32_16x16x32_bf16 v[100:103], a[108:111], a[152:155], v[100:103]
 s_and_b32 s36, s95, 31
 ds_read_b64_tr_b16 a[80:81], v9 offset:0
 v_cvt_pk_bf16_f32 v242, v244, v245
 v_mfma_f32_16x16x32_bf16 v[108:111], a[96:99], a[132:135], 0
 s_add_u32 m0, s29, 147456
 ds_read_b64_tr_b16 a[82:83], v9 offset:4096
 v_cvt_pk_bf16_f32 v243, v246, v247
 v_mfma_f32_16x16x32_bf16 v[108:111], a[100:103], a[140:143], v[108:111]
 ds_read_b64_tr_b16 a[84:85], v9 offset:16384
 buffer_load_dwordx4 v2, s[16:19], s51 offen lds
 v_mfma_f32_16x16x32_bf16 v[108:111], a[104:107], a[148:151], v[108:111]
 s_add_u32 s59, s56, 8192
 ds_read_b64_tr_b16 a[86:87], v9 offset:20480
 v_xor_b32 v10, 65760, v6
 v_mfma_f32_16x16x32_bf16 v[108:111], a[108:111], a[156:159], v[108:111]
 s_waitcnt lgkmcnt(6)
 ds_read_b64_tr_b16 a[88:89], v10 offset:0
 v_cvt_pk_bf16_f32 v248, v248, v249
 v_mfma_f32_16x16x32_bf16 v[116:119], a[64:67], a[128:131], 0
 ds_read_b64_tr_b16 a[90:91], v10 offset:4096
 buffer_store_dwordx4 v[144:147], v1, s[12:15], s59 offen offset:2048 sc1
 v_mfma_f32_16x16x32_bf16 v[116:119], a[68:71], a[136:139], v[116:119]
 s_add_u32 m0, s29, 151552
 ds_read_b64_tr_b16 a[92:93], v10 offset:16384
 v_cvt_pk_bf16_f32 v249, v250, v251
 v_mfma_f32_16x16x32_bf16 v[116:119], a[72:75], a[144:147], v[116:119]
 s_waitcnt lgkmcnt(7)
 ds_read_b64_tr_b16 a[94:95], v10 offset:20480
 v_xor_b32 v7, 256, v6
 v_mfma_f32_16x16x32_bf16 v[116:119], a[76:79], a[152:155], v[116:119]
 ds_read_b64_tr_b16 a[96:97], v7 offset:0
 buffer_load_dwordx4 v2, s[16:19], s52 offen lds
 v_mfma_f32_16x16x32_bf16 v[124:127], a[64:67], a[132:135], 0
 s_lshr_b32 s37, s95, 5
 ds_read_b64_tr_b16 a[98:99], v7 offset:4096
 v_cvt_pk_bf16_f32 v250, v252, v253
 v_mfma_f32_16x16x32_bf16 v[124:127], a[68:71], a[140:143], v[124:127]
 s_lshl_b32 s38, s3, 4
 ds_read_b64_tr_b16 a[100:101], v7 offset:16384
 v_cvt_pk_bf16_f32 v251, v254, v255
 v_mfma_f32_16x16x32_bf16 v[124:127], a[72:75], a[148:151], v[124:127]
 s_add_u32 s59, s56, 0
 ds_read_b64_tr_b16 a[102:103], v7 offset:20480
 v_xor_b32 v8, 65792, v6
 v_mfma_f32_16x16x32_bf16 v[124:127], a[76:79], a[156:159], v[124:127]
 s_waitcnt lgkmcnt(6)
 ds_read_b64_tr_b16 a[104:105], v8 offset:0
 buffer_store_dwordx4 v[152:155], v1, s[12:15], s59 offen offset:2048 sc1
 v_mfma_f32_16x16x32_bf16 v[132:135], a[80:83], a[128:131], 0
 s_add_u32 m0, s29, 155648
 ds_read_b64_tr_b16 a[106:107], v8 offset:4096
 v_accvgpr_read_b32 v11, a245
 v_mfma_f32_16x16x32_bf16 v[132:135], a[84:87], a[136:139], v[132:135]
 ds_read_b64_tr_b16 a[108:109], v8 offset:16384
 buffer_load_dwordx4 v2, s[16:19], s53 offen lds
 v_mfma_f32_16x16x32_bf16 v[132:135], a[88:91], a[144:147], v[132:135]
 s_waitcnt lgkmcnt(7)
 ds_read_b64_tr_b16 a[110:111], v8 offset:20480
 v_xor_b32 v9, 288, v6
 v_mfma_f32_16x16x32_bf16 v[132:135], a[92:95], a[152:155], v[132:135]
 s_lshl_b32 s39, s36, 6
 ds_read_b64_tr_b16 a[64:65], v9 offset:0
 v_mov_b32 v12, 0
 v_mfma_f32_16x16x32_bf16 v[140:143], a[80:83], a[132:135], 0
 ds_read_b64_tr_b16 a[66:67], v9 offset:4096
 global_load_dword v5, v12, s[90:91] offset:128 sc1
 v_mfma_f32_16x16x32_bf16 v[140:143], a[84:87], a[140:143], v[140:143]
 s_add_u32 s38, s38, s39
 ds_read_b64_tr_b16 a[68:69], v9 offset:16384
 v_and_b32 v12, 11, v0
 v_mfma_f32_16x16x32_bf16 v[140:143], a[88:91], a[148:151], v[140:143]
 s_add_u32 m0, s29, 159744
 ds_read_b64_tr_b16 a[70:71], v9 offset:20480
 v_xor_b32 v10, 65824, v6
 v_mfma_f32_16x16x32_bf16 v[140:143], a[92:95], a[156:159], v[140:143]
 s_waitcnt lgkmcnt(6)
 ds_read_b64_tr_b16 a[72:73], v10 offset:0
 buffer_load_dwordx4 v2, s[16:19], s54 offen lds
 v_mfma_f32_16x16x32_bf16 v[148:151], a[96:99], a[128:131], 0
 s_add_u32 s59, s56, 24576
 ds_read_b64_tr_b16 a[74:75], v10 offset:4096
 v_lshlrev_b32 v12, 2, v12
 v_mfma_f32_16x16x32_bf16 v[148:151], a[100:103], a[136:139], v[148:151]
 ds_read_b64_tr_b16 a[76:77], v10 offset:16384
 buffer_store_dwordx4 v[160:163], v1, s[12:15], s59 offen offset:3072 sc1
 v_mfma_f32_16x16x32_bf16 v[148:151], a[104:107], a[144:147], v[148:151]
 s_waitcnt lgkmcnt(7)
 ds_read_b64_tr_b16 a[78:79], v10 offset:20480
 v_xor_b32 v7, 320, v6
 v_mfma_f32_16x16x32_bf16 v[148:151], a[108:111], a[152:155], v[148:151]
 s_mul_i32 s38, s38, 896
 ds_read_b64_tr_b16 a[80:81], v7 offset:0
 v_and_b32 v14, 15, v0
 v_mfma_f32_16x16x32_bf16 v[156:159], a[96:99], a[132:135], 0
 s_lshl_b32 s39, s37, 7
 ds_read_b64_tr_b16 a[82:83], v7 offset:4096
 v_lshrrev_b32 v3, 4, v0
 v_mfma_f32_16x16x32_bf16 v[156:159], a[100:103], a[140:143], v[156:159]
 s_add_u32 s38, s38, s39
 ds_read_b64_tr_b16 a[84:85], v7 offset:16384
 v_lshlrev_b32 v3, 2, v3
 v_mfma_f32_16x16x32_bf16 v[156:159], a[104:107], a[148:151], v[156:159]
 s_add_u32 s59, s56, 16384
 ds_read_b64_tr_b16 a[86:87], v7 offset:20480
 v_xor_b32 v8, 65856, v6
 v_mfma_f32_16x16x32_bf16 v[156:159], a[108:111], a[156:159], v[156:159]
 s_waitcnt lgkmcnt(6)
 ds_read_b64_tr_b16 a[88:89], v8 offset:0
 v_sub_u32 v14, v14, v3
 v_mfma_f32_16x16x32_bf16 v[164:167], a[64:67], a[128:131], 0
 ds_read_b64_tr_b16 a[90:91], v8 offset:4096
 buffer_store_dwordx4 v[168:171], v1, s[12:15], s59 offen offset:3072 sc1
 v_mfma_f32_16x16x32_bf16 v[164:167], a[68:71], a[136:139], v[164:167]
 s_lshl_b32 s39, s37, 9
 ds_read_b64_tr_b16 a[92:93], v8 offset:16384
 v_lshrrev_b32_e64 v3, 6, s29
 v_mfma_f32_16x16x32_bf16 v[164:167], a[72:75], a[144:147], v[164:167]
 s_waitcnt lgkmcnt(7)
 ds_read_b64_tr_b16 a[94:95], v8 offset:20480
 v_xor_b32 v9, 352, v6
 v_mfma_f32_16x16x32_bf16 v[164:167], a[76:79], a[152:155], v[164:167]
 s_mov_b32 s4, s66
 ds_read_b64_tr_b16 a[96:97], v9 offset:0
 v_add_u32 v14, v3, v14
 v_mfma_f32_16x16x32_bf16 v[172:175], a[64:67], a[132:135], 0
 s_mov_b32 s5, s67
 ds_read_b64_tr_b16 a[98:99], v9 offset:4096
 v_mov_b32 v15, 0xf149f2ca
 v_mfma_f32_16x16x32_bf16 v[172:175], a[68:71], a[140:143], v[172:175]
 s_mov_b32 s6, 1835008
 ds_read_b64_tr_b16 a[100:101], v9 offset:16384
 v_cmp_gt_i32 vcc, 0, v14
 v_mfma_f32_16x16x32_bf16 v[172:175], a[72:75], a[148:151], v[172:175]
 s_add_u32 s59, s56, 8192
 ds_read_b64_tr_b16 a[102:103], v9 offset:20480
 v_xor_b32 v10, 65888, v6
 v_mfma_f32_16x16x32_bf16 v[172:175], a[76:79], a[156:159], v[172:175]
 s_waitcnt lgkmcnt(6)
 ds_read_b64_tr_b16 a[104:105], v10 offset:0
 buffer_store_dwordx4 v[176:179], v1, s[12:15], s59 offen offset:3072 sc1
 v_mfma_f32_16x16x32_bf16 v[180:183], a[80:83], a[128:131], 0
 s_mov_b32 s7, 0x20000
 ds_read_b64_tr_b16 a[106:107], v10 offset:4096
 v_cndmask_b32 v3, 0, v15, vcc
 v_mfma_f32_16x16x32_bf16 v[180:183], a[84:87], a[136:139], v[180:183]
 s_mov_b32 s8, s68
 ds_read_b64_tr_b16 a[108:109], v10 offset:16384
 v_accvgpr_write_b32 a224, v3
 v_mfma_f32_16x16x32_bf16 v[180:183], a[88:91], a[144:147], v[180:183]
 s_waitcnt lgkmcnt(7)
 ds_read_b64_tr_b16 a[110:111], v10 offset:20480
 v_xor_b32 v7, 384, v6
 v_mfma_f32_16x16x32_bf16 v[180:183], a[92:95], a[152:155], v[180:183]
 s_mov_b32 s9, s69
 ds_read_b64_tr_b16 a[64:65], v7 offset:0
 v_cmp_gt_i32 vcc, 1, v14
 v_mfma_f32_16x16x32_bf16 v[188:191], a[80:83], a[132:135], 0
 s_mov_b32 s10, 1835008
 ds_read_b64_tr_b16 a[66:67], v7 offset:4096
 v_cndmask_b32 v3, 0, v15, vcc
 v_mfma_f32_16x16x32_bf16 v[188:191], a[84:87], a[140:143], v[188:191]
 s_mov_b32 s11, 0x20000
 ds_read_b64_tr_b16 a[68:69], v7 offset:16384
 v_accvgpr_write_b32 a225, v3
 v_mfma_f32_16x16x32_bf16 v[188:191], a[88:91], a[148:151], v[188:191]
 s_add_u32 s59, s56, 0
 ds_read_b64_tr_b16 a[70:71], v7 offset:20480
 v_xor_b32 v8, 65920, v6
 v_mfma_f32_16x16x32_bf16 v[188:191], a[92:95], a[156:159], v[188:191]
 s_waitcnt lgkmcnt(6)
 ds_read_b64_tr_b16 a[72:73], v8 offset:0
 buffer_store_dwordx4 v[184:187], v1, s[12:15], s59 offen offset:3072 sc1
 v_mfma_f32_16x16x32_bf16 v[196:199], a[96:99], a[128:131], 0
 s_mov_b32 s20, s70
 ds_read_b64_tr_b16 a[74:75], v8 offset:4096
 v_cmp_gt_i32 vcc, 2, v14
 v_mfma_f32_16x16x32_bf16 v[196:199], a[100:103], a[136:139], v[196:199]
 s_mov_b32 s21, s71
 ds_read_b64_tr_b16 a[76:77], v8 offset:16384
 v_cndmask_b32 v3, 0, v15, vcc
 v_mfma_f32_16x16x32_bf16 v[196:199], a[104:107], a[144:147], v[196:199]
 s_waitcnt lgkmcnt(7)
 ds_read_b64_tr_b16 a[78:79], v8 offset:20480
 v_xor_b32 v9, 416, v6
 v_mfma_f32_16x16x32_bf16 v[196:199], a[108:111], a[152:155], v[196:199]
 s_mov_b32 s22, 3584
 ds_read_b64_tr_b16 a[80:81], v9 offset:0
 v_accvgpr_write_b32 a226, v3
 v_mfma_f32_16x16x32_bf16 v[204:207], a[96:99], a[132:135], 0
 s_mov_b32 s23, 0x20000
 ds_read_b64_tr_b16 a[82:83], v9 offset:4096
 v_cmp_gt_i32 vcc, 3, v14
 v_mfma_f32_16x16x32_bf16 v[204:207], a[100:103], a[140:143], v[204:207]
 ds_read_b64_tr_b16 a[84:85], v9 offset:16384
 v_lshrrev_b32 v120, 3, v0
 v_mfma_f32_16x16x32_bf16 v[204:207], a[104:107], a[148:151], v[204:207]
 s_add_u32 s59, s56, 57344
 ds_read_b64_tr_b16 a[86:87], v9 offset:20480
 v_xor_b32 v10, 65952, v6
 v_mfma_f32_16x16x32_bf16 v[204:207], a[108:111], a[156:159], v[204:207]
 s_waitcnt lgkmcnt(6)
 ds_read_b64_tr_b16 a[88:89], v10 offset:0
 buffer_store_dwordx4 v[192:195], v1, s[12:15], s59 offen offset:2048 sc1
 v_mfma_f32_16x16x32_bf16 v[212:215], a[64:67], a[128:131], 0
 ds_read_b64_tr_b16 a[90:91], v10 offset:4096
 v_mul_u32_u24 v120, 1792, v120
 v_mfma_f32_16x16x32_bf16 v[212:215], a[68:71], a[136:139], v[212:215]
 ds_read_b64_tr_b16 a[92:93], v10 offset:16384
 v_and_b32 v121, 7, v0
 v_mfma_f32_16x16x32_bf16 v[212:215], a[72:75], a[144:147], v[212:215]
 s_waitcnt lgkmcnt(7)
 ds_read_b64_tr_b16 a[94:95], v10 offset:20480
 v_xor_b32 v7, 448, v6
 v_mfma_f32_16x16x32_bf16 v[212:215], a[76:79], a[152:155], v[212:215]
 ds_read_b64_tr_b16 a[96:97], v7 offset:0
 v_lshl_add_u32 v120, v121, 4, v120
 v_mfma_f32_16x16x32_bf16 v[220:223], a[64:67], a[132:135], 0
 ds_read_b64_tr_b16 a[98:99], v7 offset:4096
 v_add_u32 v120, s38, v120
 v_mfma_f32_16x16x32_bf16 v[220:223], a[68:71], a[140:143], v[220:223]
 ds_read_b64_tr_b16 a[100:101], v7 offset:16384
 v_lshlrev_b32 v121, 6, v121
 v_mfma_f32_16x16x32_bf16 v[220:223], a[72:75], a[148:151], v[220:223]
 s_add_u32 s59, s56, 49152
 ds_read_b64_tr_b16 a[102:103], v7 offset:20480
 v_xor_b32 v8, 65984, v6
 v_mfma_f32_16x16x32_bf16 v[220:223], a[76:79], a[156:159], v[220:223]
 s_waitcnt lgkmcnt(6)
 ds_read_b64_tr_b16 a[104:105], v8 offset:0
 buffer_store_dwordx4 v[200:203], v1, s[12:15], s59 offen offset:2048 sc1
 v_mfma_f32_16x16x32_bf16 v[228:231], a[80:83], a[128:131], 0
 ds_read_b64_tr_b16 a[106:107], v8 offset:4096
 v_subrev_u32 v122, 2688, v120
 v_mfma_f32_16x16x32_bf16 v[228:231], a[84:87], a[136:139], v[228:231]
 ds_read_b64_tr_b16 a[108:109], v8 offset:16384
 v_subrev_u32 v123, 1792, v120
 v_mfma_f32_16x16x32_bf16 v[228:231], a[88:91], a[144:147], v[228:231]
 s_waitcnt lgkmcnt(7)
 ds_read_b64_tr_b16 a[110:111], v8 offset:20480
 v_xor_b32 v9, 480, v6
 v_mfma_f32_16x16x32_bf16 v[228:231], a[92:95], a[152:155], v[228:231]
 ds_read_b64_tr_b16 a[64:65], v9 offset:0
 v_subrev_u32 v128, 896, v120
 v_mfma_f32_16x16x32_bf16 v[236:239], a[80:83], a[132:135], 0
 ds_read_b64_tr_b16 a[66:67], v9 offset:4096
 v_cndmask_b32 v3, 0, v15, vcc
 v_mfma_f32_16x16x32_bf16 v[236:239], a[84:87], a[140:143], v[236:239]
 ds_read_b64_tr_b16 a[68:69], v9 offset:16384
 v_accvgpr_write_b32 a227, v3
 v_mfma_f32_16x16x32_bf16 v[236:239], a[88:91], a[148:151], v[236:239]
 s_add_u32 s59, s56, 40960
 ds_read_b64_tr_b16 a[70:71], v9 offset:20480
 v_xor_b32 v10, 66016, v6
 v_mfma_f32_16x16x32_bf16 v[236:239], a[92:95], a[156:159], v[236:239]
 s_waitcnt lgkmcnt(6)
 ds_read_b64_tr_b16 a[72:73], v10 offset:0
 buffer_store_dwordx4 v[208:211], v1, s[12:15], s59 offen offset:2048 sc1
 v_mfma_f32_16x16x32_bf16 v[244:247], a[96:99], a[128:131], 0
 ds_read_b64_tr_b16 a[74:75], v10 offset:4096
 v_cmp_gt_i32 vcc, 16, v14
 v_mfma_f32_16x16x32_bf16 v[244:247], a[100:103], a[136:139], v[244:247]
 s_waitcnt vmcnt(25)
 ds_read_b64_tr_b16 a[76:77], v10 offset:16384
 v_xor_b32 v7, 32768, v6
 v_mfma_f32_16x16x32_bf16 v[244:247], a[104:107], a[144:147], v[244:247]
 s_waitcnt lgkmcnt(7)
 s_barrier
 ds_read_b64_tr_b16 a[78:79], v10 offset:20480
 v_mfma_f32_16x16x32_bf16 v[244:247], a[108:111], a[152:155], v[244:247]
 ds_read_b64_tr_b16 a[80:81], v7 offset:0
 v_cndmask_b32 v3, 0, v15, vcc
 v_mfma_f32_16x16x32_bf16 v[252:255], a[96:99], a[132:135], 0
 ds_read_b64_tr_b16 a[82:83], v7 offset:4096
 v_accvgpr_write_b32 a228, v3
 v_mfma_f32_16x16x32_bf16 v[252:255], a[100:103], a[140:143], v[252:255]
 ds_read_b64_tr_b16 a[84:85], v7 offset:16384
 v_cmp_gt_i32 vcc, 17, v14
 v_mfma_f32_16x16x32_bf16 v[252:255], a[104:107], a[148:151], v[252:255]
 s_add_u32 s59, s56, 32768
 ds_read_b64_tr_b16 a[86:87], v7 offset:20480
 v_xor_b32 v8, 98304, v6
 v_mfma_f32_16x16x32_bf16 v[252:255], a[108:111], a[156:159], v[252:255]
 s_waitcnt lgkmcnt(6)
 ds_read_b64_tr_b16 a[88:89], v8 offset:0
 buffer_store_dwordx4 v[216:219], v1, s[12:15], s59 offen offset:2048 sc1
 v_mfma_f32_16x16x32_bf16 v[16:19], a[64:67], a[128:131], 0
 ds_read_b64_tr_b16 a[90:91], v8 offset:4096
 v_cndmask_b32 v3, 0, v15, vcc
 v_mfma_f32_16x16x32_bf16 v[16:19], a[68:71], a[136:139], v[16:19]
 ds_read_b64_tr_b16 a[92:93], v8 offset:16384
 v_accvgpr_write_b32 a229, v3
 v_mfma_f32_16x16x32_bf16 v[16:19], a[72:75], a[144:147], v[16:19]
 s_waitcnt lgkmcnt(7)
 ds_read_b64_tr_b16 a[94:95], v8 offset:20480
 v_xor_b32 v9, 32800, v6
 v_mfma_f32_16x16x32_bf16 v[16:19], a[76:79], a[152:155], v[16:19]
 ds_read_b64_tr_b16 a[96:97], v9 offset:0
 v_cmp_gt_i32 vcc, 18, v14
 v_mfma_f32_16x16x32_bf16 v[24:27], a[64:67], a[132:135], 0
 s_waitcnt lgkmcnt(9)
 ds_read_b64_tr_b16 a[98:99], v9 offset:4096
 v_cndmask_b32 v3, 0, v15, vcc
 v_mfma_f32_16x16x32_bf16 v[24:27], a[68:71], a[140:143], v[24:27]
 s_barrier
 ds_read_b64_tr_b16 a[100:101], v9 offset:16384
 v_accvgpr_write_b32 a230, v3
 v_mfma_f32_16x16x32_bf16 v[24:27], a[72:75], a[148:151], v[24:27]
 s_add_u32 m0, s29, 0
 ds_read_b64_tr_b16 a[102:103], v9 offset:20480
 v_xor_b32 v10, 98336, v6
 v_mfma_f32_16x16x32_bf16 v[24:27], a[76:79], a[156:159], v[24:27]
 s_waitcnt lgkmcnt(6)
 ds_read_b64_tr_b16 a[104:105], v10 offset:0
 v_add_u32 v2, 0x80000, v2
 v_mfma_f32_16x16x32_bf16 v[28:31], a[80:83], a[160:163], v[28:31]
 ds_read_b64_tr_b16 a[106:107], v10 offset:4096
 buffer_load_dwordx4 v2, s[16:19], 0 offen lds
 v_mfma_f32_16x16x32_bf16 v[28:31], a[84:87], a[168:171], v[28:31]
 s_add_u32 s59, s56, 57344
 ds_read_b64_tr_b16 a[108:109], v10 offset:16384
 v_cmp_gt_i32 vcc, 19, v14
 v_mfma_f32_16x16x32_bf16 v[28:31], a[88:91], a[176:179], v[28:31]
 s_waitcnt lgkmcnt(7)
 ds_read_b64_tr_b16 a[110:111], v10 offset:20480
 v_xor_b32 v7, 32832, v6
 v_mfma_f32_16x16x32_bf16 v[28:31], a[92:95], a[184:187], v[28:31]
 ds_read_b64_tr_b16 a[64:65], v7 offset:0
 buffer_store_dwordx4 v[224:227], v1, s[12:15], s59 offen offset:3072 sc1
 v_mfma_f32_16x16x32_bf16 v[44:47], a[80:83], a[164:167], v[44:47]
 s_add_u32 m0, s29, 4096
 ds_read_b64_tr_b16 a[66:67], v7 offset:4096
 v_add_u32 v4, 4096, v1
 v_mfma_f32_16x16x32_bf16 v[44:47], a[84:87], a[172:175], v[44:47]
 ds_read_b64_tr_b16 a[68:69], v7 offset:16384
 buffer_load_dwordx4 v2, s[16:19], s48 offen lds
 v_mfma_f32_16x16x32_bf16 v[44:47], a[88:91], a[180:183], v[44:47]
 ds_read_b64_tr_b16 a[70:71], v7 offset:20480
 v_xor_b32 v8, 98368, v6
 v_mfma_f32_16x16x32_bf16 v[44:47], a[92:95], a[188:191], v[44:47]
 s_waitcnt lgkmcnt(6)
 ds_read_b64_tr_b16 a[72:73], v8 offset:0
 v_cndmask_b32 v3, 0, v15, vcc
 v_mfma_f32_16x16x32_bf16 v[52:55], a[96:99], a[160:163], v[52:55]
 ds_read_b64_tr_b16 a[74:75], v8 offset:4096
 v_accvgpr_write_b32 a231, v3
 v_mfma_f32_16x16x32_bf16 v[52:55], a[100:103], a[168:171], v[52:55]
 s_add_u32 m0, s29, 8192
 ds_read_b64_tr_b16 a[76:77], v8 offset:16384
 v_cmp_gt_i32 vcc, 32, v14
 v_mfma_f32_16x16x32_bf16 v[52:55], a[104:107], a[176:179], v[52:55]
 s_waitcnt lgkmcnt(7)
 ds_read_b64_tr_b16 a[78:79], v8 offset:20480
 v_xor_b32 v9, 32864, v6
 v_mfma_f32_16x16x32_bf16 v[52:55], a[108:111], a[184:187], v[52:55]
 ds_read_b64_tr_b16 a[80:81], v9 offset:0
 buffer_load_dwordx4 v2, s[16:19], s49 offen lds
 v_mfma_f32_16x16x32_bf16 v[60:63], a[96:99], a[164:167], v[60:63]
 s_add_u32 s59, s56, 49152
 ds_read_b64_tr_b16 a[82:83], v9 offset:4096
 v_cndmask_b32 v3, 0, v15, vcc
 v_mfma_f32_16x16x32_bf16 v[60:63], a[100:103], a[172:175], v[60:63]
 ds_read_b64_tr_b16 a[84:85], v9 offset:16384
 buffer_store_dwordx4 v[232:235], v1, s[12:15], s59 offen offset:3072 sc1
 v_mfma_f32_16x16x32_bf16 v[60:63], a[104:107], a[180:183], v[60:63]
 s_add_u32 m0, s29, 12288
 ds_read_b64_tr_b16 a[86:87], v9 offset:20480
 v_xor_b32 v10, 98400, v6
 v_mfma_f32_16x16x32_bf16 v[60:63], a[108:111], a[188:191], v[60:63]
 s_waitcnt lgkmcnt(6)
 ds_read_b64_tr_b16 a[88:89], v10 offset:0
 v_accvgpr_write_b32 a232, v3
 v_mfma_f32_16x16x32_bf16 v[20:23], a[64:67], a[160:163], v[20:23]
 ds_read_b64_tr_b16 a[90:91], v10 offset:4096
 buffer_load_dwordx4 v2, s[16:19], s50 offen lds
 v_mfma_f32_16x16x32_bf16 v[20:23], a[68:71], a[168:171], v[20:23]
 ds_read_b64_tr_b16 a[92:93], v10 offset:16384
 v_cmp_gt_i32 vcc, 33, v14
 v_mfma_f32_16x16x32_bf16 v[20:23], a[72:75], a[176:179], v[20:23]
 s_waitcnt lgkmcnt(7)
 ds_read_b64_tr_b16 a[94:95], v10 offset:20480
 v_xor_b32 v7, 32896, v6
 v_mfma_f32_16x16x32_bf16 v[20:23], a[76:79], a[184:187], v[20:23]
 ds_read_b64_tr_b16 a[96:97], v7 offset:0
 v_cndmask_b32 v3, 0, v15, vcc
 v_mfma_f32_16x16x32_bf16 v[36:39], a[64:67], a[164:167], v[36:39]
 s_add_u32 m0, s29, 16384
 ds_read_b64_tr_b16 a[98:99], v7 offset:4096
 v_accvgpr_write_b32 a233, v3
 v_mfma_f32_16x16x32_bf16 v[36:39], a[68:71], a[172:175], v[36:39]
 ds_read_b64_tr_b16 a[100:101], v7 offset:16384
 buffer_load_dwordx4 v2, s[16:19], s51 offen lds
 v_mfma_f32_16x16x32_bf16 v[36:39], a[72:75], a[180:183], v[36:39]
 s_add_u32 s59, s56, 40960
 ds_read_b64_tr_b16 a[102:103], v7 offset:20480
 v_xor_b32 v8, 98432, v6
 v_mfma_f32_16x16x32_bf16 v[36:39], a[76:79], a[188:191], v[36:39]
 s_waitcnt lgkmcnt(6)
 ds_read_b64_tr_b16 a[104:105], v8 offset:0
 buffer_store_dwordx4 v[240:243], v1, s[12:15], s59 offen offset:3072 sc1
 v_mfma_f32_16x16x32_bf16 v[68:71], a[80:83], a[160:163], v[68:71]
 ds_read_b64_tr_b16 a[106:107], v8 offset:4096
 v_cmp_gt_i32 vcc, 34, v14
 v_mfma_f32_16x16x32_bf16 v[68:71], a[84:87], a[168:171], v[68:71]
 s_add_u32 m0, s29, 20480
 ds_read_b64_tr_b16 a[108:109], v8 offset:16384
 v_cndmask_b32 v3, 0, v15, vcc
 v_mfma_f32_16x16x32_bf16 v[68:71], a[88:91], a[176:179], v[68:71]
 s_waitcnt lgkmcnt(7)
 ds_read_b64_tr_b16 a[110:111], v8 offset:20480
 v_xor_b32 v9, 32928, v6
 v_mfma_f32_16x16x32_bf16 v[68:71], a[92:95], a[184:187], v[68:71]
 ds_read_b64_tr_b16 a[64:65], v9 offset:0
 buffer_load_dwordx4 v2, s[16:19], s52 offen lds
 v_mfma_f32_16x16x32_bf16 v[76:79], a[80:83], a[164:167], v[76:79]
 ds_read_b64_tr_b16 a[66:67], v9 offset:4096
 v_accvgpr_write_b32 a234, v3
 v_mfma_f32_16x16x32_bf16 v[76:79], a[84:87], a[172:175], v[76:79]
 ds_read_b64_tr_b16 a[68:69], v9 offset:16384
 v_cmp_gt_i32 vcc, 35, v14
 v_mfma_f32_16x16x32_bf16 v[76:79], a[88:91], a[180:183], v[76:79]
 s_add_u32 m0, s29, 24576
 ds_read_b64_tr_b16 a[70:71], v9 offset:20480
 v_xor_b32 v10, 98464, v6
 v_mfma_f32_16x16x32_bf16 v[76:79], a[92:95], a[188:191], v[76:79]
 s_waitcnt lgkmcnt(6)
 ds_read_b64_tr_b16 a[72:73], v10 offset:0
 v_cndmask_b32 v3, 0, v15, vcc
 v_mfma_f32_16x16x32_bf16 v[84:87], a[96:99], a[160:163], v[84:87]
 ds_read_b64_tr_b16 a[74:75], v10 offset:4096
 buffer_load_dwordx4 v2, s[16:19], s53 offen lds
 v_mfma_f32_16x16x32_bf16 v[84:87], a[100:103], a[168:171], v[84:87]
 s_add_u32 s59, s56, 32768
 ds_read_b64_tr_b16 a[76:77], v10 offset:16384
 v_accvgpr_write_b32 a235, v3
 v_mfma_f32_16x16x32_bf16 v[84:87], a[104:107], a[176:179], v[84:87]
 s_waitcnt lgkmcnt(7)
 ds_read_b64_tr_b16 a[78:79], v10 offset:20480
 v_xor_b32 v7, 32960, v6
 v_mfma_f32_16x16x32_bf16 v[84:87], a[108:111], a[184:187], v[84:87]
 ds_read_b64_tr_b16 a[80:81], v7 offset:0
 buffer_store_dwordx4 v[248:251], v1, s[12:15], s59 offen offset:3072 sc1
 v_mfma_f32_16x16x32_bf16 v[92:95], a[96:99], a[164:167], v[92:95]
 s_add_u32 m0, s29, 28672
 ds_read_b64_tr_b16 a[82:83], v7 offset:4096
 v_cmp_gt_i32 vcc, 48, v14
 v_mfma_f32_16x16x32_bf16 v[92:95], a[100:103], a[172:175], v[92:95]
 ds_read_b64_tr_b16 a[84:85], v7 offset:16384
 buffer_load_dwordx4 v2, s[16:19], s54 offen lds
 v_mfma_f32_16x16x32_bf16 v[92:95], a[104:107], a[180:183], v[92:95]
 ds_read_b64_tr_b16 a[86:87], v7 offset:20480
 v_xor_b32 v8, 98496, v6
 v_mfma_f32_16x16x32_bf16 v[92:95], a[108:111], a[188:191], v[92:95]
 s_waitcnt lgkmcnt(6)
 ds_read_b64_tr_b16 a[88:89], v8 offset:0
 v_cndmask_b32 v3, 0, v15, vcc
 v_mfma_f32_16x16x32_bf16 v[100:103], a[64:67], a[160:163], v[100:103]
 s_add_u32 m0, s29, 65536
 ds_read_b64_tr_b16 a[90:91], v8 offset:4096
 v_add_u32 v2, 0x80000, v2
 v_mfma_f32_16x16x32_bf16 v[100:103], a[68:71], a[168:171], v[100:103]
 ds_read_b64_tr_b16 a[92:93], v8 offset:16384
 buffer_load_dwordx4 v2, s[16:19], 0 offen lds
 v_mfma_f32_16x16x32_bf16 v[100:103], a[72:75], a[176:179], v[100:103]
 s_waitcnt lgkmcnt(7)
 ds_read_b64_tr_b16 a[94:95], v8 offset:20480
 v_xor_b32 v9, 32992, v6
 v_mfma_f32_16x16x32_bf16 v[100:103], a[76:79], a[184:187], v[100:103]
 ds_read_b64_tr_b16 a[96:97], v9 offset:0
 v_accvgpr_write_b32 a236, v3
 v_mfma_f32_16x16x32_bf16 v[108:111], a[64:67], a[164:167], v[108:111]
 ds_read_b64_tr_b16 a[98:99], v9 offset:4096
 v_cmp_gt_i32 vcc, 49, v14
 v_mfma_f32_16x16x32_bf16 v[108:111], a[68:71], a[172:175], v[108:111]
 ds_read_b64_tr_b16 a[100:101], v9 offset:16384
 v_cndmask_b32 v3, 0, v15, vcc
 v_mfma_f32_16x16x32_bf16 v[108:111], a[72:75], a[180:183], v[108:111]
 s_add_u32 m0, s29, 69632
 ds_read_b64_tr_b16 a[102:103], v9 offset:20480
 v_xor_b32 v10, 98528, v6
 v_mfma_f32_16x16x32_bf16 v[108:111], a[76:79], a[188:191], v[108:111]
 s_waitcnt lgkmcnt(6)
 ds_read_b64_tr_b16 a[104:105], v10 offset:0
 buffer_load_dwordx4 v2, s[16:19], s48 offen lds
 v_mfma_f32_16x16x32_bf16 v[116:119], a[80:83], a[160:163], v[116:119]
 ds_read_b64_tr_b16 a[106:107], v10 offset:4096
 v_accvgpr_write_b32 a237, v3
 v_mfma_f32_16x16x32_bf16 v[116:119], a[84:87], a[168:171], v[116:119]
 ds_read_b64_tr_b16 a[108:109], v10 offset:16384
 v_cmp_gt_i32 vcc, 50, v14
 v_mfma_f32_16x16x32_bf16 v[116:119], a[88:91], a[176:179], v[116:119]
 s_waitcnt lgkmcnt(7)
 ds_read_b64_tr_b16 a[110:111], v10 offset:20480
 v_xor_b32 v7, 33024, v6
 v_mfma_f32_16x16x32_bf16 v[116:119], a[92:95], a[184:187], v[116:119]
 s_add_u32 m0, s29, 73728
 ds_read_b64_tr_b16 a[64:65], v7 offset:0
 v_cndmask_b32 v3, 0, v15, vcc
 v_mfma_f32_16x16x32_bf16 v[124:127], a[80:83], a[164:167], v[124:127]
 ds_read_b64_tr_b16 a[66:67], v7 offset:4096
 buffer_load_dwordx4 v2, s[16:19], s49 offen lds
 v_mfma_f32_16x16x32_bf16 v[124:127], a[84:87], a[172:175], v[124:127]
 ds_read_b64_tr_b16 a[68:69], v7 offset:16384
 v_accvgpr_write_b32 a238, v3
 v_mfma_f32_16x16x32_bf16 v[124:127], a[88:91], a[180:183], v[124:127]
 ds_read_b64_tr_b16 a[70:71], v7 offset:20480
 v_xor_b32 v8, 98560, v6
 v_mfma_f32_16x16x32_bf16 v[124:127], a[92:95], a[188:191], v[124:127]
 s_waitcnt lgkmcnt(6)
 ds_read_b64_tr_b16 a[72:73], v8 offset:0
 v_cmp_gt_i32 vcc, 51, v14
 v_mfma_f32_16x16x32_bf16 v[132:135], a[96:99], a[160:163], v[132:135]
 s_add_u32 m0, s29, 77824
 ds_read_b64_tr_b16 a[74:75], v8 offset:4096
 v_cndmask_b32 v3, 0, v15, vcc
 v_mfma_f32_16x16x32_bf16 v[132:135], a[100:103], a[168:171], v[132:135]
 ds_read_b64_tr_b16 a[76:77], v8 offset:16384
 buffer_load_dwordx4 v2, s[16:19], s50 offen lds
 v_mfma_f32_16x16x32_bf16 v[132:135], a[104:107], a[176:179], v[132:135]
 s_waitcnt lgkmcnt(7)
 ds_read_b64_tr_b16 a[78:79], v8 offset:20480
 v_xor_b32 v9, 33056, v6
 v_mfma_f32_16x16x32_bf16 v[132:135], a[108:111], a[184:187], v[132:135]
 ds_read_b64_tr_b16 a[80:81], v9 offset:0
 v_accvgpr_write_b32 a239, v3
 v_mfma_f32_16x16x32_bf16 v[140:143], a[96:99], a[164:167], v[140:143]
 ds_read_b64_tr_b16 a[82:83], v9 offset:4096
 v_mfma_f32_16x16x32_bf16 v[140:143], a[100:103], a[172:175], v[140:143]
 ds_read_b64_tr_b16 a[84:85], v9 offset:16384
 v_mfma_f32_16x16x32_bf16 v[140:143], a[104:107], a[180:183], v[140:143]
 s_add_u32 m0, s29, 81920
 ds_read_b64_tr_b16 a[86:87], v9 offset:20480
 v_xor_b32 v10, 98592, v6
 v_mfma_f32_16x16x32_bf16 v[140:143], a[108:111], a[188:191], v[140:143]
 s_waitcnt lgkmcnt(6)
 ds_read_b64_tr_b16 a[88:89], v10 offset:0
 buffer_load_dwordx4 v2, s[16:19], s51 offen lds
 v_mfma_f32_16x16x32_bf16 v[148:151], a[64:67], a[160:163], v[148:151]
 ds_read_b64_tr_b16 a[90:91], v10 offset:4096
 v_mfma_f32_16x16x32_bf16 v[148:151], a[68:71], a[168:171], v[148:151]
 ds_read_b64_tr_b16 a[92:93], v10 offset:16384
 v_mfma_f32_16x16x32_bf16 v[148:151], a[72:75], a[176:179], v[148:151]
 s_waitcnt lgkmcnt(7)
 ds_read_b64_tr_b16 a[94:95], v10 offset:20480
 v_xor_b32 v7, 33088, v6
 v_mfma_f32_16x16x32_bf16 v[148:151], a[76:79], a[184:187], v[148:151]
 s_add_u32 m0, s29, 86016
 ds_read_b64_tr_b16 a[96:97], v7 offset:0
 v_mfma_f32_16x16x32_bf16 v[156:159], a[64:67], a[164:167], v[156:159]
 ds_read_b64_tr_b16 a[98:99], v7 offset:4096
 buffer_load_dwordx4 v2, s[16:19], s52 offen lds
 v_mfma_f32_16x16x32_bf16 v[156:159], a[68:71], a[172:175], v[156:159]
 ds_read_b64_tr_b16 a[100:101], v7 offset:16384
 v_mfma_f32_16x16x32_bf16 v[156:159], a[72:75], a[180:183], v[156:159]
 ds_read_b64_tr_b16 a[102:103], v7 offset:20480
 v_xor_b32 v8, 98624, v6
 v_mfma_f32_16x16x32_bf16 v[156:159], a[76:79], a[188:191], v[156:159]
 s_waitcnt lgkmcnt(6)
 ds_read_b64_tr_b16 a[104:105], v8 offset:0
 v_mfma_f32_16x16x32_bf16 v[164:167], a[80:83], a[160:163], v[164:167]
 s_add_u32 m0, s29, 90112
 ds_read_b64_tr_b16 a[106:107], v8 offset:4096
 v_mfma_f32_16x16x32_bf16 v[164:167], a[84:87], a[168:171], v[164:167]
 ds_read_b64_tr_b16 a[108:109], v8 offset:16384
 buffer_load_dwordx4 v2, s[16:19], s53 offen lds
 v_mfma_f32_16x16x32_bf16 v[164:167], a[88:91], a[176:179], v[164:167]
 s_waitcnt lgkmcnt(7)
 ds_read_b64_tr_b16 a[110:111], v8 offset:20480
 v_xor_b32 v9, 33120, v6
 v_mfma_f32_16x16x32_bf16 v[164:167], a[92:95], a[184:187], v[164:167]
 s_waitcnt vmcnt(8)
 ds_read_b64_tr_b16 a[64:65], v9 offset:0
 v_mfma_f32_16x16x32_bf16 v[172:175], a[80:83], a[164:167], v[172:175]
 s_barrier
 ds_read_b64_tr_b16 a[66:67], v9 offset:4096
 v_mfma_f32_16x16x32_bf16 v[172:175], a[84:87], a[172:175], v[172:175]
 ds_read_b64_tr_b16 a[68:69], v9 offset:16384
 buffer_store_dword v11, v11, s[12:15], s92 offen sc1
 v_mfma_f32_16x16x32_bf16 v[172:175], a[88:91], a[180:183], v[172:175]
 s_add_u32 m0, s29, 94208
 ds_read_b64_tr_b16 a[70:71], v9 offset:20480
 v_xor_b32 v10, 98656, v6
 v_mfma_f32_16x16x32_bf16 v[172:175], a[92:95], a[188:191], v[172:175]
 s_waitcnt lgkmcnt(6)
 ds_read_b64_tr_b16 a[72:73], v10 offset:0
 buffer_load_dwordx4 v2, s[16:19], s54 offen lds
 v_mfma_f32_16x16x32_bf16 v[180:183], a[96:99], a[160:163], v[180:183]
 ds_read_b64_tr_b16 a[74:75], v10 offset:4096
 v_mfma_f32_16x16x32_bf16 v[180:183], a[100:103], a[168:171], v[180:183]
 ds_read_b64_tr_b16 a[76:77], v10 offset:16384
 v_mfma_f32_16x16x32_bf16 v[180:183], a[104:107], a[176:179], v[180:183]
 s_waitcnt lgkmcnt(7)
 ds_read_b64_tr_b16 a[78:79], v10 offset:20480
 v_xor_b32 v7, 33152, v6
 v_mfma_f32_16x16x32_bf16 v[180:183], a[108:111], a[184:187], v[180:183]
 ds_read_b64_tr_b16 a[80:81], v7 offset:0
 v_mfma_f32_16x16x32_bf16 v[188:191], a[96:99], a[164:167], v[188:191]
 ds_read_b64_tr_b16 a[82:83], v7 offset:4096
 v_mfma_f32_16x16x32_bf16 v[188:191], a[100:103], a[172:175], v[188:191]
 ds_read_b64_tr_b16 a[84:85], v7 offset:16384
 v_mfma_f32_16x16x32_bf16 v[188:191], a[104:107], a[180:183], v[188:191]
 ds_read_b64_tr_b16 a[86:87], v7 offset:20480
 v_xor_b32 v8, 98688, v6
 v_mfma_f32_16x16x32_bf16 v[188:191], a[108:111], a[188:191], v[188:191]
 s_waitcnt lgkmcnt(6)
 ds_read_b64_tr_b16 a[88:89], v8 offset:0
 v_mfma_f32_16x16x32_bf16 v[196:199], a[64:67], a[160:163], v[196:199]
 s_and_b32 s58, s92, ~127
 ds_read_b64_tr_b16 a[90:91], v8 offset:4096
 v_mfma_f32_16x16x32_bf16 v[196:199], a[68:71], a[168:171], v[196:199]
 s_lshl_b32 s37, s25, 1
 ds_read_b64_tr_b16 a[92:93], v8 offset:16384
 v_mfma_f32_16x16x32_bf16 v[196:199], a[72:75], a[176:179], v[196:199]
 s_waitcnt lgkmcnt(7)
 ds_read_b64_tr_b16 a[94:95], v8 offset:20480
 v_xor_b32 v9, 33184, v6
 v_mfma_f32_16x16x32_bf16 v[196:199], a[76:79], a[184:187], v[196:199]
 s_sub_i32 s38, 12, s37
 ds_read_b64_tr_b16 a[96:97], v9 offset:0
 v_mfma_f32_16x16x32_bf16 v[204:207], a[64:67], a[164:167], v[204:207]
 s_max_i32 s38, s38, 0
 ds_read_b64_tr_b16 a[98:99], v9 offset:4096
 v_mfma_f32_16x16x32_bf16 v[204:207], a[68:71], a[172:175], v[204:207]
 s_mul_i32 s49, s26, 1048576
 ds_read_b64_tr_b16 a[100:101], v9 offset:16384
 v_mfma_f32_16x16x32_bf16 v[204:207], a[72:75], a[180:183], v[204:207]
 s_lshl_b32 s50, s3, 13
 ds_read_b64_tr_b16 a[102:103], v9 offset:20480
 v_xor_b32 v10, 98720, v6
 v_mfma_f32_16x16x32_bf16 v[204:207], a[76:79], a[188:191], v[204:207]
 s_waitcnt lgkmcnt(6)
 ds_read_b64_tr_b16 a[104:105], v10 offset:0
 v_mfma_f32_16x16x32_bf16 v[212:215], a[80:83], a[160:163], v[212:215]
 s_add_u32 s49, s49, s50
 ds_read_b64_tr_b16 a[106:107], v10 offset:4096
 v_mfma_f32_16x16x32_bf16 v[212:215], a[84:87], a[168:171], v[212:215]
 s_mov_b32 s54, 0
 ds_read_b64_tr_b16 a[108:109], v10 offset:16384
 v_mfma_f32_16x16x32_bf16 v[212:215], a[88:91], a[176:179], v[212:215]
 s_waitcnt lgkmcnt(7)
 ds_read_b64_tr_b16 a[110:111], v10 offset:20480
 v_xor_b32 v7, 33216, v6
 v_mfma_f32_16x16x32_bf16 v[212:215], a[92:95], a[184:187], v[212:215]
 s_add_u32 s44, s37, 1
 ds_read_b64_tr_b16 a[64:65], v7 offset:0
 v_mfma_f32_16x16x32_bf16 v[220:223], a[80:83], a[164:167], v[220:223]
 s_mov_b32 s42, s49
 ds_read_b64_tr_b16 a[66:67], v7 offset:4096
 v_mfma_f32_16x16x32_bf16 v[220:223], a[84:87], a[172:175], v[220:223]
 s_add_u32 s60, s94, 4
 ds_read_b64_tr_b16 a[68:69], v7 offset:16384
 v_mfma_f32_16x16x32_bf16 v[220:223], a[88:91], a[180:183], v[220:223]
 s_mov_b32 s45, 2
 ds_read_b64_tr_b16 a[70:71], v7 offset:20480
 v_xor_b32 v8, 98752, v6
 v_mfma_f32_16x16x32_bf16 v[220:223], a[92:95], a[188:191], v[220:223]
 s_waitcnt lgkmcnt(6)
 ds_read_b64_tr_b16 a[72:73], v8 offset:0
 buffer_load_dwordx4 v[32:35], v122, s[4:7], 0 offen
 v_mfma_f32_16x16x32_bf16 v[228:231], a[96:99], a[160:163], v[228:231]
 s_mov_b32 s66, 1
 ds_read_b64_tr_b16 a[74:75], v8 offset:4096
 v_mfma_f32_16x16x32_bf16 v[228:231], a[100:103], a[168:171], v[228:231]
 s_mov_b32 s68, 1
 ds_read_b64_tr_b16 a[76:77], v8 offset:16384
 v_mfma_f32_16x16x32_bf16 v[228:231], a[104:107], a[176:179], v[228:231]
 s_waitcnt lgkmcnt(7)
 ds_read_b64_tr_b16 a[78:79], v8 offset:20480
 v_xor_b32 v9, 33248, v6
 v_mfma_f32_16x16x32_bf16 v[228:231], a[108:111], a[184:187], v[228:231]
 ds_read_b64_tr_b16 a[80:81], v9 offset:0
 buffer_load_dwordx4 v[40:43], v123, s[4:7], 0 offen
 v_mfma_f32_16x16x32_bf16 v[236:239], a[96:99], a[164:167], v[236:239]
 s_mov_b32 s70, 32768
 ds_read_b64_tr_b16 a[82:83], v9 offset:4096
 v_mfma_f32_16x16x32_bf16 v[236:239], a[100:103], a[172:175], v[236:239]
 s_mov_b32 s71, s70
 ds_read_b64_tr_b16 a[84:85], v9 offset:16384
 v_mfma_f32_16x16x32_bf16 v[236:239], a[104:107], a[180:183], v[236:239]
 s_add_u32 s43, s42, 16777216
 ds_read_b64_tr_b16 a[86:87], v9 offset:20480
 v_xor_b32 v10, 98784, v6
 v_mfma_f32_16x16x32_bf16 v[236:239], a[108:111], a[188:191], v[236:239]
 s_waitcnt lgkmcnt(6)
 ds_read_b64_tr_b16 a[88:89], v10 offset:0
 buffer_load_dwordx4 v[48:51], v128, s[4:7], 0 offen
 v_mfma_f32_16x16x32_bf16 v[244:247], a[64:67], a[160:163], v[244:247]
 s_mov_b32 s40, s50
 ds_read_b64_tr_b16 a[90:91], v10 offset:4096
 v_mfma_f32_16x16x32_bf16 v[244:247], a[68:71], a[168:171], v[244:247]
 s_waitcnt vmcnt(3)
 ds_read_b64_tr_b16 a[92:93], v10 offset:16384
 v_xor_b32 v7, 131072, v6
 v_mfma_f32_16x16x32_bf16 v[244:247], a[72:75], a[176:179], v[244:247]
 s_waitcnt lgkmcnt(7)
 s_barrier
 ds_read_b64_tr_b16 a[94:95], v10 offset:20480
 v_mfma_f32_16x16x32_bf16 v[244:247], a[76:79], a[184:187], v[244:247]
 ds_read_b64_tr_b16 a[96:97], v7 offset:0
 buffer_load_dwordx4 v[56:59], v120, s[4:7], 0 offen offset:0
 v_mfma_f32_16x16x32_bf16 v[252:255], a[64:67], a[164:167], v[252:255]
 s_add_u32 s41, s50, 0x10000
 ds_read_b64_tr_b16 a[98:99], v7 offset:4096
 v_mfma_f32_16x16x32_bf16 v[252:255], a[68:71], a[172:175], v[252:255]
 s_lshr_b32 s61, s95, 4
 ds_read_b64_tr_b16 a[100:101], v7 offset:16384
 v_mfma_f32_16x16x32_bf16 v[252:255], a[72:75], a[180:183], v[252:255]
 s_lshl_b32 s61, s61, 7
 ds_read_b64_tr_b16 a[102:103], v7 offset:20480
 v_xor_b32 v8, 0, v6
 v_mfma_f32_16x16x32_bf16 v[252:255], a[76:79], a[188:191], v[252:255]
 s_waitcnt lgkmcnt(6)
 ds_read_b64_tr_b16 a[104:105], v8 offset:0
 buffer_load_dwordx4 v[64:67], v120, s[4:7], 0 offen offset:896
 v_mfma_f32_16x16x32_bf16 v[16:19], a[80:83], a[160:163], v[16:19]
 s_add_u32 s61, s61, 84959232
 ds_read_b64_tr_b16 a[106:107], v8 offset:4096
 v_mfma_f32_16x16x32_bf16 v[16:19], a[84:87], a[168:171], v[16:19]
 s_mov_b32 s47, 0x4b800000
 ds_read_b64_tr_b16 a[108:109], v8 offset:16384
 v_mfma_f32_16x16x32_bf16 v[16:19], a[88:91], a[176:179], v[16:19]
 s_waitcnt lgkmcnt(7)
 ds_read_b64_tr_b16 a[110:111], v8 offset:20480
 v_xor_b32 v9, 65536, v6
 v_mfma_f32_16x16x32_bf16 v[16:19], a[92:95], a[184:187], v[16:19]
 ds_read_b64_tr_b16 a[64:65], v9 offset:0
 buffer_load_dwordx4 v[72:75], v120, s[8:11], 0 offen offset:0
 v_mfma_f32_16x16x32_bf16 v[24:27], a[80:83], a[164:167], v[24:27]
 s_lshl_b32 s30, s95, 1
 ds_read_b64_tr_b16 a[66:67], v9 offset:4096
 v_mfma_f32_16x16x32_bf16 v[24:27], a[84:87], a[172:175], v[24:27]
 s_lshr_b32 s31, s3, 1
 ds_read_b64_tr_b16 a[68:69], v9 offset:16384
 v_mfma_f32_16x16x32_bf16 v[24:27], a[88:91], a[180:183], v[24:27]
 s_add_u32 s30, s30, s31
 ds_read_b64_tr_b16 a[70:71], v9 offset:20480
 v_xor_b32 v10, 131104, v6
 v_mfma_f32_16x16x32_bf16 v[24:27], a[92:95], a[188:191], v[24:27]
 s_waitcnt lgkmcnt(6)
 ds_read_b64_tr_b16 a[72:73], v10 offset:0
 buffer_load_dwordx4 v[80:83], v120, s[8:11], 0 offen offset:896
 v_mfma_f32_16x16x32_bf16 v[28:31], a[96:99], a[192:195], v[28:31]
 s_min_u32 s30, s30, 223
 ds_read_b64_tr_b16 a[74:75], v10 offset:4096
 v_mfma_f32_16x16x32_bf16 v[28:31], a[100:103], a[200:203], v[28:31]
 s_lshl_b32 s30, s30, 2
 ds_read_b64_tr_b16 a[76:77], v10 offset:16384
 v_mfma_f32_16x16x32_bf16 v[28:31], a[104:107], a[208:211], v[28:31]
 s_waitcnt lgkmcnt(3)
 ds_read_b64_tr_b16 a[78:79], v10 offset:20480
 v_xor_b32 v7, 32, v6
 v_mfma_f32_16x16x32_bf16 v[28:31], a[108:111], a[216:219], v[28:31]
 ds_read_b64_tr_b16 a[80:81], v7 offset:0
 buffer_load_dwordx4 v[88:91], v121, s[20:23], s39 offen offset:0
 v_mfma_f32_16x16x32_bf16 v[28:31], a[64:67], a[112:115], v[28:31]
 ds_read_b64_tr_b16 a[82:83], v7 offset:4096
 v_mfma_f32_16x16x32_bf16 v[28:31], a[68:71], a[120:123], v[28:31]
 ds_read_b64_tr_b16 a[84:85], v7 offset:16384
 v_mfma_f32_16x16x32_bf16 v[44:47], a[96:99], a[196:199], v[44:47]
 ds_read_b64_tr_b16 a[86:87], v7 offset:20480
 v_xor_b32 v8, 65568, v6
 v_mfma_f32_16x16x32_bf16 v[44:47], a[100:103], a[204:207], v[44:47]
 ds_read_b64_tr_b16 a[88:89], v8 offset:0
 buffer_load_dwordx4 v[96:99], v121, s[20:23], s39 offen offset:16
 v_mfma_f32_16x16x32_bf16 v[44:47], a[104:107], a[212:215], v[44:47]
 ds_read_b64_tr_b16 a[90:91], v8 offset:4096
 v_mfma_f32_16x16x32_bf16 v[44:47], a[108:111], a[220:223], v[44:47]
 ds_read_b64_tr_b16 a[92:93], v8 offset:16384
 v_mfma_f32_16x16x32_bf16 v[44:47], a[64:67], a[116:119], v[44:47]
 ds_read_b64_tr_b16 a[94:95], v8 offset:20480
 v_xor_b32 v9, 131136, v6
 v_mfma_f32_16x16x32_bf16 v[44:47], a[68:71], a[124:127], v[44:47]
 s_waitcnt lgkmcnt(6)
 ds_read_b64_tr_b16 a[96:97], v9 offset:0
 buffer_load_dwordx4 v[104:107], v121, s[20:23], s39 offen offset:32
 v_mfma_f32_16x16x32_bf16 v[52:55], a[72:75], a[192:195], v[52:55]
 ds_read_b64_tr_b16 a[98:99], v9 offset:4096
 v_mfma_f32_16x16x32_bf16 v[52:55], a[76:79], a[200:203], v[52:55]
 ds_read_b64_tr_b16 a[100:101], v9 offset:16384
 v_mfma_f32_16x16x32_bf16 v[52:55], a[80:83], a[208:211], v[52:55]
 s_waitcnt lgkmcnt(3)
 ds_read_b64_tr_b16 a[102:103], v9 offset:20480
 v_xor_b32 v10, 64, v6
 v_mfma_f32_16x16x32_bf16 v[52:55], a[84:87], a[216:219], v[52:55]
 ds_read_b64_tr_b16 a[104:105], v10 offset:0
 buffer_load_dwordx4 v[112:115], v121, s[20:23], s39 offen offset:48
 v_mfma_f32_16x16x32_bf16 v[52:55], a[88:91], a[112:115], v[52:55]
 ds_read_b64_tr_b16 a[106:107], v10 offset:4096
 v_mfma_f32_16x16x32_bf16 v[52:55], a[92:95], a[120:123], v[52:55]
 ds_read_b64_tr_b16 a[108:109], v10 offset:16384
 v_mfma_f32_16x16x32_bf16 v[60:63], a[72:75], a[196:199], v[60:63]
 ds_read_b64_tr_b16 a[110:111], v10 offset:20480
 v_xor_b32 v7, 65600, v6
 v_mfma_f32_16x16x32_bf16 v[60:63], a[76:79], a[204:207], v[60:63]
 ds_read_b64_tr_b16 a[64:65], v7 offset:0
 v_mfma_f32_16x16x32_bf16 v[60:63], a[80:83], a[212:215], v[60:63]
 s_and_b32 s4, s2, 127
 ds_read_b64_tr_b16 a[66:67], v7 offset:4096
 v_mfma_f32_16x16x32_bf16 v[60:63], a[84:87], a[220:223], v[60:63]
 s_lshl_b32 s4, s4, 2
 ds_read_b64_tr_b16 a[68:69], v7 offset:16384
 v_mfma_f32_16x16x32_bf16 v[60:63], a[88:91], a[116:119], v[60:63]
 s_add_u32 s4, s4, s3
 ds_read_b64_tr_b16 a[70:71], v7 offset:20480
 v_xor_b32 v8, 131168, v6
 v_mfma_f32_16x16x32_bf16 v[60:63], a[92:95], a[124:127], v[60:63]
 s_waitcnt lgkmcnt(6)
 ds_read_b64_tr_b16 a[72:73], v8 offset:0
 v_mfma_f32_16x16x32_bf16 v[20:23], a[96:99], a[192:195], v[20:23]
 s_mul_i32 s5, s4, 17408
 ds_read_b64_tr_b16 a[74:75], v8 offset:4096
 v_mfma_f32_16x16x32_bf16 v[20:23], a[100:103], a[200:203], v[20:23]
 s_add_u32 s5, s5, 50331648
 ds_read_b64_tr_b16 a[76:77], v8 offset:16384
 v_mul_f32 v28, s34, v28
 v_mfma_f32_16x16x32_bf16 v[20:23], a[104:107], a[208:211], v[20:23]
 s_waitcnt lgkmcnt(3)
 ds_read_b64_tr_b16 a[78:79], v8 offset:20480
 v_xor_b32 v9, 96, v6
 v_mfma_f32_16x16x32_bf16 v[20:23], a[108:111], a[216:219], v[20:23]
 s_add_u32 s4, s5, 0x2000
 ds_read_b64_tr_b16 a[80:81], v9 offset:0
 v_mul_f32 v29, s34, v29
 v_mfma_f32_16x16x32_bf16 v[20:23], a[64:67], a[112:115], v[20:23]
 s_mov_b32 s6, 2.0
 ds_read_b64_tr_b16 a[82:83], v9 offset:4096
 v_mul_f32 v30, s34, v30
 v_mfma_f32_16x16x32_bf16 v[20:23], a[68:71], a[120:123], v[20:23]
 s_min_u32 s7, s38, 1
 ds_read_b64_tr_b16 a[84:85], v9 offset:16384
 v_mul_f32 v31, s34, v31
 v_mfma_f32_16x16x32_bf16 v[36:39], a[96:99], a[196:199], v[36:39]
 s_cmp_eq_u32 s44, 1
 s_cselect_b32 s53, 1, 0
 ds_read_b64_tr_b16 a[86:87], v9 offset:20480
 v_xor_b32 v10, 65632, v6
 v_mfma_f32_16x16x32_bf16 v[36:39], a[100:103], a[204:207], v[36:39]
 s_cmp_eq_u32 s38, 0
 s_cmov_b32 s4, 2.0
 ds_read_b64_tr_b16 a[88:89], v10 offset:0
 v_mfma_f32_16x16x32_bf16 v[36:39], a[104:107], a[212:215], v[36:39]
 s_cmp_eq_u32 s38, 0
 s_cmov_b32 s5, 2.0
 ds_read_b64_tr_b16 a[90:91], v10 offset:4096
 v_mfma_f32_16x16x32_bf16 v[36:39], a[108:111], a[220:223], v[36:39]
 s_cmp_eq_u32 s38, 0
 s_cmov_b32 s60, s58
 ds_read_b64_tr_b16 a[92:93], v10 offset:16384
 v_mfma_f32_16x16x32_bf16 v[36:39], a[64:67], a[116:119], v[36:39]
 s_mov_b64 s[8:9], s[12:13]
 ds_read_b64_tr_b16 a[94:95], v10 offset:20480
 v_xor_b32 v7, 131200, v6
 v_mfma_f32_16x16x32_bf16 v[36:39], a[68:71], a[124:127], v[36:39]
 s_waitcnt lgkmcnt(6)
 ds_read_b64_tr_b16 a[96:97], v7 offset:0
 v_mul_f32 v52, s34, v52
 v_mfma_f32_16x16x32_bf16 v[68:71], a[72:75], a[192:195], v[68:71]
 s_mov_b32 s10, s14
 ds_read_b64_tr_b16 a[98:99], v7 offset:4096
 v_mul_f32 v53, s34, v53
 v_mfma_f32_16x16x32_bf16 v[68:71], a[76:79], a[200:203], v[68:71]
 s_mov_b32 s76, 0
 ds_read_b64_tr_b16 a[100:101], v7 offset:16384
 v_mul_f32 v54, s34, v54
 v_mfma_f32_16x16x32_bf16 v[68:71], a[80:83], a[208:211], v[68:71]
 s_waitcnt lgkmcnt(3)
 ds_read_b64_tr_b16 a[102:103], v7 offset:20480
 v_xor_b32 v8, 128, v6
 v_mfma_f32_16x16x32_bf16 v[68:71], a[84:87], a[216:219], v[68:71]
 s_movk_i32 s77, 0x1000
 ds_read_b64_tr_b16 a[104:105], v8 offset:0
 v_mul_f32 v55, s34, v55
 v_mfma_f32_16x16x32_bf16 v[68:71], a[88:91], a[112:115], v[68:71]
 s_mov_b32 s51, 0
 ds_read_b64_tr_b16 a[106:107], v8 offset:4096
 v_cvt_pk_bf16_f32 v28, v28, v29
 v_mfma_f32_16x16x32_bf16 v[68:71], a[92:95], a[120:123], v[68:71]
 s_mul_i32 s78, s26, 229376
 ds_read_b64_tr_b16 a[108:109], v8 offset:16384
 v_cvt_pk_bf16_f32 v29, v30, v31
 v_mfma_f32_16x16x32_bf16 v[76:79], a[72:75], a[196:199], v[76:79]
 s_add_u32 s79, s78, 28672
 ds_read_b64_tr_b16 a[110:111], v8 offset:20480
 v_xor_b32 v9, 65664, v6
 v_mfma_f32_16x16x32_bf16 v[76:79], a[76:79], a[204:207], v[76:79]
 s_add_u32 s80, s78, 57344
 ds_read_b64_tr_b16 a[64:65], v9 offset:0
 v_cvt_pk_bf16_f32 v30, v52, v53
 v_mfma_f32_16x16x32_bf16 v[76:79], a[80:83], a[212:215], v[76:79]
 s_add_u32 s81, s78, 86016
 ds_read_b64_tr_b16 a[66:67], v9 offset:4096
 v_cvt_pk_bf16_f32 v31, v54, v55
 v_mfma_f32_16x16x32_bf16 v[76:79], a[84:87], a[220:223], v[76:79]
 s_add_u32 s82, s78, 114688
 ds_read_b64_tr_b16 a[68:69], v9 offset:16384
 v_accvgpr_write_b32 a0, v28
 v_mfma_f32_16x16x32_bf16 v[76:79], a[88:91], a[116:119], v[76:79]
 s_add_u32 s83, s78, 143360
 ds_read_b64_tr_b16 a[70:71], v9 offset:20480
 v_xor_b32 v10, 131232, v6
 v_mfma_f32_16x16x32_bf16 v[76:79], a[92:95], a[124:127], v[76:79]
 s_waitcnt lgkmcnt(6)
 ds_read_b64_tr_b16 a[72:73], v10 offset:0
 v_accvgpr_write_b32 a1, v29
 v_mfma_f32_16x16x32_bf16 v[84:87], a[96:99], a[192:195], v[84:87]
 s_add_u32 s84, s78, 172032
 ds_read_b64_tr_b16 a[74:75], v10 offset:4096
 v_accvgpr_write_b32 a2, v30
 v_mfma_f32_16x16x32_bf16 v[84:87], a[100:103], a[200:203], v[84:87]
 s_add_u32 s85, s78, 200704
 ds_read_b64_tr_b16 a[76:77], v10 offset:16384
 v_accvgpr_write_b32 a3, v31
 v_mfma_f32_16x16x32_bf16 v[84:87], a[104:107], a[208:211], v[84:87]
 s_waitcnt lgkmcnt(3)
 ds_read_b64_tr_b16 a[78:79], v10 offset:20480
 v_xor_b32 v7, 160, v6
 v_mfma_f32_16x16x32_bf16 v[84:87], a[108:111], a[216:219], v[84:87]
 ds_read_b64_tr_b16 a[80:81], v7 offset:0
 v_mul_f32 v44, s34, v44
 v_mfma_f32_16x16x32_bf16 v[84:87], a[64:67], a[112:115], v[84:87]
 ds_read_b64_tr_b16 a[82:83], v7 offset:4096
 v_mul_f32 v45, s34, v45
 v_mfma_f32_16x16x32_bf16 v[84:87], a[68:71], a[120:123], v[84:87]
 ds_read_b64_tr_b16 a[84:85], v7 offset:16384
 v_mul_f32 v46, s34, v46
 v_mfma_f32_16x16x32_bf16 v[92:95], a[96:99], a[196:199], v[92:95]
 ds_read_b64_tr_b16 a[86:87], v7 offset:20480
 v_xor_b32 v8, 65696, v6
 v_mfma_f32_16x16x32_bf16 v[92:95], a[100:103], a[204:207], v[92:95]
 ds_read_b64_tr_b16 a[88:89], v8 offset:0
 v_mul_f32 v47, s34, v47
 v_mfma_f32_16x16x32_bf16 v[92:95], a[104:107], a[212:215], v[92:95]
 ds_read_b64_tr_b16 a[90:91], v8 offset:4096
 v_mul_f32 v60, s34, v60
 v_mfma_f32_16x16x32_bf16 v[92:95], a[108:111], a[220:223], v[92:95]
 ds_read_b64_tr_b16 a[92:93], v8 offset:16384
 v_mul_f32 v61, s34, v61
 v_mfma_f32_16x16x32_bf16 v[92:95], a[64:67], a[116:119], v[92:95]
 ds_read_b64_tr_b16 a[94:95], v8 offset:20480
 v_xor_b32 v9, 131264, v6
 v_mfma_f32_16x16x32_bf16 v[92:95], a[68:71], a[124:127], v[92:95]
 s_waitcnt lgkmcnt(6)
 ds_read_b64_tr_b16 a[96:97], v9 offset:0
 v_mul_f32 v62, s34, v62
 v_mfma_f32_16x16x32_bf16 v[100:103], a[72:75], a[192:195], v[100:103]
 ds_read_b64_tr_b16 a[98:99], v9 offset:4096
 v_mul_f32 v63, s34, v63
 v_mfma_f32_16x16x32_bf16 v[100:103], a[76:79], a[200:203], v[100:103]
 ds_read_b64_tr_b16 a[100:101], v9 offset:16384
 v_cvt_pk_bf16_f32 v44, v44, v45
 v_mfma_f32_16x16x32_bf16 v[100:103], a[80:83], a[208:211], v[100:103]
 s_waitcnt lgkmcnt(3)
 ds_read_b64_tr_b16 a[102:103], v9 offset:20480
 v_xor_b32 v10, 192, v6
 v_mfma_f32_16x16x32_bf16 v[100:103], a[84:87], a[216:219], v[100:103]
 ds_read_b64_tr_b16 a[104:105], v10 offset:0
 v_cvt_pk_bf16_f32 v45, v46, v47
 v_mfma_f32_16x16x32_bf16 v[100:103], a[88:91], a[112:115], v[100:103]
 ds_read_b64_tr_b16 a[106:107], v10 offset:4096
 v_cvt_pk_bf16_f32 v46, v60, v61
 v_mfma_f32_16x16x32_bf16 v[100:103], a[92:95], a[120:123], v[100:103]
 ds_read_b64_tr_b16 a[108:109], v10 offset:16384
 v_cvt_pk_bf16_f32 v47, v62, v63
 v_mfma_f32_16x16x32_bf16 v[108:111], a[72:75], a[196:199], v[108:111]
 ds_read_b64_tr_b16 a[110:111], v10 offset:20480
 v_xor_b32 v7, 65728, v6
 v_mfma_f32_16x16x32_bf16 v[108:111], a[76:79], a[204:207], v[108:111]
 ds_read_b64_tr_b16 a[64:65], v7 offset:0
 v_accvgpr_write_b32 a32, v44
 v_mfma_f32_16x16x32_bf16 v[108:111], a[80:83], a[212:215], v[108:111]
 ds_read_b64_tr_b16 a[66:67], v7 offset:4096
 v_accvgpr_write_b32 a33, v45
 v_mfma_f32_16x16x32_bf16 v[108:111], a[84:87], a[220:223], v[108:111]
 ds_read_b64_tr_b16 a[68:69], v7 offset:16384
 v_accvgpr_write_b32 a34, v46
 v_mfma_f32_16x16x32_bf16 v[108:111], a[88:91], a[116:119], v[108:111]
 ds_read_b64_tr_b16 a[70:71], v7 offset:20480
 v_xor_b32 v8, 131296, v6
 v_mfma_f32_16x16x32_bf16 v[108:111], a[92:95], a[124:127], v[108:111]
 s_waitcnt lgkmcnt(6)
 ds_read_b64_tr_b16 a[72:73], v8 offset:0
 v_accvgpr_write_b32 a35, v47
 v_mfma_f32_16x16x32_bf16 v[116:119], a[96:99], a[192:195], v[116:119]
 ds_read_b64_tr_b16 a[74:75], v8 offset:4096
 v_mul_f32 v20, s34, v20
 v_mfma_f32_16x16x32_bf16 v[116:119], a[100:103], a[200:203], v[116:119]
 ds_read_b64_tr_b16 a[76:77], v8 offset:16384
 v_mul_f32 v21, s34, v21
 v_mfma_f32_16x16x32_bf16 v[116:119], a[104:107], a[208:211], v[116:119]
 s_waitcnt lgkmcnt(3)
 ds_read_b64_tr_b16 a[78:79], v8 offset:20480
 v_xor_b32 v9, 224, v6
 v_mfma_f32_16x16x32_bf16 v[116:119], a[108:111], a[216:219], v[116:119]
 ds_read_b64_tr_b16 a[80:81], v9 offset:0
 v_mul_f32 v22, s34, v22
 v_mfma_f32_16x16x32_bf16 v[116:119], a[64:67], a[112:115], v[116:119]
 ds_read_b64_tr_b16 a[82:83], v9 offset:4096
 v_mul_f32 v23, s34, v23
 v_mfma_f32_16x16x32_bf16 v[116:119], a[68:71], a[120:123], v[116:119]
 ds_read_b64_tr_b16 a[84:85], v9 offset:16384
 v_mul_f32 v68, s34, v68
 v_mfma_f32_16x16x32_bf16 v[124:127], a[96:99], a[196:199], v[124:127]
 ds_read_b64_tr_b16 a[86:87], v9 offset:20480
 v_xor_b32 v10, 65760, v6
 v_mfma_f32_16x16x32_bf16 v[124:127], a[100:103], a[204:207], v[124:127]
 ds_read_b64_tr_b16 a[88:89], v10 offset:0
 v_mul_f32 v69, s34, v69
 v_mfma_f32_16x16x32_bf16 v[124:127], a[104:107], a[212:215], v[124:127]
 ds_read_b64_tr_b16 a[90:91], v10 offset:4096
 v_mul_f32 v70, s34, v70
 v_mfma_f32_16x16x32_bf16 v[124:127], a[108:111], a[220:223], v[124:127]
 ds_read_b64_tr_b16 a[92:93], v10 offset:16384
 v_mul_f32 v71, s34, v71
 v_mfma_f32_16x16x32_bf16 v[124:127], a[64:67], a[116:119], v[124:127]
 ds_read_b64_tr_b16 a[94:95], v10 offset:20480
 v_xor_b32 v7, 131328, v6
 v_mfma_f32_16x16x32_bf16 v[124:127], a[68:71], a[124:127], v[124:127]
 s_waitcnt lgkmcnt(6)
 ds_read_b64_tr_b16 a[96:97], v7 offset:0
 v_cvt_pk_bf16_f32 v20, v20, v21
 v_mfma_f32_16x16x32_bf16 v[132:135], a[72:75], a[192:195], v[132:135]
 ds_read_b64_tr_b16 a[98:99], v7 offset:4096
 v_cvt_pk_bf16_f32 v21, v22, v23
 v_mfma_f32_16x16x32_bf16 v[132:135], a[76:79], a[200:203], v[132:135]
 ds_read_b64_tr_b16 a[100:101], v7 offset:16384
 v_cvt_pk_bf16_f32 v22, v68, v69
 v_mfma_f32_16x16x32_bf16 v[132:135], a[80:83], a[208:211], v[132:135]
 s_waitcnt lgkmcnt(3)
 ds_read_b64_tr_b16 a[102:103], v7 offset:20480
 v_xor_b32 v8, 256, v6
 v_mfma_f32_16x16x32_bf16 v[132:135], a[84:87], a[216:219], v[132:135]
 ds_read_b64_tr_b16 a[104:105], v8 offset:0
 v_cvt_pk_bf16_f32 v23, v70, v71
 v_mfma_f32_16x16x32_bf16 v[132:135], a[88:91], a[112:115], v[132:135]
 ds_read_b64_tr_b16 a[106:107], v8 offset:4096
 v_accvgpr_write_b32 a4, v20
 v_mfma_f32_16x16x32_bf16 v[132:135], a[92:95], a[120:123], v[132:135]
 ds_read_b64_tr_b16 a[108:109], v8 offset:16384
 v_accvgpr_write_b32 a5, v21
 v_mfma_f32_16x16x32_bf16 v[140:143], a[72:75], a[196:199], v[140:143]
 ds_read_b64_tr_b16 a[110:111], v8 offset:20480
 v_xor_b32 v9, 65792, v6
 v_mfma_f32_16x16x32_bf16 v[140:143], a[76:79], a[204:207], v[140:143]
 ds_read_b64_tr_b16 a[64:65], v9 offset:0
 v_accvgpr_write_b32 a6, v22
 v_mfma_f32_16x16x32_bf16 v[140:143], a[80:83], a[212:215], v[140:143]
 ds_read_b64_tr_b16 a[66:67], v9 offset:4096
 v_accvgpr_write_b32 a7, v23
 v_mfma_f32_16x16x32_bf16 v[140:143], a[84:87], a[220:223], v[140:143]
 ds_read_b64_tr_b16 a[68:69], v9 offset:16384
 v_mul_f32 v36, s34, v36
 v_mfma_f32_16x16x32_bf16 v[140:143], a[88:91], a[116:119], v[140:143]
 ds_read_b64_tr_b16 a[70:71], v9 offset:20480
 v_xor_b32 v10, 131360, v6
 v_mfma_f32_16x16x32_bf16 v[140:143], a[92:95], a[124:127], v[140:143]
 s_waitcnt lgkmcnt(6)
 ds_read_b64_tr_b16 a[72:73], v10 offset:0
 v_mul_f32 v37, s34, v37
 v_mfma_f32_16x16x32_bf16 v[148:151], a[96:99], a[192:195], v[148:151]
 ds_read_b64_tr_b16 a[74:75], v10 offset:4096
 v_mul_f32 v38, s34, v38
 v_mfma_f32_16x16x32_bf16 v[148:151], a[100:103], a[200:203], v[148:151]
 ds_read_b64_tr_b16 a[76:77], v10 offset:16384
 v_mul_f32 v39, s34, v39
 v_mfma_f32_16x16x32_bf16 v[148:151], a[104:107], a[208:211], v[148:151]
 s_waitcnt lgkmcnt(3)
 ds_read_b64_tr_b16 a[78:79], v10 offset:20480
 v_xor_b32 v7, 288, v6
 v_mfma_f32_16x16x32_bf16 v[148:151], a[108:111], a[216:219], v[148:151]
 ds_read_b64_tr_b16 a[80:81], v7 offset:0
 v_mul_f32 v76, s34, v76
 v_mfma_f32_16x16x32_bf16 v[148:151], a[64:67], a[112:115], v[148:151]
 ds_read_b64_tr_b16 a[82:83], v7 offset:4096
 v_mul_f32 v77, s34, v77
 v_mfma_f32_16x16x32_bf16 v[148:151], a[68:71], a[120:123], v[148:151]
 ds_read_b64_tr_b16 a[84:85], v7 offset:16384
 v_mul_f32 v78, s34, v78
 v_mfma_f32_16x16x32_bf16 v[156:159], a[96:99], a[196:199], v[156:159]
 ds_read_b64_tr_b16 a[86:87], v7 offset:20480
 v_xor_b32 v8, 65824, v6
 v_mfma_f32_16x16x32_bf16 v[156:159], a[100:103], a[204:207], v[156:159]
 ds_read_b64_tr_b16 a[88:89], v8 offset:0
 v_mul_f32 v79, s34, v79
 v_mfma_f32_16x16x32_bf16 v[156:159], a[104:107], a[212:215], v[156:159]
 ds_read_b64_tr_b16 a[90:91], v8 offset:4096
 v_cvt_pk_bf16_f32 v36, v36, v37
 v_mfma_f32_16x16x32_bf16 v[156:159], a[108:111], a[220:223], v[156:159]
 ds_read_b64_tr_b16 a[92:93], v8 offset:16384
 v_cvt_pk_bf16_f32 v37, v38, v39
 v_mfma_f32_16x16x32_bf16 v[156:159], a[64:67], a[116:119], v[156:159]
 ds_read_b64_tr_b16 a[94:95], v8 offset:20480
 v_xor_b32 v9, 131392, v6
 v_mfma_f32_16x16x32_bf16 v[156:159], a[68:71], a[124:127], v[156:159]
 s_waitcnt lgkmcnt(6)
 ds_read_b64_tr_b16 a[96:97], v9 offset:0
 v_cvt_pk_bf16_f32 v38, v76, v77
 v_mfma_f32_16x16x32_bf16 v[164:167], a[72:75], a[192:195], v[164:167]
 ds_read_b64_tr_b16 a[98:99], v9 offset:4096
 v_cvt_pk_bf16_f32 v39, v78, v79
 v_mfma_f32_16x16x32_bf16 v[164:167], a[76:79], a[200:203], v[164:167]
 ds_read_b64_tr_b16 a[100:101], v9 offset:16384
 v_accvgpr_write_b32 a36, v36
 v_mfma_f32_16x16x32_bf16 v[164:167], a[80:83], a[208:211], v[164:167]
 s_waitcnt lgkmcnt(3)
 ds_read_b64_tr_b16 a[102:103], v9 offset:20480
 v_xor_b32 v10, 320, v6
 v_mfma_f32_16x16x32_bf16 v[164:167], a[84:87], a[216:219], v[164:167]
 ds_read_b64_tr_b16 a[104:105], v10 offset:0
 v_accvgpr_write_b32 a37, v37
 v_mfma_f32_16x16x32_bf16 v[164:167], a[88:91], a[112:115], v[164:167]
 ds_read_b64_tr_b16 a[106:107], v10 offset:4096
 v_accvgpr_write_b32 a38, v38
 v_mfma_f32_16x16x32_bf16 v[164:167], a[92:95], a[120:123], v[164:167]
 ds_read_b64_tr_b16 a[108:109], v10 offset:16384
 v_accvgpr_write_b32 a39, v39
 v_mfma_f32_16x16x32_bf16 v[172:175], a[72:75], a[196:199], v[172:175]
 ds_read_b64_tr_b16 a[110:111], v10 offset:20480
 v_xor_b32 v7, 65856, v6
 v_mfma_f32_16x16x32_bf16 v[172:175], a[76:79], a[204:207], v[172:175]
 ds_read_b64_tr_b16 a[64:65], v7 offset:0
 v_mul_f32 v84, s34, v84
 v_mfma_f32_16x16x32_bf16 v[172:175], a[80:83], a[212:215], v[172:175]
 ds_read_b64_tr_b16 a[66:67], v7 offset:4096
 v_mul_f32 v85, s34, v85
 v_mfma_f32_16x16x32_bf16 v[172:175], a[84:87], a[220:223], v[172:175]
 ds_read_b64_tr_b16 a[68:69], v7 offset:16384
 v_mul_f32 v86, s34, v86
 v_mfma_f32_16x16x32_bf16 v[172:175], a[88:91], a[116:119], v[172:175]
 ds_read_b64_tr_b16 a[70:71], v7 offset:20480
 v_xor_b32 v8, 131424, v6
 v_mfma_f32_16x16x32_bf16 v[172:175], a[92:95], a[124:127], v[172:175]
 s_waitcnt lgkmcnt(6)
 ds_read_b64_tr_b16 a[72:73], v8 offset:0
 v_mul_f32 v87, s34, v87
 v_mfma_f32_16x16x32_bf16 v[180:183], a[96:99], a[192:195], v[180:183]
 ds_read_b64_tr_b16 a[74:75], v8 offset:4096
 v_mul_f32 v100, s34, v100
 v_mfma_f32_16x16x32_bf16 v[180:183], a[100:103], a[200:203], v[180:183]
 ds_read_b64_tr_b16 a[76:77], v8 offset:16384
 v_mul_f32 v101, s34, v101
 v_mfma_f32_16x16x32_bf16 v[180:183], a[104:107], a[208:211], v[180:183]
 s_waitcnt lgkmcnt(3)
 ds_read_b64_tr_b16 a[78:79], v8 offset:20480
 v_xor_b32 v9, 352, v6
 v_mfma_f32_16x16x32_bf16 v[180:183], a[108:111], a[216:219], v[180:183]
 ds_read_b64_tr_b16 a[80:81], v9 offset:0
 v_mul_f32 v102, s34, v102
 v_mfma_f32_16x16x32_bf16 v[180:183], a[64:67], a[112:115], v[180:183]
 ds_read_b64_tr_b16 a[82:83], v9 offset:4096
 v_mul_f32 v103, s34, v103
 v_mfma_f32_16x16x32_bf16 v[180:183], a[68:71], a[120:123], v[180:183]
 ds_read_b64_tr_b16 a[84:85], v9 offset:16384
 v_cvt_pk_bf16_f32 v84, v84, v85
 v_mfma_f32_16x16x32_bf16 v[188:191], a[96:99], a[196:199], v[188:191]
 ds_read_b64_tr_b16 a[86:87], v9 offset:20480
 v_xor_b32 v10, 65888, v6
 v_mfma_f32_16x16x32_bf16 v[188:191], a[100:103], a[204:207], v[188:191]
 ds_read_b64_tr_b16 a[88:89], v10 offset:0
 v_cvt_pk_bf16_f32 v85, v86, v87
 v_mfma_f32_16x16x32_bf16 v[188:191], a[104:107], a[212:215], v[188:191]
 ds_read_b64_tr_b16 a[90:91], v10 offset:4096
 v_cvt_pk_bf16_f32 v86, v100, v101
 v_mfma_f32_16x16x32_bf16 v[188:191], a[108:111], a[220:223], v[188:191]
 ds_read_b64_tr_b16 a[92:93], v10 offset:16384
 v_cvt_pk_bf16_f32 v87, v102, v103
 v_mfma_f32_16x16x32_bf16 v[188:191], a[64:67], a[116:119], v[188:191]
 ds_read_b64_tr_b16 a[94:95], v10 offset:20480
 v_xor_b32 v7, 131456, v6
 v_mfma_f32_16x16x32_bf16 v[188:191], a[68:71], a[124:127], v[188:191]
 s_waitcnt lgkmcnt(6)
 ds_read_b64_tr_b16 a[96:97], v7 offset:0
 v_accvgpr_write_b32 a8, v84
 v_mfma_f32_16x16x32_bf16 v[196:199], a[72:75], a[192:195], v[196:199]
 ds_read_b64_tr_b16 a[98:99], v7 offset:4096
 v_accvgpr_write_b32 a9, v85
 v_mfma_f32_16x16x32_bf16 v[196:199], a[76:79], a[200:203], v[196:199]
 ds_read_b64_tr_b16 a[100:101], v7 offset:16384
 v_accvgpr_write_b32 a10, v86
 v_mfma_f32_16x16x32_bf16 v[196:199], a[80:83], a[208:211], v[196:199]
 s_waitcnt lgkmcnt(3)
 ds_read_b64_tr_b16 a[102:103], v7 offset:20480
 v_xor_b32 v8, 384, v6
 v_mfma_f32_16x16x32_bf16 v[196:199], a[84:87], a[216:219], v[196:199]
 ds_read_b64_tr_b16 a[104:105], v8 offset:0
 v_accvgpr_write_b32 a11, v87
 v_mfma_f32_16x16x32_bf16 v[196:199], a[88:91], a[112:115], v[196:199]
 ds_read_b64_tr_b16 a[106:107], v8 offset:4096
 v_mul_f32 v92, s34, v92
 v_mfma_f32_16x16x32_bf16 v[196:199], a[92:95], a[120:123], v[196:199]
 ds_read_b64_tr_b16 a[108:109], v8 offset:16384
 v_mul_f32 v93, s34, v93
 v_mfma_f32_16x16x32_bf16 v[204:207], a[72:75], a[196:199], v[204:207]
 ds_read_b64_tr_b16 a[110:111], v8 offset:20480
 v_xor_b32 v9, 65920, v6
 v_mfma_f32_16x16x32_bf16 v[204:207], a[76:79], a[204:207], v[204:207]
 ds_read_b64_tr_b16 a[64:65], v9 offset:0
 v_mul_f32 v94, s34, v94
 v_mfma_f32_16x16x32_bf16 v[204:207], a[80:83], a[212:215], v[204:207]
 ds_read_b64_tr_b16 a[66:67], v9 offset:4096
 v_mul_f32 v95, s34, v95
 v_mfma_f32_16x16x32_bf16 v[204:207], a[84:87], a[220:223], v[204:207]
 ds_read_b64_tr_b16 a[68:69], v9 offset:16384
 v_mul_f32 v108, s34, v108
 v_mfma_f32_16x16x32_bf16 v[204:207], a[88:91], a[116:119], v[204:207]
 ds_read_b64_tr_b16 a[70:71], v9 offset:20480
 v_xor_b32 v10, 131488, v6
 v_mfma_f32_16x16x32_bf16 v[204:207], a[92:95], a[124:127], v[204:207]
 s_waitcnt lgkmcnt(6)
 ds_read_b64_tr_b16 a[72:73], v10 offset:0
 v_mul_f32 v109, s34, v109
 v_mfma_f32_16x16x32_bf16 v[212:215], a[96:99], a[192:195], v[212:215]
 ds_read_b64_tr_b16 a[74:75], v10 offset:4096
 v_mul_f32 v110, s34, v110
 v_mfma_f32_16x16x32_bf16 v[212:215], a[100:103], a[200:203], v[212:215]
 ds_read_b64_tr_b16 a[76:77], v10 offset:16384
 v_mul_f32 v111, s34, v111
 v_mfma_f32_16x16x32_bf16 v[212:215], a[104:107], a[208:211], v[212:215]
 s_waitcnt lgkmcnt(3)
 ds_read_b64_tr_b16 a[78:79], v10 offset:20480
 v_xor_b32 v7, 416, v6
 v_mfma_f32_16x16x32_bf16 v[212:215], a[108:111], a[216:219], v[212:215]
 ds_read_b64_tr_b16 a[80:81], v7 offset:0
 v_cvt_pk_bf16_f32 v92, v92, v93
 v_mfma_f32_16x16x32_bf16 v[212:215], a[64:67], a[112:115], v[212:215]
 ds_read_b64_tr_b16 a[82:83], v7 offset:4096
 v_cvt_pk_bf16_f32 v93, v94, v95
 v_mfma_f32_16x16x32_bf16 v[212:215], a[68:71], a[120:123], v[212:215]
 ds_read_b64_tr_b16 a[84:85], v7 offset:16384
 v_cvt_pk_bf16_f32 v94, v108, v109
 v_mfma_f32_16x16x32_bf16 v[220:223], a[96:99], a[196:199], v[220:223]
 ds_read_b64_tr_b16 a[86:87], v7 offset:20480
 v_xor_b32 v8, 65952, v6
 v_mfma_f32_16x16x32_bf16 v[220:223], a[100:103], a[204:207], v[220:223]
 ds_read_b64_tr_b16 a[88:89], v8 offset:0
 v_cvt_pk_bf16_f32 v95, v110, v111
 v_mfma_f32_16x16x32_bf16 v[220:223], a[104:107], a[212:215], v[220:223]
 ds_read_b64_tr_b16 a[90:91], v8 offset:4096
 v_accvgpr_write_b32 a40, v92
 v_mfma_f32_16x16x32_bf16 v[220:223], a[108:111], a[220:223], v[220:223]
 ds_read_b64_tr_b16 a[92:93], v8 offset:16384
 v_accvgpr_write_b32 a41, v93
 v_mfma_f32_16x16x32_bf16 v[220:223], a[64:67], a[116:119], v[220:223]
 ds_read_b64_tr_b16 a[94:95], v8 offset:20480
 v_xor_b32 v9, 131520, v6
 v_mfma_f32_16x16x32_bf16 v[220:223], a[68:71], a[124:127], v[220:223]
 s_waitcnt lgkmcnt(6)
 ds_read_b64_tr_b16 a[96:97], v9 offset:0
 v_accvgpr_write_b32 a42, v94
 v_mfma_f32_16x16x32_bf16 v[228:231], a[72:75], a[192:195], v[228:231]
 ds_read_b64_tr_b16 a[98:99], v9 offset:4096
 v_accvgpr_write_b32 a43, v95
 v_mfma_f32_16x16x32_bf16 v[228:231], a[76:79], a[200:203], v[228:231]
 ds_read_b64_tr_b16 a[100:101], v9 offset:16384
 v_mul_f32 v116, s34, v116
 v_mfma_f32_16x16x32_bf16 v[228:231], a[80:83], a[208:211], v[228:231]
 s_waitcnt lgkmcnt(3)
 ds_read_b64_tr_b16 a[102:103], v9 offset:20480
 v_xor_b32 v10, 448, v6
 v_mfma_f32_16x16x32_bf16 v[228:231], a[84:87], a[216:219], v[228:231]
 ds_read_b64_tr_b16 a[104:105], v10 offset:0
 v_mul_f32 v117, s34, v117
 v_mfma_f32_16x16x32_bf16 v[228:231], a[88:91], a[112:115], v[228:231]
 ds_read_b64_tr_b16 a[106:107], v10 offset:4096
 v_mul_f32 v118, s34, v118
 v_mfma_f32_16x16x32_bf16 v[228:231], a[92:95], a[120:123], v[228:231]
 ds_read_b64_tr_b16 a[108:109], v10 offset:16384
 v_mul_f32 v119, s34, v119
 v_mfma_f32_16x16x32_bf16 v[236:239], a[72:75], a[196:199], v[236:239]
 ds_read_b64_tr_b16 a[110:111], v10 offset:20480
 v_xor_b32 v7, 65984, v6
 v_mfma_f32_16x16x32_bf16 v[236:239], a[76:79], a[204:207], v[236:239]
 ds_read_b64_tr_b16 a[64:65], v7 offset:0
 buffer_load_dword v13, v12, s[12:15], s58 offen sc1
 v_mfma_f32_16x16x32_bf16 v[236:239], a[80:83], a[212:215], v[236:239]
 ds_read_b64_tr_b16 a[66:67], v7 offset:4096
 v_mul_f32 v132, s34, v132
 v_mfma_f32_16x16x32_bf16 v[236:239], a[84:87], a[220:223], v[236:239]
 ds_read_b64_tr_b16 a[68:69], v7 offset:16384
 v_mul_f32 v133, s34, v133
 v_mfma_f32_16x16x32_bf16 v[236:239], a[88:91], a[116:119], v[236:239]
 ds_read_b64_tr_b16 a[70:71], v7 offset:20480
 v_xor_b32 v8, 131552, v6
 v_mfma_f32_16x16x32_bf16 v[236:239], a[92:95], a[124:127], v[236:239]
 s_waitcnt lgkmcnt(6)
 ds_read_b64_tr_b16 a[72:73], v8 offset:0
 v_mul_f32 v134, s34, v134
 v_mfma_f32_16x16x32_bf16 v[244:247], a[96:99], a[192:195], v[244:247]
 ds_read_b64_tr_b16 a[74:75], v8 offset:4096
 v_mul_f32 v135, s34, v135
 v_mfma_f32_16x16x32_bf16 v[244:247], a[100:103], a[200:203], v[244:247]
 ds_read_b64_tr_b16 a[76:77], v8 offset:16384
 v_cvt_pk_bf16_f32 v116, v116, v117
 v_mfma_f32_16x16x32_bf16 v[244:247], a[104:107], a[208:211], v[244:247]
 s_waitcnt lgkmcnt(3)
 ds_read_b64_tr_b16 a[78:79], v8 offset:20480
 v_xor_b32 v9, 480, v6
 v_mfma_f32_16x16x32_bf16 v[244:247], a[108:111], a[216:219], v[244:247]
 ds_read_b64_tr_b16 a[80:81], v9 offset:0
 v_cvt_pk_bf16_f32 v117, v118, v119
 v_mfma_f32_16x16x32_bf16 v[244:247], a[64:67], a[112:115], v[244:247]
 ds_read_b64_tr_b16 a[82:83], v9 offset:4096
 v_cvt_pk_bf16_f32 v118, v132, v133
 v_mfma_f32_16x16x32_bf16 v[244:247], a[68:71], a[120:123], v[244:247]
 ds_read_b64_tr_b16 a[84:85], v9 offset:16384
 v_cvt_pk_bf16_f32 v119, v134, v135
 v_mfma_f32_16x16x32_bf16 v[252:255], a[96:99], a[196:199], v[252:255]
 ds_read_b64_tr_b16 a[86:87], v9 offset:20480
 v_xor_b32 v10, 66016, v6
 v_mfma_f32_16x16x32_bf16 v[252:255], a[100:103], a[204:207], v[252:255]
 ds_read_b64_tr_b16 a[88:89], v10 offset:0
 v_accvgpr_write_b32 a12, v116
 v_mfma_f32_16x16x32_bf16 v[252:255], a[104:107], a[212:215], v[252:255]
 ds_read_b64_tr_b16 a[90:91], v10 offset:4096
 v_accvgpr_write_b32 a13, v117
 v_mfma_f32_16x16x32_bf16 v[252:255], a[108:111], a[220:223], v[252:255]
 ds_read_b64_tr_b16 a[92:93], v10 offset:16384
 v_accvgpr_write_b32 a14, v118
 v_mfma_f32_16x16x32_bf16 v[252:255], a[64:67], a[116:119], v[252:255]
 ds_read_b64_tr_b16 a[94:95], v10 offset:20480
 v_accvgpr_write_b32 a15, v119
 v_mfma_f32_16x16x32_bf16 v[252:255], a[68:71], a[124:127], v[252:255]
 s_waitcnt lgkmcnt(6)
 v_mfma_f32_16x16x32_bf16 v[16:19], a[72:75], a[192:195], v[16:19]
 v_mfma_f32_16x16x32_bf16 v[16:19], a[76:79], a[200:203], v[16:19]
 v_mfma_f32_16x16x32_bf16 v[16:19], a[80:83], a[208:211], v[16:19]
 s_waitcnt lgkmcnt(0)
 v_mfma_f32_16x16x32_bf16 v[16:19], a[84:87], a[216:219], v[16:19]
 v_mfma_f32_16x16x32_bf16 v[16:19], a[88:91], a[112:115], v[16:19]
 v_mfma_f32_16x16x32_bf16 v[16:19], a[92:95], a[120:123], v[16:19]
 v_mfma_f32_16x16x32_bf16 v[24:27], a[72:75], a[196:199], v[24:27]
 v_mfma_f32_16x16x32_bf16 v[24:27], a[76:79], a[204:207], v[24:27]
 v_mfma_f32_16x16x32_bf16 v[24:27], a[80:83], a[212:215], v[24:27]
 v_mfma_f32_16x16x32_bf16 v[24:27], a[84:87], a[220:223], v[24:27]
 s_waitcnt lgkmcnt(0)
 v_mfma_f32_16x16x32_bf16 v[24:27], a[88:91], a[116:119], v[24:27]
 s_barrier
 v_mfma_f32_16x16x32_bf16 v[24:27], a[92:95], a[124:127], v[24:27]
 s_waitcnt vmcnt(0)
 v_cmp_ne_u32 s[16:17], 0, v13
 v_cmp_gt_u32 vcc, 256, v5
 s_or_b64 vcc, vcc, s[16:17]
 s_mov_b32 m0, s40
 s_cselect_b32 s48, 0, 1
 s_cselect_b32 s52, 2.0, s42
 buffer_load_dwordx4 v1, s[12:15], s52 offen offset:0 sc1 lds
 v_pk_mul_f32 v[124:125], v[124:125], s[34:35]
 v_pk_mul_f32 v[126:127], v[126:127], s[34:35]
 v_pk_mul_f32 v[140:141], v[140:141], s[34:35]
 v_pk_mul_f32 v[142:143], v[142:143], s[34:35]
 v_cvt_pk_bf16_f32 v124, v124, v125
 v_cvt_pk_bf16_f32 v125, v126, v127
 v_cvt_pk_bf16_f32 v126, v140, v141
 v_cvt_pk_bf16_f32 v127, v142, v143
 v_accvgpr_write_b32 a44, v124
 v_accvgpr_write_b32 a45, v125
 v_accvgpr_write_b32 a46, v126
 v_accvgpr_write_b32 a47, v127
 v_pk_mul_f32 v[148:149], v[148:149], s[34:35]
 v_pk_mul_f32 v[150:151], v[150:151], s[34:35]
 buffer_load_dwordx4 v1, s[12:15], s52 offen offset:1024 sc1 lds
 v_pk_mul_f32 v[164:165], v[164:165], s[34:35]
 v_pk_mul_f32 v[166:167], v[166:167], s[34:35]
 v_cvt_pk_bf16_f32 v148, v148, v149
 v_cvt_pk_bf16_f32 v149, v150, v151
 v_cvt_pk_bf16_f32 v150, v164, v165
 v_cvt_pk_bf16_f32 v151, v166, v167
 v_accvgpr_write_b32 a16, v148
 v_accvgpr_write_b32 a17, v149
 v_accvgpr_write_b32 a18, v150
 v_accvgpr_write_b32 a19, v151
 v_pk_mul_f32 v[156:157], v[156:157], s[34:35]
 v_pk_mul_f32 v[158:159], v[158:159], s[34:35]
 v_pk_mul_f32 v[172:173], v[172:173], s[34:35]
 buffer_load_dwordx4 v1, s[12:15], s52 offen offset:2048 sc1 lds
 v_pk_mul_f32 v[174:175], v[174:175], s[34:35]
 v_cvt_pk_bf16_f32 v156, v156, v157
 v_cvt_pk_bf16_f32 v157, v158, v159
 v_cvt_pk_bf16_f32 v158, v172, v173
 v_cvt_pk_bf16_f32 v159, v174, v175
 v_accvgpr_write_b32 a48, v156
 v_accvgpr_write_b32 a49, v157
 v_accvgpr_write_b32 a50, v158
 v_accvgpr_write_b32 a51, v159
 v_pk_mul_f32 v[180:181], v[180:181], s[34:35]
 v_pk_mul_f32 v[182:183], v[182:183], s[34:35]
 v_pk_mul_f32 v[196:197], v[196:197], s[34:35]
 v_pk_mul_f32 v[198:199], v[198:199], s[34:35]
 v_cvt_pk_bf16_f32 v180, v180, v181
 buffer_load_dwordx4 v1, s[12:15], s52 offen offset:3072 sc1 lds
 v_cvt_pk_bf16_f32 v181, v182, v183
 v_cvt_pk_bf16_f32 v182, v196, v197
 v_cvt_pk_bf16_f32 v183, v198, v199
 v_accvgpr_write_b32 a20, v180
 v_accvgpr_write_b32 a21, v181
 v_accvgpr_write_b32 a22, v182
 v_accvgpr_write_b32 a23, v183
 v_pk_mul_f32 v[188:189], v[188:189], s[34:35]
 v_pk_mul_f32 v[190:191], v[190:191], s[34:35]
 v_pk_mul_f32 v[204:205], v[204:205], s[34:35]
 v_pk_mul_f32 v[206:207], v[206:207], s[34:35]
 v_cvt_pk_bf16_f32 v188, v188, v189
 v_cvt_pk_bf16_f32 v189, v190, v191
 s_bitset1_b32 m0, 12
 s_nop 0
 buffer_load_dwordx4 v4, s[12:15], s52 offen offset:0 sc1 lds
 v_cvt_pk_bf16_f32 v190, v204, v205
 v_cvt_pk_bf16_f32 v191, v206, v207
 v_accvgpr_write_b32 a52, v188
 v_accvgpr_write_b32 a53, v189
 v_accvgpr_write_b32 a54, v190
 v_accvgpr_write_b32 a55, v191
 v_pk_mul_f32 v[212:213], v[212:213], s[34:35]
 v_pk_mul_f32 v[214:215], v[214:215], s[34:35]
 v_pk_mul_f32 v[228:229], v[228:229], s[34:35]
 v_pk_mul_f32 v[230:231], v[230:231], s[34:35]
 v_cvt_pk_bf16_f32 v212, v212, v213
 v_cvt_pk_bf16_f32 v213, v214, v215
 v_cvt_pk_bf16_f32 v214, v228, v229
 v_cvt_pk_bf16_f32 v215, v230, v231
 buffer_load_dwordx4 v4, s[12:15], s52 offen offset:1024 sc1 lds
 v_accvgpr_write_b32 a24, v212
 v_accvgpr_write_b32 a25, v213
 v_accvgpr_write_b32 a26, v214
 v_accvgpr_write_b32 a27, v215
 v_pk_mul_f32 v[220:221], v[220:221], s[34:35]
 v_pk_mul_f32 v[222:223], v[222:223], s[34:35]
 v_pk_mul_f32 v[236:237], v[236:237], s[34:35]
 v_pk_mul_f32 v[238:239], v[238:239], s[34:35]
 v_cvt_pk_bf16_f32 v220, v220, v221
 v_cvt_pk_bf16_f32 v221, v222, v223
 v_cvt_pk_bf16_f32 v222, v236, v237
 v_cvt_pk_bf16_f32 v223, v238, v239
 v_accvgpr_write_b32 a56, v220
 buffer_load_dwordx4 v4, s[12:15], s52 offen offset:2048 sc1 lds
 v_accvgpr_write_b32 a57, v221
 v_accvgpr_write_b32 a58, v222
 v_accvgpr_write_b32 a59, v223
 v_pk_mul_f32 v[244:245], v[244:245], s[34:35]
 v_pk_mul_f32 v[246:247], v[246:247], s[34:35]
 v_pk_mul_f32 v[16:17], v[16:17], s[34:35]
 v_pk_mul_f32 v[18:19], v[18:19], s[34:35]
 v_cvt_pk_bf16_f32 v244, v244, v245
 v_cvt_pk_bf16_f32 v245, v246, v247
 v_cvt_pk_bf16_f32 v246, v16, v17
 v_cvt_pk_bf16_f32 v247, v18, v19
 v_accvgpr_write_b32 a28, v244
 v_accvgpr_write_b32 a29, v245
 v_accvgpr_write_b32 a30, v246
 buffer_load_dwordx4 v4, s[12:15], s52 offen offset:3072 sc1 lds
 v_accvgpr_write_b32 a31, v247
 v_pk_mul_f32 v[252:253], v[252:253], s[34:35]
 v_pk_mul_f32 v[254:255], v[254:255], s[34:35]
 v_pk_mul_f32 v[24:25], v[24:25], s[34:35]
 v_pk_mul_f32 v[26:27], v[26:27], s[34:35]
 v_cvt_pk_bf16_f32 v252, v252, v253
 v_cvt_pk_bf16_f32 v253, v254, v255
 v_cvt_pk_bf16_f32 v254, v24, v25
 v_cvt_pk_bf16_f32 v255, v26, v27
 v_accvgpr_write_b32 a60, v252
 v_accvgpr_write_b32 a61, v253
 v_accvgpr_write_b32 a62, v254
 v_accvgpr_write_b32 a63, v255
 s_branch L_kvdone
L_late0:
 v_mfma_f32_16x16x32_bf16 a[232:235], a[0:3], a[96:99], a[232:235]
 ds_read_b64_tr_b16 a[24:25], v9 offset:32768
 v_mfma_f32_16x16x32_bf16 a[232:235], a[4:7], a[100:103], a[232:235]
 s_add_u32 m0, s33, 0xfffffd00
 ds_read_b64_tr_b16 a[26:27], v9 offset:36864
 v_mfma_f32_16x16x32_bf16 a[224:227], a[4:7], a[108:111], a[224:227]
 s_waitcnt lgkmcnt(13)
 ds_read_b64_tr_b16 a[28:29], v9 offset:49152
 v_mfma_f32_16x16x32_bf16 a[224:227], a[0:3], a[104:107], a[224:227]
 ds_read_b64_tr_b16 a[30:31], v9 offset:53248
 buffer_load_dwordx4 v15, s[20:23], 0 offen offset:768 lds
 v_mfma_f32_16x16x32_bf16 v[24:27], a[0:3], a[112:115], v[24:27]
 s_waitcnt lgkmcnt(12)
 ds_read_b128 a[64:67], v4 offset:32768
 v_mfma_f32_16x16x32_bf16 v[24:27], a[4:7], a[116:119], v[24:27]
 v_mfma_f32_16x16x32_bf16 v[16:19], a[4:7], a[124:127], v[16:19]
 s_add_u32 m0, s33, 0xfffffd80
 ds_read_b128 a[68:71], v5 offset:32768
 v_mfma_f32_16x16x32_bf16 v[16:19], a[0:3], a[120:123], v[16:19]
 s_waitcnt lgkmcnt(10)
 buffer_load_dwordx4 v15, s[20:23], 0 offen offset:1664 lds
 v_mfma_f32_16x16x32_bf16 v[20:23], a[8:11], a[120:123], v[20:23]
 ds_read_b128 a[76:79], v5 offset:34816
 v_mfma_f32_16x16x32_bf16 v[20:23], a[12:15], a[124:127], v[20:23]
 v_mfma_f32_16x16x32_bf16 v[28:31], a[12:15], a[116:119], v[28:31]
 s_add_u32 m0, s33, 0x500
 ds_read_b128 a[72:75], v4 offset:34816
 v_mfma_f32_16x16x32_bf16 v[28:31], a[8:11], a[112:115], v[28:31]
 buffer_load_dwordx4 v15, s[20:23], s57 offen offset:768 lds
 v_mfma_f32_16x16x32_bf16 a[228:231], a[8:11], a[104:107], a[228:231]
 ds_read_b128 a[80:83], v4 offset:36864
 v_mfma_f32_16x16x32_bf16 a[228:231], a[12:15], a[108:111], a[228:231]
 v_mfma_f32_16x16x32_bf16 a[236:239], a[12:15], a[100:103], a[236:239]
 s_add_u32 m0, s33, 0x580
 ds_read_b128 a[84:87], v5 offset:36864
 v_mfma_f32_16x16x32_bf16 a[236:239], a[8:11], a[96:99], a[236:239]
 s_waitcnt lgkmcnt(10)
 buffer_load_dwordx4 v15, s[20:23], s57 offen offset:1664 lds
 v_mfma_f32_16x16x32_bf16 v[56:59], a[16:19], a[96:99], v[56:59]
 ds_read_b128 a[92:95], v5 offset:38912
 v_mfma_f32_16x16x32_bf16 v[56:59], a[20:23], a[100:103], v[56:59]
 v_cvt_pk_bf16_f32 v16, v16, v17
 v_cvt_pk_bf16_f32 v17, v18, v19
 v_mfma_f32_16x16x32_bf16 v[48:51], a[20:23], a[108:111], v[48:51]
 ds_read_b128 a[88:91], v4 offset:38912
 v_cvt_pk_bf16_f32 v18, v20, v21
 v_mfma_f32_16x16x32_bf16 v[48:51], a[16:19], a[104:107], v[48:51]
 v_cvt_pk_bf16_f32 v19, v22, v23
 v_cvt_pk_bf16_f32 v24, v24, v25
 v_mfma_f32_16x16x32_bf16 v[40:43], a[16:19], a[112:115], v[40:43]
 ds_read_b64_tr_b16 a[32:33], v10 offset:32768
 v_cvt_pk_bf16_f32 v25, v26, v27
 v_mfma_f32_16x16x32_bf16 v[40:43], a[20:23], a[116:119], v[40:43]
 ds_read_b64_tr_b16 a[34:35], v10 offset:36864
 v_cvt_pk_bf16_f32 v26, v28, v29
 v_mfma_f32_16x16x32_bf16 v[32:35], a[20:23], a[124:127], v[32:35]
 s_add_u32 s59, s56, 57344
 ds_read_b64_tr_b16 a[36:37], v10 offset:49152
 v_cvt_pk_bf16_f32 v27, v30, v31
 v_mfma_f32_16x16x32_bf16 v[32:35], a[16:19], a[120:123], v[32:35]
 s_waitcnt lgkmcnt(11)
 ds_read_b64_tr_b16 a[38:39], v10 offset:53248
 v_accvgpr_read_b32 v20, a224
 v_mfma_f32_16x16x32_bf16 v[36:39], a[24:27], a[120:123], v[36:39]
 ds_read_b64_tr_b16 a[40:41], v11 offset:32768
 buffer_store_dwordx4 v[16:19], v1, s[12:15], s59 offen offset:0 sc1
 v_mfma_f32_16x16x32_bf16 v[36:39], a[28:31], a[124:127], v[36:39]
 ds_read_b64_tr_b16 a[42:43], v11 offset:36864
 v_accvgpr_read_b32 v21, a225
 v_mfma_f32_16x16x32_bf16 v[44:47], a[28:31], a[116:119], v[44:47]
 ds_read_b64_tr_b16 a[44:45], v11 offset:49152
 v_accvgpr_read_b32 v22, a226
 v_mfma_f32_16x16x32_bf16 v[44:47], a[24:27], a[112:115], v[44:47]
 ds_read_b64_tr_b16 a[46:47], v11 offset:53248
 v_accvgpr_read_b32 v23, a227
 v_mfma_f32_16x16x32_bf16 v[52:55], a[24:27], a[104:107], v[52:55]
 ds_read_b64_tr_b16 a[48:49], v12 offset:32768
 v_accvgpr_read_b32 v28, a228
 v_mfma_f32_16x16x32_bf16 v[52:55], a[28:31], a[108:111], v[52:55]
 ds_read_b64_tr_b16 a[50:51], v12 offset:36864
 v_accvgpr_read_b32 v29, a229
 v_mfma_f32_16x16x32_bf16 v[60:63], a[28:31], a[100:103], v[60:63]
 s_add_u32 s59, s56, 49152
 ds_read_b64_tr_b16 a[52:53], v12 offset:49152
 v_accvgpr_read_b32 v30, a230
 v_mfma_f32_16x16x32_bf16 v[60:63], a[24:27], a[96:99], v[60:63]
 s_waitcnt lgkmcnt(15)
 ds_read_b64_tr_b16 a[54:55], v12 offset:53248
 buffer_store_dwordx4 v[24:27], v1, s[12:15], s59 offen offset:0 sc1
 v_mfma_f32_16x16x32_bf16 v[88:91], a[0:3], a[64:67], v[88:91]
 ds_read_b64_tr_b16 a[56:57], v13 offset:32768
 v_accvgpr_read_b32 v31, a231
 v_mfma_f32_16x16x32_bf16 v[88:91], a[4:7], a[68:71], v[88:91]
 ds_read_b64_tr_b16 a[58:59], v13 offset:36864
 v_cvt_pk_bf16_f32 v20, v20, v21
 v_mfma_f32_16x16x32_bf16 v[80:83], a[4:7], a[76:79], v[80:83]
 ds_read_b64_tr_b16 a[60:61], v13 offset:49152
 v_cvt_pk_bf16_f32 v21, v22, v23
 v_mfma_f32_16x16x32_bf16 v[80:83], a[0:3], a[72:75], v[80:83]
 s_waitcnt lgkmcnt(15)
 ds_read_b64_tr_b16 a[62:63], v13 offset:53248
 v_cvt_pk_bf16_f32 v22, v28, v29
 v_mfma_f32_16x16x32_bf16 v[72:75], a[0:3], a[80:83], v[72:75]
 v_cvt_pk_bf16_f32 v23, v30, v31
 v_cvt_pk_bf16_f32 v32, v32, v33
 v_mfma_f32_16x16x32_bf16 v[72:75], a[4:7], a[84:87], v[72:75]
 s_add_u32 s59, s56, 40960
 v_cvt_pk_bf16_f32 v33, v34, v35
 v_cvt_pk_bf16_f32 v34, v36, v37
 v_mfma_f32_16x16x32_bf16 v[64:67], a[4:7], a[92:95], v[64:67]
 buffer_store_dwordx4 v[20:23], v1, s[12:15], s59 offen offset:0 sc1
 v_mfma_f32_16x16x32_bf16 v[64:67], a[0:3], a[88:91], v[64:67]
 s_waitcnt lgkmcnt(0)
 v_cvt_pk_bf16_f32 v35, v38, v39
 v_cvt_pk_bf16_f32 v40, v40, v41
 v_mfma_f32_16x16x32_bf16 v[68:71], a[8:11], a[88:91], v[68:71]
 s_barrier
 v_xor_b32 v6, s60, v6
 v_cvt_pk_bf16_f32 v41, v42, v43
 v_mfma_f32_16x16x32_bf16 v[68:71], a[12:15], a[92:95], v[68:71]
 s_add_u32 m0, s29, 32768
 v_add_u32 v2, 0x80000, v2
 v_cvt_pk_bf16_f32 v42, v44, v45
 v_mfma_f32_16x16x32_bf16 v[76:79], a[12:15], a[84:87], v[76:79]
 buffer_load_dwordx4 v2, s[16:19], 0 offen lds
 v_mfma_f32_16x16x32_bf16 v[76:79], a[8:11], a[80:83], v[76:79]
 v_cvt_pk_bf16_f32 v43, v46, v47
 v_accvgpr_read_b32 v36, a232
 v_mfma_f32_16x16x32_bf16 v[84:87], a[8:11], a[72:75], v[84:87]
 v_accvgpr_read_b32 v37, a233
 v_accvgpr_read_b32 v38, a234
 v_mfma_f32_16x16x32_bf16 v[84:87], a[12:15], a[76:79], v[84:87]
 v_accvgpr_read_b32 v39, a235
 v_accvgpr_read_b32 v44, a236
 v_mfma_f32_16x16x32_bf16 v[92:95], a[12:15], a[68:71], v[92:95]
 s_add_u32 m0, s29, 36864
 v_accvgpr_read_b32 v45, a237
 v_accvgpr_read_b32 v46, a238
 v_mfma_f32_16x16x32_bf16 v[92:95], a[8:11], a[64:67], v[92:95]
 buffer_load_dwordx4 v2, s[16:19], s48 offen lds
 v_mfma_f32_16x16x32_bf16 v[120:123], a[16:19], a[64:67], v[120:123]
 v_accvgpr_read_b32 v47, a239
 v_cvt_pk_bf16_f32 v36, v36, v37
 v_mfma_f32_16x16x32_bf16 v[120:123], a[20:23], a[68:71], v[120:123]
 v_cvt_pk_bf16_f32 v37, v38, v39
 v_cvt_pk_bf16_f32 v38, v44, v45
 v_mfma_f32_16x16x32_bf16 v[112:115], a[20:23], a[76:79], v[112:115]
 v_cvt_pk_bf16_f32 v39, v46, v47
 v_cvt_pk_bf16_f32 v48, v48, v49
 v_mfma_f32_16x16x32_bf16 v[112:115], a[16:19], a[72:75], v[112:115]
 s_add_u32 m0, s29, 40960
 v_cvt_pk_bf16_f32 v49, v50, v51
 v_cvt_pk_bf16_f32 v50, v52, v53
 v_mfma_f32_16x16x32_bf16 v[104:107], a[16:19], a[80:83], v[104:107]
 buffer_load_dwordx4 v2, s[16:19], s49 offen lds
 v_mfma_f32_16x16x32_bf16 v[104:107], a[20:23], a[84:87], v[104:107]
 v_cvt_pk_bf16_f32 v51, v54, v55
 v_cvt_pk_bf16_f32 v56, v56, v57
 v_mfma_f32_16x16x32_bf16 v[96:99], a[20:23], a[92:95], v[96:99]
 v_cvt_pk_bf16_f32 v57, v58, v59
 v_cvt_pk_bf16_f32 v58, v60, v61
 v_mfma_f32_16x16x32_bf16 v[96:99], a[16:19], a[88:91], v[96:99]
 v_cvt_pk_bf16_f32 v59, v62, v63
 v_cvt_pk_bf16_f32 v64, v64, v65
 v_mfma_f32_16x16x32_bf16 v[100:103], a[24:27], a[88:91], v[100:103]
 s_add_u32 m0, s29, 45056
 v_cvt_pk_bf16_f32 v65, v66, v67
 v_cvt_pk_bf16_f32 v66, v68, v69
 v_mfma_f32_16x16x32_bf16 v[100:103], a[28:31], a[92:95], v[100:103]
 buffer_load_dwordx4 v2, s[16:19], s50 offen lds
 v_mfma_f32_16x16x32_bf16 v[108:111], a[28:31], a[84:87], v[108:111]
 s_add_u32 s59, s56, 32768
 v_cvt_pk_bf16_f32 v67, v70, v71
 v_cvt_pk_bf16_f32 v72, v72, v73
 v_mfma_f32_16x16x32_bf16 v[108:111], a[24:27], a[80:83], v[108:111]
 buffer_store_dwordx4 v[36:39], v1, s[12:15], s59 offen offset:0 sc1
 v_mfma_f32_16x16x32_bf16 v[116:119], a[24:27], a[72:75], v[116:119]
 v_cvt_pk_bf16_f32 v73, v74, v75
 v_cvt_pk_bf16_f32 v74, v76, v77
 v_mfma_f32_16x16x32_bf16 v[116:119], a[28:31], a[76:79], v[116:119]
 s_add_u32 m0, s29, 49152
 v_cvt_pk_bf16_f32 v75, v78, v79
 v_cvt_pk_bf16_f32 v80, v80, v81
 v_mfma_f32_16x16x32_bf16 v[124:127], a[28:31], a[68:71], v[124:127]
 buffer_load_dwordx4 v2, s[16:19], s51 offen lds
 v_mfma_f32_16x16x32_bf16 v[124:127], a[24:27], a[64:67], v[124:127]
 v_cvt_pk_bf16_f32 v81, v82, v83
 v_cvt_pk_bf16_f32 v82, v84, v85
 v_mfma_f32_16x16x32_bf16 v[152:155], a[32:35], a[64:67], v[152:155]
 v_cvt_pk_bf16_f32 v83, v86, v87
 v_cvt_pk_bf16_f32 v88, v88, v89
 v_mfma_f32_16x16x32_bf16 v[152:155], a[36:39], a[68:71], v[152:155]
 v_cvt_pk_bf16_f32 v89, v90, v91
 v_cvt_pk_bf16_f32 v90, v92, v93
 v_mfma_f32_16x16x32_bf16 v[144:147], a[36:39], a[76:79], v[144:147]
 s_add_u32 m0, s29, 53248
 v_cvt_pk_bf16_f32 v91, v94, v95
 v_cvt_pk_bf16_f32 v96, v96, v97
 v_mfma_f32_16x16x32_bf16 v[144:147], a[32:35], a[72:75], v[144:147]
 buffer_load_dwordx4 v2, s[16:19], s52 offen lds
 v_mfma_f32_16x16x32_bf16 v[136:139], a[32:35], a[80:83], v[136:139]
 v_cvt_pk_bf16_f32 v97, v98, v99
 v_cvt_pk_bf16_f32 v98, v100, v101
 v_mfma_f32_16x16x32_bf16 v[136:139], a[36:39], a[84:87], v[136:139]
 v_cvt_pk_bf16_f32 v99, v102, v103
 v_cvt_pk_bf16_f32 v104, v104, v105
 v_mfma_f32_16x16x32_bf16 v[128:131], a[36:39], a[92:95], v[128:131]
 v_cvt_pk_bf16_f32 v105, v106, v107
 v_cvt_pk_bf16_f32 v106, v108, v109
 v_mfma_f32_16x16x32_bf16 v[128:131], a[32:35], a[88:91], v[128:131]
 s_add_u32 m0, s29, 57344
 v_cvt_pk_bf16_f32 v107, v110, v111
 v_cvt_pk_bf16_f32 v112, v112, v113
 v_mfma_f32_16x16x32_bf16 v[132:135], a[40:43], a[88:91], v[132:135]
 buffer_load_dwordx4 v2, s[16:19], s53 offen lds
 v_mfma_f32_16x16x32_bf16 v[132:135], a[44:47], a[92:95], v[132:135]
 v_cvt_pk_bf16_f32 v113, v114, v115
 v_cvt_pk_bf16_f32 v114, v116, v117
 v_mfma_f32_16x16x32_bf16 v[140:143], a[44:47], a[84:87], v[140:143]
 v_cvt_pk_bf16_f32 v115, v118, v119
 v_cvt_pk_bf16_f32 v120, v120, v121
 v_mfma_f32_16x16x32_bf16 v[140:143], a[40:43], a[80:83], v[140:143]
 v_cvt_pk_bf16_f32 v121, v122, v123
 v_cvt_pk_bf16_f32 v122, v124, v125
 v_mfma_f32_16x16x32_bf16 v[148:151], a[40:43], a[72:75], v[148:151]
 s_add_u32 m0, s29, 61440
 v_cvt_pk_bf16_f32 v123, v126, v127
 v_mfma_f32_16x16x32_bf16 v[148:151], a[44:47], a[76:79], v[148:151]
 buffer_load_dwordx4 v2, s[16:19], s54 offen lds
 v_mfma_f32_16x16x32_bf16 v[156:159], a[44:47], a[68:71], v[156:159]
 v_mfma_f32_16x16x32_bf16 v[156:159], a[40:43], a[64:67], v[156:159]
 v_mfma_f32_16x16x32_bf16 v[184:187], a[48:51], a[64:67], v[184:187]
 s_add_u32 m0, s29, 98304
 v_add_u32 v2, 0x80000, v2
 v_mfma_f32_16x16x32_bf16 v[184:187], a[52:55], a[68:71], v[184:187]
 buffer_load_dwordx4 v2, s[16:19], 0 offen lds
 v_mfma_f32_16x16x32_bf16 v[176:179], a[52:55], a[76:79], v[176:179]
 v_cvt_pk_bf16_f32 v128, v128, v129
 v_cvt_pk_bf16_f32 v129, v130, v131
 v_mfma_f32_16x16x32_bf16 v[176:179], a[48:51], a[72:75], v[176:179]
 v_cvt_pk_bf16_f32 v130, v132, v133
 v_cvt_pk_bf16_f32 v131, v134, v135
 v_mfma_f32_16x16x32_bf16 v[168:171], a[48:51], a[80:83], v[168:171]
 v_cvt_pk_bf16_f32 v136, v136, v137
 v_cvt_pk_bf16_f32 v137, v138, v139
 v_mfma_f32_16x16x32_bf16 v[168:171], a[52:55], a[84:87], v[168:171]
 s_add_u32 m0, s29, 102400
 v_cvt_pk_bf16_f32 v138, v140, v141
 v_cvt_pk_bf16_f32 v139, v142, v143
 v_mfma_f32_16x16x32_bf16 v[160:163], a[52:55], a[92:95], v[160:163]
 buffer_load_dwordx4 v2, s[16:19], s48 offen lds
 v_mfma_f32_16x16x32_bf16 v[160:163], a[48:51], a[88:91], v[160:163]
 v_cvt_pk_bf16_f32 v144, v144, v145
 v_cvt_pk_bf16_f32 v145, v146, v147
 v_mfma_f32_16x16x32_bf16 v[164:167], a[56:59], a[88:91], v[164:167]
 v_cvt_pk_bf16_f32 v146, v148, v149
 v_cvt_pk_bf16_f32 v147, v150, v151
 v_mfma_f32_16x16x32_bf16 v[164:167], a[60:63], a[92:95], v[164:167]
 v_cvt_pk_bf16_f32 v152, v152, v153
 v_cvt_pk_bf16_f32 v153, v154, v155
 v_mfma_f32_16x16x32_bf16 v[172:175], a[60:63], a[84:87], v[172:175]
 s_add_u32 m0, s29, 106496
 v_cvt_pk_bf16_f32 v154, v156, v157
 v_cvt_pk_bf16_f32 v155, v158, v159
 v_mfma_f32_16x16x32_bf16 v[172:175], a[56:59], a[80:83], v[172:175]
 buffer_load_dwordx4 v2, s[16:19], s49 offen lds
 v_mfma_f32_16x16x32_bf16 v[180:183], a[56:59], a[72:75], v[180:183]
 v_mfma_f32_16x16x32_bf16 v[180:183], a[60:63], a[76:79], v[180:183]
 v_mfma_f32_16x16x32_bf16 v[188:191], a[60:63], a[68:71], v[188:191]
 v_mfma_f32_16x16x32_bf16 v[188:191], a[56:59], a[64:67], v[188:191]
 s_add_u32 m0, s29, 110592
 v_mfma_f32_16x16x32_bf16 v[216:219], a[32:35], a[96:99], v[216:219]
 buffer_load_dwordx4 v2, s[16:19], s50 offen lds
 v_mfma_f32_16x16x32_bf16 v[216:219], a[36:39], a[100:103], v[216:219]
 v_cvt_pk_bf16_f32 v160, v160, v161
 v_cvt_pk_bf16_f32 v161, v162, v163
 v_mfma_f32_16x16x32_bf16 v[208:211], a[36:39], a[108:111], v[208:211]
 v_cvt_pk_bf16_f32 v162, v164, v165
 v_cvt_pk_bf16_f32 v163, v166, v167
 v_mfma_f32_16x16x32_bf16 v[208:211], a[32:35], a[104:107], v[208:211]
 v_cvt_pk_bf16_f32 v168, v168, v169
 v_cvt_pk_bf16_f32 v169, v170, v171
 v_mfma_f32_16x16x32_bf16 v[200:203], a[32:35], a[112:115], v[200:203]
 s_add_u32 m0, s29, 114688
 v_cvt_pk_bf16_f32 v170, v172, v173
 v_cvt_pk_bf16_f32 v171, v174, v175
 v_mfma_f32_16x16x32_bf16 v[200:203], a[36:39], a[116:119], v[200:203]
 buffer_load_dwordx4 v2, s[16:19], s51 offen lds
 v_mfma_f32_16x16x32_bf16 v[192:195], a[36:39], a[124:127], v[192:195]
 v_cvt_pk_bf16_f32 v176, v176, v177
 v_cvt_pk_bf16_f32 v177, v178, v179
 v_mfma_f32_16x16x32_bf16 v[192:195], a[32:35], a[120:123], v[192:195]
 v_cvt_pk_bf16_f32 v178, v180, v181
 v_cvt_pk_bf16_f32 v179, v182, v183
 v_mfma_f32_16x16x32_bf16 v[196:199], a[40:43], a[120:123], v[196:199]
 v_cvt_pk_bf16_f32 v184, v184, v185
 v_cvt_pk_bf16_f32 v185, v186, v187
 v_mfma_f32_16x16x32_bf16 v[196:199], a[44:47], a[124:127], v[196:199]
 s_add_u32 m0, s29, 118784
 v_cvt_pk_bf16_f32 v186, v188, v189
 v_cvt_pk_bf16_f32 v187, v190, v191
 v_mfma_f32_16x16x32_bf16 v[204:207], a[44:47], a[116:119], v[204:207]
 buffer_load_dwordx4 v2, s[16:19], s52 offen lds
 v_mfma_f32_16x16x32_bf16 v[204:207], a[40:43], a[112:115], v[204:207]
 v_mfma_f32_16x16x32_bf16 v[212:215], a[40:43], a[104:107], v[212:215]
 v_mfma_f32_16x16x32_bf16 v[212:215], a[44:47], a[108:111], v[212:215]
 v_mfma_f32_16x16x32_bf16 v[220:223], a[44:47], a[100:103], v[220:223]
 s_add_u32 m0, s29, 122880
 v_mfma_f32_16x16x32_bf16 v[220:223], a[40:43], a[96:99], v[220:223]
 buffer_load_dwordx4 v2, s[16:19], s53 offen lds
 v_mfma_f32_16x16x32_bf16 v[248:251], a[48:51], a[96:99], v[248:251]
 v_mfma_f32_16x16x32_bf16 v[248:251], a[52:55], a[100:103], v[248:251]
 s_waitcnt vmcnt(19)
 v_cvt_pk_bf16_f32 v192, v192, v193
 v_cvt_pk_bf16_f32 v193, v194, v195
 v_mfma_f32_16x16x32_bf16 v[240:243], a[52:55], a[108:111], v[240:243]
 s_barrier
 v_xor_b32 v7, 0, v6
 v_cvt_pk_bf16_f32 v194, v196, v197
 v_mfma_f32_16x16x32_bf16 v[240:243], a[48:51], a[104:107], v[240:243]
 s_add_u32 m0, s29, 126976
 ds_read_b64_tr_b16 a[64:65], v7 offset:0
 v_cvt_pk_bf16_f32 v195, v198, v199
 v_mfma_f32_16x16x32_bf16 v[232:235], a[48:51], a[112:115], v[232:235]
 ds_read_b64_tr_b16 a[66:67], v7 offset:4096
 buffer_load_dwordx4 v2, s[16:19], s54 offen lds
 v_mfma_f32_16x16x32_bf16 v[232:235], a[52:55], a[116:119], v[232:235]
 ds_read_b64_tr_b16 a[68:69], v7 offset:16384
 v_cvt_pk_bf16_f32 v200, v200, v201
 v_mfma_f32_16x16x32_bf16 v[224:227], a[52:55], a[124:127], v[224:227]
 ds_read_b64_tr_b16 a[70:71], v7 offset:20480
 v_xor_b32 v8, 65536, v6
 v_mfma_f32_16x16x32_bf16 v[224:227], a[48:51], a[120:123], v[224:227]
 ds_read_b64_tr_b16 a[72:73], v8 offset:0
 v_cvt_pk_bf16_f32 v201, v202, v203
 v_mfma_f32_16x16x32_bf16 v[228:231], a[56:59], a[120:123], v[228:231]
 ds_read_b64_tr_b16 a[74:75], v8 offset:4096
 v_cvt_pk_bf16_f32 v202, v204, v205
 v_mfma_f32_16x16x32_bf16 v[228:231], a[60:63], a[124:127], v[228:231]
 ds_read_b64_tr_b16 a[76:77], v8 offset:16384
 v_cvt_pk_bf16_f32 v203, v206, v207
 v_mfma_f32_16x16x32_bf16 v[236:239], a[60:63], a[116:119], v[236:239]
 ds_read_b64_tr_b16 a[78:79], v8 offset:20480
 v_xor_b32 v9, 32, v6
 v_mfma_f32_16x16x32_bf16 v[236:239], a[56:59], a[112:115], v[236:239]
 ds_read_b64_tr_b16 a[80:81], v9 offset:0
 v_cvt_pk_bf16_f32 v208, v208, v209
 v_mfma_f32_16x16x32_bf16 v[244:247], a[56:59], a[104:107], v[244:247]
 ds_read_b64_tr_b16 a[82:83], v9 offset:4096
 v_cvt_pk_bf16_f32 v209, v210, v211
 v_mfma_f32_16x16x32_bf16 v[244:247], a[60:63], a[108:111], v[244:247]
 ds_read_b64_tr_b16 a[84:85], v9 offset:16384
 v_cvt_pk_bf16_f32 v210, v212, v213
 v_mfma_f32_16x16x32_bf16 v[252:255], a[60:63], a[100:103], v[252:255]
 ds_read_b64_tr_b16 a[86:87], v9 offset:20480
 v_xor_b32 v10, 65568, v6
 v_mfma_f32_16x16x32_bf16 v[252:255], a[56:59], a[96:99], v[252:255]
 s_waitcnt lgkmcnt(6)
 ds_read_b64_tr_b16 a[88:89], v10 offset:0
 v_cvt_pk_bf16_f32 v211, v214, v215
 v_mfma_f32_16x16x32_bf16 v[28:31], a[64:67], a[128:131], 0
 ds_read_b64_tr_b16 a[90:91], v10 offset:4096
 v_cvt_pk_bf16_f32 v216, v216, v217
 v_mfma_f32_16x16x32_bf16 v[28:31], a[68:71], a[136:139], v[28:31]
 ds_read_b64_tr_b16 a[92:93], v10 offset:16384
 v_xor_b32 v7, 64, v6
 v_mfma_f32_16x16x32_bf16 v[28:31], a[72:75], a[144:147], v[28:31]
 s_waitcnt lgkmcnt(7)
 ds_read_b128 a[112:115], v14 offset:0
 ds_read_b64_tr_b16 a[94:95], v10 offset:20480
 v_mfma_f32_16x16x32_bf16 v[28:31], a[76:79], a[152:155], v[28:31]
 ds_read_b64_tr_b16 a[96:97], v7 offset:0
 v_cvt_pk_bf16_f32 v217, v218, v219
 v_mfma_f32_16x16x32_bf16 v[44:47], a[64:67], a[132:135], 0
 ds_read_b128 a[120:123], v3 offset:0
 ds_read_b64_tr_b16 a[98:99], v7 offset:4096
 v_mfma_f32_16x16x32_bf16 v[44:47], a[68:71], a[140:143], v[44:47]
 ds_read_b64_tr_b16 a[100:101], v7 offset:16384
 v_xor_b32 v8, 65600, v6
 v_mfma_f32_16x16x32_bf16 v[44:47], a[72:75], a[148:151], v[44:47]
 ds_read_b128 a[116:119], v14 offset:2048
 ds_read_b64_tr_b16 a[102:103], v7 offset:20480
 v_mfma_f32_16x16x32_bf16 v[44:47], a[76:79], a[156:159], v[44:47]
 s_waitcnt lgkmcnt(9)
 ds_read_b64_tr_b16 a[104:105], v8 offset:0
 v_cvt_pk_bf16_f32 v218, v220, v221
 v_mfma_f32_16x16x32_bf16 v[52:55], a[80:83], a[128:131], 0
 ds_read_b128 a[124:127], v3 offset:2048
 ds_read_b64_tr_b16 a[106:107], v8 offset:4096
 v_mfma_f32_16x16x32_bf16 v[52:55], a[84:87], a[136:139], v[52:55]
 ds_read_b64_tr_b16 a[108:109], v8 offset:16384
 v_cvt_pk_bf16_f32 v219, v222, v223
 v_mfma_f32_16x16x32_bf16 v[52:55], a[88:91], a[144:147], v[52:55]
 s_waitcnt lgkmcnt(10)
 ds_read_b64_tr_b16 a[110:111], v8 offset:20480
 v_xor_b32 v9, 96, v6
 v_mfma_f32_16x16x32_bf16 v[52:55], a[92:95], a[152:155], v[52:55]
 ds_read_b64_tr_b16 a[64:65], v9 offset:0
 v_cvt_pk_bf16_f32 v224, v224, v225
 v_mfma_f32_16x16x32_bf16 v[60:63], a[80:83], a[132:135], 0
 ds_read_b64_tr_b16 a[66:67], v9 offset:4096
 v_cvt_pk_bf16_f32 v225, v226, v227
 v_mfma_f32_16x16x32_bf16 v[60:63], a[84:87], a[140:143], v[60:63]
 ds_read_b64_tr_b16 a[68:69], v9 offset:16384
 v_cvt_pk_bf16_f32 v226, v228, v229
 v_mfma_f32_16x16x32_bf16 v[60:63], a[88:91], a[148:151], v[60:63]
 ds_read_b64_tr_b16 a[70:71], v9 offset:20480
 v_xor_b32 v10, 65632, v6
 v_mfma_f32_16x16x32_bf16 v[60:63], a[92:95], a[156:159], v[60:63]
 s_waitcnt lgkmcnt(6)
 ds_read_b64_tr_b16 a[72:73], v10 offset:0
 v_cvt_pk_bf16_f32 v227, v230, v231
 v_mfma_f32_16x16x32_bf16 v[20:23], a[96:99], a[128:131], 0
 ds_read_b64_tr_b16 a[74:75], v10 offset:4096
 v_cvt_pk_bf16_f32 v232, v232, v233
 v_mfma_f32_16x16x32_bf16 v[20:23], a[100:103], a[136:139], v[20:23]
 s_waitcnt lgkmcnt(8)
 ds_read_b64_tr_b16 a[76:77], v10 offset:16384
 v_xor_b32 v7, 128, v6
 v_mfma_f32_16x16x32_bf16 v[20:23], a[104:107], a[144:147], v[20:23]
 s_waitcnt lgkmcnt(7)
 s_barrier
 ds_read_b64_tr_b16 a[78:79], v10 offset:20480
 v_mfma_f32_16x16x32_bf16 v[20:23], a[108:111], a[152:155], v[20:23]
 s_add_u32 m0, s29, 131072
 ds_read_b64_tr_b16 a[80:81], v7 offset:0
 v_add_u32 v2, 0x80000, v2
 v_mfma_f32_16x16x32_bf16 v[36:39], a[96:99], a[132:135], 0
 ds_read_b64_tr_b16 a[82:83], v7 offset:4096
 buffer_load_dwordx4 v2, s[16:19], 0 offen lds
 v_mfma_f32_16x16x32_bf16 v[36:39], a[100:103], a[140:143], v[36:39]
 ds_read_b64_tr_b16 a[84:85], v7 offset:16384
 v_cvt_pk_bf16_f32 v233, v234, v235
 v_mfma_f32_16x16x32_bf16 v[36:39], a[104:107], a[148:151], v[36:39]
 ds_read_b64_tr_b16 a[86:87], v7 offset:20480
 v_xor_b32 v8, 65664, v6
 v_mfma_f32_16x16x32_bf16 v[36:39], a[108:111], a[156:159], v[36:39]
 s_waitcnt lgkmcnt(6)
 ds_read_b64_tr_b16 a[88:89], v8 offset:0
 v_cvt_pk_bf16_f32 v234, v236, v237
 v_mfma_f32_16x16x32_bf16 v[68:71], a[64:67], a[128:131], 0
 ds_read_b64_tr_b16 a[90:91], v8 offset:4096
 v_cvt_pk_bf16_f32 v235, v238, v239
 v_mfma_f32_16x16x32_bf16 v[68:71], a[68:71], a[136:139], v[68:71]
 s_add_u32 m0, s29, 135168
 ds_read_b64_tr_b16 a[92:93], v8 offset:16384
 v_cvt_pk_bf16_f32 v240, v240, v241
 v_mfma_f32_16x16x32_bf16 v[68:71], a[72:75], a[144:147], v[68:71]
 s_waitcnt lgkmcnt(7)
 ds_read_b64_tr_b16 a[94:95], v8 offset:20480
 v_xor_b32 v9, 160, v6
 v_mfma_f32_16x16x32_bf16 v[68:71], a[76:79], a[152:155], v[68:71]
 ds_read_b64_tr_b16 a[96:97], v9 offset:0
 buffer_load_dwordx4 v2, s[16:19], s48 offen lds
 v_mfma_f32_16x16x32_bf16 v[76:79], a[64:67], a[132:135], 0
 ds_read_b64_tr_b16 a[98:99], v9 offset:4096
 v_cvt_pk_bf16_f32 v241, v242, v243
 v_mfma_f32_16x16x32_bf16 v[76:79], a[68:71], a[140:143], v[76:79]
 ds_read_b64_tr_b16 a[100:101], v9 offset:16384
 v_cvt_pk_bf16_f32 v242, v244, v245
 v_mfma_f32_16x16x32_bf16 v[76:79], a[72:75], a[148:151], v[76:79]
 ds_read_b64_tr_b16 a[102:103], v9 offset:20480
 v_xor_b32 v10, 65696, v6
 v_mfma_f32_16x16x32_bf16 v[76:79], a[76:79], a[156:159], v[76:79]
 s_waitcnt lgkmcnt(6)
 ds_read_b64_tr_b16 a[104:105], v10 offset:0
 v_cvt_pk_bf16_f32 v243, v246, v247
 v_mfma_f32_16x16x32_bf16 v[84:87], a[80:83], a[128:131], 0
 s_add_u32 m0, s29, 139264
 ds_read_b64_tr_b16 a[106:107], v10 offset:4096
 v_cvt_pk_bf16_f32 v248, v248, v249
 v_mfma_f32_16x16x32_bf16 v[84:87], a[84:87], a[136:139], v[84:87]
 ds_read_b64_tr_b16 a[108:109], v10 offset:16384
 buffer_load_dwordx4 v2, s[16:19], s49 offen lds
 v_mfma_f32_16x16x32_bf16 v[84:87], a[88:91], a[144:147], v[84:87]
 s_waitcnt lgkmcnt(7)
 ds_read_b64_tr_b16 a[110:111], v10 offset:20480
 v_xor_b32 v7, 192, v6
 v_mfma_f32_16x16x32_bf16 v[84:87], a[92:95], a[152:155], v[84:87]
 ds_read_b64_tr_b16 a[64:65], v7 offset:0
 v_cvt_pk_bf16_f32 v249, v250, v251
 v_mfma_f32_16x16x32_bf16 v[92:95], a[80:83], a[132:135], 0
 ds_read_b64_tr_b16 a[66:67], v7 offset:4096
 v_cvt_pk_bf16_f32 v250, v252, v253
 v_mfma_f32_16x16x32_bf16 v[92:95], a[84:87], a[140:143], v[92:95]
 ds_read_b64_tr_b16 a[68:69], v7 offset:16384
 v_cvt_pk_bf16_f32 v251, v254, v255
 v_mfma_f32_16x16x32_bf16 v[92:95], a[88:91], a[148:151], v[92:95]
 s_add_u32 m0, s29, 143360
 ds_read_b64_tr_b16 a[70:71], v7 offset:20480
 v_xor_b32 v8, 65728, v6
 v_mfma_f32_16x16x32_bf16 v[92:95], a[92:95], a[156:159], v[92:95]
 s_waitcnt lgkmcnt(6)
 ds_read_b64_tr_b16 a[72:73], v8 offset:0
 buffer_load_dwordx4 v2, s[16:19], s50 offen lds
 v_mfma_f32_16x16x32_bf16 v[100:103], a[96:99], a[128:131], 0
 ds_read_b64_tr_b16 a[74:75], v8 offset:4096
 v_mov_b32 v12, 0
 v_mfma_f32_16x16x32_bf16 v[100:103], a[100:103], a[136:139], v[100:103]
 ds_read_b64_tr_b16 a[76:77], v8 offset:16384
 global_load_dword v5, v12, s[90:91] offset:128 sc1
 v_mfma_f32_16x16x32_bf16 v[100:103], a[104:107], a[144:147], v[100:103]
 s_waitcnt lgkmcnt(7)
 ds_read_b64_tr_b16 a[78:79], v8 offset:20480
 v_xor_b32 v9, 224, v6
 v_mfma_f32_16x16x32_bf16 v[100:103], a[108:111], a[152:155], v[100:103]
 s_and_b32 s36, s95, 31
 ds_read_b64_tr_b16 a[80:81], v9 offset:0
 v_and_b32 v12, 11, v0
 v_mfma_f32_16x16x32_bf16 v[108:111], a[96:99], a[132:135], 0
 s_add_u32 m0, s29, 147456
 ds_read_b64_tr_b16 a[82:83], v9 offset:4096
 v_lshlrev_b32 v12, 2, v12
 v_mfma_f32_16x16x32_bf16 v[108:111], a[100:103], a[140:143], v[108:111]
 ds_read_b64_tr_b16 a[84:85], v9 offset:16384
 buffer_load_dwordx4 v2, s[16:19], s51 offen lds
 v_mfma_f32_16x16x32_bf16 v[108:111], a[104:107], a[148:151], v[108:111]
 s_lshr_b32 s37, s95, 5
 ds_read_b64_tr_b16 a[86:87], v9 offset:20480
 v_xor_b32 v10, 65760, v6
 v_mfma_f32_16x16x32_bf16 v[108:111], a[108:111], a[156:159], v[108:111]
 s_waitcnt lgkmcnt(6)
 ds_read_b64_tr_b16 a[88:89], v10 offset:0
 v_and_b32 v14, 15, v0
 v_mfma_f32_16x16x32_bf16 v[116:119], a[64:67], a[128:131], 0
 s_lshl_b32 s38, s3, 4
 ds_read_b64_tr_b16 a[90:91], v10 offset:4096
 v_lshrrev_b32 v3, 4, v0
 v_mfma_f32_16x16x32_bf16 v[116:119], a[68:71], a[136:139], v[116:119]
 s_add_u32 m0, s29, 151552
 ds_read_b64_tr_b16 a[92:93], v10 offset:16384
 v_lshlrev_b32 v3, 2, v3
 v_mfma_f32_16x16x32_bf16 v[116:119], a[72:75], a[144:147], v[116:119]
 s_waitcnt lgkmcnt(7)
 ds_read_b64_tr_b16 a[94:95], v10 offset:20480
 v_xor_b32 v7, 256, v6
 v_mfma_f32_16x16x32_bf16 v[116:119], a[76:79], a[152:155], v[116:119]
 ds_read_b64_tr_b16 a[96:97], v7 offset:0
 buffer_load_dwordx4 v2, s[16:19], s52 offen lds
 v_mfma_f32_16x16x32_bf16 v[124:127], a[64:67], a[132:135], 0
 s_lshl_b32 s39, s36, 6
 ds_read_b64_tr_b16 a[98:99], v7 offset:4096
 v_sub_u32 v14, v14, v3
 v_mfma_f32_16x16x32_bf16 v[124:127], a[68:71], a[140:143], v[124:127]
 s_add_u32 s38, s38, s39
 ds_read_b64_tr_b16 a[100:101], v7 offset:16384
 v_lshrrev_b32_e64 v3, 6, s29
 v_mfma_f32_16x16x32_bf16 v[124:127], a[72:75], a[148:151], v[124:127]
 s_mul_i32 s38, s38, 896
 ds_read_b64_tr_b16 a[102:103], v7 offset:20480
 v_xor_b32 v8, 65792, v6
 v_mfma_f32_16x16x32_bf16 v[124:127], a[76:79], a[156:159], v[124:127]
 s_waitcnt lgkmcnt(6)
 ds_read_b64_tr_b16 a[104:105], v8 offset:0
 v_add_u32 v14, v3, v14
 v_mfma_f32_16x16x32_bf16 v[132:135], a[80:83], a[128:131], 0
 s_add_u32 m0, s29, 155648
 ds_read_b64_tr_b16 a[106:107], v8 offset:4096
 v_mov_b32 v15, 0xf149f2ca
 v_mfma_f32_16x16x32_bf16 v[132:135], a[84:87], a[136:139], v[132:135]
 ds_read_b64_tr_b16 a[108:109], v8 offset:16384
 buffer_load_dwordx4 v2, s[16:19], s53 offen lds
 v_mfma_f32_16x16x32_bf16 v[132:135], a[88:91], a[144:147], v[132:135]
 s_waitcnt lgkmcnt(7)
 ds_read_b64_tr_b16 a[110:111], v8 offset:20480
 v_xor_b32 v9, 288, v6
 v_mfma_f32_16x16x32_bf16 v[132:135], a[92:95], a[152:155], v[132:135]
 s_lshl_b32 s39, s37, 7
 ds_read_b64_tr_b16 a[64:65], v9 offset:0
 v_cmp_gt_i32 vcc, 0, v14
 v_mfma_f32_16x16x32_bf16 v[140:143], a[80:83], a[132:135], 0
 s_add_u32 s38, s38, s39
 ds_read_b64_tr_b16 a[66:67], v9 offset:4096
 v_cndmask_b32 v3, 0, v15, vcc
 v_mfma_f32_16x16x32_bf16 v[140:143], a[84:87], a[140:143], v[140:143]
 s_lshl_b32 s39, s37, 9
 ds_read_b64_tr_b16 a[68:69], v9 offset:16384
 v_accvgpr_write_b32 a224, v3
 v_mfma_f32_16x16x32_bf16 v[140:143], a[88:91], a[148:151], v[140:143]
 s_add_u32 m0, s29, 159744
 ds_read_b64_tr_b16 a[70:71], v9 offset:20480
 v_xor_b32 v10, 65824, v6
 v_mfma_f32_16x16x32_bf16 v[140:143], a[92:95], a[156:159], v[140:143]
 s_waitcnt lgkmcnt(6)
 ds_read_b64_tr_b16 a[72:73], v10 offset:0
 buffer_load_dwordx4 v2, s[16:19], s54 offen lds
 v_mfma_f32_16x16x32_bf16 v[148:151], a[96:99], a[128:131], 0
 s_mov_b32 s4, s66
 ds_read_b64_tr_b16 a[74:75], v10 offset:4096
 v_cmp_gt_i32 vcc, 1, v14
 v_mfma_f32_16x16x32_bf16 v[148:151], a[100:103], a[136:139], v[148:151]
 s_mov_b32 s5, s67
 ds_read_b64_tr_b16 a[76:77], v10 offset:16384
 v_cndmask_b32 v3, 0, v15, vcc
 v_mfma_f32_16x16x32_bf16 v[148:151], a[104:107], a[144:147], v[148:151]
 s_waitcnt lgkmcnt(7)
 ds_read_b64_tr_b16 a[78:79], v10 offset:20480
 v_xor_b32 v7, 320, v6
 v_mfma_f32_16x16x32_bf16 v[148:151], a[108:111], a[152:155], v[148:151]
 s_mov_b32 s6, 1835008
 ds_read_b64_tr_b16 a[80:81], v7 offset:0
 v_accvgpr_write_b32 a225, v3
 v_mfma_f32_16x16x32_bf16 v[156:159], a[96:99], a[132:135], 0
 s_mov_b32 s7, 0x20000
 ds_read_b64_tr_b16 a[82:83], v7 offset:4096
 v_cmp_gt_i32 vcc, 2, v14
 v_mfma_f32_16x16x32_bf16 v[156:159], a[100:103], a[140:143], v[156:159]
 s_mov_b32 s8, s68
 ds_read_b64_tr_b16 a[84:85], v7 offset:16384
 v_cndmask_b32 v3, 0, v15, vcc
 v_mfma_f32_16x16x32_bf16 v[156:159], a[104:107], a[148:151], v[156:159]
 s_mov_b32 s9, s69
 ds_read_b64_tr_b16 a[86:87], v7 offset:20480
 v_xor_b32 v8, 65856, v6
 v_mfma_f32_16x16x32_bf16 v[156:159], a[108:111], a[156:159], v[156:159]
 s_waitcnt lgkmcnt(6)
 ds_read_b64_tr_b16 a[88:89], v8 offset:0
 v_accvgpr_write_b32 a226, v3
 v_mfma_f32_16x16x32_bf16 v[164:167], a[64:67], a[128:131], 0
 s_mov_b32 s10, 1835008
 ds_read_b64_tr_b16 a[90:91], v8 offset:4096
 v_cmp_gt_i32 vcc, 3, v14
 v_mfma_f32_16x16x32_bf16 v[164:167], a[68:71], a[136:139], v[164:167]
 s_mov_b32 s11, 0x20000
 ds_read_b64_tr_b16 a[92:93], v8 offset:16384
 v_cndmask_b32 v3, 0, v15, vcc
 v_mfma_f32_16x16x32_bf16 v[164:167], a[72:75], a[144:147], v[164:167]
 s_waitcnt lgkmcnt(7)
 ds_read_b64_tr_b16 a[94:95], v8 offset:20480
 v_xor_b32 v9, 352, v6
 v_mfma_f32_16x16x32_bf16 v[164:167], a[76:79], a[152:155], v[164:167]
 s_mov_b32 s20, s70
 ds_read_b64_tr_b16 a[96:97], v9 offset:0
 v_accvgpr_write_b32 a227, v3
 v_mfma_f32_16x16x32_bf16 v[172:175], a[64:67], a[132:135], 0
 s_mov_b32 s21, s71
 ds_read_b64_tr_b16 a[98:99], v9 offset:4096
 v_cmp_gt_i32 vcc, 16, v14
 v_mfma_f32_16x16x32_bf16 v[172:175], a[68:71], a[140:143], v[172:175]
 s_mov_b32 s22, 3584
 ds_read_b64_tr_b16 a[100:101], v9 offset:16384
 v_cndmask_b32 v3, 0, v15, vcc
 v_mfma_f32_16x16x32_bf16 v[172:175], a[72:75], a[148:151], v[172:175]
 s_mov_b32 s23, 0x20000
 ds_read_b64_tr_b16 a[102:103], v9 offset:20480
 v_xor_b32 v10, 65888, v6
 v_mfma_f32_16x16x32_bf16 v[172:175], a[76:79], a[156:159], v[172:175]
 s_waitcnt lgkmcnt(6)
 ds_read_b64_tr_b16 a[104:105], v10 offset:0
 v_accvgpr_write_b32 a228, v3
 v_mfma_f32_16x16x32_bf16 v[180:183], a[80:83], a[128:131], 0
 ds_read_b64_tr_b16 a[106:107], v10 offset:4096
 v_cmp_gt_i32 vcc, 17, v14
 v_mfma_f32_16x16x32_bf16 v[180:183], a[84:87], a[136:139], v[180:183]
 ds_read_b64_tr_b16 a[108:109], v10 offset:16384
 v_cndmask_b32 v3, 0, v15, vcc
 v_mfma_f32_16x16x32_bf16 v[180:183], a[88:91], a[144:147], v[180:183]
 s_waitcnt lgkmcnt(7)
 ds_read_b64_tr_b16 a[110:111], v10 offset:20480
 v_xor_b32 v7, 384, v6
 v_mfma_f32_16x16x32_bf16 v[180:183], a[92:95], a[152:155], v[180:183]
 ds_read_b64_tr_b16 a[64:65], v7 offset:0
 v_accvgpr_write_b32 a229, v3
 v_mfma_f32_16x16x32_bf16 v[188:191], a[80:83], a[132:135], 0
 ds_read_b64_tr_b16 a[66:67], v7 offset:4096
 v_cmp_gt_i32 vcc, 18, v14
 v_mfma_f32_16x16x32_bf16 v[188:191], a[84:87], a[140:143], v[188:191]
 ds_read_b64_tr_b16 a[68:69], v7 offset:16384
 v_cndmask_b32 v3, 0, v15, vcc
 v_mfma_f32_16x16x32_bf16 v[188:191], a[88:91], a[148:151], v[188:191]
 ds_read_b64_tr_b16 a[70:71], v7 offset:20480
 v_xor_b32 v8, 65920, v6
 v_mfma_f32_16x16x32_bf16 v[188:191], a[92:95], a[156:159], v[188:191]
 s_waitcnt lgkmcnt(6)
 ds_read_b64_tr_b16 a[72:73], v8 offset:0
 v_accvgpr_write_b32 a230, v3
 v_mfma_f32_16x16x32_bf16 v[196:199], a[96:99], a[128:131], 0
 ds_read_b64_tr_b16 a[74:75], v8 offset:4096
 v_cmp_gt_i32 vcc, 19, v14
 v_mfma_f32_16x16x32_bf16 v[196:199], a[100:103], a[136:139], v[196:199]
 ds_read_b64_tr_b16 a[76:77], v8 offset:16384
 v_cndmask_b32 v3, 0, v15, vcc
 v_mfma_f32_16x16x32_bf16 v[196:199], a[104:107], a[144:147], v[196:199]
 s_waitcnt lgkmcnt(7)
 ds_read_b64_tr_b16 a[78:79], v8 offset:20480
 v_xor_b32 v9, 416, v6
 v_mfma_f32_16x16x32_bf16 v[196:199], a[108:111], a[152:155], v[196:199]
 ds_read_b64_tr_b16 a[80:81], v9 offset:0
 v_accvgpr_write_b32 a231, v3
 v_mfma_f32_16x16x32_bf16 v[204:207], a[96:99], a[132:135], 0
 ds_read_b64_tr_b16 a[82:83], v9 offset:4096
 v_cmp_gt_i32 vcc, 32, v14
 v_mfma_f32_16x16x32_bf16 v[204:207], a[100:103], a[140:143], v[204:207]
 ds_read_b64_tr_b16 a[84:85], v9 offset:16384
 v_cndmask_b32 v3, 0, v15, vcc
 v_mfma_f32_16x16x32_bf16 v[204:207], a[104:107], a[148:151], v[204:207]
 ds_read_b64_tr_b16 a[86:87], v9 offset:20480
 v_xor_b32 v10, 65952, v6
 v_mfma_f32_16x16x32_bf16 v[204:207], a[108:111], a[156:159], v[204:207]
 s_waitcnt lgkmcnt(6)
 ds_read_b64_tr_b16 a[88:89], v10 offset:0
 v_accvgpr_write_b32 a232, v3
 v_mfma_f32_16x16x32_bf16 v[212:215], a[64:67], a[128:131], 0
 ds_read_b64_tr_b16 a[90:91], v10 offset:4096
 v_cmp_gt_i32 vcc, 33, v14
 v_mfma_f32_16x16x32_bf16 v[212:215], a[68:71], a[136:139], v[212:215]
 ds_read_b64_tr_b16 a[92:93], v10 offset:16384
 v_cndmask_b32 v3, 0, v15, vcc
 v_mfma_f32_16x16x32_bf16 v[212:215], a[72:75], a[144:147], v[212:215]
 s_waitcnt lgkmcnt(7)
 ds_read_b64_tr_b16 a[94:95], v10 offset:20480
 v_xor_b32 v7, 448, v6
 v_mfma_f32_16x16x32_bf16 v[212:215], a[76:79], a[152:155], v[212:215]
 s_add_u32 s59, s56, 57344
 ds_read_b64_tr_b16 a[96:97], v7 offset:0
 v_accvgpr_write_b32 a233, v3
 v_mfma_f32_16x16x32_bf16 v[220:223], a[64:67], a[132:135], 0
 ds_read_b64_tr_b16 a[98:99], v7 offset:4096
 buffer_store_dwordx4 v[32:35], v1, s[12:15], s59 offen offset:1024 sc1
 v_mfma_f32_16x16x32_bf16 v[220:223], a[68:71], a[140:143], v[220:223]
 ds_read_b64_tr_b16 a[100:101], v7 offset:16384
 v_cmp_gt_i32 vcc, 34, v14
 v_mfma_f32_16x16x32_bf16 v[220:223], a[72:75], a[148:151], v[220:223]
 ds_read_b64_tr_b16 a[102:103], v7 offset:20480
 v_xor_b32 v8, 65984, v6
 v_mfma_f32_16x16x32_bf16 v[220:223], a[76:79], a[156:159], v[220:223]
 s_waitcnt lgkmcnt(6)
 ds_read_b64_tr_b16 a[104:105], v8 offset:0
 v_cndmask_b32 v3, 0, v15, vcc
 v_mfma_f32_16x16x32_bf16 v[228:231], a[80:83], a[128:131], 0
 ds_read_b64_tr_b16 a[106:107], v8 offset:4096
 v_accvgpr_write_b32 a234, v3
 v_mfma_f32_16x16x32_bf16 v[228:231], a[84:87], a[136:139], v[228:231]
 ds_read_b64_tr_b16 a[108:109], v8 offset:16384
 v_cmp_gt_i32 vcc, 35, v14
 v_mfma_f32_16x16x32_bf16 v[228:231], a[88:91], a[144:147], v[228:231]
 s_waitcnt lgkmcnt(7)
 ds_read_b64_tr_b16 a[110:111], v8 offset:20480
 v_xor_b32 v9, 480, v6
 v_mfma_f32_16x16x32_bf16 v[228:231], a[92:95], a[152:155], v[228:231]
 ds_read_b64_tr_b16 a[64:65], v9 offset:0
 v_cndmask_b32 v3, 0, v15, vcc
 v_mfma_f32_16x16x32_bf16 v[236:239], a[80:83], a[132:135], 0
 ds_read_b64_tr_b16 a[66:67], v9 offset:4096
 v_accvgpr_write_b32 a235, v3
 v_mfma_f32_16x16x32_bf16 v[236:239], a[84:87], a[140:143], v[236:239]
 ds_read_b64_tr_b16 a[68:69], v9 offset:16384
 v_cmp_gt_i32 vcc, 48, v14
 v_mfma_f32_16x16x32_bf16 v[236:239], a[88:91], a[148:151], v[236:239]
 s_add_u32 s59, s56, 49152
 ds_read_b64_tr_b16 a[70:71], v9 offset:20480
 v_xor_b32 v10, 66016, v6
 v_mfma_f32_16x16x32_bf16 v[236:239], a[92:95], a[156:159], v[236:239]
 s_waitcnt lgkmcnt(6)
 ds_read_b64_tr_b16 a[72:73], v10 offset:0
 buffer_store_dwordx4 v[40:43], v1, s[12:15], s59 offen offset:1024 sc1
 v_mfma_f32_16x16x32_bf16 v[244:247], a[96:99], a[128:131], 0
 ds_read_b64_tr_b16 a[74:75], v10 offset:4096
 v_cndmask_b32 v3, 0, v15, vcc
 v_mfma_f32_16x16x32_bf16 v[244:247], a[100:103], a[136:139], v[244:247]
 s_waitcnt vmcnt(11)
 ds_read_b64_tr_b16 a[76:77], v10 offset:16384
 v_xor_b32 v7, 32768, v6
 v_mfma_f32_16x16x32_bf16 v[244:247], a[104:107], a[144:147], v[244:247]
 s_waitcnt lgkmcnt(7)
 s_barrier
 ds_read_b64_tr_b16 a[78:79], v10 offset:20480
 v_mfma_f32_16x16x32_bf16 v[244:247], a[108:111], a[152:155], v[244:247]
 ds_read_b64_tr_b16 a[80:81], v7 offset:0
 v_accvgpr_write_b32 a236, v3
 v_mfma_f32_16x16x32_bf16 v[252:255], a[96:99], a[132:135], 0
 ds_read_b64_tr_b16 a[82:83], v7 offset:4096
 v_cmp_gt_i32 vcc, 49, v14
 v_mfma_f32_16x16x32_bf16 v[252:255], a[100:103], a[140:143], v[252:255]
 ds_read_b64_tr_b16 a[84:85], v7 offset:16384
 v_cndmask_b32 v3, 0, v15, vcc
 v_mfma_f32_16x16x32_bf16 v[252:255], a[104:107], a[148:151], v[252:255]
 ds_read_b64_tr_b16 a[86:87], v7 offset:20480
 v_xor_b32 v8, 98304, v6
 v_mfma_f32_16x16x32_bf16 v[252:255], a[108:111], a[156:159], v[252:255]
 s_waitcnt lgkmcnt(6)
 ds_read_b64_tr_b16 a[88:89], v8 offset:0
 v_accvgpr_write_b32 a237, v3
 v_mfma_f32_16x16x32_bf16 v[16:19], a[64:67], a[128:131], 0
 s_add_u32 s59, s56, 40960
 ds_read_b64_tr_b16 a[90:91], v8 offset:4096
 v_cmp_gt_i32 vcc, 50, v14
 v_mfma_f32_16x16x32_bf16 v[16:19], a[68:71], a[136:139], v[16:19]
 ds_read_b64_tr_b16 a[92:93], v8 offset:16384
 buffer_store_dwordx4 v[48:51], v1, s[12:15], s59 offen offset:1024 sc1
 v_mfma_f32_16x16x32_bf16 v[16:19], a[72:75], a[144:147], v[16:19]
 s_waitcnt lgkmcnt(7)
 ds_read_b64_tr_b16 a[94:95], v8 offset:20480
 v_xor_b32 v9, 32800, v6
 v_mfma_f32_16x16x32_bf16 v[16:19], a[76:79], a[152:155], v[16:19]
 ds_read_b64_tr_b16 a[96:97], v9 offset:0
 v_cndmask_b32 v3, 0, v15, vcc
 v_mfma_f32_16x16x32_bf16 v[24:27], a[64:67], a[132:135], 0
 s_waitcnt lgkmcnt(9)
 ds_read_b64_tr_b16 a[98:99], v9 offset:4096
 v_accvgpr_write_b32 a238, v3
 v_mfma_f32_16x16x32_bf16 v[24:27], a[68:71], a[140:143], v[24:27]
 s_barrier
 ds_read_b64_tr_b16 a[100:101], v9 offset:16384
 v_cmp_gt_i32 vcc, 51, v14
 v_mfma_f32_16x16x32_bf16 v[24:27], a[72:75], a[148:151], v[24:27]
 s_add_u32 m0, s29, 0
 ds_read_b64_tr_b16 a[102:103], v9 offset:20480
 v_xor_b32 v10, 98336, v6
 v_mfma_f32_16x16x32_bf16 v[24:27], a[76:79], a[156:159], v[24:27]
 s_waitcnt lgkmcnt(6)
 ds_read_b64_tr_b16 a[104:105], v10 offset:0
 v_add_u32 v2, 0x80000, v2
 v_mfma_f32_16x16x32_bf16 v[28:31], a[80:83], a[160:163], v[28:31]
 ds_read_b64_tr_b16 a[106:107], v10 offset:4096
 buffer_load_dwordx4 v2, s[16:19], 0 offen lds
 v_mfma_f32_16x16x32_bf16 v[28:31], a[84:87], a[168:171], v[28:31]
 s_add_u32 s59, s56, 32768
 ds_read_b64_tr_b16 a[108:109], v10 offset:16384
 v_cndmask_b32 v3, 0, v15, vcc
 v_mfma_f32_16x16x32_bf16 v[28:31], a[88:91], a[176:179], v[28:31]
 s_waitcnt lgkmcnt(7)
 ds_read_b64_tr_b16 a[110:111], v10 offset:20480
 v_xor_b32 v7, 32832, v6
 v_mfma_f32_16x16x32_bf16 v[28:31], a[92:95], a[184:187], v[28:31]
 ds_read_b64_tr_b16 a[64:65], v7 offset:0
 buffer_store_dwordx4 v[56:59], v1, s[12:15], s59 offen offset:1024 sc1
 v_mfma_f32_16x16x32_bf16 v[44:47], a[80:83], a[164:167], v[44:47]
 s_add_u32 m0, s29, 4096
 ds_read_b64_tr_b16 a[66:67], v7 offset:4096
 v_add_u32 v4, 4096, v1
 v_mfma_f32_16x16x32_bf16 v[44:47], a[84:87], a[172:175], v[44:47]
 ds_read_b64_tr_b16 a[68:69], v7 offset:16384
 buffer_load_dwordx4 v2, s[16:19], s48 offen lds
 v_mfma_f32_16x16x32_bf16 v[44:47], a[88:91], a[180:183], v[44:47]
 ds_read_b64_tr_b16 a[70:71], v7 offset:20480
 v_xor_b32 v8, 98368, v6
 v_mfma_f32_16x16x32_bf16 v[44:47], a[92:95], a[188:191], v[44:47]
 s_waitcnt lgkmcnt(6)
 ds_read_b64_tr_b16 a[72:73], v8 offset:0
 v_accvgpr_write_b32 a239, v3
 v_mfma_f32_16x16x32_bf16 v[52:55], a[96:99], a[160:163], v[52:55]
 ds_read_b64_tr_b16 a[74:75], v8 offset:4096
 v_mfma_f32_16x16x32_bf16 v[52:55], a[100:103], a[168:171], v[52:55]
 s_add_u32 m0, s29, 8192
 ds_read_b64_tr_b16 a[76:77], v8 offset:16384
 v_mfma_f32_16x16x32_bf16 v[52:55], a[104:107], a[176:179], v[52:55]
 s_waitcnt lgkmcnt(7)
 ds_read_b64_tr_b16 a[78:79], v8 offset:20480
 v_xor_b32 v9, 32864, v6
 v_mfma_f32_16x16x32_bf16 v[52:55], a[108:111], a[184:187], v[52:55]
 ds_read_b64_tr_b16 a[80:81], v9 offset:0
 buffer_load_dwordx4 v2, s[16:19], s49 offen lds
 v_mfma_f32_16x16x32_bf16 v[60:63], a[96:99], a[164:167], v[60:63]
 s_add_u32 s59, s56, 24576
 ds_read_b64_tr_b16 a[82:83], v9 offset:4096
 v_mfma_f32_16x16x32_bf16 v[60:63], a[100:103], a[172:175], v[60:63]
 ds_read_b64_tr_b16 a[84:85], v9 offset:16384
 buffer_store_dwordx4 v[64:67], v1, s[12:15], s59 offen offset:0 sc1
 v_mfma_f32_16x16x32_bf16 v[60:63], a[104:107], a[180:183], v[60:63]
 s_add_u32 m0, s29, 12288
 ds_read_b64_tr_b16 a[86:87], v9 offset:20480
 v_xor_b32 v10, 98400, v6
 v_mfma_f32_16x16x32_bf16 v[60:63], a[108:111], a[188:191], v[60:63]
 s_waitcnt lgkmcnt(6)
 ds_read_b64_tr_b16 a[88:89], v10 offset:0
 v_mfma_f32_16x16x32_bf16 v[20:23], a[64:67], a[160:163], v[20:23]
 ds_read_b64_tr_b16 a[90:91], v10 offset:4096
 buffer_load_dwordx4 v2, s[16:19], s50 offen lds
 v_mfma_f32_16x16x32_bf16 v[20:23], a[68:71], a[168:171], v[20:23]
 ds_read_b64_tr_b16 a[92:93], v10 offset:16384
 v_mfma_f32_16x16x32_bf16 v[20:23], a[72:75], a[176:179], v[20:23]
 s_waitcnt lgkmcnt(7)
 ds_read_b64_tr_b16 a[94:95], v10 offset:20480
 v_xor_b32 v7, 32896, v6
 v_mfma_f32_16x16x32_bf16 v[20:23], a[76:79], a[184:187], v[20:23]
 ds_read_b64_tr_b16 a[96:97], v7 offset:0
 v_mfma_f32_16x16x32_bf16 v[36:39], a[64:67], a[164:167], v[36:39]
 s_add_u32 m0, s29, 16384
 ds_read_b64_tr_b16 a[98:99], v7 offset:4096
 v_mfma_f32_16x16x32_bf16 v[36:39], a[68:71], a[172:175], v[36:39]
 ds_read_b64_tr_b16 a[100:101], v7 offset:16384
 buffer_load_dwordx4 v2, s[16:19], s51 offen lds
 v_mfma_f32_16x16x32_bf16 v[36:39], a[72:75], a[180:183], v[36:39]
 s_add_u32 s59, s56, 16384
 ds_read_b64_tr_b16 a[102:103], v7 offset:20480
 v_xor_b32 v8, 98432, v6
 v_mfma_f32_16x16x32_bf16 v[36:39], a[76:79], a[188:191], v[36:39]
 s_waitcnt lgkmcnt(6)
 ds_read_b64_tr_b16 a[104:105], v8 offset:0
 buffer_store_dwordx4 v[72:75], v1, s[12:15], s59 offen offset:0 sc1
 v_mfma_f32_16x16x32_bf16 v[68:71], a[80:83], a[160:163], v[68:71]
 ds_read_b64_tr_b16 a[106:107], v8 offset:4096
 v_mfma_f32_16x16x32_bf16 v[68:71], a[84:87], a[168:171], v[68:71]
 s_add_u32 m0, s29, 20480
 ds_read_b64_tr_b16 a[108:109], v8 offset:16384
 v_mfma_f32_16x16x32_bf16 v[68:71], a[88:91], a[176:179], v[68:71]
 s_waitcnt lgkmcnt(7)
 ds_read_b64_tr_b16 a[110:111], v8 offset:20480
 v_xor_b32 v9, 32928, v6
 v_mfma_f32_16x16x32_bf16 v[68:71], a[92:95], a[184:187], v[68:71]
 ds_read_b64_tr_b16 a[64:65], v9 offset:0
 buffer_load_dwordx4 v2, s[16:19], s52 offen lds
 v_mfma_f32_16x16x32_bf16 v[76:79], a[80:83], a[164:167], v[76:79]
 ds_read_b64_tr_b16 a[66:67], v9 offset:4096
 v_mfma_f32_16x16x32_bf16 v[76:79], a[84:87], a[172:175], v[76:79]
 ds_read_b64_tr_b16 a[68:69], v9 offset:16384
 v_mfma_f32_16x16x32_bf16 v[76:79], a[88:91], a[180:183], v[76:79]
 s_add_u32 m0, s29, 24576
 ds_read_b64_tr_b16 a[70:71], v9 offset:20480
 v_xor_b32 v10, 98464, v6
 v_mfma_f32_16x16x32_bf16 v[76:79], a[92:95], a[188:191], v[76:79]
 s_waitcnt lgkmcnt(6)
 ds_read_b64_tr_b16 a[72:73], v10 offset:0
 v_mfma_f32_16x16x32_bf16 v[84:87], a[96:99], a[160:163], v[84:87]
 ds_read_b64_tr_b16 a[74:75], v10 offset:4096
 buffer_load_dwordx4 v2, s[16:19], s53 offen lds
 v_mfma_f32_16x16x32_bf16 v[84:87], a[100:103], a[168:171], v[84:87]
 s_add_u32 s59, s56, 8192
 ds_read_b64_tr_b16 a[76:77], v10 offset:16384
 v_mfma_f32_16x16x32_bf16 v[84:87], a[104:107], a[176:179], v[84:87]
 s_waitcnt lgkmcnt(7)
 ds_read_b64_tr_b16 a[78:79], v10 offset:20480
 v_xor_b32 v7, 32960, v6
 v_mfma_f32_16x16x32_bf16 v[84:87], a[108:111], a[184:187], v[84:87]
 ds_read_b64_tr_b16 a[80:81], v7 offset:0
 buffer_store_dwordx4 v[80:83], v1, s[12:15], s59 offen offset:0 sc1
 v_mfma_f32_16x16x32_bf16 v[92:95], a[96:99], a[164:167], v[92:95]
 s_add_u32 m0, s29, 28672
 ds_read_b64_tr_b16 a[82:83], v7 offset:4096
 v_mfma_f32_16x16x32_bf16 v[92:95], a[100:103], a[172:175], v[92:95]
 ds_read_b64_tr_b16 a[84:85], v7 offset:16384
 buffer_load_dwordx4 v2, s[16:19], s54 offen lds
 v_mfma_f32_16x16x32_bf16 v[92:95], a[104:107], a[180:183], v[92:95]
 ds_read_b64_tr_b16 a[86:87], v7 offset:20480
 v_xor_b32 v8, 98496, v6
 v_mfma_f32_16x16x32_bf16 v[92:95], a[108:111], a[188:191], v[92:95]
 s_waitcnt lgkmcnt(6)
 ds_read_b64_tr_b16 a[88:89], v8 offset:0
 v_mfma_f32_16x16x32_bf16 v[100:103], a[64:67], a[160:163], v[100:103]
 s_add_u32 m0, s29, 65536
 ds_read_b64_tr_b16 a[90:91], v8 offset:4096
 v_add_u32 v2, 0x80000, v2
 v_mfma_f32_16x16x32_bf16 v[100:103], a[68:71], a[168:171], v[100:103]
 ds_read_b64_tr_b16 a[92:93], v8 offset:16384
 buffer_load_dwordx4 v2, s[16:19], 0 offen lds
 v_mfma_f32_16x16x32_bf16 v[100:103], a[72:75], a[176:179], v[100:103]
 s_waitcnt lgkmcnt(7)
 ds_read_b64_tr_b16 a[94:95], v8 offset:20480
 v_xor_b32 v9, 32992, v6
 v_mfma_f32_16x16x32_bf16 v[100:103], a[76:79], a[184:187], v[100:103]
 ds_read_b64_tr_b16 a[96:97], v9 offset:0
 v_mfma_f32_16x16x32_bf16 v[108:111], a[64:67], a[164:167], v[108:111]
 s_add_u32 s59, s56, 0
 ds_read_b64_tr_b16 a[98:99], v9 offset:4096
 v_mfma_f32_16x16x32_bf16 v[108:111], a[68:71], a[172:175], v[108:111]
 ds_read_b64_tr_b16 a[100:101], v9 offset:16384
 buffer_store_dwordx4 v[88:91], v1, s[12:15], s59 offen offset:0 sc1
 v_mfma_f32_16x16x32_bf16 v[108:111], a[72:75], a[180:183], v[108:111]
 s_add_u32 m0, s29, 69632
 ds_read_b64_tr_b16 a[102:103], v9 offset:20480
 v_xor_b32 v10, 98528, v6
 v_mfma_f32_16x16x32_bf16 v[108:111], a[76:79], a[188:191], v[108:111]
 s_waitcnt lgkmcnt(6)
 ds_read_b64_tr_b16 a[104:105], v10 offset:0
 buffer_load_dwordx4 v2, s[16:19], s48 offen lds
 v_mfma_f32_16x16x32_bf16 v[116:119], a[80:83], a[160:163], v[116:119]
 ds_read_b64_tr_b16 a[106:107], v10 offset:4096
 v_mfma_f32_16x16x32_bf16 v[116:119], a[84:87], a[168:171], v[116:119]
 ds_read_b64_tr_b16 a[108:109], v10 offset:16384
 v_mfma_f32_16x16x32_bf16 v[116:119], a[88:91], a[176:179], v[116:119]
 s_waitcnt lgkmcnt(7)
 ds_read_b64_tr_b16 a[110:111], v10 offset:20480
 v_xor_b32 v7, 33024, v6
 v_mfma_f32_16x16x32_bf16 v[116:119], a[92:95], a[184:187], v[116:119]
 s_add_u32 m0, s29, 73728
 ds_read_b64_tr_b16 a[64:65], v7 offset:0
 v_mfma_f32_16x16x32_bf16 v[124:127], a[80:83], a[164:167], v[124:127]
 ds_read_b64_tr_b16 a[66:67], v7 offset:4096
 buffer_load_dwordx4 v2, s[16:19], s49 offen lds
 v_mfma_f32_16x16x32_bf16 v[124:127], a[84:87], a[172:175], v[124:127]
 ds_read_b64_tr_b16 a[68:69], v7 offset:16384
 v_mfma_f32_16x16x32_bf16 v[124:127], a[88:91], a[180:183], v[124:127]
 s_add_u32 s59, s56, 24576
 ds_read_b64_tr_b16 a[70:71], v7 offset:20480
 v_xor_b32 v8, 98560, v6
 v_mfma_f32_16x16x32_bf16 v[124:127], a[92:95], a[188:191], v[124:127]
 s_waitcnt lgkmcnt(6)
 ds_read_b64_tr_b16 a[72:73], v8 offset:0
 buffer_store_dwordx4 v[96:99], v1, s[12:15], s59 offen offset:1024 sc1
 v_mfma_f32_16x16x32_bf16 v[132:135], a[96:99], a[160:163], v[132:135]
 s_add_u32 m0, s29, 77824
 ds_read_b64_tr_b16 a[74:75], v8 offset:4096
 v_mfma_f32_16x16x32_bf16 v[132:135], a[100:103], a[168:171], v[132:135]
 ds_read_b64_tr_b16 a[76:77], v8 offset:16384
 buffer_load_dwordx4 v2, s[16:19], s50 offen lds
 v_mfma_f32_16x16x32_bf16 v[132:135], a[104:107], a[176:179], v[132:135]
 s_waitcnt lgkmcnt(7)
 ds_read_b64_tr_b16 a[78:79], v8 offset:20480
 v_xor_b32 v9, 33056, v6
 v_mfma_f32_16x16x32_bf16 v[132:135], a[108:111], a[184:187], v[132:135]
 ds_read_b64_tr_b16 a[80:81], v9 offset:0
 v_mfma_f32_16x16x32_bf16 v[140:143], a[96:99], a[164:167], v[140:143]
 ds_read_b64_tr_b16 a[82:83], v9 offset:4096
 v_mfma_f32_16x16x32_bf16 v[140:143], a[100:103], a[172:175], v[140:143]
 ds_read_b64_tr_b16 a[84:85], v9 offset:16384
 v_mfma_f32_16x16x32_bf16 v[140:143], a[104:107], a[180:183], v[140:143]
 s_add_u32 m0, s29, 81920
 ds_read_b64_tr_b16 a[86:87], v9 offset:20480
 v_xor_b32 v10, 98592, v6
 v_mfma_f32_16x16x32_bf16 v[140:143], a[108:111], a[188:191], v[140:143]
 s_waitcnt lgkmcnt(6)
 ds_read_b64_tr_b16 a[88:89], v10 offset:0
 buffer_load_dwordx4 v2, s[16:19], s51 offen lds
 v_mfma_f32_16x16x32_bf16 v[148:151], a[64:67], a[160:163], v[148:151]
 s_add_u32 s59, s56, 16384
 ds_read_b64_tr_b16 a[90:91], v10 offset:4096
 v_mfma_f32_16x16x32_bf16 v[148:151], a[68:71], a[168:171], v[148:151]
 ds_read_b64_tr_b16 a[92:93], v10 offset:16384
 buffer_store_dwordx4 v[104:107], v1, s[12:15], s59 offen offset:1024 sc1
 v_mfma_f32_16x16x32_bf16 v[148:151], a[72:75], a[176:179], v[148:151]
 s_waitcnt lgkmcnt(7)
 ds_read_b64_tr_b16 a[94:95], v10 offset:20480
 v_xor_b32 v7, 33088, v6
 v_mfma_f32_16x16x32_bf16 v[148:151], a[76:79], a[184:187], v[148:151]
 s_add_u32 m0, s29, 86016
 ds_read_b64_tr_b16 a[96:97], v7 offset:0
 v_mfma_f32_16x16x32_bf16 v[156:159], a[64:67], a[164:167], v[156:159]
 ds_read_b64_tr_b16 a[98:99], v7 offset:4096
 buffer_load_dwordx4 v2, s[16:19], s52 offen lds
 v_mfma_f32_16x16x32_bf16 v[156:159], a[68:71], a[172:175], v[156:159]
 ds_read_b64_tr_b16 a[100:101], v7 offset:16384
 v_mfma_f32_16x16x32_bf16 v[156:159], a[72:75], a[180:183], v[156:159]
 ds_read_b64_tr_b16 a[102:103], v7 offset:20480
 v_xor_b32 v8, 98624, v6
 v_mfma_f32_16x16x32_bf16 v[156:159], a[76:79], a[188:191], v[156:159]
 s_waitcnt lgkmcnt(6)
 ds_read_b64_tr_b16 a[104:105], v8 offset:0
 v_mfma_f32_16x16x32_bf16 v[164:167], a[80:83], a[160:163], v[164:167]
 s_add_u32 m0, s29, 90112
 ds_read_b64_tr_b16 a[106:107], v8 offset:4096
 v_mfma_f32_16x16x32_bf16 v[164:167], a[84:87], a[168:171], v[164:167]
 ds_read_b64_tr_b16 a[108:109], v8 offset:16384
 buffer_load_dwordx4 v2, s[16:19], s53 offen lds
 v_mfma_f32_16x16x32_bf16 v[164:167], a[88:91], a[176:179], v[164:167]
 s_waitcnt lgkmcnt(7)
 ds_read_b64_tr_b16 a[110:111], v8 offset:20480
 v_xor_b32 v9, 33120, v6
 v_mfma_f32_16x16x32_bf16 v[164:167], a[92:95], a[184:187], v[164:167]
 s_add_u32 s59, s56, 8192
 ds_read_b64_tr_b16 a[64:65], v9 offset:0
 v_mfma_f32_16x16x32_bf16 v[172:175], a[80:83], a[164:167], v[172:175]
 ds_read_b64_tr_b16 a[66:67], v9 offset:4096
 buffer_store_dwordx4 v[112:115], v1, s[12:15], s59 offen offset:1024 sc1
 v_mfma_f32_16x16x32_bf16 v[172:175], a[84:87], a[172:175], v[172:175]
 ds_read_b64_tr_b16 a[68:69], v9 offset:16384
 v_mfma_f32_16x16x32_bf16 v[172:175], a[88:91], a[180:183], v[172:175]
 s_add_u32 m0, s29, 94208
 ds_read_b64_tr_b16 a[70:71], v9 offset:20480
 v_xor_b32 v10, 98656, v6
 v_mfma_f32_16x16x32_bf16 v[172:175], a[92:95], a[188:191], v[172:175]
 s_waitcnt lgkmcnt(6)
 ds_read_b64_tr_b16 a[72:73], v10 offset:0
 buffer_load_dwordx4 v2, s[16:19], s54 offen lds
 v_mfma_f32_16x16x32_bf16 v[180:183], a[96:99], a[160:163], v[180:183]
 ds_read_b64_tr_b16 a[74:75], v10 offset:4096
 v_mfma_f32_16x16x32_bf16 v[180:183], a[100:103], a[168:171], v[180:183]
 ds_read_b64_tr_b16 a[76:77], v10 offset:16384
 v_mfma_f32_16x16x32_bf16 v[180:183], a[104:107], a[176:179], v[180:183]
 s_waitcnt lgkmcnt(7)
 ds_read_b64_tr_b16 a[78:79], v10 offset:20480
 v_xor_b32 v7, 33152, v6
 v_mfma_f32_16x16x32_bf16 v[180:183], a[108:111], a[184:187], v[180:183]
 ds_read_b64_tr_b16 a[80:81], v7 offset:0
 v_mfma_f32_16x16x32_bf16 v[188:191], a[96:99], a[164:167], v[188:191]
 ds_read_b64_tr_b16 a[82:83], v7 offset:4096
 v_mfma_f32_16x16x32_bf16 v[188:191], a[100:103], a[172:175], v[188:191]
 ds_read_b64_tr_b16 a[84:85], v7 offset:16384
 v_mfma_f32_16x16x32_bf16 v[188:191], a[104:107], a[180:183], v[188:191]
 s_add_u32 s59, s56, 0
 ds_read_b64_tr_b16 a[86:87], v7 offset:20480
 v_xor_b32 v8, 98688, v6
 v_mfma_f32_16x16x32_bf16 v[188:191], a[108:111], a[188:191], v[188:191]
 s_waitcnt lgkmcnt(6)
 ds_read_b64_tr_b16 a[88:89], v8 offset:0
 buffer_store_dwordx4 v[120:123], v1, s[12:15], s59 offen offset:1024 sc1
 v_mfma_f32_16x16x32_bf16 v[196:199], a[64:67], a[160:163], v[196:199]
 ds_read_b64_tr_b16 a[90:91], v8 offset:4096
 v_mfma_f32_16x16x32_bf16 v[196:199], a[68:71], a[168:171], v[196:199]
 ds_read_b64_tr_b16 a[92:93], v8 offset:16384
 v_mfma_f32_16x16x32_bf16 v[196:199], a[72:75], a[176:179], v[196:199]
 s_waitcnt lgkmcnt(7)
 ds_read_b64_tr_b16 a[94:95], v8 offset:20480
 v_xor_b32 v9, 33184, v6
 v_mfma_f32_16x16x32_bf16 v[196:199], a[76:79], a[184:187], v[196:199]
 ds_read_b64_tr_b16 a[96:97], v9 offset:0
 v_mfma_f32_16x16x32_bf16 v[204:207], a[64:67], a[164:167], v[204:207]
 ds_read_b64_tr_b16 a[98:99], v9 offset:4096
 v_mfma_f32_16x16x32_bf16 v[204:207], a[68:71], a[172:175], v[204:207]
 ds_read_b64_tr_b16 a[100:101], v9 offset:16384
 v_mfma_f32_16x16x32_bf16 v[204:207], a[72:75], a[180:183], v[204:207]
 ds_read_b64_tr_b16 a[102:103], v9 offset:20480
 v_xor_b32 v10, 98720, v6
 v_mfma_f32_16x16x32_bf16 v[204:207], a[76:79], a[188:191], v[204:207]
 s_waitcnt lgkmcnt(6)
 ds_read_b64_tr_b16 a[104:105], v10 offset:0
 v_mfma_f32_16x16x32_bf16 v[212:215], a[80:83], a[160:163], v[212:215]
 s_add_u32 s59, s56, 24576
 ds_read_b64_tr_b16 a[106:107], v10 offset:4096
 v_mfma_f32_16x16x32_bf16 v[212:215], a[84:87], a[168:171], v[212:215]
 ds_read_b64_tr_b16 a[108:109], v10 offset:16384
 buffer_store_dwordx4 v[128:131], v1, s[12:15], s59 offen offset:2048 sc1
 v_mfma_f32_16x16x32_bf16 v[212:215], a[88:91], a[176:179], v[212:215]
 s_waitcnt lgkmcnt(7)
 ds_read_b64_tr_b16 a[110:111], v10 offset:20480
 v_xor_b32 v7, 33216, v6
 v_mfma_f32_16x16x32_bf16 v[212:215], a[92:95], a[184:187], v[212:215]
 ds_read_b64_tr_b16 a[64:65], v7 offset:0
 v_lshrrev_b32 v120, 3, v0
 v_mfma_f32_16x16x32_bf16 v[220:223], a[80:83], a[164:167], v[220:223]
 ds_read_b64_tr_b16 a[66:67], v7 offset:4096
 v_mul_u32_u24 v120, 1792, v120
 v_mfma_f32_16x16x32_bf16 v[220:223], a[84:87], a[172:175], v[220:223]
 ds_read_b64_tr_b16 a[68:69], v7 offset:16384
 v_and_b32 v121, 7, v0
 v_mfma_f32_16x16x32_bf16 v[220:223], a[88:91], a[180:183], v[220:223]
 ds_read_b64_tr_b16 a[70:71], v7 offset:20480
 v_xor_b32 v8, 98752, v6
 v_mfma_f32_16x16x32_bf16 v[220:223], a[92:95], a[188:191], v[220:223]
 s_waitcnt lgkmcnt(6)
 ds_read_b64_tr_b16 a[72:73], v8 offset:0
 v_lshl_add_u32 v120, v121, 4, v120
 v_mfma_f32_16x16x32_bf16 v[228:231], a[96:99], a[160:163], v[228:231]
 ds_read_b64_tr_b16 a[74:75], v8 offset:4096
 v_add_u32 v120, s38, v120
 v_mfma_f32_16x16x32_bf16 v[228:231], a[100:103], a[168:171], v[228:231]
 s_add_u32 s59, s56, 16384
 ds_read_b64_tr_b16 a[76:77], v8 offset:16384
 v_lshlrev_b32 v121, 6, v121
 v_mfma_f32_16x16x32_bf16 v[228:231], a[104:107], a[176:179], v[228:231]
 s_waitcnt lgkmcnt(7)
 ds_read_b64_tr_b16 a[78:79], v8 offset:20480
 v_xor_b32 v9, 33248, v6
 v_mfma_f32_16x16x32_bf16 v[228:231], a[108:111], a[184:187], v[228:231]
 ds_read_b64_tr_b16 a[80:81], v9 offset:0
 buffer_store_dwordx4 v[136:139], v1, s[12:15], s59 offen offset:2048 sc1
 v_mfma_f32_16x16x32_bf16 v[236:239], a[96:99], a[164:167], v[236:239]
 ds_read_b64_tr_b16 a[82:83], v9 offset:4096
 v_subrev_u32 v122, 2688, v120
 v_mfma_f32_16x16x32_bf16 v[236:239], a[100:103], a[172:175], v[236:239]
 ds_read_b64_tr_b16 a[84:85], v9 offset:16384
 v_subrev_u32 v123, 1792, v120
 v_mfma_f32_16x16x32_bf16 v[236:239], a[104:107], a[180:183], v[236:239]
 ds_read_b64_tr_b16 a[86:87], v9 offset:20480
 v_xor_b32 v10, 98784, v6
 v_mfma_f32_16x16x32_bf16 v[236:239], a[108:111], a[188:191], v[236:239]
 s_waitcnt lgkmcnt(6)
 ds_read_b64_tr_b16 a[88:89], v10 offset:0
 v_subrev_u32 v128, 896, v120
 v_mfma_f32_16x16x32_bf16 v[244:247], a[64:67], a[160:163], v[244:247]
 ds_read_b64_tr_b16 a[90:91], v10 offset:4096
 buffer_load_dwordx4 v[32:35], v122, s[4:7], 0 offen
 v_mfma_f32_16x16x32_bf16 v[244:247], a[68:71], a[168:171], v[244:247]
 s_waitcnt vmcnt(4)
 ds_read_b64_tr_b16 a[92:93], v10 offset:16384
 v_xor_b32 v7, 131072, v6
 v_mfma_f32_16x16x32_bf16 v[244:247], a[72:75], a[176:179], v[244:247]
 s_waitcnt lgkmcnt(7)
 s_barrier
 ds_read_b64_tr_b16 a[94:95], v10 offset:20480
 v_mfma_f32_16x16x32_bf16 v[244:247], a[76:79], a[184:187], v[244:247]
 s_and_b32 s58, s92, ~127
 ds_read_b64_tr_b16 a[96:97], v7 offset:0
 v_mfma_f32_16x16x32_bf16 v[252:255], a[64:67], a[164:167], v[252:255]
 s_add_u32 s59, s56, 8192
 ds_read_b64_tr_b16 a[98:99], v7 offset:4096
 v_mfma_f32_16x16x32_bf16 v[252:255], a[68:71], a[172:175], v[252:255]
 ds_read_b64_tr_b16 a[100:101], v7 offset:16384
 buffer_store_dwordx4 v[144:147], v1, s[12:15], s59 offen offset:2048 sc1
 v_mfma_f32_16x16x32_bf16 v[252:255], a[72:75], a[180:183], v[252:255]
 s_lshl_b32 s37, s25, 1
 ds_read_b64_tr_b16 a[102:103], v7 offset:20480
 v_xor_b32 v8, 0, v6
 v_mfma_f32_16x16x32_bf16 v[252:255], a[76:79], a[188:191], v[252:255]
 s_waitcnt lgkmcnt(6)
 ds_read_b64_tr_b16 a[104:105], v8 offset:0
 buffer_load_dwordx4 v[40:43], v123, s[4:7], 0 offen
 v_mfma_f32_16x16x32_bf16 v[16:19], a[80:83], a[160:163], v[16:19]
 s_sub_i32 s38, 12, s37
 ds_read_b64_tr_b16 a[106:107], v8 offset:4096
 v_mfma_f32_16x16x32_bf16 v[16:19], a[84:87], a[168:171], v[16:19]
 s_max_i32 s38, s38, 0
 ds_read_b64_tr_b16 a[108:109], v8 offset:16384
 v_mfma_f32_16x16x32_bf16 v[16:19], a[88:91], a[176:179], v[16:19]
 s_waitcnt lgkmcnt(7)
 ds_read_b64_tr_b16 a[110:111], v8 offset:20480
 v_xor_b32 v9, 65536, v6
 v_mfma_f32_16x16x32_bf16 v[16:19], a[92:95], a[184:187], v[16:19]
 ds_read_b64_tr_b16 a[64:65], v9 offset:0
 buffer_load_dwordx4 v[48:51], v128, s[4:7], 0 offen
 v_mfma_f32_16x16x32_bf16 v[24:27], a[80:83], a[164:167], v[24:27]
 s_mul_i32 s49, s26, 1048576
 ds_read_b64_tr_b16 a[66:67], v9 offset:4096
 v_mfma_f32_16x16x32_bf16 v[24:27], a[84:87], a[172:175], v[24:27]
 s_lshl_b32 s50, s3, 13
 ds_read_b64_tr_b16 a[68:69], v9 offset:16384
 v_mfma_f32_16x16x32_bf16 v[24:27], a[88:91], a[180:183], v[24:27]
 s_add_u32 s59, s56, 0
 ds_read_b64_tr_b16 a[70:71], v9 offset:20480
 v_xor_b32 v10, 131104, v6
 v_mfma_f32_16x16x32_bf16 v[24:27], a[92:95], a[188:191], v[24:27]
 s_waitcnt lgkmcnt(6)
 ds_read_b64_tr_b16 a[72:73], v10 offset:0
 buffer_store_dwordx4 v[152:155], v1, s[12:15], s59 offen offset:2048 sc1
 v_mfma_f32_16x16x32_bf16 v[28:31], a[96:99], a[192:195], v[28:31]
 s_add_u32 s49, s49, s50
 ds_read_b64_tr_b16 a[74:75], v10 offset:4096
 v_mfma_f32_16x16x32_bf16 v[28:31], a[100:103], a[200:203], v[28:31]
 ds_read_b64_tr_b16 a[76:77], v10 offset:16384
 buffer_load_dwordx4 v[56:59], v120, s[4:7], 0 offen offset:0
 v_mfma_f32_16x16x32_bf16 v[28:31], a[104:107], a[208:211], v[28:31]
 s_waitcnt lgkmcnt(3)
 ds_read_b64_tr_b16 a[78:79], v10 offset:20480
 v_xor_b32 v7, 32, v6
 v_mfma_f32_16x16x32_bf16 v[28:31], a[108:111], a[216:219], v[28:31]
 s_mov_b32 s54, 0
 ds_read_b64_tr_b16 a[80:81], v7 offset:0
 v_mfma_f32_16x16x32_bf16 v[28:31], a[64:67], a[112:115], v[28:31]
 s_add_u32 s44, s37, 1
 ds_read_b64_tr_b16 a[82:83], v7 offset:4096
 v_mfma_f32_16x16x32_bf16 v[28:31], a[68:71], a[120:123], v[28:31]
 ds_read_b64_tr_b16 a[84:85], v7 offset:16384
 buffer_load_dwordx4 v[64:67], v120, s[4:7], 0 offen offset:896
 v_mfma_f32_16x16x32_bf16 v[44:47], a[96:99], a[196:199], v[44:47]
 s_mov_b32 s42, s49
 ds_read_b64_tr_b16 a[86:87], v7 offset:20480
 v_xor_b32 v8, 65568, v6
 v_mfma_f32_16x16x32_bf16 v[44:47], a[100:103], a[204:207], v[44:47]
 s_add_u32 s60, s94, 4
 ds_read_b64_tr_b16 a[88:89], v8 offset:0
 v_mfma_f32_16x16x32_bf16 v[44:47], a[104:107], a[212:215], v[44:47]
 s_add_u32 s59, s56, 24576
 ds_read_b64_tr_b16 a[90:91], v8 offset:4096
 v_mfma_f32_16x16x32_bf16 v[44:47], a[108:111], a[220:223], v[44:47]
 ds_read_b64_tr_b16 a[92:93], v8 offset:16384
 buffer_store_dwordx4 v[160:163], v1, s[12:15], s59 offen offset:3072 sc1
 v_mfma_f32_16x16x32_bf16 v[44:47], a[64:67], a[116:119], v[44:47]
 s_mov_b32 s45, 2
 ds_read_b64_tr_b16 a[94:95], v8 offset:20480
 v_xor_b32 v9, 131136, v6
 v_mfma_f32_16x16x32_bf16 v[44:47], a[68:71], a[124:127], v[44:47]
 s_waitcnt lgkmcnt(6)
 ds_read_b64_tr_b16 a[96:97], v9 offset:0
 buffer_load_dwordx4 v[72:75], v120, s[8:11], 0 offen offset:0
 v_mfma_f32_16x16x32_bf16 v[52:55], a[72:75], a[192:195], v[52:55]
 s_mov_b32 s66, 1
 ds_read_b64_tr_b16 a[98:99], v9 offset:4096
 v_mfma_f32_16x16x32_bf16 v[52:55], a[76:79], a[200:203], v[52:55]
 s_mov_b32 s68, 1
 ds_read_b64_tr_b16 a[100:101], v9 offset:16384
 v_mfma_f32_16x16x32_bf16 v[52:55], a[80:83], a[208:211], v[52:55]
 s_waitcnt lgkmcnt(3)
 ds_read_b64_tr_b16 a[102:103], v9 offset:20480
 v_xor_b32 v10, 64, v6
 v_mfma_f32_16x16x32_bf16 v[52:55], a[84:87], a[216:219], v[52:55]
 ds_read_b64_tr_b16 a[104:105], v10 offset:0
 buffer_load_dwordx4 v[80:83], v120, s[8:11], 0 offen offset:896
 v_mfma_f32_16x16x32_bf16 v[52:55], a[88:91], a[112:115], v[52:55]
 s_mov_b32 s70, 32768
 ds_read_b64_tr_b16 a[106:107], v10 offset:4096
 v_mfma_f32_16x16x32_bf16 v[52:55], a[92:95], a[120:123], v[52:55]
 s_mov_b32 s71, s70
 ds_read_b64_tr_b16 a[108:109], v10 offset:16384
 v_mfma_f32_16x16x32_bf16 v[60:63], a[72:75], a[196:199], v[60:63]
 s_add_u32 s59, s56, 16384
 ds_read_b64_tr_b16 a[110:111], v10 offset:20480
 v_xor_b32 v7, 65600, v6
 v_mfma_f32_16x16x32_bf16 v[60:63], a[76:79], a[204:207], v[60:63]
 ds_read_b64_tr_b16 a[64:65], v7 offset:0
 buffer_store_dwordx4 v[168:171], v1, s[12:15], s59 offen offset:3072 sc1
 v_mfma_f32_16x16x32_bf16 v[60:63], a[80:83], a[212:215], v[60:63]
 s_add_u32 s43, s42, 16777216
 ds_read_b64_tr_b16 a[66:67], v7 offset:4096
 v_mfma_f32_16x16x32_bf16 v[60:63], a[84:87], a[220:223], v[60:63]
 ds_read_b64_tr_b16 a[68:69], v7 offset:16384
 buffer_load_dwordx4 v[88:91], v121, s[20:23], s39 offen offset:0
 v_mfma_f32_16x16x32_bf16 v[60:63], a[88:91], a[116:119], v[60:63]
 s_mov_b32 s40, s50
 ds_read_b64_tr_b16 a[70:71], v7 offset:20480
 v_xor_b32 v8, 131168, v6
 v_mfma_f32_16x16x32_bf16 v[60:63], a[92:95], a[124:127], v[60:63]
 s_waitcnt lgkmcnt(6)
 ds_read_b64_tr_b16 a[72:73], v8 offset:0
 v_mfma_f32_16x16x32_bf16 v[20:23], a[96:99], a[192:195], v[20:23]
 s_add_u32 s41, s50, 0x10000
 ds_read_b64_tr_b16 a[74:75], v8 offset:4096
 v_mfma_f32_16x16x32_bf16 v[20:23], a[100:103], a[200:203], v[20:23]
 ds_read_b64_tr_b16 a[76:77], v8 offset:16384
 buffer_load_dwordx4 v[96:99], v121, s[20:23], s39 offen offset:16
 v_mfma_f32_16x16x32_bf16 v[20:23], a[104:107], a[208:211], v[20:23]
 s_waitcnt lgkmcnt(3)
 ds_read_b64_tr_b16 a[78:79], v8 offset:20480
 v_xor_b32 v9, 96, v6
 v_mfma_f32_16x16x32_bf16 v[20:23], a[108:111], a[216:219], v[20:23]
 s_lshr_b32 s61, s95, 4
 ds_read_b64_tr_b16 a[80:81], v9 offset:0
 v_mul_f32 v28, s34, v28
 v_mfma_f32_16x16x32_bf16 v[20:23], a[64:67], a[112:115], v[20:23]
 s_add_u32 s59, s56, 8192
 ds_read_b64_tr_b16 a[82:83], v9 offset:4096
 v_mul_f32 v29, s34, v29
 v_mfma_f32_16x16x32_bf16 v[20:23], a[68:71], a[120:123], v[20:23]
 ds_read_b64_tr_b16 a[84:85], v9 offset:16384
 buffer_store_dwordx4 v[176:179], v1, s[12:15], s59 offen offset:3072 sc1
 v_mfma_f32_16x16x32_bf16 v[36:39], a[96:99], a[196:199], v[36:39]
 s_lshl_b32 s61, s61, 7
 ds_read_b64_tr_b16 a[86:87], v9 offset:20480
 v_xor_b32 v10, 65632, v6
 v_mfma_f32_16x16x32_bf16 v[36:39], a[100:103], a[204:207], v[36:39]
 ds_read_b64_tr_b16 a[88:89], v10 offset:0
 buffer_load_dwordx4 v[104:107], v121, s[20:23], s39 offen offset:32
 v_mfma_f32_16x16x32_bf16 v[36:39], a[104:107], a[212:215], v[36:39]
 s_add_u32 s61, s61, 84959232
 ds_read_b64_tr_b16 a[90:91], v10 offset:4096
 v_mul_f32 v30, s34, v30
 v_mfma_f32_16x16x32_bf16 v[36:39], a[108:111], a[220:223], v[36:39]
 s_mov_b32 s47, 0x4b800000
 ds_read_b64_tr_b16 a[92:93], v10 offset:16384
 v_mul_f32 v31, s34, v31
 v_mfma_f32_16x16x32_bf16 v[36:39], a[64:67], a[116:119], v[36:39]
 s_lshl_b32 s30, s95, 1
 ds_read_b64_tr_b16 a[94:95], v10 offset:20480
 v_xor_b32 v7, 131200, v6
 v_mfma_f32_16x16x32_bf16 v[36:39], a[68:71], a[124:127], v[36:39]
 s_waitcnt lgkmcnt(6)
 ds_read_b64_tr_b16 a[96:97], v7 offset:0
 buffer_load_dwordx4 v[112:115], v121, s[20:23], s39 offen offset:48
 v_mfma_f32_16x16x32_bf16 v[68:71], a[72:75], a[192:195], v[68:71]
 s_lshr_b32 s31, s3, 1
 ds_read_b64_tr_b16 a[98:99], v7 offset:4096
 v_mul_f32 v52, s34, v52
 v_mfma_f32_16x16x32_bf16 v[68:71], a[76:79], a[200:203], v[68:71]
 s_add_u32 s59, s56, 0
 ds_read_b64_tr_b16 a[100:101], v7 offset:16384
 v_mul_f32 v53, s34, v53
 v_mfma_f32_16x16x32_bf16 v[68:71], a[80:83], a[208:211], v[68:71]
 s_waitcnt lgkmcnt(3)
 ds_read_b64_tr_b16 a[102:103], v7 offset:20480
 v_xor_b32 v8, 128, v6
 v_mfma_f32_16x16x32_bf16 v[68:71], a[84:87], a[216:219], v[68:71]
 ds_read_b64_tr_b16 a[104:105], v8 offset:0
 buffer_store_dwordx4 v[184:187], v1, s[12:15], s59 offen offset:3072 sc1
 v_mfma_f32_16x16x32_bf16 v[68:71], a[88:91], a[112:115], v[68:71]
 s_add_u32 s30, s30, s31
 ds_read_b64_tr_b16 a[106:107], v8 offset:4096
 v_mul_f32 v54, s34, v54
 v_mfma_f32_16x16x32_bf16 v[68:71], a[92:95], a[120:123], v[68:71]
 s_min_u32 s30, s30, 223
 ds_read_b64_tr_b16 a[108:109], v8 offset:16384
 v_mul_f32 v55, s34, v55
 v_mfma_f32_16x16x32_bf16 v[76:79], a[72:75], a[196:199], v[76:79]
 s_lshl_b32 s30, s30, 2
 ds_read_b64_tr_b16 a[110:111], v8 offset:20480
 v_xor_b32 v9, 65664, v6
 v_mfma_f32_16x16x32_bf16 v[76:79], a[76:79], a[204:207], v[76:79]
 s_and_b32 s4, s2, 127
 ds_read_b64_tr_b16 a[64:65], v9 offset:0
 v_cvt_pk_bf16_f32 v28, v28, v29
 v_mfma_f32_16x16x32_bf16 v[76:79], a[80:83], a[212:215], v[76:79]
 s_lshl_b32 s4, s4, 2
 ds_read_b64_tr_b16 a[66:67], v9 offset:4096
 v_cvt_pk_bf16_f32 v29, v30, v31
 v_mfma_f32_16x16x32_bf16 v[76:79], a[84:87], a[220:223], v[76:79]
 s_add_u32 s4, s4, s3
 ds_read_b64_tr_b16 a[68:69], v9 offset:16384
 v_cvt_pk_bf16_f32 v30, v52, v53
 v_mfma_f32_16x16x32_bf16 v[76:79], a[88:91], a[116:119], v[76:79]
 s_mul_i32 s5, s4, 17408
 ds_read_b64_tr_b16 a[70:71], v9 offset:20480
 v_xor_b32 v10, 131232, v6
 v_mfma_f32_16x16x32_bf16 v[76:79], a[92:95], a[124:127], v[76:79]
 s_waitcnt lgkmcnt(6)
 ds_read_b64_tr_b16 a[72:73], v10 offset:0
 v_cvt_pk_bf16_f32 v31, v54, v55
 v_mfma_f32_16x16x32_bf16 v[84:87], a[96:99], a[192:195], v[84:87]
 s_add_u32 s59, s56, 57344
 ds_read_b64_tr_b16 a[74:75], v10 offset:4096
 v_accvgpr_write_b32 a0, v28
 v_mfma_f32_16x16x32_bf16 v[84:87], a[100:103], a[200:203], v[84:87]
 ds_read_b64_tr_b16 a[76:77], v10 offset:16384
 buffer_store_dwordx4 v[192:195], v1, s[12:15], s59 offen offset:2048 sc1
 v_mfma_f32_16x16x32_bf16 v[84:87], a[104:107], a[208:211], v[84:87]
 s_waitcnt lgkmcnt(3)
 ds_read_b64_tr_b16 a[78:79], v10 offset:20480
 v_xor_b32 v7, 160, v6
 v_mfma_f32_16x16x32_bf16 v[84:87], a[108:111], a[216:219], v[84:87]
 s_add_u32 s5, s5, 50331648
 ds_read_b64_tr_b16 a[80:81], v7 offset:0
 v_accvgpr_write_b32 a1, v29
 v_mfma_f32_16x16x32_bf16 v[84:87], a[64:67], a[112:115], v[84:87]
 s_add_u32 s4, s5, 0x2000
 ds_read_b64_tr_b16 a[82:83], v7 offset:4096
 v_accvgpr_write_b32 a2, v30
 v_mfma_f32_16x16x32_bf16 v[84:87], a[68:71], a[120:123], v[84:87]
 s_mov_b32 s6, 2.0
 ds_read_b64_tr_b16 a[84:85], v7 offset:16384
 v_accvgpr_write_b32 a3, v31
 v_mfma_f32_16x16x32_bf16 v[92:95], a[96:99], a[196:199], v[92:95]
 s_min_u32 s7, s38, 1
 ds_read_b64_tr_b16 a[86:87], v7 offset:20480
 v_xor_b32 v8, 65696, v6
 v_mfma_f32_16x16x32_bf16 v[92:95], a[100:103], a[204:207], v[92:95]
 s_cmp_eq_u32 s44, 1
 s_cselect_b32 s53, 1, 0
 ds_read_b64_tr_b16 a[88:89], v8 offset:0
 v_mfma_f32_16x16x32_bf16 v[92:95], a[104:107], a[212:215], v[92:95]
 s_cmp_eq_u32 s38, 0
 s_cmov_b32 s4, 2.0
 ds_read_b64_tr_b16 a[90:91], v8 offset:4096
 v_mfma_f32_16x16x32_bf16 v[92:95], a[108:111], a[220:223], v[92:95]
 s_cmp_eq_u32 s38, 0
 s_cmov_b32 s5, 2.0
 ds_read_b64_tr_b16 a[92:93], v8 offset:16384
 v_mfma_f32_16x16x32_bf16 v[92:95], a[64:67], a[116:119], v[92:95]
 s_add_u32 s59, s56, 49152
 ds_read_b64_tr_b16 a[94:95], v8 offset:20480
 v_xor_b32 v9, 131264, v6
 v_mfma_f32_16x16x32_bf16 v[92:95], a[68:71], a[124:127], v[92:95]
 s_waitcnt lgkmcnt(6)
 ds_read_b64_tr_b16 a[96:97], v9 offset:0
 buffer_store_dwordx4 v[200:203], v1, s[12:15], s59 offen offset:2048 sc1
 v_mfma_f32_16x16x32_bf16 v[100:103], a[72:75], a[192:195], v[100:103]
 s_cmp_eq_u32 s38, 0
 s_cmov_b32 s60, s58
 ds_read_b64_tr_b16 a[98:99], v9 offset:4096
 v_mfma_f32_16x16x32_bf16 v[100:103], a[76:79], a[200:203], v[100:103]
 s_mov_b64 s[8:9], s[12:13]
 ds_read_b64_tr_b16 a[100:101], v9 offset:16384
 v_mul_f32 v44, s34, v44
 v_mfma_f32_16x16x32_bf16 v[100:103], a[80:83], a[208:211], v[100:103]
 s_waitcnt lgkmcnt(3)
 ds_read_b64_tr_b16 a[102:103], v9 offset:20480
 v_xor_b32 v10, 192, v6
 v_mfma_f32_16x16x32_bf16 v[100:103], a[84:87], a[216:219], v[100:103]
 s_mov_b32 s10, s14
 ds_read_b64_tr_b16 a[104:105], v10 offset:0
 v_mul_f32 v45, s34, v45
 v_mfma_f32_16x16x32_bf16 v[100:103], a[88:91], a[112:115], v[100:103]
 s_mov_b32 s76, 0
 ds_read_b64_tr_b16 a[106:107], v10 offset:4096
 v_mul_f32 v46, s34, v46
 v_mfma_f32_16x16x32_bf16 v[100:103], a[92:95], a[120:123], v[100:103]
 s_movk_i32 s77, 0x1000
 ds_read_b64_tr_b16 a[108:109], v10 offset:16384
 v_mul_f32 v47, s34, v47
 v_mfma_f32_16x16x32_bf16 v[108:111], a[72:75], a[196:199], v[108:111]
 s_mov_b32 s51, 0
 ds_read_b64_tr_b16 a[110:111], v10 offset:20480
 v_xor_b32 v7, 65728, v6
 v_mfma_f32_16x16x32_bf16 v[108:111], a[76:79], a[204:207], v[108:111]
 s_mul_i32 s78, s26, 229376
 ds_read_b64_tr_b16 a[64:65], v7 offset:0
 v_mul_f32 v60, s34, v60
 v_mfma_f32_16x16x32_bf16 v[108:111], a[80:83], a[212:215], v[108:111]
 s_add_u32 s59, s56, 40960
 ds_read_b64_tr_b16 a[66:67], v7 offset:4096
 v_mul_f32 v61, s34, v61
 v_mfma_f32_16x16x32_bf16 v[108:111], a[84:87], a[220:223], v[108:111]
 ds_read_b64_tr_b16 a[68:69], v7 offset:16384
 buffer_store_dwordx4 v[208:211], v1, s[12:15], s59 offen offset:2048 sc1
 v_mfma_f32_16x16x32_bf16 v[108:111], a[88:91], a[116:119], v[108:111]
 s_add_u32 s79, s78, 28672
 ds_read_b64_tr_b16 a[70:71], v7 offset:20480
 v_xor_b32 v8, 131296, v6
 v_mfma_f32_16x16x32_bf16 v[108:111], a[92:95], a[124:127], v[108:111]
 s_waitcnt lgkmcnt(6)
 ds_read_b64_tr_b16 a[72:73], v8 offset:0
 v_mul_f32 v62, s34, v62
 v_mfma_f32_16x16x32_bf16 v[116:119], a[96:99], a[192:195], v[116:119]
 s_add_u32 s80, s78, 57344
 ds_read_b64_tr_b16 a[74:75], v8 offset:4096
 v_mul_f32 v63, s34, v63
 v_mfma_f32_16x16x32_bf16 v[116:119], a[100:103], a[200:203], v[116:119]
 s_add_u32 s81, s78, 86016
 ds_read_b64_tr_b16 a[76:77], v8 offset:16384
 v_cvt_pk_bf16_f32 v44, v44, v45
 v_mfma_f32_16x16x32_bf16 v[116:119], a[104:107], a[208:211], v[116:119]
 s_waitcnt lgkmcnt(3)
 ds_read_b64_tr_b16 a[78:79], v8 offset:20480
 v_xor_b32 v9, 224, v6
 v_mfma_f32_16x16x32_bf16 v[116:119], a[108:111], a[216:219], v[116:119]
 s_add_u32 s82, s78, 114688
 ds_read_b64_tr_b16 a[80:81], v9 offset:0
 v_cvt_pk_bf16_f32 v45, v46, v47
 v_mfma_f32_16x16x32_bf16 v[116:119], a[64:67], a[112:115], v[116:119]
 s_add_u32 s83, s78, 143360
 ds_read_b64_tr_b16 a[82:83], v9 offset:4096
 v_cvt_pk_bf16_f32 v46, v60, v61
 v_mfma_f32_16x16x32_bf16 v[116:119], a[68:71], a[120:123], v[116:119]
 s_add_u32 s84, s78, 172032
 ds_read_b64_tr_b16 a[84:85], v9 offset:16384
 v_cvt_pk_bf16_f32 v47, v62, v63
 v_mfma_f32_16x16x32_bf16 v[124:127], a[96:99], a[196:199], v[124:127]
 s_add_u32 s59, s56, 32768
 ds_read_b64_tr_b16 a[86:87], v9 offset:20480
 v_xor_b32 v10, 65760, v6
 v_mfma_f32_16x16x32_bf16 v[124:127], a[100:103], a[204:207], v[124:127]
 ds_read_b64_tr_b16 a[88:89], v10 offset:0
 buffer_store_dwordx4 v[216:219], v1, s[12:15], s59 offen offset:2048 sc1
 v_mfma_f32_16x16x32_bf16 v[124:127], a[104:107], a[212:215], v[124:127]
 s_add_u32 s85, s78, 200704
 ds_read_b64_tr_b16 a[90:91], v10 offset:4096
 v_accvgpr_write_b32 a32, v44
 v_mfma_f32_16x16x32_bf16 v[124:127], a[108:111], a[220:223], v[124:127]
 ds_read_b64_tr_b16 a[92:93], v10 offset:16384
 v_accvgpr_write_b32 a33, v45
 v_mfma_f32_16x16x32_bf16 v[124:127], a[64:67], a[116:119], v[124:127]
 ds_read_b64_tr_b16 a[94:95], v10 offset:20480
 v_xor_b32 v7, 131328, v6
 v_mfma_f32_16x16x32_bf16 v[124:127], a[68:71], a[124:127], v[124:127]
 s_waitcnt lgkmcnt(6)
 ds_read_b64_tr_b16 a[96:97], v7 offset:0
 v_accvgpr_write_b32 a34, v46
 v_mfma_f32_16x16x32_bf16 v[132:135], a[72:75], a[192:195], v[132:135]
 ds_read_b64_tr_b16 a[98:99], v7 offset:4096
 v_accvgpr_write_b32 a35, v47
 v_mfma_f32_16x16x32_bf16 v[132:135], a[76:79], a[200:203], v[132:135]
 ds_read_b64_tr_b16 a[100:101], v7 offset:16384
 v_mul_f32 v20, s34, v20
 v_mfma_f32_16x16x32_bf16 v[132:135], a[80:83], a[208:211], v[132:135]
 s_waitcnt lgkmcnt(3)
 ds_read_b64_tr_b16 a[102:103], v7 offset:20480
 v_xor_b32 v8, 256, v6
 v_mfma_f32_16x16x32_bf16 v[132:135], a[84:87], a[216:219], v[132:135]
 ds_read_b64_tr_b16 a[104:105], v8 offset:0
 v_mul_f32 v21, s34, v21
 v_mfma_f32_16x16x32_bf16 v[132:135], a[88:91], a[112:115], v[132:135]
 s_add_u32 s59, s56, 57344
 ds_read_b64_tr_b16 a[106:107], v8 offset:4096
 v_mul_f32 v22, s34, v22
 v_mfma_f32_16x16x32_bf16 v[132:135], a[92:95], a[120:123], v[132:135]
 ds_read_b64_tr_b16 a[108:109], v8 offset:16384
 buffer_store_dwordx4 v[224:227], v1, s[12:15], s59 offen offset:3072 sc1
 v_mfma_f32_16x16x32_bf16 v[140:143], a[72:75], a[196:199], v[140:143]
 ds_read_b64_tr_b16 a[110:111], v8 offset:20480
 v_xor_b32 v9, 65792, v6
 v_mfma_f32_16x16x32_bf16 v[140:143], a[76:79], a[204:207], v[140:143]
 ds_read_b64_tr_b16 a[64:65], v9 offset:0
 v_mul_f32 v23, s34, v23
 v_mfma_f32_16x16x32_bf16 v[140:143], a[80:83], a[212:215], v[140:143]
 ds_read_b64_tr_b16 a[66:67], v9 offset:4096
 v_mul_f32 v68, s34, v68
 v_mfma_f32_16x16x32_bf16 v[140:143], a[84:87], a[220:223], v[140:143]
 ds_read_b64_tr_b16 a[68:69], v9 offset:16384
 v_mul_f32 v69, s34, v69
 v_mfma_f32_16x16x32_bf16 v[140:143], a[88:91], a[116:119], v[140:143]
 ds_read_b64_tr_b16 a[70:71], v9 offset:20480
 v_xor_b32 v10, 131360, v6
 v_mfma_f32_16x16x32_bf16 v[140:143], a[92:95], a[124:127], v[140:143]
 s_waitcnt lgkmcnt(6)
 ds_read_b64_tr_b16 a[72:73], v10 offset:0
 v_mul_f32 v70, s34, v70
 v_mfma_f32_16x16x32_bf16 v[148:151], a[96:99], a[192:195], v[148:151]
 ds_read_b64_tr_b16 a[74:75], v10 offset:4096
 v_mul_f32 v71, s34, v71
 v_mfma_f32_16x16x32_bf16 v[148:151], a[100:103], a[200:203], v[148:151]
 s_add_u32 s59, s56, 49152
 ds_read_b64_tr_b16 a[76:77], v10 offset:16384
 v_cvt_pk_bf16_f32 v20, v20, v21
 v_mfma_f32_16x16x32_bf16 v[148:151], a[104:107], a[208:211], v[148:151]
 s_waitcnt lgkmcnt(3)
 ds_read_b64_tr_b16 a[78:79], v10 offset:20480
 v_xor_b32 v7, 288, v6
 v_mfma_f32_16x16x32_bf16 v[148:151], a[108:111], a[216:219], v[148:151]
 ds_read_b64_tr_b16 a[80:81], v7 offset:0
 buffer_store_dwordx4 v[232:235], v1, s[12:15], s59 offen offset:3072 sc1
 v_mfma_f32_16x16x32_bf16 v[148:151], a[64:67], a[112:115], v[148:151]
 ds_read_b64_tr_b16 a[82:83], v7 offset:4096
 v_cvt_pk_bf16_f32 v21, v22, v23
 v_mfma_f32_16x16x32_bf16 v[148:151], a[68:71], a[120:123], v[148:151]
 ds_read_b64_tr_b16 a[84:85], v7 offset:16384
 v_cvt_pk_bf16_f32 v22, v68, v69
 v_mfma_f32_16x16x32_bf16 v[156:159], a[96:99], a[196:199], v[156:159]
 ds_read_b64_tr_b16 a[86:87], v7 offset:20480
 v_xor_b32 v8, 65824, v6
 v_mfma_f32_16x16x32_bf16 v[156:159], a[100:103], a[204:207], v[156:159]
 ds_read_b64_tr_b16 a[88:89], v8 offset:0
 v_cvt_pk_bf16_f32 v23, v70, v71
 v_mfma_f32_16x16x32_bf16 v[156:159], a[104:107], a[212:215], v[156:159]
 ds_read_b64_tr_b16 a[90:91], v8 offset:4096
 v_accvgpr_write_b32 a4, v20
 v_mfma_f32_16x16x32_bf16 v[156:159], a[108:111], a[220:223], v[156:159]
 ds_read_b64_tr_b16 a[92:93], v8 offset:16384
 v_accvgpr_write_b32 a5, v21
 v_mfma_f32_16x16x32_bf16 v[156:159], a[64:67], a[116:119], v[156:159]
 ds_read_b64_tr_b16 a[94:95], v8 offset:20480
 v_xor_b32 v9, 131392, v6
 v_mfma_f32_16x16x32_bf16 v[156:159], a[68:71], a[124:127], v[156:159]
 s_waitcnt lgkmcnt(6)
 ds_read_b64_tr_b16 a[96:97], v9 offset:0
 v_accvgpr_write_b32 a6, v22
 v_mfma_f32_16x16x32_bf16 v[164:167], a[72:75], a[192:195], v[164:167]
 s_add_u32 s59, s56, 40960
 ds_read_b64_tr_b16 a[98:99], v9 offset:4096
 v_accvgpr_write_b32 a7, v23
 v_mfma_f32_16x16x32_bf16 v[164:167], a[76:79], a[200:203], v[164:167]
 ds_read_b64_tr_b16 a[100:101], v9 offset:16384
 buffer_store_dwordx4 v[240:243], v1, s[12:15], s59 offen offset:3072 sc1
 v_mfma_f32_16x16x32_bf16 v[164:167], a[80:83], a[208:211], v[164:167]
 s_waitcnt lgkmcnt(3)
 ds_read_b64_tr_b16 a[102:103], v9 offset:20480
 v_xor_b32 v10, 320, v6
 v_mfma_f32_16x16x32_bf16 v[164:167], a[84:87], a[216:219], v[164:167]
 ds_read_b64_tr_b16 a[104:105], v10 offset:0
 v_mul_f32 v36, s34, v36
 v_mfma_f32_16x16x32_bf16 v[164:167], a[88:91], a[112:115], v[164:167]
 ds_read_b64_tr_b16 a[106:107], v10 offset:4096
 v_mul_f32 v37, s34, v37
 v_mfma_f32_16x16x32_bf16 v[164:167], a[92:95], a[120:123], v[164:167]
 ds_read_b64_tr_b16 a[108:109], v10 offset:16384
 v_mul_f32 v38, s34, v38
 v_mfma_f32_16x16x32_bf16 v[172:175], a[72:75], a[196:199], v[172:175]
 ds_read_b64_tr_b16 a[110:111], v10 offset:20480
 v_xor_b32 v7, 65856, v6
 v_mfma_f32_16x16x32_bf16 v[172:175], a[76:79], a[204:207], v[172:175]
 ds_read_b64_tr_b16 a[64:65], v7 offset:0
 v_mul_f32 v39, s34, v39
 v_mfma_f32_16x16x32_bf16 v[172:175], a[80:83], a[212:215], v[172:175]
 ds_read_b64_tr_b16 a[66:67], v7 offset:4096
 v_mul_f32 v76, s34, v76
 v_mfma_f32_16x16x32_bf16 v[172:175], a[84:87], a[220:223], v[172:175]
 ds_read_b64_tr_b16 a[68:69], v7 offset:16384
 v_mul_f32 v77, s34, v77
 v_mfma_f32_16x16x32_bf16 v[172:175], a[88:91], a[116:119], v[172:175]
 s_add_u32 s59, s56, 32768
 ds_read_b64_tr_b16 a[70:71], v7 offset:20480
 v_xor_b32 v8, 131424, v6
 v_mfma_f32_16x16x32_bf16 v[172:175], a[92:95], a[124:127], v[172:175]
 s_waitcnt lgkmcnt(6)
 ds_read_b64_tr_b16 a[72:73], v8 offset:0
 buffer_store_dwordx4 v[248:251], v1, s[12:15], s59 offen offset:3072 sc1
 v_mfma_f32_16x16x32_bf16 v[180:183], a[96:99], a[192:195], v[180:183]
 ds_read_b64_tr_b16 a[74:75], v8 offset:4096
 v_mul_f32 v78, s34, v78
 v_mfma_f32_16x16x32_bf16 v[180:183], a[100:103], a[200:203], v[180:183]
 ds_read_b64_tr_b16 a[76:77], v8 offset:16384
 v_mul_f32 v79, s34, v79
 v_mfma_f32_16x16x32_bf16 v[180:183], a[104:107], a[208:211], v[180:183]
 s_waitcnt lgkmcnt(3)
 ds_read_b64_tr_b16 a[78:79], v8 offset:20480
 v_xor_b32 v9, 352, v6
 v_mfma_f32_16x16x32_bf16 v[180:183], a[108:111], a[216:219], v[180:183]
 ds_read_b64_tr_b16 a[80:81], v9 offset:0
 v_cvt_pk_bf16_f32 v36, v36, v37
 v_mfma_f32_16x16x32_bf16 v[180:183], a[64:67], a[112:115], v[180:183]
 ds_read_b64_tr_b16 a[82:83], v9 offset:4096
 v_cvt_pk_bf16_f32 v37, v38, v39
 v_mfma_f32_16x16x32_bf16 v[180:183], a[68:71], a[120:123], v[180:183]
 ds_read_b64_tr_b16 a[84:85], v9 offset:16384
 v_cvt_pk_bf16_f32 v38, v76, v77
 v_mfma_f32_16x16x32_bf16 v[188:191], a[96:99], a[196:199], v[188:191]
 ds_read_b64_tr_b16 a[86:87], v9 offset:20480
 v_xor_b32 v10, 65888, v6
 v_mfma_f32_16x16x32_bf16 v[188:191], a[100:103], a[204:207], v[188:191]
 ds_read_b64_tr_b16 a[88:89], v10 offset:0
 v_cvt_pk_bf16_f32 v39, v78, v79
 v_mfma_f32_16x16x32_bf16 v[188:191], a[104:107], a[212:215], v[188:191]
 ds_read_b64_tr_b16 a[90:91], v10 offset:4096
 v_accvgpr_write_b32 a36, v36
 v_mfma_f32_16x16x32_bf16 v[188:191], a[108:111], a[220:223], v[188:191]
 ds_read_b64_tr_b16 a[92:93], v10 offset:16384
 v_accvgpr_write_b32 a37, v37
 v_mfma_f32_16x16x32_bf16 v[188:191], a[64:67], a[116:119], v[188:191]
 ds_read_b64_tr_b16 a[94:95], v10 offset:20480
 v_xor_b32 v7, 131456, v6
 v_mfma_f32_16x16x32_bf16 v[188:191], a[68:71], a[124:127], v[188:191]
 s_waitcnt lgkmcnt(6)
 ds_read_b64_tr_b16 a[96:97], v7 offset:0
 v_accvgpr_write_b32 a38, v38
 v_mfma_f32_16x16x32_bf16 v[196:199], a[72:75], a[192:195], v[196:199]
 ds_read_b64_tr_b16 a[98:99], v7 offset:4096
 v_accvgpr_write_b32 a39, v39
 v_mfma_f32_16x16x32_bf16 v[196:199], a[76:79], a[200:203], v[196:199]
 ds_read_b64_tr_b16 a[100:101], v7 offset:16384
 v_mul_f32 v84, s34, v84
 v_mfma_f32_16x16x32_bf16 v[196:199], a[80:83], a[208:211], v[196:199]
 s_waitcnt lgkmcnt(3)
 ds_read_b64_tr_b16 a[102:103], v7 offset:20480
 v_xor_b32 v8, 384, v6
 v_mfma_f32_16x16x32_bf16 v[196:199], a[84:87], a[216:219], v[196:199]
 ds_read_b64_tr_b16 a[104:105], v8 offset:0
 v_mul_f32 v85, s34, v85
 v_mfma_f32_16x16x32_bf16 v[196:199], a[88:91], a[112:115], v[196:199]
 ds_read_b64_tr_b16 a[106:107], v8 offset:4096
 v_mul_f32 v86, s34, v86
 v_mfma_f32_16x16x32_bf16 v[196:199], a[92:95], a[120:123], v[196:199]
 ds_read_b64_tr_b16 a[108:109], v8 offset:16384
 v_mul_f32 v87, s34, v87
 v_mfma_f32_16x16x32_bf16 v[204:207], a[72:75], a[196:199], v[204:207]
 ds_read_b64_tr_b16 a[110:111], v8 offset:20480
 v_xor_b32 v9, 65920, v6
 v_mfma_f32_16x16x32_bf16 v[204:207], a[76:79], a[204:207], v[204:207]
 ds_read_b64_tr_b16 a[64:65], v9 offset:0
 v_mul_f32 v100, s34, v100
 v_mfma_f32_16x16x32_bf16 v[204:207], a[80:83], a[212:215], v[204:207]
 ds_read_b64_tr_b16 a[66:67], v9 offset:4096
 v_mul_f32 v101, s34, v101
 v_mfma_f32_16x16x32_bf16 v[204:207], a[84:87], a[220:223], v[204:207]
 ds_read_b64_tr_b16 a[68:69], v9 offset:16384
 v_mul_f32 v102, s34, v102
 v_mfma_f32_16x16x32_bf16 v[204:207], a[88:91], a[116:119], v[204:207]
 ds_read_b64_tr_b16 a[70:71], v9 offset:20480
 v_xor_b32 v10, 131488, v6
 v_mfma_f32_16x16x32_bf16 v[204:207], a[92:95], a[124:127], v[204:207]
 s_waitcnt lgkmcnt(6)
 ds_read_b64_tr_b16 a[72:73], v10 offset:0
 v_mul_f32 v103, s34, v103
 v_mfma_f32_16x16x32_bf16 v[212:215], a[96:99], a[192:195], v[212:215]
 ds_read_b64_tr_b16 a[74:75], v10 offset:4096
 v_cvt_pk_bf16_f32 v84, v84, v85
 v_mfma_f32_16x16x32_bf16 v[212:215], a[100:103], a[200:203], v[212:215]
 ds_read_b64_tr_b16 a[76:77], v10 offset:16384
 v_cvt_pk_bf16_f32 v85, v86, v87
 v_mfma_f32_16x16x32_bf16 v[212:215], a[104:107], a[208:211], v[212:215]
 s_waitcnt lgkmcnt(3)
 ds_read_b64_tr_b16 a[78:79], v10 offset:20480
 v_xor_b32 v7, 416, v6
 v_mfma_f32_16x16x32_bf16 v[212:215], a[108:111], a[216:219], v[212:215]
 ds_read_b64_tr_b16 a[80:81], v7 offset:0
 v_cvt_pk_bf16_f32 v86, v100, v101
 v_mfma_f32_16x16x32_bf16 v[212:215], a[64:67], a[112:115], v[212:215]
 ds_read_b64_tr_b16 a[82:83], v7 offset:4096
 v_cvt_pk_bf16_f32 v87, v102, v103
 v_mfma_f32_16x16x32_bf16 v[212:215], a[68:71], a[120:123], v[212:215]
 ds_read_b64_tr_b16 a[84:85], v7 offset:16384
 v_accvgpr_write_b32 a8, v84
 v_mfma_f32_16x16x32_bf16 v[220:223], a[96:99], a[196:199], v[220:223]
 ds_read_b64_tr_b16 a[86:87], v7 offset:20480
 v_xor_b32 v8, 65952, v6
 v_mfma_f32_16x16x32_bf16 v[220:223], a[100:103], a[204:207], v[220:223]
 ds_read_b64_tr_b16 a[88:89], v8 offset:0
 v_accvgpr_write_b32 a9, v85
 v_mfma_f32_16x16x32_bf16 v[220:223], a[104:107], a[212:215], v[220:223]
 ds_read_b64_tr_b16 a[90:91], v8 offset:4096
 v_accvgpr_write_b32 a10, v86
 v_mfma_f32_16x16x32_bf16 v[220:223], a[108:111], a[220:223], v[220:223]
 ds_read_b64_tr_b16 a[92:93], v8 offset:16384
 v_accvgpr_write_b32 a11, v87
 v_mfma_f32_16x16x32_bf16 v[220:223], a[64:67], a[116:119], v[220:223]
 ds_read_b64_tr_b16 a[94:95], v8 offset:20480
 v_xor_b32 v9, 131520, v6
 v_mfma_f32_16x16x32_bf16 v[220:223], a[68:71], a[124:127], v[220:223]
 s_waitcnt lgkmcnt(6)
 ds_read_b64_tr_b16 a[96:97], v9 offset:0
 v_mul_f32 v92, s34, v92
 v_mfma_f32_16x16x32_bf16 v[228:231], a[72:75], a[192:195], v[228:231]
 ds_read_b64_tr_b16 a[98:99], v9 offset:4096
 v_mul_f32 v93, s34, v93
 v_mfma_f32_16x16x32_bf16 v[228:231], a[76:79], a[200:203], v[228:231]
 ds_read_b64_tr_b16 a[100:101], v9 offset:16384
 v_mul_f32 v94, s34, v94
 v_mfma_f32_16x16x32_bf16 v[228:231], a[80:83], a[208:211], v[228:231]
 s_waitcnt lgkmcnt(3)
 ds_read_b64_tr_b16 a[102:103], v9 offset:20480
 v_xor_b32 v10, 448, v6
 v_mfma_f32_16x16x32_bf16 v[228:231], a[84:87], a[216:219], v[228:231]
 ds_read_b64_tr_b16 a[104:105], v10 offset:0
 v_mul_f32 v95, s34, v95
 v_mfma_f32_16x16x32_bf16 v[228:231], a[88:91], a[112:115], v[228:231]
 ds_read_b64_tr_b16 a[106:107], v10 offset:4096
 v_mul_f32 v108, s34, v108
 v_mfma_f32_16x16x32_bf16 v[228:231], a[92:95], a[120:123], v[228:231]
 ds_read_b64_tr_b16 a[108:109], v10 offset:16384
 v_mul_f32 v109, s34, v109
 v_mfma_f32_16x16x32_bf16 v[236:239], a[72:75], a[196:199], v[236:239]
 ds_read_b64_tr_b16 a[110:111], v10 offset:20480
 v_xor_b32 v7, 65984, v6
 v_mfma_f32_16x16x32_bf16 v[236:239], a[76:79], a[204:207], v[236:239]
 ds_read_b64_tr_b16 a[64:65], v7 offset:0
 buffer_load_dword v13, v12, s[12:15], s58 offen sc1
 v_mfma_f32_16x16x32_bf16 v[236:239], a[80:83], a[212:215], v[236:239]
 ds_read_b64_tr_b16 a[66:67], v7 offset:4096
 v_mul_f32 v110, s34, v110
 v_mfma_f32_16x16x32_bf16 v[236:239], a[84:87], a[220:223], v[236:239]
 ds_read_b64_tr_b16 a[68:69], v7 offset:16384
 v_mul_f32 v111, s34, v111
 v_mfma_f32_16x16x32_bf16 v[236:239], a[88:91], a[116:119], v[236:239]
 ds_read_b64_tr_b16 a[70:71], v7 offset:20480
 v_xor_b32 v8, 131552, v6
 v_mfma_f32_16x16x32_bf16 v[236:239], a[92:95], a[124:127], v[236:239]
 s_waitcnt lgkmcnt(6)
 ds_read_b64_tr_b16 a[72:73], v8 offset:0
 v_cvt_pk_bf16_f32 v92, v92, v93
 v_mfma_f32_16x16x32_bf16 v[244:247], a[96:99], a[192:195], v[244:247]
 ds_read_b64_tr_b16 a[74:75], v8 offset:4096
 v_cvt_pk_bf16_f32 v93, v94, v95
 v_mfma_f32_16x16x32_bf16 v[244:247], a[100:103], a[200:203], v[244:247]
 ds_read_b64_tr_b16 a[76:77], v8 offset:16384
 v_cvt_pk_bf16_f32 v94, v108, v109
 v_mfma_f32_16x16x32_bf16 v[244:247], a[104:107], a[208:211], v[244:247]
 s_waitcnt lgkmcnt(3)
 ds_read_b64_tr_b16 a[78:79], v8 offset:20480
 v_xor_b32 v9, 480, v6
 v_mfma_f32_16x16x32_bf16 v[244:247], a[108:111], a[216:219], v[244:247]
 ds_read_b64_tr_b16 a[80:81], v9 offset:0
 v_cvt_pk_bf16_f32 v95, v110, v111
 v_mfma_f32_16x16x32_bf16 v[244:247], a[64:67], a[112:115], v[244:247]
 ds_read_b64_tr_b16 a[82:83], v9 offset:4096
 v_accvgpr_write_b32 a40, v92
 v_mfma_f32_16x16x32_bf16 v[244:247], a[68:71], a[120:123], v[244:247]
 ds_read_b64_tr_b16 a[84:85], v9 offset:16384
 v_accvgpr_write_b32 a41, v93
 v_mfma_f32_16x16x32_bf16 v[252:255], a[96:99], a[196:199], v[252:255]
 ds_read_b64_tr_b16 a[86:87], v9 offset:20480
 v_xor_b32 v10, 66016, v6
 v_mfma_f32_16x16x32_bf16 v[252:255], a[100:103], a[204:207], v[252:255]
 ds_read_b64_tr_b16 a[88:89], v10 offset:0
 v_accvgpr_write_b32 a42, v94
 v_mfma_f32_16x16x32_bf16 v[252:255], a[104:107], a[212:215], v[252:255]
 ds_read_b64_tr_b16 a[90:91], v10 offset:4096
 v_accvgpr_write_b32 a43, v95
 v_mfma_f32_16x16x32_bf16 v[252:255], a[108:111], a[220:223], v[252:255]
 ds_read_b64_tr_b16 a[92:93], v10 offset:16384
 v_mfma_f32_16x16x32_bf16 v[252:255], a[64:67], a[116:119], v[252:255]
 ds_read_b64_tr_b16 a[94:95], v10 offset:20480
 v_mfma_f32_16x16x32_bf16 v[252:255], a[68:71], a[124:127], v[252:255]
 s_waitcnt lgkmcnt(6)
 v_mfma_f32_16x16x32_bf16 v[16:19], a[72:75], a[192:195], v[16:19]
 v_mfma_f32_16x16x32_bf16 v[16:19], a[76:79], a[200:203], v[16:19]
 v_mfma_f32_16x16x32_bf16 v[16:19], a[80:83], a[208:211], v[16:19]
 s_waitcnt lgkmcnt(0)
 v_mfma_f32_16x16x32_bf16 v[16:19], a[84:87], a[216:219], v[16:19]
 v_mfma_f32_16x16x32_bf16 v[16:19], a[88:91], a[112:115], v[16:19]
 v_mfma_f32_16x16x32_bf16 v[16:19], a[92:95], a[120:123], v[16:19]
 v_mfma_f32_16x16x32_bf16 v[24:27], a[72:75], a[196:199], v[24:27]
 v_mfma_f32_16x16x32_bf16 v[24:27], a[76:79], a[204:207], v[24:27]
 v_mfma_f32_16x16x32_bf16 v[24:27], a[80:83], a[212:215], v[24:27]
 v_mfma_f32_16x16x32_bf16 v[24:27], a[84:87], a[220:223], v[24:27]
 s_waitcnt lgkmcnt(0)
 v_mfma_f32_16x16x32_bf16 v[24:27], a[88:91], a[116:119], v[24:27]
 s_barrier
 v_mfma_f32_16x16x32_bf16 v[24:27], a[92:95], a[124:127], v[24:27]
 s_waitcnt vmcnt(0)
 v_cmp_ne_u32 s[16:17], 0, v13
 v_cmp_gt_u32 vcc, 256, v5
 s_or_b64 vcc, vcc, s[16:17]
 s_mov_b32 m0, s40
 s_cselect_b32 s48, 0, 1
 s_cselect_b32 s52, 2.0, s42
 buffer_load_dwordx4 v1, s[12:15], s52 offen offset:0 sc1 lds
 v_pk_mul_f32 v[116:117], v[116:117], s[34:35]
 v_pk_mul_f32 v[118:119], v[118:119], s[34:35]
 v_pk_mul_f32 v[132:133], v[132:133], s[34:35]
 v_pk_mul_f32 v[134:135], v[134:135], s[34:35]
 v_cvt_pk_bf16_f32 v116, v116, v117
 v_cvt_pk_bf16_f32 v117, v118, v119
 v_cvt_pk_bf16_f32 v118, v132, v133
 v_cvt_pk_bf16_f32 v119, v134, v135
 v_accvgpr_write_b32 a12, v116
 v_accvgpr_write_b32 a13, v117
 v_accvgpr_write_b32 a14, v118
 v_accvgpr_write_b32 a15, v119
 v_pk_mul_f32 v[124:125], v[124:125], s[34:35]
 v_pk_mul_f32 v[126:127], v[126:127], s[34:35]
 v_pk_mul_f32 v[140:141], v[140:141], s[34:35]
 buffer_load_dwordx4 v1, s[12:15], s52 offen offset:1024 sc1 lds
 v_pk_mul_f32 v[142:143], v[142:143], s[34:35]
 v_cvt_pk_bf16_f32 v124, v124, v125
 v_cvt_pk_bf16_f32 v125, v126, v127
 v_cvt_pk_bf16_f32 v126, v140, v141
 v_cvt_pk_bf16_f32 v127, v142, v143
 v_accvgpr_write_b32 a44, v124
 v_accvgpr_write_b32 a45, v125
 v_accvgpr_write_b32 a46, v126
 v_accvgpr_write_b32 a47, v127
 v_pk_mul_f32 v[148:149], v[148:149], s[34:35]
 v_pk_mul_f32 v[150:151], v[150:151], s[34:35]
 v_pk_mul_f32 v[164:165], v[164:165], s[34:35]
 v_pk_mul_f32 v[166:167], v[166:167], s[34:35]
 v_cvt_pk_bf16_f32 v148, v148, v149
 v_cvt_pk_bf16_f32 v149, v150, v151
 buffer_load_dwordx4 v1, s[12:15], s52 offen offset:2048 sc1 lds
 v_cvt_pk_bf16_f32 v150, v164, v165
 v_cvt_pk_bf16_f32 v151, v166, v167
 v_accvgpr_write_b32 a16, v148
 v_accvgpr_write_b32 a17, v149
 v_accvgpr_write_b32 a18, v150
 v_accvgpr_write_b32 a19, v151
 v_pk_mul_f32 v[156:157], v[156:157], s[34:35]
 v_pk_mul_f32 v[158:159], v[158:159], s[34:35]
 v_pk_mul_f32 v[172:173], v[172:173], s[34:35]
 v_pk_mul_f32 v[174:175], v[174:175], s[34:35]
 v_cvt_pk_bf16_f32 v156, v156, v157
 v_cvt_pk_bf16_f32 v157, v158, v159
 v_cvt_pk_bf16_f32 v158, v172, v173
 v_cvt_pk_bf16_f32 v159, v174, v175
 v_accvgpr_write_b32 a48, v156
 buffer_load_dwordx4 v1, s[12:15], s52 offen offset:3072 sc1 lds
 v_accvgpr_write_b32 a49, v157
 v_accvgpr_write_b32 a50, v158
 v_accvgpr_write_b32 a51, v159
 v_pk_mul_f32 v[180:181], v[180:181], s[34:35]
 v_pk_mul_f32 v[182:183], v[182:183], s[34:35]
 v_pk_mul_f32 v[196:197], v[196:197], s[34:35]
 v_pk_mul_f32 v[198:199], v[198:199], s[34:35]
 v_cvt_pk_bf16_f32 v180, v180, v181
 v_cvt_pk_bf16_f32 v181, v182, v183
 v_cvt_pk_bf16_f32 v182, v196, v197
 v_cvt_pk_bf16_f32 v183, v198, v199
 v_accvgpr_write_b32 a20, v180
 v_accvgpr_write_b32 a21, v181
 v_accvgpr_write_b32 a22, v182
 v_accvgpr_write_b32 a23, v183
 s_bitset1_b32 m0, 12
 s_nop 0
 buffer_load_dwordx4 v4, s[12:15], s52 offen offset:0 sc1 lds
 v_pk_mul_f32 v[188:189], v[188:189], s[34:35]
 v_pk_mul_f32 v[190:191], v[190:191], s[34:35]
 v_pk_mul_f32 v[204:205], v[204:205], s[34:35]
 v_pk_mul_f32 v[206:207], v[206:207], s[34:35]
 v_cvt_pk_bf16_f32 v188, v188, v189
 v_cvt_pk_bf16_f32 v189, v190, v191
 v_cvt_pk_bf16_f32 v190, v204, v205
 v_cvt_pk_bf16_f32 v191, v206, v207
 v_accvgpr_write_b32 a52, v188
 v_accvgpr_write_b32 a53, v189
 v_accvgpr_write_b32 a54, v190
 v_accvgpr_write_b32 a55, v191
 v_pk_mul_f32 v[212:213], v[212:213], s[34:35]
 v_pk_mul_f32 v[214:215], v[214:215], s[34:35]
 v_pk_mul_f32 v[228:229], v[228:229], s[34:35]
 buffer_load_dwordx4 v4, s[12:15], s52 offen offset:1024 sc1 lds
 v_pk_mul_f32 v[230:231], v[230:231], s[34:35]
 v_cvt_pk_bf16_f32 v212, v212, v213
 v_cvt_pk_bf16_f32 v213, v214, v215
 v_cvt_pk_bf16_f32 v214, v228, v229
 v_cvt_pk_bf16_f32 v215, v230, v231
 v_accvgpr_write_b32 a24, v212
 v_accvgpr_write_b32 a25, v213
 v_accvgpr_write_b32 a26, v214
 v_accvgpr_write_b32 a27, v215
 v_pk_mul_f32 v[220:221], v[220:221], s[34:35]
 v_pk_mul_f32 v[222:223], v[222:223], s[34:35]
 v_pk_mul_f32 v[236:237], v[236:237], s[34:35]
 v_pk_mul_f32 v[238:239], v[238:239], s[34:35]
 v_cvt_pk_bf16_f32 v220, v220, v221
 v_cvt_pk_bf16_f32 v221, v222, v223
 buffer_load_dwordx4 v4, s[12:15], s52 offen offset:2048 sc1 lds
 v_cvt_pk_bf16_f32 v222, v236, v237
 v_cvt_pk_bf16_f32 v223, v238, v239
 v_accvgpr_write_b32 a56, v220
 v_accvgpr_write_b32 a57, v221
 v_accvgpr_write_b32 a58, v222
 v_accvgpr_write_b32 a59, v223
 v_pk_mul_f32 v[244:245], v[244:245], s[34:35]
 v_pk_mul_f32 v[246:247], v[246:247], s[34:35]
 v_pk_mul_f32 v[16:17], v[16:17], s[34:35]
 v_pk_mul_f32 v[18:19], v[18:19], s[34:35]
 v_cvt_pk_bf16_f32 v244, v244, v245
 v_cvt_pk_bf16_f32 v245, v246, v247
 v_cvt_pk_bf16_f32 v246, v16, v17
 v_cvt_pk_bf16_f32 v247, v18, v19
 v_accvgpr_write_b32 a28, v244
 buffer_load_dwordx4 v4, s[12:15], s52 offen offset:3072 sc1 lds
 v_accvgpr_write_b32 a29, v245
 v_accvgpr_write_b32 a30, v246
 v_accvgpr_write_b32 a31, v247
 v_pk_mul_f32 v[252:253], v[252:253], s[34:35]
 v_pk_mul_f32 v[254:255], v[254:255], s[34:35]
 v_pk_mul_f32 v[24:25], v[24:25], s[34:35]
 v_pk_mul_f32 v[26:27], v[26:27], s[34:35]
 v_cvt_pk_bf16_f32 v252, v252, v253
 v_cvt_pk_bf16_f32 v253, v254, v255
 v_cvt_pk_bf16_f32 v254, v24, v25
 v_cvt_pk_bf16_f32 v255, v26, v27
 v_accvgpr_write_b32 a60, v252
 v_accvgpr_write_b32 a61, v253
 v_accvgpr_write_b32 a62, v254
 v_accvgpr_write_b32 a63, v255
 s_branch L_kvdone
L_kloop_side:
 s_mov_b64 exec, 1
 global_atomic_add v3, v15, s[90:91] offset:128 sc1
 s_mov_b64 exec, -1
 s_mov_b32 s55, 6
 s_branch L_kloop
L_vloop_side:
 s_mov_b64 exec, 1
 global_atomic_add v3, v15, s[90:91] offset:128 sc1
 s_mov_b64 exec, -1
 s_mov_b32 s55, 6
 s_branch L_vloop
L_vloop_head:
 v_mfma_f32_16x16x32_bf16 v[64:67], a[64:67], a[0:3], 0
 s_add_u32 m0, s29, 118784
 ds_read_b64_tr_b16 a[24:25], v9 offset:0
 v_mfma_f32_16x16x32_bf16 v[64:67], a[68:71], a[4:7], v[64:67]
 ds_read_b64_tr_b16 a[26:27], v9 offset:4096
 buffer_load_dwordx4 v2, s[8:11], s52 offen  lds
 v_mfma_f32_16x16x32_bf16 v[68:71], a[76:79], a[4:7], 0
 ds_read_b64_tr_b16 a[28:29], v9 offset:16384
 v_mfma_f32_16x16x32_bf16 v[68:71], a[72:75], a[0:3], v[68:71]
 ds_read_b64_tr_b16 a[30:31], v9 offset:20480
 v_mfma_f32_16x16x32_bf16 v[72:75], a[80:83], a[0:3], 0
 s_add_u32 m0, s29, 53248
 ds_read_b128 a[96:99], v4 offset:8192
 v_mfma_f32_16x16x32_bf16 v[72:75], a[84:87], a[4:7], v[72:75]
 buffer_load_dwordx4 v1, s[4:7], s45 offen  lds
 v_mfma_f32_16x16x32_bf16 v[76:79], a[92:95], a[4:7], 0
 ds_read_b128 a[100:103], v5 offset:8192
 v_mfma_f32_16x16x32_bf16 v[76:79], a[88:91], a[0:3], v[76:79]
 v_mfma_f32_16x16x32_bf16 v[84:87], a[88:91], a[8:11], 0
 s_add_u32 m0, s29, 122880
 ds_read_b128 a[108:111], v5 offset:10240
 v_mfma_f32_16x16x32_bf16 v[84:87], a[92:95], a[12:15], v[84:87]
 buffer_load_dwordx4 v2, s[8:11], s53 offen  lds
 v_mfma_f32_16x16x32_bf16 v[80:83], a[84:87], a[12:15], 0
 ds_read_b128 a[104:107], v4 offset:10240
 v_mfma_f32_16x16x32_bf16 v[80:83], a[80:83], a[8:11], v[80:83]
 v_mfma_f32_16x16x32_bf16 v[92:95], a[72:75], a[8:11], 0
 s_add_u32 m0, s29, 57344
 ds_read_b128 a[112:115], v4 offset:12288
 v_mfma_f32_16x16x32_bf16 v[92:95], a[76:79], a[12:15], v[92:95]
 buffer_load_dwordx4 v1, s[4:7], s46 offen  lds
 v_mfma_f32_16x16x32_bf16 v[88:91], a[68:71], a[12:15], 0
 ds_read_b128 a[116:119], v5 offset:12288
 v_mfma_f32_16x16x32_bf16 v[88:91], a[64:67], a[8:11], v[88:91]
 v_mfma_f32_16x16x32_bf16 v[96:99], a[64:67], a[16:19], 0
 s_add_u32 m0, s29, 126976
 ds_read_b128 a[124:127], v5 offset:14336
 v_mfma_f32_16x16x32_bf16 v[96:99], a[68:71], a[20:23], v[96:99]
 buffer_load_dwordx4 v2, s[8:11], s54 offen  lds
 v_mfma_f32_16x16x32_bf16 v[100:103], a[76:79], a[20:23], 0
 ds_read_b128 a[120:123], v4 offset:14336
 v_mfma_f32_16x16x32_bf16 v[100:103], a[72:75], a[16:19], v[100:103]
 v_mfma_f32_16x16x32_bf16 v[104:107], a[80:83], a[16:19], 0
 s_add_u32 m0, s29, 61440
 ds_read_b64_tr_b16 a[32:33], v10 offset:0
 v_mfma_f32_16x16x32_bf16 v[104:107], a[84:87], a[20:23], v[104:107]
 ds_read_b64_tr_b16 a[34:35], v10 offset:4096
 buffer_load_dwordx4 v1, s[4:7], s47 offen  lds
 v_mfma_f32_16x16x32_bf16 v[108:111], a[92:95], a[20:23], 0
 ds_read_b64_tr_b16 a[36:37], v10 offset:16384
 v_add_u32 v1, 128, v1
 v_mfma_f32_16x16x32_bf16 v[108:111], a[88:91], a[16:19], v[108:111]
 s_waitcnt lgkmcnt(8)
 ds_read_b64_tr_b16 a[38:39], v10 offset:20480
 v_add_u32 v2, 0x80000, v2
 v_mfma_f32_16x16x32_bf16 v[116:119], a[88:91], a[24:27], 0
 ds_read_b64_tr_b16 a[40:41], v11 offset:0
 v_mfma_f32_16x16x32_bf16 v[116:119], a[92:95], a[28:31], v[116:119]
 ds_read_b64_tr_b16 a[42:43], v11 offset:4096
 v_mfma_f32_16x16x32_bf16 v[112:115], a[84:87], a[28:31], 0
 ds_read_b64_tr_b16 a[44:45], v11 offset:16384
 v_mfma_f32_16x16x32_bf16 v[112:115], a[80:83], a[24:27], v[112:115]
 ds_read_b64_tr_b16 a[46:47], v11 offset:20480
 v_mfma_f32_16x16x32_bf16 v[124:127], a[72:75], a[24:27], 0
 ds_read_b64_tr_b16 a[48:49], v12 offset:0
 v_mfma_f32_16x16x32_bf16 v[124:127], a[76:79], a[28:31], v[124:127]
 ds_read_b64_tr_b16 a[50:51], v12 offset:4096
 v_mfma_f32_16x16x32_bf16 v[120:123], a[68:71], a[28:31], 0
 ds_read_b64_tr_b16 a[52:53], v12 offset:16384
 v_mfma_f32_16x16x32_bf16 v[120:123], a[64:67], a[24:27], v[120:123]
 ds_read_b64_tr_b16 a[54:55], v12 offset:20480
 v_mfma_f32_16x16x32_bf16 v[16:19], a[96:99], a[0:3], 0
 ds_read_b64_tr_b16 a[56:57], v13 offset:0
 v_mfma_f32_16x16x32_bf16 v[16:19], a[100:103], a[4:7], v[16:19]
 ds_read_b64_tr_b16 a[58:59], v13 offset:4096
 v_mfma_f32_16x16x32_bf16 v[20:23], a[108:111], a[4:7], 0
 s_waitcnt lgkmcnt(8)
 ds_read_b64_tr_b16 a[60:61], v13 offset:16384
 v_mfma_f32_16x16x32_bf16 v[20:23], a[104:107], a[0:3], v[20:23]
 ds_read_b64_tr_b16 a[62:63], v13 offset:20480
 v_mfma_f32_16x16x32_bf16 v[24:27], a[112:115], a[0:3], 0
 v_mfma_f32_16x16x32_bf16 v[24:27], a[116:119], a[4:7], v[24:27]
 v_mfma_f32_16x16x32_bf16 v[28:31], a[124:127], a[4:7], 0
 v_mfma_f32_16x16x32_bf16 v[28:31], a[120:123], a[0:3], v[28:31]
 s_waitcnt lgkmcnt(0)
 v_mfma_f32_16x16x32_bf16 a[228:231], a[120:123], a[8:11], 0
 s_barrier
 v_mfma_f32_16x16x32_bf16 a[228:231], a[124:127], a[12:15], a[228:231]
 s_add_u32 m0, s29, 65536
 v_mfma_f32_16x16x32_bf16 a[224:227], a[116:119], a[12:15], 0
 buffer_load_dwordx4 v2, s[8:11], 0 offen  lds
 v_mfma_f32_16x16x32_bf16 a[224:227], a[112:115], a[8:11], a[224:227]
 v_mfma_f32_16x16x32_bf16 a[236:239], a[104:107], a[8:11], 0
 v_mfma_f32_16x16x32_bf16 a[236:239], a[108:111], a[12:15], a[236:239]
 v_mfma_f32_16x16x32_bf16 a[232:235], a[100:103], a[12:15], 0
 s_add_u32 m0, s29, 0
 v_mfma_f32_16x16x32_bf16 a[232:235], a[96:99], a[8:11], a[232:235]
 buffer_load_dwordx4 v1, s[4:7], 0 offen  lds
 v_mfma_f32_16x16x32_bf16 v[32:35], a[96:99], a[16:19], 0
 v_mfma_f32_16x16x32_bf16 v[32:35], a[100:103], a[20:23], v[32:35]
 v_mfma_f32_16x16x32_bf16 v[36:39], a[108:111], a[20:23], 0
 v_mfma_f32_16x16x32_bf16 v[36:39], a[104:107], a[16:19], v[36:39]
 s_add_u32 m0, s29, 69632
 v_mfma_f32_16x16x32_bf16 v[40:43], a[112:115], a[16:19], 0
 buffer_load_dwordx4 v2, s[8:11], s48 offen  lds
 v_mfma_f32_16x16x32_bf16 v[40:43], a[116:119], a[20:23], v[40:43]
 v_mfma_f32_16x16x32_bf16 v[44:47], a[124:127], a[20:23], 0
 v_mfma_f32_16x16x32_bf16 v[44:47], a[120:123], a[16:19], v[44:47]
 v_mfma_f32_16x16x32_bf16 v[52:55], a[120:123], a[24:27], 0
 s_add_u32 m0, s29, 4096
 v_mfma_f32_16x16x32_bf16 v[52:55], a[124:127], a[28:31], v[52:55]
 buffer_load_dwordx4 v1, s[4:7], s41 offen  lds
 v_mfma_f32_16x16x32_bf16 v[48:51], a[116:119], a[28:31], 0
 v_mfma_f32_16x16x32_bf16 v[48:51], a[112:115], a[24:27], v[48:51]
 v_mfma_f32_16x16x32_bf16 v[60:63], a[104:107], a[24:27], 0
 v_mfma_f32_16x16x32_bf16 v[60:63], a[108:111], a[28:31], v[60:63]
 s_add_u32 m0, s29, 73728
 v_mfma_f32_16x16x32_bf16 v[56:59], a[100:103], a[28:31], 0
 buffer_load_dwordx4 v2, s[8:11], s49 offen  lds
 v_mfma_f32_16x16x32_bf16 v[56:59], a[96:99], a[24:27], v[56:59]
 v_mfma_f32_16x16x32_bf16 v[192:195], a[96:99], a[32:35], 0
 v_mfma_f32_16x16x32_bf16 v[192:195], a[100:103], a[36:39], v[192:195]
 v_mfma_f32_16x16x32_bf16 v[196:199], a[108:111], a[36:39], 0
 s_add_u32 m0, s29, 8192
 v_mfma_f32_16x16x32_bf16 v[196:199], a[104:107], a[32:35], v[196:199]
 buffer_load_dwordx4 v1, s[4:7], s42 offen  lds
 v_mfma_f32_16x16x32_bf16 v[200:203], a[112:115], a[32:35], 0
 v_mfma_f32_16x16x32_bf16 v[200:203], a[116:119], a[36:39], v[200:203]
 v_mfma_f32_16x16x32_bf16 v[204:207], a[124:127], a[36:39], 0
 v_mfma_f32_16x16x32_bf16 v[204:207], a[120:123], a[32:35], v[204:207]
 s_add_u32 m0, s29, 77824
 v_mfma_f32_16x16x32_bf16 v[212:215], a[120:123], a[40:43], 0
 buffer_load_dwordx4 v2, s[8:11], s50 offen  lds
 v_mfma_f32_16x16x32_bf16 v[212:215], a[124:127], a[44:47], v[212:215]
 v_mfma_f32_16x16x32_bf16 v[208:211], a[116:119], a[44:47], 0
 v_mfma_f32_16x16x32_bf16 v[208:211], a[112:115], a[40:43], v[208:211]
 v_mfma_f32_16x16x32_bf16 v[220:223], a[104:107], a[40:43], 0
 s_add_u32 m0, s29, 12288
 v_mfma_f32_16x16x32_bf16 v[220:223], a[108:111], a[44:47], v[220:223]
 buffer_load_dwordx4 v1, s[4:7], s43 offen  lds
 v_mfma_f32_16x16x32_bf16 v[216:219], a[100:103], a[44:47], 0
 v_mfma_f32_16x16x32_bf16 v[216:219], a[96:99], a[40:43], v[216:219]
 v_mfma_f32_16x16x32_bf16 v[224:227], a[96:99], a[48:51], 0
 v_mfma_f32_16x16x32_bf16 v[224:227], a[100:103], a[52:55], v[224:227]
 s_add_u32 m0, s29, 81920
 v_mfma_f32_16x16x32_bf16 v[228:231], a[108:111], a[52:55], 0
 buffer_load_dwordx4 v2, s[8:11], s51 offen  lds
 v_mfma_f32_16x16x32_bf16 v[228:231], a[104:107], a[48:51], v[228:231]
 v_mfma_f32_16x16x32_bf16 v[232:235], a[112:115], a[48:51], 0
 v_mfma_f32_16x16x32_bf16 v[232:235], a[116:119], a[52:55], v[232:235]
 v_mfma_f32_16x16x32_bf16 v[236:239], a[124:127], a[52:55], 0
 s_add_u32 m0, s29, 16384
 v_mfma_f32_16x16x32_bf16 v[236:239], a[120:123], a[48:51], v[236:239]
 buffer_load_dwordx4 v1, s[4:7], s44 offen  lds
 v_mfma_f32_16x16x32_bf16 v[244:247], a[120:123], a[56:59], 0
 v_mfma_f32_16x16x32_bf16 v[244:247], a[124:127], a[60:63], v[244:247]
 v_mfma_f32_16x16x32_bf16 v[240:243], a[116:119], a[60:63], 0
 v_mfma_f32_16x16x32_bf16 v[240:243], a[112:115], a[56:59], v[240:243]
 s_add_u32 m0, s29, 86016
 v_mfma_f32_16x16x32_bf16 v[252:255], a[104:107], a[56:59], 0
 s_waitcnt vmcnt(10)
 buffer_load_dwordx4 v2, s[8:11], s52 offen  lds
 v_mfma_f32_16x16x32_bf16 v[252:255], a[108:111], a[60:63], v[252:255]
 s_barrier
 ds_read_b64_tr_b16 a[0:1], v6 offset:32768
 v_mfma_f32_16x16x32_bf16 v[248:251], a[100:103], a[60:63], 0
 ds_read_b64_tr_b16 a[2:3], v6 offset:36864
 v_mfma_f32_16x16x32_bf16 v[248:251], a[96:99], a[56:59], v[248:251]
 ds_read_b128 a[96:99], v4 offset:40960
 v_mfma_f32_16x16x32_bf16 v[128:131], a[64:67], a[32:35], 0
 s_add_u32 m0, s29, 20480
 v_mfma_f32_16x16x32_bf16 v[128:131], a[68:71], a[36:39], v[128:131]
 buffer_load_dwordx4 v1, s[4:7], s45 offen  lds
 v_mfma_f32_16x16x32_bf16 v[132:135], a[76:79], a[36:39], 0
 ds_read_b64_tr_b16 a[4:5], v6 offset:49152
 v_mfma_f32_16x16x32_bf16 v[132:135], a[72:75], a[32:35], v[132:135]
 ds_read_b64_tr_b16 a[6:7], v6 offset:53248
 v_mfma_f32_16x16x32_bf16 v[136:139], a[80:83], a[32:35], 0
 ds_read_b128 a[100:103], v5 offset:40960
 v_mfma_f32_16x16x32_bf16 v[136:139], a[84:87], a[36:39], v[136:139]
 s_add_u32 m0, s29, 90112
 v_mfma_f32_16x16x32_bf16 v[140:143], a[92:95], a[36:39], 0
 buffer_load_dwordx4 v2, s[8:11], s53 offen  lds
 v_mfma_f32_16x16x32_bf16 v[140:143], a[88:91], a[32:35], v[140:143]
 ds_read_b128 a[108:111], v5 offset:43008
 v_mfma_f32_16x16x32_bf16 v[148:151], a[88:91], a[40:43], 0
 v_mfma_f32_16x16x32_bf16 v[148:151], a[92:95], a[44:47], v[148:151]
 ds_read_b128 a[104:107], v4 offset:43008
 v_mfma_f32_16x16x32_bf16 v[144:147], a[84:87], a[44:47], 0
 s_add_u32 m0, s29, 24576
 v_mfma_f32_16x16x32_bf16 v[144:147], a[80:83], a[40:43], v[144:147]
 buffer_load_dwordx4 v1, s[4:7], s46 offen  lds
 v_mfma_f32_16x16x32_bf16 v[156:159], a[72:75], a[40:43], 0
 ds_read_b128 a[112:115], v4 offset:45056
 v_mfma_f32_16x16x32_bf16 v[156:159], a[76:79], a[44:47], v[156:159]
 v_mfma_f32_16x16x32_bf16 v[152:155], a[68:71], a[44:47], 0
 ds_read_b128 a[116:119], v5 offset:45056
 v_mfma_f32_16x16x32_bf16 v[152:155], a[64:67], a[40:43], v[152:155]
 s_add_u32 m0, s29, 94208
 v_mfma_f32_16x16x32_bf16 v[160:163], a[64:67], a[48:51], 0
 buffer_load_dwordx4 v2, s[8:11], s54 offen  lds
 v_mfma_f32_16x16x32_bf16 v[160:163], a[68:71], a[52:55], v[160:163]
 ds_read_b128 a[124:127], v5 offset:47104
 v_mfma_f32_16x16x32_bf16 v[164:167], a[76:79], a[52:55], 0
 v_mfma_f32_16x16x32_bf16 v[164:167], a[72:75], a[48:51], v[164:167]
 ds_read_b128 a[120:123], v4 offset:47104
 v_mfma_f32_16x16x32_bf16 v[168:171], a[80:83], a[48:51], 0
 s_add_u32 m0, s29, 28672
 v_mfma_f32_16x16x32_bf16 v[168:171], a[84:87], a[52:55], v[168:171]
 buffer_load_dwordx4 v1, s[4:7], s47 offen  lds
 v_mfma_f32_16x16x32_bf16 v[172:175], a[92:95], a[52:55], 0
 v_mfma_f32_16x16x32_bf16 v[172:175], a[88:91], a[48:51], v[172:175]
 ds_read_b64_tr_b16 a[8:9], v7 offset:32768
 v_mfma_f32_16x16x32_bf16 v[180:183], a[88:91], a[56:59], 0
 v_mfma_f32_16x16x32_bf16 v[180:183], a[92:95], a[60:63], v[180:183]
 ds_read_b64_tr_b16 a[10:11], v7 offset:36864
 v_mfma_f32_16x16x32_bf16 v[176:179], a[84:87], a[60:63], 0
 ds_read_b64_tr_b16 a[12:13], v7 offset:49152
 v_mfma_f32_16x16x32_bf16 v[176:179], a[80:83], a[56:59], v[176:179]
 ds_read_b64_tr_b16 a[14:15], v7 offset:53248
 v_mfma_f32_16x16x32_bf16 v[188:191], a[72:75], a[56:59], 0
 ds_read_b64_tr_b16 a[16:17], v8 offset:32768
 v_mfma_f32_16x16x32_bf16 v[188:191], a[76:79], a[60:63], v[188:191]
 ds_read_b64_tr_b16 a[18:19], v8 offset:36864
 v_mfma_f32_16x16x32_bf16 v[184:187], a[68:71], a[60:63], 0
 ds_read_b64_tr_b16 a[20:21], v8 offset:49152
 v_mfma_f32_16x16x32_bf16 v[184:187], a[64:67], a[56:59], v[184:187]
 s_waitcnt lgkmcnt(8)
 ds_read_b64_tr_b16 a[22:23], v8 offset:53248
 v_add_u32 v1, 128, v1
 v_add_u32 v2, 0x80000, v2
 s_add_u32 s56, s56, s30
 buffer_load_dword a243, v14, s[36:39], s56 offen
 s_add_u32 s56, s56, s30
 buffer_load_dword a243, v14, s[36:39], s56 offen
 s_add_u32 s56, s56, s30
 s_branch L_vloop_mid
.p2align 6
L_vloop:
 v_mfma_f32_16x16x32_bf16 v[64:67], a[64:67], a[0:3], v[64:67]
 ds_read_b64_tr_b16 a[24:25], v9 offset:0
 v_mfma_f32_16x16x32_bf16 v[64:67], a[68:71], a[4:7], v[64:67]
 ds_read_b64_tr_b16 a[26:27], v9 offset:4096
 v_mfma_f32_16x16x32_bf16 v[68:71], a[76:79], a[4:7], v[68:71]
 ds_read_b64_tr_b16 a[28:29], v9 offset:16384
 v_mfma_f32_16x16x32_bf16 v[68:71], a[72:75], a[0:3], v[68:71]
 ds_read_b64_tr_b16 a[30:31], v9 offset:20480
 v_mfma_f32_16x16x32_bf16 v[72:75], a[80:83], a[0:3], v[72:75]
 ds_read_b128 a[96:99], v4 offset:8192
 v_mfma_f32_16x16x32_bf16 v[72:75], a[84:87], a[4:7], v[72:75]
 v_mfma_f32_16x16x32_bf16 v[76:79], a[92:95], a[4:7], v[76:79]
 s_waitcnt lgkmcnt(8)
 ds_read_b128 a[100:103], v5 offset:8192
 v_mfma_f32_16x16x32_bf16 v[76:79], a[88:91], a[0:3], v[76:79]
 v_mfma_f32_16x16x32_bf16 v[84:87], a[88:91], a[8:11], v[84:87]
 ds_read_b128 a[108:111], v5 offset:10240
 v_mfma_f32_16x16x32_bf16 v[84:87], a[92:95], a[12:15], v[84:87]
 v_mfma_f32_16x16x32_bf16 v[80:83], a[84:87], a[12:15], v[80:83]
 ds_read_b128 a[104:107], v4 offset:10240
 v_mfma_f32_16x16x32_bf16 v[80:83], a[80:83], a[8:11], v[80:83]
 v_mfma_f32_16x16x32_bf16 v[92:95], a[72:75], a[8:11], v[92:95]
 ds_read_b128 a[112:115], v4 offset:12288
 v_mfma_f32_16x16x32_bf16 v[92:95], a[76:79], a[12:15], v[92:95]
 v_mfma_f32_16x16x32_bf16 v[88:91], a[68:71], a[12:15], v[88:91]
 ds_read_b128 a[116:119], v5 offset:12288
 v_mfma_f32_16x16x32_bf16 v[88:91], a[64:67], a[8:11], v[88:91]
 s_waitcnt lgkmcnt(8)
 v_mfma_f32_16x16x32_bf16 v[96:99], a[64:67], a[16:19], v[96:99]
 ds_read_b128 a[124:127], v5 offset:14336
 v_mfma_f32_16x16x32_bf16 v[96:99], a[68:71], a[20:23], v[96:99]
 v_mfma_f32_16x16x32_bf16 v[100:103], a[76:79], a[20:23], v[100:103]
 ds_read_b128 a[120:123], v4 offset:14336
 v_mfma_f32_16x16x32_bf16 v[100:103], a[72:75], a[16:19], v[100:103]
 v_mfma_f32_16x16x32_bf16 v[104:107], a[80:83], a[16:19], v[104:107]
 ds_read_b64_tr_b16 a[32:33], v10 offset:0
 v_mfma_f32_16x16x32_bf16 v[104:107], a[84:87], a[20:23], v[104:107]
 ds_read_b64_tr_b16 a[34:35], v10 offset:4096
 v_mfma_f32_16x16x32_bf16 v[108:111], a[92:95], a[20:23], v[108:111]
 ds_read_b64_tr_b16 a[36:37], v10 offset:16384
 v_mfma_f32_16x16x32_bf16 v[108:111], a[88:91], a[16:19], v[108:111]
 ds_read_b64_tr_b16 a[38:39], v10 offset:20480
 v_mfma_f32_16x16x32_bf16 v[116:119], a[88:91], a[24:27], v[116:119]
 s_waitcnt lgkmcnt(8)
 ds_read_b64_tr_b16 a[40:41], v11 offset:0
 v_mfma_f32_16x16x32_bf16 v[116:119], a[92:95], a[28:31], v[116:119]
 ds_read_b64_tr_b16 a[42:43], v11 offset:4096
 v_mfma_f32_16x16x32_bf16 v[112:115], a[84:87], a[28:31], v[112:115]
 ds_read_b64_tr_b16 a[44:45], v11 offset:16384
 v_mfma_f32_16x16x32_bf16 v[112:115], a[80:83], a[24:27], v[112:115]
 ds_read_b64_tr_b16 a[46:47], v11 offset:20480
 v_mfma_f32_16x16x32_bf16 v[124:127], a[72:75], a[24:27], v[124:127]
 ds_read_b64_tr_b16 a[48:49], v12 offset:0
 v_mfma_f32_16x16x32_bf16 v[124:127], a[76:79], a[28:31], v[124:127]
 ds_read_b64_tr_b16 a[50:51], v12 offset:4096
 v_mfma_f32_16x16x32_bf16 v[120:123], a[68:71], a[28:31], v[120:123]
 ds_read_b64_tr_b16 a[52:53], v12 offset:16384
 v_mfma_f32_16x16x32_bf16 v[120:123], a[64:67], a[24:27], v[120:123]
 ds_read_b64_tr_b16 a[54:55], v12 offset:20480
 v_mfma_f32_16x16x32_bf16 v[16:19], a[96:99], a[0:3], v[16:19]
 ds_read_b64_tr_b16 a[56:57], v13 offset:0
 v_mfma_f32_16x16x32_bf16 v[16:19], a[100:103], a[4:7], v[16:19]
 ds_read_b64_tr_b16 a[58:59], v13 offset:4096
 v_mfma_f32_16x16x32_bf16 v[20:23], a[108:111], a[4:7], v[20:23]
 ds_read_b64_tr_b16 a[60:61], v13 offset:16384
 v_mfma_f32_16x16x32_bf16 v[20:23], a[104:107], a[0:3], v[20:23]
 s_waitcnt lgkmcnt(8)
 ds_read_b64_tr_b16 a[62:63], v13 offset:20480
 v_mfma_f32_16x16x32_bf16 v[24:27], a[112:115], a[0:3], v[24:27]
 v_mfma_f32_16x16x32_bf16 v[24:27], a[116:119], a[4:7], v[24:27]
 v_mfma_f32_16x16x32_bf16 v[28:31], a[124:127], a[4:7], v[28:31]
 v_mfma_f32_16x16x32_bf16 v[28:31], a[120:123], a[0:3], v[28:31]
 s_waitcnt lgkmcnt(0)
 v_mfma_f32_16x16x32_bf16 a[228:231], a[120:123], a[8:11], a[228:231]
 s_barrier
 v_mfma_f32_16x16x32_bf16 a[228:231], a[124:127], a[12:15], a[228:231]
 s_add_u32 m0, s29, 65536
 v_mfma_f32_16x16x32_bf16 a[224:227], a[116:119], a[12:15], a[224:227]
 buffer_load_dwordx4 v2, s[8:11], 0 offen  lds
 v_mfma_f32_16x16x32_bf16 a[224:227], a[112:115], a[8:11], a[224:227]
 v_mfma_f32_16x16x32_bf16 a[236:239], a[104:107], a[8:11], a[236:239]
 v_mfma_f32_16x16x32_bf16 a[236:239], a[108:111], a[12:15], a[236:239]
 v_mfma_f32_16x16x32_bf16 a[232:235], a[100:103], a[12:15], a[232:235]
 s_add_u32 m0, s29, 0
 v_mfma_f32_16x16x32_bf16 a[232:235], a[96:99], a[8:11], a[232:235]
 buffer_load_dwordx4 v1, s[4:7], 0 offen  lds
 v_mfma_f32_16x16x32_bf16 v[32:35], a[96:99], a[16:19], v[32:35]
 v_mfma_f32_16x16x32_bf16 v[32:35], a[100:103], a[20:23], v[32:35]
 v_mfma_f32_16x16x32_bf16 v[36:39], a[108:111], a[20:23], v[36:39]
 v_mfma_f32_16x16x32_bf16 v[36:39], a[104:107], a[16:19], v[36:39]
 s_add_u32 m0, s29, 69632
 v_mfma_f32_16x16x32_bf16 v[40:43], a[112:115], a[16:19], v[40:43]
 buffer_load_dwordx4 v2, s[8:11], s48 offen  lds
 v_mfma_f32_16x16x32_bf16 v[40:43], a[116:119], a[20:23], v[40:43]
 v_mfma_f32_16x16x32_bf16 v[44:47], a[124:127], a[20:23], v[44:47]
 v_mfma_f32_16x16x32_bf16 v[44:47], a[120:123], a[16:19], v[44:47]
 v_mfma_f32_16x16x32_bf16 v[52:55], a[120:123], a[24:27], v[52:55]
 s_add_u32 m0, s29, 4096
 v_mfma_f32_16x16x32_bf16 v[52:55], a[124:127], a[28:31], v[52:55]
 buffer_load_dwordx4 v1, s[4:7], s41 offen  lds
 v_mfma_f32_16x16x32_bf16 v[48:51], a[116:119], a[28:31], v[48:51]
 v_mfma_f32_16x16x32_bf16 v[48:51], a[112:115], a[24:27], v[48:51]
 v_mfma_f32_16x16x32_bf16 v[60:63], a[104:107], a[24:27], v[60:63]
 v_mfma_f32_16x16x32_bf16 v[60:63], a[108:111], a[28:31], v[60:63]
 s_add_u32 m0, s29, 73728
 v_mfma_f32_16x16x32_bf16 v[56:59], a[100:103], a[28:31], v[56:59]
 buffer_load_dwordx4 v2, s[8:11], s49 offen  lds
 v_mfma_f32_16x16x32_bf16 v[56:59], a[96:99], a[24:27], v[56:59]
 v_mfma_f32_16x16x32_bf16 v[192:195], a[96:99], a[32:35], v[192:195]
 v_mfma_f32_16x16x32_bf16 v[192:195], a[100:103], a[36:39], v[192:195]
 v_mfma_f32_16x16x32_bf16 v[196:199], a[108:111], a[36:39], v[196:199]
 s_add_u32 m0, s29, 8192
 v_mfma_f32_16x16x32_bf16 v[196:199], a[104:107], a[32:35], v[196:199]
 buffer_load_dwordx4 v1, s[4:7], s42 offen  lds
 v_mfma_f32_16x16x32_bf16 v[200:203], a[112:115], a[32:35], v[200:203]
 v_mfma_f32_16x16x32_bf16 v[200:203], a[116:119], a[36:39], v[200:203]
 v_mfma_f32_16x16x32_bf16 v[204:207], a[124:127], a[36:39], v[204:207]
 v_mfma_f32_16x16x32_bf16 v[204:207], a[120:123], a[32:35], v[204:207]
 s_add_u32 m0, s29, 77824
 v_mfma_f32_16x16x32_bf16 v[212:215], a[120:123], a[40:43], v[212:215]
 buffer_load_dwordx4 v2, s[8:11], s50 offen  lds
 v_mfma_f32_16x16x32_bf16 v[212:215], a[124:127], a[44:47], v[212:215]
 v_mfma_f32_16x16x32_bf16 v[208:211], a[116:119], a[44:47], v[208:211]
 v_mfma_f32_16x16x32_bf16 v[208:211], a[112:115], a[40:43], v[208:211]
 v_mfma_f32_16x16x32_bf16 v[220:223], a[104:107], a[40:43], v[220:223]
 s_add_u32 m0, s29, 12288
 v_mfma_f32_16x16x32_bf16 v[220:223], a[108:111], a[44:47], v[220:223]
 buffer_load_dwordx4 v1, s[4:7], s43 offen  lds
 v_mfma_f32_16x16x32_bf16 v[216:219], a[100:103], a[44:47], v[216:219]
 v_mfma_f32_16x16x32_bf16 v[216:219], a[96:99], a[40:43], v[216:219]
 v_mfma_f32_16x16x32_bf16 v[224:227], a[96:99], a[48:51], v[224:227]
 v_mfma_f32_16x16x32_bf16 v[224:227], a[100:103], a[52:55], v[224:227]
 s_add_u32 m0, s29, 81920
 v_mfma_f32_16x16x32_bf16 v[228:231], a[108:111], a[52:55], v[228:231]
 buffer_load_dwordx4 v2, s[8:11], s51 offen  lds
 v_mfma_f32_16x16x32_bf16 v[228:231], a[104:107], a[48:51], v[228:231]
 v_mfma_f32_16x16x32_bf16 v[232:235], a[112:115], a[48:51], v[232:235]
 v_mfma_f32_16x16x32_bf16 v[232:235], a[116:119], a[52:55], v[232:235]
 v_mfma_f32_16x16x32_bf16 v[236:239], a[124:127], a[52:55], v[236:239]
 s_add_u32 m0, s29, 16384
 v_mfma_f32_16x16x32_bf16 v[236:239], a[120:123], a[48:51], v[236:239]
 buffer_load_dwordx4 v1, s[4:7], s44 offen  lds
 v_mfma_f32_16x16x32_bf16 v[244:247], a[120:123], a[56:59], v[244:247]
 v_mfma_f32_16x16x32_bf16 v[244:247], a[124:127], a[60:63], v[244:247]
 v_mfma_f32_16x16x32_bf16 v[240:243], a[116:119], a[60:63], v[240:243]
 v_mfma_f32_16x16x32_bf16 v[240:243], a[112:115], a[56:59], v[240:243]
 s_add_u32 m0, s29, 86016
 v_mfma_f32_16x16x32_bf16 v[252:255], a[104:107], a[56:59], v[252:255]
 s_waitcnt vmcnt(11)
 buffer_load_dwordx4 v2, s[8:11], s52 offen  lds
 v_mfma_f32_16x16x32_bf16 v[252:255], a[108:111], a[60:63], v[252:255]
 s_barrier
 ds_read_b64_tr_b16 a[0:1], v6 offset:32768
 v_mfma_f32_16x16x32_bf16 v[248:251], a[100:103], a[60:63], v[248:251]
 ds_read_b64_tr_b16 a[2:3], v6 offset:36864
 v_mfma_f32_16x16x32_bf16 v[248:251], a[96:99], a[56:59], v[248:251]
 ds_read_b128 a[96:99], v4 offset:40960
 v_mfma_f32_16x16x32_bf16 v[128:131], a[64:67], a[32:35], v[128:131]
 s_add_u32 m0, s29, 20480
 v_mfma_f32_16x16x32_bf16 v[128:131], a[68:71], a[36:39], v[128:131]
 buffer_load_dwordx4 v1, s[4:7], s45 offen  lds
 v_mfma_f32_16x16x32_bf16 v[132:135], a[76:79], a[36:39], v[132:135]
 ds_read_b64_tr_b16 a[4:5], v6 offset:49152
 v_mfma_f32_16x16x32_bf16 v[132:135], a[72:75], a[32:35], v[132:135]
 ds_read_b64_tr_b16 a[6:7], v6 offset:53248
 v_mfma_f32_16x16x32_bf16 v[136:139], a[80:83], a[32:35], v[136:139]
 ds_read_b128 a[100:103], v5 offset:40960
 v_mfma_f32_16x16x32_bf16 v[136:139], a[84:87], a[36:39], v[136:139]
 s_add_u32 m0, s29, 90112
 v_mfma_f32_16x16x32_bf16 v[140:143], a[92:95], a[36:39], v[140:143]
 buffer_load_dwordx4 v2, s[8:11], s53 offen  lds
 v_mfma_f32_16x16x32_bf16 v[140:143], a[88:91], a[32:35], v[140:143]
 ds_read_b128 a[108:111], v5 offset:43008
 v_mfma_f32_16x16x32_bf16 v[148:151], a[88:91], a[40:43], v[148:151]
 v_mfma_f32_16x16x32_bf16 v[148:151], a[92:95], a[44:47], v[148:151]
 ds_read_b128 a[104:107], v4 offset:43008
 v_mfma_f32_16x16x32_bf16 v[144:147], a[84:87], a[44:47], v[144:147]
 s_add_u32 m0, s29, 24576
 v_mfma_f32_16x16x32_bf16 v[144:147], a[80:83], a[40:43], v[144:147]
 buffer_load_dwordx4 v1, s[4:7], s46 offen  lds
 v_mfma_f32_16x16x32_bf16 v[156:159], a[72:75], a[40:43], v[156:159]
 ds_read_b128 a[112:115], v4 offset:45056
 v_mfma_f32_16x16x32_bf16 v[156:159], a[76:79], a[44:47], v[156:159]
 v_mfma_f32_16x16x32_bf16 v[152:155], a[68:71], a[44:47], v[152:155]
 ds_read_b128 a[116:119], v5 offset:45056
 v_mfma_f32_16x16x32_bf16 v[152:155], a[64:67], a[40:43], v[152:155]
 s_add_u32 m0, s29, 94208
 v_mfma_f32_16x16x32_bf16 v[160:163], a[64:67], a[48:51], v[160:163]
 buffer_load_dwordx4 v2, s[8:11], s54 offen  lds
 v_mfma_f32_16x16x32_bf16 v[160:163], a[68:71], a[52:55], v[160:163]
 ds_read_b128 a[124:127], v5 offset:47104
 v_mfma_f32_16x16x32_bf16 v[164:167], a[76:79], a[52:55], v[164:167]
 v_mfma_f32_16x16x32_bf16 v[164:167], a[72:75], a[48:51], v[164:167]
 ds_read_b128 a[120:123], v4 offset:47104
 v_mfma_f32_16x16x32_bf16 v[168:171], a[80:83], a[48:51], v[168:171]
 s_add_u32 m0, s29, 28672
 v_mfma_f32_16x16x32_bf16 v[168:171], a[84:87], a[52:55], v[168:171]
 buffer_load_dwordx4 v1, s[4:7], s47 offen  lds
 v_mfma_f32_16x16x32_bf16 v[172:175], a[92:95], a[52:55], v[172:175]
 v_add_u32 v1, 128, v1
 v_add_u32 v2, 0x80000, v2
 v_mfma_f32_16x16x32_bf16 v[172:175], a[88:91], a[48:51], v[172:175]
 ds_read_b64_tr_b16 a[8:9], v7 offset:32768
 v_mfma_f32_16x16x32_bf16 v[180:183], a[88:91], a[56:59], v[180:183]
 buffer_load_dword a243, v14, s[36:39], s56 offen
 v_mfma_f32_16x16x32_bf16 v[180:183], a[92:95], a[60:63], v[180:183]
 s_add_u32 s56, s56, s30
 ds_read_b64_tr_b16 a[10:11], v7 offset:36864
 v_mfma_f32_16x16x32_bf16 v[176:179], a[84:87], a[60:63], v[176:179]
 ds_read_b64_tr_b16 a[12:13], v7 offset:49152
 v_mfma_f32_16x16x32_bf16 v[176:179], a[80:83], a[56:59], v[176:179]
 ds_read_b64_tr_b16 a[14:15], v7 offset:53248
 v_mfma_f32_16x16x32_bf16 v[188:191], a[72:75], a[56:59], v[188:191]
 ds_read_b64_tr_b16 a[16:17], v8 offset:32768
 v_mfma_f32_16x16x32_bf16 v[188:191], a[76:79], a[60:63], v[188:191]
 ds_read_b64_tr_b16 a[18:19], v8 offset:36864
 v_mfma_f32_16x16x32_bf16 v[184:187], a[68:71], a[60:63], v[184:187]
 ds_read_b64_tr_b16 a[20:21], v8 offset:49152
 v_mfma_f32_16x16x32_bf16 v[184:187], a[64:67], a[56:59], v[184:187]
 s_waitcnt lgkmcnt(8)
 ds_read_b64_tr_b16 a[22:23], v8 offset:53248
L_vloop_mid:
 v_mfma_f32_16x16x32_bf16 v[16:19], a[96:99], a[0:3], v[16:19]
 ds_read_b64_tr_b16 a[24:25], v9 offset:32768
 v_mfma_f32_16x16x32_bf16 v[16:19], a[100:103], a[4:7], v[16:19]
 ds_read_b64_tr_b16 a[26:27], v9 offset:36864
 v_mfma_f32_16x16x32_bf16 v[20:23], a[108:111], a[4:7], v[20:23]
 ds_read_b64_tr_b16 a[28:29], v9 offset:49152
 v_mfma_f32_16x16x32_bf16 v[20:23], a[104:107], a[0:3], v[20:23]
 ds_read_b64_tr_b16 a[30:31], v9 offset:53248
 v_mfma_f32_16x16x32_bf16 v[24:27], a[112:115], a[0:3], v[24:27]
 ds_read_b128 a[64:67], v4 offset:32768
 v_mfma_f32_16x16x32_bf16 v[24:27], a[116:119], a[4:7], v[24:27]
 v_mfma_f32_16x16x32_bf16 v[28:31], a[124:127], a[4:7], v[28:31]
 s_waitcnt lgkmcnt(8)
 ds_read_b128 a[68:71], v5 offset:32768
 v_mfma_f32_16x16x32_bf16 v[28:31], a[120:123], a[0:3], v[28:31]
 v_mfma_f32_16x16x32_bf16 a[228:231], a[120:123], a[8:11], a[228:231]
 ds_read_b128 a[76:79], v5 offset:34816
 v_mfma_f32_16x16x32_bf16 a[228:231], a[124:127], a[12:15], a[228:231]
 v_mfma_f32_16x16x32_bf16 a[224:227], a[116:119], a[12:15], a[224:227]
 ds_read_b128 a[72:75], v4 offset:34816
 v_mfma_f32_16x16x32_bf16 a[224:227], a[112:115], a[8:11], a[224:227]
 v_mfma_f32_16x16x32_bf16 a[236:239], a[104:107], a[8:11], a[236:239]
 ds_read_b128 a[80:83], v4 offset:36864
 v_mfma_f32_16x16x32_bf16 a[236:239], a[108:111], a[12:15], a[236:239]
 v_mfma_f32_16x16x32_bf16 a[232:235], a[100:103], a[12:15], a[232:235]
 ds_read_b128 a[84:87], v5 offset:36864
 v_mfma_f32_16x16x32_bf16 a[232:235], a[96:99], a[8:11], a[232:235]
 s_waitcnt lgkmcnt(8)
 v_mfma_f32_16x16x32_bf16 v[32:35], a[96:99], a[16:19], v[32:35]
 ds_read_b128 a[92:95], v5 offset:38912
 v_mfma_f32_16x16x32_bf16 v[32:35], a[100:103], a[20:23], v[32:35]
 v_mfma_f32_16x16x32_bf16 v[36:39], a[108:111], a[20:23], v[36:39]
 ds_read_b128 a[88:91], v4 offset:38912
 v_mfma_f32_16x16x32_bf16 v[36:39], a[104:107], a[16:19], v[36:39]
 v_mfma_f32_16x16x32_bf16 v[40:43], a[112:115], a[16:19], v[40:43]
 ds_read_b64_tr_b16 a[32:33], v10 offset:32768
 v_mfma_f32_16x16x32_bf16 v[40:43], a[116:119], a[20:23], v[40:43]
 ds_read_b64_tr_b16 a[34:35], v10 offset:36864
 v_mfma_f32_16x16x32_bf16 v[44:47], a[124:127], a[20:23], v[44:47]
 ds_read_b64_tr_b16 a[36:37], v10 offset:49152
 v_mfma_f32_16x16x32_bf16 v[44:47], a[120:123], a[16:19], v[44:47]
 ds_read_b64_tr_b16 a[38:39], v10 offset:53248
 v_mfma_f32_16x16x32_bf16 v[52:55], a[120:123], a[24:27], v[52:55]
 s_waitcnt lgkmcnt(8)
 ds_read_b64_tr_b16 a[40:41], v11 offset:32768
 v_mfma_f32_16x16x32_bf16 v[52:55], a[124:127], a[28:31], v[52:55]
 ds_read_b64_tr_b16 a[42:43], v11 offset:36864
 v_mfma_f32_16x16x32_bf16 v[48:51], a[116:119], a[28:31], v[48:51]
 ds_read_b64_tr_b16 a[44:45], v11 offset:49152
 v_mfma_f32_16x16x32_bf16 v[48:51], a[112:115], a[24:27], v[48:51]
 ds_read_b64_tr_b16 a[46:47], v11 offset:53248
 v_mfma_f32_16x16x32_bf16 v[60:63], a[104:107], a[24:27], v[60:63]
 ds_read_b64_tr_b16 a[48:49], v12 offset:32768
 v_mfma_f32_16x16x32_bf16 v[60:63], a[108:111], a[28:31], v[60:63]
 ds_read_b64_tr_b16 a[50:51], v12 offset:36864
 v_mfma_f32_16x16x32_bf16 v[56:59], a[100:103], a[28:31], v[56:59]
 ds_read_b64_tr_b16 a[52:53], v12 offset:49152
 v_mfma_f32_16x16x32_bf16 v[56:59], a[96:99], a[24:27], v[56:59]
 ds_read_b64_tr_b16 a[54:55], v12 offset:53248
 v_mfma_f32_16x16x32_bf16 v[64:67], a[64:67], a[0:3], v[64:67]
 ds_read_b64_tr_b16 a[56:57], v13 offset:32768
 v_mfma_f32_16x16x32_bf16 v[64:67], a[68:71], a[4:7], v[64:67]
 ds_read_b64_tr_b16 a[58:59], v13 offset:36864
 v_mfma_f32_16x16x32_bf16 v[68:71], a[76:79], a[4:7], v[68:71]
 ds_read_b64_tr_b16 a[60:61], v13 offset:49152
 v_mfma_f32_16x16x32_bf16 v[68:71], a[72:75], a[0:3], v[68:71]
 s_waitcnt lgkmcnt(8)
 ds_read_b64_tr_b16 a[62:63], v13 offset:53248
 v_mfma_f32_16x16x32_bf16 v[72:75], a[80:83], a[0:3], v[72:75]
 v_mfma_f32_16x16x32_bf16 v[72:75], a[84:87], a[4:7], v[72:75]
 v_mfma_f32_16x16x32_bf16 v[76:79], a[92:95], a[4:7], v[76:79]
 v_mfma_f32_16x16x32_bf16 v[76:79], a[88:91], a[0:3], v[76:79]
 s_waitcnt lgkmcnt(0)
 v_mfma_f32_16x16x32_bf16 v[84:87], a[88:91], a[8:11], v[84:87]
 s_barrier
 v_mfma_f32_16x16x32_bf16 v[84:87], a[92:95], a[12:15], v[84:87]
 s_add_u32 m0, s29, 98304
 v_mfma_f32_16x16x32_bf16 v[80:83], a[84:87], a[12:15], v[80:83]
 buffer_load_dwordx4 v2, s[8:11], 0 offen  lds
 v_mfma_f32_16x16x32_bf16 v[80:83], a[80:83], a[8:11], v[80:83]
 v_mfma_f32_16x16x32_bf16 v[92:95], a[72:75], a[8:11], v[92:95]
 v_mfma_f32_16x16x32_bf16 v[92:95], a[76:79], a[12:15], v[92:95]
 v_mfma_f32_16x16x32_bf16 v[88:91], a[68:71], a[12:15], v[88:91]
 s_add_u32 m0, s29, 32768
 v_mfma_f32_16x16x32_bf16 v[88:91], a[64:67], a[8:11], v[88:91]
 buffer_load_dwordx4 v1, s[4:7], 0 offen  lds
 v_mfma_f32_16x16x32_bf16 v[96:99], a[64:67], a[16:19], v[96:99]
 v_mfma_f32_16x16x32_bf16 v[96:99], a[68:71], a[20:23], v[96:99]
 v_mfma_f32_16x16x32_bf16 v[100:103], a[76:79], a[20:23], v[100:103]
 v_mfma_f32_16x16x32_bf16 v[100:103], a[72:75], a[16:19], v[100:103]
 s_add_u32 m0, s29, 102400
 v_mfma_f32_16x16x32_bf16 v[104:107], a[80:83], a[16:19], v[104:107]
 buffer_load_dwordx4 v2, s[8:11], s48 offen  lds
 v_mfma_f32_16x16x32_bf16 v[104:107], a[84:87], a[20:23], v[104:107]
 v_mfma_f32_16x16x32_bf16 v[108:111], a[92:95], a[20:23], v[108:111]
 v_mfma_f32_16x16x32_bf16 v[108:111], a[88:91], a[16:19], v[108:111]
 v_mfma_f32_16x16x32_bf16 v[116:119], a[88:91], a[24:27], v[116:119]
 s_add_u32 m0, s29, 36864
 v_mfma_f32_16x16x32_bf16 v[116:119], a[92:95], a[28:31], v[116:119]
 buffer_load_dwordx4 v1, s[4:7], s41 offen  lds
 v_mfma_f32_16x16x32_bf16 v[112:115], a[84:87], a[28:31], v[112:115]
 v_mfma_f32_16x16x32_bf16 v[112:115], a[80:83], a[24:27], v[112:115]
 v_mfma_f32_16x16x32_bf16 v[124:127], a[72:75], a[24:27], v[124:127]
 v_mfma_f32_16x16x32_bf16 v[124:127], a[76:79], a[28:31], v[124:127]
 s_add_u32 m0, s29, 106496
 v_mfma_f32_16x16x32_bf16 v[120:123], a[68:71], a[28:31], v[120:123]
 buffer_load_dwordx4 v2, s[8:11], s49 offen  lds
 v_mfma_f32_16x16x32_bf16 v[120:123], a[64:67], a[24:27], v[120:123]
 v_mfma_f32_16x16x32_bf16 v[128:131], a[64:67], a[32:35], v[128:131]
 v_mfma_f32_16x16x32_bf16 v[128:131], a[68:71], a[36:39], v[128:131]
 v_mfma_f32_16x16x32_bf16 v[132:135], a[76:79], a[36:39], v[132:135]
 s_add_u32 m0, s29, 40960
 v_mfma_f32_16x16x32_bf16 v[132:135], a[72:75], a[32:35], v[132:135]
 buffer_load_dwordx4 v1, s[4:7], s42 offen  lds
 v_mfma_f32_16x16x32_bf16 v[136:139], a[80:83], a[32:35], v[136:139]
 v_mfma_f32_16x16x32_bf16 v[136:139], a[84:87], a[36:39], v[136:139]
 v_mfma_f32_16x16x32_bf16 v[140:143], a[92:95], a[36:39], v[140:143]
 v_mfma_f32_16x16x32_bf16 v[140:143], a[88:91], a[32:35], v[140:143]
 s_add_u32 m0, s29, 110592
 v_mfma_f32_16x16x32_bf16 v[148:151], a[88:91], a[40:43], v[148:151]
 buffer_load_dwordx4 v2, s[8:11], s50 offen  lds
 v_mfma_f32_16x16x32_bf16 v[148:151], a[92:95], a[44:47], v[148:151]
 v_mfma_f32_16x16x32_bf16 v[144:147], a[84:87], a[44:47], v[144:147]
 v_mfma_f32_16x16x32_bf16 v[144:147], a[80:83], a[40:43], v[144:147]
 v_mfma_f32_16x16x32_bf16 v[156:159], a[72:75], a[40:43], v[156:159]
 s_add_u32 m0, s29, 45056
 v_mfma_f32_16x16x32_bf16 v[156:159], a[76:79], a[44:47], v[156:159]
 buffer_load_dwordx4 v1, s[4:7], s43 offen  lds
 v_mfma_f32_16x16x32_bf16 v[152:155], a[68:71], a[44:47], v[152:155]
 v_mfma_f32_16x16x32_bf16 v[152:155], a[64:67], a[40:43], v[152:155]
 v_mfma_f32_16x16x32_bf16 v[160:163], a[64:67], a[48:51], v[160:163]
 v_mfma_f32_16x16x32_bf16 v[160:163], a[68:71], a[52:55], v[160:163]
 s_add_u32 m0, s29, 114688
 v_mfma_f32_16x16x32_bf16 v[164:167], a[76:79], a[52:55], v[164:167]
 buffer_load_dwordx4 v2, s[8:11], s51 offen  lds
 v_mfma_f32_16x16x32_bf16 v[164:167], a[72:75], a[48:51], v[164:167]
 v_mfma_f32_16x16x32_bf16 v[168:171], a[80:83], a[48:51], v[168:171]
 v_mfma_f32_16x16x32_bf16 v[168:171], a[84:87], a[52:55], v[168:171]
 v_mfma_f32_16x16x32_bf16 v[172:175], a[92:95], a[52:55], v[172:175]
 s_add_u32 m0, s29, 49152
 v_mfma_f32_16x16x32_bf16 v[172:175], a[88:91], a[48:51], v[172:175]
 buffer_load_dwordx4 v1, s[4:7], s44 offen  lds
 v_mfma_f32_16x16x32_bf16 v[180:183], a[88:91], a[56:59], v[180:183]
 v_mfma_f32_16x16x32_bf16 v[180:183], a[92:95], a[60:63], v[180:183]
 v_mfma_f32_16x16x32_bf16 v[176:179], a[84:87], a[60:63], v[176:179]
 v_mfma_f32_16x16x32_bf16 v[176:179], a[80:83], a[56:59], v[176:179]
 s_add_u32 m0, s29, 118784
 v_mfma_f32_16x16x32_bf16 v[188:191], a[72:75], a[56:59], v[188:191]
 s_waitcnt vmcnt(11)
 buffer_load_dwordx4 v2, s[8:11], s52 offen  lds
 v_mfma_f32_16x16x32_bf16 v[188:191], a[76:79], a[60:63], v[188:191]
 s_barrier
 ds_read_b64_tr_b16 a[0:1], v6 offset:0
 v_mfma_f32_16x16x32_bf16 v[184:187], a[68:71], a[60:63], v[184:187]
 ds_read_b64_tr_b16 a[2:3], v6 offset:4096
 v_mfma_f32_16x16x32_bf16 v[184:187], a[64:67], a[56:59], v[184:187]
 ds_read_b128 a[64:67], v4 offset:0
 v_mfma_f32_16x16x32_bf16 v[192:195], a[96:99], a[32:35], v[192:195]
 s_add_u32 m0, s29, 53248
 v_mfma_f32_16x16x32_bf16 v[192:195], a[100:103], a[36:39], v[192:195]
 buffer_load_dwordx4 v1, s[4:7], s45 offen  lds
 v_mfma_f32_16x16x32_bf16 v[196:199], a[108:111], a[36:39], v[196:199]
 ds_read_b64_tr_b16 a[4:5], v6 offset:16384
 v_mfma_f32_16x16x32_bf16 v[196:199], a[104:107], a[32:35], v[196:199]
 ds_read_b64_tr_b16 a[6:7], v6 offset:20480
 v_mfma_f32_16x16x32_bf16 v[200:203], a[112:115], a[32:35], v[200:203]
 ds_read_b128 a[68:71], v5 offset:0
 v_mfma_f32_16x16x32_bf16 v[200:203], a[116:119], a[36:39], v[200:203]
 s_add_u32 m0, s29, 122880
 v_mfma_f32_16x16x32_bf16 v[204:207], a[124:127], a[36:39], v[204:207]
 buffer_load_dwordx4 v2, s[8:11], s53 offen  lds
 v_mfma_f32_16x16x32_bf16 v[204:207], a[120:123], a[32:35], v[204:207]
 ds_read_b128 a[76:79], v5 offset:2048
 v_mfma_f32_16x16x32_bf16 v[212:215], a[120:123], a[40:43], v[212:215]
 v_mfma_f32_16x16x32_bf16 v[212:215], a[124:127], a[44:47], v[212:215]
 ds_read_b128 a[72:75], v4 offset:2048
 v_mfma_f32_16x16x32_bf16 v[208:211], a[116:119], a[44:47], v[208:211]
 s_add_u32 m0, s29, 57344
 v_mfma_f32_16x16x32_bf16 v[208:211], a[112:115], a[40:43], v[208:211]
 buffer_load_dwordx4 v1, s[4:7], s46 offen  lds
 v_mfma_f32_16x16x32_bf16 v[220:223], a[104:107], a[40:43], v[220:223]
 ds_read_b128 a[80:83], v4 offset:4096
 v_mfma_f32_16x16x32_bf16 v[220:223], a[108:111], a[44:47], v[220:223]
 v_mfma_f32_16x16x32_bf16 v[216:219], a[100:103], a[44:47], v[216:219]
 ds_read_b128 a[84:87], v5 offset:4096
 v_mfma_f32_16x16x32_bf16 v[216:219], a[96:99], a[40:43], v[216:219]
 s_add_u32 m0, s29, 126976
 v_mfma_f32_16x16x32_bf16 v[224:227], a[96:99], a[48:51], v[224:227]
 buffer_load_dwordx4 v2, s[8:11], s54 offen  lds
 v_mfma_f32_16x16x32_bf16 v[224:227], a[100:103], a[52:55], v[224:227]
 ds_read_b128 a[92:95], v5 offset:6144
 v_mfma_f32_16x16x32_bf16 v[228:231], a[108:111], a[52:55], v[228:231]
 v_mfma_f32_16x16x32_bf16 v[228:231], a[104:107], a[48:51], v[228:231]
 ds_read_b128 a[88:91], v4 offset:6144
 v_mfma_f32_16x16x32_bf16 v[232:235], a[112:115], a[48:51], v[232:235]
 s_add_u32 m0, s29, 61440
 v_mfma_f32_16x16x32_bf16 v[232:235], a[116:119], a[52:55], v[232:235]
 buffer_load_dwordx4 v1, s[4:7], s47 offen  lds
 v_mfma_f32_16x16x32_bf16 v[236:239], a[124:127], a[52:55], v[236:239]
 v_add_u32 v1, 128, v1
 v_add_u32 v2, 0x80000, v2
 v_mfma_f32_16x16x32_bf16 v[236:239], a[120:123], a[48:51], v[236:239]
 ds_read_b64_tr_b16 a[8:9], v7 offset:0
 v_mfma_f32_16x16x32_bf16 v[244:247], a[120:123], a[56:59], v[244:247]
 buffer_load_dword a243, v14, s[36:39], s56 offen
 v_mfma_f32_16x16x32_bf16 v[244:247], a[124:127], a[60:63], v[244:247]
 s_add_u32 s56, s56, s30
 ds_read_b64_tr_b16 a[10:11], v7 offset:4096
 v_mfma_f32_16x16x32_bf16 v[240:243], a[116:119], a[60:63], v[240:243]
 ds_read_b64_tr_b16 a[12:13], v7 offset:16384
 v_mfma_f32_16x16x32_bf16 v[240:243], a[112:115], a[56:59], v[240:243]
 ds_read_b64_tr_b16 a[14:15], v7 offset:20480
 v_mfma_f32_16x16x32_bf16 v[252:255], a[104:107], a[56:59], v[252:255]
 ds_read_b64_tr_b16 a[16:17], v8 offset:0
 v_mfma_f32_16x16x32_bf16 v[252:255], a[108:111], a[60:63], v[252:255]
 s_add_u32 s61, s61, 1
 ds_read_b64_tr_b16 a[18:19], v8 offset:4096
 v_mfma_f32_16x16x32_bf16 v[248:251], a[100:103], a[60:63], v[248:251]
 s_cmp_lt_u32 s61, s55
 ds_read_b64_tr_b16 a[20:21], v8 offset:16384
 v_mfma_f32_16x16x32_bf16 v[248:251], a[96:99], a[56:59], v[248:251]
 s_waitcnt lgkmcnt(8)
 ds_read_b64_tr_b16 a[22:23], v8 offset:20480
 s_cbranch_scc1 L_vloop
 s_cmp_lt_u32 s61, 6
 s_cbranch_scc1 L_vloop_side
 v_mfma_f32_16x16x32_bf16 v[64:67], a[64:67], a[0:3], v[64:67]
 ds_read_b64_tr_b16 a[24:25], v9 offset:0
 v_accvgpr_read_b32 v15, a240
 v_mfma_f32_16x16x32_bf16 v[64:67], a[68:71], a[4:7], v[64:67]
 ds_read_b64_tr_b16 a[26:27], v9 offset:4096
 v_accvgpr_read_b32 v14, a242
 v_mfma_f32_16x16x32_bf16 v[68:71], a[76:79], a[4:7], v[68:71]
 s_waitcnt lgkmcnt(12)
 ds_read_b64_tr_b16 a[28:29], v9 offset:16384
 v_xor_b32 v3, 64, v14
 v_mfma_f32_16x16x32_bf16 v[68:71], a[72:75], a[0:3], v[68:71]
 ds_read_b64_tr_b16 a[30:31], v9 offset:20480
 v_mfma_f32_16x16x32_bf16 v[72:75], a[80:83], a[0:3], v[72:75]
 s_add_u32 m0, s33, 0x0
 ds_read_b128 a[96:99], v4 offset:8192
 v_mfma_f32_16x16x32_bf16 v[72:75], a[84:87], a[4:7], v[72:75]
 s_waitcnt lgkmcnt(11)
 v_mfma_f32_16x16x32_bf16 v[76:79], a[92:95], a[4:7], v[76:79]
 ds_read_b128 a[100:103], v5 offset:8192
 buffer_load_dwordx4 v15, s[20:23], 0 offen offset:0 lds
 v_mfma_f32_16x16x32_bf16 v[76:79], a[88:91], a[0:3], v[76:79]
 v_mfma_f32_16x16x32_bf16 v[84:87], a[88:91], a[8:11], v[84:87]
 s_waitcnt lgkmcnt(10)
 ds_read_b128 a[108:111], v5 offset:10240
 v_mfma_f32_16x16x32_bf16 v[84:87], a[92:95], a[12:15], v[84:87]
 s_add_u32 m0, s33, 0x80
 v_mfma_f32_16x16x32_bf16 v[80:83], a[84:87], a[12:15], v[80:83]
 ds_read_b128 a[104:107], v4 offset:10240
 buffer_load_dwordx4 v15, s[20:23], 0 offen offset:896 lds
 v_mfma_f32_16x16x32_bf16 v[80:83], a[80:83], a[8:11], v[80:83]
 v_mfma_f32_16x16x32_bf16 v[92:95], a[72:75], a[8:11], v[92:95]
 ds_read_b128 a[112:115], v4 offset:12288
 v_mfma_f32_16x16x32_bf16 v[92:95], a[76:79], a[12:15], v[92:95]
 s_add_u32 m0, s33, 0x800
 v_mfma_f32_16x16x32_bf16 v[88:91], a[68:71], a[12:15], v[88:91]
 ds_read_b128 a[116:119], v5 offset:12288
 buffer_load_dwordx4 v15, s[20:23], s57 offen offset:0 lds
 v_mfma_f32_16x16x32_bf16 v[88:91], a[64:67], a[8:11], v[88:91]
 s_waitcnt lgkmcnt(10)
 v_mfma_f32_16x16x32_bf16 v[96:99], a[64:67], a[16:19], v[96:99]
 ds_read_b128 a[124:127], v5 offset:14336
 v_mfma_f32_16x16x32_bf16 v[96:99], a[68:71], a[20:23], v[96:99]
 s_add_u32 m0, s33, 0x880
 v_mfma_f32_16x16x32_bf16 v[100:103], a[76:79], a[20:23], v[100:103]
 ds_read_b128 a[120:123], v4 offset:14336
 buffer_load_dwordx4 v15, s[20:23], s57 offen offset:896 lds
 v_mfma_f32_16x16x32_bf16 v[100:103], a[72:75], a[16:19], v[100:103]
 v_mfma_f32_16x16x32_bf16 v[104:107], a[80:83], a[16:19], v[104:107]
 ds_read_b64_tr_b16 a[32:33], v10 offset:0
 v_mfma_f32_16x16x32_bf16 v[104:107], a[84:87], a[20:23], v[104:107]
 s_add_u32 m0, s33, 0xf80
 ds_read_b64_tr_b16 a[34:35], v10 offset:4096
 v_mfma_f32_16x16x32_bf16 v[108:111], a[92:95], a[20:23], v[108:111]
 ds_read_b64_tr_b16 a[36:37], v10 offset:16384
 buffer_load_dwordx4 v15, s[20:23], 0 offen offset:128 lds
 v_mfma_f32_16x16x32_bf16 v[108:111], a[88:91], a[16:19], v[108:111]
 s_waitcnt lgkmcnt(11)
 ds_read_b64_tr_b16 a[38:39], v10 offset:20480
 v_mfma_f32_16x16x32_bf16 v[116:119], a[88:91], a[24:27], v[116:119]
 ds_read_b64_tr_b16 a[40:41], v11 offset:0
 v_mfma_f32_16x16x32_bf16 v[116:119], a[92:95], a[28:31], v[116:119]
 s_add_u32 m0, s33, 0x1000
 ds_read_b64_tr_b16 a[42:43], v11 offset:4096
 v_mfma_f32_16x16x32_bf16 v[112:115], a[84:87], a[28:31], v[112:115]
 ds_read_b64_tr_b16 a[44:45], v11 offset:16384
 buffer_load_dwordx4 v15, s[20:23], 0 offen offset:1024 lds
 v_mfma_f32_16x16x32_bf16 v[112:115], a[80:83], a[24:27], v[112:115]
 ds_read_b64_tr_b16 a[46:47], v11 offset:20480
 v_mfma_f32_16x16x32_bf16 v[124:127], a[72:75], a[24:27], v[124:127]
 ds_read_b64_tr_b16 a[48:49], v12 offset:0
 v_mfma_f32_16x16x32_bf16 v[124:127], a[76:79], a[28:31], v[124:127]
 s_add_u32 m0, s33, 0x1780
 ds_read_b64_tr_b16 a[50:51], v12 offset:4096
 v_mfma_f32_16x16x32_bf16 v[120:123], a[68:71], a[28:31], v[120:123]
 ds_read_b64_tr_b16 a[52:53], v12 offset:16384
 buffer_load_dwordx4 v15, s[20:23], s57 offen offset:128 lds
 v_mfma_f32_16x16x32_bf16 v[120:123], a[64:67], a[24:27], v[120:123]
 s_waitcnt lgkmcnt(15)
 ds_read_b64_tr_b16 a[54:55], v12 offset:20480
 v_mfma_f32_16x16x32_bf16 v[16:19], a[96:99], a[0:3], v[16:19]
 ds_read_b64_tr_b16 a[56:57], v13 offset:0
 v_mfma_f32_16x16x32_bf16 v[16:19], a[100:103], a[4:7], v[16:19]
 s_add_u32 m0, s33, 0x1800
 ds_read_b64_tr_b16 a[58:59], v13 offset:4096
 v_mfma_f32_16x16x32_bf16 v[20:23], a[108:111], a[4:7], v[20:23]
 ds_read_b64_tr_b16 a[60:61], v13 offset:16384
 buffer_load_dwordx4 v15, s[20:23], s57 offen offset:1024 lds
 v_mfma_f32_16x16x32_bf16 v[20:23], a[104:107], a[0:3], v[20:23]
 s_waitcnt lgkmcnt(15)
 ds_read_b64_tr_b16 a[62:63], v13 offset:20480
 v_mfma_f32_16x16x32_bf16 v[24:27], a[112:115], a[0:3], v[24:27]
 v_mfma_f32_16x16x32_bf16 v[24:27], a[116:119], a[4:7], v[24:27]
 v_mfma_f32_16x16x32_bf16 v[28:31], a[124:127], a[4:7], v[28:31]
 v_mfma_f32_16x16x32_bf16 v[28:31], a[120:123], a[0:3], v[28:31]
 s_waitcnt lgkmcnt(0)
 v_mfma_f32_16x16x32_bf16 a[228:231], a[120:123], a[8:11], a[228:231]
 s_barrier
 v_mfma_f32_16x16x32_bf16 a[228:231], a[124:127], a[12:15], a[228:231]
 s_add_u32 m0, s29, 65536
 v_mfma_f32_16x16x32_bf16 a[224:227], a[116:119], a[12:15], a[224:227]
 buffer_load_dwordx4 v2, s[8:11], 0 offen  lds
 v_mfma_f32_16x16x32_bf16 a[224:227], a[112:115], a[8:11], a[224:227]
 v_mfma_f32_16x16x32_bf16 a[236:239], a[104:107], a[8:11], a[236:239]
 v_mfma_f32_16x16x32_bf16 a[236:239], a[108:111], a[12:15], a[236:239]
 v_mfma_f32_16x16x32_bf16 a[232:235], a[100:103], a[12:15], a[232:235]
 s_add_u32 m0, s29, 0
 v_mfma_f32_16x16x32_bf16 a[232:235], a[96:99], a[8:11], a[232:235]
 buffer_load_dwordx4 v1, s[4:7], 0 offen  lds
 v_mfma_f32_16x16x32_bf16 v[32:35], a[96:99], a[16:19], v[32:35]
 v_mfma_f32_16x16x32_bf16 v[32:35], a[100:103], a[20:23], v[32:35]
 v_mfma_f32_16x16x32_bf16 v[36:39], a[108:111], a[20:23], v[36:39]
 v_mfma_f32_16x16x32_bf16 v[36:39], a[104:107], a[16:19], v[36:39]
 s_add_u32 m0, s29, 69632
 v_mfma_f32_16x16x32_bf16 v[40:43], a[112:115], a[16:19], v[40:43]
 buffer_load_dwordx4 v2, s[8:11], s48 offen  lds
 v_mfma_f32_16x16x32_bf16 v[40:43], a[116:119], a[20:23], v[40:43]
 v_mfma_f32_16x16x32_bf16 v[44:47], a[124:127], a[20:23], v[44:47]
 v_mfma_f32_16x16x32_bf16 v[44:47], a[120:123], a[16:19], v[44:47]
 v_mfma_f32_16x16x32_bf16 v[52:55], a[120:123], a[24:27], v[52:55]
 s_add_u32 m0, s29, 4096
 v_mfma_f32_16x16x32_bf16 v[52:55], a[124:127], a[28:31], v[52:55]
 buffer_load_dwordx4 v1, s[4:7], s41 offen  lds
 v_mfma_f32_16x16x32_bf16 v[48:51], a[116:119], a[28:31], v[48:51]
 v_mfma_f32_16x16x32_bf16 v[48:51], a[112:115], a[24:27], v[48:51]
 v_mfma_f32_16x16x32_bf16 v[60:63], a[104:107], a[24:27], v[60:63]
 v_mfma_f32_16x16x32_bf16 v[60:63], a[108:111], a[28:31], v[60:63]
 s_add_u32 m0, s29, 73728
 v_mfma_f32_16x16x32_bf16 v[56:59], a[100:103], a[28:31], v[56:59]
 buffer_load_dwordx4 v2, s[8:11], s49 offen  lds
 v_mfma_f32_16x16x32_bf16 v[56:59], a[96:99], a[24:27], v[56:59]
 v_mfma_f32_16x16x32_bf16 v[192:195], a[96:99], a[32:35], v[192:195]
 v_mfma_f32_16x16x32_bf16 v[192:195], a[100:103], a[36:39], v[192:195]
 v_mfma_f32_16x16x32_bf16 v[196:199], a[108:111], a[36:39], v[196:199]
 s_add_u32 m0, s29, 8192
 v_mfma_f32_16x16x32_bf16 v[196:199], a[104:107], a[32:35], v[196:199]
 buffer_load_dwordx4 v1, s[4:7], s42 offen  lds
 v_mfma_f32_16x16x32_bf16 v[200:203], a[112:115], a[32:35], v[200:203]
 v_mfma_f32_16x16x32_bf16 v[200:203], a[116:119], a[36:39], v[200:203]
 v_mfma_f32_16x16x32_bf16 v[204:207], a[124:127], a[36:39], v[204:207]
 v_mfma_f32_16x16x32_bf16 v[204:207], a[120:123], a[32:35], v[204:207]
 s_add_u32 m0, s29, 77824
 v_mfma_f32_16x16x32_bf16 v[212:215], a[120:123], a[40:43], v[212:215]
 buffer_load_dwordx4 v2, s[8:11], s50 offen  lds
 v_mfma_f32_16x16x32_bf16 v[212:215], a[124:127], a[44:47], v[212:215]
 v_mfma_f32_16x16x32_bf16 v[208:211], a[116:119], a[44:47], v[208:211]
 v_mfma_f32_16x16x32_bf16 v[208:211], a[112:115], a[40:43], v[208:211]
 v_mfma_f32_16x16x32_bf16 v[220:223], a[104:107], a[40:43], v[220:223]
 s_add_u32 m0, s29, 12288
 v_mfma_f32_16x16x32_bf16 v[220:223], a[108:111], a[44:47], v[220:223]
 buffer_load_dwordx4 v1, s[4:7], s43 offen  lds
 v_mfma_f32_16x16x32_bf16 v[216:219], a[100:103], a[44:47], v[216:219]
 v_mfma_f32_16x16x32_bf16 v[216:219], a[96:99], a[40:43], v[216:219]
 v_mfma_f32_16x16x32_bf16 v[224:227], a[96:99], a[48:51], v[224:227]
 v_mfma_f32_16x16x32_bf16 v[224:227], a[100:103], a[52:55], v[224:227]
 s_add_u32 m0, s29, 81920
 v_mfma_f32_16x16x32_bf16 v[228:231], a[108:111], a[52:55], v[228:231]
 buffer_load_dwordx4 v2, s[8:11], s51 offen  lds
 v_mfma_f32_16x16x32_bf16 v[228:231], a[104:107], a[48:51], v[228:231]
 v_mfma_f32_16x16x32_bf16 v[232:235], a[112:115], a[48:51], v[232:235]
 v_mfma_f32_16x16x32_bf16 v[232:235], a[116:119], a[52:55], v[232:235]
 v_mfma_f32_16x16x32_bf16 v[236:239], a[124:127], a[52:55], v[236:239]
 s_add_u32 m0, s29, 16384
 v_mfma_f32_16x16x32_bf16 v[236:239], a[120:123], a[48:51], v[236:239]
 buffer_load_dwordx4 v1, s[4:7], s44 offen  lds
 v_mfma_f32_16x16x32_bf16 v[244:247], a[120:123], a[56:59], v[244:247]
 v_mfma_f32_16x16x32_bf16 v[244:247], a[124:127], a[60:63], v[244:247]
 v_mfma_f32_16x16x32_bf16 v[240:243], a[116:119], a[60:63], v[240:243]
 v_mfma_f32_16x16x32_bf16 v[240:243], a[112:115], a[56:59], v[240:243]
 s_add_u32 m0, s29, 86016
 v_mfma_f32_16x16x32_bf16 v[252:255], a[104:107], a[56:59], v[252:255]
 s_waitcnt vmcnt(10)
 buffer_load_dwordx4 v2, s[8:11], s52 offen  lds
 v_mfma_f32_16x16x32_bf16 v[252:255], a[108:111], a[60:63], v[252:255]
 s_barrier
 ds_read_b64_tr_b16 a[0:1], v6 offset:32768
 v_mfma_f32_16x16x32_bf16 v[248:251], a[100:103], a[60:63], v[248:251]
 ds_read_b64_tr_b16 a[2:3], v6 offset:36864
 v_mfma_f32_16x16x32_bf16 v[248:251], a[96:99], a[56:59], v[248:251]
 ds_read_b128 a[96:99], v4 offset:40960
 v_mfma_f32_16x16x32_bf16 v[128:131], a[64:67], a[32:35], v[128:131]
 s_add_u32 m0, s29, 20480
 ds_read_b128 a[128:131], v14 offset:0
 v_mfma_f32_16x16x32_bf16 v[128:131], a[68:71], a[36:39], v[128:131]
 buffer_load_dwordx4 v1, s[4:7], s45 offen  lds
 v_mfma_f32_16x16x32_bf16 v[132:135], a[76:79], a[36:39], v[132:135]
 ds_read_b64_tr_b16 a[4:5], v6 offset:49152
 v_mfma_f32_16x16x32_bf16 v[132:135], a[72:75], a[32:35], v[132:135]
 ds_read_b64_tr_b16 a[6:7], v6 offset:53248
 v_mfma_f32_16x16x32_bf16 v[136:139], a[80:83], a[32:35], v[136:139]
 ds_read_b128 a[100:103], v5 offset:40960
 v_mfma_f32_16x16x32_bf16 v[136:139], a[84:87], a[36:39], v[136:139]
 s_add_u32 m0, s29, 90112
 ds_read_b128 a[136:139], v3 offset:0
 v_mfma_f32_16x16x32_bf16 v[140:143], a[92:95], a[36:39], v[140:143]
 buffer_load_dwordx4 v2, s[8:11], s53 offen  lds
 v_mfma_f32_16x16x32_bf16 v[140:143], a[88:91], a[32:35], v[140:143]
 ds_read_b128 a[108:111], v5 offset:43008
 v_mfma_f32_16x16x32_bf16 v[148:151], a[88:91], a[40:43], v[148:151]
 ds_read_b128 a[132:135], v14 offset:2048
 v_mfma_f32_16x16x32_bf16 v[148:151], a[92:95], a[44:47], v[148:151]
 ds_read_b128 a[104:107], v4 offset:43008
 v_mfma_f32_16x16x32_bf16 v[144:147], a[84:87], a[44:47], v[144:147]
 s_add_u32 m0, s29, 24576
 ds_read_b128 a[140:143], v3 offset:2048
 v_mfma_f32_16x16x32_bf16 v[144:147], a[80:83], a[40:43], v[144:147]
 buffer_load_dwordx4 v1, s[4:7], s46 offen  lds
 v_mfma_f32_16x16x32_bf16 v[156:159], a[72:75], a[40:43], v[156:159]
 ds_read_b128 a[112:115], v4 offset:45056
 v_mfma_f32_16x16x32_bf16 v[156:159], a[76:79], a[44:47], v[156:159]
 ds_read_b128 a[144:147], v14 offset:4096
 v_mfma_f32_16x16x32_bf16 v[152:155], a[68:71], a[44:47], v[152:155]
 ds_read_b128 a[116:119], v5 offset:45056
 v_mfma_f32_16x16x32_bf16 v[152:155], a[64:67], a[40:43], v[152:155]
 s_add_u32 m0, s29, 94208
 ds_read_b128 a[152:155], v3 offset:4096
 v_mfma_f32_16x16x32_bf16 v[160:163], a[64:67], a[48:51], v[160:163]
 buffer_load_dwordx4 v2, s[8:11], s54 offen  lds
 v_mfma_f32_16x16x32_bf16 v[160:163], a[68:71], a[52:55], v[160:163]
 ds_read_b128 a[124:127], v5 offset:47104
 v_mfma_f32_16x16x32_bf16 v[164:167], a[76:79], a[52:55], v[164:167]
 ds_read_b128 a[148:151], v14 offset:6144
 v_mfma_f32_16x16x32_bf16 v[164:167], a[72:75], a[48:51], v[164:167]
 ds_read_b128 a[120:123], v4 offset:47104
 v_mfma_f32_16x16x32_bf16 v[168:171], a[80:83], a[48:51], v[168:171]
 s_add_u32 m0, s29, 28672
 ds_read_b128 a[156:159], v3 offset:6144
 v_mfma_f32_16x16x32_bf16 v[168:171], a[84:87], a[52:55], v[168:171]
 buffer_load_dwordx4 v1, s[4:7], s47 offen  lds
 v_mfma_f32_16x16x32_bf16 v[172:175], a[92:95], a[52:55], v[172:175]
 v_add_u32 v1, 128, v1
 v_add_u32 v2, 0x80000, v2
 v_mfma_f32_16x16x32_bf16 v[172:175], a[88:91], a[48:51], v[172:175]
 ds_read_b64_tr_b16 a[8:9], v7 offset:32768
 v_mfma_f32_16x16x32_bf16 v[180:183], a[88:91], a[56:59], v[180:183]
 v_mfma_f32_16x16x32_bf16 v[180:183], a[92:95], a[60:63], v[180:183]
 ds_read_b64_tr_b16 a[10:11], v7 offset:36864
 v_mfma_f32_16x16x32_bf16 v[176:179], a[84:87], a[60:63], v[176:179]
 ds_read_b64_tr_b16 a[12:13], v7 offset:49152
 v_mfma_f32_16x16x32_bf16 v[176:179], a[80:83], a[56:59], v[176:179]
 ds_read_b64_tr_b16 a[14:15], v7 offset:53248
 v_mfma_f32_16x16x32_bf16 v[188:191], a[72:75], a[56:59], v[188:191]
 ds_read_b64_tr_b16 a[16:17], v8 offset:32768
 v_mfma_f32_16x16x32_bf16 v[188:191], a[76:79], a[60:63], v[188:191]
 ds_read_b64_tr_b16 a[18:19], v8 offset:36864
 v_mfma_f32_16x16x32_bf16 v[184:187], a[68:71], a[60:63], v[184:187]
 ds_read_b64_tr_b16 a[20:21], v8 offset:49152
 v_mfma_f32_16x16x32_bf16 v[184:187], a[64:67], a[56:59], v[184:187]
 s_waitcnt lgkmcnt(15)
 ds_read_b64_tr_b16 a[22:23], v8 offset:53248
 v_mfma_f32_16x16x32_bf16 v[16:19], a[96:99], a[0:3], v[16:19]
 ds_read_b64_tr_b16 a[24:25], v9 offset:32768
 v_mfma_f32_16x16x32_bf16 v[16:19], a[100:103], a[4:7], v[16:19]
 s_add_u32 m0, s33, 0xffffff00
 ds_read_b64_tr_b16 a[26:27], v9 offset:36864
 v_mfma_f32_16x16x32_bf16 v[20:23], a[108:111], a[4:7], v[20:23]
 s_waitcnt lgkmcnt(10)
 ds_read_b64_tr_b16 a[28:29], v9 offset:49152
 v_mfma_f32_16x16x32_bf16 v[20:23], a[104:107], a[0:3], v[20:23]
 ds_read_b64_tr_b16 a[30:31], v9 offset:53248
 buffer_load_dwordx4 v15, s[20:23], 0 offen offset:256 lds
 v_mfma_f32_16x16x32_bf16 v[24:27], a[112:115], a[0:3], v[24:27]
 ds_read_b128 a[64:67], v4 offset:32768
 v_mfma_f32_16x16x32_bf16 v[24:27], a[116:119], a[4:7], v[24:27]
 v_mfma_f32_16x16x32_bf16 v[28:31], a[124:127], a[4:7], v[28:31]
 s_add_u32 m0, s33, 0xffffff80
 ds_read_b128 a[68:71], v5 offset:32768
 v_mfma_f32_16x16x32_bf16 v[28:31], a[120:123], a[0:3], v[28:31]
 s_waitcnt lgkmcnt(10)
 buffer_load_dwordx4 v15, s[20:23], 0 offen offset:1152 lds
 v_mfma_f32_16x16x32_bf16 a[228:231], a[120:123], a[8:11], a[228:231]
 ds_read_b128 a[76:79], v5 offset:34816
 v_mfma_f32_16x16x32_bf16 a[228:231], a[124:127], a[12:15], a[228:231]
 v_mfma_f32_16x16x32_bf16 a[224:227], a[116:119], a[12:15], a[224:227]
 s_add_u32 m0, s33, 0x700
 ds_read_b128 a[72:75], v4 offset:34816
 v_mfma_f32_16x16x32_bf16 a[224:227], a[112:115], a[8:11], a[224:227]
 buffer_load_dwordx4 v15, s[20:23], s57 offen offset:256 lds
 v_mfma_f32_16x16x32_bf16 a[236:239], a[104:107], a[8:11], a[236:239]
 ds_read_b128 a[80:83], v4 offset:36864
 v_mfma_f32_16x16x32_bf16 a[236:239], a[108:111], a[12:15], a[236:239]
 v_mfma_f32_16x16x32_bf16 a[232:235], a[100:103], a[12:15], a[232:235]
 s_add_u32 m0, s33, 0x780
 ds_read_b128 a[84:87], v5 offset:36864
 v_mfma_f32_16x16x32_bf16 a[232:235], a[96:99], a[8:11], a[232:235]
 s_waitcnt lgkmcnt(10)
 buffer_load_dwordx4 v15, s[20:23], s57 offen offset:1152 lds
 v_mfma_f32_16x16x32_bf16 v[32:35], a[96:99], a[16:19], v[32:35]
 ds_read_b128 a[92:95], v5 offset:38912
 v_mfma_f32_16x16x32_bf16 v[32:35], a[100:103], a[20:23], v[32:35]
 v_mfma_f32_16x16x32_bf16 v[36:39], a[108:111], a[20:23], v[36:39]
 s_add_u32 m0, s33, 0xe80
 ds_read_b128 a[88:91], v4 offset:38912
 v_mfma_f32_16x16x32_bf16 v[36:39], a[104:107], a[16:19], v[36:39]
 buffer_load_dwordx4 v15, s[20:23], 0 offen offset:384 lds
 v_mfma_f32_16x16x32_bf16 v[40:43], a[112:115], a[16:19], v[40:43]
 ds_read_b64_tr_b16 a[32:33], v10 offset:32768
 v_mfma_f32_16x16x32_bf16 v[40:43], a[116:119], a[20:23], v[40:43]
 ds_read_b64_tr_b16 a[34:35], v10 offset:36864
 v_mfma_f32_16x16x32_bf16 v[44:47], a[124:127], a[20:23], v[44:47]
 s_add_u32 m0, s33, 0xf00
 ds_read_b64_tr_b16 a[36:37], v10 offset:49152
 v_mfma_f32_16x16x32_bf16 v[44:47], a[120:123], a[16:19], v[44:47]
 s_waitcnt lgkmcnt(11)
 ds_read_b64_tr_b16 a[38:39], v10 offset:53248
 buffer_load_dwordx4 v15, s[20:23], 0 offen offset:1280 lds
 v_mfma_f32_16x16x32_bf16 v[52:55], a[120:123], a[24:27], v[52:55]
 ds_read_b64_tr_b16 a[40:41], v11 offset:32768
 v_mfma_f32_16x16x32_bf16 v[52:55], a[124:127], a[28:31], v[52:55]
 ds_read_b64_tr_b16 a[42:43], v11 offset:36864
 v_mfma_f32_16x16x32_bf16 v[48:51], a[116:119], a[28:31], v[48:51]
 s_add_u32 m0, s33, 0x1680
 ds_read_b64_tr_b16 a[44:45], v11 offset:49152
 v_mfma_f32_16x16x32_bf16 v[48:51], a[112:115], a[24:27], v[48:51]
 ds_read_b64_tr_b16 a[46:47], v11 offset:53248
 buffer_load_dwordx4 v15, s[20:23], s57 offen offset:384 lds
 v_mfma_f32_16x16x32_bf16 v[60:63], a[104:107], a[24:27], v[60:63]
 ds_read_b64_tr_b16 a[48:49], v12 offset:32768
 v_mfma_f32_16x16x32_bf16 v[60:63], a[108:111], a[28:31], v[60:63]
 ds_read_b64_tr_b16 a[50:51], v12 offset:36864
 v_mfma_f32_16x16x32_bf16 v[56:59], a[100:103], a[28:31], v[56:59]
 s_add_u32 m0, s33, 0x1700
 ds_read_b64_tr_b16 a[52:53], v12 offset:49152
 v_mfma_f32_16x16x32_bf16 v[56:59], a[96:99], a[24:27], v[56:59]
 s_waitcnt lgkmcnt(15)
 ds_read_b64_tr_b16 a[54:55], v12 offset:53248
 buffer_load_dwordx4 v15, s[20:23], s57 offen offset:1280 lds
 v_mfma_f32_16x16x32_bf16 v[64:67], a[64:67], a[0:3], v[64:67]
 ds_read_b64_tr_b16 a[56:57], v13 offset:32768
 v_mfma_f32_16x16x32_bf16 v[64:67], a[68:71], a[4:7], v[64:67]
 ds_read_b64_tr_b16 a[58:59], v13 offset:36864
 v_mfma_f32_16x16x32_bf16 v[68:71], a[76:79], a[4:7], v[68:71]
 ds_read_b64_tr_b16 a[60:61], v13 offset:49152
 v_mfma_f32_16x16x32_bf16 v[68:71], a[72:75], a[0:3], v[68:71]
 s_waitcnt lgkmcnt(15)
 ds_read_b64_tr_b16 a[62:63], v13 offset:53248
 v_mfma_f32_16x16x32_bf16 v[72:75], a[80:83], a[0:3], v[72:75]
 v_mfma_f32_16x16x32_bf16 v[72:75], a[84:87], a[4:7], v[72:75]
 v_mfma_f32_16x16x32_bf16 v[76:79], a[92:95], a[4:7], v[76:79]
 v_mfma_f32_16x16x32_bf16 v[76:79], a[88:91], a[0:3], v[76:79]
 s_waitcnt lgkmcnt(0)
 v_mfma_f32_16x16x32_bf16 v[84:87], a[88:91], a[8:11], v[84:87]
 s_barrier
 v_mfma_f32_16x16x32_bf16 v[84:87], a[92:95], a[12:15], v[84:87]
 s_add_u32 m0, s29, 98304
 v_mfma_f32_16x16x32_bf16 v[80:83], a[84:87], a[12:15], v[80:83]
 buffer_load_dwordx4 v2, s[8:11], 0 offen  lds
 v_mfma_f32_16x16x32_bf16 v[80:83], a[80:83], a[8:11], v[80:83]
 v_mfma_f32_16x16x32_bf16 v[92:95], a[72:75], a[8:11], v[92:95]
 v_mfma_f32_16x16x32_bf16 v[92:95], a[76:79], a[12:15], v[92:95]
 v_mfma_f32_16x16x32_bf16 v[88:91], a[68:71], a[12:15], v[88:91]
 s_add_u32 m0, s29, 32768
 v_mfma_f32_16x16x32_bf16 v[88:91], a[64:67], a[8:11], v[88:91]
 buffer_load_dwordx4 v1, s[4:7], 0 offen  lds
 v_mfma_f32_16x16x32_bf16 v[96:99], a[64:67], a[16:19], v[96:99]
 v_mfma_f32_16x16x32_bf16 v[96:99], a[68:71], a[20:23], v[96:99]
 v_mfma_f32_16x16x32_bf16 v[100:103], a[76:79], a[20:23], v[100:103]
 v_mfma_f32_16x16x32_bf16 v[100:103], a[72:75], a[16:19], v[100:103]
 s_add_u32 m0, s29, 102400
 v_mfma_f32_16x16x32_bf16 v[104:107], a[80:83], a[16:19], v[104:107]
 buffer_load_dwordx4 v2, s[8:11], s48 offen  lds
 v_mfma_f32_16x16x32_bf16 v[104:107], a[84:87], a[20:23], v[104:107]
 v_mfma_f32_16x16x32_bf16 v[108:111], a[92:95], a[20:23], v[108:111]
 v_mfma_f32_16x16x32_bf16 v[108:111], a[88:91], a[16:19], v[108:111]
 v_mfma_f32_16x16x32_bf16 v[116:119], a[88:91], a[24:27], v[116:119]
 s_add_u32 m0, s29, 36864
 v_mfma_f32_16x16x32_bf16 v[116:119], a[92:95], a[28:31], v[116:119]
 buffer_load_dwordx4 v1, s[4:7], s41 offen  lds
 v_mfma_f32_16x16x32_bf16 v[112:115], a[84:87], a[28:31], v[112:115]
 v_mfma_f32_16x16x32_bf16 v[112:115], a[80:83], a[24:27], v[112:115]
 v_mfma_f32_16x16x32_bf16 v[124:127], a[72:75], a[24:27], v[124:127]
 v_mfma_f32_16x16x32_bf16 v[124:127], a[76:79], a[28:31], v[124:127]
 s_add_u32 m0, s29, 106496
 v_mfma_f32_16x16x32_bf16 v[120:123], a[68:71], a[28:31], v[120:123]
 buffer_load_dwordx4 v2, s[8:11], s49 offen  lds
 v_mfma_f32_16x16x32_bf16 v[120:123], a[64:67], a[24:27], v[120:123]
 v_mfma_f32_16x16x32_bf16 v[128:131], a[64:67], a[32:35], v[128:131]
 v_mfma_f32_16x16x32_bf16 v[128:131], a[68:71], a[36:39], v[128:131]
 v_mfma_f32_16x16x32_bf16 v[132:135], a[76:79], a[36:39], v[132:135]
 s_add_u32 m0, s29, 40960
 v_mfma_f32_16x16x32_bf16 v[132:135], a[72:75], a[32:35], v[132:135]
 buffer_load_dwordx4 v1, s[4:7], s42 offen  lds
 v_mfma_f32_16x16x32_bf16 v[136:139], a[80:83], a[32:35], v[136:139]
 v_mfma_f32_16x16x32_bf16 v[136:139], a[84:87], a[36:39], v[136:139]
 v_mfma_f32_16x16x32_bf16 v[140:143], a[92:95], a[36:39], v[140:143]
 v_mfma_f32_16x16x32_bf16 v[140:143], a[88:91], a[32:35], v[140:143]
 s_add_u32 m0, s29, 110592
 v_mfma_f32_16x16x32_bf16 v[148:151], a[88:91], a[40:43], v[148:151]
 buffer_load_dwordx4 v2, s[8:11], s50 offen  lds
 v_mfma_f32_16x16x32_bf16 v[148:151], a[92:95], a[44:47], v[148:151]
 v_mfma_f32_16x16x32_bf16 v[144:147], a[84:87], a[44:47], v[144:147]
 v_mfma_f32_16x16x32_bf16 v[144:147], a[80:83], a[40:43], v[144:147]
 v_mfma_f32_16x16x32_bf16 v[156:159], a[72:75], a[40:43], v[156:159]
 s_add_u32 m0, s29, 45056
 v_mfma_f32_16x16x32_bf16 v[156:159], a[76:79], a[44:47], v[156:159]
 buffer_load_dwordx4 v1, s[4:7], s43 offen  lds
 v_mfma_f32_16x16x32_bf16 v[152:155], a[68:71], a[44:47], v[152:155]
 v_mfma_f32_16x16x32_bf16 v[152:155], a[64:67], a[40:43], v[152:155]
 v_mfma_f32_16x16x32_bf16 v[160:163], a[64:67], a[48:51], v[160:163]
 v_mfma_f32_16x16x32_bf16 v[160:163], a[68:71], a[52:55], v[160:163]
 s_add_u32 m0, s29, 114688
 v_mfma_f32_16x16x32_bf16 v[164:167], a[76:79], a[52:55], v[164:167]
 buffer_load_dwordx4 v2, s[8:11], s51 offen  lds
 v_mfma_f32_16x16x32_bf16 v[164:167], a[72:75], a[48:51], v[164:167]
 v_mfma_f32_16x16x32_bf16 v[168:171], a[80:83], a[48:51], v[168:171]
 v_mfma_f32_16x16x32_bf16 v[168:171], a[84:87], a[52:55], v[168:171]
 v_mfma_f32_16x16x32_bf16 v[172:175], a[92:95], a[52:55], v[172:175]
 s_add_u32 m0, s29, 49152
 v_mfma_f32_16x16x32_bf16 v[172:175], a[88:91], a[48:51], v[172:175]
 buffer_load_dwordx4 v1, s[4:7], s44 offen  lds
 v_mfma_f32_16x16x32_bf16 v[180:183], a[88:91], a[56:59], v[180:183]
 v_mfma_f32_16x16x32_bf16 v[180:183], a[92:95], a[60:63], v[180:183]
 v_mfma_f32_16x16x32_bf16 v[176:179], a[84:87], a[60:63], v[176:179]
 v_mfma_f32_16x16x32_bf16 v[176:179], a[80:83], a[56:59], v[176:179]
 s_add_u32 m0, s29, 118784
 v_mfma_f32_16x16x32_bf16 v[188:191], a[72:75], a[56:59], v[188:191]
 s_waitcnt vmcnt(10)
 buffer_load_dwordx4 v2, s[8:11], s52 offen  lds
 v_mfma_f32_16x16x32_bf16 v[188:191], a[76:79], a[60:63], v[188:191]
 s_barrier
 ds_read_b64_tr_b16 a[0:1], v6 offset:0
 v_mfma_f32_16x16x32_bf16 v[184:187], a[68:71], a[60:63], v[184:187]
 ds_read_b64_tr_b16 a[2:3], v6 offset:4096
 v_mfma_f32_16x16x32_bf16 v[184:187], a[64:67], a[56:59], v[184:187]
 ds_read_b128 a[64:67], v4 offset:0
 v_mfma_f32_16x16x32_bf16 v[192:195], a[96:99], a[32:35], v[192:195]
 s_add_u32 m0, s29, 53248
 ds_read_b128 a[160:163], v14 offset:0
 v_mfma_f32_16x16x32_bf16 v[192:195], a[100:103], a[36:39], v[192:195]
 buffer_load_dwordx4 v1, s[4:7], s45 offen  lds
 v_mfma_f32_16x16x32_bf16 v[196:199], a[108:111], a[36:39], v[196:199]
 ds_read_b64_tr_b16 a[4:5], v6 offset:16384
 v_mfma_f32_16x16x32_bf16 v[196:199], a[104:107], a[32:35], v[196:199]
 ds_read_b64_tr_b16 a[6:7], v6 offset:20480
 v_mfma_f32_16x16x32_bf16 v[200:203], a[112:115], a[32:35], v[200:203]
 ds_read_b128 a[68:71], v5 offset:0
 v_mfma_f32_16x16x32_bf16 v[200:203], a[116:119], a[36:39], v[200:203]
 s_add_u32 m0, s29, 122880
 ds_read_b128 a[168:171], v3 offset:0
 v_mfma_f32_16x16x32_bf16 v[204:207], a[124:127], a[36:39], v[204:207]
 buffer_load_dwordx4 v2, s[8:11], s53 offen  lds
 v_mfma_f32_16x16x32_bf16 v[204:207], a[120:123], a[32:35], v[204:207]
 ds_read_b128 a[76:79], v5 offset:2048
 v_mfma_f32_16x16x32_bf16 v[212:215], a[120:123], a[40:43], v[212:215]
 ds_read_b128 a[164:167], v14 offset:2048
 v_mfma_f32_16x16x32_bf16 v[212:215], a[124:127], a[44:47], v[212:215]
 ds_read_b128 a[72:75], v4 offset:2048
 v_mfma_f32_16x16x32_bf16 v[208:211], a[116:119], a[44:47], v[208:211]
 s_add_u32 m0, s29, 57344
 ds_read_b128 a[172:175], v3 offset:2048
 v_mfma_f32_16x16x32_bf16 v[208:211], a[112:115], a[40:43], v[208:211]
 buffer_load_dwordx4 v1, s[4:7], s46 offen  lds
 v_mfma_f32_16x16x32_bf16 v[220:223], a[104:107], a[40:43], v[220:223]
 ds_read_b128 a[80:83], v4 offset:4096
 v_mfma_f32_16x16x32_bf16 v[220:223], a[108:111], a[44:47], v[220:223]
 ds_read_b128 a[176:179], v14 offset:4096
 v_mfma_f32_16x16x32_bf16 v[216:219], a[100:103], a[44:47], v[216:219]
 ds_read_b128 a[84:87], v5 offset:4096
 v_mfma_f32_16x16x32_bf16 v[216:219], a[96:99], a[40:43], v[216:219]
 s_add_u32 m0, s29, 126976
 ds_read_b128 a[184:187], v3 offset:4096
 v_mfma_f32_16x16x32_bf16 v[224:227], a[96:99], a[48:51], v[224:227]
 buffer_load_dwordx4 v2, s[8:11], s54 offen  lds
 v_mfma_f32_16x16x32_bf16 v[224:227], a[100:103], a[52:55], v[224:227]
 ds_read_b128 a[92:95], v5 offset:6144
 v_mfma_f32_16x16x32_bf16 v[228:231], a[108:111], a[52:55], v[228:231]
 ds_read_b128 a[180:183], v14 offset:6144
 v_mfma_f32_16x16x32_bf16 v[228:231], a[104:107], a[48:51], v[228:231]
 ds_read_b128 a[88:91], v4 offset:6144
 v_mfma_f32_16x16x32_bf16 v[232:235], a[112:115], a[48:51], v[232:235]
 s_add_u32 m0, s29, 61440
 ds_read_b128 a[188:191], v3 offset:6144
 v_mfma_f32_16x16x32_bf16 v[232:235], a[116:119], a[52:55], v[232:235]
 buffer_load_dwordx4 v1, s[4:7], s47 offen  lds
 v_mfma_f32_16x16x32_bf16 v[236:239], a[124:127], a[52:55], v[236:239]
 v_add_u32 v1, 128, v1
 v_add_u32 v2, 0x80000, v2
 v_mfma_f32_16x16x32_bf16 v[236:239], a[120:123], a[48:51], v[236:239]
 ds_read_b64_tr_b16 a[8:9], v7 offset:0
 v_mfma_f32_16x16x32_bf16 v[244:247], a[120:123], a[56:59], v[244:247]
 v_mfma_f32_16x16x32_bf16 v[244:247], a[124:127], a[60:63], v[244:247]
 ds_read_b64_tr_b16 a[10:11], v7 offset:4096
 v_mfma_f32_16x16x32_bf16 v[240:243], a[116:119], a[60:63], v[240:243]
 ds_read_b64_tr_b16 a[12:13], v7 offset:16384
 v_mfma_f32_16x16x32_bf16 v[240:243], a[112:115], a[56:59], v[240:243]
 ds_read_b64_tr_b16 a[14:15], v7 offset:20480
 v_mfma_f32_16x16x32_bf16 v[252:255], a[104:107], a[56:59], v[252:255]
 ds_read_b64_tr_b16 a[16:17], v8 offset:0
 v_mfma_f32_16x16x32_bf16 v[252:255], a[108:111], a[60:63], v[252:255]
 ds_read_b64_tr_b16 a[18:19], v8 offset:4096
 v_mfma_f32_16x16x32_bf16 v[248:251], a[100:103], a[60:63], v[248:251]
 ds_read_b64_tr_b16 a[20:21], v8 offset:16384
 v_mfma_f32_16x16x32_bf16 v[248:251], a[96:99], a[56:59], v[248:251]
 s_waitcnt lgkmcnt(15)
 ds_read_b64_tr_b16 a[22:23], v8 offset:20480
 v_mfma_f32_16x16x32_bf16 v[64:67], a[64:67], a[0:3], v[64:67]
 ds_read_b64_tr_b16 a[24:25], v9 offset:0
 v_lshlrev_b32 v1, 4, v0
 v_mfma_f32_16x16x32_bf16 v[64:67], a[68:71], a[4:7], v[64:67]
 s_add_u32 m0, s33, 0xfffffe00
 ds_read_b64_tr_b16 a[26:27], v9 offset:4096
 v_mfma_f32_16x16x32_bf16 v[68:71], a[76:79], a[4:7], v[68:71]
 s_waitcnt lgkmcnt(10)
 ds_read_b64_tr_b16 a[28:29], v9 offset:16384
 v_mfma_f32_16x16x32_bf16 v[68:71], a[72:75], a[0:3], v[68:71]
 ds_read_b64_tr_b16 a[30:31], v9 offset:20480
 buffer_load_dwordx4 v15, s[20:23], 0 offen offset:512 lds
 v_mfma_f32_16x16x32_bf16 v[72:75], a[80:83], a[0:3], v[72:75]
 ds_read_b128 a[96:99], v4 offset:8192
 v_mfma_f32_16x16x32_bf16 v[72:75], a[84:87], a[4:7], v[72:75]
 v_mfma_f32_16x16x32_bf16 v[76:79], a[92:95], a[4:7], v[76:79]
 s_add_u32 m0, s33, 0xfffffe80
 ds_read_b128 a[100:103], v5 offset:8192
 v_mfma_f32_16x16x32_bf16 v[76:79], a[88:91], a[0:3], v[76:79]
 s_waitcnt lgkmcnt(10)
 buffer_load_dwordx4 v15, s[20:23], 0 offen offset:1408 lds
 v_mfma_f32_16x16x32_bf16 v[84:87], a[88:91], a[8:11], v[84:87]
 ds_read_b128 a[108:111], v5 offset:10240
 v_mfma_f32_16x16x32_bf16 v[84:87], a[92:95], a[12:15], v[84:87]
 v_mfma_f32_16x16x32_bf16 v[80:83], a[84:87], a[12:15], v[80:83]
 s_add_u32 m0, s33, 0x600
 ds_read_b128 a[104:107], v4 offset:10240
 v_mfma_f32_16x16x32_bf16 v[80:83], a[80:83], a[8:11], v[80:83]
 buffer_load_dwordx4 v15, s[20:23], s57 offen offset:512 lds
 v_mfma_f32_16x16x32_bf16 v[92:95], a[72:75], a[8:11], v[92:95]
 ds_read_b128 a[112:115], v4 offset:12288
 v_mfma_f32_16x16x32_bf16 v[92:95], a[76:79], a[12:15], v[92:95]
 v_mfma_f32_16x16x32_bf16 v[88:91], a[68:71], a[12:15], v[88:91]
 s_add_u32 m0, s33, 0x680
 ds_read_b128 a[116:119], v5 offset:12288
 v_mfma_f32_16x16x32_bf16 v[88:91], a[64:67], a[8:11], v[88:91]
 s_waitcnt lgkmcnt(10)
 buffer_load_dwordx4 v15, s[20:23], s57 offen offset:1408 lds
 v_mfma_f32_16x16x32_bf16 v[96:99], a[64:67], a[16:19], v[96:99]
 ds_read_b128 a[124:127], v5 offset:14336
 v_mfma_f32_16x16x32_bf16 v[96:99], a[68:71], a[20:23], v[96:99]
 v_mfma_f32_16x16x32_bf16 v[100:103], a[76:79], a[20:23], v[100:103]
 s_add_u32 m0, s33, 0xd80
 ds_read_b128 a[120:123], v4 offset:14336
 v_mfma_f32_16x16x32_bf16 v[100:103], a[72:75], a[16:19], v[100:103]
 buffer_load_dwordx4 v15, s[20:23], 0 offen offset:640 lds
 v_mfma_f32_16x16x32_bf16 v[104:107], a[80:83], a[16:19], v[104:107]
 ds_read_b64_tr_b16 a[32:33], v10 offset:0
 v_mfma_f32_16x16x32_bf16 v[104:107], a[84:87], a[20:23], v[104:107]
 ds_read_b64_tr_b16 a[34:35], v10 offset:4096
 v_mfma_f32_16x16x32_bf16 v[108:111], a[92:95], a[20:23], v[108:111]
 s_add_u32 m0, s33, 0xe00
 ds_read_b64_tr_b16 a[36:37], v10 offset:16384
 v_mfma_f32_16x16x32_bf16 v[108:111], a[88:91], a[16:19], v[108:111]
 s_waitcnt lgkmcnt(11)
 ds_read_b64_tr_b16 a[38:39], v10 offset:20480
 buffer_load_dwordx4 v15, s[20:23], 0 offen offset:1536 lds
 v_mfma_f32_16x16x32_bf16 v[116:119], a[88:91], a[24:27], v[116:119]
 ds_read_b64_tr_b16 a[40:41], v11 offset:0
 v_mfma_f32_16x16x32_bf16 v[116:119], a[92:95], a[28:31], v[116:119]
 ds_read_b64_tr_b16 a[42:43], v11 offset:4096
 v_mfma_f32_16x16x32_bf16 v[112:115], a[84:87], a[28:31], v[112:115]
 s_add_u32 m0, s33, 0x1580
 ds_read_b64_tr_b16 a[44:45], v11 offset:16384
 v_mfma_f32_16x16x32_bf16 v[112:115], a[80:83], a[24:27], v[112:115]
 ds_read_b64_tr_b16 a[46:47], v11 offset:20480
 buffer_load_dwordx4 v15, s[20:23], s57 offen offset:640 lds
 v_mfma_f32_16x16x32_bf16 v[124:127], a[72:75], a[24:27], v[124:127]
 ds_read_b64_tr_b16 a[48:49], v12 offset:0
 v_mfma_f32_16x16x32_bf16 v[124:127], a[76:79], a[28:31], v[124:127]
 ds_read_b64_tr_b16 a[50:51], v12 offset:4096
 v_mfma_f32_16x16x32_bf16 v[120:123], a[68:71], a[28:31], v[120:123]
 s_add_u32 m0, s33, 0x1600
 ds_read_b64_tr_b16 a[52:53], v12 offset:16384
 v_mfma_f32_16x16x32_bf16 v[120:123], a[64:67], a[24:27], v[120:123]
 s_waitcnt lgkmcnt(15)
 ds_read_b64_tr_b16 a[54:55], v12 offset:20480
 buffer_load_dwordx4 v15, s[20:23], s57 offen offset:1536 lds
 v_mfma_f32_16x16x32_bf16 v[16:19], a[96:99], a[0:3], v[16:19]
 ds_read_b64_tr_b16 a[56:57], v13 offset:0
 v_mfma_f32_16x16x32_bf16 v[16:19], a[100:103], a[4:7], v[16:19]
 ds_read_b64_tr_b16 a[58:59], v13 offset:4096
 v_mfma_f32_16x16x32_bf16 v[20:23], a[108:111], a[4:7], v[20:23]
 ds_read_b64_tr_b16 a[60:61], v13 offset:16384
 v_mfma_f32_16x16x32_bf16 v[20:23], a[104:107], a[0:3], v[20:23]
 s_waitcnt lgkmcnt(15)
 ds_read_b64_tr_b16 a[62:63], v13 offset:20480
 v_mfma_f32_16x16x32_bf16 v[24:27], a[112:115], a[0:3], v[24:27]
 v_mfma_f32_16x16x32_bf16 v[24:27], a[116:119], a[4:7], v[24:27]
 v_mfma_f32_16x16x32_bf16 v[28:31], a[124:127], a[4:7], v[28:31]
 v_mfma_f32_16x16x32_bf16 v[28:31], a[120:123], a[0:3], v[28:31]
 s_waitcnt lgkmcnt(0)
 v_mfma_f32_16x16x32_bf16 a[228:231], a[120:123], a[8:11], a[228:231]
 s_barrier
 v_mfma_f32_16x16x32_bf16 a[228:231], a[124:127], a[12:15], a[228:231]
 s_add_u32 m0, s29, 0
 v_add_u32 v2, 0xff800000, v2
 v_mfma_f32_16x16x32_bf16 a[224:227], a[116:119], a[12:15], a[224:227]
 buffer_load_dwordx4 v2, s[16:19], 0 offen lds
 v_mfma_f32_16x16x32_bf16 a[224:227], a[112:115], a[8:11], a[224:227]
 v_mfma_f32_16x16x32_bf16 a[236:239], a[104:107], a[8:11], a[236:239]
 v_mfma_f32_16x16x32_bf16 a[236:239], a[108:111], a[12:15], a[236:239]
 v_mfma_f32_16x16x32_bf16 a[232:235], a[100:103], a[12:15], a[232:235]
 s_add_u32 m0, s29, 4096
 v_mfma_f32_16x16x32_bf16 a[232:235], a[96:99], a[8:11], a[232:235]
 buffer_load_dwordx4 v2, s[16:19], s48 offen lds
 v_mfma_f32_16x16x32_bf16 v[32:35], a[96:99], a[16:19], v[32:35]
 v_mfma_f32_16x16x32_bf16 v[32:35], a[100:103], a[20:23], v[32:35]
 v_mfma_f32_16x16x32_bf16 v[36:39], a[108:111], a[20:23], v[36:39]
 v_mfma_f32_16x16x32_bf16 v[36:39], a[104:107], a[16:19], v[36:39]
 s_add_u32 m0, s29, 8192
 v_mfma_f32_16x16x32_bf16 v[40:43], a[112:115], a[16:19], v[40:43]
 buffer_load_dwordx4 v2, s[16:19], s49 offen lds
 v_mfma_f32_16x16x32_bf16 v[40:43], a[116:119], a[20:23], v[40:43]
 v_mfma_f32_16x16x32_bf16 v[44:47], a[124:127], a[20:23], v[44:47]
 v_mfma_f32_16x16x32_bf16 v[44:47], a[120:123], a[16:19], v[44:47]
 v_mfma_f32_16x16x32_bf16 v[52:55], a[120:123], a[24:27], v[52:55]
 s_add_u32 m0, s29, 12288
 v_mfma_f32_16x16x32_bf16 v[52:55], a[124:127], a[28:31], v[52:55]
 buffer_load_dwordx4 v2, s[16:19], s50 offen lds
 v_mfma_f32_16x16x32_bf16 v[48:51], a[116:119], a[28:31], v[48:51]
 v_mfma_f32_16x16x32_bf16 v[48:51], a[112:115], a[24:27], v[48:51]
 v_mfma_f32_16x16x32_bf16 v[60:63], a[104:107], a[24:27], v[60:63]
 v_mfma_f32_16x16x32_bf16 v[60:63], a[108:111], a[28:31], v[60:63]
 s_add_u32 m0, s29, 16384
 v_mfma_f32_16x16x32_bf16 v[56:59], a[100:103], a[28:31], v[56:59]
 buffer_load_dwordx4 v2, s[16:19], s51 offen lds
 v_mfma_f32_16x16x32_bf16 v[56:59], a[96:99], a[24:27], v[56:59]
 v_mfma_f32_16x16x32_bf16 v[192:195], a[96:99], a[32:35], v[192:195]
 v_mfma_f32_16x16x32_bf16 v[192:195], a[100:103], a[36:39], v[192:195]
 v_mfma_f32_16x16x32_bf16 v[196:199], a[108:111], a[36:39], v[196:199]
 s_add_u32 m0, s29, 20480
 v_mfma_f32_16x16x32_bf16 v[196:199], a[104:107], a[32:35], v[196:199]
 buffer_load_dwordx4 v2, s[16:19], s52 offen lds
 v_mfma_f32_16x16x32_bf16 v[200:203], a[112:115], a[32:35], v[200:203]
 v_mfma_f32_16x16x32_bf16 v[200:203], a[116:119], a[36:39], v[200:203]
 v_mfma_f32_16x16x32_bf16 v[204:207], a[124:127], a[36:39], v[204:207]
 v_mfma_f32_16x16x32_bf16 v[204:207], a[120:123], a[32:35], v[204:207]
 s_add_u32 m0, s29, 24576
 v_mfma_f32_16x16x32_bf16 v[212:215], a[120:123], a[40:43], v[212:215]
 buffer_load_dwordx4 v2, s[16:19], s53 offen lds
 v_mfma_f32_16x16x32_bf16 v[212:215], a[124:127], a[44:47], v[212:215]
 v_mfma_f32_16x16x32_bf16 v[208:211], a[116:119], a[44:47], v[208:211]
 v_mfma_f32_16x16x32_bf16 v[208:211], a[112:115], a[40:43], v[208:211]
 v_mfma_f32_16x16x32_bf16 v[220:223], a[104:107], a[40:43], v[220:223]
 s_add_u32 m0, s29, 28672
 v_mfma_f32_16x16x32_bf16 v[220:223], a[108:111], a[44:47], v[220:223]
 buffer_load_dwordx4 v2, s[16:19], s54 offen lds
 v_mfma_f32_16x16x32_bf16 v[216:219], a[100:103], a[44:47], v[216:219]
 v_mfma_f32_16x16x32_bf16 v[216:219], a[96:99], a[40:43], v[216:219]
 v_mfma_f32_16x16x32_bf16 v[224:227], a[96:99], a[48:51], v[224:227]
 s_add_u32 m0, s29, 65536
 v_add_u32 v2, 0x80000, v2
 v_mfma_f32_16x16x32_bf16 v[224:227], a[100:103], a[52:55], v[224:227]
 buffer_load_dwordx4 v2, s[16:19], 0 offen lds
 v_mfma_f32_16x16x32_bf16 v[228:231], a[108:111], a[52:55], v[228:231]
 v_mfma_f32_16x16x32_bf16 v[228:231], a[104:107], a[48:51], v[228:231]
 v_mfma_f32_16x16x32_bf16 v[232:235], a[112:115], a[48:51], v[232:235]
 v_mfma_f32_16x16x32_bf16 v[232:235], a[116:119], a[52:55], v[232:235]
 s_add_u32 m0, s29, 69632
 v_mfma_f32_16x16x32_bf16 v[236:239], a[124:127], a[52:55], v[236:239]
 buffer_load_dwordx4 v2, s[16:19], s48 offen lds
 v_mfma_f32_16x16x32_bf16 v[236:239], a[120:123], a[48:51], v[236:239]
 v_mfma_f32_16x16x32_bf16 v[244:247], a[120:123], a[56:59], v[244:247]
 v_mfma_f32_16x16x32_bf16 v[244:247], a[124:127], a[60:63], v[244:247]
 v_mfma_f32_16x16x32_bf16 v[240:243], a[116:119], a[60:63], v[240:243]
 s_add_u32 m0, s29, 73728
 v_mfma_f32_16x16x32_bf16 v[240:243], a[112:115], a[56:59], v[240:243]
 buffer_load_dwordx4 v2, s[16:19], s49 offen lds
 v_mfma_f32_16x16x32_bf16 v[252:255], a[104:107], a[56:59], v[252:255]
 s_waitcnt vmcnt(11)
 v_mfma_f32_16x16x32_bf16 v[252:255], a[108:111], a[60:63], v[252:255]
 s_barrier
 ds_read_b64_tr_b16 a[0:1], v6 offset:32768
 v_mfma_f32_16x16x32_bf16 v[248:251], a[100:103], a[60:63], v[248:251]
 ds_read_b64_tr_b16 a[2:3], v6 offset:36864
 v_mfma_f32_16x16x32_bf16 v[248:251], a[96:99], a[56:59], v[248:251]
 s_add_u32 m0, s29, 77824
 ds_read_b128 a[96:99], v4 offset:40960
 v_mfma_f32_16x16x32_bf16 v[128:131], a[64:67], a[32:35], v[128:131]
 ds_read_b128 a[192:195], v14 offset:0
 buffer_load_dwordx4 v2, s[16:19], s50 offen lds
 v_mfma_f32_16x16x32_bf16 v[128:131], a[68:71], a[36:39], v[128:131]
 ds_read_b128 a[200:203], v3 offset:0
 v_mfma_f32_16x16x32_bf16 v[132:135], a[76:79], a[36:39], v[132:135]
 s_mov_b32 s56, s58
 ds_read_b64_tr_b16 a[4:5], v6 offset:49152
 v_mfma_f32_16x16x32_bf16 v[132:135], a[72:75], a[32:35], v[132:135]
 ds_read_b64_tr_b16 a[6:7], v6 offset:53248
 v_mfma_f32_16x16x32_bf16 v[136:139], a[80:83], a[32:35], v[136:139]
 s_add_u32 m0, s29, 81920
 ds_read_b128 a[100:103], v5 offset:40960
 v_mfma_f32_16x16x32_bf16 v[136:139], a[84:87], a[36:39], v[136:139]
 ds_read_b128 a[196:199], v14 offset:2048
 buffer_load_dwordx4 v2, s[16:19], s51 offen lds
 v_mfma_f32_16x16x32_bf16 v[140:143], a[92:95], a[36:39], v[140:143]
 ds_read_b128 a[204:207], v3 offset:2048
 v_mfma_f32_16x16x32_bf16 v[140:143], a[88:91], a[32:35], v[140:143]
 ds_read_b128 a[108:111], v5 offset:43008
 v_mfma_f32_16x16x32_bf16 v[148:151], a[88:91], a[40:43], v[148:151]
 ds_read_b128 a[208:211], v14 offset:4096
 v_mfma_f32_16x16x32_bf16 v[148:151], a[92:95], a[44:47], v[148:151]
 s_add_u32 m0, s29, 86016
 ds_read_b128 a[104:107], v4 offset:43008
 v_mfma_f32_16x16x32_bf16 v[144:147], a[84:87], a[44:47], v[144:147]
 ds_read_b128 a[216:219], v3 offset:4096
 buffer_load_dwordx4 v2, s[16:19], s52 offen lds
 v_mfma_f32_16x16x32_bf16 v[144:147], a[80:83], a[40:43], v[144:147]
 ds_read_b128 a[212:215], v14 offset:6144
 v_mfma_f32_16x16x32_bf16 v[156:159], a[72:75], a[40:43], v[156:159]
 s_cmp_lt_u32 s25, 4
 s_cselect_b32 s1, 2.0, s92
 ds_read_b128 a[112:115], v4 offset:45056
 v_mfma_f32_16x16x32_bf16 v[156:159], a[76:79], a[44:47], v[156:159]
 ds_read_b128 a[220:223], v3 offset:6144
 v_mfma_f32_16x16x32_bf16 v[152:155], a[68:71], a[44:47], v[152:155]
 s_add_u32 m0, s29, 90112
 ds_read_b128 a[116:119], v5 offset:45056
 v_mfma_f32_16x16x32_bf16 v[152:155], a[64:67], a[40:43], v[152:155]
 buffer_load_dwordx4 v2, s[16:19], s53 offen lds
 v_mfma_f32_16x16x32_bf16 v[160:163], a[64:67], a[48:51], v[160:163]
 v_mfma_f32_16x16x32_bf16 v[160:163], a[68:71], a[52:55], v[160:163]
 ds_read_b128 a[124:127], v5 offset:47104
 v_mfma_f32_16x16x32_bf16 v[164:167], a[76:79], a[52:55], v[164:167]
 v_mfma_f32_16x16x32_bf16 v[164:167], a[72:75], a[48:51], v[164:167]
 s_add_u32 m0, s29, 94208
 ds_read_b128 a[120:123], v4 offset:47104
 v_mfma_f32_16x16x32_bf16 v[168:171], a[80:83], a[48:51], v[168:171]
 buffer_load_dwordx4 v2, s[16:19], s54 offen lds
 v_mfma_f32_16x16x32_bf16 v[168:171], a[84:87], a[52:55], v[168:171]
 v_mfma_f32_16x16x32_bf16 v[172:175], a[92:95], a[52:55], v[172:175]
 v_mfma_f32_16x16x32_bf16 v[172:175], a[88:91], a[48:51], v[172:175]
 ds_read_b64_tr_b16 a[8:9], v7 offset:32768
 v_mfma_f32_16x16x32_bf16 v[180:183], a[88:91], a[56:59], v[180:183]
 v_mfma_f32_16x16x32_bf16 v[180:183], a[92:95], a[60:63], v[180:183]
 ds_read_b64_tr_b16 a[10:11], v7 offset:36864
 v_mfma_f32_16x16x32_bf16 v[176:179], a[84:87], a[60:63], v[176:179]
 ds_read_b64_tr_b16 a[12:13], v7 offset:49152
 v_mfma_f32_16x16x32_bf16 v[176:179], a[80:83], a[56:59], v[176:179]
 ds_read_b64_tr_b16 a[14:15], v7 offset:53248
 v_mfma_f32_16x16x32_bf16 v[188:191], a[72:75], a[56:59], v[188:191]
 ds_read_b64_tr_b16 a[16:17], v8 offset:32768
 v_mfma_f32_16x16x32_bf16 v[188:191], a[76:79], a[60:63], v[188:191]
 ds_read_b64_tr_b16 a[18:19], v8 offset:36864
 v_mfma_f32_16x16x32_bf16 v[184:187], a[68:71], a[60:63], v[184:187]
 ds_read_b64_tr_b16 a[20:21], v8 offset:49152
 v_mfma_f32_16x16x32_bf16 v[184:187], a[64:67], a[56:59], v[184:187]
 s_waitcnt lgkmcnt(15)
 ds_read_b64_tr_b16 a[22:23], v8 offset:53248
 s_cmp_ge_u32 s25, 4
 s_cbranch_scc1 L_late1
 v_mfma_f32_16x16x32_bf16 v[16:19], a[96:99], a[0:3], v[16:19]
 ds_read_b64_tr_b16 a[24:25], v9 offset:32768
 v_mfma_f32_16x16x32_bf16 v[16:19], a[100:103], a[4:7], v[16:19]
 s_add_u32 m0, s33, 0xfffffd00
 ds_read_b64_tr_b16 a[26:27], v9 offset:36864
 v_mfma_f32_16x16x32_bf16 v[20:23], a[108:111], a[4:7], v[20:23]
 s_waitcnt lgkmcnt(13)
 ds_read_b64_tr_b16 a[28:29], v9 offset:49152
 v_mfma_f32_16x16x32_bf16 v[20:23], a[104:107], a[0:3], v[20:23]
 ds_read_b64_tr_b16 a[30:31], v9 offset:53248
 buffer_load_dwordx4 v15, s[20:23], 0 offen offset:768 lds
 v_mfma_f32_16x16x32_bf16 v[24:27], a[112:115], a[0:3], v[24:27]
 s_waitcnt lgkmcnt(12)
 ds_read_b128 a[64:67], v4 offset:32768
 v_mfma_f32_16x16x32_bf16 v[24:27], a[116:119], a[4:7], v[24:27]
 v_mfma_f32_16x16x32_bf16 v[28:31], a[124:127], a[4:7], v[28:31]
 s_add_u32 m0, s33, 0xfffffd80
 ds_read_b128 a[68:71], v5 offset:32768
 v_mfma_f32_16x16x32_bf16 v[28:31], a[120:123], a[0:3], v[28:31]
 s_waitcnt lgkmcnt(10)
 buffer_load_dwordx4 v15, s[20:23], 0 offen offset:1664 lds
 v_mfma_f32_16x16x32_bf16 a[228:231], a[120:123], a[8:11], a[228:231]
 ds_read_b128 a[76:79], v5 offset:34816
 v_mfma_f32_16x16x32_bf16 a[228:231], a[124:127], a[12:15], a[228:231]
 v_mfma_f32_16x16x32_bf16 a[224:227], a[116:119], a[12:15], a[224:227]
 s_add_u32 m0, s33, 0x500
 ds_read_b128 a[72:75], v4 offset:34816
 v_mfma_f32_16x16x32_bf16 a[224:227], a[112:115], a[8:11], a[224:227]
 buffer_load_dwordx4 v15, s[20:23], s57 offen offset:768 lds
 v_mfma_f32_16x16x32_bf16 a[236:239], a[104:107], a[8:11], a[236:239]
 ds_read_b128 a[80:83], v4 offset:36864
 v_cvt_pk_bf16_f32 v16, v16, v17
 v_mfma_f32_16x16x32_bf16 a[236:239], a[108:111], a[12:15], a[236:239]
 v_cvt_pk_bf16_f32 v17, v18, v19
 v_cvt_pk_bf16_f32 v18, v20, v21
 v_mfma_f32_16x16x32_bf16 a[232:235], a[100:103], a[12:15], a[232:235]
 s_add_u32 m0, s33, 0x580
 ds_read_b128 a[84:87], v5 offset:36864
 v_cvt_pk_bf16_f32 v19, v22, v23
 v_mfma_f32_16x16x32_bf16 a[232:235], a[96:99], a[8:11], a[232:235]
 s_waitcnt lgkmcnt(10)
 buffer_load_dwordx4 v15, s[20:23], s57 offen offset:1664 lds
 v_mfma_f32_16x16x32_bf16 v[32:35], a[96:99], a[16:19], v[32:35]
 ds_read_b128 a[92:95], v5 offset:38912
 v_cvt_pk_bf16_f32 v24, v24, v25
 v_mfma_f32_16x16x32_bf16 v[32:35], a[100:103], a[20:23], v[32:35]
 v_cvt_pk_bf16_f32 v25, v26, v27
 v_cvt_pk_bf16_f32 v26, v28, v29
 v_mfma_f32_16x16x32_bf16 v[36:39], a[108:111], a[20:23], v[36:39]
 ds_read_b128 a[88:91], v4 offset:38912
 v_cvt_pk_bf16_f32 v27, v30, v31
 v_mfma_f32_16x16x32_bf16 v[36:39], a[104:107], a[16:19], v[36:39]
 v_accvgpr_read_b32 v20, a224
 v_accvgpr_read_b32 v21, a225
 v_mfma_f32_16x16x32_bf16 v[40:43], a[112:115], a[16:19], v[40:43]
 ds_read_b64_tr_b16 a[32:33], v10 offset:32768
 v_accvgpr_read_b32 v22, a226
 v_mfma_f32_16x16x32_bf16 v[40:43], a[116:119], a[20:23], v[40:43]
 ds_read_b64_tr_b16 a[34:35], v10 offset:36864
 v_accvgpr_read_b32 v23, a227
 v_mfma_f32_16x16x32_bf16 v[44:47], a[124:127], a[20:23], v[44:47]
 s_add_u32 s59, s56, 32768
 ds_read_b64_tr_b16 a[36:37], v10 offset:49152
 v_accvgpr_read_b32 v28, a228
 v_mfma_f32_16x16x32_bf16 v[44:47], a[120:123], a[16:19], v[44:47]
 s_waitcnt lgkmcnt(11)
 ds_read_b64_tr_b16 a[38:39], v10 offset:53248
 v_accvgpr_read_b32 v29, a229
 v_mfma_f32_16x16x32_bf16 v[52:55], a[120:123], a[24:27], v[52:55]
 ds_read_b64_tr_b16 a[40:41], v11 offset:32768
 buffer_store_dwordx4 v[16:19], v1, s[12:15], s59 offen offset:0 sc1
 v_mfma_f32_16x16x32_bf16 v[52:55], a[124:127], a[28:31], v[52:55]
 ds_read_b64_tr_b16 a[42:43], v11 offset:36864
 v_accvgpr_read_b32 v30, a230
 v_mfma_f32_16x16x32_bf16 v[48:51], a[116:119], a[28:31], v[48:51]
 ds_read_b64_tr_b16 a[44:45], v11 offset:49152
 v_accvgpr_read_b32 v31, a231
 v_mfma_f32_16x16x32_bf16 v[48:51], a[112:115], a[24:27], v[48:51]
 ds_read_b64_tr_b16 a[46:47], v11 offset:53248
 v_cvt_pk_bf16_f32 v20, v20, v21
 v_mfma_f32_16x16x32_bf16 v[60:63], a[104:107], a[24:27], v[60:63]
 ds_read_b64_tr_b16 a[48:49], v12 offset:32768
 v_cvt_pk_bf16_f32 v21, v22, v23
 v_mfma_f32_16x16x32_bf16 v[60:63], a[108:111], a[28:31], v[60:63]
 ds_read_b64_tr_b16 a[50:51], v12 offset:36864
 v_cvt_pk_bf16_f32 v22, v28, v29
 v_mfma_f32_16x16x32_bf16 v[56:59], a[100:103], a[28:31], v[56:59]
 s_add_u32 s59, s56, 49152
 ds_read_b64_tr_b16 a[52:53], v12 offset:49152
 v_cvt_pk_bf16_f32 v23, v30, v31
 v_mfma_f32_16x16x32_bf16 v[56:59], a[96:99], a[24:27], v[56:59]
 s_waitcnt lgkmcnt(15)
 ds_read_b64_tr_b16 a[54:55], v12 offset:53248
 buffer_store_dwordx4 v[24:27], v1, s[12:15], s59 offen offset:0 sc1
 v_mfma_f32_16x16x32_bf16 v[64:67], a[64:67], a[0:3], v[64:67]
 ds_read_b64_tr_b16 a[56:57], v13 offset:32768
 v_cvt_pk_bf16_f32 v32, v32, v33
 v_mfma_f32_16x16x32_bf16 v[64:67], a[68:71], a[4:7], v[64:67]
 ds_read_b64_tr_b16 a[58:59], v13 offset:36864
 v_cvt_pk_bf16_f32 v33, v34, v35
 v_mfma_f32_16x16x32_bf16 v[68:71], a[76:79], a[4:7], v[68:71]
 ds_read_b64_tr_b16 a[60:61], v13 offset:49152
 v_cvt_pk_bf16_f32 v34, v36, v37
 v_mfma_f32_16x16x32_bf16 v[68:71], a[72:75], a[0:3], v[68:71]
 s_waitcnt lgkmcnt(15)
 ds_read_b64_tr_b16 a[62:63], v13 offset:53248
 v_cvt_pk_bf16_f32 v35, v38, v39
 v_mfma_f32_16x16x32_bf16 v[72:75], a[80:83], a[0:3], v[72:75]
 v_cvt_pk_bf16_f32 v40, v40, v41
 v_cvt_pk_bf16_f32 v41, v42, v43
 v_mfma_f32_16x16x32_bf16 v[72:75], a[84:87], a[4:7], v[72:75]
 s_add_u32 s59, s56, 49152
 v_cvt_pk_bf16_f32 v42, v44, v45
 v_cvt_pk_bf16_f32 v43, v46, v47
 v_mfma_f32_16x16x32_bf16 v[76:79], a[92:95], a[4:7], v[76:79]
 buffer_store_dwordx4 v[20:23], v1, s[12:15], s59 offen offset:1024 sc1
 v_mfma_f32_16x16x32_bf16 v[76:79], a[88:91], a[0:3], v[76:79]
 s_waitcnt lgkmcnt(0)
 v_accvgpr_read_b32 v36, a232
 v_accvgpr_read_b32 v37, a233
 v_mfma_f32_16x16x32_bf16 v[84:87], a[88:91], a[8:11], v[84:87]
 s_barrier
 v_xor_b32 v6, s60, v6
 v_accvgpr_read_b32 v38, a234
 v_mfma_f32_16x16x32_bf16 v[84:87], a[92:95], a[12:15], v[84:87]
 s_add_u32 m0, s29, 32768
 v_add_u32 v2, 0x80000, v2
 v_accvgpr_read_b32 v39, a235
 v_mfma_f32_16x16x32_bf16 v[80:83], a[84:87], a[12:15], v[80:83]
 buffer_load_dwordx4 v2, s[16:19], 0 offen lds
 v_mfma_f32_16x16x32_bf16 v[80:83], a[80:83], a[8:11], v[80:83]
 v_accvgpr_read_b32 v44, a236
 v_accvgpr_read_b32 v45, a237
 v_mfma_f32_16x16x32_bf16 v[92:95], a[72:75], a[8:11], v[92:95]
 s_add_u32 s59, s56, 32768
 v_accvgpr_read_b32 v46, a238
 v_accvgpr_read_b32 v47, a239
 v_mfma_f32_16x16x32_bf16 v[92:95], a[76:79], a[12:15], v[92:95]
 buffer_store_dwordx4 v[32:35], v1, s[12:15], s59 offen offset:2048 sc1
 v_mfma_f32_16x16x32_bf16 v[88:91], a[68:71], a[12:15], v[88:91]
 s_add_u32 m0, s29, 36864
 v_cvt_pk_bf16_f32 v36, v36, v37
 v_cvt_pk_bf16_f32 v37, v38, v39
 v_mfma_f32_16x16x32_bf16 v[88:91], a[64:67], a[8:11], v[88:91]
 buffer_load_dwordx4 v2, s[16:19], s48 offen lds
 v_mfma_f32_16x16x32_bf16 v[96:99], a[64:67], a[16:19], v[96:99]
 v_cvt_pk_bf16_f32 v38, v44, v45
 v_cvt_pk_bf16_f32 v39, v46, v47
 v_mfma_f32_16x16x32_bf16 v[96:99], a[68:71], a[20:23], v[96:99]
 v_cvt_pk_bf16_f32 v48, v48, v49
 v_cvt_pk_bf16_f32 v49, v50, v51
 v_mfma_f32_16x16x32_bf16 v[100:103], a[76:79], a[20:23], v[100:103]
 v_cvt_pk_bf16_f32 v50, v52, v53
 v_cvt_pk_bf16_f32 v51, v54, v55
 v_mfma_f32_16x16x32_bf16 v[100:103], a[72:75], a[16:19], v[100:103]
 s_add_u32 m0, s29, 40960
 v_cvt_pk_bf16_f32 v56, v56, v57
 v_cvt_pk_bf16_f32 v57, v58, v59
 v_mfma_f32_16x16x32_bf16 v[104:107], a[80:83], a[16:19], v[104:107]
 buffer_load_dwordx4 v2, s[16:19], s49 offen lds
 v_mfma_f32_16x16x32_bf16 v[104:107], a[84:87], a[20:23], v[104:107]
 s_add_u32 s59, s56, 49152
 v_cvt_pk_bf16_f32 v58, v60, v61
 v_cvt_pk_bf16_f32 v59, v62, v63
 v_mfma_f32_16x16x32_bf16 v[108:111], a[92:95], a[20:23], v[108:111]
 buffer_store_dwordx4 v[40:43], v1, s[12:15], s59 offen offset:2048 sc1
 v_mfma_f32_16x16x32_bf16 v[108:111], a[88:91], a[16:19], v[108:111]
 v_cvt_pk_bf16_f32 v64, v64, v65
 v_cvt_pk_bf16_f32 v65, v66, v67
 v_mfma_f32_16x16x32_bf16 v[116:119], a[88:91], a[24:27], v[116:119]
 s_add_u32 m0, s29, 45056
 v_cvt_pk_bf16_f32 v66, v68, v69
 v_cvt_pk_bf16_f32 v67, v70, v71
 v_mfma_f32_16x16x32_bf16 v[116:119], a[92:95], a[28:31], v[116:119]
 buffer_load_dwordx4 v2, s[16:19], s50 offen lds
 v_mfma_f32_16x16x32_bf16 v[112:115], a[84:87], a[28:31], v[112:115]
 v_cvt_pk_bf16_f32 v72, v72, v73
 v_cvt_pk_bf16_f32 v73, v74, v75
 v_mfma_f32_16x16x32_bf16 v[112:115], a[80:83], a[24:27], v[112:115]
 v_cvt_pk_bf16_f32 v74, v76, v77
 v_cvt_pk_bf16_f32 v75, v78, v79
 v_mfma_f32_16x16x32_bf16 v[124:127], a[72:75], a[24:27], v[124:127]
 v_cvt_pk_bf16_f32 v80, v80, v81
 v_cvt_pk_bf16_f32 v81, v82, v83
 v_mfma_f32_16x16x32_bf16 v[124:127], a[76:79], a[28:31], v[124:127]
 s_add_u32 m0, s29, 49152
 v_cvt_pk_bf16_f32 v82, v84, v85
 v_cvt_pk_bf16_f32 v83, v86, v87
 v_mfma_f32_16x16x32_bf16 v[120:123], a[68:71], a[28:31], v[120:123]
 buffer_load_dwordx4 v2, s[16:19], s51 offen lds
 v_mfma_f32_16x16x32_bf16 v[120:123], a[64:67], a[24:27], v[120:123]
 s_add_u32 s59, s56, 32768
 v_cvt_pk_bf16_f32 v88, v88, v89
 v_cvt_pk_bf16_f32 v89, v90, v91
 v_mfma_f32_16x16x32_bf16 v[128:131], a[64:67], a[32:35], v[128:131]
 buffer_store_dwordx4 v[36:39], v1, s[12:15], s59 offen offset:1024 sc1
 v_mfma_f32_16x16x32_bf16 v[128:131], a[68:71], a[36:39], v[128:131]
 v_cvt_pk_bf16_f32 v90, v92, v93
 v_cvt_pk_bf16_f32 v91, v94, v95
 v_mfma_f32_16x16x32_bf16 v[132:135], a[76:79], a[36:39], v[132:135]
 s_add_u32 m0, s29, 53248
 v_cvt_pk_bf16_f32 v96, v96, v97
 v_cvt_pk_bf16_f32 v97, v98, v99
 v_mfma_f32_16x16x32_bf16 v[132:135], a[72:75], a[32:35], v[132:135]
 buffer_load_dwordx4 v2, s[16:19], s52 offen lds
 v_mfma_f32_16x16x32_bf16 v[136:139], a[80:83], a[32:35], v[136:139]
 v_cvt_pk_bf16_f32 v98, v100, v101
 v_cvt_pk_bf16_f32 v99, v102, v103
 v_mfma_f32_16x16x32_bf16 v[136:139], a[84:87], a[36:39], v[136:139]
 v_cvt_pk_bf16_f32 v104, v104, v105
 v_cvt_pk_bf16_f32 v105, v106, v107
 v_mfma_f32_16x16x32_bf16 v[140:143], a[92:95], a[36:39], v[140:143]
 v_cvt_pk_bf16_f32 v106, v108, v109
 v_cvt_pk_bf16_f32 v107, v110, v111
 v_mfma_f32_16x16x32_bf16 v[140:143], a[88:91], a[32:35], v[140:143]
 s_add_u32 m0, s29, 57344
 v_cvt_pk_bf16_f32 v112, v112, v113
 v_cvt_pk_bf16_f32 v113, v114, v115
 v_mfma_f32_16x16x32_bf16 v[148:151], a[88:91], a[40:43], v[148:151]
 buffer_load_dwordx4 v2, s[16:19], s53 offen lds
 v_mfma_f32_16x16x32_bf16 v[148:151], a[92:95], a[44:47], v[148:151]
 s_add_u32 s59, s56, 49152
 v_cvt_pk_bf16_f32 v114, v116, v117
 v_cvt_pk_bf16_f32 v115, v118, v119
 v_mfma_f32_16x16x32_bf16 v[144:147], a[84:87], a[44:47], v[144:147]
 buffer_store_dwordx4 v[48:51], v1, s[12:15], s59 offen offset:3072 sc1
 v_mfma_f32_16x16x32_bf16 v[144:147], a[80:83], a[40:43], v[144:147]
 v_cvt_pk_bf16_f32 v120, v120, v121
 v_cvt_pk_bf16_f32 v121, v122, v123
 v_mfma_f32_16x16x32_bf16 v[156:159], a[72:75], a[40:43], v[156:159]
 s_add_u32 m0, s29, 61440
 v_cvt_pk_bf16_f32 v122, v124, v125
 v_cvt_pk_bf16_f32 v123, v126, v127
 v_mfma_f32_16x16x32_bf16 v[156:159], a[76:79], a[44:47], v[156:159]
 buffer_load_dwordx4 v2, s[16:19], s54 offen lds
 v_mfma_f32_16x16x32_bf16 v[152:155], a[68:71], a[44:47], v[152:155]
 v_cvt_pk_bf16_f32 v128, v128, v129
 v_cvt_pk_bf16_f32 v129, v130, v131
 v_mfma_f32_16x16x32_bf16 v[152:155], a[64:67], a[40:43], v[152:155]
 v_cvt_pk_bf16_f32 v130, v132, v133
 v_cvt_pk_bf16_f32 v131, v134, v135
 v_mfma_f32_16x16x32_bf16 v[160:163], a[64:67], a[48:51], v[160:163]
 s_add_u32 m0, s29, 98304
 v_add_u32 v2, 0x80000, v2
 v_cvt_pk_bf16_f32 v136, v136, v137
 v_mfma_f32_16x16x32_bf16 v[160:163], a[68:71], a[52:55], v[160:163]
 buffer_load_dwordx4 v2, s[16:19], 0 offen lds
 v_mfma_f32_16x16x32_bf16 v[164:167], a[76:79], a[52:55], v[164:167]
 s_add_u32 s59, s56, 32768
 v_cvt_pk_bf16_f32 v137, v138, v139
 v_cvt_pk_bf16_f32 v138, v140, v141
 v_mfma_f32_16x16x32_bf16 v[164:167], a[72:75], a[48:51], v[164:167]
 buffer_store_dwordx4 v[56:59], v1, s[12:15], s59 offen offset:3072 sc1
 v_mfma_f32_16x16x32_bf16 v[168:171], a[80:83], a[48:51], v[168:171]
 v_cvt_pk_bf16_f32 v139, v142, v143
 v_cvt_pk_bf16_f32 v144, v144, v145
 v_mfma_f32_16x16x32_bf16 v[168:171], a[84:87], a[52:55], v[168:171]
 s_add_u32 m0, s29, 102400
 v_cvt_pk_bf16_f32 v145, v146, v147
 v_cvt_pk_bf16_f32 v146, v148, v149
 v_mfma_f32_16x16x32_bf16 v[172:175], a[92:95], a[52:55], v[172:175]
 buffer_load_dwordx4 v2, s[16:19], s48 offen lds
 v_mfma_f32_16x16x32_bf16 v[172:175], a[88:91], a[48:51], v[172:175]
 v_cvt_pk_bf16_f32 v147, v150, v151
 v_cvt_pk_bf16_f32 v152, v152, v153
 v_mfma_f32_16x16x32_bf16 v[180:183], a[88:91], a[56:59], v[180:183]
 v_cvt_pk_bf16_f32 v153, v154, v155
 v_cvt_pk_bf16_f32 v154, v156, v157
 v_mfma_f32_16x16x32_bf16 v[180:183], a[92:95], a[60:63], v[180:183]
 v_cvt_pk_bf16_f32 v155, v158, v159
 v_mfma_f32_16x16x32_bf16 v[176:179], a[84:87], a[60:63], v[176:179]
 s_add_u32 m0, s29, 106496
 v_mfma_f32_16x16x32_bf16 v[176:179], a[80:83], a[56:59], v[176:179]
 buffer_load_dwordx4 v2, s[16:19], s49 offen lds
 v_mfma_f32_16x16x32_bf16 v[188:191], a[72:75], a[56:59], v[188:191]
 s_add_u32 s59, s56, 0
 v_cvt_pk_bf16_f32 v160, v160, v161
 v_cvt_pk_bf16_f32 v161, v162, v163
 v_mfma_f32_16x16x32_bf16 v[188:191], a[76:79], a[60:63], v[188:191]
 buffer_store_dwordx4 v[64:67], v1, s[12:15], s59 offen offset:0 sc1
 v_mfma_f32_16x16x32_bf16 v[184:187], a[68:71], a[60:63], v[184:187]
 v_cvt_pk_bf16_f32 v162, v164, v165
 v_cvt_pk_bf16_f32 v163, v166, v167
 v_mfma_f32_16x16x32_bf16 v[184:187], a[64:67], a[56:59], v[184:187]
 s_add_u32 m0, s29, 110592
 v_cvt_pk_bf16_f32 v168, v168, v169
 v_cvt_pk_bf16_f32 v169, v170, v171
 v_mfma_f32_16x16x32_bf16 v[192:195], a[96:99], a[32:35], v[192:195]
 buffer_load_dwordx4 v2, s[16:19], s50 offen lds
 v_mfma_f32_16x16x32_bf16 v[192:195], a[100:103], a[36:39], v[192:195]
 v_cvt_pk_bf16_f32 v170, v172, v173
 v_cvt_pk_bf16_f32 v171, v174, v175
 v_mfma_f32_16x16x32_bf16 v[196:199], a[108:111], a[36:39], v[196:199]
 v_mfma_f32_16x16x32_bf16 v[196:199], a[104:107], a[32:35], v[196:199]
 v_cvt_pk_bf16_f32 v176, v176, v177
 v_cvt_pk_bf16_f32 v177, v178, v179
 v_mfma_f32_16x16x32_bf16 v[200:203], a[112:115], a[32:35], v[200:203]
 s_add_u32 m0, s29, 114688
 v_cvt_pk_bf16_f32 v178, v180, v181
 v_cvt_pk_bf16_f32 v179, v182, v183
 v_mfma_f32_16x16x32_bf16 v[200:203], a[116:119], a[36:39], v[200:203]
 buffer_load_dwordx4 v2, s[16:19], s51 offen lds
 v_mfma_f32_16x16x32_bf16 v[204:207], a[124:127], a[36:39], v[204:207]
 s_add_u32 s59, s56, 16384
 v_mfma_f32_16x16x32_bf16 v[204:207], a[120:123], a[32:35], v[204:207]
 buffer_store_dwordx4 v[72:75], v1, s[12:15], s59 offen offset:0 sc1
 v_mfma_f32_16x16x32_bf16 v[212:215], a[120:123], a[40:43], v[212:215]
 v_cvt_pk_bf16_f32 v184, v184, v185
 v_cvt_pk_bf16_f32 v185, v186, v187
 v_mfma_f32_16x16x32_bf16 v[212:215], a[124:127], a[44:47], v[212:215]
 s_add_u32 m0, s29, 118784
 v_cvt_pk_bf16_f32 v186, v188, v189
 v_cvt_pk_bf16_f32 v187, v190, v191
 v_mfma_f32_16x16x32_bf16 v[208:211], a[116:119], a[44:47], v[208:211]
 buffer_load_dwordx4 v2, s[16:19], s52 offen lds
 v_mfma_f32_16x16x32_bf16 v[208:211], a[112:115], a[40:43], v[208:211]
 v_cvt_pk_bf16_f32 v192, v192, v193
 v_cvt_pk_bf16_f32 v193, v194, v195
 v_mfma_f32_16x16x32_bf16 v[220:223], a[104:107], a[40:43], v[220:223]
 v_cvt_pk_bf16_f32 v194, v196, v197
 v_cvt_pk_bf16_f32 v195, v198, v199
 v_mfma_f32_16x16x32_bf16 v[220:223], a[108:111], a[44:47], v[220:223]
 v_mfma_f32_16x16x32_bf16 v[216:219], a[100:103], a[44:47], v[216:219]
 s_add_u32 m0, s29, 122880
 v_mfma_f32_16x16x32_bf16 v[216:219], a[96:99], a[40:43], v[216:219]
 buffer_load_dwordx4 v2, s[16:19], s53 offen lds
 v_mfma_f32_16x16x32_bf16 v[224:227], a[96:99], a[48:51], v[224:227]
 s_add_u32 s59, s56, 16384
 v_cvt_pk_bf16_f32 v200, v200, v201
 v_cvt_pk_bf16_f32 v201, v202, v203
 v_mfma_f32_16x16x32_bf16 v[224:227], a[100:103], a[52:55], v[224:227]
 s_waitcnt vmcnt(25)
 buffer_store_dwordx4 v[80:83], v1, s[12:15], s59 offen offset:1024 sc1
 v_mfma_f32_16x16x32_bf16 v[228:231], a[108:111], a[52:55], v[228:231]
 s_barrier
 v_xor_b32 v7, 0, v6
 v_cvt_pk_bf16_f32 v202, v204, v205
 v_mfma_f32_16x16x32_bf16 v[228:231], a[104:107], a[48:51], v[228:231]
 s_add_u32 m0, s29, 126976
 ds_read_b64_tr_b16 a[64:65], v7 offset:0
 v_cvt_pk_bf16_f32 v203, v206, v207
 v_mfma_f32_16x16x32_bf16 v[232:235], a[112:115], a[48:51], v[232:235]
 ds_read_b64_tr_b16 a[66:67], v7 offset:4096
 buffer_load_dwordx4 v2, s[16:19], s54 offen lds
 v_mfma_f32_16x16x32_bf16 v[232:235], a[116:119], a[52:55], v[232:235]
 ds_read_b64_tr_b16 a[68:69], v7 offset:16384
 v_cvt_pk_bf16_f32 v208, v208, v209
 v_mfma_f32_16x16x32_bf16 v[236:239], a[124:127], a[52:55], v[236:239]
 ds_read_b64_tr_b16 a[70:71], v7 offset:20480
 v_xor_b32 v8, 65536, v6
 v_mfma_f32_16x16x32_bf16 v[236:239], a[120:123], a[48:51], v[236:239]
 s_add_u32 s59, s56, 0
 ds_read_b64_tr_b16 a[72:73], v8 offset:0
 v_cvt_pk_bf16_f32 v209, v210, v211
 v_mfma_f32_16x16x32_bf16 v[244:247], a[120:123], a[56:59], v[244:247]
 ds_read_b64_tr_b16 a[74:75], v8 offset:4096
 buffer_store_dwordx4 v[88:91], v1, s[12:15], s59 offen offset:1024 sc1
 v_mfma_f32_16x16x32_bf16 v[244:247], a[124:127], a[60:63], v[244:247]
 ds_read_b64_tr_b16 a[76:77], v8 offset:16384
 v_cvt_pk_bf16_f32 v210, v212, v213
 v_mfma_f32_16x16x32_bf16 v[240:243], a[116:119], a[60:63], v[240:243]
 ds_read_b64_tr_b16 a[78:79], v8 offset:20480
 v_xor_b32 v9, 32, v6
 v_mfma_f32_16x16x32_bf16 v[240:243], a[112:115], a[56:59], v[240:243]
 ds_read_b64_tr_b16 a[80:81], v9 offset:0
 v_cvt_pk_bf16_f32 v211, v214, v215
 v_mfma_f32_16x16x32_bf16 v[252:255], a[104:107], a[56:59], v[252:255]
 ds_read_b64_tr_b16 a[82:83], v9 offset:4096
 v_cvt_pk_bf16_f32 v216, v216, v217
 v_mfma_f32_16x16x32_bf16 v[252:255], a[108:111], a[60:63], v[252:255]
 ds_read_b64_tr_b16 a[84:85], v9 offset:16384
 v_cvt_pk_bf16_f32 v217, v218, v219
 v_mfma_f32_16x16x32_bf16 v[248:251], a[100:103], a[60:63], v[248:251]
 s_add_u32 s59, s56, 0
 ds_read_b64_tr_b16 a[86:87], v9 offset:20480
 v_xor_b32 v10, 65568, v6
 v_mfma_f32_16x16x32_bf16 v[248:251], a[96:99], a[56:59], v[248:251]
 s_waitcnt lgkmcnt(6)
 ds_read_b64_tr_b16 a[88:89], v10 offset:0
 buffer_store_dwordx4 v[96:99], v1, s[12:15], s59 offen offset:2048 sc1
 v_mfma_f32_16x16x32_bf16 v[28:31], a[64:67], a[128:131], 0
 ds_read_b64_tr_b16 a[90:91], v10 offset:4096
 v_cvt_pk_bf16_f32 v218, v220, v221
 v_mfma_f32_16x16x32_bf16 v[28:31], a[68:71], a[136:139], v[28:31]
 ds_read_b64_tr_b16 a[92:93], v10 offset:16384
 v_xor_b32 v7, 64, v6
 v_mfma_f32_16x16x32_bf16 v[28:31], a[72:75], a[144:147], v[28:31]
 s_waitcnt lgkmcnt(7)
 ds_read_b128 a[112:115], v14 offset:0
 ds_read_b64_tr_b16 a[94:95], v10 offset:20480
 v_mfma_f32_16x16x32_bf16 v[28:31], a[76:79], a[152:155], v[28:31]
 ds_read_b64_tr_b16 a[96:97], v7 offset:0
 v_cvt_pk_bf16_f32 v219, v222, v223
 v_mfma_f32_16x16x32_bf16 v[44:47], a[64:67], a[132:135], 0
 ds_read_b128 a[120:123], v3 offset:0
 ds_read_b64_tr_b16 a[98:99], v7 offset:4096
 v_mfma_f32_16x16x32_bf16 v[44:47], a[68:71], a[140:143], v[44:47]
 s_add_u32 s59, s56, 16384
 ds_read_b64_tr_b16 a[100:101], v7 offset:16384
 v_xor_b32 v8, 65600, v6
 v_mfma_f32_16x16x32_bf16 v[44:47], a[72:75], a[148:151], v[44:47]
 ds_read_b128 a[116:119], v14 offset:2048
 ds_read_b64_tr_b16 a[102:103], v7 offset:20480
 buffer_store_dwordx4 v[104:107], v1, s[12:15], s59 offen offset:2048 sc1
 v_mfma_f32_16x16x32_bf16 v[44:47], a[76:79], a[156:159], v[44:47]
 s_waitcnt lgkmcnt(9)
 ds_read_b64_tr_b16 a[104:105], v8 offset:0
 v_cvt_pk_bf16_f32 v224, v224, v225
 v_mfma_f32_16x16x32_bf16 v[52:55], a[80:83], a[128:131], 0
 ds_read_b128 a[124:127], v3 offset:2048
 ds_read_b64_tr_b16 a[106:107], v8 offset:4096
 v_mfma_f32_16x16x32_bf16 v[52:55], a[84:87], a[136:139], v[52:55]
 ds_read_b64_tr_b16 a[108:109], v8 offset:16384
 v_cvt_pk_bf16_f32 v225, v226, v227
 v_mfma_f32_16x16x32_bf16 v[52:55], a[88:91], a[144:147], v[52:55]
 s_waitcnt lgkmcnt(10)
 ds_read_b64_tr_b16 a[110:111], v8 offset:20480
 v_xor_b32 v9, 96, v6
 v_mfma_f32_16x16x32_bf16 v[52:55], a[92:95], a[152:155], v[52:55]
 ds_read_b64_tr_b16 a[64:65], v9 offset:0
 v_cvt_pk_bf16_f32 v226, v228, v229
 v_mfma_f32_16x16x32_bf16 v[60:63], a[80:83], a[132:135], 0
 s_add_u32 s59, s56, 16384
 ds_read_b64_tr_b16 a[66:67], v9 offset:4096
 v_cvt_pk_bf16_f32 v227, v230, v231
 v_mfma_f32_16x16x32_bf16 v[60:63], a[84:87], a[140:143], v[60:63]
 ds_read_b64_tr_b16 a[68:69], v9 offset:16384
 buffer_store_dwordx4 v[112:115], v1, s[12:15], s59 offen offset:3072 sc1
 v_mfma_f32_16x16x32_bf16 v[60:63], a[88:91], a[148:151], v[60:63]
 ds_read_b64_tr_b16 a[70:71], v9 offset:20480
 v_xor_b32 v10, 65632, v6
 v_mfma_f32_16x16x32_bf16 v[60:63], a[92:95], a[156:159], v[60:63]
 s_waitcnt lgkmcnt(6)
 ds_read_b64_tr_b16 a[72:73], v10 offset:0
 v_cvt_pk_bf16_f32 v232, v232, v233
 v_mfma_f32_16x16x32_bf16 v[20:23], a[96:99], a[128:131], 0
 ds_read_b64_tr_b16 a[74:75], v10 offset:4096
 v_cvt_pk_bf16_f32 v233, v234, v235
 v_mfma_f32_16x16x32_bf16 v[20:23], a[100:103], a[136:139], v[20:23]
 s_waitcnt lgkmcnt(8)
 ds_read_b64_tr_b16 a[76:77], v10 offset:16384
 v_xor_b32 v7, 128, v6
 v_mfma_f32_16x16x32_bf16 v[20:23], a[104:107], a[144:147], v[20:23]
 s_waitcnt lgkmcnt(7)
 s_barrier
 ds_read_b64_tr_b16 a[78:79], v10 offset:20480
 v_mfma_f32_16x16x32_bf16 v[20:23], a[108:111], a[152:155], v[20:23]
 s_add_u32 m0, s29, 131072
 ds_read_b64_tr_b16 a[80:81], v7 offset:0
 v_add_u32 v2, 0x80000, v2
 v_mfma_f32_16x16x32_bf16 v[36:39], a[96:99], a[132:135], 0
 ds_read_b64_tr_b16 a[82:83], v7 offset:4096
 buffer_load_dwordx4 v2, s[16:19], 0 offen lds
 v_mfma_f32_16x16x32_bf16 v[36:39], a[100:103], a[140:143], v[36:39]
 ds_read_b64_tr_b16 a[84:85], v7 offset:16384
 v_cvt_pk_bf16_f32 v234, v236, v237
 v_mfma_f32_16x16x32_bf16 v[36:39], a[104:107], a[148:151], v[36:39]
 s_add_u32 s59, s56, 0
 ds_read_b64_tr_b16 a[86:87], v7 offset:20480
 v_xor_b32 v8, 65664, v6
 v_mfma_f32_16x16x32_bf16 v[36:39], a[108:111], a[156:159], v[36:39]
 s_waitcnt lgkmcnt(6)
 ds_read_b64_tr_b16 a[88:89], v8 offset:0
 buffer_store_dwordx4 v[120:123], v1, s[12:15], s59 offen offset:3072 sc1
 v_mfma_f32_16x16x32_bf16 v[68:71], a[64:67], a[128:131], 0
 ds_read_b64_tr_b16 a[90:91], v8 offset:4096
 v_cvt_pk_bf16_f32 v235, v238, v239
 v_mfma_f32_16x16x32_bf16 v[68:71], a[68:71], a[136:139], v[68:71]
 s_add_u32 m0, s29, 135168
 ds_read_b64_tr_b16 a[92:93], v8 offset:16384
 v_cvt_pk_bf16_f32 v240, v240, v241
 v_mfma_f32_16x16x32_bf16 v[68:71], a[72:75], a[144:147], v[68:71]
 s_waitcnt lgkmcnt(7)
 ds_read_b64_tr_b16 a[94:95], v8 offset:20480
 v_xor_b32 v9, 160, v6
 v_mfma_f32_16x16x32_bf16 v[68:71], a[76:79], a[152:155], v[68:71]
 ds_read_b64_tr_b16 a[96:97], v9 offset:0
 buffer_load_dwordx4 v2, s[16:19], s48 offen lds
 v_mfma_f32_16x16x32_bf16 v[76:79], a[64:67], a[132:135], 0
 ds_read_b64_tr_b16 a[98:99], v9 offset:4096
 v_cvt_pk_bf16_f32 v241, v242, v243
 v_mfma_f32_16x16x32_bf16 v[76:79], a[68:71], a[140:143], v[76:79]
 ds_read_b64_tr_b16 a[100:101], v9 offset:16384
 v_cvt_pk_bf16_f32 v242, v244, v245
 v_mfma_f32_16x16x32_bf16 v[76:79], a[72:75], a[148:151], v[76:79]
 s_add_u32 s59, s56, 4096
 ds_read_b64_tr_b16 a[102:103], v9 offset:20480
 v_xor_b32 v10, 65696, v6
 v_mfma_f32_16x16x32_bf16 v[76:79], a[76:79], a[156:159], v[76:79]
 s_waitcnt lgkmcnt(6)
 ds_read_b64_tr_b16 a[104:105], v10 offset:0
 buffer_store_dwordx4 v[128:131], v1, s[12:15], s59 offen offset:0 sc1
 v_mfma_f32_16x16x32_bf16 v[84:87], a[80:83], a[128:131], 0
 s_add_u32 m0, s29, 139264
 ds_read_b64_tr_b16 a[106:107], v10 offset:4096
 v_cvt_pk_bf16_f32 v243, v246, v247
 v_mfma_f32_16x16x32_bf16 v[84:87], a[84:87], a[136:139], v[84:87]
 ds_read_b64_tr_b16 a[108:109], v10 offset:16384
 buffer_load_dwordx4 v2, s[16:19], s49 offen lds
 v_mfma_f32_16x16x32_bf16 v[84:87], a[88:91], a[144:147], v[84:87]
 s_waitcnt lgkmcnt(7)
 ds_read_b64_tr_b16 a[110:111], v10 offset:20480
 v_xor_b32 v7, 192, v6
 v_mfma_f32_16x16x32_bf16 v[84:87], a[92:95], a[152:155], v[84:87]
 ds_read_b64_tr_b16 a[64:65], v7 offset:0
 v_cvt_pk_bf16_f32 v248, v248, v249
 v_mfma_f32_16x16x32_bf16 v[92:95], a[80:83], a[132:135], 0
 ds_read_b64_tr_b16 a[66:67], v7 offset:4096
 v_cvt_pk_bf16_f32 v249, v250, v251
 v_mfma_f32_16x16x32_bf16 v[92:95], a[84:87], a[140:143], v[92:95]
 ds_read_b64_tr_b16 a[68:69], v7 offset:16384
 v_cvt_pk_bf16_f32 v250, v252, v253
 v_mfma_f32_16x16x32_bf16 v[92:95], a[88:91], a[148:151], v[92:95]
 s_add_u32 m0, s29, 143360
 ds_read_b64_tr_b16 a[70:71], v7 offset:20480
 v_xor_b32 v8, 65728, v6
 v_mfma_f32_16x16x32_bf16 v[92:95], a[92:95], a[156:159], v[92:95]
 s_waitcnt lgkmcnt(6)
 ds_read_b64_tr_b16 a[72:73], v8 offset:0
 buffer_load_dwordx4 v2, s[16:19], s50 offen lds
 v_mfma_f32_16x16x32_bf16 v[100:103], a[96:99], a[128:131], 0
 s_add_u32 s59, s56, 20480
 ds_read_b64_tr_b16 a[74:75], v8 offset:4096
 v_cvt_pk_bf16_f32 v251, v254, v255
 v_mfma_f32_16x16x32_bf16 v[100:103], a[100:103], a[136:139], v[100:103]
 ds_read_b64_tr_b16 a[76:77], v8 offset:16384
 buffer_store_dwordx4 v[136:139], v1, s[12:15], s59 offen offset:0 sc1
 v_mfma_f32_16x16x32_bf16 v[100:103], a[104:107], a[144:147], v[100:103]
 s_waitcnt lgkmcnt(7)
 ds_read_b64_tr_b16 a[78:79], v8 offset:20480
 v_xor_b32 v9, 224, v6
 v_mfma_f32_16x16x32_bf16 v[100:103], a[108:111], a[152:155], v[100:103]
 s_and_b32 s36, s95, 31
 ds_read_b64_tr_b16 a[80:81], v9 offset:0
 v_accvgpr_read_b32 v11, a245
 v_mfma_f32_16x16x32_bf16 v[108:111], a[96:99], a[132:135], 0
 s_add_u32 m0, s29, 147456
 ds_read_b64_tr_b16 a[82:83], v9 offset:4096
 v_mov_b32 v12, 0
 v_mfma_f32_16x16x32_bf16 v[108:111], a[100:103], a[140:143], v[108:111]
 ds_read_b64_tr_b16 a[84:85], v9 offset:16384
 buffer_load_dwordx4 v2, s[16:19], s51 offen lds
 v_mfma_f32_16x16x32_bf16 v[108:111], a[104:107], a[148:151], v[108:111]
 s_add_u32 s59, s56, 20480
 ds_read_b64_tr_b16 a[86:87], v9 offset:20480
 v_xor_b32 v10, 65760, v6
 v_mfma_f32_16x16x32_bf16 v[108:111], a[108:111], a[156:159], v[108:111]
 s_waitcnt lgkmcnt(6)
 ds_read_b64_tr_b16 a[88:89], v10 offset:0
 v_and_b32 v14, 15, v0
 v_mfma_f32_16x16x32_bf16 v[116:119], a[64:67], a[128:131], 0
 ds_read_b64_tr_b16 a[90:91], v10 offset:4096
 buffer_store_dwordx4 v[144:147], v1, s[12:15], s59 offen offset:1024 sc1
 v_mfma_f32_16x16x32_bf16 v[116:119], a[68:71], a[136:139], v[116:119]
 s_add_u32 m0, s29, 151552
 ds_read_b64_tr_b16 a[92:93], v10 offset:16384
 v_lshrrev_b32 v3, 4, v0
 v_mfma_f32_16x16x32_bf16 v[116:119], a[72:75], a[144:147], v[116:119]
 s_waitcnt lgkmcnt(7)
 ds_read_b64_tr_b16 a[94:95], v10 offset:20480
 v_xor_b32 v7, 256, v6
 v_mfma_f32_16x16x32_bf16 v[116:119], a[76:79], a[152:155], v[116:119]
 ds_read_b64_tr_b16 a[96:97], v7 offset:0
 buffer_load_dwordx4 v2, s[16:19], s52 offen lds
 v_mfma_f32_16x16x32_bf16 v[124:127], a[64:67], a[132:135], 0
 s_lshr_b32 s37, s95, 5
 ds_read_b64_tr_b16 a[98:99], v7 offset:4096
 v_lshlrev_b32 v3, 2, v3
 v_mfma_f32_16x16x32_bf16 v[124:127], a[68:71], a[140:143], v[124:127]
 ds_read_b64_tr_b16 a[100:101], v7 offset:16384
 global_load_dword v5, v12, s[90:91] offset:128 sc1
 v_mfma_f32_16x16x32_bf16 v[124:127], a[72:75], a[148:151], v[124:127]
 s_add_u32 s59, s56, 4096
 ds_read_b64_tr_b16 a[102:103], v7 offset:20480
 v_xor_b32 v8, 65792, v6
 v_mfma_f32_16x16x32_bf16 v[124:127], a[76:79], a[156:159], v[124:127]
 s_waitcnt lgkmcnt(6)
 ds_read_b64_tr_b16 a[104:105], v8 offset:0
 buffer_store_dwordx4 v[152:155], v1, s[12:15], s59 offen offset:1024 sc1
 v_mfma_f32_16x16x32_bf16 v[132:135], a[80:83], a[128:131], 0
 s_add_u32 m0, s29, 155648
 ds_read_b64_tr_b16 a[106:107], v8 offset:4096
 v_and_b32 v12, 11, v0
 v_mfma_f32_16x16x32_bf16 v[132:135], a[84:87], a[136:139], v[132:135]
 ds_read_b64_tr_b16 a[108:109], v8 offset:16384
 buffer_load_dwordx4 v2, s[16:19], s53 offen lds
 v_mfma_f32_16x16x32_bf16 v[132:135], a[88:91], a[144:147], v[132:135]
 s_waitcnt lgkmcnt(7)
 ds_read_b64_tr_b16 a[110:111], v8 offset:20480
 v_xor_b32 v9, 288, v6
 v_mfma_f32_16x16x32_bf16 v[132:135], a[92:95], a[152:155], v[132:135]
 s_lshl_b32 s38, s3, 4
 ds_read_b64_tr_b16 a[64:65], v9 offset:0
 v_lshlrev_b32 v12, 2, v12
 v_mfma_f32_16x16x32_bf16 v[140:143], a[80:83], a[132:135], 0
 s_lshl_b32 s39, s36, 6
 ds_read_b64_tr_b16 a[66:67], v9 offset:4096
 v_sub_u32 v14, v14, v3
 v_mfma_f32_16x16x32_bf16 v[140:143], a[84:87], a[140:143], v[140:143]
 s_add_u32 s38, s38, s39
 ds_read_b64_tr_b16 a[68:69], v9 offset:16384
 v_lshrrev_b32_e64 v3, 6, s29
 v_mfma_f32_16x16x32_bf16 v[140:143], a[88:91], a[148:151], v[140:143]
 s_add_u32 m0, s29, 159744
 ds_read_b64_tr_b16 a[70:71], v9 offset:20480
 v_xor_b32 v10, 65824, v6
 v_mfma_f32_16x16x32_bf16 v[140:143], a[92:95], a[156:159], v[140:143]
 s_waitcnt lgkmcnt(6)
 ds_read_b64_tr_b16 a[72:73], v10 offset:0
 buffer_load_dwordx4 v2, s[16:19], s54 offen lds
 v_mfma_f32_16x16x32_bf16 v[148:151], a[96:99], a[128:131], 0
 s_add_u32 s59, s56, 4096
 ds_read_b64_tr_b16 a[74:75], v10 offset:4096
 v_add_u32 v14, v3, v14
 v_mfma_f32_16x16x32_bf16 v[148:151], a[100:103], a[136:139], v[148:151]
 ds_read_b64_tr_b16 a[76:77], v10 offset:16384
 buffer_store_dwordx4 v[160:163], v1, s[12:15], s59 offen offset:2048 sc1
 v_mfma_f32_16x16x32_bf16 v[148:151], a[104:107], a[144:147], v[148:151]
 s_waitcnt lgkmcnt(7)
 ds_read_b64_tr_b16 a[78:79], v10 offset:20480
 v_xor_b32 v7, 320, v6
 v_mfma_f32_16x16x32_bf16 v[148:151], a[108:111], a[152:155], v[148:151]
 s_mul_i32 s38, s38, 896
 ds_read_b64_tr_b16 a[80:81], v7 offset:0
 v_mov_b32 v15, 0xf149f2ca
 v_mfma_f32_16x16x32_bf16 v[156:159], a[96:99], a[132:135], 0
 s_lshl_b32 s39, s37, 7
 ds_read_b64_tr_b16 a[82:83], v7 offset:4096
 v_cmp_gt_i32 vcc, 0, v14
 v_mfma_f32_16x16x32_bf16 v[156:159], a[100:103], a[140:143], v[156:159]
 s_add_u32 s38, s38, s39
 ds_read_b64_tr_b16 a[84:85], v7 offset:16384
 v_cndmask_b32 v3, 0, v15, vcc
 v_mfma_f32_16x16x32_bf16 v[156:159], a[104:107], a[148:151], v[156:159]
 s_add_u32 s59, s56, 20480
 ds_read_b64_tr_b16 a[86:87], v7 offset:20480
 v_xor_b32 v8, 65856, v6
 v_mfma_f32_16x16x32_bf16 v[156:159], a[108:111], a[156:159], v[156:159]
 s_waitcnt lgkmcnt(6)
 ds_read_b64_tr_b16 a[88:89], v8 offset:0
 v_accvgpr_write_b32 a224, v3
 v_mfma_f32_16x16x32_bf16 v[164:167], a[64:67], a[128:131], 0
 ds_read_b64_tr_b16 a[90:91], v8 offset:4096
 buffer_store_dwordx4 v[168:171], v1, s[12:15], s59 offen offset:2048 sc1
 v_mfma_f32_16x16x32_bf16 v[164:167], a[68:71], a[136:139], v[164:167]
 s_lshl_b32 s39, s37, 9
 ds_read_b64_tr_b16 a[92:93], v8 offset:16384
 v_cmp_gt_i32 vcc, 1, v14
 v_mfma_f32_16x16x32_bf16 v[164:167], a[72:75], a[144:147], v[164:167]
 s_waitcnt lgkmcnt(7)
 ds_read_b64_tr_b16 a[94:95], v8 offset:20480
 v_xor_b32 v9, 352, v6
 v_mfma_f32_16x16x32_bf16 v[164:167], a[76:79], a[152:155], v[164:167]
 s_mov_b32 s4, s66
 ds_read_b64_tr_b16 a[96:97], v9 offset:0
 v_cndmask_b32 v3, 0, v15, vcc
 v_mfma_f32_16x16x32_bf16 v[172:175], a[64:67], a[132:135], 0
 s_mov_b32 s5, s67
 ds_read_b64_tr_b16 a[98:99], v9 offset:4096
 v_accvgpr_write_b32 a225, v3
 v_mfma_f32_16x16x32_bf16 v[172:175], a[68:71], a[140:143], v[172:175]
 s_mov_b32 s6, 1835008
 ds_read_b64_tr_b16 a[100:101], v9 offset:16384
 v_cmp_gt_i32 vcc, 2, v14
 v_mfma_f32_16x16x32_bf16 v[172:175], a[72:75], a[148:151], v[172:175]
 s_add_u32 s59, s56, 20480
 ds_read_b64_tr_b16 a[102:103], v9 offset:20480
 v_xor_b32 v10, 65888, v6
 v_mfma_f32_16x16x32_bf16 v[172:175], a[76:79], a[156:159], v[172:175]
 s_waitcnt lgkmcnt(6)
 ds_read_b64_tr_b16 a[104:105], v10 offset:0
 buffer_store_dwordx4 v[176:179], v1, s[12:15], s59 offen offset:3072 sc1
 v_mfma_f32_16x16x32_bf16 v[180:183], a[80:83], a[128:131], 0
 s_mov_b32 s7, 0x20000
 ds_read_b64_tr_b16 a[106:107], v10 offset:4096
 v_cndmask_b32 v3, 0, v15, vcc
 v_mfma_f32_16x16x32_bf16 v[180:183], a[84:87], a[136:139], v[180:183]
 s_mov_b32 s8, s68
 ds_read_b64_tr_b16 a[108:109], v10 offset:16384
 v_accvgpr_write_b32 a226, v3
 v_mfma_f32_16x16x32_bf16 v[180:183], a[88:91], a[144:147], v[180:183]
 s_waitcnt lgkmcnt(7)
 ds_read_b64_tr_b16 a[110:111], v10 offset:20480
 v_xor_b32 v7, 384, v6
 v_mfma_f32_16x16x32_bf16 v[180:183], a[92:95], a[152:155], v[180:183]
 s_mov_b32 s9, s69
 ds_read_b64_tr_b16 a[64:65], v7 offset:0
 v_cmp_gt_i32 vcc, 3, v14
 v_mfma_f32_16x16x32_bf16 v[188:191], a[80:83], a[132:135], 0
 s_mov_b32 s10, 1835008
 ds_read_b64_tr_b16 a[66:67], v7 offset:4096
 v_cndmask_b32 v3, 0, v15, vcc
 v_mfma_f32_16x16x32_bf16 v[188:191], a[84:87], a[140:143], v[188:191]
 s_mov_b32 s11, 0x20000
 ds_read_b64_tr_b16 a[68:69], v7 offset:16384
 v_accvgpr_write_b32 a227, v3
 v_mfma_f32_16x16x32_bf16 v[188:191], a[88:91], a[148:151], v[188:191]
 s_add_u32 s59, s56, 4096
 ds_read_b64_tr_b16 a[70:71], v7 offset:20480
 v_xor_b32 v8, 65920, v6
 v_mfma_f32_16x16x32_bf16 v[188:191], a[92:95], a[156:159], v[188:191]
 s_waitcnt lgkmcnt(6)
 ds_read_b64_tr_b16 a[72:73], v8 offset:0
 buffer_store_dwordx4 v[184:187], v1, s[12:15], s59 offen offset:3072 sc1
 v_mfma_f32_16x16x32_bf16 v[196:199], a[96:99], a[128:131], 0
 s_mov_b32 s20, s70
 ds_read_b64_tr_b16 a[74:75], v8 offset:4096
 v_cmp_gt_i32 vcc, 16, v14
 v_mfma_f32_16x16x32_bf16 v[196:199], a[100:103], a[136:139], v[196:199]
 s_mov_b32 s21, s71
 ds_read_b64_tr_b16 a[76:77], v8 offset:16384
 v_cndmask_b32 v3, 0, v15, vcc
 v_mfma_f32_16x16x32_bf16 v[196:199], a[104:107], a[144:147], v[196:199]
 s_waitcnt lgkmcnt(7)
 ds_read_b64_tr_b16 a[78:79], v8 offset:20480
 v_xor_b32 v9, 416, v6
 v_mfma_f32_16x16x32_bf16 v[196:199], a[108:111], a[152:155], v[196:199]
 s_mov_b32 s22, 3584
 ds_read_b64_tr_b16 a[80:81], v9 offset:0
 v_accvgpr_write_b32 a228, v3
 v_mfma_f32_16x16x32_bf16 v[204:207], a[96:99], a[132:135], 0
 s_mov_b32 s23, 0x20000
 ds_read_b64_tr_b16 a[82:83], v9 offset:4096
 v_cmp_gt_i32 vcc, 17, v14
 v_mfma_f32_16x16x32_bf16 v[204:207], a[100:103], a[140:143], v[204:207]
 ds_read_b64_tr_b16 a[84:85], v9 offset:16384
 v_lshrrev_b32 v120, 3, v0
 v_mfma_f32_16x16x32_bf16 v[204:207], a[104:107], a[148:151], v[204:207]
 s_add_u32 s59, s56, 36864
 ds_read_b64_tr_b16 a[86:87], v9 offset:20480
 v_xor_b32 v10, 65952, v6
 v_mfma_f32_16x16x32_bf16 v[204:207], a[108:111], a[156:159], v[204:207]
 s_waitcnt lgkmcnt(6)
 ds_read_b64_tr_b16 a[88:89], v10 offset:0
 buffer_store_dwordx4 v[192:195], v1, s[12:15], s59 offen offset:0 sc1
 v_mfma_f32_16x16x32_bf16 v[212:215], a[64:67], a[128:131], 0
 ds_read_b64_tr_b16 a[90:91], v10 offset:4096
 v_mul_u32_u24 v120, 1792, v120
 v_mfma_f32_16x16x32_bf16 v[212:215], a[68:71], a[136:139], v[212:215]
 ds_read_b64_tr_b16 a[92:93], v10 offset:16384
 v_and_b32 v121, 7, v0
 v_mfma_f32_16x16x32_bf16 v[212:215], a[72:75], a[144:147], v[212:215]
 s_waitcnt lgkmcnt(7)
 ds_read_b64_tr_b16 a[94:95], v10 offset:20480
 v_xor_b32 v7, 448, v6
 v_mfma_f32_16x16x32_bf16 v[212:215], a[76:79], a[152:155], v[212:215]
 ds_read_b64_tr_b16 a[96:97], v7 offset:0
 v_lshl_add_u32 v120, v121, 4, v120
 v_mfma_f32_16x16x32_bf16 v[220:223], a[64:67], a[132:135], 0
 ds_read_b64_tr_b16 a[98:99], v7 offset:4096
 v_add_u32 v120, s38, v120
 v_mfma_f32_16x16x32_bf16 v[220:223], a[68:71], a[140:143], v[220:223]
 ds_read_b64_tr_b16 a[100:101], v7 offset:16384
 v_lshlrev_b32 v121, 6, v121
 v_mfma_f32_16x16x32_bf16 v[220:223], a[72:75], a[148:151], v[220:223]
 s_add_u32 s59, s56, 53248
 ds_read_b64_tr_b16 a[102:103], v7 offset:20480
 v_xor_b32 v8, 65984, v6
 v_mfma_f32_16x16x32_bf16 v[220:223], a[76:79], a[156:159], v[220:223]
 s_waitcnt lgkmcnt(6)
 ds_read_b64_tr_b16 a[104:105], v8 offset:0
 buffer_store_dwordx4 v[200:203], v1, s[12:15], s59 offen offset:0 sc1
 v_mfma_f32_16x16x32_bf16 v[228:231], a[80:83], a[128:131], 0
 ds_read_b64_tr_b16 a[106:107], v8 offset:4096
 v_subrev_u32 v122, 2688, v120
 v_mfma_f32_16x16x32_bf16 v[228:231], a[84:87], a[136:139], v[228:231]
 ds_read_b64_tr_b16 a[108:109], v8 offset:16384
 v_subrev_u32 v123, 1792, v120
 v_mfma_f32_16x16x32_bf16 v[228:231], a[88:91], a[144:147], v[228:231]
 s_waitcnt lgkmcnt(7)
 ds_read_b64_tr_b16 a[110:111], v8 offset:20480
 v_xor_b32 v9, 480, v6
 v_mfma_f32_16x16x32_bf16 v[228:231], a[92:95], a[152:155], v[228:231]
 ds_read_b64_tr_b16 a[64:65], v9 offset:0
 v_subrev_u32 v128, 896, v120
 v_mfma_f32_16x16x32_bf16 v[236:239], a[80:83], a[132:135], 0
 ds_read_b64_tr_b16 a[66:67], v9 offset:4096
 v_cndmask_b32 v3, 0, v15, vcc
 v_mfma_f32_16x16x32_bf16 v[236:239], a[84:87], a[140:143], v[236:239]
 ds_read_b64_tr_b16 a[68:69], v9 offset:16384
 v_accvgpr_write_b32 a229, v3
 v_mfma_f32_16x16x32_bf16 v[236:239], a[88:91], a[148:151], v[236:239]
 s_add_u32 s59, s56, 53248
 ds_read_b64_tr_b16 a[70:71], v9 offset:20480
 v_xor_b32 v10, 66016, v6
 v_mfma_f32_16x16x32_bf16 v[236:239], a[92:95], a[156:159], v[236:239]
 s_waitcnt lgkmcnt(6)
 ds_read_b64_tr_b16 a[72:73], v10 offset:0
 buffer_store_dwordx4 v[208:211], v1, s[12:15], s59 offen offset:1024 sc1
 v_mfma_f32_16x16x32_bf16 v[244:247], a[96:99], a[128:131], 0
 ds_read_b64_tr_b16 a[74:75], v10 offset:4096
 v_cmp_gt_i32 vcc, 18, v14
 v_mfma_f32_16x16x32_bf16 v[244:247], a[100:103], a[136:139], v[244:247]
 s_waitcnt vmcnt(25)
 ds_read_b64_tr_b16 a[76:77], v10 offset:16384
 v_xor_b32 v7, 32768, v6
 v_mfma_f32_16x16x32_bf16 v[244:247], a[104:107], a[144:147], v[244:247]
 s_waitcnt lgkmcnt(7)
 s_barrier
 ds_read_b64_tr_b16 a[78:79], v10 offset:20480
 v_mfma_f32_16x16x32_bf16 v[244:247], a[108:111], a[152:155], v[244:247]
 ds_read_b64_tr_b16 a[80:81], v7 offset:0
 v_cndmask_b32 v3, 0, v15, vcc
 v_mfma_f32_16x16x32_bf16 v[252:255], a[96:99], a[132:135], 0
 ds_read_b64_tr_b16 a[82:83], v7 offset:4096
 v_accvgpr_write_b32 a230, v3
 v_mfma_f32_16x16x32_bf16 v[252:255], a[100:103], a[140:143], v[252:255]
 ds_read_b64_tr_b16 a[84:85], v7 offset:16384
 v_cmp_gt_i32 vcc, 19, v14
 v_mfma_f32_16x16x32_bf16 v[252:255], a[104:107], a[148:151], v[252:255]
 s_add_u32 s59, s56, 36864
 ds_read_b64_tr_b16 a[86:87], v7 offset:20480
 v_xor_b32 v8, 98304, v6
 v_mfma_f32_16x16x32_bf16 v[252:255], a[108:111], a[156:159], v[252:255]
 s_waitcnt lgkmcnt(6)
 ds_read_b64_tr_b16 a[88:89], v8 offset:0
 buffer_store_dwordx4 v[216:219], v1, s[12:15], s59 offen offset:1024 sc1
 v_mfma_f32_16x16x32_bf16 v[16:19], a[64:67], a[128:131], 0
 ds_read_b64_tr_b16 a[90:91], v8 offset:4096
 v_cndmask_b32 v3, 0, v15, vcc
 v_mfma_f32_16x16x32_bf16 v[16:19], a[68:71], a[136:139], v[16:19]
 ds_read_b64_tr_b16 a[92:93], v8 offset:16384
 v_accvgpr_write_b32 a231, v3
 v_mfma_f32_16x16x32_bf16 v[16:19], a[72:75], a[144:147], v[16:19]
 s_waitcnt lgkmcnt(7)
 ds_read_b64_tr_b16 a[94:95], v8 offset:20480
 v_xor_b32 v9, 32800, v6
 v_mfma_f32_16x16x32_bf16 v[16:19], a[76:79], a[152:155], v[16:19]
 ds_read_b64_tr_b16 a[96:97], v9 offset:0
 v_cmp_gt_i32 vcc, 32, v14
 v_mfma_f32_16x16x32_bf16 v[24:27], a[64:67], a[132:135], 0
 s_waitcnt lgkmcnt(9)
 ds_read_b64_tr_b16 a[98:99], v9 offset:4096
 v_cndmask_b32 v3, 0, v15, vcc
 v_mfma_f32_16x16x32_bf16 v[24:27], a[68:71], a[140:143], v[24:27]
 s_barrier
 ds_read_b64_tr_b16 a[100:101], v9 offset:16384
 v_accvgpr_write_b32 a232, v3
 v_mfma_f32_16x16x32_bf16 v[24:27], a[72:75], a[148:151], v[24:27]
 s_add_u32 m0, s29, 0
 ds_read_b64_tr_b16 a[102:103], v9 offset:20480
 v_xor_b32 v10, 98336, v6
 v_mfma_f32_16x16x32_bf16 v[24:27], a[76:79], a[156:159], v[24:27]
 s_waitcnt lgkmcnt(6)
 ds_read_b64_tr_b16 a[104:105], v10 offset:0
 v_add_u32 v2, 0x80000, v2
 v_mfma_f32_16x16x32_bf16 v[28:31], a[80:83], a[160:163], v[28:31]
 ds_read_b64_tr_b16 a[106:107], v10 offset:4096
 buffer_load_dwordx4 v2, s[16:19], 0 offen lds
 v_mfma_f32_16x16x32_bf16 v[28:31], a[84:87], a[168:171], v[28:31]
 s_add_u32 s59, s56, 36864
 ds_read_b64_tr_b16 a[108:109], v10 offset:16384
 v_cmp_gt_i32 vcc, 33, v14
 v_mfma_f32_16x16x32_bf16 v[28:31], a[88:91], a[176:179], v[28:31]
 s_waitcnt lgkmcnt(7)
 ds_read_b64_tr_b16 a[110:111], v10 offset:20480
 v_xor_b32 v7, 32832, v6
 v_mfma_f32_16x16x32_bf16 v[28:31], a[92:95], a[184:187], v[28:31]
 ds_read_b64_tr_b16 a[64:65], v7 offset:0
 buffer_store_dwordx4 v[224:227], v1, s[12:15], s59 offen offset:2048 sc1
 v_mfma_f32_16x16x32_bf16 v[44:47], a[80:83], a[164:167], v[44:47]
 s_add_u32 m0, s29, 4096
 ds_read_b64_tr_b16 a[66:67], v7 offset:4096
 v_add_u32 v4, 4096, v1
 v_mfma_f32_16x16x32_bf16 v[44:47], a[84:87], a[172:175], v[44:47]
 ds_read_b64_tr_b16 a[68:69], v7 offset:16384
 buffer_load_dwordx4 v2, s[16:19], s48 offen lds
 v_mfma_f32_16x16x32_bf16 v[44:47], a[88:91], a[180:183], v[44:47]
 ds_read_b64_tr_b16 a[70:71], v7 offset:20480
 v_xor_b32 v8, 98368, v6
 v_mfma_f32_16x16x32_bf16 v[44:47], a[92:95], a[188:191], v[44:47]
 s_waitcnt lgkmcnt(6)
 ds_read_b64_tr_b16 a[72:73], v8 offset:0
 v_cndmask_b32 v3, 0, v15, vcc
 v_mfma_f32_16x16x32_bf16 v[52:55], a[96:99], a[160:163], v[52:55]
 ds_read_b64_tr_b16 a[74:75], v8 offset:4096
 v_accvgpr_write_b32 a233, v3
 v_mfma_f32_16x16x32_bf16 v[52:55], a[100:103], a[168:171], v[52:55]
 s_add_u32 m0, s29, 8192
 ds_read_b64_tr_b16 a[76:77], v8 offset:16384
 v_cmp_gt_i32 vcc, 34, v14
 v_mfma_f32_16x16x32_bf16 v[52:55], a[104:107], a[176:179], v[52:55]
 s_waitcnt lgkmcnt(7)
 ds_read_b64_tr_b16 a[78:79], v8 offset:20480
 v_xor_b32 v9, 32864, v6
 v_mfma_f32_16x16x32_bf16 v[52:55], a[108:111], a[184:187], v[52:55]
 ds_read_b64_tr_b16 a[80:81], v9 offset:0
 buffer_load_dwordx4 v2, s[16:19], s49 offen lds
 v_mfma_f32_16x16x32_bf16 v[60:63], a[96:99], a[164:167], v[60:63]
 s_add_u32 s59, s56, 53248
 ds_read_b64_tr_b16 a[82:83], v9 offset:4096
 v_cndmask_b32 v3, 0, v15, vcc
 v_mfma_f32_16x16x32_bf16 v[60:63], a[100:103], a[172:175], v[60:63]
 ds_read_b64_tr_b16 a[84:85], v9 offset:16384
 buffer_store_dwordx4 v[232:235], v1, s[12:15], s59 offen offset:2048 sc1
 v_mfma_f32_16x16x32_bf16 v[60:63], a[104:107], a[180:183], v[60:63]
 s_add_u32 m0, s29, 12288
 ds_read_b64_tr_b16 a[86:87], v9 offset:20480
 v_xor_b32 v10, 98400, v6
 v_mfma_f32_16x16x32_bf16 v[60:63], a[108:111], a[188:191], v[60:63]
 s_waitcnt lgkmcnt(6)
 ds_read_b64_tr_b16 a[88:89], v10 offset:0
 v_accvgpr_write_b32 a234, v3
 v_mfma_f32_16x16x32_bf16 v[20:23], a[64:67], a[160:163], v[20:23]
 ds_read_b64_tr_b16 a[90:91], v10 offset:4096
 buffer_load_dwordx4 v2, s[16:19], s50 offen lds
 v_mfma_f32_16x16x32_bf16 v[20:23], a[68:71], a[168:171], v[20:23]
 ds_read_b64_tr_b16 a[92:93], v10 offset:16384
 v_cmp_gt_i32 vcc, 35, v14
 v_mfma_f32_16x16x32_bf16 v[20:23], a[72:75], a[176:179], v[20:23]
 s_waitcnt lgkmcnt(7)
 ds_read_b64_tr_b16 a[94:95], v10 offset:20480
 v_xor_b32 v7, 32896, v6
 v_mfma_f32_16x16x32_bf16 v[20:23], a[76:79], a[184:187], v[20:23]
 ds_read_b64_tr_b16 a[96:97], v7 offset:0
 v_cndmask_b32 v3, 0, v15, vcc
 v_mfma_f32_16x16x32_bf16 v[36:39], a[64:67], a[164:167], v[36:39]
 s_add_u32 m0, s29, 16384
 ds_read_b64_tr_b16 a[98:99], v7 offset:4096
 v_accvgpr_write_b32 a235, v3
 v_mfma_f32_16x16x32_bf16 v[36:39], a[68:71], a[172:175], v[36:39]
 ds_read_b64_tr_b16 a[100:101], v7 offset:16384
 buffer_load_dwordx4 v2, s[16:19], s51 offen lds
 v_mfma_f32_16x16x32_bf16 v[36:39], a[72:75], a[180:183], v[36:39]
 s_add_u32 s59, s56, 53248
 ds_read_b64_tr_b16 a[102:103], v7 offset:20480
 v_xor_b32 v8, 98432, v6
 v_mfma_f32_16x16x32_bf16 v[36:39], a[76:79], a[188:191], v[36:39]
 s_waitcnt lgkmcnt(6)
 ds_read_b64_tr_b16 a[104:105], v8 offset:0
 buffer_store_dwordx4 v[240:243], v1, s[12:15], s59 offen offset:3072 sc1
 v_mfma_f32_16x16x32_bf16 v[68:71], a[80:83], a[160:163], v[68:71]
 ds_read_b64_tr_b16 a[106:107], v8 offset:4096
 v_cmp_gt_i32 vcc, 48, v14
 v_mfma_f32_16x16x32_bf16 v[68:71], a[84:87], a[168:171], v[68:71]
 s_add_u32 m0, s29, 20480
 ds_read_b64_tr_b16 a[108:109], v8 offset:16384
 v_cndmask_b32 v3, 0, v15, vcc
 v_mfma_f32_16x16x32_bf16 v[68:71], a[88:91], a[176:179], v[68:71]
 s_waitcnt lgkmcnt(7)
 ds_read_b64_tr_b16 a[110:111], v8 offset:20480
 v_xor_b32 v9, 32928, v6
 v_mfma_f32_16x16x32_bf16 v[68:71], a[92:95], a[184:187], v[68:71]
 ds_read_b64_tr_b16 a[64:65], v9 offset:0
 buffer_load_dwordx4 v2, s[16:19], s52 offen lds
 v_mfma_f32_16x16x32_bf16 v[76:79], a[80:83], a[164:167], v[76:79]
 ds_read_b64_tr_b16 a[66:67], v9 offset:4096
 v_accvgpr_write_b32 a236, v3
 v_mfma_f32_16x16x32_bf16 v[76:79], a[84:87], a[172:175], v[76:79]
 ds_read_b64_tr_b16 a[68:69], v9 offset:16384
 v_cmp_gt_i32 vcc, 49, v14
 v_mfma_f32_16x16x32_bf16 v[76:79], a[88:91], a[180:183], v[76:79]
 s_add_u32 m0, s29, 24576
 ds_read_b64_tr_b16 a[70:71], v9 offset:20480
 v_xor_b32 v10, 98464, v6
 v_mfma_f32_16x16x32_bf16 v[76:79], a[92:95], a[188:191], v[76:79]
 s_waitcnt lgkmcnt(6)
 ds_read_b64_tr_b16 a[72:73], v10 offset:0
 v_cndmask_b32 v3, 0, v15, vcc
 v_mfma_f32_16x16x32_bf16 v[84:87], a[96:99], a[160:163], v[84:87]
 ds_read_b64_tr_b16 a[74:75], v10 offset:4096
 buffer_load_dwordx4 v2, s[16:19], s53 offen lds
 v_mfma_f32_16x16x32_bf16 v[84:87], a[100:103], a[168:171], v[84:87]
 s_add_u32 s59, s56, 36864
 ds_read_b64_tr_b16 a[76:77], v10 offset:16384
 v_accvgpr_write_b32 a237, v3
 v_mfma_f32_16x16x32_bf16 v[84:87], a[104:107], a[176:179], v[84:87]
 s_waitcnt lgkmcnt(7)
 ds_read_b64_tr_b16 a[78:79], v10 offset:20480
 v_xor_b32 v7, 32960, v6
 v_mfma_f32_16x16x32_bf16 v[84:87], a[108:111], a[184:187], v[84:87]
 ds_read_b64_tr_b16 a[80:81], v7 offset:0
 buffer_store_dwordx4 v[248:251], v1, s[12:15], s59 offen offset:3072 sc1
 v_mfma_f32_16x16x32_bf16 v[92:95], a[96:99], a[164:167], v[92:95]
 s_add_u32 m0, s29, 28672
 ds_read_b64_tr_b16 a[82:83], v7 offset:4096
 v_cmp_gt_i32 vcc, 50, v14
 v_mfma_f32_16x16x32_bf16 v[92:95], a[100:103], a[172:175], v[92:95]
 ds_read_b64_tr_b16 a[84:85], v7 offset:16384
 buffer_load_dwordx4 v2, s[16:19], s54 offen lds
 v_mfma_f32_16x16x32_bf16 v[92:95], a[104:107], a[180:183], v[92:95]
 ds_read_b64_tr_b16 a[86:87], v7 offset:20480
 v_xor_b32 v8, 98496, v6
 v_mfma_f32_16x16x32_bf16 v[92:95], a[108:111], a[188:191], v[92:95]
 s_waitcnt lgkmcnt(6)
 ds_read_b64_tr_b16 a[88:89], v8 offset:0
 v_cndmask_b32 v3, 0, v15, vcc
 v_mfma_f32_16x16x32_bf16 v[100:103], a[64:67], a[160:163], v[100:103]
 s_add_u32 m0, s29, 65536
 ds_read_b64_tr_b16 a[90:91], v8 offset:4096
 v_add_u32 v2, 0x80000, v2
 v_mfma_f32_16x16x32_bf16 v[100:103], a[68:71], a[168:171], v[100:103]
 ds_read_b64_tr_b16 a[92:93], v8 offset:16384
 buffer_load_dwordx4 v2, s[16:19], 0 offen lds
 v_mfma_f32_16x16x32_bf16 v[100:103], a[72:75], a[176:179], v[100:103]
 s_waitcnt lgkmcnt(7)
 ds_read_b64_tr_b16 a[94:95], v8 offset:20480
 v_xor_b32 v9, 32992, v6
 v_mfma_f32_16x16x32_bf16 v[100:103], a[76:79], a[184:187], v[100:103]
 ds_read_b64_tr_b16 a[96:97], v9 offset:0
 v_accvgpr_write_b32 a238, v3
 v_mfma_f32_16x16x32_bf16 v[108:111], a[64:67], a[164:167], v[108:111]
 ds_read_b64_tr_b16 a[98:99], v9 offset:4096
 v_cmp_gt_i32 vcc, 51, v14
 v_mfma_f32_16x16x32_bf16 v[108:111], a[68:71], a[172:175], v[108:111]
 ds_read_b64_tr_b16 a[100:101], v9 offset:16384
 v_cndmask_b32 v3, 0, v15, vcc
 v_mfma_f32_16x16x32_bf16 v[108:111], a[72:75], a[180:183], v[108:111]
 s_add_u32 m0, s29, 69632
 ds_read_b64_tr_b16 a[102:103], v9 offset:20480
 v_xor_b32 v10, 98528, v6
 v_mfma_f32_16x16x32_bf16 v[108:111], a[76:79], a[188:191], v[108:111]
 s_waitcnt lgkmcnt(6)
 ds_read_b64_tr_b16 a[104:105], v10 offset:0
 buffer_load_dwordx4 v2, s[16:19], s48 offen lds
 v_mfma_f32_16x16x32_bf16 v[116:119], a[80:83], a[160:163], v[116:119]
 ds_read_b64_tr_b16 a[106:107], v10 offset:4096
 v_accvgpr_write_b32 a239, v3
 v_mfma_f32_16x16x32_bf16 v[116:119], a[84:87], a[168:171], v[116:119]
 ds_read_b64_tr_b16 a[108:109], v10 offset:16384
 v_mfma_f32_16x16x32_bf16 v[116:119], a[88:91], a[176:179], v[116:119]
 s_waitcnt lgkmcnt(7)
 ds_read_b64_tr_b16 a[110:111], v10 offset:20480
 v_xor_b32 v7, 33024, v6
 v_mfma_f32_16x16x32_bf16 v[116:119], a[92:95], a[184:187], v[116:119]
 s_add_u32 m0, s29, 73728
 ds_read_b64_tr_b16 a[64:65], v7 offset:0
 v_mfma_f32_16x16x32_bf16 v[124:127], a[80:83], a[164:167], v[124:127]
 ds_read_b64_tr_b16 a[66:67], v7 offset:4096
 buffer_load_dwordx4 v2, s[16:19], s49 offen lds
 v_mfma_f32_16x16x32_bf16 v[124:127], a[84:87], a[172:175], v[124:127]
 ds_read_b64_tr_b16 a[68:69], v7 offset:16384
 v_mfma_f32_16x16x32_bf16 v[124:127], a[88:91], a[180:183], v[124:127]
 ds_read_b64_tr_b16 a[70:71], v7 offset:20480
 v_xor_b32 v8, 98560, v6
 v_mfma_f32_16x16x32_bf16 v[124:127], a[92:95], a[188:191], v[124:127]
 s_waitcnt lgkmcnt(6)
 ds_read_b64_tr_b16 a[72:73], v8 offset:0
 v_mfma_f32_16x16x32_bf16 v[132:135], a[96:99], a[160:163], v[132:135]
 s_add_u32 m0, s29, 77824
 ds_read_b64_tr_b16 a[74:75], v8 offset:4096
 v_mfma_f32_16x16x32_bf16 v[132:135], a[100:103], a[168:171], v[132:135]
 ds_read_b64_tr_b16 a[76:77], v8 offset:16384
 buffer_load_dwordx4 v2, s[16:19], s50 offen lds
 v_mfma_f32_16x16x32_bf16 v[132:135], a[104:107], a[176:179], v[132:135]
 s_waitcnt lgkmcnt(7)
 ds_read_b64_tr_b16 a[78:79], v8 offset:20480
 v_xor_b32 v9, 33056, v6
 v_mfma_f32_16x16x32_bf16 v[132:135], a[108:111], a[184:187], v[132:135]
 ds_read_b64_tr_b16 a[80:81], v9 offset:0
 v_mfma_f32_16x16x32_bf16 v[140:143], a[96:99], a[164:167], v[140:143]
 ds_read_b64_tr_b16 a[82:83], v9 offset:4096
 v_mfma_f32_16x16x32_bf16 v[140:143], a[100:103], a[172:175], v[140:143]
 ds_read_b64_tr_b16 a[84:85], v9 offset:16384
 v_mfma_f32_16x16x32_bf16 v[140:143], a[104:107], a[180:183], v[140:143]
 s_add_u32 m0, s29, 81920
 ds_read_b64_tr_b16 a[86:87], v9 offset:20480
 v_xor_b32 v10, 98592, v6
 v_mfma_f32_16x16x32_bf16 v[140:143], a[108:111], a[188:191], v[140:143]
 s_waitcnt lgkmcnt(6)
 ds_read_b64_tr_b16 a[88:89], v10 offset:0
 buffer_load_dwordx4 v2, s[16:19], s51 offen lds
 v_mfma_f32_16x16x32_bf16 v[148:151], a[64:67], a[160:163], v[148:151]
 ds_read_b64_tr_b16 a[90:91], v10 offset:4096
 v_mfma_f32_16x16x32_bf16 v[148:151], a[68:71], a[168:171], v[148:151]
 ds_read_b64_tr_b16 a[92:93], v10 offset:16384
 v_mfma_f32_16x16x32_bf16 v[148:151], a[72:75], a[176:179], v[148:151]
 s_waitcnt lgkmcnt(7)
 ds_read_b64_tr_b16 a[94:95], v10 offset:20480
 v_xor_b32 v7, 33088, v6
 v_mfma_f32_16x16x32_bf16 v[148:151], a[76:79], a[184:187], v[148:151]
 s_add_u32 m0, s29, 86016
 ds_read_b64_tr_b16 a[96:97], v7 offset:0
 v_mfma_f32_16x16x32_bf16 v[156:159], a[64:67], a[164:167], v[156:159]
 ds_read_b64_tr_b16 a[98:99], v7 offset:4096
 buffer_load_dwordx4 v2, s[16:19], s52 offen lds
 v_mfma_f32_16x16x32_bf16 v[156:159], a[68:71], a[172:175], v[156:159]
 ds_read_b64_tr_b16 a[100:101], v7 offset:16384
 v_mfma_f32_16x16x32_bf16 v[156:159], a[72:75], a[180:183], v[156:159]
 ds_read_b64_tr_b16 a[102:103], v7 offset:20480
 v_xor_b32 v8, 98624, v6
 v_mfma_f32_16x16x32_bf16 v[156:159], a[76:79], a[188:191], v[156:159]
 s_waitcnt lgkmcnt(6)
 ds_read_b64_tr_b16 a[104:105], v8 offset:0
 v_mfma_f32_16x16x32_bf16 v[164:167], a[80:83], a[160:163], v[164:167]
 s_add_u32 m0, s29, 90112
 ds_read_b64_tr_b16 a[106:107], v8 offset:4096
 v_mfma_f32_16x16x32_bf16 v[164:167], a[84:87], a[168:171], v[164:167]
 ds_read_b64_tr_b16 a[108:109], v8 offset:16384
 buffer_load_dwordx4 v2, s[16:19], s53 offen lds
 v_mfma_f32_16x16x32_bf16 v[164:167], a[88:91], a[176:179], v[164:167]
 s_waitcnt lgkmcnt(7)
 ds_read_b64_tr_b16 a[110:111], v8 offset:20480
 v_xor_b32 v9, 33120, v6
 v_mfma_f32_16x16x32_bf16 v[164:167], a[92:95], a[184:187], v[164:167]
 s_waitcnt vmcnt(8)
 ds_read_b64_tr_b16 a[64:65], v9 offset:0
 v_mfma_f32_16x16x32_bf16 v[172:175], a[80:83], a[164:167], v[172:175]
 s_barrier
 ds_read_b64_tr_b16 a[66:67], v9 offset:4096
 v_mfma_f32_16x16x32_bf16 v[172:175], a[84:87], a[172:175], v[172:175]
 ds_read_b64_tr_b16 a[68:69], v9 offset:16384
 buffer_store_dword v11, v11, s[12:15], s92 offen sc1
 v_mfma_f32_16x16x32_bf16 v[172:175], a[88:91], a[180:183], v[172:175]
 s_add_u32 m0, s29, 94208
 ds_read_b64_tr_b16 a[70:71], v9 offset:20480
 v_xor_b32 v10, 98656, v6
 v_mfma_f32_16x16x32_bf16 v[172:175], a[92:95], a[188:191], v[172:175]
 s_waitcnt lgkmcnt(6)
 ds_read_b64_tr_b16 a[72:73], v10 offset:0
 buffer_load_dwordx4 v2, s[16:19], s54 offen lds
 v_mfma_f32_16x16x32_bf16 v[180:183], a[96:99], a[160:163], v[180:183]
 ds_read_b64_tr_b16 a[74:75], v10 offset:4096
 v_mfma_f32_16x16x32_bf16 v[180:183], a[100:103], a[168:171], v[180:183]
 ds_read_b64_tr_b16 a[76:77], v10 offset:16384
 v_mfma_f32_16x16x32_bf16 v[180:183], a[104:107], a[176:179], v[180:183]
 s_waitcnt lgkmcnt(7)
 ds_read_b64_tr_b16 a[78:79], v10 offset:20480
 v_xor_b32 v7, 33152, v6
 v_mfma_f32_16x16x32_bf16 v[180:183], a[108:111], a[184:187], v[180:183]
 ds_read_b64_tr_b16 a[80:81], v7 offset:0
 v_mfma_f32_16x16x32_bf16 v[188:191], a[96:99], a[164:167], v[188:191]
 ds_read_b64_tr_b16 a[82:83], v7 offset:4096
 v_mfma_f32_16x16x32_bf16 v[188:191], a[100:103], a[172:175], v[188:191]
 ds_read_b64_tr_b16 a[84:85], v7 offset:16384
 v_mfma_f32_16x16x32_bf16 v[188:191], a[104:107], a[180:183], v[188:191]
 ds_read_b64_tr_b16 a[86:87], v7 offset:20480
 v_xor_b32 v8, 98688, v6
 v_mfma_f32_16x16x32_bf16 v[188:191], a[108:111], a[188:191], v[188:191]
 s_waitcnt lgkmcnt(6)
 ds_read_b64_tr_b16 a[88:89], v8 offset:0
 v_mfma_f32_16x16x32_bf16 v[196:199], a[64:67], a[160:163], v[196:199]
 s_and_b32 s58, s92, ~127
 ds_read_b64_tr_b16 a[90:91], v8 offset:4096
 v_mfma_f32_16x16x32_bf16 v[196:199], a[68:71], a[168:171], v[196:199]
 s_lshl_b32 s37, s25, 1
 ds_read_b64_tr_b16 a[92:93], v8 offset:16384
 v_mfma_f32_16x16x32_bf16 v[196:199], a[72:75], a[176:179], v[196:199]
 s_waitcnt lgkmcnt(7)
 ds_read_b64_tr_b16 a[94:95], v8 offset:20480
 v_xor_b32 v9, 33184, v6
 v_mfma_f32_16x16x32_bf16 v[196:199], a[76:79], a[184:187], v[196:199]
 s_sub_i32 s38, 12, s37
 ds_read_b64_tr_b16 a[96:97], v9 offset:0
 v_mfma_f32_16x16x32_bf16 v[204:207], a[64:67], a[164:167], v[204:207]
 s_max_i32 s38, s38, 0
 ds_read_b64_tr_b16 a[98:99], v9 offset:4096
 v_mfma_f32_16x16x32_bf16 v[204:207], a[68:71], a[172:175], v[204:207]
 s_mul_i32 s49, s26, 1048576
 ds_read_b64_tr_b16 a[100:101], v9 offset:16384
 v_mfma_f32_16x16x32_bf16 v[204:207], a[72:75], a[180:183], v[204:207]
 s_lshl_b32 s50, s3, 13
 ds_read_b64_tr_b16 a[102:103], v9 offset:20480
 v_xor_b32 v10, 98720, v6
 v_mfma_f32_16x16x32_bf16 v[204:207], a[76:79], a[188:191], v[204:207]
 s_waitcnt lgkmcnt(6)
 ds_read_b64_tr_b16 a[104:105], v10 offset:0
 v_mfma_f32_16x16x32_bf16 v[212:215], a[80:83], a[160:163], v[212:215]
 s_add_u32 s49, s49, s50
 ds_read_b64_tr_b16 a[106:107], v10 offset:4096
 v_mfma_f32_16x16x32_bf16 v[212:215], a[84:87], a[168:171], v[212:215]
 s_mov_b32 s54, 2
 ds_read_b64_tr_b16 a[108:109], v10 offset:16384
 v_mfma_f32_16x16x32_bf16 v[212:215], a[88:91], a[176:179], v[212:215]
 s_waitcnt lgkmcnt(7)
 ds_read_b64_tr_b16 a[110:111], v10 offset:20480
 v_xor_b32 v7, 33216, v6
 v_mfma_f32_16x16x32_bf16 v[212:215], a[92:95], a[184:187], v[212:215]
 s_sub_u32 s44, 31, s37
 ds_read_b64_tr_b16 a[64:65], v7 offset:0
 v_mfma_f32_16x16x32_bf16 v[220:223], a[80:83], a[164:167], v[220:223]
 s_sub_u32 s44, s44, s38
 ds_read_b64_tr_b16 a[66:67], v7 offset:4096
 v_mfma_f32_16x16x32_bf16 v[220:223], a[84:87], a[172:175], v[220:223]
 s_mul_i32 s55, s38, 32768
 ds_read_b64_tr_b16 a[68:69], v7 offset:16384
 v_mfma_f32_16x16x32_bf16 v[220:223], a[88:91], a[180:183], v[220:223]
 s_add_u32 s42, s55, s49
 ds_read_b64_tr_b16 a[70:71], v7 offset:20480
 v_xor_b32 v8, 98752, v6
 v_mfma_f32_16x16x32_bf16 v[220:223], a[92:95], a[188:191], v[220:223]
 s_waitcnt lgkmcnt(6)
 ds_read_b64_tr_b16 a[72:73], v8 offset:0
 buffer_load_dwordx4 v[32:35], v122, s[4:7], 0 offen
 v_mfma_f32_16x16x32_bf16 v[228:231], a[96:99], a[160:163], v[228:231]
 s_add_u32 s60, s58, 16
 ds_read_b64_tr_b16 a[74:75], v8 offset:4096
 v_mfma_f32_16x16x32_bf16 v[228:231], a[100:103], a[168:171], v[228:231]
 s_sub_u32 s45, 17, s37
 ds_read_b64_tr_b16 a[76:77], v8 offset:16384
 v_mfma_f32_16x16x32_bf16 v[228:231], a[104:107], a[176:179], v[228:231]
 s_waitcnt lgkmcnt(7)
 ds_read_b64_tr_b16 a[78:79], v8 offset:20480
 v_xor_b32 v9, 33248, v6
 v_mfma_f32_16x16x32_bf16 v[228:231], a[108:111], a[184:187], v[228:231]
 ds_read_b64_tr_b16 a[80:81], v9 offset:0
 buffer_load_dwordx4 v[40:43], v123, s[4:7], 0 offen
 v_mfma_f32_16x16x32_bf16 v[236:239], a[96:99], a[164:167], v[236:239]
 s_sub_u32 s66, s42, 32768
 ds_read_b64_tr_b16 a[82:83], v9 offset:4096
 v_mfma_f32_16x16x32_bf16 v[236:239], a[100:103], a[172:175], v[236:239]
 s_add_u32 s42, s49, 491520
 ds_read_b64_tr_b16 a[84:85], v9 offset:16384
 v_mfma_f32_16x16x32_bf16 v[236:239], a[104:107], a[180:183], v[236:239]
 s_add_u32 s67, s49, 524288
 ds_read_b64_tr_b16 a[86:87], v9 offset:20480
 v_xor_b32 v10, 98784, v6
 v_mfma_f32_16x16x32_bf16 v[236:239], a[108:111], a[188:191], v[236:239]
 s_waitcnt lgkmcnt(6)
 ds_read_b64_tr_b16 a[88:89], v10 offset:0
 buffer_load_dwordx4 v[48:51], v128, s[4:7], 0 offen
 v_mfma_f32_16x16x32_bf16 v[244:247], a[64:67], a[160:163], v[244:247]
 s_add_u32 s68, s66, 16777216
 ds_read_b64_tr_b16 a[90:91], v10 offset:4096
 v_mfma_f32_16x16x32_bf16 v[244:247], a[68:71], a[168:171], v[244:247]
 s_waitcnt vmcnt(3)
 ds_read_b64_tr_b16 a[92:93], v10 offset:16384
 v_xor_b32 v7, 131072, v6
 v_mfma_f32_16x16x32_bf16 v[244:247], a[72:75], a[176:179], v[244:247]
 s_waitcnt lgkmcnt(7)
 s_barrier
 ds_read_b64_tr_b16 a[94:95], v10 offset:20480
 v_mfma_f32_16x16x32_bf16 v[244:247], a[76:79], a[184:187], v[244:247]
 ds_read_b64_tr_b16 a[96:97], v7 offset:0
 buffer_load_dwordx4 v[56:59], v120, s[4:7], 0 offen offset:0
 v_mfma_f32_16x16x32_bf16 v[252:255], a[64:67], a[164:167], v[252:255]
 s_add_u32 s69, s67, 16777216
 ds_read_b64_tr_b16 a[98:99], v7 offset:4096
 v_mfma_f32_16x16x32_bf16 v[252:255], a[68:71], a[172:175], v[252:255]
 s_mov_b32 s70, 0xffff8000
 ds_read_b64_tr_b16 a[100:101], v7 offset:16384
 v_mfma_f32_16x16x32_bf16 v[252:255], a[72:75], a[180:183], v[252:255]
 s_mov_b32 s71, s70
 ds_read_b64_tr_b16 a[102:103], v7 offset:20480
 v_xor_b32 v8, 0, v6
 v_mfma_f32_16x16x32_bf16 v[252:255], a[76:79], a[188:191], v[252:255]
 s_waitcnt lgkmcnt(6)
 ds_read_b64_tr_b16 a[104:105], v8 offset:0
 buffer_load_dwordx4 v[64:67], v120, s[4:7], 0 offen offset:896
 v_mfma_f32_16x16x32_bf16 v[16:19], a[80:83], a[160:163], v[16:19]
 s_add_u32 s43, s42, 16777216
 ds_read_b64_tr_b16 a[106:107], v8 offset:4096
 v_mfma_f32_16x16x32_bf16 v[16:19], a[84:87], a[168:171], v[16:19]
 s_mov_b32 s40, s50
 ds_read_b64_tr_b16 a[108:109], v8 offset:16384
 v_mfma_f32_16x16x32_bf16 v[16:19], a[88:91], a[176:179], v[16:19]
 s_waitcnt lgkmcnt(7)
 ds_read_b64_tr_b16 a[110:111], v8 offset:20480
 v_xor_b32 v9, 65536, v6
 v_mfma_f32_16x16x32_bf16 v[16:19], a[92:95], a[184:187], v[16:19]
 ds_read_b64_tr_b16 a[64:65], v9 offset:0
 buffer_load_dwordx4 v[72:75], v120, s[8:11], 0 offen offset:0
 v_mfma_f32_16x16x32_bf16 v[24:27], a[80:83], a[164:167], v[24:27]
 s_add_u32 s41, s50, 0x10000
 ds_read_b64_tr_b16 a[66:67], v9 offset:4096
 v_mfma_f32_16x16x32_bf16 v[24:27], a[84:87], a[172:175], v[24:27]
 s_lshr_b32 s61, s95, 4
 ds_read_b64_tr_b16 a[68:69], v9 offset:16384
 v_mfma_f32_16x16x32_bf16 v[24:27], a[88:91], a[180:183], v[24:27]
 s_lshl_b32 s61, s61, 7
 ds_read_b64_tr_b16 a[70:71], v9 offset:20480
 v_xor_b32 v10, 131104, v6
 v_mfma_f32_16x16x32_bf16 v[24:27], a[92:95], a[188:191], v[24:27]
 s_waitcnt lgkmcnt(6)
 ds_read_b64_tr_b16 a[72:73], v10 offset:0
 buffer_load_dwordx4 v[80:83], v120, s[8:11], 0 offen offset:896
 v_mfma_f32_16x16x32_bf16 v[28:31], a[96:99], a[192:195], v[28:31]
 s_add_u32 s61, s61, 84959232
 ds_read_b64_tr_b16 a[74:75], v10 offset:4096
 v_mfma_f32_16x16x32_bf16 v[28:31], a[100:103], a[200:203], v[28:31]
 s_mov_b32 s47, 0x4b800000
 ds_read_b64_tr_b16 a[76:77], v10 offset:16384
 v_mfma_f32_16x16x32_bf16 v[28:31], a[104:107], a[208:211], v[28:31]
 s_waitcnt lgkmcnt(3)
 ds_read_b64_tr_b16 a[78:79], v10 offset:20480
 v_xor_b32 v7, 32, v6
 v_mfma_f32_16x16x32_bf16 v[28:31], a[108:111], a[216:219], v[28:31]
 ds_read_b64_tr_b16 a[80:81], v7 offset:0
 buffer_load_dwordx4 v[88:91], v121, s[20:23], s39 offen offset:0
 v_mfma_f32_16x16x32_bf16 v[28:31], a[64:67], a[112:115], v[28:31]
 s_lshl_b32 s30, s95, 1
 ds_read_b64_tr_b16 a[82:83], v7 offset:4096
 v_mfma_f32_16x16x32_bf16 v[28:31], a[68:71], a[120:123], v[28:31]
 s_lshr_b32 s31, s3, 1
 ds_read_b64_tr_b16 a[84:85], v7 offset:16384
 v_mfma_f32_16x16x32_bf16 v[44:47], a[96:99], a[196:199], v[44:47]
 s_add_u32 s30, s30, s31
 ds_read_b64_tr_b16 a[86:87], v7 offset:20480
 v_xor_b32 v8, 65568, v6
 v_mfma_f32_16x16x32_bf16 v[44:47], a[100:103], a[204:207], v[44:47]
 ds_read_b64_tr_b16 a[88:89], v8 offset:0
 buffer_load_dwordx4 v[96:99], v121, s[20:23], s39 offen offset:16
 v_mfma_f32_16x16x32_bf16 v[44:47], a[104:107], a[212:215], v[44:47]
 s_min_u32 s30, s30, 223
 ds_read_b64_tr_b16 a[90:91], v8 offset:4096
 v_mfma_f32_16x16x32_bf16 v[44:47], a[108:111], a[220:223], v[44:47]
 s_lshl_b32 s30, s30, 2
 ds_read_b64_tr_b16 a[92:93], v8 offset:16384
 v_mfma_f32_16x16x32_bf16 v[44:47], a[64:67], a[116:119], v[44:47]
 ds_read_b64_tr_b16 a[94:95], v8 offset:20480
 v_xor_b32 v9, 131136, v6
 v_mfma_f32_16x16x32_bf16 v[44:47], a[68:71], a[124:127], v[44:47]
 s_waitcnt lgkmcnt(6)
 ds_read_b64_tr_b16 a[96:97], v9 offset:0
 buffer_load_dwordx4 v[104:107], v121, s[20:23], s39 offen offset:32
 v_mfma_f32_16x16x32_bf16 v[52:55], a[72:75], a[192:195], v[52:55]
 ds_read_b64_tr_b16 a[98:99], v9 offset:4096
 v_mfma_f32_16x16x32_bf16 v[52:55], a[76:79], a[200:203], v[52:55]
 ds_read_b64_tr_b16 a[100:101], v9 offset:16384
 v_mfma_f32_16x16x32_bf16 v[52:55], a[80:83], a[208:211], v[52:55]
 s_waitcnt lgkmcnt(3)
 ds_read_b64_tr_b16 a[102:103], v9 offset:20480
 v_xor_b32 v10, 64, v6
 v_mfma_f32_16x16x32_bf16 v[52:55], a[84:87], a[216:219], v[52:55]
 ds_read_b64_tr_b16 a[104:105], v10 offset:0
 buffer_load_dwordx4 v[112:115], v121, s[20:23], s39 offen offset:48
 v_mfma_f32_16x16x32_bf16 v[52:55], a[88:91], a[112:115], v[52:55]
 ds_read_b64_tr_b16 a[106:107], v10 offset:4096
 v_mfma_f32_16x16x32_bf16 v[52:55], a[92:95], a[120:123], v[52:55]
 ds_read_b64_tr_b16 a[108:109], v10 offset:16384
 v_mfma_f32_16x16x32_bf16 v[60:63], a[72:75], a[196:199], v[60:63]
 ds_read_b64_tr_b16 a[110:111], v10 offset:20480
 v_xor_b32 v7, 65600, v6
 v_mfma_f32_16x16x32_bf16 v[60:63], a[76:79], a[204:207], v[60:63]
 ds_read_b64_tr_b16 a[64:65], v7 offset:0
 v_mfma_f32_16x16x32_bf16 v[60:63], a[80:83], a[212:215], v[60:63]
 s_and_b32 s4, s2, 127
 ds_read_b64_tr_b16 a[66:67], v7 offset:4096
 v_mfma_f32_16x16x32_bf16 v[60:63], a[84:87], a[220:223], v[60:63]
 s_lshl_b32 s4, s4, 2
 ds_read_b64_tr_b16 a[68:69], v7 offset:16384
 v_mfma_f32_16x16x32_bf16 v[60:63], a[88:91], a[116:119], v[60:63]
 s_add_u32 s4, s4, s3
 ds_read_b64_tr_b16 a[70:71], v7 offset:20480
 v_xor_b32 v8, 131168, v6
 v_mfma_f32_16x16x32_bf16 v[60:63], a[92:95], a[124:127], v[60:63]
 s_waitcnt lgkmcnt(6)
 ds_read_b64_tr_b16 a[72:73], v8 offset:0
 v_mfma_f32_16x16x32_bf16 v[20:23], a[96:99], a[192:195], v[20:23]
 s_lshl_b32 s6, s4, 10
 ds_read_b64_tr_b16 a[74:75], v8 offset:4096
 v_mfma_f32_16x16x32_bf16 v[20:23], a[100:103], a[200:203], v[20:23]
 s_add_u32 s6, s6, 83886080
 ds_read_b64_tr_b16 a[76:77], v8 offset:16384
 v_mul_f32 v28, s34, v28
 v_mfma_f32_16x16x32_bf16 v[20:23], a[104:107], a[208:211], v[20:23]
 s_waitcnt lgkmcnt(3)
 ds_read_b64_tr_b16 a[78:79], v8 offset:20480
 v_xor_b32 v9, 96, v6
 v_mfma_f32_16x16x32_bf16 v[20:23], a[108:111], a[216:219], v[20:23]
 s_mul_i32 s4, s4, 17408
 ds_read_b64_tr_b16 a[80:81], v9 offset:0
 v_mul_f32 v29, s34, v29
 v_mfma_f32_16x16x32_bf16 v[20:23], a[64:67], a[112:115], v[20:23]
 s_add_u32 s4, s4, 67108864
 ds_read_b64_tr_b16 a[82:83], v9 offset:4096
 v_mul_f32 v30, s34, v30
 v_mfma_f32_16x16x32_bf16 v[20:23], a[68:71], a[120:123], v[20:23]
 s_add_u32 s5, s4, 0x2000
 ds_read_b64_tr_b16 a[84:85], v9 offset:16384
 v_mul_f32 v31, s34, v31
 v_mfma_f32_16x16x32_bf16 v[36:39], a[96:99], a[196:199], v[36:39]
 s_mov_b32 s7, 0
 ds_read_b64_tr_b16 a[86:87], v9 offset:20480
 v_xor_b32 v10, 65632, v6
 v_mfma_f32_16x16x32_bf16 v[36:39], a[100:103], a[204:207], v[36:39]
 s_mov_b32 s53, 0
 ds_read_b64_tr_b16 a[88:89], v10 offset:0
 v_mul_f32 v52, s34, v52
 v_mfma_f32_16x16x32_bf16 v[36:39], a[104:107], a[212:215], v[36:39]
 s_cmp_eq_u32 s38, 0
 s_cmov_b32 s4, 2.0
 ds_read_b64_tr_b16 a[90:91], v10 offset:4096
 v_mfma_f32_16x16x32_bf16 v[36:39], a[108:111], a[220:223], v[36:39]
 s_cmp_eq_u32 s38, 0
 s_cmov_b32 s5, 2.0
 ds_read_b64_tr_b16 a[92:93], v10 offset:16384
 v_mfma_f32_16x16x32_bf16 v[36:39], a[64:67], a[116:119], v[36:39]
 s_cmp_eq_u32 s38, 0
 s_cmov_b32 s6, 2.0
 ds_read_b64_tr_b16 a[94:95], v10 offset:20480
 v_xor_b32 v7, 131200, v6
 v_mfma_f32_16x16x32_bf16 v[36:39], a[68:71], a[124:127], v[36:39]
 s_waitcnt lgkmcnt(6)
 ds_read_b64_tr_b16 a[96:97], v7 offset:0
 v_mul_f32 v53, s34, v53
 v_mfma_f32_16x16x32_bf16 v[68:71], a[72:75], a[192:195], v[68:71]
 s_mov_b64 s[8:9], s[12:13]
 ds_read_b64_tr_b16 a[98:99], v7 offset:4096
 v_mul_f32 v54, s34, v54
 v_mfma_f32_16x16x32_bf16 v[68:71], a[76:79], a[200:203], v[68:71]
 s_mov_b32 s10, s14
 ds_read_b64_tr_b16 a[100:101], v7 offset:16384
 v_mul_f32 v55, s34, v55
 v_mfma_f32_16x16x32_bf16 v[68:71], a[80:83], a[208:211], v[68:71]
 s_waitcnt lgkmcnt(3)
 ds_read_b64_tr_b16 a[102:103], v7 offset:20480
 v_xor_b32 v8, 128, v6
 v_mfma_f32_16x16x32_bf16 v[68:71], a[84:87], a[216:219], v[68:71]
 s_mov_b32 s76, 0
 ds_read_b64_tr_b16 a[104:105], v8 offset:0
 v_cvt_pk_bf16_f32 v28, v28, v29
 v_mfma_f32_16x16x32_bf16 v[68:71], a[88:91], a[112:115], v[68:71]
 s_movk_i32 s77, 0x1000
 ds_read_b64_tr_b16 a[106:107], v8 offset:4096
 v_cvt_pk_bf16_f32 v29, v30, v31
 v_mfma_f32_16x16x32_bf16 v[68:71], a[92:95], a[120:123], v[68:71]
 s_mov_b32 s51, 0
 ds_read_b64_tr_b16 a[108:109], v8 offset:16384
 v_cvt_pk_bf16_f32 v30, v52, v53
 v_mfma_f32_16x16x32_bf16 v[76:79], a[72:75], a[196:199], v[76:79]
 s_mul_i32 s78, s26, 229376
 ds_read_b64_tr_b16 a[110:111], v8 offset:20480
 v_xor_b32 v9, 65664, v6
 v_mfma_f32_16x16x32_bf16 v[76:79], a[76:79], a[204:207], v[76:79]
 s_add_u32 s79, s78, 28672
 ds_read_b64_tr_b16 a[64:65], v9 offset:0
 v_cvt_pk_bf16_f32 v31, v54, v55
 v_mfma_f32_16x16x32_bf16 v[76:79], a[80:83], a[212:215], v[76:79]
 s_add_u32 s80, s78, 57344
 ds_read_b64_tr_b16 a[66:67], v9 offset:4096
 v_accvgpr_write_b32 a0, v28
 v_mfma_f32_16x16x32_bf16 v[76:79], a[84:87], a[220:223], v[76:79]
 s_add_u32 s81, s78, 86016
 ds_read_b64_tr_b16 a[68:69], v9 offset:16384
 v_accvgpr_write_b32 a1, v29
 v_mfma_f32_16x16x32_bf16 v[76:79], a[88:91], a[116:119], v[76:79]
 s_add_u32 s82, s78, 114688
 ds_read_b64_tr_b16 a[70:71], v9 offset:20480
 v_xor_b32 v10, 131232, v6
 v_mfma_f32_16x16x32_bf16 v[76:79], a[92:95], a[124:127], v[76:79]
 s_waitcnt lgkmcnt(6)
 ds_read_b64_tr_b16 a[72:73], v10 offset:0
 v_accvgpr_write_b32 a2, v30
 v_mfma_f32_16x16x32_bf16 v[84:87], a[96:99], a[192:195], v[84:87]
 s_add_u32 s83, s78, 143360
 ds_read_b64_tr_b16 a[74:75], v10 offset:4096
 v_accvgpr_write_b32 a3, v31
 v_mfma_f32_16x16x32_bf16 v[84:87], a[100:103], a[200:203], v[84:87]
 s_add_u32 s84, s78, 172032
 ds_read_b64_tr_b16 a[76:77], v10 offset:16384
 v_mul_f32 v44, s34, v44
 v_mfma_f32_16x16x32_bf16 v[84:87], a[104:107], a[208:211], v[84:87]
 s_waitcnt lgkmcnt(3)
 ds_read_b64_tr_b16 a[78:79], v10 offset:20480
 v_xor_b32 v7, 160, v6
 v_mfma_f32_16x16x32_bf16 v[84:87], a[108:111], a[216:219], v[84:87]
 s_add_u32 s85, s78, 200704
 ds_read_b64_tr_b16 a[80:81], v7 offset:0
 v_mul_f32 v45, s34, v45
 v_mfma_f32_16x16x32_bf16 v[84:87], a[64:67], a[112:115], v[84:87]
 s_add_u32 s59, s62, 0
 ds_read_b64_tr_b16 a[82:83], v7 offset:4096
 v_mul_f32 v46, s34, v46
 v_mfma_f32_16x16x32_bf16 v[84:87], a[68:71], a[120:123], v[84:87]
 ds_read_b64_tr_b16 a[84:85], v7 offset:16384
 buffer_store_dwordx4 v[28:31], v1, s[12:15], s59 offen offset:0 sc1
 v_mfma_f32_16x16x32_bf16 v[92:95], a[96:99], a[196:199], v[92:95]
 ds_read_b64_tr_b16 a[86:87], v7 offset:20480
 v_xor_b32 v8, 65696, v6
 v_mfma_f32_16x16x32_bf16 v[92:95], a[100:103], a[204:207], v[92:95]
 ds_read_b64_tr_b16 a[88:89], v8 offset:0
 v_mul_f32 v47, s34, v47
 v_mfma_f32_16x16x32_bf16 v[92:95], a[104:107], a[212:215], v[92:95]
 ds_read_b64_tr_b16 a[90:91], v8 offset:4096
 v_mul_f32 v60, s34, v60
 v_mfma_f32_16x16x32_bf16 v[92:95], a[108:111], a[220:223], v[92:95]
 ds_read_b64_tr_b16 a[92:93], v8 offset:16384
 v_mul_f32 v61, s34, v61
 v_mfma_f32_16x16x32_bf16 v[92:95], a[64:67], a[116:119], v[92:95]
 ds_read_b64_tr_b16 a[94:95], v8 offset:20480
 v_xor_b32 v9, 131264, v6
 v_mfma_f32_16x16x32_bf16 v[92:95], a[68:71], a[124:127], v[92:95]
 s_waitcnt lgkmcnt(6)
 ds_read_b64_tr_b16 a[96:97], v9 offset:0
 v_mul_f32 v62, s34, v62
 v_mfma_f32_16x16x32_bf16 v[100:103], a[72:75], a[192:195], v[100:103]
 ds_read_b64_tr_b16 a[98:99], v9 offset:4096
 v_mul_f32 v63, s34, v63
 v_mfma_f32_16x16x32_bf16 v[100:103], a[76:79], a[200:203], v[100:103]
 ds_read_b64_tr_b16 a[100:101], v9 offset:16384
 v_cvt_pk_bf16_f32 v44, v44, v45
 v_mfma_f32_16x16x32_bf16 v[100:103], a[80:83], a[208:211], v[100:103]
 s_waitcnt lgkmcnt(3)
 ds_read_b64_tr_b16 a[102:103], v9 offset:20480
 v_xor_b32 v10, 192, v6
 v_mfma_f32_16x16x32_bf16 v[100:103], a[84:87], a[216:219], v[100:103]
 ds_read_b64_tr_b16 a[104:105], v10 offset:0
 v_cvt_pk_bf16_f32 v45, v46, v47
 v_mfma_f32_16x16x32_bf16 v[100:103], a[88:91], a[112:115], v[100:103]
 ds_read_b64_tr_b16 a[106:107], v10 offset:4096
 v_cvt_pk_bf16_f32 v46, v60, v61
 v_mfma_f32_16x16x32_bf16 v[100:103], a[92:95], a[120:123], v[100:103]
 ds_read_b64_tr_b16 a[108:109], v10 offset:16384
 v_cvt_pk_bf16_f32 v47, v62, v63
 v_mfma_f32_16x16x32_bf16 v[108:111], a[72:75], a[196:199], v[108:111]
 s_add_u32 s59, s62, 8192
 ds_read_b64_tr_b16 a[110:111], v10 offset:20480
 v_xor_b32 v7, 65728, v6
 v_mfma_f32_16x16x32_bf16 v[108:111], a[76:79], a[204:207], v[108:111]
 ds_read_b64_tr_b16 a[64:65], v7 offset:0
 buffer_store_dwordx4 v[44:47], v1, s[12:15], s59 offen offset:0 sc1
 v_mfma_f32_16x16x32_bf16 v[108:111], a[80:83], a[212:215], v[108:111]
 ds_read_b64_tr_b16 a[66:67], v7 offset:4096
 v_accvgpr_write_b32 a32, v44
 v_mfma_f32_16x16x32_bf16 v[108:111], a[84:87], a[220:223], v[108:111]
 ds_read_b64_tr_b16 a[68:69], v7 offset:16384
 v_accvgpr_write_b32 a33, v45
 v_mfma_f32_16x16x32_bf16 v[108:111], a[88:91], a[116:119], v[108:111]
 ds_read_b64_tr_b16 a[70:71], v7 offset:20480
 v_xor_b32 v8, 131296, v6
 v_mfma_f32_16x16x32_bf16 v[108:111], a[92:95], a[124:127], v[108:111]
 s_waitcnt lgkmcnt(6)
 ds_read_b64_tr_b16 a[72:73], v8 offset:0
 v_accvgpr_write_b32 a34, v46
 v_mfma_f32_16x16x32_bf16 v[116:119], a[96:99], a[192:195], v[116:119]
 ds_read_b64_tr_b16 a[74:75], v8 offset:4096
 v_accvgpr_write_b32 a35, v47
 v_mfma_f32_16x16x32_bf16 v[116:119], a[100:103], a[200:203], v[116:119]
 ds_read_b64_tr_b16 a[76:77], v8 offset:16384
 v_mul_f32 v20, s34, v20
 v_mfma_f32_16x16x32_bf16 v[116:119], a[104:107], a[208:211], v[116:119]
 s_waitcnt lgkmcnt(3)
 ds_read_b64_tr_b16 a[78:79], v8 offset:20480
 v_xor_b32 v9, 224, v6
 v_mfma_f32_16x16x32_bf16 v[116:119], a[108:111], a[216:219], v[116:119]
 ds_read_b64_tr_b16 a[80:81], v9 offset:0
 v_mul_f32 v21, s34, v21
 v_mfma_f32_16x16x32_bf16 v[116:119], a[64:67], a[112:115], v[116:119]
 ds_read_b64_tr_b16 a[82:83], v9 offset:4096
 v_mul_f32 v22, s34, v22
 v_mfma_f32_16x16x32_bf16 v[116:119], a[68:71], a[120:123], v[116:119]
 ds_read_b64_tr_b16 a[84:85], v9 offset:16384
 v_mul_f32 v23, s34, v23
 v_mfma_f32_16x16x32_bf16 v[124:127], a[96:99], a[196:199], v[124:127]
 ds_read_b64_tr_b16 a[86:87], v9 offset:20480
 v_xor_b32 v10, 65760, v6
 v_mfma_f32_16x16x32_bf16 v[124:127], a[100:103], a[204:207], v[124:127]
 ds_read_b64_tr_b16 a[88:89], v10 offset:0
 v_mul_f32 v68, s34, v68
 v_mfma_f32_16x16x32_bf16 v[124:127], a[104:107], a[212:215], v[124:127]
 ds_read_b64_tr_b16 a[90:91], v10 offset:4096
 v_mul_f32 v69, s34, v69
 v_mfma_f32_16x16x32_bf16 v[124:127], a[108:111], a[220:223], v[124:127]
 ds_read_b64_tr_b16 a[92:93], v10 offset:16384
 v_mul_f32 v70, s34, v70
 v_mfma_f32_16x16x32_bf16 v[124:127], a[64:67], a[116:119], v[124:127]
 ds_read_b64_tr_b16 a[94:95], v10 offset:20480
 v_xor_b32 v7, 131328, v6
 v_mfma_f32_16x16x32_bf16 v[124:127], a[68:71], a[124:127], v[124:127]
 s_waitcnt lgkmcnt(6)
 ds_read_b64_tr_b16 a[96:97], v7 offset:0
 v_mul_f32 v71, s34, v71
 v_mfma_f32_16x16x32_bf16 v[132:135], a[72:75], a[192:195], v[132:135]
 ds_read_b64_tr_b16 a[98:99], v7 offset:4096
 v_cvt_pk_bf16_f32 v20, v20, v21
 v_mfma_f32_16x16x32_bf16 v[132:135], a[76:79], a[200:203], v[132:135]
 ds_read_b64_tr_b16 a[100:101], v7 offset:16384
 v_cvt_pk_bf16_f32 v21, v22, v23
 v_mfma_f32_16x16x32_bf16 v[132:135], a[80:83], a[208:211], v[132:135]
 s_waitcnt lgkmcnt(3)
 ds_read_b64_tr_b16 a[102:103], v7 offset:20480
 v_xor_b32 v8, 256, v6
 v_mfma_f32_16x16x32_bf16 v[132:135], a[84:87], a[216:219], v[132:135]
 ds_read_b64_tr_b16 a[104:105], v8 offset:0
 v_cvt_pk_bf16_f32 v22, v68, v69
 v_mfma_f32_16x16x32_bf16 v[132:135], a[88:91], a[112:115], v[132:135]
 s_add_u32 s59, s62, 0
 ds_read_b64_tr_b16 a[106:107], v8 offset:4096
 v_cvt_pk_bf16_f32 v23, v70, v71
 v_mfma_f32_16x16x32_bf16 v[132:135], a[92:95], a[120:123], v[132:135]
 ds_read_b64_tr_b16 a[108:109], v8 offset:16384
 buffer_store_dwordx4 v[20:23], v1, s[12:15], s59 offen offset:1024 sc1
 v_mfma_f32_16x16x32_bf16 v[140:143], a[72:75], a[196:199], v[140:143]
 ds_read_b64_tr_b16 a[110:111], v8 offset:20480
 v_xor_b32 v9, 65792, v6
 v_mfma_f32_16x16x32_bf16 v[140:143], a[76:79], a[204:207], v[140:143]
 ds_read_b64_tr_b16 a[64:65], v9 offset:0
 v_accvgpr_write_b32 a4, v20
 v_mfma_f32_16x16x32_bf16 v[140:143], a[80:83], a[212:215], v[140:143]
 ds_read_b64_tr_b16 a[66:67], v9 offset:4096
 v_accvgpr_write_b32 a5, v21
 v_mfma_f32_16x16x32_bf16 v[140:143], a[84:87], a[220:223], v[140:143]
 ds_read_b64_tr_b16 a[68:69], v9 offset:16384
 v_accvgpr_write_b32 a6, v22
 v_mfma_f32_16x16x32_bf16 v[140:143], a[88:91], a[116:119], v[140:143]
 ds_read_b64_tr_b16 a[70:71], v9 offset:20480
 v_xor_b32 v10, 131360, v6
 v_mfma_f32_16x16x32_bf16 v[140:143], a[92:95], a[124:127], v[140:143]
 s_waitcnt lgkmcnt(6)
 ds_read_b64_tr_b16 a[72:73], v10 offset:0
 v_accvgpr_write_b32 a7, v23
 v_mfma_f32_16x16x32_bf16 v[148:151], a[96:99], a[192:195], v[148:151]
 ds_read_b64_tr_b16 a[74:75], v10 offset:4096
 v_mul_f32 v36, s34, v36
 v_mfma_f32_16x16x32_bf16 v[148:151], a[100:103], a[200:203], v[148:151]
 ds_read_b64_tr_b16 a[76:77], v10 offset:16384
 v_mul_f32 v37, s34, v37
 v_mfma_f32_16x16x32_bf16 v[148:151], a[104:107], a[208:211], v[148:151]
 s_waitcnt lgkmcnt(3)
 ds_read_b64_tr_b16 a[78:79], v10 offset:20480
 v_xor_b32 v7, 288, v6
 v_mfma_f32_16x16x32_bf16 v[148:151], a[108:111], a[216:219], v[148:151]
 ds_read_b64_tr_b16 a[80:81], v7 offset:0
 v_mul_f32 v38, s34, v38
 v_mfma_f32_16x16x32_bf16 v[148:151], a[64:67], a[112:115], v[148:151]
 ds_read_b64_tr_b16 a[82:83], v7 offset:4096
 v_mul_f32 v39, s34, v39
 v_mfma_f32_16x16x32_bf16 v[148:151], a[68:71], a[120:123], v[148:151]
 ds_read_b64_tr_b16 a[84:85], v7 offset:16384
 v_mul_f32 v76, s34, v76
 v_mfma_f32_16x16x32_bf16 v[156:159], a[96:99], a[196:199], v[156:159]
 ds_read_b64_tr_b16 a[86:87], v7 offset:20480
 v_xor_b32 v8, 65824, v6
 v_mfma_f32_16x16x32_bf16 v[156:159], a[100:103], a[204:207], v[156:159]
 ds_read_b64_tr_b16 a[88:89], v8 offset:0
 v_mul_f32 v77, s34, v77
 v_mfma_f32_16x16x32_bf16 v[156:159], a[104:107], a[212:215], v[156:159]
 ds_read_b64_tr_b16 a[90:91], v8 offset:4096
 v_mul_f32 v78, s34, v78
 v_mfma_f32_16x16x32_bf16 v[156:159], a[108:111], a[220:223], v[156:159]
 ds_read_b64_tr_b16 a[92:93], v8 offset:16384
 v_mul_f32 v79, s34, v79
 v_mfma_f32_16x16x32_bf16 v[156:159], a[64:67], a[116:119], v[156:159]
 ds_read_b64_tr_b16 a[94:95], v8 offset:20480
 v_xor_b32 v9, 131392, v6
 v_mfma_f32_16x16x32_bf16 v[156:159], a[68:71], a[124:127], v[156:159]
 s_waitcnt lgkmcnt(6)
 ds_read_b64_tr_b16 a[96:97], v9 offset:0
 v_cvt_pk_bf16_f32 v36, v36, v37
 v_mfma_f32_16x16x32_bf16 v[164:167], a[72:75], a[192:195], v[164:167]
 ds_read_b64_tr_b16 a[98:99], v9 offset:4096
 v_cvt_pk_bf16_f32 v37, v38, v39
 v_mfma_f32_16x16x32_bf16 v[164:167], a[76:79], a[200:203], v[164:167]
 ds_read_b64_tr_b16 a[100:101], v9 offset:16384
 v_cvt_pk_bf16_f32 v38, v76, v77
 v_mfma_f32_16x16x32_bf16 v[164:167], a[80:83], a[208:211], v[164:167]
 s_waitcnt lgkmcnt(3)
 ds_read_b64_tr_b16 a[102:103], v9 offset:20480
 v_xor_b32 v10, 320, v6
 v_mfma_f32_16x16x32_bf16 v[164:167], a[84:87], a[216:219], v[164:167]
 s_add_u32 s59, s62, 8192
 ds_read_b64_tr_b16 a[104:105], v10 offset:0
 v_cvt_pk_bf16_f32 v39, v78, v79
 v_mfma_f32_16x16x32_bf16 v[164:167], a[88:91], a[112:115], v[164:167]
 ds_read_b64_tr_b16 a[106:107], v10 offset:4096
 buffer_store_dwordx4 v[36:39], v1, s[12:15], s59 offen offset:1024 sc1
 v_mfma_f32_16x16x32_bf16 v[164:167], a[92:95], a[120:123], v[164:167]
 ds_read_b64_tr_b16 a[108:109], v10 offset:16384
 v_accvgpr_write_b32 a36, v36
 v_mfma_f32_16x16x32_bf16 v[172:175], a[72:75], a[196:199], v[172:175]
 ds_read_b64_tr_b16 a[110:111], v10 offset:20480
 v_xor_b32 v7, 65856, v6
 v_mfma_f32_16x16x32_bf16 v[172:175], a[76:79], a[204:207], v[172:175]
 ds_read_b64_tr_b16 a[64:65], v7 offset:0
 v_accvgpr_write_b32 a37, v37
 v_mfma_f32_16x16x32_bf16 v[172:175], a[80:83], a[212:215], v[172:175]
 ds_read_b64_tr_b16 a[66:67], v7 offset:4096
 v_accvgpr_write_b32 a38, v38
 v_mfma_f32_16x16x32_bf16 v[172:175], a[84:87], a[220:223], v[172:175]
 ds_read_b64_tr_b16 a[68:69], v7 offset:16384
 v_accvgpr_write_b32 a39, v39
 v_mfma_f32_16x16x32_bf16 v[172:175], a[88:91], a[116:119], v[172:175]
 ds_read_b64_tr_b16 a[70:71], v7 offset:20480
 v_xor_b32 v8, 131424, v6
 v_mfma_f32_16x16x32_bf16 v[172:175], a[92:95], a[124:127], v[172:175]
 s_waitcnt lgkmcnt(6)
 ds_read_b64_tr_b16 a[72:73], v8 offset:0
 v_mul_f32 v84, s34, v84
 v_mfma_f32_16x16x32_bf16 v[180:183], a[96:99], a[192:195], v[180:183]
 ds_read_b64_tr_b16 a[74:75], v8 offset:4096
 v_mul_f32 v85, s34, v85
 v_mfma_f32_16x16x32_bf16 v[180:183], a[100:103], a[200:203], v[180:183]
 ds_read_b64_tr_b16 a[76:77], v8 offset:16384
 v_mul_f32 v86, s34, v86
 v_mfma_f32_16x16x32_bf16 v[180:183], a[104:107], a[208:211], v[180:183]
 s_waitcnt lgkmcnt(3)
 ds_read_b64_tr_b16 a[78:79], v8 offset:20480
 v_xor_b32 v9, 352, v6
 v_mfma_f32_16x16x32_bf16 v[180:183], a[108:111], a[216:219], v[180:183]
 ds_read_b64_tr_b16 a[80:81], v9 offset:0
 v_mul_f32 v87, s34, v87
 v_mfma_f32_16x16x32_bf16 v[180:183], a[64:67], a[112:115], v[180:183]
 ds_read_b64_tr_b16 a[82:83], v9 offset:4096
 v_mul_f32 v100, s34, v100
 v_mfma_f32_16x16x32_bf16 v[180:183], a[68:71], a[120:123], v[180:183]
 ds_read_b64_tr_b16 a[84:85], v9 offset:16384
 v_mul_f32 v101, s34, v101
 v_mfma_f32_16x16x32_bf16 v[188:191], a[96:99], a[196:199], v[188:191]
 ds_read_b64_tr_b16 a[86:87], v9 offset:20480
 v_xor_b32 v10, 65888, v6
 v_mfma_f32_16x16x32_bf16 v[188:191], a[100:103], a[204:207], v[188:191]
 ds_read_b64_tr_b16 a[88:89], v10 offset:0
 v_mul_f32 v102, s34, v102
 v_mfma_f32_16x16x32_bf16 v[188:191], a[104:107], a[212:215], v[188:191]
 ds_read_b64_tr_b16 a[90:91], v10 offset:4096
 v_mul_f32 v103, s34, v103
 v_mfma_f32_16x16x32_bf16 v[188:191], a[108:111], a[220:223], v[188:191]
 ds_read_b64_tr_b16 a[92:93], v10 offset:16384
 v_cvt_pk_bf16_f32 v84, v84, v85
 v_mfma_f32_16x16x32_bf16 v[188:191], a[64:67], a[116:119], v[188:191]
 ds_read_b64_tr_b16 a[94:95], v10 offset:20480
 v_xor_b32 v7, 131456, v6
 v_mfma_f32_16x16x32_bf16 v[188:191], a[68:71], a[124:127], v[188:191]
 s_waitcnt lgkmcnt(6)
 ds_read_b64_tr_b16 a[96:97], v7 offset:0
 v_cvt_pk_bf16_f32 v85, v86, v87
 v_mfma_f32_16x16x32_bf16 v[196:199], a[72:75], a[192:195], v[196:199]
 ds_read_b64_tr_b16 a[98:99], v7 offset:4096
 v_cvt_pk_bf16_f32 v86, v100, v101
 v_mfma_f32_16x16x32_bf16 v[196:199], a[76:79], a[200:203], v[196:199]
 s_add_u32 s59, s62, 0
 ds_read_b64_tr_b16 a[100:101], v7 offset:16384
 v_cvt_pk_bf16_f32 v87, v102, v103
 v_mfma_f32_16x16x32_bf16 v[196:199], a[80:83], a[208:211], v[196:199]
 s_waitcnt lgkmcnt(3)
 ds_read_b64_tr_b16 a[102:103], v7 offset:20480
 v_xor_b32 v8, 384, v6
 v_mfma_f32_16x16x32_bf16 v[196:199], a[84:87], a[216:219], v[196:199]
 ds_read_b64_tr_b16 a[104:105], v8 offset:0
 buffer_store_dwordx4 v[84:87], v1, s[12:15], s59 offen offset:2048 sc1
 v_mfma_f32_16x16x32_bf16 v[196:199], a[88:91], a[112:115], v[196:199]
 ds_read_b64_tr_b16 a[106:107], v8 offset:4096
 v_accvgpr_write_b32 a8, v84
 v_mfma_f32_16x16x32_bf16 v[196:199], a[92:95], a[120:123], v[196:199]
 ds_read_b64_tr_b16 a[108:109], v8 offset:16384
 v_accvgpr_write_b32 a9, v85
 v_mfma_f32_16x16x32_bf16 v[204:207], a[72:75], a[196:199], v[204:207]
 ds_read_b64_tr_b16 a[110:111], v8 offset:20480
 v_xor_b32 v9, 65920, v6
 v_mfma_f32_16x16x32_bf16 v[204:207], a[76:79], a[204:207], v[204:207]
 ds_read_b64_tr_b16 a[64:65], v9 offset:0
 v_accvgpr_write_b32 a10, v86
 v_mfma_f32_16x16x32_bf16 v[204:207], a[80:83], a[212:215], v[204:207]
 ds_read_b64_tr_b16 a[66:67], v9 offset:4096
 v_accvgpr_write_b32 a11, v87
 v_mfma_f32_16x16x32_bf16 v[204:207], a[84:87], a[220:223], v[204:207]
 ds_read_b64_tr_b16 a[68:69], v9 offset:16384
 v_mul_f32 v92, s34, v92
 v_mfma_f32_16x16x32_bf16 v[204:207], a[88:91], a[116:119], v[204:207]
 ds_read_b64_tr_b16 a[70:71], v9 offset:20480
 v_xor_b32 v10, 131488, v6
 v_mfma_f32_16x16x32_bf16 v[204:207], a[92:95], a[124:127], v[204:207]
 s_waitcnt lgkmcnt(6)
 ds_read_b64_tr_b16 a[72:73], v10 offset:0
 v_mul_f32 v93, s34, v93
 v_mfma_f32_16x16x32_bf16 v[212:215], a[96:99], a[192:195], v[212:215]
 ds_read_b64_tr_b16 a[74:75], v10 offset:4096
 v_mul_f32 v94, s34, v94
 v_mfma_f32_16x16x32_bf16 v[212:215], a[100:103], a[200:203], v[212:215]
 ds_read_b64_tr_b16 a[76:77], v10 offset:16384
 v_mul_f32 v95, s34, v95
 v_mfma_f32_16x16x32_bf16 v[212:215], a[104:107], a[208:211], v[212:215]
 s_waitcnt lgkmcnt(3)
 ds_read_b64_tr_b16 a[78:79], v10 offset:20480
 v_xor_b32 v7, 416, v6
 v_mfma_f32_16x16x32_bf16 v[212:215], a[108:111], a[216:219], v[212:215]
 ds_read_b64_tr_b16 a[80:81], v7 offset:0
 v_mul_f32 v108, s34, v108
 v_mfma_f32_16x16x32_bf16 v[212:215], a[64:67], a[112:115], v[212:215]
 ds_read_b64_tr_b16 a[82:83], v7 offset:4096
 v_mul_f32 v109, s34, v109
 v_mfma_f32_16x16x32_bf16 v[212:215], a[68:71], a[120:123], v[212:215]
 ds_read_b64_tr_b16 a[84:85], v7 offset:16384
 v_mul_f32 v110, s34, v110
 v_mfma_f32_16x16x32_bf16 v[220:223], a[96:99], a[196:199], v[220:223]
 ds_read_b64_tr_b16 a[86:87], v7 offset:20480
 v_xor_b32 v8, 65952, v6
 v_mfma_f32_16x16x32_bf16 v[220:223], a[100:103], a[204:207], v[220:223]
 ds_read_b64_tr_b16 a[88:89], v8 offset:0
 v_mul_f32 v111, s34, v111
 v_mfma_f32_16x16x32_bf16 v[220:223], a[104:107], a[212:215], v[220:223]
 ds_read_b64_tr_b16 a[90:91], v8 offset:4096
 v_cvt_pk_bf16_f32 v92, v92, v93
 v_mfma_f32_16x16x32_bf16 v[220:223], a[108:111], a[220:223], v[220:223]
 ds_read_b64_tr_b16 a[92:93], v8 offset:16384
 v_cvt_pk_bf16_f32 v93, v94, v95
 v_mfma_f32_16x16x32_bf16 v[220:223], a[64:67], a[116:119], v[220:223]
 ds_read_b64_tr_b16 a[94:95], v8 offset:20480
 v_xor_b32 v9, 131520, v6
 v_mfma_f32_16x16x32_bf16 v[220:223], a[68:71], a[124:127], v[220:223]
 s_waitcnt lgkmcnt(6)
 ds_read_b64_tr_b16 a[96:97], v9 offset:0
 v_cvt_pk_bf16_f32 v94, v108, v109
 v_mfma_f32_16x16x32_bf16 v[228:231], a[72:75], a[192:195], v[228:231]
 s_add_u32 s59, s62, 8192
 ds_read_b64_tr_b16 a[98:99], v9 offset:4096
 v_cvt_pk_bf16_f32 v95, v110, v111
 v_mfma_f32_16x16x32_bf16 v[228:231], a[76:79], a[200:203], v[228:231]
 ds_read_b64_tr_b16 a[100:101], v9 offset:16384
 buffer_store_dwordx4 v[92:95], v1, s[12:15], s59 offen offset:2048 sc1
 v_mfma_f32_16x16x32_bf16 v[228:231], a[80:83], a[208:211], v[228:231]
 s_waitcnt lgkmcnt(3)
 ds_read_b64_tr_b16 a[102:103], v9 offset:20480
 v_xor_b32 v10, 448, v6
 v_mfma_f32_16x16x32_bf16 v[228:231], a[84:87], a[216:219], v[228:231]
 ds_read_b64_tr_b16 a[104:105], v10 offset:0
 v_accvgpr_write_b32 a40, v92
 v_mfma_f32_16x16x32_bf16 v[228:231], a[88:91], a[112:115], v[228:231]
 ds_read_b64_tr_b16 a[106:107], v10 offset:4096
 v_accvgpr_write_b32 a41, v93
 v_mfma_f32_16x16x32_bf16 v[228:231], a[92:95], a[120:123], v[228:231]
 ds_read_b64_tr_b16 a[108:109], v10 offset:16384
 v_accvgpr_write_b32 a42, v94
 v_mfma_f32_16x16x32_bf16 v[236:239], a[72:75], a[196:199], v[236:239]
 ds_read_b64_tr_b16 a[110:111], v10 offset:20480
 v_xor_b32 v7, 65984, v6
 v_mfma_f32_16x16x32_bf16 v[236:239], a[76:79], a[204:207], v[236:239]
 ds_read_b64_tr_b16 a[64:65], v7 offset:0
 buffer_load_dword v13, v12, s[12:15], s58 offen sc1
 v_mfma_f32_16x16x32_bf16 v[236:239], a[80:83], a[212:215], v[236:239]
 ds_read_b64_tr_b16 a[66:67], v7 offset:4096
 v_accvgpr_write_b32 a43, v95
 v_mfma_f32_16x16x32_bf16 v[236:239], a[84:87], a[220:223], v[236:239]
 ds_read_b64_tr_b16 a[68:69], v7 offset:16384
 v_mul_f32 v116, s34, v116
 v_mfma_f32_16x16x32_bf16 v[236:239], a[88:91], a[116:119], v[236:239]
 ds_read_b64_tr_b16 a[70:71], v7 offset:20480
 v_xor_b32 v8, 131552, v6
 v_mfma_f32_16x16x32_bf16 v[236:239], a[92:95], a[124:127], v[236:239]
 s_waitcnt lgkmcnt(6)
 ds_read_b64_tr_b16 a[72:73], v8 offset:0
 v_mul_f32 v117, s34, v117
 v_mfma_f32_16x16x32_bf16 v[244:247], a[96:99], a[192:195], v[244:247]
 ds_read_b64_tr_b16 a[74:75], v8 offset:4096
 v_mul_f32 v118, s34, v118
 v_mfma_f32_16x16x32_bf16 v[244:247], a[100:103], a[200:203], v[244:247]
 ds_read_b64_tr_b16 a[76:77], v8 offset:16384
 v_mul_f32 v119, s34, v119
 v_mfma_f32_16x16x32_bf16 v[244:247], a[104:107], a[208:211], v[244:247]
 s_waitcnt lgkmcnt(3)
 ds_read_b64_tr_b16 a[78:79], v8 offset:20480
 v_xor_b32 v9, 480, v6
 v_mfma_f32_16x16x32_bf16 v[244:247], a[108:111], a[216:219], v[244:247]
 ds_read_b64_tr_b16 a[80:81], v9 offset:0
 v_mul_f32 v132, s34, v132
 v_mfma_f32_16x16x32_bf16 v[244:247], a[64:67], a[112:115], v[244:247]
 ds_read_b64_tr_b16 a[82:83], v9 offset:4096
 v_mul_f32 v133, s34, v133
 v_mfma_f32_16x16x32_bf16 v[244:247], a[68:71], a[120:123], v[244:247]
 ds_read_b64_tr_b16 a[84:85], v9 offset:16384
 v_mul_f32 v134, s34, v134
 v_mfma_f32_16x16x32_bf16 v[252:255], a[96:99], a[196:199], v[252:255]
 ds_read_b64_tr_b16 a[86:87], v9 offset:20480
 v_xor_b32 v10, 66016, v6
 v_mfma_f32_16x16x32_bf16 v[252:255], a[100:103], a[204:207], v[252:255]
 ds_read_b64_tr_b16 a[88:89], v10 offset:0
 v_mul_f32 v135, s34, v135
 v_mfma_f32_16x16x32_bf16 v[252:255], a[104:107], a[212:215], v[252:255]
 ds_read_b64_tr_b16 a[90:91], v10 offset:4096
 v_cvt_pk_bf16_f32 v116, v116, v117
 v_mfma_f32_16x16x32_bf16 v[252:255], a[108:111], a[220:223], v[252:255]
 ds_read_b64_tr_b16 a[92:93], v10 offset:16384
 v_cvt_pk_bf16_f32 v117, v118, v119
 v_mfma_f32_16x16x32_bf16 v[252:255], a[64:67], a[116:119], v[252:255]
 s_add_u32 s59, s62, 0
 ds_read_b64_tr_b16 a[94:95], v10 offset:20480
 v_cvt_pk_bf16_f32 v118, v132, v133
 v_mfma_f32_16x16x32_bf16 v[252:255], a[68:71], a[124:127], v[252:255]
 s_waitcnt lgkmcnt(6)
 v_cvt_pk_bf16_f32 v119, v134, v135
 v_accvgpr_write_b32 a12, v116
 v_mfma_f32_16x16x32_bf16 v[16:19], a[72:75], a[192:195], v[16:19]
 buffer_store_dwordx4 v[116:119], v1, s[12:15], s59 offen offset:3072 sc1
 v_mfma_f32_16x16x32_bf16 v[16:19], a[76:79], a[200:203], v[16:19]
 v_accvgpr_write_b32 a13, v117
 v_accvgpr_write_b32 a14, v118
 v_mfma_f32_16x16x32_bf16 v[16:19], a[80:83], a[208:211], v[16:19]
 s_waitcnt lgkmcnt(0)
 v_accvgpr_write_b32 a15, v119
 v_mfma_f32_16x16x32_bf16 v[16:19], a[84:87], a[216:219], v[16:19]
 v_mfma_f32_16x16x32_bf16 v[16:19], a[88:91], a[112:115], v[16:19]
 v_mfma_f32_16x16x32_bf16 v[16:19], a[92:95], a[120:123], v[16:19]
 v_mfma_f32_16x16x32_bf16 v[24:27], a[72:75], a[196:199], v[24:27]
 v_mfma_f32_16x16x32_bf16 v[24:27], a[76:79], a[204:207], v[24:27]
 v_mfma_f32_16x16x32_bf16 v[24:27], a[80:83], a[212:215], v[24:27]
 v_mfma_f32_16x16x32_bf16 v[24:27], a[84:87], a[220:223], v[24:27]
 s_waitcnt lgkmcnt(0)
 v_mfma_f32_16x16x32_bf16 v[24:27], a[88:91], a[116:119], v[24:27]
 s_barrier
 v_mfma_f32_16x16x32_bf16 v[24:27], a[92:95], a[124:127], v[24:27]
 s_waitcnt vmcnt(1)
 v_cmp_ne_u32 s[16:17], 0, v13
 v_cmp_gt_u32 vcc, 256, v5
 s_or_b64 vcc, vcc, s[16:17]
 s_mov_b32 m0, s40
 s_cselect_b32 s48, 0, 1
 s_cselect_b32 s52, 2.0, s42
 buffer_load_dwordx4 v1, s[12:15], s52 offen offset:0 sc1 lds
 v_pk_mul_f32 v[124:125], v[124:125], s[34:35]
 v_pk_mul_f32 v[126:127], v[126:127], s[34:35]
 v_pk_mul_f32 v[140:141], v[140:141], s[34:35]
 v_pk_mul_f32 v[142:143], v[142:143], s[34:35]
 v_cvt_pk_bf16_f32 v124, v124, v125
 v_cvt_pk_bf16_f32 v125, v126, v127
 v_cvt_pk_bf16_f32 v126, v140, v141
 v_cvt_pk_bf16_f32 v127, v142, v143
 s_add_u32 s59, s62, 8192
 buffer_store_dwordx4 v[124:127], v1, s[12:15], s59 offen offset:3072 sc1
 v_accvgpr_write_b32 a44, v124
 v_accvgpr_write_b32 a45, v125
 v_accvgpr_write_b32 a46, v126
 v_accvgpr_write_b32 a47, v127
 v_pk_mul_f32 v[148:149], v[148:149], s[34:35]
 v_pk_mul_f32 v[150:151], v[150:151], s[34:35]
 buffer_load_dwordx4 v1, s[12:15], s52 offen offset:1024 sc1 lds
 v_pk_mul_f32 v[164:165], v[164:165], s[34:35]
 v_pk_mul_f32 v[166:167], v[166:167], s[34:35]
 v_cvt_pk_bf16_f32 v148, v148, v149
 v_cvt_pk_bf16_f32 v149, v150, v151
 v_cvt_pk_bf16_f32 v150, v164, v165
 v_cvt_pk_bf16_f32 v151, v166, v167
 s_add_u32 s59, s62, 4096
 buffer_store_dwordx4 v[148:151], v1, s[12:15], s59 offen offset:0 sc1
 v_accvgpr_write_b32 a16, v148
 v_accvgpr_write_b32 a17, v149
 v_accvgpr_write_b32 a18, v150
 v_accvgpr_write_b32 a19, v151
 v_pk_mul_f32 v[156:157], v[156:157], s[34:35]
 v_pk_mul_f32 v[158:159], v[158:159], s[34:35]
 v_pk_mul_f32 v[172:173], v[172:173], s[34:35]
 v_pk_mul_f32 v[174:175], v[174:175], s[34:35]
 buffer_load_dwordx4 v1, s[12:15], s52 offen offset:2048 sc1 lds
 v_cvt_pk_bf16_f32 v156, v156, v157
 v_cvt_pk_bf16_f32 v157, v158, v159
 v_cvt_pk_bf16_f32 v158, v172, v173
 v_cvt_pk_bf16_f32 v159, v174, v175
 s_add_u32 s59, s62, 12288
 buffer_store_dwordx4 v[156:159], v1, s[12:15], s59 offen offset:0 sc1
 v_accvgpr_write_b32 a48, v156
 v_accvgpr_write_b32 a49, v157
 v_accvgpr_write_b32 a50, v158
 v_accvgpr_write_b32 a51, v159
 v_pk_mul_f32 v[180:181], v[180:181], s[34:35]
 v_pk_mul_f32 v[182:183], v[182:183], s[34:35]
 v_pk_mul_f32 v[196:197], v[196:197], s[34:35]
 v_pk_mul_f32 v[198:199], v[198:199], s[34:35]
 v_cvt_pk_bf16_f32 v180, v180, v181
 v_cvt_pk_bf16_f32 v181, v182, v183
 buffer_load_dwordx4 v1, s[12:15], s52 offen offset:3072 sc1 lds
 v_cvt_pk_bf16_f32 v182, v196, v197
 v_cvt_pk_bf16_f32 v183, v198, v199
 s_add_u32 s59, s62, 4096
 buffer_store_dwordx4 v[180:183], v1, s[12:15], s59 offen offset:1024 sc1
 v_accvgpr_write_b32 a20, v180
 v_accvgpr_write_b32 a21, v181
 v_accvgpr_write_b32 a22, v182
 v_accvgpr_write_b32 a23, v183
 v_pk_mul_f32 v[188:189], v[188:189], s[34:35]
 v_pk_mul_f32 v[190:191], v[190:191], s[34:35]
 v_pk_mul_f32 v[204:205], v[204:205], s[34:35]
 v_pk_mul_f32 v[206:207], v[206:207], s[34:35]
 v_cvt_pk_bf16_f32 v188, v188, v189
 v_cvt_pk_bf16_f32 v189, v190, v191
 v_cvt_pk_bf16_f32 v190, v204, v205
 s_bitset1_b32 m0, 12
 s_nop 0
 buffer_load_dwordx4 v4, s[12:15], s52 offen offset:0 sc1 lds
 v_cvt_pk_bf16_f32 v191, v206, v207
 s_add_u32 s59, s62, 12288
 buffer_store_dwordx4 v[188:191], v1, s[12:15], s59 offen offset:1024 sc1
 v_accvgpr_write_b32 a52, v188
 v_accvgpr_write_b32 a53, v189
 v_accvgpr_write_b32 a54, v190
 v_accvgpr_write_b32 a55, v191
 v_pk_mul_f32 v[212:213], v[212:213], s[34:35]
 v_pk_mul_f32 v[214:215], v[214:215], s[34:35]
 v_pk_mul_f32 v[228:229], v[228:229], s[34:35]
 v_pk_mul_f32 v[230:231], v[230:231], s[34:35]
 v_cvt_pk_bf16_f32 v212, v212, v213
 v_cvt_pk_bf16_f32 v213, v214, v215
 v_cvt_pk_bf16_f32 v214, v228, v229
 v_cvt_pk_bf16_f32 v215, v230, v231
 s_add_u32 s59, s62, 4096
 buffer_load_dwordx4 v4, s[12:15], s52 offen offset:1024 sc1 lds
 buffer_store_dwordx4 v[212:215], v1, s[12:15], s59 offen offset:2048 sc1
 v_accvgpr_write_b32 a24, v212
 v_accvgpr_write_b32 a25, v213
 v_accvgpr_write_b32 a26, v214
 v_accvgpr_write_b32 a27, v215
 v_pk_mul_f32 v[220:221], v[220:221], s[34:35]
 v_pk_mul_f32 v[222:223], v[222:223], s[34:35]
 v_pk_mul_f32 v[236:237], v[236:237], s[34:35]
 v_pk_mul_f32 v[238:239], v[238:239], s[34:35]
 v_cvt_pk_bf16_f32 v220, v220, v221
 v_cvt_pk_bf16_f32 v221, v222, v223
 v_cvt_pk_bf16_f32 v222, v236, v237
 v_cvt_pk_bf16_f32 v223, v238, v239
 s_add_u32 s59, s62, 12288
 buffer_store_dwordx4 v[220:223], v1, s[12:15], s59 offen offset:2048 sc1
 v_accvgpr_write_b32 a56, v220
 buffer_load_dwordx4 v4, s[12:15], s52 offen offset:2048 sc1 lds
 v_accvgpr_write_b32 a57, v221
 v_accvgpr_write_b32 a58, v222
 v_accvgpr_write_b32 a59, v223
 v_pk_mul_f32 v[244:245], v[244:245], s[34:35]
 v_pk_mul_f32 v[246:247], v[246:247], s[34:35]
 v_pk_mul_f32 v[16:17], v[16:17], s[34:35]
 v_pk_mul_f32 v[18:19], v[18:19], s[34:35]
 v_cvt_pk_bf16_f32 v244, v244, v245
 v_cvt_pk_bf16_f32 v245, v246, v247
 v_cvt_pk_bf16_f32 v246, v16, v17
 v_cvt_pk_bf16_f32 v247, v18, v19
 s_add_u32 s59, s62, 4096
 buffer_store_dwordx4 v[244:247], v1, s[12:15], s59 offen offset:3072 sc1
 v_accvgpr_write_b32 a28, v244
 v_accvgpr_write_b32 a29, v245
 v_accvgpr_write_b32 a30, v246
 buffer_load_dwordx4 v4, s[12:15], s52 offen offset:3072 sc1 lds
 v_accvgpr_write_b32 a31, v247
 v_pk_mul_f32 v[252:253], v[252:253], s[34:35]
 v_pk_mul_f32 v[254:255], v[254:255], s[34:35]
 v_pk_mul_f32 v[24:25], v[24:25], s[34:35]
 v_pk_mul_f32 v[26:27], v[26:27], s[34:35]
 v_cvt_pk_bf16_f32 v252, v252, v253
 v_cvt_pk_bf16_f32 v253, v254, v255
 v_cvt_pk_bf16_f32 v254, v24, v25
 v_cvt_pk_bf16_f32 v255, v26, v27
 s_add_u32 s59, s62, 12288
 buffer_store_dwordx4 v[252:255], v1, s[12:15], s59 offen offset:3072 sc1
 v_accvgpr_write_b32 a60, v252
 v_accvgpr_write_b32 a61, v253
 v_accvgpr_write_b32 a62, v254
 v_accvgpr_write_b32 a63, v255
 s_branch L_kvdone
L_late1:
 v_mfma_f32_16x16x32_bf16 v[16:19], a[96:99], a[0:3], v[16:19]
 ds_read_b64_tr_b16 a[24:25], v9 offset:32768
 v_mfma_f32_16x16x32_bf16 v[16:19], a[100:103], a[4:7], v[16:19]
 s_add_u32 m0, s33, 0xfffffd00
 ds_read_b64_tr_b16 a[26:27], v9 offset:36864
 v_mfma_f32_16x16x32_bf16 v[20:23], a[108:111], a[4:7], v[20:23]
 s_waitcnt lgkmcnt(13)
 ds_read_b64_tr_b16 a[28:29], v9 offset:49152
 v_mfma_f32_16x16x32_bf16 v[20:23], a[104:107], a[0:3], v[20:23]
 ds_read_b64_tr_b16 a[30:31], v9 offset:53248
 buffer_load_dwordx4 v15, s[20:23], 0 offen offset:768 lds
 v_mfma_f32_16x16x32_bf16 v[24:27], a[112:115], a[0:3], v[24:27]
 s_waitcnt lgkmcnt(12)
 ds_read_b128 a[64:67], v4 offset:32768
 v_mfma_f32_16x16x32_bf16 v[24:27], a[116:119], a[4:7], v[24:27]
 v_mfma_f32_16x16x32_bf16 v[28:31], a[124:127], a[4:7], v[28:31]
 s_add_u32 m0, s33, 0xfffffd80
 ds_read_b128 a[68:71], v5 offset:32768
 v_mfma_f32_16x16x32_bf16 v[28:31], a[120:123], a[0:3], v[28:31]
 s_waitcnt lgkmcnt(10)
 buffer_load_dwordx4 v15, s[20:23], 0 offen offset:1664 lds
 v_mfma_f32_16x16x32_bf16 a[228:231], a[120:123], a[8:11], a[228:231]
 ds_read_b128 a[76:79], v5 offset:34816
 v_mfma_f32_16x16x32_bf16 a[228:231], a[124:127], a[12:15], a[228:231]
 v_mfma_f32_16x16x32_bf16 a[224:227], a[116:119], a[12:15], a[224:227]
 s_add_u32 m0, s33, 0x500
 ds_read_b128 a[72:75], v4 offset:34816
 v_mfma_f32_16x16x32_bf16 a[224:227], a[112:115], a[8:11], a[224:227]
 buffer_load_dwordx4 v15, s[20:23], s57 offen offset:768 lds
 v_mfma_f32_16x16x32_bf16 a[236:239], a[104:107], a[8:11], a[236:239]
 ds_read_b128 a[80:83], v4 offset:36864
 v_cvt_pk_bf16_f32 v16, v16, v17
 v_mfma_f32_16x16x32_bf16 a[236:239], a[108:111], a[12:15], a[236:239]
 v_cvt_pk_bf16_f32 v17, v18, v19
 v_cvt_pk_bf16_f32 v18, v20, v21
 v_mfma_f32_16x16x32_bf16 a[232:235], a[100:103], a[12:15], a[232:235]
 s_add_u32 m0, s33, 0x580
 ds_read_b128 a[84:87], v5 offset:36864
 v_cvt_pk_bf16_f32 v19, v22, v23
 v_mfma_f32_16x16x32_bf16 a[232:235], a[96:99], a[8:11], a[232:235]
 s_waitcnt lgkmcnt(10)
 buffer_load_dwordx4 v15, s[20:23], s57 offen offset:1664 lds
 v_mfma_f32_16x16x32_bf16 v[32:35], a[96:99], a[16:19], v[32:35]
 ds_read_b128 a[92:95], v5 offset:38912
 v_cvt_pk_bf16_f32 v24, v24, v25
 v_mfma_f32_16x16x32_bf16 v[32:35], a[100:103], a[20:23], v[32:35]
 v_cvt_pk_bf16_f32 v25, v26, v27
 v_cvt_pk_bf16_f32 v26, v28, v29
 v_mfma_f32_16x16x32_bf16 v[36:39], a[108:111], a[20:23], v[36:39]
 ds_read_b128 a[88:91], v4 offset:38912
 v_cvt_pk_bf16_f32 v27, v30, v31
 v_mfma_f32_16x16x32_bf16 v[36:39], a[104:107], a[16:19], v[36:39]
 v_accvgpr_read_b32 v20, a224
 v_accvgpr_read_b32 v21, a225
 v_mfma_f32_16x16x32_bf16 v[40:43], a[112:115], a[16:19], v[40:43]
 ds_read_b64_tr_b16 a[32:33], v10 offset:32768
 v_accvgpr_read_b32 v22, a226
 v_mfma_f32_16x16x32_bf16 v[40:43], a[116:119], a[20:23], v[40:43]
 ds_read_b64_tr_b16 a[34:35], v10 offset:36864
 v_accvgpr_read_b32 v23, a227
 v_mfma_f32_16x16x32_bf16 v[44:47], a[124:127], a[20:23], v[44:47]
 s_add_u32 s59, s56, 32768
 ds_read_b64_tr_b16 a[36:37], v10 offset:49152
 v_accvgpr_read_b32 v28, a228
 v_mfma_f32_16x16x32_bf16 v[44:47], a[120:123], a[16:19], v[44:47]
 s_waitcnt lgkmcnt(11)
 ds_read_b64_tr_b16 a[38:39], v10 offset:53248
 v_accvgpr_read_b32 v29, a229
 v_mfma_f32_16x16x32_bf16 v[52:55], a[120:123], a[24:27], v[52:55]
 ds_read_b64_tr_b16 a[40:41], v11 offset:32768
 buffer_store_dwordx4 v[16:19], v1, s[12:15], s59 offen offset:0 sc1
 v_mfma_f32_16x16x32_bf16 v[52:55], a[124:127], a[28:31], v[52:55]
 ds_read_b64_tr_b16 a[42:43], v11 offset:36864
 v_accvgpr_read_b32 v30, a230
 v_mfma_f32_16x16x32_bf16 v[48:51], a[116:119], a[28:31], v[48:51]
 ds_read_b64_tr_b16 a[44:45], v11 offset:49152
 v_accvgpr_read_b32 v31, a231
 v_mfma_f32_16x16x32_bf16 v[48:51], a[112:115], a[24:27], v[48:51]
 ds_read_b64_tr_b16 a[46:47], v11 offset:53248
 v_cvt_pk_bf16_f32 v20, v20, v21
 v_mfma_f32_16x16x32_bf16 v[60:63], a[104:107], a[24:27], v[60:63]
 ds_read_b64_tr_b16 a[48:49], v12 offset:32768
 v_cvt_pk_bf16_f32 v21, v22, v23
 v_mfma_f32_16x16x32_bf16 v[60:63], a[108:111], a[28:31], v[60:63]
 ds_read_b64_tr_b16 a[50:51], v12 offset:36864
 v_cvt_pk_bf16_f32 v22, v28, v29
 v_mfma_f32_16x16x32_bf16 v[56:59], a[100:103], a[28:31], v[56:59]
 s_add_u32 s59, s56, 49152
 ds_read_b64_tr_b16 a[52:53], v12 offset:49152
 v_cvt_pk_bf16_f32 v23, v30, v31
 v_mfma_f32_16x16x32_bf16 v[56:59], a[96:99], a[24:27], v[56:59]
 s_waitcnt lgkmcnt(15)
 ds_read_b64_tr_b16 a[54:55], v12 offset:53248
 buffer_store_dwordx4 v[24:27], v1, s[12:15], s59 offen offset:0 sc1
 v_mfma_f32_16x16x32_bf16 v[64:67], a[64:67], a[0:3], v[64:67]
 ds_read_b64_tr_b16 a[56:57], v13 offset:32768
 v_cvt_pk_bf16_f32 v32, v32, v33
 v_mfma_f32_16x16x32_bf16 v[64:67], a[68:71], a[4:7], v[64:67]
 ds_read_b64_tr_b16 a[58:59], v13 offset:36864
 v_cvt_pk_bf16_f32 v33, v34, v35
 v_mfma_f32_16x16x32_bf16 v[68:71], a[76:79], a[4:7], v[68:71]
 ds_read_b64_tr_b16 a[60:61], v13 offset:49152
 v_cvt_pk_bf16_f32 v34, v36, v37
 v_mfma_f32_16x16x32_bf16 v[68:71], a[72:75], a[0:3], v[68:71]
 s_waitcnt lgkmcnt(15)
 ds_read_b64_tr_b16 a[62:63], v13 offset:53248
 v_cvt_pk_bf16_f32 v35, v38, v39
 v_mfma_f32_16x16x32_bf16 v[72:75], a[80:83], a[0:3], v[72:75]
 v_cvt_pk_bf16_f32 v40, v40, v41
 v_cvt_pk_bf16_f32 v41, v42, v43
 v_mfma_f32_16x16x32_bf16 v[72:75], a[84:87], a[4:7], v[72:75]
 s_add_u32 s59, s56, 49152
 v_cvt_pk_bf16_f32 v42, v44, v45
 v_cvt_pk_bf16_f32 v43, v46, v47
 v_mfma_f32_16x16x32_bf16 v[76:79], a[92:95], a[4:7], v[76:79]
 buffer_store_dwordx4 v[20:23], v1, s[12:15], s59 offen offset:1024 sc1
 v_mfma_f32_16x16x32_bf16 v[76:79], a[88:91], a[0:3], v[76:79]
 s_waitcnt lgkmcnt(0)
 v_accvgpr_read_b32 v36, a232
 v_accvgpr_read_b32 v37, a233
 v_mfma_f32_16x16x32_bf16 v[84:87], a[88:91], a[8:11], v[84:87]
 s_barrier
 v_xor_b32 v6, s60, v6
 v_accvgpr_read_b32 v38, a234
 v_mfma_f32_16x16x32_bf16 v[84:87], a[92:95], a[12:15], v[84:87]
 s_add_u32 m0, s29, 32768
 v_add_u32 v2, 0x80000, v2
 v_accvgpr_read_b32 v39, a235
 v_mfma_f32_16x16x32_bf16 v[80:83], a[84:87], a[12:15], v[80:83]
 buffer_load_dwordx4 v2, s[16:19], 0 offen lds
 v_mfma_f32_16x16x32_bf16 v[80:83], a[80:83], a[8:11], v[80:83]
 v_accvgpr_read_b32 v44, a236
 v_accvgpr_read_b32 v45, a237
 v_mfma_f32_16x16x32_bf16 v[92:95], a[72:75], a[8:11], v[92:95]
 v_accvgpr_read_b32 v46, a238
 v_accvgpr_read_b32 v47, a239
 v_mfma_f32_16x16x32_bf16 v[92:95], a[76:79], a[12:15], v[92:95]
 v_cvt_pk_bf16_f32 v36, v36, v37
 v_cvt_pk_bf16_f32 v37, v38, v39
 v_mfma_f32_16x16x32_bf16 v[88:91], a[68:71], a[12:15], v[88:91]
 s_add_u32 m0, s29, 36864
 v_cvt_pk_bf16_f32 v38, v44, v45
 v_cvt_pk_bf16_f32 v39, v46, v47
 v_mfma_f32_16x16x32_bf16 v[88:91], a[64:67], a[8:11], v[88:91]
 buffer_load_dwordx4 v2, s[16:19], s48 offen lds
 v_mfma_f32_16x16x32_bf16 v[96:99], a[64:67], a[16:19], v[96:99]
 v_cvt_pk_bf16_f32 v48, v48, v49
 v_cvt_pk_bf16_f32 v49, v50, v51
 v_mfma_f32_16x16x32_bf16 v[96:99], a[68:71], a[20:23], v[96:99]
 v_cvt_pk_bf16_f32 v50, v52, v53
 v_cvt_pk_bf16_f32 v51, v54, v55
 v_mfma_f32_16x16x32_bf16 v[100:103], a[76:79], a[20:23], v[100:103]
 v_cvt_pk_bf16_f32 v56, v56, v57
 v_cvt_pk_bf16_f32 v57, v58, v59
 v_mfma_f32_16x16x32_bf16 v[100:103], a[72:75], a[16:19], v[100:103]
 s_add_u32 m0, s29, 40960
 v_cvt_pk_bf16_f32 v58, v60, v61
 v_cvt_pk_bf16_f32 v59, v62, v63
 v_mfma_f32_16x16x32_bf16 v[104:107], a[80:83], a[16:19], v[104:107]
 buffer_load_dwordx4 v2, s[16:19], s49 offen lds
 v_mfma_f32_16x16x32_bf16 v[104:107], a[84:87], a[20:23], v[104:107]
 v_cvt_pk_bf16_f32 v64, v64, v65
 v_cvt_pk_bf16_f32 v65, v66, v67
 v_mfma_f32_16x16x32_bf16 v[108:111], a[92:95], a[20:23], v[108:111]
 v_cvt_pk_bf16_f32 v66, v68, v69
 v_cvt_pk_bf16_f32 v67, v70, v71
 v_mfma_f32_16x16x32_bf16 v[108:111], a[88:91], a[16:19], v[108:111]
 v_cvt_pk_bf16_f32 v72, v72, v73
 v_cvt_pk_bf16_f32 v73, v74, v75
 v_mfma_f32_16x16x32_bf16 v[116:119], a[88:91], a[24:27], v[116:119]
 s_add_u32 m0, s29, 45056
 v_cvt_pk_bf16_f32 v74, v76, v77
 v_cvt_pk_bf16_f32 v75, v78, v79
 v_mfma_f32_16x16x32_bf16 v[116:119], a[92:95], a[28:31], v[116:119]
 buffer_load_dwordx4 v2, s[16:19], s50 offen lds
 v_mfma_f32_16x16x32_bf16 v[112:115], a[84:87], a[28:31], v[112:115]
 s_add_u32 s59, s56, 32768
 v_cvt_pk_bf16_f32 v80, v80, v81
 v_cvt_pk_bf16_f32 v81, v82, v83
 v_mfma_f32_16x16x32_bf16 v[112:115], a[80:83], a[24:27], v[112:115]
 buffer_store_dwordx4 v[36:39], v1, s[12:15], s59 offen offset:1024 sc1
 v_mfma_f32_16x16x32_bf16 v[124:127], a[72:75], a[24:27], v[124:127]
 v_cvt_pk_bf16_f32 v82, v84, v85
 v_cvt_pk_bf16_f32 v83, v86, v87
 v_mfma_f32_16x16x32_bf16 v[124:127], a[76:79], a[28:31], v[124:127]
 s_add_u32 m0, s29, 49152
 v_cvt_pk_bf16_f32 v88, v88, v89
 v_cvt_pk_bf16_f32 v89, v90, v91
 v_mfma_f32_16x16x32_bf16 v[120:123], a[68:71], a[28:31], v[120:123]
 buffer_load_dwordx4 v2, s[16:19], s51 offen lds
 v_mfma_f32_16x16x32_bf16 v[120:123], a[64:67], a[24:27], v[120:123]
 v_cvt_pk_bf16_f32 v90, v92, v93
 v_cvt_pk_bf16_f32 v91, v94, v95
 v_mfma_f32_16x16x32_bf16 v[128:131], a[64:67], a[32:35], v[128:131]
 v_cvt_pk_bf16_f32 v96, v96, v97
 v_cvt_pk_bf16_f32 v97, v98, v99
 v_mfma_f32_16x16x32_bf16 v[128:131], a[68:71], a[36:39], v[128:131]
 v_cvt_pk_bf16_f32 v98, v100, v101
 v_cvt_pk_bf16_f32 v99, v102, v103
 v_mfma_f32_16x16x32_bf16 v[132:135], a[76:79], a[36:39], v[132:135]
 s_add_u32 m0, s29, 53248
 v_cvt_pk_bf16_f32 v104, v104, v105
 v_cvt_pk_bf16_f32 v105, v106, v107
 v_mfma_f32_16x16x32_bf16 v[132:135], a[72:75], a[32:35], v[132:135]
 buffer_load_dwordx4 v2, s[16:19], s52 offen lds
 v_mfma_f32_16x16x32_bf16 v[136:139], a[80:83], a[32:35], v[136:139]
 v_cvt_pk_bf16_f32 v106, v108, v109
 v_cvt_pk_bf16_f32 v107, v110, v111
 v_mfma_f32_16x16x32_bf16 v[136:139], a[84:87], a[36:39], v[136:139]
 v_cvt_pk_bf16_f32 v112, v112, v113
 v_cvt_pk_bf16_f32 v113, v114, v115
 v_mfma_f32_16x16x32_bf16 v[140:143], a[92:95], a[36:39], v[140:143]
 v_cvt_pk_bf16_f32 v114, v116, v117
 v_cvt_pk_bf16_f32 v115, v118, v119
 v_mfma_f32_16x16x32_bf16 v[140:143], a[88:91], a[32:35], v[140:143]
 s_add_u32 m0, s29, 57344
 v_cvt_pk_bf16_f32 v120, v120, v121
 v_cvt_pk_bf16_f32 v121, v122, v123
 v_mfma_f32_16x16x32_bf16 v[148:151], a[88:91], a[40:43], v[148:151]
 buffer_load_dwordx4 v2, s[16:19], s53 offen lds
 v_mfma_f32_16x16x32_bf16 v[148:151], a[92:95], a[44:47], v[148:151]
 v_cvt_pk_bf16_f32 v122, v124, v125
 v_cvt_pk_bf16_f32 v123, v126, v127
 v_mfma_f32_16x16x32_bf16 v[144:147], a[84:87], a[44:47], v[144:147]
 v_mfma_f32_16x16x32_bf16 v[144:147], a[80:83], a[40:43], v[144:147]
 v_cvt_pk_bf16_f32 v128, v128, v129
 v_cvt_pk_bf16_f32 v129, v130, v131
 v_mfma_f32_16x16x32_bf16 v[156:159], a[72:75], a[40:43], v[156:159]
 s_add_u32 m0, s29, 61440
 v_cvt_pk_bf16_f32 v130, v132, v133
 v_cvt_pk_bf16_f32 v131, v134, v135
 v_mfma_f32_16x16x32_bf16 v[156:159], a[76:79], a[44:47], v[156:159]
 buffer_load_dwordx4 v2, s[16:19], s54 offen lds
 v_mfma_f32_16x16x32_bf16 v[152:155], a[68:71], a[44:47], v[152:155]
 v_mfma_f32_16x16x32_bf16 v[152:155], a[64:67], a[40:43], v[152:155]
 v_cvt_pk_bf16_f32 v136, v136, v137
 v_cvt_pk_bf16_f32 v137, v138, v139
 v_mfma_f32_16x16x32_bf16 v[160:163], a[64:67], a[48:51], v[160:163]
 s_add_u32 m0, s29, 98304
 v_add_u32 v2, 0x80000, v2
 v_cvt_pk_bf16_f32 v138, v140, v141
 v_mfma_f32_16x16x32_bf16 v[160:163], a[68:71], a[52:55], v[160:163]
 buffer_load_dwordx4 v2, s[16:19], 0 offen lds
 v_mfma_f32_16x16x32_bf16 v[164:167], a[76:79], a[52:55], v[164:167]
 v_cvt_pk_bf16_f32 v139, v142, v143
 v_mfma_f32_16x16x32_bf16 v[164:167], a[72:75], a[48:51], v[164:167]
 v_cvt_pk_bf16_f32 v144, v144, v145
 v_cvt_pk_bf16_f32 v145, v146, v147
 v_mfma_f32_16x16x32_bf16 v[168:171], a[80:83], a[48:51], v[168:171]
 v_cvt_pk_bf16_f32 v146, v148, v149
 v_cvt_pk_bf16_f32 v147, v150, v151
 v_mfma_f32_16x16x32_bf16 v[168:171], a[84:87], a[52:55], v[168:171]
 s_add_u32 m0, s29, 102400
 v_mfma_f32_16x16x32_bf16 v[172:175], a[92:95], a[52:55], v[172:175]
 buffer_load_dwordx4 v2, s[16:19], s48 offen lds
 v_mfma_f32_16x16x32_bf16 v[172:175], a[88:91], a[48:51], v[172:175]
 v_cvt_pk_bf16_f32 v152, v152, v153
 v_cvt_pk_bf16_f32 v153, v154, v155
 v_mfma_f32_16x16x32_bf16 v[180:183], a[88:91], a[56:59], v[180:183]
 v_cvt_pk_bf16_f32 v154, v156, v157
 v_cvt_pk_bf16_f32 v155, v158, v159
 v_mfma_f32_16x16x32_bf16 v[180:183], a[92:95], a[60:63], v[180:183]
 v_mfma_f32_16x16x32_bf16 v[176:179], a[84:87], a[60:63], v[176:179]
 s_add_u32 m0, s29, 106496
 v_mfma_f32_16x16x32_bf16 v[176:179], a[80:83], a[56:59], v[176:179]
 buffer_load_dwordx4 v2, s[16:19], s49 offen lds
 v_mfma_f32_16x16x32_bf16 v[188:191], a[72:75], a[56:59], v[188:191]
 v_cvt_pk_bf16_f32 v160, v160, v161
 v_cvt_pk_bf16_f32 v161, v162, v163
 v_mfma_f32_16x16x32_bf16 v[188:191], a[76:79], a[60:63], v[188:191]
 v_cvt_pk_bf16_f32 v162, v164, v165
 v_cvt_pk_bf16_f32 v163, v166, v167
 v_mfma_f32_16x16x32_bf16 v[184:187], a[68:71], a[60:63], v[184:187]
 v_mfma_f32_16x16x32_bf16 v[184:187], a[64:67], a[56:59], v[184:187]
 s_add_u32 m0, s29, 110592
 v_cvt_pk_bf16_f32 v168, v168, v169
 v_cvt_pk_bf16_f32 v169, v170, v171
 v_mfma_f32_16x16x32_bf16 v[192:195], a[96:99], a[32:35], v[192:195]
 buffer_load_dwordx4 v2, s[16:19], s50 offen lds
 v_mfma_f32_16x16x32_bf16 v[192:195], a[100:103], a[36:39], v[192:195]
 v_cvt_pk_bf16_f32 v170, v172, v173
 v_cvt_pk_bf16_f32 v171, v174, v175
 v_mfma_f32_16x16x32_bf16 v[196:199], a[108:111], a[36:39], v[196:199]
 v_mfma_f32_16x16x32_bf16 v[196:199], a[104:107], a[32:35], v[196:199]
 v_cvt_pk_bf16_f32 v176, v176, v177
 v_cvt_pk_bf16_f32 v177, v178, v179
 v_mfma_f32_16x16x32_bf16 v[200:203], a[112:115], a[32:35], v[200:203]
 s_add_u32 m0, s29, 114688
 v_cvt_pk_bf16_f32 v178, v180, v181
 v_cvt_pk_bf16_f32 v179, v182, v183
 v_mfma_f32_16x16x32_bf16 v[200:203], a[116:119], a[36:39], v[200:203]
 buffer_load_dwordx4 v2, s[16:19], s51 offen lds
 v_mfma_f32_16x16x32_bf16 v[204:207], a[124:127], a[36:39], v[204:207]
 v_mfma_f32_16x16x32_bf16 v[204:207], a[120:123], a[32:35], v[204:207]
 v_cvt_pk_bf16_f32 v184, v184, v185
 v_cvt_pk_bf16_f32 v185, v186, v187
 v_mfma_f32_16x16x32_bf16 v[212:215], a[120:123], a[40:43], v[212:215]
 v_cvt_pk_bf16_f32 v186, v188, v189
 v_cvt_pk_bf16_f32 v187, v190, v191
 v_mfma_f32_16x16x32_bf16 v[212:215], a[124:127], a[44:47], v[212:215]
 s_add_u32 m0, s29, 118784
 v_mfma_f32_16x16x32_bf16 v[208:211], a[116:119], a[44:47], v[208:211]
 buffer_load_dwordx4 v2, s[16:19], s52 offen lds
 v_mfma_f32_16x16x32_bf16 v[208:211], a[112:115], a[40:43], v[208:211]
 v_cvt_pk_bf16_f32 v192, v192, v193
 v_cvt_pk_bf16_f32 v193, v194, v195
 v_mfma_f32_16x16x32_bf16 v[220:223], a[104:107], a[40:43], v[220:223]
 v_cvt_pk_bf16_f32 v194, v196, v197
 v_cvt_pk_bf16_f32 v195, v198, v199
 v_mfma_f32_16x16x32_bf16 v[220:223], a[108:111], a[44:47], v[220:223]
 v_mfma_f32_16x16x32_bf16 v[216:219], a[100:103], a[44:47], v[216:219]
 s_add_u32 m0, s29, 122880
 v_mfma_f32_16x16x32_bf16 v[216:219], a[96:99], a[40:43], v[216:219]
 buffer_load_dwordx4 v2, s[16:19], s53 offen lds
 v_mfma_f32_16x16x32_bf16 v[224:227], a[96:99], a[48:51], v[224:227]
 v_cvt_pk_bf16_f32 v200, v200, v201
 v_cvt_pk_bf16_f32 v201, v202, v203
 v_mfma_f32_16x16x32_bf16 v[224:227], a[100:103], a[52:55], v[224:227]
 s_waitcnt vmcnt(19)
 v_cvt_pk_bf16_f32 v202, v204, v205
 v_cvt_pk_bf16_f32 v203, v206, v207
 v_mfma_f32_16x16x32_bf16 v[228:231], a[108:111], a[52:55], v[228:231]
 s_barrier
 v_xor_b32 v7, 0, v6
 v_mfma_f32_16x16x32_bf16 v[228:231], a[104:107], a[48:51], v[228:231]
 s_add_u32 m0, s29, 126976
 ds_read_b64_tr_b16 a[64:65], v7 offset:0
 v_cvt_pk_bf16_f32 v208, v208, v209
 v_mfma_f32_16x16x32_bf16 v[232:235], a[112:115], a[48:51], v[232:235]
 ds_read_b64_tr_b16 a[66:67], v7 offset:4096
 buffer_load_dwordx4 v2, s[16:19], s54 offen lds
 v_mfma_f32_16x16x32_bf16 v[232:235], a[116:119], a[52:55], v[232:235]
 ds_read_b64_tr_b16 a[68:69], v7 offset:16384
 v_cvt_pk_bf16_f32 v209, v210, v211
 v_mfma_f32_16x16x32_bf16 v[236:239], a[124:127], a[52:55], v[236:239]
 ds_read_b64_tr_b16 a[70:71], v7 offset:20480
 v_xor_b32 v8, 65536, v6
 v_mfma_f32_16x16x32_bf16 v[236:239], a[120:123], a[48:51], v[236:239]
 ds_read_b64_tr_b16 a[72:73], v8 offset:0
 v_cvt_pk_bf16_f32 v210, v212, v213
 v_mfma_f32_16x16x32_bf16 v[244:247], a[120:123], a[56:59], v[244:247]
 ds_read_b64_tr_b16 a[74:75], v8 offset:4096
 v_cvt_pk_bf16_f32 v211, v214, v215
 v_mfma_f32_16x16x32_bf16 v[244:247], a[124:127], a[60:63], v[244:247]
 ds_read_b64_tr_b16 a[76:77], v8 offset:16384
 v_cvt_pk_bf16_f32 v216, v216, v217
 v_mfma_f32_16x16x32_bf16 v[240:243], a[116:119], a[60:63], v[240:243]
 ds_read_b64_tr_b16 a[78:79], v8 offset:20480
 v_xor_b32 v9, 32, v6
 v_mfma_f32_16x16x32_bf16 v[240:243], a[112:115], a[56:59], v[240:243]
 ds_read_b64_tr_b16 a[80:81], v9 offset:0
 v_cvt_pk_bf16_f32 v217, v218, v219
 v_mfma_f32_16x16x32_bf16 v[252:255], a[104:107], a[56:59], v[252:255]
 ds_read_b64_tr_b16 a[82:83], v9 offset:4096
 v_cvt_pk_bf16_f32 v218, v220, v221
 v_mfma_f32_16x16x32_bf16 v[252:255], a[108:111], a[60:63], v[252:255]
 ds_read_b64_tr_b16 a[84:85], v9 offset:16384
 v_cvt_pk_bf16_f32 v219, v222, v223
 v_mfma_f32_16x16x32_bf16 v[248:251], a[100:103], a[60:63], v[248:251]
 ds_read_b64_tr_b16 a[86:87], v9 offset:20480
 v_xor_b32 v10, 65568, v6
 v_mfma_f32_16x16x32_bf16 v[248:251], a[96:99], a[56:59], v[248:251]
 s_waitcnt lgkmcnt(6)
 ds_read_b64_tr_b16 a[88:89], v10 offset:0
 v_cvt_pk_bf16_f32 v224, v224, v225
 v_mfma_f32_16x16x32_bf16 v[28:31], a[64:67], a[128:131], 0
 ds_read_b64_tr_b16 a[90:91], v10 offset:4096
 v_cvt_pk_bf16_f32 v225, v226, v227
 v_mfma_f32_16x16x32_bf16 v[28:31], a[68:71], a[136:139], v[28:31]
 ds_read_b64_tr_b16 a[92:93], v10 offset:16384
 v_xor_b32 v7, 64, v6
 v_mfma_f32_16x16x32_bf16 v[28:31], a[72:75], a[144:147], v[28:31]
 s_waitcnt lgkmcnt(7)
 ds_read_b128 a[112:115], v14 offset:0
 ds_read_b64_tr_b16 a[94:95], v10 offset:20480
 v_mfma_f32_16x16x32_bf16 v[28:31], a[76:79], a[152:155], v[28:31]
 ds_read_b64_tr_b16 a[96:97], v7 offset:0
 v_cvt_pk_bf16_f32 v226, v228, v229
 v_mfma_f32_16x16x32_bf16 v[44:47], a[64:67], a[132:135], 0
 ds_read_b128 a[120:123], v3 offset:0
 ds_read_b64_tr_b16 a[98:99], v7 offset:4096
 v_mfma_f32_16x16x32_bf16 v[44:47], a[68:71], a[140:143], v[44:47]
 ds_read_b64_tr_b16 a[100:101], v7 offset:16384
 v_xor_b32 v8, 65600, v6
 v_mfma_f32_16x16x32_bf16 v[44:47], a[72:75], a[148:151], v[44:47]
 ds_read_b128 a[116:119], v14 offset:2048
 ds_read_b64_tr_b16 a[102:103], v7 offset:20480
 v_mfma_f32_16x16x32_bf16 v[44:47], a[76:79], a[156:159], v[44:47]
 s_waitcnt lgkmcnt(9)
 ds_read_b64_tr_b16 a[104:105], v8 offset:0
 v_cvt_pk_bf16_f32 v227, v230, v231
 v_mfma_f32_16x16x32_bf16 v[52:55], a[80:83], a[128:131], 0
 ds_read_b128 a[124:127], v3 offset:2048
 ds_read_b64_tr_b16 a[106:107], v8 offset:4096
 v_mfma_f32_16x16x32_bf16 v[52:55], a[84:87], a[136:139], v[52:55]
 ds_read_b64_tr_b16 a[108:109], v8 offset:16384
 v_cvt_pk_bf16_f32 v232, v232, v233
 v_mfma_f32_16x16x32_bf16 v[52:55], a[88:91], a[144:147], v[52:55]
 s_waitcnt lgkmcnt(10)
 ds_read_b64_tr_b16 a[110:111], v8 offset:20480
 v_xor_b32 v9, 96, v6
 v_mfma_f32_16x16x32_bf16 v[52:55], a[92:95], a[152:155], v[52:55]
 ds_read_b64_tr_b16 a[64:65], v9 offset:0
 v_cvt_pk_bf16_f32 v233, v234, v235
 v_mfma_f32_16x16x32_bf16 v[60:63], a[80:83], a[132:135], 0
 ds_read_b64_tr_b16 a[66:67], v9 offset:4096
 v_cvt_pk_bf16_f32 v234, v236, v237
 v_mfma_f32_16x16x32_bf16 v[60:63], a[84:87], a[140:143], v[60:63]
 ds_read_b64_tr_b16 a[68:69], v9 offset:16384
 v_cvt_pk_bf16_f32 v235, v238, v239
 v_mfma_f32_16x16x32_bf16 v[60:63], a[88:91], a[148:151], v[60:63]
 ds_read_b64_tr_b16 a[70:71], v9 offset:20480
 v_xor_b32 v10, 65632, v6
 v_mfma_f32_16x16x32_bf16 v[60:63], a[92:95], a[156:159], v[60:63]
 s_waitcnt lgkmcnt(6)
 ds_read_b64_tr_b16 a[72:73], v10 offset:0
 v_cvt_pk_bf16_f32 v240, v240, v241
 v_mfma_f32_16x16x32_bf16 v[20:23], a[96:99], a[128:131], 0
 ds_read_b64_tr_b16 a[74:75], v10 offset:4096
 v_cvt_pk_bf16_f32 v241, v242, v243
 v_mfma_f32_16x16x32_bf16 v[20:23], a[100:103], a[136:139], v[20:23]
 s_waitcnt lgkmcnt(8)
 ds_read_b64_tr_b16 a[76:77], v10 offset:16384
 v_xor_b32 v7, 128, v6
 v_mfma_f32_16x16x32_bf16 v[20:23], a[104:107], a[144:147], v[20:23]
 s_waitcnt lgkmcnt(7)
 s_barrier
 ds_read_b64_tr_b16 a[78:79], v10 offset:20480
 v_mfma_f32_16x16x32_bf16 v[20:23], a[108:111], a[152:155], v[20:23]
 s_add_u32 m0, s29, 131072
 ds_read_b64_tr_b16 a[80:81], v7 offset:0
 v_add_u32 v2, 0x80000, v2
 v_mfma_f32_16x16x32_bf16 v[36:39], a[96:99], a[132:135], 0
 ds_read_b64_tr_b16 a[82:83], v7 offset:4096
 buffer_load_dwordx4 v2, s[16:19], 0 offen lds
 v_mfma_f32_16x16x32_bf16 v[36:39], a[100:103], a[140:143], v[36:39]
 ds_read_b64_tr_b16 a[84:85], v7 offset:16384
 v_cvt_pk_bf16_f32 v242, v244, v245
 v_mfma_f32_16x16x32_bf16 v[36:39], a[104:107], a[148:151], v[36:39]
 ds_read_b64_tr_b16 a[86:87], v7 offset:20480
 v_xor_b32 v8, 65664, v6
 v_mfma_f32_16x16x32_bf16 v[36:39], a[108:111], a[156:159], v[36:39]
 s_waitcnt lgkmcnt(6)
 ds_read_b64_tr_b16 a[88:89], v8 offset:0
 v_cvt_pk_bf16_f32 v243, v246, v247
 v_mfma_f32_16x16x32_bf16 v[68:71], a[64:67], a[128:131], 0
 ds_read_b64_tr_b16 a[90:91], v8 offset:4096
 v_cvt_pk_bf16_f32 v248, v248, v249
 v_mfma_f32_16x16x32_bf16 v[68:71], a[68:71], a[136:139], v[68:71]
 s_add_u32 m0, s29, 135168
 ds_read_b64_tr_b16 a[92:93], v8 offset:16384
 v_cvt_pk_bf16_f32 v249, v250, v251
 v_mfma_f32_16x16x32_bf16 v[68:71], a[72:75], a[144:147], v[68:71]
 s_waitcnt lgkmcnt(7)
 ds_read_b64_tr_b16 a[94:95], v8 offset:20480
 v_xor_b32 v9, 160, v6
 v_mfma_f32_16x16x32_bf16 v[68:71], a[76:79], a[152:155], v[68:71]
 ds_read_b64_tr_b16 a[96:97], v9 offset:0
 buffer_load_dwordx4 v2, s[16:19], s48 offen lds
 v_mfma_f32_16x16x32_bf16 v[76:79], a[64:67], a[132:135], 0
 ds_read_b64_tr_b16 a[98:99], v9 offset:4096
 v_cvt_pk_bf16_f32 v250, v252, v253
 v_mfma_f32_16x16x32_bf16 v[76:79], a[68:71], a[140:143], v[76:79]
 ds_read_b64_tr_b16 a[100:101], v9 offset:16384
 v_cvt_pk_bf16_f32 v251, v254, v255
 v_mfma_f32_16x16x32_bf16 v[76:79], a[72:75], a[148:151], v[76:79]
 ds_read_b64_tr_b16 a[102:103], v9 offset:20480
 v_xor_b32 v10, 65696, v6
 v_mfma_f32_16x16x32_bf16 v[76:79], a[76:79], a[156:159], v[76:79]
 s_waitcnt lgkmcnt(6)
 ds_read_b64_tr_b16 a[104:105], v10 offset:0
 v_mov_b32 v12, 0
 v_mfma_f32_16x16x32_bf16 v[84:87], a[80:83], a[128:131], 0
 s_add_u32 m0, s29, 139264
 ds_read_b64_tr_b16 a[106:107], v10 offset:4096
 v_mfma_f32_16x16x32_bf16 v[84:87], a[84:87], a[136:139], v[84:87]
 ds_read_b64_tr_b16 a[108:109], v10 offset:16384
 buffer_load_dwordx4 v2, s[16:19], s49 offen lds
 v_mfma_f32_16x16x32_bf16 v[84:87], a[88:91], a[144:147], v[84:87]
 s_waitcnt lgkmcnt(7)
 ds_read_b64_tr_b16 a[110:111], v10 offset:20480
 v_xor_b32 v7, 192, v6
 v_mfma_f32_16x16x32_bf16 v[84:87], a[92:95], a[152:155], v[84:87]
 ds_read_b64_tr_b16 a[64:65], v7 offset:0
 global_load_dword v5, v12, s[90:91] offset:128 sc1
 v_mfma_f32_16x16x32_bf16 v[92:95], a[80:83], a[132:135], 0
 ds_read_b64_tr_b16 a[66:67], v7 offset:4096
 v_and_b32 v12, 11, v0
 v_mfma_f32_16x16x32_bf16 v[92:95], a[84:87], a[140:143], v[92:95]
 ds_read_b64_tr_b16 a[68:69], v7 offset:16384
 v_lshlrev_b32 v12, 2, v12
 v_mfma_f32_16x16x32_bf16 v[92:95], a[88:91], a[148:151], v[92:95]
 s_add_u32 m0, s29, 143360
 ds_read_b64_tr_b16 a[70:71], v7 offset:20480
 v_xor_b32 v8, 65728, v6
 v_mfma_f32_16x16x32_bf16 v[92:95], a[92:95], a[156:159], v[92:95]
 s_waitcnt lgkmcnt(6)
 ds_read_b64_tr_b16 a[72:73], v8 offset:0
 buffer_load_dwordx4 v2, s[16:19], s50 offen lds
 v_mfma_f32_16x16x32_bf16 v[100:103], a[96:99], a[128:131], 0
 ds_read_b64_tr_b16 a[74:75], v8 offset:4096
 v_mfma_f32_16x16x32_bf16 v[100:103], a[100:103], a[136:139], v[100:103]
 s_and_b32 s36, s95, 31
 ds_read_b64_tr_b16 a[76:77], v8 offset:16384
 v_and_b32 v14, 15, v0
 v_mfma_f32_16x16x32_bf16 v[100:103], a[104:107], a[144:147], v[100:103]
 s_waitcnt lgkmcnt(7)
 ds_read_b64_tr_b16 a[78:79], v8 offset:20480
 v_xor_b32 v9, 224, v6
 v_mfma_f32_16x16x32_bf16 v[100:103], a[108:111], a[152:155], v[100:103]
 s_lshr_b32 s37, s95, 5
 ds_read_b64_tr_b16 a[80:81], v9 offset:0
 v_lshrrev_b32 v3, 4, v0
 v_mfma_f32_16x16x32_bf16 v[108:111], a[96:99], a[132:135], 0
 s_add_u32 m0, s29, 147456
 ds_read_b64_tr_b16 a[82:83], v9 offset:4096
 v_lshlrev_b32 v3, 2, v3
 v_mfma_f32_16x16x32_bf16 v[108:111], a[100:103], a[140:143], v[108:111]
 ds_read_b64_tr_b16 a[84:85], v9 offset:16384
 buffer_load_dwordx4 v2, s[16:19], s51 offen lds
 v_mfma_f32_16x16x32_bf16 v[108:111], a[104:107], a[148:151], v[108:111]
 s_lshl_b32 s38, s3, 4
 ds_read_b64_tr_b16 a[86:87], v9 offset:20480
 v_xor_b32 v10, 65760, v6
 v_mfma_f32_16x16x32_bf16 v[108:111], a[108:111], a[156:159], v[108:111]
 s_waitcnt lgkmcnt(6)
 ds_read_b64_tr_b16 a[88:89], v10 offset:0
 v_sub_u32 v14, v14, v3
 v_mfma_f32_16x16x32_bf16 v[116:119], a[64:67], a[128:131], 0
 s_lshl_b32 s39, s36, 6
 ds_read_b64_tr_b16 a[90:91], v10 offset:4096
 v_lshrrev_b32_e64 v3, 6, s29
 v_mfma_f32_16x16x32_bf16 v[116:119], a[68:71], a[136:139], v[116:119]
 s_add_u32 m0, s29, 151552
 ds_read_b64_tr_b16 a[92:93], v10 offset:16384
 v_add_u32 v14, v3, v14
 v_mfma_f32_16x16x32_bf16 v[116:119], a[72:75], a[144:147], v[116:119]
 s_waitcnt lgkmcnt(7)
 ds_read_b64_tr_b16 a[94:95], v10 offset:20480
 v_xor_b32 v7, 256, v6
 v_mfma_f32_16x16x32_bf16 v[116:119], a[76:79], a[152:155], v[116:119]
 ds_read_b64_tr_b16 a[96:97], v7 offset:0
 buffer_load_dwordx4 v2, s[16:19], s52 offen lds
 v_mfma_f32_16x16x32_bf16 v[124:127], a[64:67], a[132:135], 0
 s_add_u32 s38, s38, s39
 ds_read_b64_tr_b16 a[98:99], v7 offset:4096
 v_mov_b32 v15, 0xf149f2ca
 v_mfma_f32_16x16x32_bf16 v[124:127], a[68:71], a[140:143], v[124:127]
 s_mul_i32 s38, s38, 896
 ds_read_b64_tr_b16 a[100:101], v7 offset:16384
 v_cmp_gt_i32 vcc, 0, v14
 v_mfma_f32_16x16x32_bf16 v[124:127], a[72:75], a[148:151], v[124:127]
 s_lshl_b32 s39, s37, 7
 ds_read_b64_tr_b16 a[102:103], v7 offset:20480
 v_xor_b32 v8, 65792, v6
 v_mfma_f32_16x16x32_bf16 v[124:127], a[76:79], a[156:159], v[124:127]
 s_waitcnt lgkmcnt(6)
 ds_read_b64_tr_b16 a[104:105], v8 offset:0
 v_cndmask_b32 v3, 0, v15, vcc
 v_mfma_f32_16x16x32_bf16 v[132:135], a[80:83], a[128:131], 0
 s_add_u32 m0, s29, 155648
 ds_read_b64_tr_b16 a[106:107], v8 offset:4096
 v_accvgpr_write_b32 a224, v3
 v_mfma_f32_16x16x32_bf16 v[132:135], a[84:87], a[136:139], v[132:135]
 ds_read_b64_tr_b16 a[108:109], v8 offset:16384
 buffer_load_dwordx4 v2, s[16:19], s53 offen lds
 v_mfma_f32_16x16x32_bf16 v[132:135], a[88:91], a[144:147], v[132:135]
 s_waitcnt lgkmcnt(7)
 ds_read_b64_tr_b16 a[110:111], v8 offset:20480
 v_xor_b32 v9, 288, v6
 v_mfma_f32_16x16x32_bf16 v[132:135], a[92:95], a[152:155], v[132:135]
 s_add_u32 s38, s38, s39
 ds_read_b64_tr_b16 a[64:65], v9 offset:0
 v_cmp_gt_i32 vcc, 1, v14
 v_mfma_f32_16x16x32_bf16 v[140:143], a[80:83], a[132:135], 0
 s_lshl_b32 s39, s37, 9
 ds_read_b64_tr_b16 a[66:67], v9 offset:4096
 v_cndmask_b32 v3, 0, v15, vcc
 v_mfma_f32_16x16x32_bf16 v[140:143], a[84:87], a[140:143], v[140:143]
 s_mov_b32 s4, s66
 ds_read_b64_tr_b16 a[68:69], v9 offset:16384
 v_accvgpr_write_b32 a225, v3
 v_mfma_f32_16x16x32_bf16 v[140:143], a[88:91], a[148:151], v[140:143]
 s_add_u32 m0, s29, 159744
 ds_read_b64_tr_b16 a[70:71], v9 offset:20480
 v_xor_b32 v10, 65824, v6
 v_mfma_f32_16x16x32_bf16 v[140:143], a[92:95], a[156:159], v[140:143]
 s_waitcnt lgkmcnt(6)
 ds_read_b64_tr_b16 a[72:73], v10 offset:0
 buffer_load_dwordx4 v2, s[16:19], s54 offen lds
 v_mfma_f32_16x16x32_bf16 v[148:151], a[96:99], a[128:131], 0
 s_mov_b32 s5, s67
 ds_read_b64_tr_b16 a[74:75], v10 offset:4096
 v_cmp_gt_i32 vcc, 2, v14
 v_mfma_f32_16x16x32_bf16 v[148:151], a[100:103], a[136:139], v[148:151]
 s_mov_b32 s6, 1835008
 ds_read_b64_tr_b16 a[76:77], v10 offset:16384
 v_cndmask_b32 v3, 0, v15, vcc
 v_mfma_f32_16x16x32_bf16 v[148:151], a[104:107], a[144:147], v[148:151]
 s_waitcnt lgkmcnt(7)
 ds_read_b64_tr_b16 a[78:79], v10 offset:20480
 v_xor_b32 v7, 320, v6
 v_mfma_f32_16x16x32_bf16 v[148:151], a[108:111], a[152:155], v[148:151]
 s_mov_b32 s7, 0x20000
 ds_read_b64_tr_b16 a[80:81], v7 offset:0
 v_accvgpr_write_b32 a226, v3
 v_mfma_f32_16x16x32_bf16 v[156:159], a[96:99], a[132:135], 0
 s_mov_b32 s8, s68
 ds_read_b64_tr_b16 a[82:83], v7 offset:4096
 v_cmp_gt_i32 vcc, 3, v14
 v_mfma_f32_16x16x32_bf16 v[156:159], a[100:103], a[140:143], v[156:159]
 s_mov_b32 s9, s69
 ds_read_b64_tr_b16 a[84:85], v7 offset:16384
 v_cndmask_b32 v3, 0, v15, vcc
 v_mfma_f32_16x16x32_bf16 v[156:159], a[104:107], a[148:151], v[156:159]
 s_mov_b32 s10, 1835008
 ds_read_b64_tr_b16 a[86:87], v7 offset:20480
 v_xor_b32 v8, 65856, v6
 v_mfma_f32_16x16x32_bf16 v[156:159], a[108:111], a[156:159], v[156:159]
 s_waitcnt lgkmcnt(6)
 ds_read_b64_tr_b16 a[88:89], v8 offset:0
 v_accvgpr_write_b32 a227, v3
 v_mfma_f32_16x16x32_bf16 v[164:167], a[64:67], a[128:131], 0
 s_mov_b32 s11, 0x20000
 ds_read_b64_tr_b16 a[90:91], v8 offset:4096
 v_cmp_gt_i32 vcc, 16, v14
 v_mfma_f32_16x16x32_bf16 v[164:167], a[68:71], a[136:139], v[164:167]
 s_mov_b32 s20, s70
 ds_read_b64_tr_b16 a[92:93], v8 offset:16384
 v_cndmask_b32 v3, 0, v15, vcc
 v_mfma_f32_16x16x32_bf16 v[164:167], a[72:75], a[144:147], v[164:167]
 s_waitcnt lgkmcnt(7)
 ds_read_b64_tr_b16 a[94:95], v8 offset:20480
 v_xor_b32 v9, 352, v6
 v_mfma_f32_16x16x32_bf16 v[164:167], a[76:79], a[152:155], v[164:167]
 s_mov_b32 s21, s71
 ds_read_b64_tr_b16 a[96:97], v9 offset:0
 v_accvgpr_write_b32 a228, v3
 v_mfma_f32_16x16x32_bf16 v[172:175], a[64:67], a[132:135], 0
 s_mov_b32 s22, 3584
 ds_read_b64_tr_b16 a[98:99], v9 offset:4096
 v_cmp_gt_i32 vcc, 17, v14
 v_mfma_f32_16x16x32_bf16 v[172:175], a[68:71], a[140:143], v[172:175]
 s_mov_b32 s23, 0x20000
 ds_read_b64_tr_b16 a[100:101], v9 offset:16384
 v_cndmask_b32 v3, 0, v15, vcc
 v_mfma_f32_16x16x32_bf16 v[172:175], a[72:75], a[148:151], v[172:175]
 ds_read_b64_tr_b16 a[102:103], v9 offset:20480
 v_xor_b32 v10, 65888, v6
 v_mfma_f32_16x16x32_bf16 v[172:175], a[76:79], a[156:159], v[172:175]
 s_waitcnt lgkmcnt(6)
 ds_read_b64_tr_b16 a[104:105], v10 offset:0
 v_accvgpr_write_b32 a229, v3
 v_mfma_f32_16x16x32_bf16 v[180:183], a[80:83], a[128:131], 0
 ds_read_b64_tr_b16 a[106:107], v10 offset:4096
 v_cmp_gt_i32 vcc, 18, v14
 v_mfma_f32_16x16x32_bf16 v[180:183], a[84:87], a[136:139], v[180:183]
 ds_read_b64_tr_b16 a[108:109], v10 offset:16384
 v_cndmask_b32 v3, 0, v15, vcc
 v_mfma_f32_16x16x32_bf16 v[180:183], a[88:91], a[144:147], v[180:183]
 s_waitcnt lgkmcnt(7)
 ds_read_b64_tr_b16 a[110:111], v10 offset:20480
 v_xor_b32 v7, 384, v6
 v_mfma_f32_16x16x32_bf16 v[180:183], a[92:95], a[152:155], v[180:183]
 ds_read_b64_tr_b16 a[64:65], v7 offset:0
 v_accvgpr_write_b32 a230, v3
 v_mfma_f32_16x16x32_bf16 v[188:191], a[80:83], a[132:135], 0
 ds_read_b64_tr_b16 a[66:67], v7 offset:4096
 v_cmp_gt_i32 vcc, 19, v14
 v_mfma_f32_16x16x32_bf16 v[188:191], a[84:87], a[140:143], v[188:191]
 ds_read_b64_tr_b16 a[68:69], v7 offset:16384
 v_cndmask_b32 v3, 0, v15, vcc
 v_mfma_f32_16x16x32_bf16 v[188:191], a[88:91], a[148:151], v[188:191]
 ds_read_b64_tr_b16 a[70:71], v7 offset:20480
 v_xor_b32 v8, 65920, v6
 v_mfma_f32_16x16x32_bf16 v[188:191], a[92:95], a[156:159], v[188:191]
 s_waitcnt lgkmcnt(6)
 ds_read_b64_tr_b16 a[72:73], v8 offset:0
 v_accvgpr_write_b32 a231, v3
 v_mfma_f32_16x16x32_bf16 v[196:199], a[96:99], a[128:131], 0
 ds_read_b64_tr_b16 a[74:75], v8 offset:4096
 v_cmp_gt_i32 vcc, 32, v14
 v_mfma_f32_16x16x32_bf16 v[196:199], a[100:103], a[136:139], v[196:199]
 ds_read_b64_tr_b16 a[76:77], v8 offset:16384
 v_cndmask_b32 v3, 0, v15, vcc
 v_mfma_f32_16x16x32_bf16 v[196:199], a[104:107], a[144:147], v[196:199]
 s_waitcnt lgkmcnt(7)
 ds_read_b64_tr_b16 a[78:79], v8 offset:20480
 v_xor_b32 v9, 416, v6
 v_mfma_f32_16x16x32_bf16 v[196:199], a[108:111], a[152:155], v[196:199]
 ds_read_b64_tr_b16 a[80:81], v9 offset:0
 v_accvgpr_write_b32 a232, v3
 v_mfma_f32_16x16x32_bf16 v[204:207], a[96:99], a[132:135], 0
 ds_read_b64_tr_b16 a[82:83], v9 offset:4096
 v_cmp_gt_i32 vcc, 33, v14
 v_mfma_f32_16x16x32_bf16 v[204:207], a[100:103], a[140:143], v[204:207]
 ds_read_b64_tr_b16 a[84:85], v9 offset:16384
 v_cndmask_b32 v3, 0, v15, vcc
 v_mfma_f32_16x16x32_bf16 v[204:207], a[104:107], a[148:151], v[204:207]
 ds_read_b64_tr_b16 a[86:87], v9 offset:20480
 v_xor_b32 v10, 65952, v6
 v_mfma_f32_16x16x32_bf16 v[204:207], a[108:111], a[156:159], v[204:207]
 s_waitcnt lgkmcnt(6)
 ds_read_b64_tr_b16 a[88:89], v10 offset:0
 v_accvgpr_write_b32 a233, v3
 v_mfma_f32_16x16x32_bf16 v[212:215], a[64:67], a[128:131], 0
 ds_read_b64_tr_b16 a[90:91], v10 offset:4096
 v_cmp_gt_i32 vcc, 34, v14
 v_mfma_f32_16x16x32_bf16 v[212:215], a[68:71], a[136:139], v[212:215]
 ds_read_b64_tr_b16 a[92:93], v10 offset:16384
 v_cndmask_b32 v3, 0, v15, vcc
 v_mfma_f32_16x16x32_bf16 v[212:215], a[72:75], a[144:147], v[212:215]
 s_waitcnt lgkmcnt(7)
 ds_read_b64_tr_b16 a[94:95], v10 offset:20480
 v_xor_b32 v7, 448, v6
 v_mfma_f32_16x16x32_bf16 v[212:215], a[76:79], a[152:155], v[212:215]
 s_add_u32 s59, s56, 32768
 ds_read_b64_tr_b16 a[96:97], v7 offset:0
 v_accvgpr_write_b32 a234, v3
 v_mfma_f32_16x16x32_bf16 v[220:223], a[64:67], a[132:135], 0
 ds_read_b64_tr_b16 a[98:99], v7 offset:4096
 buffer_store_dwordx4 v[32:35], v1, s[12:15], s59 offen offset:2048 sc1
 v_mfma_f32_16x16x32_bf16 v[220:223], a[68:71], a[140:143], v[220:223]
 ds_read_b64_tr_b16 a[100:101], v7 offset:16384
 v_cmp_gt_i32 vcc, 35, v14
 v_mfma_f32_16x16x32_bf16 v[220:223], a[72:75], a[148:151], v[220:223]
 ds_read_b64_tr_b16 a[102:103], v7 offset:20480
 v_xor_b32 v8, 65984, v6
 v_mfma_f32_16x16x32_bf16 v[220:223], a[76:79], a[156:159], v[220:223]
 s_waitcnt lgkmcnt(6)
 ds_read_b64_tr_b16 a[104:105], v8 offset:0
 v_cndmask_b32 v3, 0, v15, vcc
 v_mfma_f32_16x16x32_bf16 v[228:231], a[80:83], a[128:131], 0
 ds_read_b64_tr_b16 a[106:107], v8 offset:4096
 v_accvgpr_write_b32 a235, v3
 v_mfma_f32_16x16x32_bf16 v[228:231], a[84:87], a[136:139], v[228:231]
 ds_read_b64_tr_b16 a[108:109], v8 offset:16384
 v_cmp_gt_i32 vcc, 48, v14
 v_mfma_f32_16x16x32_bf16 v[228:231], a[88:91], a[144:147], v[228:231]
 s_waitcnt lgkmcnt(7)
 ds_read_b64_tr_b16 a[110:111], v8 offset:20480
 v_xor_b32 v9, 480, v6
 v_mfma_f32_16x16x32_bf16 v[228:231], a[92:95], a[152:155], v[228:231]
 ds_read_b64_tr_b16 a[64:65], v9 offset:0
 v_cndmask_b32 v3, 0, v15, vcc
 v_mfma_f32_16x16x32_bf16 v[236:239], a[80:83], a[132:135], 0
 ds_read_b64_tr_b16 a[66:67], v9 offset:4096
 v_accvgpr_write_b32 a236, v3
 v_mfma_f32_16x16x32_bf16 v[236:239], a[84:87], a[140:143], v[236:239]
 ds_read_b64_tr_b16 a[68:69], v9 offset:16384
 v_cmp_gt_i32 vcc, 49, v14
 v_mfma_f32_16x16x32_bf16 v[236:239], a[88:91], a[148:151], v[236:239]
 s_add_u32 s59, s56, 49152
 ds_read_b64_tr_b16 a[70:71], v9 offset:20480
 v_xor_b32 v10, 66016, v6
 v_mfma_f32_16x16x32_bf16 v[236:239], a[92:95], a[156:159], v[236:239]
 s_waitcnt lgkmcnt(6)
 ds_read_b64_tr_b16 a[72:73], v10 offset:0
 buffer_store_dwordx4 v[40:43], v1, s[12:15], s59 offen offset:2048 sc1
 v_mfma_f32_16x16x32_bf16 v[244:247], a[96:99], a[128:131], 0
 ds_read_b64_tr_b16 a[74:75], v10 offset:4096
 v_cndmask_b32 v3, 0, v15, vcc
 v_mfma_f32_16x16x32_bf16 v[244:247], a[100:103], a[136:139], v[244:247]
 s_waitcnt vmcnt(11)
 ds_read_b64_tr_b16 a[76:77], v10 offset:16384
 v_xor_b32 v7, 32768, v6
 v_mfma_f32_16x16x32_bf16 v[244:247], a[104:107], a[144:147], v[244:247]
 s_waitcnt lgkmcnt(7)
 s_barrier
 ds_read_b64_tr_b16 a[78:79], v10 offset:20480
 v_mfma_f32_16x16x32_bf16 v[244:247], a[108:111], a[152:155], v[244:247]
 ds_read_b64_tr_b16 a[80:81], v7 offset:0
 v_accvgpr_write_b32 a237, v3
 v_mfma_f32_16x16x32_bf16 v[252:255], a[96:99], a[132:135], 0
 ds_read_b64_tr_b16 a[82:83], v7 offset:4096
 v_cmp_gt_i32 vcc, 50, v14
 v_mfma_f32_16x16x32_bf16 v[252:255], a[100:103], a[140:143], v[252:255]
 ds_read_b64_tr_b16 a[84:85], v7 offset:16384
 v_cndmask_b32 v3, 0, v15, vcc
 v_mfma_f32_16x16x32_bf16 v[252:255], a[104:107], a[148:151], v[252:255]
 ds_read_b64_tr_b16 a[86:87], v7 offset:20480
 v_xor_b32 v8, 98304, v6
 v_mfma_f32_16x16x32_bf16 v[252:255], a[108:111], a[156:159], v[252:255]
 s_waitcnt lgkmcnt(6)
 ds_read_b64_tr_b16 a[88:89], v8 offset:0
 v_accvgpr_write_b32 a238, v3
 v_mfma_f32_16x16x32_bf16 v[16:19], a[64:67], a[128:131], 0
 s_add_u32 s59, s56, 49152
 ds_read_b64_tr_b16 a[90:91], v8 offset:4096
 v_cmp_gt_i32 vcc, 51, v14
 v_mfma_f32_16x16x32_bf16 v[16:19], a[68:71], a[136:139], v[16:19]
 ds_read_b64_tr_b16 a[92:93], v8 offset:16384
 buffer_store_dwordx4 v[48:51], v1, s[12:15], s59 offen offset:3072 sc1
 v_mfma_f32_16x16x32_bf16 v[16:19], a[72:75], a[144:147], v[16:19]
 s_waitcnt lgkmcnt(7)
 ds_read_b64_tr_b16 a[94:95], v8 offset:20480
 v_xor_b32 v9, 32800, v6
 v_mfma_f32_16x16x32_bf16 v[16:19], a[76:79], a[152:155], v[16:19]
 ds_read_b64_tr_b16 a[96:97], v9 offset:0
 v_cndmask_b32 v3, 0, v15, vcc
 v_mfma_f32_16x16x32_bf16 v[24:27], a[64:67], a[132:135], 0
 s_waitcnt lgkmcnt(9)
 ds_read_b64_tr_b16 a[98:99], v9 offset:4096
 v_accvgpr_write_b32 a239, v3
 v_mfma_f32_16x16x32_bf16 v[24:27], a[68:71], a[140:143], v[24:27]
 s_barrier
 ds_read_b64_tr_b16 a[100:101], v9 offset:16384
 v_mfma_f32_16x16x32_bf16 v[24:27], a[72:75], a[148:151], v[24:27]
 s_add_u32 m0, s29, 0
 ds_read_b64_tr_b16 a[102:103], v9 offset:20480
 v_xor_b32 v10, 98336, v6
 v_mfma_f32_16x16x32_bf16 v[24:27], a[76:79], a[156:159], v[24:27]
 s_waitcnt lgkmcnt(6)
 ds_read_b64_tr_b16 a[104:105], v10 offset:0
 v_add_u32 v2, 0x80000, v2
 v_mfma_f32_16x16x32_bf16 v[28:31], a[80:83], a[160:163], v[28:31]
 ds_read_b64_tr_b16 a[106:107], v10 offset:4096
 buffer_load_dwordx4 v2, s[16:19], 0 offen lds
 v_mfma_f32_16x16x32_bf16 v[28:31], a[84:87], a[168:171], v[28:31]
 s_add_u32 s59, s56, 32768
 ds_read_b64_tr_b16 a[108:109], v10 offset:16384
 v_mfma_f32_16x16x32_bf16 v[28:31], a[88:91], a[176:179], v[28:31]
 s_waitcnt lgkmcnt(7)
 ds_read_b64_tr_b16 a[110:111], v10 offset:20480
 v_xor_b32 v7, 32832, v6
 v_mfma_f32_16x16x32_bf16 v[28:31], a[92:95], a[184:187], v[28:31]
 ds_read_b64_tr_b16 a[64:65], v7 offset:0
 buffer_store_dwordx4 v[56:59], v1, s[12:15], s59 offen offset:3072 sc1
 v_mfma_f32_16x16x32_bf16 v[44:47], a[80:83], a[164:167], v[44:47]
 s_add_u32 m0, s29, 4096
 ds_read_b64_tr_b16 a[66:67], v7 offset:4096
 v_add_u32 v4, 4096, v1
 v_mfma_f32_16x16x32_bf16 v[44:47], a[84:87], a[172:175], v[44:47]
 ds_read_b64_tr_b16 a[68:69], v7 offset:16384
 buffer_load_dwordx4 v2, s[16:19], s48 offen lds
 v_mfma_f32_16x16x32_bf16 v[44:47], a[88:91], a[180:183], v[44:47]
 ds_read_b64_tr_b16 a[70:71], v7 offset:20480
 v_xor_b32 v8, 98368, v6
 v_mfma_f32_16x16x32_bf16 v[44:47], a[92:95], a[188:191], v[44:47]
 s_waitcnt lgkmcnt(6)
 ds_read_b64_tr_b16 a[72:73], v8 offset:0
 v_mfma_f32_16x16x32_bf16 v[52:55], a[96:99], a[160:163], v[52:55]
 ds_read_b64_tr_b16 a[74:75], v8 offset:4096
 v_mfma_f32_16x16x32_bf16 v[52:55], a[100:103], a[168:171], v[52:55]
 s_add_u32 m0, s29, 8192
 ds_read_b64_tr_b16 a[76:77], v8 offset:16384
 v_mfma_f32_16x16x32_bf16 v[52:55], a[104:107], a[176:179], v[52:55]
 s_waitcnt lgkmcnt(7)
 ds_read_b64_tr_b16 a[78:79], v8 offset:20480
 v_xor_b32 v9, 32864, v6
 v_mfma_f32_16x16x32_bf16 v[52:55], a[108:111], a[184:187], v[52:55]
 ds_read_b64_tr_b16 a[80:81], v9 offset:0
 buffer_load_dwordx4 v2, s[16:19], s49 offen lds
 v_mfma_f32_16x16x32_bf16 v[60:63], a[96:99], a[164:167], v[60:63]
 s_add_u32 s59, s56, 0
 ds_read_b64_tr_b16 a[82:83], v9 offset:4096
 v_mfma_f32_16x16x32_bf16 v[60:63], a[100:103], a[172:175], v[60:63]
 ds_read_b64_tr_b16 a[84:85], v9 offset:16384
 buffer_store_dwordx4 v[64:67], v1, s[12:15], s59 offen offset:0 sc1
 v_mfma_f32_16x16x32_bf16 v[60:63], a[104:107], a[180:183], v[60:63]
 s_add_u32 m0, s29, 12288
 ds_read_b64_tr_b16 a[86:87], v9 offset:20480
 v_xor_b32 v10, 98400, v6
 v_mfma_f32_16x16x32_bf16 v[60:63], a[108:111], a[188:191], v[60:63]
 s_waitcnt lgkmcnt(6)
 ds_read_b64_tr_b16 a[88:89], v10 offset:0
 v_mfma_f32_16x16x32_bf16 v[20:23], a[64:67], a[160:163], v[20:23]
 ds_read_b64_tr_b16 a[90:91], v10 offset:4096
 buffer_load_dwordx4 v2, s[16:19], s50 offen lds
 v_mfma_f32_16x16x32_bf16 v[20:23], a[68:71], a[168:171], v[20:23]
 ds_read_b64_tr_b16 a[92:93], v10 offset:16384
 v_mfma_f32_16x16x32_bf16 v[20:23], a[72:75], a[176:179], v[20:23]
 s_waitcnt lgkmcnt(7)
 ds_read_b64_tr_b16 a[94:95], v10 offset:20480
 v_xor_b32 v7, 32896, v6
 v_mfma_f32_16x16x32_bf16 v[20:23], a[76:79], a[184:187], v[20:23]
 ds_read_b64_tr_b16 a[96:97], v7 offset:0
 v_mfma_f32_16x16x32_bf16 v[36:39], a[64:67], a[164:167], v[36:39]
 s_add_u32 m0, s29, 16384
 ds_read_b64_tr_b16 a[98:99], v7 offset:4096
 v_mfma_f32_16x16x32_bf16 v[36:39], a[68:71], a[172:175], v[36:39]
 ds_read_b64_tr_b16 a[100:101], v7 offset:16384
 buffer_load_dwordx4 v2, s[16:19], s51 offen lds
 v_mfma_f32_16x16x32_bf16 v[36:39], a[72:75], a[180:183], v[36:39]
 s_add_u32 s59, s56, 16384
 ds_read_b64_tr_b16 a[102:103], v7 offset:20480
 v_xor_b32 v8, 98432, v6
 v_mfma_f32_16x16x32_bf16 v[36:39], a[76:79], a[188:191], v[36:39]
 s_waitcnt lgkmcnt(6)
 ds_read_b64_tr_b16 a[104:105], v8 offset:0
 buffer_store_dwordx4 v[72:75], v1, s[12:15], s59 offen offset:0 sc1
 v_mfma_f32_16x16x32_bf16 v[68:71], a[80:83], a[160:163], v[68:71]
 ds_read_b64_tr_b16 a[106:107], v8 offset:4096
 v_mfma_f32_16x16x32_bf16 v[68:71], a[84:87], a[168:171], v[68:71]
 s_add_u32 m0, s29, 20480
 ds_read_b64_tr_b16 a[108:109], v8 offset:16384
 v_mfma_f32_16x16x32_bf16 v[68:71], a[88:91], a[176:179], v[68:71]
 s_waitcnt lgkmcnt(7)
 ds_read_b64_tr_b16 a[110:111], v8 offset:20480
 v_xor_b32 v9, 32928, v6
 v_mfma_f32_16x16x32_bf16 v[68:71], a[92:95], a[184:187], v[68:71]
 ds_read_b64_tr_b16 a[64:65], v9 offset:0
 buffer_load_dwordx4 v2, s[16:19], s52 offen lds
 v_mfma_f32_16x16x32_bf16 v[76:79], a[80:83], a[164:167], v[76:79]
 ds_read_b64_tr_b16 a[66:67], v9 offset:4096
 v_mfma_f32_16x16x32_bf16 v[76:79], a[84:87], a[172:175], v[76:79]
 ds_read_b64_tr_b16 a[68:69], v9 offset:16384
 v_mfma_f32_16x16x32_bf16 v[76:79], a[88:91], a[180:183], v[76:79]
 s_add_u32 m0, s29, 24576
 ds_read_b64_tr_b16 a[70:71], v9 offset:20480
 v_xor_b32 v10, 98464, v6
 v_mfma_f32_16x16x32_bf16 v[76:79], a[92:95], a[188:191], v[76:79]
 s_waitcnt lgkmcnt(6)
 ds_read_b64_tr_b16 a[72:73], v10 offset:0
 v_mfma_f32_16x16x32_bf16 v[84:87], a[96:99], a[160:163], v[84:87]
 ds_read_b64_tr_b16 a[74:75], v10 offset:4096
 buffer_load_dwordx4 v2, s[16:19], s53 offen lds
 v_mfma_f32_16x16x32_bf16 v[84:87], a[100:103], a[168:171], v[84:87]
 s_add_u32 s59, s56, 16384
 ds_read_b64_tr_b16 a[76:77], v10 offset:16384
 v_mfma_f32_16x16x32_bf16 v[84:87], a[104:107], a[176:179], v[84:87]
 s_waitcnt lgkmcnt(7)
 ds_read_b64_tr_b16 a[78:79], v10 offset:20480
 v_xor_b32 v7, 32960, v6
 v_mfma_f32_16x16x32_bf16 v[84:87], a[108:111], a[184:187], v[84:87]
 ds_read_b64_tr_b16 a[80:81], v7 offset:0
 buffer_store_dwordx4 v[80:83], v1, s[12:15], s59 offen offset:1024 sc1
 v_mfma_f32_16x16x32_bf16 v[92:95], a[96:99], a[164:167], v[92:95]
 s_add_u32 m0, s29, 28672
 ds_read_b64_tr_b16 a[82:83], v7 offset:4096
 v_mfma_f32_16x16x32_bf16 v[92:95], a[100:103], a[172:175], v[92:95]
 ds_read_b64_tr_b16 a[84:85], v7 offset:16384
 buffer_load_dwordx4 v2, s[16:19], s54 offen lds
 v_mfma_f32_16x16x32_bf16 v[92:95], a[104:107], a[180:183], v[92:95]
 ds_read_b64_tr_b16 a[86:87], v7 offset:20480
 v_xor_b32 v8, 98496, v6
 v_mfma_f32_16x16x32_bf16 v[92:95], a[108:111], a[188:191], v[92:95]
 s_waitcnt lgkmcnt(6)
 ds_read_b64_tr_b16 a[88:89], v8 offset:0
 v_mfma_f32_16x16x32_bf16 v[100:103], a[64:67], a[160:163], v[100:103]
 s_add_u32 m0, s29, 65536
 ds_read_b64_tr_b16 a[90:91], v8 offset:4096
 v_add_u32 v2, 0x80000, v2
 v_mfma_f32_16x16x32_bf16 v[100:103], a[68:71], a[168:171], v[100:103]
 ds_read_b64_tr_b16 a[92:93], v8 offset:16384
 buffer_load_dwordx4 v2, s[16:19], 0 offen lds
 v_mfma_f32_16x16x32_bf16 v[100:103], a[72:75], a[176:179], v[100:103]
 s_waitcnt lgkmcnt(7)
 ds_read_b64_tr_b16 a[94:95], v8 offset:20480
 v_xor_b32 v9, 32992, v6
 v_mfma_f32_16x16x32_bf16 v[100:103], a[76:79], a[184:187], v[100:103]
 ds_read_b64_tr_b16 a[96:97], v9 offset:0
 v_mfma_f32_16x16x32_bf16 v[108:111], a[64:67], a[164:167], v[108:111]
 s_add_u32 s59, s56, 0
 ds_read_b64_tr_b16 a[98:99], v9 offset:4096
 v_mfma_f32_16x16x32_bf16 v[108:111], a[68:71], a[172:175], v[108:111]
 ds_read_b64_tr_b16 a[100:101], v9 offset:16384
 buffer_store_dwordx4 v[88:91], v1, s[12:15], s59 offen offset:1024 sc1
 v_mfma_f32_16x16x32_bf16 v[108:111], a[72:75], a[180:183], v[108:111]
 s_add_u32 m0, s29, 69632
 ds_read_b64_tr_b16 a[102:103], v9 offset:20480
 v_xor_b32 v10, 98528, v6
 v_mfma_f32_16x16x32_bf16 v[108:111], a[76:79], a[188:191], v[108:111]
 s_waitcnt lgkmcnt(6)
 ds_read_b64_tr_b16 a[104:105], v10 offset:0
 buffer_load_dwordx4 v2, s[16:19], s48 offen lds
 v_mfma_f32_16x16x32_bf16 v[116:119], a[80:83], a[160:163], v[116:119]
 ds_read_b64_tr_b16 a[106:107], v10 offset:4096
 v_mfma_f32_16x16x32_bf16 v[116:119], a[84:87], a[168:171], v[116:119]
 ds_read_b64_tr_b16 a[108:109], v10 offset:16384
 v_mfma_f32_16x16x32_bf16 v[116:119], a[88:91], a[176:179], v[116:119]
 s_waitcnt lgkmcnt(7)
 ds_read_b64_tr_b16 a[110:111], v10 offset:20480
 v_xor_b32 v7, 33024, v6
 v_mfma_f32_16x16x32_bf16 v[116:119], a[92:95], a[184:187], v[116:119]
 s_add_u32 m0, s29, 73728
 ds_read_b64_tr_b16 a[64:65], v7 offset:0
 v_mfma_f32_16x16x32_bf16 v[124:127], a[80:83], a[164:167], v[124:127]
 ds_read_b64_tr_b16 a[66:67], v7 offset:4096
 buffer_load_dwordx4 v2, s[16:19], s49 offen lds
 v_mfma_f32_16x16x32_bf16 v[124:127], a[84:87], a[172:175], v[124:127]
 ds_read_b64_tr_b16 a[68:69], v7 offset:16384
 v_mfma_f32_16x16x32_bf16 v[124:127], a[88:91], a[180:183], v[124:127]
 s_add_u32 s59, s56, 0
 ds_read_b64_tr_b16 a[70:71], v7 offset:20480
 v_xor_b32 v8, 98560, v6
 v_mfma_f32_16x16x32_bf16 v[124:127], a[92:95], a[188:191], v[124:127]
 s_waitcnt lgkmcnt(6)
 ds_read_b64_tr_b16 a[72:73], v8 offset:0
 buffer_store_dwordx4 v[96:99], v1, s[12:15], s59 offen offset:2048 sc1
 v_mfma_f32_16x16x32_bf16 v[132:135], a[96:99], a[160:163], v[132:135]
 s_add_u32 m0, s29, 77824
 ds_read_b64_tr_b16 a[74:75], v8 offset:4096
 v_mfma_f32_16x16x32_bf16 v[132:135], a[100:103], a[168:171], v[132:135]
 ds_read_b64_tr_b16 a[76:77], v8 offset:16384
 buffer_load_dwordx4 v2, s[16:19], s50 offen lds
 v_mfma_f32_16x16x32_bf16 v[132:135], a[104:107], a[176:179], v[132:135]
 s_waitcnt lgkmcnt(7)
 ds_read_b64_tr_b16 a[78:79], v8 offset:20480
 v_xor_b32 v9, 33056, v6
 v_mfma_f32_16x16x32_bf16 v[132:135], a[108:111], a[184:187], v[132:135]
 ds_read_b64_tr_b16 a[80:81], v9 offset:0
 v_mfma_f32_16x16x32_bf16 v[140:143], a[96:99], a[164:167], v[140:143]
 ds_read_b64_tr_b16 a[82:83], v9 offset:4096
 v_mfma_f32_16x16x32_bf16 v[140:143], a[100:103], a[172:175], v[140:143]
 ds_read_b64_tr_b16 a[84:85], v9 offset:16384
 v_mfma_f32_16x16x32_bf16 v[140:143], a[104:107], a[180:183], v[140:143]
 s_add_u32 m0, s29, 81920
 ds_read_b64_tr_b16 a[86:87], v9 offset:20480
 v_xor_b32 v10, 98592, v6
 v_mfma_f32_16x16x32_bf16 v[140:143], a[108:111], a[188:191], v[140:143]
 s_waitcnt lgkmcnt(6)
 ds_read_b64_tr_b16 a[88:89], v10 offset:0
 buffer_load_dwordx4 v2, s[16:19], s51 offen lds
 v_mfma_f32_16x16x32_bf16 v[148:151], a[64:67], a[160:163], v[148:151]
 s_add_u32 s59, s56, 16384
 ds_read_b64_tr_b16 a[90:91], v10 offset:4096
 v_mfma_f32_16x16x32_bf16 v[148:151], a[68:71], a[168:171], v[148:151]
 ds_read_b64_tr_b16 a[92:93], v10 offset:16384
 buffer_store_dwordx4 v[104:107], v1, s[12:15], s59 offen offset:2048 sc1
 v_mfma_f32_16x16x32_bf16 v[148:151], a[72:75], a[176:179], v[148:151]
 s_waitcnt lgkmcnt(7)
 ds_read_b64_tr_b16 a[94:95], v10 offset:20480
 v_xor_b32 v7, 33088, v6
 v_mfma_f32_16x16x32_bf16 v[148:151], a[76:79], a[184:187], v[148:151]
 s_add_u32 m0, s29, 86016
 ds_read_b64_tr_b16 a[96:97], v7 offset:0
 v_mfma_f32_16x16x32_bf16 v[156:159], a[64:67], a[164:167], v[156:159]
 ds_read_b64_tr_b16 a[98:99], v7 offset:4096
 buffer_load_dwordx4 v2, s[16:19], s52 offen lds
 v_mfma_f32_16x16x32_bf16 v[156:159], a[68:71], a[172:175], v[156:159]
 ds_read_b64_tr_b16 a[100:101], v7 offset:16384
 v_mfma_f32_16x16x32_bf16 v[156:159], a[72:75], a[180:183], v[156:159]
 ds_read_b64_tr_b16 a[102:103], v7 offset:20480
 v_xor_b32 v8, 98624, v6
 v_mfma_f32_16x16x32_bf16 v[156:159], a[76:79], a[188:191], v[156:159]
 s_waitcnt lgkmcnt(6)
 ds_read_b64_tr_b16 a[104:105], v8 offset:0
 v_mfma_f32_16x16x32_bf16 v[164:167], a[80:83], a[160:163], v[164:167]
 s_add_u32 m0, s29, 90112
 ds_read_b64_tr_b16 a[106:107], v8 offset:4096
 v_mfma_f32_16x16x32_bf16 v[164:167], a[84:87], a[168:171], v[164:167]
 ds_read_b64_tr_b16 a[108:109], v8 offset:16384
 buffer_load_dwordx4 v2, s[16:19], s53 offen lds
 v_mfma_f32_16x16x32_bf16 v[164:167], a[88:91], a[176:179], v[164:167]
 s_waitcnt lgkmcnt(7)
 ds_read_b64_tr_b16 a[110:111], v8 offset:20480
 v_xor_b32 v9, 33120, v6
 v_mfma_f32_16x16x32_bf16 v[164:167], a[92:95], a[184:187], v[164:167]
 s_add_u32 s59, s56, 16384
 ds_read_b64_tr_b16 a[64:65], v9 offset:0
 v_mfma_f32_16x16x32_bf16 v[172:175], a[80:83], a[164:167], v[172:175]
 ds_read_b64_tr_b16 a[66:67], v9 offset:4096
 buffer_store_dwordx4 v[112:115], v1, s[12:15], s59 offen offset:3072 sc1
 v_mfma_f32_16x16x32_bf16 v[172:175], a[84:87], a[172:175], v[172:175]
 ds_read_b64_tr_b16 a[68:69], v9 offset:16384
 v_mfma_f32_16x16x32_bf16 v[172:175], a[88:91], a[180:183], v[172:175]
 s_add_u32 m0, s29, 94208
 ds_read_b64_tr_b16 a[70:71], v9 offset:20480
 v_xor_b32 v10, 98656, v6
 v_mfma_f32_16x16x32_bf16 v[172:175], a[92:95], a[188:191], v[172:175]
 s_waitcnt lgkmcnt(6)
 ds_read_b64_tr_b16 a[72:73], v10 offset:0
 buffer_load_dwordx4 v2, s[16:19], s54 offen lds
 v_mfma_f32_16x16x32_bf16 v[180:183], a[96:99], a[160:163], v[180:183]
 ds_read_b64_tr_b16 a[74:75], v10 offset:4096
 v_mfma_f32_16x16x32_bf16 v[180:183], a[100:103], a[168:171], v[180:183]
 ds_read_b64_tr_b16 a[76:77], v10 offset:16384
 v_mfma_f32_16x16x32_bf16 v[180:183], a[104:107], a[176:179], v[180:183]
 s_waitcnt lgkmcnt(7)
 ds_read_b64_tr_b16 a[78:79], v10 offset:20480
 v_xor_b32 v7, 33152, v6
 v_mfma_f32_16x16x32_bf16 v[180:183], a[108:111], a[184:187], v[180:183]
 ds_read_b64_tr_b16 a[80:81], v7 offset:0
 v_mfma_f32_16x16x32_bf16 v[188:191], a[96:99], a[164:167], v[188:191]
 ds_read_b64_tr_b16 a[82:83], v7 offset:4096
 v_mfma_f32_16x16x32_bf16 v[188:191], a[100:103], a[172:175], v[188:191]
 ds_read_b64_tr_b16 a[84:85], v7 offset:16384
 v_mfma_f32_16x16x32_bf16 v[188:191], a[104:107], a[180:183], v[188:191]
 s_add_u32 s59, s56, 0
 ds_read_b64_tr_b16 a[86:87], v7 offset:20480
 v_xor_b32 v8, 98688, v6
 v_mfma_f32_16x16x32_bf16 v[188:191], a[108:111], a[188:191], v[188:191]
 s_waitcnt lgkmcnt(6)
 ds_read_b64_tr_b16 a[88:89], v8 offset:0
 buffer_store_dwordx4 v[120:123], v1, s[12:15], s59 offen offset:3072 sc1
 v_mfma_f32_16x16x32_bf16 v[196:199], a[64:67], a[160:163], v[196:199]
 ds_read_b64_tr_b16 a[90:91], v8 offset:4096
 v_mfma_f32_16x16x32_bf16 v[196:199], a[68:71], a[168:171], v[196:199]
 ds_read_b64_tr_b16 a[92:93], v8 offset:16384
 v_mfma_f32_16x16x32_bf16 v[196:199], a[72:75], a[176:179], v[196:199]
 s_waitcnt lgkmcnt(7)
 ds_read_b64_tr_b16 a[94:95], v8 offset:20480
 v_xor_b32 v9, 33184, v6
 v_mfma_f32_16x16x32_bf16 v[196:199], a[76:79], a[184:187], v[196:199]
 ds_read_b64_tr_b16 a[96:97], v9 offset:0
 v_mfma_f32_16x16x32_bf16 v[204:207], a[64:67], a[164:167], v[204:207]
 ds_read_b64_tr_b16 a[98:99], v9 offset:4096
 v_mfma_f32_16x16x32_bf16 v[204:207], a[68:71], a[172:175], v[204:207]
 ds_read_b64_tr_b16 a[100:101], v9 offset:16384
 v_mfma_f32_16x16x32_bf16 v[204:207], a[72:75], a[180:183], v[204:207]
 ds_read_b64_tr_b16 a[102:103], v9 offset:20480
 v_xor_b32 v10, 98720, v6
 v_mfma_f32_16x16x32_bf16 v[204:207], a[76:79], a[188:191], v[204:207]
 s_waitcnt lgkmcnt(6)
 ds_read_b64_tr_b16 a[104:105], v10 offset:0
 v_mfma_f32_16x16x32_bf16 v[212:215], a[80:83], a[160:163], v[212:215]
 s_add_u32 s59, s56, 4096
 ds_read_b64_tr_b16 a[106:107], v10 offset:4096
 v_mfma_f32_16x16x32_bf16 v[212:215], a[84:87], a[168:171], v[212:215]
 ds_read_b64_tr_b16 a[108:109], v10 offset:16384
 buffer_store_dwordx4 v[128:131], v1, s[12:15], s59 offen offset:0 sc1
 v_mfma_f32_16x16x32_bf16 v[212:215], a[88:91], a[176:179], v[212:215]
 s_waitcnt lgkmcnt(7)
 ds_read_b64_tr_b16 a[110:111], v10 offset:20480
 v_xor_b32 v7, 33216, v6
 v_mfma_f32_16x16x32_bf16 v[212:215], a[92:95], a[184:187], v[212:215]
 ds_read_b64_tr_b16 a[64:65], v7 offset:0
 v_lshrrev_b32 v120, 3, v0
 v_mfma_f32_16x16x32_bf16 v[220:223], a[80:83], a[164:167], v[220:223]
 ds_read_b64_tr_b16 a[66:67], v7 offset:4096
 v_mul_u32_u24 v120, 1792, v120
 v_mfma_f32_16x16x32_bf16 v[220:223], a[84:87], a[172:175], v[220:223]
 ds_read_b64_tr_b16 a[68:69], v7 offset:16384
 v_and_b32 v121, 7, v0
 v_mfma_f32_16x16x32_bf16 v[220:223], a[88:91], a[180:183], v[220:223]
 ds_read_b64_tr_b16 a[70:71], v7 offset:20480
 v_xor_b32 v8, 98752, v6
 v_mfma_f32_16x16x32_bf16 v[220:223], a[92:95], a[188:191], v[220:223]
 s_waitcnt lgkmcnt(6)
 ds_read_b64_tr_b16 a[72:73], v8 offset:0
 v_lshl_add_u32 v120, v121, 4, v120
 v_mfma_f32_16x16x32_bf16 v[228:231], a[96:99], a[160:163], v[228:231]
 ds_read_b64_tr_b16 a[74:75], v8 offset:4096
 v_add_u32 v120, s38, v120
 v_mfma_f32_16x16x32_bf16 v[228:231], a[100:103], a[168:171], v[228:231]
 s_add_u32 s59, s56, 20480
 ds_read_b64_tr_b16 a[76:77], v8 offset:16384
 v_lshlrev_b32 v121, 6, v121
 v_mfma_f32_16x16x32_bf16 v[228:231], a[104:107], a[176:179], v[228:231]
 s_waitcnt lgkmcnt(7)
 ds_read_b64_tr_b16 a[78:79], v8 offset:20480
 v_xor_b32 v9, 33248, v6
 v_mfma_f32_16x16x32_bf16 v[228:231], a[108:111], a[184:187], v[228:231]
 ds_read_b64_tr_b16 a[80:81], v9 offset:0
 buffer_store_dwordx4 v[136:139], v1, s[12:15], s59 offen offset:0 sc1
 v_mfma_f32_16x16x32_bf16 v[236:239], a[96:99], a[164:167], v[236:239]
 ds_read_b64_tr_b16 a[82:83], v9 offset:4096
 v_subrev_u32 v122, 2688, v120
 v_mfma_f32_16x16x32_bf16 v[236:239], a[100:103], a[172:175], v[236:239]
 ds_read_b64_tr_b16 a[84:85], v9 offset:16384
 v_subrev_u32 v123, 1792, v120
 v_mfma_f32_16x16x32_bf16 v[236:239], a[104:107], a[180:183], v[236:239]
 ds_read_b64_tr_b16 a[86:87], v9 offset:20480
 v_xor_b32 v10, 98784, v6
 v_mfma_f32_16x16x32_bf16 v[236:239], a[108:111], a[188:191], v[236:239]
 s_waitcnt lgkmcnt(6)
 ds_read_b64_tr_b16 a[88:89], v10 offset:0
 v_subrev_u32 v128, 896, v120
 v_mfma_f32_16x16x32_bf16 v[244:247], a[64:67], a[160:163], v[244:247]
 ds_read_b64_tr_b16 a[90:91], v10 offset:4096
 buffer_load_dwordx4 v[32:35], v122, s[4:7], 0 offen
 v_mfma_f32_16x16x32_bf16 v[244:247], a[68:71], a[168:171], v[244:247]
 s_waitcnt vmcnt(4)
 ds_read_b64_tr_b16 a[92:93], v10 offset:16384
 v_xor_b32 v7, 131072, v6
 v_mfma_f32_16x16x32_bf16 v[244:247], a[72:75], a[176:179], v[244:247]
 s_waitcnt lgkmcnt(7)
 s_barrier
 ds_read_b64_tr_b16 a[94:95], v10 offset:20480
 v_mfma_f32_16x16x32_bf16 v[244:247], a[76:79], a[184:187], v[244:247]
 s_and_b32 s58, s92, ~127
 ds_read_b64_tr_b16 a[96:97], v7 offset:0
 v_mfma_f32_16x16x32_bf16 v[252:255], a[64:67], a[164:167], v[252:255]
 s_add_u32 s59, s56, 20480
 ds_read_b64_tr_b16 a[98:99], v7 offset:4096
 v_mfma_f32_16x16x32_bf16 v[252:255], a[68:71], a[172:175], v[252:255]
 ds_read_b64_tr_b16 a[100:101], v7 offset:16384
 buffer_store_dwordx4 v[144:147], v1, s[12:15], s59 offen offset:1024 sc1
 v_mfma_f32_16x16x32_bf16 v[252:255], a[72:75], a[180:183], v[252:255]
 s_lshl_b32 s37, s25, 1
 ds_read_b64_tr_b16 a[102:103], v7 offset:20480
 v_xor_b32 v8, 0, v6
 v_mfma_f32_16x16x32_bf16 v[252:255], a[76:79], a[188:191], v[252:255]
 s_waitcnt lgkmcnt(6)
 ds_read_b64_tr_b16 a[104:105], v8 offset:0
 buffer_load_dwordx4 v[40:43], v123, s[4:7], 0 offen
 v_mfma_f32_16x16x32_bf16 v[16:19], a[80:83], a[160:163], v[16:19]
 s_sub_i32 s38, 12, s37
 ds_read_b64_tr_b16 a[106:107], v8 offset:4096
 v_mfma_f32_16x16x32_bf16 v[16:19], a[84:87], a[168:171], v[16:19]
 s_max_i32 s38, s38, 0
 ds_read_b64_tr_b16 a[108:109], v8 offset:16384
 v_mfma_f32_16x16x32_bf16 v[16:19], a[88:91], a[176:179], v[16:19]
 s_waitcnt lgkmcnt(7)
 ds_read_b64_tr_b16 a[110:111], v8 offset:20480
 v_xor_b32 v9, 65536, v6
 v_mfma_f32_16x16x32_bf16 v[16:19], a[92:95], a[184:187], v[16:19]
 ds_read_b64_tr_b16 a[64:65], v9 offset:0
 buffer_load_dwordx4 v[48:51], v128, s[4:7], 0 offen
 v_mfma_f32_16x16x32_bf16 v[24:27], a[80:83], a[164:167], v[24:27]
 s_mul_i32 s49, s26, 1048576
 ds_read_b64_tr_b16 a[66:67], v9 offset:4096
 v_mfma_f32_16x16x32_bf16 v[24:27], a[84:87], a[172:175], v[24:27]
 s_lshl_b32 s50, s3, 13
 ds_read_b64_tr_b16 a[68:69], v9 offset:16384
 v_mfma_f32_16x16x32_bf16 v[24:27], a[88:91], a[180:183], v[24:27]
 s_add_u32 s59, s56, 4096
 ds_read_b64_tr_b16 a[70:71], v9 offset:20480
 v_xor_b32 v10, 131104, v6
 v_mfma_f32_16x16x32_bf16 v[24:27], a[92:95], a[188:191], v[24:27]
 s_waitcnt lgkmcnt(6)
 ds_read_b64_tr_b16 a[72:73], v10 offset:0
 buffer_store_dwordx4 v[152:155], v1, s[12:15], s59 offen offset:1024 sc1
 v_mfma_f32_16x16x32_bf16 v[28:31], a[96:99], a[192:195], v[28:31]
 s_add_u32 s49, s49, s50
 ds_read_b64_tr_b16 a[74:75], v10 offset:4096
 v_mfma_f32_16x16x32_bf16 v[28:31], a[100:103], a[200:203], v[28:31]
 ds_read_b64_tr_b16 a[76:77], v10 offset:16384
 buffer_load_dwordx4 v[56:59], v120, s[4:7], 0 offen offset:0
 v_mfma_f32_16x16x32_bf16 v[28:31], a[104:107], a[208:211], v[28:31]
 s_waitcnt lgkmcnt(3)
 ds_read_b64_tr_b16 a[78:79], v10 offset:20480
 v_xor_b32 v7, 32, v6
 v_mfma_f32_16x16x32_bf16 v[28:31], a[108:111], a[216:219], v[28:31]
 s_mov_b32 s54, 2
 ds_read_b64_tr_b16 a[80:81], v7 offset:0
 v_mfma_f32_16x16x32_bf16 v[28:31], a[64:67], a[112:115], v[28:31]
 s_sub_u32 s44, 31, s37
 ds_read_b64_tr_b16 a[82:83], v7 offset:4096
 v_mfma_f32_16x16x32_bf16 v[28:31], a[68:71], a[120:123], v[28:31]
 ds_read_b64_tr_b16 a[84:85], v7 offset:16384
 buffer_load_dwordx4 v[64:67], v120, s[4:7], 0 offen offset:896
 v_mfma_f32_16x16x32_bf16 v[44:47], a[96:99], a[196:199], v[44:47]
 s_sub_u32 s44, s44, s38
 ds_read_b64_tr_b16 a[86:87], v7 offset:20480
 v_xor_b32 v8, 65568, v6
 v_mfma_f32_16x16x32_bf16 v[44:47], a[100:103], a[204:207], v[44:47]
 s_mul_i32 s55, s38, 32768
 ds_read_b64_tr_b16 a[88:89], v8 offset:0
 v_mfma_f32_16x16x32_bf16 v[44:47], a[104:107], a[212:215], v[44:47]
 s_add_u32 s59, s56, 4096
 ds_read_b64_tr_b16 a[90:91], v8 offset:4096
 v_mfma_f32_16x16x32_bf16 v[44:47], a[108:111], a[220:223], v[44:47]
 ds_read_b64_tr_b16 a[92:93], v8 offset:16384
 buffer_store_dwordx4 v[160:163], v1, s[12:15], s59 offen offset:2048 sc1
 v_mfma_f32_16x16x32_bf16 v[44:47], a[64:67], a[116:119], v[44:47]
 s_add_u32 s42, s55, s49
 ds_read_b64_tr_b16 a[94:95], v8 offset:20480
 v_xor_b32 v9, 131136, v6
 v_mfma_f32_16x16x32_bf16 v[44:47], a[68:71], a[124:127], v[44:47]
 s_waitcnt lgkmcnt(6)
 ds_read_b64_tr_b16 a[96:97], v9 offset:0
 buffer_load_dwordx4 v[72:75], v120, s[8:11], 0 offen offset:0
 v_mfma_f32_16x16x32_bf16 v[52:55], a[72:75], a[192:195], v[52:55]
 s_add_u32 s60, s58, 16
 ds_read_b64_tr_b16 a[98:99], v9 offset:4096
 v_mfma_f32_16x16x32_bf16 v[52:55], a[76:79], a[200:203], v[52:55]
 s_sub_u32 s45, 17, s37
 ds_read_b64_tr_b16 a[100:101], v9 offset:16384
 v_mfma_f32_16x16x32_bf16 v[52:55], a[80:83], a[208:211], v[52:55]
 s_waitcnt lgkmcnt(3)
 ds_read_b64_tr_b16 a[102:103], v9 offset:20480
 v_xor_b32 v10, 64, v6
 v_mfma_f32_16x16x32_bf16 v[52:55], a[84:87], a[216:219], v[52:55]
 ds_read_b64_tr_b16 a[104:105], v10 offset:0
 buffer_load_dwordx4 v[80:83], v120, s[8:11], 0 offen offset:896
 v_mfma_f32_16x16x32_bf16 v[52:55], a[88:91], a[112:115], v[52:55]
 s_sub_u32 s66, s42, 32768
 ds_read_b64_tr_b16 a[106:107], v10 offset:4096
 v_mfma_f32_16x16x32_bf16 v[52:55], a[92:95], a[120:123], v[52:55]
 s_add_u32 s42, s49, 491520
 ds_read_b64_tr_b16 a[108:109], v10 offset:16384
 v_mfma_f32_16x16x32_bf16 v[60:63], a[72:75], a[196:199], v[60:63]
 s_add_u32 s59, s56, 20480
 ds_read_b64_tr_b16 a[110:111], v10 offset:20480
 v_xor_b32 v7, 65600, v6
 v_mfma_f32_16x16x32_bf16 v[60:63], a[76:79], a[204:207], v[60:63]
 ds_read_b64_tr_b16 a[64:65], v7 offset:0
 buffer_store_dwordx4 v[168:171], v1, s[12:15], s59 offen offset:2048 sc1
 v_mfma_f32_16x16x32_bf16 v[60:63], a[80:83], a[212:215], v[60:63]
 s_add_u32 s67, s49, 524288
 ds_read_b64_tr_b16 a[66:67], v7 offset:4096
 v_mfma_f32_16x16x32_bf16 v[60:63], a[84:87], a[220:223], v[60:63]
 ds_read_b64_tr_b16 a[68:69], v7 offset:16384
 buffer_load_dwordx4 v[88:91], v121, s[20:23], s39 offen offset:0
 v_mfma_f32_16x16x32_bf16 v[60:63], a[88:91], a[116:119], v[60:63]
 s_add_u32 s68, s66, 16777216
 ds_read_b64_tr_b16 a[70:71], v7 offset:20480
 v_xor_b32 v8, 131168, v6
 v_mfma_f32_16x16x32_bf16 v[60:63], a[92:95], a[124:127], v[60:63]
 s_waitcnt lgkmcnt(6)
 ds_read_b64_tr_b16 a[72:73], v8 offset:0
 v_mfma_f32_16x16x32_bf16 v[20:23], a[96:99], a[192:195], v[20:23]
 s_add_u32 s69, s67, 16777216
 ds_read_b64_tr_b16 a[74:75], v8 offset:4096
 v_mfma_f32_16x16x32_bf16 v[20:23], a[100:103], a[200:203], v[20:23]
 ds_read_b64_tr_b16 a[76:77], v8 offset:16384
 buffer_load_dwordx4 v[96:99], v121, s[20:23], s39 offen offset:16
 v_mfma_f32_16x16x32_bf16 v[20:23], a[104:107], a[208:211], v[20:23]
 s_waitcnt lgkmcnt(3)
 ds_read_b64_tr_b16 a[78:79], v8 offset:20480
 v_xor_b32 v9, 96, v6
 v_mfma_f32_16x16x32_bf16 v[20:23], a[108:111], a[216:219], v[20:23]
 s_mov_b32 s70, 0xffff8000
 ds_read_b64_tr_b16 a[80:81], v9 offset:0
 v_mul_f32 v28, s34, v28
 v_mfma_f32_16x16x32_bf16 v[20:23], a[64:67], a[112:115], v[20:23]
 s_add_u32 s59, s56, 20480
 ds_read_b64_tr_b16 a[82:83], v9 offset:4096
 v_mul_f32 v29, s34, v29
 v_mfma_f32_16x16x32_bf16 v[20:23], a[68:71], a[120:123], v[20:23]
 ds_read_b64_tr_b16 a[84:85], v9 offset:16384
 buffer_store_dwordx4 v[176:179], v1, s[12:15], s59 offen offset:3072 sc1
 v_mfma_f32_16x16x32_bf16 v[36:39], a[96:99], a[196:199], v[36:39]
 s_mov_b32 s71, s70
 ds_read_b64_tr_b16 a[86:87], v9 offset:20480
 v_xor_b32 v10, 65632, v6
 v_mfma_f32_16x16x32_bf16 v[36:39], a[100:103], a[204:207], v[36:39]
 ds_read_b64_tr_b16 a[88:89], v10 offset:0
 buffer_load_dwordx4 v[104:107], v121, s[20:23], s39 offen offset:32
 v_mfma_f32_16x16x32_bf16 v[36:39], a[104:107], a[212:215], v[36:39]
 s_add_u32 s43, s42, 16777216
 ds_read_b64_tr_b16 a[90:91], v10 offset:4096
 v_mul_f32 v30, s34, v30
 v_mfma_f32_16x16x32_bf16 v[36:39], a[108:111], a[220:223], v[36:39]
 s_mov_b32 s40, s50
 ds_read_b64_tr_b16 a[92:93], v10 offset:16384
 v_mul_f32 v31, s34, v31
 v_mfma_f32_16x16x32_bf16 v[36:39], a[64:67], a[116:119], v[36:39]
 s_add_u32 s41, s50, 0x10000
 ds_read_b64_tr_b16 a[94:95], v10 offset:20480
 v_xor_b32 v7, 131200, v6
 v_mfma_f32_16x16x32_bf16 v[36:39], a[68:71], a[124:127], v[36:39]
 s_waitcnt lgkmcnt(6)
 ds_read_b64_tr_b16 a[96:97], v7 offset:0
 buffer_load_dwordx4 v[112:115], v121, s[20:23], s39 offen offset:48
 v_mfma_f32_16x16x32_bf16 v[68:71], a[72:75], a[192:195], v[68:71]
 s_lshr_b32 s61, s95, 4
 ds_read_b64_tr_b16 a[98:99], v7 offset:4096
 v_mul_f32 v52, s34, v52
 v_mfma_f32_16x16x32_bf16 v[68:71], a[76:79], a[200:203], v[68:71]
 s_add_u32 s59, s56, 4096
 ds_read_b64_tr_b16 a[100:101], v7 offset:16384
 v_mul_f32 v53, s34, v53
 v_mfma_f32_16x16x32_bf16 v[68:71], a[80:83], a[208:211], v[68:71]
 s_waitcnt lgkmcnt(3)
 ds_read_b64_tr_b16 a[102:103], v7 offset:20480
 v_xor_b32 v8, 128, v6
 v_mfma_f32_16x16x32_bf16 v[68:71], a[84:87], a[216:219], v[68:71]
 ds_read_b64_tr_b16 a[104:105], v8 offset:0
 buffer_store_dwordx4 v[184:187], v1, s[12:15], s59 offen offset:3072 sc1
 v_mfma_f32_16x16x32_bf16 v[68:71], a[88:91], a[112:115], v[68:71]
 s_lshl_b32 s61, s61, 7
 ds_read_b64_tr_b16 a[106:107], v8 offset:4096
 v_mul_f32 v54, s34, v54
 v_mfma_f32_16x16x32_bf16 v[68:71], a[92:95], a[120:123], v[68:71]
 s_add_u32 s61, s61, 84959232
 ds_read_b64_tr_b16 a[108:109], v8 offset:16384
 v_mul_f32 v55, s34, v55
 v_mfma_f32_16x16x32_bf16 v[76:79], a[72:75], a[196:199], v[76:79]
 s_mov_b32 s47, 0x4b800000
 ds_read_b64_tr_b16 a[110:111], v8 offset:20480
 v_xor_b32 v9, 65664, v6
 v_mfma_f32_16x16x32_bf16 v[76:79], a[76:79], a[204:207], v[76:79]
 s_lshl_b32 s30, s95, 1
 ds_read_b64_tr_b16 a[64:65], v9 offset:0
 v_cvt_pk_bf16_f32 v28, v28, v29
 v_mfma_f32_16x16x32_bf16 v[76:79], a[80:83], a[212:215], v[76:79]
 s_lshr_b32 s31, s3, 1
 ds_read_b64_tr_b16 a[66:67], v9 offset:4096
 v_cvt_pk_bf16_f32 v29, v30, v31
 v_mfma_f32_16x16x32_bf16 v[76:79], a[84:87], a[220:223], v[76:79]
 s_add_u32 s30, s30, s31
 ds_read_b64_tr_b16 a[68:69], v9 offset:16384
 v_cvt_pk_bf16_f32 v30, v52, v53
 v_mfma_f32_16x16x32_bf16 v[76:79], a[88:91], a[116:119], v[76:79]
 s_min_u32 s30, s30, 223
 ds_read_b64_tr_b16 a[70:71], v9 offset:20480
 v_xor_b32 v10, 131232, v6
 v_mfma_f32_16x16x32_bf16 v[76:79], a[92:95], a[124:127], v[76:79]
 s_waitcnt lgkmcnt(6)
 ds_read_b64_tr_b16 a[72:73], v10 offset:0
 v_cvt_pk_bf16_f32 v31, v54, v55
 v_mfma_f32_16x16x32_bf16 v[84:87], a[96:99], a[192:195], v[84:87]
 s_add_u32 s59, s56, 36864
 ds_read_b64_tr_b16 a[74:75], v10 offset:4096
 v_accvgpr_write_b32 a0, v28
 v_mfma_f32_16x16x32_bf16 v[84:87], a[100:103], a[200:203], v[84:87]
 ds_read_b64_tr_b16 a[76:77], v10 offset:16384
 buffer_store_dwordx4 v[192:195], v1, s[12:15], s59 offen offset:0 sc1
 v_mfma_f32_16x16x32_bf16 v[84:87], a[104:107], a[208:211], v[84:87]
 s_waitcnt lgkmcnt(3)
 ds_read_b64_tr_b16 a[78:79], v10 offset:20480
 v_xor_b32 v7, 160, v6
 v_mfma_f32_16x16x32_bf16 v[84:87], a[108:111], a[216:219], v[84:87]
 s_lshl_b32 s30, s30, 2
 ds_read_b64_tr_b16 a[80:81], v7 offset:0
 v_accvgpr_write_b32 a1, v29
 v_mfma_f32_16x16x32_bf16 v[84:87], a[64:67], a[112:115], v[84:87]
 s_and_b32 s4, s2, 127
 ds_read_b64_tr_b16 a[82:83], v7 offset:4096
 v_accvgpr_write_b32 a2, v30
 v_mfma_f32_16x16x32_bf16 v[84:87], a[68:71], a[120:123], v[84:87]
 s_lshl_b32 s4, s4, 2
 ds_read_b64_tr_b16 a[84:85], v7 offset:16384
 v_accvgpr_write_b32 a3, v31
 v_mfma_f32_16x16x32_bf16 v[92:95], a[96:99], a[196:199], v[92:95]
 s_add_u32 s4, s4, s3
 ds_read_b64_tr_b16 a[86:87], v7 offset:20480
 v_xor_b32 v8, 65696, v6
 v_mfma_f32_16x16x32_bf16 v[92:95], a[100:103], a[204:207], v[92:95]
 s_lshl_b32 s6, s4, 10
 ds_read_b64_tr_b16 a[88:89], v8 offset:0
 v_mul_f32 v44, s34, v44
 v_mfma_f32_16x16x32_bf16 v[92:95], a[104:107], a[212:215], v[92:95]
 s_add_u32 s6, s6, 83886080
 ds_read_b64_tr_b16 a[90:91], v8 offset:4096
 v_mul_f32 v45, s34, v45
 v_mfma_f32_16x16x32_bf16 v[92:95], a[108:111], a[220:223], v[92:95]
 s_mul_i32 s4, s4, 17408
 ds_read_b64_tr_b16 a[92:93], v8 offset:16384
 v_mul_f32 v46, s34, v46
 v_mfma_f32_16x16x32_bf16 v[92:95], a[64:67], a[116:119], v[92:95]
 s_add_u32 s59, s56, 53248
 ds_read_b64_tr_b16 a[94:95], v8 offset:20480
 v_xor_b32 v9, 131264, v6
 v_mfma_f32_16x16x32_bf16 v[92:95], a[68:71], a[124:127], v[92:95]
 s_waitcnt lgkmcnt(6)
 ds_read_b64_tr_b16 a[96:97], v9 offset:0
 buffer_store_dwordx4 v[200:203], v1, s[12:15], s59 offen offset:0 sc1
 v_mfma_f32_16x16x32_bf16 v[100:103], a[72:75], a[192:195], v[100:103]
 s_add_u32 s4, s4, 67108864
 ds_read_b64_tr_b16 a[98:99], v9 offset:4096
 v_mul_f32 v47, s34, v47
 v_mfma_f32_16x16x32_bf16 v[100:103], a[76:79], a[200:203], v[100:103]
 s_add_u32 s5, s4, 0x2000
 ds_read_b64_tr_b16 a[100:101], v9 offset:16384
 v_mul_f32 v60, s34, v60
 v_mfma_f32_16x16x32_bf16 v[100:103], a[80:83], a[208:211], v[100:103]
 s_waitcnt lgkmcnt(3)
 ds_read_b64_tr_b16 a[102:103], v9 offset:20480
 v_xor_b32 v10, 192, v6
 v_mfma_f32_16x16x32_bf16 v[100:103], a[84:87], a[216:219], v[100:103]
 s_mov_b32 s7, 0
 ds_read_b64_tr_b16 a[104:105], v10 offset:0
 v_mul_f32 v61, s34, v61
 v_mfma_f32_16x16x32_bf16 v[100:103], a[88:91], a[112:115], v[100:103]
 s_mov_b32 s53, 0
 ds_read_b64_tr_b16 a[106:107], v10 offset:4096
 v_mul_f32 v62, s34, v62
 v_mfma_f32_16x16x32_bf16 v[100:103], a[92:95], a[120:123], v[100:103]
 s_cmp_eq_u32 s38, 0
 s_cmov_b32 s4, 2.0
 ds_read_b64_tr_b16 a[108:109], v10 offset:16384
 v_mfma_f32_16x16x32_bf16 v[108:111], a[72:75], a[196:199], v[108:111]
 s_cmp_eq_u32 s38, 0
 s_cmov_b32 s5, 2.0
 ds_read_b64_tr_b16 a[110:111], v10 offset:20480
 v_xor_b32 v7, 65728, v6
 v_mfma_f32_16x16x32_bf16 v[108:111], a[76:79], a[204:207], v[108:111]
 s_cmp_eq_u32 s38, 0
 s_cmov_b32 s6, 2.0
 ds_read_b64_tr_b16 a[64:65], v7 offset:0
 v_mfma_f32_16x16x32_bf16 v[108:111], a[80:83], a[212:215], v[108:111]
 s_add_u32 s59, s56, 53248
 ds_read_b64_tr_b16 a[66:67], v7 offset:4096
 v_mul_f32 v63, s34, v63
 v_mfma_f32_16x16x32_bf16 v[108:111], a[84:87], a[220:223], v[108:111]
 ds_read_b64_tr_b16 a[68:69], v7 offset:16384
 buffer_store_dwordx4 v[208:211], v1, s[12:15], s59 offen offset:1024 sc1
 v_mfma_f32_16x16x32_bf16 v[108:111], a[88:91], a[116:119], v[108:111]
 s_mov_b64 s[8:9], s[12:13]
 ds_read_b64_tr_b16 a[70:71], v7 offset:20480
 v_xor_b32 v8, 131296, v6
 v_mfma_f32_16x16x32_bf16 v[108:111], a[92:95], a[124:127], v[108:111]
 s_waitcnt lgkmcnt(6)
 ds_read_b64_tr_b16 a[72:73], v8 offset:0
 v_cvt_pk_bf16_f32 v44, v44, v45
 v_mfma_f32_16x16x32_bf16 v[116:119], a[96:99], a[192:195], v[116:119]
 s_mov_b32 s10, s14
 ds_read_b64_tr_b16 a[74:75], v8 offset:4096
 v_cvt_pk_bf16_f32 v45, v46, v47
 v_mfma_f32_16x16x32_bf16 v[116:119], a[100:103], a[200:203], v[116:119]
 s_mov_b32 s76, 0
 ds_read_b64_tr_b16 a[76:77], v8 offset:16384
 v_cvt_pk_bf16_f32 v46, v60, v61
 v_mfma_f32_16x16x32_bf16 v[116:119], a[104:107], a[208:211], v[116:119]
 s_waitcnt lgkmcnt(3)
 ds_read_b64_tr_b16 a[78:79], v8 offset:20480
 v_xor_b32 v9, 224, v6
 v_mfma_f32_16x16x32_bf16 v[116:119], a[108:111], a[216:219], v[116:119]
 s_movk_i32 s77, 0x1000
 ds_read_b64_tr_b16 a[80:81], v9 offset:0
 v_cvt_pk_bf16_f32 v47, v62, v63
 v_mfma_f32_16x16x32_bf16 v[116:119], a[64:67], a[112:115], v[116:119]
 s_mov_b32 s51, 0
 ds_read_b64_tr_b16 a[82:83], v9 offset:4096
 v_accvgpr_write_b32 a32, v44
 v_mfma_f32_16x16x32_bf16 v[116:119], a[68:71], a[120:123], v[116:119]
 s_mul_i32 s78, s26, 229376
 ds_read_b64_tr_b16 a[84:85], v9 offset:16384
 v_accvgpr_write_b32 a33, v45
 v_mfma_f32_16x16x32_bf16 v[124:127], a[96:99], a[196:199], v[124:127]
 s_add_u32 s59, s56, 36864
 ds_read_b64_tr_b16 a[86:87], v9 offset:20480
 v_xor_b32 v10, 65760, v6
 v_mfma_f32_16x16x32_bf16 v[124:127], a[100:103], a[204:207], v[124:127]
 ds_read_b64_tr_b16 a[88:89], v10 offset:0
 buffer_store_dwordx4 v[216:219], v1, s[12:15], s59 offen offset:1024 sc1
 v_mfma_f32_16x16x32_bf16 v[124:127], a[104:107], a[212:215], v[124:127]
 s_add_u32 s79, s78, 28672
 ds_read_b64_tr_b16 a[90:91], v10 offset:4096
 v_accvgpr_write_b32 a34, v46
 v_mfma_f32_16x16x32_bf16 v[124:127], a[108:111], a[220:223], v[124:127]
 s_add_u32 s80, s78, 57344
 ds_read_b64_tr_b16 a[92:93], v10 offset:16384
 v_accvgpr_write_b32 a35, v47
 v_mfma_f32_16x16x32_bf16 v[124:127], a[64:67], a[116:119], v[124:127]
 s_add_u32 s81, s78, 86016
 ds_read_b64_tr_b16 a[94:95], v10 offset:20480
 v_xor_b32 v7, 131328, v6
 v_mfma_f32_16x16x32_bf16 v[124:127], a[68:71], a[124:127], v[124:127]
 s_waitcnt lgkmcnt(6)
 ds_read_b64_tr_b16 a[96:97], v7 offset:0
 v_mul_f32 v20, s34, v20
 v_mfma_f32_16x16x32_bf16 v[132:135], a[72:75], a[192:195], v[132:135]
 s_add_u32 s82, s78, 114688
 ds_read_b64_tr_b16 a[98:99], v7 offset:4096
 v_mul_f32 v21, s34, v21
 v_mfma_f32_16x16x32_bf16 v[132:135], a[76:79], a[200:203], v[132:135]
 s_add_u32 s83, s78, 143360
 ds_read_b64_tr_b16 a[100:101], v7 offset:16384
 v_mul_f32 v22, s34, v22
 v_mfma_f32_16x16x32_bf16 v[132:135], a[80:83], a[208:211], v[132:135]
 s_waitcnt lgkmcnt(3)
 ds_read_b64_tr_b16 a[102:103], v7 offset:20480
 v_xor_b32 v8, 256, v6
 v_mfma_f32_16x16x32_bf16 v[132:135], a[84:87], a[216:219], v[132:135]
 s_add_u32 s84, s78, 172032
 ds_read_b64_tr_b16 a[104:105], v8 offset:0
 v_mul_f32 v23, s34, v23
 v_mfma_f32_16x16x32_bf16 v[132:135], a[88:91], a[112:115], v[132:135]
 s_add_u32 s59, s56, 36864
 ds_read_b64_tr_b16 a[106:107], v8 offset:4096
 v_mul_f32 v68, s34, v68
 v_mfma_f32_16x16x32_bf16 v[132:135], a[92:95], a[120:123], v[132:135]
 ds_read_b64_tr_b16 a[108:109], v8 offset:16384
 buffer_store_dwordx4 v[224:227], v1, s[12:15], s59 offen offset:2048 sc1
 v_mfma_f32_16x16x32_bf16 v[140:143], a[72:75], a[196:199], v[140:143]
 s_add_u32 s85, s78, 200704
 ds_read_b64_tr_b16 a[110:111], v8 offset:20480
 v_xor_b32 v9, 65792, v6
 v_mfma_f32_16x16x32_bf16 v[140:143], a[76:79], a[204:207], v[140:143]
 s_add_u32 s59, s62, 0
 ds_read_b64_tr_b16 a[64:65], v9 offset:0
 v_mul_f32 v69, s34, v69
 v_mfma_f32_16x16x32_bf16 v[140:143], a[80:83], a[212:215], v[140:143]
 ds_read_b64_tr_b16 a[66:67], v9 offset:4096
 buffer_store_dwordx4 v[28:31], v1, s[12:15], s59 offen offset:0 sc1
 v_mfma_f32_16x16x32_bf16 v[140:143], a[84:87], a[220:223], v[140:143]
 ds_read_b64_tr_b16 a[68:69], v9 offset:16384
 v_mul_f32 v70, s34, v70
 v_mfma_f32_16x16x32_bf16 v[140:143], a[88:91], a[116:119], v[140:143]
 s_add_u32 s59, s62, 8192
 ds_read_b64_tr_b16 a[70:71], v9 offset:20480
 v_xor_b32 v10, 131360, v6
 v_mfma_f32_16x16x32_bf16 v[140:143], a[92:95], a[124:127], v[140:143]
 s_waitcnt lgkmcnt(6)
 ds_read_b64_tr_b16 a[72:73], v10 offset:0
 buffer_store_dwordx4 v[44:47], v1, s[12:15], s59 offen offset:0 sc1
 v_mfma_f32_16x16x32_bf16 v[148:151], a[96:99], a[192:195], v[148:151]
 ds_read_b64_tr_b16 a[74:75], v10 offset:4096
 v_mul_f32 v71, s34, v71
 v_mfma_f32_16x16x32_bf16 v[148:151], a[100:103], a[200:203], v[148:151]
 s_add_u32 s59, s56, 53248
 ds_read_b64_tr_b16 a[76:77], v10 offset:16384
 v_cvt_pk_bf16_f32 v20, v20, v21
 v_mfma_f32_16x16x32_bf16 v[148:151], a[104:107], a[208:211], v[148:151]
 s_waitcnt lgkmcnt(3)
 ds_read_b64_tr_b16 a[78:79], v10 offset:20480
 v_xor_b32 v7, 288, v6
 v_mfma_f32_16x16x32_bf16 v[148:151], a[108:111], a[216:219], v[148:151]
 ds_read_b64_tr_b16 a[80:81], v7 offset:0
 buffer_store_dwordx4 v[232:235], v1, s[12:15], s59 offen offset:2048 sc1
 v_mfma_f32_16x16x32_bf16 v[148:151], a[64:67], a[112:115], v[148:151]
 ds_read_b64_tr_b16 a[82:83], v7 offset:4096
 v_cvt_pk_bf16_f32 v21, v22, v23
 v_mfma_f32_16x16x32_bf16 v[148:151], a[68:71], a[120:123], v[148:151]
 ds_read_b64_tr_b16 a[84:85], v7 offset:16384
 v_cvt_pk_bf16_f32 v22, v68, v69
 v_mfma_f32_16x16x32_bf16 v[156:159], a[96:99], a[196:199], v[156:159]
 ds_read_b64_tr_b16 a[86:87], v7 offset:20480
 v_xor_b32 v8, 65824, v6
 v_mfma_f32_16x16x32_bf16 v[156:159], a[100:103], a[204:207], v[156:159]
 s_add_u32 s59, s62, 0
 ds_read_b64_tr_b16 a[88:89], v8 offset:0
 v_cvt_pk_bf16_f32 v23, v70, v71
 v_mfma_f32_16x16x32_bf16 v[156:159], a[104:107], a[212:215], v[156:159]
 ds_read_b64_tr_b16 a[90:91], v8 offset:4096
 buffer_store_dwordx4 v[20:23], v1, s[12:15], s59 offen offset:1024 sc1
 v_mfma_f32_16x16x32_bf16 v[156:159], a[108:111], a[220:223], v[156:159]
 ds_read_b64_tr_b16 a[92:93], v8 offset:16384
 v_accvgpr_write_b32 a4, v20
 v_mfma_f32_16x16x32_bf16 v[156:159], a[64:67], a[116:119], v[156:159]
 ds_read_b64_tr_b16 a[94:95], v8 offset:20480
 v_xor_b32 v9, 131392, v6
 v_mfma_f32_16x16x32_bf16 v[156:159], a[68:71], a[124:127], v[156:159]
 s_waitcnt lgkmcnt(6)
 ds_read_b64_tr_b16 a[96:97], v9 offset:0
 v_accvgpr_write_b32 a5, v21
 v_mfma_f32_16x16x32_bf16 v[164:167], a[72:75], a[192:195], v[164:167]
 s_add_u32 s59, s56, 53248
 ds_read_b64_tr_b16 a[98:99], v9 offset:4096
 v_accvgpr_write_b32 a6, v22
 v_mfma_f32_16x16x32_bf16 v[164:167], a[76:79], a[200:203], v[164:167]
 ds_read_b64_tr_b16 a[100:101], v9 offset:16384
 buffer_store_dwordx4 v[240:243], v1, s[12:15], s59 offen offset:3072 sc1
 v_mfma_f32_16x16x32_bf16 v[164:167], a[80:83], a[208:211], v[164:167]
 s_waitcnt lgkmcnt(3)
 ds_read_b64_tr_b16 a[102:103], v9 offset:20480
 v_xor_b32 v10, 320, v6
 v_mfma_f32_16x16x32_bf16 v[164:167], a[84:87], a[216:219], v[164:167]
 ds_read_b64_tr_b16 a[104:105], v10 offset:0
 v_accvgpr_write_b32 a7, v23
 v_mfma_f32_16x16x32_bf16 v[164:167], a[88:91], a[112:115], v[164:167]
 ds_read_b64_tr_b16 a[106:107], v10 offset:4096
 v_mul_f32 v36, s34, v36
 v_mfma_f32_16x16x32_bf16 v[164:167], a[92:95], a[120:123], v[164:167]
 ds_read_b64_tr_b16 a[108:109], v10 offset:16384
 v_mul_f32 v37, s34, v37
 v_mfma_f32_16x16x32_bf16 v[172:175], a[72:75], a[196:199], v[172:175]
 ds_read_b64_tr_b16 a[110:111], v10 offset:20480
 v_xor_b32 v7, 65856, v6
 v_mfma_f32_16x16x32_bf16 v[172:175], a[76:79], a[204:207], v[172:175]
 ds_read_b64_tr_b16 a[64:65], v7 offset:0
 v_mul_f32 v38, s34, v38
 v_mfma_f32_16x16x32_bf16 v[172:175], a[80:83], a[212:215], v[172:175]
 ds_read_b64_tr_b16 a[66:67], v7 offset:4096
 v_mul_f32 v39, s34, v39
 v_mfma_f32_16x16x32_bf16 v[172:175], a[84:87], a[220:223], v[172:175]
 ds_read_b64_tr_b16 a[68:69], v7 offset:16384
 v_mul_f32 v76, s34, v76
 v_mfma_f32_16x16x32_bf16 v[172:175], a[88:91], a[116:119], v[172:175]
 s_add_u32 s59, s56, 36864
 ds_read_b64_tr_b16 a[70:71], v7 offset:20480
 v_xor_b32 v8, 131424, v6
 v_mfma_f32_16x16x32_bf16 v[172:175], a[92:95], a[124:127], v[172:175]
 s_waitcnt lgkmcnt(6)
 ds_read_b64_tr_b16 a[72:73], v8 offset:0
 buffer_store_dwordx4 v[248:251], v1, s[12:15], s59 offen offset:3072 sc1
 v_mfma_f32_16x16x32_bf16 v[180:183], a[96:99], a[192:195], v[180:183]
 ds_read_b64_tr_b16 a[74:75], v8 offset:4096
 v_mul_f32 v77, s34, v77
 v_mfma_f32_16x16x32_bf16 v[180:183], a[100:103], a[200:203], v[180:183]
 ds_read_b64_tr_b16 a[76:77], v8 offset:16384
 v_mul_f32 v78, s34, v78
 v_mfma_f32_16x16x32_bf16 v[180:183], a[104:107], a[208:211], v[180:183]
 s_waitcnt lgkmcnt(3)
 ds_read_b64_tr_b16 a[78:79], v8 offset:20480
 v_xor_b32 v9, 352, v6
 v_mfma_f32_16x16x32_bf16 v[180:183], a[108:111], a[216:219], v[180:183]
 ds_read_b64_tr_b16 a[80:81], v9 offset:0
 v_mul_f32 v79, s34, v79
 v_mfma_f32_16x16x32_bf16 v[180:183], a[64:67], a[112:115], v[180:183]
 ds_read_b64_tr_b16 a[82:83], v9 offset:4096
 v_cvt_pk_bf16_f32 v36, v36, v37
 v_mfma_f32_16x16x32_bf16 v[180:183], a[68:71], a[120:123], v[180:183]
 ds_read_b64_tr_b16 a[84:85], v9 offset:16384
 v_cvt_pk_bf16_f32 v37, v38, v39
 v_mfma_f32_16x16x32_bf16 v[188:191], a[96:99], a[196:199], v[188:191]
 ds_read_b64_tr_b16 a[86:87], v9 offset:20480
 v_xor_b32 v10, 65888, v6
 v_mfma_f32_16x16x32_bf16 v[188:191], a[100:103], a[204:207], v[188:191]
 ds_read_b64_tr_b16 a[88:89], v10 offset:0
 v_cvt_pk_bf16_f32 v38, v76, v77
 v_mfma_f32_16x16x32_bf16 v[188:191], a[104:107], a[212:215], v[188:191]
 s_add_u32 s59, s62, 8192
 ds_read_b64_tr_b16 a[90:91], v10 offset:4096
 v_cvt_pk_bf16_f32 v39, v78, v79
 v_mfma_f32_16x16x32_bf16 v[188:191], a[108:111], a[220:223], v[188:191]
 ds_read_b64_tr_b16 a[92:93], v10 offset:16384
 buffer_store_dwordx4 v[36:39], v1, s[12:15], s59 offen offset:1024 sc1
 v_mfma_f32_16x16x32_bf16 v[188:191], a[64:67], a[116:119], v[188:191]
 ds_read_b64_tr_b16 a[94:95], v10 offset:20480
 v_xor_b32 v7, 131456, v6
 v_mfma_f32_16x16x32_bf16 v[188:191], a[68:71], a[124:127], v[188:191]
 s_waitcnt lgkmcnt(6)
 ds_read_b64_tr_b16 a[96:97], v7 offset:0
 v_accvgpr_write_b32 a36, v36
 v_mfma_f32_16x16x32_bf16 v[196:199], a[72:75], a[192:195], v[196:199]
 ds_read_b64_tr_b16 a[98:99], v7 offset:4096
 v_accvgpr_write_b32 a37, v37
 v_mfma_f32_16x16x32_bf16 v[196:199], a[76:79], a[200:203], v[196:199]
 ds_read_b64_tr_b16 a[100:101], v7 offset:16384
 v_accvgpr_write_b32 a38, v38
 v_mfma_f32_16x16x32_bf16 v[196:199], a[80:83], a[208:211], v[196:199]
 s_waitcnt lgkmcnt(3)
 ds_read_b64_tr_b16 a[102:103], v7 offset:20480
 v_xor_b32 v8, 384, v6
 v_mfma_f32_16x16x32_bf16 v[196:199], a[84:87], a[216:219], v[196:199]
 ds_read_b64_tr_b16 a[104:105], v8 offset:0
 v_accvgpr_write_b32 a39, v39
 v_mfma_f32_16x16x32_bf16 v[196:199], a[88:91], a[112:115], v[196:199]
 ds_read_b64_tr_b16 a[106:107], v8 offset:4096
 v_mul_f32 v84, s34, v84
 v_mfma_f32_16x16x32_bf16 v[196:199], a[92:95], a[120:123], v[196:199]
 ds_read_b64_tr_b16 a[108:109], v8 offset:16384
 v_mul_f32 v85, s34, v85
 v_mfma_f32_16x16x32_bf16 v[204:207], a[72:75], a[196:199], v[204:207]
 ds_read_b64_tr_b16 a[110:111], v8 offset:20480
 v_xor_b32 v9, 65920, v6
 v_mfma_f32_16x16x32_bf16 v[204:207], a[76:79], a[204:207], v[204:207]
 ds_read_b64_tr_b16 a[64:65], v9 offset:0
 v_mul_f32 v86, s34, v86
 v_mfma_f32_16x16x32_bf16 v[204:207], a[80:83], a[212:215], v[204:207]
 ds_read_b64_tr_b16 a[66:67], v9 offset:4096
 v_mul_f32 v87, s34, v87
 v_mfma_f32_16x16x32_bf16 v[204:207], a[84:87], a[220:223], v[204:207]
 ds_read_b64_tr_b16 a[68:69], v9 offset:16384
 v_mul_f32 v100, s34, v100
 v_mfma_f32_16x16x32_bf16 v[204:207], a[88:91], a[116:119], v[204:207]
 ds_read_b64_tr_b16 a[70:71], v9 offset:20480
 v_xor_b32 v10, 131488, v6
 v_mfma_f32_16x16x32_bf16 v[204:207], a[92:95], a[124:127], v[204:207]
 s_waitcnt lgkmcnt(6)
 ds_read_b64_tr_b16 a[72:73], v10 offset:0
 v_mul_f32 v101, s34, v101
 v_mfma_f32_16x16x32_bf16 v[212:215], a[96:99], a[192:195], v[212:215]
 ds_read_b64_tr_b16 a[74:75], v10 offset:4096
 v_mul_f32 v102, s34, v102
 v_mfma_f32_16x16x32_bf16 v[212:215], a[100:103], a[200:203], v[212:215]
 ds_read_b64_tr_b16 a[76:77], v10 offset:16384
 v_mul_f32 v103, s34, v103
 v_mfma_f32_16x16x32_bf16 v[212:215], a[104:107], a[208:211], v[212:215]
 s_waitcnt lgkmcnt(3)
 ds_read_b64_tr_b16 a[78:79], v10 offset:20480
 v_xor_b32 v7, 416, v6
 v_mfma_f32_16x16x32_bf16 v[212:215], a[108:111], a[216:219], v[212:215]
 ds_read_b64_tr_b16 a[80:81], v7 offset:0
 v_cvt_pk_bf16_f32 v84, v84, v85
 v_mfma_f32_16x16x32_bf16 v[212:215], a[64:67], a[112:115], v[212:215]
 ds_read_b64_tr_b16 a[82:83], v7 offset:4096
 v_cvt_pk_bf16_f32 v85, v86, v87
 v_mfma_f32_16x16x32_bf16 v[212:215], a[68:71], a[120:123], v[212:215]
 ds_read_b64_tr_b16 a[84:85], v7 offset:16384
 v_cvt_pk_bf16_f32 v86, v100, v101
 v_mfma_f32_16x16x32_bf16 v[220:223], a[96:99], a[196:199], v[220:223]
 ds_read_b64_tr_b16 a[86:87], v7 offset:20480
 v_xor_b32 v8, 65952, v6
 v_mfma_f32_16x16x32_bf16 v[220:223], a[100:103], a[204:207], v[220:223]
 s_add_u32 s59, s62, 0
 ds_read_b64_tr_b16 a[88:89], v8 offset:0
 v_cvt_pk_bf16_f32 v87, v102, v103
 v_mfma_f32_16x16x32_bf16 v[220:223], a[104:107], a[212:215], v[220:223]
 ds_read_b64_tr_b16 a[90:91], v8 offset:4096
 buffer_store_dwordx4 v[84:87], v1, s[12:15], s59 offen offset:2048 sc1
 v_mfma_f32_16x16x32_bf16 v[220:223], a[108:111], a[220:223], v[220:223]
 ds_read_b64_tr_b16 a[92:93], v8 offset:16384
 v_accvgpr_write_b32 a8, v84
 v_mfma_f32_16x16x32_bf16 v[220:223], a[64:67], a[116:119], v[220:223]
 ds_read_b64_tr_b16 a[94:95], v8 offset:20480
 v_xor_b32 v9, 131520, v6
 v_mfma_f32_16x16x32_bf16 v[220:223], a[68:71], a[124:127], v[220:223]
 s_waitcnt lgkmcnt(6)
 ds_read_b64_tr_b16 a[96:97], v9 offset:0
 v_accvgpr_write_b32 a9, v85
 v_mfma_f32_16x16x32_bf16 v[228:231], a[72:75], a[192:195], v[228:231]
 ds_read_b64_tr_b16 a[98:99], v9 offset:4096
 v_accvgpr_write_b32 a10, v86
 v_mfma_f32_16x16x32_bf16 v[228:231], a[76:79], a[200:203], v[228:231]
 ds_read_b64_tr_b16 a[100:101], v9 offset:16384
 v_accvgpr_write_b32 a11, v87
 v_mfma_f32_16x16x32_bf16 v[228:231], a[80:83], a[208:211], v[228:231]
 s_waitcnt lgkmcnt(3)
 ds_read_b64_tr_b16 a[102:103], v9 offset:20480
 v_xor_b32 v10, 448, v6
 v_mfma_f32_16x16x32_bf16 v[228:231], a[84:87], a[216:219], v[228:231]
 ds_read_b64_tr_b16 a[104:105], v10 offset:0
 v_mul_f32 v92, s34, v92
 v_mfma_f32_16x16x32_bf16 v[228:231], a[88:91], a[112:115], v[228:231]
 ds_read_b64_tr_b16 a[106:107], v10 offset:4096
 v_mul_f32 v93, s34, v93
 v_mfma_f32_16x16x32_bf16 v[228:231], a[92:95], a[120:123], v[228:231]
 ds_read_b64_tr_b16 a[108:109], v10 offset:16384
 v_mul_f32 v94, s34, v94
 v_mfma_f32_16x16x32_bf16 v[236:239], a[72:75], a[196:199], v[236:239]
 ds_read_b64_tr_b16 a[110:111], v10 offset:20480
 v_xor_b32 v7, 65984, v6
 v_mfma_f32_16x16x32_bf16 v[236:239], a[76:79], a[204:207], v[236:239]
 ds_read_b64_tr_b16 a[64:65], v7 offset:0
 buffer_load_dword v13, v12, s[12:15], s58 offen sc1
 v_mfma_f32_16x16x32_bf16 v[236:239], a[80:83], a[212:215], v[236:239]
 ds_read_b64_tr_b16 a[66:67], v7 offset:4096
 v_mul_f32 v95, s34, v95
 v_mfma_f32_16x16x32_bf16 v[236:239], a[84:87], a[220:223], v[236:239]
 ds_read_b64_tr_b16 a[68:69], v7 offset:16384
 v_mul_f32 v108, s34, v108
 v_mfma_f32_16x16x32_bf16 v[236:239], a[88:91], a[116:119], v[236:239]
 ds_read_b64_tr_b16 a[70:71], v7 offset:20480
 v_xor_b32 v8, 131552, v6
 v_mfma_f32_16x16x32_bf16 v[236:239], a[92:95], a[124:127], v[236:239]
 s_waitcnt lgkmcnt(6)
 ds_read_b64_tr_b16 a[72:73], v8 offset:0
 v_mul_f32 v109, s34, v109
 v_mfma_f32_16x16x32_bf16 v[244:247], a[96:99], a[192:195], v[244:247]
 ds_read_b64_tr_b16 a[74:75], v8 offset:4096
 v_mul_f32 v110, s34, v110
 v_mfma_f32_16x16x32_bf16 v[244:247], a[100:103], a[200:203], v[244:247]
 ds_read_b64_tr_b16 a[76:77], v8 offset:16384
 v_mul_f32 v111, s34, v111
 v_mfma_f32_16x16x32_bf16 v[244:247], a[104:107], a[208:211], v[244:247]
 s_waitcnt lgkmcnt(3)
 ds_read_b64_tr_b16 a[78:79], v8 offset:20480
 v_xor_b32 v9, 480, v6
 v_mfma_f32_16x16x32_bf16 v[244:247], a[108:111], a[216:219], v[244:247]
 ds_read_b64_tr_b16 a[80:81], v9 offset:0
 v_cvt_pk_bf16_f32 v92, v92, v93
 v_mfma_f32_16x16x32_bf16 v[244:247], a[64:67], a[112:115], v[244:247]
 ds_read_b64_tr_b16 a[82:83], v9 offset:4096
 v_cvt_pk_bf16_f32 v93, v94, v95
 v_mfma_f32_16x16x32_bf16 v[244:247], a[68:71], a[120:123], v[244:247]
 ds_read_b64_tr_b16 a[84:85], v9 offset:16384
 v_cvt_pk_bf16_f32 v94, v108, v109
 v_mfma_f32_16x16x32_bf16 v[252:255], a[96:99], a[196:199], v[252:255]
 ds_read_b64_tr_b16 a[86:87], v9 offset:20480
 v_xor_b32 v10, 66016, v6
 v_mfma_f32_16x16x32_bf16 v[252:255], a[100:103], a[204:207], v[252:255]
 s_add_u32 s59, s62, 8192
 ds_read_b64_tr_b16 a[88:89], v10 offset:0
 v_cvt_pk_bf16_f32 v95, v110, v111
 v_mfma_f32_16x16x32_bf16 v[252:255], a[104:107], a[212:215], v[252:255]
 ds_read_b64_tr_b16 a[90:91], v10 offset:4096
 buffer_store_dwordx4 v[92:95], v1, s[12:15], s59 offen offset:2048 sc1
 v_mfma_f32_16x16x32_bf16 v[252:255], a[108:111], a[220:223], v[252:255]
 ds_read_b64_tr_b16 a[92:93], v10 offset:16384
 v_accvgpr_write_b32 a40, v92
 v_mfma_f32_16x16x32_bf16 v[252:255], a[64:67], a[116:119], v[252:255]
 ds_read_b64_tr_b16 a[94:95], v10 offset:20480
 v_accvgpr_write_b32 a41, v93
 v_mfma_f32_16x16x32_bf16 v[252:255], a[68:71], a[124:127], v[252:255]
 s_waitcnt lgkmcnt(6)
 v_accvgpr_write_b32 a42, v94
 v_accvgpr_write_b32 a43, v95
 v_mfma_f32_16x16x32_bf16 v[16:19], a[72:75], a[192:195], v[16:19]
 v_mfma_f32_16x16x32_bf16 v[16:19], a[76:79], a[200:203], v[16:19]
 v_mfma_f32_16x16x32_bf16 v[16:19], a[80:83], a[208:211], v[16:19]
 s_waitcnt lgkmcnt(0)
 v_mfma_f32_16x16x32_bf16 v[16:19], a[84:87], a[216:219], v[16:19]
 v_mfma_f32_16x16x32_bf16 v[16:19], a[88:91], a[112:115], v[16:19]
 v_mfma_f32_16x16x32_bf16 v[16:19], a[92:95], a[120:123], v[16:19]
 v_mfma_f32_16x16x32_bf16 v[24:27], a[72:75], a[196:199], v[24:27]
 v_mfma_f32_16x16x32_bf16 v[24:27], a[76:79], a[204:207], v[24:27]
 v_mfma_f32_16x16x32_bf16 v[24:27], a[80:83], a[212:215], v[24:27]
 v_mfma_f32_16x16x32_bf16 v[24:27], a[84:87], a[220:223], v[24:27]
 s_waitcnt lgkmcnt(0)
 v_mfma_f32_16x16x32_bf16 v[24:27], a[88:91], a[116:119], v[24:27]
 s_barrier
 v_mfma_f32_16x16x32_bf16 v[24:27], a[92:95], a[124:127], v[24:27]
 s_waitcnt vmcnt(1)
 v_cmp_ne_u32 s[16:17], 0, v13
 v_cmp_gt_u32 vcc, 256, v5
 s_or_b64 vcc, vcc, s[16:17]
 s_mov_b32 m0, s40
 s_cselect_b32 s48, 0, 1
 s_cselect_b32 s52, 2.0, s42
 buffer_load_dwordx4 v1, s[12:15], s52 offen offset:0 sc1 lds
 v_pk_mul_f32 v[116:117], v[116:117], s[34:35]
 v_pk_mul_f32 v[118:119], v[118:119], s[34:35]
 v_pk_mul_f32 v[132:133], v[132:133], s[34:35]
 v_pk_mul_f32 v[134:135], v[134:135], s[34:35]
 v_cvt_pk_bf16_f32 v116, v116, v117
 v_cvt_pk_bf16_f32 v117, v118, v119
 v_cvt_pk_bf16_f32 v118, v132, v133
 v_cvt_pk_bf16_f32 v119, v134, v135
 s_add_u32 s59, s62, 0
 buffer_store_dwordx4 v[116:119], v1, s[12:15], s59 offen offset:3072 sc1
 v_accvgpr_write_b32 a12, v116
 v_accvgpr_write_b32 a13, v117
 v_accvgpr_write_b32 a14, v118
 v_accvgpr_write_b32 a15, v119
 v_pk_mul_f32 v[124:125], v[124:125], s[34:35]
 v_pk_mul_f32 v[126:127], v[126:127], s[34:35]
 v_pk_mul_f32 v[140:141], v[140:141], s[34:35]
 v_pk_mul_f32 v[142:143], v[142:143], s[34:35]
 buffer_load_dwordx4 v1, s[12:15], s52 offen offset:1024 sc1 lds
 v_cvt_pk_bf16_f32 v124, v124, v125
 v_cvt_pk_bf16_f32 v125, v126, v127
 v_cvt_pk_bf16_f32 v126, v140, v141
 v_cvt_pk_bf16_f32 v127, v142, v143
 s_add_u32 s59, s62, 8192
 buffer_store_dwordx4 v[124:127], v1, s[12:15], s59 offen offset:3072 sc1
 v_accvgpr_write_b32 a44, v124
 v_accvgpr_write_b32 a45, v125
 v_accvgpr_write_b32 a46, v126
 v_accvgpr_write_b32 a47, v127
 v_pk_mul_f32 v[148:149], v[148:149], s[34:35]
 v_pk_mul_f32 v[150:151], v[150:151], s[34:35]
 v_pk_mul_f32 v[164:165], v[164:165], s[34:35]
 v_pk_mul_f32 v[166:167], v[166:167], s[34:35]
 v_cvt_pk_bf16_f32 v148, v148, v149
 v_cvt_pk_bf16_f32 v149, v150, v151
 v_cvt_pk_bf16_f32 v150, v164, v165
 buffer_load_dwordx4 v1, s[12:15], s52 offen offset:2048 sc1 lds
 v_cvt_pk_bf16_f32 v151, v166, v167
 s_add_u32 s59, s62, 4096
 buffer_store_dwordx4 v[148:151], v1, s[12:15], s59 offen offset:0 sc1
 v_accvgpr_write_b32 a16, v148
 v_accvgpr_write_b32 a17, v149
 v_accvgpr_write_b32 a18, v150
 v_accvgpr_write_b32 a19, v151
 v_pk_mul_f32 v[156:157], v[156:157], s[34:35]
 v_pk_mul_f32 v[158:159], v[158:159], s[34:35]
 v_pk_mul_f32 v[172:173], v[172:173], s[34:35]
 v_pk_mul_f32 v[174:175], v[174:175], s[34:35]
 v_cvt_pk_bf16_f32 v156, v156, v157
 v_cvt_pk_bf16_f32 v157, v158, v159
 v_cvt_pk_bf16_f32 v158, v172, v173
 v_cvt_pk_bf16_f32 v159, v174, v175
 s_add_u32 s59, s62, 12288
 buffer_store_dwordx4 v[156:159], v1, s[12:15], s59 offen offset:0 sc1
 v_accvgpr_write_b32 a48, v156
 buffer_load_dwordx4 v1, s[12:15], s52 offen offset:3072 sc1 lds
 v_accvgpr_write_b32 a49, v157
 v_accvgpr_write_b32 a50, v158
 v_accvgpr_write_b32 a51, v159
 v_pk_mul_f32 v[180:181], v[180:181], s[34:35]
 v_pk_mul_f32 v[182:183], v[182:183], s[34:35]
 v_pk_mul_f32 v[196:197], v[196:197], s[34:35]
 v_pk_mul_f32 v[198:199], v[198:199], s[34:35]
 v_cvt_pk_bf16_f32 v180, v180, v181
 v_cvt_pk_bf16_f32 v181, v182, v183
 v_cvt_pk_bf16_f32 v182, v196, v197
 v_cvt_pk_bf16_f32 v183, v198, v199
 s_add_u32 s59, s62, 4096
 buffer_store_dwordx4 v[180:183], v1, s[12:15], s59 offen offset:1024 sc1
 v_accvgpr_write_b32 a20, v180
 v_accvgpr_write_b32 a21, v181
 v_accvgpr_write_b32 a22, v182
 v_accvgpr_write_b32 a23, v183
 s_bitset1_b32 m0, 12
 s_nop 0
 buffer_load_dwordx4 v4, s[12:15], s52 offen offset:0 sc1 lds
 v_pk_mul_f32 v[188:189], v[188:189], s[34:35]
 v_pk_mul_f32 v[190:191], v[190:191], s[34:35]
 v_pk_mul_f32 v[204:205], v[204:205], s[34:35]
 v_pk_mul_f32 v[206:207], v[206:207], s[34:35]
 v_cvt_pk_bf16_f32 v188, v188, v189
 v_cvt_pk_bf16_f32 v189, v190, v191
 v_cvt_pk_bf16_f32 v190, v204, v205
 v_cvt_pk_bf16_f32 v191, v206, v207
 s_add_u32 s59, s62, 12288
 buffer_store_dwordx4 v[188:191], v1, s[12:15], s59 offen offset:1024 sc1
 v_accvgpr_write_b32 a52, v188
 v_accvgpr_write_b32 a53, v189
 v_accvgpr_write_b32 a54, v190
 v_accvgpr_write_b32 a55, v191
 v_pk_mul_f32 v[212:213], v[212:213], s[34:35]
 v_pk_mul_f32 v[214:215], v[214:215], s[34:35]
 v_pk_mul_f32 v[228:229], v[228:229], s[34:35]
 v_pk_mul_f32 v[230:231], v[230:231], s[34:35]
 buffer_load_dwordx4 v4, s[12:15], s52 offen offset:1024 sc1 lds
 v_cvt_pk_bf16_f32 v212, v212, v213
 v_cvt_pk_bf16_f32 v213, v214, v215
 v_cvt_pk_bf16_f32 v214, v228, v229
 v_cvt_pk_bf16_f32 v215, v230, v231
 s_add_u32 s59, s62, 4096
 buffer_store_dwordx4 v[212:215], v1, s[12:15], s59 offen offset:2048 sc1
 v_accvgpr_write_b32 a24, v212
 v_accvgpr_write_b32 a25, v213
 v_accvgpr_write_b32 a26, v214
 v_accvgpr_write_b32 a27, v215
 v_pk_mul_f32 v[220:221], v[220:221], s[34:35]
 v_pk_mul_f32 v[222:223], v[222:223], s[34:35]
 v_pk_mul_f32 v[236:237], v[236:237], s[34:35]
 v_pk_mul_f32 v[238:239], v[238:239], s[34:35]
 v_cvt_pk_bf16_f32 v220, v220, v221
 v_cvt_pk_bf16_f32 v221, v222, v223
 v_cvt_pk_bf16_f32 v222, v236, v237
 buffer_load_dwordx4 v4, s[12:15], s52 offen offset:2048 sc1 lds
 v_cvt_pk_bf16_f32 v223, v238, v239
 s_add_u32 s59, s62, 12288
 buffer_store_dwordx4 v[220:223], v1, s[12:15], s59 offen offset:2048 sc1
 v_accvgpr_write_b32 a56, v220
 v_accvgpr_write_b32 a57, v221
 v_accvgpr_write_b32 a58, v222
 v_accvgpr_write_b32 a59, v223
 v_pk_mul_f32 v[244:245], v[244:245], s[34:35]
 v_pk_mul_f32 v[246:247], v[246:247], s[34:35]
 v_pk_mul_f32 v[16:17], v[16:17], s[34:35]
 v_pk_mul_f32 v[18:19], v[18:19], s[34:35]
 v_cvt_pk_bf16_f32 v244, v244, v245
 v_cvt_pk_bf16_f32 v245, v246, v247
 v_cvt_pk_bf16_f32 v246, v16, v17
 v_cvt_pk_bf16_f32 v247, v18, v19
 s_add_u32 s59, s62, 4096
 buffer_store_dwordx4 v[244:247], v1, s[12:15], s59 offen offset:3072 sc1
 v_accvgpr_write_b32 a28, v244
 buffer_load_dwordx4 v4, s[12:15], s52 offen offset:3072 sc1 lds
 v_accvgpr_write_b32 a29, v245
 v_accvgpr_write_b32 a30, v246
 v_accvgpr_write_b32 a31, v247
 v_pk_mul_f32 v[252:253], v[252:253], s[34:35]
 v_pk_mul_f32 v[254:255], v[254:255], s[34:35]
 v_pk_mul_f32 v[24:25], v[24:25], s[34:35]
 v_pk_mul_f32 v[26:27], v[26:27], s[34:35]
 v_cvt_pk_bf16_f32 v252, v252, v253
 v_cvt_pk_bf16_f32 v253, v254, v255
 v_cvt_pk_bf16_f32 v254, v24, v25
 v_cvt_pk_bf16_f32 v255, v26, v27
 s_add_u32 s59, s62, 12288
 buffer_store_dwordx4 v[252:255], v1, s[12:15], s59 offen offset:3072 sc1
 v_accvgpr_write_b32 a60, v252
 v_accvgpr_write_b32 a61, v253
 v_accvgpr_write_b32 a62, v254
 v_accvgpr_write_b32 a63, v255
L_kvdone:
 s_load_dword s31, s[74:75], s30
 s_cmp_ge_u32 s28, 14
 s_cbranch_scc1 L_s1b
 s_mov_b32 s36, 0xffff0000
 s_and_b32 s33, s95, 31
 s_lshr_b32 s34, s95, 5
 v_lshlrev_b32 v128, 16, v32
 v_and_b32 v129, s36, v32
 v_lshlrev_b32 v130, 16, v40
 v_and_b32 v131, s36, v40
 v_lshlrev_b32 v132, 16, v48
 v_and_b32 v133, s36, v48
 v_lshlrev_b32 v134, 16, v56
 v_and_b32 v135, s36, v56
 v_lshlrev_b32 v136, 16, v64
 v_and_b32 v137, s36, v64
 v_lshlrev_b32 v138, 16, v72
 v_and_b32 v139, s36, v72
 v_lshlrev_b32 v140, 16, v80
 v_and_b32 v141, s36, v80
 v_lshlrev_b32 v142, 16, v88
 v_lshlrev_b32 v143, 16, v90
 v_and_b32 v144, s36, v88
 v_and_b32 v145, s36, v90
 v_lshlrev_b32 v146, 16, v89
 v_lshlrev_b32 v147, 16, v91
 v_and_b32 v148, s36, v89
 v_and_b32 v149, s36, v91
 v_pk_mul_f32 v[150:151], v[128:129], v[148:149]
 v_pk_fma_f32 v[150:151], v[130:131], v[146:147], v[150:151]
 v_pk_fma_f32 v[150:151], v[132:133], v[144:145], v[150:151]
 v_pk_fma_f32 v[150:151], v[134:135], v[142:143], v[150:151]
 v_pk_mul_f32 v[150:151], v[150:151], v[138:139]
 v_cvt_pk_bf16_f32 v16, v150, v151
 v_pk_mul_f32 v[152:153], v[130:131], v[148:149]
 v_pk_fma_f32 v[152:153], v[132:133], v[146:147], v[152:153]
 v_pk_fma_f32 v[152:153], v[134:135], v[144:145], v[152:153]
 v_pk_fma_f32 v[152:153], v[136:137], v[142:143], v[152:153]
 v_pk_mul_f32 v[152:153], v[152:153], v[140:141]
 v_cvt_pk_bf16_f32 v20, v152, v153
 v_lshlrev_b32 v128, 16, v33
 v_and_b32 v129, s36, v33
 v_lshlrev_b32 v130, 16, v41
 v_and_b32 v131, s36, v41
 v_lshlrev_b32 v132, 16, v49
 v_and_b32 v133, s36, v49
 v_lshlrev_b32 v134, 16, v57
 v_and_b32 v135, s36, v57
 v_lshlrev_b32 v136, 16, v65
 v_and_b32 v137, s36, v65
 v_lshlrev_b32 v138, 16, v73
 v_and_b32 v139, s36, v73
 v_lshlrev_b32 v140, 16, v81
 v_and_b32 v141, s36, v81
 v_lshlrev_b32 v142, 16, v96
 v_lshlrev_b32 v143, 16, v98
 v_and_b32 v144, s36, v96
 v_and_b32 v145, s36, v98
 v_lshlrev_b32 v146, 16, v97
 v_lshlrev_b32 v147, 16, v99
 v_and_b32 v148, s36, v97
 v_and_b32 v149, s36, v99
 v_pk_mul_f32 v[150:151], v[128:129], v[148:149]
 v_pk_fma_f32 v[150:151], v[130:131], v[146:147], v[150:151]
 v_pk_fma_f32 v[150:151], v[132:133], v[144:145], v[150:151]
 v_pk_fma_f32 v[150:151], v[134:135], v[142:143], v[150:151]
 v_pk_mul_f32 v[150:151], v[150:151], v[138:139]
 v_cvt_pk_bf16_f32 v17, v150, v151
 v_pk_mul_f32 v[152:153], v[130:131], v[148:149]
 v_pk_fma_f32 v[152:153], v[132:133], v[146:147], v[152:153]
 v_pk_fma_f32 v[152:153], v[134:135], v[144:145], v[152:153]
 v_pk_fma_f32 v[152:153], v[136:137], v[142:143], v[152:153]
 v_pk_mul_f32 v[152:153], v[152:153], v[140:141]
 v_cvt_pk_bf16_f32 v21, v152, v153
 v_lshlrev_b32 v128, 16, v34
 v_and_b32 v129, s36, v34
 v_lshlrev_b32 v130, 16, v42
 v_and_b32 v131, s36, v42
 v_lshlrev_b32 v132, 16, v50
 v_and_b32 v133, s36, v50
 v_lshlrev_b32 v134, 16, v58
 v_and_b32 v135, s36, v58
 v_lshlrev_b32 v136, 16, v66
 v_and_b32 v137, s36, v66
 v_lshlrev_b32 v138, 16, v74
 v_and_b32 v139, s36, v74
 v_lshlrev_b32 v140, 16, v82
 v_and_b32 v141, s36, v82
 v_lshlrev_b32 v142, 16, v104
 v_lshlrev_b32 v143, 16, v106
 v_and_b32 v144, s36, v104
 v_and_b32 v145, s36, v106
 v_lshlrev_b32 v146, 16, v105
 v_lshlrev_b32 v147, 16, v107
 v_and_b32 v148, s36, v105
 v_and_b32 v149, s36, v107
 v_pk_mul_f32 v[150:151], v[128:129], v[148:149]
 v_pk_fma_f32 v[150:151], v[130:131], v[146:147], v[150:151]
 v_pk_fma_f32 v[150:151], v[132:133], v[144:145], v[150:151]
 v_pk_fma_f32 v[150:151], v[134:135], v[142:143], v[150:151]
 v_pk_mul_f32 v[150:151], v[150:151], v[138:139]
 v_cvt_pk_bf16_f32 v18, v150, v151
 v_pk_mul_f32 v[152:153], v[130:131], v[148:149]
 v_pk_fma_f32 v[152:153], v[132:133], v[146:147], v[152:153]
 v_pk_fma_f32 v[152:153], v[134:135], v[144:145], v[152:153]
 v_pk_fma_f32 v[152:153], v[136:137], v[142:143], v[152:153]
 v_pk_mul_f32 v[152:153], v[152:153], v[140:141]
 v_cvt_pk_bf16_f32 v22, v152, v153
 v_lshlrev_b32 v128, 16, v35
 v_and_b32 v129, s36, v35
 v_lshlrev_b32 v130, 16, v43
 v_and_b32 v131, s36, v43
 v_lshlrev_b32 v132, 16, v51
 v_and_b32 v133, s36, v51
 v_lshlrev_b32 v134, 16, v59
 v_and_b32 v135, s36, v59
 v_lshlrev_b32 v136, 16, v67
 v_and_b32 v137, s36, v67
 v_lshlrev_b32 v138, 16, v75
 v_and_b32 v139, s36, v75
 v_lshlrev_b32 v140, 16, v83
 v_and_b32 v141, s36, v83
 v_lshlrev_b32 v142, 16, v112
 v_lshlrev_b32 v143, 16, v114
 v_and_b32 v144, s36, v112
 v_and_b32 v145, s36, v114
 v_lshlrev_b32 v146, 16, v113
 v_lshlrev_b32 v147, 16, v115
 v_and_b32 v148, s36, v113
 v_and_b32 v149, s36, v115
 v_pk_mul_f32 v[150:151], v[128:129], v[148:149]
 v_pk_fma_f32 v[150:151], v[130:131], v[146:147], v[150:151]
 v_pk_fma_f32 v[150:151], v[132:133], v[144:145], v[150:151]
 v_pk_fma_f32 v[150:151], v[134:135], v[142:143], v[150:151]
 v_pk_mul_f32 v[150:151], v[150:151], v[138:139]
 v_cvt_pk_bf16_f32 v19, v150, v151
 v_pk_mul_f32 v[152:153], v[130:131], v[148:149]
 v_pk_fma_f32 v[152:153], v[132:133], v[146:147], v[152:153]
 v_pk_fma_f32 v[152:153], v[134:135], v[144:145], v[152:153]
 v_pk_fma_f32 v[152:153], v[136:137], v[142:143], v[152:153]
 v_pk_mul_f32 v[152:153], v[152:153], v[140:141]
 v_cvt_pk_bf16_f32 v23, v152, v153
 v_lshrrev_b32 v26, 3, v0
 v_lshlrev_b32 v26, 8, v26
 v_and_b32 v25, 7, v0
 v_lshl_add_u32 v26, v25, 4, v26
 s_lshl_b32 s35, s3, 11
 s_add_u32 s35, s35, 0x20000
 v_add_u32 v26, s35, v26
 ds_write_b128 v26, v[16:19] offset:0
 ds_write_b128 v26, v[20:23] offset:128
 v_bfe_u32 v24, v0, 2, 2
 v_bfe_u32 v28, v0, 4, 1
 v_lshl_add_u32 v24, v28, 3, v24
 v_lshlrev_b32 v24, 2, v24
 v_lshrrev_b32 v28, 5, v0
 v_add_u32 v24, v24, v28
 v_lshlrev_b32 v24, 7, v24
 v_and_b32 v28, 3, v0
 v_lshl_add_u32 v24, v28, 3, v24
 s_lshl_b32 s35, s3, 5
 s_add_u32 s35, s35, 0x20000
 v_add_u32 v24, s35, v24
 v_and_b32 v25, 15, v0
 v_mul_u32_u24 v25, 4096, v25
 v_lshrrev_b32 v28, 4, v0
 v_lshl_add_u32 v25, v28, 4, v25
 s_lshl_b32 s35, s34, 2
 s_add_u32 s35, s35, s3
 s_mul_i32 s35, s35, 65536
 s_lshl_b32 s36, s33, 7
 s_add_u32 s35, s35, s36
 s_add_u32 s35, s35, 85983232
L_s1b:
 s_add_u32 s52, s52, s70
 s_or_b32 m0, s40, 0x8000
 s_nop 0
 buffer_load_dwordx4 v1, s[12:15], s52 offen offset:0 sc1 lds
 v_mov_b32 v2, v1
 v_add_u32 v3, 0x10000, v1
 v_mov_b64 v[96:97], 0
 v_mov_b64 v[98:99], 0
 v_mov_b64 v[100:101], 0
 v_mov_b64 v[102:103], 0
 v_mov_b64 v[104:105], 0
 v_mov_b64 v[106:107], 0
 v_mov_b64 v[108:109], 0
 v_mov_b64 v[110:111], 0
 v_mov_b64 v[112:113], 0
 v_mov_b64 v[114:115], 0
 buffer_load_dwordx4 v1, s[12:15], s52 offen offset:1024 sc1 lds
 v_mov_b64 v[116:117], 0
 v_mov_b64 v[118:119], 0
 v_mov_b64 v[120:121], 0
 v_mov_b64 v[122:123], 0
 v_mov_b64 v[124:125], 0
 v_mov_b64 v[126:127], 0
 v_mov_b64 v[128:129], 0
 v_mov_b64 v[130:131], 0
 v_mov_b64 v[132:133], 0
 v_mov_b64 v[134:135], 0
 v_mov_b64 v[136:137], 0
 v_mov_b64 v[138:139], 0
 buffer_load_dwordx4 v1, s[12:15], s52 offen offset:2048 sc1 lds
 v_mov_b64 v[140:141], 0
 v_mov_b64 v[142:143], 0
 v_mov_b64 v[144:145], 0
 v_mov_b64 v[146:147], 0
 v_mov_b64 v[148:149], 0
 v_mov_b64 v[150:151], 0
 v_mov_b64 v[152:153], 0
 v_mov_b64 v[154:155], 0
 v_mov_b64 v[156:157], 0
 v_mov_b64 v[158:159], 0
 v_mov_b64 v[160:161], 0
 buffer_load_dwordx4 v1, s[12:15], s52 offen offset:3072 sc1 lds
 v_mov_b64 v[162:163], 0
 v_mov_b64 v[164:165], 0
 v_mov_b64 v[166:167], 0
 v_mov_b64 v[168:169], 0
 v_mov_b64 v[170:171], 0
 v_mov_b64 v[172:173], 0
 v_mov_b64 v[174:175], 0
 v_mov_b64 v[176:177], 0
 v_mov_b64 v[178:179], 0
 v_mov_b64 v[180:181], 0
 v_mov_b64 v[182:183], 0
 v_mov_b64 v[184:185], 0
 s_bitset1_b32 m0, 12
 s_nop 0
 buffer_load_dwordx4 v4, s[12:15], s52 offen offset:0 sc1 lds
 v_mov_b64 v[186:187], 0
 v_mov_b64 v[188:189], 0
 v_mov_b64 v[190:191], 0
 v_mov_b64 v[192:193], 0
 v_mov_b64 v[194:195], 0
 v_mov_b64 v[196:197], 0
 v_mov_b64 v[198:199], 0
 v_mov_b64 v[200:201], 0
 v_mov_b64 v[202:203], 0
 v_mov_b64 v[204:205], 0
 v_mov_b64 v[206:207], 0
 v_mov_b64 v[208:209], 0
 buffer_load_dwordx4 v4, s[12:15], s52 offen offset:1024 sc1 lds
 v_mov_b64 v[210:211], 0
 v_mov_b64 v[212:213], 0
 v_mov_b64 v[214:215], 0
 v_mov_b64 v[216:217], 0
 v_mov_b64 v[218:219], 0
 v_mov_b64 v[220:221], 0
 v_mov_b64 v[222:223], 0
 v_mov_b64 v[224:225], 0
 v_mov_b64 v[226:227], 0
 v_mov_b64 v[228:229], 0
 v_mov_b64 v[230:231], 0
 buffer_load_dwordx4 v4, s[12:15], s52 offen offset:2048 sc1 lds
 v_mov_b64 v[232:233], 0
 v_mov_b64 v[234:235], 0
 v_mov_b64 v[236:237], 0
 v_mov_b64 v[238:239], 0
 v_mov_b64 v[240:241], 0
 v_mov_b64 v[242:243], 0
 v_mov_b64 v[244:245], 0
 v_mov_b64 v[246:247], 0
 v_mov_b64 v[248:249], 0
 v_mov_b64 v[250:251], 0
 v_mov_b64 v[252:253], 0
 v_mov_b64 v[254:255], 0
 buffer_load_dwordx4 v4, s[12:15], s52 offen offset:3072 sc1 lds
 v_mov_b32 v7, 0
 v_mov_b32 v8, 0
 v_mov_b32 v9, 0
 v_mov_b32 v10, 0
 v_mov_b32 v13, v1
 v_mul_u32_u24 v15, s27, v12
 v_accvgpr_write_b32 a246, 1
 v_accvgpr_write_b32 a247, 1
 s_cmp_lt_u32 s28, 14
 s_cselect_b32 s62, 1, 0
 s_andn2_b32 s62, s62, s27
 s_cmp_ge_u32 s44, 2
 s_cbranch_scc1 L_nomask0
 v_accvgpr_read_b32 v96, a224
 v_accvgpr_read_b32 v97, a225
 v_accvgpr_read_b32 v98, a226
 v_accvgpr_read_b32 v99, a227
 v_accvgpr_read_b32 v104, a228
 v_accvgpr_read_b32 v105, a229
 v_accvgpr_read_b32 v106, a230
 v_accvgpr_read_b32 v107, a231
 v_accvgpr_read_b32 v112, a232
 v_accvgpr_read_b32 v113, a233
 v_accvgpr_read_b32 v114, a234
 v_accvgpr_read_b32 v115, a235
 v_accvgpr_read_b32 v120, a236
 v_accvgpr_read_b32 v121, a237
 v_accvgpr_read_b32 v122, a238
 v_accvgpr_read_b32 v123, a239
L_nomask0:
 v_accvgpr_read_b32 v27, a245
 s_lshl_b32 s36, s95, 2
 s_add_u32 s36, s36, 84959232
 s_cmp_lt_u32 s28, 14
 s_cselect_b32 s36, s36, 2.0
 s_add_u32 s33, s94, 4
 s_cmp_eq_u32 s27, 1
 s_cselect_b32 s33, s33, 2.0
 s_cmp_eq_u32 s48, 0
 s_cbranch_scc1 L_kvlate
 s_add_u32 s42, s52, s70
L_kvok:
 s_waitcnt vmcnt(8) lgkmcnt(0)
 s_barrier
 ds_read_b128 a[64:67], v2 offset:0
 ds_read_b128 a[68:71], v2 offset:1024
 ds_read_b128 a[72:75], v2 offset:2048
 ds_read_b128 a[76:79], v2 offset:3072
 ds_read_b128 a[80:83], v2 offset:4096
 ds_read_b128 a[84:87], v2 offset:5120
 ds_read_b128 a[88:91], v2 offset:6144
 ds_read_b128 a[92:95], v2 offset:7168
 buffer_store_dword v27, v27, s[12:15], s1 offen sc1
 buffer_store_dword v27, v27, s[12:15], s33 offen sc1
 s_cmp_ge_u32 s28, 14
 s_cbranch_scc1 L_s1c
 ds_read_b64_tr_b16 v[16:17], v24 offset:0
 ds_read_b64_tr_b16 v[18:19], v24 offset:2048
 ds_read_b64_tr_b16 v[20:21], v24 offset:256
 ds_read_b64_tr_b16 v[22:23], v24 offset:2304
 s_waitcnt lgkmcnt(0)
 buffer_store_dwordx4 v[16:19], v25, s[12:15], s35 offen offset:0 sc1
 buffer_store_dwordx4 v[20:23], v25, s[12:15], s35 offen offset:64 sc1
L_s1c:
 s_mov_b32 m0, s41
 s_waitcnt lgkmcnt(0)
 v_mfma_f32_16x16x32_bf16 v[32:35], a[64:67], a[0:3], v[96:99]
 ds_read_b128 a[96:99], v2 offset:8192
 v_mfma_f32_16x16x32_bf16 v[32:35], a[68:71], a[4:7], v[32:35]
 buffer_load_dwordx4 v1, s[12:15], s43 offen offset:0 sc1 lds
 v_mfma_f32_16x16x32_bf16 v[32:35], a[72:75], a[8:11], v[32:35]
 ds_read_b128 a[100:103], v2 offset:9216
 v_mfma_f32_16x16x32_bf16 v[32:35], a[76:79], a[12:15], v[32:35]
 v_mfma_f32_16x16x32_bf16 v[32:35], a[80:83], a[16:19], v[32:35]
 ds_read_b128 a[104:107], v2 offset:10240
 v_mfma_f32_16x16x32_bf16 v[32:35], a[84:87], a[20:23], v[32:35]
 buffer_load_dwordx4 v1, s[12:15], s43 offen offset:1024 sc1 lds
 v_mfma_f32_16x16x32_bf16 v[32:35], a[88:91], a[24:27], v[32:35]
 ds_read_b128 a[108:111], v2 offset:11264
 v_mfma_f32_16x16x32_bf16 v[32:35], a[92:95], a[28:31], v[32:35]
 v_mfma_f32_16x16x32_bf16 v[36:39], a[64:67], a[32:35], v[100:103]
 ds_read_b128 a[112:115], v2 offset:12288
 v_mfma_f32_16x16x32_bf16 v[36:39], a[68:71], a[36:39], v[36:39]
 buffer_load_dwordx4 v1, s[12:15], s43 offen offset:2048 sc1 lds
 v_mfma_f32_16x16x32_bf16 v[36:39], a[72:75], a[40:43], v[36:39]
 ds_read_b128 a[116:119], v2 offset:13312
 v_mfma_f32_16x16x32_bf16 v[36:39], a[76:79], a[44:47], v[36:39]
 v_mfma_f32_16x16x32_bf16 v[36:39], a[80:83], a[48:51], v[36:39]
 ds_read_b128 a[120:123], v2 offset:14336
 v_mfma_f32_16x16x32_bf16 v[36:39], a[84:87], a[52:55], v[36:39]
 buffer_load_dwordx4 v1, s[12:15], s43 offen offset:3072 sc1 lds
 v_mfma_f32_16x16x32_bf16 v[36:39], a[88:91], a[56:59], v[36:39]
 ds_read_b128 a[124:127], v2 offset:15360
 v_mfma_f32_16x16x32_bf16 v[36:39], a[92:95], a[60:63], v[36:39]
 s_waitcnt lgkmcnt(6)
 v_exp_f32 v64, v32
 v_mfma_f32_16x16x32_bf16 v[40:43], a[96:99], a[0:3], v[104:107]
 s_bitset1_b32 m0, 12
 ds_read_b128 a[64:67], v2 offset:16384
 v_mfma_f32_16x16x32_bf16 v[40:43], a[100:103], a[4:7], v[40:43]
 s_waitcnt lgkmcnt(5)
 buffer_load_dwordx4 v4, s[12:15], s43 offen offset:0 sc1 lds
 v_mfma_f32_16x16x32_bf16 v[40:43], a[104:107], a[8:11], v[40:43]
 ds_read_b128 a[68:71], v2 offset:17408
 v_mfma_f32_16x16x32_bf16 v[40:43], a[108:111], a[12:15], v[40:43]
 s_waitcnt lgkmcnt(4)
 v_exp_f32 v65, v33
 v_mfma_f32_16x16x32_bf16 v[40:43], a[112:115], a[16:19], v[40:43]
 ds_read_b128 a[72:75], v2 offset:18432
 v_add_f32 v5, v64, v65
 v_mfma_f32_16x16x32_bf16 v[40:43], a[116:119], a[20:23], v[40:43]
 s_waitcnt lgkmcnt(3)
 buffer_load_dwordx4 v4, s[12:15], s43 offen offset:1024 sc1 lds
 v_mfma_f32_16x16x32_bf16 v[40:43], a[120:123], a[24:27], v[40:43]
 ds_read_b128 a[76:79], v2 offset:19456
 v_mfma_f32_16x16x32_bf16 v[40:43], a[124:127], a[28:31], v[40:43]
 v_exp_f32 v66, v34
 v_mfma_f32_16x16x32_bf16 v[44:47], a[96:99], a[32:35], v[108:111]
 ds_read_b128 a[80:83], v2 offset:20480
 v_add_f32 v5, v5, v66
 v_mfma_f32_16x16x32_bf16 v[44:47], a[100:103], a[36:39], v[44:47]
 buffer_load_dwordx4 v4, s[12:15], s43 offen offset:2048 sc1 lds
 v_mfma_f32_16x16x32_bf16 v[44:47], a[104:107], a[40:43], v[44:47]
 ds_read_b128 a[84:87], v2 offset:21504
 v_mfma_f32_16x16x32_bf16 v[44:47], a[108:111], a[44:47], v[44:47]
 v_exp_f32 v67, v35
 v_mfma_f32_16x16x32_bf16 v[44:47], a[112:115], a[48:51], v[44:47]
 ds_read_b128 a[88:91], v2 offset:22528
 v_add_f32 v5, v5, v67
 v_mfma_f32_16x16x32_bf16 v[44:47], a[116:119], a[52:55], v[44:47]
 buffer_load_dwordx4 v4, s[12:15], s43 offen offset:3072 sc1 lds
 v_mfma_f32_16x16x32_bf16 v[44:47], a[120:123], a[56:59], v[44:47]
 ds_read_b128 a[92:95], v2 offset:23552
 v_mfma_f32_16x16x32_bf16 v[44:47], a[124:127], a[60:63], v[44:47]
 s_waitcnt lgkmcnt(6)
 v_exp_f32 v68, v36
 v_mfma_f32_16x16x32_bf16 v[48:51], a[64:67], a[0:3], v[112:115]
 s_add_u32 s43, s43, s71
 ds_read_b128 a[96:99], v2 offset:24576
 v_mfma_f32_16x16x32_bf16 v[48:51], a[68:71], a[4:7], v[48:51]
 s_waitcnt lgkmcnt(5)
 v_exp_f32 v69, v37
 v_mfma_f32_16x16x32_bf16 v[48:51], a[72:75], a[8:11], v[48:51]
 s_xor_b32 s41, s41, 0x8000
 ds_read_b128 a[100:103], v2 offset:25600
 v_add_f32 v6, v68, v69
 v_mfma_f32_16x16x32_bf16 v[48:51], a[76:79], a[12:15], v[48:51]
 s_waitcnt lgkmcnt(4)
 v_exp_f32 v70, v38
 v_mfma_f32_16x16x32_bf16 v[48:51], a[80:83], a[16:19], v[48:51]
 ds_read_b128 a[104:107], v2 offset:26624
 v_add_f32 v6, v6, v70
 v_mfma_f32_16x16x32_bf16 v[48:51], a[84:87], a[20:23], v[48:51]
 s_waitcnt lgkmcnt(3)
 v_exp_f32 v71, v39
 v_mfma_f32_16x16x32_bf16 v[48:51], a[88:91], a[24:27], v[48:51]
 ds_read_b128 a[108:111], v2 offset:27648
 v_add_f32 v6, v6, v71
 v_mfma_f32_16x16x32_bf16 v[48:51], a[92:95], a[28:31], v[48:51]
 v_exp_f32 v72, v40
 v_mfma_f32_16x16x32_bf16 v[52:55], a[64:67], a[32:35], v[116:119]
 ds_read_b128 a[112:115], v2 offset:28672
 v_add_f32 v5, v5, v72
 v_mfma_f32_16x16x32_bf16 v[52:55], a[68:71], a[36:39], v[52:55]
 v_exp_f32 v73, v41
 v_mfma_f32_16x16x32_bf16 v[52:55], a[72:75], a[40:43], v[52:55]
 ds_read_b128 a[116:119], v2 offset:29696
 v_add_f32 v5, v5, v73
 v_mfma_f32_16x16x32_bf16 v[52:55], a[76:79], a[44:47], v[52:55]
 v_exp_f32 v74, v42
 v_mfma_f32_16x16x32_bf16 v[52:55], a[80:83], a[48:51], v[52:55]
 ds_read_b128 a[120:123], v2 offset:30720
 v_add_f32 v5, v5, v74
 v_mfma_f32_16x16x32_bf16 v[52:55], a[84:87], a[52:55], v[52:55]
 v_exp_f32 v75, v43
 v_mfma_f32_16x16x32_bf16 v[52:55], a[88:91], a[56:59], v[52:55]
 ds_read_b128 a[124:127], v2 offset:31744
 v_add_f32 v5, v5, v75
 v_mfma_f32_16x16x32_bf16 v[52:55], a[92:95], a[60:63], v[52:55]
 s_waitcnt lgkmcnt(6)
 v_exp_f32 v76, v44
 v_mfma_f32_16x16x32_bf16 v[56:59], a[96:99], a[0:3], v[120:123]
 v_exp_f32 v77, v45
 v_mfma_f32_16x16x32_bf16 v[56:59], a[100:103], a[4:7], v[56:59]
 s_waitcnt lgkmcnt(4)
 v_exp_f32 v78, v46
 v_mfma_f32_16x16x32_bf16 v[56:59], a[104:107], a[8:11], v[56:59]
 v_exp_f32 v79, v47
 v_mfma_f32_16x16x32_bf16 v[56:59], a[108:111], a[12:15], v[56:59]
 s_waitcnt lgkmcnt(2)
 v_exp_f32 v80, v48
 v_mfma_f32_16x16x32_bf16 v[56:59], a[112:115], a[16:19], v[56:59]
 v_exp_f32 v81, v49
 v_mfma_f32_16x16x32_bf16 v[56:59], a[116:119], a[20:23], v[56:59]
 s_waitcnt lgkmcnt(0)
 v_exp_f32 v82, v50
 v_mfma_f32_16x16x32_bf16 v[56:59], a[120:123], a[24:27], v[56:59]
 v_exp_f32 v83, v51
 v_mfma_f32_16x16x32_bf16 v[56:59], a[124:127], a[28:31], v[56:59]
 v_exp_f32 v84, v52
 v_mfma_f32_16x16x32_bf16 v[60:63], a[96:99], a[32:35], v[124:127]
 v_exp_f32 v85, v53
 v_mfma_f32_16x16x32_bf16 v[60:63], a[100:103], a[36:39], v[60:63]
 v_exp_f32 v86, v54
 v_mfma_f32_16x16x32_bf16 v[60:63], a[104:107], a[40:43], v[60:63]
 v_exp_f32 v87, v55
 v_mfma_f32_16x16x32_bf16 v[60:63], a[108:111], a[44:47], v[60:63]
 v_add_f32 v6, v6, v76
 v_mfma_f32_16x16x32_bf16 v[60:63], a[112:115], a[48:51], v[60:63]
 v_add_f32 v6, v6, v77
 v_mfma_f32_16x16x32_bf16 v[60:63], a[116:119], a[52:55], v[60:63]
 v_exp_f32 v88, v56
 v_mfma_f32_16x16x32_bf16 v[60:63], a[120:123], a[56:59], v[60:63]
 v_exp_f32 v89, v57
 v_mfma_f32_16x16x32_bf16 v[60:63], a[124:127], a[60:63], v[60:63]
 v_exp_f32 v90, v58
 v_xor_b32 v2, 0x8000, v2
 s_waitcnt vmcnt(8)
 s_barrier
 ds_read_b128 a[64:67], v2 offset:0
 ds_read_b128 a[68:71], v2 offset:1024
 ds_read_b128 a[72:75], v2 offset:2048
 ds_read_b128 a[76:79], v2 offset:3072
 ds_read_b128 a[80:83], v2 offset:4096
 ds_read_b128 a[84:87], v2 offset:5120
 ds_read_b128 a[88:91], v2 offset:6144
 ds_read_b128 a[92:95], v2 offset:7168
 buffer_store_dword v27, v27, s[12:15], s36 offen sc1
 v_exp_f32 v91, v59
 v_exp_f32 v92, v60
 v_exp_f32 v93, v61
 v_exp_f32 v94, v62
 v_exp_f32 v95, v63
 v_add_f32 v6, v6, v78
 v_add_f32 v6, v6, v79
 v_add_f32 v5, v5, v80
 v_add_f32 v5, v5, v81
 v_add_f32 v5, v5, v82
 v_add_f32 v5, v5, v83
 v_add_f32 v6, v6, v84
 v_add_f32 v6, v6, v85
 v_add_f32 v6, v6, v86
 v_add_f32 v6, v6, v87
 v_add_f32 v5, v5, v88
 v_add_f32 v5, v5, v89
 v_add_f32 v5, v5, v90
 v_add_f32 v5, v5, v91
 v_add_f32 v6, v6, v92
 v_add_f32 v6, v6, v93
 v_add_f32 v6, v6, v94
 v_add_f32 v6, v6, v95
L_first:
 v_add_f32 v11, v5, v6
 v_min_f32 v12, v5, v6
 v_cmp_nge_f32 vcc, s47, v11
 s_mov_b32 s46, 0xff800000
 s_cbranch_vccnz L_slow2
 v_cmp_gt_f32 vcc, 0x33800000, v12
 s_cbranch_vccnz L_rowchk
L_firstok:
 s_mov_b32 s46, 0
 s_waitcnt lgkmcnt(0)
 s_cmp_gt_u32 s44, s45
 s_cbranch_scc0 L_ret2
.p2align 6
L_loop:
 v_mfma_f32_16x16x32_bf16 v[32:35], a[64:67], a[0:3], v[96:99]
 s_mov_b32 m0, s40
 ds_read_b128 a[96:99], v2 offset:8192
 v_cvt_pk_bf16_f32 v16, v64, v65
 v_mfma_f32_16x16x32_bf16 v[32:35], a[68:71], a[4:7], v[32:35]
 s_waitcnt lgkmcnt(5)
 buffer_load_dwordx4 v13, s[8:11], s42 offen offset:0 sc1 lds
 v_mfma_f32_16x16x32_bf16 v[32:35], a[72:75], a[8:11], v[32:35]
 ds_read_b128 a[100:103], v2 offset:9216
 v_cvt_pk_bf16_f32 v17, v66, v67
 v_mfma_f32_16x16x32_bf16 v[32:35], a[76:79], a[12:15], v[32:35]
 s_waitcnt lgkmcnt(4)
 v_cvt_pk_bf16_f32 v20, v68, v69
 v_cvt_pk_bf16_f32 v21, v70, v71
 v_mfma_f32_16x16x32_bf16 v[32:35], a[80:83], a[16:19], v[32:35]
 s_add_u32 s39, s42, s76
 ds_read_b128 a[104:107], v2 offset:10240
 v_add_f32 v7, v7, v5
 v_mfma_f32_16x16x32_bf16 v[32:35], a[84:87], a[20:23], v[32:35]
 s_waitcnt lgkmcnt(3)
 v_add_f32 v8, v8, v6
 v_cvt_pk_bf16_f32 v18, v72, v73
 v_mfma_f32_16x16x32_bf16 v[32:35], a[88:91], a[24:27], v[32:35]
 ds_read_b128 a[108:111], v2 offset:11264
 v_cvt_pk_bf16_f32 v19, v74, v75
 v_mfma_f32_16x16x32_bf16 v[32:35], a[92:95], a[28:31], v[32:35]
 buffer_load_dwordx4 v13, s[8:11], s39 offen offset:1024 sc1 lds
 v_mfma_f32_16x16x32_bf16 v[36:39], a[64:67], a[32:35], v[100:103]
 ds_read_b128 a[112:115], v2 offset:12288
 v_cvt_pk_bf16_f32 v22, v76, v77
 v_mfma_f32_16x16x32_bf16 v[36:39], a[68:71], a[36:39], v[36:39]
 v_cvt_pk_bf16_f32 v23, v78, v79
 v_cvt_pk_bf16_f32 v24, v80, v81
 v_mfma_f32_16x16x32_bf16 v[36:39], a[72:75], a[40:43], v[36:39]
 s_add_u32 s39, s39, s76
 ds_read_b128 a[116:119], v2 offset:13312
 v_cvt_pk_bf16_f32 v25, v82, v83
 v_mfma_f32_16x16x32_bf16 v[36:39], a[76:79], a[44:47], v[36:39]
 v_cvt_pk_bf16_f32 v28, v84, v85
 v_cvt_pk_bf16_f32 v29, v86, v87
 v_mfma_f32_16x16x32_bf16 v[36:39], a[80:83], a[48:51], v[36:39]
 ds_read_b128 a[120:123], v2 offset:14336
 v_cvt_pk_bf16_f32 v26, v88, v89
 v_mfma_f32_16x16x32_bf16 v[36:39], a[84:87], a[52:55], v[36:39]
 buffer_load_dwordx4 v13, s[8:11], s39 offen offset:2048 sc1 lds
 v_mfma_f32_16x16x32_bf16 v[36:39], a[88:91], a[56:59], v[36:39]
 ds_read_b128 a[124:127], v2 offset:15360
 v_cvt_pk_bf16_f32 v27, v90, v91
 v_mfma_f32_16x16x32_bf16 v[36:39], a[92:95], a[60:63], v[36:39]
 s_waitcnt lgkmcnt(6)
 v_exp_f32 v64, v32
 v_mfma_f32_16x16x32_bf16 v[40:43], a[96:99], a[0:3], v[104:107]
 s_add_u32 s39, s39, s76
 ds_read_b128 a[64:67], v2 offset:16384
 v_cvt_pk_bf16_f32 v30, v92, v93
 v_mfma_f32_16x16x32_bf16 v[40:43], a[100:103], a[4:7], v[40:43]
 s_waitcnt lgkmcnt(5)
 v_exp_f32 v65, v33
 v_mfma_f32_16x16x32_bf16 v[40:43], a[104:107], a[8:11], v[40:43]
 ds_read_b128 a[68:71], v2 offset:17408
 v_cvt_pk_bf16_f32 v31, v94, v95
 v_mfma_f32_16x16x32_bf16 v[40:43], a[108:111], a[12:15], v[40:43]
 s_waitcnt lgkmcnt(4)
 buffer_load_dwordx4 v13, s[8:11], s39 offen offset:3072 sc1 lds
 v_mfma_f32_16x16x32_bf16 v[40:43], a[112:115], a[16:19], v[40:43]
 ds_read_b128 a[72:75], v2 offset:18432
 v_add_f32 v5, v64, v65
 v_mfma_f32_16x16x32_bf16 v[40:43], a[116:119], a[20:23], v[40:43]
 s_waitcnt lgkmcnt(3)
 v_exp_f32 v66, v34
 v_mfma_f32_16x16x32_bf16 v[40:43], a[120:123], a[24:27], v[40:43]
 s_add_u32 s39, s39, s77
 ds_read_b128 a[76:79], v2 offset:19456
 v_add_f32 v5, v5, v66
 v_mfma_f32_16x16x32_bf16 v[40:43], a[124:127], a[28:31], v[40:43]
 v_exp_f32 v67, v35
 v_mfma_f32_16x16x32_bf16 v[44:47], a[96:99], a[32:35], v[108:111]
 s_bitset1_b32 m0, 12
 ds_read_b128 a[80:83], v2 offset:20480
 v_add_f32 v5, v5, v67
 v_mfma_f32_16x16x32_bf16 v[44:47], a[100:103], a[36:39], v[44:47]
 buffer_load_dwordx4 v13, s[8:11], s39 offen offset:0 sc1 lds
 v_mfma_f32_16x16x32_bf16 v[44:47], a[104:107], a[40:43], v[44:47]
 ds_read_b128 a[84:87], v2 offset:21504
 v_mfma_f32_16x16x32_bf16 v[44:47], a[108:111], a[44:47], v[44:47]
 v_exp_f32 v68, v36
 v_mfma_f32_16x16x32_bf16 v[44:47], a[112:115], a[48:51], v[44:47]
 s_add_u32 s39, s39, s76
 ds_read_b128 a[88:91], v2 offset:22528
 v_mfma_f32_16x16x32_bf16 v[44:47], a[116:119], a[52:55], v[44:47]
 v_exp_f32 v69, v37
 v_mfma_f32_16x16x32_bf16 v[44:47], a[120:123], a[56:59], v[44:47]
 ds_read_b128 a[92:95], v2 offset:23552
 v_add_f32 v6, v68, v69
 v_mfma_f32_16x16x32_bf16 v[44:47], a[124:127], a[60:63], v[44:47]
 s_waitcnt lgkmcnt(6)
 buffer_load_dwordx4 v13, s[8:11], s39 offen offset:1024 sc1 lds
 v_mfma_f32_16x16x32_bf16 v[48:51], a[64:67], a[0:3], v[112:115]
 ds_read_b128 a[96:99], v2 offset:24576
 v_mfma_f32_16x16x32_bf16 v[48:51], a[68:71], a[4:7], v[48:51]
 s_waitcnt lgkmcnt(5)
 v_exp_f32 v70, v38
 v_mfma_f32_16x16x32_bf16 v[48:51], a[72:75], a[8:11], v[48:51]
 s_add_u32 s39, s39, s76
 ds_read_b128 a[100:103], v2 offset:25600
 v_add_f32 v6, v6, v70
 v_mfma_f32_16x16x32_bf16 v[48:51], a[76:79], a[12:15], v[48:51]
 s_waitcnt lgkmcnt(4)
 v_exp_f32 v71, v39
 v_mfma_f32_16x16x32_bf16 v[48:51], a[80:83], a[16:19], v[48:51]
 ds_read_b128 a[104:107], v2 offset:26624
 v_add_f32 v6, v6, v71
 v_mfma_f32_16x16x32_bf16 v[48:51], a[84:87], a[20:23], v[48:51]
 s_waitcnt lgkmcnt(3)
 buffer_load_dwordx4 v13, s[8:11], s39 offen offset:2048 sc1 lds
 v_mfma_f32_16x16x32_bf16 v[48:51], a[88:91], a[24:27], v[48:51]
 ds_read_b128 a[108:111], v2 offset:27648
 v_mfma_f32_16x16x32_bf16 v[48:51], a[92:95], a[28:31], v[48:51]
 v_exp_f32 v72, v40
 v_mfma_f32_16x16x32_bf16 v[52:55], a[64:67], a[32:35], v[116:119]
 s_add_u32 s39, s39, s76
 ds_read_b128 a[112:115], v2 offset:28672
 v_add_f32 v5, v5, v72
 v_mfma_f32_16x16x32_bf16 v[52:55], a[68:71], a[36:39], v[52:55]
 v_exp_f32 v73, v41
 v_mfma_f32_16x16x32_bf16 v[52:55], a[72:75], a[40:43], v[52:55]
 s_xor_b32 s40, s40, 0x8000
 ds_read_b128 a[116:119], v2 offset:29696
 v_add_f32 v5, v5, v73
 v_mfma_f32_16x16x32_bf16 v[52:55], a[76:79], a[44:47], v[52:55]
 buffer_load_dwordx4 v13, s[8:11], s39 offen offset:3072 sc1 lds
 v_mfma_f32_16x16x32_bf16 v[52:55], a[80:83], a[48:51], v[52:55]
 s_add_u32 s42, s42, s70
 ds_read_b128 a[120:123], v2 offset:30720
 v_mfma_f32_16x16x32_bf16 v[52:55], a[84:87], a[52:55], v[52:55]
 v_exp_f32 v74, v42
 v_mfma_f32_16x16x32_bf16 v[52:55], a[88:91], a[56:59], v[52:55]
 s_waitcnt vmcnt(8) lgkmcnt(5)
 ds_read_b128 a[124:127], v2 offset:31744
 v_add_f32 v5, v5, v74
 v_mfma_f32_16x16x32_bf16 v[52:55], a[92:95], a[60:63], v[52:55]
 s_barrier
 v_mfma_f32_16x16x32_bf16 v[56:59], a[96:99], a[0:3], v[120:123]
 s_mov_b32 m0, s41
 ds_read_b128 a[64:67], v3 offset:0
 v_xor_b32 v2, 0x8000, v2
 v_mfma_f32_16x16x32_bf16 v[56:59], a[100:103], a[4:7], v[56:59]
 s_waitcnt lgkmcnt(5)
 buffer_load_dwordx4 v1, s[12:15], s43 offen offset:0 sc1 lds
 v_mfma_f32_16x16x32_bf16 v[56:59], a[104:107], a[8:11], v[56:59]
 s_cmp_eq_u32 s42, s66
 ds_read_b128 a[68:71], v3 offset:16384
 v_mfma_f32_16x16x32_bf16 v[56:59], a[108:111], a[12:15], v[56:59]
 s_waitcnt lgkmcnt(4)
 v_exp_f32 v75, v43
 v_mfma_f32_16x16x32_bf16 v[56:59], a[112:115], a[16:19], v[56:59]
 s_cmov_b32 s42, s67
 ds_read_b128 a[72:75], v3 offset:1024
 v_add_f32 v5, v5, v75
 v_mfma_f32_16x16x32_bf16 v[56:59], a[116:119], a[20:23], v[56:59]
 s_waitcnt lgkmcnt(3)
 v_exp_f32 v76, v44
 v_mfma_f32_16x16x32_bf16 v[56:59], a[120:123], a[24:27], v[56:59]
 s_cmov_b32 s70, 32768
 ds_read_b128 a[76:79], v3 offset:17408
 v_add_f32 v6, v6, v76
 v_mfma_f32_16x16x32_bf16 v[56:59], a[124:127], a[28:31], v[56:59]
 buffer_load_dwordx4 v1, s[12:15], s43 offen offset:1024 sc1 lds
 v_mfma_f32_16x16x32_bf16 v[60:63], a[96:99], a[32:35], v[124:127]
 ds_read_b128 a[80:83], v3 offset:2048
 v_mfma_f32_16x16x32_bf16 v[60:63], a[100:103], a[36:39], v[60:63]
 v_exp_f32 v77, v45
 v_mfma_f32_16x16x32_bf16 v[60:63], a[104:107], a[40:43], v[60:63]
 ds_read_b128 a[84:87], v3 offset:18432
 v_add_f32 v6, v6, v77
 v_mfma_f32_16x16x32_bf16 v[60:63], a[108:111], a[44:47], v[60:63]
 v_exp_f32 v78, v46
 v_mfma_f32_16x16x32_bf16 v[60:63], a[112:115], a[48:51], v[60:63]
 ds_read_b128 a[88:91], v3 offset:3072
 v_add_f32 v6, v6, v78
 v_mfma_f32_16x16x32_bf16 v[60:63], a[116:119], a[52:55], v[60:63]
 buffer_load_dwordx4 v1, s[12:15], s43 offen offset:2048 sc1 lds
 v_mfma_f32_16x16x32_bf16 v[60:63], a[120:123], a[56:59], v[60:63]
 ds_read_b128 a[92:95], v3 offset:19456
 v_mfma_f32_16x16x32_bf16 v[60:63], a[124:127], a[60:63], v[60:63]
 s_waitcnt lgkmcnt(6)
 v_exp_f32 v79, v47
 v_mfma_f32_16x16x32_bf16 v[128:131], a[64:67], v[16:19], v[128:131]
 ds_read_b128 a[96:99], v3 offset:4096
 v_add_f32 v6, v6, v79
 v_mfma_f32_16x16x32_bf16 v[128:131], a[68:71], v[24:27], v[128:131]
 v_exp_f32 v80, v48
 v_mfma_f32_16x16x32_bf16 v[192:195], a[68:71], v[28:31], v[192:195]
 ds_read_b128 a[100:103], v3 offset:20480
 v_add_f32 v5, v5, v80
 v_mfma_f32_16x16x32_bf16 v[192:195], a[64:67], v[20:23], v[192:195]
 s_waitcnt lgkmcnt(6)
 buffer_load_dwordx4 v1, s[12:15], s43 offen offset:3072 sc1 lds
 v_mfma_f32_16x16x32_bf16 v[132:135], a[72:75], v[16:19], v[132:135]
 ds_read_b128 a[104:107], v3 offset:5120
 v_mfma_f32_16x16x32_bf16 v[132:135], a[76:79], v[24:27], v[132:135]
 v_exp_f32 v81, v49
 v_mfma_f32_16x16x32_bf16 v[196:199], a[76:79], v[28:31], v[196:199]
 ds_read_b128 a[108:111], v3 offset:21504
 v_add_f32 v5, v5, v81
 v_mfma_f32_16x16x32_bf16 v[196:199], a[72:75], v[20:23], v[196:199]
 s_waitcnt lgkmcnt(6)
 v_exp_f32 v82, v50
 v_mfma_f32_16x16x32_bf16 v[136:139], a[80:83], v[16:19], v[136:139]
 s_bitset1_b32 m0, 12
 ds_read_b128 a[112:115], v3 offset:6144
 v_add_f32 v5, v5, v82
 v_mfma_f32_16x16x32_bf16 v[136:139], a[84:87], v[24:27], v[136:139]
 buffer_load_dwordx4 v4, s[12:15], s43 offen offset:0 sc1 lds
 v_mfma_f32_16x16x32_bf16 v[200:203], a[84:87], v[28:31], v[200:203]
 ds_read_b128 a[116:119], v3 offset:22528
 v_mfma_f32_16x16x32_bf16 v[200:203], a[80:83], v[20:23], v[200:203]
 s_waitcnt lgkmcnt(6)
 v_exp_f32 v83, v51
 v_mfma_f32_16x16x32_bf16 v[140:143], a[88:91], v[16:19], v[140:143]
 ds_read_b128 a[120:123], v3 offset:7168
 v_add_f32 v5, v5, v83
 v_mfma_f32_16x16x32_bf16 v[140:143], a[92:95], v[24:27], v[140:143]
 v_exp_f32 v84, v52
 v_mfma_f32_16x16x32_bf16 v[204:207], a[92:95], v[28:31], v[204:207]
 ds_read_b128 a[124:127], v3 offset:23552
 v_add_f32 v6, v6, v84
 v_mfma_f32_16x16x32_bf16 v[204:207], a[88:91], v[20:23], v[204:207]
 s_waitcnt lgkmcnt(6)
 buffer_load_dwordx4 v4, s[12:15], s43 offen offset:1024 sc1 lds
 v_mfma_f32_16x16x32_bf16 v[144:147], a[96:99], v[16:19], v[144:147]
 ds_read_b128 a[64:67], v3 offset:8192
 v_mfma_f32_16x16x32_bf16 v[144:147], a[100:103], v[24:27], v[144:147]
 v_exp_f32 v85, v53
 v_mfma_f32_16x16x32_bf16 v[208:211], a[100:103], v[28:31], v[208:211]
 ds_read_b128 a[68:71], v3 offset:24576
 v_add_f32 v6, v6, v85
 v_mfma_f32_16x16x32_bf16 v[208:211], a[96:99], v[20:23], v[208:211]
 s_waitcnt lgkmcnt(6)
 v_exp_f32 v86, v54
 v_mfma_f32_16x16x32_bf16 v[148:151], a[104:107], v[16:19], v[148:151]
 ds_read_b128 a[72:75], v3 offset:9216
 v_add_f32 v6, v6, v86
 v_mfma_f32_16x16x32_bf16 v[148:151], a[108:111], v[24:27], v[148:151]
 buffer_load_dwordx4 v4, s[12:15], s43 offen offset:2048 sc1 lds
 v_mfma_f32_16x16x32_bf16 v[212:215], a[108:111], v[28:31], v[212:215]
 ds_read_b128 a[76:79], v3 offset:25600
 v_mfma_f32_16x16x32_bf16 v[212:215], a[104:107], v[20:23], v[212:215]
 s_waitcnt lgkmcnt(6)
 v_exp_f32 v87, v55
 v_mfma_f32_16x16x32_bf16 v[152:155], a[112:115], v[16:19], v[152:155]
 ds_read_b128 a[80:83], v3 offset:10240
 v_add_f32 v6, v6, v87
 v_mfma_f32_16x16x32_bf16 v[152:155], a[116:119], v[24:27], v[152:155]
 v_exp_f32 v88, v56
 v_mfma_f32_16x16x32_bf16 v[216:219], a[116:119], v[28:31], v[216:219]
 s_xor_b32 s41, s41, 0x8000
 ds_read_b128 a[84:87], v3 offset:26624
 v_add_f32 v5, v5, v88
 v_mfma_f32_16x16x32_bf16 v[216:219], a[112:115], v[20:23], v[216:219]
 s_waitcnt lgkmcnt(6)
 buffer_load_dwordx4 v4, s[12:15], s43 offen offset:3072 sc1 lds
 v_mfma_f32_16x16x32_bf16 v[156:159], a[120:123], v[16:19], v[156:159]
 s_add_u32 s43, s43, s71
 ds_read_b128 a[88:91], v3 offset:11264
 v_mfma_f32_16x16x32_bf16 v[156:159], a[124:127], v[24:27], v[156:159]
 v_exp_f32 v89, v57
 v_mfma_f32_16x16x32_bf16 v[220:223], a[124:127], v[28:31], v[220:223]
 s_cmp_eq_u32 s43, s68
 ds_read_b128 a[92:95], v3 offset:27648
 v_add_f32 v5, v5, v89
 v_mfma_f32_16x16x32_bf16 v[220:223], a[120:123], v[20:23], v[220:223]
 s_waitcnt lgkmcnt(6)
 v_exp_f32 v90, v58
 v_mfma_f32_16x16x32_bf16 v[160:163], a[64:67], v[16:19], v[160:163]
 s_cmov_b32 s43, s69
 ds_read_b128 a[96:99], v3 offset:12288
 v_add_f32 v5, v5, v90
 v_mfma_f32_16x16x32_bf16 v[160:163], a[68:71], v[24:27], v[160:163]
 s_cmov_b32 s71, 32768
 v_exp_f32 v91, v59
 v_mfma_f32_16x16x32_bf16 v[224:227], a[68:71], v[28:31], v[224:227]
 ds_read_b128 a[100:103], v3 offset:28672
 v_add_f32 v5, v5, v91
 v_mfma_f32_16x16x32_bf16 v[224:227], a[64:67], v[20:23], v[224:227]
 s_waitcnt lgkmcnt(6)
 v_exp_f32 v92, v60
 v_mfma_f32_16x16x32_bf16 v[164:167], a[72:75], v[16:19], v[164:167]
 ds_read_b128 a[104:107], v3 offset:13312
 v_add_f32 v6, v6, v92
 v_mfma_f32_16x16x32_bf16 v[164:167], a[76:79], v[24:27], v[164:167]
 v_exp_f32 v93, v61
 v_mfma_f32_16x16x32_bf16 v[228:231], a[76:79], v[28:31], v[228:231]
 ds_read_b128 a[108:111], v3 offset:29696
 v_add_f32 v6, v6, v93
 v_mfma_f32_16x16x32_bf16 v[228:231], a[72:75], v[20:23], v[228:231]
 s_waitcnt lgkmcnt(6)
 v_exp_f32 v94, v62
 v_mfma_f32_16x16x32_bf16 v[168:171], a[80:83], v[16:19], v[168:171]
 ds_read_b128 a[112:115], v3 offset:14336
 v_add_f32 v6, v6, v94
 v_mfma_f32_16x16x32_bf16 v[168:171], a[84:87], v[24:27], v[168:171]
 v_exp_f32 v95, v63
 v_mfma_f32_16x16x32_bf16 v[232:235], a[84:87], v[28:31], v[232:235]
 ds_read_b128 a[116:119], v3 offset:30720
 v_add_f32 v6, v6, v95
 v_mfma_f32_16x16x32_bf16 v[232:235], a[80:83], v[20:23], v[232:235]
 s_waitcnt lgkmcnt(6)
 v_add_f32 v11, v5, v6
 v_mfma_f32_16x16x32_bf16 v[172:175], a[88:91], v[16:19], v[172:175]
 ds_read_b128 a[120:123], v3 offset:15360
 v_cmp_nge_f32 vcc, s47, v11
 v_mfma_f32_16x16x32_bf16 v[172:175], a[92:95], v[24:27], v[172:175]
 buffer_load_dword a246, v15, s[12:15], s60 offen sc1
 v_mfma_f32_16x16x32_bf16 v[236:239], a[92:95], v[28:31], v[236:239]
 s_waitcnt vmcnt(9) lgkmcnt(5)
 ds_read_b128 a[124:127], v3 offset:31744
 v_mfma_f32_16x16x32_bf16 v[236:239], a[88:91], v[20:23], v[236:239]
 s_barrier
 v_mfma_f32_16x16x32_bf16 v[176:179], a[96:99], v[16:19], v[176:179]
 ds_read_b128 a[64:67], v2 offset:0
 v_xor_b32 v3, 0x8000, v3
 v_mfma_f32_16x16x32_bf16 v[176:179], a[100:103], v[24:27], v[176:179]
 v_mfma_f32_16x16x32_bf16 v[240:243], a[100:103], v[28:31], v[240:243]
 ds_read_b128 a[68:71], v2 offset:1024
 v_mfma_f32_16x16x32_bf16 v[240:243], a[96:99], v[20:23], v[240:243]
 s_waitcnt lgkmcnt(6)
 v_mfma_f32_16x16x32_bf16 v[180:183], a[104:107], v[16:19], v[180:183]
 ds_read_b128 a[72:75], v2 offset:2048
 v_mfma_f32_16x16x32_bf16 v[180:183], a[108:111], v[24:27], v[180:183]
 v_mfma_f32_16x16x32_bf16 v[244:247], a[108:111], v[28:31], v[244:247]
 ds_read_b128 a[76:79], v2 offset:3072
 v_mfma_f32_16x16x32_bf16 v[244:247], a[104:107], v[20:23], v[244:247]
 s_waitcnt lgkmcnt(6)
 v_mfma_f32_16x16x32_bf16 v[184:187], a[112:115], v[16:19], v[184:187]
 s_sub_u32 s44, s44, 1
 ds_read_b128 a[80:83], v2 offset:4096
 v_mfma_f32_16x16x32_bf16 v[184:187], a[116:119], v[24:27], v[184:187]
 v_mfma_f32_16x16x32_bf16 v[248:251], a[116:119], v[28:31], v[248:251]
 ds_read_b128 a[84:87], v2 offset:5120
 v_mfma_f32_16x16x32_bf16 v[248:251], a[112:115], v[20:23], v[248:251]
 s_waitcnt lgkmcnt(6)
 v_mfma_f32_16x16x32_bf16 v[188:191], a[120:123], v[16:19], v[188:191]
 s_cmp_gt_u32 s44, s45
 ds_read_b128 a[88:91], v2 offset:6144
 v_mfma_f32_16x16x32_bf16 v[188:191], a[124:127], v[24:27], v[188:191]
 s_cselect_b64 vcc, vcc, -1
 v_mfma_f32_16x16x32_bf16 v[252:255], a[124:127], v[28:31], v[252:255]
 s_waitcnt lgkmcnt(5)
 ds_read_b128 a[92:95], v2 offset:7168
 v_mfma_f32_16x16x32_bf16 v[252:255], a[120:123], v[20:23], v[252:255]
 s_cbranch_vccz L_loop
 v_cmp_nge_f32 vcc, s47, v11
 s_cbranch_vccnz L_slow
L_ret2:
 s_cmp_lg_u32 s44, 2
 s_cbranch_scc1 L_disp
 v_mfma_f32_16x16x32_bf16 v[36:39], a[64:67], a[32:35], v[100:103]
 s_mov_b32 m0, s40
 ds_read_b128 a[96:99], v2 offset:8192
 v_accvgpr_read_b32 v96, a224
 v_mfma_f32_16x16x32_bf16 v[36:39], a[68:71], a[36:39], v[36:39]
 s_waitcnt lgkmcnt(5)
 buffer_load_dwordx4 v1, s[12:15], s42 offen offset:0 sc1 lds
 v_mfma_f32_16x16x32_bf16 v[36:39], a[72:75], a[40:43], v[36:39]
 ds_read_b128 a[100:103], v2 offset:9216
 v_accvgpr_read_b32 v97, a225
 v_mfma_f32_16x16x32_bf16 v[36:39], a[76:79], a[44:47], v[36:39]
 s_waitcnt lgkmcnt(4)
 v_accvgpr_read_b32 v98, a226
 v_accvgpr_read_b32 v99, a227
 v_mfma_f32_16x16x32_bf16 v[36:39], a[80:83], a[48:51], v[36:39]
 ds_read_b128 a[104:107], v2 offset:10240
 v_cvt_pk_bf16_f32 v20, v68, v69
 v_mfma_f32_16x16x32_bf16 v[36:39], a[84:87], a[52:55], v[36:39]
 s_waitcnt lgkmcnt(3)
 v_cvt_pk_bf16_f32 v21, v70, v71
 v_cvt_pk_bf16_f32 v16, v64, v65
 v_mfma_f32_16x16x32_bf16 v[36:39], a[88:91], a[56:59], v[36:39]
 ds_read_b128 a[108:111], v2 offset:11264
 v_cvt_pk_bf16_f32 v17, v66, v67
 v_mfma_f32_16x16x32_bf16 v[36:39], a[92:95], a[60:63], v[36:39]
 buffer_load_dwordx4 v1, s[12:15], s42 offen offset:1024 sc1 lds
 v_mfma_f32_16x16x32_bf16 v[32:35], a[64:67], a[0:3], v[96:99]
 ds_read_b128 a[112:115], v2 offset:12288
 v_add_f32 v7, v7, v5
 v_mfma_f32_16x16x32_bf16 v[32:35], a[68:71], a[4:7], v[32:35]
 v_add_f32 v8, v8, v6
 v_accvgpr_read_b32 v104, a228
 v_mfma_f32_16x16x32_bf16 v[32:35], a[72:75], a[8:11], v[32:35]
 ds_read_b128 a[116:119], v2 offset:13312
 v_accvgpr_read_b32 v105, a229
 v_mfma_f32_16x16x32_bf16 v[32:35], a[76:79], a[12:15], v[32:35]
 v_accvgpr_read_b32 v106, a230
 v_accvgpr_read_b32 v107, a231
 v_mfma_f32_16x16x32_bf16 v[32:35], a[80:83], a[16:19], v[32:35]
 ds_read_b128 a[120:123], v2 offset:14336
 v_cvt_pk_bf16_f32 v22, v76, v77
 v_mfma_f32_16x16x32_bf16 v[32:35], a[84:87], a[20:23], v[32:35]
 buffer_load_dwordx4 v1, s[12:15], s42 offen offset:2048 sc1 lds
 v_mfma_f32_16x16x32_bf16 v[32:35], a[88:91], a[24:27], v[32:35]
 ds_read_b128 a[124:127], v2 offset:15360
 v_cvt_pk_bf16_f32 v23, v78, v79
 v_mfma_f32_16x16x32_bf16 v[32:35], a[92:95], a[28:31], v[32:35]
 s_waitcnt lgkmcnt(6)
 v_exp_f32 v68, v36
 v_mfma_f32_16x16x32_bf16 v[44:47], a[96:99], a[32:35], v[108:111]
 ds_read_b128 a[64:67], v2 offset:16384
 v_cvt_pk_bf16_f32 v18, v72, v73
 v_mfma_f32_16x16x32_bf16 v[44:47], a[100:103], a[36:39], v[44:47]
 s_waitcnt lgkmcnt(5)
 v_exp_f32 v69, v37
 v_mfma_f32_16x16x32_bf16 v[44:47], a[104:107], a[40:43], v[44:47]
 ds_read_b128 a[68:71], v2 offset:17408
 v_cvt_pk_bf16_f32 v19, v74, v75
 v_add_f32 v6, v68, v69
 v_mfma_f32_16x16x32_bf16 v[44:47], a[108:111], a[44:47], v[44:47]
 s_waitcnt lgkmcnt(4)
 buffer_load_dwordx4 v1, s[12:15], s42 offen offset:3072 sc1 lds
 v_mfma_f32_16x16x32_bf16 v[44:47], a[112:115], a[48:51], v[44:47]
 ds_read_b128 a[72:75], v2 offset:18432
 v_accvgpr_read_b32 v112, a232
 v_mfma_f32_16x16x32_bf16 v[44:47], a[116:119], a[52:55], v[44:47]
 s_waitcnt lgkmcnt(3)
 v_exp_f32 v70, v38
 v_mfma_f32_16x16x32_bf16 v[44:47], a[120:123], a[56:59], v[44:47]
 ds_read_b128 a[76:79], v2 offset:19456
 v_accvgpr_read_b32 v113, a233
 v_add_f32 v6, v6, v70
 v_mfma_f32_16x16x32_bf16 v[44:47], a[124:127], a[60:63], v[44:47]
 v_exp_f32 v71, v39
 v_mfma_f32_16x16x32_bf16 v[40:43], a[96:99], a[0:3], v[104:107]
 s_bitset1_b32 m0, 12
 ds_read_b128 a[80:83], v2 offset:20480
 v_accvgpr_read_b32 v114, a234
 v_add_f32 v6, v6, v71
 v_mfma_f32_16x16x32_bf16 v[40:43], a[100:103], a[4:7], v[40:43]
 buffer_load_dwordx4 v4, s[12:15], s42 offen offset:0 sc1 lds
 v_mfma_f32_16x16x32_bf16 v[40:43], a[104:107], a[8:11], v[40:43]
 ds_read_b128 a[84:87], v2 offset:21504
 v_accvgpr_read_b32 v115, a235
 v_mfma_f32_16x16x32_bf16 v[40:43], a[108:111], a[12:15], v[40:43]
 v_exp_f32 v64, v32
 v_mfma_f32_16x16x32_bf16 v[40:43], a[112:115], a[16:19], v[40:43]
 ds_read_b128 a[88:91], v2 offset:22528
 v_cvt_pk_bf16_f32 v28, v84, v85
 v_mfma_f32_16x16x32_bf16 v[40:43], a[116:119], a[20:23], v[40:43]
 v_exp_f32 v65, v33
 v_mfma_f32_16x16x32_bf16 v[40:43], a[120:123], a[24:27], v[40:43]
 ds_read_b128 a[92:95], v2 offset:23552
 v_cvt_pk_bf16_f32 v29, v86, v87
 v_add_f32 v5, v64, v65
 v_mfma_f32_16x16x32_bf16 v[40:43], a[124:127], a[28:31], v[40:43]
 s_waitcnt lgkmcnt(6)
 buffer_load_dwordx4 v4, s[12:15], s42 offen offset:1024 sc1 lds
 v_mfma_f32_16x16x32_bf16 v[52:55], a[64:67], a[32:35], v[116:119]
 ds_read_b128 a[96:99], v2 offset:24576
 v_cvt_pk_bf16_f32 v24, v80, v81
 v_mfma_f32_16x16x32_bf16 v[52:55], a[68:71], a[36:39], v[52:55]
 s_waitcnt lgkmcnt(5)
 v_exp_f32 v66, v34
 v_mfma_f32_16x16x32_bf16 v[52:55], a[72:75], a[40:43], v[52:55]
 ds_read_b128 a[100:103], v2 offset:25600
 v_cvt_pk_bf16_f32 v25, v82, v83
 v_add_f32 v5, v5, v66
 v_mfma_f32_16x16x32_bf16 v[52:55], a[76:79], a[44:47], v[52:55]
 s_waitcnt lgkmcnt(4)
 v_exp_f32 v67, v35
 v_mfma_f32_16x16x32_bf16 v[52:55], a[80:83], a[48:51], v[52:55]
 ds_read_b128 a[104:107], v2 offset:26624
 v_accvgpr_read_b32 v120, a236
 v_add_f32 v5, v5, v67
 v_mfma_f32_16x16x32_bf16 v[52:55], a[84:87], a[52:55], v[52:55]
 s_waitcnt lgkmcnt(3)
 buffer_load_dwordx4 v4, s[12:15], s42 offen offset:2048 sc1 lds
 v_mfma_f32_16x16x32_bf16 v[52:55], a[88:91], a[56:59], v[52:55]
 ds_read_b128 a[108:111], v2 offset:27648
 v_accvgpr_read_b32 v121, a237
 v_mfma_f32_16x16x32_bf16 v[52:55], a[92:95], a[60:63], v[52:55]
 v_exp_f32 v76, v44
 v_mfma_f32_16x16x32_bf16 v[48:51], a[64:67], a[0:3], v[112:115]
 ds_read_b128 a[112:115], v2 offset:28672
 v_accvgpr_read_b32 v122, a238
 v_add_f32 v6, v6, v76
 v_mfma_f32_16x16x32_bf16 v[48:51], a[68:71], a[4:7], v[48:51]
 v_exp_f32 v77, v45
 v_mfma_f32_16x16x32_bf16 v[48:51], a[72:75], a[8:11], v[48:51]
 ds_read_b128 a[116:119], v2 offset:29696
 v_accvgpr_read_b32 v123, a239
 v_add_f32 v6, v6, v77
 v_mfma_f32_16x16x32_bf16 v[48:51], a[76:79], a[12:15], v[48:51]
 buffer_load_dwordx4 v4, s[12:15], s42 offen offset:3072 sc1 lds
 v_mfma_f32_16x16x32_bf16 v[48:51], a[80:83], a[16:19], v[48:51]
 ds_read_b128 a[120:123], v2 offset:30720
 v_cvt_pk_bf16_f32 v30, v92, v93
 v_mfma_f32_16x16x32_bf16 v[48:51], a[84:87], a[20:23], v[48:51]
 v_exp_f32 v78, v46
 v_mfma_f32_16x16x32_bf16 v[48:51], a[88:91], a[24:27], v[48:51]
 s_waitcnt vmcnt(8)
 ds_read_b128 a[124:127], v2 offset:31744
 v_xor_b32 v2, 0x8000, v2
 v_add_f32 v6, v6, v78
 v_mfma_f32_16x16x32_bf16 v[48:51], a[92:95], a[28:31], v[48:51]
 s_waitcnt lgkmcnt(6)
 s_barrier
 v_exp_f32 v79, v47
 v_mfma_f32_16x16x32_bf16 v[60:63], a[96:99], a[32:35], v[124:127]
 s_mov_b32 m0, s41
 ds_read_b128 a[64:67], v3 offset:0
 v_accvgpr_read_b32 v12, a246
 v_add_f32 v6, v6, v79
 v_mfma_f32_16x16x32_bf16 v[60:63], a[100:103], a[36:39], v[60:63]
 s_waitcnt lgkmcnt(5)
 buffer_load_dwordx4 v1, s[12:15], s43 offen offset:0 sc1 lds
 v_mfma_f32_16x16x32_bf16 v[60:63], a[104:107], a[40:43], v[60:63]
 ds_read_b128 a[68:71], v3 offset:16384
 v_cmp_ne_u32 s[20:21], 0, v12
 v_mfma_f32_16x16x32_bf16 v[60:63], a[108:111], a[44:47], v[60:63]
 s_waitcnt lgkmcnt(4)
 v_exp_f32 v72, v40
 v_mfma_f32_16x16x32_bf16 v[60:63], a[112:115], a[48:51], v[60:63]
 s_cmp_eq_u64 s[20:21], 0
 ds_read_b128 a[72:75], v3 offset:1024
 v_cvt_pk_bf16_f32 v31, v94, v95
 v_add_f32 v5, v5, v72
 v_mfma_f32_16x16x32_bf16 v[60:63], a[116:119], a[52:55], v[60:63]
 s_waitcnt lgkmcnt(3)
 buffer_load_dwordx4 v1, s[12:15], s43 offen offset:1024 sc1 lds
 v_mfma_f32_16x16x32_bf16 v[60:63], a[120:123], a[56:59], v[60:63]
 s_cselect_b32 s51, 1, 0
 ds_read_b128 a[76:79], v3 offset:17408
 v_cvt_pk_bf16_f32 v26, v88, v89
 v_mfma_f32_16x16x32_bf16 v[60:63], a[124:127], a[60:63], v[60:63]
 s_cselect_b32 s55, s4, 2.0
 v_exp_f32 v73, v41
 v_mfma_f32_16x16x32_bf16 v[56:59], a[96:99], a[0:3], v[120:123]
 s_cselect_b32 s56, s5, 2.0
 ds_read_b128 a[80:83], v3 offset:2048
 v_cvt_pk_bf16_f32 v27, v90, v91
 v_mfma_f32_16x16x32_bf16 v[56:59], a[100:103], a[4:7], v[56:59]
 buffer_load_dwordx4 v1, s[12:15], s43 offen offset:2048 sc1 lds
 v_mfma_f32_16x16x32_bf16 v[56:59], a[104:107], a[8:11], v[56:59]
 s_cselect_b32 s57, s6, 2.0
 ds_read_b128 a[84:87], v3 offset:18432
 v_add_f32 v5, v5, v73
 v_mfma_f32_16x16x32_bf16 v[56:59], a[108:111], a[12:15], v[56:59]
 v_exp_f32 v74, v42
 v_mfma_f32_16x16x32_bf16 v[56:59], a[112:115], a[16:19], v[56:59]
 ds_read_b128 a[88:91], v3 offset:3072
 v_accvgpr_read_b32 v13, a244
 v_mfma_f32_16x16x32_bf16 v[56:59], a[116:119], a[20:23], v[56:59]
 buffer_load_dwordx4 v1, s[12:15], s43 offen offset:3072 sc1 lds
 v_mfma_f32_16x16x32_bf16 v[56:59], a[120:123], a[24:27], v[56:59]
 ds_read_b128 a[92:95], v3 offset:19456
 v_add_f32 v5, v5, v74
 v_mfma_f32_16x16x32_bf16 v[56:59], a[124:127], a[28:31], v[56:59]
 s_waitcnt lgkmcnt(6)
 v_exp_f32 v75, v43
 v_mfma_f32_16x16x32_bf16 v[128:131], a[64:67], v[16:19], v[128:131]
 s_bitset1_b32 m0, 12
 ds_read_b128 a[96:99], v3 offset:4096
 v_add_f32 v5, v5, v75
 v_mfma_f32_16x16x32_bf16 v[128:131], a[68:71], v[24:27], v[128:131]
 buffer_load_dwordx4 v4, s[12:15], s43 offen offset:0 sc1 lds
 v_mfma_f32_16x16x32_bf16 v[192:195], a[68:71], v[28:31], v[192:195]
 ds_read_b128 a[100:103], v3 offset:20480
 v_sub_f32 v12, v10, v9
 v_mfma_f32_16x16x32_bf16 v[192:195], a[64:67], v[20:23], v[192:195]
 s_waitcnt lgkmcnt(6)
 v_exp_f32 v84, v52
 v_add_f32 v127, v123, v12
 v_mfma_f32_16x16x32_bf16 v[132:135], a[72:75], v[16:19], v[132:135]
 ds_read_b128 a[104:107], v3 offset:5120
 v_add_f32 v6, v6, v84
 v_mfma_f32_16x16x32_bf16 v[132:135], a[76:79], v[24:27], v[132:135]
 buffer_load_dwordx4 v4, s[12:15], s43 offen offset:1024 sc1 lds
 v_mfma_f32_16x16x32_bf16 v[196:199], a[76:79], v[28:31], v[196:199]
 ds_read_b128 a[108:111], v3 offset:21504
 v_add_f32 v100, v96, v12
 v_mfma_f32_16x16x32_bf16 v[196:199], a[72:75], v[20:23], v[196:199]
 s_waitcnt lgkmcnt(6)
 v_exp_f32 v85, v53
 v_mfma_f32_16x16x32_bf16 v[136:139], a[80:83], v[16:19], v[136:139]
 ds_read_b128 a[112:115], v3 offset:6144
 v_add_f32 v6, v6, v85
 v_mfma_f32_16x16x32_bf16 v[136:139], a[84:87], v[24:27], v[136:139]
 buffer_load_dwordx4 v4, s[12:15], s43 offen offset:2048 sc1 lds
 v_mfma_f32_16x16x32_bf16 v[200:203], a[84:87], v[28:31], v[200:203]
 ds_read_b128 a[116:119], v3 offset:22528
 v_add_f32 v101, v97, v12
 v_mfma_f32_16x16x32_bf16 v[200:203], a[80:83], v[20:23], v[200:203]
 s_waitcnt lgkmcnt(6)
 v_exp_f32 v86, v54
 v_mfma_f32_16x16x32_bf16 v[140:143], a[88:91], v[16:19], v[140:143]
 ds_read_b128 a[120:123], v3 offset:7168
 v_add_f32 v6, v6, v86
 v_mfma_f32_16x16x32_bf16 v[140:143], a[92:95], v[24:27], v[140:143]
 buffer_load_dwordx4 v4, s[12:15], s43 offen offset:3072 sc1 lds
 v_mfma_f32_16x16x32_bf16 v[204:207], a[92:95], v[28:31], v[204:207]
 s_add_u32 s43, s43, 32768
 ds_read_b128 a[124:127], v3 offset:23552
 v_add_f32 v102, v98, v12
 v_mfma_f32_16x16x32_bf16 v[204:207], a[88:91], v[20:23], v[204:207]
 s_waitcnt lgkmcnt(6)
 v_exp_f32 v87, v55
 v_mfma_f32_16x16x32_bf16 v[144:147], a[96:99], v[16:19], v[144:147]
 s_xor_b32 s41, s41, 0x8000
 ds_read_b128 a[64:67], v3 offset:8192
 v_add_f32 v6, v6, v87
 v_mfma_f32_16x16x32_bf16 v[144:147], a[100:103], v[24:27], v[144:147]
 buffer_load_dwordx4 a[192:195], v1, s[12:15], s57 offen sc1
 v_mfma_f32_16x16x32_bf16 v[208:211], a[100:103], v[28:31], v[208:211]
 s_xor_b32 s40, s40, 0x8000
 ds_read_b128 a[68:71], v3 offset:24576
 v_add_f32 v103, v99, v12
 v_mfma_f32_16x16x32_bf16 v[208:211], a[96:99], v[20:23], v[208:211]
 s_waitcnt lgkmcnt(6)
 v_exp_f32 v80, v48
 v_mfma_f32_16x16x32_bf16 v[148:151], a[104:107], v[16:19], v[148:151]
 s_add_u32 s52, s50, 131072
 ds_read_b128 a[72:75], v3 offset:9216
 v_add_f32 v5, v5, v80
 v_mfma_f32_16x16x32_bf16 v[148:151], a[108:111], v[24:27], v[148:151]
 buffer_load_dwordx4 a[128:131], v1, s[12:15], s55 offen offset:0 sc1
 v_mfma_f32_16x16x32_bf16 v[212:215], a[108:111], v[28:31], v[212:215]
 s_mul_i32 s58, s3, 50176
 ds_read_b128 a[76:79], v3 offset:25600
 v_add_f32 v108, v104, v12
 v_mfma_f32_16x16x32_bf16 v[212:215], a[104:107], v[20:23], v[212:215]
 s_waitcnt lgkmcnt(6)
 v_exp_f32 v81, v49
 v_mfma_f32_16x16x32_bf16 v[152:155], a[112:115], v[16:19], v[152:155]
 s_sub_u32 s58, 128, s58
 ds_read_b128 a[80:83], v3 offset:10240
 v_add_f32 v5, v5, v81
 v_mfma_f32_16x16x32_bf16 v[152:155], a[116:119], v[24:27], v[152:155]
 buffer_load_dwordx4 a[132:135], v1, s[12:15], s55 offen offset:1024 sc1
 v_mfma_f32_16x16x32_bf16 v[216:219], a[116:119], v[28:31], v[216:219]
 s_cmp_eq_u32 s7, 0
 ds_read_b128 a[84:87], v3 offset:26624
 v_add_f32 v109, v105, v12
 v_mfma_f32_16x16x32_bf16 v[216:219], a[112:115], v[20:23], v[216:219]
 s_waitcnt lgkmcnt(6)
 v_exp_f32 v82, v50
 v_mfma_f32_16x16x32_bf16 v[156:159], a[120:123], v[16:19], v[156:159]
 s_cselect_b32 s42, s78, s49
 ds_read_b128 a[88:91], v3 offset:11264
 v_add_f32 v5, v5, v82
 v_mfma_f32_16x16x32_bf16 v[156:159], a[124:127], v[24:27], v[156:159]
 buffer_load_dwordx4 a[136:139], v1, s[12:15], s55 offen offset:2048 sc1
 v_mfma_f32_16x16x32_bf16 v[220:223], a[124:127], v[28:31], v[220:223]
 s_cmov_b32 s40, s52
 ds_read_b128 a[92:95], v3 offset:27648
 v_add_f32 v110, v106, v12
 v_mfma_f32_16x16x32_bf16 v[220:223], a[120:123], v[20:23], v[220:223]
 s_waitcnt lgkmcnt(6)
 v_exp_f32 v83, v51
 v_mfma_f32_16x16x32_bf16 v[160:163], a[64:67], v[16:19], v[160:163]
 s_cmov_b64 s[8:9], s[86:87]
 ds_read_b128 a[96:99], v3 offset:12288
 v_add_f32 v5, v5, v83
 v_mfma_f32_16x16x32_bf16 v[160:163], a[68:71], v[24:27], v[160:163]
 buffer_load_dwordx4 a[140:143], v1, s[12:15], s55 offen offset:3072 sc1
 v_mfma_f32_16x16x32_bf16 v[224:227], a[68:71], v[28:31], v[224:227]
 s_cmov_b32 s10, 3670016
 ds_read_b128 a[100:103], v3 offset:28672
 v_add_f32 v111, v107, v12
 v_mfma_f32_16x16x32_bf16 v[224:227], a[64:67], v[20:23], v[224:227]
 s_waitcnt lgkmcnt(6)
 v_exp_f32 v92, v60
 v_mfma_f32_16x16x32_bf16 v[164:167], a[72:75], v[16:19], v[164:167]
 s_cmov_b32 s76, 6144
 ds_read_b128 a[104:107], v3 offset:13312
 v_add_f32 v6, v6, v92
 v_mfma_f32_16x16x32_bf16 v[164:167], a[76:79], v[24:27], v[164:167]
 buffer_load_dwordx4 a[144:147], v4, s[12:15], s55 offen offset:0 sc1
 v_mfma_f32_16x16x32_bf16 v[228:231], a[76:79], v[28:31], v[228:231]
 s_cmov_b32 s77, 10240
 ds_read_b128 a[108:111], v3 offset:29696
 v_add_f32 v116, v112, v12
 v_mfma_f32_16x16x32_bf16 v[228:231], a[72:75], v[20:23], v[228:231]
 s_waitcnt lgkmcnt(6)
 v_exp_f32 v93, v61
 v_mfma_f32_16x16x32_bf16 v[168:171], a[80:83], v[16:19], v[168:171]
 s_mov_b32 s44, 1
 ds_read_b128 a[112:115], v3 offset:14336
 v_add_f32 v6, v6, v93
 v_mfma_f32_16x16x32_bf16 v[168:171], a[84:87], v[24:27], v[168:171]
 buffer_load_dwordx4 a[148:151], v4, s[12:15], s55 offen offset:1024 sc1
 v_mfma_f32_16x16x32_bf16 v[232:235], a[84:87], v[28:31], v[232:235]
 s_cmp_eq_u32 s51, 1
 ds_read_b128 a[116:119], v3 offset:30720
 v_add_f32 v117, v113, v12
 v_mfma_f32_16x16x32_bf16 v[232:235], a[80:83], v[20:23], v[232:235]
 s_waitcnt lgkmcnt(6)
 v_exp_f32 v94, v62
 v_mfma_f32_16x16x32_bf16 v[172:175], a[88:91], v[16:19], v[172:175]
 ds_read_b128 a[120:123], v3 offset:15360
 v_add_f32 v6, v6, v94
 v_mfma_f32_16x16x32_bf16 v[172:175], a[92:95], v[24:27], v[172:175]
 buffer_load_dwordx4 a[152:155], v4, s[12:15], s55 offen offset:2048 sc1
 v_mfma_f32_16x16x32_bf16 v[236:239], a[92:95], v[28:31], v[236:239]
 s_waitcnt vmcnt(16)
 ds_read_b128 a[124:127], v3 offset:31744
 v_xor_b32 v3, 0x8000, v3
 v_mfma_f32_16x16x32_bf16 v[236:239], a[88:91], v[20:23], v[236:239]
 s_waitcnt lgkmcnt(6)
 s_barrier
 v_exp_f32 v95, v63
 v_mfma_f32_16x16x32_bf16 v[176:179], a[96:99], v[16:19], v[176:179]
 ds_read_b128 a[64:67], v2 offset:0
 v_add_f32 v6, v6, v95
 v_mfma_f32_16x16x32_bf16 v[176:179], a[100:103], v[24:27], v[176:179]
 buffer_load_dwordx4 a[156:159], v4, s[12:15], s55 offen offset:3072 sc1
 v_mfma_f32_16x16x32_bf16 v[240:243], a[100:103], v[28:31], v[240:243]
 s_waitcnt vmcnt(9)
 ds_read_b128 a[68:71], v2 offset:1024
 v_add_f32 v118, v114, v12
 v_mfma_f32_16x16x32_bf16 v[240:243], a[96:99], v[20:23], v[240:243]
 s_waitcnt lgkmcnt(6)
 s_barrier
 v_exp_f32 v88, v56
 v_mfma_f32_16x16x32_bf16 v[180:183], a[104:107], v[16:19], v[180:183]
 ds_read_b128 a[72:75], v2 offset:2048
 v_exp_f32 v89, v57
 v_add_f32 v5, v5, v88
 v_mfma_f32_16x16x32_bf16 v[180:183], a[108:111], v[24:27], v[180:183]
 ds_read_b128 a[96:99], v3 offset:0
 v_exp_f32 v90, v58
 v_add_f32 v5, v5, v89
 v_mfma_f32_16x16x32_bf16 v[244:247], a[108:111], v[28:31], v[244:247]
 ds_read_b128 a[76:79], v2 offset:3072
 v_exp_f32 v91, v59
 v_mfma_f32_16x16x32_bf16 v[244:247], a[104:107], v[20:23], v[244:247]
 s_waitcnt lgkmcnt(7)
 ds_read_b128 a[100:103], v3 offset:16384
 v_add_f32 v5, v5, v90
 v_mfma_f32_16x16x32_bf16 v[184:187], a[112:115], v[16:19], v[184:187]
 ds_read_b128 a[80:83], v2 offset:4096
 v_add_f32 v5, v5, v91
 v_mfma_f32_16x16x32_bf16 v[184:187], a[116:119], v[24:27], v[184:187]
 ds_read_b128 a[104:107], v3 offset:1024
 v_add_f32 v11, v5, v6
 v_mfma_f32_16x16x32_bf16 v[248:251], a[116:119], v[28:31], v[248:251]
 ds_read_b128 a[84:87], v2 offset:5120
 v_cmp_nge_f32 vcc, s47, v11
 v_mfma_f32_16x16x32_bf16 v[248:251], a[112:115], v[20:23], v[248:251]
 s_waitcnt lgkmcnt(9)
 ds_read_b128 a[108:111], v3 offset:17408
 v_add_f32 v119, v115, v12
 v_mfma_f32_16x16x32_bf16 v[188:191], a[120:123], v[16:19], v[188:191]
 s_cselect_b64 vcc, vcc, -1
 ds_read_b128 a[88:91], v2 offset:6144
 v_add_f32 v124, v120, v12
 v_mfma_f32_16x16x32_bf16 v[188:191], a[124:127], v[24:27], v[188:191]
 ds_read_b128 a[112:115], v3 offset:2048
 v_add_f32 v125, v121, v12
 v_mfma_f32_16x16x32_bf16 v[252:255], a[124:127], v[28:31], v[252:255]
 ds_read_b128 a[92:95], v2 offset:7168
 v_add_f32 v126, v122, v12
 v_mfma_f32_16x16x32_bf16 v[252:255], a[120:123], v[20:23], v[252:255]
 s_waitcnt lgkmcnt(11)
 ds_read_b128 a[116:119], v3 offset:18432
 s_cbranch_vccnz L_g0x
L_p1:
 v_mfma_f32_16x16x32_bf16 v[36:39], a[64:67], a[32:35], v[100:103]
 s_mov_b32 m0, s40
 ds_read_b128 a[120:123], v3 offset:3072
 v_cvt_pk_bf16_f32 v16, v64, v65
 v_cvt_pk_bf16_f32 v24, v80, v81
 v_mfma_f32_16x16x32_bf16 v[36:39], a[68:71], a[36:39], v[36:39]
 s_waitcnt lgkmcnt(10)
 ds_read_b128 a[124:127], v3 offset:19456
 buffer_load_dwordx4 v13, s[8:11], s42 offen offset:0 sc1 lds
 v_mfma_f32_16x16x32_bf16 v[36:39], a[72:75], a[40:43], v[36:39]
 s_add_u32 s39, s42, s76
 ds_read_b128 a[64:67], v2 offset:8192
 v_cvt_pk_bf16_f32 v17, v66, v67
 v_cvt_pk_bf16_f32 v25, v82, v83
 v_mfma_f32_16x16x32_bf16 v[36:39], a[76:79], a[44:47], v[36:39]
 s_waitcnt lgkmcnt(8)
 ds_read_b128 a[68:71], v2 offset:9216
 v_cvt_pk_bf16_f32 v18, v72, v73
 v_cvt_pk_bf16_f32 v26, v88, v89
 v_mfma_f32_16x16x32_bf16 v[36:39], a[80:83], a[48:51], v[36:39]
 buffer_load_dwordx4 v13, s[8:11], s39 offen offset:1024 sc1 lds
 v_mfma_f32_16x16x32_bf16 v[36:39], a[84:87], a[52:55], v[36:39]
 s_waitcnt lgkmcnt(5)
 ds_read_b128 a[72:75], v2 offset:10240
 v_cvt_pk_bf16_f32 v19, v74, v75
 v_cvt_pk_bf16_f32 v27, v90, v91
 v_mfma_f32_16x16x32_bf16 v[36:39], a[88:91], a[56:59], v[36:39]
 ds_read_b128 a[76:79], v2 offset:11264
 v_cvt_pk_bf16_f32 v20, v68, v69
 v_mfma_f32_16x16x32_bf16 v[36:39], a[92:95], a[60:63], v[36:39]
 s_add_u32 s39, s39, s76
 v_cvt_pk_bf16_f32 v21, v70, v71
 v_cvt_pk_bf16_f32 v22, v76, v77
 v_mfma_f32_16x16x32_bf16 v[128:131], a[96:99], v[16:19], v[128:131]
 ds_read_b128 a[80:83], v2 offset:12288
 buffer_load_dwordx4 v13, s[8:11], s39 offen offset:2048 sc1 lds
 v_mfma_f32_16x16x32_bf16 v[128:131], a[100:103], v[24:27], v[128:131]
 ds_read_b128 a[84:87], v2 offset:13312
 v_cvt_pk_bf16_f32 v23, v78, v79
 v_mfma_f32_16x16x32_bf16 v[132:135], a[104:107], v[16:19], v[132:135]
 v_cvt_pk_bf16_f32 v28, v84, v85
 v_cvt_pk_bf16_f32 v29, v86, v87
 v_mfma_f32_16x16x32_bf16 v[132:135], a[108:111], v[24:27], v[132:135]
 s_add_u32 s39, s39, s76
 ds_read_b128 a[88:91], v2 offset:14336
 v_cvt_pk_bf16_f32 v30, v92, v93
 v_mfma_f32_16x16x32_bf16 v[136:139], a[112:115], v[16:19], v[136:139]
 s_waitcnt lgkmcnt(8)
 ds_read_b128 a[92:95], v2 offset:15360
 v_cvt_pk_bf16_f32 v31, v94, v95
 v_mfma_f32_16x16x32_bf16 v[136:139], a[116:119], v[24:27], v[136:139]
 buffer_load_dwordx4 v13, s[8:11], s39 offen offset:3072 sc1 lds
 v_mfma_f32_16x16x32_bf16 v[140:143], a[120:123], v[16:19], v[140:143]
 s_waitcnt lgkmcnt(8)
 v_add_f32 v7, v7, v5
 v_add_f32 v8, v8, v6
 v_mfma_f32_16x16x32_bf16 v[140:143], a[124:127], v[24:27], v[140:143]
 s_bitset1_b32 m0, 12
 v_exp_f32 v68, v36
 v_mfma_f32_16x16x32_bf16 v[192:195], a[96:99], v[20:23], v[192:195]
 s_add_u32 s39, s39, s77
 ds_read_b128 a[96:99], v3 offset:4096
 v_mfma_f32_16x16x32_bf16 v[192:195], a[100:103], v[28:31], v[192:195]
 ds_read_b128 a[100:103], v3 offset:20480
 buffer_load_dwordx4 v13, s[8:11], s39 offen offset:0 sc1 lds
 v_mfma_f32_16x16x32_bf16 v[196:199], a[104:107], v[20:23], v[196:199]
 s_add_u32 s39, s39, s76
 v_exp_f32 v69, v37
 v_mfma_f32_16x16x32_bf16 v[196:199], a[108:111], v[28:31], v[196:199]
 ds_read_b128 a[104:107], v3 offset:5120
 buffer_load_dwordx4 v13, s[8:11], s39 offen offset:1024 sc1 lds
 v_mfma_f32_16x16x32_bf16 v[200:203], a[112:115], v[20:23], v[200:203]
 ds_read_b128 a[108:111], v3 offset:21504
 v_add_f32 v6, v68, v69
 v_mfma_f32_16x16x32_bf16 v[200:203], a[116:119], v[28:31], v[200:203]
 v_exp_f32 v70, v38
 v_mfma_f32_16x16x32_bf16 v[204:207], a[120:123], v[20:23], v[204:207]
 s_add_u32 s39, s39, s76
 ds_read_b128 a[112:115], v3 offset:6144
 v_add_f32 v6, v6, v70
 v_mfma_f32_16x16x32_bf16 v[204:207], a[124:127], v[28:31], v[204:207]
 s_waitcnt lgkmcnt(11)
 ds_read_b128 a[116:119], v3 offset:22528
 v_exp_f32 v71, v39
 v_mfma_f32_16x16x32_bf16 v[44:47], a[64:67], a[32:35], v[108:111]
 buffer_load_dwordx4 v13, s[8:11], s39 offen offset:2048 sc1 lds
 v_mfma_f32_16x16x32_bf16 v[44:47], a[68:71], a[36:39], v[44:47]
 s_waitcnt lgkmcnt(10)
 ds_read_b128 a[120:123], v3 offset:7168
 v_add_f32 v6, v6, v71
 v_mfma_f32_16x16x32_bf16 v[44:47], a[72:75], a[40:43], v[44:47]
 s_barrier
 ds_read_b128 a[124:127], v3 offset:23552
 v_mfma_f32_16x16x32_bf16 v[44:47], a[76:79], a[44:47], v[44:47]
 s_waitcnt lgkmcnt(10)
 v_mfma_f32_16x16x32_bf16 v[44:47], a[80:83], a[48:51], v[44:47]
 s_add_u32 s39, s39, s76
 ds_read_b128 a[64:67], v2 offset:16384
 v_mfma_f32_16x16x32_bf16 v[44:47], a[84:87], a[52:55], v[44:47]
 s_waitcnt lgkmcnt(9)
 ds_read_b128 a[68:71], v2 offset:17408
 buffer_load_dwordx4 v13, s[8:11], s39 offen offset:3072 sc1 lds
 v_mfma_f32_16x16x32_bf16 v[44:47], a[88:91], a[56:59], v[44:47]
 v_mfma_f32_16x16x32_bf16 v[44:47], a[92:95], a[60:63], v[44:47]
 s_waitcnt lgkmcnt(8)
 ds_read_b128 a[72:75], v2 offset:18432
 buffer_load_dwordx4 a[0:3], v1, s[12:15], s56 offen offset:0 sc1
 v_mfma_f32_16x16x32_bf16 v[144:147], a[96:99], v[16:19], v[144:147]
 ds_read_b128 a[76:79], v2 offset:19456
 v_mfma_f32_16x16x32_bf16 v[144:147], a[100:103], v[24:27], v[144:147]
 v_mfma_f32_16x16x32_bf16 v[208:211], a[100:103], v[28:31], v[208:211]
 ds_read_b128 a[80:83], v2 offset:20480
 buffer_load_dwordx4 a[4:7], v1, s[12:15], s56 offen offset:1024 sc1
 v_mfma_f32_16x16x32_bf16 v[208:211], a[96:99], v[20:23], v[208:211]
 s_waitcnt lgkmcnt(9)
 ds_read_b128 a[84:87], v2 offset:21504
 v_mfma_f32_16x16x32_bf16 v[148:151], a[104:107], v[16:19], v[148:151]
 v_exp_f32 v76, v44
 v_mfma_f32_16x16x32_bf16 v[148:151], a[108:111], v[24:27], v[148:151]
 ds_read_b128 a[88:91], v2 offset:22528
 v_add_f32 v6, v6, v76
 v_mfma_f32_16x16x32_bf16 v[212:215], a[108:111], v[28:31], v[212:215]
 ds_read_b128 a[92:95], v2 offset:23552
 v_exp_f32 v77, v45
 v_mfma_f32_16x16x32_bf16 v[212:215], a[104:107], v[20:23], v[212:215]
 s_waitcnt lgkmcnt(10)
 buffer_load_dwordx4 a[8:11], v1, s[12:15], s56 offen offset:2048 sc1
 v_mfma_f32_16x16x32_bf16 v[152:155], a[112:115], v[16:19], v[152:155]
 ds_read_b128 a[96:99], v3 offset:8192
 v_add_f32 v6, v6, v77
 v_mfma_f32_16x16x32_bf16 v[152:155], a[116:119], v[24:27], v[152:155]
 ds_read_b128 a[100:103], v3 offset:24576
 v_exp_f32 v78, v46
 v_mfma_f32_16x16x32_bf16 v[216:219], a[116:119], v[28:31], v[216:219]
 buffer_load_dwordx4 a[12:15], v1, s[12:15], s56 offen offset:3072 sc1
 v_mfma_f32_16x16x32_bf16 v[216:219], a[112:115], v[20:23], v[216:219]
 s_waitcnt lgkmcnt(10)
 ds_read_b128 a[104:107], v3 offset:9216
 v_add_f32 v6, v6, v78
 v_mfma_f32_16x16x32_bf16 v[156:159], a[120:123], v[16:19], v[156:159]
 ds_read_b128 a[108:111], v3 offset:25600
 v_exp_f32 v79, v47
 v_mfma_f32_16x16x32_bf16 v[156:159], a[124:127], v[24:27], v[156:159]
 buffer_load_dwordx4 a[16:19], v4, s[12:15], s56 offen offset:0 sc1
 v_mfma_f32_16x16x32_bf16 v[220:223], a[124:127], v[28:31], v[220:223]
 ds_read_b128 a[112:115], v3 offset:10240
 v_add_f32 v6, v6, v79
 v_mfma_f32_16x16x32_bf16 v[220:223], a[120:123], v[20:23], v[220:223]
 s_waitcnt lgkmcnt(11)
 ds_read_b128 a[116:119], v3 offset:26624
 v_mfma_f32_16x16x32_bf16 v[52:55], a[64:67], a[32:35], v[116:119]
 v_mfma_f32_16x16x32_bf16 v[52:55], a[68:71], a[36:39], v[52:55]
 s_waitcnt lgkmcnt(10)
 ds_read_b128 a[120:123], v3 offset:11264
 buffer_load_dwordx4 a[20:23], v4, s[12:15], s56 offen offset:1024 sc1
 v_mfma_f32_16x16x32_bf16 v[52:55], a[72:75], a[40:43], v[52:55]
 ds_read_b128 a[124:127], v3 offset:27648
 v_mfma_f32_16x16x32_bf16 v[52:55], a[76:79], a[44:47], v[52:55]
 s_waitcnt lgkmcnt(10)
 v_mfma_f32_16x16x32_bf16 v[52:55], a[80:83], a[48:51], v[52:55]
 ds_read_b128 a[64:67], v2 offset:24576
 buffer_load_dwordx4 a[24:27], v4, s[12:15], s56 offen offset:2048 sc1
 v_mfma_f32_16x16x32_bf16 v[52:55], a[84:87], a[52:55], v[52:55]
 s_waitcnt lgkmcnt(9)
 ds_read_b128 a[68:71], v2 offset:25600
 v_mfma_f32_16x16x32_bf16 v[52:55], a[88:91], a[56:59], v[52:55]
 v_mfma_f32_16x16x32_bf16 v[52:55], a[92:95], a[60:63], v[52:55]
 s_waitcnt lgkmcnt(8)
 ds_read_b128 a[72:75], v2 offset:26624
 v_mfma_f32_16x16x32_bf16 v[160:163], a[96:99], v[16:19], v[160:163]
 ds_read_b128 a[76:79], v2 offset:27648
 v_mfma_f32_16x16x32_bf16 v[160:163], a[100:103], v[24:27], v[160:163]
 buffer_load_dwordx4 a[28:31], v4, s[12:15], s56 offen offset:3072 sc1
 v_mfma_f32_16x16x32_bf16 v[224:227], a[100:103], v[28:31], v[224:227]
 s_mov_b32 m0, s41
 ds_read_b128 a[80:83], v2 offset:28672
 v_mfma_f32_16x16x32_bf16 v[224:227], a[96:99], v[20:23], v[224:227]
 s_waitcnt lgkmcnt(9)
 ds_read_b128 a[84:87], v2 offset:29696
 v_mfma_f32_16x16x32_bf16 v[164:167], a[104:107], v[16:19], v[164:167]
 buffer_load_dwordx4 v1, s[12:15], s43 offen offset:0 sc1 lds
 v_mfma_f32_16x16x32_bf16 v[164:167], a[108:111], v[24:27], v[164:167]
 ds_read_b128 a[88:91], v2 offset:30720
 v_exp_f32 v84, v52
 v_mfma_f32_16x16x32_bf16 v[228:231], a[108:111], v[28:31], v[228:231]
 ds_read_b128 a[92:95], v2 offset:31744
 v_xor_b32 v2, 0x8000, v2
 v_add_f32 v6, v6, v84
 v_mfma_f32_16x16x32_bf16 v[228:231], a[104:107], v[20:23], v[228:231]
 s_waitcnt lgkmcnt(10)
 buffer_load_dwordx4 v1, s[12:15], s43 offen offset:1024 sc1 lds
 v_mfma_f32_16x16x32_bf16 v[168:171], a[112:115], v[16:19], v[168:171]
 ds_read_b128 a[96:99], v3 offset:12288
 v_exp_f32 v85, v53
 v_mfma_f32_16x16x32_bf16 v[168:171], a[116:119], v[24:27], v[168:171]
 ds_read_b128 a[100:103], v3 offset:28672
 v_add_f32 v6, v6, v85
 v_mfma_f32_16x16x32_bf16 v[232:235], a[116:119], v[28:31], v[232:235]
 v_exp_f32 v86, v54
 v_mfma_f32_16x16x32_bf16 v[232:235], a[112:115], v[20:23], v[232:235]
 s_waitcnt lgkmcnt(10)
 ds_read_b128 a[104:107], v3 offset:13312
 buffer_load_dwordx4 v1, s[12:15], s43 offen offset:2048 sc1 lds
 v_mfma_f32_16x16x32_bf16 v[172:175], a[120:123], v[16:19], v[172:175]
 ds_read_b128 a[108:111], v3 offset:29696
 v_add_f32 v6, v6, v86
 v_mfma_f32_16x16x32_bf16 v[172:175], a[124:127], v[24:27], v[172:175]
 v_exp_f32 v87, v55
 v_mfma_f32_16x16x32_bf16 v[236:239], a[124:127], v[28:31], v[236:239]
 s_mov_b32 s44, 0
 ds_read_b128 a[112:115], v3 offset:14336
 v_add_f32 v6, v6, v87
 v_mfma_f32_16x16x32_bf16 v[236:239], a[120:123], v[20:23], v[236:239]
 s_waitcnt lgkmcnt(11)
 ds_read_b128 a[116:119], v3 offset:30720
 v_mfma_f32_16x16x32_bf16 v[60:63], a[64:67], a[32:35], v[124:127]
 buffer_load_dwordx4 v1, s[12:15], s43 offen offset:3072 sc1 lds
 v_mfma_f32_16x16x32_bf16 v[60:63], a[68:71], a[36:39], v[60:63]
 s_waitcnt lgkmcnt(10)
 ds_read_b128 a[120:123], v3 offset:15360
 v_mfma_f32_16x16x32_bf16 v[60:63], a[72:75], a[40:43], v[60:63]
 s_bitset1_b32 m0, 12
 ds_read_b128 a[124:127], v3 offset:31744
 v_xor_b32 v3, 0x8000, v3
 v_mfma_f32_16x16x32_bf16 v[60:63], a[76:79], a[44:47], v[60:63]
 s_waitcnt lgkmcnt(10)
 buffer_load_dwordx4 v4, s[12:15], s43 offen offset:0 sc1 lds
 v_mfma_f32_16x16x32_bf16 v[60:63], a[80:83], a[48:51], v[60:63]
 v_mfma_f32_16x16x32_bf16 v[60:63], a[84:87], a[52:55], v[60:63]
 s_waitcnt lgkmcnt(8)
 v_mfma_f32_16x16x32_bf16 v[60:63], a[88:91], a[56:59], v[60:63]
 buffer_load_dwordx4 v4, s[12:15], s43 offen offset:1024 sc1 lds
 v_mfma_f32_16x16x32_bf16 v[60:63], a[92:95], a[60:63], v[60:63]
 s_waitcnt lgkmcnt(6)
 v_mfma_f32_16x16x32_bf16 v[176:179], a[96:99], v[16:19], v[176:179]
 s_waitcnt vmcnt(14)
 v_mfma_f32_16x16x32_bf16 v[176:179], a[100:103], v[24:27], v[176:179]
 s_barrier
 v_mfma_f32_16x16x32_bf16 v[240:243], a[100:103], v[28:31], v[240:243]
 ds_read_b128 a[64:67], v2 offset:0
 buffer_load_dwordx4 v4, s[12:15], s43 offen offset:2048 sc1 lds
 v_mfma_f32_16x16x32_bf16 v[240:243], a[96:99], v[20:23], v[240:243]
 s_waitcnt lgkmcnt(5)
 ds_read_b128 a[68:71], v2 offset:1024
 v_mfma_f32_16x16x32_bf16 v[180:183], a[104:107], v[16:19], v[180:183]
 v_exp_f32 v92, v60
 v_mfma_f32_16x16x32_bf16 v[180:183], a[108:111], v[24:27], v[180:183]
 ds_read_b128 a[72:75], v2 offset:2048
 v_add_f32 v6, v6, v92
 v_mfma_f32_16x16x32_bf16 v[244:247], a[108:111], v[28:31], v[244:247]
 ds_read_b128 a[76:79], v2 offset:3072
 v_exp_f32 v93, v61
 v_mfma_f32_16x16x32_bf16 v[244:247], a[104:107], v[20:23], v[244:247]
 s_waitcnt lgkmcnt(6)
 buffer_load_dwordx4 v4, s[12:15], s43 offen offset:3072 sc1 lds
 v_mfma_f32_16x16x32_bf16 v[184:187], a[112:115], v[16:19], v[184:187]
 ds_read_b128 a[80:83], v2 offset:4096
 v_add_f32 v6, v6, v93
 v_exp_f32 v94, v62
 v_mfma_f32_16x16x32_bf16 v[184:187], a[116:119], v[24:27], v[184:187]
 v_add_f32 v6, v6, v94
 v_exp_f32 v95, v63
 v_mfma_f32_16x16x32_bf16 v[248:251], a[116:119], v[28:31], v[248:251]
 ds_read_b128 a[84:87], v2 offset:5120
 v_add_f32 v6, v6, v95
 v_mfma_f32_16x16x32_bf16 v[248:251], a[112:115], v[20:23], v[248:251]
 s_waitcnt lgkmcnt(6)
 ds_read_b128 a[88:91], v2 offset:6144
 v_cmp_nge_f32 vcc, s47, v6
 v_mfma_f32_16x16x32_bf16 v[188:191], a[120:123], v[16:19], v[188:191]
 v_mfma_f32_16x16x32_bf16 v[188:191], a[124:127], v[24:27], v[188:191]
 ds_read_b128 a[92:95], v2 offset:7168
 v_mfma_f32_16x16x32_bf16 v[252:255], a[124:127], v[28:31], v[252:255]
 v_mfma_f32_16x16x32_bf16 v[252:255], a[120:123], v[20:23], v[252:255]
 s_cbranch_vccnz L_slow
L_p2:
 s_cmp_lg_u32 s7, 0
 s_cbranch_scc1 L_switch
 v_and_b32 v11, 31, v0
 v_lshlrev_b32 v11, 2, v11
 buffer_load_dword a247, v11, s[12:15], s61 offen sc1
 v_accvgpr_read_b32 v32, a192
 v_accvgpr_read_b32 v33, a193
 v_accvgpr_read_b32 v34, a194
 v_accvgpr_read_b32 v35, a195
 v_add_u32 v2, s58, v13
 v_cmp_neq_f32 vcc, v34, v9
 v_cmp_neq_f32 s[20:21], v35, v10
 s_or_b64 vcc, vcc, s[20:21]
 s_cmp_eq_u32 s51, 1
 s_cselect_b64 vcc, vcc, -1
 s_cmp_eq_u32 s38, 0
 s_cselect_b64 vcc, 0, vcc
 s_cbranch_vccnz L_fagen
 v_mfma_f32_16x16x32_bf16 v[128:131], a[250:253], a[128:131], v[128:131]
 v_cvt_pk_bf16_f32 v20, v68, v69
 v_cvt_pk_bf16_f32 v21, v70, v71
 v_mfma_f32_16x16x32_bf16 v[132:135], a[248:251], a[128:131], v[132:135]
 v_cvt_pk_bf16_f32 v22, v76, v77
 v_cvt_pk_bf16_f32 v23, v78, v79
 v_mfma_f32_16x16x32_bf16 v[136:139], a[250:253], a[132:135], v[136:139]
 v_cvt_pk_bf16_f32 v28, v84, v85
 v_cvt_pk_bf16_f32 v29, v86, v87
 v_mfma_f32_16x16x32_bf16 v[140:143], a[248:251], a[132:135], v[140:143]
 v_cvt_pk_bf16_f32 v30, v92, v93
 v_cvt_pk_bf16_f32 v31, v94, v95
 v_mfma_f32_16x16x32_bf16 v[144:147], a[250:253], a[136:139], v[144:147]
 s_waitcnt vmcnt(0)
 v_add_f32 v8, v8, v6
 v_accvgpr_read_b32 v44, a254
 v_mfma_f32_16x16x32_bf16 v[148:151], a[248:251], a[136:139], v[148:151]
 s_barrier
 ds_read_b128 a[64:67], v3 offset:0
 v_mfma_f32_16x16x32_bf16 v[152:155], a[250:253], a[140:143], v[152:155]
 s_add_u32 m0, s29, 0
 ds_read_b128 a[68:71], v3 offset:16384
 v_mov_b32 v40, v7
 v_mfma_f32_16x16x32_bf16 v[156:159], a[248:251], a[140:143], v[156:159]
 buffer_load_dwordx4 v2, s[8:11], s78 offen lds
 v_mfma_f32_16x16x32_bf16 v[160:163], a[250:253], a[144:147], v[160:163]
 ds_read_b128 a[72:75], v3 offset:1024
 v_mov_b32 v41, v8
 v_mfma_f32_16x16x32_bf16 v[164:167], a[248:251], a[144:147], v[164:167]
 ds_read_b128 a[76:79], v3 offset:17408
 v_cvt_pk_bf16_f32 v128, v128, v129
 v_mfma_f32_16x16x32_bf16 v[168:171], a[250:253], a[148:151], v[168:171]
 s_add_u32 m0, s29, 4096
 v_permlane32_swap_b32 v7, v40
 v_permlane32_swap_b32 v8, v41
 v_mfma_f32_16x16x32_bf16 v[172:175], a[248:251], a[148:151], v[172:175]
 ds_read_b128 a[80:83], v3 offset:2048
 buffer_load_dwordx4 v2, s[8:11], s79 offen lds
 v_mfma_f32_16x16x32_bf16 v[176:179], a[250:253], a[152:155], v[176:179]
 ds_read_b128 a[84:87], v3 offset:18432
 v_add_f32 v7, v7, v40
 v_mfma_f32_16x16x32_bf16 v[180:183], a[248:251], a[152:155], v[180:183]
 v_add_f32 v8, v8, v41
 v_cvt_pk_bf16_f32 v129, v130, v131
 v_mfma_f32_16x16x32_bf16 v[184:187], a[250:253], a[156:159], v[184:187]
 s_add_u32 m0, s29, 8192
 ds_read_b128 a[88:91], v3 offset:3072
 v_cvt_pk_bf16_f32 v130, v132, v133
 v_mfma_f32_16x16x32_bf16 v[188:191], a[248:251], a[156:159], v[188:191]
 s_waitcnt lgkmcnt(5)
 ds_read_b128 a[92:95], v3 offset:19456
 v_mov_b32 v40, v7
 v_mfma_f32_16x16x32_bf16 v[192:195], a[64:67], v[20:23], v[192:195]
 s_waitcnt vmcnt(10)
 buffer_load_dwordx4 v2, s[8:11], s80 offen lds
 v_mfma_f32_16x16x32_bf16 v[192:195], a[68:71], v[28:31], v[192:195]
 ds_read_b128 a[96:99], v3 offset:4096
 v_mov_b32 v41, v8
 v_mfma_f32_16x16x32_bf16 v[192:195], a[250:253], a[0:3], v[192:195]
 s_waitcnt lgkmcnt(5)
 ds_read_b128 a[100:103], v3 offset:20480
 v_cvt_pk_bf16_f32 v131, v134, v135
 v_mfma_f32_16x16x32_bf16 v[196:199], a[72:75], v[20:23], v[196:199]
 s_add_u32 m0, s29, 12288
 v_permlane16_swap_b32 v7, v40
 v_permlane16_swap_b32 v8, v41
 v_mfma_f32_16x16x32_bf16 v[196:199], a[76:79], v[28:31], v[196:199]
 ds_read_b128 a[104:107], v3 offset:5120
 buffer_load_dwordx4 v2, s[8:11], s81 offen lds
 v_mfma_f32_16x16x32_bf16 v[196:199], a[248:251], a[0:3], v[196:199]
 s_waitcnt lgkmcnt(5)
 ds_read_b128 a[108:111], v3 offset:21504
 v_add_f32 v7, v7, v40
 v_mfma_f32_16x16x32_bf16 v[200:203], a[80:83], v[20:23], v[200:203]
 v_add_f32 v8, v8, v41
 v_cvt_pk_bf16_f32 v136, v136, v137
 v_mfma_f32_16x16x32_bf16 v[200:203], a[84:87], v[28:31], v[200:203]
 s_add_u32 m0, s29, 16384
 ds_read_b128 a[112:115], v3 offset:6144
 v_cvt_pk_bf16_f32 v137, v138, v139
 v_mfma_f32_16x16x32_bf16 v[200:203], a[250:253], a[4:7], v[200:203]
 s_waitcnt lgkmcnt(5)
 ds_read_b128 a[116:119], v3 offset:22528
 v_add_f32 v7, v7, v32
 v_mfma_f32_16x16x32_bf16 v[204:207], a[88:91], v[20:23], v[204:207]
 buffer_load_dwordx4 v2, s[8:11], s82 offen lds
 v_mfma_f32_16x16x32_bf16 v[204:207], a[92:95], v[28:31], v[204:207]
 ds_read_b128 a[120:123], v3 offset:7168
 v_add_f32 v8, v8, v33
 v_mfma_f32_16x16x32_bf16 v[204:207], a[248:251], a[4:7], v[204:207]
 s_waitcnt lgkmcnt(5)
 ds_read_b128 a[124:127], v3 offset:23552
 v_cvt_pk_bf16_f32 v138, v140, v141
 v_mfma_f32_16x16x32_bf16 v[208:211], a[96:99], v[20:23], v[208:211]
 s_add_u32 m0, s29, 20480
 v_cvt_pk_bf16_f32 v139, v142, v143
 v_cvt_pk_bf16_f32 v144, v144, v145
 v_mfma_f32_16x16x32_bf16 v[208:211], a[100:103], v[28:31], v[208:211]
 ds_read_b128 a[64:67], v3 offset:8192
 buffer_load_dwordx4 v2, s[8:11], s83 offen lds
 v_mfma_f32_16x16x32_bf16 v[208:211], a[250:253], a[8:11], v[208:211]
 s_waitcnt lgkmcnt(5)
 ds_read_b128 a[68:71], v3 offset:24576
 v_cvt_pk_bf16_f32 v145, v146, v147
 v_mfma_f32_16x16x32_bf16 v[212:215], a[104:107], v[20:23], v[212:215]
 v_cvt_pk_bf16_f32 v146, v148, v149
 v_cvt_pk_bf16_f32 v147, v150, v151
 v_mfma_f32_16x16x32_bf16 v[212:215], a[108:111], v[28:31], v[212:215]
 s_add_u32 m0, s29, 24576
 ds_read_b128 a[72:75], v3 offset:9216
 v_cvt_pk_bf16_f32 v152, v152, v153
 v_mfma_f32_16x16x32_bf16 v[212:215], a[248:251], a[8:11], v[212:215]
 s_waitcnt lgkmcnt(5)
 ds_read_b128 a[76:79], v3 offset:25600
 v_cvt_pk_bf16_f32 v153, v154, v155
 v_mfma_f32_16x16x32_bf16 v[216:219], a[112:115], v[20:23], v[216:219]
 buffer_load_dwordx4 v2, s[8:11], s84 offen lds
 v_mfma_f32_16x16x32_bf16 v[216:219], a[116:119], v[28:31], v[216:219]
 ds_read_b128 a[80:83], v3 offset:10240
 v_cvt_pk_bf16_f32 v154, v156, v157
 v_mfma_f32_16x16x32_bf16 v[216:219], a[250:253], a[12:15], v[216:219]
 s_waitcnt lgkmcnt(5)
 ds_read_b128 a[84:87], v3 offset:26624
 v_cvt_pk_bf16_f32 v155, v158, v159
 v_mfma_f32_16x16x32_bf16 v[220:223], a[120:123], v[20:23], v[220:223]
 s_add_u32 m0, s29, 28672
 v_cvt_pk_bf16_f32 v160, v160, v161
 v_cvt_pk_bf16_f32 v161, v162, v163
 v_mfma_f32_16x16x32_bf16 v[220:223], a[124:127], v[28:31], v[220:223]
 ds_read_b128 a[88:91], v3 offset:11264
 buffer_load_dwordx4 v2, s[8:11], s85 offen lds
 v_mfma_f32_16x16x32_bf16 v[220:223], a[248:251], a[12:15], v[220:223]
 s_waitcnt lgkmcnt(5)
 ds_read_b128 a[92:95], v3 offset:27648
 v_add_u32 v2, 128, v2
 v_mfma_f32_16x16x32_bf16 v[224:227], a[64:67], v[20:23], v[224:227]
 v_cvt_pk_bf16_f32 v162, v164, v165
 v_cvt_pk_bf16_f32 v163, v166, v167
 v_mfma_f32_16x16x32_bf16 v[224:227], a[68:71], v[28:31], v[224:227]
 ds_read_b128 a[96:99], v3 offset:12288
 v_cvt_pk_bf16_f32 v168, v168, v169
 v_mfma_f32_16x16x32_bf16 v[224:227], a[250:253], a[16:19], v[224:227]
 s_waitcnt lgkmcnt(5)
 ds_read_b128 a[100:103], v3 offset:28672
 v_cvt_pk_bf16_f32 v169, v170, v171
 v_mfma_f32_16x16x32_bf16 v[228:231], a[72:75], v[20:23], v[228:231]
 v_cvt_pk_bf16_f32 v170, v172, v173
 v_cvt_pk_bf16_f32 v171, v174, v175
 v_mfma_f32_16x16x32_bf16 v[228:231], a[76:79], v[28:31], v[228:231]
 ds_read_b128 a[104:107], v3 offset:13312
 v_cvt_pk_bf16_f32 v176, v176, v177
 v_mfma_f32_16x16x32_bf16 v[228:231], a[248:251], a[16:19], v[228:231]
 s_waitcnt lgkmcnt(5)
 ds_read_b128 a[108:111], v3 offset:29696
 v_cvt_pk_bf16_f32 v177, v178, v179
 v_mfma_f32_16x16x32_bf16 v[232:235], a[80:83], v[20:23], v[232:235]
 v_cvt_pk_bf16_f32 v178, v180, v181
 v_cvt_pk_bf16_f32 v179, v182, v183
 v_mfma_f32_16x16x32_bf16 v[232:235], a[84:87], v[28:31], v[232:235]
 ds_read_b128 a[112:115], v3 offset:14336
 v_cvt_pk_bf16_f32 v184, v184, v185
 v_mfma_f32_16x16x32_bf16 v[232:235], a[250:253], a[20:23], v[232:235]
 s_waitcnt lgkmcnt(5)
 ds_read_b128 a[116:119], v3 offset:30720
 v_cvt_pk_bf16_f32 v185, v186, v187
 v_mfma_f32_16x16x32_bf16 v[236:239], a[88:91], v[20:23], v[236:239]
 v_cvt_pk_bf16_f32 v186, v188, v189
 v_cvt_pk_bf16_f32 v187, v190, v191
 v_mfma_f32_16x16x32_bf16 v[236:239], a[92:95], v[28:31], v[236:239]
 ds_read_b128 a[120:123], v3 offset:15360
 v_cvt_pk_bf16_f32 v192, v192, v193
 v_mfma_f32_16x16x32_bf16 v[236:239], a[248:251], a[20:23], v[236:239]
 s_waitcnt lgkmcnt(5)
 ds_read_b128 a[124:127], v3 offset:31744
 v_cvt_pk_bf16_f32 v193, v194, v195
 v_mfma_f32_16x16x32_bf16 v[240:243], a[96:99], v[20:23], v[240:243]
 v_cvt_pk_bf16_f32 v194, v196, v197
 v_cvt_pk_bf16_f32 v195, v198, v199
 v_mfma_f32_16x16x32_bf16 v[240:243], a[100:103], v[28:31], v[240:243]
 v_cvt_pk_bf16_f32 v200, v200, v201
 v_cvt_pk_bf16_f32 v201, v202, v203
 v_mfma_f32_16x16x32_bf16 v[240:243], a[250:253], a[24:27], v[240:243]
 s_waitcnt lgkmcnt(4)
 v_cvt_pk_bf16_f32 v202, v204, v205
 v_cvt_pk_bf16_f32 v203, v206, v207
 v_mfma_f32_16x16x32_bf16 v[244:247], a[104:107], v[20:23], v[244:247]
 v_cvt_pk_bf16_f32 v208, v208, v209
 v_cvt_pk_bf16_f32 v209, v210, v211
 v_mfma_f32_16x16x32_bf16 v[244:247], a[108:111], v[28:31], v[244:247]
 v_cvt_pk_bf16_f32 v210, v212, v213
 v_cvt_pk_bf16_f32 v211, v214, v215
 v_mfma_f32_16x16x32_bf16 v[244:247], a[248:251], a[24:27], v[244:247]
 s_waitcnt lgkmcnt(2)
 v_cvt_pk_bf16_f32 v216, v216, v217
 v_cvt_pk_bf16_f32 v217, v218, v219
 v_mfma_f32_16x16x32_bf16 v[248:251], a[112:115], v[20:23], v[248:251]
 v_cvt_pk_bf16_f32 v218, v220, v221
 v_cvt_pk_bf16_f32 v219, v222, v223
 v_mfma_f32_16x16x32_bf16 v[248:251], a[116:119], v[28:31], v[248:251]
 v_cvt_pk_bf16_f32 v224, v224, v225
 v_cvt_pk_bf16_f32 v225, v226, v227
 v_mfma_f32_16x16x32_bf16 v[248:251], a[250:253], a[28:31], v[248:251]
 s_waitcnt lgkmcnt(0)
 v_cvt_pk_bf16_f32 v226, v228, v229
 v_cvt_pk_bf16_f32 v227, v230, v231
 v_mfma_f32_16x16x32_bf16 v[252:255], a[120:123], v[20:23], v[252:255]
 v_cvt_pk_bf16_f32 v232, v232, v233
 v_cvt_pk_bf16_f32 v233, v234, v235
 v_mfma_f32_16x16x32_bf16 v[252:255], a[124:127], v[28:31], v[252:255]
 v_cvt_pk_bf16_f32 v234, v236, v237
 v_cvt_pk_bf16_f32 v235, v238, v239
 v_mfma_f32_16x16x32_bf16 v[252:255], a[248:251], a[28:31], v[252:255]
 v_cvt_pk_bf16_f32 v240, v240, v241
 v_cvt_pk_bf16_f32 v241, v242, v243
 ds_read_b64_tr_b16 a[160:161], v44 offset:0
 ds_read_b64_tr_b16 a[162:163], v44 offset:2048
 ds_read_b64_tr_b16 a[164:165], v44 offset:4096
 ds_read_b64_tr_b16 a[166:167], v44 offset:6144
 ds_read_b64_tr_b16 a[168:169], v44 offset:8192
 ds_read_b64_tr_b16 a[170:171], v44 offset:10240
 ds_read_b64_tr_b16 a[172:173], v44 offset:12288
 ds_read_b64_tr_b16 a[174:175], v44 offset:14336
 ds_read_b64_tr_b16 a[176:177], v44 offset:16384
 ds_read_b64_tr_b16 a[178:179], v44 offset:18432
 ds_read_b64_tr_b16 a[180:181], v44 offset:20480
 ds_read_b64_tr_b16 a[182:183], v44 offset:22528
 ds_read_b64_tr_b16 a[184:185], v44 offset:24576
 ds_read_b64_tr_b16 a[186:187], v44 offset:26624
 s_nop 1
 v_rcp_f32 v64, v7
 v_rcp_f32 v65, v8
 v_cvt_pk_bf16_f32 v242, v244, v245
 v_cvt_pk_bf16_f32 v243, v246, v247
 v_cvt_pk_bf16_f32 v248, v248, v249
 v_cvt_pk_bf16_f32 v249, v250, v251
 v_cvt_pk_bf16_f32 v250, v252, v253
 v_cvt_pk_bf16_f32 v251, v254, v255
 s_cmp_lg_u32 s27, 0
 s_cbranch_scc1 L_op1in
 s_waitcnt vmcnt(0) lgkmcnt(0)
 s_mov_b32 s59, 2.0
 s_cmp_eq_u32 s62, 0
 s_cbranch_scc1 L_t1park
 v_accvgpr_read_b32 v12, a247
 v_cmp_ne_u32 vcc, 0, v12
 s_cbranch_vccz L_poll1_ok
 v_and_b32 v11, 31, v0
 v_lshlrev_b32 v11, 2, v11
 s_mov_b32 s32, 0
L_poll1:
 buffer_load_dword v12, v11, s[12:15], s61 offen sc1
 s_waitcnt vmcnt(0)
 v_cmp_ne_u32 vcc, 0, v12
 s_cbranch_vccz L_poll1_ok
 s_sleep 6
 s_add_u32 s32, s32, 1
 s_cmp_lt_u32 s32, 0x80000
 s_cbranch_scc1 L_poll1
L_poll1_ok:
 s_branch L_t1park
L_kvlate:
 v_cmp_gt_u32 vcc, 256, v5
 v_mov_b32 v29, 0
 s_mov_b32 s32, 0
 s_cbranch_vccz L_armed
L_pollA:
 global_load_dword v28, v29, s[90:91] offset:128 sc1
 s_add_u32 s32, s32, 1
 s_waitcnt vmcnt(0)
 v_cmp_gt_u32 vcc, 256, v28
 s_cmp_lt_u32 s32, 0x80000
 s_cselect_b64 vcc, vcc, 0
 s_cbranch_vccnz L_pollA
L_armed:
 v_and_b32 v28, 11, v0
 v_lshlrev_b32 v28, 2, v28
 s_mov_b32 s32, 0
L_poll0:
 buffer_load_dword v29, v28, s[12:15], s58 offen sc1
 s_waitcnt vmcnt(0)
 v_cmp_ne_u32 vcc, 0, v29
 s_cbranch_vccz L_poll0_ok
 s_sleep 6
 s_add_u32 s32, s32, 1
 s_cmp_lt_u32 s32, 0x80000
 s_cbranch_scc1 L_poll0
L_poll0_ok:
 s_mov_b32 m0, s40
 s_nop 0
 buffer_load_dwordx4 v1, s[12:15], s42 offen offset:0 sc1 lds
 buffer_load_dwordx4 v1, s[12:15], s42 offen offset:1024 sc1 lds
 buffer_load_dwordx4 v1, s[12:15], s42 offen offset:2048 sc1 lds
 buffer_load_dwordx4 v1, s[12:15], s42 offen offset:3072 sc1 lds
 s_bitset1_b32 m0, 12
 s_nop 0
 buffer_load_dwordx4 v4, s[12:15], s42 offen offset:0 sc1 lds
 buffer_load_dwordx4 v4, s[12:15], s42 offen offset:1024 sc1 lds
 buffer_load_dwordx4 v4, s[12:15], s42 offen offset:2048 sc1 lds
 buffer_load_dwordx4 v4, s[12:15], s42 offen offset:3072 sc1 lds
 s_add_u32 s42, s42, s70
 s_xor_b32 s40, s40, 0x8000
 s_mov_b32 m0, s40
 s_nop 0
 buffer_load_dwordx4 v1, s[12:15], s42 offen offset:0 sc1 lds
 buffer_load_dwordx4 v1, s[12:15], s42 offen offset:1024 sc1 lds
 buffer_load_dwordx4 v1, s[12:15], s42 offen offset:2048 sc1 lds
 buffer_load_dwordx4 v1, s[12:15], s42 offen offset:3072 sc1 lds
 s_bitset1_b32 m0, 12
 s_nop 0
 buffer_load_dwordx4 v4, s[12:15], s42 offen offset:0 sc1 lds
 buffer_load_dwordx4 v4, s[12:15], s42 offen offset:1024 sc1 lds
 buffer_load_dwordx4 v4, s[12:15], s42 offen offset:2048 sc1 lds
 buffer_load_dwordx4 v4, s[12:15], s42 offen offset:3072 sc1 lds
 s_add_u32 s42, s42, s70
 s_xor_b32 s40, s40, 0x8000
 s_branch L_kvok
L_rowchk:
 v_mov_b32 v16, v5
 v_mov_b32 v17, v6
 v_mov_b32 v18, v16
 v_mov_b32 v19, v17
 s_nop 0
 v_permlane32_swap_b32 v16, v18
 v_permlane32_swap_b32 v17, v19
 s_nop 0
 v_add_f32 v16, v16, v18
 v_add_f32 v17, v17, v19
 v_mov_b32 v18, v16
 v_mov_b32 v19, v17
 s_nop 0
 v_permlane16_swap_b32 v16, v18
 v_permlane16_swap_b32 v17, v19
 s_nop 0
 v_add_f32 v16, v16, v18
 v_add_f32 v17, v17, v19
 v_min_f32 v16, v16, v17
 v_cmp_gt_f32 vcc, 0x33800000, v16
 s_cbranch_vccz L_firstok
 s_branch L_slow2
L_slow:
 s_cmp_lg_u32 s47, 0x4b800000
 s_cbranch_scc1 L_switched
 s_nop 5
L_slow2:
 v_max3_f32 v11, v32, v33, v34
 v_max3_f32 v11, v11, v35, v40
 v_max3_f32 v11, v11, v41, v42
 v_max3_f32 v11, v11, v43, v48
 v_max3_f32 v11, v11, v49, v50
 v_max3_f32 v11, v11, v51, v56
 v_max3_f32 v11, v11, v57, v58
 v_max_f32 v11, v11, v59
 v_mov_b32 v16, v11
 s_nop 1
 v_permlane32_swap_b32 v11, v16
 s_nop 1
 v_max_f32 v11, v11, v16
 v_mov_b32 v16, v11
 s_nop 1
 v_permlane16_swap_b32 v11, v16
 s_nop 1
 v_max_f32 v11, v11, v16
 v_max_f32 v11, s46, v11
 v_sub_f32 v9, v9, v11
 v_sub_f32 v32, v32, v11
 v_sub_f32 v33, v33, v11
 v_sub_f32 v34, v34, v11
 v_sub_f32 v35, v35, v11
 v_sub_f32 v40, v40, v11
 v_sub_f32 v41, v41, v11
 v_sub_f32 v42, v42, v11
 v_sub_f32 v43, v43, v11
 v_sub_f32 v48, v48, v11
 v_sub_f32 v49, v49, v11
 v_sub_f32 v50, v50, v11
 v_sub_f32 v51, v51, v11
 v_sub_f32 v56, v56, v11
 v_sub_f32 v57, v57, v11
 v_sub_f32 v58, v58, v11
 v_sub_f32 v59, v59, v11
 v_exp_f32 v64, v32
 v_mov_b32 v96, v9
 v_exp_f32 v65, v33
 v_mov_b32 v97, v9
 v_exp_f32 v66, v34
 v_mov_b32 v98, v9
 v_exp_f32 v67, v35
 v_mov_b32 v99, v9
 v_exp_f32 v72, v40
 v_mov_b32 v104, v9
 v_exp_f32 v73, v41
 v_mov_b32 v105, v9
 v_exp_f32 v74, v42
 v_mov_b32 v106, v9
 v_exp_f32 v75, v43
 v_mov_b32 v107, v9
 v_exp_f32 v80, v48
 v_mov_b32 v112, v9
 v_exp_f32 v81, v49
 v_mov_b32 v113, v9
 v_exp_f32 v82, v50
 v_mov_b32 v114, v9
 v_exp_f32 v83, v51
 v_mov_b32 v115, v9
 v_exp_f32 v88, v56
 v_mov_b32 v120, v9
 v_exp_f32 v89, v57
 v_mov_b32 v121, v9
 v_exp_f32 v90, v58
 v_mov_b32 v122, v9
 v_exp_f32 v91, v59
 v_mov_b32 v123, v9
 v_add_f32 v5, v64, v65
 v_add_f32 v5, v5, v66
 v_add_f32 v5, v5, v67
 v_add_f32 v5, v5, v72
 v_add_f32 v5, v5, v73
 v_add_f32 v5, v5, v74
 v_add_f32 v5, v5, v75
 v_add_f32 v5, v5, v80
 v_add_f32 v5, v5, v81
 v_add_f32 v5, v5, v82
 v_add_f32 v5, v5, v83
 v_add_f32 v5, v5, v88
 v_add_f32 v5, v5, v89
 v_add_f32 v5, v5, v90
 v_add_f32 v5, v5, v91
 v_max3_f32 v12, v36, v37, v38
 v_max3_f32 v12, v12, v39, v44
 v_max3_f32 v12, v12, v45, v46
 v_max3_f32 v12, v12, v47, v52
 v_max3_f32 v12, v12, v53, v54
 v_max3_f32 v12, v12, v55, v60
 v_max3_f32 v12, v12, v61, v62
 v_max_f32 v12, v12, v63
 v_mov_b32 v16, v12
 s_nop 1
 v_permlane32_swap_b32 v12, v16
 s_nop 1
 v_max_f32 v12, v12, v16
 v_mov_b32 v16, v12
 s_nop 1
 v_permlane16_swap_b32 v12, v16
 s_nop 1
 v_max_f32 v12, v12, v16
 v_max_f32 v12, s46, v12
 v_sub_f32 v10, v10, v12
 v_sub_f32 v36, v36, v12
 v_sub_f32 v37, v37, v12
 v_sub_f32 v38, v38, v12
 v_sub_f32 v39, v39, v12
 v_sub_f32 v44, v44, v12
 v_sub_f32 v45, v45, v12
 v_sub_f32 v46, v46, v12
 v_sub_f32 v47, v47, v12
 v_sub_f32 v52, v52, v12
 v_sub_f32 v53, v53, v12
 v_sub_f32 v54, v54, v12
 v_sub_f32 v55, v55, v12
 v_sub_f32 v60, v60, v12
 v_sub_f32 v61, v61, v12
 v_sub_f32 v62, v62, v12
 v_sub_f32 v63, v63, v12
 v_exp_f32 v68, v36
 v_mov_b32 v100, v10
 v_exp_f32 v69, v37
 v_mov_b32 v101, v10
 v_exp_f32 v70, v38
 v_mov_b32 v102, v10
 v_exp_f32 v71, v39
 v_mov_b32 v103, v10
 v_exp_f32 v76, v44
 v_mov_b32 v108, v10
 v_exp_f32 v77, v45
 v_mov_b32 v109, v10
 v_exp_f32 v78, v46
 v_mov_b32 v110, v10
 v_exp_f32 v79, v47
 v_mov_b32 v111, v10
 v_exp_f32 v84, v52
 v_mov_b32 v116, v10
 v_exp_f32 v85, v53
 v_mov_b32 v117, v10
 v_exp_f32 v86, v54
 v_mov_b32 v118, v10
 v_exp_f32 v87, v55
 v_mov_b32 v119, v10
 v_exp_f32 v92, v60
 v_mov_b32 v124, v10
 v_exp_f32 v93, v61
 v_mov_b32 v125, v10
 v_exp_f32 v94, v62
 v_mov_b32 v126, v10
 v_exp_f32 v95, v63
 v_mov_b32 v127, v10
 v_add_f32 v6, v68, v69
 v_add_f32 v6, v6, v70
 v_add_f32 v6, v6, v71
 v_add_f32 v6, v6, v76
 v_add_f32 v6, v6, v77
 v_add_f32 v6, v6, v78
 v_add_f32 v6, v6, v79
 v_add_f32 v6, v6, v84
 v_add_f32 v6, v6, v85
 v_add_f32 v6, v6, v86
 v_add_f32 v6, v6, v87
 v_add_f32 v6, v6, v92
 v_add_f32 v6, v6, v93
 v_add_f32 v6, v6, v94
 v_add_f32 v6, v6, v95
 v_mov_b32 v16, 0xf149f2ca
 v_cmp_gt_i32 s[16:17], 0, v14
 v_cmp_gt_i32 s[18:19], 1, v14
 v_cmp_gt_i32 s[20:21], 2, v14
 v_cmp_gt_i32 s[22:23], 3, v14
 v_cndmask_b32 v20, v9, v16, s[16:17]
 v_cndmask_b32 v21, v9, v16, s[18:19]
 v_cndmask_b32 v22, v9, v16, s[20:21]
 v_cndmask_b32 v23, v9, v16, s[22:23]
 v_accvgpr_write_b32 a224, v20
 v_accvgpr_write_b32 a225, v21
 v_accvgpr_write_b32 a226, v22
 v_accvgpr_write_b32 a227, v23
 v_cmp_gt_i32 s[16:17], 16, v14
 v_cmp_gt_i32 s[18:19], 17, v14
 v_cmp_gt_i32 s[20:21], 18, v14
 v_cmp_gt_i32 s[22:23], 19, v14
 v_cndmask_b32 v20, v9, v16, s[16:17]
 v_cndmask_b32 v21, v9, v16, s[18:19]
 v_cndmask_b32 v22, v9, v16, s[20:21]
 v_cndmask_b32 v23, v9, v16, s[22:23]
 v_accvgpr_write_b32 a228, v20
 v_accvgpr_write_b32 a229, v21
 v_accvgpr_write_b32 a230, v22
 v_accvgpr_write_b32 a231, v23
 v_cmp_gt_i32 s[16:17], 32, v14
 v_cmp_gt_i32 s[18:19], 33, v14
 v_cmp_gt_i32 s[20:21], 34, v14
 v_cmp_gt_i32 s[22:23], 35, v14
 v_cndmask_b32 v20, v9, v16, s[16:17]
 v_cndmask_b32 v21, v9, v16, s[18:19]
 v_cndmask_b32 v22, v9, v16, s[20:21]
 v_cndmask_b32 v23, v9, v16, s[22:23]
 v_accvgpr_write_b32 a232, v20
 v_accvgpr_write_b32 a233, v21
 v_accvgpr_write_b32 a234, v22
 v_accvgpr_write_b32 a235, v23
 v_cmp_gt_i32 s[16:17], 48, v14
 v_cmp_gt_i32 s[18:19], 49, v14
 v_cmp_gt_i32 s[20:21], 50, v14
 v_cmp_gt_i32 s[22:23], 51, v14
 v_cndmask_b32 v20, v9, v16, s[16:17]
 v_cndmask_b32 v21, v9, v16, s[18:19]
 v_cndmask_b32 v22, v9, v16, s[20:21]
 v_cndmask_b32 v23, v9, v16, s[22:23]
 v_accvgpr_write_b32 a236, v20
 v_accvgpr_write_b32 a237, v21
 v_accvgpr_write_b32 a238, v22
 v_accvgpr_write_b32 a239, v23
 s_waitcnt lgkmcnt(0)
 s_cmp_lg_u32 s46, 0
 s_mov_b32 s46, 0
 s_cbranch_scc1 L_ret
 v_exp_f32 v11, -v11
 s_nop 0
 v_mul_f32 v7, v7, v11
 v_mul_f32 v128, v128, v11
 v_mul_f32 v129, v129, v11
 v_mul_f32 v130, v130, v11
 v_mul_f32 v131, v131, v11
 v_mul_f32 v132, v132, v11
 v_mul_f32 v133, v133, v11
 v_mul_f32 v134, v134, v11
 v_mul_f32 v135, v135, v11
 v_mul_f32 v136, v136, v11
 v_mul_f32 v137, v137, v11
 v_mul_f32 v138, v138, v11
 v_mul_f32 v139, v139, v11
 v_mul_f32 v140, v140, v11
 v_mul_f32 v141, v141, v11
 v_mul_f32 v142, v142, v11
 v_mul_f32 v143, v143, v11
 v_mul_f32 v144, v144, v11
 v_mul_f32 v145, v145, v11
 v_mul_f32 v146, v146, v11
 v_mul_f32 v147, v147, v11
 v_mul_f32 v148, v148, v11
 v_mul_f32 v149, v149, v11
 v_mul_f32 v150, v150, v11
 v_mul_f32 v151, v151, v11
 v_mul_f32 v152, v152, v11
 v_mul_f32 v153, v153, v11
 v_mul_f32 v154, v154, v11
 v_mul_f32 v155, v155, v11
 v_mul_f32 v156, v156, v11
 v_mul_f32 v157, v157, v11
 v_mul_f32 v158, v158, v11
 v_mul_f32 v159, v159, v11
 v_mul_f32 v160, v160, v11
 v_mul_f32 v161, v161, v11
 v_mul_f32 v162, v162, v11
 v_mul_f32 v163, v163, v11
 v_mul_f32 v164, v164, v11
 v_mul_f32 v165, v165, v11
 v_mul_f32 v166, v166, v11
 v_mul_f32 v167, v167, v11
 v_mul_f32 v168, v168, v11
 v_mul_f32 v169, v169, v11
 v_mul_f32 v170, v170, v11
 v_mul_f32 v171, v171, v11
 v_mul_f32 v172, v172, v11
 v_mul_f32 v173, v173, v11
 v_mul_f32 v174, v174, v11
 v_mul_f32 v175, v175, v11
 v_mul_f32 v176, v176, v11
 v_mul_f32 v177, v177, v11
 v_mul_f32 v178, v178, v11
 v_mul_f32 v179, v179, v11
 v_mul_f32 v180, v180, v11
 v_mul_f32 v181, v181, v11
 v_mul_f32 v182, v182, v11
 v_mul_f32 v183, v183, v11
 v_mul_f32 v184, v184, v11
 v_mul_f32 v185, v185, v11
 v_mul_f32 v186, v186, v11
 v_mul_f32 v187, v187, v11
 v_mul_f32 v188, v188, v11
 v_mul_f32 v189, v189, v11
 v_mul_f32 v190, v190, v11
 v_mul_f32 v191, v191, v11
 v_exp_f32 v12, -v12
 s_nop 0
 v_mul_f32 v8, v8, v12
 v_mul_f32 v192, v192, v12
 v_mul_f32 v193, v193, v12
 v_mul_f32 v194, v194, v12
 v_mul_f32 v195, v195, v12
 v_mul_f32 v196, v196, v12
 v_mul_f32 v197, v197, v12
 v_mul_f32 v198, v198, v12
 v_mul_f32 v199, v199, v12
 v_mul_f32 v200, v200, v12
 v_mul_f32 v201, v201, v12
 v_mul_f32 v202, v202, v12
 v_mul_f32 v203, v203, v12
 v_mul_f32 v204, v204, v12
 v_mul_f32 v205, v205, v12
 v_mul_f32 v206, v206, v12
 v_mul_f32 v207, v207, v12
 v_mul_f32 v208, v208, v12
 v_mul_f32 v209, v209, v12
 v_mul_f32 v210, v210, v12
 v_mul_f32 v211, v211, v12
 v_mul_f32 v212, v212, v12
 v_mul_f32 v213, v213, v12
 v_mul_f32 v214, v214, v12
 v_mul_f32 v215, v215, v12
 v_mul_f32 v216, v216, v12
 v_mul_f32 v217, v217, v12
 v_mul_f32 v218, v218, v12
 v_mul_f32 v219, v219, v12
 v_mul_f32 v220, v220, v12
 v_mul_f32 v221, v221, v12
 v_mul_f32 v222, v222, v12
 v_mul_f32 v223, v223, v12
 v_mul_f32 v224, v224, v12
 v_mul_f32 v225, v225, v12
 v_mul_f32 v226, v226, v12
 v_mul_f32 v227, v227, v12
 v_mul_f32 v228, v228, v12
 v_mul_f32 v229, v229, v12
 v_mul_f32 v230, v230, v12
 v_mul_f32 v231, v231, v12
 v_mul_f32 v232, v232, v12
 v_mul_f32 v233, v233, v12
 v_mul_f32 v234, v234, v12
 v_mul_f32 v235, v235, v12
 v_mul_f32 v236, v236, v12
 v_mul_f32 v237, v237, v12
 v_mul_f32 v238, v238, v12
 v_mul_f32 v239, v239, v12
 v_mul_f32 v240, v240, v12
 v_mul_f32 v241, v241, v12
 v_mul_f32 v242, v242, v12
 v_mul_f32 v243, v243, v12
 v_mul_f32 v244, v244, v12
 v_mul_f32 v245, v245, v12
 v_mul_f32 v246, v246, v12
 v_mul_f32 v247, v247, v12
 v_mul_f32 v248, v248, v12
 v_mul_f32 v249, v249, v12
 v_mul_f32 v250, v250, v12
 v_mul_f32 v251, v251, v12
 v_mul_f32 v252, v252, v12
 v_mul_f32 v253, v253, v12
 v_mul_f32 v254, v254, v12
 v_mul_f32 v255, v255, v12
 s_branch L_ret
L_ret:
 s_cmp_gt_u32 s44, s45
 s_cbranch_scc1 L_loop
 s_branch L_ret2
L_disp:
 s_cmp_lt_u32 s44, 2
 s_cbranch_scc1 L_d1
 s_waitcnt vmcnt(0)
 v_accvgpr_read_b32 v12, a246
 v_cmp_ne_u32 vcc, 0, v12
 s_cbranch_vccz L_poll2_ok
 v_and_b32 v11, 11, v0
 v_lshlrev_b32 v11, 2, v11
 s_mov_b32 s32, 0
L_poll2:
 buffer_load_dword v12, v11, s[12:15], s60 offen sc1
 s_waitcnt vmcnt(0)
 v_cmp_ne_u32 vcc, 0, v12
 s_cbranch_vccz L_poll2_ok
 s_sleep 6
 s_add_u32 s32, s32, 1
 s_cmp_lt_u32 s32, 0x80000
 s_cbranch_scc1 L_poll2
L_poll2_ok:
 s_cmp_eq_u32 s38, 0
 s_cselect_b32 s60, s60, s94
 v_mov_b32 v15, 0
 s_mov_b32 s45, 2
 s_branch L_loop
L_d1:
 s_cmp_eq_u32 s54, 1
 s_cbranch_scc1 L_seg2
 s_cmp_eq_u32 s44, 0
 s_cbranch_scc1 L_p2
 s_cmp_eq_u32 s53, 0
 s_cbranch_scc1 L_g0y
 s_mov_b32 s53, 0
 s_add_u32 s52, s50, 131072
 s_mul_i32 s58, s3, 50176
 s_sub_u32 s58, 128, s58
 s_cmp_eq_u32 s7, 0
 s_cselect_b32 s42, s78, s49
 s_cmov_b32 s40, s52
 s_cmov_b64 s[8:9], s[86:87]
 s_cmov_b32 s10, 3670016
 s_cmov_b32 s76, 6144
 s_cmov_b32 s77, 10240
 s_mov_b32 s44, 1
 s_waitcnt vmcnt(0)
 s_barrier
 ds_read_b128 a[96:99], v3 offset:0
 ds_read_b128 a[100:103], v3 offset:16384
 ds_read_b128 a[104:107], v3 offset:1024
 ds_read_b128 a[108:111], v3 offset:17408
 ds_read_b128 a[112:115], v3 offset:2048
 ds_read_b128 a[116:119], v3 offset:18432
 s_branch L_g0y
L_g0x:
 v_cmp_nge_f32 vcc, s47, v11
 s_cbranch_vccnz L_slow
L_g0y:
 v_mov_b32 v16, 0xf149f2ca
 v_cmp_gt_i32 s[16:17], 0, v14
 v_cmp_gt_i32 s[18:19], 1, v14
 v_cmp_gt_i32 s[20:21], 2, v14
 v_cmp_gt_i32 s[22:23], 3, v14
 v_cndmask_b32 v100, v10, v16, s[16:17]
 v_cndmask_b32 v101, v10, v16, s[18:19]
 v_cndmask_b32 v102, v10, v16, s[20:21]
 v_cndmask_b32 v103, v10, v16, s[22:23]
 v_cmp_gt_i32 s[16:17], 16, v14
 v_cmp_gt_i32 s[18:19], 17, v14
 v_cmp_gt_i32 s[20:21], 18, v14
 v_cmp_gt_i32 s[22:23], 19, v14
 v_cndmask_b32 v108, v10, v16, s[16:17]
 v_cndmask_b32 v109, v10, v16, s[18:19]
 v_cndmask_b32 v110, v10, v16, s[20:21]
 v_cndmask_b32 v111, v10, v16, s[22:23]
 v_cmp_gt_i32 s[16:17], 32, v14
 v_cmp_gt_i32 s[18:19], 33, v14
 v_cmp_gt_i32 s[20:21], 34, v14
 v_cmp_gt_i32 s[22:23], 35, v14
 v_cndmask_b32 v116, v10, v16, s[16:17]
 v_cndmask_b32 v117, v10, v16, s[18:19]
 v_cndmask_b32 v118, v10, v16, s[20:21]
 v_cndmask_b32 v119, v10, v16, s[22:23]
 v_cmp_gt_i32 s[16:17], 48, v14
 v_cmp_gt_i32 s[18:19], 49, v14
 v_cmp_gt_i32 s[20:21], 50, v14
 v_cmp_gt_i32 s[22:23], 51, v14
 v_cndmask_b32 v124, v10, v16, s[16:17]
 v_cndmask_b32 v125, v10, v16, s[18:19]
 v_cndmask_b32 v126, v10, v16, s[20:21]
 v_cndmask_b32 v127, v10, v16, s[22:23]
 s_waitcnt lgkmcnt(0)
 s_cmp_eq_u32 s51, 1
 s_cbranch_scc1 L_p1
 s_cmp_eq_u32 s7, 0
 s_cbranch_scc1 L_g0z
 v_and_b32 v11, 0, v0
 v_lshlrev_b32 v11, 2, v11
 s_mov_b32 s32, 0
L_poll3:
 buffer_load_dword v12, v11, s[12:15], s60 offen sc1
 s_waitcnt vmcnt(0)
 v_cmp_ne_u32 vcc, 0, v12
 s_cbranch_vccz L_poll3_ok
 s_sleep 1
 s_add_u32 s32, s32, 1
 s_cmp_lt_u32 s32, 0x80000
 s_cbranch_scc1 L_poll3
L_poll3_ok:
 s_branch L_g0w
L_g0z:
 buffer_load_dword v12, v15, s[12:15], s60 offen sc1
 s_waitcnt vmcnt(0)
 v_cmp_ne_u32 vcc, 0, v12
L_g0w:
 s_cmp_eq_u64 vcc, 0
 s_cselect_b32 s51, 1, 0
 s_cselect_b32 s55, s4, 2.0
 s_cselect_b32 s56, s5, 2.0
 s_cselect_b32 s57, s6, 2.0
 buffer_load_dwordx4 a[192:195], v1, s[12:15], s57 offen sc1
 buffer_load_dwordx4 a[128:131], v1, s[12:15], s55 offen offset:0 sc1
 buffer_load_dwordx4 a[132:135], v1, s[12:15], s55 offen offset:1024 sc1
 buffer_load_dwordx4 a[136:139], v1, s[12:15], s55 offen offset:2048 sc1
 buffer_load_dwordx4 a[140:143], v1, s[12:15], s55 offen offset:3072 sc1
 buffer_load_dwordx4 a[144:147], v4, s[12:15], s55 offen offset:0 sc1
 buffer_load_dwordx4 a[148:151], v4, s[12:15], s55 offen offset:1024 sc1
 buffer_load_dwordx4 a[152:155], v4, s[12:15], s55 offen offset:2048 sc1
 buffer_load_dwordx4 a[156:159], v4, s[12:15], s55 offen offset:3072 sc1
 s_branch L_p1
L_seg2:
 s_cmp_eq_u32 s44, 0
 s_cbranch_scc1 L_tail
L_last:
 v_and_b32 v11, 31, v0
 v_lshlrev_b32 v11, 2, v11
 buffer_load_dword a247, v11, s[12:15], s61 offen sc1
 v_accvgpr_read_b32 v13, a241
 s_mov_b64 s[8:9], s[86:87]
 s_mov_b32 s10, 3670016
 s_mov_b32 s42, s78
 s_add_u32 s40, s50, 131072
 s_movk_i32 s76, 6144
 s_movk_i32 s77, 10240
 s_branch L_loop
L_switch:
 v_accvgpr_mov_b32 a32, a128
 v_accvgpr_mov_b32 a33, a129
 v_accvgpr_mov_b32 a34, a130
 v_accvgpr_mov_b32 a35, a131
 v_accvgpr_mov_b32 a36, a132
 v_accvgpr_mov_b32 a37, a133
 v_accvgpr_mov_b32 a38, a134
 v_accvgpr_mov_b32 a39, a135
 v_accvgpr_mov_b32 a40, a136
 v_accvgpr_mov_b32 a41, a137
 v_accvgpr_mov_b32 a42, a138
 v_accvgpr_mov_b32 a43, a139
 v_accvgpr_mov_b32 a44, a140
 v_accvgpr_mov_b32 a45, a141
 v_accvgpr_mov_b32 a46, a142
 v_accvgpr_mov_b32 a47, a143
 v_accvgpr_mov_b32 a48, a144
 v_accvgpr_mov_b32 a49, a145
 v_accvgpr_mov_b32 a50, a146
 v_accvgpr_mov_b32 a51, a147
 v_accvgpr_mov_b32 a52, a148
 v_accvgpr_mov_b32 a53, a149
 v_accvgpr_mov_b32 a54, a150
 v_accvgpr_mov_b32 a55, a151
 v_accvgpr_mov_b32 a56, a152
 v_accvgpr_mov_b32 a57, a153
 v_accvgpr_mov_b32 a58, a154
 v_accvgpr_mov_b32 a59, a155
 v_accvgpr_mov_b32 a60, a156
 v_accvgpr_mov_b32 a61, a157
 v_accvgpr_mov_b32 a62, a158
 v_accvgpr_mov_b32 a63, a159
 v_mov_b64 v[96:97], 0
 v_mov_b64 v[98:99], 0
 v_mov_b64 v[100:101], 0
 v_mov_b64 v[102:103], 0
 v_mov_b64 v[104:105], 0
 v_mov_b64 v[106:107], 0
 v_mov_b64 v[108:109], 0
 v_mov_b64 v[110:111], 0
 v_mov_b64 v[112:113], 0
 v_mov_b64 v[114:115], 0
 v_mov_b64 v[116:117], 0
 v_mov_b64 v[118:119], 0
 v_mov_b64 v[120:121], 0
 v_mov_b64 v[122:123], 0
 v_mov_b64 v[124:125], 0
 v_mov_b64 v[126:127], 0
 v_mov_b64 v[64:65], 0
 v_mov_b64 v[66:67], 0
 v_mov_b64 v[72:73], 0
 v_mov_b64 v[74:75], 0
 v_mov_b64 v[80:81], 0
 v_mov_b64 v[82:83], 0
 v_mov_b64 v[88:89], 0
 v_mov_b64 v[90:91], 0
 v_mov_b32 v5, 0
 s_add_u32 s42, s49, 32768
 s_xor_b32 s40, s40, 0x8000
 s_xor_b32 s41, s41, 0x8000
 s_add_u32 s43, s49, 16777216
 s_mov_b32 s44, s38
 s_mov_b32 s45, 1
 s_mov_b32 s47, -1.0
 s_waitcnt vmcnt(8) lgkmcnt(0)
 s_cmp_eq_u32 s38, 1
 s_cbranch_scc1 L_last
 s_branch L_loop
L_switched:
 v_mov_b32 v18, v7
 v_mov_b32 v19, v8
 s_nop 0
 v_permlane32_swap_b32 v7, v18
 v_permlane32_swap_b32 v8, v19
 s_nop 0
 v_add_f32 v7, v7, v18
 v_add_f32 v8, v8, v19
 s_nop 0
 v_mov_b32 v18, v7
 v_mov_b32 v19, v8
 s_nop 0
 v_permlane16_swap_b32 v7, v18
 v_permlane16_swap_b32 v8, v19
 s_nop 0
 v_add_f32 v7, v7, v18
 v_add_f32 v8, v8, v19
 s_nop 0
 v_rcp_f32 v16, v7
 v_rcp_f32 v17, v8
 s_mov_b32 s47, 0x4b800000
 s_mov_b32 s54, 1
 v_accvgpr_write_b32 a200, v16
 v_cvt_pk_bf16_f32 v128, v128, v129
 v_cvt_pk_bf16_f32 v129, v130, v131
 v_cvt_pk_bf16_f32 v130, v132, v133
 v_cvt_pk_bf16_f32 v131, v134, v135
 v_accvgpr_write_b32 a128, v128
 v_accvgpr_write_b32 a129, v129
 v_accvgpr_write_b32 a130, v130
 v_accvgpr_write_b32 a131, v131
 v_cvt_pk_bf16_f32 v136, v136, v137
 v_cvt_pk_bf16_f32 v137, v138, v139
 v_cvt_pk_bf16_f32 v138, v140, v141
 v_cvt_pk_bf16_f32 v139, v142, v143
 v_accvgpr_write_b32 a132, v136
 v_accvgpr_write_b32 a133, v137
 v_accvgpr_write_b32 a134, v138
 v_accvgpr_write_b32 a135, v139
 v_cvt_pk_bf16_f32 v144, v144, v145
 v_cvt_pk_bf16_f32 v145, v146, v147
 v_cvt_pk_bf16_f32 v146, v148, v149
 v_cvt_pk_bf16_f32 v147, v150, v151
 v_accvgpr_write_b32 a136, v144
 v_accvgpr_write_b32 a137, v145
 v_accvgpr_write_b32 a138, v146
 v_accvgpr_write_b32 a139, v147
 v_cvt_pk_bf16_f32 v152, v152, v153
 v_cvt_pk_bf16_f32 v153, v154, v155
 v_cvt_pk_bf16_f32 v154, v156, v157
 v_cvt_pk_bf16_f32 v155, v158, v159
 v_accvgpr_write_b32 a140, v152
 v_accvgpr_write_b32 a141, v153
 v_accvgpr_write_b32 a142, v154
 v_accvgpr_write_b32 a143, v155
 v_cvt_pk_bf16_f32 v160, v160, v161
 v_cvt_pk_bf16_f32 v161, v162, v163
 v_cvt_pk_bf16_f32 v162, v164, v165
 v_cvt_pk_bf16_f32 v163, v166, v167
 v_accvgpr_write_b32 a144, v160
 v_accvgpr_write_b32 a145, v161
 v_accvgpr_write_b32 a146, v162
 v_accvgpr_write_b32 a147, v163
 v_cvt_pk_bf16_f32 v168, v168, v169
 v_cvt_pk_bf16_f32 v169, v170, v171
 v_cvt_pk_bf16_f32 v170, v172, v173
 v_cvt_pk_bf16_f32 v171, v174, v175
 v_accvgpr_write_b32 a148, v168
 v_accvgpr_write_b32 a149, v169
 v_accvgpr_write_b32 a150, v170
 v_accvgpr_write_b32 a151, v171
 v_cvt_pk_bf16_f32 v176, v176, v177
 v_cvt_pk_bf16_f32 v177, v178, v179
 v_cvt_pk_bf16_f32 v178, v180, v181
 v_cvt_pk_bf16_f32 v179, v182, v183
 v_accvgpr_write_b32 a152, v176
 v_accvgpr_write_b32 a153, v177
 v_accvgpr_write_b32 a154, v178
 v_accvgpr_write_b32 a155, v179
 v_cvt_pk_bf16_f32 v184, v184, v185
 v_cvt_pk_bf16_f32 v185, v186, v187
 v_cvt_pk_bf16_f32 v186, v188, v189
 v_cvt_pk_bf16_f32 v187, v190, v191
 v_accvgpr_write_b32 a156, v184
 v_accvgpr_write_b32 a157, v185
 v_accvgpr_write_b32 a158, v186
 v_accvgpr_write_b32 a159, v187
 v_accvgpr_write_b32 a201, v17
 v_cvt_pk_bf16_f32 v192, v192, v193
 v_cvt_pk_bf16_f32 v193, v194, v195
 v_cvt_pk_bf16_f32 v194, v196, v197
 v_cvt_pk_bf16_f32 v195, v198, v199
 v_accvgpr_write_b32 a160, v192
 v_accvgpr_write_b32 a161, v193
 v_accvgpr_write_b32 a162, v194
 v_accvgpr_write_b32 a163, v195
 v_cvt_pk_bf16_f32 v200, v200, v201
 v_cvt_pk_bf16_f32 v201, v202, v203
 v_cvt_pk_bf16_f32 v202, v204, v205
 v_cvt_pk_bf16_f32 v203, v206, v207
 v_accvgpr_write_b32 a164, v200
 v_accvgpr_write_b32 a165, v201
 v_accvgpr_write_b32 a166, v202
 v_accvgpr_write_b32 a167, v203
 v_cvt_pk_bf16_f32 v208, v208, v209
 v_cvt_pk_bf16_f32 v209, v210, v211
 v_cvt_pk_bf16_f32 v210, v212, v213
 v_cvt_pk_bf16_f32 v211, v214, v215
 v_accvgpr_write_b32 a168, v208
 v_accvgpr_write_b32 a169, v209
 v_accvgpr_write_b32 a170, v210
 v_accvgpr_write_b32 a171, v211
 v_cvt_pk_bf16_f32 v216, v216, v217
 v_cvt_pk_bf16_f32 v217, v218, v219
 v_cvt_pk_bf16_f32 v218, v220, v221
 v_cvt_pk_bf16_f32 v219, v222, v223
 v_accvgpr_write_b32 a172, v216
 v_accvgpr_write_b32 a173, v217
 v_accvgpr_write_b32 a174, v218
 v_accvgpr_write_b32 a175, v219
 v_cvt_pk_bf16_f32 v224, v224, v225
 v_cvt_pk_bf16_f32 v225, v226, v227
 v_cvt_pk_bf16_f32 v226, v228, v229
 v_cvt_pk_bf16_f32 v227, v230, v231
 v_accvgpr_write_b32 a176, v224
 v_accvgpr_write_b32 a177, v225
 v_accvgpr_write_b32 a178, v226
 v_accvgpr_write_b32 a179, v227
 v_cvt_pk_bf16_f32 v232, v232, v233
 v_cvt_pk_bf16_f32 v233, v234, v235
 v_cvt_pk_bf16_f32 v234, v236, v237
 v_cvt_pk_bf16_f32 v235, v238, v239
 v_accvgpr_write_b32 a180, v232
 v_accvgpr_write_b32 a181, v233
 v_accvgpr_write_b32 a182, v234
 v_accvgpr_write_b32 a183, v235
 v_cvt_pk_bf16_f32 v240, v240, v241
 v_cvt_pk_bf16_f32 v241, v242, v243
 v_cvt_pk_bf16_f32 v242, v244, v245
 v_cvt_pk_bf16_f32 v243, v246, v247
 v_accvgpr_write_b32 a184, v240
 v_accvgpr_write_b32 a185, v241
 v_accvgpr_write_b32 a186, v242
 v_accvgpr_write_b32 a187, v243
 v_cvt_pk_bf16_f32 v248, v248, v249
 v_cvt_pk_bf16_f32 v249, v250, v251
 v_cvt_pk_bf16_f32 v250, v252, v253
 v_cvt_pk_bf16_f32 v251, v254, v255
 v_accvgpr_write_b32 a188, v248
 v_accvgpr_write_b32 a189, v249
 v_accvgpr_write_b32 a190, v250
 v_accvgpr_write_b32 a191, v251
 v_mov_b64 v[128:129], 0
 v_mov_b64 v[130:131], 0
 v_mov_b64 v[132:133], 0
 v_mov_b64 v[134:135], 0
 v_mov_b64 v[136:137], 0
 v_mov_b64 v[138:139], 0
 v_mov_b64 v[140:141], 0
 v_mov_b64 v[142:143], 0
 v_mov_b64 v[144:145], 0
 v_mov_b64 v[146:147], 0
 v_mov_b64 v[148:149], 0
 v_mov_b64 v[150:151], 0
 v_mov_b64 v[152:153], 0
 v_mov_b64 v[154:155], 0
 v_mov_b64 v[156:157], 0
 v_mov_b64 v[158:159], 0
 v_mov_b64 v[160:161], 0
 v_mov_b64 v[162:163], 0
 v_mov_b64 v[164:165], 0
 v_mov_b64 v[166:167], 0
 v_mov_b64 v[168:169], 0
 v_mov_b64 v[170:171], 0
 v_mov_b64 v[172:173], 0
 v_mov_b64 v[174:175], 0
 v_mov_b64 v[176:177], 0
 v_mov_b64 v[178:179], 0
 v_mov_b64 v[180:181], 0
 v_mov_b64 v[182:183], 0
 v_mov_b64 v[184:185], 0
 v_mov_b64 v[186:187], 0
 v_mov_b64 v[188:189], 0
 v_mov_b64 v[190:191], 0
 v_mov_b64 v[192:193], 0
 v_mov_b64 v[194:195], 0
 v_mov_b64 v[196:197], 0
 v_mov_b64 v[198:199], 0
 v_mov_b64 v[200:201], 0
 v_mov_b64 v[202:203], 0
 v_mov_b64 v[204:205], 0
 v_mov_b64 v[206:207], 0
 v_mov_b64 v[208:209], 0
 v_mov_b64 v[210:211], 0
 v_mov_b64 v[212:213], 0
 v_mov_b64 v[214:215], 0
 v_mov_b64 v[216:217], 0
 v_mov_b64 v[218:219], 0
 v_mov_b64 v[220:221], 0
 v_mov_b64 v[222:223], 0
 v_mov_b64 v[224:225], 0
 v_mov_b64 v[226:227], 0
 v_mov_b64 v[228:229], 0
 v_mov_b64 v[230:231], 0
 v_mov_b64 v[232:233], 0
 v_mov_b64 v[234:235], 0
 v_mov_b64 v[236:237], 0
 v_mov_b64 v[238:239], 0
 v_mov_b64 v[240:241], 0
 v_mov_b64 v[242:243], 0
 v_mov_b64 v[244:245], 0
 v_mov_b64 v[246:247], 0
 v_mov_b64 v[248:249], 0
 v_mov_b64 v[250:251], 0
 v_mov_b64 v[252:253], 0
 v_mov_b64 v[254:255], 0
 v_mov_b32 v7, 0
 v_mov_b32 v8, 0
 v_mov_b32 v9, 0
 v_mov_b32 v10, 0
 s_branch L_first
L_fagen:
 v_mov_b32 v5, 0
 buffer_load_dword a246, v15, s[12:15], s60 offen sc1
 v_mov_b32 v64, 0
 v_mov_b32 v65, 0
 v_mov_b32 v66, 0
 v_mov_b32 v67, 0
 v_mov_b32 v72, 0
 v_mov_b32 v73, 0
 v_mov_b32 v74, 0
 v_mov_b32 v75, 0
 v_mov_b32 v80, 0
 v_mov_b32 v81, 0
 v_mov_b32 v82, 0
 v_mov_b32 v83, 0
 v_mov_b32 v88, 0
 v_mov_b32 v89, 0
 v_mov_b32 v90, 0
 v_mov_b32 v91, 0
L_tail:
 s_and_b32 s55, s2, 127
 s_lshl_b32 s57, s55, 2
 s_add_u32 s57, s57, s3
 s_mul_i32 s55, s57, 17408
 s_add_u32 s55, s55, 67108864
 s_lshl_b32 s57, s57, 10
 s_add_u32 s57, s57, 83886080
 s_mul_i32 s58, s3, 50176
 s_sub_u32 s58, 128, s58
 v_add_u32 v2, s58, v13
 v_cvt_pk_bf16_f32 v16, v64, v65
 v_cvt_pk_bf16_f32 v17, v66, v67
 v_cvt_pk_bf16_f32 v20, v68, v69
 v_cvt_pk_bf16_f32 v21, v70, v71
 v_cvt_pk_bf16_f32 v18, v72, v73
 v_cvt_pk_bf16_f32 v19, v74, v75
 v_cvt_pk_bf16_f32 v22, v76, v77
 v_cvt_pk_bf16_f32 v23, v78, v79
 v_cvt_pk_bf16_f32 v24, v80, v81
 v_cvt_pk_bf16_f32 v25, v82, v83
 v_cvt_pk_bf16_f32 v28, v84, v85
 v_cvt_pk_bf16_f32 v29, v86, v87
 v_cvt_pk_bf16_f32 v26, v88, v89
 v_cvt_pk_bf16_f32 v27, v90, v91
 v_cvt_pk_bf16_f32 v30, v92, v93
 v_cvt_pk_bf16_f32 v31, v94, v95
 v_add_f32 v7, v7, v5
 v_add_f32 v8, v8, v6
 s_waitcnt vmcnt(0) lgkmcnt(0)
 s_barrier
 ds_read_b128 a[64:67], v3 offset:0
 ds_read_b128 a[68:71], v3 offset:16384
 ds_read_b128 a[72:75], v3 offset:1024
 ds_read_b128 a[76:79], v3 offset:17408
 ds_read_b128 a[80:83], v3 offset:2048
 ds_read_b128 a[84:87], v3 offset:18432
 ds_read_b128 a[88:91], v3 offset:3072
 ds_read_b128 a[92:95], v3 offset:19456
 s_cmp_lg_u32 s38, 0
 s_cselect_b32 s58, s54, 0
 s_cmp_eq_u32 s58, 2
 s_cbranch_scc1 L_tail2
 s_cmp_eq_u32 s62, 0
 s_cbranch_scc1 L_nou
 v_accvgpr_read_b32 v12, a247
 v_cmp_ne_u32 vcc, 0, v12
 s_cbranch_vccz L_poll4_ok
 v_and_b32 v11, 31, v0
 v_lshlrev_b32 v11, 2, v11
 s_mov_b32 s32, 0
L_poll4:
 buffer_load_dword v12, v11, s[12:15], s61 offen sc1
 s_waitcnt vmcnt(0)
 v_cmp_ne_u32 vcc, 0, v12
 s_cbranch_vccz L_poll4_ok
 s_sleep 6
 s_add_u32 s32, s32, 1
 s_cmp_lt_u32 s32, 0x80000
 s_cbranch_scc1 L_poll4
L_poll4_ok:
L_nou:
 s_cmp_eq_u32 s54, 1
 s_cselect_b32 s55, s55, 2.0
 s_cselect_b32 s57, s57, 2.0
 s_cselect_b32 s59, s94, 2.0
 s_add_u32 s56, s55, 0x2000
 s_waitcnt lgkmcnt(0)
 v_mfma_f32_16x16x32_bf16 v[128:131], a[64:67], v[16:19], v[128:131]
 s_add_u32 m0, s29, 0
 ds_read_b128 a[96:99], v3 offset:4096
 v_mov_b32 v72, v7
 v_mfma_f32_16x16x32_bf16 v[128:131], a[68:71], v[24:27], v[128:131]
 buffer_load_dwordx4 v2, s[8:11], s78 offen lds
 v_mfma_f32_16x16x32_bf16 v[192:195], a[68:71], v[28:31], v[192:195]
 ds_read_b128 a[100:103], v3 offset:20480
 v_mov_b32 v73, v8
 v_mfma_f32_16x16x32_bf16 v[192:195], a[64:67], v[20:23], v[192:195]
 v_permlane32_swap_b32 v7, v72
 v_permlane32_swap_b32 v8, v73
 v_mfma_f32_16x16x32_bf16 v[132:135], a[72:75], v[16:19], v[132:135]
 s_add_u32 m0, s29, 4096
 ds_read_b128 a[104:107], v3 offset:5120
 v_accvgpr_read_b32 v44, a254
 v_mfma_f32_16x16x32_bf16 v[132:135], a[76:79], v[24:27], v[132:135]
 buffer_load_dwordx4 v2, s[8:11], s79 offen lds
 v_mfma_f32_16x16x32_bf16 v[196:199], a[76:79], v[28:31], v[196:199]
 ds_read_b128 a[108:111], v3 offset:21504
 v_add_f32 v7, v7, v72
 v_mfma_f32_16x16x32_bf16 v[196:199], a[72:75], v[20:23], v[196:199]
 v_add_f32 v8, v8, v73
 v_mfma_f32_16x16x32_bf16 v[136:139], a[80:83], v[16:19], v[136:139]
 s_add_u32 m0, s29, 8192
 ds_read_b128 a[112:115], v3 offset:6144
 v_mov_b32 v72, v7
 v_mfma_f32_16x16x32_bf16 v[136:139], a[84:87], v[24:27], v[136:139]
 buffer_load_dwordx4 v2, s[8:11], s80 offen lds
 v_mfma_f32_16x16x32_bf16 v[200:203], a[84:87], v[28:31], v[200:203]
 s_add_u32 m0, s29, 12288
 ds_read_b128 a[116:119], v3 offset:22528
 v_mov_b32 v73, v8
 v_mfma_f32_16x16x32_bf16 v[200:203], a[80:83], v[20:23], v[200:203]
 buffer_load_dwordx4 v2, s[8:11], s81 offen lds
 v_mfma_f32_16x16x32_bf16 v[140:143], a[88:91], v[16:19], v[140:143]
 s_add_u32 m0, s29, 16384
 ds_read_b128 a[120:123], v3 offset:7168
 v_mfma_f32_16x16x32_bf16 v[140:143], a[92:95], v[24:27], v[140:143]
 buffer_load_dwordx4 v2, s[8:11], s82 offen lds
 v_mfma_f32_16x16x32_bf16 v[204:207], a[92:95], v[28:31], v[204:207]
 ds_read_b128 a[124:127], v3 offset:23552
 v_permlane16_swap_b32 v7, v72
 v_mfma_f32_16x16x32_bf16 v[204:207], a[88:91], v[20:23], v[204:207]
 s_waitcnt lgkmcnt(6)
 v_permlane16_swap_b32 v8, v73
 v_cvt_pk_bf16_f32 v128, v128, v129
 v_mfma_f32_16x16x32_bf16 v[144:147], a[96:99], v[16:19], v[144:147]
 s_add_u32 m0, s29, 20480
 ds_read_b128 a[64:67], v3 offset:8192
 v_cvt_pk_bf16_f32 v129, v130, v131
 v_mfma_f32_16x16x32_bf16 v[144:147], a[100:103], v[24:27], v[144:147]
 buffer_load_dwordx4 v2, s[8:11], s83 offen lds
 v_mfma_f32_16x16x32_bf16 v[208:211], a[100:103], v[28:31], v[208:211]
 s_add_u32 m0, s29, 24576
 ds_read_b128 a[68:71], v3 offset:24576
 v_add_f32 v7, v7, v72
 v_mfma_f32_16x16x32_bf16 v[208:211], a[96:99], v[20:23], v[208:211]
 s_waitcnt lgkmcnt(6)
 buffer_load_dwordx4 v2, s[8:11], s84 offen lds
 v_mfma_f32_16x16x32_bf16 v[148:151], a[104:107], v[16:19], v[148:151]
 s_add_u32 m0, s29, 28672
 ds_read_b128 a[72:75], v3 offset:9216
 v_add_f32 v8, v8, v73
 v_mfma_f32_16x16x32_bf16 v[148:151], a[108:111], v[24:27], v[148:151]
 buffer_load_dwordx4 v2, s[8:11], s85 offen lds
 v_mfma_f32_16x16x32_bf16 v[212:215], a[108:111], v[28:31], v[212:215]
 ds_read_b128 a[76:79], v3 offset:25600
 v_add_u32 v2, 128, v2
 v_mfma_f32_16x16x32_bf16 v[212:215], a[104:107], v[20:23], v[212:215]
 s_waitcnt lgkmcnt(6)
 v_cvt_pk_bf16_f32 v130, v132, v133
 v_cvt_pk_bf16_f32 v131, v134, v135
 v_mfma_f32_16x16x32_bf16 v[152:155], a[112:115], v[16:19], v[152:155]
 ds_read_b128 a[80:83], v3 offset:10240
 v_cvt_pk_bf16_f32 v192, v192, v193
 v_mfma_f32_16x16x32_bf16 v[152:155], a[116:119], v[24:27], v[152:155]
 buffer_store_dwordx4 v[128:131], v1, s[12:15], s55 offen offset:0 sc1
 v_mfma_f32_16x16x32_bf16 v[216:219], a[116:119], v[28:31], v[216:219]
 ds_read_b128 a[84:87], v3 offset:26624
 v_cvt_pk_bf16_f32 v193, v194, v195
 v_mfma_f32_16x16x32_bf16 v[216:219], a[112:115], v[20:23], v[216:219]
 s_waitcnt lgkmcnt(6)
 v_cvt_pk_bf16_f32 v194, v196, v197
 v_cvt_pk_bf16_f32 v195, v198, v199
 v_mfma_f32_16x16x32_bf16 v[156:159], a[120:123], v[16:19], v[156:159]
 ds_read_b128 a[88:91], v3 offset:11264
 v_cvt_pk_bf16_f32 v136, v136, v137
 v_mfma_f32_16x16x32_bf16 v[156:159], a[124:127], v[24:27], v[156:159]
 buffer_store_dwordx4 v[192:195], v1, s[12:15], s56 offen offset:0 sc1
 v_mfma_f32_16x16x32_bf16 v[220:223], a[124:127], v[28:31], v[220:223]
 ds_read_b128 a[92:95], v3 offset:27648
 v_cvt_pk_bf16_f32 v137, v138, v139
 v_mfma_f32_16x16x32_bf16 v[220:223], a[120:123], v[20:23], v[220:223]
 s_waitcnt lgkmcnt(6)
 v_cvt_pk_bf16_f32 v138, v140, v141
 v_cvt_pk_bf16_f32 v139, v142, v143
 v_mfma_f32_16x16x32_bf16 v[160:163], a[64:67], v[16:19], v[160:163]
 ds_read_b128 a[96:99], v3 offset:12288
 v_cvt_pk_bf16_f32 v200, v200, v201
 v_mfma_f32_16x16x32_bf16 v[160:163], a[68:71], v[24:27], v[160:163]
 buffer_store_dwordx4 v[136:139], v1, s[12:15], s55 offen offset:1024 sc1
 v_mfma_f32_16x16x32_bf16 v[224:227], a[68:71], v[28:31], v[224:227]
 ds_read_b128 a[100:103], v3 offset:28672
 v_cvt_pk_bf16_f32 v201, v202, v203
 v_mfma_f32_16x16x32_bf16 v[224:227], a[64:67], v[20:23], v[224:227]
 s_waitcnt lgkmcnt(6)
 v_cvt_pk_bf16_f32 v202, v204, v205
 v_cvt_pk_bf16_f32 v203, v206, v207
 v_mfma_f32_16x16x32_bf16 v[164:167], a[72:75], v[16:19], v[164:167]
 ds_read_b128 a[104:107], v3 offset:13312
 v_cvt_pk_bf16_f32 v144, v144, v145
 v_mfma_f32_16x16x32_bf16 v[164:167], a[76:79], v[24:27], v[164:167]
 buffer_store_dwordx4 v[200:203], v1, s[12:15], s56 offen offset:1024 sc1
 v_mfma_f32_16x16x32_bf16 v[228:231], a[76:79], v[28:31], v[228:231]
 ds_read_b128 a[108:111], v3 offset:29696
 v_cvt_pk_bf16_f32 v145, v146, v147
 v_mfma_f32_16x16x32_bf16 v[228:231], a[72:75], v[20:23], v[228:231]
 s_waitcnt lgkmcnt(6)
 v_cvt_pk_bf16_f32 v146, v148, v149
 v_cvt_pk_bf16_f32 v147, v150, v151
 v_mfma_f32_16x16x32_bf16 v[168:171], a[80:83], v[16:19], v[168:171]
 ds_read_b128 a[112:115], v3 offset:14336
 v_cvt_pk_bf16_f32 v208, v208, v209
 v_mfma_f32_16x16x32_bf16 v[168:171], a[84:87], v[24:27], v[168:171]
 buffer_store_dwordx4 v[144:147], v1, s[12:15], s55 offen offset:2048 sc1
 v_mfma_f32_16x16x32_bf16 v[232:235], a[84:87], v[28:31], v[232:235]
 ds_read_b128 a[116:119], v3 offset:30720
 v_cvt_pk_bf16_f32 v209, v210, v211
 v_mfma_f32_16x16x32_bf16 v[232:235], a[80:83], v[20:23], v[232:235]
 s_waitcnt lgkmcnt(6)
 v_cvt_pk_bf16_f32 v210, v212, v213
 v_cvt_pk_bf16_f32 v211, v214, v215
 v_mfma_f32_16x16x32_bf16 v[172:175], a[88:91], v[16:19], v[172:175]
 ds_read_b128 a[120:123], v3 offset:15360
 v_cvt_pk_bf16_f32 v152, v152, v153
 v_mfma_f32_16x16x32_bf16 v[172:175], a[92:95], v[24:27], v[172:175]
 buffer_store_dwordx4 v[208:211], v1, s[12:15], s56 offen offset:2048 sc1
 v_mfma_f32_16x16x32_bf16 v[236:239], a[92:95], v[28:31], v[236:239]
 ds_read_b128 a[124:127], v3 offset:31744
 v_cvt_pk_bf16_f32 v153, v154, v155
 v_mfma_f32_16x16x32_bf16 v[236:239], a[88:91], v[20:23], v[236:239]
 s_waitcnt lgkmcnt(6)
 v_cvt_pk_bf16_f32 v154, v156, v157
 v_cvt_pk_bf16_f32 v155, v158, v159
 v_mfma_f32_16x16x32_bf16 v[176:179], a[96:99], v[16:19], v[176:179]
 v_cvt_pk_bf16_f32 v216, v216, v217
 v_cvt_pk_bf16_f32 v217, v218, v219
 v_mfma_f32_16x16x32_bf16 v[176:179], a[100:103], v[24:27], v[176:179]
 buffer_store_dwordx4 v[152:155], v1, s[12:15], s55 offen offset:3072 sc1
 v_mfma_f32_16x16x32_bf16 v[240:243], a[100:103], v[28:31], v[240:243]
 v_cvt_pk_bf16_f32 v218, v220, v221
 v_cvt_pk_bf16_f32 v219, v222, v223
 v_mfma_f32_16x16x32_bf16 v[240:243], a[96:99], v[20:23], v[240:243]
 s_waitcnt lgkmcnt(4)
 v_cvt_pk_bf16_f32 v160, v160, v161
 v_cvt_pk_bf16_f32 v161, v162, v163
 v_mfma_f32_16x16x32_bf16 v[180:183], a[104:107], v[16:19], v[180:183]
 v_cvt_pk_bf16_f32 v162, v164, v165
 v_cvt_pk_bf16_f32 v163, v166, v167
 v_mfma_f32_16x16x32_bf16 v[180:183], a[108:111], v[24:27], v[180:183]
 buffer_store_dwordx4 v[216:219], v1, s[12:15], s56 offen offset:3072 sc1
 v_mfma_f32_16x16x32_bf16 v[244:247], a[108:111], v[28:31], v[244:247]
 v_cvt_pk_bf16_f32 v224, v224, v225
 v_cvt_pk_bf16_f32 v225, v226, v227
 v_mfma_f32_16x16x32_bf16 v[244:247], a[104:107], v[20:23], v[244:247]
 s_waitcnt lgkmcnt(2)
 v_cvt_pk_bf16_f32 v226, v228, v229
 v_cvt_pk_bf16_f32 v227, v230, v231
 v_mfma_f32_16x16x32_bf16 v[184:187], a[112:115], v[16:19], v[184:187]
 v_cvt_pk_bf16_f32 v168, v168, v169
 v_cvt_pk_bf16_f32 v169, v170, v171
 v_mfma_f32_16x16x32_bf16 v[184:187], a[116:119], v[24:27], v[184:187]
 buffer_store_dwordx4 v[160:163], v4, s[12:15], s55 offen offset:0 sc1
 v_mfma_f32_16x16x32_bf16 v[248:251], a[116:119], v[28:31], v[248:251]
 v_cvt_pk_bf16_f32 v170, v172, v173
 v_cvt_pk_bf16_f32 v171, v174, v175
 v_mfma_f32_16x16x32_bf16 v[248:251], a[112:115], v[20:23], v[248:251]
 s_waitcnt lgkmcnt(0)
 v_cvt_pk_bf16_f32 v232, v232, v233
 v_cvt_pk_bf16_f32 v233, v234, v235
 v_mfma_f32_16x16x32_bf16 v[188:191], a[120:123], v[16:19], v[188:191]
 v_cvt_pk_bf16_f32 v234, v236, v237
 v_cvt_pk_bf16_f32 v235, v238, v239
 v_mfma_f32_16x16x32_bf16 v[188:191], a[124:127], v[24:27], v[188:191]
 buffer_store_dwordx4 v[224:227], v4, s[12:15], s56 offen offset:0 sc1
 v_mfma_f32_16x16x32_bf16 v[252:255], a[124:127], v[28:31], v[252:255]
 v_mfma_f32_16x16x32_bf16 v[252:255], a[120:123], v[20:23], v[252:255]
 ds_read_b64_tr_b16 a[0:1], v44 offset:0
 ds_read_b64_tr_b16 a[2:3], v44 offset:2048
 ds_read_b64_tr_b16 a[4:5], v44 offset:4096
 ds_read_b64_tr_b16 a[6:7], v44 offset:6144
 ds_read_b64_tr_b16 a[8:9], v44 offset:8192
 ds_read_b64_tr_b16 a[10:11], v44 offset:10240
 ds_read_b64_tr_b16 a[12:13], v44 offset:12288
 ds_read_b64_tr_b16 a[14:15], v44 offset:14336
 ds_read_b64_tr_b16 a[16:17], v44 offset:16384
 ds_read_b64_tr_b16 a[18:19], v44 offset:18432
 ds_read_b64_tr_b16 a[20:21], v44 offset:20480
 ds_read_b64_tr_b16 a[22:23], v44 offset:22528
 ds_read_b64_tr_b16 a[24:25], v44 offset:24576
 ds_read_b64_tr_b16 a[26:27], v44 offset:26624
 v_mov_b32 v68, v7
 v_mov_b32 v69, v8
 v_mov_b32 v70, v9
 v_mov_b32 v71, v10
 v_accvgpr_read_b32 v64, a200
 v_accvgpr_read_b32 v65, a201
 v_cvt_pk_bf16_f32 v176, v176, v177
 v_cvt_pk_bf16_f32 v177, v178, v179
 v_cvt_pk_bf16_f32 v178, v180, v181
 v_cvt_pk_bf16_f32 v179, v182, v183
 v_cvt_pk_bf16_f32 v240, v240, v241
 v_cvt_pk_bf16_f32 v241, v242, v243
 v_cvt_pk_bf16_f32 v242, v244, v245
 v_cvt_pk_bf16_f32 v243, v246, v247
 v_cvt_pk_bf16_f32 v184, v184, v185
 v_cvt_pk_bf16_f32 v185, v186, v187
 v_cvt_pk_bf16_f32 v186, v188, v189
 v_cvt_pk_bf16_f32 v187, v190, v191
 v_cvt_pk_bf16_f32 v248, v248, v249
 v_cvt_pk_bf16_f32 v249, v250, v251
 v_cvt_pk_bf16_f32 v250, v252, v253
 v_cvt_pk_bf16_f32 v251, v254, v255
 s_branch L_op0in
L_t1park:
 v_accvgpr_write_b32 a128, v128
 v_accvgpr_write_b32 a129, v129
 v_accvgpr_write_b32 a130, v130
 v_accvgpr_write_b32 a131, v131
 v_accvgpr_write_b32 a160, v192
 v_accvgpr_write_b32 a161, v193
 v_accvgpr_write_b32 a162, v194
 v_accvgpr_write_b32 a163, v195
 v_accvgpr_write_b32 a132, v136
 v_accvgpr_write_b32 a133, v137
 v_accvgpr_write_b32 a134, v138
 v_accvgpr_write_b32 a135, v139
 v_accvgpr_write_b32 a164, v200
 v_accvgpr_write_b32 a165, v201
 v_accvgpr_write_b32 a166, v202
 v_accvgpr_write_b32 a167, v203
 v_accvgpr_write_b32 a136, v144
 v_accvgpr_write_b32 a137, v145
 v_accvgpr_write_b32 a138, v146
 v_accvgpr_write_b32 a139, v147
 v_accvgpr_write_b32 a168, v208
 v_accvgpr_write_b32 a169, v209
 v_accvgpr_write_b32 a170, v210
 v_accvgpr_write_b32 a171, v211
 v_accvgpr_write_b32 a140, v152
 v_accvgpr_write_b32 a141, v153
 v_accvgpr_write_b32 a142, v154
 v_accvgpr_write_b32 a143, v155
 v_accvgpr_write_b32 a172, v216
 v_accvgpr_write_b32 a173, v217
 v_accvgpr_write_b32 a174, v218
 v_accvgpr_write_b32 a175, v219
 v_accvgpr_write_b32 a144, v160
 v_accvgpr_write_b32 a145, v161
 v_accvgpr_write_b32 a146, v162
 v_accvgpr_write_b32 a147, v163
 v_accvgpr_write_b32 a176, v224
 v_accvgpr_write_b32 a177, v225
 v_accvgpr_write_b32 a178, v226
 v_accvgpr_write_b32 a179, v227
 v_accvgpr_write_b32 a148, v168
 v_accvgpr_write_b32 a149, v169
 v_accvgpr_write_b32 a150, v170
 v_accvgpr_write_b32 a151, v171
 v_accvgpr_write_b32 a180, v232
 v_accvgpr_write_b32 a181, v233
 v_accvgpr_write_b32 a182, v234
 v_accvgpr_write_b32 a183, v235
 v_accvgpr_write_b32 a152, v176
 v_accvgpr_write_b32 a153, v177
 v_accvgpr_write_b32 a154, v178
 v_accvgpr_write_b32 a155, v179
 v_accvgpr_write_b32 a184, v240
 v_accvgpr_write_b32 a185, v241
 v_accvgpr_write_b32 a186, v242
 v_accvgpr_write_b32 a187, v243
 v_accvgpr_write_b32 a156, v184
 v_accvgpr_write_b32 a157, v185
 v_accvgpr_write_b32 a158, v186
 v_accvgpr_write_b32 a159, v187
 v_accvgpr_write_b32 a188, v248
 v_accvgpr_write_b32 a189, v249
 v_accvgpr_write_b32 a190, v250
 v_accvgpr_write_b32 a191, v251
 s_branch L_opB
L_tail2:
 v_accvgpr_read_b32 v11, a246
 s_mov_b32 s52, s55
 s_mov_b32 s53, s57
 v_readfirstlane_b32 s58, v11
 s_mov_b32 s59, 2.0
 s_nop 1
 s_cmp_eq_u32 s58, 0
 s_cselect_b32 s55, s55, 2.0
 s_cselect_b32 s57, s57, 2.0
 s_add_u32 s56, s55, 0x2000
 buffer_load_dwordx4 v[68:71], v1, s[12:15], s57 offen sc1
 s_waitcnt lgkmcnt(0)
 v_mfma_f32_16x16x32_bf16 v[128:131], a[64:67], v[16:19], v[128:131]
 ds_read_b128 a[96:99], v3 offset:4096
 v_mfma_f32_16x16x32_bf16 v[128:131], a[68:71], v[24:27], v[128:131]
 buffer_load_dwordx4 v[32:35], v1, s[12:15], s55 offen offset:0 sc1
 v_mfma_f32_16x16x32_bf16 v[192:195], a[68:71], v[28:31], v[192:195]
 ds_read_b128 a[100:103], v3 offset:20480
 v_mfma_f32_16x16x32_bf16 v[192:195], a[64:67], v[20:23], v[192:195]
 v_mov_b32 v72, v7
 v_mov_b32 v73, v8
 v_mfma_f32_16x16x32_bf16 v[132:135], a[72:75], v[16:19], v[132:135]
 ds_read_b128 a[104:107], v3 offset:5120
 v_mfma_f32_16x16x32_bf16 v[132:135], a[76:79], v[24:27], v[132:135]
 buffer_load_dwordx4 v[96:99], v1, s[12:15], s56 offen offset:0 sc1
 v_mfma_f32_16x16x32_bf16 v[196:199], a[76:79], v[28:31], v[196:199]
 ds_read_b128 a[108:111], v3 offset:21504
 v_mfma_f32_16x16x32_bf16 v[196:199], a[72:75], v[20:23], v[196:199]
 v_permlane32_swap_b32 v7, v72
 v_permlane32_swap_b32 v8, v73
 v_mfma_f32_16x16x32_bf16 v[136:139], a[80:83], v[16:19], v[136:139]
 ds_read_b128 a[112:115], v3 offset:6144
 v_mfma_f32_16x16x32_bf16 v[136:139], a[84:87], v[24:27], v[136:139]
 buffer_load_dwordx4 v[36:39], v1, s[12:15], s55 offen offset:1024 sc1
 v_mfma_f32_16x16x32_bf16 v[200:203], a[84:87], v[28:31], v[200:203]
 ds_read_b128 a[116:119], v3 offset:22528
 v_mfma_f32_16x16x32_bf16 v[200:203], a[80:83], v[20:23], v[200:203]
 v_add_f32 v7, v7, v72
 v_add_f32 v8, v8, v73
 v_mfma_f32_16x16x32_bf16 v[140:143], a[88:91], v[16:19], v[140:143]
 ds_read_b128 a[120:123], v3 offset:7168
 v_mfma_f32_16x16x32_bf16 v[140:143], a[92:95], v[24:27], v[140:143]
 buffer_load_dwordx4 v[100:103], v1, s[12:15], s56 offen offset:1024 sc1
 v_mfma_f32_16x16x32_bf16 v[204:207], a[92:95], v[28:31], v[204:207]
 ds_read_b128 a[124:127], v3 offset:23552
 v_mfma_f32_16x16x32_bf16 v[204:207], a[88:91], v[20:23], v[204:207]
 s_waitcnt lgkmcnt(6)
 v_mov_b32 v72, v7
 v_mov_b32 v73, v8
 v_mfma_f32_16x16x32_bf16 v[144:147], a[96:99], v[16:19], v[144:147]
 ds_read_b128 a[64:67], v3 offset:8192
 v_mfma_f32_16x16x32_bf16 v[144:147], a[100:103], v[24:27], v[144:147]
 buffer_load_dwordx4 v[40:43], v1, s[12:15], s55 offen offset:2048 sc1
 v_mfma_f32_16x16x32_bf16 v[208:211], a[100:103], v[28:31], v[208:211]
 ds_read_b128 a[68:71], v3 offset:24576
 v_mfma_f32_16x16x32_bf16 v[208:211], a[96:99], v[20:23], v[208:211]
 s_waitcnt lgkmcnt(6)
 v_permlane16_swap_b32 v7, v72
 v_permlane16_swap_b32 v8, v73
 v_mfma_f32_16x16x32_bf16 v[148:151], a[104:107], v[16:19], v[148:151]
 ds_read_b128 a[72:75], v3 offset:9216
 v_mfma_f32_16x16x32_bf16 v[148:151], a[108:111], v[24:27], v[148:151]
 buffer_load_dwordx4 v[104:107], v1, s[12:15], s56 offen offset:2048 sc1
 v_mfma_f32_16x16x32_bf16 v[212:215], a[108:111], v[28:31], v[212:215]
 ds_read_b128 a[76:79], v3 offset:25600
 v_mfma_f32_16x16x32_bf16 v[212:215], a[104:107], v[20:23], v[212:215]
 s_waitcnt lgkmcnt(6)
 v_add_f32 v7, v7, v72
 v_add_f32 v8, v8, v73
 v_mfma_f32_16x16x32_bf16 v[152:155], a[112:115], v[16:19], v[152:155]
 ds_read_b128 a[80:83], v3 offset:10240
 v_mfma_f32_16x16x32_bf16 v[152:155], a[116:119], v[24:27], v[152:155]
 buffer_load_dwordx4 v[44:47], v1, s[12:15], s55 offen offset:3072 sc1
 v_mfma_f32_16x16x32_bf16 v[216:219], a[116:119], v[28:31], v[216:219]
 ds_read_b128 a[84:87], v3 offset:26624
 v_mfma_f32_16x16x32_bf16 v[216:219], a[112:115], v[20:23], v[216:219]
 s_waitcnt lgkmcnt(6)
 v_mfma_f32_16x16x32_bf16 v[156:159], a[120:123], v[16:19], v[156:159]
 ds_read_b128 a[88:91], v3 offset:11264
 v_mfma_f32_16x16x32_bf16 v[156:159], a[124:127], v[24:27], v[156:159]
 buffer_load_dwordx4 v[108:111], v1, s[12:15], s56 offen offset:3072 sc1
 v_mfma_f32_16x16x32_bf16 v[220:223], a[124:127], v[28:31], v[220:223]
 ds_read_b128 a[92:95], v3 offset:27648
 v_mfma_f32_16x16x32_bf16 v[220:223], a[120:123], v[20:23], v[220:223]
 s_waitcnt lgkmcnt(6)
 v_mfma_f32_16x16x32_bf16 v[160:163], a[64:67], v[16:19], v[160:163]
 ds_read_b128 a[96:99], v3 offset:12288
 v_mfma_f32_16x16x32_bf16 v[160:163], a[68:71], v[24:27], v[160:163]
 buffer_load_dwordx4 v[48:51], v4, s[12:15], s55 offen offset:0 sc1
 v_mfma_f32_16x16x32_bf16 v[224:227], a[68:71], v[28:31], v[224:227]
 ds_read_b128 a[100:103], v3 offset:28672
 v_mfma_f32_16x16x32_bf16 v[224:227], a[64:67], v[20:23], v[224:227]
 s_waitcnt lgkmcnt(6)
 v_mfma_f32_16x16x32_bf16 v[164:167], a[72:75], v[16:19], v[164:167]
 ds_read_b128 a[104:107], v3 offset:13312
 v_mfma_f32_16x16x32_bf16 v[164:167], a[76:79], v[24:27], v[164:167]
 buffer_load_dwordx4 v[112:115], v4, s[12:15], s56 offen offset:0 sc1
 v_mfma_f32_16x16x32_bf16 v[228:231], a[76:79], v[28:31], v[228:231]
 ds_read_b128 a[108:111], v3 offset:29696
 v_mfma_f32_16x16x32_bf16 v[228:231], a[72:75], v[20:23], v[228:231]
 s_waitcnt lgkmcnt(6)
 v_mfma_f32_16x16x32_bf16 v[168:171], a[80:83], v[16:19], v[168:171]
 ds_read_b128 a[112:115], v3 offset:14336
 v_mfma_f32_16x16x32_bf16 v[168:171], a[84:87], v[24:27], v[168:171]
 buffer_load_dwordx4 v[52:55], v4, s[12:15], s55 offen offset:1024 sc1
 v_mfma_f32_16x16x32_bf16 v[232:235], a[84:87], v[28:31], v[232:235]
 ds_read_b128 a[116:119], v3 offset:30720
 v_mfma_f32_16x16x32_bf16 v[232:235], a[80:83], v[20:23], v[232:235]
 s_waitcnt lgkmcnt(6)
 v_mfma_f32_16x16x32_bf16 v[172:175], a[88:91], v[16:19], v[172:175]
 ds_read_b128 a[120:123], v3 offset:15360
 v_mfma_f32_16x16x32_bf16 v[172:175], a[92:95], v[24:27], v[172:175]
 buffer_load_dwordx4 v[116:119], v4, s[12:15], s56 offen offset:1024 sc1
 v_mfma_f32_16x16x32_bf16 v[236:239], a[92:95], v[28:31], v[236:239]
 ds_read_b128 a[124:127], v3 offset:31744
 v_mfma_f32_16x16x32_bf16 v[236:239], a[88:91], v[20:23], v[236:239]
 s_waitcnt lgkmcnt(6)
 v_mfma_f32_16x16x32_bf16 v[176:179], a[96:99], v[16:19], v[176:179]
 v_mfma_f32_16x16x32_bf16 v[176:179], a[100:103], v[24:27], v[176:179]
 buffer_load_dwordx4 v[56:59], v4, s[12:15], s55 offen offset:2048 sc1
 v_mfma_f32_16x16x32_bf16 v[240:243], a[100:103], v[28:31], v[240:243]
 v_mfma_f32_16x16x32_bf16 v[240:243], a[96:99], v[20:23], v[240:243]
 s_waitcnt lgkmcnt(4)
 v_mfma_f32_16x16x32_bf16 v[180:183], a[104:107], v[16:19], v[180:183]
 v_mfma_f32_16x16x32_bf16 v[180:183], a[108:111], v[24:27], v[180:183]
 buffer_load_dwordx4 v[120:123], v4, s[12:15], s56 offen offset:2048 sc1
 v_mfma_f32_16x16x32_bf16 v[244:247], a[108:111], v[28:31], v[244:247]
 v_mfma_f32_16x16x32_bf16 v[244:247], a[104:107], v[20:23], v[244:247]
 s_waitcnt lgkmcnt(2)
 v_mfma_f32_16x16x32_bf16 v[184:187], a[112:115], v[16:19], v[184:187]
 v_mfma_f32_16x16x32_bf16 v[184:187], a[116:119], v[24:27], v[184:187]
 buffer_load_dwordx4 v[60:63], v4, s[12:15], s55 offen offset:3072 sc1
 v_mfma_f32_16x16x32_bf16 v[248:251], a[116:119], v[28:31], v[248:251]
 v_mfma_f32_16x16x32_bf16 v[248:251], a[112:115], v[20:23], v[248:251]
 s_waitcnt lgkmcnt(0)
 v_mfma_f32_16x16x32_bf16 v[188:191], a[120:123], v[16:19], v[188:191]
 v_mfma_f32_16x16x32_bf16 v[188:191], a[124:127], v[24:27], v[188:191]
 v_mfma_f32_16x16x32_bf16 v[252:255], a[124:127], v[28:31], v[252:255]
 v_mfma_f32_16x16x32_bf16 v[252:255], a[120:123], v[20:23], v[252:255]
 buffer_load_dwordx4 v[124:127], v4, s[12:15], s56 offen offset:3072 sc1
 s_cmp_eq_u32 s58, 0
 s_cbranch_scc1 L_merge2
 v_and_b32 v11, 0, v0
 v_lshlrev_b32 v11, 2, v11
 s_mov_b32 s32, 0
L_poll5:
 buffer_load_dword v12, v11, s[12:15], s94 offen sc1
 s_waitcnt vmcnt(0)
 v_cmp_ne_u32 vcc, 0, v12
 s_cbranch_vccz L_poll5_ok
 s_sleep 6
 s_add_u32 s32, s32, 1
 s_cmp_lt_u32 s32, 0x80000
 s_cbranch_scc1 L_poll5
L_poll5_ok:
 s_mov_b32 s55, s52
 s_mov_b32 s57, s53
 s_add_u32 s56, s55, 0x2000
 buffer_load_dwordx4 v[68:71], v1, s[12:15], s57 offen sc1
 buffer_load_dwordx4 v[32:35], v1, s[12:15], s55 offen offset:0 sc1
 buffer_load_dwordx4 v[96:99], v1, s[12:15], s56 offen offset:0 sc1
 buffer_load_dwordx4 v[36:39], v1, s[12:15], s55 offen offset:1024 sc1
 buffer_load_dwordx4 v[100:103], v1, s[12:15], s56 offen offset:1024 sc1
 buffer_load_dwordx4 v[40:43], v1, s[12:15], s55 offen offset:2048 sc1
 buffer_load_dwordx4 v[104:107], v1, s[12:15], s56 offen offset:2048 sc1
 buffer_load_dwordx4 v[44:47], v1, s[12:15], s55 offen offset:3072 sc1
 buffer_load_dwordx4 v[108:111], v1, s[12:15], s56 offen offset:3072 sc1
 buffer_load_dwordx4 v[48:51], v4, s[12:15], s55 offen offset:0 sc1
 buffer_load_dwordx4 v[112:115], v4, s[12:15], s56 offen offset:0 sc1
 buffer_load_dwordx4 v[52:55], v4, s[12:15], s55 offen offset:1024 sc1
 buffer_load_dwordx4 v[116:119], v4, s[12:15], s56 offen offset:1024 sc1
 buffer_load_dwordx4 v[56:59], v4, s[12:15], s55 offen offset:2048 sc1
 buffer_load_dwordx4 v[120:123], v4, s[12:15], s56 offen offset:2048 sc1
 buffer_load_dwordx4 v[60:63], v4, s[12:15], s55 offen offset:3072 sc1
 buffer_load_dwordx4 v[124:127], v4, s[12:15], s56 offen offset:3072 sc1
L_merge2:
 s_waitcnt vmcnt(14)
 v_cmp_neq_f32 vcc, v70, v9
 v_cmp_neq_f32 s[20:21], v71, v10
 s_or_b64 vcc, vcc, s[20:21]
 s_cbranch_vccnz L_mslow
 v_mfma_f32_16x16x32_bf16 v[128:131], a[250:253], v[32:35], v[128:131]
 s_add_u32 m0, s29, 0
 v_add_f32 v7, v7, v68
 v_add_f32 v8, v8, v69
 v_mfma_f32_16x16x32_bf16 v[132:135], a[248:251], v[32:35], v[132:135]
 buffer_load_dwordx4 v2, s[8:11], s78 offen lds
 v_mfma_f32_16x16x32_bf16 v[192:195], a[250:253], v[96:99], v[192:195]
 v_rcp_f32 v64, v7
 v_mfma_f32_16x16x32_bf16 v[196:199], a[248:251], v[96:99], v[196:199]
 s_waitcnt vmcnt(13)
 v_rcp_f32 v65, v8
 v_mfma_f32_16x16x32_bf16 v[136:139], a[250:253], v[36:39], v[136:139]
 s_add_u32 m0, s29, 4096
 v_mfma_f32_16x16x32_bf16 v[140:143], a[248:251], v[36:39], v[140:143]
 buffer_load_dwordx4 v2, s[8:11], s79 offen lds
 v_mfma_f32_16x16x32_bf16 v[200:203], a[250:253], v[100:103], v[200:203]
 v_cvt_pk_bf16_f32 v128, v128, v129
 v_cvt_pk_bf16_f32 v129, v130, v131
 v_mfma_f32_16x16x32_bf16 v[204:207], a[248:251], v[100:103], v[204:207]
 s_waitcnt vmcnt(12)
 v_cvt_pk_bf16_f32 v130, v132, v133
 v_cvt_pk_bf16_f32 v131, v134, v135
 v_mfma_f32_16x16x32_bf16 v[144:147], a[250:253], v[40:43], v[144:147]
 s_add_u32 m0, s29, 8192
 v_cvt_pk_bf16_f32 v192, v192, v193
 v_cvt_pk_bf16_f32 v193, v194, v195
 v_mfma_f32_16x16x32_bf16 v[148:151], a[248:251], v[40:43], v[148:151]
 buffer_load_dwordx4 v2, s[8:11], s80 offen lds
 v_mfma_f32_16x16x32_bf16 v[208:211], a[250:253], v[104:107], v[208:211]
 v_cvt_pk_bf16_f32 v194, v196, v197
 v_cvt_pk_bf16_f32 v195, v198, v199
 v_mfma_f32_16x16x32_bf16 v[212:215], a[248:251], v[104:107], v[212:215]
 s_waitcnt vmcnt(11)
 v_cvt_pk_bf16_f32 v136, v136, v137
 v_cvt_pk_bf16_f32 v137, v138, v139
 v_mfma_f32_16x16x32_bf16 v[152:155], a[250:253], v[44:47], v[152:155]
 s_add_u32 m0, s29, 12288
 v_cvt_pk_bf16_f32 v138, v140, v141
 v_cvt_pk_bf16_f32 v139, v142, v143
 v_mfma_f32_16x16x32_bf16 v[156:159], a[248:251], v[44:47], v[156:159]
 buffer_load_dwordx4 v2, s[8:11], s81 offen lds
 v_mfma_f32_16x16x32_bf16 v[216:219], a[250:253], v[108:111], v[216:219]
 v_cvt_pk_bf16_f32 v200, v200, v201
 v_cvt_pk_bf16_f32 v201, v202, v203
 v_mfma_f32_16x16x32_bf16 v[220:223], a[248:251], v[108:111], v[220:223]
 s_waitcnt vmcnt(10)
 v_cvt_pk_bf16_f32 v202, v204, v205
 v_cvt_pk_bf16_f32 v203, v206, v207
 v_mfma_f32_16x16x32_bf16 v[160:163], a[250:253], v[48:51], v[160:163]
 s_add_u32 m0, s29, 16384
 v_cvt_pk_bf16_f32 v144, v144, v145
 v_cvt_pk_bf16_f32 v145, v146, v147
 v_mfma_f32_16x16x32_bf16 v[164:167], a[248:251], v[48:51], v[164:167]
 buffer_load_dwordx4 v2, s[8:11], s82 offen lds
 v_mfma_f32_16x16x32_bf16 v[224:227], a[250:253], v[112:115], v[224:227]
 v_cvt_pk_bf16_f32 v146, v148, v149
 v_cvt_pk_bf16_f32 v147, v150, v151
 v_mfma_f32_16x16x32_bf16 v[228:231], a[248:251], v[112:115], v[228:231]
 s_waitcnt vmcnt(9)
 v_cvt_pk_bf16_f32 v208, v208, v209
 v_cvt_pk_bf16_f32 v209, v210, v211
 v_mfma_f32_16x16x32_bf16 v[168:171], a[250:253], v[52:55], v[168:171]
 s_add_u32 m0, s29, 20480
 v_cvt_pk_bf16_f32 v210, v212, v213
 v_cvt_pk_bf16_f32 v211, v214, v215
 v_mfma_f32_16x16x32_bf16 v[172:175], a[248:251], v[52:55], v[172:175]
 buffer_load_dwordx4 v2, s[8:11], s83 offen lds
 v_mfma_f32_16x16x32_bf16 v[232:235], a[250:253], v[116:119], v[232:235]
 v_cvt_pk_bf16_f32 v152, v152, v153
 v_cvt_pk_bf16_f32 v153, v154, v155
 v_mfma_f32_16x16x32_bf16 v[236:239], a[248:251], v[116:119], v[236:239]
 s_waitcnt vmcnt(8)
 v_cvt_pk_bf16_f32 v154, v156, v157
 v_cvt_pk_bf16_f32 v155, v158, v159
 v_mfma_f32_16x16x32_bf16 v[176:179], a[250:253], v[56:59], v[176:179]
 s_add_u32 m0, s29, 24576
 v_cvt_pk_bf16_f32 v216, v216, v217
 v_cvt_pk_bf16_f32 v217, v218, v219
 v_mfma_f32_16x16x32_bf16 v[180:183], a[248:251], v[56:59], v[180:183]
 buffer_load_dwordx4 v2, s[8:11], s84 offen lds
 v_mfma_f32_16x16x32_bf16 v[240:243], a[250:253], v[120:123], v[240:243]
 v_cvt_pk_bf16_f32 v218, v220, v221
 v_cvt_pk_bf16_f32 v219, v222, v223
 v_mfma_f32_16x16x32_bf16 v[244:247], a[248:251], v[120:123], v[244:247]
 s_waitcnt vmcnt(7)
 v_cvt_pk_bf16_f32 v160, v160, v161
 v_cvt_pk_bf16_f32 v161, v162, v163
 v_mfma_f32_16x16x32_bf16 v[184:187], a[250:253], v[60:63], v[184:187]
 s_add_u32 m0, s29, 28672
 v_cvt_pk_bf16_f32 v162, v164, v165
 v_cvt_pk_bf16_f32 v163, v166, v167
 v_mfma_f32_16x16x32_bf16 v[188:191], a[248:251], v[60:63], v[188:191]
 buffer_load_dwordx4 v2, s[8:11], s85 offen lds
 v_mfma_f32_16x16x32_bf16 v[248:251], a[250:253], v[124:127], v[248:251]
 v_cvt_pk_bf16_f32 v224, v224, v225
 v_cvt_pk_bf16_f32 v225, v226, v227
 v_mfma_f32_16x16x32_bf16 v[252:255], a[248:251], v[124:127], v[252:255]
 v_cvt_pk_bf16_f32 v226, v228, v229
 v_cvt_pk_bf16_f32 v227, v230, v231
 v_add_u32 v2, 128, v2
 v_cvt_pk_bf16_f32 v168, v168, v169
 v_cvt_pk_bf16_f32 v169, v170, v171
 v_cvt_pk_bf16_f32 v170, v172, v173
 v_cvt_pk_bf16_f32 v171, v174, v175
 v_cvt_pk_bf16_f32 v232, v232, v233
 v_cvt_pk_bf16_f32 v233, v234, v235
 v_cvt_pk_bf16_f32 v234, v236, v237
 v_cvt_pk_bf16_f32 v235, v238, v239
 v_cvt_pk_bf16_f32 v176, v176, v177
 v_cvt_pk_bf16_f32 v177, v178, v179
 v_cvt_pk_bf16_f32 v178, v180, v181
 v_cvt_pk_bf16_f32 v179, v182, v183
 v_cvt_pk_bf16_f32 v240, v240, v241
 v_cvt_pk_bf16_f32 v241, v242, v243
 v_cvt_pk_bf16_f32 v242, v244, v245
 v_cvt_pk_bf16_f32 v243, v246, v247
 v_cvt_pk_bf16_f32 v184, v184, v185
 v_cvt_pk_bf16_f32 v185, v186, v187
 v_cvt_pk_bf16_f32 v186, v188, v189
 v_cvt_pk_bf16_f32 v187, v190, v191
 v_cvt_pk_bf16_f32 v248, v248, v249
 v_cvt_pk_bf16_f32 v249, v250, v251
 v_cvt_pk_bf16_f32 v250, v252, v253
 v_cvt_pk_bf16_f32 v251, v254, v255
 s_waitcnt vmcnt(0)
 s_branch L_attdone
L_mslow:
 s_add_u32 m0, s29, 0
 s_nop 0
 buffer_load_dwordx4 v2, s[8:11], s78 offen lds
 s_add_u32 m0, s29, 4096
 s_nop 0
 buffer_load_dwordx4 v2, s[8:11], s79 offen lds
 s_add_u32 m0, s29, 8192
 s_nop 0
 buffer_load_dwordx4 v2, s[8:11], s80 offen lds
 s_add_u32 m0, s29, 12288
 s_nop 0
 buffer_load_dwordx4 v2, s[8:11], s81 offen lds
 s_add_u32 m0, s29, 16384
 s_nop 0
 buffer_load_dwordx4 v2, s[8:11], s82 offen lds
 s_add_u32 m0, s29, 20480
 s_nop 0
 buffer_load_dwordx4 v2, s[8:11], s83 offen lds
 s_add_u32 m0, s29, 24576
 s_nop 0
 buffer_load_dwordx4 v2, s[8:11], s84 offen lds
 s_add_u32 m0, s29, 28672
 s_nop 0
 buffer_load_dwordx4 v2, s[8:11], s85 offen lds
 v_add_u32 v2, 128, v2
 s_mov_b32 s58, 0xffff0000
 s_waitcnt vmcnt(0)
 v_min_f32 v20, v70, v9
 v_sub_f32 v21, v20, v9
 v_sub_f32 v22, v20, v70
 v_exp_f32 v16, v21
 v_exp_f32 v18, v22
 s_nop 0
 v_mul_f32 v7, v7, v16
 v_fmac_f32 v7, v68, v18
 v_rcp_f32 v64, v7
 v_min_f32 v20, v71, v10
 v_sub_f32 v21, v20, v10
 v_sub_f32 v22, v20, v71
 v_exp_f32 v17, v21
 v_exp_f32 v19, v22
 s_nop 0
 v_mul_f32 v8, v8, v17
 v_fmac_f32 v8, v69, v19
 v_rcp_f32 v65, v8
 v_lshlrev_b32 v24, 16, v32
 v_and_b32 v25, s58, v32
 v_pk_mul_f32 v[24:25], v[24:25], v[18:19] op_sel:[0,0] op_sel_hi:[1,0]
 v_pk_fma_f32 v[128:129], v[128:129], v[16:17], v[24:25] op_sel:[0,0,0] op_sel_hi:[1,0,1]
 v_lshlrev_b32 v26, 16, v33
 v_and_b32 v27, s58, v33
 v_pk_mul_f32 v[26:27], v[26:27], v[18:19] op_sel:[0,0] op_sel_hi:[1,0]
 v_pk_fma_f32 v[130:131], v[130:131], v[16:17], v[26:27] op_sel:[0,0,0] op_sel_hi:[1,0,1]
 v_lshlrev_b32 v28, 16, v34
 v_and_b32 v29, s58, v34
 v_pk_mul_f32 v[28:29], v[28:29], v[18:19] op_sel:[0,0] op_sel_hi:[1,0]
 v_pk_fma_f32 v[132:133], v[132:133], v[16:17], v[28:29] op_sel:[0,0,0] op_sel_hi:[1,0,1]
 v_lshlrev_b32 v30, 16, v35
 v_and_b32 v31, s58, v35
 v_pk_mul_f32 v[30:31], v[30:31], v[18:19] op_sel:[0,0] op_sel_hi:[1,0]
 v_pk_fma_f32 v[134:135], v[134:135], v[16:17], v[30:31] op_sel:[0,0,0] op_sel_hi:[1,0,1]
 v_cvt_pk_bf16_f32 v128, v128, v129
 v_cvt_pk_bf16_f32 v129, v130, v131
 v_cvt_pk_bf16_f32 v130, v132, v133
 v_cvt_pk_bf16_f32 v131, v134, v135
 v_lshlrev_b32 v24, 16, v36
 v_and_b32 v25, s58, v36
 v_pk_mul_f32 v[24:25], v[24:25], v[18:19] op_sel:[0,0] op_sel_hi:[1,0]
 v_pk_fma_f32 v[136:137], v[136:137], v[16:17], v[24:25] op_sel:[0,0,0] op_sel_hi:[1,0,1]
 v_lshlrev_b32 v26, 16, v37
 v_and_b32 v27, s58, v37
 v_pk_mul_f32 v[26:27], v[26:27], v[18:19] op_sel:[0,0] op_sel_hi:[1,0]
 v_pk_fma_f32 v[138:139], v[138:139], v[16:17], v[26:27] op_sel:[0,0,0] op_sel_hi:[1,0,1]
 v_lshlrev_b32 v28, 16, v38
 v_and_b32 v29, s58, v38
 v_pk_mul_f32 v[28:29], v[28:29], v[18:19] op_sel:[0,0] op_sel_hi:[1,0]
 v_pk_fma_f32 v[140:141], v[140:141], v[16:17], v[28:29] op_sel:[0,0,0] op_sel_hi:[1,0,1]
 v_lshlrev_b32 v30, 16, v39
 v_and_b32 v31, s58, v39
 v_pk_mul_f32 v[30:31], v[30:31], v[18:19] op_sel:[0,0] op_sel_hi:[1,0]
 v_pk_fma_f32 v[142:143], v[142:143], v[16:17], v[30:31] op_sel:[0,0,0] op_sel_hi:[1,0,1]
 v_cvt_pk_bf16_f32 v136, v136, v137
 v_cvt_pk_bf16_f32 v137, v138, v139
 v_cvt_pk_bf16_f32 v138, v140, v141
 v_cvt_pk_bf16_f32 v139, v142, v143
 v_lshlrev_b32 v24, 16, v40
 v_and_b32 v25, s58, v40
 v_pk_mul_f32 v[24:25], v[24:25], v[18:19] op_sel:[0,0] op_sel_hi:[1,0]
 v_pk_fma_f32 v[144:145], v[144:145], v[16:17], v[24:25] op_sel:[0,0,0] op_sel_hi:[1,0,1]
 v_lshlrev_b32 v26, 16, v41
 v_and_b32 v27, s58, v41
 v_pk_mul_f32 v[26:27], v[26:27], v[18:19] op_sel:[0,0] op_sel_hi:[1,0]
 v_pk_fma_f32 v[146:147], v[146:147], v[16:17], v[26:27] op_sel:[0,0,0] op_sel_hi:[1,0,1]
 v_lshlrev_b32 v28, 16, v42
 v_and_b32 v29, s58, v42
 v_pk_mul_f32 v[28:29], v[28:29], v[18:19] op_sel:[0,0] op_sel_hi:[1,0]
 v_pk_fma_f32 v[148:149], v[148:149], v[16:17], v[28:29] op_sel:[0,0,0] op_sel_hi:[1,0,1]
 v_lshlrev_b32 v30, 16, v43
 v_and_b32 v31, s58, v43
 v_pk_mul_f32 v[30:31], v[30:31], v[18:19] op_sel:[0,0] op_sel_hi:[1,0]
 v_pk_fma_f32 v[150:151], v[150:151], v[16:17], v[30:31] op_sel:[0,0,0] op_sel_hi:[1,0,1]
 v_cvt_pk_bf16_f32 v144, v144, v145
 v_cvt_pk_bf16_f32 v145, v146, v147
 v_cvt_pk_bf16_f32 v146, v148, v149
 v_cvt_pk_bf16_f32 v147, v150, v151
 v_lshlrev_b32 v24, 16, v44
 v_and_b32 v25, s58, v44
 v_pk_mul_f32 v[24:25], v[24:25], v[18:19] op_sel:[0,0] op_sel_hi:[1,0]
 v_pk_fma_f32 v[152:153], v[152:153], v[16:17], v[24:25] op_sel:[0,0,0] op_sel_hi:[1,0,1]
 v_lshlrev_b32 v26, 16, v45
 v_and_b32 v27, s58, v45
 v_pk_mul_f32 v[26:27], v[26:27], v[18:19] op_sel:[0,0] op_sel_hi:[1,0]
 v_pk_fma_f32 v[154:155], v[154:155], v[16:17], v[26:27] op_sel:[0,0,0] op_sel_hi:[1,0,1]
 v_lshlrev_b32 v28, 16, v46
 v_and_b32 v29, s58, v46
 v_pk_mul_f32 v[28:29], v[28:29], v[18:19] op_sel:[0,0] op_sel_hi:[1,0]
 v_pk_fma_f32 v[156:157], v[156:157], v[16:17], v[28:29] op_sel:[0,0,0] op_sel_hi:[1,0,1]
 v_lshlrev_b32 v30, 16, v47
 v_and_b32 v31, s58, v47
 v_pk_mul_f32 v[30:31], v[30:31], v[18:19] op_sel:[0,0] op_sel_hi:[1,0]
 v_pk_fma_f32 v[158:159], v[158:159], v[16:17], v[30:31] op_sel:[0,0,0] op_sel_hi:[1,0,1]
 v_cvt_pk_bf16_f32 v152, v152, v153
 v_cvt_pk_bf16_f32 v153, v154, v155
 v_cvt_pk_bf16_f32 v154, v156, v157
 v_cvt_pk_bf16_f32 v155, v158, v159
 v_lshlrev_b32 v24, 16, v48
 v_and_b32 v25, s58, v48
 v_pk_mul_f32 v[24:25], v[24:25], v[18:19] op_sel:[0,0] op_sel_hi:[1,0]
 v_pk_fma_f32 v[160:161], v[160:161], v[16:17], v[24:25] op_sel:[0,0,0] op_sel_hi:[1,0,1]
 v_lshlrev_b32 v26, 16, v49
 v_and_b32 v27, s58, v49
 v_pk_mul_f32 v[26:27], v[26:27], v[18:19] op_sel:[0,0] op_sel_hi:[1,0]
 v_pk_fma_f32 v[162:163], v[162:163], v[16:17], v[26:27] op_sel:[0,0,0] op_sel_hi:[1,0,1]
 v_lshlrev_b32 v28, 16, v50
 v_and_b32 v29, s58, v50
 v_pk_mul_f32 v[28:29], v[28:29], v[18:19] op_sel:[0,0] op_sel_hi:[1,0]
 v_pk_fma_f32 v[164:165], v[164:165], v[16:17], v[28:29] op_sel:[0,0,0] op_sel_hi:[1,0,1]
 v_lshlrev_b32 v30, 16, v51
 v_and_b32 v31, s58, v51
 v_pk_mul_f32 v[30:31], v[30:31], v[18:19] op_sel:[0,0] op_sel_hi:[1,0]
 v_pk_fma_f32 v[166:167], v[166:167], v[16:17], v[30:31] op_sel:[0,0,0] op_sel_hi:[1,0,1]
 v_cvt_pk_bf16_f32 v160, v160, v161
 v_cvt_pk_bf16_f32 v161, v162, v163
 v_cvt_pk_bf16_f32 v162, v164, v165
 v_cvt_pk_bf16_f32 v163, v166, v167
 v_lshlrev_b32 v24, 16, v52
 v_and_b32 v25, s58, v52
 v_pk_mul_f32 v[24:25], v[24:25], v[18:19] op_sel:[0,0] op_sel_hi:[1,0]
 v_pk_fma_f32 v[168:169], v[168:169], v[16:17], v[24:25] op_sel:[0,0,0] op_sel_hi:[1,0,1]
 v_lshlrev_b32 v26, 16, v53
 v_and_b32 v27, s58, v53
 v_pk_mul_f32 v[26:27], v[26:27], v[18:19] op_sel:[0,0] op_sel_hi:[1,0]
 v_pk_fma_f32 v[170:171], v[170:171], v[16:17], v[26:27] op_sel:[0,0,0] op_sel_hi:[1,0,1]
 v_lshlrev_b32 v28, 16, v54
 v_and_b32 v29, s58, v54
 v_pk_mul_f32 v[28:29], v[28:29], v[18:19] op_sel:[0,0] op_sel_hi:[1,0]
 v_pk_fma_f32 v[172:173], v[172:173], v[16:17], v[28:29] op_sel:[0,0,0] op_sel_hi:[1,0,1]
 v_lshlrev_b32 v30, 16, v55
 v_and_b32 v31, s58, v55
 v_pk_mul_f32 v[30:31], v[30:31], v[18:19] op_sel:[0,0] op_sel_hi:[1,0]
 v_pk_fma_f32 v[174:175], v[174:175], v[16:17], v[30:31] op_sel:[0,0,0] op_sel_hi:[1,0,1]
 v_cvt_pk_bf16_f32 v168, v168, v169
 v_cvt_pk_bf16_f32 v169, v170, v171
 v_cvt_pk_bf16_f32 v170, v172, v173
 v_cvt_pk_bf16_f32 v171, v174, v175
 v_lshlrev_b32 v24, 16, v56
 v_and_b32 v25, s58, v56
 v_pk_mul_f32 v[24:25], v[24:25], v[18:19] op_sel:[0,0] op_sel_hi:[1,0]
 v_pk_fma_f32 v[176:177], v[176:177], v[16:17], v[24:25] op_sel:[0,0,0] op_sel_hi:[1,0,1]
 v_lshlrev_b32 v26, 16, v57
 v_and_b32 v27, s58, v57
 v_pk_mul_f32 v[26:27], v[26:27], v[18:19] op_sel:[0,0] op_sel_hi:[1,0]
 v_pk_fma_f32 v[178:179], v[178:179], v[16:17], v[26:27] op_sel:[0,0,0] op_sel_hi:[1,0,1]
 v_lshlrev_b32 v28, 16, v58
 v_and_b32 v29, s58, v58
 v_pk_mul_f32 v[28:29], v[28:29], v[18:19] op_sel:[0,0] op_sel_hi:[1,0]
 v_pk_fma_f32 v[180:181], v[180:181], v[16:17], v[28:29] op_sel:[0,0,0] op_sel_hi:[1,0,1]
 v_lshlrev_b32 v30, 16, v59
 v_and_b32 v31, s58, v59
 v_pk_mul_f32 v[30:31], v[30:31], v[18:19] op_sel:[0,0] op_sel_hi:[1,0]
 v_pk_fma_f32 v[182:183], v[182:183], v[16:17], v[30:31] op_sel:[0,0,0] op_sel_hi:[1,0,1]
 v_cvt_pk_bf16_f32 v176, v176, v177
 v_cvt_pk_bf16_f32 v177, v178, v179
 v_cvt_pk_bf16_f32 v178, v180, v181
 v_cvt_pk_bf16_f32 v179, v182, v183
 v_lshlrev_b32 v24, 16, v60
 v_and_b32 v25, s58, v60
 v_pk_mul_f32 v[24:25], v[24:25], v[18:19] op_sel:[0,0] op_sel_hi:[1,0]
 v_pk_fma_f32 v[184:185], v[184:185], v[16:17], v[24:25] op_sel:[0,0,0] op_sel_hi:[1,0,1]
 v_lshlrev_b32 v26, 16, v61
 v_and_b32 v27, s58, v61
 v_pk_mul_f32 v[26:27], v[26:27], v[18:19] op_sel:[0,0] op_sel_hi:[1,0]
 v_pk_fma_f32 v[186:187], v[186:187], v[16:17], v[26:27] op_sel:[0,0,0] op_sel_hi:[1,0,1]
 v_lshlrev_b32 v28, 16, v62
 v_and_b32 v29, s58, v62
 v_pk_mul_f32 v[28:29], v[28:29], v[18:19] op_sel:[0,0] op_sel_hi:[1,0]
 v_pk_fma_f32 v[188:189], v[188:189], v[16:17], v[28:29] op_sel:[0,0,0] op_sel_hi:[1,0,1]
 v_lshlrev_b32 v30, 16, v63
 v_and_b32 v31, s58, v63
 v_pk_mul_f32 v[30:31], v[30:31], v[18:19] op_sel:[0,0] op_sel_hi:[1,0]
 v_pk_fma_f32 v[190:191], v[190:191], v[16:17], v[30:31] op_sel:[0,0,0] op_sel_hi:[1,0,1]
 v_cvt_pk_bf16_f32 v184, v184, v185
 v_cvt_pk_bf16_f32 v185, v186, v187
 v_cvt_pk_bf16_f32 v186, v188, v189
 v_cvt_pk_bf16_f32 v187, v190, v191
 v_lshlrev_b32 v24, 16, v96
 v_and_b32 v25, s58, v96
 v_pk_mul_f32 v[24:25], v[24:25], v[18:19] op_sel:[0,1] op_sel_hi:[1,1]
 v_pk_fma_f32 v[192:193], v[192:193], v[16:17], v[24:25] op_sel:[0,1,0] op_sel_hi:[1,1,1]
 v_lshlrev_b32 v26, 16, v97
 v_and_b32 v27, s58, v97
 v_pk_mul_f32 v[26:27], v[26:27], v[18:19] op_sel:[0,1] op_sel_hi:[1,1]
 v_pk_fma_f32 v[194:195], v[194:195], v[16:17], v[26:27] op_sel:[0,1,0] op_sel_hi:[1,1,1]
 v_lshlrev_b32 v28, 16, v98
 v_and_b32 v29, s58, v98
 v_pk_mul_f32 v[28:29], v[28:29], v[18:19] op_sel:[0,1] op_sel_hi:[1,1]
 v_pk_fma_f32 v[196:197], v[196:197], v[16:17], v[28:29] op_sel:[0,1,0] op_sel_hi:[1,1,1]
 v_lshlrev_b32 v30, 16, v99
 v_and_b32 v31, s58, v99
 v_pk_mul_f32 v[30:31], v[30:31], v[18:19] op_sel:[0,1] op_sel_hi:[1,1]
 v_pk_fma_f32 v[198:199], v[198:199], v[16:17], v[30:31] op_sel:[0,1,0] op_sel_hi:[1,1,1]
 v_cvt_pk_bf16_f32 v192, v192, v193
 v_cvt_pk_bf16_f32 v193, v194, v195
 v_cvt_pk_bf16_f32 v194, v196, v197
 v_cvt_pk_bf16_f32 v195, v198, v199
 v_lshlrev_b32 v24, 16, v100
 v_and_b32 v25, s58, v100
 v_pk_mul_f32 v[24:25], v[24:25], v[18:19] op_sel:[0,1] op_sel_hi:[1,1]
 v_pk_fma_f32 v[200:201], v[200:201], v[16:17], v[24:25] op_sel:[0,1,0] op_sel_hi:[1,1,1]
 v_lshlrev_b32 v26, 16, v101
 v_and_b32 v27, s58, v101
 v_pk_mul_f32 v[26:27], v[26:27], v[18:19] op_sel:[0,1] op_sel_hi:[1,1]
 v_pk_fma_f32 v[202:203], v[202:203], v[16:17], v[26:27] op_sel:[0,1,0] op_sel_hi:[1,1,1]
 v_lshlrev_b32 v28, 16, v102
 v_and_b32 v29, s58, v102
 v_pk_mul_f32 v[28:29], v[28:29], v[18:19] op_sel:[0,1] op_sel_hi:[1,1]
 v_pk_fma_f32 v[204:205], v[204:205], v[16:17], v[28:29] op_sel:[0,1,0] op_sel_hi:[1,1,1]
 v_lshlrev_b32 v30, 16, v103
 v_and_b32 v31, s58, v103
 v_pk_mul_f32 v[30:31], v[30:31], v[18:19] op_sel:[0,1] op_sel_hi:[1,1]
 v_pk_fma_f32 v[206:207], v[206:207], v[16:17], v[30:31] op_sel:[0,1,0] op_sel_hi:[1,1,1]
 v_cvt_pk_bf16_f32 v200, v200, v201
 v_cvt_pk_bf16_f32 v201, v202, v203
 v_cvt_pk_bf16_f32 v202, v204, v205
 v_cvt_pk_bf16_f32 v203, v206, v207
 v_lshlrev_b32 v24, 16, v104
 v_and_b32 v25, s58, v104
 v_pk_mul_f32 v[24:25], v[24:25], v[18:19] op_sel:[0,1] op_sel_hi:[1,1]
 v_pk_fma_f32 v[208:209], v[208:209], v[16:17], v[24:25] op_sel:[0,1,0] op_sel_hi:[1,1,1]
 v_lshlrev_b32 v26, 16, v105
 v_and_b32 v27, s58, v105
 v_pk_mul_f32 v[26:27], v[26:27], v[18:19] op_sel:[0,1] op_sel_hi:[1,1]
 v_pk_fma_f32 v[210:211], v[210:211], v[16:17], v[26:27] op_sel:[0,1,0] op_sel_hi:[1,1,1]
 v_lshlrev_b32 v28, 16, v106
 v_and_b32 v29, s58, v106
 v_pk_mul_f32 v[28:29], v[28:29], v[18:19] op_sel:[0,1] op_sel_hi:[1,1]
 v_pk_fma_f32 v[212:213], v[212:213], v[16:17], v[28:29] op_sel:[0,1,0] op_sel_hi:[1,1,1]
 v_lshlrev_b32 v30, 16, v107
 v_and_b32 v31, s58, v107
 v_pk_mul_f32 v[30:31], v[30:31], v[18:19] op_sel:[0,1] op_sel_hi:[1,1]
 v_pk_fma_f32 v[214:215], v[214:215], v[16:17], v[30:31] op_sel:[0,1,0] op_sel_hi:[1,1,1]
 v_cvt_pk_bf16_f32 v208, v208, v209
 v_cvt_pk_bf16_f32 v209, v210, v211
 v_cvt_pk_bf16_f32 v210, v212, v213
 v_cvt_pk_bf16_f32 v211, v214, v215
 v_lshlrev_b32 v24, 16, v108
 v_and_b32 v25, s58, v108
 v_pk_mul_f32 v[24:25], v[24:25], v[18:19] op_sel:[0,1] op_sel_hi:[1,1]
 v_pk_fma_f32 v[216:217], v[216:217], v[16:17], v[24:25] op_sel:[0,1,0] op_sel_hi:[1,1,1]
 v_lshlrev_b32 v26, 16, v109
 v_and_b32 v27, s58, v109
 v_pk_mul_f32 v[26:27], v[26:27], v[18:19] op_sel:[0,1] op_sel_hi:[1,1]
 v_pk_fma_f32 v[218:219], v[218:219], v[16:17], v[26:27] op_sel:[0,1,0] op_sel_hi:[1,1,1]
 v_lshlrev_b32 v28, 16, v110
 v_and_b32 v29, s58, v110
 v_pk_mul_f32 v[28:29], v[28:29], v[18:19] op_sel:[0,1] op_sel_hi:[1,1]
 v_pk_fma_f32 v[220:221], v[220:221], v[16:17], v[28:29] op_sel:[0,1,0] op_sel_hi:[1,1,1]
 v_lshlrev_b32 v30, 16, v111
 v_and_b32 v31, s58, v111
 v_pk_mul_f32 v[30:31], v[30:31], v[18:19] op_sel:[0,1] op_sel_hi:[1,1]
 v_pk_fma_f32 v[222:223], v[222:223], v[16:17], v[30:31] op_sel:[0,1,0] op_sel_hi:[1,1,1]
 v_cvt_pk_bf16_f32 v216, v216, v217
 v_cvt_pk_bf16_f32 v217, v218, v219
 v_cvt_pk_bf16_f32 v218, v220, v221
 v_cvt_pk_bf16_f32 v219, v222, v223
 v_lshlrev_b32 v24, 16, v112
 v_and_b32 v25, s58, v112
 v_pk_mul_f32 v[24:25], v[24:25], v[18:19] op_sel:[0,1] op_sel_hi:[1,1]
 v_pk_fma_f32 v[224:225], v[224:225], v[16:17], v[24:25] op_sel:[0,1,0] op_sel_hi:[1,1,1]
 v_lshlrev_b32 v26, 16, v113
 v_and_b32 v27, s58, v113
 v_pk_mul_f32 v[26:27], v[26:27], v[18:19] op_sel:[0,1] op_sel_hi:[1,1]
 v_pk_fma_f32 v[226:227], v[226:227], v[16:17], v[26:27] op_sel:[0,1,0] op_sel_hi:[1,1,1]
 v_lshlrev_b32 v28, 16, v114
 v_and_b32 v29, s58, v114
 v_pk_mul_f32 v[28:29], v[28:29], v[18:19] op_sel:[0,1] op_sel_hi:[1,1]
 v_pk_fma_f32 v[228:229], v[228:229], v[16:17], v[28:29] op_sel:[0,1,0] op_sel_hi:[1,1,1]
 v_lshlrev_b32 v30, 16, v115
 v_and_b32 v31, s58, v115
 v_pk_mul_f32 v[30:31], v[30:31], v[18:19] op_sel:[0,1] op_sel_hi:[1,1]
 v_pk_fma_f32 v[230:231], v[230:231], v[16:17], v[30:31] op_sel:[0,1,0] op_sel_hi:[1,1,1]
 v_cvt_pk_bf16_f32 v224, v224, v225
 v_cvt_pk_bf16_f32 v225, v226, v227
 v_cvt_pk_bf16_f32 v226, v228, v229
 v_cvt_pk_bf16_f32 v227, v230, v231
 v_lshlrev_b32 v24, 16, v116
 v_and_b32 v25, s58, v116
 v_pk_mul_f32 v[24:25], v[24:25], v[18:19] op_sel:[0,1] op_sel_hi:[1,1]
 v_pk_fma_f32 v[232:233], v[232:233], v[16:17], v[24:25] op_sel:[0,1,0] op_sel_hi:[1,1,1]
 v_lshlrev_b32 v26, 16, v117
 v_and_b32 v27, s58, v117
 v_pk_mul_f32 v[26:27], v[26:27], v[18:19] op_sel:[0,1] op_sel_hi:[1,1]
 v_pk_fma_f32 v[234:235], v[234:235], v[16:17], v[26:27] op_sel:[0,1,0] op_sel_hi:[1,1,1]
 v_lshlrev_b32 v28, 16, v118
 v_and_b32 v29, s58, v118
 v_pk_mul_f32 v[28:29], v[28:29], v[18:19] op_sel:[0,1] op_sel_hi:[1,1]
 v_pk_fma_f32 v[236:237], v[236:237], v[16:17], v[28:29] op_sel:[0,1,0] op_sel_hi:[1,1,1]
 v_lshlrev_b32 v30, 16, v119
 v_and_b32 v31, s58, v119
 v_pk_mul_f32 v[30:31], v[30:31], v[18:19] op_sel:[0,1] op_sel_hi:[1,1]
 v_pk_fma_f32 v[238:239], v[238:239], v[16:17], v[30:31] op_sel:[0,1,0] op_sel_hi:[1,1,1]
 v_cvt_pk_bf16_f32 v232, v232, v233
 v_cvt_pk_bf16_f32 v233, v234, v235
 v_cvt_pk_bf16_f32 v234, v236, v237
 v_cvt_pk_bf16_f32 v235, v238, v239
 v_lshlrev_b32 v24, 16, v120
 v_and_b32 v25, s58, v120
 v_pk_mul_f32 v[24:25], v[24:25], v[18:19] op_sel:[0,1] op_sel_hi:[1,1]
 v_pk_fma_f32 v[240:241], v[240:241], v[16:17], v[24:25] op_sel:[0,1,0] op_sel_hi:[1,1,1]
 v_lshlrev_b32 v26, 16, v121
 v_and_b32 v27, s58, v121
 v_pk_mul_f32 v[26:27], v[26:27], v[18:19] op_sel:[0,1] op_sel_hi:[1,1]
 v_pk_fma_f32 v[242:243], v[242:243], v[16:17], v[26:27] op_sel:[0,1,0] op_sel_hi:[1,1,1]
 v_lshlrev_b32 v28, 16, v122
 v_and_b32 v29, s58, v122
 v_pk_mul_f32 v[28:29], v[28:29], v[18:19] op_sel:[0,1] op_sel_hi:[1,1]
 v_pk_fma_f32 v[244:245], v[244:245], v[16:17], v[28:29] op_sel:[0,1,0] op_sel_hi:[1,1,1]
 v_lshlrev_b32 v30, 16, v123
 v_and_b32 v31, s58, v123
 v_pk_mul_f32 v[30:31], v[30:31], v[18:19] op_sel:[0,1] op_sel_hi:[1,1]
 v_pk_fma_f32 v[246:247], v[246:247], v[16:17], v[30:31] op_sel:[0,1,0] op_sel_hi:[1,1,1]
 v_cvt_pk_bf16_f32 v240, v240, v241
 v_cvt_pk_bf16_f32 v241, v242, v243
 v_cvt_pk_bf16_f32 v242, v244, v245
 v_cvt_pk_bf16_f32 v243, v246, v247
 v_lshlrev_b32 v24, 16, v124
 v_and_b32 v25, s58, v124
 v_pk_mul_f32 v[24:25], v[24:25], v[18:19] op_sel:[0,1] op_sel_hi:[1,1]
 v_pk_fma_f32 v[248:249], v[248:249], v[16:17], v[24:25] op_sel:[0,1,0] op_sel_hi:[1,1,1]
 v_lshlrev_b32 v26, 16, v125
 v_and_b32 v27, s58, v125
 v_pk_mul_f32 v[26:27], v[26:27], v[18:19] op_sel:[0,1] op_sel_hi:[1,1]
 v_pk_fma_f32 v[250:251], v[250:251], v[16:17], v[26:27] op_sel:[0,1,0] op_sel_hi:[1,1,1]
 v_lshlrev_b32 v28, 16, v126
 v_and_b32 v29, s58, v126
 v_pk_mul_f32 v[28:29], v[28:29], v[18:19] op_sel:[0,1] op_sel_hi:[1,1]
 v_pk_fma_f32 v[252:253], v[252:253], v[16:17], v[28:29] op_sel:[0,1,0] op_sel_hi:[1,1,1]
 v_lshlrev_b32 v30, 16, v127
 v_and_b32 v31, s58, v127
 v_pk_mul_f32 v[30:31], v[30:31], v[18:19] op_sel:[0,1] op_sel_hi:[1,1]
 v_pk_fma_f32 v[254:255], v[254:255], v[16:17], v[30:31] op_sel:[0,1,0] op_sel_hi:[1,1,1]
 v_cvt_pk_bf16_f32 v248, v248, v249
 v_cvt_pk_bf16_f32 v249, v250, v251
 v_cvt_pk_bf16_f32 v250, v252, v253
 v_cvt_pk_bf16_f32 v251, v254, v255
L_attdone:
 v_accvgpr_read_b32 v44, a254
 ds_read_b64_tr_b16 a[160:161], v44 offset:0
 ds_read_b64_tr_b16 a[162:163], v44 offset:2048
 ds_read_b64_tr_b16 a[164:165], v44 offset:4096
 ds_read_b64_tr_b16 a[166:167], v44 offset:6144
 ds_read_b64_tr_b16 a[168:169], v44 offset:8192
 ds_read_b64_tr_b16 a[170:171], v44 offset:10240
 ds_read_b64_tr_b16 a[172:173], v44 offset:12288
 ds_read_b64_tr_b16 a[174:175], v44 offset:14336
 ds_read_b64_tr_b16 a[176:177], v44 offset:16384
 ds_read_b64_tr_b16 a[178:179], v44 offset:18432
 ds_read_b64_tr_b16 a[180:181], v44 offset:20480
 ds_read_b64_tr_b16 a[182:183], v44 offset:22528
 ds_read_b64_tr_b16 a[184:185], v44 offset:24576
 ds_read_b64_tr_b16 a[186:187], v44 offset:26624
L_op1in:
 s_waitcnt lgkmcnt(7)
 v_mfma_f32_16x16x32_bf16 v[72:75], a[160:163], v[128:131], 0
 s_lshl_b32 s48, s63, 3
 ds_read_b64_tr_b16 a[188:189], v44 offset:28672
 v_xor_b32 v45, 32, v44
 v_mfma_f32_16x16x32_bf16 v[72:75], a[164:167], v[136:139], v[72:75]
 s_add_u32 s48, s48, s3
 ds_read_b64_tr_b16 a[190:191], v44 offset:30720
 v_xor_b32 v46, 64, v44
 v_mfma_f32_16x16x32_bf16 v[72:75], a[168:171], v[144:147], v[72:75]
 s_waitcnt lgkmcnt(4)
 ds_read_b64_tr_b16 a[192:193], v45 offset:0
 v_xor_b32 v47, 96, v44
 v_mfma_f32_16x16x32_bf16 v[72:75], a[172:175], v[152:155], v[72:75]
 s_add_u32 m0, s29, 32768
 ds_read_b64_tr_b16 a[194:195], v45 offset:2048
 v_accvgpr_read_b32 v9, a245
 v_mfma_f32_16x16x32_bf16 v[72:75], a[176:179], v[160:163], v[72:75]
 ds_read_b64_tr_b16 a[196:197], v45 offset:4096
 buffer_load_dwordx4 v2, s[8:11], s78 offen lds
 v_mfma_f32_16x16x32_bf16 v[72:75], a[180:183], v[168:171], v[72:75]
 s_waitcnt lgkmcnt(3)
 ds_read_b64_tr_b16 a[198:199], v45 offset:6144
 v_mfma_f32_16x16x32_bf16 v[72:75], a[184:187], v[176:179], v[72:75]
 s_mul_i32 s48, s48, 243712
 ds_read_b64_tr_b16 a[200:201], v45 offset:8192
 v_mfma_f32_16x16x32_bf16 v[72:75], a[188:191], v[184:187], v[72:75]
 s_lshl_b32 s58, s26, 10
 ds_read_b64_tr_b16 a[202:203], v45 offset:10240
 v_mfma_f32_16x16x32_bf16 v[80:83], a[160:163], v[192:195], 0
 s_add_u32 s48, s48, s58
 ds_read_b64_tr_b16 a[204:205], v45 offset:12288
 v_mfma_f32_16x16x32_bf16 v[80:83], a[164:167], v[200:203], v[80:83]
 s_add_u32 s48, s48, 117440512
 ds_read_b64_tr_b16 a[206:207], v45 offset:14336
 v_mfma_f32_16x16x32_bf16 v[80:83], a[168:171], v[208:211], v[80:83]
 s_add_u32 m0, s29, 36864
 ds_read_b64_tr_b16 a[208:209], v45 offset:16384
 v_mfma_f32_16x16x32_bf16 v[80:83], a[172:175], v[216:219], v[80:83]
 ds_read_b64_tr_b16 a[210:211], v45 offset:18432
 buffer_load_dwordx4 v2, s[8:11], s79 offen lds
 v_mfma_f32_16x16x32_bf16 v[80:83], a[176:179], v[224:227], v[80:83]
 ds_read_b64_tr_b16 a[212:213], v45 offset:20480
 v_and_b32 v10, 15, v0
 v_mfma_f32_16x16x32_bf16 v[80:83], a[180:183], v[232:235], v[80:83]
 ds_read_b64_tr_b16 a[214:215], v45 offset:22528
 v_mul_f32 v72, v72, v64
 v_mfma_f32_16x16x32_bf16 v[80:83], a[184:187], v[240:243], v[80:83]
 ds_read_b64_tr_b16 a[216:217], v45 offset:24576
 v_lshlrev_b32 v10, 2, v10
 v_mfma_f32_16x16x32_bf16 v[80:83], a[188:191], v[248:251], v[80:83]
 s_waitcnt lgkmcnt(7)
 ds_read_b64_tr_b16 a[218:219], v45 offset:26624
 v_mul_f32 v73, v73, v64
 v_mfma_f32_16x16x32_bf16 v[76:79], a[192:195], v[128:131], 0
 s_cmp_lt_u32 s28, 14
 s_cselect_b32 s52, 0, 1
 ds_read_b64_tr_b16 a[220:221], v45 offset:28672
 v_mfma_f32_16x16x32_bf16 v[76:79], a[196:199], v[136:139], v[76:79]
 s_add_u32 m0, s29, 40960
 ds_read_b64_tr_b16 a[222:223], v45 offset:30720
 v_mul_f32 v74, v74, v64
 v_mfma_f32_16x16x32_bf16 v[76:79], a[200:203], v[144:147], v[76:79]
 s_waitcnt lgkmcnt(4)
 ds_read_b64_tr_b16 a[160:161], v46 offset:0
 buffer_load_dwordx4 v2, s[8:11], s80 offen lds
 v_mfma_f32_16x16x32_bf16 v[76:79], a[204:207], v[152:155], v[76:79]
 s_mov_b32 s53, 0
 ds_read_b64_tr_b16 a[162:163], v46 offset:2048
 v_mul_f32 v75, v75, v64
 v_mfma_f32_16x16x32_bf16 v[76:79], a[208:211], v[160:163], v[76:79]
 ds_read_b64_tr_b16 a[164:165], v46 offset:4096
 v_mul_f32 v80, v80, v65
 v_mfma_f32_16x16x32_bf16 v[76:79], a[212:215], v[168:171], v[76:79]
 s_waitcnt lgkmcnt(3)
 ds_read_b64_tr_b16 a[166:167], v46 offset:6144
 v_mul_f32 v81, v81, v65
 v_mfma_f32_16x16x32_bf16 v[76:79], a[216:219], v[176:179], v[76:79]
 ds_read_b64_tr_b16 a[168:169], v46 offset:8192
 v_mul_f32 v82, v82, v65
 v_mfma_f32_16x16x32_bf16 v[76:79], a[220:223], v[184:187], v[76:79]
 ds_read_b64_tr_b16 a[170:171], v46 offset:10240
 v_mul_f32 v83, v83, v65
 v_mfma_f32_16x16x32_bf16 v[84:87], a[192:195], v[192:195], 0
 s_add_u32 m0, s29, 45056
 ds_read_b64_tr_b16 a[172:173], v46 offset:12288
 v_mfma_f32_16x16x32_bf16 v[84:87], a[196:199], v[200:203], v[84:87]
 ds_read_b64_tr_b16 a[174:175], v46 offset:14336
 buffer_load_dwordx4 v2, s[8:11], s81 offen lds
 v_mfma_f32_16x16x32_bf16 v[84:87], a[200:203], v[208:211], v[84:87]
 ds_read_b64_tr_b16 a[176:177], v46 offset:16384
 v_mfma_f32_16x16x32_bf16 v[84:87], a[204:207], v[216:219], v[84:87]
 ds_read_b64_tr_b16 a[178:179], v46 offset:18432
 v_mfma_f32_16x16x32_bf16 v[84:87], a[208:211], v[224:227], v[84:87]
 ds_read_b64_tr_b16 a[180:181], v46 offset:20480
 v_mul_f32 v76, v76, v64
 v_mfma_f32_16x16x32_bf16 v[84:87], a[212:215], v[232:235], v[84:87]
 ds_read_b64_tr_b16 a[182:183], v46 offset:22528
 v_mul_f32 v77, v77, v64
 v_mfma_f32_16x16x32_bf16 v[84:87], a[216:219], v[240:243], v[84:87]
 s_add_u32 m0, s29, 49152
 ds_read_b64_tr_b16 a[184:185], v46 offset:24576
 v_mul_f32 v78, v78, v64
 v_mfma_f32_16x16x32_bf16 v[84:87], a[220:223], v[248:251], v[84:87]
 s_waitcnt lgkmcnt(7)
 ds_read_b64_tr_b16 a[186:187], v46 offset:26624
 v_mul_f32 v79, v79, v64
 v_mfma_f32_16x16x32_bf16 v[88:91], a[160:163], v[128:131], 0
 ds_read_b64_tr_b16 a[188:189], v46 offset:28672
 buffer_load_dwordx4 v2, s[8:11], s82 offen lds
 v_mfma_f32_16x16x32_bf16 v[88:91], a[164:167], v[136:139], v[88:91]
 s_lshl_b32 s44, s24, 7
 ds_read_b64_tr_b16 a[190:191], v46 offset:30720
 v_cvt_pk_bf16_f32 v72, v72, v73
 v_mfma_f32_16x16x32_bf16 v[88:91], a[168:171], v[144:147], v[88:91]
 s_waitcnt lgkmcnt(4)
 ds_read_b64_tr_b16 a[192:193], v47 offset:0
 v_cvt_pk_bf16_f32 v73, v74, v75
 v_mfma_f32_16x16x32_bf16 v[88:91], a[172:175], v[152:155], v[88:91]
 s_add_u32 s44, s44, 84938752
 ds_read_b64_tr_b16 a[194:195], v47 offset:2048
 v_cvt_pk_bf16_f32 v74, v76, v77
 v_mfma_f32_16x16x32_bf16 v[88:91], a[176:179], v[160:163], v[88:91]
 s_add_u32 s58, s48, 0
 ds_read_b64_tr_b16 a[196:197], v47 offset:4096
 v_cvt_pk_bf16_f32 v75, v78, v79
 v_mfma_f32_16x16x32_bf16 v[88:91], a[180:183], v[168:171], v[88:91]
 s_waitcnt lgkmcnt(3)
 ds_read_b64_tr_b16 a[198:199], v47 offset:6144
 buffer_store_dwordx4 v[72:75], v1, s[12:15], s58 offen sc1
 v_mfma_f32_16x16x32_bf16 v[88:91], a[184:187], v[176:179], v[88:91]
 s_add_u32 m0, s29, 53248
 ds_read_b64_tr_b16 a[200:201], v47 offset:8192
 v_mul_f32 v84, v84, v65
 v_mfma_f32_16x16x32_bf16 v[88:91], a[188:191], v[184:187], v[88:91]
 ds_read_b64_tr_b16 a[202:203], v47 offset:10240
 buffer_load_dwordx4 v2, s[8:11], s83 offen lds
 v_mfma_f32_16x16x32_bf16 v[96:99], a[160:163], v[192:195], 0
 s_lshl_b32 s40, s24, 1
 ds_read_b64_tr_b16 a[204:205], v47 offset:12288
 v_mul_f32 v85, v85, v65
 v_mfma_f32_16x16x32_bf16 v[96:99], a[164:167], v[200:203], v[96:99]
 s_and_b32 s41, s28, 1
 ds_read_b64_tr_b16 a[206:207], v47 offset:14336
 v_mul_f32 v86, v86, v65
 v_mfma_f32_16x16x32_bf16 v[96:99], a[168:171], v[208:211], v[96:99]
 s_add_u32 s40, s40, s41
 ds_read_b64_tr_b16 a[208:209], v47 offset:16384
 v_mul_f32 v87, v87, v65
 v_mfma_f32_16x16x32_bf16 v[96:99], a[172:175], v[216:219], v[96:99]
 s_lshr_b32 s41, s28, 1
 ds_read_b64_tr_b16 a[210:211], v47 offset:18432
 v_cvt_pk_bf16_f32 v80, v80, v81
 v_mfma_f32_16x16x32_bf16 v[96:99], a[176:179], v[224:227], v[96:99]
 s_lshl_b32 s42, s40, 2
 ds_read_b64_tr_b16 a[212:213], v47 offset:20480
 v_cvt_pk_bf16_f32 v81, v82, v83
 v_mfma_f32_16x16x32_bf16 v[96:99], a[180:183], v[232:235], v[96:99]
 s_add_u32 m0, s29, 57344
 ds_read_b64_tr_b16 a[214:215], v47 offset:22528
 v_cvt_pk_bf16_f32 v82, v84, v85
 v_mfma_f32_16x16x32_bf16 v[96:99], a[184:187], v[240:243], v[96:99]
 ds_read_b64_tr_b16 a[216:217], v47 offset:24576
 buffer_load_dwordx4 v2, s[8:11], s84 offen lds
 v_mfma_f32_16x16x32_bf16 v[96:99], a[188:191], v[248:251], v[96:99]
 s_waitcnt lgkmcnt(7)
 ds_read_b64_tr_b16 a[218:219], v47 offset:26624
 v_cvt_pk_bf16_f32 v83, v86, v87
 v_mfma_f32_16x16x32_bf16 v[92:95], a[192:195], v[128:131], 0
 s_waitcnt vmcnt(8)
 ds_read_b64_tr_b16 a[220:221], v47 offset:28672
 v_mul_f32 v88, v88, v64
 v_mfma_f32_16x16x32_bf16 v[92:95], a[196:199], v[136:139], v[92:95]
 s_barrier
 ds_read_b64_tr_b16 a[222:223], v47 offset:30720
 v_xor_b32 v44, 0x20000, v44
 v_mfma_f32_16x16x32_bf16 v[92:95], a[200:203], v[144:147], v[92:95]
 s_waitcnt lgkmcnt(4)
 ds_read_b64_tr_b16 a[160:161], v44 offset:0
 v_mul_f32 v89, v89, v64
 v_mfma_f32_16x16x32_bf16 v[92:95], a[204:207], v[152:155], v[92:95]
 s_add_u32 s42, s42, s3
 ds_read_b64_tr_b16 a[162:163], v44 offset:2048
 v_mul_f32 v90, v90, v64
 v_mfma_f32_16x16x32_bf16 v[92:95], a[208:211], v[160:163], v[92:95]
 s_add_u32 m0, s29, 61440
 ds_read_b64_tr_b16 a[164:165], v44 offset:4096
 v_mul_f32 v91, v91, v64
 v_mfma_f32_16x16x32_bf16 v[92:95], a[212:215], v[168:171], v[92:95]
 s_waitcnt lgkmcnt(3)
 ds_read_b64_tr_b16 a[166:167], v44 offset:6144
 buffer_load_dwordx4 v2, s[8:11], s85 offen lds
 v_mfma_f32_16x16x32_bf16 v[92:95], a[216:219], v[176:179], v[92:95]
 s_add_u32 s58, s48, 974848
 ds_read_b64_tr_b16 a[168:169], v44 offset:8192
 v_add_u32 v2, 128, v2
 v_mfma_f32_16x16x32_bf16 v[92:95], a[220:223], v[184:187], v[92:95]
 ds_read_b64_tr_b16 a[170:171], v44 offset:10240
 buffer_store_dwordx4 v[80:83], v1, s[12:15], s58 offen sc1
 v_mfma_f32_16x16x32_bf16 v[100:103], a[192:195], v[192:195], 0
 s_mul_i32 s37, s42, 243712
 ds_read_b64_tr_b16 a[172:173], v44 offset:12288
 v_mul_f32 v96, v96, v65
 v_mfma_f32_16x16x32_bf16 v[100:103], a[196:199], v[200:203], v[100:103]
 s_mul_i32 s43, s41, 17408
 ds_read_b64_tr_b16 a[174:175], v44 offset:14336
 v_mul_f32 v97, v97, v65
 v_mfma_f32_16x16x32_bf16 v[100:103], a[200:203], v[208:211], v[100:103]
 s_add_u32 s37, s37, s43
 ds_read_b64_tr_b16 a[176:177], v44 offset:16384
 v_mul_f32 v98, v98, v65
 v_mfma_f32_16x16x32_bf16 v[100:103], a[204:207], v[216:219], v[100:103]
 s_add_u32 s37, s37, 117440512
 ds_read_b64_tr_b16 a[178:179], v44 offset:18432
 v_mul_f32 v99, v99, v65
 v_mfma_f32_16x16x32_bf16 v[100:103], a[208:211], v[224:227], v[100:103]
 s_add_u32 s38, s37, 121856
 ds_read_b64_tr_b16 a[180:181], v44 offset:20480
 v_mul_f32 v92, v92, v64
 v_mfma_f32_16x16x32_bf16 v[100:103], a[212:215], v[232:235], v[100:103]
 ds_read_b64_tr_b16 a[182:183], v44 offset:22528
 v_mul_f32 v93, v93, v64
 v_mfma_f32_16x16x32_bf16 v[100:103], a[216:219], v[240:243], v[100:103]
 ds_read_b64_tr_b16 a[184:185], v44 offset:24576
 v_mul_f32 v94, v94, v64
 v_mfma_f32_16x16x32_bf16 v[100:103], a[220:223], v[248:251], v[100:103]
 s_waitcnt lgkmcnt(7)
 ds_read_b64_tr_b16 a[186:187], v44 offset:26624
 v_mul_f32 v95, v95, v64
 v_mfma_f32_16x16x32_bf16 v[104:107], a[160:163], v[128:131], 0
 ds_read_b64_tr_b16 a[188:189], v44 offset:28672
 v_cvt_pk_bf16_f32 v88, v88, v89
 v_mfma_f32_16x16x32_bf16 v[104:107], a[164:167], v[136:139], v[104:107]
 ds_read_b64_tr_b16 a[190:191], v44 offset:30720
 v_xor_b32 v45, 0x20000, v45
 v_mfma_f32_16x16x32_bf16 v[104:107], a[168:171], v[144:147], v[104:107]
 s_waitcnt lgkmcnt(4)
 ds_read_b64_tr_b16 a[192:193], v45 offset:0
 v_cvt_pk_bf16_f32 v89, v90, v91
 v_mfma_f32_16x16x32_bf16 v[104:107], a[172:175], v[152:155], v[104:107]
 s_add_u32 m0, s29, 65536
 ds_read_b64_tr_b16 a[194:195], v45 offset:2048
 v_cvt_pk_bf16_f32 v90, v92, v93
 v_mfma_f32_16x16x32_bf16 v[104:107], a[176:179], v[160:163], v[104:107]
 ds_read_b64_tr_b16 a[196:197], v45 offset:4096
 buffer_load_dwordx4 v2, s[8:11], s78 offen lds
 v_mfma_f32_16x16x32_bf16 v[104:107], a[180:183], v[168:171], v[104:107]
 s_waitcnt lgkmcnt(3)
 ds_read_b64_tr_b16 a[198:199], v45 offset:6144
 v_cvt_pk_bf16_f32 v91, v94, v95
 v_mfma_f32_16x16x32_bf16 v[104:107], a[184:187], v[176:179], v[104:107]
 s_add_u32 s58, s48, 17408
 ds_read_b64_tr_b16 a[200:201], v45 offset:8192
 v_mul_f32 v100, v100, v65
 v_mfma_f32_16x16x32_bf16 v[104:107], a[188:191], v[184:187], v[104:107]
 ds_read_b64_tr_b16 a[202:203], v45 offset:10240
 buffer_store_dwordx4 v[88:91], v1, s[12:15], s58 offen sc1
 v_mfma_f32_16x16x32_bf16 v[112:115], a[160:163], v[192:195], 0
 ds_read_b64_tr_b16 a[204:205], v45 offset:12288
 v_mul_f32 v101, v101, v65
 v_mfma_f32_16x16x32_bf16 v[112:115], a[164:167], v[200:203], v[112:115]
 ds_read_b64_tr_b16 a[206:207], v45 offset:14336
 v_mul_f32 v102, v102, v65
 v_mfma_f32_16x16x32_bf16 v[112:115], a[168:171], v[208:211], v[112:115]
 s_add_u32 m0, s29, 69632
 ds_read_b64_tr_b16 a[208:209], v45 offset:16384
 v_mul_f32 v103, v103, v65
 v_mfma_f32_16x16x32_bf16 v[112:115], a[172:175], v[216:219], v[112:115]
 ds_read_b64_tr_b16 a[210:211], v45 offset:18432
 buffer_load_dwordx4 v2, s[8:11], s79 offen lds
 v_mfma_f32_16x16x32_bf16 v[112:115], a[176:179], v[224:227], v[112:115]
 ds_read_b64_tr_b16 a[212:213], v45 offset:20480
 v_cvt_pk_bf16_f32 v96, v96, v97
 v_mfma_f32_16x16x32_bf16 v[112:115], a[180:183], v[232:235], v[112:115]
 ds_read_b64_tr_b16 a[214:215], v45 offset:22528
 v_cvt_pk_bf16_f32 v97, v98, v99
 v_mfma_f32_16x16x32_bf16 v[112:115], a[184:187], v[240:243], v[112:115]
 s_add_u32 s58, s48, 992256
 ds_read_b64_tr_b16 a[216:217], v45 offset:24576
 v_cvt_pk_bf16_f32 v98, v100, v101
 v_mfma_f32_16x16x32_bf16 v[112:115], a[188:191], v[248:251], v[112:115]
 s_waitcnt lgkmcnt(7)
 ds_read_b64_tr_b16 a[218:219], v45 offset:26624
 v_cvt_pk_bf16_f32 v99, v102, v103
 v_mfma_f32_16x16x32_bf16 v[108:111], a[192:195], v[128:131], 0
 ds_read_b64_tr_b16 a[220:221], v45 offset:28672
 buffer_store_dwordx4 v[96:99], v1, s[12:15], s58 offen sc1
 v_mfma_f32_16x16x32_bf16 v[108:111], a[196:199], v[136:139], v[108:111]
 s_add_u32 m0, s29, 73728
 ds_read_b64_tr_b16 a[222:223], v45 offset:30720
 v_xor_b32 v46, 0x20000, v46
 v_mfma_f32_16x16x32_bf16 v[108:111], a[200:203], v[144:147], v[108:111]
 s_waitcnt lgkmcnt(4)
 ds_read_b64_tr_b16 a[160:161], v46 offset:0
 buffer_load_dwordx4 v2, s[8:11], s80 offen lds
 v_mfma_f32_16x16x32_bf16 v[108:111], a[204:207], v[152:155], v[108:111]
 ds_read_b64_tr_b16 a[162:163], v46 offset:2048
 v_mul_f32 v104, v104, v64
 v_mfma_f32_16x16x32_bf16 v[108:111], a[208:211], v[160:163], v[108:111]
 ds_read_b64_tr_b16 a[164:165], v46 offset:4096
 v_mul_f32 v105, v105, v64
 v_mfma_f32_16x16x32_bf16 v[108:111], a[212:215], v[168:171], v[108:111]
 s_waitcnt lgkmcnt(3)
 ds_read_b64_tr_b16 a[166:167], v46 offset:6144
 v_mul_f32 v106, v106, v64
 v_mfma_f32_16x16x32_bf16 v[108:111], a[216:219], v[176:179], v[108:111]
 ds_read_b64_tr_b16 a[168:169], v46 offset:8192
 v_mul_f32 v107, v107, v64
 v_mfma_f32_16x16x32_bf16 v[108:111], a[220:223], v[184:187], v[108:111]
 ds_read_b64_tr_b16 a[170:171], v46 offset:10240
 v_mul_f32 v112, v112, v65
 v_mfma_f32_16x16x32_bf16 v[116:119], a[192:195], v[192:195], 0
 s_add_u32 m0, s29, 77824
 ds_read_b64_tr_b16 a[172:173], v46 offset:12288
 v_mul_f32 v113, v113, v65
 v_mfma_f32_16x16x32_bf16 v[116:119], a[196:199], v[200:203], v[116:119]
 ds_read_b64_tr_b16 a[174:175], v46 offset:14336
 buffer_load_dwordx4 v2, s[8:11], s81 offen lds
 v_mfma_f32_16x16x32_bf16 v[116:119], a[200:203], v[208:211], v[116:119]
 ds_read_b64_tr_b16 a[176:177], v46 offset:16384
 v_mul_f32 v114, v114, v65
 v_mfma_f32_16x16x32_bf16 v[116:119], a[204:207], v[216:219], v[116:119]
 ds_read_b64_tr_b16 a[178:179], v46 offset:18432
 v_mul_f32 v115, v115, v65
 v_mfma_f32_16x16x32_bf16 v[116:119], a[208:211], v[224:227], v[116:119]
 ds_read_b64_tr_b16 a[180:181], v46 offset:20480
 v_mul_f32 v108, v108, v64
 v_mfma_f32_16x16x32_bf16 v[116:119], a[212:215], v[232:235], v[116:119]
 ds_read_b64_tr_b16 a[182:183], v46 offset:22528
 v_mul_f32 v109, v109, v64
 v_mfma_f32_16x16x32_bf16 v[116:119], a[216:219], v[240:243], v[116:119]
 s_add_u32 m0, s29, 81920
 ds_read_b64_tr_b16 a[184:185], v46 offset:24576
 v_mul_f32 v110, v110, v64
 v_mfma_f32_16x16x32_bf16 v[116:119], a[220:223], v[248:251], v[116:119]
 s_waitcnt lgkmcnt(7)
 ds_read_b64_tr_b16 a[186:187], v46 offset:26624
 v_mul_f32 v111, v111, v64
 v_mfma_f32_16x16x32_bf16 v[72:75], a[160:163], v[128:131], 0
 ds_read_b64_tr_b16 a[188:189], v46 offset:28672
 buffer_load_dwordx4 v2, s[8:11], s82 offen lds
 v_mfma_f32_16x16x32_bf16 v[72:75], a[164:167], v[136:139], v[72:75]
 ds_read_b64_tr_b16 a[190:191], v46 offset:30720
 v_xor_b32 v47, 0x20000, v47
 v_mfma_f32_16x16x32_bf16 v[72:75], a[168:171], v[144:147], v[72:75]
 s_waitcnt lgkmcnt(4)
 ds_read_b64_tr_b16 a[192:193], v47 offset:0
 v_cvt_pk_bf16_f32 v104, v104, v105
 v_mfma_f32_16x16x32_bf16 v[72:75], a[172:175], v[152:155], v[72:75]
 ds_read_b64_tr_b16 a[194:195], v47 offset:2048
 v_cvt_pk_bf16_f32 v105, v106, v107
 v_mfma_f32_16x16x32_bf16 v[72:75], a[176:179], v[160:163], v[72:75]
 ds_read_b64_tr_b16 a[196:197], v47 offset:4096
 v_cvt_pk_bf16_f32 v106, v108, v109
 v_mfma_f32_16x16x32_bf16 v[72:75], a[180:183], v[168:171], v[72:75]
 s_waitcnt lgkmcnt(3)
 ds_read_b64_tr_b16 a[198:199], v47 offset:6144
 v_cvt_pk_bf16_f32 v107, v110, v111
 v_mfma_f32_16x16x32_bf16 v[72:75], a[184:187], v[176:179], v[72:75]
 s_add_u32 m0, s29, 86016
 ds_read_b64_tr_b16 a[200:201], v47 offset:8192
 v_mul_f32 v116, v116, v65
 v_mfma_f32_16x16x32_bf16 v[72:75], a[188:191], v[184:187], v[72:75]
 ds_read_b64_tr_b16 a[202:203], v47 offset:10240
 buffer_load_dwordx4 v2, s[8:11], s83 offen lds
 v_mfma_f32_16x16x32_bf16 v[80:83], a[160:163], v[192:195], 0
 s_add_u32 s58, s48, 34816
 ds_read_b64_tr_b16 a[204:205], v47 offset:12288
 v_mul_f32 v117, v117, v65
 v_mfma_f32_16x16x32_bf16 v[80:83], a[164:167], v[200:203], v[80:83]
 ds_read_b64_tr_b16 a[206:207], v47 offset:14336
 buffer_store_dwordx4 v[104:107], v1, s[12:15], s58 offen sc1
 v_mfma_f32_16x16x32_bf16 v[80:83], a[168:171], v[208:211], v[80:83]
 ds_read_b64_tr_b16 a[208:209], v47 offset:16384
 v_mul_f32 v118, v118, v65
 v_mfma_f32_16x16x32_bf16 v[80:83], a[172:175], v[216:219], v[80:83]
 ds_read_b64_tr_b16 a[210:211], v47 offset:18432
 v_mul_f32 v119, v119, v65
 v_mfma_f32_16x16x32_bf16 v[80:83], a[176:179], v[224:227], v[80:83]
 ds_read_b64_tr_b16 a[212:213], v47 offset:20480
 v_cvt_pk_bf16_f32 v112, v112, v113
 v_mfma_f32_16x16x32_bf16 v[80:83], a[180:183], v[232:235], v[80:83]
 s_add_u32 m0, s29, 90112
 ds_read_b64_tr_b16 a[214:215], v47 offset:22528
 v_cvt_pk_bf16_f32 v113, v114, v115
 v_mfma_f32_16x16x32_bf16 v[80:83], a[184:187], v[240:243], v[80:83]
 ds_read_b64_tr_b16 a[216:217], v47 offset:24576
 buffer_load_dwordx4 v2, s[8:11], s84 offen lds
 v_mfma_f32_16x16x32_bf16 v[80:83], a[188:191], v[248:251], v[80:83]
 s_waitcnt lgkmcnt(7)
 ds_read_b64_tr_b16 a[218:219], v47 offset:26624
 v_cvt_pk_bf16_f32 v114, v116, v117
 v_mfma_f32_16x16x32_bf16 v[76:79], a[192:195], v[128:131], 0
 s_waitcnt vmcnt(11)
 ds_read_b64_tr_b16 a[220:221], v47 offset:28672
 v_cvt_pk_bf16_f32 v115, v118, v119
 v_mfma_f32_16x16x32_bf16 v[76:79], a[196:199], v[136:139], v[76:79]
 s_barrier
 ds_read_b64_tr_b16 a[222:223], v47 offset:30720
 v_mul_f32 v72, v72, v64
 v_mfma_f32_16x16x32_bf16 v[76:79], a[200:203], v[144:147], v[76:79]
 s_waitcnt lgkmcnt(4)
 ds_read_b64_tr_b16 a[160:161], v44 offset:32768
 v_mul_f32 v73, v73, v64
 v_mfma_f32_16x16x32_bf16 v[76:79], a[204:207], v[152:155], v[76:79]
 ds_read_b64_tr_b16 a[162:163], v44 offset:34816
 v_mul_f32 v74, v74, v64
 v_mfma_f32_16x16x32_bf16 v[76:79], a[208:211], v[160:163], v[76:79]
 s_add_u32 m0, s29, 94208
 ds_read_b64_tr_b16 a[164:165], v44 offset:36864
 v_mul_f32 v75, v75, v64
 v_mfma_f32_16x16x32_bf16 v[76:79], a[212:215], v[168:171], v[76:79]
 s_waitcnt lgkmcnt(3)
 ds_read_b64_tr_b16 a[166:167], v44 offset:38912
 buffer_load_dwordx4 v2, s[8:11], s85 offen lds
 v_mfma_f32_16x16x32_bf16 v[76:79], a[216:219], v[176:179], v[76:79]
 s_add_u32 s58, s48, 1009664
 ds_read_b64_tr_b16 a[168:169], v44 offset:40960
 v_add_u32 v2, 128, v2
 v_mfma_f32_16x16x32_bf16 v[76:79], a[220:223], v[184:187], v[76:79]
 ds_read_b64_tr_b16 a[170:171], v44 offset:43008
 buffer_store_dwordx4 v[112:115], v1, s[12:15], s58 offen sc1
 v_mfma_f32_16x16x32_bf16 v[84:87], a[192:195], v[192:195], 0
 ds_read_b64_tr_b16 a[172:173], v44 offset:45056
 v_mul_f32 v80, v80, v65
 v_mfma_f32_16x16x32_bf16 v[84:87], a[196:199], v[200:203], v[84:87]
 ds_read_b64_tr_b16 a[174:175], v44 offset:47104
 v_mul_f32 v81, v81, v65
 v_mfma_f32_16x16x32_bf16 v[84:87], a[200:203], v[208:211], v[84:87]
 ds_read_b64_tr_b16 a[176:177], v44 offset:49152
 v_mul_f32 v82, v82, v65
 v_mfma_f32_16x16x32_bf16 v[84:87], a[204:207], v[216:219], v[84:87]
 ds_read_b64_tr_b16 a[178:179], v44 offset:51200
 v_mul_f32 v83, v83, v65
 v_mfma_f32_16x16x32_bf16 v[84:87], a[208:211], v[224:227], v[84:87]
 ds_read_b64_tr_b16 a[180:181], v44 offset:53248
 v_mul_f32 v76, v76, v64
 v_mfma_f32_16x16x32_bf16 v[84:87], a[212:215], v[232:235], v[84:87]
 ds_read_b64_tr_b16 a[182:183], v44 offset:55296
 v_mul_f32 v77, v77, v64
 v_mfma_f32_16x16x32_bf16 v[84:87], a[216:219], v[240:243], v[84:87]
 ds_read_b64_tr_b16 a[184:185], v44 offset:57344
 v_mul_f32 v78, v78, v64
 v_mfma_f32_16x16x32_bf16 v[84:87], a[220:223], v[248:251], v[84:87]
 s_waitcnt lgkmcnt(7)
 ds_read_b64_tr_b16 a[186:187], v44 offset:59392
 v_mul_f32 v79, v79, v64
 v_mfma_f32_16x16x32_bf16 v[88:91], a[160:163], v[128:131], 0
 ds_read_b64_tr_b16 a[188:189], v44 offset:61440
 v_cvt_pk_bf16_f32 v72, v72, v73
 v_mfma_f32_16x16x32_bf16 v[88:91], a[164:167], v[136:139], v[88:91]
 ds_read_b64_tr_b16 a[190:191], v44 offset:63488
 v_cvt_pk_bf16_f32 v73, v74, v75
 v_mfma_f32_16x16x32_bf16 v[88:91], a[168:171], v[144:147], v[88:91]
 s_waitcnt lgkmcnt(4)
 ds_read_b64_tr_b16 a[192:193], v45 offset:32768
 v_cvt_pk_bf16_f32 v74, v76, v77
 v_mfma_f32_16x16x32_bf16 v[88:91], a[172:175], v[152:155], v[88:91]
 s_add_u32 m0, s29, 98304
 ds_read_b64_tr_b16 a[194:195], v45 offset:34816
 v_cvt_pk_bf16_f32 v75, v78, v79
 v_mfma_f32_16x16x32_bf16 v[88:91], a[176:179], v[160:163], v[88:91]
 ds_read_b64_tr_b16 a[196:197], v45 offset:36864
 buffer_load_dwordx4 v2, s[8:11], s78 offen lds
 v_mfma_f32_16x16x32_bf16 v[88:91], a[180:183], v[168:171], v[88:91]
 s_waitcnt lgkmcnt(3)
 ds_read_b64_tr_b16 a[198:199], v45 offset:38912
 v_mul_f32 v84, v84, v65
 v_mfma_f32_16x16x32_bf16 v[88:91], a[184:187], v[176:179], v[88:91]
 s_add_u32 s58, s48, 52224
 ds_read_b64_tr_b16 a[200:201], v45 offset:40960
 v_mul_f32 v85, v85, v65
 v_mfma_f32_16x16x32_bf16 v[88:91], a[188:191], v[184:187], v[88:91]
 ds_read_b64_tr_b16 a[202:203], v45 offset:43008
 buffer_store_dwordx4 v[72:75], v1, s[12:15], s58 offen sc1
 v_mfma_f32_16x16x32_bf16 v[96:99], a[160:163], v[192:195], 0
 ds_read_b64_tr_b16 a[204:205], v45 offset:45056
 v_mul_f32 v86, v86, v65
 v_mfma_f32_16x16x32_bf16 v[96:99], a[164:167], v[200:203], v[96:99]
 ds_read_b64_tr_b16 a[206:207], v45 offset:47104
 v_mul_f32 v87, v87, v65
 v_mfma_f32_16x16x32_bf16 v[96:99], a[168:171], v[208:211], v[96:99]
 s_add_u32 m0, s29, 102400
 ds_read_b64_tr_b16 a[208:209], v45 offset:49152
 v_cvt_pk_bf16_f32 v80, v80, v81
 v_mfma_f32_16x16x32_bf16 v[96:99], a[172:175], v[216:219], v[96:99]
 ds_read_b64_tr_b16 a[210:211], v45 offset:51200
 buffer_load_dwordx4 v2, s[8:11], s79 offen lds
 v_mfma_f32_16x16x32_bf16 v[96:99], a[176:179], v[224:227], v[96:99]
 ds_read_b64_tr_b16 a[212:213], v45 offset:53248
 v_cvt_pk_bf16_f32 v81, v82, v83
 v_mfma_f32_16x16x32_bf16 v[96:99], a[180:183], v[232:235], v[96:99]
 ds_read_b64_tr_b16 a[214:215], v45 offset:55296
 v_cvt_pk_bf16_f32 v82, v84, v85
 v_mfma_f32_16x16x32_bf16 v[96:99], a[184:187], v[240:243], v[96:99]
 s_add_u32 s58, s48, 1027072
 ds_read_b64_tr_b16 a[216:217], v45 offset:57344
 v_cvt_pk_bf16_f32 v83, v86, v87
 v_mfma_f32_16x16x32_bf16 v[96:99], a[188:191], v[248:251], v[96:99]
 s_waitcnt lgkmcnt(7)
 ds_read_b64_tr_b16 a[218:219], v45 offset:59392
 buffer_store_dwordx4 v[80:83], v1, s[12:15], s58 offen sc1
 v_mfma_f32_16x16x32_bf16 v[92:95], a[192:195], v[128:131], 0
 ds_read_b64_tr_b16 a[220:221], v45 offset:61440
 v_mul_f32 v88, v88, v64
 v_mfma_f32_16x16x32_bf16 v[92:95], a[196:199], v[136:139], v[92:95]
 s_add_u32 m0, s29, 106496
 ds_read_b64_tr_b16 a[222:223], v45 offset:63488
 v_mul_f32 v89, v89, v64
 v_mfma_f32_16x16x32_bf16 v[92:95], a[200:203], v[144:147], v[92:95]
 s_waitcnt lgkmcnt(4)
 ds_read_b64_tr_b16 a[160:161], v46 offset:32768
 buffer_load_dwordx4 v2, s[8:11], s80 offen lds
 v_mfma_f32_16x16x32_bf16 v[92:95], a[204:207], v[152:155], v[92:95]
 ds_read_b64_tr_b16 a[162:163], v46 offset:34816
 v_mul_f32 v90, v90, v64
 v_mfma_f32_16x16x32_bf16 v[92:95], a[208:211], v[160:163], v[92:95]
 ds_read_b64_tr_b16 a[164:165], v46 offset:36864
 v_mul_f32 v91, v91, v64
 v_mfma_f32_16x16x32_bf16 v[92:95], a[212:215], v[168:171], v[92:95]
 s_waitcnt lgkmcnt(3)
 ds_read_b64_tr_b16 a[166:167], v46 offset:38912
 v_mul_f32 v96, v96, v65
 v_mfma_f32_16x16x32_bf16 v[92:95], a[216:219], v[176:179], v[92:95]
 ds_read_b64_tr_b16 a[168:169], v46 offset:40960
 v_mul_f32 v97, v97, v65
 v_mfma_f32_16x16x32_bf16 v[92:95], a[220:223], v[184:187], v[92:95]
 ds_read_b64_tr_b16 a[170:171], v46 offset:43008
 v_mul_f32 v98, v98, v65
 v_mfma_f32_16x16x32_bf16 v[100:103], a[192:195], v[192:195], 0
 s_add_u32 m0, s29, 110592
 ds_read_b64_tr_b16 a[172:173], v46 offset:45056
 v_mul_f32 v99, v99, v65
 v_mfma_f32_16x16x32_bf16 v[100:103], a[196:199], v[200:203], v[100:103]
 ds_read_b64_tr_b16 a[174:175], v46 offset:47104
 buffer_load_dwordx4 v2, s[8:11], s81 offen lds
 v_mfma_f32_16x16x32_bf16 v[100:103], a[200:203], v[208:211], v[100:103]
 ds_read_b64_tr_b16 a[176:177], v46 offset:49152
 v_mfma_f32_16x16x32_bf16 v[100:103], a[204:207], v[216:219], v[100:103]
 ds_read_b64_tr_b16 a[178:179], v46 offset:51200
 v_mfma_f32_16x16x32_bf16 v[100:103], a[208:211], v[224:227], v[100:103]
 ds_read_b64_tr_b16 a[180:181], v46 offset:53248
 v_mul_f32 v92, v92, v64
 v_mfma_f32_16x16x32_bf16 v[100:103], a[212:215], v[232:235], v[100:103]
 ds_read_b64_tr_b16 a[182:183], v46 offset:55296
 v_mul_f32 v93, v93, v64
 v_mfma_f32_16x16x32_bf16 v[100:103], a[216:219], v[240:243], v[100:103]
 s_add_u32 m0, s29, 114688
 ds_read_b64_tr_b16 a[184:185], v46 offset:57344
 v_mul_f32 v94, v94, v64
 v_mfma_f32_16x16x32_bf16 v[100:103], a[220:223], v[248:251], v[100:103]
 s_waitcnt lgkmcnt(7)
 ds_read_b64_tr_b16 a[186:187], v46 offset:59392
 v_mul_f32 v95, v95, v64
 v_mfma_f32_16x16x32_bf16 v[104:107], a[160:163], v[128:131], 0
 ds_read_b64_tr_b16 a[188:189], v46 offset:61440
 buffer_load_dwordx4 v2, s[8:11], s82 offen lds
 v_mfma_f32_16x16x32_bf16 v[104:107], a[164:167], v[136:139], v[104:107]
 ds_read_b64_tr_b16 a[190:191], v46 offset:63488
 v_cvt_pk_bf16_f32 v88, v88, v89
 v_mfma_f32_16x16x32_bf16 v[104:107], a[168:171], v[144:147], v[104:107]
 s_waitcnt lgkmcnt(4)
 ds_read_b64_tr_b16 a[192:193], v47 offset:32768
 v_cvt_pk_bf16_f32 v89, v90, v91
 v_mfma_f32_16x16x32_bf16 v[104:107], a[172:175], v[152:155], v[104:107]
 ds_read_b64_tr_b16 a[194:195], v47 offset:34816
 v_cvt_pk_bf16_f32 v90, v92, v93
 v_mfma_f32_16x16x32_bf16 v[104:107], a[176:179], v[160:163], v[104:107]
 s_add_u32 s58, s48, 69632
 ds_read_b64_tr_b16 a[196:197], v47 offset:36864
 v_cvt_pk_bf16_f32 v91, v94, v95
 v_mfma_f32_16x16x32_bf16 v[104:107], a[180:183], v[168:171], v[104:107]
 s_waitcnt lgkmcnt(3)
 ds_read_b64_tr_b16 a[198:199], v47 offset:38912
 buffer_store_dwordx4 v[88:91], v1, s[12:15], s58 offen sc1
 v_mfma_f32_16x16x32_bf16 v[104:107], a[184:187], v[176:179], v[104:107]
 s_add_u32 m0, s29, 118784
 ds_read_b64_tr_b16 a[200:201], v47 offset:40960
 v_mul_f32 v100, v100, v65
 v_mfma_f32_16x16x32_bf16 v[104:107], a[188:191], v[184:187], v[104:107]
 ds_read_b64_tr_b16 a[202:203], v47 offset:43008
 buffer_load_dwordx4 v2, s[8:11], s83 offen lds
 v_mfma_f32_16x16x32_bf16 v[112:115], a[160:163], v[192:195], 0
 ds_read_b64_tr_b16 a[204:205], v47 offset:45056
 v_mul_f32 v101, v101, v65
 v_mfma_f32_16x16x32_bf16 v[112:115], a[164:167], v[200:203], v[112:115]
 ds_read_b64_tr_b16 a[206:207], v47 offset:47104
 v_mul_f32 v102, v102, v65
 v_mfma_f32_16x16x32_bf16 v[112:115], a[168:171], v[208:211], v[112:115]
 ds_read_b64_tr_b16 a[208:209], v47 offset:49152
 v_mul_f32 v103, v103, v65
 v_mfma_f32_16x16x32_bf16 v[112:115], a[172:175], v[216:219], v[112:115]
 ds_read_b64_tr_b16 a[210:211], v47 offset:51200
 v_cvt_pk_bf16_f32 v96, v96, v97
 v_mfma_f32_16x16x32_bf16 v[112:115], a[176:179], v[224:227], v[112:115]
 ds_read_b64_tr_b16 a[212:213], v47 offset:53248
 v_cvt_pk_bf16_f32 v97, v98, v99
 v_mfma_f32_16x16x32_bf16 v[112:115], a[180:183], v[232:235], v[112:115]
 s_add_u32 m0, s29, 122880
 ds_read_b64_tr_b16 a[214:215], v47 offset:55296
 v_cvt_pk_bf16_f32 v98, v100, v101
 v_mfma_f32_16x16x32_bf16 v[112:115], a[184:187], v[240:243], v[112:115]
 ds_read_b64_tr_b16 a[216:217], v47 offset:57344
 buffer_load_dwordx4 v2, s[8:11], s84 offen lds
 v_mfma_f32_16x16x32_bf16 v[112:115], a[188:191], v[248:251], v[112:115]
 s_waitcnt lgkmcnt(7)
 ds_read_b64_tr_b16 a[218:219], v47 offset:59392
 v_cvt_pk_bf16_f32 v99, v102, v103
 v_mfma_f32_16x16x32_bf16 v[108:111], a[192:195], v[128:131], 0
 s_waitcnt vmcnt(11)
 ds_read_b64_tr_b16 a[220:221], v47 offset:61440
 v_mul_f32 v104, v104, v64
 v_mfma_f32_16x16x32_bf16 v[108:111], a[196:199], v[136:139], v[108:111]
 s_barrier
 ds_read_b64_tr_b16 a[222:223], v47 offset:63488
 v_xor_b32 v44, 0x10000, v44
 v_mfma_f32_16x16x32_bf16 v[108:111], a[200:203], v[144:147], v[108:111]
 s_waitcnt lgkmcnt(4)
 ds_read_b64_tr_b16 a[160:161], v44 offset:0
 v_mul_f32 v105, v105, v64
 v_mfma_f32_16x16x32_bf16 v[108:111], a[204:207], v[152:155], v[108:111]
 ds_read_b64_tr_b16 a[162:163], v44 offset:2048
 v_mul_f32 v106, v106, v64
 v_mfma_f32_16x16x32_bf16 v[108:111], a[208:211], v[160:163], v[108:111]
 s_add_u32 m0, s29, 126976
 ds_read_b64_tr_b16 a[164:165], v44 offset:4096
 v_mul_f32 v107, v107, v64
 v_mfma_f32_16x16x32_bf16 v[108:111], a[212:215], v[168:171], v[108:111]
 s_waitcnt lgkmcnt(3)
 ds_read_b64_tr_b16 a[166:167], v44 offset:6144
 buffer_load_dwordx4 v2, s[8:11], s85 offen lds
 v_mfma_f32_16x16x32_bf16 v[108:111], a[216:219], v[176:179], v[108:111]
 s_add_u32 s58, s48, 1044480
 ds_read_b64_tr_b16 a[168:169], v44 offset:8192
 v_add_u32 v2, 128, v2
 v_mfma_f32_16x16x32_bf16 v[108:111], a[220:223], v[184:187], v[108:111]
 ds_read_b64_tr_b16 a[170:171], v44 offset:10240
 buffer_store_dwordx4 v[96:99], v1, s[12:15], s58 offen sc1
 v_mfma_f32_16x16x32_bf16 v[116:119], a[192:195], v[192:195], 0
 ds_read_b64_tr_b16 a[172:173], v44 offset:12288
 v_mul_f32 v112, v112, v65
 v_mfma_f32_16x16x32_bf16 v[116:119], a[196:199], v[200:203], v[116:119]
 ds_read_b64_tr_b16 a[174:175], v44 offset:14336
 v_mul_f32 v113, v113, v65
 v_mfma_f32_16x16x32_bf16 v[116:119], a[200:203], v[208:211], v[116:119]
 ds_read_b64_tr_b16 a[176:177], v44 offset:16384
 v_mul_f32 v114, v114, v65
 v_mfma_f32_16x16x32_bf16 v[116:119], a[204:207], v[216:219], v[116:119]
 ds_read_b64_tr_b16 a[178:179], v44 offset:18432
 v_mul_f32 v115, v115, v65
 v_mfma_f32_16x16x32_bf16 v[116:119], a[208:211], v[224:227], v[116:119]
 ds_read_b64_tr_b16 a[180:181], v44 offset:20480
 v_mul_f32 v108, v108, v64
 v_mfma_f32_16x16x32_bf16 v[116:119], a[212:215], v[232:235], v[116:119]
 ds_read_b64_tr_b16 a[182:183], v44 offset:22528
 v_mul_f32 v109, v109, v64
 v_mfma_f32_16x16x32_bf16 v[116:119], a[216:219], v[240:243], v[116:119]
 ds_read_b64_tr_b16 a[184:185], v44 offset:24576
 v_mul_f32 v110, v110, v64
 v_mfma_f32_16x16x32_bf16 v[116:119], a[220:223], v[248:251], v[116:119]
 s_waitcnt lgkmcnt(7)
 ds_read_b64_tr_b16 a[186:187], v44 offset:26624
 v_mul_f32 v111, v111, v64
 v_mfma_f32_16x16x32_bf16 v[72:75], a[160:163], v[128:131], 0
 ds_read_b64_tr_b16 a[188:189], v44 offset:28672
 v_cvt_pk_bf16_f32 v104, v104, v105
 v_mfma_f32_16x16x32_bf16 v[72:75], a[164:167], v[136:139], v[72:75]
 ds_read_b64_tr_b16 a[190:191], v44 offset:30720
 v_xor_b32 v45, 0x10000, v45
 v_mfma_f32_16x16x32_bf16 v[72:75], a[168:171], v[144:147], v[72:75]
 s_waitcnt lgkmcnt(4)
 ds_read_b64_tr_b16 a[192:193], v45 offset:0
 v_cvt_pk_bf16_f32 v105, v106, v107
 v_mfma_f32_16x16x32_bf16 v[72:75], a[172:175], v[152:155], v[72:75]
 s_add_u32 m0, s29, 131072
 ds_read_b64_tr_b16 a[194:195], v45 offset:2048
 v_cvt_pk_bf16_f32 v106, v108, v109
 v_mfma_f32_16x16x32_bf16 v[72:75], a[176:179], v[160:163], v[72:75]
 ds_read_b64_tr_b16 a[196:197], v45 offset:4096
 buffer_load_dwordx4 v2, s[8:11], s78 offen lds
 v_mfma_f32_16x16x32_bf16 v[72:75], a[180:183], v[168:171], v[72:75]
 s_waitcnt lgkmcnt(3)
 ds_read_b64_tr_b16 a[198:199], v45 offset:6144
 v_cvt_pk_bf16_f32 v107, v110, v111
 v_mfma_f32_16x16x32_bf16 v[72:75], a[184:187], v[176:179], v[72:75]
 s_add_u32 s58, s48, 87040
 ds_read_b64_tr_b16 a[200:201], v45 offset:8192
 v_mul_f32 v116, v116, v65
 v_mfma_f32_16x16x32_bf16 v[72:75], a[188:191], v[184:187], v[72:75]
 ds_read_b64_tr_b16 a[202:203], v45 offset:10240
 buffer_store_dwordx4 v[104:107], v1, s[12:15], s58 offen sc1
 v_mfma_f32_16x16x32_bf16 v[80:83], a[160:163], v[192:195], 0
 ds_read_b64_tr_b16 a[204:205], v45 offset:12288
 v_mul_f32 v117, v117, v65
 v_mfma_f32_16x16x32_bf16 v[80:83], a[164:167], v[200:203], v[80:83]
 ds_read_b64_tr_b16 a[206:207], v45 offset:14336
 v_mul_f32 v118, v118, v65
 v_mfma_f32_16x16x32_bf16 v[80:83], a[168:171], v[208:211], v[80:83]
 s_add_u32 m0, s29, 135168
 ds_read_b64_tr_b16 a[208:209], v45 offset:16384
 v_mul_f32 v119, v119, v65
 v_mfma_f32_16x16x32_bf16 v[80:83], a[172:175], v[216:219], v[80:83]
 ds_read_b64_tr_b16 a[210:211], v45 offset:18432
 buffer_load_dwordx4 v2, s[8:11], s79 offen lds
 v_mfma_f32_16x16x32_bf16 v[80:83], a[176:179], v[224:227], v[80:83]
 ds_read_b64_tr_b16 a[212:213], v45 offset:20480
 v_cvt_pk_bf16_f32 v112, v112, v113
 v_mfma_f32_16x16x32_bf16 v[80:83], a[180:183], v[232:235], v[80:83]
 ds_read_b64_tr_b16 a[214:215], v45 offset:22528
 v_cvt_pk_bf16_f32 v113, v114, v115
 v_mfma_f32_16x16x32_bf16 v[80:83], a[184:187], v[240:243], v[80:83]
 s_add_u32 s58, s48, 1061888
 ds_read_b64_tr_b16 a[216:217], v45 offset:24576
 v_cvt_pk_bf16_f32 v114, v116, v117
 v_mfma_f32_16x16x32_bf16 v[80:83], a[188:191], v[248:251], v[80:83]
 s_waitcnt lgkmcnt(7)
 ds_read_b64_tr_b16 a[218:219], v45 offset:26624
 v_cvt_pk_bf16_f32 v115, v118, v119
 v_mfma_f32_16x16x32_bf16 v[76:79], a[192:195], v[128:131], 0
 ds_read_b64_tr_b16 a[220:221], v45 offset:28672
 buffer_store_dwordx4 v[112:115], v1, s[12:15], s58 offen sc1
 v_mfma_f32_16x16x32_bf16 v[76:79], a[196:199], v[136:139], v[76:79]
 s_add_u32 m0, s29, 139264
 ds_read_b64_tr_b16 a[222:223], v45 offset:30720
 v_xor_b32 v46, 0x10000, v46
 v_mfma_f32_16x16x32_bf16 v[76:79], a[200:203], v[144:147], v[76:79]
 s_waitcnt lgkmcnt(4)
 ds_read_b64_tr_b16 a[160:161], v46 offset:0
 buffer_load_dwordx4 v2, s[8:11], s80 offen lds
 v_mfma_f32_16x16x32_bf16 v[76:79], a[204:207], v[152:155], v[76:79]
 ds_read_b64_tr_b16 a[162:163], v46 offset:2048
 v_mul_f32 v72, v72, v64
 v_mfma_f32_16x16x32_bf16 v[76:79], a[208:211], v[160:163], v[76:79]
 ds_read_b64_tr_b16 a[164:165], v46 offset:4096
 v_mul_f32 v73, v73, v64
 v_mfma_f32_16x16x32_bf16 v[76:79], a[212:215], v[168:171], v[76:79]
 s_waitcnt lgkmcnt(3)
 ds_read_b64_tr_b16 a[166:167], v46 offset:6144
 v_mul_f32 v74, v74, v64
 v_mfma_f32_16x16x32_bf16 v[76:79], a[216:219], v[176:179], v[76:79]
 ds_read_b64_tr_b16 a[168:169], v46 offset:8192
 v_mul_f32 v75, v75, v64
 v_mfma_f32_16x16x32_bf16 v[76:79], a[220:223], v[184:187], v[76:79]
 ds_read_b64_tr_b16 a[170:171], v46 offset:10240
 v_mul_f32 v80, v80, v65
 v_mfma_f32_16x16x32_bf16 v[84:87], a[192:195], v[192:195], 0
 s_add_u32 m0, s29, 143360
 ds_read_b64_tr_b16 a[172:173], v46 offset:12288
 v_mul_f32 v81, v81, v65
 v_mfma_f32_16x16x32_bf16 v[84:87], a[196:199], v[200:203], v[84:87]
 ds_read_b64_tr_b16 a[174:175], v46 offset:14336
 buffer_load_dwordx4 v2, s[8:11], s81 offen lds
 v_mfma_f32_16x16x32_bf16 v[84:87], a[200:203], v[208:211], v[84:87]
 ds_read_b64_tr_b16 a[176:177], v46 offset:16384
 v_mul_f32 v82, v82, v65
 v_mfma_f32_16x16x32_bf16 v[84:87], a[204:207], v[216:219], v[84:87]
 ds_read_b64_tr_b16 a[178:179], v46 offset:18432
 v_mul_f32 v83, v83, v65
 v_mfma_f32_16x16x32_bf16 v[84:87], a[208:211], v[224:227], v[84:87]
 ds_read_b64_tr_b16 a[180:181], v46 offset:20480
 v_mul_f32 v76, v76, v64
 v_mfma_f32_16x16x32_bf16 v[84:87], a[212:215], v[232:235], v[84:87]
 ds_read_b64_tr_b16 a[182:183], v46 offset:22528
 v_mul_f32 v77, v77, v64
 v_mfma_f32_16x16x32_bf16 v[84:87], a[216:219], v[240:243], v[84:87]
 s_add_u32 m0, s29, 147456
 ds_read_b64_tr_b16 a[184:185], v46 offset:24576
 v_mul_f32 v78, v78, v64
 v_mfma_f32_16x16x32_bf16 v[84:87], a[220:223], v[248:251], v[84:87]
 s_waitcnt lgkmcnt(7)
 ds_read_b64_tr_b16 a[186:187], v46 offset:26624
 v_mul_f32 v79, v79, v64
 v_mfma_f32_16x16x32_bf16 v[88:91], a[160:163], v[128:131], 0
 ds_read_b64_tr_b16 a[188:189], v46 offset:28672
 buffer_load_dwordx4 v2, s[8:11], s82 offen lds
 v_mfma_f32_16x16x32_bf16 v[88:91], a[164:167], v[136:139], v[88:91]
 ds_read_b64_tr_b16 a[190:191], v46 offset:30720
 v_xor_b32 v47, 0x10000, v47
 v_mfma_f32_16x16x32_bf16 v[88:91], a[168:171], v[144:147], v[88:91]
 s_waitcnt lgkmcnt(4)
 ds_read_b64_tr_b16 a[192:193], v47 offset:0
 v_cvt_pk_bf16_f32 v72, v72, v73
 v_mfma_f32_16x16x32_bf16 v[88:91], a[172:175], v[152:155], v[88:91]
 ds_read_b64_tr_b16 a[194:195], v47 offset:2048
 v_cvt_pk_bf16_f32 v73, v74, v75
 v_mfma_f32_16x16x32_bf16 v[88:91], a[176:179], v[160:163], v[88:91]
 ds_read_b64_tr_b16 a[196:197], v47 offset:4096
 v_cvt_pk_bf16_f32 v74, v76, v77
 v_mfma_f32_16x16x32_bf16 v[88:91], a[180:183], v[168:171], v[88:91]
 s_waitcnt lgkmcnt(3)
 ds_read_b64_tr_b16 a[198:199], v47 offset:6144
 v_cvt_pk_bf16_f32 v75, v78, v79
 v_mfma_f32_16x16x32_bf16 v[88:91], a[184:187], v[176:179], v[88:91]
 s_add_u32 m0, s29, 151552
 ds_read_b64_tr_b16 a[200:201], v47 offset:8192
 v_mul_f32 v84, v84, v65
 v_mfma_f32_16x16x32_bf16 v[88:91], a[188:191], v[184:187], v[88:91]
 ds_read_b64_tr_b16 a[202:203], v47 offset:10240
 buffer_load_dwordx4 v2, s[8:11], s83 offen lds
 v_mfma_f32_16x16x32_bf16 v[96:99], a[160:163], v[192:195], 0
 s_add_u32 s58, s48, 104448
 ds_read_b64_tr_b16 a[204:205], v47 offset:12288
 v_mul_f32 v85, v85, v65
 v_mfma_f32_16x16x32_bf16 v[96:99], a[164:167], v[200:203], v[96:99]
 ds_read_b64_tr_b16 a[206:207], v47 offset:14336
 buffer_store_dwordx4 v[72:75], v1, s[12:15], s58 offen sc1
 v_mfma_f32_16x16x32_bf16 v[96:99], a[168:171], v[208:211], v[96:99]
 ds_read_b64_tr_b16 a[208:209], v47 offset:16384
 v_mul_f32 v86, v86, v65
 v_mfma_f32_16x16x32_bf16 v[96:99], a[172:175], v[216:219], v[96:99]
 ds_read_b64_tr_b16 a[210:211], v47 offset:18432
 v_mul_f32 v87, v87, v65
 v_mfma_f32_16x16x32_bf16 v[96:99], a[176:179], v[224:227], v[96:99]
 ds_read_b64_tr_b16 a[212:213], v47 offset:20480
 v_cvt_pk_bf16_f32 v80, v80, v81
 v_mfma_f32_16x16x32_bf16 v[96:99], a[180:183], v[232:235], v[96:99]
 s_add_u32 m0, s29, 155648
 ds_read_b64_tr_b16 a[214:215], v47 offset:22528
 v_cvt_pk_bf16_f32 v81, v82, v83
 v_mfma_f32_16x16x32_bf16 v[96:99], a[184:187], v[240:243], v[96:99]
 ds_read_b64_tr_b16 a[216:217], v47 offset:24576
 buffer_load_dwordx4 v2, s[8:11], s84 offen lds
 v_mfma_f32_16x16x32_bf16 v[96:99], a[188:191], v[248:251], v[96:99]
 s_waitcnt lgkmcnt(7)
 ds_read_b64_tr_b16 a[218:219], v47 offset:26624
 v_cvt_pk_bf16_f32 v82, v84, v85
 v_mfma_f32_16x16x32_bf16 v[92:95], a[192:195], v[128:131], 0
 s_waitcnt vmcnt(11)
 ds_read_b64_tr_b16 a[220:221], v47 offset:28672
 v_cvt_pk_bf16_f32 v83, v86, v87
 v_mfma_f32_16x16x32_bf16 v[92:95], a[196:199], v[136:139], v[92:95]
 s_barrier
 ds_read_b64_tr_b16 a[222:223], v47 offset:30720
 v_mul_f32 v88, v88, v64
 v_mfma_f32_16x16x32_bf16 v[92:95], a[200:203], v[144:147], v[92:95]
 s_waitcnt lgkmcnt(4)
 ds_read_b64_tr_b16 a[160:161], v44 offset:32768
 v_mul_f32 v89, v89, v64
 v_mfma_f32_16x16x32_bf16 v[92:95], a[204:207], v[152:155], v[92:95]
 ds_read_b64_tr_b16 a[162:163], v44 offset:34816
 v_mul_f32 v90, v90, v64
 v_mfma_f32_16x16x32_bf16 v[92:95], a[208:211], v[160:163], v[92:95]
 s_add_u32 m0, s29, 159744
 ds_read_b64_tr_b16 a[164:165], v44 offset:36864
 v_mul_f32 v91, v91, v64
 v_mfma_f32_16x16x32_bf16 v[92:95], a[212:215], v[168:171], v[92:95]
 s_waitcnt lgkmcnt(3)
 ds_read_b64_tr_b16 a[166:167], v44 offset:38912
 buffer_load_dwordx4 v2, s[8:11], s85 offen lds
 v_mfma_f32_16x16x32_bf16 v[92:95], a[216:219], v[176:179], v[92:95]
 s_add_u32 s58, s48, 1079296
 ds_read_b64_tr_b16 a[168:169], v44 offset:40960
 v_add_u32 v2, 128, v2
 v_mfma_f32_16x16x32_bf16 v[92:95], a[220:223], v[184:187], v[92:95]
 ds_read_b64_tr_b16 a[170:171], v44 offset:43008
 buffer_store_dwordx4 v[80:83], v1, s[12:15], s58 offen sc1
 v_mfma_f32_16x16x32_bf16 v[100:103], a[192:195], v[192:195], 0
 ds_read_b64_tr_b16 a[172:173], v44 offset:45056
 v_mul_f32 v96, v96, v65
 v_mfma_f32_16x16x32_bf16 v[100:103], a[196:199], v[200:203], v[100:103]
 ds_read_b64_tr_b16 a[174:175], v44 offset:47104
 v_mul_f32 v97, v97, v65
 v_mfma_f32_16x16x32_bf16 v[100:103], a[200:203], v[208:211], v[100:103]
 ds_read_b64_tr_b16 a[176:177], v44 offset:49152
 v_mul_f32 v98, v98, v65
 v_mfma_f32_16x16x32_bf16 v[100:103], a[204:207], v[216:219], v[100:103]
 ds_read_b64_tr_b16 a[178:179], v44 offset:51200
 v_mul_f32 v99, v99, v65
 v_mfma_f32_16x16x32_bf16 v[100:103], a[208:211], v[224:227], v[100:103]
 ds_read_b64_tr_b16 a[180:181], v44 offset:53248
 v_mul_f32 v92, v92, v64
 v_mfma_f32_16x16x32_bf16 v[100:103], a[212:215], v[232:235], v[100:103]
 ds_read_b64_tr_b16 a[182:183], v44 offset:55296
 v_mul_f32 v93, v93, v64
 v_mfma_f32_16x16x32_bf16 v[100:103], a[216:219], v[240:243], v[100:103]
 ds_read_b64_tr_b16 a[184:185], v44 offset:57344
 v_mul_f32 v94, v94, v64
 v_mfma_f32_16x16x32_bf16 v[100:103], a[220:223], v[248:251], v[100:103]
 s_waitcnt lgkmcnt(7)
 ds_read_b64_tr_b16 a[186:187], v44 offset:59392
 v_mul_f32 v95, v95, v64
 v_mfma_f32_16x16x32_bf16 v[104:107], a[160:163], v[128:131], 0
 ds_read_b64_tr_b16 a[188:189], v44 offset:61440
 v_cvt_pk_bf16_f32 v88, v88, v89
 v_mfma_f32_16x16x32_bf16 v[104:107], a[164:167], v[136:139], v[104:107]
 ds_read_b64_tr_b16 a[190:191], v44 offset:63488
 v_cvt_pk_bf16_f32 v89, v90, v91
 v_mfma_f32_16x16x32_bf16 v[104:107], a[168:171], v[144:147], v[104:107]
 s_waitcnt lgkmcnt(4)
 ds_read_b64_tr_b16 a[192:193], v45 offset:32768
 v_cvt_pk_bf16_f32 v90, v92, v93
 v_mfma_f32_16x16x32_bf16 v[104:107], a[172:175], v[152:155], v[104:107]
 s_add_u32 m0, s29, 0
 ds_read_b64_tr_b16 a[194:195], v45 offset:34816
 v_cvt_pk_bf16_f32 v91, v94, v95
 v_mfma_f32_16x16x32_bf16 v[104:107], a[176:179], v[160:163], v[104:107]
 ds_read_b64_tr_b16 a[196:197], v45 offset:36864
 buffer_load_dwordx4 v2, s[8:11], s78 offen lds
 v_mfma_f32_16x16x32_bf16 v[104:107], a[180:183], v[168:171], v[104:107]
 s_waitcnt lgkmcnt(3)
 ds_read_b64_tr_b16 a[198:199], v45 offset:38912
 v_mul_f32 v100, v100, v65
 v_mfma_f32_16x16x32_bf16 v[104:107], a[184:187], v[176:179], v[104:107]
 s_add_u32 s58, s48, 121856
 ds_read_b64_tr_b16 a[200:201], v45 offset:40960
 v_mul_f32 v101, v101, v65
 v_mfma_f32_16x16x32_bf16 v[104:107], a[188:191], v[184:187], v[104:107]
 ds_read_b64_tr_b16 a[202:203], v45 offset:43008
 buffer_store_dwordx4 v[88:91], v1, s[12:15], s58 offen sc1
 v_mfma_f32_16x16x32_bf16 v[112:115], a[160:163], v[192:195], 0
 ds_read_b64_tr_b16 a[204:205], v45 offset:45056
 v_mul_f32 v102, v102, v65
 v_mfma_f32_16x16x32_bf16 v[112:115], a[164:167], v[200:203], v[112:115]
 ds_read_b64_tr_b16 a[206:207], v45 offset:47104
 v_mul_f32 v103, v103, v65
 v_mfma_f32_16x16x32_bf16 v[112:115], a[168:171], v[208:211], v[112:115]
 s_add_u32 m0, s29, 4096
 ds_read_b64_tr_b16 a[208:209], v45 offset:49152
 v_cvt_pk_bf16_f32 v96, v96, v97
 v_mfma_f32_16x16x32_bf16 v[112:115], a[172:175], v[216:219], v[112:115]
 ds_read_b64_tr_b16 a[210:211], v45 offset:51200
 buffer_load_dwordx4 v2, s[8:11], s79 offen lds
 v_mfma_f32_16x16x32_bf16 v[112:115], a[176:179], v[224:227], v[112:115]
 ds_read_b64_tr_b16 a[212:213], v45 offset:53248
 v_cvt_pk_bf16_f32 v97, v98, v99
 v_mfma_f32_16x16x32_bf16 v[112:115], a[180:183], v[232:235], v[112:115]
 ds_read_b64_tr_b16 a[214:215], v45 offset:55296
 v_cvt_pk_bf16_f32 v98, v100, v101
 v_mfma_f32_16x16x32_bf16 v[112:115], a[184:187], v[240:243], v[112:115]
 s_add_u32 s58, s48, 1096704
 ds_read_b64_tr_b16 a[216:217], v45 offset:57344
 v_cvt_pk_bf16_f32 v99, v102, v103
 v_mfma_f32_16x16x32_bf16 v[112:115], a[188:191], v[248:251], v[112:115]
 s_waitcnt lgkmcnt(7)
 ds_read_b64_tr_b16 a[218:219], v45 offset:59392
 buffer_store_dwordx4 v[96:99], v1, s[12:15], s58 offen sc1
 v_mfma_f32_16x16x32_bf16 v[108:111], a[192:195], v[128:131], 0
 ds_read_b64_tr_b16 a[220:221], v45 offset:61440
 v_mul_f32 v104, v104, v64
 v_mfma_f32_16x16x32_bf16 v[108:111], a[196:199], v[136:139], v[108:111]
 s_add_u32 m0, s29, 8192
 ds_read_b64_tr_b16 a[222:223], v45 offset:63488
 v_mul_f32 v105, v105, v64
 v_mfma_f32_16x16x32_bf16 v[108:111], a[200:203], v[144:147], v[108:111]
 s_waitcnt lgkmcnt(4)
 ds_read_b64_tr_b16 a[160:161], v46 offset:32768
 buffer_load_dwordx4 v2, s[8:11], s80 offen lds
 v_mfma_f32_16x16x32_bf16 v[108:111], a[204:207], v[152:155], v[108:111]
 ds_read_b64_tr_b16 a[162:163], v46 offset:34816
 v_mul_f32 v106, v106, v64
 v_mfma_f32_16x16x32_bf16 v[108:111], a[208:211], v[160:163], v[108:111]
 ds_read_b64_tr_b16 a[164:165], v46 offset:36864
 v_mul_f32 v107, v107, v64
 v_mfma_f32_16x16x32_bf16 v[108:111], a[212:215], v[168:171], v[108:111]
 s_waitcnt lgkmcnt(3)
 ds_read_b64_tr_b16 a[166:167], v46 offset:38912
 v_mul_f32 v112, v112, v65
 v_mfma_f32_16x16x32_bf16 v[108:111], a[216:219], v[176:179], v[108:111]
 ds_read_b64_tr_b16 a[168:169], v46 offset:40960
 v_mul_f32 v113, v113, v65
 v_mfma_f32_16x16x32_bf16 v[108:111], a[220:223], v[184:187], v[108:111]
 ds_read_b64_tr_b16 a[170:171], v46 offset:43008
 v_mul_f32 v114, v114, v65
 v_mfma_f32_16x16x32_bf16 v[116:119], a[192:195], v[192:195], 0
 s_add_u32 m0, s29, 12288
 ds_read_b64_tr_b16 a[172:173], v46 offset:45056
 v_mul_f32 v115, v115, v65
 v_mfma_f32_16x16x32_bf16 v[116:119], a[196:199], v[200:203], v[116:119]
 ds_read_b64_tr_b16 a[174:175], v46 offset:47104
 buffer_load_dwordx4 v2, s[8:11], s81 offen lds
 v_mfma_f32_16x16x32_bf16 v[116:119], a[200:203], v[208:211], v[116:119]
 ds_read_b64_tr_b16 a[176:177], v46 offset:49152
 v_mfma_f32_16x16x32_bf16 v[116:119], a[204:207], v[216:219], v[116:119]
 ds_read_b64_tr_b16 a[178:179], v46 offset:51200
 v_mfma_f32_16x16x32_bf16 v[116:119], a[208:211], v[224:227], v[116:119]
 ds_read_b64_tr_b16 a[180:181], v46 offset:53248
 v_mul_f32 v108, v108, v64
 v_mfma_f32_16x16x32_bf16 v[116:119], a[212:215], v[232:235], v[116:119]
 ds_read_b64_tr_b16 a[182:183], v46 offset:55296
 v_mul_f32 v109, v109, v64
 v_mfma_f32_16x16x32_bf16 v[116:119], a[216:219], v[240:243], v[116:119]
 s_add_u32 m0, s29, 16384
 ds_read_b64_tr_b16 a[184:185], v46 offset:57344
 v_mul_f32 v110, v110, v64
 v_mfma_f32_16x16x32_bf16 v[116:119], a[220:223], v[248:251], v[116:119]
 s_waitcnt lgkmcnt(7)
 ds_read_b64_tr_b16 a[186:187], v46 offset:59392
 v_mul_f32 v111, v111, v64
 v_mfma_f32_16x16x32_bf16 v[72:75], a[160:163], v[128:131], 0
 ds_read_b64_tr_b16 a[188:189], v46 offset:61440
 buffer_load_dwordx4 v2, s[8:11], s82 offen lds
 v_mfma_f32_16x16x32_bf16 v[72:75], a[164:167], v[136:139], v[72:75]
 ds_read_b64_tr_b16 a[190:191], v46 offset:63488
 v_cvt_pk_bf16_f32 v104, v104, v105
 v_mfma_f32_16x16x32_bf16 v[72:75], a[168:171], v[144:147], v[72:75]
 s_waitcnt lgkmcnt(4)
 ds_read_b64_tr_b16 a[192:193], v47 offset:32768
 v_cvt_pk_bf16_f32 v105, v106, v107
 v_mfma_f32_16x16x32_bf16 v[72:75], a[172:175], v[152:155], v[72:75]
 ds_read_b64_tr_b16 a[194:195], v47 offset:34816
 v_cvt_pk_bf16_f32 v106, v108, v109
 v_mfma_f32_16x16x32_bf16 v[72:75], a[176:179], v[160:163], v[72:75]
 s_add_u32 s58, s48, 139264
 ds_read_b64_tr_b16 a[196:197], v47 offset:36864
 v_cvt_pk_bf16_f32 v107, v110, v111
 v_mfma_f32_16x16x32_bf16 v[72:75], a[180:183], v[168:171], v[72:75]
 s_waitcnt lgkmcnt(3)
 ds_read_b64_tr_b16 a[198:199], v47 offset:38912
 buffer_store_dwordx4 v[104:107], v1, s[12:15], s58 offen sc1
 v_mfma_f32_16x16x32_bf16 v[72:75], a[184:187], v[176:179], v[72:75]
 s_add_u32 m0, s29, 20480
 ds_read_b64_tr_b16 a[200:201], v47 offset:40960
 v_mul_f32 v116, v116, v65
 v_mfma_f32_16x16x32_bf16 v[72:75], a[188:191], v[184:187], v[72:75]
 ds_read_b64_tr_b16 a[202:203], v47 offset:43008
 buffer_load_dwordx4 v2, s[8:11], s83 offen lds
 v_mfma_f32_16x16x32_bf16 v[80:83], a[160:163], v[192:195], 0
 ds_read_b64_tr_b16 a[204:205], v47 offset:45056
 v_mul_f32 v117, v117, v65
 v_mfma_f32_16x16x32_bf16 v[80:83], a[164:167], v[200:203], v[80:83]
 ds_read_b64_tr_b16 a[206:207], v47 offset:47104
 v_mul_f32 v118, v118, v65
 v_mfma_f32_16x16x32_bf16 v[80:83], a[168:171], v[208:211], v[80:83]
 ds_read_b64_tr_b16 a[208:209], v47 offset:49152
 v_mul_f32 v119, v119, v65
 v_mfma_f32_16x16x32_bf16 v[80:83], a[172:175], v[216:219], v[80:83]
 ds_read_b64_tr_b16 a[210:211], v47 offset:51200
 v_cvt_pk_bf16_f32 v112, v112, v113
 v_mfma_f32_16x16x32_bf16 v[80:83], a[176:179], v[224:227], v[80:83]
 ds_read_b64_tr_b16 a[212:213], v47 offset:53248
 v_cvt_pk_bf16_f32 v113, v114, v115
 v_mfma_f32_16x16x32_bf16 v[80:83], a[180:183], v[232:235], v[80:83]
 s_add_u32 m0, s29, 24576
 ds_read_b64_tr_b16 a[214:215], v47 offset:55296
 v_cvt_pk_bf16_f32 v114, v116, v117
 v_mfma_f32_16x16x32_bf16 v[80:83], a[184:187], v[240:243], v[80:83]
 ds_read_b64_tr_b16 a[216:217], v47 offset:57344
 buffer_load_dwordx4 v2, s[8:11], s84 offen lds
 v_mfma_f32_16x16x32_bf16 v[80:83], a[188:191], v[248:251], v[80:83]
 s_waitcnt lgkmcnt(7)
 ds_read_b64_tr_b16 a[218:219], v47 offset:59392
 v_cvt_pk_bf16_f32 v115, v118, v119
 v_mfma_f32_16x16x32_bf16 v[76:79], a[192:195], v[128:131], 0
 s_waitcnt vmcnt(10)
 ds_read_b64_tr_b16 a[220:221], v47 offset:61440
 v_mul_f32 v72, v72, v64
 v_mfma_f32_16x16x32_bf16 v[76:79], a[196:199], v[136:139], v[76:79]
 s_barrier
 ds_read_b64_tr_b16 a[222:223], v47 offset:63488
 v_xor_b32 v44, 0x30000, v44
 v_mfma_f32_16x16x32_bf16 v[76:79], a[200:203], v[144:147], v[76:79]
 s_waitcnt lgkmcnt(4)
 ds_read_b64_tr_b16 a[160:161], v44 offset:0
 buffer_store_dword v9, v9, s[12:15], s93 offen offset:64 sc1
 v_mfma_f32_16x16x32_bf16 v[76:79], a[204:207], v[152:155], v[76:79]
 ds_read_b64_tr_b16 a[162:163], v44 offset:2048
 v_mul_f32 v73, v73, v64
 v_mfma_f32_16x16x32_bf16 v[76:79], a[208:211], v[160:163], v[76:79]
 s_add_u32 m0, s29, 28672
 ds_read_b64_tr_b16 a[164:165], v44 offset:4096
 v_mul_f32 v74, v74, v64
 v_mfma_f32_16x16x32_bf16 v[76:79], a[212:215], v[168:171], v[76:79]
 s_waitcnt lgkmcnt(3)
 ds_read_b64_tr_b16 a[166:167], v44 offset:6144
 buffer_load_dwordx4 v2, s[8:11], s85 offen lds
 v_mfma_f32_16x16x32_bf16 v[76:79], a[216:219], v[176:179], v[76:79]
 s_add_u32 s58, s48, 1114112
 ds_read_b64_tr_b16 a[168:169], v44 offset:8192
 v_add_u32 v2, 128, v2
 v_mfma_f32_16x16x32_bf16 v[76:79], a[220:223], v[184:187], v[76:79]
 ds_read_b64_tr_b16 a[170:171], v44 offset:10240
 buffer_store_dwordx4 v[112:115], v1, s[12:15], s58 offen sc1
 v_mfma_f32_16x16x32_bf16 v[84:87], a[192:195], v[192:195], 0
 ds_read_b64_tr_b16 a[172:173], v44 offset:12288
 v_mul_f32 v75, v75, v64
 v_mfma_f32_16x16x32_bf16 v[84:87], a[196:199], v[200:203], v[84:87]
 ds_read_b64_tr_b16 a[174:175], v44 offset:14336
 v_mul_f32 v80, v80, v65
 v_mfma_f32_16x16x32_bf16 v[84:87], a[200:203], v[208:211], v[84:87]
 ds_read_b64_tr_b16 a[176:177], v44 offset:16384
 v_mul_f32 v81, v81, v65
 v_mfma_f32_16x16x32_bf16 v[84:87], a[204:207], v[216:219], v[84:87]
 ds_read_b64_tr_b16 a[178:179], v44 offset:18432
 v_mul_f32 v82, v82, v65
 v_mfma_f32_16x16x32_bf16 v[84:87], a[208:211], v[224:227], v[84:87]
 ds_read_b64_tr_b16 a[180:181], v44 offset:20480
 v_mul_f32 v76, v76, v64
 v_mfma_f32_16x16x32_bf16 v[84:87], a[212:215], v[232:235], v[84:87]
 ds_read_b64_tr_b16 a[182:183], v44 offset:22528
 v_mul_f32 v77, v77, v64
 v_mfma_f32_16x16x32_bf16 v[84:87], a[216:219], v[240:243], v[84:87]
 ds_read_b64_tr_b16 a[184:185], v44 offset:24576
 v_mul_f32 v78, v78, v64
 v_mfma_f32_16x16x32_bf16 v[84:87], a[220:223], v[248:251], v[84:87]
 s_waitcnt lgkmcnt(7)
 ds_read_b64_tr_b16 a[186:187], v44 offset:26624
 v_mul_f32 v79, v79, v64
 v_mfma_f32_16x16x32_bf16 v[88:91], a[160:163], v[128:131], 0
 ds_read_b64_tr_b16 a[188:189], v44 offset:28672
 v_cvt_pk_bf16_f32 v72, v72, v73
 v_mfma_f32_16x16x32_bf16 v[88:91], a[164:167], v[136:139], v[88:91]
 ds_read_b64_tr_b16 a[190:191], v44 offset:30720
 v_xor_b32 v45, 0x30000, v45
 v_mfma_f32_16x16x32_bf16 v[88:91], a[168:171], v[144:147], v[88:91]
 s_waitcnt lgkmcnt(4)
 ds_read_b64_tr_b16 a[192:193], v45 offset:0
 v_cvt_pk_bf16_f32 v73, v74, v75
 v_mfma_f32_16x16x32_bf16 v[88:91], a[172:175], v[152:155], v[88:91]
 ds_read_b64_tr_b16 a[194:195], v45 offset:2048
 v_cvt_pk_bf16_f32 v74, v76, v77
 v_mfma_f32_16x16x32_bf16 v[88:91], a[176:179], v[160:163], v[88:91]
 s_add_u32 s58, s48, 156672
 ds_read_b64_tr_b16 a[196:197], v45 offset:4096
 v_cvt_pk_bf16_f32 v75, v78, v79
 v_mfma_f32_16x16x32_bf16 v[88:91], a[180:183], v[168:171], v[88:91]
 s_waitcnt lgkmcnt(3)
 ds_read_b64_tr_b16 a[198:199], v45 offset:6144
 buffer_store_dwordx4 v[72:75], v1, s[12:15], s58 offen sc1
 v_mfma_f32_16x16x32_bf16 v[88:91], a[184:187], v[176:179], v[88:91]
 ds_read_b64_tr_b16 a[200:201], v45 offset:8192
 v_mul_f32 v83, v83, v65
 v_mfma_f32_16x16x32_bf16 v[88:91], a[188:191], v[184:187], v[88:91]
 ds_read_b64_tr_b16 a[202:203], v45 offset:10240
 v_mul_f32 v84, v84, v65
 v_mfma_f32_16x16x32_bf16 v[96:99], a[160:163], v[192:195], 0
 ds_read_b64_tr_b16 a[204:205], v45 offset:12288
 v_mul_f32 v85, v85, v65
 v_mfma_f32_16x16x32_bf16 v[96:99], a[164:167], v[200:203], v[96:99]
 ds_read_b64_tr_b16 a[206:207], v45 offset:14336
 v_mul_f32 v86, v86, v65
 v_mfma_f32_16x16x32_bf16 v[96:99], a[168:171], v[208:211], v[96:99]
 ds_read_b64_tr_b16 a[208:209], v45 offset:16384
 v_mul_f32 v87, v87, v65
 v_mfma_f32_16x16x32_bf16 v[96:99], a[172:175], v[216:219], v[96:99]
 ds_read_b64_tr_b16 a[210:211], v45 offset:18432
 v_cvt_pk_bf16_f32 v80, v80, v81
 v_mfma_f32_16x16x32_bf16 v[96:99], a[176:179], v[224:227], v[96:99]
 ds_read_b64_tr_b16 a[212:213], v45 offset:20480
 v_cvt_pk_bf16_f32 v81, v82, v83
 v_mfma_f32_16x16x32_bf16 v[96:99], a[180:183], v[232:235], v[96:99]
 ds_read_b64_tr_b16 a[214:215], v45 offset:22528
 v_cvt_pk_bf16_f32 v82, v84, v85
 v_mfma_f32_16x16x32_bf16 v[96:99], a[184:187], v[240:243], v[96:99]
 s_add_u32 s58, s48, 1131520
 ds_read_b64_tr_b16 a[216:217], v45 offset:24576
 v_cvt_pk_bf16_f32 v83, v86, v87
 v_mfma_f32_16x16x32_bf16 v[96:99], a[188:191], v[248:251], v[96:99]
 s_waitcnt lgkmcnt(7)
 ds_read_b64_tr_b16 a[218:219], v45 offset:26624
 buffer_store_dwordx4 v[80:83], v1, s[12:15], s58 offen sc1
 v_mfma_f32_16x16x32_bf16 v[92:95], a[192:195], v[128:131], 0
 ds_read_b64_tr_b16 a[220:221], v45 offset:28672
 v_mul_f32 v88, v88, v64
 v_mfma_f32_16x16x32_bf16 v[92:95], a[196:199], v[136:139], v[92:95]
 ds_read_b64_tr_b16 a[222:223], v45 offset:30720
 v_xor_b32 v46, 0x30000, v46
 v_mfma_f32_16x16x32_bf16 v[92:95], a[200:203], v[144:147], v[92:95]
 s_waitcnt lgkmcnt(4)
 ds_read_b64_tr_b16 a[160:161], v46 offset:0
 v_mul_f32 v89, v89, v64
 v_mfma_f32_16x16x32_bf16 v[92:95], a[204:207], v[152:155], v[92:95]
 ds_read_b64_tr_b16 a[162:163], v46 offset:2048
 v_mul_f32 v90, v90, v64
 v_mfma_f32_16x16x32_bf16 v[92:95], a[208:211], v[160:163], v[92:95]
 ds_read_b64_tr_b16 a[164:165], v46 offset:4096
 v_mul_f32 v91, v91, v64
 v_mfma_f32_16x16x32_bf16 v[92:95], a[212:215], v[168:171], v[92:95]
 s_waitcnt lgkmcnt(3)
 ds_read_b64_tr_b16 a[166:167], v46 offset:6144
 v_mul_f32 v96, v96, v65
 v_mfma_f32_16x16x32_bf16 v[92:95], a[216:219], v[176:179], v[92:95]
 ds_read_b64_tr_b16 a[168:169], v46 offset:8192
 v_mul_f32 v97, v97, v65
 v_mfma_f32_16x16x32_bf16 v[92:95], a[220:223], v[184:187], v[92:95]
 ds_read_b64_tr_b16 a[170:171], v46 offset:10240
 v_mul_f32 v98, v98, v65
 v_mfma_f32_16x16x32_bf16 v[100:103], a[192:195], v[192:195], 0
 ds_read_b64_tr_b16 a[172:173], v46 offset:12288
 v_mul_f32 v99, v99, v65
 v_mfma_f32_16x16x32_bf16 v[100:103], a[196:199], v[200:203], v[100:103]
 ds_read_b64_tr_b16 a[174:175], v46 offset:14336
 v_mfma_f32_16x16x32_bf16 v[100:103], a[200:203], v[208:211], v[100:103]
 ds_read_b64_tr_b16 a[176:177], v46 offset:16384
 v_mfma_f32_16x16x32_bf16 v[100:103], a[204:207], v[216:219], v[100:103]
 ds_read_b64_tr_b16 a[178:179], v46 offset:18432
 v_mfma_f32_16x16x32_bf16 v[100:103], a[208:211], v[224:227], v[100:103]
 ds_read_b64_tr_b16 a[180:181], v46 offset:20480
 v_mul_f32 v92, v92, v64
 v_mfma_f32_16x16x32_bf16 v[100:103], a[212:215], v[232:235], v[100:103]
 ds_read_b64_tr_b16 a[182:183], v46 offset:22528
 v_mul_f32 v93, v93, v64
 v_mfma_f32_16x16x32_bf16 v[100:103], a[216:219], v[240:243], v[100:103]
 ds_read_b64_tr_b16 a[184:185], v46 offset:24576
 v_mul_f32 v94, v94, v64
 v_mfma_f32_16x16x32_bf16 v[100:103], a[220:223], v[248:251], v[100:103]
 s_waitcnt lgkmcnt(7)
 ds_read_b64_tr_b16 a[186:187], v46 offset:26624
 v_mul_f32 v95, v95, v64
 v_mfma_f32_16x16x32_bf16 v[104:107], a[160:163], v[128:131], 0
 ds_read_b64_tr_b16 a[188:189], v46 offset:28672
 v_cvt_pk_bf16_f32 v88, v88, v89
 v_mfma_f32_16x16x32_bf16 v[104:107], a[164:167], v[136:139], v[104:107]
 ds_read_b64_tr_b16 a[190:191], v46 offset:30720
 v_xor_b32 v47, 0x30000, v47
 v_mfma_f32_16x16x32_bf16 v[104:107], a[168:171], v[144:147], v[104:107]
 s_waitcnt lgkmcnt(4)
 ds_read_b64_tr_b16 a[192:193], v47 offset:0
 v_cvt_pk_bf16_f32 v89, v90, v91
 v_mfma_f32_16x16x32_bf16 v[104:107], a[172:175], v[152:155], v[104:107]
 ds_read_b64_tr_b16 a[194:195], v47 offset:2048
 v_cvt_pk_bf16_f32 v90, v92, v93
 v_mfma_f32_16x16x32_bf16 v[104:107], a[176:179], v[160:163], v[104:107]
 s_add_u32 s58, s48, 174080
 ds_read_b64_tr_b16 a[196:197], v47 offset:4096
 v_cvt_pk_bf16_f32 v91, v94, v95
 v_mfma_f32_16x16x32_bf16 v[104:107], a[180:183], v[168:171], v[104:107]
 s_waitcnt lgkmcnt(3)
 ds_read_b64_tr_b16 a[198:199], v47 offset:6144
 buffer_store_dwordx4 v[88:91], v1, s[12:15], s58 offen sc1
 v_mfma_f32_16x16x32_bf16 v[104:107], a[184:187], v[176:179], v[104:107]
 ds_read_b64_tr_b16 a[200:201], v47 offset:8192
 v_mul_f32 v100, v100, v65
 v_mfma_f32_16x16x32_bf16 v[104:107], a[188:191], v[184:187], v[104:107]
 ds_read_b64_tr_b16 a[202:203], v47 offset:10240
 v_mul_f32 v101, v101, v65
 v_mfma_f32_16x16x32_bf16 v[112:115], a[160:163], v[192:195], 0
 ds_read_b64_tr_b16 a[204:205], v47 offset:12288
 v_mul_f32 v102, v102, v65
 v_mfma_f32_16x16x32_bf16 v[112:115], a[164:167], v[200:203], v[112:115]
 ds_read_b64_tr_b16 a[206:207], v47 offset:14336
 v_mul_f32 v103, v103, v65
 v_mfma_f32_16x16x32_bf16 v[112:115], a[168:171], v[208:211], v[112:115]
 ds_read_b64_tr_b16 a[208:209], v47 offset:16384
 v_cvt_pk_bf16_f32 v96, v96, v97
 v_mfma_f32_16x16x32_bf16 v[112:115], a[172:175], v[216:219], v[112:115]
 ds_read_b64_tr_b16 a[210:211], v47 offset:18432
 v_cvt_pk_bf16_f32 v97, v98, v99
 v_mfma_f32_16x16x32_bf16 v[112:115], a[176:179], v[224:227], v[112:115]
 ds_read_b64_tr_b16 a[212:213], v47 offset:20480
 v_cvt_pk_bf16_f32 v98, v100, v101
 v_mfma_f32_16x16x32_bf16 v[112:115], a[180:183], v[232:235], v[112:115]
 s_add_u32 s58, s48, 1148928
 ds_read_b64_tr_b16 a[214:215], v47 offset:22528
 v_cvt_pk_bf16_f32 v99, v102, v103
 v_mfma_f32_16x16x32_bf16 v[112:115], a[184:187], v[240:243], v[112:115]
 ds_read_b64_tr_b16 a[216:217], v47 offset:24576
 buffer_store_dwordx4 v[96:99], v1, s[12:15], s58 offen sc1
 v_mfma_f32_16x16x32_bf16 v[112:115], a[188:191], v[248:251], v[112:115]
 s_waitcnt lgkmcnt(7)
 ds_read_b64_tr_b16 a[218:219], v47 offset:26624
 v_mul_f32 v104, v104, v64
 v_mfma_f32_16x16x32_bf16 v[108:111], a[192:195], v[128:131], 0
 s_waitcnt vmcnt(5)
 ds_read_b64_tr_b16 a[220:221], v47 offset:28672
 v_mul_f32 v105, v105, v64
 v_mfma_f32_16x16x32_bf16 v[108:111], a[196:199], v[136:139], v[108:111]
 s_barrier
 ds_read_b64_tr_b16 a[222:223], v47 offset:30720
 v_xor_b32 v44, 0x20000, v44
 v_mfma_f32_16x16x32_bf16 v[108:111], a[200:203], v[144:147], v[108:111]
 s_waitcnt lgkmcnt(4)
 ds_read_b64_tr_b16 a[160:161], v44 offset:0
 v_mul_f32 v106, v106, v64
 v_mfma_f32_16x16x32_bf16 v[108:111], a[204:207], v[152:155], v[108:111]
 ds_read_b64_tr_b16 a[162:163], v44 offset:2048
 v_mul_f32 v107, v107, v64
 v_mfma_f32_16x16x32_bf16 v[108:111], a[208:211], v[160:163], v[108:111]
 ds_read_b64_tr_b16 a[164:165], v44 offset:4096
 v_mul_f32 v112, v112, v65
 v_mfma_f32_16x16x32_bf16 v[108:111], a[212:215], v[168:171], v[108:111]
 s_waitcnt lgkmcnt(3)
 ds_read_b64_tr_b16 a[166:167], v44 offset:6144
 v_mul_f32 v113, v113, v65
 v_mfma_f32_16x16x32_bf16 v[108:111], a[216:219], v[176:179], v[108:111]
 ds_read_b64_tr_b16 a[168:169], v44 offset:8192
 v_mul_f32 v114, v114, v65
 v_mfma_f32_16x16x32_bf16 v[108:111], a[220:223], v[184:187], v[108:111]
 ds_read_b64_tr_b16 a[170:171], v44 offset:10240
 v_mul_f32 v115, v115, v65
 v_mfma_f32_16x16x32_bf16 v[116:119], a[192:195], v[192:195], 0
 ds_read_b64_tr_b16 a[172:173], v44 offset:12288
 v_mfma_f32_16x16x32_bf16 v[116:119], a[196:199], v[200:203], v[116:119]
 ds_read_b64_tr_b16 a[174:175], v44 offset:14336
 v_mfma_f32_16x16x32_bf16 v[116:119], a[200:203], v[208:211], v[116:119]
 ds_read_b64_tr_b16 a[176:177], v44 offset:16384
 v_mfma_f32_16x16x32_bf16 v[116:119], a[204:207], v[216:219], v[116:119]
 ds_read_b64_tr_b16 a[178:179], v44 offset:18432
 v_mfma_f32_16x16x32_bf16 v[116:119], a[208:211], v[224:227], v[116:119]
 ds_read_b64_tr_b16 a[180:181], v44 offset:20480
 v_mul_f32 v108, v108, v64
 v_mfma_f32_16x16x32_bf16 v[116:119], a[212:215], v[232:235], v[116:119]
 ds_read_b64_tr_b16 a[182:183], v44 offset:22528
 v_mul_f32 v109, v109, v64
 v_mfma_f32_16x16x32_bf16 v[116:119], a[216:219], v[240:243], v[116:119]
 ds_read_b64_tr_b16 a[184:185], v44 offset:24576
 v_mul_f32 v110, v110, v64
 v_mfma_f32_16x16x32_bf16 v[116:119], a[220:223], v[248:251], v[116:119]
 s_waitcnt lgkmcnt(7)
 ds_read_b64_tr_b16 a[186:187], v44 offset:26624
 v_mul_f32 v111, v111, v64
 v_mfma_f32_16x16x32_bf16 v[72:75], a[160:163], v[128:131], 0
 ds_read_b64_tr_b16 a[188:189], v44 offset:28672
 v_cvt_pk_bf16_f32 v104, v104, v105
 v_mfma_f32_16x16x32_bf16 v[72:75], a[164:167], v[136:139], v[72:75]
 ds_read_b64_tr_b16 a[190:191], v44 offset:30720
 v_xor_b32 v45, 0x20000, v45
 v_mfma_f32_16x16x32_bf16 v[72:75], a[168:171], v[144:147], v[72:75]
 s_waitcnt lgkmcnt(4)
 ds_read_b64_tr_b16 a[192:193], v45 offset:0
 v_cvt_pk_bf16_f32 v105, v106, v107
 v_mfma_f32_16x16x32_bf16 v[72:75], a[172:175], v[152:155], v[72:75]
 ds_read_b64_tr_b16 a[194:195], v45 offset:2048
 v_cvt_pk_bf16_f32 v106, v108, v109
 v_mfma_f32_16x16x32_bf16 v[72:75], a[176:179], v[160:163], v[72:75]
 s_add_u32 s58, s48, 191488
 ds_read_b64_tr_b16 a[196:197], v45 offset:4096
 v_cvt_pk_bf16_f32 v107, v110, v111
 v_mfma_f32_16x16x32_bf16 v[72:75], a[180:183], v[168:171], v[72:75]
 s_waitcnt lgkmcnt(3)
 ds_read_b64_tr_b16 a[198:199], v45 offset:6144
 buffer_store_dwordx4 v[104:107], v1, s[12:15], s58 offen sc1
 v_mfma_f32_16x16x32_bf16 v[72:75], a[184:187], v[176:179], v[72:75]
 ds_read_b64_tr_b16 a[200:201], v45 offset:8192
 v_mul_f32 v116, v116, v65
 v_mfma_f32_16x16x32_bf16 v[72:75], a[188:191], v[184:187], v[72:75]
 ds_read_b64_tr_b16 a[202:203], v45 offset:10240
 v_mul_f32 v117, v117, v65
 v_mfma_f32_16x16x32_bf16 v[80:83], a[160:163], v[192:195], 0
 ds_read_b64_tr_b16 a[204:205], v45 offset:12288
 v_mul_f32 v118, v118, v65
 v_mfma_f32_16x16x32_bf16 v[80:83], a[164:167], v[200:203], v[80:83]
 ds_read_b64_tr_b16 a[206:207], v45 offset:14336
 v_mul_f32 v119, v119, v65
 v_mfma_f32_16x16x32_bf16 v[80:83], a[168:171], v[208:211], v[80:83]
 ds_read_b64_tr_b16 a[208:209], v45 offset:16384
 v_cvt_pk_bf16_f32 v112, v112, v113
 v_mfma_f32_16x16x32_bf16 v[80:83], a[172:175], v[216:219], v[80:83]
 ds_read_b64_tr_b16 a[210:211], v45 offset:18432
 v_cvt_pk_bf16_f32 v113, v114, v115
 v_mfma_f32_16x16x32_bf16 v[80:83], a[176:179], v[224:227], v[80:83]
 ds_read_b64_tr_b16 a[212:213], v45 offset:20480
 v_cvt_pk_bf16_f32 v114, v116, v117
 v_mfma_f32_16x16x32_bf16 v[80:83], a[180:183], v[232:235], v[80:83]
 s_add_u32 s58, s48, 1166336
 ds_read_b64_tr_b16 a[214:215], v45 offset:22528
 v_cvt_pk_bf16_f32 v115, v118, v119
 v_mfma_f32_16x16x32_bf16 v[80:83], a[184:187], v[240:243], v[80:83]
 ds_read_b64_tr_b16 a[216:217], v45 offset:24576
 buffer_store_dwordx4 v[112:115], v1, s[12:15], s58 offen sc1
 v_mfma_f32_16x16x32_bf16 v[80:83], a[188:191], v[248:251], v[80:83]
 s_waitcnt lgkmcnt(7)
 ds_read_b64_tr_b16 a[218:219], v45 offset:26624
 v_mul_f32 v72, v72, v64
 v_mfma_f32_16x16x32_bf16 v[76:79], a[192:195], v[128:131], 0
 ds_read_b64_tr_b16 a[220:221], v45 offset:28672
 v_mul_f32 v73, v73, v64
 v_mfma_f32_16x16x32_bf16 v[76:79], a[196:199], v[136:139], v[76:79]
 ds_read_b64_tr_b16 a[222:223], v45 offset:30720
 v_xor_b32 v46, 0x20000, v46
 v_mfma_f32_16x16x32_bf16 v[76:79], a[200:203], v[144:147], v[76:79]
 s_waitcnt lgkmcnt(4)
 ds_read_b64_tr_b16 a[160:161], v46 offset:0
 v_mul_f32 v74, v74, v64
 v_mfma_f32_16x16x32_bf16 v[76:79], a[204:207], v[152:155], v[76:79]
 ds_read_b64_tr_b16 a[162:163], v46 offset:2048
 v_mul_f32 v75, v75, v64
 v_mfma_f32_16x16x32_bf16 v[76:79], a[208:211], v[160:163], v[76:79]
 ds_read_b64_tr_b16 a[164:165], v46 offset:4096
 v_mul_f32 v80, v80, v65
 v_mfma_f32_16x16x32_bf16 v[76:79], a[212:215], v[168:171], v[76:79]
 s_waitcnt lgkmcnt(3)
 ds_read_b64_tr_b16 a[166:167], v46 offset:6144
 v_mul_f32 v81, v81, v65
 v_mfma_f32_16x16x32_bf16 v[76:79], a[216:219], v[176:179], v[76:79]
 ds_read_b64_tr_b16 a[168:169], v46 offset:8192
 v_mul_f32 v82, v82, v65
 v_mfma_f32_16x16x32_bf16 v[76:79], a[220:223], v[184:187], v[76:79]
 ds_read_b64_tr_b16 a[170:171], v46 offset:10240
 v_mul_f32 v83, v83, v65
 v_mfma_f32_16x16x32_bf16 v[84:87], a[192:195], v[192:195], 0
 ds_read_b64_tr_b16 a[172:173], v46 offset:12288
 buffer_load_dword v12, v10, s[12:15], s44 offen sc1
 v_mfma_f32_16x16x32_bf16 v[84:87], a[196:199], v[200:203], v[84:87]
 ds_read_b64_tr_b16 a[174:175], v46 offset:14336
 v_mfma_f32_16x16x32_bf16 v[84:87], a[200:203], v[208:211], v[84:87]
 ds_read_b64_tr_b16 a[176:177], v46 offset:16384
 v_mfma_f32_16x16x32_bf16 v[84:87], a[204:207], v[216:219], v[84:87]
 ds_read_b64_tr_b16 a[178:179], v46 offset:18432
 v_mfma_f32_16x16x32_bf16 v[84:87], a[208:211], v[224:227], v[84:87]
 ds_read_b64_tr_b16 a[180:181], v46 offset:20480
 v_mul_f32 v76, v76, v64
 v_mfma_f32_16x16x32_bf16 v[84:87], a[212:215], v[232:235], v[84:87]
 ds_read_b64_tr_b16 a[182:183], v46 offset:22528
 v_mul_f32 v77, v77, v64
 v_mfma_f32_16x16x32_bf16 v[84:87], a[216:219], v[240:243], v[84:87]
 ds_read_b64_tr_b16 a[184:185], v46 offset:24576
 v_mul_f32 v78, v78, v64
 v_mfma_f32_16x16x32_bf16 v[84:87], a[220:223], v[248:251], v[84:87]
 s_waitcnt lgkmcnt(7)
 ds_read_b64_tr_b16 a[186:187], v46 offset:26624
 v_mul_f32 v79, v79, v64
 v_mfma_f32_16x16x32_bf16 v[88:91], a[160:163], v[128:131], 0
 ds_read_b64_tr_b16 a[188:189], v46 offset:28672
 v_cvt_pk_bf16_f32 v72, v72, v73
 v_mfma_f32_16x16x32_bf16 v[88:91], a[164:167], v[136:139], v[88:91]
 ds_read_b64_tr_b16 a[190:191], v46 offset:30720
 v_xor_b32 v47, 0x20000, v47
 v_mfma_f32_16x16x32_bf16 v[88:91], a[168:171], v[144:147], v[88:91]
 s_waitcnt lgkmcnt(4)
 ds_read_b64_tr_b16 a[192:193], v47 offset:0
 v_cvt_pk_bf16_f32 v73, v74, v75
 v_mfma_f32_16x16x32_bf16 v[88:91], a[172:175], v[152:155], v[88:91]
 ds_read_b64_tr_b16 a[194:195], v47 offset:2048
 v_cvt_pk_bf16_f32 v74, v76, v77
 v_mfma_f32_16x16x32_bf16 v[88:91], a[176:179], v[160:163], v[88:91]
 s_add_u32 s58, s48, 208896
 ds_read_b64_tr_b16 a[196:197], v47 offset:4096
 v_cvt_pk_bf16_f32 v75, v78, v79
 v_mfma_f32_16x16x32_bf16 v[88:91], a[180:183], v[168:171], v[88:91]
 s_waitcnt lgkmcnt(3)
 ds_read_b64_tr_b16 a[198:199], v47 offset:6144
 buffer_store_dwordx4 v[72:75], v1, s[12:15], s58 offen sc1
 v_mfma_f32_16x16x32_bf16 v[88:91], a[184:187], v[176:179], v[88:91]
 ds_read_b64_tr_b16 a[200:201], v47 offset:8192
 v_mul_f32 v84, v84, v65
 v_mfma_f32_16x16x32_bf16 v[88:91], a[188:191], v[184:187], v[88:91]
 ds_read_b64_tr_b16 a[202:203], v47 offset:10240
 v_mul_f32 v85, v85, v65
 v_mfma_f32_16x16x32_bf16 v[96:99], a[160:163], v[192:195], 0
 ds_read_b64_tr_b16 a[204:205], v47 offset:12288
 v_mul_f32 v86, v86, v65
 v_mfma_f32_16x16x32_bf16 v[96:99], a[164:167], v[200:203], v[96:99]
 ds_read_b64_tr_b16 a[206:207], v47 offset:14336
 v_mul_f32 v87, v87, v65
 v_mfma_f32_16x16x32_bf16 v[96:99], a[168:171], v[208:211], v[96:99]
 ds_read_b64_tr_b16 a[208:209], v47 offset:16384
 v_cvt_pk_bf16_f32 v80, v80, v81
 v_mfma_f32_16x16x32_bf16 v[96:99], a[172:175], v[216:219], v[96:99]
 ds_read_b64_tr_b16 a[210:211], v47 offset:18432
 v_cvt_pk_bf16_f32 v81, v82, v83
 v_mfma_f32_16x16x32_bf16 v[96:99], a[176:179], v[224:227], v[96:99]
 ds_read_b64_tr_b16 a[212:213], v47 offset:20480
 v_cvt_pk_bf16_f32 v82, v84, v85
 v_mfma_f32_16x16x32_bf16 v[96:99], a[180:183], v[232:235], v[96:99]
 s_add_u32 s58, s48, 1183744
 ds_read_b64_tr_b16 a[214:215], v47 offset:22528
 v_cvt_pk_bf16_f32 v83, v86, v87
 v_mfma_f32_16x16x32_bf16 v[96:99], a[184:187], v[240:243], v[96:99]
 ds_read_b64_tr_b16 a[216:217], v47 offset:24576
 buffer_store_dwordx4 v[80:83], v1, s[12:15], s58 offen sc1
 v_mfma_f32_16x16x32_bf16 v[96:99], a[188:191], v[248:251], v[96:99]
 s_waitcnt lgkmcnt(7)
 ds_read_b64_tr_b16 a[218:219], v47 offset:26624
 v_mul_f32 v88, v88, v64
 v_mfma_f32_16x16x32_bf16 v[92:95], a[192:195], v[128:131], 0
 ds_read_b64_tr_b16 a[220:221], v47 offset:28672
 v_mul_f32 v89, v89, v64
 v_mfma_f32_16x16x32_bf16 v[92:95], a[196:199], v[136:139], v[92:95]
 ds_read_b64_tr_b16 a[222:223], v47 offset:30720
 v_mul_f32 v90, v90, v64
 v_mfma_f32_16x16x32_bf16 v[92:95], a[200:203], v[144:147], v[92:95]
 s_waitcnt lgkmcnt(4)
 v_mul_f32 v91, v91, v64
 v_mfma_f32_16x16x32_bf16 v[92:95], a[204:207], v[152:155], v[92:95]
 v_mfma_f32_16x16x32_bf16 v[92:95], a[208:211], v[160:163], v[92:95]
 v_mul_f32 v96, v96, v65
 v_mul_f32 v97, v97, v65
 v_mfma_f32_16x16x32_bf16 v[92:95], a[212:215], v[168:171], v[92:95]
 s_waitcnt lgkmcnt(0)
 v_mul_f32 v98, v98, v65
 v_mul_f32 v99, v99, v65
 v_mfma_f32_16x16x32_bf16 v[92:95], a[216:219], v[176:179], v[92:95]
 v_mfma_f32_16x16x32_bf16 v[92:95], a[220:223], v[184:187], v[92:95]
 v_mfma_f32_16x16x32_bf16 v[100:103], a[192:195], v[192:195], 0
 v_mfma_f32_16x16x32_bf16 v[100:103], a[196:199], v[200:203], v[100:103]
 v_mfma_f32_16x16x32_bf16 v[100:103], a[200:203], v[208:211], v[100:103]
 v_mfma_f32_16x16x32_bf16 v[100:103], a[204:207], v[216:219], v[100:103]
 v_mfma_f32_16x16x32_bf16 v[100:103], a[208:211], v[224:227], v[100:103]
 v_mfma_f32_16x16x32_bf16 v[100:103], a[212:215], v[232:235], v[100:103]
 v_mfma_f32_16x16x32_bf16 v[100:103], a[216:219], v[240:243], v[100:103]
 v_mfma_f32_16x16x32_bf16 v[100:103], a[220:223], v[248:251], v[100:103]
 s_nop 4
 v_mul_f32 v92, v92, v64
 v_mul_f32 v93, v93, v64
 v_mul_f32 v94, v94, v64
 v_mul_f32 v95, v95, v64
 v_cvt_pk_bf16_f32 v88, v88, v89
 v_cvt_pk_bf16_f32 v89, v90, v91
 v_cvt_pk_bf16_f32 v90, v92, v93
 v_cvt_pk_bf16_f32 v91, v94, v95
 s_add_u32 s58, s48, 226304
 buffer_store_dwordx4 v[88:91], v1, s[12:15], s58 offen sc1
 v_mul_f32 v100, v100, v65
 v_mul_f32 v101, v101, v65
 v_mul_f32 v102, v102, v65
 v_mul_f32 v103, v103, v65
 v_cvt_pk_bf16_f32 v96, v96, v97
 v_cvt_pk_bf16_f32 v97, v98, v99
 v_cvt_pk_bf16_f32 v98, v100, v101
 v_cvt_pk_bf16_f32 v99, v102, v103
 s_add_u32 s58, s48, 1201152
 buffer_store_dwordx4 v[96:99], v1, s[12:15], s58 offen sc1
 s_cmp_ge_u32 s28, 14
 s_cbranch_scc1 L_idle
 s_waitcnt vmcnt(4)
 v_cmp_ne_u32 vcc, 0, v12
 s_cmp_eq_u64 vcc, 0
 s_cselect_b32 s50, 1, 0
 s_cselect_b32 s51, s38, 2.0
 s_lshl_b32 s42, s42, 4
 s_lshl_b32 s36, s41, 6
 s_add_u32 s36, s36, 896
 s_add_u32 s35, s36, 1835008
 s_add_u32 s39, s37, 15597568
 s_mov_b32 s8, s88
 s_mov_b32 s9, s89
 s_mov_b32 s10, 3670016
 s_mov_b32 s11, 0x20000
 v_and_b32 v2, 15, v0
 v_add_u32 v2, s42, v2
 v_mul_u32_u24 v7, 896, v2
 v_lshrrev_b32 v3, 4, v0
 v_lshlrev_b32 v8, 4, v3
 v_lshl_add_u32 v2, v7, 1, v8
 v_add_u32 v7, v7, v8
 v_and_b32 v4, 1, v0
 v_lshlrev_b32 v4, 4, v4
 v_mov_b32 v5, 0x3f80
 v_lshlrev_b32 v4, v4, v5
 v_bfe_u32 v5, v0, 3, 1
 v_bfe_u32 v6, v0, 1, 1
 v_lshl_add_u32 v5, v5, 1, v6
 v_bfe_u32 v6, v0, 2, 1
 v_lshlrev_b32 v6, 1, v6
 v_sub_u32 v6, v3, v6
 v_lshl_add_u32 v5, v6, 2, v5
 v_cmp_eq_u32 s[16:17], 0, v5
 v_cmp_eq_u32 s[18:19], 1, v5
 v_cmp_eq_u32 s[20:21], 2, v5
 v_cmp_eq_u32 s[22:23], 3, v5
 v_cndmask_b32 v24, 0, v4, s[16:17]
 v_cndmask_b32 v25, 0, v4, s[18:19]
 v_cndmask_b32 v26, 0, v4, s[20:21]
 v_cndmask_b32 v27, 0, v4, s[22:23]
 v_cmp_eq_u32 s[16:17], 4, v5
 v_cmp_eq_u32 s[18:19], 5, v5
 v_cmp_eq_u32 s[20:21], 6, v5
 v_cmp_eq_u32 s[22:23], 7, v5
 v_cndmask_b32 v28, 0, v4, s[16:17]
 v_cndmask_b32 v29, 0, v4, s[18:19]
 v_cndmask_b32 v30, 0, v4, s[20:21]
 v_cndmask_b32 v31, 0, v4, s[22:23]
 s_add_u32 s45, s44, 1024
 s_add_u32 s39, s39, 121856
 s_waitcnt vmcnt(0)
 s_barrier
 buffer_store_dword v9, v9, s[12:15], s93 offen sc1
 buffer_load_dwordx4 a[128:131], v1, s[12:15], s51 offen offset:0 sc1
 buffer_load_dwordx4 a[132:135], v1, s[12:15], s51 offen offset:1024 sc1
 buffer_load_dwordx4 a[136:139], v1, s[12:15], s51 offen offset:2048 sc1
 buffer_load_dwordx4 a[140:143], v1, s[12:15], s51 offen offset:3072 sc1
 s_add_u32 s51, s51, 4096
 buffer_load_dwordx4 a[144:147], v1, s[12:15], s51 offen offset:0 sc1
 buffer_load_dwordx4 a[148:151], v1, s[12:15], s51 offen offset:1024 sc1
 buffer_load_dwordx4 a[152:155], v1, s[12:15], s51 offen offset:2048 sc1
 buffer_load_dwordx4 a[156:159], v1, s[12:15], s51 offen offset:3072 sc1
 s_add_u32 s51, s51, 4096
 buffer_load_dwordx4 a[160:163], v1, s[12:15], s51 offen offset:0 sc1
 buffer_load_dwordx4 a[164:167], v1, s[12:15], s51 offen offset:1024 sc1
 buffer_load_dwordx4 a[168:171], v1, s[12:15], s51 offen offset:2048 sc1
 buffer_load_dwordx4 a[172:175], v1, s[12:15], s51 offen offset:3072 sc1
 s_add_u32 s51, s51, 4096
 buffer_load_dwordx4 a[176:179], v1, s[12:15], s51 offen offset:0 sc1
 buffer_load_dwordx4 a[180:183], v1, s[12:15], s51 offen offset:1024 sc1
 buffer_load_dwordx4 a[184:187], v1, s[12:15], s51 offen offset:2048 sc1
 buffer_load_dwordx4 a[188:191], v1, s[12:15], s51 offen offset:3072 sc1
 s_add_u32 s51, s51, 4096
 s_cmp_eq_u32 s50, 1
 s_cbranch_scc1 L_haveshort
 v_and_b32 v16, 15, v0
 v_lshlrev_b32 v16, 2, v16
 s_mov_b32 s32, 0
L_poll6:
 buffer_load_dword v17, v16, s[12:15], s44 offen sc1
 s_waitcnt vmcnt(0)
 v_cmp_ne_u32 vcc, 0, v17
 s_cbranch_vccz L_poll6_ok
 s_sleep 6
 s_add_u32 s32, s32, 1
 s_cmp_lt_u32 s32, 0x80000
 s_cbranch_scc1 L_poll6
L_poll6_ok:
 buffer_load_dwordx4 a[128:131], v1, s[12:15], s38 offen offset:0 sc1
 buffer_load_dwordx4 a[132:135], v1, s[12:15], s38 offen offset:1024 sc1
 buffer_load_dwordx4 a[136:139], v1, s[12:15], s38 offen offset:2048 sc1
 buffer_load_dwordx4 a[140:143], v1, s[12:15], s38 offen offset:3072 sc1
 s_add_u32 s38, s38, 4096
 buffer_load_dwordx4 a[144:147], v1, s[12:15], s38 offen offset:0 sc1
 buffer_load_dwordx4 a[148:151], v1, s[12:15], s38 offen offset:1024 sc1
 buffer_load_dwordx4 a[152:155], v1, s[12:15], s38 offen offset:2048 sc1
 buffer_load_dwordx4 a[156:159], v1, s[12:15], s38 offen offset:3072 sc1
 s_add_u32 s38, s38, 4096
 buffer_load_dwordx4 a[160:163], v1, s[12:15], s38 offen offset:0 sc1
 buffer_load_dwordx4 a[164:167], v1, s[12:15], s38 offen offset:1024 sc1
 buffer_load_dwordx4 a[168:171], v1, s[12:15], s38 offen offset:2048 sc1
 buffer_load_dwordx4 a[172:175], v1, s[12:15], s38 offen offset:3072 sc1
 s_add_u32 s38, s38, 4096
 buffer_load_dwordx4 a[176:179], v1, s[12:15], s38 offen offset:0 sc1
 buffer_load_dwordx4 a[180:183], v1, s[12:15], s38 offen offset:1024 sc1
 buffer_load_dwordx4 a[184:187], v1, s[12:15], s38 offen offset:2048 sc1
 buffer_load_dwordx4 a[188:191], v1, s[12:15], s38 offen offset:3072 sc1
 s_add_u32 s38, s38, 4096
L_haveshort:
 v_and_b32 v17, 15, v0
 v_lshlrev_b32 v17, 2, v17
 buffer_load_dword a246, v17, s[12:15], s45 offen sc1
 s_waitcnt vmcnt(16)
 v_mfma_f32_16x16x32_bf16 v[40:43], v[24:27], a[128:131], 0
 v_mfma_f32_16x16x32_bf16 v[44:47], v[28:31], a[128:131], 0
 s_waitcnt vmcnt(15)
 v_mfma_f32_16x16x32_bf16 v[40:43], v[24:27], a[132:135], v[40:43]
 v_mfma_f32_16x16x32_bf16 v[44:47], v[28:31], a[132:135], v[44:47]
 s_waitcnt vmcnt(14)
 v_mfma_f32_16x16x32_bf16 v[40:43], v[24:27], a[136:139], v[40:43]
 v_mfma_f32_16x16x32_bf16 v[44:47], v[28:31], a[136:139], v[44:47]
 s_waitcnt vmcnt(13)
 v_mfma_f32_16x16x32_bf16 v[40:43], v[24:27], a[140:143], v[40:43]
 v_mfma_f32_16x16x32_bf16 v[44:47], v[28:31], a[140:143], v[44:47]
 s_waitcnt vmcnt(12)
 v_mfma_f32_16x16x32_bf16 v[40:43], v[24:27], a[144:147], v[40:43]
 v_mfma_f32_16x16x32_bf16 v[44:47], v[28:31], a[144:147], v[44:47]
 s_waitcnt vmcnt(11)
 v_mfma_f32_16x16x32_bf16 v[40:43], v[24:27], a[148:151], v[40:43]
 v_mfma_f32_16x16x32_bf16 v[44:47], v[28:31], a[148:151], v[44:47]
 s_waitcnt vmcnt(10)
 v_mfma_f32_16x16x32_bf16 v[40:43], v[24:27], a[152:155], v[40:43]
 v_mfma_f32_16x16x32_bf16 v[44:47], v[28:31], a[152:155], v[44:47]
 s_waitcnt vmcnt(9)
 v_mfma_f32_16x16x32_bf16 v[40:43], v[24:27], a[156:159], v[40:43]
 v_mfma_f32_16x16x32_bf16 v[44:47], v[28:31], a[156:159], v[44:47]
 s_waitcnt vmcnt(8)
 v_mfma_f32_16x16x32_bf16 v[40:43], v[24:27], a[160:163], v[40:43]
 v_mfma_f32_16x16x32_bf16 v[44:47], v[28:31], a[160:163], v[44:47]
 s_waitcnt vmcnt(7)
 v_mfma_f32_16x16x32_bf16 v[40:43], v[24:27], a[164:167], v[40:43]
 v_mfma_f32_16x16x32_bf16 v[44:47], v[28:31], a[164:167], v[44:47]
 s_waitcnt vmcnt(6)
 v_mfma_f32_16x16x32_bf16 v[40:43], v[24:27], a[168:171], v[40:43]
 v_mfma_f32_16x16x32_bf16 v[44:47], v[28:31], a[168:171], v[44:47]
 s_waitcnt vmcnt(5)
 v_mfma_f32_16x16x32_bf16 v[40:43], v[24:27], a[172:175], v[40:43]
 v_mfma_f32_16x16x32_bf16 v[44:47], v[28:31], a[172:175], v[44:47]
 s_waitcnt vmcnt(4)
 v_mfma_f32_16x16x32_bf16 v[40:43], v[24:27], a[176:179], v[40:43]
 v_mfma_f32_16x16x32_bf16 v[44:47], v[28:31], a[176:179], v[44:47]
 s_waitcnt vmcnt(3)
 v_mfma_f32_16x16x32_bf16 v[40:43], v[24:27], a[180:183], v[40:43]
 v_mfma_f32_16x16x32_bf16 v[44:47], v[28:31], a[180:183], v[44:47]
 s_waitcnt vmcnt(2)
 v_mfma_f32_16x16x32_bf16 v[40:43], v[24:27], a[184:187], v[40:43]
 v_mfma_f32_16x16x32_bf16 v[44:47], v[28:31], a[184:187], v[44:47]
 s_waitcnt vmcnt(1)
 v_mfma_f32_16x16x32_bf16 v[40:43], v[24:27], a[188:191], v[40:43]
 v_mfma_f32_16x16x32_bf16 v[44:47], v[28:31], a[188:191], v[44:47]
 s_nop 7
 v_cvt_pk_bf16_f32 v40, v40, v41
 v_cvt_pk_bf16_f32 v41, v42, v43
 v_cvt_pk_bf16_f32 v42, v44, v45
 v_cvt_pk_bf16_f32 v43, v46, v47
 buffer_store_dwordx4 v[40:43], v2, s[8:11], s36 offen offset:448
 s_waitcnt vmcnt(1)
 s_waitcnt vmcnt(2)
 s_cmp_lg_u32 s3, 0
 s_cbranch_scc1 L_w0a
 v_accvgpr_read_b32 v17, a246
 v_cmp_ne_u32 vcc, 0, v17
 s_cbranch_vccz L_poll7_ok
 v_and_b32 v16, 15, v0
 v_lshlrev_b32 v16, 2, v16
 s_mov_b32 s32, 0
L_poll7:
 buffer_load_dword v17, v16, s[12:15], s45 offen sc1
 s_waitcnt vmcnt(0)
 v_cmp_ne_u32 vcc, 0, v17
 s_cbranch_vccz L_poll7_ok
 s_sleep 6
 s_add_u32 s32, s32, 1
 s_cmp_lt_u32 s32, 0x80000
 s_cbranch_scc1 L_poll7
L_poll7_ok:
L_w0a:
 s_barrier
 buffer_load_dwordx4 a[0:3], v1, s[12:15], s39 offen offset:0 sc1
 buffer_load_dwordx4 a[4:7], v1, s[12:15], s39 offen offset:1024 sc1
 buffer_load_dwordx4 a[8:11], v1, s[12:15], s39 offen offset:2048 sc1
 buffer_load_dwordx4 a[12:15], v1, s[12:15], s39 offen offset:3072 sc1
 s_add_u32 s39, s39, 4096
 buffer_load_dwordx4 a[16:19], v1, s[12:15], s39 offen offset:0 sc1
 buffer_load_dwordx4 a[20:23], v1, s[12:15], s39 offen offset:1024 sc1
 buffer_load_dwordx4 a[24:27], v1, s[12:15], s39 offen offset:2048 sc1
 buffer_load_dwordx4 a[28:31], v1, s[12:15], s39 offen offset:3072 sc1
 s_add_u32 s39, s39, 4096
 buffer_load_dwordx4 a[32:35], v1, s[12:15], s39 offen offset:0 sc1
 buffer_load_dwordx4 a[36:39], v1, s[12:15], s39 offen offset:1024 sc1
 buffer_load_dwordx4 a[40:43], v1, s[12:15], s39 offen offset:2048 sc1
 buffer_load_dwordx4 a[44:47], v1, s[12:15], s39 offen offset:3072 sc1
 s_add_u32 s39, s39, 4096
 buffer_load_dwordx4 a[48:51], v1, s[12:15], s39 offen offset:0 sc1
 buffer_load_dwordx4 a[52:55], v1, s[12:15], s39 offen offset:1024 sc1
 buffer_load_dwordx4 a[56:59], v1, s[12:15], s39 offen offset:2048 sc1
 buffer_load_dwordx4 a[60:63], v1, s[12:15], s39 offen offset:3072 sc1
 s_add_u32 s39, s39, 4096
 s_waitcnt vmcnt(15)
 v_mfma_f32_16x16x32_bf16 v[48:51], v[24:27], a[0:3], 0
 v_mfma_f32_16x16x32_bf16 v[52:55], v[28:31], a[0:3], 0
 s_waitcnt vmcnt(14)
 v_mfma_f32_16x16x32_bf16 v[48:51], v[24:27], a[4:7], v[48:51]
 v_mfma_f32_16x16x32_bf16 v[52:55], v[28:31], a[4:7], v[52:55]
 s_waitcnt vmcnt(13)
 v_mfma_f32_16x16x32_bf16 v[48:51], v[24:27], a[8:11], v[48:51]
 v_mfma_f32_16x16x32_bf16 v[52:55], v[28:31], a[8:11], v[52:55]
 s_waitcnt vmcnt(12)
 v_mfma_f32_16x16x32_bf16 v[48:51], v[24:27], a[12:15], v[48:51]
 v_mfma_f32_16x16x32_bf16 v[52:55], v[28:31], a[12:15], v[52:55]
 s_waitcnt vmcnt(11)
 v_mfma_f32_16x16x32_bf16 v[48:51], v[24:27], a[16:19], v[48:51]
 v_mfma_f32_16x16x32_bf16 v[52:55], v[28:31], a[16:19], v[52:55]
 s_waitcnt vmcnt(10)
 v_mfma_f32_16x16x32_bf16 v[48:51], v[24:27], a[20:23], v[48:51]
 v_mfma_f32_16x16x32_bf16 v[52:55], v[28:31], a[20:23], v[52:55]
 s_waitcnt vmcnt(9)
 v_mfma_f32_16x16x32_bf16 v[48:51], v[24:27], a[24:27], v[48:51]
 v_mfma_f32_16x16x32_bf16 v[52:55], v[28:31], a[24:27], v[52:55]
 s_waitcnt vmcnt(8)
 v_mfma_f32_16x16x32_bf16 v[48:51], v[24:27], a[28:31], v[48:51]
 v_mfma_f32_16x16x32_bf16 v[52:55], v[28:31], a[28:31], v[52:55]
 s_waitcnt vmcnt(7)
 v_mfma_f32_16x16x32_bf16 v[48:51], v[24:27], a[32:35], v[48:51]
 v_mfma_f32_16x16x32_bf16 v[52:55], v[28:31], a[32:35], v[52:55]
 s_waitcnt vmcnt(6)
 v_mfma_f32_16x16x32_bf16 v[48:51], v[24:27], a[36:39], v[48:51]
 v_mfma_f32_16x16x32_bf16 v[52:55], v[28:31], a[36:39], v[52:55]
 s_waitcnt vmcnt(5)
 v_mfma_f32_16x16x32_bf16 v[48:51], v[24:27], a[40:43], v[48:51]
 v_mfma_f32_16x16x32_bf16 v[52:55], v[28:31], a[40:43], v[52:55]
 s_waitcnt vmcnt(4)
 v_mfma_f32_16x16x32_bf16 v[48:51], v[24:27], a[44:47], v[48:51]
 v_mfma_f32_16x16x32_bf16 v[52:55], v[28:31], a[44:47], v[52:55]
 s_waitcnt vmcnt(3)
 v_mfma_f32_16x16x32_bf16 v[48:51], v[24:27], a[48:51], v[48:51]
 v_mfma_f32_16x16x32_bf16 v[52:55], v[28:31], a[48:51], v[52:55]
 s_waitcnt vmcnt(2)
 v_mfma_f32_16x16x32_bf16 v[48:51], v[24:27], a[52:55], v[48:51]
 v_mfma_f32_16x16x32_bf16 v[52:55], v[28:31], a[52:55], v[52:55]
 s_waitcnt vmcnt(1)
 v_mfma_f32_16x16x32_bf16 v[48:51], v[24:27], a[56:59], v[48:51]
 v_mfma_f32_16x16x32_bf16 v[52:55], v[28:31], a[56:59], v[52:55]
 s_waitcnt vmcnt(0)
 v_mfma_f32_16x16x32_bf16 v[48:51], v[24:27], a[60:63], v[48:51]
 v_mfma_f32_16x16x32_bf16 v[52:55], v[28:31], a[60:63], v[52:55]
 s_nop 7
 v_cvt_pk_bf16_f32 v48, v48, v49
 v_cvt_pk_bf16_f32 v49, v50, v51
 v_cvt_pk_bf16_f32 v50, v52, v53
 v_cvt_pk_bf16_f32 v51, v54, v55
 buffer_store_dwordx4 v[48:51], v2, s[8:11], s35 offen offset:448
 s_branch L_fin
L_idle:
 s_waitcnt vmcnt(0)
 s_barrier
 s_cmp_lg_u32 s3, 0
 s_cbranch_scc1 L_pub8
 v_mov_b32 v11, 0
 s_mov_b64 exec, 1
 buffer_store_dword v11, v11, s[12:15], s93 offen sc1
 s_mov_b64 exec, -1
L_pub8:
 s_branch L_fin
L_opB:
 v_accvgpr_read_b32 v44, a254
 ds_read_b64_tr_b16 a[0:1], v44 offset:0
 ds_read_b64_tr_b16 a[2:3], v44 offset:2048
 ds_read_b64_tr_b16 a[4:5], v44 offset:4096
 ds_read_b64_tr_b16 a[6:7], v44 offset:6144
 ds_read_b64_tr_b16 a[8:9], v44 offset:8192
 ds_read_b64_tr_b16 a[10:11], v44 offset:10240
 ds_read_b64_tr_b16 a[12:13], v44 offset:12288
 ds_read_b64_tr_b16 a[14:15], v44 offset:14336
 ds_read_b64_tr_b16 a[16:17], v44 offset:16384
 ds_read_b64_tr_b16 a[18:19], v44 offset:18432
 ds_read_b64_tr_b16 a[20:21], v44 offset:20480
 ds_read_b64_tr_b16 a[22:23], v44 offset:22528
 ds_read_b64_tr_b16 a[24:25], v44 offset:24576
 ds_read_b64_tr_b16 a[26:27], v44 offset:26624
L_op0in:
 s_waitcnt lgkmcnt(7)
 v_mfma_f32_16x16x32_bf16 v[72:75], a[0:3], a[128:131], 0
 ds_read_b64_tr_b16 a[28:29], v44 offset:28672
 buffer_store_dwordx4 v[68:71], v1, s[12:15], s57 offen sc1
 v_mfma_f32_16x16x32_bf16 v[72:75], a[4:7], a[132:135], v[72:75]
 s_lshl_b32 s48, s63, 3
 ds_read_b64_tr_b16 a[30:31], v44 offset:30720
 v_xor_b32 v45, 32, v44
 v_mfma_f32_16x16x32_bf16 v[72:75], a[8:11], a[136:139], v[72:75]
 s_waitcnt lgkmcnt(4)
 ds_read_b64_tr_b16 a[32:33], v45 offset:0
 v_xor_b32 v46, 64, v44
 v_mfma_f32_16x16x32_bf16 v[72:75], a[12:15], a[140:143], v[72:75]
 ds_read_b64_tr_b16 a[34:35], v45 offset:2048
 buffer_store_dwordx4 v[168:171], v4, s[12:15], s55 offen offset:1024 sc1
 v_mfma_f32_16x16x32_bf16 v[72:75], a[16:19], a[144:147], v[72:75]
 s_add_u32 s48, s48, s3
 ds_read_b64_tr_b16 a[36:37], v45 offset:4096
 v_xor_b32 v47, 96, v44
 v_mfma_f32_16x16x32_bf16 v[72:75], a[20:23], a[148:151], v[72:75]
 s_waitcnt lgkmcnt(3)
 ds_read_b64_tr_b16 a[38:39], v45 offset:6144
 v_accvgpr_read_b32 v9, a245
 v_mfma_f32_16x16x32_bf16 v[72:75], a[24:27], a[152:155], v[72:75]
 ds_read_b64_tr_b16 a[40:41], v45 offset:8192
 buffer_store_dwordx4 v[232:235], v4, s[12:15], s56 offen offset:1024 sc1
 v_mfma_f32_16x16x32_bf16 v[72:75], a[28:31], a[156:159], v[72:75]
 s_mul_i32 s48, s48, 243712
 ds_read_b64_tr_b16 a[42:43], v45 offset:10240
 v_mfma_f32_16x16x32_bf16 v[80:83], a[0:3], a[160:163], 0
 s_lshl_b32 s58, s26, 10
 ds_read_b64_tr_b16 a[44:45], v45 offset:12288
 v_mfma_f32_16x16x32_bf16 v[80:83], a[4:7], a[164:167], v[80:83]
 ds_read_b64_tr_b16 a[46:47], v45 offset:14336
 buffer_store_dwordx4 v[176:179], v4, s[12:15], s55 offen offset:2048 sc1
 v_mfma_f32_16x16x32_bf16 v[80:83], a[8:11], a[168:171], v[80:83]
 s_add_u32 s48, s48, s58
 ds_read_b64_tr_b16 a[48:49], v45 offset:16384
 v_mfma_f32_16x16x32_bf16 v[80:83], a[12:15], a[172:175], v[80:83]
 s_add_u32 s48, s48, 117440512
 ds_read_b64_tr_b16 a[50:51], v45 offset:18432
 v_mfma_f32_16x16x32_bf16 v[80:83], a[16:19], a[176:179], v[80:83]
 ds_read_b64_tr_b16 a[52:53], v45 offset:20480
 buffer_store_dwordx4 v[240:243], v4, s[12:15], s56 offen offset:2048 sc1
 v_mfma_f32_16x16x32_bf16 v[80:83], a[20:23], a[180:183], v[80:83]
 ds_read_b64_tr_b16 a[54:55], v45 offset:22528
 v_mul_f32 v72, v72, v64
 v_mfma_f32_16x16x32_bf16 v[80:83], a[24:27], a[184:187], v[80:83]
 ds_read_b64_tr_b16 a[56:57], v45 offset:24576
 v_mul_f32 v73, v73, v64
 v_mfma_f32_16x16x32_bf16 v[80:83], a[28:31], a[188:191], v[80:83]
 s_waitcnt lgkmcnt(7)
 ds_read_b64_tr_b16 a[58:59], v45 offset:26624
 buffer_store_dwordx4 v[184:187], v4, s[12:15], s55 offen offset:3072 sc1
 v_mfma_f32_16x16x32_bf16 v[76:79], a[32:35], a[128:131], 0
 ds_read_b64_tr_b16 a[60:61], v45 offset:28672
 v_mul_f32 v74, v74, v64
 v_mfma_f32_16x16x32_bf16 v[76:79], a[36:39], a[132:135], v[76:79]
 ds_read_b64_tr_b16 a[62:63], v45 offset:30720
 v_mul_f32 v75, v75, v64
 v_mfma_f32_16x16x32_bf16 v[76:79], a[40:43], a[136:139], v[76:79]
 s_waitcnt lgkmcnt(4)
 ds_read_b64_tr_b16 a[0:1], v46 offset:0
 buffer_store_dwordx4 v[248:251], v4, s[12:15], s56 offen offset:3072 sc1
 v_mfma_f32_16x16x32_bf16 v[76:79], a[44:47], a[140:143], v[76:79]
 ds_read_b64_tr_b16 a[2:3], v46 offset:2048
 v_mfma_f32_16x16x32_bf16 v[76:79], a[48:51], a[144:147], v[76:79]
 s_add_u32 m0, s29, 32768
 ds_read_b64_tr_b16 a[4:5], v46 offset:4096
 v_mul_f32 v80, v80, v65
 v_mfma_f32_16x16x32_bf16 v[76:79], a[52:55], a[148:151], v[76:79]
 s_waitcnt lgkmcnt(3)
 ds_read_b64_tr_b16 a[6:7], v46 offset:6144
 buffer_load_dwordx4 v2, s[8:11], s78 offen lds
 v_mfma_f32_16x16x32_bf16 v[76:79], a[56:59], a[152:155], v[76:79]
 ds_read_b64_tr_b16 a[8:9], v46 offset:8192
 v_mul_f32 v81, v81, v65
 v_mfma_f32_16x16x32_bf16 v[76:79], a[60:63], a[156:159], v[76:79]
 ds_read_b64_tr_b16 a[10:11], v46 offset:10240
 v_mul_f32 v82, v82, v65
 v_mfma_f32_16x16x32_bf16 v[84:87], a[32:35], a[160:163], 0
 ds_read_b64_tr_b16 a[12:13], v46 offset:12288
 v_mul_f32 v83, v83, v65
 v_mfma_f32_16x16x32_bf16 v[84:87], a[36:39], a[164:167], v[84:87]
 ds_read_b64_tr_b16 a[14:15], v46 offset:14336
 v_mfma_f32_16x16x32_bf16 v[84:87], a[40:43], a[168:171], v[84:87]
 ds_read_b64_tr_b16 a[16:17], v46 offset:16384
 v_mfma_f32_16x16x32_bf16 v[84:87], a[44:47], a[172:175], v[84:87]
 s_add_u32 m0, s29, 36864
 ds_read_b64_tr_b16 a[18:19], v46 offset:18432
 v_mfma_f32_16x16x32_bf16 v[84:87], a[48:51], a[176:179], v[84:87]
 ds_read_b64_tr_b16 a[20:21], v46 offset:20480
 buffer_load_dwordx4 v2, s[8:11], s79 offen lds
 v_mfma_f32_16x16x32_bf16 v[84:87], a[52:55], a[180:183], v[84:87]
 ds_read_b64_tr_b16 a[22:23], v46 offset:22528
 v_mul_f32 v76, v76, v64
 v_mfma_f32_16x16x32_bf16 v[84:87], a[56:59], a[184:187], v[84:87]
 s_lshl_b32 s44, s24, 7
 ds_read_b64_tr_b16 a[24:25], v46 offset:24576
 v_mul_f32 v77, v77, v64
 v_mfma_f32_16x16x32_bf16 v[84:87], a[60:63], a[188:191], v[84:87]
 s_waitcnt lgkmcnt(7)
 ds_read_b64_tr_b16 a[26:27], v46 offset:26624
 v_mul_f32 v78, v78, v64
 v_mfma_f32_16x16x32_bf16 v[88:91], a[0:3], a[128:131], 0
 s_add_u32 s44, s44, 84938752
 ds_read_b64_tr_b16 a[28:29], v46 offset:28672
 v_mul_f32 v79, v79, v64
 v_mfma_f32_16x16x32_bf16 v[88:91], a[4:7], a[132:135], v[88:91]
 s_add_u32 m0, s29, 40960
 ds_read_b64_tr_b16 a[30:31], v46 offset:30720
 v_cvt_pk_bf16_f32 v72, v72, v73
 v_mfma_f32_16x16x32_bf16 v[88:91], a[8:11], a[136:139], v[88:91]
 s_waitcnt lgkmcnt(4)
 ds_read_b64_tr_b16 a[32:33], v47 offset:0
 v_cvt_pk_bf16_f32 v73, v74, v75
 v_mfma_f32_16x16x32_bf16 v[88:91], a[12:15], a[140:143], v[88:91]
 ds_read_b64_tr_b16 a[34:35], v47 offset:2048
 buffer_load_dwordx4 v2, s[8:11], s80 offen lds
 v_mfma_f32_16x16x32_bf16 v[88:91], a[16:19], a[144:147], v[88:91]
 s_add_u32 s58, s48, 0
 ds_read_b64_tr_b16 a[36:37], v47 offset:4096
 v_cvt_pk_bf16_f32 v74, v76, v77
 v_mfma_f32_16x16x32_bf16 v[88:91], a[20:23], a[148:151], v[88:91]
 s_waitcnt lgkmcnt(3)
 ds_read_b64_tr_b16 a[38:39], v47 offset:6144
 v_cvt_pk_bf16_f32 v75, v78, v79
 v_mfma_f32_16x16x32_bf16 v[88:91], a[24:27], a[152:155], v[88:91]
 ds_read_b64_tr_b16 a[40:41], v47 offset:8192
 buffer_store_dwordx4 v[72:75], v1, s[12:15], s58 offen sc1
 v_mfma_f32_16x16x32_bf16 v[88:91], a[28:31], a[156:159], v[88:91]
 s_waitcnt vmcnt(4)
 ds_read_b64_tr_b16 a[42:43], v47 offset:10240
 v_mul_f32 v84, v84, v65
 v_mfma_f32_16x16x32_bf16 v[96:99], a[0:3], a[160:163], 0
 s_barrier
 ds_read_b64_tr_b16 a[44:45], v47 offset:12288
 v_mul_f32 v85, v85, v65
 v_mfma_f32_16x16x32_bf16 v[96:99], a[4:7], a[164:167], v[96:99]
 ds_read_b64_tr_b16 a[46:47], v47 offset:14336
 buffer_store_dword v9, v9, s[12:15], s59 offen sc1
 v_mfma_f32_16x16x32_bf16 v[96:99], a[8:11], a[168:171], v[96:99]
 s_add_u32 m0, s29, 45056
 ds_read_b64_tr_b16 a[48:49], v47 offset:16384
 v_mul_f32 v86, v86, v65
 v_mfma_f32_16x16x32_bf16 v[96:99], a[12:15], a[172:175], v[96:99]
 ds_read_b64_tr_b16 a[50:51], v47 offset:18432
 buffer_load_dwordx4 v2, s[8:11], s81 offen lds
 v_mfma_f32_16x16x32_bf16 v[96:99], a[16:19], a[176:179], v[96:99]
 s_lshl_b32 s40, s24, 1
 ds_read_b64_tr_b16 a[52:53], v47 offset:20480
 v_mul_f32 v87, v87, v65
 v_mfma_f32_16x16x32_bf16 v[96:99], a[20:23], a[180:183], v[96:99]
 s_and_b32 s41, s28, 1
 ds_read_b64_tr_b16 a[54:55], v47 offset:22528
 v_cvt_pk_bf16_f32 v80, v80, v81
 v_mfma_f32_16x16x32_bf16 v[96:99], a[24:27], a[184:187], v[96:99]
 s_add_u32 s40, s40, s41
 ds_read_b64_tr_b16 a[56:57], v47 offset:24576
 v_cvt_pk_bf16_f32 v81, v82, v83
 v_mfma_f32_16x16x32_bf16 v[96:99], a[28:31], a[188:191], v[96:99]
 s_waitcnt lgkmcnt(7)
 ds_read_b64_tr_b16 a[58:59], v47 offset:26624
 v_cvt_pk_bf16_f32 v82, v84, v85
 v_mfma_f32_16x16x32_bf16 v[92:95], a[32:35], a[128:131], 0
 s_lshr_b32 s41, s28, 1
 ds_read_b64_tr_b16 a[60:61], v47 offset:28672
 v_cvt_pk_bf16_f32 v83, v86, v87
 v_mfma_f32_16x16x32_bf16 v[92:95], a[36:39], a[132:135], v[92:95]
 s_add_u32 m0, s29, 49152
 ds_read_b64_tr_b16 a[62:63], v47 offset:30720
 v_xor_b32 v44, 0x20000, v44
 v_mfma_f32_16x16x32_bf16 v[92:95], a[40:43], a[136:139], v[92:95]
 s_waitcnt lgkmcnt(4)
 ds_read_b64_tr_b16 a[0:1], v44 offset:0
 buffer_load_dwordx4 v2, s[8:11], s82 offen lds
 v_mfma_f32_16x16x32_bf16 v[92:95], a[44:47], a[140:143], v[92:95]
 s_add_u32 s58, s48, 974848
 ds_read_b64_tr_b16 a[2:3], v44 offset:2048
 v_mul_f32 v88, v88, v64
 v_mfma_f32_16x16x32_bf16 v[92:95], a[48:51], a[144:147], v[92:95]
 ds_read_b64_tr_b16 a[4:5], v44 offset:4096
 buffer_store_dwordx4 v[80:83], v1, s[12:15], s58 offen sc1
 v_mfma_f32_16x16x32_bf16 v[92:95], a[52:55], a[148:151], v[92:95]
 s_waitcnt lgkmcnt(3)
 ds_read_b64_tr_b16 a[6:7], v44 offset:6144
 v_mul_f32 v89, v89, v64
 v_mfma_f32_16x16x32_bf16 v[92:95], a[56:59], a[152:155], v[92:95]
 s_lshl_b32 s42, s40, 2
 ds_read_b64_tr_b16 a[8:9], v44 offset:8192
 v_mul_f32 v90, v90, v64
 v_mfma_f32_16x16x32_bf16 v[92:95], a[60:63], a[156:159], v[92:95]
 s_add_u32 s42, s42, s3
 ds_read_b64_tr_b16 a[10:11], v44 offset:10240
 v_mul_f32 v91, v91, v64
 v_mfma_f32_16x16x32_bf16 v[100:103], a[32:35], a[160:163], 0
 s_add_u32 m0, s29, 53248
 ds_read_b64_tr_b16 a[12:13], v44 offset:12288
 v_mul_f32 v96, v96, v65
 v_mfma_f32_16x16x32_bf16 v[100:103], a[36:39], a[164:167], v[100:103]
 ds_read_b64_tr_b16 a[14:15], v44 offset:14336
 buffer_load_dwordx4 v2, s[8:11], s83 offen lds
 v_mfma_f32_16x16x32_bf16 v[100:103], a[40:43], a[168:171], v[100:103]
 s_mul_i32 s37, s42, 243712
 ds_read_b64_tr_b16 a[16:17], v44 offset:16384
 v_mul_f32 v97, v97, v65
 v_mfma_f32_16x16x32_bf16 v[100:103], a[44:47], a[172:175], v[100:103]
 s_mul_i32 s43, s41, 17408
 ds_read_b64_tr_b16 a[18:19], v44 offset:18432
 v_mul_f32 v98, v98, v65
 v_mfma_f32_16x16x32_bf16 v[100:103], a[48:51], a[176:179], v[100:103]
 s_add_u32 s37, s37, s43
 ds_read_b64_tr_b16 a[20:21], v44 offset:20480
 v_mul_f32 v92, v92, v64
 v_mfma_f32_16x16x32_bf16 v[100:103], a[52:55], a[180:183], v[100:103]
 s_add_u32 s37, s37, 117440512
 ds_read_b64_tr_b16 a[22:23], v44 offset:22528
 v_mul_f32 v93, v93, v64
 v_mfma_f32_16x16x32_bf16 v[100:103], a[56:59], a[184:187], v[100:103]
 s_add_u32 m0, s29, 57344
 ds_read_b64_tr_b16 a[24:25], v44 offset:24576
 v_mul_f32 v94, v94, v64
 v_mfma_f32_16x16x32_bf16 v[100:103], a[60:63], a[188:191], v[100:103]
 s_waitcnt lgkmcnt(7)
 ds_read_b64_tr_b16 a[26:27], v44 offset:26624
 v_mul_f32 v95, v95, v64
 v_mfma_f32_16x16x32_bf16 v[104:107], a[0:3], a[128:131], 0
 ds_read_b64_tr_b16 a[28:29], v44 offset:28672
 buffer_load_dwordx4 v2, s[8:11], s84 offen lds
 v_mfma_f32_16x16x32_bf16 v[104:107], a[4:7], a[132:135], v[104:107]
 s_add_u32 s38, s37, 121856
 ds_read_b64_tr_b16 a[30:31], v44 offset:30720
 v_xor_b32 v45, 0x20000, v45
 v_mfma_f32_16x16x32_bf16 v[104:107], a[8:11], a[136:139], v[104:107]
 s_waitcnt lgkmcnt(4)
 ds_read_b64_tr_b16 a[32:33], v45 offset:0
 v_cvt_pk_bf16_f32 v88, v88, v89
 v_mfma_f32_16x16x32_bf16 v[104:107], a[12:15], a[140:143], v[104:107]
 ds_read_b64_tr_b16 a[34:35], v45 offset:2048
 v_cvt_pk_bf16_f32 v89, v90, v91
 v_mfma_f32_16x16x32_bf16 v[104:107], a[16:19], a[144:147], v[104:107]
 ds_read_b64_tr_b16 a[36:37], v45 offset:4096
 v_cvt_pk_bf16_f32 v90, v92, v93
 v_mfma_f32_16x16x32_bf16 v[104:107], a[20:23], a[148:151], v[104:107]
 s_waitcnt lgkmcnt(3)
 ds_read_b64_tr_b16 a[38:39], v45 offset:6144
 v_cvt_pk_bf16_f32 v91, v94, v95
 v_mfma_f32_16x16x32_bf16 v[104:107], a[24:27], a[152:155], v[104:107]
 s_add_u32 m0, s29, 61440
 ds_read_b64_tr_b16 a[40:41], v45 offset:8192
 v_mul_f32 v99, v99, v65
 v_mfma_f32_16x16x32_bf16 v[104:107], a[28:31], a[156:159], v[104:107]
 ds_read_b64_tr_b16 a[42:43], v45 offset:10240
 buffer_load_dwordx4 v2, s[8:11], s85 offen lds
 v_mfma_f32_16x16x32_bf16 v[112:115], a[0:3], a[160:163], 0
 s_add_u32 s58, s48, 17408
 ds_read_b64_tr_b16 a[44:45], v45 offset:12288
 v_add_u32 v2, 128, v2
 v_mfma_f32_16x16x32_bf16 v[112:115], a[4:7], a[164:167], v[112:115]
 ds_read_b64_tr_b16 a[46:47], v45 offset:14336
 buffer_store_dwordx4 v[88:91], v1, s[12:15], s58 offen sc1
 v_mfma_f32_16x16x32_bf16 v[112:115], a[8:11], a[168:171], v[112:115]
 ds_read_b64_tr_b16 a[48:49], v45 offset:16384
 v_mul_f32 v100, v100, v65
 v_mfma_f32_16x16x32_bf16 v[112:115], a[12:15], a[172:175], v[112:115]
 ds_read_b64_tr_b16 a[50:51], v45 offset:18432
 v_mul_f32 v101, v101, v65
 v_mfma_f32_16x16x32_bf16 v[112:115], a[16:19], a[176:179], v[112:115]
 ds_read_b64_tr_b16 a[52:53], v45 offset:20480
 v_mul_f32 v102, v102, v65
 v_mfma_f32_16x16x32_bf16 v[112:115], a[20:23], a[180:183], v[112:115]
 s_add_u32 m0, s29, 65536
 ds_read_b64_tr_b16 a[54:55], v45 offset:22528
 v_mul_f32 v103, v103, v65
 v_mfma_f32_16x16x32_bf16 v[112:115], a[24:27], a[184:187], v[112:115]
 ds_read_b64_tr_b16 a[56:57], v45 offset:24576
 buffer_load_dwordx4 v2, s[8:11], s78 offen lds
 v_mfma_f32_16x16x32_bf16 v[112:115], a[28:31], a[188:191], v[112:115]
 s_waitcnt lgkmcnt(7)
 ds_read_b64_tr_b16 a[58:59], v45 offset:26624
 v_cvt_pk_bf16_f32 v96, v96, v97
 v_mfma_f32_16x16x32_bf16 v[108:111], a[32:35], a[128:131], 0
 ds_read_b64_tr_b16 a[60:61], v45 offset:28672
 v_cvt_pk_bf16_f32 v97, v98, v99
 v_mfma_f32_16x16x32_bf16 v[108:111], a[36:39], a[132:135], v[108:111]
 ds_read_b64_tr_b16 a[62:63], v45 offset:30720
 v_xor_b32 v46, 0x20000, v46
 v_mfma_f32_16x16x32_bf16 v[108:111], a[40:43], a[136:139], v[108:111]
 s_waitcnt lgkmcnt(4)
 ds_read_b64_tr_b16 a[0:1], v46 offset:0
 v_cvt_pk_bf16_f32 v98, v100, v101
 v_mfma_f32_16x16x32_bf16 v[108:111], a[44:47], a[140:143], v[108:111]
 ds_read_b64_tr_b16 a[2:3], v46 offset:2048
 v_cvt_pk_bf16_f32 v99, v102, v103
 v_mfma_f32_16x16x32_bf16 v[108:111], a[48:51], a[144:147], v[108:111]
 s_add_u32 m0, s29, 69632
 ds_read_b64_tr_b16 a[4:5], v46 offset:4096
 v_mul_f32 v104, v104, v64
 v_mfma_f32_16x16x32_bf16 v[108:111], a[52:55], a[148:151], v[108:111]
 s_waitcnt lgkmcnt(3)
 ds_read_b64_tr_b16 a[6:7], v46 offset:6144
 buffer_load_dwordx4 v2, s[8:11], s79 offen lds
 v_mfma_f32_16x16x32_bf16 v[108:111], a[56:59], a[152:155], v[108:111]
 s_add_u32 s58, s48, 992256
 ds_read_b64_tr_b16 a[8:9], v46 offset:8192
 v_mul_f32 v105, v105, v64
 v_mfma_f32_16x16x32_bf16 v[108:111], a[60:63], a[156:159], v[108:111]
 ds_read_b64_tr_b16 a[10:11], v46 offset:10240
 buffer_store_dwordx4 v[96:99], v1, s[12:15], s58 offen sc1
 v_mfma_f32_16x16x32_bf16 v[116:119], a[32:35], a[160:163], 0
 ds_read_b64_tr_b16 a[12:13], v46 offset:12288
 v_mul_f32 v106, v106, v64
 v_mfma_f32_16x16x32_bf16 v[116:119], a[36:39], a[164:167], v[116:119]
 ds_read_b64_tr_b16 a[14:15], v46 offset:14336
 v_mul_f32 v107, v107, v64
 v_mfma_f32_16x16x32_bf16 v[116:119], a[40:43], a[168:171], v[116:119]
 ds_read_b64_tr_b16 a[16:17], v46 offset:16384
 v_mul_f32 v112, v112, v65
 v_mfma_f32_16x16x32_bf16 v[116:119], a[44:47], a[172:175], v[116:119]
 s_add_u32 m0, s29, 73728
 ds_read_b64_tr_b16 a[18:19], v46 offset:18432
 v_mul_f32 v113, v113, v65
 v_mfma_f32_16x16x32_bf16 v[116:119], a[48:51], a[176:179], v[116:119]
 ds_read_b64_tr_b16 a[20:21], v46 offset:20480
 buffer_load_dwordx4 v2, s[8:11], s80 offen lds
 v_mfma_f32_16x16x32_bf16 v[116:119], a[52:55], a[180:183], v[116:119]
 ds_read_b64_tr_b16 a[22:23], v46 offset:22528
 v_mul_f32 v108, v108, v64
 v_mfma_f32_16x16x32_bf16 v[116:119], a[56:59], a[184:187], v[116:119]
 ds_read_b64_tr_b16 a[24:25], v46 offset:24576
 v_mul_f32 v109, v109, v64
 v_mfma_f32_16x16x32_bf16 v[116:119], a[60:63], a[188:191], v[116:119]
 s_waitcnt lgkmcnt(7)
 ds_read_b64_tr_b16 a[26:27], v46 offset:26624
 v_mul_f32 v110, v110, v64
 v_mfma_f32_16x16x32_bf16 v[72:75], a[0:3], a[128:131], 0
 ds_read_b64_tr_b16 a[28:29], v46 offset:28672
 v_mul_f32 v111, v111, v64
 v_mfma_f32_16x16x32_bf16 v[72:75], a[4:7], a[132:135], v[72:75]
 s_add_u32 m0, s29, 77824
 ds_read_b64_tr_b16 a[30:31], v46 offset:30720
 v_xor_b32 v47, 0x20000, v47
 v_mfma_f32_16x16x32_bf16 v[72:75], a[8:11], a[136:139], v[72:75]
 s_waitcnt lgkmcnt(4)
 ds_read_b64_tr_b16 a[32:33], v47 offset:0
 v_cvt_pk_bf16_f32 v104, v104, v105
 v_mfma_f32_16x16x32_bf16 v[72:75], a[12:15], a[140:143], v[72:75]
 ds_read_b64_tr_b16 a[34:35], v47 offset:2048
 buffer_load_dwordx4 v2, s[8:11], s81 offen lds
 v_mfma_f32_16x16x32_bf16 v[72:75], a[16:19], a[144:147], v[72:75]
 ds_read_b64_tr_b16 a[36:37], v47 offset:4096
 v_cvt_pk_bf16_f32 v105, v106, v107
 v_mfma_f32_16x16x32_bf16 v[72:75], a[20:23], a[148:151], v[72:75]
 s_waitcnt lgkmcnt(3)
 ds_read_b64_tr_b16 a[38:39], v47 offset:6144
 v_cvt_pk_bf16_f32 v106, v108, v109
 v_mfma_f32_16x16x32_bf16 v[72:75], a[24:27], a[152:155], v[72:75]
 s_add_u32 s58, s48, 34816
 ds_read_b64_tr_b16 a[40:41], v47 offset:8192
 v_cvt_pk_bf16_f32 v107, v110, v111
 v_mfma_f32_16x16x32_bf16 v[72:75], a[28:31], a[156:159], v[72:75]
 ds_read_b64_tr_b16 a[42:43], v47 offset:10240
 buffer_store_dwordx4 v[104:107], v1, s[12:15], s58 offen sc1
 v_mfma_f32_16x16x32_bf16 v[80:83], a[0:3], a[160:163], 0
 ds_read_b64_tr_b16 a[44:45], v47 offset:12288
 v_mul_f32 v114, v114, v65
 v_mfma_f32_16x16x32_bf16 v[80:83], a[4:7], a[164:167], v[80:83]
 s_add_u32 m0, s29, 81920
 ds_read_b64_tr_b16 a[46:47], v47 offset:14336
 v_mul_f32 v115, v115, v65
 v_mfma_f32_16x16x32_bf16 v[80:83], a[8:11], a[168:171], v[80:83]
 ds_read_b64_tr_b16 a[48:49], v47 offset:16384
 buffer_load_dwordx4 v2, s[8:11], s82 offen lds
 v_mfma_f32_16x16x32_bf16 v[80:83], a[12:15], a[172:175], v[80:83]
 ds_read_b64_tr_b16 a[50:51], v47 offset:18432
 v_mul_f32 v116, v116, v65
 v_mfma_f32_16x16x32_bf16 v[80:83], a[16:19], a[176:179], v[80:83]
 ds_read_b64_tr_b16 a[52:53], v47 offset:20480
 v_mul_f32 v117, v117, v65
 v_mfma_f32_16x16x32_bf16 v[80:83], a[20:23], a[180:183], v[80:83]
 ds_read_b64_tr_b16 a[54:55], v47 offset:22528
 v_mul_f32 v118, v118, v65
 v_mfma_f32_16x16x32_bf16 v[80:83], a[24:27], a[184:187], v[80:83]
 ds_read_b64_tr_b16 a[56:57], v47 offset:24576
 v_mul_f32 v119, v119, v65
 v_mfma_f32_16x16x32_bf16 v[80:83], a[28:31], a[188:191], v[80:83]
 s_waitcnt lgkmcnt(7)
 ds_read_b64_tr_b16 a[58:59], v47 offset:26624
 v_cvt_pk_bf16_f32 v112, v112, v113
 v_mfma_f32_16x16x32_bf16 v[76:79], a[32:35], a[128:131], 0
 s_waitcnt vmcnt(8)
 ds_read_b64_tr_b16 a[60:61], v47 offset:28672
 v_cvt_pk_bf16_f32 v113, v114, v115
 v_mfma_f32_16x16x32_bf16 v[76:79], a[36:39], a[132:135], v[76:79]
 s_barrier
 ds_read_b64_tr_b16 a[62:63], v47 offset:30720
 v_cvt_pk_bf16_f32 v114, v116, v117
 v_mfma_f32_16x16x32_bf16 v[76:79], a[40:43], a[136:139], v[76:79]
 s_waitcnt lgkmcnt(4)
 ds_read_b64_tr_b16 a[0:1], v44 offset:32768
 v_cvt_pk_bf16_f32 v115, v118, v119
 v_mfma_f32_16x16x32_bf16 v[76:79], a[44:47], a[140:143], v[76:79]
 s_add_u32 m0, s29, 86016
 ds_read_b64_tr_b16 a[2:3], v44 offset:34816
 v_mul_f32 v72, v72, v64
 v_mfma_f32_16x16x32_bf16 v[76:79], a[48:51], a[144:147], v[76:79]
 ds_read_b64_tr_b16 a[4:5], v44 offset:36864
 buffer_load_dwordx4 v2, s[8:11], s83 offen lds
 v_mfma_f32_16x16x32_bf16 v[76:79], a[52:55], a[148:151], v[76:79]
 s_waitcnt lgkmcnt(3)
 ds_read_b64_tr_b16 a[6:7], v44 offset:38912
 v_mul_f32 v73, v73, v64
 v_mfma_f32_16x16x32_bf16 v[76:79], a[56:59], a[152:155], v[76:79]
 s_add_u32 s58, s48, 1009664
 ds_read_b64_tr_b16 a[8:9], v44 offset:40960
 v_mul_f32 v74, v74, v64
 v_mfma_f32_16x16x32_bf16 v[76:79], a[60:63], a[156:159], v[76:79]
 ds_read_b64_tr_b16 a[10:11], v44 offset:43008
 buffer_store_dwordx4 v[112:115], v1, s[12:15], s58 offen sc1
 v_mfma_f32_16x16x32_bf16 v[84:87], a[32:35], a[160:163], 0
 ds_read_b64_tr_b16 a[12:13], v44 offset:45056
 v_mul_f32 v75, v75, v64
 v_mfma_f32_16x16x32_bf16 v[84:87], a[36:39], a[164:167], v[84:87]
 ds_read_b64_tr_b16 a[14:15], v44 offset:47104
 v_mul_f32 v80, v80, v65
 v_mfma_f32_16x16x32_bf16 v[84:87], a[40:43], a[168:171], v[84:87]
 s_add_u32 m0, s29, 90112
 ds_read_b64_tr_b16 a[16:17], v44 offset:49152
 v_mul_f32 v81, v81, v65
 v_mfma_f32_16x16x32_bf16 v[84:87], a[44:47], a[172:175], v[84:87]
 ds_read_b64_tr_b16 a[18:19], v44 offset:51200
 buffer_load_dwordx4 v2, s[8:11], s84 offen lds
 v_mfma_f32_16x16x32_bf16 v[84:87], a[48:51], a[176:179], v[84:87]
 ds_read_b64_tr_b16 a[20:21], v44 offset:53248
 v_mul_f32 v76, v76, v64
 v_mfma_f32_16x16x32_bf16 v[84:87], a[52:55], a[180:183], v[84:87]
 ds_read_b64_tr_b16 a[22:23], v44 offset:55296
 v_mul_f32 v77, v77, v64
 v_mfma_f32_16x16x32_bf16 v[84:87], a[56:59], a[184:187], v[84:87]
 ds_read_b64_tr_b16 a[24:25], v44 offset:57344
 v_mul_f32 v78, v78, v64
 v_mfma_f32_16x16x32_bf16 v[84:87], a[60:63], a[188:191], v[84:87]
 s_waitcnt lgkmcnt(7)
 ds_read_b64_tr_b16 a[26:27], v44 offset:59392
 v_mul_f32 v79, v79, v64
 v_mfma_f32_16x16x32_bf16 v[88:91], a[0:3], a[128:131], 0
 ds_read_b64_tr_b16 a[28:29], v44 offset:61440
 v_cvt_pk_bf16_f32 v72, v72, v73
 v_mfma_f32_16x16x32_bf16 v[88:91], a[4:7], a[132:135], v[88:91]
 s_add_u32 m0, s29, 94208
 ds_read_b64_tr_b16 a[30:31], v44 offset:63488
 v_cvt_pk_bf16_f32 v73, v74, v75
 v_mfma_f32_16x16x32_bf16 v[88:91], a[8:11], a[136:139], v[88:91]
 s_waitcnt lgkmcnt(4)
 ds_read_b64_tr_b16 a[32:33], v45 offset:32768
 buffer_load_dwordx4 v2, s[8:11], s85 offen lds
 v_mfma_f32_16x16x32_bf16 v[88:91], a[12:15], a[140:143], v[88:91]
 ds_read_b64_tr_b16 a[34:35], v45 offset:34816
 v_add_u32 v2, 128, v2
 v_mfma_f32_16x16x32_bf16 v[88:91], a[16:19], a[144:147], v[88:91]
 s_add_u32 s58, s48, 52224
 ds_read_b64_tr_b16 a[36:37], v45 offset:36864
 v_cvt_pk_bf16_f32 v74, v76, v77
 v_mfma_f32_16x16x32_bf16 v[88:91], a[20:23], a[148:151], v[88:91]
 s_waitcnt lgkmcnt(3)
 ds_read_b64_tr_b16 a[38:39], v45 offset:38912
 v_cvt_pk_bf16_f32 v75, v78, v79
 v_mfma_f32_16x16x32_bf16 v[88:91], a[24:27], a[152:155], v[88:91]
 ds_read_b64_tr_b16 a[40:41], v45 offset:40960
 buffer_store_dwordx4 v[72:75], v1, s[12:15], s58 offen sc1
 v_mfma_f32_16x16x32_bf16 v[88:91], a[28:31], a[156:159], v[88:91]
 ds_read_b64_tr_b16 a[42:43], v45 offset:43008
 v_mul_f32 v82, v82, v65
 v_mfma_f32_16x16x32_bf16 v[96:99], a[0:3], a[160:163], 0
 s_add_u32 m0, s29, 98304
 ds_read_b64_tr_b16 a[44:45], v45 offset:45056
 v_mul_f32 v83, v83, v65
 v_mfma_f32_16x16x32_bf16 v[96:99], a[4:7], a[164:167], v[96:99]
 ds_read_b64_tr_b16 a[46:47], v45 offset:47104
 buffer_load_dwordx4 v2, s[8:11], s78 offen lds
 v_mfma_f32_16x16x32_bf16 v[96:99], a[8:11], a[168:171], v[96:99]
 ds_read_b64_tr_b16 a[48:49], v45 offset:49152
 v_mul_f32 v84, v84, v65
 v_mfma_f32_16x16x32_bf16 v[96:99], a[12:15], a[172:175], v[96:99]
 ds_read_b64_tr_b16 a[50:51], v45 offset:51200
 v_mul_f32 v85, v85, v65
 v_mfma_f32_16x16x32_bf16 v[96:99], a[16:19], a[176:179], v[96:99]
 ds_read_b64_tr_b16 a[52:53], v45 offset:53248
 v_mul_f32 v86, v86, v65
 v_mfma_f32_16x16x32_bf16 v[96:99], a[20:23], a[180:183], v[96:99]
 ds_read_b64_tr_b16 a[54:55], v45 offset:55296
 v_mul_f32 v87, v87, v65
 v_mfma_f32_16x16x32_bf16 v[96:99], a[24:27], a[184:187], v[96:99]
 s_add_u32 m0, s29, 102400
 ds_read_b64_tr_b16 a[56:57], v45 offset:57344
 v_cvt_pk_bf16_f32 v80, v80, v81
 v_mfma_f32_16x16x32_bf16 v[96:99], a[28:31], a[188:191], v[96:99]
 s_waitcnt lgkmcnt(7)
 ds_read_b64_tr_b16 a[58:59], v45 offset:59392
 v_cvt_pk_bf16_f32 v81, v82, v83
 v_mfma_f32_16x16x32_bf16 v[92:95], a[32:35], a[128:131], 0
 ds_read_b64_tr_b16 a[60:61], v45 offset:61440
 buffer_load_dwordx4 v2, s[8:11], s79 offen lds
 v_mfma_f32_16x16x32_bf16 v[92:95], a[36:39], a[132:135], v[92:95]
 s_add_u32 s58, s48, 1027072
 ds_read_b64_tr_b16 a[62:63], v45 offset:63488
 v_cvt_pk_bf16_f32 v82, v84, v85
 v_mfma_f32_16x16x32_bf16 v[92:95], a[40:43], a[136:139], v[92:95]
 s_waitcnt lgkmcnt(4)
 ds_read_b64_tr_b16 a[0:1], v46 offset:32768
 v_cvt_pk_bf16_f32 v83, v86, v87
 v_mfma_f32_16x16x32_bf16 v[92:95], a[44:47], a[140:143], v[92:95]
 ds_read_b64_tr_b16 a[2:3], v46 offset:34816
 buffer_store_dwordx4 v[80:83], v1, s[12:15], s58 offen sc1
 v_mfma_f32_16x16x32_bf16 v[92:95], a[48:51], a[144:147], v[92:95]
 ds_read_b64_tr_b16 a[4:5], v46 offset:36864
 v_mul_f32 v88, v88, v64
 v_mfma_f32_16x16x32_bf16 v[92:95], a[52:55], a[148:151], v[92:95]
 s_waitcnt lgkmcnt(3)
 ds_read_b64_tr_b16 a[6:7], v46 offset:38912
 v_mul_f32 v89, v89, v64
 v_mfma_f32_16x16x32_bf16 v[92:95], a[56:59], a[152:155], v[92:95]
 s_add_u32 m0, s29, 106496
 ds_read_b64_tr_b16 a[8:9], v46 offset:40960
 v_mul_f32 v90, v90, v64
 v_mfma_f32_16x16x32_bf16 v[92:95], a[60:63], a[156:159], v[92:95]
 ds_read_b64_tr_b16 a[10:11], v46 offset:43008
 buffer_load_dwordx4 v2, s[8:11], s80 offen lds
 v_mfma_f32_16x16x32_bf16 v[100:103], a[32:35], a[160:163], 0
 ds_read_b64_tr_b16 a[12:13], v46 offset:45056
 v_mul_f32 v91, v91, v64
 v_mfma_f32_16x16x32_bf16 v[100:103], a[36:39], a[164:167], v[100:103]
 ds_read_b64_tr_b16 a[14:15], v46 offset:47104
 v_mul_f32 v96, v96, v65
 v_mfma_f32_16x16x32_bf16 v[100:103], a[40:43], a[168:171], v[100:103]
 ds_read_b64_tr_b16 a[16:17], v46 offset:49152
 v_mul_f32 v97, v97, v65
 v_mfma_f32_16x16x32_bf16 v[100:103], a[44:47], a[172:175], v[100:103]
 ds_read_b64_tr_b16 a[18:19], v46 offset:51200
 v_mul_f32 v98, v98, v65
 v_mfma_f32_16x16x32_bf16 v[100:103], a[48:51], a[176:179], v[100:103]
 ds_read_b64_tr_b16 a[20:21], v46 offset:53248
 v_mul_f32 v92, v92, v64
 v_mfma_f32_16x16x32_bf16 v[100:103], a[52:55], a[180:183], v[100:103]
 s_add_u32 m0, s29, 110592
 ds_read_b64_tr_b16 a[22:23], v46 offset:55296
 v_mul_f32 v93, v93, v64
 v_mfma_f32_16x16x32_bf16 v[100:103], a[56:59], a[184:187], v[100:103]
 ds_read_b64_tr_b16 a[24:25], v46 offset:57344
 buffer_load_dwordx4 v2, s[8:11], s81 offen lds
 v_mfma_f32_16x16x32_bf16 v[100:103], a[60:63], a[188:191], v[100:103]
 s_waitcnt lgkmcnt(7)
 ds_read_b64_tr_b16 a[26:27], v46 offset:59392
 v_mul_f32 v94, v94, v64
 v_mfma_f32_16x16x32_bf16 v[104:107], a[0:3], a[128:131], 0
 ds_read_b64_tr_b16 a[28:29], v46 offset:61440
 v_mul_f32 v95, v95, v64
 v_mfma_f32_16x16x32_bf16 v[104:107], a[4:7], a[132:135], v[104:107]
 ds_read_b64_tr_b16 a[30:31], v46 offset:63488
 v_cvt_pk_bf16_f32 v88, v88, v89
 v_mfma_f32_16x16x32_bf16 v[104:107], a[8:11], a[136:139], v[104:107]
 s_waitcnt lgkmcnt(4)
 ds_read_b64_tr_b16 a[32:33], v47 offset:32768
 v_cvt_pk_bf16_f32 v89, v90, v91
 v_mfma_f32_16x16x32_bf16 v[104:107], a[12:15], a[140:143], v[104:107]
 ds_read_b64_tr_b16 a[34:35], v47 offset:34816
 v_cvt_pk_bf16_f32 v90, v92, v93
 v_mfma_f32_16x16x32_bf16 v[104:107], a[16:19], a[144:147], v[104:107]
 s_add_u32 m0, s29, 114688
 ds_read_b64_tr_b16 a[36:37], v47 offset:36864
 v_cvt_pk_bf16_f32 v91, v94, v95
 v_mfma_f32_16x16x32_bf16 v[104:107], a[20:23], a[148:151], v[104:107]
 s_waitcnt lgkmcnt(3)
 ds_read_b64_tr_b16 a[38:39], v47 offset:38912
 buffer_load_dwordx4 v2, s[8:11], s82 offen lds
 v_mfma_f32_16x16x32_bf16 v[104:107], a[24:27], a[152:155], v[104:107]
 s_add_u32 s58, s48, 69632
 ds_read_b64_tr_b16 a[40:41], v47 offset:40960
 v_mul_f32 v99, v99, v65
 v_mfma_f32_16x16x32_bf16 v[104:107], a[28:31], a[156:159], v[104:107]
 ds_read_b64_tr_b16 a[42:43], v47 offset:43008
 buffer_store_dwordx4 v[88:91], v1, s[12:15], s58 offen sc1
 v_mfma_f32_16x16x32_bf16 v[112:115], a[0:3], a[160:163], 0
 ds_read_b64_tr_b16 a[44:45], v47 offset:45056
 v_mul_f32 v100, v100, v65
 v_mfma_f32_16x16x32_bf16 v[112:115], a[4:7], a[164:167], v[112:115]
 ds_read_b64_tr_b16 a[46:47], v47 offset:47104
 v_mul_f32 v101, v101, v65
 v_mfma_f32_16x16x32_bf16 v[112:115], a[8:11], a[168:171], v[112:115]
 ds_read_b64_tr_b16 a[48:49], v47 offset:49152
 v_mul_f32 v102, v102, v65
 v_mfma_f32_16x16x32_bf16 v[112:115], a[12:15], a[172:175], v[112:115]
 s_add_u32 m0, s29, 118784
 ds_read_b64_tr_b16 a[50:51], v47 offset:51200
 v_mul_f32 v103, v103, v65
 v_mfma_f32_16x16x32_bf16 v[112:115], a[16:19], a[176:179], v[112:115]
 ds_read_b64_tr_b16 a[52:53], v47 offset:53248
 buffer_load_dwordx4 v2, s[8:11], s83 offen lds
 v_mfma_f32_16x16x32_bf16 v[112:115], a[20:23], a[180:183], v[112:115]
 ds_read_b64_tr_b16 a[54:55], v47 offset:55296
 v_cvt_pk_bf16_f32 v96, v96, v97
 v_mfma_f32_16x16x32_bf16 v[112:115], a[24:27], a[184:187], v[112:115]
 ds_read_b64_tr_b16 a[56:57], v47 offset:57344
 v_cvt_pk_bf16_f32 v97, v98, v99
 v_mfma_f32_16x16x32_bf16 v[112:115], a[28:31], a[188:191], v[112:115]
 s_waitcnt lgkmcnt(7)
 ds_read_b64_tr_b16 a[58:59], v47 offset:59392
 v_cvt_pk_bf16_f32 v98, v100, v101
 v_mfma_f32_16x16x32_bf16 v[108:111], a[32:35], a[128:131], 0
 s_waitcnt vmcnt(9)
 ds_read_b64_tr_b16 a[60:61], v47 offset:61440
 v_cvt_pk_bf16_f32 v99, v102, v103
 v_mfma_f32_16x16x32_bf16 v[108:111], a[36:39], a[132:135], v[108:111]
 s_barrier
 ds_read_b64_tr_b16 a[62:63], v47 offset:63488
 v_xor_b32 v44, 0x10000, v44
 v_mfma_f32_16x16x32_bf16 v[108:111], a[40:43], a[136:139], v[108:111]
 s_waitcnt lgkmcnt(4)
 ds_read_b64_tr_b16 a[0:1], v44 offset:0
 v_mul_f32 v104, v104, v64
 v_mfma_f32_16x16x32_bf16 v[108:111], a[44:47], a[140:143], v[108:111]
 s_add_u32 m0, s29, 122880
 ds_read_b64_tr_b16 a[2:3], v44 offset:2048
 v_mul_f32 v105, v105, v64
 v_mfma_f32_16x16x32_bf16 v[108:111], a[48:51], a[144:147], v[108:111]
 ds_read_b64_tr_b16 a[4:5], v44 offset:4096
 buffer_load_dwordx4 v2, s[8:11], s84 offen lds
 v_mfma_f32_16x16x32_bf16 v[108:111], a[52:55], a[148:151], v[108:111]
 s_waitcnt lgkmcnt(3)
 ds_read_b64_tr_b16 a[6:7], v44 offset:6144
 v_mul_f32 v106, v106, v64
 v_mfma_f32_16x16x32_bf16 v[108:111], a[56:59], a[152:155], v[108:111]
 s_add_u32 s58, s48, 1044480
 ds_read_b64_tr_b16 a[8:9], v44 offset:8192
 v_mul_f32 v107, v107, v64
 v_mfma_f32_16x16x32_bf16 v[108:111], a[60:63], a[156:159], v[108:111]
 ds_read_b64_tr_b16 a[10:11], v44 offset:10240
 buffer_store_dwordx4 v[96:99], v1, s[12:15], s58 offen sc1
 v_mfma_f32_16x16x32_bf16 v[116:119], a[32:35], a[160:163], 0
 ds_read_b64_tr_b16 a[12:13], v44 offset:12288
 v_mul_f32 v112, v112, v65
 v_mfma_f32_16x16x32_bf16 v[116:119], a[36:39], a[164:167], v[116:119]
 ds_read_b64_tr_b16 a[14:15], v44 offset:14336
 v_mul_f32 v113, v113, v65
 v_mfma_f32_16x16x32_bf16 v[116:119], a[40:43], a[168:171], v[116:119]
 s_add_u32 m0, s29, 126976
 ds_read_b64_tr_b16 a[16:17], v44 offset:16384
 v_mul_f32 v114, v114, v65
 v_mfma_f32_16x16x32_bf16 v[116:119], a[44:47], a[172:175], v[116:119]
 ds_read_b64_tr_b16 a[18:19], v44 offset:18432
 buffer_load_dwordx4 v2, s[8:11], s85 offen lds
 v_mfma_f32_16x16x32_bf16 v[116:119], a[48:51], a[176:179], v[116:119]
 ds_read_b64_tr_b16 a[20:21], v44 offset:20480
 v_add_u32 v2, 128, v2
 v_mfma_f32_16x16x32_bf16 v[116:119], a[52:55], a[180:183], v[116:119]
 ds_read_b64_tr_b16 a[22:23], v44 offset:22528
 v_mul_f32 v108, v108, v64
 v_mfma_f32_16x16x32_bf16 v[116:119], a[56:59], a[184:187], v[116:119]
 ds_read_b64_tr_b16 a[24:25], v44 offset:24576
 v_mul_f32 v109, v109, v64
 v_mfma_f32_16x16x32_bf16 v[116:119], a[60:63], a[188:191], v[116:119]
 s_waitcnt lgkmcnt(7)
 ds_read_b64_tr_b16 a[26:27], v44 offset:26624
 v_mul_f32 v110, v110, v64
 v_mfma_f32_16x16x32_bf16 v[72:75], a[0:3], a[128:131], 0
 ds_read_b64_tr_b16 a[28:29], v44 offset:28672
 v_mul_f32 v111, v111, v64
 v_mfma_f32_16x16x32_bf16 v[72:75], a[4:7], a[132:135], v[72:75]
 ds_read_b64_tr_b16 a[30:31], v44 offset:30720
 v_xor_b32 v45, 0x10000, v45
 v_mfma_f32_16x16x32_bf16 v[72:75], a[8:11], a[136:139], v[72:75]
 s_waitcnt lgkmcnt(4)
 ds_read_b64_tr_b16 a[32:33], v45 offset:0
 v_cvt_pk_bf16_f32 v104, v104, v105
 v_mfma_f32_16x16x32_bf16 v[72:75], a[12:15], a[140:143], v[72:75]
 s_add_u32 m0, s29, 131072
 ds_read_b64_tr_b16 a[34:35], v45 offset:2048
 v_cvt_pk_bf16_f32 v105, v106, v107
 v_mfma_f32_16x16x32_bf16 v[72:75], a[16:19], a[144:147], v[72:75]
 ds_read_b64_tr_b16 a[36:37], v45 offset:4096
 buffer_load_dwordx4 v2, s[8:11], s78 offen lds
 v_mfma_f32_16x16x32_bf16 v[72:75], a[20:23], a[148:151], v[72:75]
 s_waitcnt lgkmcnt(3)
 ds_read_b64_tr_b16 a[38:39], v45 offset:6144
 v_cvt_pk_bf16_f32 v106, v108, v109
 v_mfma_f32_16x16x32_bf16 v[72:75], a[24:27], a[152:155], v[72:75]
 s_add_u32 s58, s48, 87040
 ds_read_b64_tr_b16 a[40:41], v45 offset:8192
 v_cvt_pk_bf16_f32 v107, v110, v111
 v_mfma_f32_16x16x32_bf16 v[72:75], a[28:31], a[156:159], v[72:75]
 ds_read_b64_tr_b16 a[42:43], v45 offset:10240
 buffer_store_dwordx4 v[104:107], v1, s[12:15], s58 offen sc1
 v_mfma_f32_16x16x32_bf16 v[80:83], a[0:3], a[160:163], 0
 ds_read_b64_tr_b16 a[44:45], v45 offset:12288
 v_mul_f32 v115, v115, v65
 v_mfma_f32_16x16x32_bf16 v[80:83], a[4:7], a[164:167], v[80:83]
 ds_read_b64_tr_b16 a[46:47], v45 offset:14336
 v_mul_f32 v116, v116, v65
 v_mfma_f32_16x16x32_bf16 v[80:83], a[8:11], a[168:171], v[80:83]
 s_add_u32 m0, s29, 135168
 ds_read_b64_tr_b16 a[48:49], v45 offset:16384
 v_mul_f32 v117, v117, v65
 v_mfma_f32_16x16x32_bf16 v[80:83], a[12:15], a[172:175], v[80:83]
 ds_read_b64_tr_b16 a[50:51], v45 offset:18432
 buffer_load_dwordx4 v2, s[8:11], s79 offen lds
 v_mfma_f32_16x16x32_bf16 v[80:83], a[16:19], a[176:179], v[80:83]
 ds_read_b64_tr_b16 a[52:53], v45 offset:20480
 v_mul_f32 v118, v118, v65
 v_mfma_f32_16x16x32_bf16 v[80:83], a[20:23], a[180:183], v[80:83]
 ds_read_b64_tr_b16 a[54:55], v45 offset:22528
 v_mul_f32 v119, v119, v65
 v_mfma_f32_16x16x32_bf16 v[80:83], a[24:27], a[184:187], v[80:83]
 ds_read_b64_tr_b16 a[56:57], v45 offset:24576
 v_cvt_pk_bf16_f32 v112, v112, v113
 v_mfma_f32_16x16x32_bf16 v[80:83], a[28:31], a[188:191], v[80:83]
 s_waitcnt lgkmcnt(7)
 ds_read_b64_tr_b16 a[58:59], v45 offset:26624
 v_cvt_pk_bf16_f32 v113, v114, v115
 v_mfma_f32_16x16x32_bf16 v[76:79], a[32:35], a[128:131], 0
 ds_read_b64_tr_b16 a[60:61], v45 offset:28672
 v_cvt_pk_bf16_f32 v114, v116, v117
 v_mfma_f32_16x16x32_bf16 v[76:79], a[36:39], a[132:135], v[76:79]
 s_add_u32 m0, s29, 139264
 ds_read_b64_tr_b16 a[62:63], v45 offset:30720
 v_xor_b32 v46, 0x10000, v46
 v_mfma_f32_16x16x32_bf16 v[76:79], a[40:43], a[136:139], v[76:79]
 s_waitcnt lgkmcnt(4)
 ds_read_b64_tr_b16 a[0:1], v46 offset:0
 buffer_load_dwordx4 v2, s[8:11], s80 offen lds
 v_mfma_f32_16x16x32_bf16 v[76:79], a[44:47], a[140:143], v[76:79]
 s_add_u32 s58, s48, 1061888
 ds_read_b64_tr_b16 a[2:3], v46 offset:2048
 v_cvt_pk_bf16_f32 v115, v118, v119
 v_mfma_f32_16x16x32_bf16 v[76:79], a[48:51], a[144:147], v[76:79]
 ds_read_b64_tr_b16 a[4:5], v46 offset:4096
 buffer_store_dwordx4 v[112:115], v1, s[12:15], s58 offen sc1
 v_mfma_f32_16x16x32_bf16 v[76:79], a[52:55], a[148:151], v[76:79]
 s_waitcnt lgkmcnt(3)
 ds_read_b64_tr_b16 a[6:7], v46 offset:6144
 v_mul_f32 v72, v72, v64
 v_mfma_f32_16x16x32_bf16 v[76:79], a[56:59], a[152:155], v[76:79]
 ds_read_b64_tr_b16 a[8:9], v46 offset:8192
 v_mul_f32 v73, v73, v64
 v_mfma_f32_16x16x32_bf16 v[76:79], a[60:63], a[156:159], v[76:79]
 ds_read_b64_tr_b16 a[10:11], v46 offset:10240
 v_mul_f32 v74, v74, v64
 v_mfma_f32_16x16x32_bf16 v[84:87], a[32:35], a[160:163], 0
 s_add_u32 m0, s29, 143360
 ds_read_b64_tr_b16 a[12:13], v46 offset:12288
 v_mul_f32 v75, v75, v64
 v_mfma_f32_16x16x32_bf16 v[84:87], a[36:39], a[164:167], v[84:87]
 ds_read_b64_tr_b16 a[14:15], v46 offset:14336
 buffer_load_dwordx4 v2, s[8:11], s81 offen lds
 v_mfma_f32_16x16x32_bf16 v[84:87], a[40:43], a[168:171], v[84:87]
 ds_read_b64_tr_b16 a[16:17], v46 offset:16384
 v_mul_f32 v80, v80, v65
 v_mfma_f32_16x16x32_bf16 v[84:87], a[44:47], a[172:175], v[84:87]
 ds_read_b64_tr_b16 a[18:19], v46 offset:18432
 v_mul_f32 v81, v81, v65
 v_mfma_f32_16x16x32_bf16 v[84:87], a[48:51], a[176:179], v[84:87]
 ds_read_b64_tr_b16 a[20:21], v46 offset:20480
 v_mul_f32 v76, v76, v64
 v_mfma_f32_16x16x32_bf16 v[84:87], a[52:55], a[180:183], v[84:87]
 ds_read_b64_tr_b16 a[22:23], v46 offset:22528
 v_mul_f32 v77, v77, v64
 v_mfma_f32_16x16x32_bf16 v[84:87], a[56:59], a[184:187], v[84:87]
 s_add_u32 m0, s29, 147456
 ds_read_b64_tr_b16 a[24:25], v46 offset:24576
 v_mul_f32 v78, v78, v64
 v_mfma_f32_16x16x32_bf16 v[84:87], a[60:63], a[188:191], v[84:87]
 s_waitcnt lgkmcnt(7)
 ds_read_b64_tr_b16 a[26:27], v46 offset:26624
 v_mul_f32 v79, v79, v64
 v_mfma_f32_16x16x32_bf16 v[88:91], a[0:3], a[128:131], 0
 ds_read_b64_tr_b16 a[28:29], v46 offset:28672
 buffer_load_dwordx4 v2, s[8:11], s82 offen lds
 v_mfma_f32_16x16x32_bf16 v[88:91], a[4:7], a[132:135], v[88:91]
 ds_read_b64_tr_b16 a[30:31], v46 offset:30720
 v_xor_b32 v47, 0x10000, v47
 v_mfma_f32_16x16x32_bf16 v[88:91], a[8:11], a[136:139], v[88:91]
 s_waitcnt lgkmcnt(4)
 ds_read_b64_tr_b16 a[32:33], v47 offset:0
 v_cvt_pk_bf16_f32 v72, v72, v73
 v_mfma_f32_16x16x32_bf16 v[88:91], a[12:15], a[140:143], v[88:91]
 ds_read_b64_tr_b16 a[34:35], v47 offset:2048
 v_cvt_pk_bf16_f32 v73, v74, v75
 v_mfma_f32_16x16x32_bf16 v[88:91], a[16:19], a[144:147], v[88:91]
 ds_read_b64_tr_b16 a[36:37], v47 offset:4096
 v_cvt_pk_bf16_f32 v74, v76, v77
 v_mfma_f32_16x16x32_bf16 v[88:91], a[20:23], a[148:151], v[88:91]
 s_waitcnt lgkmcnt(3)
 ds_read_b64_tr_b16 a[38:39], v47 offset:6144
 v_cvt_pk_bf16_f32 v75, v78, v79
 v_mfma_f32_16x16x32_bf16 v[88:91], a[24:27], a[152:155], v[88:91]
 s_add_u32 m0, s29, 151552
 ds_read_b64_tr_b16 a[40:41], v47 offset:8192
 v_mul_f32 v82, v82, v65
 v_mfma_f32_16x16x32_bf16 v[88:91], a[28:31], a[156:159], v[88:91]
 ds_read_b64_tr_b16 a[42:43], v47 offset:10240
 buffer_load_dwordx4 v2, s[8:11], s83 offen lds
 v_mfma_f32_16x16x32_bf16 v[96:99], a[0:3], a[160:163], 0
 s_add_u32 s58, s48, 104448
 ds_read_b64_tr_b16 a[44:45], v47 offset:12288
 v_mul_f32 v83, v83, v65
 v_mfma_f32_16x16x32_bf16 v[96:99], a[4:7], a[164:167], v[96:99]
 ds_read_b64_tr_b16 a[46:47], v47 offset:14336
 buffer_store_dwordx4 v[72:75], v1, s[12:15], s58 offen sc1
 v_mfma_f32_16x16x32_bf16 v[96:99], a[8:11], a[168:171], v[96:99]
 ds_read_b64_tr_b16 a[48:49], v47 offset:16384
 v_mul_f32 v84, v84, v65
 v_mfma_f32_16x16x32_bf16 v[96:99], a[12:15], a[172:175], v[96:99]
 ds_read_b64_tr_b16 a[50:51], v47 offset:18432
 v_mul_f32 v85, v85, v65
 v_mfma_f32_16x16x32_bf16 v[96:99], a[16:19], a[176:179], v[96:99]
 ds_read_b64_tr_b16 a[52:53], v47 offset:20480
 v_mul_f32 v86, v86, v65
 v_mfma_f32_16x16x32_bf16 v[96:99], a[20:23], a[180:183], v[96:99]
 s_add_u32 m0, s29, 155648
 ds_read_b64_tr_b16 a[54:55], v47 offset:22528
 v_mul_f32 v87, v87, v65
 v_mfma_f32_16x16x32_bf16 v[96:99], a[24:27], a[184:187], v[96:99]
 ds_read_b64_tr_b16 a[56:57], v47 offset:24576
 buffer_load_dwordx4 v2, s[8:11], s84 offen lds
 v_mfma_f32_16x16x32_bf16 v[96:99], a[28:31], a[188:191], v[96:99]
 s_waitcnt lgkmcnt(7)
 ds_read_b64_tr_b16 a[58:59], v47 offset:26624
 v_cvt_pk_bf16_f32 v80, v80, v81
 v_mfma_f32_16x16x32_bf16 v[92:95], a[32:35], a[128:131], 0
 s_waitcnt vmcnt(10)
 ds_read_b64_tr_b16 a[60:61], v47 offset:28672
 v_cvt_pk_bf16_f32 v81, v82, v83
 v_mfma_f32_16x16x32_bf16 v[92:95], a[36:39], a[132:135], v[92:95]
 s_barrier
 ds_read_b64_tr_b16 a[62:63], v47 offset:30720
 v_cvt_pk_bf16_f32 v82, v84, v85
 v_mfma_f32_16x16x32_bf16 v[92:95], a[40:43], a[136:139], v[92:95]
 s_waitcnt lgkmcnt(4)
 ds_read_b64_tr_b16 a[0:1], v44 offset:32768
 v_cvt_pk_bf16_f32 v83, v86, v87
 v_mfma_f32_16x16x32_bf16 v[92:95], a[44:47], a[140:143], v[92:95]
 s_lshl_b32 s34, s95, 2
 ds_read_b64_tr_b16 a[2:3], v44 offset:34816
 v_mul_f32 v88, v88, v64
 v_mfma_f32_16x16x32_bf16 v[92:95], a[48:51], a[144:147], v[92:95]
 s_add_u32 m0, s29, 159744
 ds_read_b64_tr_b16 a[4:5], v44 offset:36864
 v_mul_f32 v89, v89, v64
 v_mfma_f32_16x16x32_bf16 v[92:95], a[52:55], a[148:151], v[92:95]
 s_waitcnt lgkmcnt(3)
 ds_read_b64_tr_b16 a[6:7], v44 offset:38912
 buffer_load_dwordx4 v2, s[8:11], s85 offen lds
 v_mfma_f32_16x16x32_bf16 v[92:95], a[56:59], a[152:155], v[92:95]
 s_add_u32 s34, s34, s3
 ds_read_b64_tr_b16 a[8:9], v44 offset:40960
 v_add_u32 v2, 128, v2
 v_mfma_f32_16x16x32_bf16 v[92:95], a[60:63], a[156:159], v[92:95]
 s_mul_i32 s35, s34, 4096
 ds_read_b64_tr_b16 a[10:11], v44 offset:43008
 v_mul_f32 v90, v90, v64
 v_mfma_f32_16x16x32_bf16 v[100:103], a[32:35], a[160:163], 0
 s_lshl_b32 s34, s34, 12
 ds_read_b64_tr_b16 a[12:13], v44 offset:45056
 v_mul_f32 v91, v91, v64
 v_mfma_f32_16x16x32_bf16 v[100:103], a[36:39], a[164:167], v[100:103]
 s_cmp_eq_u32 s62, 0
 s_cmov_b32 s34, 2.0
 s_cmov_b32 s35, 2.0
 ds_read_b64_tr_b16 a[14:15], v44 offset:47104
 v_mfma_f32_16x16x32_bf16 v[100:103], a[40:43], a[168:171], v[100:103]
 s_add_u32 s35, s35, 85983232
 ds_read_b64_tr_b16 a[16:17], v44 offset:49152
 v_mul_f32 v96, v96, v65
 v_mfma_f32_16x16x32_bf16 v[100:103], a[44:47], a[172:175], v[100:103]
 s_mul_i32 s33, s3, 8736
 ds_read_b64_tr_b16 a[18:19], v44 offset:51200
 v_mul_f32 v97, v97, v65
 v_mfma_f32_16x16x32_bf16 v[100:103], a[48:51], a[176:179], v[100:103]
 s_add_u32 s33, s33, 0x10000
 ds_read_b64_tr_b16 a[20:21], v44 offset:53248
 v_mul_f32 v92, v92, v64
 v_mfma_f32_16x16x32_bf16 v[100:103], a[52:55], a[180:183], v[100:103]
 s_mov_b32 s4, s72
 ds_read_b64_tr_b16 a[22:23], v44 offset:55296
 v_mul_f32 v93, v93, v64
 v_mfma_f32_16x16x32_bf16 v[100:103], a[56:59], a[184:187], v[100:103]
 s_mov_b32 s5, s73
 ds_read_b64_tr_b16 a[24:25], v44 offset:57344
 v_mul_f32 v94, v94, v64
 v_mfma_f32_16x16x32_bf16 v[100:103], a[60:63], a[188:191], v[100:103]
 s_waitcnt lgkmcnt(7)
 ds_read_b64_tr_b16 a[26:27], v44 offset:59392
 v_mul_f32 v95, v95, v64
 v_mfma_f32_16x16x32_bf16 v[104:107], a[0:3], a[128:131], 0
 s_mov_b32 s6, 1835008
 ds_read_b64_tr_b16 a[28:29], v44 offset:61440
 v_cvt_pk_bf16_f32 v88, v88, v89
 v_mfma_f32_16x16x32_bf16 v[104:107], a[4:7], a[132:135], v[104:107]
 s_mov_b32 s7, 0x20000
 ds_read_b64_tr_b16 a[30:31], v44 offset:63488
 v_cvt_pk_bf16_f32 v89, v90, v91
 v_mfma_f32_16x16x32_bf16 v[104:107], a[8:11], a[136:139], v[104:107]
 s_waitcnt lgkmcnt(4)
 ds_read_b64_tr_b16 a[32:33], v45 offset:32768
 v_cvt_pk_bf16_f32 v90, v92, v93
 v_mfma_f32_16x16x32_bf16 v[104:107], a[12:15], a[140:143], v[104:107]
 s_add_u32 m0, s29, 0
 ds_read_b64_tr_b16 a[34:35], v45 offset:34816
 v_lshrrev_b32 v10, 1, v0
 v_mfma_f32_16x16x32_bf16 v[104:107], a[16:19], a[144:147], v[104:107]
 ds_read_b64_tr_b16 a[36:37], v45 offset:36864
 buffer_load_dwordx4 v2, s[8:11], s78 offen lds
 v_mfma_f32_16x16x32_bf16 v[104:107], a[20:23], a[148:151], v[104:107]
 s_waitcnt lgkmcnt(3)
 ds_read_b64_tr_b16 a[38:39], v45 offset:38912
 v_lshlrev_b32 v10, 7, v10
 v_mfma_f32_16x16x32_bf16 v[104:107], a[24:27], a[152:155], v[104:107]
 ds_read_b64_tr_b16 a[40:41], v45 offset:40960
 v_cvt_pk_bf16_f32 v91, v94, v95
 v_mfma_f32_16x16x32_bf16 v[104:107], a[28:31], a[156:159], v[104:107]
 s_add_u32 s58, s48, 1079296
 ds_read_b64_tr_b16 a[42:43], v45 offset:43008
 v_and_b32 v11, 1, v0
 v_mfma_f32_16x16x32_bf16 v[112:115], a[0:3], a[160:163], 0
 ds_read_b64_tr_b16 a[44:45], v45 offset:45056
 buffer_store_dwordx4 v[80:83], v1, s[12:15], s58 offen sc1
 v_mfma_f32_16x16x32_bf16 v[112:115], a[4:7], a[164:167], v[112:115]
 ds_read_b64_tr_b16 a[46:47], v45 offset:47104
 v_lshl_add_u32 v10, v11, 4, v10
 v_mfma_f32_16x16x32_bf16 v[112:115], a[8:11], a[168:171], v[112:115]
 s_add_u32 m0, s29, 4096
 ds_read_b64_tr_b16 a[48:49], v45 offset:49152
 v_mul_f32 v98, v98, v65
 v_mfma_f32_16x16x32_bf16 v[112:115], a[12:15], a[172:175], v[112:115]
 ds_read_b64_tr_b16 a[50:51], v45 offset:51200
 buffer_load_dwordx4 v2, s[8:11], s79 offen lds
 v_mfma_f32_16x16x32_bf16 v[112:115], a[16:19], a[176:179], v[112:115]
 s_add_u32 s58, s48, 121856
 ds_read_b64_tr_b16 a[52:53], v45 offset:53248
 v_and_b32 v11, 31, v0
 v_mfma_f32_16x16x32_bf16 v[112:115], a[20:23], a[180:183], v[112:115]
 ds_read_b64_tr_b16 a[54:55], v45 offset:55296
 buffer_store_dwordx4 v[88:91], v1, s[12:15], s58 offen sc1
 v_mfma_f32_16x16x32_bf16 v[112:115], a[24:27], a[184:187], v[112:115]
 ds_read_b64_tr_b16 a[56:57], v45 offset:57344
 v_lshl_add_u32 v11, v11, 2, s33
 v_mfma_f32_16x16x32_bf16 v[112:115], a[28:31], a[188:191], v[112:115]
 s_waitcnt lgkmcnt(7)
 ds_read_b64_tr_b16 a[58:59], v45 offset:59392
 v_mul_f32 v99, v99, v65
 v_mfma_f32_16x16x32_bf16 v[108:111], a[32:35], a[128:131], 0
 ds_read_b64_tr_b16 a[60:61], v45 offset:61440
 v_and_b32 v12, 7, v0
 v_mfma_f32_16x16x32_bf16 v[108:111], a[36:39], a[132:135], v[108:111]
 s_add_u32 m0, s29, 8192
 ds_read_b64_tr_b16 a[62:63], v45 offset:63488
 v_mul_f32 v100, v100, v65
 v_mfma_f32_16x16x32_bf16 v[108:111], a[40:43], a[136:139], v[108:111]
 s_waitcnt lgkmcnt(4)
 ds_read_b64_tr_b16 a[0:1], v46 offset:32768
 buffer_load_dwordx4 v2, s[8:11], s80 offen lds
 v_mfma_f32_16x16x32_bf16 v[108:111], a[44:47], a[140:143], v[108:111]
 ds_read_b64_tr_b16 a[2:3], v46 offset:34816
 v_lshl_add_u32 v12, v12, 2, s33
 v_mfma_f32_16x16x32_bf16 v[108:111], a[48:51], a[144:147], v[108:111]
 ds_read_b64_tr_b16 a[4:5], v46 offset:36864
 v_mul_f32 v101, v101, v65
 v_mfma_f32_16x16x32_bf16 v[108:111], a[52:55], a[148:151], v[108:111]
 s_waitcnt lgkmcnt(3)
 ds_read_b64_tr_b16 a[6:7], v46 offset:38912
 v_mov_b32 v13, 0
 v_mfma_f32_16x16x32_bf16 v[108:111], a[56:59], a[152:155], v[108:111]
 ds_read_b64_tr_b16 a[8:9], v46 offset:40960
 v_mul_f32 v102, v102, v65
 v_mfma_f32_16x16x32_bf16 v[108:111], a[60:63], a[156:159], v[108:111]
 ds_read_b64_tr_b16 a[10:11], v46 offset:43008
 v_mul_f32 v103, v103, v65
 v_mfma_f32_16x16x32_bf16 v[116:119], a[32:35], a[160:163], 0
 s_add_u32 m0, s29, 12288
 ds_read_b64_tr_b16 a[12:13], v46 offset:45056
 v_cvt_pk_bf16_f32 v96, v96, v97
 v_mfma_f32_16x16x32_bf16 v[116:119], a[36:39], a[164:167], v[116:119]
 ds_read_b64_tr_b16 a[14:15], v46 offset:47104
 buffer_load_dwordx4 v2, s[8:11], s81 offen lds
 v_mfma_f32_16x16x32_bf16 v[116:119], a[40:43], a[168:171], v[116:119]
 ds_read_b64_tr_b16 a[16:17], v46 offset:49152
 v_cvt_pk_bf16_f32 v97, v98, v99
 v_mfma_f32_16x16x32_bf16 v[116:119], a[44:47], a[172:175], v[116:119]
 ds_read_b64_tr_b16 a[18:19], v46 offset:51200
 v_cvt_pk_bf16_f32 v98, v100, v101
 v_mfma_f32_16x16x32_bf16 v[116:119], a[48:51], a[176:179], v[116:119]
 s_add_u32 s58, s48, 1096704
 ds_read_b64_tr_b16 a[20:21], v46 offset:53248
 v_cvt_pk_bf16_f32 v99, v102, v103
 v_mfma_f32_16x16x32_bf16 v[116:119], a[52:55], a[180:183], v[116:119]
 ds_read_b64_tr_b16 a[22:23], v46 offset:55296
 buffer_store_dwordx4 v[96:99], v1, s[12:15], s58 offen sc1
 v_mfma_f32_16x16x32_bf16 v[116:119], a[56:59], a[184:187], v[116:119]
 s_add_u32 m0, s29, 16384
 ds_read_b64_tr_b16 a[24:25], v46 offset:57344
 v_mul_f32 v104, v104, v64
 v_mfma_f32_16x16x32_bf16 v[116:119], a[60:63], a[188:191], v[116:119]
 s_waitcnt lgkmcnt(7)
 ds_read_b64_tr_b16 a[26:27], v46 offset:59392
 v_mul_f32 v105, v105, v64
 v_mfma_f32_16x16x32_bf16 v[72:75], a[0:3], a[128:131], 0
 ds_read_b64_tr_b16 a[28:29], v46 offset:61440
 buffer_load_dwordx4 v2, s[8:11], s82 offen lds
 v_mfma_f32_16x16x32_bf16 v[72:75], a[4:7], a[132:135], v[72:75]
 ds_read_b64_tr_b16 a[30:31], v46 offset:63488
 v_mul_f32 v106, v106, v64
 v_mfma_f32_16x16x32_bf16 v[72:75], a[8:11], a[136:139], v[72:75]
 s_waitcnt lgkmcnt(4)
 ds_read_b64_tr_b16 a[32:33], v47 offset:32768
 v_mul_f32 v107, v107, v64
 v_mfma_f32_16x16x32_bf16 v[72:75], a[12:15], a[140:143], v[72:75]
 ds_read_b64_tr_b16 a[34:35], v47 offset:34816
 v_mul_f32 v108, v108, v64
 v_mfma_f32_16x16x32_bf16 v[72:75], a[16:19], a[144:147], v[72:75]
 ds_read_b64_tr_b16 a[36:37], v47 offset:36864
 v_mul_f32 v109, v109, v64
 v_mfma_f32_16x16x32_bf16 v[72:75], a[20:23], a[148:151], v[72:75]
 s_waitcnt lgkmcnt(3)
 ds_read_b64_tr_b16 a[38:39], v47 offset:38912
 v_mul_f32 v110, v110, v64
 v_mfma_f32_16x16x32_bf16 v[72:75], a[24:27], a[152:155], v[72:75]
 s_add_u32 m0, s29, 20480
 ds_read_b64_tr_b16 a[40:41], v47 offset:40960
 v_mul_f32 v111, v111, v64
 v_mfma_f32_16x16x32_bf16 v[72:75], a[28:31], a[156:159], v[72:75]
 ds_read_b64_tr_b16 a[42:43], v47 offset:43008
 buffer_load_dwordx4 v2, s[8:11], s83 offen lds
 v_mfma_f32_16x16x32_bf16 v[80:83], a[0:3], a[160:163], 0
 ds_read_b64_tr_b16 a[44:45], v47 offset:45056
 v_cvt_pk_bf16_f32 v104, v104, v105
 v_mfma_f32_16x16x32_bf16 v[80:83], a[4:7], a[164:167], v[80:83]
 ds_read_b64_tr_b16 a[46:47], v47 offset:47104
 v_cvt_pk_bf16_f32 v105, v106, v107
 v_mfma_f32_16x16x32_bf16 v[80:83], a[8:11], a[168:171], v[80:83]
 ds_read_b64_tr_b16 a[48:49], v47 offset:49152
 v_cvt_pk_bf16_f32 v106, v108, v109
 v_mfma_f32_16x16x32_bf16 v[80:83], a[12:15], a[172:175], v[80:83]
 s_add_u32 s58, s48, 139264
 ds_read_b64_tr_b16 a[50:51], v47 offset:51200
 v_cvt_pk_bf16_f32 v107, v110, v111
 v_mfma_f32_16x16x32_bf16 v[80:83], a[16:19], a[176:179], v[80:83]
 ds_read_b64_tr_b16 a[52:53], v47 offset:53248
 buffer_store_dwordx4 v[104:107], v1, s[12:15], s58 offen sc1
 v_mfma_f32_16x16x32_bf16 v[80:83], a[20:23], a[180:183], v[80:83]
 s_add_u32 m0, s29, 24576
 ds_read_b64_tr_b16 a[54:55], v47 offset:55296
 v_mul_f32 v112, v112, v65
 v_mfma_f32_16x16x32_bf16 v[80:83], a[24:27], a[184:187], v[80:83]
 ds_read_b64_tr_b16 a[56:57], v47 offset:57344
 buffer_load_dwordx4 v2, s[8:11], s84 offen lds
 v_mfma_f32_16x16x32_bf16 v[80:83], a[28:31], a[188:191], v[80:83]
 s_waitcnt lgkmcnt(7)
 ds_read_b64_tr_b16 a[58:59], v47 offset:59392
 v_mul_f32 v113, v113, v65
 v_mfma_f32_16x16x32_bf16 v[76:79], a[32:35], a[128:131], 0
 s_waitcnt vmcnt(9)
 ds_read_b64_tr_b16 a[60:61], v47 offset:61440
 v_mul_f32 v114, v114, v65
 v_mfma_f32_16x16x32_bf16 v[76:79], a[36:39], a[132:135], v[76:79]
 s_barrier
 ds_read_b64_tr_b16 a[62:63], v47 offset:63488
 v_xor_b32 v44, 0x30000, v44
 v_mfma_f32_16x16x32_bf16 v[76:79], a[40:43], a[136:139], v[76:79]
 s_waitcnt lgkmcnt(4)
 ds_read_b64_tr_b16 a[0:1], v44 offset:0
 buffer_store_dword v9, v9, s[12:15], s93 offen offset:64 sc1
 v_mfma_f32_16x16x32_bf16 v[76:79], a[44:47], a[140:143], v[76:79]
 ds_read_b64_tr_b16 a[2:3], v44 offset:2048
 v_mul_f32 v115, v115, v65
 v_mfma_f32_16x16x32_bf16 v[76:79], a[48:51], a[144:147], v[76:79]
 s_add_u32 m0, s29, 28672
 ds_read_b64_tr_b16 a[4:5], v44 offset:4096
 v_mul_f32 v116, v116, v65
 v_mfma_f32_16x16x32_bf16 v[76:79], a[52:55], a[148:151], v[76:79]
 s_waitcnt lgkmcnt(3)
 ds_read_b64_tr_b16 a[6:7], v44 offset:6144
 buffer_load_dwordx4 v2, s[8:11], s85 offen lds
 v_mfma_f32_16x16x32_bf16 v[76:79], a[56:59], a[152:155], v[76:79]
 ds_read_b64_tr_b16 a[8:9], v44 offset:8192
 v_add_u32 v2, 128, v2
 v_mfma_f32_16x16x32_bf16 v[76:79], a[60:63], a[156:159], v[76:79]
 ds_read_b64_tr_b16 a[10:11], v44 offset:10240
 v_mul_f32 v117, v117, v65
 v_mfma_f32_16x16x32_bf16 v[84:87], a[32:35], a[160:163], 0
 ds_read_b64_tr_b16 a[12:13], v44 offset:12288
 v_mul_f32 v118, v118, v65
 v_mfma_f32_16x16x32_bf16 v[84:87], a[36:39], a[164:167], v[84:87]
 ds_read_b64_tr_b16 a[14:15], v44 offset:14336
 v_mul_f32 v119, v119, v65
 v_mfma_f32_16x16x32_bf16 v[84:87], a[40:43], a[168:171], v[84:87]
 ds_read_b64_tr_b16 a[16:17], v44 offset:16384
 v_cvt_pk_bf16_f32 v112, v112, v113
 v_mfma_f32_16x16x32_bf16 v[84:87], a[44:47], a[172:175], v[84:87]
 s_waitcnt lgkmcnt(9)
 ds_read_b64_tr_b16 a[18:19], v44 offset:18432
 v_cvt_pk_bf16_f32 v113, v114, v115
 v_mfma_f32_16x16x32_bf16 v[84:87], a[48:51], a[176:179], v[84:87]
 s_barrier
 ds_read_b64_tr_b16 a[20:21], v44 offset:20480
 v_cvt_pk_bf16_f32 v114, v116, v117
 v_mfma_f32_16x16x32_bf16 v[84:87], a[52:55], a[180:183], v[84:87]
 s_add_u32 m0, s33, 4640
 ds_read_b64_tr_b16 a[22:23], v44 offset:22528
 v_cvt_pk_bf16_f32 v115, v118, v119
 v_mfma_f32_16x16x32_bf16 v[84:87], a[56:59], a[184:187], v[84:87]
 ds_read_b64_tr_b16 a[24:25], v44 offset:24576
 buffer_load_dwordx4 v1, s[4:7], s34 offen offset:0 lds
 v_mfma_f32_16x16x32_bf16 v[84:87], a[60:63], a[188:191], v[84:87]
 s_waitcnt lgkmcnt(7)
 ds_read_b64_tr_b16 a[26:27], v44 offset:26624
 v_mul_f32 v72, v72, v64
 v_mfma_f32_16x16x32_bf16 v[88:91], a[0:3], a[128:131], 0
 ds_read_b64_tr_b16 a[28:29], v44 offset:28672
 v_mul_f32 v73, v73, v64
 v_mfma_f32_16x16x32_bf16 v[88:91], a[4:7], a[132:135], v[88:91]
 s_add_u32 s58, s48, 1114112
 ds_read_b64_tr_b16 a[30:31], v44 offset:30720
 v_xor_b32 v45, 0x30000, v45
 v_mfma_f32_16x16x32_bf16 v[88:91], a[8:11], a[136:139], v[88:91]
 s_waitcnt lgkmcnt(4)
 ds_read_b64_tr_b16 a[32:33], v45 offset:0
 buffer_store_dwordx4 v[112:115], v1, s[12:15], s58 offen sc1
 v_mfma_f32_16x16x32_bf16 v[88:91], a[12:15], a[140:143], v[88:91]
 ds_read_b64_tr_b16 a[34:35], v45 offset:2048
 v_mul_f32 v74, v74, v64
 v_mfma_f32_16x16x32_bf16 v[88:91], a[16:19], a[144:147], v[88:91]
 ds_read_b64_tr_b16 a[36:37], v45 offset:4096
 v_mul_f32 v75, v75, v64
 v_mfma_f32_16x16x32_bf16 v[88:91], a[20:23], a[148:151], v[88:91]
 s_waitcnt lgkmcnt(3)
 ds_read_b64_tr_b16 a[38:39], v45 offset:6144
 buffer_load_dwordx4 v1, s[4:7], s34 offen offset:1024 lds
 v_mfma_f32_16x16x32_bf16 v[88:91], a[24:27], a[152:155], v[88:91]
 ds_read_b64_tr_b16 a[40:41], v45 offset:8192
 v_mul_f32 v76, v76, v64
 v_mfma_f32_16x16x32_bf16 v[88:91], a[28:31], a[156:159], v[88:91]
 ds_read_b64_tr_b16 a[42:43], v45 offset:10240
 v_mul_f32 v77, v77, v64
 v_mfma_f32_16x16x32_bf16 v[96:99], a[0:3], a[160:163], 0
 ds_read_b64_tr_b16 a[44:45], v45 offset:12288
 v_mul_f32 v78, v78, v64
 v_mfma_f32_16x16x32_bf16 v[96:99], a[4:7], a[164:167], v[96:99]
 ds_read_b64_tr_b16 a[46:47], v45 offset:14336
 v_mul_f32 v79, v79, v64
 v_mfma_f32_16x16x32_bf16 v[96:99], a[8:11], a[168:171], v[96:99]
 ds_read_b64_tr_b16 a[48:49], v45 offset:16384
 v_cvt_pk_bf16_f32 v72, v72, v73
 v_mfma_f32_16x16x32_bf16 v[96:99], a[12:15], a[172:175], v[96:99]
 ds_read_b64_tr_b16 a[50:51], v45 offset:18432
 v_cvt_pk_bf16_f32 v73, v74, v75
 v_mfma_f32_16x16x32_bf16 v[96:99], a[16:19], a[176:179], v[96:99]
 ds_read_b64_tr_b16 a[52:53], v45 offset:20480
 buffer_load_dwordx4 v1, s[4:7], s34 offen offset:2048 lds
 v_mfma_f32_16x16x32_bf16 v[96:99], a[20:23], a[180:183], v[96:99]
 ds_read_b64_tr_b16 a[54:55], v45 offset:22528
 v_cvt_pk_bf16_f32 v74, v76, v77
 v_mfma_f32_16x16x32_bf16 v[96:99], a[24:27], a[184:187], v[96:99]
 s_add_u32 s58, s48, 156672
 ds_read_b64_tr_b16 a[56:57], v45 offset:24576
 v_cvt_pk_bf16_f32 v75, v78, v79
 v_mfma_f32_16x16x32_bf16 v[96:99], a[28:31], a[188:191], v[96:99]
 s_waitcnt lgkmcnt(7)
 ds_read_b64_tr_b16 a[58:59], v45 offset:26624
 buffer_store_dwordx4 v[72:75], v1, s[12:15], s58 offen sc1
 v_mfma_f32_16x16x32_bf16 v[92:95], a[32:35], a[128:131], 0
 ds_read_b64_tr_b16 a[60:61], v45 offset:28672
 v_mul_f32 v80, v80, v65
 v_mfma_f32_16x16x32_bf16 v[92:95], a[36:39], a[132:135], v[92:95]
 ds_read_b64_tr_b16 a[62:63], v45 offset:30720
 v_xor_b32 v46, 0x30000, v46
 v_mfma_f32_16x16x32_bf16 v[92:95], a[40:43], a[136:139], v[92:95]
 s_waitcnt lgkmcnt(4)
 ds_read_b64_tr_b16 a[0:1], v46 offset:0
 v_mul_f32 v81, v81, v65
 v_mfma_f32_16x16x32_bf16 v[92:95], a[44:47], a[140:143], v[92:95]
 ds_read_b64_tr_b16 a[2:3], v46 offset:2048
 buffer_load_dwordx4 v1, s[4:7], s34 offen offset:3072 lds
 v_mfma_f32_16x16x32_bf16 v[92:95], a[48:51], a[144:147], v[92:95]
 ds_read_b64_tr_b16 a[4:5], v46 offset:4096
 v_mul_f32 v82, v82, v65
 v_mfma_f32_16x16x32_bf16 v[92:95], a[52:55], a[148:151], v[92:95]
 s_waitcnt lgkmcnt(3)
 ds_read_b64_tr_b16 a[6:7], v46 offset:6144
 v_mul_f32 v83, v83, v65
 v_mfma_f32_16x16x32_bf16 v[92:95], a[56:59], a[152:155], v[92:95]
 ds_read_b64_tr_b16 a[8:9], v46 offset:8192
 v_mul_f32 v84, v84, v65
 v_mfma_f32_16x16x32_bf16 v[92:95], a[60:63], a[156:159], v[92:95]
 ds_read_b64_tr_b16 a[10:11], v46 offset:10240
 v_mul_f32 v85, v85, v65
 v_mfma_f32_16x16x32_bf16 v[100:103], a[32:35], a[160:163], 0
 ds_read_b64_tr_b16 a[12:13], v46 offset:12288
 v_mul_f32 v86, v86, v65
 v_mfma_f32_16x16x32_bf16 v[100:103], a[36:39], a[164:167], v[100:103]
 s_add_u32 m0, s33, 128
 ds_read_b64_tr_b16 a[14:15], v46 offset:14336
 v_mul_f32 v87, v87, v65
 v_mfma_f32_16x16x32_bf16 v[100:103], a[40:43], a[168:171], v[100:103]
 ds_read_b64_tr_b16 a[16:17], v46 offset:16384
 buffer_load_dwordx4 v10, s[12:15], s35 offen offset:0 sc1 lds
 v_mfma_f32_16x16x32_bf16 v[100:103], a[44:47], a[172:175], v[100:103]
 ds_read_b64_tr_b16 a[18:19], v46 offset:18432
 v_cvt_pk_bf16_f32 v80, v80, v81
 v_mfma_f32_16x16x32_bf16 v[100:103], a[48:51], a[176:179], v[100:103]
 ds_read_b64_tr_b16 a[20:21], v46 offset:20480
 v_cvt_pk_bf16_f32 v81, v82, v83
 v_mfma_f32_16x16x32_bf16 v[100:103], a[52:55], a[180:183], v[100:103]
 ds_read_b64_tr_b16 a[22:23], v46 offset:22528
 v_cvt_pk_bf16_f32 v82, v84, v85
 v_mfma_f32_16x16x32_bf16 v[100:103], a[56:59], a[184:187], v[100:103]
 s_add_u32 s58, s48, 1131520
 ds_read_b64_tr_b16 a[24:25], v46 offset:24576
 v_cvt_pk_bf16_f32 v83, v86, v87
 v_mfma_f32_16x16x32_bf16 v[100:103], a[60:63], a[188:191], v[100:103]
 s_waitcnt lgkmcnt(7)
 ds_read_b64_tr_b16 a[26:27], v46 offset:26624
 buffer_store_dwordx4 v[80:83], v1, s[12:15], s58 offen sc1
 v_mfma_f32_16x16x32_bf16 v[104:107], a[0:3], a[128:131], 0
 ds_read_b64_tr_b16 a[28:29], v46 offset:28672
 v_mul_f32 v88, v88, v64
 v_mfma_f32_16x16x32_bf16 v[104:107], a[4:7], a[132:135], v[104:107]
 s_add_u32 m0, s33, 1248
 ds_read_b64_tr_b16 a[30:31], v46 offset:30720
 v_xor_b32 v47, 0x30000, v47
 v_mfma_f32_16x16x32_bf16 v[104:107], a[8:11], a[136:139], v[104:107]
 s_waitcnt lgkmcnt(4)
 ds_read_b64_tr_b16 a[32:33], v47 offset:0
 buffer_load_dwordx4 v10, s[12:15], s35 offen offset:32 sc1 lds
 v_mfma_f32_16x16x32_bf16 v[104:107], a[12:15], a[140:143], v[104:107]
 ds_read_b64_tr_b16 a[34:35], v47 offset:2048
 v_mul_f32 v89, v89, v64
 v_mfma_f32_16x16x32_bf16 v[104:107], a[16:19], a[144:147], v[104:107]
 ds_read_b64_tr_b16 a[36:37], v47 offset:4096
 v_mul_f32 v90, v90, v64
 v_mfma_f32_16x16x32_bf16 v[104:107], a[20:23], a[148:151], v[104:107]
 s_waitcnt lgkmcnt(3)
 ds_read_b64_tr_b16 a[38:39], v47 offset:6144
 v_mul_f32 v91, v91, v64
 v_mfma_f32_16x16x32_bf16 v[104:107], a[24:27], a[152:155], v[104:107]
 ds_read_b64_tr_b16 a[40:41], v47 offset:8192
 v_mul_f32 v92, v92, v64
 v_mfma_f32_16x16x32_bf16 v[104:107], a[28:31], a[156:159], v[104:107]
 ds_read_b64_tr_b16 a[42:43], v47 offset:10240
 v_mul_f32 v93, v93, v64
 v_mfma_f32_16x16x32_bf16 v[112:115], a[0:3], a[160:163], 0
 s_add_u32 m0, s33, 2368
 ds_read_b64_tr_b16 a[44:45], v47 offset:12288
 v_mul_f32 v94, v94, v64
 v_mfma_f32_16x16x32_bf16 v[112:115], a[4:7], a[164:167], v[112:115]
 ds_read_b64_tr_b16 a[46:47], v47 offset:14336
 buffer_load_dwordx4 v10, s[12:15], s35 offen offset:64 sc1 lds
 v_mfma_f32_16x16x32_bf16 v[112:115], a[8:11], a[168:171], v[112:115]
 ds_read_b64_tr_b16 a[48:49], v47 offset:16384
 v_mul_f32 v95, v95, v64
 v_mfma_f32_16x16x32_bf16 v[112:115], a[12:15], a[172:175], v[112:115]
 ds_read_b64_tr_b16 a[50:51], v47 offset:18432
 v_cvt_pk_bf16_f32 v88, v88, v89
 v_mfma_f32_16x16x32_bf16 v[112:115], a[16:19], a[176:179], v[112:115]
 ds_read_b64_tr_b16 a[52:53], v47 offset:20480
 v_cvt_pk_bf16_f32 v89, v90, v91
 v_mfma_f32_16x16x32_bf16 v[112:115], a[20:23], a[180:183], v[112:115]
 ds_read_b64_tr_b16 a[54:55], v47 offset:22528
 v_cvt_pk_bf16_f32 v90, v92, v93
 v_mfma_f32_16x16x32_bf16 v[112:115], a[24:27], a[184:187], v[112:115]
 s_add_u32 m0, s33, 3488
 ds_read_b64_tr_b16 a[56:57], v47 offset:24576
 v_cvt_pk_bf16_f32 v91, v94, v95
 v_mfma_f32_16x16x32_bf16 v[112:115], a[28:31], a[188:191], v[112:115]
 s_waitcnt lgkmcnt(7)
 ds_read_b64_tr_b16 a[58:59], v47 offset:26624
 v_mul_f32 v96, v96, v65
 v_mfma_f32_16x16x32_bf16 v[108:111], a[32:35], a[128:131], 0
 s_waitcnt vmcnt(10)
 ds_read_b64_tr_b16 a[60:61], v47 offset:28672
 buffer_load_dwordx4 v10, s[12:15], s35 offen offset:96 sc1 lds
 v_mfma_f32_16x16x32_bf16 v[108:111], a[36:39], a[132:135], v[108:111]
 s_barrier
 ds_read_b64_tr_b16 a[62:63], v47 offset:30720
 v_xor_b32 v44, 0x20000, v44
 v_mfma_f32_16x16x32_bf16 v[108:111], a[40:43], a[136:139], v[108:111]
 s_waitcnt lgkmcnt(4)
 ds_read_b64_tr_b16 a[0:1], v44 offset:0
 v_mul_f32 v97, v97, v65
 v_mfma_f32_16x16x32_bf16 v[108:111], a[44:47], a[140:143], v[108:111]
 s_add_u32 s58, s48, 174080
 ds_read_b64_tr_b16 a[2:3], v44 offset:2048
 v_mul_f32 v98, v98, v65
 v_mfma_f32_16x16x32_bf16 v[108:111], a[48:51], a[144:147], v[108:111]
 ds_read_b64_tr_b16 a[4:5], v44 offset:4096
 buffer_store_dwordx4 v[88:91], v1, s[12:15], s58 offen sc1
 v_mfma_f32_16x16x32_bf16 v[108:111], a[52:55], a[148:151], v[108:111]
 s_waitcnt lgkmcnt(3)
 ds_read_b64_tr_b16 a[6:7], v44 offset:6144
 v_mul_f32 v99, v99, v65
 v_mfma_f32_16x16x32_bf16 v[108:111], a[56:59], a[152:155], v[108:111]
 ds_read_b64_tr_b16 a[8:9], v44 offset:8192
 v_mul_f32 v100, v100, v65
 v_mfma_f32_16x16x32_bf16 v[108:111], a[60:63], a[156:159], v[108:111]
 ds_read_b64_tr_b16 a[10:11], v44 offset:10240
 v_mul_f32 v101, v101, v65
 v_mfma_f32_16x16x32_bf16 v[116:119], a[32:35], a[160:163], 0
 ds_read_b64_tr_b16 a[12:13], v44 offset:12288
 v_mul_f32 v102, v102, v65
 v_mfma_f32_16x16x32_bf16 v[116:119], a[36:39], a[164:167], v[116:119]
 ds_read_b64_tr_b16 a[14:15], v44 offset:14336
 v_mul_f32 v103, v103, v65
 v_mfma_f32_16x16x32_bf16 v[116:119], a[40:43], a[168:171], v[116:119]
 ds_read_b64_tr_b16 a[16:17], v44 offset:16384
 v_cvt_pk_bf16_f32 v96, v96, v97
 v_mfma_f32_16x16x32_bf16 v[116:119], a[44:47], a[172:175], v[116:119]
 ds_read_b64_tr_b16 a[18:19], v44 offset:18432
 v_cvt_pk_bf16_f32 v97, v98, v99
 v_mfma_f32_16x16x32_bf16 v[116:119], a[48:51], a[176:179], v[116:119]
 ds_read_b64_tr_b16 a[20:21], v44 offset:20480
 v_cvt_pk_bf16_f32 v98, v100, v101
 v_mfma_f32_16x16x32_bf16 v[116:119], a[52:55], a[180:183], v[116:119]
 s_add_u32 s58, s48, 1148928
 ds_read_b64_tr_b16 a[22:23], v44 offset:22528
 v_cvt_pk_bf16_f32 v99, v102, v103
 v_mfma_f32_16x16x32_bf16 v[116:119], a[56:59], a[184:187], v[116:119]
 ds_read_b64_tr_b16 a[24:25], v44 offset:24576
 buffer_store_dwordx4 v[96:99], v1, s[12:15], s58 offen sc1
 v_mfma_f32_16x16x32_bf16 v[116:119], a[60:63], a[188:191], v[116:119]
 s_waitcnt lgkmcnt(7)
 ds_read_b64_tr_b16 a[26:27], v44 offset:26624
 v_mul_f32 v104, v104, v64
 v_mfma_f32_16x16x32_bf16 v[72:75], a[0:3], a[128:131], 0
 ds_read_b64_tr_b16 a[28:29], v44 offset:28672
 v_mul_f32 v105, v105, v64
 v_mfma_f32_16x16x32_bf16 v[72:75], a[4:7], a[132:135], v[72:75]
 ds_read_b64_tr_b16 a[30:31], v44 offset:30720
 v_xor_b32 v45, 0x20000, v45
 v_mfma_f32_16x16x32_bf16 v[72:75], a[8:11], a[136:139], v[72:75]
 s_waitcnt lgkmcnt(4)
 ds_read_b64_tr_b16 a[32:33], v45 offset:0
 v_mul_f32 v106, v106, v64
 v_mfma_f32_16x16x32_bf16 v[72:75], a[12:15], a[140:143], v[72:75]
 ds_read_b64_tr_b16 a[34:35], v45 offset:2048
 v_mul_f32 v107, v107, v64
 v_mfma_f32_16x16x32_bf16 v[72:75], a[16:19], a[144:147], v[72:75]
 ds_read_b64_tr_b16 a[36:37], v45 offset:4096
 v_mul_f32 v108, v108, v64
 v_mfma_f32_16x16x32_bf16 v[72:75], a[20:23], a[148:151], v[72:75]
 s_waitcnt lgkmcnt(3)
 ds_read_b64_tr_b16 a[38:39], v45 offset:6144
 v_mul_f32 v109, v109, v64
 v_mfma_f32_16x16x32_bf16 v[72:75], a[24:27], a[152:155], v[72:75]
 ds_read_b64_tr_b16 a[40:41], v45 offset:8192
 v_mul_f32 v110, v110, v64
 v_mfma_f32_16x16x32_bf16 v[72:75], a[28:31], a[156:159], v[72:75]
 ds_read_b64_tr_b16 a[42:43], v45 offset:10240
 v_mul_f32 v111, v111, v64
 v_mfma_f32_16x16x32_bf16 v[80:83], a[0:3], a[160:163], 0
 ds_read_b64_tr_b16 a[44:45], v45 offset:12288
 v_cvt_pk_bf16_f32 v104, v104, v105
 v_mfma_f32_16x16x32_bf16 v[80:83], a[4:7], a[164:167], v[80:83]
 ds_read_b64_tr_b16 a[46:47], v45 offset:14336
 v_cvt_pk_bf16_f32 v105, v106, v107
 v_mfma_f32_16x16x32_bf16 v[80:83], a[8:11], a[168:171], v[80:83]
 ds_read_b64_tr_b16 a[48:49], v45 offset:16384
 v_cvt_pk_bf16_f32 v106, v108, v109
 v_mfma_f32_16x16x32_bf16 v[80:83], a[12:15], a[172:175], v[80:83]
 s_add_u32 s58, s48, 191488
 ds_read_b64_tr_b16 a[50:51], v45 offset:18432
 v_cvt_pk_bf16_f32 v107, v110, v111
 v_mfma_f32_16x16x32_bf16 v[80:83], a[16:19], a[176:179], v[80:83]
 ds_read_b64_tr_b16 a[52:53], v45 offset:20480
 buffer_store_dwordx4 v[104:107], v1, s[12:15], s58 offen sc1
 v_mfma_f32_16x16x32_bf16 v[80:83], a[20:23], a[180:183], v[80:83]
 ds_read_b64_tr_b16 a[54:55], v45 offset:22528
 v_mul_f32 v112, v112, v65
 v_mfma_f32_16x16x32_bf16 v[80:83], a[24:27], a[184:187], v[80:83]
 ds_read_b64_tr_b16 a[56:57], v45 offset:24576
 v_mul_f32 v113, v113, v65
 v_mfma_f32_16x16x32_bf16 v[80:83], a[28:31], a[188:191], v[80:83]
 s_waitcnt lgkmcnt(7)
 ds_read_b64_tr_b16 a[58:59], v45 offset:26624
 v_mul_f32 v114, v114, v65
 v_mfma_f32_16x16x32_bf16 v[76:79], a[32:35], a[128:131], 0
 ds_read_b64_tr_b16 a[60:61], v45 offset:28672
 v_mul_f32 v115, v115, v65
 v_mfma_f32_16x16x32_bf16 v[76:79], a[36:39], a[132:135], v[76:79]
 ds_read_b64_tr_b16 a[62:63], v45 offset:30720
 v_xor_b32 v46, 0x20000, v46
 v_mfma_f32_16x16x32_bf16 v[76:79], a[40:43], a[136:139], v[76:79]
 s_waitcnt lgkmcnt(4)
 ds_read_b64_tr_b16 a[0:1], v46 offset:0
 v_mul_f32 v116, v116, v65
 v_mfma_f32_16x16x32_bf16 v[76:79], a[44:47], a[140:143], v[76:79]
 ds_read_b64_tr_b16 a[2:3], v46 offset:2048
 v_mul_f32 v117, v117, v65
 v_mfma_f32_16x16x32_bf16 v[76:79], a[48:51], a[144:147], v[76:79]
 ds_read_b64_tr_b16 a[4:5], v46 offset:4096
 v_mul_f32 v118, v118, v65
 v_mfma_f32_16x16x32_bf16 v[76:79], a[52:55], a[148:151], v[76:79]
 s_waitcnt lgkmcnt(3)
 ds_read_b64_tr_b16 a[6:7], v46 offset:6144
 v_mul_f32 v119, v119, v65
 v_mfma_f32_16x16x32_bf16 v[76:79], a[56:59], a[152:155], v[76:79]
 ds_read_b64_tr_b16 a[8:9], v46 offset:8192
 v_cvt_pk_bf16_f32 v112, v112, v113
 v_mfma_f32_16x16x32_bf16 v[76:79], a[60:63], a[156:159], v[76:79]
 ds_read_b64_tr_b16 a[10:11], v46 offset:10240
 v_cvt_pk_bf16_f32 v113, v114, v115
 v_mfma_f32_16x16x32_bf16 v[84:87], a[32:35], a[160:163], 0
 ds_read_b64_tr_b16 a[12:13], v46 offset:12288
 v_cvt_pk_bf16_f32 v114, v116, v117
 v_mfma_f32_16x16x32_bf16 v[84:87], a[36:39], a[164:167], v[84:87]
 s_add_u32 s58, s48, 1166336
 ds_read_b64_tr_b16 a[14:15], v46 offset:14336
 v_cvt_pk_bf16_f32 v115, v118, v119
 v_mfma_f32_16x16x32_bf16 v[84:87], a[40:43], a[168:171], v[84:87]
 ds_read_b64_tr_b16 a[16:17], v46 offset:16384
 buffer_store_dwordx4 v[112:115], v1, s[12:15], s58 offen sc1
 v_mfma_f32_16x16x32_bf16 v[84:87], a[44:47], a[172:175], v[84:87]
 ds_read_b64_tr_b16 a[18:19], v46 offset:18432
 v_mul_f32 v72, v72, v64
 v_mfma_f32_16x16x32_bf16 v[84:87], a[48:51], a[176:179], v[84:87]
 ds_read_b64_tr_b16 a[20:21], v46 offset:20480
 v_mul_f32 v73, v73, v64
 v_mfma_f32_16x16x32_bf16 v[84:87], a[52:55], a[180:183], v[84:87]
 ds_read_b64_tr_b16 a[22:23], v46 offset:22528
 v_mul_f32 v74, v74, v64
 v_mfma_f32_16x16x32_bf16 v[84:87], a[56:59], a[184:187], v[84:87]
 ds_read_b64_tr_b16 a[24:25], v46 offset:24576
 v_mul_f32 v75, v75, v64
 v_mfma_f32_16x16x32_bf16 v[84:87], a[60:63], a[188:191], v[84:87]
 s_waitcnt lgkmcnt(7)
 ds_read_b64_tr_b16 a[26:27], v46 offset:26624
 v_mul_f32 v76, v76, v64
 v_mfma_f32_16x16x32_bf16 v[88:91], a[0:3], a[128:131], 0
 ds_read_b64_tr_b16 a[28:29], v46 offset:28672
 v_mul_f32 v77, v77, v64
 v_mfma_f32_16x16x32_bf16 v[88:91], a[4:7], a[132:135], v[88:91]
 ds_read_b64_tr_b16 a[30:31], v46 offset:30720
 v_xor_b32 v47, 0x20000, v47
 v_mfma_f32_16x16x32_bf16 v[88:91], a[8:11], a[136:139], v[88:91]
 s_waitcnt lgkmcnt(4)
 ds_read_b64_tr_b16 a[32:33], v47 offset:0
 v_mul_f32 v78, v78, v64
 v_mfma_f32_16x16x32_bf16 v[88:91], a[12:15], a[140:143], v[88:91]
 ds_read_b64_tr_b16 a[34:35], v47 offset:2048
 v_mul_f32 v79, v79, v64
 v_mfma_f32_16x16x32_bf16 v[88:91], a[16:19], a[144:147], v[88:91]
 ds_read_b64_tr_b16 a[36:37], v47 offset:4096
 v_cvt_pk_bf16_f32 v72, v72, v73
 v_mfma_f32_16x16x32_bf16 v[88:91], a[20:23], a[148:151], v[88:91]
 s_waitcnt lgkmcnt(3)
 ds_read_b64_tr_b16 a[38:39], v47 offset:6144
 v_cvt_pk_bf16_f32 v73, v74, v75
 v_mfma_f32_16x16x32_bf16 v[88:91], a[24:27], a[152:155], v[88:91]
 ds_read_b64_tr_b16 a[40:41], v47 offset:8192
 v_cvt_pk_bf16_f32 v74, v76, v77
 v_mfma_f32_16x16x32_bf16 v[88:91], a[28:31], a[156:159], v[88:91]
 s_add_u32 s58, s48, 208896
 ds_read_b64_tr_b16 a[42:43], v47 offset:10240
 v_cvt_pk_bf16_f32 v75, v78, v79
 v_mfma_f32_16x16x32_bf16 v[96:99], a[0:3], a[160:163], 0
 ds_read_b64_tr_b16 a[44:45], v47 offset:12288
 buffer_store_dwordx4 v[72:75], v1, s[12:15], s58 offen sc1
 v_mfma_f32_16x16x32_bf16 v[96:99], a[4:7], a[164:167], v[96:99]
 ds_read_b64_tr_b16 a[46:47], v47 offset:14336
 v_mul_f32 v80, v80, v65
 v_mfma_f32_16x16x32_bf16 v[96:99], a[8:11], a[168:171], v[96:99]
 ds_read_b64_tr_b16 a[48:49], v47 offset:16384
 v_mul_f32 v81, v81, v65
 v_mfma_f32_16x16x32_bf16 v[96:99], a[12:15], a[172:175], v[96:99]
 ds_read_b64_tr_b16 a[50:51], v47 offset:18432
 v_mul_f32 v82, v82, v65
 v_mfma_f32_16x16x32_bf16 v[96:99], a[16:19], a[176:179], v[96:99]
 ds_read_b64_tr_b16 a[52:53], v47 offset:20480
 v_mul_f32 v83, v83, v65
 v_mfma_f32_16x16x32_bf16 v[96:99], a[20:23], a[180:183], v[96:99]
 ds_read_b64_tr_b16 a[54:55], v47 offset:22528
 v_mul_f32 v84, v84, v65
 v_mfma_f32_16x16x32_bf16 v[96:99], a[24:27], a[184:187], v[96:99]
 ds_read_b64_tr_b16 a[56:57], v47 offset:24576
 v_mul_f32 v85, v85, v65
 v_mfma_f32_16x16x32_bf16 v[96:99], a[28:31], a[188:191], v[96:99]
 s_waitcnt lgkmcnt(7)
 ds_read_b64_tr_b16 a[58:59], v47 offset:26624
 v_mul_f32 v86, v86, v65
 v_mfma_f32_16x16x32_bf16 v[92:95], a[32:35], a[128:131], 0
 ds_read_b64_tr_b16 a[60:61], v47 offset:28672
 v_mul_f32 v87, v87, v65
 v_mfma_f32_16x16x32_bf16 v[92:95], a[36:39], a[132:135], v[92:95]
 ds_read_b64_tr_b16 a[62:63], v47 offset:30720
 v_cvt_pk_bf16_f32 v80, v80, v81
 v_mfma_f32_16x16x32_bf16 v[92:95], a[40:43], a[136:139], v[92:95]
 s_waitcnt lgkmcnt(4)
 v_cvt_pk_bf16_f32 v81, v82, v83
 v_cvt_pk_bf16_f32 v82, v84, v85
 v_mfma_f32_16x16x32_bf16 v[92:95], a[44:47], a[140:143], v[92:95]
 s_add_u32 s58, s48, 1183744
 ds_write_b32 v11, v13 offset:0
 v_cvt_pk_bf16_f32 v83, v86, v87
 v_mul_f32 v88, v88, v64
 v_mfma_f32_16x16x32_bf16 v[92:95], a[48:51], a[144:147], v[92:95]
 ds_write_b32 v11, v13 offset:1152
 buffer_store_dwordx4 v[80:83], v1, s[12:15], s58 offen sc1
 v_mfma_f32_16x16x32_bf16 v[92:95], a[52:55], a[148:151], v[92:95]
 s_waitcnt lgkmcnt(0)
 ds_write_b32 v11, v13 offset:2304
 v_mul_f32 v89, v89, v64
 v_mul_f32 v90, v90, v64
 v_mfma_f32_16x16x32_bf16 v[92:95], a[56:59], a[152:155], v[92:95]
 ds_write_b32 v11, v13 offset:3456
 v_mul_f32 v91, v91, v64
 v_mul_f32 v96, v96, v65
 v_mfma_f32_16x16x32_bf16 v[92:95], a[60:63], a[156:159], v[92:95]
 ds_write_b32 v12, v13 offset:4608
 v_mul_f32 v97, v97, v65
 v_mul_f32 v98, v98, v65
 v_mfma_f32_16x16x32_bf16 v[100:103], a[32:35], a[160:163], 0
 v_mul_f32 v99, v99, v65
 v_mfma_f32_16x16x32_bf16 v[100:103], a[36:39], a[164:167], v[100:103]
 v_mfma_f32_16x16x32_bf16 v[100:103], a[40:43], a[168:171], v[100:103]
 v_mfma_f32_16x16x32_bf16 v[100:103], a[44:47], a[172:175], v[100:103]
 v_mfma_f32_16x16x32_bf16 v[100:103], a[48:51], a[176:179], v[100:103]
 v_mfma_f32_16x16x32_bf16 v[100:103], a[52:55], a[180:183], v[100:103]
 v_mfma_f32_16x16x32_bf16 v[100:103], a[56:59], a[184:187], v[100:103]
 v_mfma_f32_16x16x32_bf16 v[100:103], a[60:63], a[188:191], v[100:103]
 s_nop 4
 v_mul_f32 v92, v92, v64
 v_mul_f32 v93, v93, v64
 v_mul_f32 v94, v94, v64
 v_mul_f32 v95, v95, v64
 v_cvt_pk_bf16_f32 v88, v88, v89
 v_cvt_pk_bf16_f32 v89, v90, v91
 v_cvt_pk_bf16_f32 v90, v92, v93
 v_cvt_pk_bf16_f32 v91, v94, v95
 s_add_u32 s58, s48, 226304
 buffer_store_dwordx4 v[88:91], v1, s[12:15], s58 offen sc1
 v_mul_f32 v100, v100, v65
 v_mul_f32 v101, v101, v65
 v_mul_f32 v102, v102, v65
 v_mul_f32 v103, v103, v65
 v_cvt_pk_bf16_f32 v96, v96, v97
 v_cvt_pk_bf16_f32 v97, v98, v99
 v_cvt_pk_bf16_f32 v98, v100, v101
 v_cvt_pk_bf16_f32 v99, v102, v103
 s_add_u32 s58, s48, 1201152
 buffer_store_dwordx4 v[96:99], v1, s[12:15], s58 offen sc1
 s_cmp_ge_u32 s28, 14
 s_cbranch_scc1 L_idle
 v_and_b32 v22, 15, v0
 v_lshrrev_b32 v23, 4, v0
 v_lshl_add_u32 v18, v22, 3, s33
 v_lshl_add_u32 v16, v23, 4, v18
 v_lshl_add_u32 v18, v23, 1, v18
 v_and_b32 v17, 3, v0
 v_bfe_u32 v24, v0, 2, 2
 v_sub_u32 v17, v17, v24
 v_lshlrev_b32 v24, 3, v23
 v_sub_u32 v17, v17, v24
 v_add_u32 v17, 32, v17
 v_lshl_add_u32 v17, v17, 3, s33
 v_lshlrev_b32 v20, 5, v22
 v_lshl_add_u32 v20, v23, 3, v20
 v_add_u32 v24, -1, v0
 v_and_b32 v24, 15, v24
 v_add_u32 v24, 48, v24
 v_add_u32 v19, -16, v0
 v_cmp_gt_u32 vcc, 16, v0
 v_accvgpr_read_b32 v21, a245
 s_add_u32 s34, s35, 4194304
 v_cndmask_b32 v19, v19, v24, vcc
 v_lshlrev_b32 v19, 2, v19
 v_cmp_eq_u32 vcc, 63, v0
 s_lshl_b32 s30, s31, 16
 s_and_b32 s31, s31, 0xffff0000
 s_bitcmp1_b32 s3, 0
 s_cselect_b32 s31, s31, s30
 v_mov_b64 v[224:225], 0
 v_mov_b64 v[226:227], 0
 v_mov_b64 v[228:229], 0
 v_mov_b64 v[230:231], 0
 v_mov_b64 v[232:233], 0
 v_mov_b64 v[234:235], 0
 v_mov_b64 v[236:237], 0
 v_mov_b64 v[238:239], 0
 v_mov_b64 v[240:241], 0
 v_mov_b64 v[242:243], 0
 v_mov_b64 v[244:245], 0
 v_mov_b64 v[246:247], 0
 v_mov_b64 v[248:249], 0
 v_mov_b64 v[250:251], 0
 v_mov_b64 v[252:253], 0
 v_mov_b64 v[254:255], 0
 s_waitcnt vmcnt(8) lgkmcnt(0)
 ds_read_b64_tr_b16 v[160:161], v17 offset:4608
 ds_read_b64_tr_b16 v[162:163], v17 offset:4576
 ds_read_b64_tr_b16 v[164:165], v17 offset:4864
 ds_read_b64_tr_b16 v[166:167], v17 offset:4832
 ds_read_b64 a[4:5], v16 offset:72
 ds_read_b64 a[6:7], v16 offset:80
 ds_read_b64 a[0:1], v16 offset:8
 ds_read_b64 a[2:3], v16 offset:16
 s_waitcnt lgkmcnt(6)
 ds_read_b64 a[68:69], v16 offset:1224
 ds_read_b64 a[70:71], v16 offset:1232
 ds_read_b64 a[64:65], v16 offset:1160
 ds_read_b64 a[66:67], v16 offset:1168
 ds_read_b64 a[132:133], v16 offset:2376
 ds_read_b64 a[134:135], v16 offset:2384
 ds_read_b64 a[128:129], v16 offset:2312
 ds_read_b64 a[130:131], v16 offset:2320
 s_waitcnt lgkmcnt(6)
 ds_read_b64 a[196:197], v16 offset:3528
 ds_read_b64 a[198:199], v16 offset:3536
 ds_read_b64 a[192:193], v16 offset:3464
 ds_read_b64 a[194:195], v16 offset:3472
 ds_read_b64_tr_b16 v[168:169], v17 offset:5120
 ds_read_b64_tr_b16 v[170:171], v17 offset:5088
 ds_read_b64_tr_b16 v[172:173], v17 offset:5376
 ds_read_b64_tr_b16 v[174:175], v17 offset:5344
 s_waitcnt lgkmcnt(6)
 ds_read_b64 a[12:13], v16 offset:200
 ds_read_b64 a[14:15], v16 offset:208
 ds_read_b64 a[8:9], v16 offset:136
 ds_read_b64 a[10:11], v16 offset:144
 ds_read_b64 a[76:77], v16 offset:1352
 ds_read_b64 a[78:79], v16 offset:1360
 ds_read_b64 a[72:73], v16 offset:1288
 ds_read_b64 a[74:75], v16 offset:1296
 s_waitcnt lgkmcnt(6)
 ds_read_b64 a[140:141], v16 offset:2504
 ds_read_b64 a[142:143], v16 offset:2512
 ds_read_b64 a[136:137], v16 offset:2440
 ds_read_b64 a[138:139], v16 offset:2448
 ds_read_b64 a[204:205], v16 offset:3656
 ds_read_b64 a[206:207], v16 offset:3664
 ds_read_b64 a[200:201], v16 offset:3592
 ds_read_b64 a[202:203], v16 offset:3600
 s_waitcnt lgkmcnt(6)
 ds_read_b64_tr_b16 v[176:177], v17 offset:5632
 ds_read_b64_tr_b16 v[178:179], v17 offset:5600
 ds_read_b64_tr_b16 v[180:181], v17 offset:5888
 ds_read_b64_tr_b16 v[182:183], v17 offset:5856
 s_waitcnt lgkmcnt(0)
 v_lshlrev_b32 v11, 2, v22
 s_add_u32 s45, s44, 1088
 v_mfma_f32_16x16x32_bf16 v[32:35], v[160:163], a[4:7], 0
 ds_read_b64 a[20:21], v16 offset:328
 v_mfma_f32_16x16x32_bf16 v[32:35], v[164:167], a[0:3], v[32:35]
 ds_read_b64 a[22:23], v16 offset:336
 v_mfma_f32_16x16x32_bf16 v[36:39], v[160:163], a[68:71], 0
 ds_read_b64 a[16:17], v16 offset:264
 v_mfma_f32_16x16x32_bf16 v[36:39], v[164:167], a[64:67], v[36:39]
 ds_read_b64 a[18:19], v16 offset:272
 v_mfma_f32_16x16x32_bf16 v[40:43], v[160:163], a[132:135], 0
 ds_read_b64 a[84:85], v16 offset:1480
 v_mfma_f32_16x16x32_bf16 v[40:43], v[164:167], a[128:131], v[40:43]
 s_waitcnt vmcnt(0)
 ds_read_b64 a[86:87], v16 offset:1488
 v_mfma_f32_16x16x32_bf16 v[44:47], v[160:163], a[196:199], 0
 s_barrier
 ds_read_b64 a[80:81], v16 offset:1416
 v_mfma_f32_16x16x32_bf16 v[44:47], v[164:167], a[192:195], v[44:47]
 ds_read_b64 a[82:83], v16 offset:1424
 buffer_store_dword v21, v21, s[12:15], s93 offen sc1
 v_mfma_f32_16x16x32_bf16 v[48:51], v[160:163], a[12:15], 0
 ds_read_b64 a[148:149], v16 offset:2632
 v_mfma_f32_16x16x32_bf16 v[48:51], v[164:167], a[8:11], v[48:51]
 ds_read_b64 a[150:151], v16 offset:2640
 v_mfma_f32_16x16x32_bf16 v[48:51], v[168:171], a[4:7], v[48:51]
 ds_read_b64 a[144:145], v16 offset:2568
 v_mfma_f32_16x16x32_bf16 v[48:51], v[172:175], a[0:3], v[48:51]
 s_lshl_b32 s42, s42, 4
 ds_read_b64 a[146:147], v16 offset:2576
 v_mfma_f32_16x16x32_bf16 v[52:55], v[160:163], a[76:79], 0
 s_lshl_b32 s36, s41, 6
 ds_read_b64 a[212:213], v16 offset:3784
 v_mfma_f32_16x16x32_bf16 v[52:55], v[164:167], a[72:75], v[52:55]
 s_add_u32 s36, s36, 896
 ds_read_b64 a[214:215], v16 offset:3792
 v_mfma_f32_16x16x32_bf16 v[52:55], v[168:171], a[68:71], v[52:55]
 s_add_u32 s35, s36, 1835008
 ds_read_b64 a[208:209], v16 offset:3720
 v_mfma_f32_16x16x32_bf16 v[52:55], v[172:175], a[64:67], v[52:55]
 s_add_u32 s39, s37, 15597568
 ds_read_b64 a[210:211], v16 offset:3728
 v_mfma_f32_16x16x32_bf16 v[56:59], v[160:163], a[140:143], 0
 s_mov_b32 s8, s88
 ds_read_b64_tr_b16 v[184:185], v17 offset:6144
 v_mfma_f32_16x16x32_bf16 v[56:59], v[164:167], a[136:139], v[56:59]
 s_mov_b32 s9, s89
 ds_read_b64_tr_b16 v[186:187], v17 offset:6112
 v_mfma_f32_16x16x32_bf16 v[56:59], v[168:171], a[132:135], v[56:59]
 s_mov_b32 s10, 3670016
 ds_read_b64_tr_b16 v[188:189], v17 offset:6400
 v_mfma_f32_16x16x32_bf16 v[56:59], v[172:175], a[128:131], v[56:59]
 s_mov_b32 s11, 0x20000
 ds_read_b64_tr_b16 v[190:191], v17 offset:6368
 v_and_b32 v2, 15, v0
 v_mfma_f32_16x16x32_bf16 v[60:63], v[160:163], a[204:207], 0
 ds_read_b64 a[28:29], v16 offset:456
 v_add_u32 v2, s42, v2
 v_mfma_f32_16x16x32_bf16 v[60:63], v[164:167], a[200:203], v[60:63]
 ds_read_b64 a[30:31], v16 offset:464
 v_mul_u32_u24 v7, 896, v2
 v_mfma_f32_16x16x32_bf16 v[60:63], v[168:171], a[196:199], v[60:63]
 ds_read_b64 a[24:25], v16 offset:392
 v_lshrrev_b32 v3, 4, v0
 v_mfma_f32_16x16x32_bf16 v[60:63], v[172:175], a[192:195], v[60:63]
 s_waitcnt lgkmcnt(15)
 ds_read_b64 a[26:27], v16 offset:400
 v_lshlrev_b32 v8, 4, v3
 v_mfma_f32_16x16x32_bf16 v[64:67], v[160:163], a[20:23], 0
 ds_read_b64 a[92:93], v16 offset:1608
 v_lshl_add_u32 v2, v7, 1, v8
 v_mfma_f32_16x16x32_bf16 v[64:67], v[164:167], a[16:19], v[64:67]
 ds_read_b64 a[94:95], v16 offset:1616
 v_add_u32 v7, v7, v8
 v_mfma_f32_16x16x32_bf16 v[64:67], v[168:171], a[12:15], v[64:67]
 ds_read_b64 a[88:89], v16 offset:1544
 v_and_b32 v4, 1, v0
 v_mfma_f32_16x16x32_bf16 v[64:67], v[172:175], a[8:11], v[64:67]
 ds_read_b64 a[90:91], v16 offset:1552
 v_lshlrev_b32 v4, 4, v4
 v_mfma_f32_16x16x32_bf16 v[64:67], v[176:179], a[4:7], v[64:67]
 ds_read_b64 a[156:157], v16 offset:2760
 v_mov_b32 v5, 0x3f80
 v_mfma_f32_16x16x32_bf16 v[64:67], v[180:183], a[0:3], v[64:67]
 ds_read_b64 a[158:159], v16 offset:2768
 v_lshlrev_b32 v4, v4, v5
 v_mfma_f32_16x16x32_bf16 v[68:71], v[160:163], a[84:87], 0
 ds_read_b64 a[152:153], v16 offset:2696
 v_bfe_u32 v5, v0, 3, 1
 v_mfma_f32_16x16x32_bf16 v[68:71], v[164:167], a[80:83], v[68:71]
 ds_read_b64 a[154:155], v16 offset:2704
 v_bfe_u32 v6, v0, 1, 1
 v_mfma_f32_16x16x32_bf16 v[68:71], v[168:171], a[76:79], v[68:71]
 ds_read_b64 a[220:221], v16 offset:3912
 v_lshl_add_u32 v5, v5, 1, v6
 v_mfma_f32_16x16x32_bf16 v[68:71], v[172:175], a[72:75], v[68:71]
 ds_read_b64 a[222:223], v16 offset:3920
 v_bfe_u32 v6, v0, 2, 1
 v_mfma_f32_16x16x32_bf16 v[68:71], v[176:179], a[68:71], v[68:71]
 ds_read_b64 a[216:217], v16 offset:3848
 v_lshlrev_b32 v6, 1, v6
 v_mfma_f32_16x16x32_bf16 v[68:71], v[180:183], a[64:67], v[68:71]
 s_waitcnt lgkmcnt(15)
 ds_read_b64 a[218:219], v16 offset:3856
 v_sub_u32 v6, v3, v6
 v_mfma_f32_16x16x32_bf16 v[72:75], v[160:163], a[148:151], 0
 ds_read_b64_tr_b16 v[192:193], v17 offset:6656
 v_lshl_add_u32 v5, v6, 2, v5
 v_mfma_f32_16x16x32_bf16 v[72:75], v[164:167], a[144:147], v[72:75]
 ds_read_b64_tr_b16 v[194:195], v17 offset:6624
 v_cmp_eq_u32 s[16:17], 0, v5
 v_mfma_f32_16x16x32_bf16 v[72:75], v[168:171], a[140:143], v[72:75]
 ds_read_b64_tr_b16 v[196:197], v17 offset:6912
 v_cmp_eq_u32 s[18:19], 1, v5
 v_mfma_f32_16x16x32_bf16 v[72:75], v[172:175], a[136:139], v[72:75]
 ds_read_b64_tr_b16 v[198:199], v17 offset:6880
 v_cmp_eq_u32 s[20:21], 2, v5
 v_mfma_f32_16x16x32_bf16 v[72:75], v[176:179], a[132:135], v[72:75]
 ds_read_b64 a[36:37], v16 offset:584
 v_cmp_eq_u32 s[22:23], 3, v5
 v_mfma_f32_16x16x32_bf16 v[72:75], v[180:183], a[128:131], v[72:75]
 ds_read_b64 a[38:39], v16 offset:592
 v_cndmask_b32 v24, 0, v4, s[16:17]
 v_mfma_f32_16x16x32_bf16 v[76:79], v[160:163], a[212:215], 0
 ds_read_b64 a[32:33], v16 offset:520
 v_cndmask_b32 v25, 0, v4, s[18:19]
 v_mfma_f32_16x16x32_bf16 v[76:79], v[164:167], a[208:211], v[76:79]
 ds_read_b64 a[34:35], v16 offset:528
 v_cndmask_b32 v26, 0, v4, s[20:21]
 v_mfma_f32_16x16x32_bf16 v[76:79], v[168:171], a[204:207], v[76:79]
 ds_read_b64 a[100:101], v16 offset:1736
 v_cndmask_b32 v27, 0, v4, s[22:23]
 v_mfma_f32_16x16x32_bf16 v[76:79], v[172:175], a[200:203], v[76:79]
 ds_read_b64 a[102:103], v16 offset:1744
 v_cmp_eq_u32 s[16:17], 4, v5
 v_mfma_f32_16x16x32_bf16 v[76:79], v[176:179], a[196:199], v[76:79]
 ds_read_b64 a[96:97], v16 offset:1672
 v_cmp_eq_u32 s[18:19], 5, v5
 v_mfma_f32_16x16x32_bf16 v[76:79], v[180:183], a[192:195], v[76:79]
 s_waitcnt lgkmcnt(15)
 ds_read_b64 a[98:99], v16 offset:1680
 v_cmp_eq_u32 s[20:21], 6, v5
 v_mfma_f32_16x16x32_bf16 v[80:83], v[160:163], a[28:31], 0
 ds_read_b64 a[164:165], v16 offset:2888
 v_cmp_eq_u32 s[22:23], 7, v5
 v_mfma_f32_16x16x32_bf16 v[80:83], v[164:167], a[24:27], v[80:83]
 ds_read_b64 a[166:167], v16 offset:2896
 buffer_load_dword v23, v11, s[12:15], s44 offen offset:64 sc1
 v_mfma_f32_16x16x32_bf16 v[80:83], v[168:171], a[20:23], v[80:83]
 ds_read_b64 a[160:161], v16 offset:2824
 v_cndmask_b32 v28, 0, v4, s[16:17]
 v_mfma_f32_16x16x32_bf16 v[80:83], v[172:175], a[16:19], v[80:83]
 ds_read_b64 a[162:163], v16 offset:2832
 v_cndmask_b32 v29, 0, v4, s[18:19]
 v_mfma_f32_16x16x32_bf16 v[80:83], v[176:179], a[12:15], v[80:83]
 ds_read_b64 a[228:229], v16 offset:4040
 v_cndmask_b32 v30, 0, v4, s[20:21]
 v_mfma_f32_16x16x32_bf16 v[80:83], v[180:183], a[8:11], v[80:83]
 ds_read_b64 a[230:231], v16 offset:4048
 v_cndmask_b32 v31, 0, v4, s[22:23]
 v_mfma_f32_16x16x32_bf16 v[80:83], v[184:187], a[4:7], v[80:83]
 s_mov_b32 s16, s64
 ds_read_b64 a[224:225], v16 offset:3976
 v_mfma_f32_16x16x32_bf16 v[80:83], v[188:191], a[0:3], v[80:83]
 s_mov_b32 s17, s65
 ds_read_b64 a[226:227], v16 offset:3984
 v_mfma_f32_16x16x32_bf16 v[84:87], v[160:163], a[92:95], 0
 s_mov_b32 s18, 1835008
 ds_read_b64_tr_b16 v[200:201], v17 offset:7168
 v_mfma_f32_16x16x32_bf16 v[84:87], v[164:167], a[88:91], v[84:87]
 s_mov_b32 s19, 0x20000
 ds_read_b64_tr_b16 v[202:203], v17 offset:7136
 v_mfma_f32_16x16x32_bf16 v[84:87], v[168:171], a[84:87], v[84:87]
 s_lshl_b32 s93, s95, 2
 ds_read_b64_tr_b16 v[204:205], v17 offset:7424
 v_mfma_f32_16x16x32_bf16 v[84:87], v[172:175], a[80:83], v[84:87]
 s_add_u32 s93, s93, 84963328
 ds_read_b64_tr_b16 v[206:207], v17 offset:7392
 v_mfma_f32_16x16x32_bf16 v[84:87], v[176:179], a[76:79], v[84:87]
 s_lshl_b32 s43, s41, 6
 ds_read_b64 a[44:45], v16 offset:712
 v_mfma_f32_16x16x32_bf16 v[84:87], v[180:183], a[72:75], v[84:87]
 s_add_u32 s43, s43, 84963328
 ds_read_b64 a[46:47], v16 offset:720
 v_mfma_f32_16x16x32_bf16 v[84:87], v[184:187], a[68:71], v[84:87]
 s_lshl_b32 s46, s41, 7
 ds_read_b64 a[40:41], v16 offset:648
 v_mfma_f32_16x16x32_bf16 v[84:87], v[188:191], a[64:67], v[84:87]
 s_add_u32 s54, s46, 917504
 ds_read_b64 a[42:43], v16 offset:656
 v_mfma_f32_16x16x32_bf16 v[88:91], v[160:163], a[156:159], 0
 s_add_u32 s55, s46, 1835008
 ds_read_b64 a[108:109], v16 offset:1864
 v_mfma_f32_16x16x32_bf16 v[88:91], v[164:167], a[152:155], v[88:91]
 s_lshl_b32 s56, s42, 1
 ds_read_b64 a[110:111], v16 offset:1872
 v_mfma_f32_16x16x32_bf16 v[88:91], v[168:171], a[148:151], v[88:91]
 s_mul_i32 s57, s41, 262144
 ds_read_b64 a[104:105], v16 offset:1800
 v_mfma_f32_16x16x32_bf16 v[88:91], v[172:175], a[144:147], v[88:91]
 s_add_u32 s56, s56, s57
 ds_read_b64 a[106:107], v16 offset:1808
 v_mfma_f32_16x16x32_bf16 v[88:91], v[176:179], a[140:143], v[88:91]
 s_add_u32 s56, s56, 90177536
 ds_read_b64 a[172:173], v16 offset:3016
 v_mfma_f32_16x16x32_bf16 v[88:91], v[180:183], a[136:139], v[88:91]
 s_add_u32 s57, s56, 131072
 ds_read_b64 a[174:175], v16 offset:3024
 v_mfma_f32_16x16x32_bf16 v[88:91], v[184:187], a[132:135], v[88:91]
 s_lshl_b32 s58, s3, 12
 ds_read_b64 a[168:169], v16 offset:2952
 v_mfma_f32_16x16x32_bf16 v[88:91], v[188:191], a[128:131], v[88:91]
 s_waitcnt lgkmcnt(15)
 ds_read_b64 a[170:171], v16 offset:2960
 v_mfma_f32_16x16x32_bf16 v[92:95], v[160:163], a[220:223], 0
 s_add_u32 s58, s58, 0x20000
 ds_read_b64 a[236:237], v16 offset:4168
 v_mfma_f32_16x16x32_bf16 v[92:95], v[164:167], a[216:219], v[92:95]
 s_mov_b32 s59, 0xffff0000
 ds_read_b64 a[238:239], v16 offset:4176
 v_mfma_f32_16x16x32_bf16 v[92:95], v[168:171], a[212:215], v[92:95]
 s_lshl_b32 s47, s3, 14
 ds_read_b64 a[232:233], v16 offset:4104
 v_lshrrev_b32 v8, 1, v0
 v_mfma_f32_16x16x32_bf16 v[92:95], v[172:175], a[208:211], v[92:95]
 ds_read_b64 a[234:235], v16 offset:4112
 v_mul_u32_u24 v8, 4096, v8
 v_mfma_f32_16x16x32_bf16 v[92:95], v[176:179], a[204:207], v[92:95]
 ds_read_b64_tr_b16 v[208:209], v17 offset:7680
 v_and_b32 v9, 1, v0
 v_mfma_f32_16x16x32_bf16 v[92:95], v[180:183], a[200:203], v[92:95]
 ds_read_b64_tr_b16 v[210:211], v17 offset:7648
 v_lshl_add_u32 v8, v9, 4, v8
 v_mfma_f32_16x16x32_bf16 v[92:95], v[184:187], a[196:199], v[92:95]
 ds_read_b64_tr_b16 v[212:213], v17 offset:7936
 v_lshlrev_b32 v10, 3, v3
 v_mfma_f32_16x16x32_bf16 v[92:95], v[188:191], a[192:195], v[92:95]
 ds_read_b64_tr_b16 v[214:215], v17 offset:7904
 v_bfe_u32 v6, v0, 2, 2
 v_mfma_f32_16x16x32_bf16 v[96:99], v[160:163], a[36:39], 0
 ds_read_b64 a[52:53], v16 offset:840
 v_add_u32 v10, v10, v6
 v_mfma_f32_16x16x32_bf16 v[96:99], v[164:167], a[32:35], v[96:99]
 ds_read_b64 a[54:55], v16 offset:848
 v_lshlrev_b32 v10, 5, v10
 v_mfma_f32_16x16x32_bf16 v[96:99], v[168:171], a[28:31], v[96:99]
 ds_read_b64 a[48:49], v16 offset:776
 v_and_b32 v6, 3, v0
 v_mfma_f32_16x16x32_bf16 v[96:99], v[172:175], a[24:27], v[96:99]
 ds_read_b64 a[50:51], v16 offset:784
 v_lshl_add_u32 v10, v6, 3, v10
 v_mfma_f32_16x16x32_bf16 v[96:99], v[176:179], a[20:23], v[96:99]
 ds_read_b64 a[116:117], v16 offset:1992
 v_add_u32 v10, s58, v10
 v_mfma_f32_16x16x32_bf16 v[96:99], v[180:183], a[16:19], v[96:99]
 ds_read_b64 a[118:119], v16 offset:2000
 v_add_u32 v9, s47, v1
 v_mfma_f32_16x16x32_bf16 v[96:99], v[184:187], a[12:15], v[96:99]
 ds_read_b64 a[112:113], v16 offset:1928
 v_add_f32 v39, v39, v42
 v_mfma_f32_16x16x32_bf16 v[96:99], v[188:191], a[8:11], v[96:99]
 ds_read_b64 a[114:115], v16 offset:1936
 v_add_f32 v43, v43, v46
 v_mfma_f32_16x16x32_bf16 v[96:99], v[192:195], a[4:7], v[96:99]
 ds_read_b64 a[180:181], v16 offset:3144
 v_add_f32 v39, v39, v45
 v_mfma_f32_16x16x32_bf16 v[96:99], v[196:199], a[0:3], v[96:99]
 ds_read_b64 a[182:183], v16 offset:3152
 v_cndmask_b32_e64 v224, v39, 0, vcc
 v_mfma_f32_16x16x32_bf16 v[100:103], v[160:163], a[100:103], 0
 s_waitcnt vmcnt(0)
 ds_read_b64 a[176:177], v16 offset:3080
 v_cmp_ne_u32 s[52:53], 0, v23
 v_mfma_f32_16x16x32_bf16 v[100:103], v[164:167], a[96:99], v[100:103]
 s_cmp_eq_u64 s[52:53], 0
 s_cselect_b32 s49, 1, 0
 s_cselect_b32 s51, s37, 2.0
 ds_read_b64 a[178:179], v16 offset:3088
 v_mfma_f32_16x16x32_bf16 v[100:103], v[168:171], a[92:95], v[100:103]
 s_lshl_b32 m0, s3, 14
 ds_read_b64 a[244:245], v16 offset:4296
 v_cndmask_b32_e64 v225, v43, 0, vcc
 v_mfma_f32_16x16x32_bf16 v[100:103], v[172:175], a[88:91], v[100:103]
 ds_read_b64 a[246:247], v16 offset:4304
 v_cndmask_b32_e64 v226, v47, 0, vcc
 v_mfma_f32_16x16x32_bf16 v[100:103], v[176:179], a[84:87], v[100:103]
 ds_read_b64 a[240:241], v16 offset:4232
 buffer_load_dwordx4 v1, s[12:15], s51 offen offset:0 sc1 lds
 v_mfma_f32_16x16x32_bf16 v[100:103], v[180:183], a[80:83], v[100:103]
 ds_read_b64 a[242:243], v16 offset:4240
 v_add_f32 v33, v33, v36
 v_mfma_f32_16x16x32_bf16 v[100:103], v[184:187], a[76:79], v[100:103]
 ds_read_b64_tr_b16 v[216:217], v17 offset:8192
 v_add_f32 v34, v34, v37
 v_mfma_f32_16x16x32_bf16 v[100:103], v[188:191], a[72:75], v[100:103]
 ds_read_b64_tr_b16 v[218:219], v17 offset:8160
 v_add_f32 v35, v35, v38
 v_mfma_f32_16x16x32_bf16 v[100:103], v[192:195], a[68:71], v[100:103]
 ds_read_b64_tr_b16 v[220:221], v17 offset:8448
 v_add_f32 v34, v34, v40
 v_mfma_f32_16x16x32_bf16 v[100:103], v[196:199], a[64:67], v[100:103]
 ds_read_b64_tr_b16 v[222:223], v17 offset:8416
 v_add_f32 v35, v35, v41
 v_mfma_f32_16x16x32_bf16 v[104:107], v[160:163], a[164:167], 0
 ds_read_b64 a[60:61], v16 offset:968
 v_add_f32 v35, v35, v44
 v_mfma_f32_16x16x32_bf16 v[104:107], v[164:167], a[160:163], v[104:107]
 ds_read_b64 a[62:63], v16 offset:976
 v_add_f32 v55, v55, v58
 v_mfma_f32_16x16x32_bf16 v[104:107], v[168:171], a[156:159], v[104:107]
 ds_read_b64 a[56:57], v16 offset:904
 buffer_load_dwordx4 v1, s[12:15], s51 offen offset:1024 sc1 lds
 v_mfma_f32_16x16x32_bf16 v[104:107], v[172:175], a[152:155], v[104:107]
 ds_read_b64 a[58:59], v16 offset:912
 v_add_f32 v59, v59, v62
 v_mfma_f32_16x16x32_bf16 v[104:107], v[176:179], a[148:151], v[104:107]
 ds_read_b64 a[124:125], v16 offset:2120
 v_add_f32 v55, v55, v61
 v_mfma_f32_16x16x32_bf16 v[104:107], v[180:183], a[144:147], v[104:107]
 ds_read_b64 a[126:127], v16 offset:2128
 v_cndmask_b32_e64 v232, v55, v39, vcc
 v_mfma_f32_16x16x32_bf16 v[104:107], v[184:187], a[140:143], v[104:107]
 ds_read_b64 a[120:121], v16 offset:2056
 v_cndmask_b32_e64 v233, v59, v43, vcc
 v_mfma_f32_16x16x32_bf16 v[104:107], v[188:191], a[136:139], v[104:107]
 ds_read_b64 a[122:123], v16 offset:2064
 v_cndmask_b32_e64 v234, v63, v47, vcc
 v_mfma_f32_16x16x32_bf16 v[104:107], v[192:195], a[132:135], v[104:107]
 ds_read_b64 a[188:189], v16 offset:3272
 v_add_f32 v49, v49, v52
 v_mfma_f32_16x16x32_bf16 v[104:107], v[196:199], a[128:131], v[104:107]
 ds_read_b64 a[190:191], v16 offset:3280
 v_add_f32 v50, v50, v53
 v_mfma_f32_16x16x32_bf16 v[108:111], v[160:163], a[228:231], 0
 ds_read_b64 a[184:185], v16 offset:3208
 buffer_load_dwordx4 v1, s[12:15], s51 offen offset:2048 sc1 lds
 v_mfma_f32_16x16x32_bf16 v[108:111], v[164:167], a[224:227], v[108:111]
 ds_read_b64 a[186:187], v16 offset:3216
 v_add_f32 v51, v51, v54
 v_mfma_f32_16x16x32_bf16 v[108:111], v[168:171], a[220:223], v[108:111]
 ds_read_b64 v[12:13], v16 offset:4424
 v_add_f32 v50, v50, v56
 v_mfma_f32_16x16x32_bf16 v[108:111], v[172:175], a[216:219], v[108:111]
 ds_read_b64 v[14:15], v16 offset:4432
 v_add_f32 v51, v51, v57
 v_mfma_f32_16x16x32_bf16 v[108:111], v[176:179], a[212:215], v[108:111]
 ds_read_b64 a[248:249], v16 offset:4360
 v_add_f32 v51, v51, v60
 v_mfma_f32_16x16x32_bf16 v[108:111], v[180:183], a[208:211], v[108:111]
 ds_read_b64 a[250:251], v16 offset:4368
 v_add_f32 v71, v71, v74
 v_mfma_f32_16x16x32_bf16 v[108:111], v[184:187], a[204:207], v[108:111]
 ds_bpermute_b32 v224, v19, v224
 v_add_f32 v75, v75, v78
 v_mfma_f32_16x16x32_bf16 v[108:111], v[188:191], a[200:203], v[108:111]
 ds_bpermute_b32 v225, v19, v225
 v_add_f32 v71, v71, v77
 v_mfma_f32_16x16x32_bf16 v[108:111], v[192:195], a[196:199], v[108:111]
 buffer_load_dwordx4 v1, s[12:15], s51 offen offset:3072 sc1 lds
 v_mfma_f32_16x16x32_bf16 v[108:111], v[196:199], a[192:195], v[108:111]
 s_waitcnt lgkmcnt(15)
 ds_bpermute_b32 v226, v19, v226
 v_cndmask_b32_e64 v240, v71, v55, vcc
 v_mfma_f32_16x16x32_bf16 v[112:115], v[160:163], a[44:47], 0
 ds_read_u16_d16_hi v228, v18 offset:128
 v_cndmask_b32_e64 v241, v75, v59, vcc
 v_mfma_f32_16x16x32_bf16 v[112:115], v[164:167], a[40:43], v[112:115]
 ds_read_u16_d16_hi v229, v18 offset:1280
 v_cndmask_b32_e64 v242, v79, v63, vcc
 v_mfma_f32_16x16x32_bf16 v[112:115], v[168:171], a[36:39], v[112:115]
 ds_read_u16_d16_hi v230, v18 offset:2432
 v_add_f32 v65, v65, v68
 v_mfma_f32_16x16x32_bf16 v[112:115], v[172:175], a[32:35], v[112:115]
 ds_read_u16_d16_hi v231, v18 offset:3584
 v_add_f32 v66, v66, v69
 v_mfma_f32_16x16x32_bf16 v[112:115], v[176:179], a[28:31], v[112:115]
 s_add_u32 m0, m0, 4096
 ds_bpermute_b32 v232, v19, v232
 v_add_f32 v67, v67, v70
 v_mfma_f32_16x16x32_bf16 v[112:115], v[180:183], a[24:27], v[112:115]
 s_add_u32 s51, s51, 4096
 ds_bpermute_b32 v233, v19, v233
 v_add_f32 v66, v66, v72
 v_mfma_f32_16x16x32_bf16 v[112:115], v[184:187], a[20:23], v[112:115]
 buffer_load_dwordx4 v1, s[12:15], s51 offen offset:0 sc1 lds
 v_mfma_f32_16x16x32_bf16 v[112:115], v[188:191], a[16:19], v[112:115]
 ds_bpermute_b32 v234, v19, v234
 v_add_f32 v67, v67, v73
 v_mfma_f32_16x16x32_bf16 v[112:115], v[192:195], a[12:15], v[112:115]
 ds_read_u16_d16_hi v236, v18 offset:256
 v_add_f32 v67, v67, v76
 v_mfma_f32_16x16x32_bf16 v[112:115], v[196:199], a[8:11], v[112:115]
 s_waitcnt lgkmcnt(9)
 v_add_f32 v32, v32, v224
 v_add_f32 v33, v33, v225
 v_mfma_f32_16x16x32_bf16 v[112:115], v[200:203], a[4:7], v[112:115]
 s_waitcnt lgkmcnt(7)
 v_add_f32 v34, v34, v226
 v_fmac_f32 v32, s31, v228
 v_mfma_f32_16x16x32_bf16 v[112:115], v[204:207], a[0:3], v[112:115]
 s_waitcnt lgkmcnt(5)
 v_fmac_f32 v33, s31, v229
 v_fmac_f32 v34, s31, v230
 v_mfma_f32_16x16x32_bf16 v[116:119], v[160:163], a[108:111], 0
 s_waitcnt lgkmcnt(4)
 v_fmac_f32 v35, s31, v231
 v_cvt_pk_bf16_f32 v32, v32, v33
 v_mfma_f32_16x16x32_bf16 v[116:119], v[164:167], a[104:107], v[116:119]
 ds_read_u16_d16_hi v237, v18 offset:1408
 v_cvt_pk_bf16_f32 v33, v34, v35
 v_mfma_f32_16x16x32_bf16 v[116:119], v[168:171], a[100:103], v[116:119]
 buffer_load_dwordx4 v1, s[12:15], s51 offen offset:1024 sc1 lds
 v_mfma_f32_16x16x32_bf16 v[116:119], v[172:175], a[96:99], v[116:119]
 buffer_store_dwordx2 v[32:33], v20, s[12:15], s34 offen offset:0 sc1
 v_mfma_f32_16x16x32_bf16 v[116:119], v[176:179], a[92:95], v[116:119]
 ds_read_u16_d16_hi v238, v18 offset:2560
 v_add_f32 v87, v87, v90
 v_mfma_f32_16x16x32_bf16 v[116:119], v[180:183], a[88:91], v[116:119]
 ds_read_u16_d16_hi v239, v18 offset:3712
 v_add_f32 v91, v91, v94
 v_mfma_f32_16x16x32_bf16 v[116:119], v[184:187], a[84:87], v[116:119]
 ds_bpermute_b32 v240, v19, v240
 v_add_f32 v87, v87, v93
 v_mfma_f32_16x16x32_bf16 v[116:119], v[188:191], a[80:83], v[116:119]
 ds_bpermute_b32 v241, v19, v241
 v_cndmask_b32_e64 v248, v87, v71, vcc
 v_mfma_f32_16x16x32_bf16 v[116:119], v[192:195], a[76:79], v[116:119]
 ds_bpermute_b32 v242, v19, v242
 v_cndmask_b32_e64 v249, v91, v75, vcc
 v_mfma_f32_16x16x32_bf16 v[116:119], v[196:199], a[72:75], v[116:119]
 ds_read_u16_d16_hi v244, v18 offset:384
 v_cndmask_b32_e64 v250, v95, v79, vcc
 v_mfma_f32_16x16x32_bf16 v[116:119], v[200:203], a[68:71], v[116:119]
 buffer_load_dwordx4 v1, s[12:15], s51 offen offset:2048 sc1 lds
 v_mfma_f32_16x16x32_bf16 v[116:119], v[204:207], a[64:67], v[116:119]
 s_waitcnt lgkmcnt(9)
 v_add_f32 v48, v48, v232
 v_add_f32 v49, v49, v233
 v_mfma_f32_16x16x32_bf16 v[120:123], v[160:163], a[172:175], 0
 s_waitcnt lgkmcnt(7)
 v_add_f32 v50, v50, v234
 v_fmac_f32 v48, s31, v236
 v_mfma_f32_16x16x32_bf16 v[120:123], v[164:167], a[168:171], v[120:123]
 s_waitcnt lgkmcnt(5)
 v_fmac_f32 v49, s31, v237
 v_fmac_f32 v50, s31, v238
 v_mfma_f32_16x16x32_bf16 v[120:123], v[168:171], a[164:167], v[120:123]
 s_waitcnt lgkmcnt(4)
 v_fmac_f32 v51, s31, v239
 v_cvt_pk_bf16_f32 v48, v48, v49
 v_mfma_f32_16x16x32_bf16 v[120:123], v[172:175], a[160:163], v[120:123]
 ds_read_u16_d16_hi v245, v18 offset:1536
 v_cvt_pk_bf16_f32 v49, v50, v51
 v_mfma_f32_16x16x32_bf16 v[120:123], v[176:179], a[156:159], v[120:123]
 buffer_store_dwordx2 v[48:49], v20, s[12:15], s34 offen offset:512 sc1
 v_mfma_f32_16x16x32_bf16 v[120:123], v[180:183], a[152:155], v[120:123]
 ds_read_u16_d16_hi v246, v18 offset:2688
 v_add_f32 v81, v81, v84
 v_mfma_f32_16x16x32_bf16 v[120:123], v[184:187], a[148:151], v[120:123]
 buffer_load_dwordx4 v1, s[12:15], s51 offen offset:3072 sc1 lds
 v_mfma_f32_16x16x32_bf16 v[120:123], v[188:191], a[144:147], v[120:123]
 ds_read_u16_d16_hi v247, v18 offset:3840
 v_add_f32 v82, v82, v85
 v_mfma_f32_16x16x32_bf16 v[120:123], v[192:195], a[140:143], v[120:123]
 ds_bpermute_b32 v248, v19, v248
 v_add_f32 v83, v83, v86
 v_mfma_f32_16x16x32_bf16 v[120:123], v[196:199], a[136:139], v[120:123]
 ds_bpermute_b32 v249, v19, v249
 v_add_f32 v82, v82, v88
 v_mfma_f32_16x16x32_bf16 v[120:123], v[200:203], a[132:135], v[120:123]
 ds_bpermute_b32 v250, v19, v250
 v_add_f32 v83, v83, v89
 v_mfma_f32_16x16x32_bf16 v[120:123], v[204:207], a[128:131], v[120:123]
 ds_read_u16_d16_hi v252, v18 offset:512
 v_add_f32 v83, v83, v92
 v_mfma_f32_16x16x32_bf16 v[124:127], v[160:163], a[236:239], 0
 s_add_u32 m0, m0, 4096
 ds_read_u16_d16_hi v253, v18 offset:1664
 v_add_f32 v103, v103, v106
 v_mfma_f32_16x16x32_bf16 v[124:127], v[164:167], a[232:235], v[124:127]
 s_waitcnt lgkmcnt(10)
 s_add_u32 s51, s51, 4096
 v_add_f32 v64, v64, v240
 v_add_f32 v65, v65, v241
 v_mfma_f32_16x16x32_bf16 v[124:127], v[168:171], a[228:231], v[124:127]
 buffer_load_dwordx4 v1, s[12:15], s51 offen offset:0 sc1 lds
 v_mfma_f32_16x16x32_bf16 v[124:127], v[172:175], a[224:227], v[124:127]
 s_waitcnt lgkmcnt(8)
 v_add_f32 v66, v66, v242
 v_fmac_f32 v64, s31, v244
 v_mfma_f32_16x16x32_bf16 v[124:127], v[176:179], a[220:223], v[124:127]
 s_waitcnt lgkmcnt(6)
 v_fmac_f32 v65, s31, v245
 v_fmac_f32 v66, s31, v246
 v_mfma_f32_16x16x32_bf16 v[124:127], v[180:183], a[216:219], v[124:127]
 s_waitcnt lgkmcnt(5)
 v_fmac_f32 v67, s31, v247
 v_cvt_pk_bf16_f32 v64, v64, v65
 v_mfma_f32_16x16x32_bf16 v[124:127], v[184:187], a[212:215], v[124:127]
 ds_read_u16_d16_hi v254, v18 offset:2816
 v_cvt_pk_bf16_f32 v65, v66, v67
 v_mfma_f32_16x16x32_bf16 v[124:127], v[188:191], a[208:211], v[124:127]
 buffer_store_dwordx2 v[64:65], v20, s[12:15], s34 offen offset:1024 sc1
 v_mfma_f32_16x16x32_bf16 v[124:127], v[192:195], a[204:207], v[124:127]
 ds_read_u16_d16_hi v255, v18 offset:3968
 v_add_f32 v107, v107, v110
 v_mfma_f32_16x16x32_bf16 v[124:127], v[196:199], a[200:203], v[124:127]
 v_add_f32 v103, v103, v109
 v_cndmask_b32_e64 v224, v103, v87, vcc
 v_mfma_f32_16x16x32_bf16 v[124:127], v[200:203], a[196:199], v[124:127]
 buffer_load_dwordx4 v1, s[12:15], s51 offen offset:1024 sc1 lds
 v_mfma_f32_16x16x32_bf16 v[124:127], v[204:207], a[192:195], v[124:127]
 v_cndmask_b32_e64 v225, v107, v91, vcc
 v_cndmask_b32_e64 v226, v111, v95, vcc
 v_mfma_f32_16x16x32_bf16 v[128:131], v[160:163], a[52:55], 0
 ds_bpermute_b32 v224, v19, v224
 v_add_f32 v97, v97, v100
 v_mfma_f32_16x16x32_bf16 v[128:131], v[164:167], a[48:51], v[128:131]
 ds_bpermute_b32 v225, v19, v225
 v_add_f32 v98, v98, v101
 v_mfma_f32_16x16x32_bf16 v[128:131], v[168:171], a[44:47], v[128:131]
 s_waitcnt lgkmcnt(7)
 v_add_f32 v80, v80, v248
 v_add_f32 v81, v81, v249
 v_mfma_f32_16x16x32_bf16 v[128:131], v[172:175], a[40:43], v[128:131]
 s_waitcnt lgkmcnt(5)
 v_add_f32 v82, v82, v250
 v_fmac_f32 v80, s31, v252
 v_mfma_f32_16x16x32_bf16 v[128:131], v[176:179], a[36:39], v[128:131]
 s_waitcnt lgkmcnt(3)
 v_fmac_f32 v81, s31, v253
 v_fmac_f32 v82, s31, v254
 v_mfma_f32_16x16x32_bf16 v[128:131], v[180:183], a[32:35], v[128:131]
 s_waitcnt lgkmcnt(2)
 v_fmac_f32 v83, s31, v255
 v_cvt_pk_bf16_f32 v80, v80, v81
 v_mfma_f32_16x16x32_bf16 v[128:131], v[184:187], a[28:31], v[128:131]
 buffer_load_dwordx4 v1, s[12:15], s51 offen offset:2048 sc1 lds
 v_mfma_f32_16x16x32_bf16 v[128:131], v[188:191], a[24:27], v[128:131]
 ds_bpermute_b32 v226, v19, v226
 v_cvt_pk_bf16_f32 v81, v82, v83
 v_mfma_f32_16x16x32_bf16 v[128:131], v[192:195], a[20:23], v[128:131]
 buffer_store_dwordx2 v[80:81], v20, s[12:15], s34 offen offset:1536 sc1
 v_mfma_f32_16x16x32_bf16 v[128:131], v[196:199], a[16:19], v[128:131]
 ds_read_u16_d16_hi v228, v18 offset:640
 v_add_f32 v99, v99, v102
 v_mfma_f32_16x16x32_bf16 v[128:131], v[200:203], a[12:15], v[128:131]
 ds_read_u16_d16_hi v229, v18 offset:1792
 v_add_f32 v98, v98, v104
 v_mfma_f32_16x16x32_bf16 v[128:131], v[204:207], a[8:11], v[128:131]
 ds_read_u16_d16_hi v230, v18 offset:2944
 v_add_f32 v99, v99, v105
 v_mfma_f32_16x16x32_bf16 v[128:131], v[208:211], a[4:7], v[128:131]
 ds_read_u16_d16_hi v231, v18 offset:4096
 v_add_f32 v99, v99, v108
 v_mfma_f32_16x16x32_bf16 v[128:131], v[212:215], a[0:3], v[128:131]
 v_add_f32 v119, v119, v122
 v_add_f32 v123, v123, v126
 v_mfma_f32_16x16x32_bf16 v[132:135], v[160:163], a[116:119], 0
 buffer_load_dwordx4 v1, s[12:15], s51 offen offset:3072 sc1 lds
 v_mfma_f32_16x16x32_bf16 v[132:135], v[164:167], a[112:115], v[132:135]
 v_add_f32 v119, v119, v125
 v_cndmask_b32_e64 v232, v119, v103, vcc
 v_mfma_f32_16x16x32_bf16 v[132:135], v[168:171], a[108:111], v[132:135]
 v_cndmask_b32_e64 v233, v123, v107, vcc
 v_cndmask_b32_e64 v234, v127, v111, vcc
 v_mfma_f32_16x16x32_bf16 v[132:135], v[172:175], a[104:107], v[132:135]
 ds_bpermute_b32 v232, v19, v232
 v_add_f32 v113, v113, v116
 v_mfma_f32_16x16x32_bf16 v[132:135], v[176:179], a[100:103], v[132:135]
 s_waitcnt lgkmcnt(6)
 v_add_f32 v96, v96, v224
 v_add_f32 v97, v97, v225
 v_mfma_f32_16x16x32_bf16 v[132:135], v[180:183], a[96:99], v[132:135]
 s_waitcnt lgkmcnt(4)
 v_add_f32 v98, v98, v226
 v_fmac_f32 v96, s31, v228
 v_mfma_f32_16x16x32_bf16 v[132:135], v[184:187], a[92:95], v[132:135]
 s_waitcnt lgkmcnt(2)
 s_add_u32 m0, m0, 4096
 v_fmac_f32 v97, s31, v229
 v_fmac_f32 v98, s31, v230
 v_mfma_f32_16x16x32_bf16 v[132:135], v[188:191], a[88:91], v[132:135]
 s_waitcnt lgkmcnt(1)
 s_add_u32 s51, s51, 4096
 v_fmac_f32 v99, s31, v231
 v_cvt_pk_bf16_f32 v96, v96, v97
 v_mfma_f32_16x16x32_bf16 v[132:135], v[192:195], a[84:87], v[132:135]
 buffer_load_dwordx4 v1, s[12:15], s51 offen offset:0 sc1 lds
 v_mfma_f32_16x16x32_bf16 v[132:135], v[196:199], a[80:83], v[132:135]
 ds_bpermute_b32 v233, v19, v233
 v_cvt_pk_bf16_f32 v97, v98, v99
 v_mfma_f32_16x16x32_bf16 v[132:135], v[200:203], a[76:79], v[132:135]
 buffer_store_dwordx2 v[96:97], v20, s[12:15], s34 offen offset:2048 sc1
 v_mfma_f32_16x16x32_bf16 v[132:135], v[204:207], a[72:75], v[132:135]
 ds_bpermute_b32 v234, v19, v234
 v_add_f32 v114, v114, v117
 v_mfma_f32_16x16x32_bf16 v[132:135], v[208:211], a[68:71], v[132:135]
 ds_read_u16_d16_hi v236, v18 offset:768
 v_add_f32 v115, v115, v118
 v_mfma_f32_16x16x32_bf16 v[132:135], v[212:215], a[64:67], v[132:135]
 ds_read_u16_d16_hi v237, v18 offset:1920
 v_add_f32 v114, v114, v120
 v_mfma_f32_16x16x32_bf16 v[136:139], v[160:163], a[180:183], 0
 ds_read_u16_d16_hi v238, v18 offset:3072
 v_add_f32 v115, v115, v121
 v_mfma_f32_16x16x32_bf16 v[136:139], v[164:167], a[176:179], v[136:139]
 ds_read_u16_d16_hi v239, v18 offset:4224
 v_add_f32 v115, v115, v124
 v_mfma_f32_16x16x32_bf16 v[136:139], v[168:171], a[172:175], v[136:139]
 buffer_load_dwordx4 v1, s[12:15], s51 offen offset:1024 sc1 lds
 v_mfma_f32_16x16x32_bf16 v[136:139], v[172:175], a[168:171], v[136:139]
 buffer_load_dwordx4 v[48:51], v7, s[16:19], s46 offen offset:0
 v_mfma_f32_16x16x32_bf16 v[136:139], v[176:179], a[164:167], v[136:139]
 v_mfma_f32_16x16x32_bf16 v[136:139], v[180:183], a[160:163], v[136:139]
 v_mfma_f32_16x16x32_bf16 v[136:139], v[184:187], a[156:159], v[136:139]
 v_mfma_f32_16x16x32_bf16 v[136:139], v[188:191], a[152:155], v[136:139]
 s_waitcnt lgkmcnt(5)
 v_add_f32 v112, v112, v232
 v_add_f32 v113, v113, v233
 v_mfma_f32_16x16x32_bf16 v[136:139], v[192:195], a[148:151], v[136:139]
 s_waitcnt lgkmcnt(3)
 v_add_f32 v114, v114, v234
 v_fmac_f32 v112, s31, v236
 v_mfma_f32_16x16x32_bf16 v[136:139], v[196:199], a[144:147], v[136:139]
 s_waitcnt lgkmcnt(1)
 v_fmac_f32 v113, s31, v237
 v_fmac_f32 v114, s31, v238
 v_mfma_f32_16x16x32_bf16 v[136:139], v[200:203], a[140:143], v[136:139]
 buffer_load_dwordx4 v1, s[12:15], s51 offen offset:2048 sc1 lds
 v_mfma_f32_16x16x32_bf16 v[136:139], v[204:207], a[136:139], v[136:139]
 s_waitcnt lgkmcnt(0)
 v_fmac_f32 v115, s31, v239
 v_cvt_pk_bf16_f32 v112, v112, v113
 v_mfma_f32_16x16x32_bf16 v[136:139], v[208:211], a[132:135], v[136:139]
 v_cvt_pk_bf16_f32 v113, v114, v115
 v_mfma_f32_16x16x32_bf16 v[136:139], v[212:215], a[128:131], v[136:139]
 buffer_store_dwordx2 v[112:113], v20, s[12:15], s34 offen offset:2560 sc1
 v_mfma_f32_16x16x32_bf16 v[140:143], v[160:163], a[244:247], 0
 v_mfma_f32_16x16x32_bf16 v[140:143], v[164:167], a[240:243], v[140:143]
 buffer_load_dwordx4 v[52:55], v7, s[16:19], s46 offen offset:64
 v_mfma_f32_16x16x32_bf16 v[140:143], v[168:171], a[236:239], v[140:143]
 v_mfma_f32_16x16x32_bf16 v[140:143], v[172:175], a[232:235], v[140:143]
 v_mfma_f32_16x16x32_bf16 v[140:143], v[176:179], a[228:231], v[140:143]
 buffer_load_dwordx4 v1, s[12:15], s51 offen offset:3072 sc1 lds
 v_mfma_f32_16x16x32_bf16 v[140:143], v[180:183], a[224:227], v[140:143]
 v_mfma_f32_16x16x32_bf16 v[140:143], v[184:187], a[220:223], v[140:143]
 v_mfma_f32_16x16x32_bf16 v[140:143], v[188:191], a[216:219], v[140:143]
 v_mfma_f32_16x16x32_bf16 v[140:143], v[192:195], a[212:215], v[140:143]
 v_mfma_f32_16x16x32_bf16 v[140:143], v[196:199], a[208:211], v[140:143]
 v_mfma_f32_16x16x32_bf16 v[140:143], v[200:203], a[204:207], v[140:143]
 v_mfma_f32_16x16x32_bf16 v[140:143], v[204:207], a[200:203], v[140:143]
 v_mfma_f32_16x16x32_bf16 v[140:143], v[208:211], a[196:199], v[140:143]
 v_mfma_f32_16x16x32_bf16 v[140:143], v[212:215], a[192:195], v[140:143]
 buffer_load_dwordx4 v[56:59], v7, s[16:19], s54 offen offset:0
 v_mfma_f32_16x16x32_bf16 v[144:147], v[160:163], a[60:63], 0
 v_mfma_f32_16x16x32_bf16 v[144:147], v[164:167], a[56:59], v[144:147]
 v_mfma_f32_16x16x32_bf16 v[144:147], v[168:171], a[52:55], v[144:147]
 v_mfma_f32_16x16x32_bf16 v[144:147], v[172:175], a[48:51], v[144:147]
 v_mfma_f32_16x16x32_bf16 v[144:147], v[176:179], a[44:47], v[144:147]
 v_mfma_f32_16x16x32_bf16 v[144:147], v[180:183], a[40:43], v[144:147]
 v_mfma_f32_16x16x32_bf16 v[144:147], v[184:187], a[36:39], v[144:147]
 v_mfma_f32_16x16x32_bf16 v[144:147], v[188:191], a[32:35], v[144:147]
 v_add_f32 v135, v135, v138
 v_add_f32 v139, v139, v142
 v_mfma_f32_16x16x32_bf16 v[144:147], v[192:195], a[28:31], v[144:147]
 v_add_f32 v135, v135, v141
 v_cndmask_b32_e64 v240, v135, v119, vcc
 v_mfma_f32_16x16x32_bf16 v[144:147], v[196:199], a[24:27], v[144:147]
 v_cndmask_b32_e64 v241, v139, v123, vcc
 v_cndmask_b32_e64 v242, v143, v127, vcc
 v_mfma_f32_16x16x32_bf16 v[144:147], v[200:203], a[20:23], v[144:147]
 ds_bpermute_b32 v240, v19, v240
 v_add_f32 v129, v129, v132
 v_mfma_f32_16x16x32_bf16 v[144:147], v[204:207], a[16:19], v[144:147]
 ds_bpermute_b32 v241, v19, v241
 v_add_f32 v130, v130, v133
 v_mfma_f32_16x16x32_bf16 v[144:147], v[208:211], a[12:15], v[144:147]
 ds_bpermute_b32 v242, v19, v242
 v_add_f32 v131, v131, v134
 v_mfma_f32_16x16x32_bf16 v[144:147], v[212:215], a[8:11], v[144:147]
 ds_read_u16_d16_hi v244, v18 offset:896
 v_add_f32 v130, v130, v136
 v_mfma_f32_16x16x32_bf16 v[144:147], v[216:219], a[4:7], v[144:147]
 ds_read_u16_d16_hi v245, v18 offset:2048
 v_add_f32 v131, v131, v137
 v_mfma_f32_16x16x32_bf16 v[144:147], v[220:223], a[0:3], v[144:147]
 ds_read_u16_d16_hi v246, v18 offset:3200
 v_add_f32 v131, v131, v140
 v_mfma_f32_16x16x32_bf16 v[148:151], v[160:163], a[124:127], 0
 ds_read_u16_d16_hi v247, v18 offset:4352
 v_mfma_f32_16x16x32_bf16 v[148:151], v[164:167], a[120:123], v[148:151]
 buffer_load_dwordx4 v[60:63], v7, s[16:19], s54 offen offset:64
 v_mfma_f32_16x16x32_bf16 v[148:151], v[168:171], a[116:119], v[148:151]
 v_mfma_f32_16x16x32_bf16 v[148:151], v[172:175], a[112:115], v[148:151]
 v_mfma_f32_16x16x32_bf16 v[148:151], v[176:179], a[108:111], v[148:151]
 v_mfma_f32_16x16x32_bf16 v[148:151], v[180:183], a[104:107], v[148:151]
 v_mfma_f32_16x16x32_bf16 v[148:151], v[184:187], a[100:103], v[148:151]
 s_waitcnt lgkmcnt(5)
 v_add_f32 v128, v128, v240
 v_add_f32 v129, v129, v241
 v_mfma_f32_16x16x32_bf16 v[148:151], v[188:191], a[96:99], v[148:151]
 s_waitcnt lgkmcnt(3)
 v_add_f32 v130, v130, v242
 v_fmac_f32 v128, s31, v244
 v_mfma_f32_16x16x32_bf16 v[148:151], v[192:195], a[92:95], v[148:151]
 buffer_load_dword v23, v11, s[12:15], s45 offen sc1
 v_mfma_f32_16x16x32_bf16 v[148:151], v[196:199], a[88:91], v[148:151]
 s_waitcnt lgkmcnt(1)
 v_fmac_f32 v129, s31, v245
 v_fmac_f32 v130, s31, v246
 v_mfma_f32_16x16x32_bf16 v[148:151], v[200:203], a[84:87], v[148:151]
 s_waitcnt lgkmcnt(0)
 v_fmac_f32 v131, s31, v247
 v_cvt_pk_bf16_f32 v128, v128, v129
 v_mfma_f32_16x16x32_bf16 v[148:151], v[204:207], a[80:83], v[148:151]
 v_cvt_pk_bf16_f32 v129, v130, v131
 v_mfma_f32_16x16x32_bf16 v[148:151], v[208:211], a[76:79], v[148:151]
 buffer_store_dwordx2 v[128:129], v20, s[12:15], s34 offen offset:3072 sc1
 v_mfma_f32_16x16x32_bf16 v[148:151], v[212:215], a[72:75], v[148:151]
 v_mfma_f32_16x16x32_bf16 v[148:151], v[216:219], a[68:71], v[148:151]
 v_mfma_f32_16x16x32_bf16 v[148:151], v[220:223], a[64:67], v[148:151]
 v_mfma_f32_16x16x32_bf16 v[152:155], v[160:163], a[188:191], 0
 v_mfma_f32_16x16x32_bf16 v[152:155], v[164:167], a[184:187], v[152:155]
 v_mfma_f32_16x16x32_bf16 v[152:155], v[168:171], a[180:183], v[152:155]
 v_mfma_f32_16x16x32_bf16 v[152:155], v[172:175], a[176:179], v[152:155]
 v_mfma_f32_16x16x32_bf16 v[152:155], v[176:179], a[172:175], v[152:155]
 v_mfma_f32_16x16x32_bf16 v[152:155], v[180:183], a[168:171], v[152:155]
 v_mfma_f32_16x16x32_bf16 v[152:155], v[184:187], a[164:167], v[152:155]
 v_mfma_f32_16x16x32_bf16 v[152:155], v[188:191], a[160:163], v[152:155]
 v_mfma_f32_16x16x32_bf16 v[152:155], v[192:195], a[156:159], v[152:155]
 v_mfma_f32_16x16x32_bf16 v[152:155], v[196:199], a[152:155], v[152:155]
 v_mfma_f32_16x16x32_bf16 v[152:155], v[200:203], a[148:151], v[152:155]
 v_mfma_f32_16x16x32_bf16 v[152:155], v[204:207], a[144:147], v[152:155]
 v_mfma_f32_16x16x32_bf16 v[152:155], v[208:211], a[140:143], v[152:155]
 v_mfma_f32_16x16x32_bf16 v[152:155], v[212:215], a[136:139], v[152:155]
 v_mfma_f32_16x16x32_bf16 v[152:155], v[216:219], a[132:135], v[152:155]
 v_mfma_f32_16x16x32_bf16 v[152:155], v[220:223], a[128:131], v[152:155]
 v_mfma_f32_16x16x32_bf16 v[156:159], v[160:163], v[12:15], 0
 v_mfma_f32_16x16x32_bf16 v[156:159], v[164:167], a[248:251], v[156:159]
 v_mfma_f32_16x16x32_bf16 v[156:159], v[168:171], a[244:247], v[156:159]
 v_mfma_f32_16x16x32_bf16 v[156:159], v[172:175], a[240:243], v[156:159]
 v_mfma_f32_16x16x32_bf16 v[156:159], v[176:179], a[236:239], v[156:159]
 v_mfma_f32_16x16x32_bf16 v[156:159], v[180:183], a[232:235], v[156:159]
 v_mfma_f32_16x16x32_bf16 v[156:159], v[184:187], a[228:231], v[156:159]
 v_mfma_f32_16x16x32_bf16 v[156:159], v[188:191], a[224:227], v[156:159]
 v_mfma_f32_16x16x32_bf16 v[156:159], v[192:195], a[220:223], v[156:159]
 v_mfma_f32_16x16x32_bf16 v[156:159], v[196:199], a[216:219], v[156:159]
 v_mfma_f32_16x16x32_bf16 v[156:159], v[200:203], a[212:215], v[156:159]
 v_mfma_f32_16x16x32_bf16 v[156:159], v[204:207], a[208:211], v[156:159]
 v_mfma_f32_16x16x32_bf16 v[156:159], v[208:211], a[204:207], v[156:159]
 v_mfma_f32_16x16x32_bf16 v[156:159], v[212:215], a[200:203], v[156:159]
 v_mfma_f32_16x16x32_bf16 v[156:159], v[216:219], a[196:199], v[156:159]
 v_mfma_f32_16x16x32_bf16 v[156:159], v[220:223], a[192:195], v[156:159]
 s_nop 7
 v_add_f32 v151, v151, v154
 v_add_f32 v155, v155, v158
 v_add_f32 v151, v151, v157
 v_cndmask_b32_e64 v248, v151, v135, vcc
 v_cndmask_b32_e64 v249, v155, v139, vcc
 v_cndmask_b32_e64 v250, v159, v143, vcc
 ds_bpermute_b32 v248, v19, v248
 ds_bpermute_b32 v249, v19, v249
 ds_bpermute_b32 v250, v19, v250
 ds_read_u16_d16_hi v252, v18 offset:1024
 ds_read_u16_d16_hi v253, v18 offset:2176
 ds_read_u16_d16_hi v254, v18 offset:3328
 ds_read_u16_d16_hi v255, v18 offset:4480
 v_add_f32 v145, v145, v148
 v_add_f32 v146, v146, v149
 v_add_f32 v147, v147, v150
 v_add_f32 v146, v146, v152
 v_add_f32 v147, v147, v153
 v_add_f32 v147, v147, v156
 s_waitcnt lgkmcnt(0)
 v_add_f32 v144, v144, v248
 v_add_f32 v145, v145, v249
 v_add_f32 v146, v146, v250
 v_fmac_f32 v144, s31, v252
 v_fmac_f32 v145, s31, v253
 v_fmac_f32 v146, s31, v254
 v_fmac_f32 v147, s31, v255
 v_cvt_pk_bf16_f32 v144, v144, v145
 v_cvt_pk_bf16_f32 v145, v146, v147
 buffer_store_dwordx2 v[144:145], v20, s[12:15], s34 offen offset:3584 sc1
 s_waitcnt vmcnt(2)
 v_cmp_ne_u32 vcc, 0, v23
 s_cmp_eq_u64 vcc, 0
 s_cselect_b32 s50, 1, 0
 s_cselect_b32 s51, s39, 2.0
 ds_read_b128 a[64:67], v9 offset:0
 ds_read_b128 a[68:71], v9 offset:1024
 ds_read_b128 a[72:75], v9 offset:2048
 ds_read_b128 a[76:79], v9 offset:3072
 ds_read_b128 a[80:83], v9 offset:4096
 ds_read_b128 a[84:87], v9 offset:5120
 ds_read_b128 a[88:91], v9 offset:6144
 ds_read_b128 a[92:95], v9 offset:7168
 ds_read_b128 a[96:99], v9 offset:8192
 ds_read_b128 a[100:103], v9 offset:9216
 ds_read_b128 a[104:107], v9 offset:10240
 ds_read_b128 a[108:111], v9 offset:11264
 ds_read_b128 a[112:115], v9 offset:12288
 ds_read_b128 a[116:119], v9 offset:13312
 ds_read_b128 a[120:123], v9 offset:14336
 ds_read_b128 a[124:127], v9 offset:15360
 s_waitcnt lgkmcnt(15)
 v_mfma_f32_16x16x32_bf16 v[40:43], v[24:27], a[64:67], 0
 v_mfma_f32_16x16x32_bf16 v[44:47], v[28:31], a[64:67], 0
 s_waitcnt lgkmcnt(14)
 v_mfma_f32_16x16x32_bf16 v[40:43], v[24:27], a[68:71], v[40:43]
 v_mfma_f32_16x16x32_bf16 v[44:47], v[28:31], a[68:71], v[44:47]
 s_waitcnt lgkmcnt(13)
 v_mfma_f32_16x16x32_bf16 v[40:43], v[24:27], a[72:75], v[40:43]
 v_mfma_f32_16x16x32_bf16 v[44:47], v[28:31], a[72:75], v[44:47]
 s_waitcnt lgkmcnt(12)
 v_mfma_f32_16x16x32_bf16 v[40:43], v[24:27], a[76:79], v[40:43]
 v_mfma_f32_16x16x32_bf16 v[44:47], v[28:31], a[76:79], v[44:47]
 s_waitcnt lgkmcnt(11)
 v_mfma_f32_16x16x32_bf16 v[40:43], v[24:27], a[80:83], v[40:43]
 v_mfma_f32_16x16x32_bf16 v[44:47], v[28:31], a[80:83], v[44:47]
 s_waitcnt lgkmcnt(10)
 v_mfma_f32_16x16x32_bf16 v[40:43], v[24:27], a[84:87], v[40:43]
 v_mfma_f32_16x16x32_bf16 v[44:47], v[28:31], a[84:87], v[44:47]
 s_waitcnt lgkmcnt(9)
 v_mfma_f32_16x16x32_bf16 v[40:43], v[24:27], a[88:91], v[40:43]
 v_mfma_f32_16x16x32_bf16 v[44:47], v[28:31], a[88:91], v[44:47]
 s_waitcnt lgkmcnt(8)
 v_mfma_f32_16x16x32_bf16 v[40:43], v[24:27], a[92:95], v[40:43]
 v_mfma_f32_16x16x32_bf16 v[44:47], v[28:31], a[92:95], v[44:47]
 s_waitcnt lgkmcnt(7)
 v_mfma_f32_16x16x32_bf16 v[40:43], v[24:27], a[96:99], v[40:43]
 v_mfma_f32_16x16x32_bf16 v[44:47], v[28:31], a[96:99], v[44:47]
 s_waitcnt lgkmcnt(6)
 v_mfma_f32_16x16x32_bf16 v[40:43], v[24:27], a[100:103], v[40:43]
 v_mfma_f32_16x16x32_bf16 v[44:47], v[28:31], a[100:103], v[44:47]
 s_waitcnt lgkmcnt(5)
 v_mfma_f32_16x16x32_bf16 v[40:43], v[24:27], a[104:107], v[40:43]
 v_mfma_f32_16x16x32_bf16 v[44:47], v[28:31], a[104:107], v[44:47]
 s_waitcnt lgkmcnt(4)
 v_mfma_f32_16x16x32_bf16 v[40:43], v[24:27], a[108:111], v[40:43]
 v_mfma_f32_16x16x32_bf16 v[44:47], v[28:31], a[108:111], v[44:47]
 s_waitcnt lgkmcnt(3)
 v_mfma_f32_16x16x32_bf16 v[40:43], v[24:27], a[112:115], v[40:43]
 v_mfma_f32_16x16x32_bf16 v[44:47], v[28:31], a[112:115], v[44:47]
 s_waitcnt lgkmcnt(2)
 v_mfma_f32_16x16x32_bf16 v[40:43], v[24:27], a[116:119], v[40:43]
 v_mfma_f32_16x16x32_bf16 v[44:47], v[28:31], a[116:119], v[44:47]
 s_waitcnt lgkmcnt(1)
 v_mfma_f32_16x16x32_bf16 v[40:43], v[24:27], a[120:123], v[40:43]
 v_mfma_f32_16x16x32_bf16 v[44:47], v[28:31], a[120:123], v[44:47]
 s_waitcnt lgkmcnt(0)
 v_mfma_f32_16x16x32_bf16 v[40:43], v[24:27], a[124:127], v[40:43]
 v_mfma_f32_16x16x32_bf16 v[44:47], v[28:31], a[124:127], v[44:47]
 s_waitcnt vmcnt(0)
 s_barrier
 buffer_store_dword v21, v21, s[12:15], s93 offen sc1
 s_cmp_eq_u32 s49, 1
 s_cbranch_scc1 L_havesh
 s_add_u32 s48, s44, 64
 s_mov_b32 s47, s51
 v_and_b32 v16, 15, v0
 v_lshlrev_b32 v16, 2, v16
 s_mov_b32 s32, 0
L_poll9:
 buffer_load_dword v17, v16, s[12:15], s48 offen sc1
 s_waitcnt vmcnt(0)
 v_cmp_ne_u32 vcc, 0, v17
 s_cbranch_vccz L_poll9_ok
 s_sleep 6
 s_add_u32 s32, s32, 1
 s_cmp_lt_u32 s32, 0x80000
 s_cbranch_scc1 L_poll9
L_poll9_ok:
 s_mov_b32 s51, s37
 s_lshl_b32 m0, s3, 14
 s_nop 0
 buffer_load_dwordx4 v1, s[12:15], s51 offen offset:0 sc1 lds
 s_nop 0
 buffer_load_dwordx4 v1, s[12:15], s51 offen offset:1024 sc1 lds
 s_nop 0
 buffer_load_dwordx4 v1, s[12:15], s51 offen offset:2048 sc1 lds
 s_nop 0
 buffer_load_dwordx4 v1, s[12:15], s51 offen offset:3072 sc1 lds
 s_add_u32 m0, m0, 4096
 s_add_u32 s51, s51, 4096
 s_nop 0
 buffer_load_dwordx4 v1, s[12:15], s51 offen offset:0 sc1 lds
 s_nop 0
 buffer_load_dwordx4 v1, s[12:15], s51 offen offset:1024 sc1 lds
 s_nop 0
 buffer_load_dwordx4 v1, s[12:15], s51 offen offset:2048 sc1 lds
 s_nop 0
 buffer_load_dwordx4 v1, s[12:15], s51 offen offset:3072 sc1 lds
 s_add_u32 m0, m0, 4096
 s_add_u32 s51, s51, 4096
 s_nop 0
 buffer_load_dwordx4 v1, s[12:15], s51 offen offset:0 sc1 lds
 s_nop 0
 buffer_load_dwordx4 v1, s[12:15], s51 offen offset:1024 sc1 lds
 s_nop 0
 buffer_load_dwordx4 v1, s[12:15], s51 offen offset:2048 sc1 lds
 s_nop 0
 buffer_load_dwordx4 v1, s[12:15], s51 offen offset:3072 sc1 lds
 s_add_u32 m0, m0, 4096
 s_add_u32 s51, s51, 4096
 s_nop 0
 buffer_load_dwordx4 v1, s[12:15], s51 offen offset:0 sc1 lds
 s_nop 0
 buffer_load_dwordx4 v1, s[12:15], s51 offen offset:1024 sc1 lds
 s_nop 0
 buffer_load_dwordx4 v1, s[12:15], s51 offen offset:2048 sc1 lds
 s_nop 0
 buffer_load_dwordx4 v1, s[12:15], s51 offen offset:3072 sc1 lds
 s_mov_b32 s51, s47
 s_waitcnt vmcnt(0)
 ds_read_b128 a[64:67], v9 offset:0
 ds_read_b128 a[68:71], v9 offset:1024
 ds_read_b128 a[72:75], v9 offset:2048
 ds_read_b128 a[76:79], v9 offset:3072
 ds_read_b128 a[80:83], v9 offset:4096
 ds_read_b128 a[84:87], v9 offset:5120
 ds_read_b128 a[88:91], v9 offset:6144
 ds_read_b128 a[92:95], v9 offset:7168
 ds_read_b128 a[96:99], v9 offset:8192
 ds_read_b128 a[100:103], v9 offset:9216
 ds_read_b128 a[104:107], v9 offset:10240
 ds_read_b128 a[108:111], v9 offset:11264
 ds_read_b128 a[112:115], v9 offset:12288
 ds_read_b128 a[116:119], v9 offset:13312
 ds_read_b128 a[120:123], v9 offset:14336
 ds_read_b128 a[124:127], v9 offset:15360
 s_waitcnt lgkmcnt(15)
 v_mfma_f32_16x16x32_bf16 v[40:43], v[24:27], a[64:67], 0
 v_mfma_f32_16x16x32_bf16 v[44:47], v[28:31], a[64:67], 0
 s_waitcnt lgkmcnt(14)
 v_mfma_f32_16x16x32_bf16 v[40:43], v[24:27], a[68:71], v[40:43]
 v_mfma_f32_16x16x32_bf16 v[44:47], v[28:31], a[68:71], v[44:47]
 s_waitcnt lgkmcnt(13)
 v_mfma_f32_16x16x32_bf16 v[40:43], v[24:27], a[72:75], v[40:43]
 v_mfma_f32_16x16x32_bf16 v[44:47], v[28:31], a[72:75], v[44:47]
 s_waitcnt lgkmcnt(12)
 v_mfma_f32_16x16x32_bf16 v[40:43], v[24:27], a[76:79], v[40:43]
 v_mfma_f32_16x16x32_bf16 v[44:47], v[28:31], a[76:79], v[44:47]
 s_waitcnt lgkmcnt(11)
 v_mfma_f32_16x16x32_bf16 v[40:43], v[24:27], a[80:83], v[40:43]
 v_mfma_f32_16x16x32_bf16 v[44:47], v[28:31], a[80:83], v[44:47]
 s_waitcnt lgkmcnt(10)
 v_mfma_f32_16x16x32_bf16 v[40:43], v[24:27], a[84:87], v[40:43]
 v_mfma_f32_16x16x32_bf16 v[44:47], v[28:31], a[84:87], v[44:47]
 s_waitcnt lgkmcnt(9)
 v_mfma_f32_16x16x32_bf16 v[40:43], v[24:27], a[88:91], v[40:43]
 v_mfma_f32_16x16x32_bf16 v[44:47], v[28:31], a[88:91], v[44:47]
 s_waitcnt lgkmcnt(8)
 v_mfma_f32_16x16x32_bf16 v[40:43], v[24:27], a[92:95], v[40:43]
 v_mfma_f32_16x16x32_bf16 v[44:47], v[28:31], a[92:95], v[44:47]
 s_waitcnt lgkmcnt(7)
 v_mfma_f32_16x16x32_bf16 v[40:43], v[24:27], a[96:99], v[40:43]
 v_mfma_f32_16x16x32_bf16 v[44:47], v[28:31], a[96:99], v[44:47]
 s_waitcnt lgkmcnt(6)
 v_mfma_f32_16x16x32_bf16 v[40:43], v[24:27], a[100:103], v[40:43]
 v_mfma_f32_16x16x32_bf16 v[44:47], v[28:31], a[100:103], v[44:47]
 s_waitcnt lgkmcnt(5)
 v_mfma_f32_16x16x32_bf16 v[40:43], v[24:27], a[104:107], v[40:43]
 v_mfma_f32_16x16x32_bf16 v[44:47], v[28:31], a[104:107], v[44:47]
 s_waitcnt lgkmcnt(4)
 v_mfma_f32_16x16x32_bf16 v[40:43], v[24:27], a[108:111], v[40:43]
 v_mfma_f32_16x16x32_bf16 v[44:47], v[28:31], a[108:111], v[44:47]
 s_waitcnt lgkmcnt(3)
 v_mfma_f32_16x16x32_bf16 v[40:43], v[24:27], a[112:115], v[40:43]
 v_mfma_f32_16x16x32_bf16 v[44:47], v[28:31], a[112:115], v[44:47]
 s_waitcnt lgkmcnt(2)
 v_mfma_f32_16x16x32_bf16 v[40:43], v[24:27], a[116:119], v[40:43]
 v_mfma_f32_16x16x32_bf16 v[44:47], v[28:31], a[116:119], v[44:47]
 s_waitcnt lgkmcnt(1)
 v_mfma_f32_16x16x32_bf16 v[40:43], v[24:27], a[120:123], v[40:43]
 v_mfma_f32_16x16x32_bf16 v[44:47], v[28:31], a[120:123], v[44:47]
 s_waitcnt lgkmcnt(0)
 v_mfma_f32_16x16x32_bf16 v[40:43], v[24:27], a[124:127], v[40:43]
 v_mfma_f32_16x16x32_bf16 v[44:47], v[28:31], a[124:127], v[44:47]
 s_nop 4
L_havesh:
 s_nop 2
 v_cvt_pk_bf16_f32 v40, v40, v41
 v_cvt_pk_bf16_f32 v41, v42, v43
 v_cvt_pk_bf16_f32 v42, v44, v45
 v_cvt_pk_bf16_f32 v43, v46, v47
 buffer_store_dwordx4 v[40:43], v2, s[8:11], s36 offen offset:0
 s_mov_b32 s51, s39
 s_cmp_lg_u32 s3, 0
 s_cmov_b32 s50, 1
 s_cmp_eq_u32 s50, 1
 s_cbranch_scc1 L_havelong
 v_and_b32 v16, 15, v0
 v_lshlrev_b32 v16, 2, v16
 s_mov_b32 s32, 0
L_poll10:
 buffer_load_dword v17, v16, s[12:15], s45 offen sc1
 s_waitcnt vmcnt(0)
 v_cmp_ne_u32 vcc, 0, v17
 s_cbranch_vccz L_poll10_ok
 s_sleep 6
 s_add_u32 s32, s32, 1
 s_cmp_lt_u32 s32, 0x80000
 s_cbranch_scc1 L_poll10
L_poll10_ok:
 s_mov_b32 s51, s39
L_havelong:
 s_barrier
 buffer_load_dwordx4 a[0:3], v1, s[12:15], s51 offen offset:0 sc1
 buffer_load_dwordx4 a[4:7], v1, s[12:15], s51 offen offset:1024 sc1
 buffer_load_dwordx4 a[8:11], v1, s[12:15], s51 offen offset:2048 sc1
 buffer_load_dwordx4 a[12:15], v1, s[12:15], s51 offen offset:3072 sc1
 s_add_u32 s51, s51, 4096
 buffer_load_dwordx4 a[16:19], v1, s[12:15], s51 offen offset:0 sc1
 buffer_load_dwordx4 a[20:23], v1, s[12:15], s51 offen offset:1024 sc1
 buffer_load_dwordx4 a[24:27], v1, s[12:15], s51 offen offset:2048 sc1
 buffer_load_dwordx4 a[28:31], v1, s[12:15], s51 offen offset:3072 sc1
 s_add_u32 s51, s51, 4096
 buffer_load_dwordx4 a[32:35], v1, s[12:15], s51 offen offset:0 sc1
 buffer_load_dwordx4 a[36:39], v1, s[12:15], s51 offen offset:1024 sc1
 buffer_load_dwordx4 a[40:43], v1, s[12:15], s51 offen offset:2048 sc1
 buffer_load_dwordx4 a[44:47], v1, s[12:15], s51 offen offset:3072 sc1
 s_add_u32 s51, s51, 4096
 buffer_load_dword v23, v11, s[12:15], s43 offen sc1
 buffer_load_dwordx4 a[48:51], v1, s[12:15], s51 offen offset:0 sc1
 buffer_load_dwordx4 a[52:55], v1, s[12:15], s51 offen offset:1024 sc1
 buffer_load_dwordx4 a[56:59], v1, s[12:15], s51 offen offset:2048 sc1
 buffer_load_dwordx4 a[60:63], v1, s[12:15], s51 offen offset:3072 sc1
 s_add_u32 s51, s51, 4096
 s_waitcnt vmcnt(16)
 v_mfma_f32_16x16x32_bf16 v[32:35], v[24:27], a[0:3], 0
 v_mfma_f32_16x16x32_bf16 v[36:39], v[28:31], a[0:3], 0
 s_waitcnt vmcnt(15)
 v_mfma_f32_16x16x32_bf16 v[32:35], v[24:27], a[4:7], v[32:35]
 v_mfma_f32_16x16x32_bf16 v[36:39], v[28:31], a[4:7], v[36:39]
 s_waitcnt vmcnt(14)
 v_mfma_f32_16x16x32_bf16 v[32:35], v[24:27], a[8:11], v[32:35]
 v_mfma_f32_16x16x32_bf16 v[36:39], v[28:31], a[8:11], v[36:39]
 s_waitcnt vmcnt(13)
 v_mfma_f32_16x16x32_bf16 v[32:35], v[24:27], a[12:15], v[32:35]
 v_mfma_f32_16x16x32_bf16 v[36:39], v[28:31], a[12:15], v[36:39]
 s_waitcnt vmcnt(12)
 v_mfma_f32_16x16x32_bf16 v[32:35], v[24:27], a[16:19], v[32:35]
 v_mfma_f32_16x16x32_bf16 v[36:39], v[28:31], a[16:19], v[36:39]
 s_waitcnt vmcnt(11)
 v_mfma_f32_16x16x32_bf16 v[32:35], v[24:27], a[20:23], v[32:35]
 v_mfma_f32_16x16x32_bf16 v[36:39], v[28:31], a[20:23], v[36:39]
 s_waitcnt vmcnt(10)
 v_mfma_f32_16x16x32_bf16 v[32:35], v[24:27], a[24:27], v[32:35]
 v_mfma_f32_16x16x32_bf16 v[36:39], v[28:31], a[24:27], v[36:39]
 s_waitcnt vmcnt(9)
 v_mfma_f32_16x16x32_bf16 v[32:35], v[24:27], a[28:31], v[32:35]
 v_mfma_f32_16x16x32_bf16 v[36:39], v[28:31], a[28:31], v[36:39]
 s_waitcnt vmcnt(8)
 v_mfma_f32_16x16x32_bf16 v[32:35], v[24:27], a[32:35], v[32:35]
 v_mfma_f32_16x16x32_bf16 v[36:39], v[28:31], a[32:35], v[36:39]
 s_waitcnt vmcnt(7)
 v_mfma_f32_16x16x32_bf16 v[32:35], v[24:27], a[36:39], v[32:35]
 v_mfma_f32_16x16x32_bf16 v[36:39], v[28:31], a[36:39], v[36:39]
 s_waitcnt vmcnt(6)
 v_mfma_f32_16x16x32_bf16 v[32:35], v[24:27], a[40:43], v[32:35]
 v_mfma_f32_16x16x32_bf16 v[36:39], v[28:31], a[40:43], v[36:39]
 s_waitcnt vmcnt(5)
 v_mfma_f32_16x16x32_bf16 v[32:35], v[24:27], a[44:47], v[32:35]
 v_mfma_f32_16x16x32_bf16 v[36:39], v[28:31], a[44:47], v[36:39]
 s_waitcnt vmcnt(4)
 v_cmp_ne_u32 vcc, 0, v23
 s_cmp_eq_u64 vcc, 0
 s_cselect_b32 s50, 1, 0
 s_cselect_b32 s52, s56, 2.0
 s_cselect_b32 s53, s57, 2.0
 s_add_u32 m0, s58, 0
 s_nop 0
 buffer_load_dwordx4 v8, s[12:15], s52 offen offset:0 sc1 lds
 s_add_u32 m0, s58, 1024
 s_nop 0
 buffer_load_dwordx4 v8, s[12:15], s53 offen offset:0 sc1 lds
 s_add_u32 m0, s58, 0
 s_nop 0
 buffer_load_dwordx4 v8, s[12:15], s52 offen offset:2048 sc1 lds
 s_add_u32 m0, s58, 1024
 s_nop 0
 buffer_load_dwordx4 v8, s[12:15], s53 offen offset:2048 sc1 lds
 s_waitcnt vmcnt(7)
 v_mfma_f32_16x16x32_bf16 v[32:35], v[24:27], a[48:51], v[32:35]
 v_mfma_f32_16x16x32_bf16 v[36:39], v[28:31], a[48:51], v[36:39]
 s_waitcnt vmcnt(6)
 v_mfma_f32_16x16x32_bf16 v[32:35], v[24:27], a[52:55], v[32:35]
 v_mfma_f32_16x16x32_bf16 v[36:39], v[28:31], a[52:55], v[36:39]
 s_waitcnt vmcnt(5)
 v_mfma_f32_16x16x32_bf16 v[32:35], v[24:27], a[56:59], v[32:35]
 v_mfma_f32_16x16x32_bf16 v[36:39], v[28:31], a[56:59], v[36:39]
 s_waitcnt vmcnt(4)
 v_mfma_f32_16x16x32_bf16 v[32:35], v[24:27], a[60:63], v[32:35]
 v_mfma_f32_16x16x32_bf16 v[36:39], v[28:31], a[60:63], v[36:39]
 s_nop 7
 v_cvt_pk_bf16_f32 v32, v32, v33
 v_cvt_pk_bf16_f32 v33, v34, v35
 v_cvt_pk_bf16_f32 v34, v36, v37
 v_cvt_pk_bf16_f32 v35, v38, v39
 buffer_store_dwordx4 v[32:35], v2, s[8:11], s35 offen offset:0
 s_cmp_eq_u32 s50, 1
 s_cbranch_scc1 L_havey
 v_and_b32 v16, 15, v0
 v_lshlrev_b32 v16, 2, v16
 s_mov_b32 s32, 0
L_poll11:
 buffer_load_dword v17, v16, s[12:15], s43 offen sc1
 s_waitcnt vmcnt(0)
 v_cmp_ne_u32 vcc, 0, v17
 s_cbranch_vccz L_poll11_ok
 s_sleep 6
 s_add_u32 s32, s32, 1
 s_cmp_lt_u32 s32, 0x80000
 s_cbranch_scc1 L_poll11
L_poll11_ok:
 s_add_u32 m0, s58, 0
 s_nop 0
 buffer_load_dwordx4 v8, s[12:15], s56 offen offset:0 sc1 lds
 s_add_u32 m0, s58, 1024
 s_nop 0
 buffer_load_dwordx4 v8, s[12:15], s57 offen offset:0 sc1 lds
 s_add_u32 m0, s58, 0
 s_nop 0
 buffer_load_dwordx4 v8, s[12:15], s56 offen offset:2048 sc1 lds
 s_add_u32 m0, s58, 1024
 s_nop 0
 buffer_load_dwordx4 v8, s[12:15], s57 offen offset:2048 sc1 lds
 s_waitcnt vmcnt(0)
L_havey:
 s_waitcnt vmcnt(1)
 ds_read_b64_tr_b16 v[64:65], v10 offset:0
 ds_read_b64_tr_b16 v[66:67], v10 offset:128
 ds_read_b64_tr_b16 v[68:69], v10 offset:1024
 ds_read_b64_tr_b16 v[70:71], v10 offset:1152
 ds_read_b64_tr_b16 v[72:73], v10 offset:2048
 ds_read_b64_tr_b16 v[74:75], v10 offset:2176
 ds_read_b64_tr_b16 v[76:77], v10 offset:3072
 ds_read_b64_tr_b16 v[78:79], v10 offset:3200
 s_waitcnt lgkmcnt(6)
 v_lshlrev_b32 v16, 16, v48
 v_and_b32 v17, s59, v48
 v_lshlrev_b32 v18, 16, v64
 v_and_b32 v19, s59, v64
 v_pk_mul_f32 v[16:17], v[16:17], v[18:19]
 v_cvt_pk_bf16_f32 v48, v16, v17
 v_lshlrev_b32 v16, 16, v49
 v_and_b32 v17, s59, v49
 v_lshlrev_b32 v18, 16, v65
 v_and_b32 v19, s59, v65
 v_pk_mul_f32 v[16:17], v[16:17], v[18:19]
 v_cvt_pk_bf16_f32 v49, v16, v17
 v_lshlrev_b32 v16, 16, v50
 v_and_b32 v17, s59, v50
 v_lshlrev_b32 v18, 16, v66
 v_and_b32 v19, s59, v66
 v_pk_mul_f32 v[16:17], v[16:17], v[18:19]
 v_cvt_pk_bf16_f32 v50, v16, v17
 v_lshlrev_b32 v16, 16, v51
 v_and_b32 v17, s59, v51
 v_lshlrev_b32 v18, 16, v67
 v_and_b32 v19, s59, v67
 v_pk_mul_f32 v[16:17], v[16:17], v[18:19]
 v_cvt_pk_bf16_f32 v51, v16, v17
 buffer_store_dwordx4 v[48:51], v2, s[8:11], s46 offen offset:0
 s_waitcnt lgkmcnt(4)
 v_lshlrev_b32 v16, 16, v52
 v_and_b32 v17, s59, v52
 v_lshlrev_b32 v18, 16, v68
 v_and_b32 v19, s59, v68
 v_pk_mul_f32 v[16:17], v[16:17], v[18:19]
 v_cvt_pk_bf16_f32 v52, v16, v17
 v_lshlrev_b32 v16, 16, v53
 v_and_b32 v17, s59, v53
 v_lshlrev_b32 v18, 16, v69
 v_and_b32 v19, s59, v69
 v_pk_mul_f32 v[16:17], v[16:17], v[18:19]
 v_cvt_pk_bf16_f32 v53, v16, v17
 v_lshlrev_b32 v16, 16, v54
 v_and_b32 v17, s59, v54
 v_lshlrev_b32 v18, 16, v70
 v_and_b32 v19, s59, v70
 v_pk_mul_f32 v[16:17], v[16:17], v[18:19]
 v_cvt_pk_bf16_f32 v54, v16, v17
 v_lshlrev_b32 v16, 16, v55
 v_and_b32 v17, s59, v55
 v_lshlrev_b32 v18, 16, v71
 v_and_b32 v19, s59, v71
 v_pk_mul_f32 v[16:17], v[16:17], v[18:19]
 v_cvt_pk_bf16_f32 v55, v16, v17
 buffer_store_dwordx4 v[52:55], v2, s[8:11], s46 offen offset:64
 s_waitcnt lgkmcnt(2)
 v_lshlrev_b32 v16, 16, v56
 v_and_b32 v17, s59, v56
 v_lshlrev_b32 v18, 16, v72
 v_and_b32 v19, s59, v72
 v_pk_mul_f32 v[16:17], v[16:17], v[18:19]
 v_cvt_pk_bf16_f32 v56, v16, v17
 v_lshlrev_b32 v16, 16, v57
 v_and_b32 v17, s59, v57
 v_lshlrev_b32 v18, 16, v73
 v_and_b32 v19, s59, v73
 v_pk_mul_f32 v[16:17], v[16:17], v[18:19]
 v_cvt_pk_bf16_f32 v57, v16, v17
 v_lshlrev_b32 v16, 16, v58
 v_and_b32 v17, s59, v58
 v_lshlrev_b32 v18, 16, v74
 v_and_b32 v19, s59, v74
 v_pk_mul_f32 v[16:17], v[16:17], v[18:19]
 v_cvt_pk_bf16_f32 v58, v16, v17
 v_lshlrev_b32 v16, 16, v59
 v_and_b32 v17, s59, v59
 v_lshlrev_b32 v18, 16, v75
 v_and_b32 v19, s59, v75
 v_pk_mul_f32 v[16:17], v[16:17], v[18:19]
 v_cvt_pk_bf16_f32 v59, v16, v17
 buffer_store_dwordx4 v[56:59], v2, s[8:11], s55 offen offset:0
 s_waitcnt lgkmcnt(0)
 v_lshlrev_b32 v16, 16, v60
 v_and_b32 v17, s59, v60
 v_lshlrev_b32 v18, 16, v76
 v_and_b32 v19, s59, v76
 v_pk_mul_f32 v[16:17], v[16:17], v[18:19]
 v_cvt_pk_bf16_f32 v60, v16, v17
 v_lshlrev_b32 v16, 16, v61
 v_and_b32 v17, s59, v61
 v_lshlrev_b32 v18, 16, v77
 v_and_b32 v19, s59, v77
 v_pk_mul_f32 v[16:17], v[16:17], v[18:19]
 v_cvt_pk_bf16_f32 v61, v16, v17
 v_lshlrev_b32 v16, 16, v62
 v_and_b32 v17, s59, v62
 v_lshlrev_b32 v18, 16, v78
 v_and_b32 v19, s59, v78
 v_pk_mul_f32 v[16:17], v[16:17], v[18:19]
 v_cvt_pk_bf16_f32 v62, v16, v17
 v_lshlrev_b32 v16, 16, v63
 v_and_b32 v17, s59, v63
 v_lshlrev_b32 v18, 16, v79
 v_and_b32 v19, s59, v79
 v_pk_mul_f32 v[16:17], v[16:17], v[18:19]
 v_cvt_pk_bf16_f32 v63, v16, v17
 buffer_store_dwordx4 v[60:63], v2, s[8:11], s55 offen offset:64
L_fin:
 s_endpgm
L_codeend:
.section .rodata,"a"
.p2align 6
.amdhsa_kernel concat_heads__ssm_conv_h3__compressed_kv_cla__prompt_kernel
  .amdhsa_next_free_vgpr 512
  .amdhsa_next_free_sgpr 102
  .amdhsa_accum_offset 256
  .amdhsa_group_segment_fixed_size 0
  .amdhsa_kernarg_size 120
  .amdhsa_user_sgpr_count 2
  .amdhsa_user_sgpr_kernarg_segment_ptr 1
  .amdhsa_system_sgpr_workgroup_id_x 1
.end_amdhsa_kernel
```

```asm
; @launch grid=(256,1,1) block=(256,1,1) lds=163840
.amdgcn_target "amdgcn-amd-amdhsa--gfx950"
.text
.globl concat_heads__ssm_conv_h3__compressed_kv_cla__prompt_kernel
.p2align 8
.type concat_heads__ssm_conv_h3__compressed_kv_cla__prompt_kernel,@function
concat_heads__ssm_conv_h3__compressed_kv_cla__prompt_kernel:
 s_cmp_lt_u32 s2, 256
 s_cbranch_scc1 L_go
 s_endpgm
L_go:
 s_load_dwordx16 s[64:79], s[0:1], 0
 s_load_dwordx8 s[80:87], s[0:1], 64
 s_load_dwordx4 s[88:91], s[0:1], 96
 s_load_dwordx2 s[12:13], s[0:1], 112
 v_lshrrev_b32 v1, 6, v0
 v_and_b32 v0, 63, v0
 v_readfirstlane_b32 s3, v1
 s_and_b32 s24, s2, 7
 s_bfe_u32 s25, s2, 0x30003
 s_bfe_u32 s26, s2, 0x10006
 s_lshl_b32 s37, s24, 1
 s_add_u32 s26, s26, s37
 s_lshr_b32 s27, s2, 7
 s_bfe_u32 s28, s2, 0x40003
 s_lshl_b32 s29, s3, 10
 s_and_b32 s39, s3, 1
 s_lshr_b32 s40, s3, 1
 s_cmp_eq_u32 s27, 0
 s_cselect_b32 s37, 7, 7
 s_add_u32 s37, s37, s25
 s_and_b32 s37, s37, 7
 s_lshl_b32 s37, s37, 1
 s_lshr_b32 s28, s28, 3
 s_add_u32 s28, s28, s37
 s_getpc_b64 s[100:101]
L_pc:
 s_sub_u32 s100, s100, L_pc-L_go
 s_subb_u32 s101, s101, 0
 s_lshr_b32 s32, s2, 1
 s_and_b32 s32, s32, 124
 s_add_u32 s32, s32, s3
 s_mul_i32 s32, s32, 1152
 s_add_u32 s32, s32, 0
 v_min_u32 v14, 8, v0
 v_lshl_add_u32 v14, v14, 7, s32
 v_min_u32 v14, L_codeend-L_go-4, v14
 global_load_dword a243, v14, s[100:101]
 s_mov_b32 s41, 65536
 s_mov_b32 s48, 32768
 s_mov_b32 s42, 131072
 s_mov_b32 s49, 131072
 s_mov_b32 s43, 196608
 s_mov_b32 s50, 163840
 s_mov_b32 s44, 262144
 s_mov_b32 s51, 262144
 s_mov_b32 s45, 327680
 s_mov_b32 s52, 294912
 s_mov_b32 s46, 393216
 s_mov_b32 s53, 393216
 s_mov_b32 s47, 458752
 s_mov_b32 s54, 425984
 s_lshl_b32 s56, s39, 1
 s_lshl_b32 s57, s40, 3
 s_add_u32 s56, s56, s57
 s_lshl_b32 s60, s25, 8
 s_lshl_b32 s58, s3, 3
 s_add_u32 s58, s58, s60
 v_lshrrev_b32 v14, 3, v0
 v_add_u32 v14, s58, v14
 v_lshlrev_b32 v14, 11, v14
 s_lshl_b32 s58, s39, 2
 v_lshrrev_b32 v15, 4, v0
 v_add_u32 v15, s58, v15
 v_xor_b32 v15, v0, v15
 v_and_b32 v15, 7, v15
 v_lshl_add_u32 v1, v15, 4, v14
 v_lshrrev_b32 v14, 5, v0
 s_lshl_b32 s58, s3, 1
 v_add_u32 v15, s58, v14
 v_lshlrev_b32 v15, 1, v15
 v_xor_b32 v15, v0, v15
 v_and_b32 v15, 31, v15
 v_lshlrev_b32 v15, 4, v15
 v_add_u32 v14, s56, v14
 v_lshl_add_u32 v14, v14, 13, v15
 s_lshl_b32 s58, s26, 9
 v_add_u32 v2, s58, v14
 s_waitcnt lgkmcnt(0)
 s_cmp_eq_u32 s27, 0
 s_cselect_b32 s8, s82, s84
 s_cselect_b32 s9, s83, s85
 s_mov_b32 s10, 8388608
 s_mov_b32 s11, 0x20000
 s_mov_b32 s4, s78
 s_mov_b32 s5, s79
 s_mov_b32 s6, 4194304
 s_mov_b32 s7, 0x20000
 s_mov_b32 s14, 268435456
 s_mov_b32 s15, 0x20000
 s_add_u32 m0, s29, 65536
 s_nop 0
 buffer_load_dwordx4 v2, s[8:11], 0 offen  lds
 s_lshl_b32 s58, s27, 3
 s_add_u32 s59, s58, s25
 s_lshl_b32 s59, s59, 2
 s_lshl_b32 s92, s26, 7
 s_add_u32 s92, s92, s59
 s_add_u32 s92, s92, 84934656
 s_add_u32 s58, s58, s24
 s_mul_i32 s95, s58, 14
 s_add_u32 s95, s95, s28
 s_sub_u32 s63, 15, s25
 s_add_u32 m0, s29, 0
 s_nop 0
 buffer_load_dwordx4 v1, s[4:7], 0 offen  lds
 s_cmp_eq_u32 s27, 0
 s_cselect_b32 s63, s25, s63
 s_lshl_b32 s93, s63, 7
 s_lshl_b32 s59, s26, 2
 s_add_u32 s93, s93, s59
 s_add_u32 s93, s93, 84938752
 s_and_b32 s94, s2, 127
 s_lshl_b32 s94, s94, 7
 s_add_u32 s94, s94, 84942848
 s_cmp_lg_u32 s3, 0
 s_cbranch_scc1 L_noclr
 s_lshl_b32 s58, s95, 2
 s_add_u32 s59, s58, 84963328
 s_add_u32 s58, s58, 84959232
 s_lshl_b32 s61, s27, 2
 s_add_u32 s61, s61, s94
 s_cmp_lt_u32 s28, 14
 s_cselect_b32 s58, s58, s92
 s_cselect_b32 s59, s59, s92
 v_mov_b32 v14, s92
 v_writelane_b32 v14, s93, 1
 v_writelane_b32 v14, s61, 2
 v_writelane_b32 v14, s58, 3
 v_writelane_b32 v14, s59, 4
 s_add_u32 s58, s93, 64
 v_writelane_b32 v14, s58, 5
 s_lshl_b32 s58, s2, 12
 s_add_u32 s58, s58, 84967424
 s_cmp_lt_u32 s2, 4
 s_cselect_b32 s58, s58, s92
 v_writelane_b32 v14, s58, 6
 v_mov_b32 v15, 1
 s_mov_b64 exec, 127
 buffer_store_dword v15, v14, s[12:15], 0 offen sc1
 s_mov_b64 exec, -1
L_noclr:
 s_add_u32 m0, s29, 69632
 s_nop 0
 buffer_load_dwordx4 v2, s[8:11], s48 offen  lds
 s_add_u32 m0, s29, 4096
 s_nop 0
 buffer_load_dwordx4 v1, s[4:7], s41 offen  lds
 s_add_u32 m0, s29, 73728
 s_nop 0
 buffer_load_dwordx4 v2, s[8:11], s49 offen  lds
 s_cmp_eq_u32 s3, 0
 s_cselect_b32 s58, 0, 0x80000000
 s_add_u32 m0, s29, 8192
 s_nop 0
 buffer_load_dwordx4 v1, s[4:7], s42 offen  lds
 v_bfrev_b32 v14, 1
 v_writelane_b32 v14, s58, 0
 v_accvgpr_write_b32 a245, v14
 s_lshl_b32 s58, s39, 7
 s_lshl_b32 s59, s40, 3
 v_and_b32 v14, 15, v0
 v_lshrrev_b32 v15, 4, v0
 s_lshl_b32 s60, s63, 7
 s_lshl_b32 s62, s3, 4
 s_add_u32 s60, s60, s62
 s_add_u32 m0, s29, 77824
 s_nop 0
 buffer_load_dwordx4 v2, s[8:11], s50 offen  lds
 v_lshrrev_b32 v13, 3, v0
 v_lshlrev_b32 v13, 1, v13
 v_add_u32 v12, s60, v13
 v_mul_u32_u24 v12, 896, v12
 v_lshrrev_b32 v13, 1, v13
 v_xor_b32 v13, v0, v13
 v_and_b32 v13, 7, v13
 v_lshl_add_u32 v13, v13, 4, v12
 v_accvgpr_write_b32 a240, v13
 s_add_u32 m0, s29, 12288
 s_nop 0
 buffer_load_dwordx4 v1, s[4:7], s43 offen  lds
 v_lshrrev_b32 v13, 1, v14
 v_xor_b32 v12, v13, v15
 v_lshlrev_b32 v12, 4, v12
 v_lshl_add_u32 v12, v13, 7, v12
 v_and_b32 v13, 1, v14
 v_lshl_add_u32 v12, v13, 10, v12
 s_lshl_b32 s33, s3, 13
 s_add_u32 s33, s33, 0x20000
 v_add_u32 v12, s33, v12
 v_accvgpr_write_b32 a242, v12
 s_add_u32 m0, s29, 81920
 s_nop 0
 buffer_load_dwordx4 v2, s[8:11], s51 offen  lds
 v_lshrrev_b32 v5, 1, v14
 v_xor_b32 v5, v5, v15
 v_add_u32 v14, s58, v14
 v_lshlrev_b32 v14, 7, v14
 v_lshl_add_u32 v4, v5, 4, v14
 v_xor_b32 v5, 64, v4
 v_bfe_u32 v14, v0, 2, 3
 v_lshrrev_b32 v15, 5, v0
 v_lshl_add_u32 v13, v15, 4, v14
 s_add_u32 m0, s29, 16384
 s_nop 0
 buffer_load_dwordx4 v1, s[4:7], s44 offen  lds
 v_lshlrev_b32 v13, 9, v13
 v_xor_b32 v14, s59, v14
 v_lshl_add_u32 v13, v14, 5, v13
 v_and_b32 v14, 3, v0
 v_lshl_add_u32 v13, v14, 3, v13
 v_add_u32 v6, 0x10000, v13
 v_xor_b32 v7, 32, v6
 v_xor_b32 v8, 64, v6
 v_xor_b32 v9, 96, v6
 v_xor_b32 v10, 128, v6
 s_add_u32 m0, s29, 86016
 s_nop 0
 buffer_load_dwordx4 v2, s[8:11], s52 offen  lds
 v_xor_b32 v11, 160, v6
 v_xor_b32 v12, 192, v6
 v_xor_b32 v13, 224, v6
 s_mov_b32 s16, s80
 s_mov_b32 s17, s81
 s_mov_b32 s18, 3670016
 s_mov_b32 s19, 0x20000
 s_mov_b32 s20, s76
 s_mov_b32 s21, s77
 s_add_u32 m0, s29, 20480
 s_nop 0
 buffer_load_dwordx4 v1, s[4:7], s45 offen  lds
 s_mov_b32 s22, 1835008
 s_mov_b32 s23, 0x20000
 s_and_b32 s62, s2, 127
 s_lshl_b32 s62, s62, 2
 s_add_u32 s62, s62, s3
 s_mul_i32 s62, s62, 17408
 s_add_u32 s62, s62, 50331648
 s_mul_i32 s58, s26, 1048576
 s_mul_i32 s59, s25, 131072
 s_add_u32 s58, s58, s59
 s_add_u32 m0, s29, 90112
 s_nop 0
 buffer_load_dwordx4 v2, s[8:11], s53 offen  lds
 s_mul_i32 s59, s39, 65536
 s_add_u32 s58, s58, s59
 s_lshl_b32 s59, s40, 12
 s_lshl_b32 s59, s59, s27
 s_add_u32 s58, s58, s59
 s_mul_i32 s59, s27, 16777216
 s_add_u32 s58, s58, s59
 s_mov_b32 s57, 57344
 s_lshl_b32 s60, s40, 8
 s_add_u32 m0, s29, 24576
 s_nop 0
 buffer_load_dwordx4 v1, s[4:7], s46 offen  lds
 s_add_u32 s60, s60, 0x10000
 s_mov_b32 s34, 0x3db8aa3b
 s_mov_b32 s35, 0x3db8aa3b
 s_mul_i32 s55, s25, 5
 s_lshr_b32 s55, s55, 3
 s_add_u32 s55, s55, 1
 s_cmp_lg_u32 s3, 0
 s_cmov_b32 s55, 6
 v_mov_b32 v15, 1
 s_cmp_ge_u32 s25, 6
 s_cmov_b32 s62, 2.0
 s_add_u32 m0, s29, 94208
 s_nop 0
 buffer_load_dwordx4 v2, s[8:11], s54 offen  lds
 v_mov_b32 v20, 0
 v_mov_b32 v21, 0
 v_mov_b32 v24, 0
 v_mov_b32 v25, 0
 v_and_b32 v26, 1, v0
 v_lshlrev_b32 v26, 4, v26
 v_mov_b32 v27, 0x3f80
 v_lshlrev_b32 v26, v26, v27
 v_bfe_u32 v27, v0, 1, 3
 s_add_u32 m0, s29, 28672
 s_nop 0
 buffer_load_dwordx4 v1, s[4:7], s47 offen  lds
 v_add_u32 v1, 128, v1
 v_add_u32 v2, 0x80000, v2
 v_lshrrev_b32 v28, 4, v0
 v_lshlrev_b32 v28, 1, v28
 v_sub_u32 v27, v27, v28
 v_cmp_eq_u32 s[0:1], 0, v27
 v_cmp_eq_u32 vcc, 1, v27
 v_lshrrev_b32 v31, 3, v0
 s_lshl_b32 s31, s3, 6
 v_add_u32 v30, s31, v31
 v_mul_u32_u24 v30, 896, v30
 s_add_u32 m0, s29, 98304
 s_nop 0
 buffer_load_dwordx4 v2, s[8:11], 0 offen  lds
 v_and_b32 v31, 6, v31
 v_xor_b32 v31, v31, v0
 v_and_b32 v31, 7, v31
 v_lshl_add_u32 v30, v31, 4, v30
 v_cndmask_b32 v22, 0, v26, s[0:1]
 v_cndmask_b32 v23, 0, v26, vcc
 v_accvgpr_write_b32 a248, v20
 v_accvgpr_write_b32 a249, v21
 v_accvgpr_write_b32 a250, v22
 v_accvgpr_write_b32 a251, v23
 s_add_u32 m0, s29, 32768
 s_nop 0
 buffer_load_dwordx4 v1, s[4:7], 0 offen  lds
 v_accvgpr_write_b32 a252, v24
 v_accvgpr_write_b32 a253, v25
 v_accvgpr_write_b32 a241, v30
 s_lshl_b32 s31, s27, 3
 s_add_u32 s31, s31, s25
 s_cmp_lt_u32 s31, 6
 s_cselect_b64 vcc, -1, 0
 v_lshlrev_b32 v31, 4, v0
 v_cndmask_b32 v30, v30, v31, vcc
 s_add_u32 m0, s29, 102400
 s_nop 0
 buffer_load_dwordx4 v2, s[8:11], s48 offen  lds
 v_accvgpr_write_b32 a244, v30
 v_lshrrev_b32 v31, 2, v0
 v_lshlrev_b32 v30, 7, v31
 v_bfe_u32 v31, v31, 1, 2
 v_lshl_add_u32 v30, v31, 5, v30
 v_and_b32 v31, 3, v0
 v_lshl_add_u32 v30, v31, 3, v30
 v_add_u32 v30, 131072, v30
 v_accvgpr_write_b32 a254, v30
 s_lshl_b32 s31, s25, 16
 s_add_u32 m0, s29, 36864
 s_nop 0
 buffer_load_dwordx4 v1, s[4:7], s41 offen  lds
 s_lshl_b32 s32, s26, 9
 s_add_u32 s31, s31, s32
 v_lshrrev_b32 v15, 3, v0
 v_lshlrev_b32 v15, 13, v15
 v_and_b32 v14, 7, v0
 v_lshlrev_b32 v14, 6, v14
 v_add3_u32 v16, v14, v15, s31
 s_lshl_b32 s31, s25, 2
 s_lshr_b32 s32, s2, 6
 s_add_u32 m0, s29, 106496
 s_nop 0
 buffer_load_dwordx4 v2, s[8:11], s49 offen  lds
 s_add_u32 s31, s31, s32
 s_lshl_b32 s31, s31, 17
 v_lshlrev_b32 v17, 11, v0
 v_add_u32 v17, s31, v17
 s_mul_i32 s36, s2, 7282
 s_lshr_b32 s36, s36, 16
 s_mul_i32 s37, s36, 9
 s_sub_u32 s37, s2, s37
 s_lshl_b32 s38, s36, 16
 s_mov_b64 s[30:31], s[80:81]
 s_add_u32 m0, s29, 40960
 s_nop 0
 buffer_load_dwordx4 v1, s[4:7], s42 offen  lds
 s_cmp_eq_u32 s37, 2
 s_cmov_b64 s[30:31], s[76:77]
 s_cmp_eq_u32 s37, 3
 s_cmov_b64 s[30:31], s[66:67]
 s_cmp_eq_u32 s37, 4
 s_cmov_b64 s[30:31], s[68:69]
 s_cmp_eq_u32 s37, 5
 s_cmov_b64 s[30:31], s[86:87]
 s_cmp_eq_u32 s37, 6
 s_cmov_b64 s[30:31], s[86:87]
 s_add_u32 m0, s29, 110592
 s_nop 0
 buffer_load_dwordx4 v2, s[8:11], s50 offen  lds
 s_cmp_eq_u32 s37, 7
 s_cmov_b64 s[30:31], s[72:73]
 s_cmp_eq_u32 s37, 8
 s_cmov_b64 s[30:31], s[64:65]
 s_add_u32 s32, s38, 1835008
 s_cmp_eq_u32 s37, 1
 s_cmov_b32 s38, s32
 s_cmp_eq_u32 s37, 6
 s_cmov_b32 s38, s32
 s_add_u32 m0, s29, 45056
 s_nop 0
 buffer_load_dwordx4 v1, s[4:7], s43 offen  lds
 s_lshl_b32 s32, s39, 15
 s_add_u32 s38, s38, s32
 s_cmp_ge_u32 s37, 9
 s_cmov_b32 s36, 28
 s_cmp_lt_u32 s36, 28
 s_cselect_b32 s32, 0x8000, 0
 s_cselect_b32 s38, s38, 0
 s_add_u32 s36, s30, s38
 s_addc_u32 s37, s31, 0
 s_add_u32 m0, s29, 114688
 s_nop 0
 buffer_load_dwordx4 v2, s[8:11], s51 offen  lds
 s_mov_b32 s38, s32
 s_mov_b32 s39, 0x20000
 v_lshlrev_b32 v14, 6, v0
 s_mov_b32 s56, 0xffffd000
 s_movk_i32 s30, 0x1000
 s_cmp_ge_u32 s3, 2
 s_cbranch_scc1 L_pfset
 s_mov_b32 s38, 0
 s_cmp_eq_u32 s3, 0
 s_cselect_b64 s[36:37], s[8:9], s[4:5]
 s_cselect_b32 s38, s10, s6
 s_movk_i32 s30, 128
 s_cmov_b32 s30, 0x80000
 s_cselect_b64 vcc, -1, 0
 s_lshl_b32 s56, s30, 1
 v_cndmask_b32 v14, v17, v16, vcc
L_pfset:
 s_add_u32 m0, s29, 49152
 s_nop 0
 buffer_load_dwordx4 v1, s[4:7], s44 offen  lds
 v_mov_b32 v15, 1
 v_lshlrev_b32 v3, 21, v0
 s_mov_b32 s61, 0
 s_waitcnt vmcnt(10)
 s_barrier
 ds_read_b64_tr_b16 a[0:1], v6 offset:0
 ds_read_b64_tr_b16 a[2:3], v6 offset:4096
 ds_read_b128 a[64:67], v4 offset:0
 ds_read_b64_tr_b16 a[4:5], v6 offset:16384
 ds_read_b64_tr_b16 a[6:7], v6 offset:20480
 ds_read_b128 a[68:71], v5 offset:0
 ds_read_b128 a[76:79], v5 offset:2048
 ds_read_b128 a[72:75], v4 offset:2048
 ds_read_b128 a[80:83], v4 offset:4096
 ds_read_b128 a[84:87], v5 offset:4096
 ds_read_b128 a[92:95], v5 offset:6144
 ds_read_b128 a[88:91], v4 offset:6144
 ds_read_b64_tr_b16 a[8:9], v7 offset:0
 ds_read_b64_tr_b16 a[10:11], v7 offset:4096
 ds_read_b64_tr_b16 a[12:13], v7 offset:16384
 ds_read_b64_tr_b16 a[14:15], v7 offset:20480
 ds_read_b64_tr_b16 a[16:17], v8 offset:0
 ds_read_b64_tr_b16 a[18:19], v8 offset:4096
 ds_read_b64_tr_b16 a[20:21], v8 offset:16384
 ds_read_b64_tr_b16 a[22:23], v8 offset:20480
 s_cmp_eq_u32 s27, 0
 s_waitcnt lgkmcnt(0)
 s_cbranch_scc0 L_vloop_head
L_kloop_head:
 v_mfma_f32_16x16x32_bf16 v[88:91], a[0:3], a[64:67], 0
 s_add_u32 m0, s29, 118784
 ds_read_b64_tr_b16 a[24:25], v9 offset:0
 v_mfma_f32_16x16x32_bf16 v[88:91], a[4:7], a[68:71], v[88:91]
 ds_read_b64_tr_b16 a[26:27], v9 offset:4096
 buffer_load_dwordx4 v2, s[8:11], s52 offen  lds
 v_mfma_f32_16x16x32_bf16 v[80:83], a[4:7], a[76:79], 0
 ds_read_b64_tr_b16 a[28:29], v9 offset:16384
 v_mfma_f32_16x16x32_bf16 v[80:83], a[0:3], a[72:75], v[80:83]
 ds_read_b64_tr_b16 a[30:31], v9 offset:20480
 v_mfma_f32_16x16x32_bf16 v[72:75], a[0:3], a[80:83], 0
 s_add_u32 m0, s29, 53248
 ds_read_b128 a[96:99], v4 offset:8192
 v_mfma_f32_16x16x32_bf16 v[72:75], a[4:7], a[84:87], v[72:75]
 buffer_load_dwordx4 v1, s[4:7], s45 offen  lds
 v_mfma_f32_16x16x32_bf16 v[64:67], a[4:7], a[92:95], 0
 ds_read_b128 a[100:103], v5 offset:8192
 v_mfma_f32_16x16x32_bf16 v[64:67], a[0:3], a[88:91], v[64:67]
 v_mfma_f32_16x16x32_bf16 v[68:71], a[8:11], a[88:91], 0
 s_add_u32 m0, s29, 122880
 ds_read_b128 a[108:111], v5 offset:10240
 v_mfma_f32_16x16x32_bf16 v[68:71], a[12:15], a[92:95], v[68:71]
 buffer_load_dwordx4 v2, s[8:11], s53 offen  lds
 v_mfma_f32_16x16x32_bf16 v[76:79], a[12:15], a[84:87], 0
 ds_read_b128 a[104:107], v4 offset:10240
 v_mfma_f32_16x16x32_bf16 v[76:79], a[8:11], a[80:83], v[76:79]
 v_mfma_f32_16x16x32_bf16 v[84:87], a[8:11], a[72:75], 0
 s_add_u32 m0, s29, 57344
 ds_read_b128 a[112:115], v4 offset:12288
 v_mfma_f32_16x16x32_bf16 v[84:87], a[12:15], a[76:79], v[84:87]
 buffer_load_dwordx4 v1, s[4:7], s46 offen  lds
 v_mfma_f32_16x16x32_bf16 v[92:95], a[12:15], a[68:71], 0
 ds_read_b128 a[116:119], v5 offset:12288
 v_mfma_f32_16x16x32_bf16 v[92:95], a[8:11], a[64:67], v[92:95]
 v_mfma_f32_16x16x32_bf16 v[120:123], a[16:19], a[64:67], 0
 s_add_u32 m0, s29, 126976
 ds_read_b128 a[124:127], v5 offset:14336
 v_mfma_f32_16x16x32_bf16 v[120:123], a[20:23], a[68:71], v[120:123]
 buffer_load_dwordx4 v2, s[8:11], s54 offen  lds
 v_mfma_f32_16x16x32_bf16 v[112:115], a[20:23], a[76:79], 0
 ds_read_b128 a[120:123], v4 offset:14336
 v_mfma_f32_16x16x32_bf16 v[112:115], a[16:19], a[72:75], v[112:115]
 v_mfma_f32_16x16x32_bf16 v[104:107], a[16:19], a[80:83], 0
 s_add_u32 m0, s29, 61440
 ds_read_b64_tr_b16 a[32:33], v10 offset:0
 v_mfma_f32_16x16x32_bf16 v[104:107], a[20:23], a[84:87], v[104:107]
 ds_read_b64_tr_b16 a[34:35], v10 offset:4096
 buffer_load_dwordx4 v1, s[4:7], s47 offen  lds
 v_mfma_f32_16x16x32_bf16 v[96:99], a[20:23], a[92:95], 0
 ds_read_b64_tr_b16 a[36:37], v10 offset:16384
 v_add_u32 v1, 128, v1
 v_mfma_f32_16x16x32_bf16 v[96:99], a[16:19], a[88:91], v[96:99]
 s_waitcnt lgkmcnt(8)
 ds_read_b64_tr_b16 a[38:39], v10 offset:20480
 v_add_u32 v2, 0x80000, v2
 v_mfma_f32_16x16x32_bf16 v[100:103], a[24:27], a[88:91], 0
 ds_read_b64_tr_b16 a[40:41], v11 offset:0
 v_mfma_f32_16x16x32_bf16 v[100:103], a[28:31], a[92:95], v[100:103]
 ds_read_b64_tr_b16 a[42:43], v11 offset:4096
 v_mfma_f32_16x16x32_bf16 v[108:111], a[28:31], a[84:87], 0
 ds_read_b64_tr_b16 a[44:45], v11 offset:16384
 v_mfma_f32_16x16x32_bf16 v[108:111], a[24:27], a[80:83], v[108:111]
 ds_read_b64_tr_b16 a[46:47], v11 offset:20480
 v_mfma_f32_16x16x32_bf16 v[116:119], a[24:27], a[72:75], 0
 ds_read_b64_tr_b16 a[48:49], v12 offset:0
 v_mfma_f32_16x16x32_bf16 v[116:119], a[28:31], a[76:79], v[116:119]
 ds_read_b64_tr_b16 a[50:51], v12 offset:4096
 v_mfma_f32_16x16x32_bf16 v[124:127], a[28:31], a[68:71], 0
 ds_read_b64_tr_b16 a[52:53], v12 offset:16384
 v_mfma_f32_16x16x32_bf16 v[124:127], a[24:27], a[64:67], v[124:127]
 ds_read_b64_tr_b16 a[54:55], v12 offset:20480
 v_mfma_f32_16x16x32_bf16 a[232:235], a[0:3], a[96:99], 0
 ds_read_b64_tr_b16 a[56:57], v13 offset:0
 v_mfma_f32_16x16x32_bf16 a[232:235], a[4:7], a[100:103], a[232:235]
 ds_read_b64_tr_b16 a[58:59], v13 offset:4096
 v_mfma_f32_16x16x32_bf16 a[224:227], a[4:7], a[108:111], 0
 s_waitcnt lgkmcnt(8)
 ds_read_b64_tr_b16 a[60:61], v13 offset:16384
 v_mfma_f32_16x16x32_bf16 a[224:227], a[0:3], a[104:107], a[224:227]
 ds_read_b64_tr_b16 a[62:63], v13 offset:20480
 v_mfma_f32_16x16x32_bf16 v[24:27], a[0:3], a[112:115], 0
 v_mfma_f32_16x16x32_bf16 v[24:27], a[4:7], a[116:119], v[24:27]
 v_mfma_f32_16x16x32_bf16 v[16:19], a[4:7], a[124:127], 0
 v_mfma_f32_16x16x32_bf16 v[16:19], a[0:3], a[120:123], v[16:19]
 s_waitcnt lgkmcnt(0)
 v_mfma_f32_16x16x32_bf16 v[20:23], a[8:11], a[120:123], 0
 s_barrier
 v_mfma_f32_16x16x32_bf16 v[20:23], a[12:15], a[124:127], v[20:23]
 s_add_u32 m0, s29, 65536
 v_mfma_f32_16x16x32_bf16 v[28:31], a[12:15], a[116:119], 0
 buffer_load_dwordx4 v2, s[8:11], 0 offen  lds
 v_mfma_f32_16x16x32_bf16 v[28:31], a[8:11], a[112:115], v[28:31]
 v_mfma_f32_16x16x32_bf16 a[228:231], a[8:11], a[104:107], 0
 v_mfma_f32_16x16x32_bf16 a[228:231], a[12:15], a[108:111], a[228:231]
 v_mfma_f32_16x16x32_bf16 a[236:239], a[12:15], a[100:103], 0
 s_add_u32 m0, s29, 0
 v_mfma_f32_16x16x32_bf16 a[236:239], a[8:11], a[96:99], a[236:239]
 buffer_load_dwordx4 v1, s[4:7], 0 offen  lds
 v_mfma_f32_16x16x32_bf16 v[56:59], a[16:19], a[96:99], 0
 v_mfma_f32_16x16x32_bf16 v[56:59], a[20:23], a[100:103], v[56:59]
 v_mfma_f32_16x16x32_bf16 v[48:51], a[20:23], a[108:111], 0
 v_mfma_f32_16x16x32_bf16 v[48:51], a[16:19], a[104:107], v[48:51]
 s_add_u32 m0, s29, 69632
 v_mfma_f32_16x16x32_bf16 v[40:43], a[16:19], a[112:115], 0
 buffer_load_dwordx4 v2, s[8:11], s48 offen  lds
 v_mfma_f32_16x16x32_bf16 v[40:43], a[20:23], a[116:119], v[40:43]
 v_mfma_f32_16x16x32_bf16 v[32:35], a[20:23], a[124:127], 0
 v_mfma_f32_16x16x32_bf16 v[32:35], a[16:19], a[120:123], v[32:35]
 v_mfma_f32_16x16x32_bf16 v[36:39], a[24:27], a[120:123], 0
 s_add_u32 m0, s29, 4096
 v_mfma_f32_16x16x32_bf16 v[36:39], a[28:31], a[124:127], v[36:39]
 buffer_load_dwordx4 v1, s[4:7], s41 offen  lds
 v_mfma_f32_16x16x32_bf16 v[44:47], a[28:31], a[116:119], 0
 v_mfma_f32_16x16x32_bf16 v[44:47], a[24:27], a[112:115], v[44:47]
 v_mfma_f32_16x16x32_bf16 v[52:55], a[24:27], a[104:107], 0
 v_mfma_f32_16x16x32_bf16 v[52:55], a[28:31], a[108:111], v[52:55]
 s_add_u32 m0, s29, 73728
 v_mfma_f32_16x16x32_bf16 v[60:63], a[28:31], a[100:103], 0
 buffer_load_dwordx4 v2, s[8:11], s49 offen  lds
 v_mfma_f32_16x16x32_bf16 v[60:63], a[24:27], a[96:99], v[60:63]
 v_mfma_f32_16x16x32_bf16 v[216:219], a[32:35], a[96:99], 0
 v_mfma_f32_16x16x32_bf16 v[216:219], a[36:39], a[100:103], v[216:219]
 v_mfma_f32_16x16x32_bf16 v[208:211], a[36:39], a[108:111], 0
 s_add_u32 m0, s29, 8192
 v_mfma_f32_16x16x32_bf16 v[208:211], a[32:35], a[104:107], v[208:211]
 buffer_load_dwordx4 v1, s[4:7], s42 offen  lds
 v_mfma_f32_16x16x32_bf16 v[200:203], a[32:35], a[112:115], 0
 v_mfma_f32_16x16x32_bf16 v[200:203], a[36:39], a[116:119], v[200:203]
 v_mfma_f32_16x16x32_bf16 v[192:195], a[36:39], a[124:127], 0
 v_mfma_f32_16x16x32_bf16 v[192:195], a[32:35], a[120:123], v[192:195]
 s_add_u32 m0, s29, 77824
 v_mfma_f32_16x16x32_bf16 v[196:199], a[40:43], a[120:123], 0
 buffer_load_dwordx4 v2, s[8:11], s50 offen  lds
 v_mfma_f32_16x16x32_bf16 v[196:199], a[44:47], a[124:127], v[196:199]
 v_mfma_f32_16x16x32_bf16 v[204:207], a[44:47], a[116:119], 0
 v_mfma_f32_16x16x32_bf16 v[204:207], a[40:43], a[112:115], v[204:207]
 v_mfma_f32_16x16x32_bf16 v[212:215], a[40:43], a[104:107], 0
 s_add_u32 m0, s29, 12288
 v_mfma_f32_16x16x32_bf16 v[212:215], a[44:47], a[108:111], v[212:215]
 buffer_load_dwordx4 v1, s[4:7], s43 offen  lds
 v_mfma_f32_16x16x32_bf16 v[220:223], a[44:47], a[100:103], 0
 v_mfma_f32_16x16x32_bf16 v[220:223], a[40:43], a[96:99], v[220:223]
 v_mfma_f32_16x16x32_bf16 v[248:251], a[48:51], a[96:99], 0
 v_mfma_f32_16x16x32_bf16 v[248:251], a[52:55], a[100:103], v[248:251]
 s_add_u32 m0, s29, 81920
 v_mfma_f32_16x16x32_bf16 v[240:243], a[52:55], a[108:111], 0
 buffer_load_dwordx4 v2, s[8:11], s51 offen  lds
 v_mfma_f32_16x16x32_bf16 v[240:243], a[48:51], a[104:107], v[240:243]
 v_mfma_f32_16x16x32_bf16 v[232:235], a[48:51], a[112:115], 0
 v_mfma_f32_16x16x32_bf16 v[232:235], a[52:55], a[116:119], v[232:235]
 v_mfma_f32_16x16x32_bf16 v[224:227], a[52:55], a[124:127], 0
 s_add_u32 m0, s29, 16384
 v_mfma_f32_16x16x32_bf16 v[224:227], a[48:51], a[120:123], v[224:227]
 buffer_load_dwordx4 v1, s[4:7], s44 offen  lds
 v_mfma_f32_16x16x32_bf16 v[228:231], a[56:59], a[120:123], 0
 v_mfma_f32_16x16x32_bf16 v[228:231], a[60:63], a[124:127], v[228:231]
 v_mfma_f32_16x16x32_bf16 v[236:239], a[60:63], a[116:119], 0
 v_mfma_f32_16x16x32_bf16 v[236:239], a[56:59], a[112:115], v[236:239]
 s_add_u32 m0, s29, 86016
 v_mfma_f32_16x16x32_bf16 v[244:247], a[56:59], a[104:107], 0
 s_waitcnt vmcnt(10)
 buffer_load_dwordx4 v2, s[8:11], s52 offen  lds
 v_mfma_f32_16x16x32_bf16 v[244:247], a[60:63], a[108:111], v[244:247]
 s_barrier
 ds_read_b64_tr_b16 a[0:1], v6 offset:32768
 v_mfma_f32_16x16x32_bf16 v[252:255], a[60:63], a[100:103], 0
 ds_read_b64_tr_b16 a[2:3], v6 offset:36864
 v_mfma_f32_16x16x32_bf16 v[252:255], a[56:59], a[96:99], v[252:255]
 ds_read_b128 a[96:99], v4 offset:40960
 v_mfma_f32_16x16x32_bf16 v[152:155], a[32:35], a[64:67], 0
 s_add_u32 m0, s29, 20480
 v_mfma_f32_16x16x32_bf16 v[152:155], a[36:39], a[68:71], v[152:155]
 buffer_load_dwordx4 v1, s[4:7], s45 offen  lds
 v_mfma_f32_16x16x32_bf16 v[144:147], a[36:39], a[76:79], 0
 ds_read_b64_tr_b16 a[4:5], v6 offset:49152
 v_mfma_f32_16x16x32_bf16 v[144:147], a[32:35], a[72:75], v[144:147]
 ds_read_b64_tr_b16 a[6:7], v6 offset:53248
 v_mfma_f32_16x16x32_bf16 v[136:139], a[32:35], a[80:83], 0
 ds_read_b128 a[100:103], v5 offset:40960
 v_mfma_f32_16x16x32_bf16 v[136:139], a[36:39], a[84:87], v[136:139]
 s_add_u32 m0, s29, 90112
 v_mfma_f32_16x16x32_bf16 v[128:131], a[36:39], a[92:95], 0
 buffer_load_dwordx4 v2, s[8:11], s53 offen  lds
 v_mfma_f32_16x16x32_bf16 v[128:131], a[32:35], a[88:91], v[128:131]
 ds_read_b128 a[108:111], v5 offset:43008
 v_mfma_f32_16x16x32_bf16 v[132:135], a[40:43], a[88:91], 0
 v_mfma_f32_16x16x32_bf16 v[132:135], a[44:47], a[92:95], v[132:135]
 ds_read_b128 a[104:107], v4 offset:43008
 v_mfma_f32_16x16x32_bf16 v[140:143], a[44:47], a[84:87], 0
 s_add_u32 m0, s29, 24576
 v_mfma_f32_16x16x32_bf16 v[140:143], a[40:43], a[80:83], v[140:143]
 buffer_load_dwordx4 v1, s[4:7], s46 offen  lds
 v_mfma_f32_16x16x32_bf16 v[148:151], a[40:43], a[72:75], 0
 ds_read_b128 a[112:115], v4 offset:45056
 v_mfma_f32_16x16x32_bf16 v[148:151], a[44:47], a[76:79], v[148:151]
 v_mfma_f32_16x16x32_bf16 v[156:159], a[44:47], a[68:71], 0
 ds_read_b128 a[116:119], v5 offset:45056
 v_mfma_f32_16x16x32_bf16 v[156:159], a[40:43], a[64:67], v[156:159]
 s_add_u32 m0, s29, 94208
 v_mfma_f32_16x16x32_bf16 v[184:187], a[48:51], a[64:67], 0
 buffer_load_dwordx4 v2, s[8:11], s54 offen  lds
 v_mfma_f32_16x16x32_bf16 v[184:187], a[52:55], a[68:71], v[184:187]
 ds_read_b128 a[124:127], v5 offset:47104
 v_mfma_f32_16x16x32_bf16 v[176:179], a[52:55], a[76:79], 0
 v_mfma_f32_16x16x32_bf16 v[176:179], a[48:51], a[72:75], v[176:179]
 ds_read_b128 a[120:123], v4 offset:47104
 v_mfma_f32_16x16x32_bf16 v[168:171], a[48:51], a[80:83], 0
 s_add_u32 m0, s29, 28672
 v_mfma_f32_16x16x32_bf16 v[168:171], a[52:55], a[84:87], v[168:171]
 buffer_load_dwordx4 v1, s[4:7], s47 offen  lds
 v_mfma_f32_16x16x32_bf16 v[160:163], a[52:55], a[92:95], 0
 v_mfma_f32_16x16x32_bf16 v[160:163], a[48:51], a[88:91], v[160:163]
 ds_read_b64_tr_b16 a[8:9], v7 offset:32768
 v_mfma_f32_16x16x32_bf16 v[164:167], a[56:59], a[88:91], 0
 v_mfma_f32_16x16x32_bf16 v[164:167], a[60:63], a[92:95], v[164:167]
 ds_read_b64_tr_b16 a[10:11], v7 offset:36864
 v_mfma_f32_16x16x32_bf16 v[172:175], a[60:63], a[84:87], 0
 ds_read_b64_tr_b16 a[12:13], v7 offset:49152
 v_mfma_f32_16x16x32_bf16 v[172:175], a[56:59], a[80:83], v[172:175]
 ds_read_b64_tr_b16 a[14:15], v7 offset:53248
 v_mfma_f32_16x16x32_bf16 v[180:183], a[56:59], a[72:75], 0
 ds_read_b64_tr_b16 a[16:17], v8 offset:32768
 v_mfma_f32_16x16x32_bf16 v[180:183], a[60:63], a[76:79], v[180:183]
 ds_read_b64_tr_b16 a[18:19], v8 offset:36864
 v_mfma_f32_16x16x32_bf16 v[188:191], a[60:63], a[68:71], 0
 ds_read_b64_tr_b16 a[20:21], v8 offset:49152
 v_mfma_f32_16x16x32_bf16 v[188:191], a[56:59], a[64:67], v[188:191]
 s_waitcnt lgkmcnt(8)
 ds_read_b64_tr_b16 a[22:23], v8 offset:53248
 v_add_u32 v1, 128, v1
 v_add_u32 v2, 0x80000, v2
 s_add_u32 s56, s56, s30
 buffer_load_dword a243, v14, s[36:39], s56 offen
 s_add_u32 s56, s56, s30
 buffer_load_dword a243, v14, s[36:39], s56 offen
 s_add_u32 s56, s56, s30
 s_branch L_kloop_mid
.p2align 6
L_kloop:
 v_mfma_f32_16x16x32_bf16 v[88:91], a[0:3], a[64:67], v[88:91]
 ds_read_b64_tr_b16 a[24:25], v9 offset:0
 v_mfma_f32_16x16x32_bf16 v[88:91], a[4:7], a[68:71], v[88:91]
 ds_read_b64_tr_b16 a[26:27], v9 offset:4096
 v_mfma_f32_16x16x32_bf16 v[80:83], a[4:7], a[76:79], v[80:83]
 ds_read_b64_tr_b16 a[28:29], v9 offset:16384
 v_mfma_f32_16x16x32_bf16 v[80:83], a[0:3], a[72:75], v[80:83]
 ds_read_b64_tr_b16 a[30:31], v9 offset:20480
 v_mfma_f32_16x16x32_bf16 v[72:75], a[0:3], a[80:83], v[72:75]
 ds_read_b128 a[96:99], v4 offset:8192
 v_mfma_f32_16x16x32_bf16 v[72:75], a[4:7], a[84:87], v[72:75]
 v_mfma_f32_16x16x32_bf16 v[64:67], a[4:7], a[92:95], v[64:67]
 s_waitcnt lgkmcnt(8)
 ds_read_b128 a[100:103], v5 offset:8192
 v_mfma_f32_16x16x32_bf16 v[64:67], a[0:3], a[88:91], v[64:67]
 v_mfma_f32_16x16x32_bf16 v[68:71], a[8:11], a[88:91], v[68:71]
 ds_read_b128 a[108:111], v5 offset:10240
 v_mfma_f32_16x16x32_bf16 v[68:71], a[12:15], a[92:95], v[68:71]
 v_mfma_f32_16x16x32_bf16 v[76:79], a[12:15], a[84:87], v[76:79]
 ds_read_b128 a[104:107], v4 offset:10240
 v_mfma_f32_16x16x32_bf16 v[76:79], a[8:11], a[80:83], v[76:79]
 v_mfma_f32_16x16x32_bf16 v[84:87], a[8:11], a[72:75], v[84:87]
 ds_read_b128 a[112:115], v4 offset:12288
 v_mfma_f32_16x16x32_bf16 v[84:87], a[12:15], a[76:79], v[84:87]
 v_mfma_f32_16x16x32_bf16 v[92:95], a[12:15], a[68:71], v[92:95]
 ds_read_b128 a[116:119], v5 offset:12288
 v_mfma_f32_16x16x32_bf16 v[92:95], a[8:11], a[64:67], v[92:95]
 s_waitcnt lgkmcnt(8)
 v_mfma_f32_16x16x32_bf16 v[120:123], a[16:19], a[64:67], v[120:123]
 ds_read_b128 a[124:127], v5 offset:14336
 v_mfma_f32_16x16x32_bf16 v[120:123], a[20:23], a[68:71], v[120:123]
 v_mfma_f32_16x16x32_bf16 v[112:115], a[20:23], a[76:79], v[112:115]
 ds_read_b128 a[120:123], v4 offset:14336
 v_mfma_f32_16x16x32_bf16 v[112:115], a[16:19], a[72:75], v[112:115]
 v_mfma_f32_16x16x32_bf16 v[104:107], a[16:19], a[80:83], v[104:107]
 ds_read_b64_tr_b16 a[32:33], v10 offset:0
 v_mfma_f32_16x16x32_bf16 v[104:107], a[20:23], a[84:87], v[104:107]
 ds_read_b64_tr_b16 a[34:35], v10 offset:4096
 v_mfma_f32_16x16x32_bf16 v[96:99], a[20:23], a[92:95], v[96:99]
 ds_read_b64_tr_b16 a[36:37], v10 offset:16384
 v_mfma_f32_16x16x32_bf16 v[96:99], a[16:19], a[88:91], v[96:99]
 ds_read_b64_tr_b16 a[38:39], v10 offset:20480
 v_mfma_f32_16x16x32_bf16 v[100:103], a[24:27], a[88:91], v[100:103]
 s_waitcnt lgkmcnt(8)
 ds_read_b64_tr_b16 a[40:41], v11 offset:0
 v_mfma_f32_16x16x32_bf16 v[100:103], a[28:31], a[92:95], v[100:103]
 ds_read_b64_tr_b16 a[42:43], v11 offset:4096
 v_mfma_f32_16x16x32_bf16 v[108:111], a[28:31], a[84:87], v[108:111]
 ds_read_b64_tr_b16 a[44:45], v11 offset:16384
 v_mfma_f32_16x16x32_bf16 v[108:111], a[24:27], a[80:83], v[108:111]
 ds_read_b64_tr_b16 a[46:47], v11 offset:20480
 v_mfma_f32_16x16x32_bf16 v[116:119], a[24:27], a[72:75], v[116:119]
 ds_read_b64_tr_b16 a[48:49], v12 offset:0
 v_mfma_f32_16x16x32_bf16 v[116:119], a[28:31], a[76:79], v[116:119]
 ds_read_b64_tr_b16 a[50:51], v12 offset:4096
 v_mfma_f32_16x16x32_bf16 v[124:127], a[28:31], a[68:71], v[124:127]
 ds_read_b64_tr_b16 a[52:53], v12 offset:16384
 v_mfma_f32_16x16x32_bf16 v[124:127], a[24:27], a[64:67], v[124:127]
 ds_read_b64_tr_b16 a[54:55], v12 offset:20480
 v_mfma_f32_16x16x32_bf16 a[232:235], a[0:3], a[96:99], a[232:235]
 ds_read_b64_tr_b16 a[56:57], v13 offset:0
 v_mfma_f32_16x16x32_bf16 a[232:235], a[4:7], a[100:103], a[232:235]
 ds_read_b64_tr_b16 a[58:59], v13 offset:4096
 v_mfma_f32_16x16x32_bf16 a[224:227], a[4:7], a[108:111], a[224:227]
 ds_read_b64_tr_b16 a[60:61], v13 offset:16384
 v_mfma_f32_16x16x32_bf16 a[224:227], a[0:3], a[104:107], a[224:227]
 s_waitcnt lgkmcnt(8)
 ds_read_b64_tr_b16 a[62:63], v13 offset:20480
 v_mfma_f32_16x16x32_bf16 v[24:27], a[0:3], a[112:115], v[24:27]
 v_mfma_f32_16x16x32_bf16 v[24:27], a[4:7], a[116:119], v[24:27]
 v_mfma_f32_16x16x32_bf16 v[16:19], a[4:7], a[124:127], v[16:19]
 v_mfma_f32_16x16x32_bf16 v[16:19], a[0:3], a[120:123], v[16:19]
 s_waitcnt lgkmcnt(0)
 v_mfma_f32_16x16x32_bf16 v[20:23], a[8:11], a[120:123], v[20:23]
 s_barrier
 v_mfma_f32_16x16x32_bf16 v[20:23], a[12:15], a[124:127], v[20:23]
 s_add_u32 m0, s29, 65536
 v_mfma_f32_16x16x32_bf16 v[28:31], a[12:15], a[116:119], v[28:31]
 buffer_load_dwordx4 v2, s[8:11], 0 offen  lds
 v_mfma_f32_16x16x32_bf16 v[28:31], a[8:11], a[112:115], v[28:31]
 v_mfma_f32_16x16x32_bf16 a[228:231], a[8:11], a[104:107], a[228:231]
 v_mfma_f32_16x16x32_bf16 a[228:231], a[12:15], a[108:111], a[228:231]
 v_mfma_f32_16x16x32_bf16 a[236:239], a[12:15], a[100:103], a[236:239]
 s_add_u32 m0, s29, 0
 v_mfma_f32_16x16x32_bf16 a[236:239], a[8:11], a[96:99], a[236:239]
 buffer_load_dwordx4 v1, s[4:7], 0 offen  lds
 v_mfma_f32_16x16x32_bf16 v[56:59], a[16:19], a[96:99], v[56:59]
 v_mfma_f32_16x16x32_bf16 v[56:59], a[20:23], a[100:103], v[56:59]
 v_mfma_f32_16x16x32_bf16 v[48:51], a[20:23], a[108:111], v[48:51]
 v_mfma_f32_16x16x32_bf16 v[48:51], a[16:19], a[104:107], v[48:51]
 s_add_u32 m0, s29, 69632
 v_mfma_f32_16x16x32_bf16 v[40:43], a[16:19], a[112:115], v[40:43]
 buffer_load_dwordx4 v2, s[8:11], s48 offen  lds
 v_mfma_f32_16x16x32_bf16 v[40:43], a[20:23], a[116:119], v[40:43]
 v_mfma_f32_16x16x32_bf16 v[32:35], a[20:23], a[124:127], v[32:35]
 v_mfma_f32_16x16x32_bf16 v[32:35], a[16:19], a[120:123], v[32:35]
 v_mfma_f32_16x16x32_bf16 v[36:39], a[24:27], a[120:123], v[36:39]
 s_add_u32 m0, s29, 4096
 v_mfma_f32_16x16x32_bf16 v[36:39], a[28:31], a[124:127], v[36:39]
 buffer_load_dwordx4 v1, s[4:7], s41 offen  lds
 v_mfma_f32_16x16x32_bf16 v[44:47], a[28:31], a[116:119], v[44:47]
 v_mfma_f32_16x16x32_bf16 v[44:47], a[24:27], a[112:115], v[44:47]
 v_mfma_f32_16x16x32_bf16 v[52:55], a[24:27], a[104:107], v[52:55]
 v_mfma_f32_16x16x32_bf16 v[52:55], a[28:31], a[108:111], v[52:55]
 s_add_u32 m0, s29, 73728
 v_mfma_f32_16x16x32_bf16 v[60:63], a[28:31], a[100:103], v[60:63]
 buffer_load_dwordx4 v2, s[8:11], s49 offen  lds
 v_mfma_f32_16x16x32_bf16 v[60:63], a[24:27], a[96:99], v[60:63]
 v_mfma_f32_16x16x32_bf16 v[216:219], a[32:35], a[96:99], v[216:219]
 v_mfma_f32_16x16x32_bf16 v[216:219], a[36:39], a[100:103], v[216:219]
 v_mfma_f32_16x16x32_bf16 v[208:211], a[36:39], a[108:111], v[208:211]
 s_add_u32 m0, s29, 8192
 v_mfma_f32_16x16x32_bf16 v[208:211], a[32:35], a[104:107], v[208:211]
 buffer_load_dwordx4 v1, s[4:7], s42 offen  lds
 v_mfma_f32_16x16x32_bf16 v[200:203], a[32:35], a[112:115], v[200:203]
 v_mfma_f32_16x16x32_bf16 v[200:203], a[36:39], a[116:119], v[200:203]
 v_mfma_f32_16x16x32_bf16 v[192:195], a[36:39], a[124:127], v[192:195]
 v_mfma_f32_16x16x32_bf16 v[192:195], a[32:35], a[120:123], v[192:195]
 s_add_u32 m0, s29, 77824
 v_mfma_f32_16x16x32_bf16 v[196:199], a[40:43], a[120:123], v[196:199]
 buffer_load_dwordx4 v2, s[8:11], s50 offen  lds
 v_mfma_f32_16x16x32_bf16 v[196:199], a[44:47], a[124:127], v[196:199]
 v_mfma_f32_16x16x32_bf16 v[204:207], a[44:47], a[116:119], v[204:207]
 v_mfma_f32_16x16x32_bf16 v[204:207], a[40:43], a[112:115], v[204:207]
 v_mfma_f32_16x16x32_bf16 v[212:215], a[40:43], a[104:107], v[212:215]
 s_add_u32 m0, s29, 12288
 v_mfma_f32_16x16x32_bf16 v[212:215], a[44:47], a[108:111], v[212:215]
 buffer_load_dwordx4 v1, s[4:7], s43 offen  lds
 v_mfma_f32_16x16x32_bf16 v[220:223], a[44:47], a[100:103], v[220:223]
 v_mfma_f32_16x16x32_bf16 v[220:223], a[40:43], a[96:99], v[220:223]
 v_mfma_f32_16x16x32_bf16 v[248:251], a[48:51], a[96:99], v[248:251]
 v_mfma_f32_16x16x32_bf16 v[248:251], a[52:55], a[100:103], v[248:251]
 s_add_u32 m0, s29, 81920
 v_mfma_f32_16x16x32_bf16 v[240:243], a[52:55], a[108:111], v[240:243]
 buffer_load_dwordx4 v2, s[8:11], s51 offen  lds
 v_mfma_f32_16x16x32_bf16 v[240:243], a[48:51], a[104:107], v[240:243]
 v_mfma_f32_16x16x32_bf16 v[232:235], a[48:51], a[112:115], v[232:235]
 v_mfma_f32_16x16x32_bf16 v[232:235], a[52:55], a[116:119], v[232:235]
 v_mfma_f32_16x16x32_bf16 v[224:227], a[52:55], a[124:127], v[224:227]
 s_add_u32 m0, s29, 16384
 v_mfma_f32_16x16x32_bf16 v[224:227], a[48:51], a[120:123], v[224:227]
 buffer_load_dwordx4 v1, s[4:7], s44 offen  lds
 v_mfma_f32_16x16x32_bf16 v[228:231], a[56:59], a[120:123], v[228:231]
 v_mfma_f32_16x16x32_bf16 v[228:231], a[60:63], a[124:127], v[228:231]
 v_mfma_f32_16x16x32_bf16 v[236:239], a[60:63], a[116:119], v[236:239]
 v_mfma_f32_16x16x32_bf16 v[236:239], a[56:59], a[112:115], v[236:239]
 s_add_u32 m0, s29, 86016
 v_mfma_f32_16x16x32_bf16 v[244:247], a[56:59], a[104:107], v[244:247]
 s_waitcnt vmcnt(11)
 buffer_load_dwordx4 v2, s[8:11], s52 offen  lds
 v_mfma_f32_16x16x32_bf16 v[244:247], a[60:63], a[108:111], v[244:247]
 s_barrier
 ds_read_b64_tr_b16 a[0:1], v6 offset:32768
 v_mfma_f32_16x16x32_bf16 v[252:255], a[60:63], a[100:103], v[252:255]
 ds_read_b64_tr_b16 a[2:3], v6 offset:36864
 v_mfma_f32_16x16x32_bf16 v[252:255], a[56:59], a[96:99], v[252:255]
 ds_read_b128 a[96:99], v4 offset:40960
 v_mfma_f32_16x16x32_bf16 v[152:155], a[32:35], a[64:67], v[152:155]
 s_add_u32 m0, s29, 20480
 v_mfma_f32_16x16x32_bf16 v[152:155], a[36:39], a[68:71], v[152:155]
 buffer_load_dwordx4 v1, s[4:7], s45 offen  lds
 v_mfma_f32_16x16x32_bf16 v[144:147], a[36:39], a[76:79], v[144:147]
 ds_read_b64_tr_b16 a[4:5], v6 offset:49152
 v_mfma_f32_16x16x32_bf16 v[144:147], a[32:35], a[72:75], v[144:147]
 ds_read_b64_tr_b16 a[6:7], v6 offset:53248
 v_mfma_f32_16x16x32_bf16 v[136:139], a[32:35], a[80:83], v[136:139]
 ds_read_b128 a[100:103], v5 offset:40960
 v_mfma_f32_16x16x32_bf16 v[136:139], a[36:39], a[84:87], v[136:139]
 s_add_u32 m0, s29, 90112
 v_mfma_f32_16x16x32_bf16 v[128:131], a[36:39], a[92:95], v[128:131]
 buffer_load_dwordx4 v2, s[8:11], s53 offen  lds
 v_mfma_f32_16x16x32_bf16 v[128:131], a[32:35], a[88:91], v[128:131]
 ds_read_b128 a[108:111], v5 offset:43008
 v_mfma_f32_16x16x32_bf16 v[132:135], a[40:43], a[88:91], v[132:135]
 v_mfma_f32_16x16x32_bf16 v[132:135], a[44:47], a[92:95], v[132:135]
 ds_read_b128 a[104:107], v4 offset:43008
 v_mfma_f32_16x16x32_bf16 v[140:143], a[44:47], a[84:87], v[140:143]
 s_add_u32 m0, s29, 24576
 v_mfma_f32_16x16x32_bf16 v[140:143], a[40:43], a[80:83], v[140:143]
 buffer_load_dwordx4 v1, s[4:7], s46 offen  lds
 v_mfma_f32_16x16x32_bf16 v[148:151], a[40:43], a[72:75], v[148:151]
 ds_read_b128 a[112:115], v4 offset:45056
 v_mfma_f32_16x16x32_bf16 v[148:151], a[44:47], a[76:79], v[148:151]
 v_mfma_f32_16x16x32_bf16 v[156:159], a[44:47], a[68:71], v[156:159]
 ds_read_b128 a[116:119], v5 offset:45056
 v_mfma_f32_16x16x32_bf16 v[156:159], a[40:43], a[64:67], v[156:159]
 s_add_u32 m0, s29, 94208
 v_mfma_f32_16x16x32_bf16 v[184:187], a[48:51], a[64:67], v[184:187]
 buffer_load_dwordx4 v2, s[8:11], s54 offen  lds
 v_mfma_f32_16x16x32_bf16 v[184:187], a[52:55], a[68:71], v[184:187]
 ds_read_b128 a[124:127], v5 offset:47104
 v_mfma_f32_16x16x32_bf16 v[176:179], a[52:55], a[76:79], v[176:179]
 v_mfma_f32_16x16x32_bf16 v[176:179], a[48:51], a[72:75], v[176:179]
 ds_read_b128 a[120:123], v4 offset:47104
 v_mfma_f32_16x16x32_bf16 v[168:171], a[48:51], a[80:83], v[168:171]
 s_add_u32 m0, s29, 28672
 v_mfma_f32_16x16x32_bf16 v[168:171], a[52:55], a[84:87], v[168:171]
 buffer_load_dwordx4 v1, s[4:7], s47 offen  lds
 v_mfma_f32_16x16x32_bf16 v[160:163], a[52:55], a[92:95], v[160:163]
 v_add_u32 v1, 128, v1
 v_add_u32 v2, 0x80000, v2
 v_mfma_f32_16x16x32_bf16 v[160:163], a[48:51], a[88:91], v[160:163]
 ds_read_b64_tr_b16 a[8:9], v7 offset:32768
 v_mfma_f32_16x16x32_bf16 v[164:167], a[56:59], a[88:91], v[164:167]
 buffer_load_dword a243, v14, s[36:39], s56 offen
 v_mfma_f32_16x16x32_bf16 v[164:167], a[60:63], a[92:95], v[164:167]
 s_add_u32 s56, s56, s30
 ds_read_b64_tr_b16 a[10:11], v7 offset:36864
 v_mfma_f32_16x16x32_bf16 v[172:175], a[60:63], a[84:87], v[172:175]
 ds_read_b64_tr_b16 a[12:13], v7 offset:49152
 v_mfma_f32_16x16x32_bf16 v[172:175], a[56:59], a[80:83], v[172:175]
 ds_read_b64_tr_b16 a[14:15], v7 offset:53248
 v_mfma_f32_16x16x32_bf16 v[180:183], a[56:59], a[72:75], v[180:183]
 ds_read_b64_tr_b16 a[16:17], v8 offset:32768
 v_mfma_f32_16x16x32_bf16 v[180:183], a[60:63], a[76:79], v[180:183]
 ds_read_b64_tr_b16 a[18:19], v8 offset:36864
 v_mfma_f32_16x16x32_bf16 v[188:191], a[60:63], a[68:71], v[188:191]
 ds_read_b64_tr_b16 a[20:21], v8 offset:49152
 v_mfma_f32_16x16x32_bf16 v[188:191], a[56:59], a[64:67], v[188:191]
 s_waitcnt lgkmcnt(8)
 ds_read_b64_tr_b16 a[22:23], v8 offset:53248
L_kloop_mid:
 v_mfma_f32_16x16x32_bf16 a[232:235], a[0:3], a[96:99], a[232:235]
 ds_read_b64_tr_b16 a[24:25], v9 offset:32768
 v_mfma_f32_16x16x32_bf16 a[232:235], a[4:7], a[100:103], a[232:235]
 ds_read_b64_tr_b16 a[26:27], v9 offset:36864
 v_mfma_f32_16x16x32_bf16 a[224:227], a[4:7], a[108:111], a[224:227]
 ds_read_b64_tr_b16 a[28:29], v9 offset:49152
 v_mfma_f32_16x16x32_bf16 a[224:227], a[0:3], a[104:107], a[224:227]
 ds_read_b64_tr_b16 a[30:31], v9 offset:53248
 v_mfma_f32_16x16x32_bf16 v[24:27], a[0:3], a[112:115], v[24:27]
 ds_read_b128 a[64:67], v4 offset:32768
 v_mfma_f32_16x16x32_bf16 v[24:27], a[4:7], a[116:119], v[24:27]
 v_mfma_f32_16x16x32_bf16 v[16:19], a[4:7], a[124:127], v[16:19]
 s_waitcnt lgkmcnt(8)
 ds_read_b128 a[68:71], v5 offset:32768
 v_mfma_f32_16x16x32_bf16 v[16:19], a[0:3], a[120:123], v[16:19]
 v_mfma_f32_16x16x32_bf16 v[20:23], a[8:11], a[120:123], v[20:23]
 ds_read_b128 a[76:79], v5 offset:34816
 v_mfma_f32_16x16x32_bf16 v[20:23], a[12:15], a[124:127], v[20:23]
 v_mfma_f32_16x16x32_bf16 v[28:31], a[12:15], a[116:119], v[28:31]
 ds_read_b128 a[72:75], v4 offset:34816
 v_mfma_f32_16x16x32_bf16 v[28:31], a[8:11], a[112:115], v[28:31]
 v_mfma_f32_16x16x32_bf16 a[228:231], a[8:11], a[104:107], a[228:231]
 ds_read_b128 a[80:83], v4 offset:36864
 v_mfma_f32_16x16x32_bf16 a[228:231], a[12:15], a[108:111], a[228:231]
 v_mfma_f32_16x16x32_bf16 a[236:239], a[12:15], a[100:103], a[236:239]
 ds_read_b128 a[84:87], v5 offset:36864
 v_mfma_f32_16x16x32_bf16 a[236:239], a[8:11], a[96:99], a[236:239]
 s_waitcnt lgkmcnt(8)
 v_mfma_f32_16x16x32_bf16 v[56:59], a[16:19], a[96:99], v[56:59]
 ds_read_b128 a[92:95], v5 offset:38912
 v_mfma_f32_16x16x32_bf16 v[56:59], a[20:23], a[100:103], v[56:59]
 v_mfma_f32_16x16x32_bf16 v[48:51], a[20:23], a[108:111], v[48:51]
 ds_read_b128 a[88:91], v4 offset:38912
 v_mfma_f32_16x16x32_bf16 v[48:51], a[16:19], a[104:107], v[48:51]
 v_mfma_f32_16x16x32_bf16 v[40:43], a[16:19], a[112:115], v[40:43]
 ds_read_b64_tr_b16 a[32:33], v10 offset:32768
 v_mfma_f32_16x16x32_bf16 v[40:43], a[20:23], a[116:119], v[40:43]
 ds_read_b64_tr_b16 a[34:35], v10 offset:36864
 v_mfma_f32_16x16x32_bf16 v[32:35], a[20:23], a[124:127], v[32:35]
 ds_read_b64_tr_b16 a[36:37], v10 offset:49152
 v_mfma_f32_16x16x32_bf16 v[32:35], a[16:19], a[120:123], v[32:35]
 ds_read_b64_tr_b16 a[38:39], v10 offset:53248
 v_mfma_f32_16x16x32_bf16 v[36:39], a[24:27], a[120:123], v[36:39]
 s_waitcnt lgkmcnt(8)
 ds_read_b64_tr_b16 a[40:41], v11 offset:32768
 v_mfma_f32_16x16x32_bf16 v[36:39], a[28:31], a[124:127], v[36:39]
 ds_read_b64_tr_b16 a[42:43], v11 offset:36864
 v_mfma_f32_16x16x32_bf16 v[44:47], a[28:31], a[116:119], v[44:47]
 ds_read_b64_tr_b16 a[44:45], v11 offset:49152
 v_mfma_f32_16x16x32_bf16 v[44:47], a[24:27], a[112:115], v[44:47]
 ds_read_b64_tr_b16 a[46:47], v11 offset:53248
 v_mfma_f32_16x16x32_bf16 v[52:55], a[24:27], a[104:107], v[52:55]
 ds_read_b64_tr_b16 a[48:49], v12 offset:32768
 v_mfma_f32_16x16x32_bf16 v[52:55], a[28:31], a[108:111], v[52:55]
 ds_read_b64_tr_b16 a[50:51], v12 offset:36864
 v_mfma_f32_16x16x32_bf16 v[60:63], a[28:31], a[100:103], v[60:63]
 ds_read_b64_tr_b16 a[52:53], v12 offset:49152
 v_mfma_f32_16x16x32_bf16 v[60:63], a[24:27], a[96:99], v[60:63]
 ds_read_b64_tr_b16 a[54:55], v12 offset:53248
 v_mfma_f32_16x16x32_bf16 v[88:91], a[0:3], a[64:67], v[88:91]
 ds_read_b64_tr_b16 a[56:57], v13 offset:32768
 v_mfma_f32_16x16x32_bf16 v[88:91], a[4:7], a[68:71], v[88:91]
 ds_read_b64_tr_b16 a[58:59], v13 offset:36864
 v_mfma_f32_16x16x32_bf16 v[80:83], a[4:7], a[76:79], v[80:83]
 ds_read_b64_tr_b16 a[60:61], v13 offset:49152
 v_mfma_f32_16x16x32_bf16 v[80:83], a[0:3], a[72:75], v[80:83]
 s_waitcnt lgkmcnt(8)
 ds_read_b64_tr_b16 a[62:63], v13 offset:53248
 v_mfma_f32_16x16x32_bf16 v[72:75], a[0:3], a[80:83], v[72:75]
 v_mfma_f32_16x16x32_bf16 v[72:75], a[4:7], a[84:87], v[72:75]
 v_mfma_f32_16x16x32_bf16 v[64:67], a[4:7], a[92:95], v[64:67]
 v_mfma_f32_16x16x32_bf16 v[64:67], a[0:3], a[88:91], v[64:67]
 s_waitcnt lgkmcnt(0)
 v_mfma_f32_16x16x32_bf16 v[68:71], a[8:11], a[88:91], v[68:71]
 s_barrier
 v_mfma_f32_16x16x32_bf16 v[68:71], a[12:15], a[92:95], v[68:71]
 s_add_u32 m0, s29, 98304
 v_mfma_f32_16x16x32_bf16 v[76:79], a[12:15], a[84:87], v[76:79]
 buffer_load_dwordx4 v2, s[8:11], 0 offen  lds
 v_mfma_f32_16x16x32_bf16 v[76:79], a[8:11], a[80:83], v[76:79]
 v_mfma_f32_16x16x32_bf16 v[84:87], a[8:11], a[72:75], v[84:87]
 v_mfma_f32_16x16x32_bf16 v[84:87], a[12:15], a[76:79], v[84:87]
 v_mfma_f32_16x16x32_bf16 v[92:95], a[12:15], a[68:71], v[92:95]
 s_add_u32 m0, s29, 32768
 v_mfma_f32_16x16x32_bf16 v[92:95], a[8:11], a[64:67], v[92:95]
 buffer_load_dwordx4 v1, s[4:7], 0 offen  lds
 v_mfma_f32_16x16x32_bf16 v[120:123], a[16:19], a[64:67], v[120:123]
 v_mfma_f32_16x16x32_bf16 v[120:123], a[20:23], a[68:71], v[120:123]
 v_mfma_f32_16x16x32_bf16 v[112:115], a[20:23], a[76:79], v[112:115]
 v_mfma_f32_16x16x32_bf16 v[112:115], a[16:19], a[72:75], v[112:115]
 s_add_u32 m0, s29, 102400
 v_mfma_f32_16x16x32_bf16 v[104:107], a[16:19], a[80:83], v[104:107]
 buffer_load_dwordx4 v2, s[8:11], s48 offen  lds
 v_mfma_f32_16x16x32_bf16 v[104:107], a[20:23], a[84:87], v[104:107]
 v_mfma_f32_16x16x32_bf16 v[96:99], a[20:23], a[92:95], v[96:99]
 v_mfma_f32_16x16x32_bf16 v[96:99], a[16:19], a[88:91], v[96:99]
 v_mfma_f32_16x16x32_bf16 v[100:103], a[24:27], a[88:91], v[100:103]
 s_add_u32 m0, s29, 36864
 v_mfma_f32_16x16x32_bf16 v[100:103], a[28:31], a[92:95], v[100:103]
 buffer_load_dwordx4 v1, s[4:7], s41 offen  lds
 v_mfma_f32_16x16x32_bf16 v[108:111], a[28:31], a[84:87], v[108:111]
 v_mfma_f32_16x16x32_bf16 v[108:111], a[24:27], a[80:83], v[108:111]
 v_mfma_f32_16x16x32_bf16 v[116:119], a[24:27], a[72:75], v[116:119]
 v_mfma_f32_16x16x32_bf16 v[116:119], a[28:31], a[76:79], v[116:119]
 s_add_u32 m0, s29, 106496
 v_mfma_f32_16x16x32_bf16 v[124:127], a[28:31], a[68:71], v[124:127]
 buffer_load_dwordx4 v2, s[8:11], s49 offen  lds
 v_mfma_f32_16x16x32_bf16 v[124:127], a[24:27], a[64:67], v[124:127]
 v_mfma_f32_16x16x32_bf16 v[152:155], a[32:35], a[64:67], v[152:155]
 v_mfma_f32_16x16x32_bf16 v[152:155], a[36:39], a[68:71], v[152:155]
 v_mfma_f32_16x16x32_bf16 v[144:147], a[36:39], a[76:79], v[144:147]
 s_add_u32 m0, s29, 40960
 v_mfma_f32_16x16x32_bf16 v[144:147], a[32:35], a[72:75], v[144:147]
 buffer_load_dwordx4 v1, s[4:7], s42 offen  lds
 v_mfma_f32_16x16x32_bf16 v[136:139], a[32:35], a[80:83], v[136:139]
 v_mfma_f32_16x16x32_bf16 v[136:139], a[36:39], a[84:87], v[136:139]
 v_mfma_f32_16x16x32_bf16 v[128:131], a[36:39], a[92:95], v[128:131]
 v_mfma_f32_16x16x32_bf16 v[128:131], a[32:35], a[88:91], v[128:131]
 s_add_u32 m0, s29, 110592
 v_mfma_f32_16x16x32_bf16 v[132:135], a[40:43], a[88:91], v[132:135]
 buffer_load_dwordx4 v2, s[8:11], s50 offen  lds
 v_mfma_f32_16x16x32_bf16 v[132:135], a[44:47], a[92:95], v[132:135]
 v_mfma_f32_16x16x32_bf16 v[140:143], a[44:47], a[84:87], v[140:143]
 v_mfma_f32_16x16x32_bf16 v[140:143], a[40:43], a[80:83], v[140:143]
 v_mfma_f32_16x16x32_bf16 v[148:151], a[40:43], a[72:75], v[148:151]
 s_add_u32 m0, s29, 45056
 v_mfma_f32_16x16x32_bf16 v[148:151], a[44:47], a[76:79], v[148:151]
 buffer_load_dwordx4 v1, s[4:7], s43 offen  lds
 v_mfma_f32_16x16x32_bf16 v[156:159], a[44:47], a[68:71], v[156:159]
 v_mfma_f32_16x16x32_bf16 v[156:159], a[40:43], a[64:67], v[156:159]
 v_mfma_f32_16x16x32_bf16 v[184:187], a[48:51], a[64:67], v[184:187]
 v_mfma_f32_16x16x32_bf16 v[184:187], a[52:55], a[68:71], v[184:187]
 s_add_u32 m0, s29, 114688
 v_mfma_f32_16x16x32_bf16 v[176:179], a[52:55], a[76:79], v[176:179]
 buffer_load_dwordx4 v2, s[8:11], s51 offen  lds
 v_mfma_f32_16x16x32_bf16 v[176:179], a[48:51], a[72:75], v[176:179]
 v_mfma_f32_16x16x32_bf16 v[168:171], a[48:51], a[80:83], v[168:171]
 v_mfma_f32_16x16x32_bf16 v[168:171], a[52:55], a[84:87], v[168:171]
 v_mfma_f32_16x16x32_bf16 v[160:163], a[52:55], a[92:95], v[160:163]
 s_add_u32 m0, s29, 49152
 v_mfma_f32_16x16x32_bf16 v[160:163], a[48:51], a[88:91], v[160:163]
 buffer_load_dwordx4 v1, s[4:7], s44 offen  lds
 v_mfma_f32_16x16x32_bf16 v[164:167], a[56:59], a[88:91], v[164:167]
 v_mfma_f32_16x16x32_bf16 v[164:167], a[60:63], a[92:95], v[164:167]
 v_mfma_f32_16x16x32_bf16 v[172:175], a[60:63], a[84:87], v[172:175]
 v_mfma_f32_16x16x32_bf16 v[172:175], a[56:59], a[80:83], v[172:175]
 s_add_u32 m0, s29, 118784
 v_mfma_f32_16x16x32_bf16 v[180:183], a[56:59], a[72:75], v[180:183]
 s_waitcnt vmcnt(11)
 buffer_load_dwordx4 v2, s[8:11], s52 offen  lds
 v_mfma_f32_16x16x32_bf16 v[180:183], a[60:63], a[76:79], v[180:183]
 s_barrier
 ds_read_b64_tr_b16 a[0:1], v6 offset:0
 v_mfma_f32_16x16x32_bf16 v[188:191], a[60:63], a[68:71], v[188:191]
 ds_read_b64_tr_b16 a[2:3], v6 offset:4096
 v_mfma_f32_16x16x32_bf16 v[188:191], a[56:59], a[64:67], v[188:191]
 ds_read_b128 a[64:67], v4 offset:0
 v_mfma_f32_16x16x32_bf16 v[216:219], a[32:35], a[96:99], v[216:219]
 s_add_u32 m0, s29, 53248
 v_mfma_f32_16x16x32_bf16 v[216:219], a[36:39], a[100:103], v[216:219]
 buffer_load_dwordx4 v1, s[4:7], s45 offen  lds
 v_mfma_f32_16x16x32_bf16 v[208:211], a[36:39], a[108:111], v[208:211]
 ds_read_b64_tr_b16 a[4:5], v6 offset:16384
 v_mfma_f32_16x16x32_bf16 v[208:211], a[32:35], a[104:107], v[208:211]
 ds_read_b64_tr_b16 a[6:7], v6 offset:20480
 v_mfma_f32_16x16x32_bf16 v[200:203], a[32:35], a[112:115], v[200:203]
 ds_read_b128 a[68:71], v5 offset:0
 v_mfma_f32_16x16x32_bf16 v[200:203], a[36:39], a[116:119], v[200:203]
 s_add_u32 m0, s29, 122880
 v_mfma_f32_16x16x32_bf16 v[192:195], a[36:39], a[124:127], v[192:195]
 buffer_load_dwordx4 v2, s[8:11], s53 offen  lds
 v_mfma_f32_16x16x32_bf16 v[192:195], a[32:35], a[120:123], v[192:195]
 ds_read_b128 a[76:79], v5 offset:2048
 v_mfma_f32_16x16x32_bf16 v[196:199], a[40:43], a[120:123], v[196:199]
 v_mfma_f32_16x16x32_bf16 v[196:199], a[44:47], a[124:127], v[196:199]
 ds_read_b128 a[72:75], v4 offset:2048
 v_mfma_f32_16x16x32_bf16 v[204:207], a[44:47], a[116:119], v[204:207]
 s_add_u32 m0, s29, 57344
 v_mfma_f32_16x16x32_bf16 v[204:207], a[40:43], a[112:115], v[204:207]
 buffer_load_dwordx4 v1, s[4:7], s46 offen  lds
 v_mfma_f32_16x16x32_bf16 v[212:215], a[40:43], a[104:107], v[212:215]
 ds_read_b128 a[80:83], v4 offset:4096
 v_mfma_f32_16x16x32_bf16 v[212:215], a[44:47], a[108:111], v[212:215]
 v_mfma_f32_16x16x32_bf16 v[220:223], a[44:47], a[100:103], v[220:223]
 ds_read_b128 a[84:87], v5 offset:4096
 v_mfma_f32_16x16x32_bf16 v[220:223], a[40:43], a[96:99], v[220:223]
 s_add_u32 m0, s29, 126976
 v_mfma_f32_16x16x32_bf16 v[248:251], a[48:51], a[96:99], v[248:251]
 buffer_load_dwordx4 v2, s[8:11], s54 offen  lds
 v_mfma_f32_16x16x32_bf16 v[248:251], a[52:55], a[100:103], v[248:251]
 ds_read_b128 a[92:95], v5 offset:6144
 v_mfma_f32_16x16x32_bf16 v[240:243], a[52:55], a[108:111], v[240:243]
 v_mfma_f32_16x16x32_bf16 v[240:243], a[48:51], a[104:107], v[240:243]
 ds_read_b128 a[88:91], v4 offset:6144
 v_mfma_f32_16x16x32_bf16 v[232:235], a[48:51], a[112:115], v[232:235]
 s_add_u32 m0, s29, 61440
 v_mfma_f32_16x16x32_bf16 v[232:235], a[52:55], a[116:119], v[232:235]
 buffer_load_dwordx4 v1, s[4:7], s47 offen  lds
 v_mfma_f32_16x16x32_bf16 v[224:227], a[52:55], a[124:127], v[224:227]
 v_add_u32 v1, 128, v1
 v_add_u32 v2, 0x80000, v2
 v_mfma_f32_16x16x32_bf16 v[224:227], a[48:51], a[120:123], v[224:227]
 ds_read_b64_tr_b16 a[8:9], v7 offset:0
 v_mfma_f32_16x16x32_bf16 v[228:231], a[56:59], a[120:123], v[228:231]
 buffer_load_dword a243, v14, s[36:39], s56 offen
 v_mfma_f32_16x16x32_bf16 v[228:231], a[60:63], a[124:127], v[228:231]
 s_add_u32 s56, s56, s30
 ds_read_b64_tr_b16 a[10:11], v7 offset:4096
 v_mfma_f32_16x16x32_bf16 v[236:239], a[60:63], a[116:119], v[236:239]
 ds_read_b64_tr_b16 a[12:13], v7 offset:16384
 v_mfma_f32_16x16x32_bf16 v[236:239], a[56:59], a[112:115], v[236:239]
 ds_read_b64_tr_b16 a[14:15], v7 offset:20480
 v_mfma_f32_16x16x32_bf16 v[244:247], a[56:59], a[104:107], v[244:247]
 ds_read_b64_tr_b16 a[16:17], v8 offset:0
 v_mfma_f32_16x16x32_bf16 v[244:247], a[60:63], a[108:111], v[244:247]
 s_add_u32 s61, s61, 1
 ds_read_b64_tr_b16 a[18:19], v8 offset:4096
 v_mfma_f32_16x16x32_bf16 v[252:255], a[60:63], a[100:103], v[252:255]
 s_cmp_lt_u32 s61, s55
 ds_read_b64_tr_b16 a[20:21], v8 offset:16384
 v_mfma_f32_16x16x32_bf16 v[252:255], a[56:59], a[96:99], v[252:255]
 s_waitcnt lgkmcnt(8)
 ds_read_b64_tr_b16 a[22:23], v8 offset:20480
 s_cbranch_scc1 L_kloop
 s_cmp_lt_u32 s61, 6
 s_cbranch_scc1 L_kloop_side
 v_mfma_f32_16x16x32_bf16 v[88:91], a[0:3], a[64:67], v[88:91]
 ds_read_b64_tr_b16 a[24:25], v9 offset:0
 v_accvgpr_read_b32 v15, a240
 v_mfma_f32_16x16x32_bf16 v[88:91], a[4:7], a[68:71], v[88:91]
 ds_read_b64_tr_b16 a[26:27], v9 offset:4096
 v_accvgpr_read_b32 v14, a242
 v_mfma_f32_16x16x32_bf16 v[80:83], a[4:7], a[76:79], v[80:83]
 s_waitcnt lgkmcnt(12)
 ds_read_b64_tr_b16 a[28:29], v9 offset:16384
 v_xor_b32 v3, 64, v14
 v_mfma_f32_16x16x32_bf16 v[80:83], a[0:3], a[72:75], v[80:83]
 ds_read_b64_tr_b16 a[30:31], v9 offset:20480
 v_mfma_f32_16x16x32_bf16 v[72:75], a[0:3], a[80:83], v[72:75]
 s_add_u32 m0, s33, 0x0
 ds_read_b128 a[96:99], v4 offset:8192
 v_mfma_f32_16x16x32_bf16 v[72:75], a[4:7], a[84:87], v[72:75]
 s_waitcnt lgkmcnt(11)
 v_mfma_f32_16x16x32_bf16 v[64:67], a[4:7], a[92:95], v[64:67]
 ds_read_b128 a[100:103], v5 offset:8192
 buffer_load_dwordx4 v15, s[20:23], 0 offen offset:0 lds
 v_mfma_f32_16x16x32_bf16 v[64:67], a[0:3], a[88:91], v[64:67]
 v_mfma_f32_16x16x32_bf16 v[68:71], a[8:11], a[88:91], v[68:71]
 s_waitcnt lgkmcnt(10)
 ds_read_b128 a[108:111], v5 offset:10240
 v_mfma_f32_16x16x32_bf16 v[68:71], a[12:15], a[92:95], v[68:71]
 s_add_u32 m0, s33, 0x80
 v_mfma_f32_16x16x32_bf16 v[76:79], a[12:15], a[84:87], v[76:79]
 ds_read_b128 a[104:107], v4 offset:10240
 buffer_load_dwordx4 v15, s[20:23], 0 offen offset:896 lds
 v_mfma_f32_16x16x32_bf16 v[76:79], a[8:11], a[80:83], v[76:79]
 v_mfma_f32_16x16x32_bf16 v[84:87], a[8:11], a[72:75], v[84:87]
 ds_read_b128 a[112:115], v4 offset:12288
 v_mfma_f32_16x16x32_bf16 v[84:87], a[12:15], a[76:79], v[84:87]
 s_add_u32 m0, s33, 0x800
 v_mfma_f32_16x16x32_bf16 v[92:95], a[12:15], a[68:71], v[92:95]
 ds_read_b128 a[116:119], v5 offset:12288
 buffer_load_dwordx4 v15, s[20:23], s57 offen offset:0 lds
 v_mfma_f32_16x16x32_bf16 v[92:95], a[8:11], a[64:67], v[92:95]
 s_waitcnt lgkmcnt(10)
 v_mfma_f32_16x16x32_bf16 v[120:123], a[16:19], a[64:67], v[120:123]
 ds_read_b128 a[124:127], v5 offset:14336
 v_mfma_f32_16x16x32_bf16 v[120:123], a[20:23], a[68:71], v[120:123]
 s_add_u32 m0, s33, 0x880
 v_mfma_f32_16x16x32_bf16 v[112:115], a[20:23], a[76:79], v[112:115]
 ds_read_b128 a[120:123], v4 offset:14336
 buffer_load_dwordx4 v15, s[20:23], s57 offen offset:896 lds
 v_mfma_f32_16x16x32_bf16 v[112:115], a[16:19], a[72:75], v[112:115]
 v_mfma_f32_16x16x32_bf16 v[104:107], a[16:19], a[80:83], v[104:107]
 ds_read_b64_tr_b16 a[32:33], v10 offset:0
 v_mfma_f32_16x16x32_bf16 v[104:107], a[20:23], a[84:87], v[104:107]
 s_add_u32 m0, s33, 0xf80
 ds_read_b64_tr_b16 a[34:35], v10 offset:4096
 v_mfma_f32_16x16x32_bf16 v[96:99], a[20:23], a[92:95], v[96:99]
 ds_read_b64_tr_b16 a[36:37], v10 offset:16384
 buffer_load_dwordx4 v15, s[20:23], 0 offen offset:128 lds
 v_mfma_f32_16x16x32_bf16 v[96:99], a[16:19], a[88:91], v[96:99]
 s_waitcnt lgkmcnt(11)
 ds_read_b64_tr_b16 a[38:39], v10 offset:20480
 v_mfma_f32_16x16x32_bf16 v[100:103], a[24:27], a[88:91], v[100:103]
 ds_read_b64_tr_b16 a[40:41], v11 offset:0
 v_mfma_f32_16x16x32_bf16 v[100:103], a[28:31], a[92:95], v[100:103]
 s_add_u32 m0, s33, 0x1000
 ds_read_b64_tr_b16 a[42:43], v11 offset:4096
 v_mfma_f32_16x16x32_bf16 v[108:111], a[28:31], a[84:87], v[108:111]
 ds_read_b64_tr_b16 a[44:45], v11 offset:16384
 buffer_load_dwordx4 v15, s[20:23], 0 offen offset:1024 lds
 v_mfma_f32_16x16x32_bf16 v[108:111], a[24:27], a[80:83], v[108:111]
 ds_read_b64_tr_b16 a[46:47], v11 offset:20480
 v_mfma_f32_16x16x32_bf16 v[116:119], a[24:27], a[72:75], v[116:119]
 ds_read_b64_tr_b16 a[48:49], v12 offset:0
 v_mfma_f32_16x16x32_bf16 v[116:119], a[28:31], a[76:79], v[116:119]
 s_add_u32 m0, s33, 0x1780
 ds_read_b64_tr_b16 a[50:51], v12 offset:4096
 v_mfma_f32_16x16x32_bf16 v[124:127], a[28:31], a[68:71], v[124:127]
 ds_read_b64_tr_b16 a[52:53], v12 offset:16384
 buffer_load_dwordx4 v15, s[20:23], s57 offen offset:128 lds
 v_mfma_f32_16x16x32_bf16 v[124:127], a[24:27], a[64:67], v[124:127]
 s_waitcnt lgkmcnt(15)
 ds_read_b64_tr_b16 a[54:55], v12 offset:20480
 v_mfma_f32_16x16x32_bf16 a[232:235], a[0:3], a[96:99], a[232:235]
 ds_read_b64_tr_b16 a[56:57], v13 offset:0
 v_mfma_f32_16x16x32_bf16 a[232:235], a[4:7], a[100:103], a[232:235]
 s_add_u32 m0, s33, 0x1800
 ds_read_b64_tr_b16 a[58:59], v13 offset:4096
 v_mfma_f32_16x16x32_bf16 a[224:227], a[4:7], a[108:111], a[224:227]
 ds_read_b64_tr_b16 a[60:61], v13 offset:16384
 buffer_load_dwordx4 v15, s[20:23], s57 offen offset:1024 lds
 v_mfma_f32_16x16x32_bf16 a[224:227], a[0:3], a[104:107], a[224:227]
 s_waitcnt lgkmcnt(15)
 ds_read_b64_tr_b16 a[62:63], v13 offset:20480
 v_mfma_f32_16x16x32_bf16 v[24:27], a[0:3], a[112:115], v[24:27]
 v_mfma_f32_16x16x32_bf16 v[24:27], a[4:7], a[116:119], v[24:27]
 v_mfma_f32_16x16x32_bf16 v[16:19], a[4:7], a[124:127], v[16:19]
 v_mfma_f32_16x16x32_bf16 v[16:19], a[0:3], a[120:123], v[16:19]
 s_waitcnt lgkmcnt(0)
 v_mfma_f32_16x16x32_bf16 v[20:23], a[8:11], a[120:123], v[20:23]
 s_barrier
 v_mfma_f32_16x16x32_bf16 v[20:23], a[12:15], a[124:127], v[20:23]
 s_add_u32 m0, s29, 65536
 v_mfma_f32_16x16x32_bf16 v[28:31], a[12:15], a[116:119], v[28:31]
 buffer_load_dwordx4 v2, s[8:11], 0 offen  lds
 v_mfma_f32_16x16x32_bf16 v[28:31], a[8:11], a[112:115], v[28:31]
 v_mfma_f32_16x16x32_bf16 a[228:231], a[8:11], a[104:107], a[228:231]
 v_mfma_f32_16x16x32_bf16 a[228:231], a[12:15], a[108:111], a[228:231]
 v_mfma_f32_16x16x32_bf16 a[236:239], a[12:15], a[100:103], a[236:239]
 s_add_u32 m0, s29, 0
 v_mfma_f32_16x16x32_bf16 a[236:239], a[8:11], a[96:99], a[236:239]
 buffer_load_dwordx4 v1, s[4:7], 0 offen  lds
 v_mfma_f32_16x16x32_bf16 v[56:59], a[16:19], a[96:99], v[56:59]
 v_mfma_f32_16x16x32_bf16 v[56:59], a[20:23], a[100:103], v[56:59]
 v_mfma_f32_16x16x32_bf16 v[48:51], a[20:23], a[108:111], v[48:51]
 v_mfma_f32_16x16x32_bf16 v[48:51], a[16:19], a[104:107], v[48:51]
 s_add_u32 m0, s29, 69632
 v_mfma_f32_16x16x32_bf16 v[40:43], a[16:19], a[112:115], v[40:43]
 buffer_load_dwordx4 v2, s[8:11], s48 offen  lds
 v_mfma_f32_16x16x32_bf16 v[40:43], a[20:23], a[116:119], v[40:43]
 v_mfma_f32_16x16x32_bf16 v[32:35], a[20:23], a[124:127], v[32:35]
 v_mfma_f32_16x16x32_bf16 v[32:35], a[16:19], a[120:123], v[32:35]
 v_mfma_f32_16x16x32_bf16 v[36:39], a[24:27], a[120:123], v[36:39]
 s_add_u32 m0, s29, 4096
 v_mfma_f32_16x16x32_bf16 v[36:39], a[28:31], a[124:127], v[36:39]
 buffer_load_dwordx4 v1, s[4:7], s41 offen  lds
 v_mfma_f32_16x16x32_bf16 v[44:47], a[28:31], a[116:119], v[44:47]
 v_mfma_f32_16x16x32_bf16 v[44:47], a[24:27], a[112:115], v[44:47]
 v_mfma_f32_16x16x32_bf16 v[52:55], a[24:27], a[104:107], v[52:55]
 v_mfma_f32_16x16x32_bf16 v[52:55], a[28:31], a[108:111], v[52:55]
 s_add_u32 m0, s29, 73728
 v_mfma_f32_16x16x32_bf16 v[60:63], a[28:31], a[100:103], v[60:63]
 buffer_load_dwordx4 v2, s[8:11], s49 offen  lds
 v_mfma_f32_16x16x32_bf16 v[60:63], a[24:27], a[96:99], v[60:63]
 v_mfma_f32_16x16x32_bf16 v[216:219], a[32:35], a[96:99], v[216:219]
 v_mfma_f32_16x16x32_bf16 v[216:219], a[36:39], a[100:103], v[216:219]
 v_mfma_f32_16x16x32_bf16 v[208:211], a[36:39], a[108:111], v[208:211]
 s_add_u32 m0, s29, 8192
 v_mfma_f32_16x16x32_bf16 v[208:211], a[32:35], a[104:107], v[208:211]
 buffer_load_dwordx4 v1, s[4:7], s42 offen  lds
 v_mfma_f32_16x16x32_bf16 v[200:203], a[32:35], a[112:115], v[200:203]
 v_mfma_f32_16x16x32_bf16 v[200:203], a[36:39], a[116:119], v[200:203]
 v_mfma_f32_16x16x32_bf16 v[192:195], a[36:39], a[124:127], v[192:195]
 v_mfma_f32_16x16x32_bf16 v[192:195], a[32:35], a[120:123], v[192:195]
 s_add_u32 m0, s29, 77824
 v_mfma_f32_16x16x32_bf16 v[196:199], a[40:43], a[120:123], v[196:199]
 buffer_load_dwordx4 v2, s[8:11], s50 offen  lds
 v_mfma_f32_16x16x32_bf16 v[196:199], a[44:47], a[124:127], v[196:199]
 v_mfma_f32_16x16x32_bf16 v[204:207], a[44:47], a[116:119], v[204:207]
 v_mfma_f32_16x16x32_bf16 v[204:207], a[40:43], a[112:115], v[204:207]
 v_mfma_f32_16x16x32_bf16 v[212:215], a[40:43], a[104:107], v[212:215]
 s_add_u32 m0, s29, 12288
 v_mfma_f32_16x16x32_bf16 v[212:215], a[44:47], a[108:111], v[212:215]
 buffer_load_dwordx4 v1, s[4:7], s43 offen  lds
 v_mfma_f32_16x16x32_bf16 v[220:223], a[44:47], a[100:103], v[220:223]
 v_mfma_f32_16x16x32_bf16 v[220:223], a[40:43], a[96:99], v[220:223]
 v_mfma_f32_16x16x32_bf16 v[248:251], a[48:51], a[96:99], v[248:251]
 v_mfma_f32_16x16x32_bf16 v[248:251], a[52:55], a[100:103], v[248:251]
 s_add_u32 m0, s29, 81920
 v_mfma_f32_16x16x32_bf16 v[240:243], a[52:55], a[108:111], v[240:243]
 buffer_load_dwordx4 v2, s[8:11], s51 offen  lds
 v_mfma_f32_16x16x32_bf16 v[240:243], a[48:51], a[104:107], v[240:243]
 v_mfma_f32_16x16x32_bf16 v[232:235], a[48:51], a[112:115], v[232:235]
 v_mfma_f32_16x16x32_bf16 v[232:235], a[52:55], a[116:119], v[232:235]
 v_mfma_f32_16x16x32_bf16 v[224:227], a[52:55], a[124:127], v[224:227]
 s_add_u32 m0, s29, 16384
 v_mfma_f32_16x16x32_bf16 v[224:227], a[48:51], a[120:123], v[224:227]
 buffer_load_dwordx4 v1, s[4:7], s44 offen  lds
 v_mfma_f32_16x16x32_bf16 v[228:231], a[56:59], a[120:123], v[228:231]
 v_mfma_f32_16x16x32_bf16 v[228:231], a[60:63], a[124:127], v[228:231]
 v_mfma_f32_16x16x32_bf16 v[236:239], a[60:63], a[116:119], v[236:239]
 v_mfma_f32_16x16x32_bf16 v[236:239], a[56:59], a[112:115], v[236:239]
 s_add_u32 m0, s29, 86016
 v_mfma_f32_16x16x32_bf16 v[244:247], a[56:59], a[104:107], v[244:247]
 s_waitcnt vmcnt(10)
 buffer_load_dwordx4 v2, s[8:11], s52 offen  lds
 v_mfma_f32_16x16x32_bf16 v[244:247], a[60:63], a[108:111], v[244:247]
 s_barrier
 ds_read_b64_tr_b16 a[0:1], v6 offset:32768
 v_mfma_f32_16x16x32_bf16 v[252:255], a[60:63], a[100:103], v[252:255]
 ds_read_b64_tr_b16 a[2:3], v6 offset:36864
 v_mfma_f32_16x16x32_bf16 v[252:255], a[56:59], a[96:99], v[252:255]
 ds_read_b128 a[96:99], v4 offset:40960
 v_mfma_f32_16x16x32_bf16 v[152:155], a[32:35], a[64:67], v[152:155]
 s_add_u32 m0, s29, 20480
 ds_read_b128 a[128:131], v14 offset:0
 v_mfma_f32_16x16x32_bf16 v[152:155], a[36:39], a[68:71], v[152:155]
 buffer_load_dwordx4 v1, s[4:7], s45 offen  lds
 v_mfma_f32_16x16x32_bf16 v[144:147], a[36:39], a[76:79], v[144:147]
 ds_read_b64_tr_b16 a[4:5], v6 offset:49152
 v_mfma_f32_16x16x32_bf16 v[144:147], a[32:35], a[72:75], v[144:147]
 ds_read_b64_tr_b16 a[6:7], v6 offset:53248
 v_mfma_f32_16x16x32_bf16 v[136:139], a[32:35], a[80:83], v[136:139]
 ds_read_b128 a[100:103], v5 offset:40960
 v_mfma_f32_16x16x32_bf16 v[136:139], a[36:39], a[84:87], v[136:139]
 s_add_u32 m0, s29, 90112
 ds_read_b128 a[136:139], v3 offset:0
 v_mfma_f32_16x16x32_bf16 v[128:131], a[36:39], a[92:95], v[128:131]
 buffer_load_dwordx4 v2, s[8:11], s53 offen  lds
 v_mfma_f32_16x16x32_bf16 v[128:131], a[32:35], a[88:91], v[128:131]
 ds_read_b128 a[108:111], v5 offset:43008
 v_mfma_f32_16x16x32_bf16 v[132:135], a[40:43], a[88:91], v[132:135]
 ds_read_b128 a[132:135], v14 offset:2048
 v_mfma_f32_16x16x32_bf16 v[132:135], a[44:47], a[92:95], v[132:135]
 ds_read_b128 a[104:107], v4 offset:43008
 v_mfma_f32_16x16x32_bf16 v[140:143], a[44:47], a[84:87], v[140:143]
 s_add_u32 m0, s29, 24576
 ds_read_b128 a[140:143], v3 offset:2048
 v_mfma_f32_16x16x32_bf16 v[140:143], a[40:43], a[80:83], v[140:143]
 buffer_load_dwordx4 v1, s[4:7], s46 offen  lds
 v_mfma_f32_16x16x32_bf16 v[148:151], a[40:43], a[72:75], v[148:151]
 ds_read_b128 a[112:115], v4 offset:45056
 v_mfma_f32_16x16x32_bf16 v[148:151], a[44:47], a[76:79], v[148:151]
 ds_read_b128 a[144:147], v14 offset:4096
 v_mfma_f32_16x16x32_bf16 v[156:159], a[44:47], a[68:71], v[156:159]
 ds_read_b128 a[116:119], v5 offset:45056
 v_mfma_f32_16x16x32_bf16 v[156:159], a[40:43], a[64:67], v[156:159]
 s_add_u32 m0, s29, 94208
 ds_read_b128 a[152:155], v3 offset:4096
 v_mfma_f32_16x16x32_bf16 v[184:187], a[48:51], a[64:67], v[184:187]
 buffer_load_dwordx4 v2, s[8:11], s54 offen  lds
 v_mfma_f32_16x16x32_bf16 v[184:187], a[52:55], a[68:71], v[184:187]
 ds_read_b128 a[124:127], v5 offset:47104
 v_mfma_f32_16x16x32_bf16 v[176:179], a[52:55], a[76:79], v[176:179]
 ds_read_b128 a[148:151], v14 offset:6144
 v_mfma_f32_16x16x32_bf16 v[176:179], a[48:51], a[72:75], v[176:179]
 ds_read_b128 a[120:123], v4 offset:47104
 v_mfma_f32_16x16x32_bf16 v[168:171], a[48:51], a[80:83], v[168:171]
 s_add_u32 m0, s29, 28672
 ds_read_b128 a[156:159], v3 offset:6144
 v_mfma_f32_16x16x32_bf16 v[168:171], a[52:55], a[84:87], v[168:171]
 buffer_load_dwordx4 v1, s[4:7], s47 offen  lds
 v_mfma_f32_16x16x32_bf16 v[160:163], a[52:55], a[92:95], v[160:163]
 v_add_u32 v1, 128, v1
 v_add_u32 v2, 0x80000, v2
 v_mfma_f32_16x16x32_bf16 v[160:163], a[48:51], a[88:91], v[160:163]
 ds_read_b64_tr_b16 a[8:9], v7 offset:32768
 v_mfma_f32_16x16x32_bf16 v[164:167], a[56:59], a[88:91], v[164:167]
 v_mfma_f32_16x16x32_bf16 v[164:167], a[60:63], a[92:95], v[164:167]
 ds_read_b64_tr_b16 a[10:11], v7 offset:36864
 v_mfma_f32_16x16x32_bf16 v[172:175], a[60:63], a[84:87], v[172:175]
 ds_read_b64_tr_b16 a[12:13], v7 offset:49152
 v_mfma_f32_16x16x32_bf16 v[172:175], a[56:59], a[80:83], v[172:175]
 ds_read_b64_tr_b16 a[14:15], v7 offset:53248
 v_mfma_f32_16x16x32_bf16 v[180:183], a[56:59], a[72:75], v[180:183]
 ds_read_b64_tr_b16 a[16:17], v8 offset:32768
 v_mfma_f32_16x16x32_bf16 v[180:183], a[60:63], a[76:79], v[180:183]
 ds_read_b64_tr_b16 a[18:19], v8 offset:36864
 v_mfma_f32_16x16x32_bf16 v[188:191], a[60:63], a[68:71], v[188:191]
 ds_read_b64_tr_b16 a[20:21], v8 offset:49152
 v_mfma_f32_16x16x32_bf16 v[188:191], a[56:59], a[64:67], v[188:191]
 s_waitcnt lgkmcnt(15)
 ds_read_b64_tr_b16 a[22:23], v8 offset:53248
 v_mfma_f32_16x16x32_bf16 a[232:235], a[0:3], a[96:99], a[232:235]
 ds_read_b64_tr_b16 a[24:25], v9 offset:32768
 v_mfma_f32_16x16x32_bf16 a[232:235], a[4:7], a[100:103], a[232:235]
 s_add_u32 m0, s33, 0xffffff00
 ds_read_b64_tr_b16 a[26:27], v9 offset:36864
 v_mfma_f32_16x16x32_bf16 a[224:227], a[4:7], a[108:111], a[224:227]
 s_waitcnt lgkmcnt(10)
 ds_read_b64_tr_b16 a[28:29], v9 offset:49152
 v_mfma_f32_16x16x32_bf16 a[224:227], a[0:3], a[104:107], a[224:227]
 ds_read_b64_tr_b16 a[30:31], v9 offset:53248
 buffer_load_dwordx4 v15, s[20:23], 0 offen offset:256 lds
 v_mfma_f32_16x16x32_bf16 v[24:27], a[0:3], a[112:115], v[24:27]
 ds_read_b128 a[64:67], v4 offset:32768
 v_mfma_f32_16x16x32_bf16 v[24:27], a[4:7], a[116:119], v[24:27]
 v_mfma_f32_16x16x32_bf16 v[16:19], a[4:7], a[124:127], v[16:19]
 s_add_u32 m0, s33, 0xffffff80
 ds_read_b128 a[68:71], v5 offset:32768
 v_mfma_f32_16x16x32_bf16 v[16:19], a[0:3], a[120:123], v[16:19]
 s_waitcnt lgkmcnt(10)
 buffer_load_dwordx4 v15, s[20:23], 0 offen offset:1152 lds
 v_mfma_f32_16x16x32_bf16 v[20:23], a[8:11], a[120:123], v[20:23]
 ds_read_b128 a[76:79], v5 offset:34816
 v_mfma_f32_16x16x32_bf16 v[20:23], a[12:15], a[124:127], v[20:23]
 v_mfma_f32_16x16x32_bf16 v[28:31], a[12:15], a[116:119], v[28:31]
 s_add_u32 m0, s33, 0x700
 ds_read_b128 a[72:75], v4 offset:34816
 v_mfma_f32_16x16x32_bf16 v[28:31], a[8:11], a[112:115], v[28:31]
 buffer_load_dwordx4 v15, s[20:23], s57 offen offset:256 lds
 v_mfma_f32_16x16x32_bf16 a[228:231], a[8:11], a[104:107], a[228:231]
 ds_read_b128 a[80:83], v4 offset:36864
 v_mfma_f32_16x16x32_bf16 a[228:231], a[12:15], a[108:111], a[228:231]
 v_mfma_f32_16x16x32_bf16 a[236:239], a[12:15], a[100:103], a[236:239]
 s_add_u32 m0, s33, 0x780
 ds_read_b128 a[84:87], v5 offset:36864
 v_mfma_f32_16x16x32_bf16 a[236:239], a[8:11], a[96:99], a[236:239]
 s_waitcnt lgkmcnt(10)
 buffer_load_dwordx4 v15, s[20:23], s57 offen offset:1152 lds
 v_mfma_f32_16x16x32_bf16 v[56:59], a[16:19], a[96:99], v[56:59]
 ds_read_b128 a[92:95], v5 offset:38912
 v_mfma_f32_16x16x32_bf16 v[56:59], a[20:23], a[100:103], v[56:59]
 v_mfma_f32_16x16x32_bf16 v[48:51], a[20:23], a[108:111], v[48:51]
 s_add_u32 m0, s33, 0xe80
 ds_read_b128 a[88:91], v4 offset:38912
 v_mfma_f32_16x16x32_bf16 v[48:51], a[16:19], a[104:107], v[48:51]
 buffer_load_dwordx4 v15, s[20:23], 0 offen offset:384 lds
 v_mfma_f32_16x16x32_bf16 v[40:43], a[16:19], a[112:115], v[40:43]
 ds_read_b64_tr_b16 a[32:33], v10 offset:32768
 v_mfma_f32_16x16x32_bf16 v[40:43], a[20:23], a[116:119], v[40:43]
 ds_read_b64_tr_b16 a[34:35], v10 offset:36864
 v_mfma_f32_16x16x32_bf16 v[32:35], a[20:23], a[124:127], v[32:35]
 s_add_u32 m0, s33, 0xf00
 ds_read_b64_tr_b16 a[36:37], v10 offset:49152
 v_mfma_f32_16x16x32_bf16 v[32:35], a[16:19], a[120:123], v[32:35]
 s_waitcnt lgkmcnt(11)
 ds_read_b64_tr_b16 a[38:39], v10 offset:53248
 buffer_load_dwordx4 v15, s[20:23], 0 offen offset:1280 lds
 v_mfma_f32_16x16x32_bf16 v[36:39], a[24:27], a[120:123], v[36:39]
 ds_read_b64_tr_b16 a[40:41], v11 offset:32768
 v_mfma_f32_16x16x32_bf16 v[36:39], a[28:31], a[124:127], v[36:39]
 ds_read_b64_tr_b16 a[42:43], v11 offset:36864
 v_mfma_f32_16x16x32_bf16 v[44:47], a[28:31], a[116:119], v[44:47]
 s_add_u32 m0, s33, 0x1680
 ds_read_b64_tr_b16 a[44:45], v11 offset:49152
 v_mfma_f32_16x16x32_bf16 v[44:47], a[24:27], a[112:115], v[44:47]
 ds_read_b64_tr_b16 a[46:47], v11 offset:53248
 buffer_load_dwordx4 v15, s[20:23], s57 offen offset:384 lds
 v_mfma_f32_16x16x32_bf16 v[52:55], a[24:27], a[104:107], v[52:55]
 ds_read_b64_tr_b16 a[48:49], v12 offset:32768
 v_mfma_f32_16x16x32_bf16 v[52:55], a[28:31], a[108:111], v[52:55]
 ds_read_b64_tr_b16 a[50:51], v12 offset:36864
 v_mfma_f32_16x16x32_bf16 v[60:63], a[28:31], a[100:103], v[60:63]
 s_add_u32 m0, s33, 0x1700
 ds_read_b64_tr_b16 a[52:53], v12 offset:49152
 v_mfma_f32_16x16x32_bf16 v[60:63], a[24:27], a[96:99], v[60:63]
 s_waitcnt lgkmcnt(15)
 ds_read_b64_tr_b16 a[54:55], v12 offset:53248
 buffer_load_dwordx4 v15, s[20:23], s57 offen offset:1280 lds
 v_mfma_f32_16x16x32_bf16 v[88:91], a[0:3], a[64:67], v[88:91]
 ds_read_b64_tr_b16 a[56:57], v13 offset:32768
 v_mfma_f32_16x16x32_bf16 v[88:91], a[4:7], a[68:71], v[88:91]
 ds_read_b64_tr_b16 a[58:59], v13 offset:36864
 v_mfma_f32_16x16x32_bf16 v[80:83], a[4:7], a[76:79], v[80:83]
 ds_read_b64_tr_b16 a[60:61], v13 offset:49152
 v_mfma_f32_16x16x32_bf16 v[80:83], a[0:3], a[72:75], v[80:83]
 s_waitcnt lgkmcnt(15)
 ds_read_b64_tr_b16 a[62:63], v13 offset:53248
 v_mfma_f32_16x16x32_bf16 v[72:75], a[0:3], a[80:83], v[72:75]
 v_mfma_f32_16x16x32_bf16 v[72:75], a[4:7], a[84:87], v[72:75]
 v_mfma_f32_16x16x32_bf16 v[64:67], a[4:7], a[92:95], v[64:67]
 v_mfma_f32_16x16x32_bf16 v[64:67], a[0:3], a[88:91], v[64:67]
 s_waitcnt lgkmcnt(0)
 v_mfma_f32_16x16x32_bf16 v[68:71], a[8:11], a[88:91], v[68:71]
 s_barrier
 v_mfma_f32_16x16x32_bf16 v[68:71], a[12:15], a[92:95], v[68:71]
 s_add_u32 m0, s29, 98304
 v_mfma_f32_16x16x32_bf16 v[76:79], a[12:15], a[84:87], v[76:79]
 buffer_load_dwordx4 v2, s[8:11], 0 offen  lds
 v_mfma_f32_16x16x32_bf16 v[76:79], a[8:11], a[80:83], v[76:79]
 v_mfma_f32_16x16x32_bf16 v[84:87], a[8:11], a[72:75], v[84:87]
 v_mfma_f32_16x16x32_bf16 v[84:87], a[12:15], a[76:79], v[84:87]
 v_mfma_f32_16x16x32_bf16 v[92:95], a[12:15], a[68:71], v[92:95]
 s_add_u32 m0, s29, 32768
 v_mfma_f32_16x16x32_bf16 v[92:95], a[8:11], a[64:67], v[92:95]
 buffer_load_dwordx4 v1, s[4:7], 0 offen  lds
 v_mfma_f32_16x16x32_bf16 v[120:123], a[16:19], a[64:67], v[120:123]
 v_mfma_f32_16x16x32_bf16 v[120:123], a[20:23], a[68:71], v[120:123]
 v_mfma_f32_16x16x32_bf16 v[112:115], a[20:23], a[76:79], v[112:115]
 v_mfma_f32_16x16x32_bf16 v[112:115], a[16:19], a[72:75], v[112:115]
 s_add_u32 m0, s29, 102400
 v_mfma_f32_16x16x32_bf16 v[104:107], a[16:19], a[80:83], v[104:107]
 buffer_load_dwordx4 v2, s[8:11], s48 offen  lds
 v_mfma_f32_16x16x32_bf16 v[104:107], a[20:23], a[84:87], v[104:107]
 v_mfma_f32_16x16x32_bf16 v[96:99], a[20:23], a[92:95], v[96:99]
 v_mfma_f32_16x16x32_bf16 v[96:99], a[16:19], a[88:91], v[96:99]
 v_mfma_f32_16x16x32_bf16 v[100:103], a[24:27], a[88:91], v[100:103]
 s_add_u32 m0, s29, 36864
 v_mfma_f32_16x16x32_bf16 v[100:103], a[28:31], a[92:95], v[100:103]
 buffer_load_dwordx4 v1, s[4:7], s41 offen  lds
 v_mfma_f32_16x16x32_bf16 v[108:111], a[28:31], a[84:87], v[108:111]
 v_mfma_f32_16x16x32_bf16 v[108:111], a[24:27], a[80:83], v[108:111]
 v_mfma_f32_16x16x32_bf16 v[116:119], a[24:27], a[72:75], v[116:119]
 v_mfma_f32_16x16x32_bf16 v[116:119], a[28:31], a[76:79], v[116:119]
 s_add_u32 m0, s29, 106496
 v_mfma_f32_16x16x32_bf16 v[124:127], a[28:31], a[68:71], v[124:127]
 buffer_load_dwordx4 v2, s[8:11], s49 offen  lds
 v_mfma_f32_16x16x32_bf16 v[124:127], a[24:27], a[64:67], v[124:127]
 v_mfma_f32_16x16x32_bf16 v[152:155], a[32:35], a[64:67], v[152:155]
 v_mfma_f32_16x16x32_bf16 v[152:155], a[36:39], a[68:71], v[152:155]
 v_mfma_f32_16x16x32_bf16 v[144:147], a[36:39], a[76:79], v[144:147]
 s_add_u32 m0, s29, 40960
 v_mfma_f32_16x16x32_bf16 v[144:147], a[32:35], a[72:75], v[144:147]
 buffer_load_dwordx4 v1, s[4:7], s42 offen  lds
 v_mfma_f32_16x16x32_bf16 v[136:139], a[32:35], a[80:83], v[136:139]
 v_mfma_f32_16x16x32_bf16 v[136:139], a[36:39], a[84:87], v[136:139]
 v_mfma_f32_16x16x32_bf16 v[128:131], a[36:39], a[92:95], v[128:131]
 v_mfma_f32_16x16x32_bf16 v[128:131], a[32:35], a[88:91], v[128:131]
 s_add_u32 m0, s29, 110592
 v_mfma_f32_16x16x32_bf16 v[132:135], a[40:43], a[88:91], v[132:135]
 buffer_load_dwordx4 v2, s[8:11], s50 offen  lds
 v_mfma_f32_16x16x32_bf16 v[132:135], a[44:47], a[92:95], v[132:135]
 v_mfma_f32_16x16x32_bf16 v[140:143], a[44:47], a[84:87], v[140:143]
 v_mfma_f32_16x16x32_bf16 v[140:143], a[40:43], a[80:83], v[140:143]
 v_mfma_f32_16x16x32_bf16 v[148:151], a[40:43], a[72:75], v[148:151]
 s_add_u32 m0, s29, 45056
 v_mfma_f32_16x16x32_bf16 v[148:151], a[44:47], a[76:79], v[148:151]
 buffer_load_dwordx4 v1, s[4:7], s43 offen  lds
 v_mfma_f32_16x16x32_bf16 v[156:159], a[44:47], a[68:71], v[156:159]
 v_mfma_f32_16x16x32_bf16 v[156:159], a[40:43], a[64:67], v[156:159]
 v_mfma_f32_16x16x32_bf16 v[184:187], a[48:51], a[64:67], v[184:187]
 v_mfma_f32_16x16x32_bf16 v[184:187], a[52:55], a[68:71], v[184:187]
 s_add_u32 m0, s29, 114688
 v_mfma_f32_16x16x32_bf16 v[176:179], a[52:55], a[76:79], v[176:179]
 buffer_load_dwordx4 v2, s[8:11], s51 offen  lds
 v_mfma_f32_16x16x32_bf16 v[176:179], a[48:51], a[72:75], v[176:179]
 v_mfma_f32_16x16x32_bf16 v[168:171], a[48:51], a[80:83], v[168:171]
 v_mfma_f32_16x16x32_bf16 v[168:171], a[52:55], a[84:87], v[168:171]
 v_mfma_f32_16x16x32_bf16 v[160:163], a[52:55], a[92:95], v[160:163]
 s_add_u32 m0, s29, 49152
 v_mfma_f32_16x16x32_bf16 v[160:163], a[48:51], a[88:91], v[160:163]
 buffer_load_dwordx4 v1, s[4:7], s44 offen  lds
 v_mfma_f32_16x16x32_bf16 v[164:167], a[56:59], a[88:91], v[164:167]
 v_mfma_f32_16x16x32_bf16 v[164:167], a[60:63], a[92:95], v[164:167]
 v_mfma_f32_16x16x32_bf16 v[172:175], a[60:63], a[84:87], v[172:175]
 v_mfma_f32_16x16x32_bf16 v[172:175], a[56:59], a[80:83], v[172:175]
 s_add_u32 m0, s29, 118784
 v_mfma_f32_16x16x32_bf16 v[180:183], a[56:59], a[72:75], v[180:183]
 s_waitcnt vmcnt(10)
 buffer_load_dwordx4 v2, s[8:11], s52 offen  lds
 v_mfma_f32_16x16x32_bf16 v[180:183], a[60:63], a[76:79], v[180:183]
 s_barrier
 ds_read_b64_tr_b16 a[0:1], v6 offset:0
 v_mfma_f32_16x16x32_bf16 v[188:191], a[60:63], a[68:71], v[188:191]
 ds_read_b64_tr_b16 a[2:3], v6 offset:4096
 v_mfma_f32_16x16x32_bf16 v[188:191], a[56:59], a[64:67], v[188:191]
 ds_read_b128 a[64:67], v4 offset:0
 v_mfma_f32_16x16x32_bf16 v[216:219], a[32:35], a[96:99], v[216:219]
 s_add_u32 m0, s29, 53248
 ds_read_b128 a[160:163], v14 offset:0
 v_mfma_f32_16x16x32_bf16 v[216:219], a[36:39], a[100:103], v[216:219]
 buffer_load_dwordx4 v1, s[4:7], s45 offen  lds
 v_mfma_f32_16x16x32_bf16 v[208:211], a[36:39], a[108:111], v[208:211]
 ds_read_b64_tr_b16 a[4:5], v6 offset:16384
 v_mfma_f32_16x16x32_bf16 v[208:211], a[32:35], a[104:107], v[208:211]
 ds_read_b64_tr_b16 a[6:7], v6 offset:20480
 v_mfma_f32_16x16x32_bf16 v[200:203], a[32:35], a[112:115], v[200:203]
 ds_read_b128 a[68:71], v5 offset:0
 v_mfma_f32_16x16x32_bf16 v[200:203], a[36:39], a[116:119], v[200:203]
 s_add_u32 m0, s29, 122880
 ds_read_b128 a[168:171], v3 offset:0
 v_mfma_f32_16x16x32_bf16 v[192:195], a[36:39], a[124:127], v[192:195]
 buffer_load_dwordx4 v2, s[8:11], s53 offen  lds
 v_mfma_f32_16x16x32_bf16 v[192:195], a[32:35], a[120:123], v[192:195]
 ds_read_b128 a[76:79], v5 offset:2048
 v_mfma_f32_16x16x32_bf16 v[196:199], a[40:43], a[120:123], v[196:199]
 ds_read_b128 a[164:167], v14 offset:2048
 v_mfma_f32_16x16x32_bf16 v[196:199], a[44:47], a[124:127], v[196:199]
 ds_read_b128 a[72:75], v4 offset:2048
 v_mfma_f32_16x16x32_bf16 v[204:207], a[44:47], a[116:119], v[204:207]
 s_add_u32 m0, s29, 57344
 ds_read_b128 a[172:175], v3 offset:2048
 v_mfma_f32_16x16x32_bf16 v[204:207], a[40:43], a[112:115], v[204:207]
 buffer_load_dwordx4 v1, s[4:7], s46 offen  lds
 v_mfma_f32_16x16x32_bf16 v[212:215], a[40:43], a[104:107], v[212:215]
 ds_read_b128 a[80:83], v4 offset:4096
 v_mfma_f32_16x16x32_bf16 v[212:215], a[44:47], a[108:111], v[212:215]
 ds_read_b128 a[176:179], v14 offset:4096
 v_mfma_f32_16x16x32_bf16 v[220:223], a[44:47], a[100:103], v[220:223]
 ds_read_b128 a[84:87], v5 offset:4096
 v_mfma_f32_16x16x32_bf16 v[220:223], a[40:43], a[96:99], v[220:223]
 s_add_u32 m0, s29, 126976
 ds_read_b128 a[184:187], v3 offset:4096
 v_mfma_f32_16x16x32_bf16 v[248:251], a[48:51], a[96:99], v[248:251]
 buffer_load_dwordx4 v2, s[8:11], s54 offen  lds
 v_mfma_f32_16x16x32_bf16 v[248:251], a[52:55], a[100:103], v[248:251]
 ds_read_b128 a[92:95], v5 offset:6144
 v_mfma_f32_16x16x32_bf16 v[240:243], a[52:55], a[108:111], v[240:243]
 ds_read_b128 a[180:183], v14 offset:6144
 v_mfma_f32_16x16x32_bf16 v[240:243], a[48:51], a[104:107], v[240:243]
 ds_read_b128 a[88:91], v4 offset:6144
 v_mfma_f32_16x16x32_bf16 v[232:235], a[48:51], a[112:115], v[232:235]
 s_add_u32 m0, s29, 61440
 ds_read_b128 a[188:191], v3 offset:6144
 v_mfma_f32_16x16x32_bf16 v[232:235], a[52:55], a[116:119], v[232:235]
 buffer_load_dwordx4 v1, s[4:7], s47 offen  lds
 v_mfma_f32_16x16x32_bf16 v[224:227], a[52:55], a[124:127], v[224:227]
 v_add_u32 v1, 128, v1
 v_add_u32 v2, 0x80000, v2
 v_mfma_f32_16x16x32_bf16 v[224:227], a[48:51], a[120:123], v[224:227]
 ds_read_b64_tr_b16 a[8:9], v7 offset:0
 v_mfma_f32_16x16x32_bf16 v[228:231], a[56:59], a[120:123], v[228:231]
 v_mfma_f32_16x16x32_bf16 v[228:231], a[60:63], a[124:127], v[228:231]
 ds_read_b64_tr_b16 a[10:11], v7 offset:4096
 v_mfma_f32_16x16x32_bf16 v[236:239], a[60:63], a[116:119], v[236:239]
 ds_read_b64_tr_b16 a[12:13], v7 offset:16384
 v_mfma_f32_16x16x32_bf16 v[236:239], a[56:59], a[112:115], v[236:239]
 ds_read_b64_tr_b16 a[14:15], v7 offset:20480
 v_mfma_f32_16x16x32_bf16 v[244:247], a[56:59], a[104:107], v[244:247]
 ds_read_b64_tr_b16 a[16:17], v8 offset:0
 v_mfma_f32_16x16x32_bf16 v[244:247], a[60:63], a[108:111], v[244:247]
 ds_read_b64_tr_b16 a[18:19], v8 offset:4096
 v_mfma_f32_16x16x32_bf16 v[252:255], a[60:63], a[100:103], v[252:255]
 ds_read_b64_tr_b16 a[20:21], v8 offset:16384
 v_mfma_f32_16x16x32_bf16 v[252:255], a[56:59], a[96:99], v[252:255]
 s_waitcnt lgkmcnt(15)
 ds_read_b64_tr_b16 a[22:23], v8 offset:20480
 v_mfma_f32_16x16x32_bf16 v[88:91], a[0:3], a[64:67], v[88:91]
 ds_read_b64_tr_b16 a[24:25], v9 offset:0
 v_lshlrev_b32 v1, 4, v0
 v_mfma_f32_16x16x32_bf16 v[88:91], a[4:7], a[68:71], v[88:91]
 s_add_u32 m0, s33, 0xfffffe00
 ds_read_b64_tr_b16 a[26:27], v9 offset:4096
 v_mfma_f32_16x16x32_bf16 v[80:83], a[4:7], a[76:79], v[80:83]
 s_waitcnt lgkmcnt(10)
 ds_read_b64_tr_b16 a[28:29], v9 offset:16384
 v_mfma_f32_16x16x32_bf16 v[80:83], a[0:3], a[72:75], v[80:83]
 ds_read_b64_tr_b16 a[30:31], v9 offset:20480
 buffer_load_dwordx4 v15, s[20:23], 0 offen offset:512 lds
 v_mfma_f32_16x16x32_bf16 v[72:75], a[0:3], a[80:83], v[72:75]
 ds_read_b128 a[96:99], v4 offset:8192
 v_mfma_f32_16x16x32_bf16 v[72:75], a[4:7], a[84:87], v[72:75]
 v_mfma_f32_16x16x32_bf16 v[64:67], a[4:7], a[92:95], v[64:67]
 s_add_u32 m0, s33, 0xfffffe80
 ds_read_b128 a[100:103], v5 offset:8192
 v_mfma_f32_16x16x32_bf16 v[64:67], a[0:3], a[88:91], v[64:67]
 s_waitcnt lgkmcnt(10)
 buffer_load_dwordx4 v15, s[20:23], 0 offen offset:1408 lds
 v_mfma_f32_16x16x32_bf16 v[68:71], a[8:11], a[88:91], v[68:71]
 ds_read_b128 a[108:111], v5 offset:10240
 v_mfma_f32_16x16x32_bf16 v[68:71], a[12:15], a[92:95], v[68:71]
 v_mfma_f32_16x16x32_bf16 v[76:79], a[12:15], a[84:87], v[76:79]
 s_add_u32 m0, s33, 0x600
 ds_read_b128 a[104:107], v4 offset:10240
 v_mfma_f32_16x16x32_bf16 v[76:79], a[8:11], a[80:83], v[76:79]
 buffer_load_dwordx4 v15, s[20:23], s57 offen offset:512 lds
 v_mfma_f32_16x16x32_bf16 v[84:87], a[8:11], a[72:75], v[84:87]
 ds_read_b128 a[112:115], v4 offset:12288
 v_mfma_f32_16x16x32_bf16 v[84:87], a[12:15], a[76:79], v[84:87]
 v_mfma_f32_16x16x32_bf16 v[92:95], a[12:15], a[68:71], v[92:95]
 s_add_u32 m0, s33, 0x680
 ds_read_b128 a[116:119], v5 offset:12288
 v_mfma_f32_16x16x32_bf16 v[92:95], a[8:11], a[64:67], v[92:95]
 s_waitcnt lgkmcnt(10)
 buffer_load_dwordx4 v15, s[20:23], s57 offen offset:1408 lds
 v_mfma_f32_16x16x32_bf16 v[120:123], a[16:19], a[64:67], v[120:123]
 ds_read_b128 a[124:127], v5 offset:14336
 v_mfma_f32_16x16x32_bf16 v[120:123], a[20:23], a[68:71], v[120:123]
 v_mfma_f32_16x16x32_bf16 v[112:115], a[20:23], a[76:79], v[112:115]
 s_add_u32 m0, s33, 0xd80
 ds_read_b128 a[120:123], v4 offset:14336
 v_mfma_f32_16x16x32_bf16 v[112:115], a[16:19], a[72:75], v[112:115]
 buffer_load_dwordx4 v15, s[20:23], 0 offen offset:640 lds
 v_mfma_f32_16x16x32_bf16 v[104:107], a[16:19], a[80:83], v[104:107]
 ds_read_b64_tr_b16 a[32:33], v10 offset:0
 v_mfma_f32_16x16x32_bf16 v[104:107], a[20:23], a[84:87], v[104:107]
 ds_read_b64_tr_b16 a[34:35], v10 offset:4096
 v_mfma_f32_16x16x32_bf16 v[96:99], a[20:23], a[92:95], v[96:99]
 s_add_u32 m0, s33, 0xe00
 ds_read_b64_tr_b16 a[36:37], v10 offset:16384
 v_mfma_f32_16x16x32_bf16 v[96:99], a[16:19], a[88:91], v[96:99]
 s_waitcnt lgkmcnt(11)
 ds_read_b64_tr_b16 a[38:39], v10 offset:20480
 buffer_load_dwordx4 v15, s[20:23], 0 offen offset:1536 lds
 v_mfma_f32_16x16x32_bf16 v[100:103], a[24:27], a[88:91], v[100:103]
 ds_read_b64_tr_b16 a[40:41], v11 offset:0
 v_mfma_f32_16x16x32_bf16 v[100:103], a[28:31], a[92:95], v[100:103]
 ds_read_b64_tr_b16 a[42:43], v11 offset:4096
 v_mfma_f32_16x16x32_bf16 v[108:111], a[28:31], a[84:87], v[108:111]
 s_add_u32 m0, s33, 0x1580
 ds_read_b64_tr_b16 a[44:45], v11 offset:16384
 v_mfma_f32_16x16x32_bf16 v[108:111], a[24:27], a[80:83], v[108:111]
 ds_read_b64_tr_b16 a[46:47], v11 offset:20480
 buffer_load_dwordx4 v15, s[20:23], s57 offen offset:640 lds
 v_mfma_f32_16x16x32_bf16 v[116:119], a[24:27], a[72:75], v[116:119]
 ds_read_b64_tr_b16 a[48:49], v12 offset:0
 v_mfma_f32_16x16x32_bf16 v[116:119], a[28:31], a[76:79], v[116:119]
 ds_read_b64_tr_b16 a[50:51], v12 offset:4096
 v_mfma_f32_16x16x32_bf16 v[124:127], a[28:31], a[68:71], v[124:127]
 s_add_u32 m0, s33, 0x1600
 ds_read_b64_tr_b16 a[52:53], v12 offset:16384
 v_mfma_f32_16x16x32_bf16 v[124:127], a[24:27], a[64:67], v[124:127]
 s_waitcnt lgkmcnt(15)
 ds_read_b64_tr_b16 a[54:55], v12 offset:20480
 buffer_load_dwordx4 v15, s[20:23], s57 offen offset:1536 lds
 v_mfma_f32_16x16x32_bf16 a[232:235], a[0:3], a[96:99], a[232:235]
 ds_read_b64_tr_b16 a[56:57], v13 offset:0
 v_mfma_f32_16x16x32_bf16 a[232:235], a[4:7], a[100:103], a[232:235]
 ds_read_b64_tr_b16 a[58:59], v13 offset:4096
 v_mfma_f32_16x16x32_bf16 a[224:227], a[4:7], a[108:111], a[224:227]
 ds_read_b64_tr_b16 a[60:61], v13 offset:16384
 v_mfma_f32_16x16x32_bf16 a[224:227], a[0:3], a[104:107], a[224:227]
 s_waitcnt lgkmcnt(15)
 ds_read_b64_tr_b16 a[62:63], v13 offset:20480
 v_mfma_f32_16x16x32_bf16 v[24:27], a[0:3], a[112:115], v[24:27]
 v_mfma_f32_16x16x32_bf16 v[24:27], a[4:7], a[116:119], v[24:27]
 v_mfma_f32_16x16x32_bf16 v[16:19], a[4:7], a[124:127], v[16:19]
 v_mfma_f32_16x16x32_bf16 v[16:19], a[0:3], a[120:123], v[16:19]
 s_waitcnt lgkmcnt(0)
 v_mfma_f32_16x16x32_bf16 v[20:23], a[8:11], a[120:123], v[20:23]
 s_barrier
 v_mfma_f32_16x16x32_bf16 v[20:23], a[12:15], a[124:127], v[20:23]
 s_add_u32 m0, s29, 0
 v_add_u32 v2, 0xff800000, v2
 v_mfma_f32_16x16x32_bf16 v[28:31], a[12:15], a[116:119], v[28:31]
 buffer_load_dwordx4 v2, s[16:19], 0 offen lds
 v_mfma_f32_16x16x32_bf16 v[28:31], a[8:11], a[112:115], v[28:31]
 v_mfma_f32_16x16x32_bf16 a[228:231], a[8:11], a[104:107], a[228:231]
 v_mfma_f32_16x16x32_bf16 a[228:231], a[12:15], a[108:111], a[228:231]
 v_mfma_f32_16x16x32_bf16 a[236:239], a[12:15], a[100:103], a[236:239]
 s_add_u32 m0, s29, 4096
 v_mfma_f32_16x16x32_bf16 a[236:239], a[8:11], a[96:99], a[236:239]
 buffer_load_dwordx4 v2, s[16:19], s48 offen lds
 v_mfma_f32_16x16x32_bf16 v[56:59], a[16:19], a[96:99], v[56:59]
 v_mfma_f32_16x16x32_bf16 v[56:59], a[20:23], a[100:103], v[56:59]
 v_mfma_f32_16x16x32_bf16 v[48:51], a[20:23], a[108:111], v[48:51]
 v_mfma_f32_16x16x32_bf16 v[48:51], a[16:19], a[104:107], v[48:51]
 s_add_u32 m0, s29, 8192
 v_mfma_f32_16x16x32_bf16 v[40:43], a[16:19], a[112:115], v[40:43]
 buffer_load_dwordx4 v2, s[16:19], s49 offen lds
 v_mfma_f32_16x16x32_bf16 v[40:43], a[20:23], a[116:119], v[40:43]
 v_mfma_f32_16x16x32_bf16 v[32:35], a[20:23], a[124:127], v[32:35]
 v_mfma_f32_16x16x32_bf16 v[32:35], a[16:19], a[120:123], v[32:35]
 v_mfma_f32_16x16x32_bf16 v[36:39], a[24:27], a[120:123], v[36:39]
 s_add_u32 m0, s29, 12288
 v_mfma_f32_16x16x32_bf16 v[36:39], a[28:31], a[124:127], v[36:39]
 buffer_load_dwordx4 v2, s[16:19], s50 offen lds
 v_mfma_f32_16x16x32_bf16 v[44:47], a[28:31], a[116:119], v[44:47]
 v_mfma_f32_16x16x32_bf16 v[44:47], a[24:27], a[112:115], v[44:47]
 v_mfma_f32_16x16x32_bf16 v[52:55], a[24:27], a[104:107], v[52:55]
 v_mfma_f32_16x16x32_bf16 v[52:55], a[28:31], a[108:111], v[52:55]
 s_add_u32 m0, s29, 16384
 v_mfma_f32_16x16x32_bf16 v[60:63], a[28:31], a[100:103], v[60:63]
 buffer_load_dwordx4 v2, s[16:19], s51 offen lds
 v_mfma_f32_16x16x32_bf16 v[60:63], a[24:27], a[96:99], v[60:63]
 v_mfma_f32_16x16x32_bf16 v[216:219], a[32:35], a[96:99], v[216:219]
 v_mfma_f32_16x16x32_bf16 v[216:219], a[36:39], a[100:103], v[216:219]
 v_mfma_f32_16x16x32_bf16 v[208:211], a[36:39], a[108:111], v[208:211]
 s_add_u32 m0, s29, 20480
 v_mfma_f32_16x16x32_bf16 v[208:211], a[32:35], a[104:107], v[208:211]
 buffer_load_dwordx4 v2, s[16:19], s52 offen lds
 v_mfma_f32_16x16x32_bf16 v[200:203], a[32:35], a[112:115], v[200:203]
 v_mfma_f32_16x16x32_bf16 v[200:203], a[36:39], a[116:119], v[200:203]
 v_mfma_f32_16x16x32_bf16 v[192:195], a[36:39], a[124:127], v[192:195]
 v_mfma_f32_16x16x32_bf16 v[192:195], a[32:35], a[120:123], v[192:195]
 s_add_u32 m0, s29, 24576
 v_mfma_f32_16x16x32_bf16 v[196:199], a[40:43], a[120:123], v[196:199]
 buffer_load_dwordx4 v2, s[16:19], s53 offen lds
 v_mfma_f32_16x16x32_bf16 v[196:199], a[44:47], a[124:127], v[196:199]
 v_mfma_f32_16x16x32_bf16 v[204:207], a[44:47], a[116:119], v[204:207]
 v_mfma_f32_16x16x32_bf16 v[204:207], a[40:43], a[112:115], v[204:207]
 v_mfma_f32_16x16x32_bf16 v[212:215], a[40:43], a[104:107], v[212:215]
 s_add_u32 m0, s29, 28672
 v_mfma_f32_16x16x32_bf16 v[212:215], a[44:47], a[108:111], v[212:215]
 buffer_load_dwordx4 v2, s[16:19], s54 offen lds
 v_mfma_f32_16x16x32_bf16 v[220:223], a[44:47], a[100:103], v[220:223]
 v_mfma_f32_16x16x32_bf16 v[220:223], a[40:43], a[96:99], v[220:223]
 v_mfma_f32_16x16x32_bf16 v[248:251], a[48:51], a[96:99], v[248:251]
 s_add_u32 m0, s29, 65536
 v_add_u32 v2, 0x80000, v2
 v_mfma_f32_16x16x32_bf16 v[248:251], a[52:55], a[100:103], v[248:251]
 buffer_load_dwordx4 v2, s[16:19], 0 offen lds
 v_mfma_f32_16x16x32_bf16 v[240:243], a[52:55], a[108:111], v[240:243]
 v_mfma_f32_16x16x32_bf16 v[240:243], a[48:51], a[104:107], v[240:243]
 v_mfma_f32_16x16x32_bf16 v[232:235], a[48:51], a[112:115], v[232:235]
 v_mfma_f32_16x16x32_bf16 v[232:235], a[52:55], a[116:119], v[232:235]
 s_add_u32 m0, s29, 69632
 v_mfma_f32_16x16x32_bf16 v[224:227], a[52:55], a[124:127], v[224:227]
 buffer_load_dwordx4 v2, s[16:19], s48 offen lds
 v_mfma_f32_16x16x32_bf16 v[224:227], a[48:51], a[120:123], v[224:227]
 v_mfma_f32_16x16x32_bf16 v[228:231], a[56:59], a[120:123], v[228:231]
 v_mfma_f32_16x16x32_bf16 v[228:231], a[60:63], a[124:127], v[228:231]
 v_mfma_f32_16x16x32_bf16 v[236:239], a[60:63], a[116:119], v[236:239]
 s_add_u32 m0, s29, 73728
 v_mfma_f32_16x16x32_bf16 v[236:239], a[56:59], a[112:115], v[236:239]
 buffer_load_dwordx4 v2, s[16:19], s49 offen lds
 v_mfma_f32_16x16x32_bf16 v[244:247], a[56:59], a[104:107], v[244:247]
 s_waitcnt vmcnt(11)
 v_mfma_f32_16x16x32_bf16 v[244:247], a[60:63], a[108:111], v[244:247]
 s_barrier
 ds_read_b64_tr_b16 a[0:1], v6 offset:32768
 v_mfma_f32_16x16x32_bf16 v[252:255], a[60:63], a[100:103], v[252:255]
 ds_read_b64_tr_b16 a[2:3], v6 offset:36864
 v_mfma_f32_16x16x32_bf16 v[252:255], a[56:59], a[96:99], v[252:255]
 s_add_u32 m0, s29, 77824
 ds_read_b128 a[96:99], v4 offset:40960
 v_mfma_f32_16x16x32_bf16 v[152:155], a[32:35], a[64:67], v[152:155]
 ds_read_b128 a[192:195], v14 offset:0
 buffer_load_dwordx4 v2, s[16:19], s50 offen lds
 v_mfma_f32_16x16x32_bf16 v[152:155], a[36:39], a[68:71], v[152:155]
 ds_read_b128 a[200:203], v3 offset:0
 v_mfma_f32_16x16x32_bf16 v[144:147], a[36:39], a[76:79], v[144:147]
 s_mov_b32 s56, s58
 ds_read_b64_tr_b16 a[4:5], v6 offset:49152
 v_mfma_f32_16x16x32_bf16 v[144:147], a[32:35], a[72:75], v[144:147]
 ds_read_b64_tr_b16 a[6:7], v6 offset:53248
 v_mfma_f32_16x16x32_bf16 v[136:139], a[32:35], a[80:83], v[136:139]
 s_add_u32 m0, s29, 81920
 ds_read_b128 a[100:103], v5 offset:40960
 v_mfma_f32_16x16x32_bf16 v[136:139], a[36:39], a[84:87], v[136:139]
 ds_read_b128 a[196:199], v14 offset:2048
 buffer_load_dwordx4 v2, s[16:19], s51 offen lds
 v_mfma_f32_16x16x32_bf16 v[128:131], a[36:39], a[92:95], v[128:131]
 ds_read_b128 a[204:207], v3 offset:2048
 v_mfma_f32_16x16x32_bf16 v[128:131], a[32:35], a[88:91], v[128:131]
 ds_read_b128 a[108:111], v5 offset:43008
 v_mfma_f32_16x16x32_bf16 v[132:135], a[40:43], a[88:91], v[132:135]
 ds_read_b128 a[208:211], v14 offset:4096
 v_mfma_f32_16x16x32_bf16 v[132:135], a[44:47], a[92:95], v[132:135]
 s_add_u32 m0, s29, 86016
 ds_read_b128 a[104:107], v4 offset:43008
 v_mfma_f32_16x16x32_bf16 v[140:143], a[44:47], a[84:87], v[140:143]
 ds_read_b128 a[216:219], v3 offset:4096
 buffer_load_dwordx4 v2, s[16:19], s52 offen lds
 v_mfma_f32_16x16x32_bf16 v[140:143], a[40:43], a[80:83], v[140:143]
 ds_read_b128 a[212:215], v14 offset:6144
 v_mfma_f32_16x16x32_bf16 v[148:151], a[40:43], a[72:75], v[148:151]
 s_cmp_lt_u32 s25, 4
 s_cselect_b32 s1, 2.0, s92
 ds_read_b128 a[112:115], v4 offset:45056
 v_mfma_f32_16x16x32_bf16 v[148:151], a[44:47], a[76:79], v[148:151]
 ds_read_b128 a[220:223], v3 offset:6144
 v_mfma_f32_16x16x32_bf16 v[156:159], a[44:47], a[68:71], v[156:159]
 s_add_u32 m0, s29, 90112
 ds_read_b128 a[116:119], v5 offset:45056
 v_mfma_f32_16x16x32_bf16 v[156:159], a[40:43], a[64:67], v[156:159]
 buffer_load_dwordx4 v2, s[16:19], s53 offen lds
 v_mfma_f32_16x16x32_bf16 v[184:187], a[48:51], a[64:67], v[184:187]
 v_mfma_f32_16x16x32_bf16 v[184:187], a[52:55], a[68:71], v[184:187]
 ds_read_b128 a[124:127], v5 offset:47104
 v_mfma_f32_16x16x32_bf16 v[176:179], a[52:55], a[76:79], v[176:179]
 v_mfma_f32_16x16x32_bf16 v[176:179], a[48:51], a[72:75], v[176:179]
 s_add_u32 m0, s29, 94208
 ds_read_b128 a[120:123], v4 offset:47104
 v_mfma_f32_16x16x32_bf16 v[168:171], a[48:51], a[80:83], v[168:171]
 buffer_load_dwordx4 v2, s[16:19], s54 offen lds
 v_mfma_f32_16x16x32_bf16 v[168:171], a[52:55], a[84:87], v[168:171]
 v_mfma_f32_16x16x32_bf16 v[160:163], a[52:55], a[92:95], v[160:163]
 v_mfma_f32_16x16x32_bf16 v[160:163], a[48:51], a[88:91], v[160:163]
 ds_read_b64_tr_b16 a[8:9], v7 offset:32768
 v_mfma_f32_16x16x32_bf16 v[164:167], a[56:59], a[88:91], v[164:167]
 v_mfma_f32_16x16x32_bf16 v[164:167], a[60:63], a[92:95], v[164:167]
 ds_read_b64_tr_b16 a[10:11], v7 offset:36864
 v_mfma_f32_16x16x32_bf16 v[172:175], a[60:63], a[84:87], v[172:175]
 ds_read_b64_tr_b16 a[12:13], v7 offset:49152
 v_mfma_f32_16x16x32_bf16 v[172:175], a[56:59], a[80:83], v[172:175]
 ds_read_b64_tr_b16 a[14:15], v7 offset:53248
 v_mfma_f32_16x16x32_bf16 v[180:183], a[56:59], a[72:75], v[180:183]
 ds_read_b64_tr_b16 a[16:17], v8 offset:32768
 v_mfma_f32_16x16x32_bf16 v[180:183], a[60:63], a[76:79], v[180:183]
 ds_read_b64_tr_b16 a[18:19], v8 offset:36864
 v_mfma_f32_16x16x32_bf16 v[188:191], a[60:63], a[68:71], v[188:191]
 ds_read_b64_tr_b16 a[20:21], v8 offset:49152
 v_mfma_f32_16x16x32_bf16 v[188:191], a[56:59], a[64:67], v[188:191]
 s_waitcnt lgkmcnt(15)
 ds_read_b64_tr_b16 a[22:23], v8 offset:53248
 s_cmp_ge_u32 s25, 4
 s_cbranch_scc1 L_late0
 v_mfma_f32_16x16x32_bf16 a[232:235], a[0:3], a[96:99], a[232:235]
 ds_read_b64_tr_b16 a[24:25], v9 offset:32768
 v_mfma_f32_16x16x32_bf16 a[232:235], a[4:7], a[100:103], a[232:235]
 s_add_u32 m0, s33, 0xfffffd00
 ds_read_b64_tr_b16 a[26:27], v9 offset:36864
 v_mfma_f32_16x16x32_bf16 a[224:227], a[4:7], a[108:111], a[224:227]
 s_waitcnt lgkmcnt(13)
 ds_read_b64_tr_b16 a[28:29], v9 offset:49152
 v_mfma_f32_16x16x32_bf16 a[224:227], a[0:3], a[104:107], a[224:227]
 ds_read_b64_tr_b16 a[30:31], v9 offset:53248
 buffer_load_dwordx4 v15, s[20:23], 0 offen offset:768 lds
 v_mfma_f32_16x16x32_bf16 v[24:27], a[0:3], a[112:115], v[24:27]
 s_waitcnt lgkmcnt(12)
 ds_read_b128 a[64:67], v4 offset:32768
 v_mfma_f32_16x16x32_bf16 v[24:27], a[4:7], a[116:119], v[24:27]
 v_mfma_f32_16x16x32_bf16 v[16:19], a[4:7], a[124:127], v[16:19]
 s_add_u32 m0, s33, 0xfffffd80
 ds_read_b128 a[68:71], v5 offset:32768
 v_mfma_f32_16x16x32_bf16 v[16:19], a[0:3], a[120:123], v[16:19]
 s_waitcnt lgkmcnt(10)
 buffer_load_dwordx4 v15, s[20:23], 0 offen offset:1664 lds
 v_mfma_f32_16x16x32_bf16 v[20:23], a[8:11], a[120:123], v[20:23]
 ds_read_b128 a[76:79], v5 offset:34816
 v_mfma_f32_16x16x32_bf16 v[20:23], a[12:15], a[124:127], v[20:23]
 v_mfma_f32_16x16x32_bf16 v[28:31], a[12:15], a[116:119], v[28:31]
 s_add_u32 m0, s33, 0x500
 ds_read_b128 a[72:75], v4 offset:34816
 v_mfma_f32_16x16x32_bf16 v[28:31], a[8:11], a[112:115], v[28:31]
 buffer_load_dwordx4 v15, s[20:23], s57 offen offset:768 lds
 v_mfma_f32_16x16x32_bf16 a[228:231], a[8:11], a[104:107], a[228:231]
 ds_read_b128 a[80:83], v4 offset:36864
 v_mfma_f32_16x16x32_bf16 a[228:231], a[12:15], a[108:111], a[228:231]
 v_mfma_f32_16x16x32_bf16 a[236:239], a[12:15], a[100:103], a[236:239]
 s_add_u32 m0, s33, 0x580
 ds_read_b128 a[84:87], v5 offset:36864
 v_mfma_f32_16x16x32_bf16 a[236:239], a[8:11], a[96:99], a[236:239]
 s_waitcnt lgkmcnt(10)
 buffer_load_dwordx4 v15, s[20:23], s57 offen offset:1664 lds
 v_mfma_f32_16x16x32_bf16 v[56:59], a[16:19], a[96:99], v[56:59]
 ds_read_b128 a[92:95], v5 offset:38912
 v_mfma_f32_16x16x32_bf16 v[56:59], a[20:23], a[100:103], v[56:59]
 v_cvt_pk_bf16_f32 v16, v16, v17
 v_cvt_pk_bf16_f32 v17, v18, v19
 v_mfma_f32_16x16x32_bf16 v[48:51], a[20:23], a[108:111], v[48:51]
 ds_read_b128 a[88:91], v4 offset:38912
 v_cvt_pk_bf16_f32 v18, v20, v21
 v_mfma_f32_16x16x32_bf16 v[48:51], a[16:19], a[104:107], v[48:51]
 v_cvt_pk_bf16_f32 v19, v22, v23
 v_cvt_pk_bf16_f32 v24, v24, v25
 v_mfma_f32_16x16x32_bf16 v[40:43], a[16:19], a[112:115], v[40:43]
 ds_read_b64_tr_b16 a[32:33], v10 offset:32768
 v_cvt_pk_bf16_f32 v25, v26, v27
 v_mfma_f32_16x16x32_bf16 v[40:43], a[20:23], a[116:119], v[40:43]
 ds_read_b64_tr_b16 a[34:35], v10 offset:36864
 v_cvt_pk_bf16_f32 v26, v28, v29
 v_mfma_f32_16x16x32_bf16 v[32:35], a[20:23], a[124:127], v[32:35]
 s_add_u32 s59, s56, 57344
 ds_read_b64_tr_b16 a[36:37], v10 offset:49152
 v_cvt_pk_bf16_f32 v27, v30, v31
 v_mfma_f32_16x16x32_bf16 v[32:35], a[16:19], a[120:123], v[32:35]
 s_waitcnt lgkmcnt(11)
 ds_read_b64_tr_b16 a[38:39], v10 offset:53248
 v_accvgpr_read_b32 v20, a224
 v_mfma_f32_16x16x32_bf16 v[36:39], a[24:27], a[120:123], v[36:39]
 ds_read_b64_tr_b16 a[40:41], v11 offset:32768
 buffer_store_dwordx4 v[16:19], v1, s[12:15], s59 offen offset:0 sc1
 v_mfma_f32_16x16x32_bf16 v[36:39], a[28:31], a[124:127], v[36:39]
 ds_read_b64_tr_b16 a[42:43], v11 offset:36864
 v_accvgpr_read_b32 v21, a225
 v_mfma_f32_16x16x32_bf16 v[44:47], a[28:31], a[116:119], v[44:47]
 ds_read_b64_tr_b16 a[44:45], v11 offset:49152
 v_accvgpr_read_b32 v22, a226
 v_mfma_f32_16x16x32_bf16 v[44:47], a[24:27], a[112:115], v[44:47]
 ds_read_b64_tr_b16 a[46:47], v11 offset:53248
 v_accvgpr_read_b32 v23, a227
 v_mfma_f32_16x16x32_bf16 v[52:55], a[24:27], a[104:107], v[52:55]
 ds_read_b64_tr_b16 a[48:49], v12 offset:32768
 v_accvgpr_read_b32 v28, a228
 v_mfma_f32_16x16x32_bf16 v[52:55], a[28:31], a[108:111], v[52:55]
 ds_read_b64_tr_b16 a[50:51], v12 offset:36864
 v_accvgpr_read_b32 v29, a229
 v_mfma_f32_16x16x32_bf16 v[60:63], a[28:31], a[100:103], v[60:63]
 s_add_u32 s59, s56, 49152
 ds_read_b64_tr_b16 a[52:53], v12 offset:49152
 v_accvgpr_read_b32 v30, a230
 v_mfma_f32_16x16x32_bf16 v[60:63], a[24:27], a[96:99], v[60:63]
 s_waitcnt lgkmcnt(15)
 ds_read_b64_tr_b16 a[54:55], v12 offset:53248
 buffer_store_dwordx4 v[24:27], v1, s[12:15], s59 offen offset:0 sc1
 v_mfma_f32_16x16x32_bf16 v[88:91], a[0:3], a[64:67], v[88:91]
 ds_read_b64_tr_b16 a[56:57], v13 offset:32768
 v_accvgpr_read_b32 v31, a231
 v_mfma_f32_16x16x32_bf16 v[88:91], a[4:7], a[68:71], v[88:91]
 ds_read_b64_tr_b16 a[58:59], v13 offset:36864
 v_cvt_pk_bf16_f32 v20, v20, v21
 v_mfma_f32_16x16x32_bf16 v[80:83], a[4:7], a[76:79], v[80:83]
 ds_read_b64_tr_b16 a[60:61], v13 offset:49152
 v_cvt_pk_bf16_f32 v21, v22, v23
 v_mfma_f32_16x16x32_bf16 v[80:83], a[0:3], a[72:75], v[80:83]
 s_waitcnt lgkmcnt(15)
 ds_read_b64_tr_b16 a[62:63], v13 offset:53248
 v_cvt_pk_bf16_f32 v22, v28, v29
 v_mfma_f32_16x16x32_bf16 v[72:75], a[0:3], a[80:83], v[72:75]
 v_cvt_pk_bf16_f32 v23, v30, v31
 v_cvt_pk_bf16_f32 v32, v32, v33
 v_mfma_f32_16x16x32_bf16 v[72:75], a[4:7], a[84:87], v[72:75]
 s_add_u32 s59, s56, 40960
 v_cvt_pk_bf16_f32 v33, v34, v35
 v_cvt_pk_bf16_f32 v34, v36, v37
 v_mfma_f32_16x16x32_bf16 v[64:67], a[4:7], a[92:95], v[64:67]
 buffer_store_dwordx4 v[20:23], v1, s[12:15], s59 offen offset:0 sc1
 v_mfma_f32_16x16x32_bf16 v[64:67], a[0:3], a[88:91], v[64:67]
 s_waitcnt lgkmcnt(0)
 v_cvt_pk_bf16_f32 v35, v38, v39
 v_cvt_pk_bf16_f32 v40, v40, v41
 v_mfma_f32_16x16x32_bf16 v[68:71], a[8:11], a[88:91], v[68:71]
 s_barrier
 v_xor_b32 v6, s60, v6
 v_cvt_pk_bf16_f32 v41, v42, v43
 v_mfma_f32_16x16x32_bf16 v[68:71], a[12:15], a[92:95], v[68:71]
 s_add_u32 m0, s29, 32768
 v_add_u32 v2, 0x80000, v2
 v_cvt_pk_bf16_f32 v42, v44, v45
 v_mfma_f32_16x16x32_bf16 v[76:79], a[12:15], a[84:87], v[76:79]
 buffer_load_dwordx4 v2, s[16:19], 0 offen lds
 v_mfma_f32_16x16x32_bf16 v[76:79], a[8:11], a[80:83], v[76:79]
 v_cvt_pk_bf16_f32 v43, v46, v47
 v_accvgpr_read_b32 v36, a232
 v_mfma_f32_16x16x32_bf16 v[84:87], a[8:11], a[72:75], v[84:87]
 s_add_u32 s59, s56, 57344
 v_accvgpr_read_b32 v37, a233
 v_accvgpr_read_b32 v38, a234
 v_mfma_f32_16x16x32_bf16 v[84:87], a[12:15], a[76:79], v[84:87]
 buffer_store_dwordx4 v[32:35], v1, s[12:15], s59 offen offset:1024 sc1
 v_mfma_f32_16x16x32_bf16 v[92:95], a[12:15], a[68:71], v[92:95]
 s_add_u32 m0, s29, 36864
 v_accvgpr_read_b32 v39, a235
 v_accvgpr_read_b32 v44, a236
 v_mfma_f32_16x16x32_bf16 v[92:95], a[8:11], a[64:67], v[92:95]
 buffer_load_dwordx4 v2, s[16:19], s48 offen lds
 v_mfma_f32_16x16x32_bf16 v[120:123], a[16:19], a[64:67], v[120:123]
 v_accvgpr_read_b32 v45, a237
 v_accvgpr_read_b32 v46, a238
 v_mfma_f32_16x16x32_bf16 v[120:123], a[20:23], a[68:71], v[120:123]
 v_accvgpr_read_b32 v47, a239
 v_cvt_pk_bf16_f32 v36, v36, v37
 v_mfma_f32_16x16x32_bf16 v[112:115], a[20:23], a[76:79], v[112:115]
 v_cvt_pk_bf16_f32 v37, v38, v39
 v_cvt_pk_bf16_f32 v38, v44, v45
 v_mfma_f32_16x16x32_bf16 v[112:115], a[16:19], a[72:75], v[112:115]
 s_add_u32 m0, s29, 40960
 v_cvt_pk_bf16_f32 v39, v46, v47
 v_cvt_pk_bf16_f32 v48, v48, v49
 v_mfma_f32_16x16x32_bf16 v[104:107], a[16:19], a[80:83], v[104:107]
 buffer_load_dwordx4 v2, s[16:19], s49 offen lds
 v_mfma_f32_16x16x32_bf16 v[104:107], a[20:23], a[84:87], v[104:107]
 s_add_u32 s59, s56, 49152
 v_cvt_pk_bf16_f32 v49, v50, v51
 v_cvt_pk_bf16_f32 v50, v52, v53
 v_mfma_f32_16x16x32_bf16 v[96:99], a[20:23], a[92:95], v[96:99]
 buffer_store_dwordx4 v[40:43], v1, s[12:15], s59 offen offset:1024 sc1
 v_mfma_f32_16x16x32_bf16 v[96:99], a[16:19], a[88:91], v[96:99]
 v_cvt_pk_bf16_f32 v51, v54, v55
 v_cvt_pk_bf16_f32 v56, v56, v57
 v_mfma_f32_16x16x32_bf16 v[100:103], a[24:27], a[88:91], v[100:103]
 s_add_u32 m0, s29, 45056
 v_cvt_pk_bf16_f32 v57, v58, v59
 v_cvt_pk_bf16_f32 v58, v60, v61
 v_mfma_f32_16x16x32_bf16 v[100:103], a[28:31], a[92:95], v[100:103]
 buffer_load_dwordx4 v2, s[16:19], s50 offen lds
 v_mfma_f32_16x16x32_bf16 v[108:111], a[28:31], a[84:87], v[108:111]
 v_cvt_pk_bf16_f32 v59, v62, v63
 v_cvt_pk_bf16_f32 v64, v64, v65
 v_mfma_f32_16x16x32_bf16 v[108:111], a[24:27], a[80:83], v[108:111]
 v_cvt_pk_bf16_f32 v65, v66, v67
 v_cvt_pk_bf16_f32 v66, v68, v69
 v_mfma_f32_16x16x32_bf16 v[116:119], a[24:27], a[72:75], v[116:119]
 v_cvt_pk_bf16_f32 v67, v70, v71
 v_cvt_pk_bf16_f32 v72, v72, v73
 v_mfma_f32_16x16x32_bf16 v[116:119], a[28:31], a[76:79], v[116:119]
 s_add_u32 m0, s29, 49152
 v_cvt_pk_bf16_f32 v73, v74, v75
 v_cvt_pk_bf16_f32 v74, v76, v77
 v_mfma_f32_16x16x32_bf16 v[124:127], a[28:31], a[68:71], v[124:127]
 buffer_load_dwordx4 v2, s[16:19], s51 offen lds
 v_mfma_f32_16x16x32_bf16 v[124:127], a[24:27], a[64:67], v[124:127]
 s_add_u32 s59, s56, 32768
 v_cvt_pk_bf16_f32 v75, v78, v79
 v_cvt_pk_bf16_f32 v80, v80, v81
 v_mfma_f32_16x16x32_bf16 v[152:155], a[32:35], a[64:67], v[152:155]
 buffer_store_dwordx4 v[36:39], v1, s[12:15], s59 offen offset:0 sc1
 v_mfma_f32_16x16x32_bf16 v[152:155], a[36:39], a[68:71], v[152:155]
 v_cvt_pk_bf16_f32 v81, v82, v83
 v_cvt_pk_bf16_f32 v82, v84, v85
 v_mfma_f32_16x16x32_bf16 v[144:147], a[36:39], a[76:79], v[144:147]
 s_add_u32 m0, s29, 53248
 v_cvt_pk_bf16_f32 v83, v86, v87
 v_cvt_pk_bf16_f32 v88, v88, v89
 v_mfma_f32_16x16x32_bf16 v[144:147], a[32:35], a[72:75], v[144:147]
 buffer_load_dwordx4 v2, s[16:19], s52 offen lds
 v_mfma_f32_16x16x32_bf16 v[136:139], a[32:35], a[80:83], v[136:139]
 v_cvt_pk_bf16_f32 v89, v90, v91
 v_cvt_pk_bf16_f32 v90, v92, v93
 v_mfma_f32_16x16x32_bf16 v[136:139], a[36:39], a[84:87], v[136:139]
 v_cvt_pk_bf16_f32 v91, v94, v95
 v_cvt_pk_bf16_f32 v96, v96, v97
 v_mfma_f32_16x16x32_bf16 v[128:131], a[36:39], a[92:95], v[128:131]
 v_cvt_pk_bf16_f32 v97, v98, v99
 v_cvt_pk_bf16_f32 v98, v100, v101
 v_mfma_f32_16x16x32_bf16 v[128:131], a[32:35], a[88:91], v[128:131]
 s_add_u32 m0, s29, 57344
 v_cvt_pk_bf16_f32 v99, v102, v103
 v_cvt_pk_bf16_f32 v104, v104, v105
 v_mfma_f32_16x16x32_bf16 v[132:135], a[40:43], a[88:91], v[132:135]
 buffer_load_dwordx4 v2, s[16:19], s53 offen lds
 v_mfma_f32_16x16x32_bf16 v[132:135], a[44:47], a[92:95], v[132:135]
 s_add_u32 s59, s56, 40960
 v_cvt_pk_bf16_f32 v105, v106, v107
 v_cvt_pk_bf16_f32 v106, v108, v109
 v_mfma_f32_16x16x32_bf16 v[140:143], a[44:47], a[84:87], v[140:143]
 buffer_store_dwordx4 v[48:51], v1, s[12:15], s59 offen offset:1024 sc1
 v_mfma_f32_16x16x32_bf16 v[140:143], a[40:43], a[80:83], v[140:143]
 v_cvt_pk_bf16_f32 v107, v110, v111
 v_cvt_pk_bf16_f32 v112, v112, v113
 v_mfma_f32_16x16x32_bf16 v[148:151], a[40:43], a[72:75], v[148:151]
 s_add_u32 m0, s29, 61440
 v_cvt_pk_bf16_f32 v113, v114, v115
 v_cvt_pk_bf16_f32 v114, v116, v117
 v_mfma_f32_16x16x32_bf16 v[148:151], a[44:47], a[76:79], v[148:151]
 buffer_load_dwordx4 v2, s[16:19], s54 offen lds
 v_mfma_f32_16x16x32_bf16 v[156:159], a[44:47], a[68:71], v[156:159]
 v_cvt_pk_bf16_f32 v115, v118, v119
 v_cvt_pk_bf16_f32 v120, v120, v121
 v_mfma_f32_16x16x32_bf16 v[156:159], a[40:43], a[64:67], v[156:159]
 v_cvt_pk_bf16_f32 v121, v122, v123
 v_cvt_pk_bf16_f32 v122, v124, v125
 v_mfma_f32_16x16x32_bf16 v[184:187], a[48:51], a[64:67], v[184:187]
 s_add_u32 m0, s29, 98304
 v_add_u32 v2, 0x80000, v2
 v_cvt_pk_bf16_f32 v123, v126, v127
 v_mfma_f32_16x16x32_bf16 v[184:187], a[52:55], a[68:71], v[184:187]
 buffer_load_dwordx4 v2, s[16:19], 0 offen lds
 v_mfma_f32_16x16x32_bf16 v[176:179], a[52:55], a[76:79], v[176:179]
 s_add_u32 s59, s56, 32768
 v_cvt_pk_bf16_f32 v128, v128, v129
 v_cvt_pk_bf16_f32 v129, v130, v131
 v_mfma_f32_16x16x32_bf16 v[176:179], a[48:51], a[72:75], v[176:179]
 buffer_store_dwordx4 v[56:59], v1, s[12:15], s59 offen offset:1024 sc1
 v_mfma_f32_16x16x32_bf16 v[168:171], a[48:51], a[80:83], v[168:171]
 v_cvt_pk_bf16_f32 v130, v132, v133
 v_cvt_pk_bf16_f32 v131, v134, v135
 v_mfma_f32_16x16x32_bf16 v[168:171], a[52:55], a[84:87], v[168:171]
 s_add_u32 m0, s29, 102400
 v_cvt_pk_bf16_f32 v136, v136, v137
 v_cvt_pk_bf16_f32 v137, v138, v139
 v_mfma_f32_16x16x32_bf16 v[160:163], a[52:55], a[92:95], v[160:163]
 buffer_load_dwordx4 v2, s[16:19], s48 offen lds
 v_mfma_f32_16x16x32_bf16 v[160:163], a[48:51], a[88:91], v[160:163]
 v_cvt_pk_bf16_f32 v138, v140, v141
 v_cvt_pk_bf16_f32 v139, v142, v143
 v_mfma_f32_16x16x32_bf16 v[164:167], a[56:59], a[88:91], v[164:167]
 v_cvt_pk_bf16_f32 v144, v144, v145
 v_cvt_pk_bf16_f32 v145, v146, v147
 v_mfma_f32_16x16x32_bf16 v[164:167], a[60:63], a[92:95], v[164:167]
 v_cvt_pk_bf16_f32 v146, v148, v149
 v_cvt_pk_bf16_f32 v147, v150, v151
 v_mfma_f32_16x16x32_bf16 v[172:175], a[60:63], a[84:87], v[172:175]
 s_add_u32 m0, s29, 106496
 v_cvt_pk_bf16_f32 v152, v152, v153
 v_cvt_pk_bf16_f32 v153, v154, v155
 v_mfma_f32_16x16x32_bf16 v[172:175], a[56:59], a[80:83], v[172:175]
 buffer_load_dwordx4 v2, s[16:19], s49 offen lds
 v_mfma_f32_16x16x32_bf16 v[180:183], a[56:59], a[72:75], v[180:183]
 s_add_u32 s59, s56, 24576
 v_cvt_pk_bf16_f32 v154, v156, v157
 v_cvt_pk_bf16_f32 v155, v158, v159
 v_mfma_f32_16x16x32_bf16 v[180:183], a[60:63], a[76:79], v[180:183]
 buffer_store_dwordx4 v[64:67], v1, s[12:15], s59 offen offset:0 sc1
 v_mfma_f32_16x16x32_bf16 v[188:191], a[60:63], a[68:71], v[188:191]
 v_mfma_f32_16x16x32_bf16 v[188:191], a[56:59], a[64:67], v[188:191]
 s_add_u32 m0, s29, 110592
 v_mfma_f32_16x16x32_bf16 v[216:219], a[32:35], a[96:99], v[216:219]
 buffer_load_dwordx4 v2, s[16:19], s50 offen lds
 v_mfma_f32_16x16x32_bf16 v[216:219], a[36:39], a[100:103], v[216:219]
 v_cvt_pk_bf16_f32 v160, v160, v161
 v_cvt_pk_bf16_f32 v161, v162, v163
 v_mfma_f32_16x16x32_bf16 v[208:211], a[36:39], a[108:111], v[208:211]
 v_cvt_pk_bf16_f32 v162, v164, v165
 v_cvt_pk_bf16_f32 v163, v166, v167
 v_mfma_f32_16x16x32_bf16 v[208:211], a[32:35], a[104:107], v[208:211]
 v_cvt_pk_bf16_f32 v168, v168, v169
 v_cvt_pk_bf16_f32 v169, v170, v171
 v_mfma_f32_16x16x32_bf16 v[200:203], a[32:35], a[112:115], v[200:203]
 s_add_u32 m0, s29, 114688
 v_cvt_pk_bf16_f32 v170, v172, v173
 v_cvt_pk_bf16_f32 v171, v174, v175
 v_mfma_f32_16x16x32_bf16 v[200:203], a[36:39], a[116:119], v[200:203]
 buffer_load_dwordx4 v2, s[16:19], s51 offen lds
 v_mfma_f32_16x16x32_bf16 v[192:195], a[36:39], a[124:127], v[192:195]
 s_add_u32 s59, s56, 16384
 v_cvt_pk_bf16_f32 v176, v176, v177
 v_cvt_pk_bf16_f32 v177, v178, v179
 v_mfma_f32_16x16x32_bf16 v[192:195], a[32:35], a[120:123], v[192:195]
 buffer_store_dwordx4 v[72:75], v1, s[12:15], s59 offen offset:0 sc1
 v_mfma_f32_16x16x32_bf16 v[196:199], a[40:43], a[120:123], v[196:199]
 v_cvt_pk_bf16_f32 v178, v180, v181
 v_cvt_pk_bf16_f32 v179, v182, v183
 v_mfma_f32_16x16x32_bf16 v[196:199], a[44:47], a[124:127], v[196:199]
 s_add_u32 m0, s29, 118784
 v_cvt_pk_bf16_f32 v184, v184, v185
 v_cvt_pk_bf16_f32 v185, v186, v187
 v_mfma_f32_16x16x32_bf16 v[204:207], a[44:47], a[116:119], v[204:207]
 buffer_load_dwordx4 v2, s[16:19], s52 offen lds
 v_mfma_f32_16x16x32_bf16 v[204:207], a[40:43], a[112:115], v[204:207]
 v_cvt_pk_bf16_f32 v186, v188, v189
 v_cvt_pk_bf16_f32 v187, v190, v191
 v_mfma_f32_16x16x32_bf16 v[212:215], a[40:43], a[104:107], v[212:215]
 v_mfma_f32_16x16x32_bf16 v[212:215], a[44:47], a[108:111], v[212:215]
 v_mfma_f32_16x16x32_bf16 v[220:223], a[44:47], a[100:103], v[220:223]
 s_add_u32 m0, s29, 122880
 v_mfma_f32_16x16x32_bf16 v[220:223], a[40:43], a[96:99], v[220:223]
 buffer_load_dwordx4 v2, s[16:19], s53 offen lds
 v_mfma_f32_16x16x32_bf16 v[248:251], a[48:51], a[96:99], v[248:251]
 s_add_u32 s59, s56, 8192
 v_mfma_f32_16x16x32_bf16 v[248:251], a[52:55], a[100:103], v[248:251]
 s_waitcnt vmcnt(25)
 buffer_store_dwordx4 v[80:83], v1, s[12:15], s59 offen offset:0 sc1
 v_mfma_f32_16x16x32_bf16 v[240:243], a[52:55], a[108:111], v[240:243]
 s_barrier
 v_xor_b32 v7, 0, v6
 v_cvt_pk_bf16_f32 v192, v192, v193
 v_mfma_f32_16x16x32_bf16 v[240:243], a[48:51], a[104:107], v[240:243]
 s_add_u32 m0, s29, 126976
 ds_read_b64_tr_b16 a[64:65], v7 offset:0
 v_cvt_pk_bf16_f32 v193, v194, v195
 v_mfma_f32_16x16x32_bf16 v[232:235], a[48:51], a[112:115], v[232:235]
 ds_read_b64_tr_b16 a[66:67], v7 offset:4096
 buffer_load_dwordx4 v2, s[16:19], s54 offen lds
 v_mfma_f32_16x16x32_bf16 v[232:235], a[52:55], a[116:119], v[232:235]
 ds_read_b64_tr_b16 a[68:69], v7 offset:16384
 v_cvt_pk_bf16_f32 v194, v196, v197
 v_mfma_f32_16x16x32_bf16 v[224:227], a[52:55], a[124:127], v[224:227]
 ds_read_b64_tr_b16 a[70:71], v7 offset:20480
 v_xor_b32 v8, 65536, v6
 v_mfma_f32_16x16x32_bf16 v[224:227], a[48:51], a[120:123], v[224:227]
 s_add_u32 s59, s56, 0
 ds_read_b64_tr_b16 a[72:73], v8 offset:0
 v_cvt_pk_bf16_f32 v195, v198, v199
 v_mfma_f32_16x16x32_bf16 v[228:231], a[56:59], a[120:123], v[228:231]
 ds_read_b64_tr_b16 a[74:75], v8 offset:4096
 buffer_store_dwordx4 v[88:91], v1, s[12:15], s59 offen offset:0 sc1
 v_mfma_f32_16x16x32_bf16 v[228:231], a[60:63], a[124:127], v[228:231]
 ds_read_b64_tr_b16 a[76:77], v8 offset:16384
 v_cvt_pk_bf16_f32 v200, v200, v201
 v_mfma_f32_16x16x32_bf16 v[236:239], a[60:63], a[116:119], v[236:239]
 ds_read_b64_tr_b16 a[78:79], v8 offset:20480
 v_xor_b32 v9, 32, v6
 v_mfma_f32_16x16x32_bf16 v[236:239], a[56:59], a[112:115], v[236:239]
 ds_read_b64_tr_b16 a[80:81], v9 offset:0
 v_cvt_pk_bf16_f32 v201, v202, v203
 v_mfma_f32_16x16x32_bf16 v[244:247], a[56:59], a[104:107], v[244:247]
 ds_read_b64_tr_b16 a[82:83], v9 offset:4096
 v_cvt_pk_bf16_f32 v202, v204, v205
 v_mfma_f32_16x16x32_bf16 v[244:247], a[60:63], a[108:111], v[244:247]
 ds_read_b64_tr_b16 a[84:85], v9 offset:16384
 v_cvt_pk_bf16_f32 v203, v206, v207
 v_mfma_f32_16x16x32_bf16 v[252:255], a[60:63], a[100:103], v[252:255]
 s_add_u32 s59, s56, 24576
 ds_read_b64_tr_b16 a[86:87], v9 offset:20480
 v_xor_b32 v10, 65568, v6
 v_mfma_f32_16x16x32_bf16 v[252:255], a[56:59], a[96:99], v[252:255]
 s_waitcnt lgkmcnt(6)
 ds_read_b64_tr_b16 a[88:89], v10 offset:0
 buffer_store_dwordx4 v[96:99], v1, s[12:15], s59 offen offset:1024 sc1
 v_mfma_f32_16x16x32_bf16 v[28:31], a[64:67], a[128:131], 0
 ds_read_b64_tr_b16 a[90:91], v10 offset:4096
 v_cvt_pk_bf16_f32 v208, v208, v209
 v_mfma_f32_16x16x32_bf16 v[28:31], a[68:71], a[136:139], v[28:31]
 ds_read_b64_tr_b16 a[92:93], v10 offset:16384
 v_xor_b32 v7, 64, v6
 v_mfma_f32_16x16x32_bf16 v[28:31], a[72:75], a[144:147], v[28:31]
 s_waitcnt lgkmcnt(7)
 ds_read_b128 a[112:115], v14 offset:0
 ds_read_b64_tr_b16 a[94:95], v10 offset:20480
 v_mfma_f32_16x16x32_bf16 v[28:31], a[76:79], a[152:155], v[28:31]
 ds_read_b64_tr_b16 a[96:97], v7 offset:0
 v_cvt_pk_bf16_f32 v209, v210, v211
 v_mfma_f32_16x16x32_bf16 v[44:47], a[64:67], a[132:135], 0
 ds_read_b128 a[120:123], v3 offset:0
 ds_read_b64_tr_b16 a[98:99], v7 offset:4096
 v_mfma_f32_16x16x32_bf16 v[44:47], a[68:71], a[140:143], v[44:47]
 s_add_u32 s59, s56, 16384
 ds_read_b64_tr_b16 a[100:101], v7 offset:16384
 v_xor_b32 v8, 65600, v6
 v_mfma_f32_16x16x32_bf16 v[44:47], a[72:75], a[148:151], v[44:47]
 ds_read_b128 a[116:119], v14 offset:2048
 ds_read_b64_tr_b16 a[102:103], v7 offset:20480
 buffer_store_dwordx4 v[104:107], v1, s[12:15], s59 offen offset:1024 sc1
 v_mfma_f32_16x16x32_bf16 v[44:47], a[76:79], a[156:159], v[44:47]
 s_waitcnt lgkmcnt(9)
 ds_read_b64_tr_b16 a[104:105], v8 offset:0
 v_cvt_pk_bf16_f32 v210, v212, v213
 v_mfma_f32_16x16x32_bf16 v[52:55], a[80:83], a[128:131], 0
 ds_read_b128 a[124:127], v3 offset:2048
 ds_read_b64_tr_b16 a[106:107], v8 offset:4096
 v_mfma_f32_16x16x32_bf16 v[52:55], a[84:87], a[136:139], v[52:55]
 ds_read_b64_tr_b16 a[108:109], v8 offset:16384
 v_cvt_pk_bf16_f32 v211, v214, v215
 v_mfma_f32_16x16x32_bf16 v[52:55], a[88:91], a[144:147], v[52:55]
 s_waitcnt lgkmcnt(10)
 ds_read_b64_tr_b16 a[110:111], v8 offset:20480
 v_xor_b32 v9, 96, v6
 v_mfma_f32_16x16x32_bf16 v[52:55], a[92:95], a[152:155], v[52:55]
 ds_read_b64_tr_b16 a[64:65], v9 offset:0
 v_cvt_pk_bf16_f32 v216, v216, v217
 v_mfma_f32_16x16x32_bf16 v[60:63], a[80:83], a[132:135], 0
 s_add_u32 s59, s56, 8192
 ds_read_b64_tr_b16 a[66:67], v9 offset:4096
 v_cvt_pk_bf16_f32 v217, v218, v219
 v_mfma_f32_16x16x32_bf16 v[60:63], a[84:87], a[140:143], v[60:63]
 ds_read_b64_tr_b16 a[68:69], v9 offset:16384
 buffer_store_dwordx4 v[112:115], v1, s[12:15], s59 offen offset:1024 sc1
 v_mfma_f32_16x16x32_bf16 v[60:63], a[88:91], a[148:151], v[60:63]
 ds_read_b64_tr_b16 a[70:71], v9 offset:20480
 v_xor_b32 v10, 65632, v6
 v_mfma_f32_16x16x32_bf16 v[60:63], a[92:95], a[156:159], v[60:63]
 s_waitcnt lgkmcnt(6)
 ds_read_b64_tr_b16 a[72:73], v10 offset:0
 v_cvt_pk_bf16_f32 v218, v220, v221
 v_mfma_f32_16x16x32_bf16 v[20:23], a[96:99], a[128:131], 0
 ds_read_b64_tr_b16 a[74:75], v10 offset:4096
 v_cvt_pk_bf16_f32 v219, v222, v223
 v_mfma_f32_16x16x32_bf16 v[20:23], a[100:103], a[136:139], v[20:23]
 s_waitcnt lgkmcnt(8)
 ds_read_b64_tr_b16 a[76:77], v10 offset:16384
 v_xor_b32 v7, 128, v6
 v_mfma_f32_16x16x32_bf16 v[20:23], a[104:107], a[144:147], v[20:23]
 s_waitcnt lgkmcnt(7)
 s_barrier
 ds_read_b64_tr_b16 a[78:79], v10 offset:20480
 v_mfma_f32_16x16x32_bf16 v[20:23], a[108:111], a[152:155], v[20:23]
 s_add_u32 m0, s29, 131072
 ds_read_b64_tr_b16 a[80:81], v7 offset:0
 v_add_u32 v2, 0x80000, v2
 v_mfma_f32_16x16x32_bf16 v[36:39], a[96:99], a[132:135], 0
 ds_read_b64_tr_b16 a[82:83], v7 offset:4096
 buffer_load_dwordx4 v2, s[16:19], 0 offen lds
 v_mfma_f32_16x16x32_bf16 v[36:39], a[100:103], a[140:143], v[36:39]
 ds_read_b64_tr_b16 a[84:85], v7 offset:16384
 v_cvt_pk_bf16_f32 v224, v224, v225
 v_mfma_f32_16x16x32_bf16 v[36:39], a[104:107], a[148:151], v[36:39]
 s_add_u32 s59, s56, 0
 ds_read_b64_tr_b16 a[86:87], v7 offset:20480
 v_xor_b32 v8, 65664, v6
 v_mfma_f32_16x16x32_bf16 v[36:39], a[108:111], a[156:159], v[36:39]
 s_waitcnt lgkmcnt(6)
 ds_read_b64_tr_b16 a[88:89], v8 offset:0
 buffer_store_dwordx4 v[120:123], v1, s[12:15], s59 offen offset:1024 sc1
 v_mfma_f32_16x16x32_bf16 v[68:71], a[64:67], a[128:131], 0
 ds_read_b64_tr_b16 a[90:91], v8 offset:4096
 v_cvt_pk_bf16_f32 v225, v226, v227
 v_mfma_f32_16x16x32_bf16 v[68:71], a[68:71], a[136:139], v[68:71]
 s_add_u32 m0, s29, 135168
 ds_read_b64_tr_b16 a[92:93], v8 offset:16384
 v_cvt_pk_bf16_f32 v226, v228, v229
 v_mfma_f32_16x16x32_bf16 v[68:71], a[72:75], a[144:147], v[68:71]
 s_waitcnt lgkmcnt(7)
 ds_read_b64_tr_b16 a[94:95], v8 offset:20480
 v_xor_b32 v9, 160, v6
 v_mfma_f32_16x16x32_bf16 v[68:71], a[76:79], a[152:155], v[68:71]
 ds_read_b64_tr_b16 a[96:97], v9 offset:0
 buffer_load_dwordx4 v2, s[16:19], s48 offen lds
 v_mfma_f32_16x16x32_bf16 v[76:79], a[64:67], a[132:135], 0
 ds_read_b64_tr_b16 a[98:99], v9 offset:4096
 v_cvt_pk_bf16_f32 v227, v230, v231
 v_mfma_f32_16x16x32_bf16 v[76:79], a[68:71], a[140:143], v[76:79]
 ds_read_b64_tr_b16 a[100:101], v9 offset:16384
 v_cvt_pk_bf16_f32 v232, v232, v233
 v_mfma_f32_16x16x32_bf16 v[76:79], a[72:75], a[148:151], v[76:79]
 s_add_u32 s59, s56, 24576
 ds_read_b64_tr_b16 a[102:103], v9 offset:20480
 v_xor_b32 v10, 65696, v6
 v_mfma_f32_16x16x32_bf16 v[76:79], a[76:79], a[156:159], v[76:79]
 s_waitcnt lgkmcnt(6)
 ds_read_b64_tr_b16 a[104:105], v10 offset:0
 buffer_store_dwordx4 v[128:131], v1, s[12:15], s59 offen offset:2048 sc1
 v_mfma_f32_16x16x32_bf16 v[84:87], a[80:83], a[128:131], 0
 s_add_u32 m0, s29, 139264
 ds_read_b64_tr_b16 a[106:107], v10 offset:4096
 v_cvt_pk_bf16_f32 v233, v234, v235
 v_mfma_f32_16x16x32_bf16 v[84:87], a[84:87], a[136:139], v[84:87]
 ds_read_b64_tr_b16 a[108:109], v10 offset:16384
 buffer_load_dwordx4 v2, s[16:19], s49 offen lds
 v_mfma_f32_16x16x32_bf16 v[84:87], a[88:91], a[144:147], v[84:87]
 s_waitcnt lgkmcnt(7)
 ds_read_b64_tr_b16 a[110:111], v10 offset:20480
 v_xor_b32 v7, 192, v6
 v_mfma_f32_16x16x32_bf16 v[84:87], a[92:95], a[152:155], v[84:87]
 ds_read_b64_tr_b16 a[64:65], v7 offset:0
 v_cvt_pk_bf16_f32 v234, v236, v237
 v_mfma_f32_16x16x32_bf16 v[92:95], a[80:83], a[132:135], 0
 ds_read_b64_tr_b16 a[66:67], v7 offset:4096
 v_cvt_pk_bf16_f32 v235, v238, v239
 v_mfma_f32_16x16x32_bf16 v[92:95], a[84:87], a[140:143], v[92:95]
 ds_read_b64_tr_b16 a[68:69], v7 offset:16384
 v_cvt_pk_bf16_f32 v240, v240, v241
 v_mfma_f32_16x16x32_bf16 v[92:95], a[88:91], a[148:151], v[92:95]
 s_add_u32 m0, s29, 143360
 ds_read_b64_tr_b16 a[70:71], v7 offset:20480
 v_xor_b32 v8, 65728, v6
 v_mfma_f32_16x16x32_bf16 v[92:95], a[92:95], a[156:159], v[92:95]
 s_waitcnt lgkmcnt(6)
 ds_read_b64_tr_b16 a[72:73], v8 offset:0
 buffer_load_dwordx4 v2, s[16:19], s50 offen lds
 v_mfma_f32_16x16x32_bf16 v[100:103], a[96:99], a[128:131], 0
 s_add_u32 s59, s56, 16384
 ds_read_b64_tr_b16 a[74:75], v8 offset:4096
 v_cvt_pk_bf16_f32 v241, v242, v243
 v_mfma_f32_16x16x32_bf16 v[100:103], a[100:103], a[136:139], v[100:103]
 ds_read_b64_tr_b16 a[76:77], v8 offset:16384
 buffer_store_dwordx4 v[136:139], v1, s[12:15], s59 offen offset:2048 sc1
 v_mfma_f32_16x16x32_bf16 v[100:103], a[104:107], a[144:147], v[100:103]
 s_waitcnt lgkmcnt(7)
 ds_read_b64_tr_b16 a[78:79], v8 offset:20480
 v_xor_b32 v9, 224, v6
 v_mfma_f32_16x16x32_bf16 v[100:103], a[108:111], a[152:155], v[100:103]
 s_and_b32 s36, s95, 31
 ds_read_b64_tr_b16 a[80:81], v9 offset:0
 v_cvt_pk_bf16_f32 v242, v244, v245
 v_mfma_f32_16x16x32_bf16 v[108:111], a[96:99], a[132:135], 0
 s_add_u32 m0, s29, 147456
 ds_read_b64_tr_b16 a[82:83], v9 offset:4096
 v_cvt_pk_bf16_f32 v243, v246, v247
 v_mfma_f32_16x16x32_bf16 v[108:111], a[100:103], a[140:143], v[108:111]
 ds_read_b64_tr_b16 a[84:85], v9 offset:16384
 buffer_load_dwordx4 v2, s[16:19], s51 offen lds
 v_mfma_f32_16x16x32_bf16 v[108:111], a[104:107], a[148:151], v[108:111]
 s_add_u32 s59, s56, 8192
 ds_read_b64_tr_b16 a[86:87], v9 offset:20480
 v_xor_b32 v10, 65760, v6
 v_mfma_f32_16x16x32_bf16 v[108:111], a[108:111], a[156:159], v[108:111]
 s_waitcnt lgkmcnt(6)
 ds_read_b64_tr_b16 a[88:89], v10 offset:0
 v_cvt_pk_bf16_f32 v248, v248, v249
 v_mfma_f32_16x16x32_bf16 v[116:119], a[64:67], a[128:131], 0
 ds_read_b64_tr_b16 a[90:91], v10 offset:4096
 buffer_store_dwordx4 v[144:147], v1, s[12:15], s59 offen offset:2048 sc1
 v_mfma_f32_16x16x32_bf16 v[116:119], a[68:71], a[136:139], v[116:119]
 s_add_u32 m0, s29, 151552
 ds_read_b64_tr_b16 a[92:93], v10 offset:16384
 v_cvt_pk_bf16_f32 v249, v250, v251
 v_mfma_f32_16x16x32_bf16 v[116:119], a[72:75], a[144:147], v[116:119]
 s_waitcnt lgkmcnt(7)
 ds_read_b64_tr_b16 a[94:95], v10 offset:20480
 v_xor_b32 v7, 256, v6
 v_mfma_f32_16x16x32_bf16 v[116:119], a[76:79], a[152:155], v[116:119]
 ds_read_b64_tr_b16 a[96:97], v7 offset:0
 buffer_load_dwordx4 v2, s[16:19], s52 offen lds
 v_mfma_f32_16x16x32_bf16 v[124:127], a[64:67], a[132:135], 0
 s_lshr_b32 s37, s95, 5
 ds_read_b64_tr_b16 a[98:99], v7 offset:4096
 v_cvt_pk_bf16_f32 v250, v252, v253
 v_mfma_f32_16x16x32_bf16 v[124:127], a[68:71], a[140:143], v[124:127]
 s_lshl_b32 s38, s3, 4
 ds_read_b64_tr_b16 a[100:101], v7 offset:16384
 v_cvt_pk_bf16_f32 v251, v254, v255
 v_mfma_f32_16x16x32_bf16 v[124:127], a[72:75], a[148:151], v[124:127]
 s_add_u32 s59, s56, 0
 ds_read_b64_tr_b16 a[102:103], v7 offset:20480
 v_xor_b32 v8, 65792, v6
 v_mfma_f32_16x16x32_bf16 v[124:127], a[76:79], a[156:159], v[124:127]
 s_waitcnt lgkmcnt(6)
 ds_read_b64_tr_b16 a[104:105], v8 offset:0
 buffer_store_dwordx4 v[152:155], v1, s[12:15], s59 offen offset:2048 sc1
 v_mfma_f32_16x16x32_bf16 v[132:135], a[80:83], a[128:131], 0
 s_add_u32 m0, s29, 155648
 ds_read_b64_tr_b16 a[106:107], v8 offset:4096
 v_accvgpr_read_b32 v11, a245
 v_mfma_f32_16x16x32_bf16 v[132:135], a[84:87], a[136:139], v[132:135]
 ds_read_b64_tr_b16 a[108:109], v8 offset:16384
 buffer_load_dwordx4 v2, s[16:19], s53 offen lds
 v_mfma_f32_16x16x32_bf16 v[132:135], a[88:91], a[144:147], v[132:135]
 s_waitcnt lgkmcnt(7)
 ds_read_b64_tr_b16 a[110:111], v8 offset:20480
 v_xor_b32 v9, 288, v6
 v_mfma_f32_16x16x32_bf16 v[132:135], a[92:95], a[152:155], v[132:135]
 s_lshl_b32 s39, s36, 6
 ds_read_b64_tr_b16 a[64:65], v9 offset:0
 v_mov_b32 v12, 0
 v_mfma_f32_16x16x32_bf16 v[140:143], a[80:83], a[132:135], 0
 ds_read_b64_tr_b16 a[66:67], v9 offset:4096
 global_load_dword v5, v12, s[90:91] offset:128 sc1
 v_mfma_f32_16x16x32_bf16 v[140:143], a[84:87], a[140:143], v[140:143]
 s_add_u32 s38, s38, s39
 ds_read_b64_tr_b16 a[68:69], v9 offset:16384
 v_and_b32 v12, 11, v0
 v_mfma_f32_16x16x32_bf16 v[140:143], a[88:91], a[148:151], v[140:143]
 s_add_u32 m0, s29, 159744
 ds_read_b64_tr_b16 a[70:71], v9 offset:20480
 v_xor_b32 v10, 65824, v6
 v_mfma_f32_16x16x32_bf16 v[140:143], a[92:95], a[156:159], v[140:143]
 s_waitcnt lgkmcnt(6)
 ds_read_b64_tr_b16 a[72:73], v10 offset:0
 buffer_load_dwordx4 v2, s[16:19], s54 offen lds
 v_mfma_f32_16x16x32_bf16 v[148:151], a[96:99], a[128:131], 0
 s_add_u32 s59, s56, 24576
 ds_read_b64_tr_b16 a[74:75], v10 offset:4096
 v_lshlrev_b32 v12, 2, v12
 v_mfma_f32_16x16x32_bf16 v[148:151], a[100:103], a[136:139], v[148:151]
 ds_read_b64_tr_b16 a[76:77], v10 offset:16384
 buffer_store_dwordx4 v[160:163], v1, s[12:15], s59 offen offset:3072 sc1
 v_mfma_f32_16x16x32_bf16 v[148:151], a[104:107], a[144:147], v[148:151]
 s_waitcnt lgkmcnt(7)
 ds_read_b64_tr_b16 a[78:79], v10 offset:20480
 v_xor_b32 v7, 320, v6
 v_mfma_f32_16x16x32_bf16 v[148:151], a[108:111], a[152:155], v[148:151]
 s_mul_i32 s38, s38, 896
 ds_read_b64_tr_b16 a[80:81], v7 offset:0
 v_and_b32 v14, 15, v0
 v_mfma_f32_16x16x32_bf16 v[156:159], a[96:99], a[132:135], 0
 s_lshl_b32 s39, s37, 7
 ds_read_b64_tr_b16 a[82:83], v7 offset:4096
 v_lshrrev_b32 v3, 4, v0
 v_mfma_f32_16x16x32_bf16 v[156:159], a[100:103], a[140:143], v[156:159]
 s_add_u32 s38, s38, s39
 ds_read_b64_tr_b16 a[84:85], v7 offset:16384
 v_lshlrev_b32 v3, 2, v3
 v_mfma_f32_16x16x32_bf16 v[156:159], a[104:107], a[148:151], v[156:159]
 s_add_u32 s59, s56, 16384
 ds_read_b64_tr_b16 a[86:87], v7 offset:20480
 v_xor_b32 v8, 65856, v6
 v_mfma_f32_16x16x32_bf16 v[156:159], a[108:111], a[156:159], v[156:159]
 s_waitcnt lgkmcnt(6)
 ds_read_b64_tr_b16 a[88:89], v8 offset:0
 v_sub_u32 v14, v14, v3
 v_mfma_f32_16x16x32_bf16 v[164:167], a[64:67], a[128:131], 0
 ds_read_b64_tr_b16 a[90:91], v8 offset:4096
 buffer_store_dwordx4 v[168:171], v1, s[12:15], s59 offen offset:3072 sc1
 v_mfma_f32_16x16x32_bf16 v[164:167], a[68:71], a[136:139], v[164:167]
 s_lshl_b32 s39, s37, 9
 ds_read_b64_tr_b16 a[92:93], v8 offset:16384
 v_lshrrev_b32_e64 v3, 6, s29
 v_mfma_f32_16x16x32_bf16 v[164:167], a[72:75], a[144:147], v[164:167]
 s_waitcnt lgkmcnt(7)
 ds_read_b64_tr_b16 a[94:95], v8 offset:20480
 v_xor_b32 v9, 352, v6
 v_mfma_f32_16x16x32_bf16 v[164:167], a[76:79], a[152:155], v[164:167]
 s_mov_b32 s4, s66
 ds_read_b64_tr_b16 a[96:97], v9 offset:0
 v_add_u32 v14, v3, v14
 v_mfma_f32_16x16x32_bf16 v[172:175], a[64:67], a[132:135], 0
 s_mov_b32 s5, s67
 ds_read_b64_tr_b16 a[98:99], v9 offset:4096
 v_mov_b32 v15, 0xf149f2ca
 v_mfma_f32_16x16x32_bf16 v[172:175], a[68:71], a[140:143], v[172:175]
 s_mov_b32 s6, 1835008
 ds_read_b64_tr_b16 a[100:101], v9 offset:16384
 v_cmp_gt_i32 vcc, 0, v14
 v_mfma_f32_16x16x32_bf16 v[172:175], a[72:75], a[148:151], v[172:175]
 s_add_u32 s59, s56, 8192
 ds_read_b64_tr_b16 a[102:103], v9 offset:20480
 v_xor_b32 v10, 65888, v6
 v_mfma_f32_16x16x32_bf16 v[172:175], a[76:79], a[156:159], v[172:175]
 s_waitcnt lgkmcnt(6)
 ds_read_b64_tr_b16 a[104:105], v10 offset:0
 buffer_store_dwordx4 v[176:179], v1, s[12:15], s59 offen offset:3072 sc1
 v_mfma_f32_16x16x32_bf16 v[180:183], a[80:83], a[128:131], 0
 s_mov_b32 s7, 0x20000
 ds_read_b64_tr_b16 a[106:107], v10 offset:4096
 v_cndmask_b32 v3, 0, v15, vcc
 v_mfma_f32_16x16x32_bf16 v[180:183], a[84:87], a[136:139], v[180:183]
 s_mov_b32 s8, s68
 ds_read_b64_tr_b16 a[108:109], v10 offset:16384
 v_accvgpr_write_b32 a224, v3
 v_mfma_f32_16x16x32_bf16 v[180:183], a[88:91], a[144:147], v[180:183]
 s_waitcnt lgkmcnt(7)
 ds_read_b64_tr_b16 a[110:111], v10 offset:20480
 v_xor_b32 v7, 384, v6
 v_mfma_f32_16x16x32_bf16 v[180:183], a[92:95], a[152:155], v[180:183]
 s_mov_b32 s9, s69
 ds_read_b64_tr_b16 a[64:65], v7 offset:0
 v_cmp_gt_i32 vcc, 1, v14
 v_mfma_f32_16x16x32_bf16 v[188:191], a[80:83], a[132:135], 0
 s_mov_b32 s10, 1835008
 ds_read_b64_tr_b16 a[66:67], v7 offset:4096
 v_cndmask_b32 v3, 0, v15, vcc
 v_mfma_f32_16x16x32_bf16 v[188:191], a[84:87], a[140:143], v[188:191]
 s_mov_b32 s11, 0x20000
 ds_read_b64_tr_b16 a[68:69], v7 offset:16384
 v_accvgpr_write_b32 a225, v3
 v_mfma_f32_16x16x32_bf16 v[188:191], a[88:91], a[148:151], v[188:191]
 s_add_u32 s59, s56, 0
 ds_read_b64_tr_b16 a[70:71], v7 offset:20480
 v_xor_b32 v8, 65920, v6
 v_mfma_f32_16x16x32_bf16 v[188:191], a[92:95], a[156:159], v[188:191]
 s_waitcnt lgkmcnt(6)
 ds_read_b64_tr_b16 a[72:73], v8 offset:0
 buffer_store_dwordx4 v[184:187], v1, s[12:15], s59 offen offset:3072 sc1
 v_mfma_f32_16x16x32_bf16 v[196:199], a[96:99], a[128:131], 0
 s_mov_b32 s20, s70
 ds_read_b64_tr_b16 a[74:75], v8 offset:4096
 v_cmp_gt_i32 vcc, 2, v14
 v_mfma_f32_16x16x32_bf16 v[196:199], a[100:103], a[136:139], v[196:199]
 s_mov_b32 s21, s71
 ds_read_b64_tr_b16 a[76:77], v8 offset:16384
 v_cndmask_b32 v3, 0, v15, vcc
 v_mfma_f32_16x16x32_bf16 v[196:199], a[104:107], a[144:147], v[196:199]
 s_waitcnt lgkmcnt(7)
 ds_read_b64_tr_b16 a[78:79], v8 offset:20480
 v_xor_b32 v9, 416, v6
 v_mfma_f32_16x16x32_bf16 v[196:199], a[108:111], a[152:155], v[196:199]
 s_mov_b32 s22, 3584
 ds_read_b64_tr_b16 a[80:81], v9 offset:0
 v_accvgpr_write_b32 a226, v3
 v_mfma_f32_16x16x32_bf16 v[204:207], a[96:99], a[132:135], 0
 s_mov_b32 s23, 0x20000
 ds_read_b64_tr_b16 a[82:83], v9 offset:4096
 v_cmp_gt_i32 vcc, 3, v14
 v_mfma_f32_16x16x32_bf16 v[204:207], a[100:103], a[140:143], v[204:207]
 ds_read_b64_tr_b16 a[84:85], v9 offset:16384
 v_lshrrev_b32 v120, 3, v0
 v_mfma_f32_16x16x32_bf16 v[204:207], a[104:107], a[148:151], v[204:207]
 s_add_u32 s59, s56, 57344
 ds_read_b64_tr_b16 a[86:87], v9 offset:20480
 v_xor_b32 v10, 65952, v6
 v_mfma_f32_16x16x32_bf16 v[204:207], a[108:111], a[156:159], v[204:207]
 s_waitcnt lgkmcnt(6)
 ds_read_b64_tr_b16 a[88:89], v10 offset:0
 buffer_store_dwordx4 v[192:195], v1, s[12:15], s59 offen offset:2048 sc1
 v_mfma_f32_16x16x32_bf16 v[212:215], a[64:67], a[128:131], 0
 ds_read_b64_tr_b16 a[90:91], v10 offset:4096
 v_mul_u32_u24 v120, 1792, v120
 v_mfma_f32_16x16x32_bf16 v[212:215], a[68:71], a[136:139], v[212:215]
 ds_read_b64_tr_b16 a[92:93], v10 offset:16384
 v_and_b32 v121, 7, v0
 v_mfma_f32_16x16x32_bf16 v[212:215], a[72:75], a[144:147], v[212:215]
 s_waitcnt lgkmcnt(7)
 ds_read_b64_tr_b16 a[94:95], v10 offset:20480
 v_xor_b32 v7, 448, v6
 v_mfma_f32_16x16x32_bf16 v[212:215], a[76:79], a[152:155], v[212:215]
 ds_read_b64_tr_b16 a[96:97], v7 offset:0
 v_lshl_add_u32 v120, v121, 4, v120
 v_mfma_f32_16x16x32_bf16 v[220:223], a[64:67], a[132:135], 0
 ds_read_b64_tr_b16 a[98:99], v7 offset:4096
 v_add_u32 v120, s38, v120
 v_mfma_f32_16x16x32_bf16 v[220:223], a[68:71], a[140:143], v[220:223]
 ds_read_b64_tr_b16 a[100:101], v7 offset:16384
 v_lshlrev_b32 v121, 6, v121
 v_mfma_f32_16x16x32_bf16 v[220:223], a[72:75], a[148:151], v[220:223]
 s_add_u32 s59, s56, 49152
 ds_read_b64_tr_b16 a[102:103], v7 offset:20480
 v_xor_b32 v8, 65984, v6
 v_mfma_f32_16x16x32_bf16 v[220:223], a[76:79], a[156:159], v[220:223]
 s_waitcnt lgkmcnt(6)
 ds_read_b64_tr_b16 a[104:105], v8 offset:0
 buffer_store_dwordx4 v[200:203], v1, s[12:15], s59 offen offset:2048 sc1
 v_mfma_f32_16x16x32_bf16 v[228:231], a[80:83], a[128:131], 0
 ds_read_b64_tr_b16 a[106:107], v8 offset:4096
 v_subrev_u32 v122, 2688, v120
 v_mfma_f32_16x16x32_bf16 v[228:231], a[84:87], a[136:139], v[228:231]
 ds_read_b64_tr_b16 a[108:109], v8 offset:16384
 v_subrev_u32 v123, 1792, v120
 v_mfma_f32_16x16x32_bf16 v[228:231], a[88:91], a[144:147], v[228:231]
 s_waitcnt lgkmcnt(7)
 ds_read_b64_tr_b16 a[110:111], v8 offset:20480
 v_xor_b32 v9, 480, v6
 v_mfma_f32_16x16x32_bf16 v[228:231], a[92:95], a[152:155], v[228:231]
 ds_read_b64_tr_b16 a[64:65], v9 offset:0
 v_subrev_u32 v128, 896, v120
 v_mfma_f32_16x16x32_bf16 v[236:239], a[80:83], a[132:135], 0
 ds_read_b64_tr_b16 a[66:67], v9 offset:4096
 v_cndmask_b32 v3, 0, v15, vcc
 v_mfma_f32_16x16x32_bf16 v[236:239], a[84:87], a[140:143], v[236:239]
 ds_read_b64_tr_b16 a[68:69], v9 offset:16384
 v_accvgpr_write_b32 a227, v3
 v_mfma_f32_16x16x32_bf16 v[236:239], a[88:91], a[148:151], v[236:239]
 s_add_u32 s59, s56, 40960
 ds_read_b64_tr_b16 a[70:71], v9 offset:20480
 v_xor_b32 v10, 66016, v6
 v_mfma_f32_16x16x32_bf16 v[236:239], a[92:95], a[156:159], v[236:239]
 s_waitcnt lgkmcnt(6)
 ds_read_b64_tr_b16 a[72:73], v10 offset:0
 buffer_store_dwordx4 v[208:211], v1, s[12:15], s59 offen offset:2048 sc1
 v_mfma_f32_16x16x32_bf16 v[244:247], a[96:99], a[128:131], 0
 ds_read_b64_tr_b16 a[74:75], v10 offset:4096
 v_cmp_gt_i32 vcc, 16, v14
 v_mfma_f32_16x16x32_bf16 v[244:247], a[100:103], a[136:139], v[244:247]
 s_waitcnt vmcnt(25)
 ds_read_b64_tr_b16 a[76:77], v10 offset:16384
 v_xor_b32 v7, 32768, v6
 v_mfma_f32_16x16x32_bf16 v[244:247], a[104:107], a[144:147], v[244:247]
 s_waitcnt lgkmcnt(7)
 s_barrier
 ds_read_b64_tr_b16 a[78:79], v10 offset:20480
 v_mfma_f32_16x16x32_bf16 v[244:247], a[108:111], a[152:155], v[244:247]
 ds_read_b64_tr_b16 a[80:81], v7 offset:0
 v_cndmask_b32 v3, 0, v15, vcc
 v_mfma_f32_16x16x32_bf16 v[252:255], a[96:99], a[132:135], 0
 ds_read_b64_tr_b16 a[82:83], v7 offset:4096
 v_accvgpr_write_b32 a228, v3
 v_mfma_f32_16x16x32_bf16 v[252:255], a[100:103], a[140:143], v[252:255]
 ds_read_b64_tr_b16 a[84:85], v7 offset:16384
 v_cmp_gt_i32 vcc, 17, v14
 v_mfma_f32_16x16x32_bf16 v[252:255], a[104:107], a[148:151], v[252:255]
 s_add_u32 s59, s56, 32768
 ds_read_b64_tr_b16 a[86:87], v7 offset:20480
 v_xor_b32 v8, 98304, v6
 v_mfma_f32_16x16x32_bf16 v[252:255], a[108:111], a[156:159], v[252:255]
 s_waitcnt lgkmcnt(6)
 ds_read_b64_tr_b16 a[88:89], v8 offset:0
 buffer_store_dwordx4 v[216:219], v1, s[12:15], s59 offen offset:2048 sc1
 v_mfma_f32_16x16x32_bf16 v[16:19], a[64:67], a[128:131], 0
 ds_read_b64_tr_b16 a[90:91], v8 offset:4096
 v_cndmask_b32 v3, 0, v15, vcc
 v_mfma_f32_16x16x32_bf16 v[16:19], a[68:71], a[136:139], v[16:19]
 ds_read_b64_tr_b16 a[92:93], v8 offset:16384
 v_accvgpr_write_b32 a229, v3
 v_mfma_f32_16x16x32_bf16 v[16:19], a[72:75], a[144:147], v[16:19]
 s_waitcnt lgkmcnt(7)
 ds_read_b64_tr_b16 a[94:95], v8 offset:20480
 v_xor_b32 v9, 32800, v6
 v_mfma_f32_16x16x32_bf16 v[16:19], a[76:79], a[152:155], v[16:19]
 ds_read_b64_tr_b16 a[96:97], v9 offset:0
 v_cmp_gt_i32 vcc, 18, v14
 v_mfma_f32_16x16x32_bf16 v[24:27], a[64:67], a[132:135], 0
 s_waitcnt lgkmcnt(9)
 ds_read_b64_tr_b16 a[98:99], v9 offset:4096
 v_cndmask_b32 v3, 0, v15, vcc
 v_mfma_f32_16x16x32_bf16 v[24:27], a[68:71], a[140:143], v[24:27]
 s_barrier
 ds_read_b64_tr_b16 a[100:101], v9 offset:16384
 v_accvgpr_write_b32 a230, v3
 v_mfma_f32_16x16x32_bf16 v[24:27], a[72:75], a[148:151], v[24:27]
 s_add_u32 m0, s29, 0
 ds_read_b64_tr_b16 a[102:103], v9 offset:20480
 v_xor_b32 v10, 98336, v6
 v_mfma_f32_16x16x32_bf16 v[24:27], a[76:79], a[156:159], v[24:27]
 s_waitcnt lgkmcnt(6)
 ds_read_b64_tr_b16 a[104:105], v10 offset:0
 v_add_u32 v2, 0x80000, v2
 v_mfma_f32_16x16x32_bf16 v[28:31], a[80:83], a[160:163], v[28:31]
 ds_read_b64_tr_b16 a[106:107], v10 offset:4096
 buffer_load_dwordx4 v2, s[16:19], 0 offen lds
 v_mfma_f32_16x16x32_bf16 v[28:31], a[84:87], a[168:171], v[28:31]
 s_add_u32 s59, s56, 57344
 ds_read_b64_tr_b16 a[108:109], v10 offset:16384
 v_cmp_gt_i32 vcc, 19, v14
 v_mfma_f32_16x16x32_bf16 v[28:31], a[88:91], a[176:179], v[28:31]
 s_waitcnt lgkmcnt(7)
 ds_read_b64_tr_b16 a[110:111], v10 offset:20480
 v_xor_b32 v7, 32832, v6
 v_mfma_f32_16x16x32_bf16 v[28:31], a[92:95], a[184:187], v[28:31]
 ds_read_b64_tr_b16 a[64:65], v7 offset:0
 buffer_store_dwordx4 v[224:227], v1, s[12:15], s59 offen offset:3072 sc1
 v_mfma_f32_16x16x32_bf16 v[44:47], a[80:83], a[164:167], v[44:47]
 s_add_u32 m0, s29, 4096
 ds_read_b64_tr_b16 a[66:67], v7 offset:4096
 v_add_u32 v4, 4096, v1
 v_mfma_f32_16x16x32_bf16 v[44:47], a[84:87], a[172:175], v[44:47]
 ds_read_b64_tr_b16 a[68:69], v7 offset:16384
 buffer_load_dwordx4 v2, s[16:19], s48 offen lds
 v_mfma_f32_16x16x32_bf16 v[44:47], a[88:91], a[180:183], v[44:47]
 ds_read_b64_tr_b16 a[70:71], v7 offset:20480
 v_xor_b32 v8, 98368, v6
 v_mfma_f32_16x16x32_bf16 v[44:47], a[92:95], a[188:191], v[44:47]
 s_waitcnt lgkmcnt(6)
 ds_read_b64_tr_b16 a[72:73], v8 offset:0
 v_cndmask_b32 v3, 0, v15, vcc
 v_mfma_f32_16x16x32_bf16 v[52:55], a[96:99], a[160:163], v[52:55]
 ds_read_b64_tr_b16 a[74:75], v8 offset:4096
 v_accvgpr_write_b32 a231, v3
 v_mfma_f32_16x16x32_bf16 v[52:55], a[100:103], a[168:171], v[52:55]
 s_add_u32 m0, s29, 8192
 ds_read_b64_tr_b16 a[76:77], v8 offset:16384
 v_cmp_gt_i32 vcc, 32, v14
 v_mfma_f32_16x16x32_bf16 v[52:55], a[104:107], a[176:179], v[52:55]
 s_waitcnt lgkmcnt(7)
 ds_read_b64_tr_b16 a[78:79], v8 offset:20480
 v_xor_b32 v9, 32864, v6
 v_mfma_f32_16x16x32_bf16 v[52:55], a[108:111], a[184:187], v[52:55]
 ds_read_b64_tr_b16 a[80:81], v9 offset:0
 buffer_load_dwordx4 v2, s[16:19], s49 offen lds
 v_mfma_f32_16x16x32_bf16 v[60:63], a[96:99], a[164:167], v[60:63]
 s_add_u32 s59, s56, 49152
 ds_read_b64_tr_b16 a[82:83], v9 offset:4096
 v_cndmask_b32 v3, 0, v15, vcc
 v_mfma_f32_16x16x32_bf16 v[60:63], a[100:103], a[172:175], v[60:63]
 ds_read_b64_tr_b16 a[84:85], v9 offset:16384
 buffer_store_dwordx4 v[232:235], v1, s[12:15], s59 offen offset:3072 sc1
 v_mfma_f32_16x16x32_bf16 v[60:63], a[104:107], a[180:183], v[60:63]
 s_add_u32 m0, s29, 12288
 ds_read_b64_tr_b16 a[86:87], v9 offset:20480
 v_xor_b32 v10, 98400, v6
 v_mfma_f32_16x16x32_bf16 v[60:63], a[108:111], a[188:191], v[60:63]
 s_waitcnt lgkmcnt(6)
 ds_read_b64_tr_b16 a[88:89], v10 offset:0
 v_accvgpr_write_b32 a232, v3
 v_mfma_f32_16x16x32_bf16 v[20:23], a[64:67], a[160:163], v[20:23]
 ds_read_b64_tr_b16 a[90:91], v10 offset:4096
 buffer_load_dwordx4 v2, s[16:19], s50 offen lds
 v_mfma_f32_16x16x32_bf16 v[20:23], a[68:71], a[168:171], v[20:23]
 ds_read_b64_tr_b16 a[92:93], v10 offset:16384
 v_cmp_gt_i32 vcc, 33, v14
 v_mfma_f32_16x16x32_bf16 v[20:23], a[72:75], a[176:179], v[20:23]
 s_waitcnt lgkmcnt(7)
 ds_read_b64_tr_b16 a[94:95], v10 offset:20480
 v_xor_b32 v7, 32896, v6
 v_mfma_f32_16x16x32_bf16 v[20:23], a[76:79], a[184:187], v[20:23]
 ds_read_b64_tr_b16 a[96:97], v7 offset:0
 v_cndmask_b32 v3, 0, v15, vcc
 v_mfma_f32_16x16x32_bf16 v[36:39], a[64:67], a[164:167], v[36:39]
 s_add_u32 m0, s29, 16384
 ds_read_b64_tr_b16 a[98:99], v7 offset:4096
 v_accvgpr_write_b32 a233, v3
 v_mfma_f32_16x16x32_bf16 v[36:39], a[68:71], a[172:175], v[36:39]
 ds_read_b64_tr_b16 a[100:101], v7 offset:16384
 buffer_load_dwordx4 v2, s[16:19], s51 offen lds
 v_mfma_f32_16x16x32_bf16 v[36:39], a[72:75], a[180:183], v[36:39]
 s_add_u32 s59, s56, 40960
 ds_read_b64_tr_b16 a[102:103], v7 offset:20480
 v_xor_b32 v8, 98432, v6
 v_mfma_f32_16x16x32_bf16 v[36:39], a[76:79], a[188:191], v[36:39]
 s_waitcnt lgkmcnt(6)
 ds_read_b64_tr_b16 a[104:105], v8 offset:0
 buffer_store_dwordx4 v[240:243], v1, s[12:15], s59 offen offset:3072 sc1
 v_mfma_f32_16x16x32_bf16 v[68:71], a[80:83], a[160:163], v[68:71]
 ds_read_b64_tr_b16 a[106:107], v8 offset:4096
 v_cmp_gt_i32 vcc, 34, v14
 v_mfma_f32_16x16x32_bf16 v[68:71], a[84:87], a[168:171], v[68:71]
 s_add_u32 m0, s29, 20480
 ds_read_b64_tr_b16 a[108:109], v8 offset:16384
 v_cndmask_b32 v3, 0, v15, vcc
 v_mfma_f32_16x16x32_bf16 v[68:71], a[88:91], a[176:179], v[68:71]
 s_waitcnt lgkmcnt(7)
 ds_read_b64_tr_b16 a[110:111], v8 offset:20480
 v_xor_b32 v9, 32928, v6
 v_mfma_f32_16x16x32_bf16 v[68:71], a[92:95], a[184:187], v[68:71]
 ds_read_b64_tr_b16 a[64:65], v9 offset:0
 buffer_load_dwordx4 v2, s[16:19], s52 offen lds
 v_mfma_f32_16x16x32_bf16 v[76:79], a[80:83], a[164:167], v[76:79]
 ds_read_b64_tr_b16 a[66:67], v9 offset:4096
 v_accvgpr_write_b32 a234, v3
 v_mfma_f32_16x16x32_bf16 v[76:79], a[84:87], a[172:175], v[76:79]
 ds_read_b64_tr_b16 a[68:69], v9 offset:16384
 v_cmp_gt_i32 vcc, 35, v14
 v_mfma_f32_16x16x32_bf16 v[76:79], a[88:91], a[180:183], v[76:79]
 s_add_u32 m0, s29, 24576
 ds_read_b64_tr_b16 a[70:71], v9 offset:20480
 v_xor_b32 v10, 98464, v6
 v_mfma_f32_16x16x32_bf16 v[76:79], a[92:95], a[188:191], v[76:79]
 s_waitcnt lgkmcnt(6)
 ds_read_b64_tr_b16 a[72:73], v10 offset:0
 v_cndmask_b32 v3, 0, v15, vcc
 v_mfma_f32_16x16x32_bf16 v[84:87], a[96:99], a[160:163], v[84:87]
 ds_read_b64_tr_b16 a[74:75], v10 offset:4096
 buffer_load_dwordx4 v2, s[16:19], s53 offen lds
 v_mfma_f32_16x16x32_bf16 v[84:87], a[100:103], a[168:171], v[84:87]
 s_add_u32 s59, s56, 32768
 ds_read_b64_tr_b16 a[76:77], v10 offset:16384
 v_accvgpr_write_b32 a235, v3
 v_mfma_f32_16x16x32_bf16 v[84:87], a[104:107], a[176:179], v[84:87]
 s_waitcnt lgkmcnt(7)
 ds_read_b64_tr_b16 a[78:79], v10 offset:20480
 v_xor_b32 v7, 32960, v6
 v_mfma_f32_16x16x32_bf16 v[84:87], a[108:111], a[184:187], v[84:87]
 ds_read_b64_tr_b16 a[80:81], v7 offset:0
 buffer_store_dwordx4 v[248:251], v1, s[12:15], s59 offen offset:3072 sc1
 v_mfma_f32_16x16x32_bf16 v[92:95], a[96:99], a[164:167], v[92:95]
 s_add_u32 m0, s29, 28672
 ds_read_b64_tr_b16 a[82:83], v7 offset:4096
 v_cmp_gt_i32 vcc, 48, v14
 v_mfma_f32_16x16x32_bf16 v[92:95], a[100:103], a[172:175], v[92:95]
 ds_read_b64_tr_b16 a[84:85], v7 offset:16384
 buffer_load_dwordx4 v2, s[16:19], s54 offen lds
 v_mfma_f32_16x16x32_bf16 v[92:95], a[104:107], a[180:183], v[92:95]
 ds_read_b64_tr_b16 a[86:87], v7 offset:20480
 v_xor_b32 v8, 98496, v6
 v_mfma_f32_16x16x32_bf16 v[92:95], a[108:111], a[188:191], v[92:95]
 s_waitcnt lgkmcnt(6)
 ds_read_b64_tr_b16 a[88:89], v8 offset:0
 v_cndmask_b32 v3, 0, v15, vcc
 v_mfma_f32_16x16x32_bf16 v[100:103], a[64:67], a[160:163], v[100:103]
 s_add_u32 m0, s29, 65536
 ds_read_b64_tr_b16 a[90:91], v8 offset:4096
 v_add_u32 v2, 0x80000, v2
 v_mfma_f32_16x16x32_bf16 v[100:103], a[68:71], a[168:171], v[100:103]
 ds_read_b64_tr_b16 a[92:93], v8 offset:16384
 buffer_load_dwordx4 v2, s[16:19], 0 offen lds
 v_mfma_f32_16x16x32_bf16 v[100:103], a[72:75], a[176:179], v[100:103]
 s_waitcnt lgkmcnt(7)
 ds_read_b64_tr_b16 a[94:95], v8 offset:20480
 v_xor_b32 v9, 32992, v6
 v_mfma_f32_16x16x32_bf16 v[100:103], a[76:79], a[184:187], v[100:103]
 ds_read_b64_tr_b16 a[96:97], v9 offset:0
 v_accvgpr_write_b32 a236, v3
 v_mfma_f32_16x16x32_bf16 v[108:111], a[64:67], a[164:167], v[108:111]
 ds_read_b64_tr_b16 a[98:99], v9 offset:4096
 v_cmp_gt_i32 vcc, 49, v14
 v_mfma_f32_16x16x32_bf16 v[108:111], a[68:71], a[172:175], v[108:111]
 ds_read_b64_tr_b16 a[100:101], v9 offset:16384
 v_cndmask_b32 v3, 0, v15, vcc
 v_mfma_f32_16x16x32_bf16 v[108:111], a[72:75], a[180:183], v[108:111]
 s_add_u32 m0, s29, 69632
 ds_read_b64_tr_b16 a[102:103], v9 offset:20480
 v_xor_b32 v10, 98528, v6
 v_mfma_f32_16x16x32_bf16 v[108:111], a[76:79], a[188:191], v[108:111]
 s_waitcnt lgkmcnt(6)
 ds_read_b64_tr_b16 a[104:105], v10 offset:0
 buffer_load_dwordx4 v2, s[16:19], s48 offen lds
 v_mfma_f32_16x16x32_bf16 v[116:119], a[80:83], a[160:163], v[116:119]
 ds_read_b64_tr_b16 a[106:107], v10 offset:4096
 v_accvgpr_write_b32 a237, v3
 v_mfma_f32_16x16x32_bf16 v[116:119], a[84:87], a[168:171], v[116:119]
 ds_read_b64_tr_b16 a[108:109], v10 offset:16384
 v_cmp_gt_i32 vcc, 50, v14
 v_mfma_f32_16x16x32_bf16 v[116:119], a[88:91], a[176:179], v[116:119]
 s_waitcnt lgkmcnt(7)
 ds_read_b64_tr_b16 a[110:111], v10 offset:20480
 v_xor_b32 v7, 33024, v6
 v_mfma_f32_16x16x32_bf16 v[116:119], a[92:95], a[184:187], v[116:119]
 s_add_u32 m0, s29, 73728
 ds_read_b64_tr_b16 a[64:65], v7 offset:0
 v_cndmask_b32 v3, 0, v15, vcc
 v_mfma_f32_16x16x32_bf16 v[124:127], a[80:83], a[164:167], v[124:127]
 ds_read_b64_tr_b16 a[66:67], v7 offset:4096
 buffer_load_dwordx4 v2, s[16:19], s49 offen lds
 v_mfma_f32_16x16x32_bf16 v[124:127], a[84:87], a[172:175], v[124:127]
 ds_read_b64_tr_b16 a[68:69], v7 offset:16384
 v_accvgpr_write_b32 a238, v3
 v_mfma_f32_16x16x32_bf16 v[124:127], a[88:91], a[180:183], v[124:127]
 ds_read_b64_tr_b16 a[70:71], v7 offset:20480
 v_xor_b32 v8, 98560, v6
 v_mfma_f32_16x16x32_bf16 v[124:127], a[92:95], a[188:191], v[124:127]
 s_waitcnt lgkmcnt(6)
 ds_read_b64_tr_b16 a[72:73], v8 offset:0
 v_cmp_gt_i32 vcc, 51, v14
 v_mfma_f32_16x16x32_bf16 v[132:135], a[96:99], a[160:163], v[132:135]
 s_add_u32 m0, s29, 77824
 ds_read_b64_tr_b16 a[74:75], v8 offset:4096
 v_cndmask_b32 v3, 0, v15, vcc
 v_mfma_f32_16x16x32_bf16 v[132:135], a[100:103], a[168:171], v[132:135]
 ds_read_b64_tr_b16 a[76:77], v8 offset:16384
 buffer_load_dwordx4 v2, s[16:19], s50 offen lds
 v_mfma_f32_16x16x32_bf16 v[132:135], a[104:107], a[176:179], v[132:135]
 s_waitcnt lgkmcnt(7)
 ds_read_b64_tr_b16 a[78:79], v8 offset:20480
 v_xor_b32 v9, 33056, v6
 v_mfma_f32_16x16x32_bf16 v[132:135], a[108:111], a[184:187], v[132:135]
 ds_read_b64_tr_b16 a[80:81], v9 offset:0
 v_accvgpr_write_b32 a239, v3
 v_mfma_f32_16x16x32_bf16 v[140:143], a[96:99], a[164:167], v[140:143]
 ds_read_b64_tr_b16 a[82:83], v9 offset:4096
 v_mfma_f32_16x16x32_bf16 v[140:143], a[100:103], a[172:175], v[140:143]
 ds_read_b64_tr_b16 a[84:85], v9 offset:16384
 v_mfma_f32_16x16x32_bf16 v[140:143], a[104:107], a[180:183], v[140:143]
 s_add_u32 m0, s29, 81920
 ds_read_b64_tr_b16 a[86:87], v9 offset:20480
 v_xor_b32 v10, 98592, v6
 v_mfma_f32_16x16x32_bf16 v[140:143], a[108:111], a[188:191], v[140:143]
 s_waitcnt lgkmcnt(6)
 ds_read_b64_tr_b16 a[88:89], v10 offset:0
 buffer_load_dwordx4 v2, s[16:19], s51 offen lds
 v_mfma_f32_16x16x32_bf16 v[148:151], a[64:67], a[160:163], v[148:151]
 ds_read_b64_tr_b16 a[90:91], v10 offset:4096
 v_mfma_f32_16x16x32_bf16 v[148:151], a[68:71], a[168:171], v[148:151]
 ds_read_b64_tr_b16 a[92:93], v10 offset:16384
 v_mfma_f32_16x16x32_bf16 v[148:151], a[72:75], a[176:179], v[148:151]
 s_waitcnt lgkmcnt(7)
 ds_read_b64_tr_b16 a[94:95], v10 offset:20480
 v_xor_b32 v7, 33088, v6
 v_mfma_f32_16x16x32_bf16 v[148:151], a[76:79], a[184:187], v[148:151]
 s_add_u32 m0, s29, 86016
 ds_read_b64_tr_b16 a[96:97], v7 offset:0
 v_mfma_f32_16x16x32_bf16 v[156:159], a[64:67], a[164:167], v[156:159]
 ds_read_b64_tr_b16 a[98:99], v7 offset:4096
 buffer_load_dwordx4 v2, s[16:19], s52 offen lds
 v_mfma_f32_16x16x32_bf16 v[156:159], a[68:71], a[172:175], v[156:159]
 ds_read_b64_tr_b16 a[100:101], v7 offset:16384
 v_mfma_f32_16x16x32_bf16 v[156:159], a[72:75], a[180:183], v[156:159]
 ds_read_b64_tr_b16 a[102:103], v7 offset:20480
 v_xor_b32 v8, 98624, v6
 v_mfma_f32_16x16x32_bf16 v[156:159], a[76:79], a[188:191], v[156:159]
 s_waitcnt lgkmcnt(6)
 ds_read_b64_tr_b16 a[104:105], v8 offset:0
 v_mfma_f32_16x16x32_bf16 v[164:167], a[80:83], a[160:163], v[164:167]
 s_add_u32 m0, s29, 90112
 ds_read_b64_tr_b16 a[106:107], v8 offset:4096
 v_mfma_f32_16x16x32_bf16 v[164:167], a[84:87], a[168:171], v[164:167]
 ds_read_b64_tr_b16 a[108:109], v8 offset:16384
 buffer_load_dwordx4 v2, s[16:19], s53 offen lds
 v_mfma_f32_16x16x32_bf16 v[164:167], a[88:91], a[176:179], v[164:167]
 s_waitcnt lgkmcnt(7)
 ds_read_b64_tr_b16 a[110:111], v8 offset:20480
 v_xor_b32 v9, 33120, v6
 v_mfma_f32_16x16x32_bf16 v[164:167], a[92:95], a[184:187], v[164:167]
 s_waitcnt vmcnt(8)
 ds_read_b64_tr_b16 a[64:65], v9 offset:0
 v_mfma_f32_16x16x32_bf16 v[172:175], a[80:83], a[164:167], v[172:175]
 s_barrier
 ds_read_b64_tr_b16 a[66:67], v9 offset:4096
 v_mfma_f32_16x16x32_bf16 v[172:175], a[84:87], a[172:175], v[172:175]
 ds_read_b64_tr_b16 a[68:69], v9 offset:16384
 buffer_store_dword v11, v11, s[12:15], s92 offen sc1
 v_mfma_f32_16x16x32_bf16 v[172:175], a[88:91], a[180:183], v[172:175]
 s_add_u32 m0, s29, 94208
 ds_read_b64_tr_b16 a[70:71], v9 offset:20480
 v_xor_b32 v10, 98656, v6
 v_mfma_f32_16x16x32_bf16 v[172:175], a[92:95], a[188:191], v[172:175]
 s_waitcnt lgkmcnt(6)
 ds_read_b64_tr_b16 a[72:73], v10 offset:0
 buffer_load_dwordx4 v2, s[16:19], s54 offen lds
 v_mfma_f32_16x16x32_bf16 v[180:183], a[96:99], a[160:163], v[180:183]
 ds_read_b64_tr_b16 a[74:75], v10 offset:4096
 v_mfma_f32_16x16x32_bf16 v[180:183], a[100:103], a[168:171], v[180:183]
 ds_read_b64_tr_b16 a[76:77], v10 offset:16384
 v_mfma_f32_16x16x32_bf16 v[180:183], a[104:107], a[176:179], v[180:183]
 s_waitcnt lgkmcnt(7)
 ds_read_b64_tr_b16 a[78:79], v10 offset:20480
 v_xor_b32 v7, 33152, v6
 v_mfma_f32_16x16x32_bf16 v[180:183], a[108:111], a[184:187], v[180:183]
 ds_read_b64_tr_b16 a[80:81], v7 offset:0
 v_mfma_f32_16x16x32_bf16 v[188:191], a[96:99], a[164:167], v[188:191]
 ds_read_b64_tr_b16 a[82:83], v7 offset:4096
 v_mfma_f32_16x16x32_bf16 v[188:191], a[100:103], a[172:175], v[188:191]
 ds_read_b64_tr_b16 a[84:85], v7 offset:16384
 v_mfma_f32_16x16x32_bf16 v[188:191], a[104:107], a[180:183], v[188:191]
 ds_read_b64_tr_b16 a[86:87], v7 offset:20480
 v_xor_b32 v8, 98688, v6
 v_mfma_f32_16x16x32_bf16 v[188:191], a[108:111], a[188:191], v[188:191]
 s_waitcnt lgkmcnt(6)
 ds_read_b64_tr_b16 a[88:89], v8 offset:0
 v_mfma_f32_16x16x32_bf16 v[196:199], a[64:67], a[160:163], v[196:199]
 s_and_b32 s58, s92, ~127
 ds_read_b64_tr_b16 a[90:91], v8 offset:4096
 v_mfma_f32_16x16x32_bf16 v[196:199], a[68:71], a[168:171], v[196:199]
 s_lshl_b32 s37, s25, 1
 ds_read_b64_tr_b16 a[92:93], v8 offset:16384
 v_mfma_f32_16x16x32_bf16 v[196:199], a[72:75], a[176:179], v[196:199]
 s_waitcnt lgkmcnt(7)
 ds_read_b64_tr_b16 a[94:95], v8 offset:20480
 v_xor_b32 v9, 33184, v6
 v_mfma_f32_16x16x32_bf16 v[196:199], a[76:79], a[184:187], v[196:199]
 s_sub_i32 s38, 12, s37
 ds_read_b64_tr_b16 a[96:97], v9 offset:0
 v_mfma_f32_16x16x32_bf16 v[204:207], a[64:67], a[164:167], v[204:207]
 s_max_i32 s38, s38, 0
 ds_read_b64_tr_b16 a[98:99], v9 offset:4096
 v_mfma_f32_16x16x32_bf16 v[204:207], a[68:71], a[172:175], v[204:207]
 s_mul_i32 s49, s26, 1048576
 ds_read_b64_tr_b16 a[100:101], v9 offset:16384
 v_mfma_f32_16x16x32_bf16 v[204:207], a[72:75], a[180:183], v[204:207]
 s_lshl_b32 s50, s3, 13
 ds_read_b64_tr_b16 a[102:103], v9 offset:20480
 v_xor_b32 v10, 98720, v6
 v_mfma_f32_16x16x32_bf16 v[204:207], a[76:79], a[188:191], v[204:207]
 s_waitcnt lgkmcnt(6)
 ds_read_b64_tr_b16 a[104:105], v10 offset:0
 v_mfma_f32_16x16x32_bf16 v[212:215], a[80:83], a[160:163], v[212:215]
 s_add_u32 s49, s49, s50
 ds_read_b64_tr_b16 a[106:107], v10 offset:4096
 v_mfma_f32_16x16x32_bf16 v[212:215], a[84:87], a[168:171], v[212:215]
 s_mov_b32 s54, 0
 ds_read_b64_tr_b16 a[108:109], v10 offset:16384
 v_mfma_f32_16x16x32_bf16 v[212:215], a[88:91], a[176:179], v[212:215]
 s_waitcnt lgkmcnt(7)
 ds_read_b64_tr_b16 a[110:111], v10 offset:20480
 v_xor_b32 v7, 33216, v6
 v_mfma_f32_16x16x32_bf16 v[212:215], a[92:95], a[184:187], v[212:215]
 s_add_u32 s44, s37, 1
 ds_read_b64_tr_b16 a[64:65], v7 offset:0
 v_mfma_f32_16x16x32_bf16 v[220:223], a[80:83], a[164:167], v[220:223]
 s_mov_b32 s42, s49
 ds_read_b64_tr_b16 a[66:67], v7 offset:4096
 v_mfma_f32_16x16x32_bf16 v[220:223], a[84:87], a[172:175], v[220:223]
 s_add_u32 s60, s94, 4
 ds_read_b64_tr_b16 a[68:69], v7 offset:16384
 v_mfma_f32_16x16x32_bf16 v[220:223], a[88:91], a[180:183], v[220:223]
 s_mov_b32 s45, 2
 ds_read_b64_tr_b16 a[70:71], v7 offset:20480
 v_xor_b32 v8, 98752, v6
 v_mfma_f32_16x16x32_bf16 v[220:223], a[92:95], a[188:191], v[220:223]
 s_waitcnt lgkmcnt(6)
 ds_read_b64_tr_b16 a[72:73], v8 offset:0
 buffer_load_dwordx4 v[32:35], v122, s[4:7], 0 offen
 v_mfma_f32_16x16x32_bf16 v[228:231], a[96:99], a[160:163], v[228:231]
 s_mov_b32 s66, 1
 ds_read_b64_tr_b16 a[74:75], v8 offset:4096
 v_mfma_f32_16x16x32_bf16 v[228:231], a[100:103], a[168:171], v[228:231]
 s_mov_b32 s68, 1
 ds_read_b64_tr_b16 a[76:77], v8 offset:16384
 v_mfma_f32_16x16x32_bf16 v[228:231], a[104:107], a[176:179], v[228:231]
 s_waitcnt lgkmcnt(7)
 ds_read_b64_tr_b16 a[78:79], v8 offset:20480
 v_xor_b32 v9, 33248, v6
 v_mfma_f32_16x16x32_bf16 v[228:231], a[108:111], a[184:187], v[228:231]
 ds_read_b64_tr_b16 a[80:81], v9 offset:0
 buffer_load_dwordx4 v[40:43], v123, s[4:7], 0 offen
 v_mfma_f32_16x16x32_bf16 v[236:239], a[96:99], a[164:167], v[236:239]
 s_mov_b32 s70, 32768
 ds_read_b64_tr_b16 a[82:83], v9 offset:4096
 v_mfma_f32_16x16x32_bf16 v[236:239], a[100:103], a[172:175], v[236:239]
 s_mov_b32 s71, s70
 ds_read_b64_tr_b16 a[84:85], v9 offset:16384
 v_mfma_f32_16x16x32_bf16 v[236:239], a[104:107], a[180:183], v[236:239]
 s_add_u32 s43, s42, 16777216
 ds_read_b64_tr_b16 a[86:87], v9 offset:20480
 v_xor_b32 v10, 98784, v6
 v_mfma_f32_16x16x32_bf16 v[236:239], a[108:111], a[188:191], v[236:239]
 s_waitcnt lgkmcnt(6)
 ds_read_b64_tr_b16 a[88:89], v10 offset:0
 buffer_load_dwordx4 v[48:51], v128, s[4:7], 0 offen
 v_mfma_f32_16x16x32_bf16 v[244:247], a[64:67], a[160:163], v[244:247]
 s_mov_b32 s40, s50
 ds_read_b64_tr_b16 a[90:91], v10 offset:4096
 v_mfma_f32_16x16x32_bf16 v[244:247], a[68:71], a[168:171], v[244:247]
 s_waitcnt vmcnt(3)
 ds_read_b64_tr_b16 a[92:93], v10 offset:16384
 v_xor_b32 v7, 131072, v6
 v_mfma_f32_16x16x32_bf16 v[244:247], a[72:75], a[176:179], v[244:247]
 s_waitcnt lgkmcnt(7)
 s_barrier
 ds_read_b64_tr_b16 a[94:95], v10 offset:20480
 v_mfma_f32_16x16x32_bf16 v[244:247], a[76:79], a[184:187], v[244:247]
 ds_read_b64_tr_b16 a[96:97], v7 offset:0
 buffer_load_dwordx4 v[56:59], v120, s[4:7], 0 offen offset:0
 v_mfma_f32_16x16x32_bf16 v[252:255], a[64:67], a[164:167], v[252:255]
 s_add_u32 s41, s50, 0x10000
 ds_read_b64_tr_b16 a[98:99], v7 offset:4096
 v_mfma_f32_16x16x32_bf16 v[252:255], a[68:71], a[172:175], v[252:255]
 s_lshr_b32 s61, s95, 4
 ds_read_b64_tr_b16 a[100:101], v7 offset:16384
 v_mfma_f32_16x16x32_bf16 v[252:255], a[72:75], a[180:183], v[252:255]
 s_lshl_b32 s61, s61, 7
 ds_read_b64_tr_b16 a[102:103], v7 offset:20480
 v_xor_b32 v8, 0, v6
 v_mfma_f32_16x16x32_bf16 v[252:255], a[76:79], a[188:191], v[252:255]
 s_waitcnt lgkmcnt(6)
 ds_read_b64_tr_b16 a[104:105], v8 offset:0
 buffer_load_dwordx4 v[64:67], v120, s[4:7], 0 offen offset:896
 v_mfma_f32_16x16x32_bf16 v[16:19], a[80:83], a[160:163], v[16:19]
 s_add_u32 s61, s61, 84959232
 ds_read_b64_tr_b16 a[106:107], v8 offset:4096
 v_mfma_f32_16x16x32_bf16 v[16:19], a[84:87], a[168:171], v[16:19]
 s_mov_b32 s47, 0x4b800000
 ds_read_b64_tr_b16 a[108:109], v8 offset:16384
 v_mfma_f32_16x16x32_bf16 v[16:19], a[88:91], a[176:179], v[16:19]
 s_waitcnt lgkmcnt(7)
 ds_read_b64_tr_b16 a[110:111], v8 offset:20480
 v_xor_b32 v9, 65536, v6
 v_mfma_f32_16x16x32_bf16 v[16:19], a[92:95], a[184:187], v[16:19]
 ds_read_b64_tr_b16 a[64:65], v9 offset:0
 buffer_load_dwordx4 v[72:75], v120, s[8:11], 0 offen offset:0
 v_mfma_f32_16x16x32_bf16 v[24:27], a[80:83], a[164:167], v[24:27]
 s_lshl_b32 s30, s95, 1
 ds_read_b64_tr_b16 a[66:67], v9 offset:4096
 v_mfma_f32_16x16x32_bf16 v[24:27], a[84:87], a[172:175], v[24:27]
 s_lshr_b32 s31, s3, 1
 ds_read_b64_tr_b16 a[68:69], v9 offset:16384
 v_mfma_f32_16x16x32_bf16 v[24:27], a[88:91], a[180:183], v[24:27]
 s_add_u32 s30, s30, s31
 ds_read_b64_tr_b16 a[70:71], v9 offset:20480
 v_xor_b32 v10, 131104, v6
 v_mfma_f32_16x16x32_bf16 v[24:27], a[92:95], a[188:191], v[24:27]
 s_waitcnt lgkmcnt(6)
 ds_read_b64_tr_b16 a[72:73], v10 offset:0
 buffer_load_dwordx4 v[80:83], v120, s[8:11], 0 offen offset:896
 v_mfma_f32_16x16x32_bf16 v[28:31], a[96:99], a[192:195], v[28:31]
 s_min_u32 s30, s30, 223
 ds_read_b64_tr_b16 a[74:75], v10 offset:4096
 v_mfma_f32_16x16x32_bf16 v[28:31], a[100:103], a[200:203], v[28:31]
 s_lshl_b32 s30, s30, 2
 ds_read_b64_tr_b16 a[76:77], v10 offset:16384
 v_mfma_f32_16x16x32_bf16 v[28:31], a[104:107], a[208:211], v[28:31]
 s_waitcnt lgkmcnt(3)
 ds_read_b64_tr_b16 a[78:79], v10 offset:20480
 v_xor_b32 v7, 32, v6
 v_mfma_f32_16x16x32_bf16 v[28:31], a[108:111], a[216:219], v[28:31]
 ds_read_b64_tr_b16 a[80:81], v7 offset:0
 buffer_load_dwordx4 v[88:91], v121, s[20:23], s39 offen offset:0
 v_mfma_f32_16x16x32_bf16 v[28:31], a[64:67], a[112:115], v[28:31]
 ds_read_b64_tr_b16 a[82:83], v7 offset:4096
 v_mfma_f32_16x16x32_bf16 v[28:31], a[68:71], a[120:123], v[28:31]
 ds_read_b64_tr_b16 a[84:85], v7 offset:16384
 v_mfma_f32_16x16x32_bf16 v[44:47], a[96:99], a[196:199], v[44:47]
 ds_read_b64_tr_b16 a[86:87], v7 offset:20480
 v_xor_b32 v8, 65568, v6
 v_mfma_f32_16x16x32_bf16 v[44:47], a[100:103], a[204:207], v[44:47]
 ds_read_b64_tr_b16 a[88:89], v8 offset:0
 buffer_load_dwordx4 v[96:99], v121, s[20:23], s39 offen offset:16
 v_mfma_f32_16x16x32_bf16 v[44:47], a[104:107], a[212:215], v[44:47]
 ds_read_b64_tr_b16 a[90:91], v8 offset:4096
 v_mfma_f32_16x16x32_bf16 v[44:47], a[108:111], a[220:223], v[44:47]
 ds_read_b64_tr_b16 a[92:93], v8 offset:16384
 v_mfma_f32_16x16x32_bf16 v[44:47], a[64:67], a[116:119], v[44:47]
 ds_read_b64_tr_b16 a[94:95], v8 offset:20480
 v_xor_b32 v9, 131136, v6
 v_mfma_f32_16x16x32_bf16 v[44:47], a[68:71], a[124:127], v[44:47]
 s_waitcnt lgkmcnt(6)
 ds_read_b64_tr_b16 a[96:97], v9 offset:0
 buffer_load_dwordx4 v[104:107], v121, s[20:23], s39 offen offset:32
 v_mfma_f32_16x16x32_bf16 v[52:55], a[72:75], a[192:195], v[52:55]
 ds_read_b64_tr_b16 a[98:99], v9 offset:4096
 v_mfma_f32_16x16x32_bf16 v[52:55], a[76:79], a[200:203], v[52:55]
 ds_read_b64_tr_b16 a[100:101], v9 offset:16384
 v_mfma_f32_16x16x32_bf16 v[52:55], a[80:83], a[208:211], v[52:55]
 s_waitcnt lgkmcnt(3)
 ds_read_b64_tr_b16 a[102:103], v9 offset:20480
 v_xor_b32 v10, 64, v6
 v_mfma_f32_16x16x32_bf16 v[52:55], a[84:87], a[216:219], v[52:55]
 ds_read_b64_tr_b16 a[104:105], v10 offset:0
 buffer_load_dwordx4 v[112:115], v121, s[20:23], s39 offen offset:48
 v_mfma_f32_16x16x32_bf16 v[52:55], a[88:91], a[112:115], v[52:55]
 ds_read_b64_tr_b16 a[106:107], v10 offset:4096
 v_mfma_f32_16x16x32_bf16 v[52:55], a[92:95], a[120:123], v[52:55]
 ds_read_b64_tr_b16 a[108:109], v10 offset:16384
 v_mfma_f32_16x16x32_bf16 v[60:63], a[72:75], a[196:199], v[60:63]
 ds_read_b64_tr_b16 a[110:111], v10 offset:20480
 v_xor_b32 v7, 65600, v6
 v_mfma_f32_16x16x32_bf16 v[60:63], a[76:79], a[204:207], v[60:63]
 ds_read_b64_tr_b16 a[64:65], v7 offset:0
 v_mfma_f32_16x16x32_bf16 v[60:63], a[80:83], a[212:215], v[60:63]
 s_and_b32 s4, s2, 127
 ds_read_b64_tr_b16 a[66:67], v7 offset:4096
 v_mfma_f32_16x16x32_bf16 v[60:63], a[84:87], a[220:223], v[60:63]
 s_lshl_b32 s4, s4, 2
 ds_read_b64_tr_b16 a[68:69], v7 offset:16384
 v_mfma_f32_16x16x32_bf16 v[60:63], a[88:91], a[116:119], v[60:63]
 s_add_u32 s4, s4, s3
 ds_read_b64_tr_b16 a[70:71], v7 offset:20480
 v_xor_b32 v8, 131168, v6
 v_mfma_f32_16x16x32_bf16 v[60:63], a[92:95], a[124:127], v[60:63]
 s_waitcnt lgkmcnt(6)
 ds_read_b64_tr_b16 a[72:73], v8 offset:0
 v_mfma_f32_16x16x32_bf16 v[20:23], a[96:99], a[192:195], v[20:23]
 s_mul_i32 s5, s4, 17408
 ds_read_b64_tr_b16 a[74:75], v8 offset:4096
 v_mfma_f32_16x16x32_bf16 v[20:23], a[100:103], a[200:203], v[20:23]
 s_add_u32 s5, s5, 50331648
 ds_read_b64_tr_b16 a[76:77], v8 offset:16384
 v_mul_f32 v28, s34, v28
 v_mfma_f32_16x16x32_bf16 v[20:23], a[104:107], a[208:211], v[20:23]
 s_waitcnt lgkmcnt(3)
 ds_read_b64_tr_b16 a[78:79], v8 offset:20480
 v_xor_b32 v9, 96, v6
 v_mfma_f32_16x16x32_bf16 v[20:23], a[108:111], a[216:219], v[20:23]
 s_add_u32 s4, s5, 0x2000
 ds_read_b64_tr_b16 a[80:81], v9 offset:0
 v_mul_f32 v29, s34, v29
 v_mfma_f32_16x16x32_bf16 v[20:23], a[64:67], a[112:115], v[20:23]
 s_mov_b32 s6, 2.0
 ds_read_b64_tr_b16 a[82:83], v9 offset:4096
 v_mul_f32 v30, s34, v30
 v_mfma_f32_16x16x32_bf16 v[20:23], a[68:71], a[120:123], v[20:23]
 s_min_u32 s7, s38, 1
 ds_read_b64_tr_b16 a[84:85], v9 offset:16384
 v_mul_f32 v31, s34, v31
 v_mfma_f32_16x16x32_bf16 v[36:39], a[96:99], a[196:199], v[36:39]
 s_cmp_eq_u32 s44, 1
 s_cselect_b32 s53, 1, 0
 ds_read_b64_tr_b16 a[86:87], v9 offset:20480
 v_xor_b32 v10, 65632, v6
 v_mfma_f32_16x16x32_bf16 v[36:39], a[100:103], a[204:207], v[36:39]
 s_cmp_eq_u32 s38, 0
 s_cmov_b32 s4, 2.0
 ds_read_b64_tr_b16 a[88:89], v10 offset:0
 v_mfma_f32_16x16x32_bf16 v[36:39], a[104:107], a[212:215], v[36:39]
 s_cmp_eq_u32 s38, 0
 s_cmov_b32 s5, 2.0
 ds_read_b64_tr_b16 a[90:91], v10 offset:4096
 v_mfma_f32_16x16x32_bf16 v[36:39], a[108:111], a[220:223], v[36:39]
 s_cmp_eq_u32 s38, 0
 s_cmov_b32 s60, s58
 ds_read_b64_tr_b16 a[92:93], v10 offset:16384
 v_mfma_f32_16x16x32_bf16 v[36:39], a[64:67], a[116:119], v[36:39]
 s_mov_b64 s[8:9], s[12:13]
 ds_read_b64_tr_b16 a[94:95], v10 offset:20480
 v_xor_b32 v7, 131200, v6
 v_mfma_f32_16x16x32_bf16 v[36:39], a[68:71], a[124:127], v[36:39]
 s_waitcnt lgkmcnt(6)
 ds_read_b64_tr_b16 a[96:97], v7 offset:0
 v_mul_f32 v52, s34, v52
 v_mfma_f32_16x16x32_bf16 v[68:71], a[72:75], a[192:195], v[68:71]
 s_mov_b32 s10, s14
 ds_read_b64_tr_b16 a[98:99], v7 offset:4096
 v_mul_f32 v53, s34, v53
 v_mfma_f32_16x16x32_bf16 v[68:71], a[76:79], a[200:203], v[68:71]
 s_mov_b32 s76, 0
 ds_read_b64_tr_b16 a[100:101], v7 offset:16384
 v_mul_f32 v54, s34, v54
 v_mfma_f32_16x16x32_bf16 v[68:71], a[80:83], a[208:211], v[68:71]
 s_waitcnt lgkmcnt(3)
 ds_read_b64_tr_b16 a[102:103], v7 offset:20480
 v_xor_b32 v8, 128, v6
 v_mfma_f32_16x16x32_bf16 v[68:71], a[84:87], a[216:219], v[68:71]
 s_movk_i32 s77, 0x1000
 ds_read_b64_tr_b16 a[104:105], v8 offset:0
 v_mul_f32 v55, s34, v55
 v_mfma_f32_16x16x32_bf16 v[68:71], a[88:91], a[112:115], v[68:71]
 s_mov_b32 s51, 0
 ds_read_b64_tr_b16 a[106:107], v8 offset:4096
 v_cvt_pk_bf16_f32 v28, v28, v29
 v_mfma_f32_16x16x32_bf16 v[68:71], a[92:95], a[120:123], v[68:71]
 s_mul_i32 s78, s26, 229376
 ds_read_b64_tr_b16 a[108:109], v8 offset:16384
 v_cvt_pk_bf16_f32 v29, v30, v31
 v_mfma_f32_16x16x32_bf16 v[76:79], a[72:75], a[196:199], v[76:79]
 s_add_u32 s79, s78, 28672
 ds_read_b64_tr_b16 a[110:111], v8 offset:20480
 v_xor_b32 v9, 65664, v6
 v_mfma_f32_16x16x32_bf16 v[76:79], a[76:79], a[204:207], v[76:79]
 s_add_u32 s80, s78, 57344
 ds_read_b64_tr_b16 a[64:65], v9 offset:0
 v_cvt_pk_bf16_f32 v30, v52, v53
 v_mfma_f32_16x16x32_bf16 v[76:79], a[80:83], a[212:215], v[76:79]
 s_add_u32 s81, s78, 86016
 ds_read_b64_tr_b16 a[66:67], v9 offset:4096
 v_cvt_pk_bf16_f32 v31, v54, v55
 v_mfma_f32_16x16x32_bf16 v[76:79], a[84:87], a[220:223], v[76:79]
 s_add_u32 s82, s78, 114688
 ds_read_b64_tr_b16 a[68:69], v9 offset:16384
 v_accvgpr_write_b32 a0, v28
 v_mfma_f32_16x16x32_bf16 v[76:79], a[88:91], a[116:119], v[76:79]
 s_add_u32 s83, s78, 143360
 ds_read_b64_tr_b16 a[70:71], v9 offset:20480
 v_xor_b32 v10, 131232, v6
 v_mfma_f32_16x16x32_bf16 v[76:79], a[92:95], a[124:127], v[76:79]
 s_waitcnt lgkmcnt(6)
 ds_read_b64_tr_b16 a[72:73], v10 offset:0
 v_accvgpr_write_b32 a1, v29
 v_mfma_f32_16x16x32_bf16 v[84:87], a[96:99], a[192:195], v[84:87]
 s_add_u32 s84, s78, 172032
 ds_read_b64_tr_b16 a[74:75], v10 offset:4096
 v_accvgpr_write_b32 a2, v30
 v_mfma_f32_16x16x32_bf16 v[84:87], a[100:103], a[200:203], v[84:87]
 s_add_u32 s85, s78, 200704
 ds_read_b64_tr_b16 a[76:77], v10 offset:16384
 v_accvgpr_write_b32 a3, v31
 v_mfma_f32_16x16x32_bf16 v[84:87], a[104:107], a[208:211], v[84:87]
 s_waitcnt lgkmcnt(3)
 ds_read_b64_tr_b16 a[78:79], v10 offset:20480
 v_xor_b32 v7, 160, v6
 v_mfma_f32_16x16x32_bf16 v[84:87], a[108:111], a[216:219], v[84:87]
 ds_read_b64_tr_b16 a[80:81], v7 offset:0
 v_mul_f32 v44, s34, v44
 v_mfma_f32_16x16x32_bf16 v[84:87], a[64:67], a[112:115], v[84:87]
 ds_read_b64_tr_b16 a[82:83], v7 offset:4096
 v_mul_f32 v45, s34, v45
 v_mfma_f32_16x16x32_bf16 v[84:87], a[68:71], a[120:123], v[84:87]
 ds_read_b64_tr_b16 a[84:85], v7 offset:16384
 v_mul_f32 v46, s34, v46
 v_mfma_f32_16x16x32_bf16 v[92:95], a[96:99], a[196:199], v[92:95]
 ds_read_b64_tr_b16 a[86:87], v7 offset:20480
 v_xor_b32 v8, 65696, v6
 v_mfma_f32_16x16x32_bf16 v[92:95], a[100:103], a[204:207], v[92:95]
 ds_read_b64_tr_b16 a[88:89], v8 offset:0
 v_mul_f32 v47, s34, v47
 v_mfma_f32_16x16x32_bf16 v[92:95], a[104:107], a[212:215], v[92:95]
 ds_read_b64_tr_b16 a[90:91], v8 offset:4096
 v_mul_f32 v60, s34, v60
 v_mfma_f32_16x16x32_bf16 v[92:95], a[108:111], a[220:223], v[92:95]
 ds_read_b64_tr_b16 a[92:93], v8 offset:16384
 v_mul_f32 v61, s34, v61
 v_mfma_f32_16x16x32_bf16 v[92:95], a[64:67], a[116:119], v[92:95]
 ds_read_b64_tr_b16 a[94:95], v8 offset:20480
 v_xor_b32 v9, 131264, v6
 v_mfma_f32_16x16x32_bf16 v[92:95], a[68:71], a[124:127], v[92:95]
 s_waitcnt lgkmcnt(6)
 ds_read_b64_tr_b16 a[96:97], v9 offset:0
 v_mul_f32 v62, s34, v62
 v_mfma_f32_16x16x32_bf16 v[100:103], a[72:75], a[192:195], v[100:103]
 ds_read_b64_tr_b16 a[98:99], v9 offset:4096
 v_mul_f32 v63, s34, v63
 v_mfma_f32_16x16x32_bf16 v[100:103], a[76:79], a[200:203], v[100:103]
 ds_read_b64_tr_b16 a[100:101], v9 offset:16384
 v_cvt_pk_bf16_f32 v44, v44, v45
 v_mfma_f32_16x16x32_bf16 v[100:103], a[80:83], a[208:211], v[100:103]
 s_waitcnt lgkmcnt(3)
 ds_read_b64_tr_b16 a[102:103], v9 offset:20480
 v_xor_b32 v10, 192, v6
 v_mfma_f32_16x16x32_bf16 v[100:103], a[84:87], a[216:219], v[100:103]
 ds_read_b64_tr_b16 a[104:105], v10 offset:0
 v_cvt_pk_bf16_f32 v45, v46, v47
 v_mfma_f32_16x16x32_bf16 v[100:103], a[88:91], a[112:115], v[100:103]
 ds_read_b64_tr_b16 a[106:107], v10 offset:4096
 v_cvt_pk_bf16_f32 v46, v60, v61
 v_mfma_f32_16x16x32_bf16 v[100:103], a[92:95], a[120:123], v[100:103]
 ds_read_b64_tr_b16 a[108:109], v10 offset:16384
 v_cvt_pk_bf16_f32 v47, v62, v63
 v_mfma_f32_16x16x32_bf16 v[108:111], a[72:75], a[196:199], v[108:111]
 ds_read_b64_tr_b16 a[110:111], v10 offset:20480
 v_xor_b32 v7, 65728, v6
 v_mfma_f32_16x16x32_bf16 v[108:111], a[76:79], a[204:207], v[108:111]
 ds_read_b64_tr_b16 a[64:65], v7 offset:0
 v_accvgpr_write_b32 a32, v44
 v_mfma_f32_16x16x32_bf16 v[108:111], a[80:83], a[212:215], v[108:111]
 ds_read_b64_tr_b16 a[66:67], v7 offset:4096
 v_accvgpr_write_b32 a33, v45
 v_mfma_f32_16x16x32_bf16 v[108:111], a[84:87], a[220:223], v[108:111]
 ds_read_b64_tr_b16 a[68:69], v7 offset:16384
 v_accvgpr_write_b32 a34, v46
 v_mfma_f32_16x16x32_bf16 v[108:111], a[88:91], a[116:119], v[108:111]
 ds_read_b64_tr_b16 a[70:71], v7 offset:20480
 v_xor_b32 v8, 131296, v6
 v_mfma_f32_16x16x32_bf16 v[108:111], a[92:95], a[124:127], v[108:111]
 s_waitcnt lgkmcnt(6)
 ds_read_b64_tr_b16 a[72:73], v8 offset:0
 v_accvgpr_write_b32 a35, v47
 v_mfma_f32_16x16x32_bf16 v[116:119], a[96:99], a[192:195], v[116:119]
 ds_read_b64_tr_b16 a[74:75], v8 offset:4096
 v_mul_f32 v20, s34, v20
 v_mfma_f32_16x16x32_bf16 v[116:119], a[100:103], a[200:203], v[116:119]
 ds_read_b64_tr_b16 a[76:77], v8 offset:16384
 v_mul_f32 v21, s34, v21
 v_mfma_f32_16x16x32_bf16 v[116:119], a[104:107], a[208:211], v[116:119]
 s_waitcnt lgkmcnt(3)
 ds_read_b64_tr_b16 a[78:79], v8 offset:20480
 v_xor_b32 v9, 224, v6
 v_mfma_f32_16x16x32_bf16 v[116:119], a[108:111], a[216:219], v[116:119]
 ds_read_b64_tr_b16 a[80:81], v9 offset:0
 v_mul_f32 v22, s34, v22
 v_mfma_f32_16x16x32_bf16 v[116:119], a[64:67], a[112:115], v[116:119]
 ds_read_b64_tr_b16 a[82:83], v9 offset:4096
 v_mul_f32 v23, s34, v23
 v_mfma_f32_16x16x32_bf16 v[116:119], a[68:71], a[120:123], v[116:119]
 ds_read_b64_tr_b16 a[84:85], v9 offset:16384
 v_mul_f32 v68, s34, v68
 v_mfma_f32_16x16x32_bf16 v[124:127], a[96:99], a[196:199], v[124:127]
 ds_read_b64_tr_b16 a[86:87], v9 offset:20480
 v_xor_b32 v10, 65760, v6
 v_mfma_f32_16x16x32_bf16 v[124:127], a[100:103], a[204:207], v[124:127]
 ds_read_b64_tr_b16 a[88:89], v10 offset:0
 v_mul_f32 v69, s34, v69
 v_mfma_f32_16x16x32_bf16 v[124:127], a[104:107], a[212:215], v[124:127]
 ds_read_b64_tr_b16 a[90:91], v10 offset:4096
 v_mul_f32 v70, s34, v70
 v_mfma_f32_16x16x32_bf16 v[124:127], a[108:111], a[220:223], v[124:127]
 ds_read_b64_tr_b16 a[92:93], v10 offset:16384
 v_mul_f32 v71, s34, v71
 v_mfma_f32_16x16x32_bf16 v[124:127], a[64:67], a[116:119], v[124:127]
 ds_read_b64_tr_b16 a[94:95], v10 offset:20480
 v_xor_b32 v7, 131328, v6
 v_mfma_f32_16x16x32_bf16 v[124:127], a[68:71], a[124:127], v[124:127]
 s_waitcnt lgkmcnt(6)
 ds_read_b64_tr_b16 a[96:97], v7 offset:0
 v_cvt_pk_bf16_f32 v20, v20, v21
 v_mfma_f32_16x16x32_bf16 v[132:135], a[72:75], a[192:195], v[132:135]
 ds_read_b64_tr_b16 a[98:99], v7 offset:4096
 v_cvt_pk_bf16_f32 v21, v22, v23
 v_mfma_f32_16x16x32_bf16 v[132:135], a[76:79], a[200:203], v[132:135]
 ds_read_b64_tr_b16 a[100:101], v7 offset:16384
 v_cvt_pk_bf16_f32 v22, v68, v69
 v_mfma_f32_16x16x32_bf16 v[132:135], a[80:83], a[208:211], v[132:135]
 s_waitcnt lgkmcnt(3)
 ds_read_b64_tr_b16 a[102:103], v7 offset:20480
 v_xor_b32 v8, 256, v6
 v_mfma_f32_16x16x32_bf16 v[132:135], a[84:87], a[216:219], v[132:135]
 ds_read_b64_tr_b16 a[104:105], v8 offset:0
 v_cvt_pk_bf16_f32 v23, v70, v71
 v_mfma_f32_16x16x32_bf16 v[132:135], a[88:91], a[112:115], v[132:135]
 ds_read_b64_tr_b16 a[106:107], v8 offset:4096
 v_accvgpr_write_b32 a4, v20
 v_mfma_f32_16x16x32_bf16 v[132:135], a[92:95], a[120:123], v[132:135]
 ds_read_b64_tr_b16 a[108:109], v8 offset:16384
 v_accvgpr_write_b32 a5, v21
 v_mfma_f32_16x16x32_bf16 v[140:143], a[72:75], a[196:199], v[140:143]
 ds_read_b64_tr_b16 a[110:111], v8 offset:20480
 v_xor_b32 v9, 65792, v6
 v_mfma_f32_16x16x32_bf16 v[140:143], a[76:79], a[204:207], v[140:143]
 ds_read_b64_tr_b16 a[64:65], v9 offset:0
 v_accvgpr_write_b32 a6, v22
 v_mfma_f32_16x16x32_bf16 v[140:143], a[80:83], a[212:215], v[140:143]
 ds_read_b64_tr_b16 a[66:67], v9 offset:4096
 v_accvgpr_write_b32 a7, v23
 v_mfma_f32_16x16x32_bf16 v[140:143], a[84:87], a[220:223], v[140:143]
 ds_read_b64_tr_b16 a[68:69], v9 offset:16384
 v_mul_f32 v36, s34, v36
 v_mfma_f32_16x16x32_bf16 v[140:143], a[88:91], a[116:119], v[140:143]
 ds_read_b64_tr_b16 a[70:71], v9 offset:20480
 v_xor_b32 v10, 131360, v6
 v_mfma_f32_16x16x32_bf16 v[140:143], a[92:95], a[124:127], v[140:143]
 s_waitcnt lgkmcnt(6)
 ds_read_b64_tr_b16 a[72:73], v10 offset:0
 v_mul_f32 v37, s34, v37
 v_mfma_f32_16x16x32_bf16 v[148:151], a[96:99], a[192:195], v[148:151]
 ds_read_b64_tr_b16 a[74:75], v10 offset:4096
 v_mul_f32 v38, s34, v38
 v_mfma_f32_16x16x32_bf16 v[148:151], a[100:103], a[200:203], v[148:151]
 ds_read_b64_tr_b16 a[76:77], v10 offset:16384
 v_mul_f32 v39, s34, v39
 v_mfma_f32_16x16x32_bf16 v[148:151], a[104:107], a[208:211], v[148:151]
 s_waitcnt lgkmcnt(3)
 ds_read_b64_tr_b16 a[78:79], v10 offset:20480
 v_xor_b32 v7, 288, v6
 v_mfma_f32_16x16x32_bf16 v[148:151], a[108:111], a[216:219], v[148:151]
 ds_read_b64_tr_b16 a[80:81], v7 offset:0
 v_mul_f32 v76, s34, v76
 v_mfma_f32_16x16x32_bf16 v[148:151], a[64:67], a[112:115], v[148:151]
 ds_read_b64_tr_b16 a[82:83], v7 offset:4096
 v_mul_f32 v77, s34, v77
 v_mfma_f32_16x16x32_bf16 v[148:151], a[68:71], a[120:123], v[148:151]
 ds_read_b64_tr_b16 a[84:85], v7 offset:16384
 v_mul_f32 v78, s34, v78
 v_mfma_f32_16x16x32_bf16 v[156:159], a[96:99], a[196:199], v[156:159]
 ds_read_b64_tr_b16 a[86:87], v7 offset:20480
 v_xor_b32 v8, 65824, v6
 v_mfma_f32_16x16x32_bf16 v[156:159], a[100:103], a[204:207], v[156:159]
 ds_read_b64_tr_b16 a[88:89], v8 offset:0
 v_mul_f32 v79, s34, v79
 v_mfma_f32_16x16x32_bf16 v[156:159], a[104:107], a[212:215], v[156:159]
 ds_read_b64_tr_b16 a[90:91], v8 offset:4096
 v_cvt_pk_bf16_f32 v36, v36, v37
 v_mfma_f32_16x16x32_bf16 v[156:159], a[108:111], a[220:223], v[156:159]
 ds_read_b64_tr_b16 a[92:93], v8 offset:16384
 v_cvt_pk_bf16_f32 v37, v38, v39
 v_mfma_f32_16x16x32_bf16 v[156:159], a[64:67], a[116:119], v[156:159]
 ds_read_b64_tr_b16 a[94:95], v8 offset:20480
 v_xor_b32 v9, 131392, v6
 v_mfma_f32_16x16x32_bf16 v[156:159], a[68:71], a[124:127], v[156:159]
 s_waitcnt lgkmcnt(6)
 ds_read_b64_tr_b16 a[96:97], v9 offset:0
 v_cvt_pk_bf16_f32 v38, v76, v77
 v_mfma_f32_16x16x32_bf16 v[164:167], a[72:75], a[192:195], v[164:167]
 ds_read_b64_tr_b16 a[98:99], v9 offset:4096
 v_cvt_pk_bf16_f32 v39, v78, v79
 v_mfma_f32_16x16x32_bf16 v[164:167], a[76:79], a[200:203], v[164:167]
 ds_read_b64_tr_b16 a[100:101], v9 offset:16384
 v_accvgpr_write_b32 a36, v36
 v_mfma_f32_16x16x32_bf16 v[164:167], a[80:83], a[208:211], v[164:167]
 s_waitcnt lgkmcnt(3)
 ds_read_b64_tr_b16 a[102:103], v9 offset:20480
 v_xor_b32 v10, 320, v6
 v_mfma_f32_16x16x32_bf16 v[164:167], a[84:87], a[216:219], v[164:167]
 ds_read_b64_tr_b16 a[104:105], v10 offset:0
 v_accvgpr_write_b32 a37, v37
 v_mfma_f32_16x16x32_bf16 v[164:167], a[88:91], a[112:115], v[164:167]
 ds_read_b64_tr_b16 a[106:107], v10 offset:4096
 v_accvgpr_write_b32 a38, v38
 v_mfma_f32_16x16x32_bf16 v[164:167], a[92:95], a[120:123], v[164:167]
 ds_read_b64_tr_b16 a[108:109], v10 offset:16384
 v_accvgpr_write_b32 a39, v39
 v_mfma_f32_16x16x32_bf16 v[172:175], a[72:75], a[196:199], v[172:175]
 ds_read_b64_tr_b16 a[110:111], v10 offset:20480
 v_xor_b32 v7, 65856, v6
 v_mfma_f32_16x16x32_bf16 v[172:175], a[76:79], a[204:207], v[172:175]
 ds_read_b64_tr_b16 a[64:65], v7 offset:0
 v_mul_f32 v84, s34, v84
 v_mfma_f32_16x16x32_bf16 v[172:175], a[80:83], a[212:215], v[172:175]
 ds_read_b64_tr_b16 a[66:67], v7 offset:4096
 v_mul_f32 v85, s34, v85
 v_mfma_f32_16x16x32_bf16 v[172:175], a[84:87], a[220:223], v[172:175]
 ds_read_b64_tr_b16 a[68:69], v7 offset:16384
 v_mul_f32 v86, s34, v86
 v_mfma_f32_16x16x32_bf16 v[172:175], a[88:91], a[116:119], v[172:175]
 ds_read_b64_tr_b16 a[70:71], v7 offset:20480
 v_xor_b32 v8, 131424, v6
 v_mfma_f32_16x16x32_bf16 v[172:175], a[92:95], a[124:127], v[172:175]
 s_waitcnt lgkmcnt(6)
 ds_read_b64_tr_b16 a[72:73], v8 offset:0
 v_mul_f32 v87, s34, v87
 v_mfma_f32_16x16x32_bf16 v[180:183], a[96:99], a[192:195], v[180:183]
 ds_read_b64_tr_b16 a[74:75], v8 offset:4096
 v_mul_f32 v100, s34, v100
 v_mfma_f32_16x16x32_bf16 v[180:183], a[100:103], a[200:203], v[180:183]
 ds_read_b64_tr_b16 a[76:77], v8 offset:16384
 v_mul_f32 v101, s34, v101
 v_mfma_f32_16x16x32_bf16 v[180:183], a[104:107], a[208:211], v[180:183]
 s_waitcnt lgkmcnt(3)
 ds_read_b64_tr_b16 a[78:79], v8 offset:20480
 v_xor_b32 v9, 352, v6
 v_mfma_f32_16x16x32_bf16 v[180:183], a[108:111], a[216:219], v[180:183]
 ds_read_b64_tr_b16 a[80:81], v9 offset:0
 v_mul_f32 v102, s34, v102
 v_mfma_f32_16x16x32_bf16 v[180:183], a[64:67], a[112:115], v[180:183]
 ds_read_b64_tr_b16 a[82:83], v9 offset:4096
 v_mul_f32 v103, s34, v103
 v_mfma_f32_16x16x32_bf16 v[180:183], a[68:71], a[120:123], v[180:183]
 ds_read_b64_tr_b16 a[84:85], v9 offset:16384
 v_cvt_pk_bf16_f32 v84, v84, v85
 v_mfma_f32_16x16x32_bf16 v[188:191], a[96:99], a[196:199], v[188:191]
 ds_read_b64_tr_b16 a[86:87], v9 offset:20480
 v_xor_b32 v10, 65888, v6
 v_mfma_f32_16x16x32_bf16 v[188:191], a[100:103], a[204:207], v[188:191]
 ds_read_b64_tr_b16 a[88:89], v10 offset:0
 v_cvt_pk_bf16_f32 v85, v86, v87
 v_mfma_f32_16x16x32_bf16 v[188:191], a[104:107], a[212:215], v[188:191]
 ds_read_b64_tr_b16 a[90:91], v10 offset:4096
 v_cvt_pk_bf16_f32 v86, v100, v101
 v_mfma_f32_16x16x32_bf16 v[188:191], a[108:111], a[220:223], v[188:191]
 ds_read_b64_tr_b16 a[92:93], v10 offset:16384
 v_cvt_pk_bf16_f32 v87, v102, v103
 v_mfma_f32_16x16x32_bf16 v[188:191], a[64:67], a[116:119], v[188:191]
 ds_read_b64_tr_b16 a[94:95], v10 offset:20480
 v_xor_b32 v7, 131456, v6
 v_mfma_f32_16x16x32_bf16 v[188:191], a[68:71], a[124:127], v[188:191]
 s_waitcnt lgkmcnt(6)
 ds_read_b64_tr_b16 a[96:97], v7 offset:0
 v_accvgpr_write_b32 a8, v84
 v_mfma_f32_16x16x32_bf16 v[196:199], a[72:75], a[192:195], v[196:199]
 ds_read_b64_tr_b16 a[98:99], v7 offset:4096
 v_accvgpr_write_b32 a9, v85
 v_mfma_f32_16x16x32_bf16 v[196:199], a[76:79], a[200:203], v[196:199]
 ds_read_b64_tr_b16 a[100:101], v7 offset:16384
 v_accvgpr_write_b32 a10, v86
 v_mfma_f32_16x16x32_bf16 v[196:199], a[80:83], a[208:211], v[196:199]
 s_waitcnt lgkmcnt(3)
 ds_read_b64_tr_b16 a[102:103], v7 offset:20480
 v_xor_b32 v8, 384, v6
 v_mfma_f32_16x16x32_bf16 v[196:199], a[84:87], a[216:219], v[196:199]
 ds_read_b64_tr_b16 a[104:105], v8 offset:0
 v_accvgpr_write_b32 a11, v87
 v_mfma_f32_16x16x32_bf16 v[196:199], a[88:91], a[112:115], v[196:199]
 ds_read_b64_tr_b16 a[106:107], v8 offset:4096
 v_mul_f32 v92, s34, v92
 v_mfma_f32_16x16x32_bf16 v[196:199], a[92:95], a[120:123], v[196:199]
 ds_read_b64_tr_b16 a[108:109], v8 offset:16384
 v_mul_f32 v93, s34, v93
 v_mfma_f32_16x16x32_bf16 v[204:207], a[72:75], a[196:199], v[204:207]
 ds_read_b64_tr_b16 a[110:111], v8 offset:20480
 v_xor_b32 v9, 65920, v6
 v_mfma_f32_16x16x32_bf16 v[204:207], a[76:79], a[204:207], v[204:207]
 ds_read_b64_tr_b16 a[64:65], v9 offset:0
 v_mul_f32 v94, s34, v94
 v_mfma_f32_16x16x32_bf16 v[204:207], a[80:83], a[212:215], v[204:207]
 ds_read_b64_tr_b16 a[66:67], v9 offset:4096
 v_mul_f32 v95, s34, v95
 v_mfma_f32_16x16x32_bf16 v[204:207], a[84:87], a[220:223], v[204:207]
 ds_read_b64_tr_b16 a[68:69], v9 offset:16384
 v_mul_f32 v108, s34, v108
 v_mfma_f32_16x16x32_bf16 v[204:207], a[88:91], a[116:119], v[204:207]
 ds_read_b64_tr_b16 a[70:71], v9 offset:20480
 v_xor_b32 v10, 131488, v6
 v_mfma_f32_16x16x32_bf16 v[204:207], a[92:95], a[124:127], v[204:207]
 s_waitcnt lgkmcnt(6)
 ds_read_b64_tr_b16 a[72:73], v10 offset:0
 v_mul_f32 v109, s34, v109
 v_mfma_f32_16x16x32_bf16 v[212:215], a[96:99], a[192:195], v[212:215]
 ds_read_b64_tr_b16 a[74:75], v10 offset:4096
 v_mul_f32 v110, s34, v110
 v_mfma_f32_16x16x32_bf16 v[212:215], a[100:103], a[200:203], v[212:215]
 ds_read_b64_tr_b16 a[76:77], v10 offset:16384
 v_mul_f32 v111, s34, v111
 v_mfma_f32_16x16x32_bf16 v[212:215], a[104:107], a[208:211], v[212:215]
 s_waitcnt lgkmcnt(3)
 ds_read_b64_tr_b16 a[78:79], v10 offset:20480
 v_xor_b32 v7, 416, v6
 v_mfma_f32_16x16x32_bf16 v[212:215], a[108:111], a[216:219], v[212:215]
 ds_read_b64_tr_b16 a[80:81], v7 offset:0
 v_cvt_pk_bf16_f32 v92, v92, v93
 v_mfma_f32_16x16x32_bf16 v[212:215], a[64:67], a[112:115], v[212:215]
 ds_read_b64_tr_b16 a[82:83], v7 offset:4096
 v_cvt_pk_bf16_f32 v93, v94, v95
 v_mfma_f32_16x16x32_bf16 v[212:215], a[68:71], a[120:123], v[212:215]
 ds_read_b64_tr_b16 a[84:85], v7 offset:16384
 v_cvt_pk_bf16_f32 v94, v108, v109
 v_mfma_f32_16x16x32_bf16 v[220:223], a[96:99], a[196:199], v[220:223]
 ds_read_b64_tr_b16 a[86:87], v7 offset:20480
 v_xor_b32 v8, 65952, v6
 v_mfma_f32_16x16x32_bf16 v[220:223], a[100:103], a[204:207], v[220:223]
 ds_read_b64_tr_b16 a[88:89], v8 offset:0
 v_cvt_pk_bf16_f32 v95, v110, v111
 v_mfma_f32_16x16x32_bf16 v[220:223], a[104:107], a[212:215], v[220:223]
 ds_read_b64_tr_b16 a[90:91], v8 offset:4096
 v_accvgpr_write_b32 a40, v92
 v_mfma_f32_16x16x32_bf16 v[220:223], a[108:111], a[220:223], v[220:223]
 ds_read_b64_tr_b16 a[92:93], v8 offset:16384
 v_accvgpr_write_b32 a41, v93
 v_mfma_f32_16x16x32_bf16 v[220:223], a[64:67], a[116:119], v[220:223]
 ds_read_b64_tr_b16 a[94:95], v8 offset:20480
 v_xor_b32 v9, 131520, v6
 v_mfma_f32_16x16x32_bf16 v[220:223], a[68:71], a[124:127], v[220:223]
 s_waitcnt lgkmcnt(6)
 ds_read_b64_tr_b16 a[96:97], v9 offset:0
 v_accvgpr_write_b32 a42, v94
 v_mfma_f32_16x16x32_bf16 v[228:231], a[72:75], a[192:195], v[228:231]
 ds_read_b64_tr_b16 a[98:99], v9 offset:4096
 v_accvgpr_write_b32 a43, v95
 v_mfma_f32_16x16x32_bf16 v[228:231], a[76:79], a[200:203], v[228:231]
 ds_read_b64_tr_b16 a[100:101], v9 offset:16384
 v_mul_f32 v116, s34, v116
 v_mfma_f32_16x16x32_bf16 v[228:231], a[80:83], a[208:211], v[228:231]
 s_waitcnt lgkmcnt(3)
 ds_read_b64_tr_b16 a[102:103], v9 offset:20480
 v_xor_b32 v10, 448, v6
 v_mfma_f32_16x16x32_bf16 v[228:231], a[84:87], a[216:219], v[228:231]
 ds_read_b64_tr_b16 a[104:105], v10 offset:0
 v_mul_f32 v117, s34, v117
 v_mfma_f32_16x16x32_bf16 v[228:231], a[88:91], a[112:115], v[228:231]
 ds_read_b64_tr_b16 a[106:107], v10 offset:4096
 v_mul_f32 v118, s34, v118
 v_mfma_f32_16x16x32_bf16 v[228:231], a[92:95], a[120:123], v[228:231]
 ds_read_b64_tr_b16 a[108:109], v10 offset:16384
 v_mul_f32 v119, s34, v119
 v_mfma_f32_16x16x32_bf16 v[236:239], a[72:75], a[196:199], v[236:239]
 ds_read_b64_tr_b16 a[110:111], v10 offset:20480
 v_xor_b32 v7, 65984, v6
 v_mfma_f32_16x16x32_bf16 v[236:239], a[76:79], a[204:207], v[236:239]
 ds_read_b64_tr_b16 a[64:65], v7 offset:0
 buffer_load_dword v13, v12, s[12:15], s58 offen sc1
 v_mfma_f32_16x16x32_bf16 v[236:239], a[80:83], a[212:215], v[236:239]
 ds_read_b64_tr_b16 a[66:67], v7 offset:4096
 v_mul_f32 v132, s34, v132
 v_mfma_f32_16x16x32_bf16 v[236:239], a[84:87], a[220:223], v[236:239]
 ds_read_b64_tr_b16 a[68:69], v7 offset:16384
 v_mul_f32 v133, s34, v133
 v_mfma_f32_16x16x32_bf16 v[236:239], a[88:91], a[116:119], v[236:239]
 ds_read_b64_tr_b16 a[70:71], v7 offset:20480
 v_xor_b32 v8, 131552, v6
 v_mfma_f32_16x16x32_bf16 v[236:239], a[92:95], a[124:127], v[236:239]
 s_waitcnt lgkmcnt(6)
 ds_read_b64_tr_b16 a[72:73], v8 offset:0
 v_mul_f32 v134, s34, v134
 v_mfma_f32_16x16x32_bf16 v[244:247], a[96:99], a[192:195], v[244:247]
 ds_read_b64_tr_b16 a[74:75], v8 offset:4096
 v_mul_f32 v135, s34, v135
 v_mfma_f32_16x16x32_bf16 v[244:247], a[100:103], a[200:203], v[244:247]
 ds_read_b64_tr_b16 a[76:77], v8 offset:16384
 v_cvt_pk_bf16_f32 v116, v116, v117
 v_mfma_f32_16x16x32_bf16 v[244:247], a[104:107], a[208:211], v[244:247]
 s_waitcnt lgkmcnt(3)
 ds_read_b64_tr_b16 a[78:79], v8 offset:20480
 v_xor_b32 v9, 480, v6
 v_mfma_f32_16x16x32_bf16 v[244:247], a[108:111], a[216:219], v[244:247]
 ds_read_b64_tr_b16 a[80:81], v9 offset:0
 v_cvt_pk_bf16_f32 v117, v118, v119
 v_mfma_f32_16x16x32_bf16 v[244:247], a[64:67], a[112:115], v[244:247]
 ds_read_b64_tr_b16 a[82:83], v9 offset:4096
 v_cvt_pk_bf16_f32 v118, v132, v133
 v_mfma_f32_16x16x32_bf16 v[244:247], a[68:71], a[120:123], v[244:247]
 ds_read_b64_tr_b16 a[84:85], v9 offset:16384
 v_cvt_pk_bf16_f32 v119, v134, v135
 v_mfma_f32_16x16x32_bf16 v[252:255], a[96:99], a[196:199], v[252:255]
 ds_read_b64_tr_b16 a[86:87], v9 offset:20480
 v_xor_b32 v10, 66016, v6
 v_mfma_f32_16x16x32_bf16 v[252:255], a[100:103], a[204:207], v[252:255]
 ds_read_b64_tr_b16 a[88:89], v10 offset:0
 v_accvgpr_write_b32 a12, v116
 v_mfma_f32_16x16x32_bf16 v[252:255], a[104:107], a[212:215], v[252:255]
 ds_read_b64_tr_b16 a[90:91], v10 offset:4096
 v_accvgpr_write_b32 a13, v117
 v_mfma_f32_16x16x32_bf16 v[252:255], a[108:111], a[220:223], v[252:255]
 ds_read_b64_tr_b16 a[92:93], v10 offset:16384
 v_accvgpr_write_b32 a14, v118
 v_mfma_f32_16x16x32_bf16 v[252:255], a[64:67], a[116:119], v[252:255]
 ds_read_b64_tr_b16 a[94:95], v10 offset:20480
 v_accvgpr_write_b32 a15, v119
 v_mfma_f32_16x16x32_bf16 v[252:255], a[68:71], a[124:127], v[252:255]
 s_waitcnt lgkmcnt(6)
 v_mfma_f32_16x16x32_bf16 v[16:19], a[72:75], a[192:195], v[16:19]
 v_mfma_f32_16x16x32_bf16 v[16:19], a[76:79], a[200:203], v[16:19]
 v_mfma_f32_16x16x32_bf16 v[16:19], a[80:83], a[208:211], v[16:19]
 s_waitcnt lgkmcnt(0)
 v_mfma_f32_16x16x32_bf16 v[16:19], a[84:87], a[216:219], v[16:19]
 v_mfma_f32_16x16x32_bf16 v[16:19], a[88:91], a[112:115], v[16:19]
 v_mfma_f32_16x16x32_bf16 v[16:19], a[92:95], a[120:123], v[16:19]
 v_mfma_f32_16x16x32_bf16 v[24:27], a[72:75], a[196:199], v[24:27]
 v_mfma_f32_16x16x32_bf16 v[24:27], a[76:79], a[204:207], v[24:27]
 v_mfma_f32_16x16x32_bf16 v[24:27], a[80:83], a[212:215], v[24:27]
 v_mfma_f32_16x16x32_bf16 v[24:27], a[84:87], a[220:223], v[24:27]
 s_waitcnt lgkmcnt(0)
 v_mfma_f32_16x16x32_bf16 v[24:27], a[88:91], a[116:119], v[24:27]
 s_barrier
 v_mfma_f32_16x16x32_bf16 v[24:27], a[92:95], a[124:127], v[24:27]
 s_waitcnt vmcnt(0)
 v_cmp_ne_u32 s[16:17], 0, v13
 v_cmp_gt_u32 vcc, 256, v5
 s_or_b64 vcc, vcc, s[16:17]
 s_mov_b32 m0, s40
 s_cselect_b32 s48, 0, 1
 s_cselect_b32 s52, 2.0, s42
 buffer_load_dwordx4 v1, s[12:15], s52 offen offset:0 sc1 lds
 v_pk_mul_f32 v[124:125], v[124:125], s[34:35]
 v_pk_mul_f32 v[126:127], v[126:127], s[34:35]
 v_pk_mul_f32 v[140:141], v[140:141], s[34:35]
 v_pk_mul_f32 v[142:143], v[142:143], s[34:35]
 v_cvt_pk_bf16_f32 v124, v124, v125
 v_cvt_pk_bf16_f32 v125, v126, v127
 v_cvt_pk_bf16_f32 v126, v140, v141
 v_cvt_pk_bf16_f32 v127, v142, v143
 v_accvgpr_write_b32 a44, v124
 v_accvgpr_write_b32 a45, v125
 v_accvgpr_write_b32 a46, v126
 v_accvgpr_write_b32 a47, v127
 v_pk_mul_f32 v[148:149], v[148:149], s[34:35]
 v_pk_mul_f32 v[150:151], v[150:151], s[34:35]
 buffer_load_dwordx4 v1, s[12:15], s52 offen offset:1024 sc1 lds
 v_pk_mul_f32 v[164:165], v[164:165], s[34:35]
 v_pk_mul_f32 v[166:167], v[166:167], s[34:35]
 v_cvt_pk_bf16_f32 v148, v148, v149
 v_cvt_pk_bf16_f32 v149, v150, v151
 v_cvt_pk_bf16_f32 v150, v164, v165
 v_cvt_pk_bf16_f32 v151, v166, v167
 v_accvgpr_write_b32 a16, v148
 v_accvgpr_write_b32 a17, v149
 v_accvgpr_write_b32 a18, v150
 v_accvgpr_write_b32 a19, v151
 v_pk_mul_f32 v[156:157], v[156:157], s[34:35]
 v_pk_mul_f32 v[158:159], v[158:159], s[34:35]
 v_pk_mul_f32 v[172:173], v[172:173], s[34:35]
 buffer_load_dwordx4 v1, s[12:15], s52 offen offset:2048 sc1 lds
 v_pk_mul_f32 v[174:175], v[174:175], s[34:35]
 v_cvt_pk_bf16_f32 v156, v156, v157
 v_cvt_pk_bf16_f32 v157, v158, v159
 v_cvt_pk_bf16_f32 v158, v172, v173
 v_cvt_pk_bf16_f32 v159, v174, v175
 v_accvgpr_write_b32 a48, v156
 v_accvgpr_write_b32 a49, v157
 v_accvgpr_write_b32 a50, v158
 v_accvgpr_write_b32 a51, v159
 v_pk_mul_f32 v[180:181], v[180:181], s[34:35]
 v_pk_mul_f32 v[182:183], v[182:183], s[34:35]
 v_pk_mul_f32 v[196:197], v[196:197], s[34:35]
 v_pk_mul_f32 v[198:199], v[198:199], s[34:35]
 v_cvt_pk_bf16_f32 v180, v180, v181
 buffer_load_dwordx4 v1, s[12:15], s52 offen offset:3072 sc1 lds
 v_cvt_pk_bf16_f32 v181, v182, v183
 v_cvt_pk_bf16_f32 v182, v196, v197
 v_cvt_pk_bf16_f32 v183, v198, v199
 v_accvgpr_write_b32 a20, v180
 v_accvgpr_write_b32 a21, v181
 v_accvgpr_write_b32 a22, v182
 v_accvgpr_write_b32 a23, v183
 v_pk_mul_f32 v[188:189], v[188:189], s[34:35]
 v_pk_mul_f32 v[190:191], v[190:191], s[34:35]
 v_pk_mul_f32 v[204:205], v[204:205], s[34:35]
 v_pk_mul_f32 v[206:207], v[206:207], s[34:35]
 v_cvt_pk_bf16_f32 v188, v188, v189
 v_cvt_pk_bf16_f32 v189, v190, v191
 s_bitset1_b32 m0, 12
 s_nop 0
 buffer_load_dwordx4 v4, s[12:15], s52 offen offset:0 sc1 lds
 v_cvt_pk_bf16_f32 v190, v204, v205
 v_cvt_pk_bf16_f32 v191, v206, v207
 v_accvgpr_write_b32 a52, v188
 v_accvgpr_write_b32 a53, v189
 v_accvgpr_write_b32 a54, v190
 v_accvgpr_write_b32 a55, v191
 v_pk_mul_f32 v[212:213], v[212:213], s[34:35]
 v_pk_mul_f32 v[214:215], v[214:215], s[34:35]
 v_pk_mul_f32 v[228:229], v[228:229], s[34:35]
 v_pk_mul_f32 v[230:231], v[230:231], s[34:35]
 v_cvt_pk_bf16_f32 v212, v212, v213
 v_cvt_pk_bf16_f32 v213, v214, v215
 v_cvt_pk_bf16_f32 v214, v228, v229
 v_cvt_pk_bf16_f32 v215, v230, v231
 buffer_load_dwordx4 v4, s[12:15], s52 offen offset:1024 sc1 lds
 v_accvgpr_write_b32 a24, v212
 v_accvgpr_write_b32 a25, v213
 v_accvgpr_write_b32 a26, v214
 v_accvgpr_write_b32 a27, v215
 v_pk_mul_f32 v[220:221], v[220:221], s[34:35]
 v_pk_mul_f32 v[222:223], v[222:223], s[34:35]
 v_pk_mul_f32 v[236:237], v[236:237], s[34:35]
 v_pk_mul_f32 v[238:239], v[238:239], s[34:35]
 v_cvt_pk_bf16_f32 v220, v220, v221
 v_cvt_pk_bf16_f32 v221, v222, v223
 v_cvt_pk_bf16_f32 v222, v236, v237
 v_cvt_pk_bf16_f32 v223, v238, v239
 v_accvgpr_write_b32 a56, v220
 buffer_load_dwordx4 v4, s[12:15], s52 offen offset:2048 sc1 lds
 v_accvgpr_write_b32 a57, v221
 v_accvgpr_write_b32 a58, v222
 v_accvgpr_write_b32 a59, v223
 v_pk_mul_f32 v[244:245], v[244:245], s[34:35]
 v_pk_mul_f32 v[246:247], v[246:247], s[34:35]
 v_pk_mul_f32 v[16:17], v[16:17], s[34:35]
 v_pk_mul_f32 v[18:19], v[18:19], s[34:35]
 v_cvt_pk_bf16_f32 v244, v244, v245
 v_cvt_pk_bf16_f32 v245, v246, v247
 v_cvt_pk_bf16_f32 v246, v16, v17
 v_cvt_pk_bf16_f32 v247, v18, v19
 v_accvgpr_write_b32 a28, v244
 v_accvgpr_write_b32 a29, v245
 v_accvgpr_write_b32 a30, v246
 buffer_load_dwordx4 v4, s[12:15], s52 offen offset:3072 sc1 lds
 v_accvgpr_write_b32 a31, v247
 v_pk_mul_f32 v[252:253], v[252:253], s[34:35]
 v_pk_mul_f32 v[254:255], v[254:255], s[34:35]
 v_pk_mul_f32 v[24:25], v[24:25], s[34:35]
 v_pk_mul_f32 v[26:27], v[26:27], s[34:35]
 v_cvt_pk_bf16_f32 v252, v252, v253
 v_cvt_pk_bf16_f32 v253, v254, v255
 v_cvt_pk_bf16_f32 v254, v24, v25
 v_cvt_pk_bf16_f32 v255, v26, v27
 v_accvgpr_write_b32 a60, v252
 v_accvgpr_write_b32 a61, v253
 v_accvgpr_write_b32 a62, v254
 v_accvgpr_write_b32 a63, v255
 s_branch L_kvdone
L_late0:
 v_mfma_f32_16x16x32_bf16 a[232:235], a[0:3], a[96:99], a[232:235]
 ds_read_b64_tr_b16 a[24:25], v9 offset:32768
 v_mfma_f32_16x16x32_bf16 a[232:235], a[4:7], a[100:103], a[232:235]
 s_add_u32 m0, s33, 0xfffffd00
 ds_read_b64_tr_b16 a[26:27], v9 offset:36864
 v_mfma_f32_16x16x32_bf16 a[224:227], a[4:7], a[108:111], a[224:227]
 s_waitcnt lgkmcnt(13)
 ds_read_b64_tr_b16 a[28:29], v9 offset:49152
 v_mfma_f32_16x16x32_bf16 a[224:227], a[0:3], a[104:107], a[224:227]
 ds_read_b64_tr_b16 a[30:31], v9 offset:53248
 buffer_load_dwordx4 v15, s[20:23], 0 offen offset:768 lds
 v_mfma_f32_16x16x32_bf16 v[24:27], a[0:3], a[112:115], v[24:27]
 s_waitcnt lgkmcnt(12)
 ds_read_b128 a[64:67], v4 offset:32768
 v_mfma_f32_16x16x32_bf16 v[24:27], a[4:7], a[116:119], v[24:27]
 v_mfma_f32_16x16x32_bf16 v[16:19], a[4:7], a[124:127], v[16:19]
 s_add_u32 m0, s33, 0xfffffd80
 ds_read_b128 a[68:71], v5 offset:32768
 v_mfma_f32_16x16x32_bf16 v[16:19], a[0:3], a[120:123], v[16:19]
 s_waitcnt lgkmcnt(10)
 buffer_load_dwordx4 v15, s[20:23], 0 offen offset:1664 lds
 v_mfma_f32_16x16x32_bf16 v[20:23], a[8:11], a[120:123], v[20:23]
 ds_read_b128 a[76:79], v5 offset:34816
 v_mfma_f32_16x16x32_bf16 v[20:23], a[12:15], a[124:127], v[20:23]
 v_mfma_f32_16x16x32_bf16 v[28:31], a[12:15], a[116:119], v[28:31]
 s_add_u32 m0, s33, 0x500
 ds_read_b128 a[72:75], v4 offset:34816
 v_mfma_f32_16x16x32_bf16 v[28:31], a[8:11], a[112:115], v[28:31]
 buffer_load_dwordx4 v15, s[20:23], s57 offen offset:768 lds
 v_mfma_f32_16x16x32_bf16 a[228:231], a[8:11], a[104:107], a[228:231]
 ds_read_b128 a[80:83], v4 offset:36864
 v_mfma_f32_16x16x32_bf16 a[228:231], a[12:15], a[108:111], a[228:231]
 v_mfma_f32_16x16x32_bf16 a[236:239], a[12:15], a[100:103], a[236:239]
 s_add_u32 m0, s33, 0x580
 ds_read_b128 a[84:87], v5 offset:36864
 v_mfma_f32_16x16x32_bf16 a[236:239], a[8:11], a[96:99], a[236:239]
 s_waitcnt lgkmcnt(10)
 buffer_load_dwordx4 v15, s[20:23], s57 offen offset:1664 lds
 v_mfma_f32_16x16x32_bf16 v[56:59], a[16:19], a[96:99], v[56:59]
 ds_read_b128 a[92:95], v5 offset:38912
 v_mfma_f32_16x16x32_bf16 v[56:59], a[20:23], a[100:103], v[56:59]
 v_cvt_pk_bf16_f32 v16, v16, v17
 v_cvt_pk_bf16_f32 v17, v18, v19
 v_mfma_f32_16x16x32_bf16 v[48:51], a[20:23], a[108:111], v[48:51]
 ds_read_b128 a[88:91], v4 offset:38912
 v_cvt_pk_bf16_f32 v18, v20, v21
 v_mfma_f32_16x16x32_bf16 v[48:51], a[16:19], a[104:107], v[48:51]
 v_cvt_pk_bf16_f32 v19, v22, v23
 v_cvt_pk_bf16_f32 v24, v24, v25
 v_mfma_f32_16x16x32_bf16 v[40:43], a[16:19], a[112:115], v[40:43]
 ds_read_b64_tr_b16 a[32:33], v10 offset:32768
 v_cvt_pk_bf16_f32 v25, v26, v27
 v_mfma_f32_16x16x32_bf16 v[40:43], a[20:23], a[116:119], v[40:43]
 ds_read_b64_tr_b16 a[34:35], v10 offset:36864
 v_cvt_pk_bf16_f32 v26, v28, v29
 v_mfma_f32_16x16x32_bf16 v[32:35], a[20:23], a[124:127], v[32:35]
 s_add_u32 s59, s56, 57344
 ds_read_b64_tr_b16 a[36:37], v10 offset:49152
 v_cvt_pk_bf16_f32 v27, v30, v31
 v_mfma_f32_16x16x32_bf16 v[32:35], a[16:19], a[120:123], v[32:35]
 s_waitcnt lgkmcnt(11)
 ds_read_b64_tr_b16 a[38:39], v10 offset:53248
 v_accvgpr_read_b32 v20, a224
 v_mfma_f32_16x16x32_bf16 v[36:39], a[24:27], a[120:123], v[36:39]
 ds_read_b64_tr_b16 a[40:41], v11 offset:32768
 buffer_store_dwordx4 v[16:19], v1, s[12:15], s59 offen offset:0 sc1
 v_mfma_f32_16x16x32_bf16 v[36:39], a[28:31], a[124:127], v[36:39]
 ds_read_b64_tr_b16 a[42:43], v11 offset:36864
 v_accvgpr_read_b32 v21, a225
 v_mfma_f32_16x16x32_bf16 v[44:47], a[28:31], a[116:119], v[44:47]
 ds_read_b64_tr_b16 a[44:45], v11 offset:49152
 v_accvgpr_read_b32 v22, a226
 v_mfma_f32_16x16x32_bf16 v[44:47], a[24:27], a[112:115], v[44:47]
 ds_read_b64_tr_b16 a[46:47], v11 offset:53248
 v_accvgpr_read_b32 v23, a227
 v_mfma_f32_16x16x32_bf16 v[52:55], a[24:27], a[104:107], v[52:55]
 ds_read_b64_tr_b16 a[48:49], v12 offset:32768
 v_accvgpr_read_b32 v28, a228
 v_mfma_f32_16x16x32_bf16 v[52:55], a[28:31], a[108:111], v[52:55]
 ds_read_b64_tr_b16 a[50:51], v12 offset:36864
 v_accvgpr_read_b32 v29, a229
 v_mfma_f32_16x16x32_bf16 v[60:63], a[28:31], a[100:103], v[60:63]
 s_add_u32 s59, s56, 49152
 ds_read_b64_tr_b16 a[52:53], v12 offset:49152
 v_accvgpr_read_b32 v30, a230
 v_mfma_f32_16x16x32_bf16 v[60:63], a[24:27], a[96:99], v[60:63]
 s_waitcnt lgkmcnt(15)
 ds_read_b64_tr_b16 a[54:55], v12 offset:53248
 buffer_store_dwordx4 v[24:27], v1, s[12:15], s59 offen offset:0 sc1
 v_mfma_f32_16x16x32_bf16 v[88:91], a[0:3], a[64:67], v[88:91]
 ds_read_b64_tr_b16 a[56:57], v13 offset:32768
 v_accvgpr_read_b32 v31, a231
 v_mfma_f32_16x16x32_bf16 v[88:91], a[4:7], a[68:71], v[88:91]
 ds_read_b64_tr_b16 a[58:59], v13 offset:36864
 v_cvt_pk_bf16_f32 v20, v20, v21
 v_mfma_f32_16x16x32_bf16 v[80:83], a[4:7], a[76:79], v[80:83]
 ds_read_b64_tr_b16 a[60:61], v13 offset:49152
 v_cvt_pk_bf16_f32 v21, v22, v23
 v_mfma_f32_16x16x32_bf16 v[80:83], a[0:3], a[72:75], v[80:83]
 s_waitcnt lgkmcnt(15)
 ds_read_b64_tr_b16 a[62:63], v13 offset:53248
 v_cvt_pk_bf16_f32 v22, v28, v29
 v_mfma_f32_16x16x32_bf16 v[72:75], a[0:3], a[80:83], v[72:75]
 v_cvt_pk_bf16_f32 v23, v30, v31
 v_cvt_pk_bf16_f32 v32, v32, v33
 v_mfma_f32_16x16x32_bf16 v[72:75], a[4:7], a[84:87], v[72:75]
 s_add_u32 s59, s56, 40960
 v_cvt_pk_bf16_f32 v33, v34, v35
 v_cvt_pk_bf16_f32 v34, v36, v37
 v_mfma_f32_16x16x32_bf16 v[64:67], a[4:7], a[92:95], v[64:67]
 buffer_store_dwordx4 v[20:23], v1, s[12:15], s59 offen offset:0 sc1
 v_mfma_f32_16x16x32_bf16 v[64:67], a[0:3], a[88:91], v[64:67]
 s_waitcnt lgkmcnt(0)
 v_cvt_pk_bf16_f32 v35, v38, v39
 v_cvt_pk_bf16_f32 v40, v40, v41
 v_mfma_f32_16x16x32_bf16 v[68:71], a[8:11], a[88:91], v[68:71]
 s_barrier
 v_xor_b32 v6, s60, v6
 v_cvt_pk_bf16_f32 v41, v42, v43
 v_mfma_f32_16x16x32_bf16 v[68:71], a[12:15], a[92:95], v[68:71]
 s_add_u32 m0, s29, 32768
 v_add_u32 v2, 0x80000, v2
 v_cvt_pk_bf16_f32 v42, v44, v45
 v_mfma_f32_16x16x32_bf16 v[76:79], a[12:15], a[84:87], v[76:79]
 buffer_load_dwordx4 v2, s[16:19], 0 offen lds
 v_mfma_f32_16x16x32_bf16 v[76:79], a[8:11], a[80:83], v[76:79]
 v_cvt_pk_bf16_f32 v43, v46, v47
 v_accvgpr_read_b32 v36, a232
 v_mfma_f32_16x16x32_bf16 v[84:87], a[8:11], a[72:75], v[84:87]
 v_accvgpr_read_b32 v37, a233
 v_accvgpr_read_b32 v38, a234
 v_mfma_f32_16x16x32_bf16 v[84:87], a[12:15], a[76:79], v[84:87]
 v_accvgpr_read_b32 v39, a235
 v_accvgpr_read_b32 v44, a236
 v_mfma_f32_16x16x32_bf16 v[92:95], a[12:15], a[68:71], v[92:95]
 s_add_u32 m0, s29, 36864
 v_accvgpr_read_b32 v45, a237
 v_accvgpr_read_b32 v46, a238
 v_mfma_f32_16x16x32_bf16 v[92:95], a[8:11], a[64:67], v[92:95]
 buffer_load_dwordx4 v2, s[16:19], s48 offen lds
 v_mfma_f32_16x16x32_bf16 v[120:123], a[16:19], a[64:67], v[120:123]
 v_accvgpr_read_b32 v47, a239
 v_cvt_pk_bf16_f32 v36, v36, v37
 v_mfma_f32_16x16x32_bf16 v[120:123], a[20:23], a[68:71], v[120:123]
 v_cvt_pk_bf16_f32 v37, v38, v39
 v_cvt_pk_bf16_f32 v38, v44, v45
 v_mfma_f32_16x16x32_bf16 v[112:115], a[20:23], a[76:79], v[112:115]
 v_cvt_pk_bf16_f32 v39, v46, v47
 v_cvt_pk_bf16_f32 v48, v48, v49
 v_mfma_f32_16x16x32_bf16 v[112:115], a[16:19], a[72:75], v[112:115]
 s_add_u32 m0, s29, 40960
 v_cvt_pk_bf16_f32 v49, v50, v51
 v_cvt_pk_bf16_f32 v50, v52, v53
 v_mfma_f32_16x16x32_bf16 v[104:107], a[16:19], a[80:83], v[104:107]
 buffer_load_dwordx4 v2, s[16:19], s49 offen lds
 v_mfma_f32_16x16x32_bf16 v[104:107], a[20:23], a[84:87], v[104:107]
 v_cvt_pk_bf16_f32 v51, v54, v55
 v_cvt_pk_bf16_f32 v56, v56, v57
 v_mfma_f32_16x16x32_bf16 v[96:99], a[20:23], a[92:95], v[96:99]
 v_cvt_pk_bf16_f32 v57, v58, v59
 v_cvt_pk_bf16_f32 v58, v60, v61
 v_mfma_f32_16x16x32_bf16 v[96:99], a[16:19], a[88:91], v[96:99]
 v_cvt_pk_bf16_f32 v59, v62, v63
 v_cvt_pk_bf16_f32 v64, v64, v65
 v_mfma_f32_16x16x32_bf16 v[100:103], a[24:27], a[88:91], v[100:103]
 s_add_u32 m0, s29, 45056
 v_cvt_pk_bf16_f32 v65, v66, v67
 v_cvt_pk_bf16_f32 v66, v68, v69
 v_mfma_f32_16x16x32_bf16 v[100:103], a[28:31], a[92:95], v[100:103]
 buffer_load_dwordx4 v2, s[16:19], s50 offen lds
 v_mfma_f32_16x16x32_bf16 v[108:111], a[28:31], a[84:87], v[108:111]
 s_add_u32 s59, s56, 32768
 v_cvt_pk_bf16_f32 v67, v70, v71
 v_cvt_pk_bf16_f32 v72, v72, v73
 v_mfma_f32_16x16x32_bf16 v[108:111], a[24:27], a[80:83], v[108:111]
 buffer_store_dwordx4 v[36:39], v1, s[12:15], s59 offen offset:0 sc1
 v_mfma_f32_16x16x32_bf16 v[116:119], a[24:27], a[72:75], v[116:119]
 v_cvt_pk_bf16_f32 v73, v74, v75
 v_cvt_pk_bf16_f32 v74, v76, v77
 v_mfma_f32_16x16x32_bf16 v[116:119], a[28:31], a[76:79], v[116:119]
 s_add_u32 m0, s29, 49152
 v_cvt_pk_bf16_f32 v75, v78, v79
 v_cvt_pk_bf16_f32 v80, v80, v81
 v_mfma_f32_16x16x32_bf16 v[124:127], a[28:31], a[68:71], v[124:127]
 buffer_load_dwordx4 v2, s[16:19], s51 offen lds
 v_mfma_f32_16x16x32_bf16 v[124:127], a[24:27], a[64:67], v[124:127]
 v_cvt_pk_bf16_f32 v81, v82, v83
 v_cvt_pk_bf16_f32 v82, v84, v85
 v_mfma_f32_16x16x32_bf16 v[152:155], a[32:35], a[64:67], v[152:155]
 v_cvt_pk_bf16_f32 v83, v86, v87
 v_cvt_pk_bf16_f32 v88, v88, v89
 v_mfma_f32_16x16x32_bf16 v[152:155], a[36:39], a[68:71], v[152:155]
 v_cvt_pk_bf16_f32 v89, v90, v91
 v_cvt_pk_bf16_f32 v90, v92, v93
 v_mfma_f32_16x16x32_bf16 v[144:147], a[36:39], a[76:79], v[144:147]
 s_add_u32 m0, s29, 53248
 v_cvt_pk_bf16_f32 v91, v94, v95
 v_cvt_pk_bf16_f32 v96, v96, v97
 v_mfma_f32_16x16x32_bf16 v[144:147], a[32:35], a[72:75], v[144:147]
 buffer_load_dwordx4 v2, s[16:19], s52 offen lds
 v_mfma_f32_16x16x32_bf16 v[136:139], a[32:35], a[80:83], v[136:139]
 v_cvt_pk_bf16_f32 v97, v98, v99
 v_cvt_pk_bf16_f32 v98, v100, v101
 v_mfma_f32_16x16x32_bf16 v[136:139], a[36:39], a[84:87], v[136:139]
 v_cvt_pk_bf16_f32 v99, v102, v103
 v_cvt_pk_bf16_f32 v104, v104, v105
 v_mfma_f32_16x16x32_bf16 v[128:131], a[36:39], a[92:95], v[128:131]
 v_cvt_pk_bf16_f32 v105, v106, v107
 v_cvt_pk_bf16_f32 v106, v108, v109
 v_mfma_f32_16x16x32_bf16 v[128:131], a[32:35], a[88:91], v[128:131]
 s_add_u32 m0, s29, 57344
 v_cvt_pk_bf16_f32 v107, v110, v111
 v_cvt_pk_bf16_f32 v112, v112, v113
 v_mfma_f32_16x16x32_bf16 v[132:135], a[40:43], a[88:91], v[132:135]
 buffer_load_dwordx4 v2, s[16:19], s53 offen lds
 v_mfma_f32_16x16x32_bf16 v[132:135], a[44:47], a[92:95], v[132:135]
 v_cvt_pk_bf16_f32 v113, v114, v115
 v_cvt_pk_bf16_f32 v114, v116, v117
 v_mfma_f32_16x16x32_bf16 v[140:143], a[44:47], a[84:87], v[140:143]
 v_cvt_pk_bf16_f32 v115, v118, v119
 v_cvt_pk_bf16_f32 v120, v120, v121
 v_mfma_f32_16x16x32_bf16 v[140:143], a[40:43], a[80:83], v[140:143]
 v_cvt_pk_bf16_f32 v121, v122, v123
 v_cvt_pk_bf16_f32 v122, v124, v125
 v_mfma_f32_16x16x32_bf16 v[148:151], a[40:43], a[72:75], v[148:151]
 s_add_u32 m0, s29, 61440
 v_cvt_pk_bf16_f32 v123, v126, v127
 v_mfma_f32_16x16x32_bf16 v[148:151], a[44:47], a[76:79], v[148:151]
 buffer_load_dwordx4 v2, s[16:19], s54 offen lds
 v_mfma_f32_16x16x32_bf16 v[156:159], a[44:47], a[68:71], v[156:159]
 v_mfma_f32_16x16x32_bf16 v[156:159], a[40:43], a[64:67], v[156:159]
 v_mfma_f32_16x16x32_bf16 v[184:187], a[48:51], a[64:67], v[184:187]
 s_add_u32 m0, s29, 98304
 v_add_u32 v2, 0x80000, v2
 v_mfma_f32_16x16x32_bf16 v[184:187], a[52:55], a[68:71], v[184:187]
 buffer_load_dwordx4 v2, s[16:19], 0 offen lds
 v_mfma_f32_16x16x32_bf16 v[176:179], a[52:55], a[76:79], v[176:179]
 v_cvt_pk_bf16_f32 v128, v128, v129
 v_cvt_pk_bf16_f32 v129, v130, v131
 v_mfma_f32_16x16x32_bf16 v[176:179], a[48:51], a[72:75], v[176:179]
 v_cvt_pk_bf16_f32 v130, v132, v133
 v_cvt_pk_bf16_f32 v131, v134, v135
 v_mfma_f32_16x16x32_bf16 v[168:171], a[48:51], a[80:83], v[168:171]
 v_cvt_pk_bf16_f32 v136, v136, v137
 v_cvt_pk_bf16_f32 v137, v138, v139
 v_mfma_f32_16x16x32_bf16 v[168:171], a[52:55], a[84:87], v[168:171]
 s_add_u32 m0, s29, 102400
 v_cvt_pk_bf16_f32 v138, v140, v141
 v_cvt_pk_bf16_f32 v139, v142, v143
 v_mfma_f32_16x16x32_bf16 v[160:163], a[52:55], a[92:95], v[160:163]
 buffer_load_dwordx4 v2, s[16:19], s48 offen lds
 v_mfma_f32_16x16x32_bf16 v[160:163], a[48:51], a[88:91], v[160:163]
 v_cvt_pk_bf16_f32 v144, v144, v145
 v_cvt_pk_bf16_f32 v145, v146, v147
 v_mfma_f32_16x16x32_bf16 v[164:167], a[56:59], a[88:91], v[164:167]
 v_cvt_pk_bf16_f32 v146, v148, v149
 v_cvt_pk_bf16_f32 v147, v150, v151
 v_mfma_f32_16x16x32_bf16 v[164:167], a[60:63], a[92:95], v[164:167]
 v_cvt_pk_bf16_f32 v152, v152, v153
 v_cvt_pk_bf16_f32 v153, v154, v155
 v_mfma_f32_16x16x32_bf16 v[172:175], a[60:63], a[84:87], v[172:175]
 s_add_u32 m0, s29, 106496
 v_cvt_pk_bf16_f32 v154, v156, v157
 v_cvt_pk_bf16_f32 v155, v158, v159
 v_mfma_f32_16x16x32_bf16 v[172:175], a[56:59], a[80:83], v[172:175]
 buffer_load_dwordx4 v2, s[16:19], s49 offen lds
 v_mfma_f32_16x16x32_bf16 v[180:183], a[56:59], a[72:75], v[180:183]
 v_mfma_f32_16x16x32_bf16 v[180:183], a[60:63], a[76:79], v[180:183]
 v_mfma_f32_16x16x32_bf16 v[188:191], a[60:63], a[68:71], v[188:191]
 v_mfma_f32_16x16x32_bf16 v[188:191], a[56:59], a[64:67], v[188:191]
 s_add_u32 m0, s29, 110592
 v_mfma_f32_16x16x32_bf16 v[216:219], a[32:35], a[96:99], v[216:219]
 buffer_load_dwordx4 v2, s[16:19], s50 offen lds
 v_mfma_f32_16x16x32_bf16 v[216:219], a[36:39], a[100:103], v[216:219]
 v_cvt_pk_bf16_f32 v160, v160, v161
 v_cvt_pk_bf16_f32 v161, v162, v163
 v_mfma_f32_16x16x32_bf16 v[208:211], a[36:39], a[108:111], v[208:211]
 v_cvt_pk_bf16_f32 v162, v164, v165
 v_cvt_pk_bf16_f32 v163, v166, v167
 v_mfma_f32_16x16x32_bf16 v[208:211], a[32:35], a[104:107], v[208:211]
 v_cvt_pk_bf16_f32 v168, v168, v169
 v_cvt_pk_bf16_f32 v169, v170, v171
 v_mfma_f32_16x16x32_bf16 v[200:203], a[32:35], a[112:115], v[200:203]
 s_add_u32 m0, s29, 114688
 v_cvt_pk_bf16_f32 v170, v172, v173
 v_cvt_pk_bf16_f32 v171, v174, v175
 v_mfma_f32_16x16x32_bf16 v[200:203], a[36:39], a[116:119], v[200:203]
 buffer_load_dwordx4 v2, s[16:19], s51 offen lds
 v_mfma_f32_16x16x32_bf16 v[192:195], a[36:39], a[124:127], v[192:195]
 v_cvt_pk_bf16_f32 v176, v176, v177
 v_cvt_pk_bf16_f32 v177, v178, v179
 v_mfma_f32_16x16x32_bf16 v[192:195], a[32:35], a[120:123], v[192:195]
 v_cvt_pk_bf16_f32 v178, v180, v181
 v_cvt_pk_bf16_f32 v179, v182, v183
 v_mfma_f32_16x16x32_bf16 v[196:199], a[40:43], a[120:123], v[196:199]
 v_cvt_pk_bf16_f32 v184, v184, v185
 v_cvt_pk_bf16_f32 v185, v186, v187
 v_mfma_f32_16x16x32_bf16 v[196:199], a[44:47], a[124:127], v[196:199]
 s_add_u32 m0, s29, 118784
 v_cvt_pk_bf16_f32 v186, v188, v189
 v_cvt_pk_bf16_f32 v187, v190, v191
 v_mfma_f32_16x16x32_bf16 v[204:207], a[44:47], a[116:119], v[204:207]
 buffer_load_dwordx4 v2, s[16:19], s52 offen lds
 v_mfma_f32_16x16x32_bf16 v[204:207], a[40:43], a[112:115], v[204:207]
 v_mfma_f32_16x16x32_bf16 v[212:215], a[40:43], a[104:107], v[212:215]
 v_mfma_f32_16x16x32_bf16 v[212:215], a[44:47], a[108:111], v[212:215]
 v_mfma_f32_16x16x32_bf16 v[220:223], a[44:47], a[100:103], v[220:223]
 s_add_u32 m0, s29, 122880
 v_mfma_f32_16x16x32_bf16 v[220:223], a[40:43], a[96:99], v[220:223]
 buffer_load_dwordx4 v2, s[16:19], s53 offen lds
 v_mfma_f32_16x16x32_bf16 v[248:251], a[48:51], a[96:99], v[248:251]
 v_mfma_f32_16x16x32_bf16 v[248:251], a[52:55], a[100:103], v[248:251]
 s_waitcnt vmcnt(19)
 v_cvt_pk_bf16_f32 v192, v192, v193
 v_cvt_pk_bf16_f32 v193, v194, v195
 v_mfma_f32_16x16x32_bf16 v[240:243], a[52:55], a[108:111], v[240:243]
 s_barrier
 v_xor_b32 v7, 0, v6
 v_cvt_pk_bf16_f32 v194, v196, v197
 v_mfma_f32_16x16x32_bf16 v[240:243], a[48:51], a[104:107], v[240:243]
 s_add_u32 m0, s29, 126976
 ds_read_b64_tr_b16 a[64:65], v7 offset:0
 v_cvt_pk_bf16_f32 v195, v198, v199
 v_mfma_f32_16x16x32_bf16 v[232:235], a[48:51], a[112:115], v[232:235]
 ds_read_b64_tr_b16 a[66:67], v7 offset:4096
 buffer_load_dwordx4 v2, s[16:19], s54 offen lds
 v_mfma_f32_16x16x32_bf16 v[232:235], a[52:55], a[116:119], v[232:235]
 ds_read_b64_tr_b16 a[68:69], v7 offset:16384
 v_cvt_pk_bf16_f32 v200, v200, v201
 v_mfma_f32_16x16x32_bf16 v[224:227], a[52:55], a[124:127], v[224:227]
 ds_read_b64_tr_b16 a[70:71], v7 offset:20480
 v_xor_b32 v8, 65536, v6
 v_mfma_f32_16x16x32_bf16 v[224:227], a[48:51], a[120:123], v[224:227]
 ds_read_b64_tr_b16 a[72:73], v8 offset:0
 v_cvt_pk_bf16_f32 v201, v202, v203
 v_mfma_f32_16x16x32_bf16 v[228:231], a[56:59], a[120:123], v[228:231]
 ds_read_b64_tr_b16 a[74:75], v8 offset:4096
 v_cvt_pk_bf16_f32 v202, v204, v205
 v_mfma_f32_16x16x32_bf16 v[228:231], a[60:63], a[124:127], v[228:231]
 ds_read_b64_tr_b16 a[76:77], v8 offset:16384
 v_cvt_pk_bf16_f32 v203, v206, v207
 v_mfma_f32_16x16x32_bf16 v[236:239], a[60:63], a[116:119], v[236:239]
 ds_read_b64_tr_b16 a[78:79], v8 offset:20480
 v_xor_b32 v9, 32, v6
 v_mfma_f32_16x16x32_bf16 v[236:239], a[56:59], a[112:115], v[236:239]
 ds_read_b64_tr_b16 a[80:81], v9 offset:0
 v_cvt_pk_bf16_f32 v208, v208, v209
 v_mfma_f32_16x16x32_bf16 v[244:247], a[56:59], a[104:107], v[244:247]
 ds_read_b64_tr_b16 a[82:83], v9 offset:4096
 v_cvt_pk_bf16_f32 v209, v210, v211
 v_mfma_f32_16x16x32_bf16 v[244:247], a[60:63], a[108:111], v[244:247]
 ds_read_b64_tr_b16 a[84:85], v9 offset:16384
 v_cvt_pk_bf16_f32 v210, v212, v213
 v_mfma_f32_16x16x32_bf16 v[252:255], a[60:63], a[100:103], v[252:255]
 ds_read_b64_tr_b16 a[86:87], v9 offset:20480
 v_xor_b32 v10, 65568, v6
 v_mfma_f32_16x16x32_bf16 v[252:255], a[56:59], a[96:99], v[252:255]
 s_waitcnt lgkmcnt(6)
 ds_read_b64_tr_b16 a[88:89], v10 offset:0
 v_cvt_pk_bf16_f32 v211, v214, v215
 v_mfma_f32_16x16x32_bf16 v[28:31], a[64:67], a[128:131], 0
 ds_read_b64_tr_b16 a[90:91], v10 offset:4096
 v_cvt_pk_bf16_f32 v216, v216, v217
 v_mfma_f32_16x16x32_bf16 v[28:31], a[68:71], a[136:139], v[28:31]
 ds_read_b64_tr_b16 a[92:93], v10 offset:16384
 v_xor_b32 v7, 64, v6
 v_mfma_f32_16x16x32_bf16 v[28:31], a[72:75], a[144:147], v[28:31]
 s_waitcnt lgkmcnt(7)
 ds_read_b128 a[112:115], v14 offset:0
 ds_read_b64_tr_b16 a[94:95], v10 offset:20480
 v_mfma_f32_16x16x32_bf16 v[28:31], a[76:79], a[152:155], v[28:31]
 ds_read_b64_tr_b16 a[96:97], v7 offset:0
 v_cvt_pk_bf16_f32 v217, v218, v219
 v_mfma_f32_16x16x32_bf16 v[44:47], a[64:67], a[132:135], 0
 ds_read_b128 a[120:123], v3 offset:0
 ds_read_b64_tr_b16 a[98:99], v7 offset:4096
 v_mfma_f32_16x16x32_bf16 v[44:47], a[68:71], a[140:143], v[44:47]
 ds_read_b64_tr_b16 a[100:101], v7 offset:16384
 v_xor_b32 v8, 65600, v6
 v_mfma_f32_16x16x32_bf16 v[44:47], a[72:75], a[148:151], v[44:47]
 ds_read_b128 a[116:119], v14 offset:2048
 ds_read_b64_tr_b16 a[102:103], v7 offset:20480
 v_mfma_f32_16x16x32_bf16 v[44:47], a[76:79], a[156:159], v[44:47]
 s_waitcnt lgkmcnt(9)
 ds_read_b64_tr_b16 a[104:105], v8 offset:0
 v_cvt_pk_bf16_f32 v218, v220, v221
 v_mfma_f32_16x16x32_bf16 v[52:55], a[80:83], a[128:131], 0
 ds_read_b128 a[124:127], v3 offset:2048
 ds_read_b64_tr_b16 a[106:107], v8 offset:4096
 v_mfma_f32_16x16x32_bf16 v[52:55], a[84:87], a[136:139], v[52:55]
 ds_read_b64_tr_b16 a[108:109], v8 offset:16384
 v_cvt_pk_bf16_f32 v219, v222, v223
 v_mfma_f32_16x16x32_bf16 v[52:55], a[88:91], a[144:147], v[52:55]
 s_waitcnt lgkmcnt(10)
 ds_read_b64_tr_b16 a[110:111], v8 offset:20480
 v_xor_b32 v9, 96, v6
 v_mfma_f32_16x16x32_bf16 v[52:55], a[92:95], a[152:155], v[52:55]
 ds_read_b64_tr_b16 a[64:65], v9 offset:0
 v_cvt_pk_bf16_f32 v224, v224, v225
 v_mfma_f32_16x16x32_bf16 v[60:63], a[80:83], a[132:135], 0
 ds_read_b64_tr_b16 a[66:67], v9 offset:4096
 v_cvt_pk_bf16_f32 v225, v226, v227
 v_mfma_f32_16x16x32_bf16 v[60:63], a[84:87], a[140:143], v[60:63]
 ds_read_b64_tr_b16 a[68:69], v9 offset:16384
 v_cvt_pk_bf16_f32 v226, v228, v229
 v_mfma_f32_16x16x32_bf16 v[60:63], a[88:91], a[148:151], v[60:63]
 ds_read_b64_tr_b16 a[70:71], v9 offset:20480
 v_xor_b32 v10, 65632, v6
 v_mfma_f32_16x16x32_bf16 v[60:63], a[92:95], a[156:159], v[60:63]
 s_waitcnt lgkmcnt(6)
 ds_read_b64_tr_b16 a[72:73], v10 offset:0
 v_cvt_pk_bf16_f32 v227, v230, v231
 v_mfma_f32_16x16x32_bf16 v[20:23], a[96:99], a[128:131], 0
 ds_read_b64_tr_b16 a[74:75], v10 offset:4096
 v_cvt_pk_bf16_f32 v232, v232, v233
 v_mfma_f32_16x16x32_bf16 v[20:23], a[100:103], a[136:139], v[20:23]
 s_waitcnt lgkmcnt(8)
 ds_read_b64_tr_b16 a[76:77], v10 offset:16384
 v_xor_b32 v7, 128, v6
 v_mfma_f32_16x16x32_bf16 v[20:23], a[104:107], a[144:147], v[20:23]
 s_waitcnt lgkmcnt(7)
 s_barrier
 ds_read_b64_tr_b16 a[78:79], v10 offset:20480
 v_mfma_f32_16x16x32_bf16 v[20:23], a[108:111], a[152:155], v[20:23]
 s_add_u32 m0, s29, 131072
 ds_read_b64_tr_b16 a[80:81], v7 offset:0
 v_add_u32 v2, 0x80000, v2
 v_mfma_f32_16x16x32_bf16 v[36:39], a[96:99], a[132:135], 0
 ds_read_b64_tr_b16 a[82:83], v7 offset:4096
 buffer_load_dwordx4 v2, s[16:19], 0 offen lds
 v_mfma_f32_16x16x32_bf16 v[36:39], a[100:103], a[140:143], v[36:39]
 ds_read_b64_tr_b16 a[84:85], v7 offset:16384
 v_cvt_pk_bf16_f32 v233, v234, v235
 v_mfma_f32_16x16x32_bf16 v[36:39], a[104:107], a[148:151], v[36:39]
 ds_read_b64_tr_b16 a[86:87], v7 offset:20480
 v_xor_b32 v8, 65664, v6
 v_mfma_f32_16x16x32_bf16 v[36:39], a[108:111], a[156:159], v[36:39]
 s_waitcnt lgkmcnt(6)
 ds_read_b64_tr_b16 a[88:89], v8 offset:0
 v_cvt_pk_bf16_f32 v234, v236, v237
 v_mfma_f32_16x16x32_bf16 v[68:71], a[64:67], a[128:131], 0
 ds_read_b64_tr_b16 a[90:91], v8 offset:4096
 v_cvt_pk_bf16_f32 v235, v238, v239
 v_mfma_f32_16x16x32_bf16 v[68:71], a[68:71], a[136:139], v[68:71]
 s_add_u32 m0, s29, 135168
 ds_read_b64_tr_b16 a[92:93], v8 offset:16384
 v_cvt_pk_bf16_f32 v240, v240, v241
 v_mfma_f32_16x16x32_bf16 v[68:71], a[72:75], a[144:147], v[68:71]
 s_waitcnt lgkmcnt(7)
 ds_read_b64_tr_b16 a[94:95], v8 offset:20480
 v_xor_b32 v9, 160, v6
 v_mfma_f32_16x16x32_bf16 v[68:71], a[76:79], a[152:155], v[68:71]
 ds_read_b64_tr_b16 a[96:97], v9 offset:0
 buffer_load_dwordx4 v2, s[16:19], s48 offen lds
 v_mfma_f32_16x16x32_bf16 v[76:79], a[64:67], a[132:135], 0
 ds_read_b64_tr_b16 a[98:99], v9 offset:4096
 v_cvt_pk_bf16_f32 v241, v242, v243
 v_mfma_f32_16x16x32_bf16 v[76:79], a[68:71], a[140:143], v[76:79]
 ds_read_b64_tr_b16 a[100:101], v9 offset:16384
 v_cvt_pk_bf16_f32 v242, v244, v245
 v_mfma_f32_16x16x32_bf16 v[76:79], a[72:75], a[148:151], v[76:79]
 ds_read_b64_tr_b16 a[102:103], v9 offset:20480
 v_xor_b32 v10, 65696, v6
 v_mfma_f32_16x16x32_bf16 v[76:79], a[76:79], a[156:159], v[76:79]
 s_waitcnt lgkmcnt(6)
 ds_read_b64_tr_b16 a[104:105], v10 offset:0
 v_cvt_pk_bf16_f32 v243, v246, v247
 v_mfma_f32_16x16x32_bf16 v[84:87], a[80:83], a[128:131], 0
 s_add_u32 m0, s29, 139264
 ds_read_b64_tr_b16 a[106:107], v10 offset:4096
 v_cvt_pk_bf16_f32 v248, v248, v249
 v_mfma_f32_16x16x32_bf16 v[84:87], a[84:87], a[136:139], v[84:87]
 ds_read_b64_tr_b16 a[108:109], v10 offset:16384
 buffer_load_dwordx4 v2, s[16:19], s49 offen lds
 v_mfma_f32_16x16x32_bf16 v[84:87], a[88:91], a[144:147], v[84:87]
 s_waitcnt lgkmcnt(7)
 ds_read_b64_tr_b16 a[110:111], v10 offset:20480
 v_xor_b32 v7, 192, v6
 v_mfma_f32_16x16x32_bf16 v[84:87], a[92:95], a[152:155], v[84:87]
 ds_read_b64_tr_b16 a[64:65], v7 offset:0
 v_cvt_pk_bf16_f32 v249, v250, v251
 v_mfma_f32_16x16x32_bf16 v[92:95], a[80:83], a[132:135], 0
 ds_read_b64_tr_b16 a[66:67], v7 offset:4096
 v_cvt_pk_bf16_f32 v250, v252, v253
 v_mfma_f32_16x16x32_bf16 v[92:95], a[84:87], a[140:143], v[92:95]
 ds_read_b64_tr_b16 a[68:69], v7 offset:16384
 v_cvt_pk_bf16_f32 v251, v254, v255
 v_mfma_f32_16x16x32_bf16 v[92:95], a[88:91], a[148:151], v[92:95]
 s_add_u32 m0, s29, 143360
 ds_read_b64_tr_b16 a[70:71], v7 offset:20480
 v_xor_b32 v8, 65728, v6
 v_mfma_f32_16x16x32_bf16 v[92:95], a[92:95], a[156:159], v[92:95]
 s_waitcnt lgkmcnt(6)
 ds_read_b64_tr_b16 a[72:73], v8 offset:0
 buffer_load_dwordx4 v2, s[16:19], s50 offen lds
 v_mfma_f32_16x16x32_bf16 v[100:103], a[96:99], a[128:131], 0
 ds_read_b64_tr_b16 a[74:75], v8 offset:4096
 v_mov_b32 v12, 0
 v_mfma_f32_16x16x32_bf16 v[100:103], a[100:103], a[136:139], v[100:103]
 ds_read_b64_tr_b16 a[76:77], v8 offset:16384
 global_load_dword v5, v12, s[90:91] offset:128 sc1
 v_mfma_f32_16x16x32_bf16 v[100:103], a[104:107], a[144:147], v[100:103]
 s_waitcnt lgkmcnt(7)
 ds_read_b64_tr_b16 a[78:79], v8 offset:20480
 v_xor_b32 v9, 224, v6
 v_mfma_f32_16x16x32_bf16 v[100:103], a[108:111], a[152:155], v[100:103]
 s_and_b32 s36, s95, 31
 ds_read_b64_tr_b16 a[80:81], v9 offset:0
 v_and_b32 v12, 11, v0
 v_mfma_f32_16x16x32_bf16 v[108:111], a[96:99], a[132:135], 0
 s_add_u32 m0, s29, 147456
 ds_read_b64_tr_b16 a[82:83], v9 offset:4096
 v_lshlrev_b32 v12, 2, v12
 v_mfma_f32_16x16x32_bf16 v[108:111], a[100:103], a[140:143], v[108:111]
 ds_read_b64_tr_b16 a[84:85], v9 offset:16384
 buffer_load_dwordx4 v2, s[16:19], s51 offen lds
 v_mfma_f32_16x16x32_bf16 v[108:111], a[104:107], a[148:151], v[108:111]
 s_lshr_b32 s37, s95, 5
 ds_read_b64_tr_b16 a[86:87], v9 offset:20480
 v_xor_b32 v10, 65760, v6
 v_mfma_f32_16x16x32_bf16 v[108:111], a[108:111], a[156:159], v[108:111]
 s_waitcnt lgkmcnt(6)
 ds_read_b64_tr_b16 a[88:89], v10 offset:0
 v_and_b32 v14, 15, v0
 v_mfma_f32_16x16x32_bf16 v[116:119], a[64:67], a[128:131], 0
 s_lshl_b32 s38, s3, 4
 ds_read_b64_tr_b16 a[90:91], v10 offset:4096
 v_lshrrev_b32 v3, 4, v0
 v_mfma_f32_16x16x32_bf16 v[116:119], a[68:71], a[136:139], v[116:119]
 s_add_u32 m0, s29, 151552
 ds_read_b64_tr_b16 a[92:93], v10 offset:16384
 v_lshlrev_b32 v3, 2, v3
 v_mfma_f32_16x16x32_bf16 v[116:119], a[72:75], a[144:147], v[116:119]
 s_waitcnt lgkmcnt(7)
 ds_read_b64_tr_b16 a[94:95], v10 offset:20480
 v_xor_b32 v7, 256, v6
 v_mfma_f32_16x16x32_bf16 v[116:119], a[76:79], a[152:155], v[116:119]
 ds_read_b64_tr_b16 a[96:97], v7 offset:0
 buffer_load_dwordx4 v2, s[16:19], s52 offen lds
 v_mfma_f32_16x16x32_bf16 v[124:127], a[64:67], a[132:135], 0
 s_lshl_b32 s39, s36, 6
 ds_read_b64_tr_b16 a[98:99], v7 offset:4096
 v_sub_u32 v14, v14, v3
 v_mfma_f32_16x16x32_bf16 v[124:127], a[68:71], a[140:143], v[124:127]
 s_add_u32 s38, s38, s39
 ds_read_b64_tr_b16 a[100:101], v7 offset:16384
 v_lshrrev_b32_e64 v3, 6, s29
 v_mfma_f32_16x16x32_bf16 v[124:127], a[72:75], a[148:151], v[124:127]
 s_mul_i32 s38, s38, 896
 ds_read_b64_tr_b16 a[102:103], v7 offset:20480
 v_xor_b32 v8, 65792, v6
 v_mfma_f32_16x16x32_bf16 v[124:127], a[76:79], a[156:159], v[124:127]
 s_waitcnt lgkmcnt(6)
 ds_read_b64_tr_b16 a[104:105], v8 offset:0
 v_add_u32 v14, v3, v14
 v_mfma_f32_16x16x32_bf16 v[132:135], a[80:83], a[128:131], 0
 s_add_u32 m0, s29, 155648
 ds_read_b64_tr_b16 a[106:107], v8 offset:4096
 v_mov_b32 v15, 0xf149f2ca
 v_mfma_f32_16x16x32_bf16 v[132:135], a[84:87], a[136:139], v[132:135]
 ds_read_b64_tr_b16 a[108:109], v8 offset:16384
 buffer_load_dwordx4 v2, s[16:19], s53 offen lds
 v_mfma_f32_16x16x32_bf16 v[132:135], a[88:91], a[144:147], v[132:135]
 s_waitcnt lgkmcnt(7)
 ds_read_b64_tr_b16 a[110:111], v8 offset:20480
 v_xor_b32 v9, 288, v6
 v_mfma_f32_16x16x32_bf16 v[132:135], a[92:95], a[152:155], v[132:135]
 s_lshl_b32 s39, s37, 7
 ds_read_b64_tr_b16 a[64:65], v9 offset:0
 v_cmp_gt_i32 vcc, 0, v14
 v_mfma_f32_16x16x32_bf16 v[140:143], a[80:83], a[132:135], 0
 s_add_u32 s38, s38, s39
 ds_read_b64_tr_b16 a[66:67], v9 offset:4096
 v_cndmask_b32 v3, 0, v15, vcc
 v_mfma_f32_16x16x32_bf16 v[140:143], a[84:87], a[140:143], v[140:143]
 s_lshl_b32 s39, s37, 9
 ds_read_b64_tr_b16 a[68:69], v9 offset:16384
 v_accvgpr_write_b32 a224, v3
 v_mfma_f32_16x16x32_bf16 v[140:143], a[88:91], a[148:151], v[140:143]
 s_add_u32 m0, s29, 159744
 ds_read_b64_tr_b16 a[70:71], v9 offset:20480
 v_xor_b32 v10, 65824, v6
 v_mfma_f32_16x16x32_bf16 v[140:143], a[92:95], a[156:159], v[140:143]
 s_waitcnt lgkmcnt(6)
 ds_read_b64_tr_b16 a[72:73], v10 offset:0
 buffer_load_dwordx4 v2, s[16:19], s54 offen lds
 v_mfma_f32_16x16x32_bf16 v[148:151], a[96:99], a[128:131], 0
 s_mov_b32 s4, s66
 ds_read_b64_tr_b16 a[74:75], v10 offset:4096
 v_cmp_gt_i32 vcc, 1, v14
 v_mfma_f32_16x16x32_bf16 v[148:151], a[100:103], a[136:139], v[148:151]
 s_mov_b32 s5, s67
 ds_read_b64_tr_b16 a[76:77], v10 offset:16384
 v_cndmask_b32 v3, 0, v15, vcc
 v_mfma_f32_16x16x32_bf16 v[148:151], a[104:107], a[144:147], v[148:151]
 s_waitcnt lgkmcnt(7)
 ds_read_b64_tr_b16 a[78:79], v10 offset:20480
 v_xor_b32 v7, 320, v6
 v_mfma_f32_16x16x32_bf16 v[148:151], a[108:111], a[152:155], v[148:151]
 s_mov_b32 s6, 1835008
 ds_read_b64_tr_b16 a[80:81], v7 offset:0
 v_accvgpr_write_b32 a225, v3
 v_mfma_f32_16x16x32_bf16 v[156:159], a[96:99], a[132:135], 0
 s_mov_b32 s7, 0x20000
 ds_read_b64_tr_b16 a[82:83], v7 offset:4096
 v_cmp_gt_i32 vcc, 2, v14
 v_mfma_f32_16x16x32_bf16 v[156:159], a[100:103], a[140:143], v[156:159]
 s_mov_b32 s8, s68
 ds_read_b64_tr_b16 a[84:85], v7 offset:16384
 v_cndmask_b32 v3, 0, v15, vcc
 v_mfma_f32_16x16x32_bf16 v[156:159], a[104:107], a[148:151], v[156:159]
 s_mov_b32 s9, s69
 ds_read_b64_tr_b16 a[86:87], v7 offset:20480
 v_xor_b32 v8, 65856, v6
 v_mfma_f32_16x16x32_bf16 v[156:159], a[108:111], a[156:159], v[156:159]
 s_waitcnt lgkmcnt(6)
 ds_read_b64_tr_b16 a[88:89], v8 offset:0
 v_accvgpr_write_b32 a226, v3
 v_mfma_f32_16x16x32_bf16 v[164:167], a[64:67], a[128:131], 0
 s_mov_b32 s10, 1835008
 ds_read_b64_tr_b16 a[90:91], v8 offset:4096
 v_cmp_gt_i32 vcc, 3, v14
 v_mfma_f32_16x16x32_bf16 v[164:167], a[68:71], a[136:139], v[164:167]
 s_mov_b32 s11, 0x20000
 ds_read_b64_tr_b16 a[92:93], v8 offset:16384
 v_cndmask_b32 v3, 0, v15, vcc
 v_mfma_f32_16x16x32_bf16 v[164:167], a[72:75], a[144:147], v[164:167]
 s_waitcnt lgkmcnt(7)
 ds_read_b64_tr_b16 a[94:95], v8 offset:20480
 v_xor_b32 v9, 352, v6
 v_mfma_f32_16x16x32_bf16 v[164:167], a[76:79], a[152:155], v[164:167]
 s_mov_b32 s20, s70
 ds_read_b64_tr_b16 a[96:97], v9 offset:0
 v_accvgpr_write_b32 a227, v3
 v_mfma_f32_16x16x32_bf16 v[172:175], a[64:67], a[132:135], 0
 s_mov_b32 s21, s71
 ds_read_b64_tr_b16 a[98:99], v9 offset:4096
 v_cmp_gt_i32 vcc, 16, v14
 v_mfma_f32_16x16x32_bf16 v[172:175], a[68:71], a[140:143], v[172:175]
 s_mov_b32 s22, 3584
 ds_read_b64_tr_b16 a[100:101], v9 offset:16384
 v_cndmask_b32 v3, 0, v15, vcc
 v_mfma_f32_16x16x32_bf16 v[172:175], a[72:75], a[148:151], v[172:175]
 s_mov_b32 s23, 0x20000
 ds_read_b64_tr_b16 a[102:103], v9 offset:20480
 v_xor_b32 v10, 65888, v6
 v_mfma_f32_16x16x32_bf16 v[172:175], a[76:79], a[156:159], v[172:175]
 s_waitcnt lgkmcnt(6)
 ds_read_b64_tr_b16 a[104:105], v10 offset:0
 v_accvgpr_write_b32 a228, v3
 v_mfma_f32_16x16x32_bf16 v[180:183], a[80:83], a[128:131], 0
 ds_read_b64_tr_b16 a[106:107], v10 offset:4096
 v_cmp_gt_i32 vcc, 17, v14
 v_mfma_f32_16x16x32_bf16 v[180:183], a[84:87], a[136:139], v[180:183]
 ds_read_b64_tr_b16 a[108:109], v10 offset:16384
 v_cndmask_b32 v3, 0, v15, vcc
 v_mfma_f32_16x16x32_bf16 v[180:183], a[88:91], a[144:147], v[180:183]
 s_waitcnt lgkmcnt(7)
 ds_read_b64_tr_b16 a[110:111], v10 offset:20480
 v_xor_b32 v7, 384, v6
 v_mfma_f32_16x16x32_bf16 v[180:183], a[92:95], a[152:155], v[180:183]
 ds_read_b64_tr_b16 a[64:65], v7 offset:0
 v_accvgpr_write_b32 a229, v3
 v_mfma_f32_16x16x32_bf16 v[188:191], a[80:83], a[132:135], 0
 ds_read_b64_tr_b16 a[66:67], v7 offset:4096
 v_cmp_gt_i32 vcc, 18, v14
 v_mfma_f32_16x16x32_bf16 v[188:191], a[84:87], a[140:143], v[188:191]
 ds_read_b64_tr_b16 a[68:69], v7 offset:16384
 v_cndmask_b32 v3, 0, v15, vcc
 v_mfma_f32_16x16x32_bf16 v[188:191], a[88:91], a[148:151], v[188:191]
 ds_read_b64_tr_b16 a[70:71], v7 offset:20480
 v_xor_b32 v8, 65920, v6
 v_mfma_f32_16x16x32_bf16 v[188:191], a[92:95], a[156:159], v[188:191]
 s_waitcnt lgkmcnt(6)
 ds_read_b64_tr_b16 a[72:73], v8 offset:0
 v_accvgpr_write_b32 a230, v3
 v_mfma_f32_16x16x32_bf16 v[196:199], a[96:99], a[128:131], 0
 ds_read_b64_tr_b16 a[74:75], v8 offset:4096
 v_cmp_gt_i32 vcc, 19, v14
 v_mfma_f32_16x16x32_bf16 v[196:199], a[100:103], a[136:139], v[196:199]
 ds_read_b64_tr_b16 a[76:77], v8 offset:16384
 v_cndmask_b32 v3, 0, v15, vcc
 v_mfma_f32_16x16x32_bf16 v[196:199], a[104:107], a[144:147], v[196:199]
 s_waitcnt lgkmcnt(7)
 ds_read_b64_tr_b16 a[78:79], v8 offset:20480
 v_xor_b32 v9, 416, v6
 v_mfma_f32_16x16x32_bf16 v[196:199], a[108:111], a[152:155], v[196:199]
 ds_read_b64_tr_b16 a[80:81], v9 offset:0
 v_accvgpr_write_b32 a231, v3
 v_mfma_f32_16x16x32_bf16 v[204:207], a[96:99], a[132:135], 0
 ds_read_b64_tr_b16 a[82:83], v9 offset:4096
 v_cmp_gt_i32 vcc, 32, v14
 v_mfma_f32_16x16x32_bf16 v[204:207], a[100:103], a[140:143], v[204:207]
 ds_read_b64_tr_b16 a[84:85], v9 offset:16384
 v_cndmask_b32 v3, 0, v15, vcc
 v_mfma_f32_16x16x32_bf16 v[204:207], a[104:107], a[148:151], v[204:207]
 ds_read_b64_tr_b16 a[86:87], v9 offset:20480
 v_xor_b32 v10, 65952, v6
 v_mfma_f32_16x16x32_bf16 v[204:207], a[108:111], a[156:159], v[204:207]
 s_waitcnt lgkmcnt(6)
 ds_read_b64_tr_b16 a[88:89], v10 offset:0
 v_accvgpr_write_b32 a232, v3
 v_mfma_f32_16x16x32_bf16 v[212:215], a[64:67], a[128:131], 0
 ds_read_b64_tr_b16 a[90:91], v10 offset:4096
 v_cmp_gt_i32 vcc, 33, v14
 v_mfma_f32_16x16x32_bf16 v[212:215], a[68:71], a[136:139], v[212:215]
 ds_read_b64_tr_b16 a[92:93], v10 offset:16384
 v_cndmask_b32 v3, 0, v15, vcc
 v_mfma_f32_16x16x32_bf16 v[212:215], a[72:75], a[144:147], v[212:215]
 s_waitcnt lgkmcnt(7)
 ds_read_b64_tr_b16 a[94:95], v10 offset:20480
 v_xor_b32 v7, 448, v6
 v_mfma_f32_16x16x32_bf16 v[212:215], a[76:79], a[152:155], v[212:215]
 s_add_u32 s59, s56, 57344
 ds_read_b64_tr_b16 a[96:97], v7 offset:0
 v_accvgpr_write_b32 a233, v3
 v_mfma_f32_16x16x32_bf16 v[220:223], a[64:67], a[132:135], 0
 ds_read_b64_tr_b16 a[98:99], v7 offset:4096
 buffer_store_dwordx4 v[32:35], v1, s[12:15], s59 offen offset:1024 sc1
 v_mfma_f32_16x16x32_bf16 v[220:223], a[68:71], a[140:143], v[220:223]
 ds_read_b64_tr_b16 a[100:101], v7 offset:16384
 v_cmp_gt_i32 vcc, 34, v14
 v_mfma_f32_16x16x32_bf16 v[220:223], a[72:75], a[148:151], v[220:223]
 ds_read_b64_tr_b16 a[102:103], v7 offset:20480
 v_xor_b32 v8, 65984, v6
 v_mfma_f32_16x16x32_bf16 v[220:223], a[76:79], a[156:159], v[220:223]
 s_waitcnt lgkmcnt(6)
 ds_read_b64_tr_b16 a[104:105], v8 offset:0
 v_cndmask_b32 v3, 0, v15, vcc
 v_mfma_f32_16x16x32_bf16 v[228:231], a[80:83], a[128:131], 0
 ds_read_b64_tr_b16 a[106:107], v8 offset:4096
 v_accvgpr_write_b32 a234, v3
 v_mfma_f32_16x16x32_bf16 v[228:231], a[84:87], a[136:139], v[228:231]
 ds_read_b64_tr_b16 a[108:109], v8 offset:16384
 v_cmp_gt_i32 vcc, 35, v14
 v_mfma_f32_16x16x32_bf16 v[228:231], a[88:91], a[144:147], v[228:231]
 s_waitcnt lgkmcnt(7)
 ds_read_b64_tr_b16 a[110:111], v8 offset:20480
 v_xor_b32 v9, 480, v6
 v_mfma_f32_16x16x32_bf16 v[228:231], a[92:95], a[152:155], v[228:231]
 ds_read_b64_tr_b16 a[64:65], v9 offset:0
 v_cndmask_b32 v3, 0, v15, vcc
 v_mfma_f32_16x16x32_bf16 v[236:239], a[80:83], a[132:135], 0
 ds_read_b64_tr_b16 a[66:67], v9 offset:4096
 v_accvgpr_write_b32 a235, v3
 v_mfma_f32_16x16x32_bf16 v[236:239], a[84:87], a[140:143], v[236:239]
 ds_read_b64_tr_b16 a[68:69], v9 offset:16384
 v_cmp_gt_i32 vcc, 48, v14
 v_mfma_f32_16x16x32_bf16 v[236:239], a[88:91], a[148:151], v[236:239]
 s_add_u32 s59, s56, 49152
 ds_read_b64_tr_b16 a[70:71], v9 offset:20480
 v_xor_b32 v10, 66016, v6
 v_mfma_f32_16x16x32_bf16 v[236:239], a[92:95], a[156:159], v[236:239]
 s_waitcnt lgkmcnt(6)
 ds_read_b64_tr_b16 a[72:73], v10 offset:0
 buffer_store_dwordx4 v[40:43], v1, s[12:15], s59 offen offset:1024 sc1
 v_mfma_f32_16x16x32_bf16 v[244:247], a[96:99], a[128:131], 0
 ds_read_b64_tr_b16 a[74:75], v10 offset:4096
 v_cndmask_b32 v3, 0, v15, vcc
 v_mfma_f32_16x16x32_bf16 v[244:247], a[100:103], a[136:139], v[244:247]
 s_waitcnt vmcnt(11)
 ds_read_b64_tr_b16 a[76:77], v10 offset:16384
 v_xor_b32 v7, 32768, v6
 v_mfma_f32_16x16x32_bf16 v[244:247], a[104:107], a[144:147], v[244:247]
 s_waitcnt lgkmcnt(7)
 s_barrier
 ds_read_b64_tr_b16 a[78:79], v10 offset:20480
 v_mfma_f32_16x16x32_bf16 v[244:247], a[108:111], a[152:155], v[244:247]
 ds_read_b64_tr_b16 a[80:81], v7 offset:0
 v_accvgpr_write_b32 a236, v3
 v_mfma_f32_16x16x32_bf16 v[252:255], a[96:99], a[132:135], 0
 ds_read_b64_tr_b16 a[82:83], v7 offset:4096
 v_cmp_gt_i32 vcc, 49, v14
 v_mfma_f32_16x16x32_bf16 v[252:255], a[100:103], a[140:143], v[252:255]
 ds_read_b64_tr_b16 a[84:85], v7 offset:16384
 v_cndmask_b32 v3, 0, v15, vcc
 v_mfma_f32_16x16x32_bf16 v[252:255], a[104:107], a[148:151], v[252:255]
 ds_read_b64_tr_b16 a[86:87], v7 offset:20480
 v_xor_b32 v8, 98304, v6
 v_mfma_f32_16x16x32_bf16 v[252:255], a[108:111], a[156:159], v[252:255]
 s_waitcnt lgkmcnt(6)
 ds_read_b64_tr_b16 a[88:89], v8 offset:0
 v_accvgpr_write_b32 a237, v3
 v_mfma_f32_16x16x32_bf16 v[16:19], a[64:67], a[128:131], 0
 s_add_u32 s59, s56, 40960
 ds_read_b64_tr_b16 a[90:91], v8 offset:4096
 v_cmp_gt_i32 vcc, 50, v14
 v_mfma_f32_16x16x32_bf16 v[16:19], a[68:71], a[136:139], v[16:19]
 ds_read_b64_tr_b16 a[92:93], v8 offset:16384
 buffer_store_dwordx4 v[48:51], v1, s[12:15], s59 offen offset:1024 sc1
 v_mfma_f32_16x16x32_bf16 v[16:19], a[72:75], a[144:147], v[16:19]
 s_waitcnt lgkmcnt(7)
 ds_read_b64_tr_b16 a[94:95], v8 offset:20480
 v_xor_b32 v9, 32800, v6
 v_mfma_f32_16x16x32_bf16 v[16:19], a[76:79], a[152:155], v[16:19]
 ds_read_b64_tr_b16 a[96:97], v9 offset:0
 v_cndmask_b32 v3, 0, v15, vcc
 v_mfma_f32_16x16x32_bf16 v[24:27], a[64:67], a[132:135], 0
 s_waitcnt lgkmcnt(9)
 ds_read_b64_tr_b16 a[98:99], v9 offset:4096
 v_accvgpr_write_b32 a238, v3
 v_mfma_f32_16x16x32_bf16 v[24:27], a[68:71], a[140:143], v[24:27]
 s_barrier
 ds_read_b64_tr_b16 a[100:101], v9 offset:16384
 v_cmp_gt_i32 vcc, 51, v14
 v_mfma_f32_16x16x32_bf16 v[24:27], a[72:75], a[148:151], v[24:27]
 s_add_u32 m0, s29, 0
 ds_read_b64_tr_b16 a[102:103], v9 offset:20480
 v_xor_b32 v10, 98336, v6
 v_mfma_f32_16x16x32_bf16 v[24:27], a[76:79], a[156:159], v[24:27]
 s_waitcnt lgkmcnt(6)
 ds_read_b64_tr_b16 a[104:105], v10 offset:0
 v_add_u32 v2, 0x80000, v2
 v_mfma_f32_16x16x32_bf16 v[28:31], a[80:83], a[160:163], v[28:31]
 ds_read_b64_tr_b16 a[106:107], v10 offset:4096
 buffer_load_dwordx4 v2, s[16:19], 0 offen lds
 v_mfma_f32_16x16x32_bf16 v[28:31], a[84:87], a[168:171], v[28:31]
 s_add_u32 s59, s56, 32768
 ds_read_b64_tr_b16 a[108:109], v10 offset:16384
 v_cndmask_b32 v3, 0, v15, vcc
 v_mfma_f32_16x16x32_bf16 v[28:31], a[88:91], a[176:179], v[28:31]
 s_waitcnt lgkmcnt(7)
 ds_read_b64_tr_b16 a[110:111], v10 offset:20480
 v_xor_b32 v7, 32832, v6
 v_mfma_f32_16x16x32_bf16 v[28:31], a[92:95], a[184:187], v[28:31]
 ds_read_b64_tr_b16 a[64:65], v7 offset:0
 buffer_store_dwordx4 v[56:59], v1, s[12:15], s59 offen offset:1024 sc1
 v_mfma_f32_16x16x32_bf16 v[44:47], a[80:83], a[164:167], v[44:47]
 s_add_u32 m0, s29, 4096
 ds_read_b64_tr_b16 a[66:67], v7 offset:4096
 v_add_u32 v4, 4096, v1
 v_mfma_f32_16x16x32_bf16 v[44:47], a[84:87], a[172:175], v[44:47]
 ds_read_b64_tr_b16 a[68:69], v7 offset:16384
 buffer_load_dwordx4 v2, s[16:19], s48 offen lds
 v_mfma_f32_16x16x32_bf16 v[44:47], a[88:91], a[180:183], v[44:47]
 ds_read_b64_tr_b16 a[70:71], v7 offset:20480
 v_xor_b32 v8, 98368, v6
 v_mfma_f32_16x16x32_bf16 v[44:47], a[92:95], a[188:191], v[44:47]
 s_waitcnt lgkmcnt(6)
 ds_read_b64_tr_b16 a[72:73], v8 offset:0
 v_accvgpr_write_b32 a239, v3
 v_mfma_f32_16x16x32_bf16 v[52:55], a[96:99], a[160:163], v[52:55]
 ds_read_b64_tr_b16 a[74:75], v8 offset:4096
 v_mfma_f32_16x16x32_bf16 v[52:55], a[100:103], a[168:171], v[52:55]
 s_add_u32 m0, s29, 8192
 ds_read_b64_tr_b16 a[76:77], v8 offset:16384
 v_mfma_f32_16x16x32_bf16 v[52:55], a[104:107], a[176:179], v[52:55]
 s_waitcnt lgkmcnt(7)
 ds_read_b64_tr_b16 a[78:79], v8 offset:20480
 v_xor_b32 v9, 32864, v6
 v_mfma_f32_16x16x32_bf16 v[52:55], a[108:111], a[184:187], v[52:55]
 ds_read_b64_tr_b16 a[80:81], v9 offset:0
 buffer_load_dwordx4 v2, s[16:19], s49 offen lds
 v_mfma_f32_16x16x32_bf16 v[60:63], a[96:99], a[164:167], v[60:63]
 s_add_u32 s59, s56, 24576
 ds_read_b64_tr_b16 a[82:83], v9 offset:4096
 v_mfma_f32_16x16x32_bf16 v[60:63], a[100:103], a[172:175], v[60:63]
 ds_read_b64_tr_b16 a[84:85], v9 offset:16384
 buffer_store_dwordx4 v[64:67], v1, s[12:15], s59 offen offset:0 sc1
 v_mfma_f32_16x16x32_bf16 v[60:63], a[104:107], a[180:183], v[60:63]
 s_add_u32 m0, s29, 12288
 ds_read_b64_tr_b16 a[86:87], v9 offset:20480
 v_xor_b32 v10, 98400, v6
 v_mfma_f32_16x16x32_bf16 v[60:63], a[108:111], a[188:191], v[60:63]
 s_waitcnt lgkmcnt(6)
 ds_read_b64_tr_b16 a[88:89], v10 offset:0
 v_mfma_f32_16x16x32_bf16 v[20:23], a[64:67], a[160:163], v[20:23]
 ds_read_b64_tr_b16 a[90:91], v10 offset:4096
 buffer_load_dwordx4 v2, s[16:19], s50 offen lds
 v_mfma_f32_16x16x32_bf16 v[20:23], a[68:71], a[168:171], v[20:23]
 ds_read_b64_tr_b16 a[92:93], v10 offset:16384
 v_mfma_f32_16x16x32_bf16 v[20:23], a[72:75], a[176:179], v[20:23]
 s_waitcnt lgkmcnt(7)
 ds_read_b64_tr_b16 a[94:95], v10 offset:20480
 v_xor_b32 v7, 32896, v6
 v_mfma_f32_16x16x32_bf16 v[20:23], a[76:79], a[184:187], v[20:23]
 ds_read_b64_tr_b16 a[96:97], v7 offset:0
 v_mfma_f32_16x16x32_bf16 v[36:39], a[64:67], a[164:167], v[36:39]
 s_add_u32 m0, s29, 16384
 ds_read_b64_tr_b16 a[98:99], v7 offset:4096
 v_mfma_f32_16x16x32_bf16 v[36:39], a[68:71], a[172:175], v[36:39]
 ds_read_b64_tr_b16 a[100:101], v7 offset:16384
 buffer_load_dwordx4 v2, s[16:19], s51 offen lds
 v_mfma_f32_16x16x32_bf16 v[36:39], a[72:75], a[180:183], v[36:39]
 s_add_u32 s59, s56, 16384
 ds_read_b64_tr_b16 a[102:103], v7 offset:20480
 v_xor_b32 v8, 98432, v6
 v_mfma_f32_16x16x32_bf16 v[36:39], a[76:79], a[188:191], v[36:39]
 s_waitcnt lgkmcnt(6)
 ds_read_b64_tr_b16 a[104:105], v8 offset:0
 buffer_store_dwordx4 v[72:75], v1, s[12:15], s59 offen offset:0 sc1
 v_mfma_f32_16x16x32_bf16 v[68:71], a[80:83], a[160:163], v[68:71]
 ds_read_b64_tr_b16 a[106:107], v8 offset:4096
 v_mfma_f32_16x16x32_bf16 v[68:71], a[84:87], a[168:171], v[68:71]
 s_add_u32 m0, s29, 20480
 ds_read_b64_tr_b16 a[108:109], v8 offset:16384
 v_mfma_f32_16x16x32_bf16 v[68:71], a[88:91], a[176:179], v[68:71]
 s_waitcnt lgkmcnt(7)
 ds_read_b64_tr_b16 a[110:111], v8 offset:20480
 v_xor_b32 v9, 32928, v6
 v_mfma_f32_16x16x32_bf16 v[68:71], a[92:95], a[184:187], v[68:71]
 ds_read_b64_tr_b16 a[64:65], v9 offset:0
 buffer_load_dwordx4 v2, s[16:19], s52 offen lds
 v_mfma_f32_16x16x32_bf16 v[76:79], a[80:83], a[164:167], v[76:79]
 ds_read_b64_tr_b16 a[66:67], v9 offset:4096
 v_mfma_f32_16x16x32_bf16 v[76:79], a[84:87], a[172:175], v[76:79]
 ds_read_b64_tr_b16 a[68:69], v9 offset:16384
 v_mfma_f32_16x16x32_bf16 v[76:79], a[88:91], a[180:183], v[76:79]
 s_add_u32 m0, s29, 24576
 ds_read_b64_tr_b16 a[70:71], v9 offset:20480
 v_xor_b32 v10, 98464, v6
 v_mfma_f32_16x16x32_bf16 v[76:79], a[92:95], a[188:191], v[76:79]
 s_waitcnt lgkmcnt(6)
 ds_read_b64_tr_b16 a[72:73], v10 offset:0
 v_mfma_f32_16x16x32_bf16 v[84:87], a[96:99], a[160:163], v[84:87]
 ds_read_b64_tr_b16 a[74:75], v10 offset:4096
 buffer_load_dwordx4 v2, s[16:19], s53 offen lds
 v_mfma_f32_16x16x32_bf16 v[84:87], a[100:103], a[168:171], v[84:87]
 s_add_u32 s59, s56, 8192
 ds_read_b64_tr_b16 a[76:77], v10 offset:16384
 v_mfma_f32_16x16x32_bf16 v[84:87], a[104:107], a[176:179], v[84:87]
 s_waitcnt lgkmcnt(7)
 ds_read_b64_tr_b16 a[78:79], v10 offset:20480
 v_xor_b32 v7, 32960, v6
 v_mfma_f32_16x16x32_bf16 v[84:87], a[108:111], a[184:187], v[84:87]
 ds_read_b64_tr_b16 a[80:81], v7 offset:0
 buffer_store_dwordx4 v[80:83], v1, s[12:15], s59 offen offset:0 sc1
 v_mfma_f32_16x16x32_bf16 v[92:95], a[96:99], a[164:167], v[92:95]
 s_add_u32 m0, s29, 28672
 ds_read_b64_tr_b16 a[82:83], v7 offset:4096
 v_mfma_f32_16x16x32_bf16 v[92:95], a[100:103], a[172:175], v[92:95]
 ds_read_b64_tr_b16 a[84:85], v7 offset:16384
 buffer_load_dwordx4 v2, s[16:19], s54 offen lds
 v_mfma_f32_16x16x32_bf16 v[92:95], a[104:107], a[180:183], v[92:95]
 ds_read_b64_tr_b16 a[86:87], v7 offset:20480
 v_xor_b32 v8, 98496, v6
 v_mfma_f32_16x16x32_bf16 v[92:95], a[108:111], a[188:191], v[92:95]
 s_waitcnt lgkmcnt(6)
 ds_read_b64_tr_b16 a[88:89], v8 offset:0
 v_mfma_f32_16x16x32_bf16 v[100:103], a[64:67], a[160:163], v[100:103]
 s_add_u32 m0, s29, 65536
 ds_read_b64_tr_b16 a[90:91], v8 offset:4096
 v_add_u32 v2, 0x80000, v2
 v_mfma_f32_16x16x32_bf16 v[100:103], a[68:71], a[168:171], v[100:103]
 ds_read_b64_tr_b16 a[92:93], v8 offset:16384
 buffer_load_dwordx4 v2, s[16:19], 0 offen lds
 v_mfma_f32_16x16x32_bf16 v[100:103], a[72:75], a[176:179], v[100:103]
 s_waitcnt lgkmcnt(7)
 ds_read_b64_tr_b16 a[94:95], v8 offset:20480
 v_xor_b32 v9, 32992, v6
 v_mfma_f32_16x16x32_bf16 v[100:103], a[76:79], a[184:187], v[100:103]
 ds_read_b64_tr_b16 a[96:97], v9 offset:0
 v_mfma_f32_16x16x32_bf16 v[108:111], a[64:67], a[164:167], v[108:111]
 s_add_u32 s59, s56, 0
 ds_read_b64_tr_b16 a[98:99], v9 offset:4096
 v_mfma_f32_16x16x32_bf16 v[108:111], a[68:71], a[172:175], v[108:111]
 ds_read_b64_tr_b16 a[100:101], v9 offset:16384
 buffer_store_dwordx4 v[88:91], v1, s[12:15], s59 offen offset:0 sc1
 v_mfma_f32_16x16x32_bf16 v[108:111], a[72:75], a[180:183], v[108:111]
 s_add_u32 m0, s29, 69632
 ds_read_b64_tr_b16 a[102:103], v9 offset:20480
 v_xor_b32 v10, 98528, v6
 v_mfma_f32_16x16x32_bf16 v[108:111], a[76:79], a[188:191], v[108:111]
 s_waitcnt lgkmcnt(6)
 ds_read_b64_tr_b16 a[104:105], v10 offset:0
 buffer_load_dwordx4 v2, s[16:19], s48 offen lds
 v_mfma_f32_16x16x32_bf16 v[116:119], a[80:83], a[160:163], v[116:119]
 ds_read_b64_tr_b16 a[106:107], v10 offset:4096
 v_mfma_f32_16x16x32_bf16 v[116:119], a[84:87], a[168:171], v[116:119]
 ds_read_b64_tr_b16 a[108:109], v10 offset:16384
 v_mfma_f32_16x16x32_bf16 v[116:119], a[88:91], a[176:179], v[116:119]
 s_waitcnt lgkmcnt(7)
 ds_read_b64_tr_b16 a[110:111], v10 offset:20480
 v_xor_b32 v7, 33024, v6
 v_mfma_f32_16x16x32_bf16 v[116:119], a[92:95], a[184:187], v[116:119]
 s_add_u32 m0, s29, 73728
 ds_read_b64_tr_b16 a[64:65], v7 offset:0
 v_mfma_f32_16x16x32_bf16 v[124:127], a[80:83], a[164:167], v[124:127]
 ds_read_b64_tr_b16 a[66:67], v7 offset:4096
 buffer_load_dwordx4 v2, s[16:19], s49 offen lds
 v_mfma_f32_16x16x32_bf16 v[124:127], a[84:87], a[172:175], v[124:127]
 ds_read_b64_tr_b16 a[68:69], v7 offset:16384
 v_mfma_f32_16x16x32_bf16 v[124:127], a[88:91], a[180:183], v[124:127]
 s_add_u32 s59, s56, 24576
 ds_read_b64_tr_b16 a[70:71], v7 offset:20480
 v_xor_b32 v8, 98560, v6
 v_mfma_f32_16x16x32_bf16 v[124:127], a[92:95], a[188:191], v[124:127]
 s_waitcnt lgkmcnt(6)
 ds_read_b64_tr_b16 a[72:73], v8 offset:0
 buffer_store_dwordx4 v[96:99], v1, s[12:15], s59 offen offset:1024 sc1
 v_mfma_f32_16x16x32_bf16 v[132:135], a[96:99], a[160:163], v[132:135]
 s_add_u32 m0, s29, 77824
 ds_read_b64_tr_b16 a[74:75], v8 offset:4096
 v_mfma_f32_16x16x32_bf16 v[132:135], a[100:103], a[168:171], v[132:135]
 ds_read_b64_tr_b16 a[76:77], v8 offset:16384
 buffer_load_dwordx4 v2, s[16:19], s50 offen lds
 v_mfma_f32_16x16x32_bf16 v[132:135], a[104:107], a[176:179], v[132:135]
 s_waitcnt lgkmcnt(7)
 ds_read_b64_tr_b16 a[78:79], v8 offset:20480
 v_xor_b32 v9, 33056, v6
 v_mfma_f32_16x16x32_bf16 v[132:135], a[108:111], a[184:187], v[132:135]
 ds_read_b64_tr_b16 a[80:81], v9 offset:0
 v_mfma_f32_16x16x32_bf16 v[140:143], a[96:99], a[164:167], v[140:143]
 ds_read_b64_tr_b16 a[82:83], v9 offset:4096
 v_mfma_f32_16x16x32_bf16 v[140:143], a[100:103], a[172:175], v[140:143]
 ds_read_b64_tr_b16 a[84:85], v9 offset:16384
 v_mfma_f32_16x16x32_bf16 v[140:143], a[104:107], a[180:183], v[140:143]
 s_add_u32 m0, s29, 81920
 ds_read_b64_tr_b16 a[86:87], v9 offset:20480
 v_xor_b32 v10, 98592, v6
 v_mfma_f32_16x16x32_bf16 v[140:143], a[108:111], a[188:191], v[140:143]
 s_waitcnt lgkmcnt(6)
 ds_read_b64_tr_b16 a[88:89], v10 offset:0
 buffer_load_dwordx4 v2, s[16:19], s51 offen lds
 v_mfma_f32_16x16x32_bf16 v[148:151], a[64:67], a[160:163], v[148:151]
 s_add_u32 s59, s56, 16384
 ds_read_b64_tr_b16 a[90:91], v10 offset:4096
 v_mfma_f32_16x16x32_bf16 v[148:151], a[68:71], a[168:171], v[148:151]
 ds_read_b64_tr_b16 a[92:93], v10 offset:16384
 buffer_store_dwordx4 v[104:107], v1, s[12:15], s59 offen offset:1024 sc1
 v_mfma_f32_16x16x32_bf16 v[148:151], a[72:75], a[176:179], v[148:151]
 s_waitcnt lgkmcnt(7)
 ds_read_b64_tr_b16 a[94:95], v10 offset:20480
 v_xor_b32 v7, 33088, v6
 v_mfma_f32_16x16x32_bf16 v[148:151], a[76:79], a[184:187], v[148:151]
 s_add_u32 m0, s29, 86016
 ds_read_b64_tr_b16 a[96:97], v7 offset:0
 v_mfma_f32_16x16x32_bf16 v[156:159], a[64:67], a[164:167], v[156:159]
 ds_read_b64_tr_b16 a[98:99], v7 offset:4096
 buffer_load_dwordx4 v2, s[16:19], s52 offen lds
 v_mfma_f32_16x16x32_bf16 v[156:159], a[68:71], a[172:175], v[156:159]
 ds_read_b64_tr_b16 a[100:101], v7 offset:16384
 v_mfma_f32_16x16x32_bf16 v[156:159], a[72:75], a[180:183], v[156:159]
 ds_read_b64_tr_b16 a[102:103], v7 offset:20480
 v_xor_b32 v8, 98624, v6
 v_mfma_f32_16x16x32_bf16 v[156:159], a[76:79], a[188:191], v[156:159]
 s_waitcnt lgkmcnt(6)
 ds_read_b64_tr_b16 a[104:105], v8 offset:0
 v_mfma_f32_16x16x32_bf16 v[164:167], a[80:83], a[160:163], v[164:167]
 s_add_u32 m0, s29, 90112
 ds_read_b64_tr_b16 a[106:107], v8 offset:4096
 v_mfma_f32_16x16x32_bf16 v[164:167], a[84:87], a[168:171], v[164:167]
 ds_read_b64_tr_b16 a[108:109], v8 offset:16384
 buffer_load_dwordx4 v2, s[16:19], s53 offen lds
 v_mfma_f32_16x16x32_bf16 v[164:167], a[88:91], a[176:179], v[164:167]
 s_waitcnt lgkmcnt(7)
 ds_read_b64_tr_b16 a[110:111], v8 offset:20480
 v_xor_b32 v9, 33120, v6
 v_mfma_f32_16x16x32_bf16 v[164:167], a[92:95], a[184:187], v[164:167]
 s_add_u32 s59, s56, 8192
 ds_read_b64_tr_b16 a[64:65], v9 offset:0
 v_mfma_f32_16x16x32_bf16 v[172:175], a[80:83], a[164:167], v[172:175]
 ds_read_b64_tr_b16 a[66:67], v9 offset:4096
 buffer_store_dwordx4 v[112:115], v1, s[12:15], s59 offen offset:1024 sc1
 v_mfma_f32_16x16x32_bf16 v[172:175], a[84:87], a[172:175], v[172:175]
 ds_read_b64_tr_b16 a[68:69], v9 offset:16384
 v_mfma_f32_16x16x32_bf16 v[172:175], a[88:91], a[180:183], v[172:175]
 s_add_u32 m0, s29, 94208
 ds_read_b64_tr_b16 a[70:71], v9 offset:20480
 v_xor_b32 v10, 98656, v6
 v_mfma_f32_16x16x32_bf16 v[172:175], a[92:95], a[188:191], v[172:175]
 s_waitcnt lgkmcnt(6)
 ds_read_b64_tr_b16 a[72:73], v10 offset:0
 buffer_load_dwordx4 v2, s[16:19], s54 offen lds
 v_mfma_f32_16x16x32_bf16 v[180:183], a[96:99], a[160:163], v[180:183]
 ds_read_b64_tr_b16 a[74:75], v10 offset:4096
 v_mfma_f32_16x16x32_bf16 v[180:183], a[100:103], a[168:171], v[180:183]
 ds_read_b64_tr_b16 a[76:77], v10 offset:16384
 v_mfma_f32_16x16x32_bf16 v[180:183], a[104:107], a[176:179], v[180:183]
 s_waitcnt lgkmcnt(7)
 ds_read_b64_tr_b16 a[78:79], v10 offset:20480
 v_xor_b32 v7, 33152, v6
 v_mfma_f32_16x16x32_bf16 v[180:183], a[108:111], a[184:187], v[180:183]
 ds_read_b64_tr_b16 a[80:81], v7 offset:0
 v_mfma_f32_16x16x32_bf16 v[188:191], a[96:99], a[164:167], v[188:191]
 ds_read_b64_tr_b16 a[82:83], v7 offset:4096
 v_mfma_f32_16x16x32_bf16 v[188:191], a[100:103], a[172:175], v[188:191]
 ds_read_b64_tr_b16 a[84:85], v7 offset:16384
 v_mfma_f32_16x16x32_bf16 v[188:191], a[104:107], a[180:183], v[188:191]
 s_add_u32 s59, s56, 0
 ds_read_b64_tr_b16 a[86:87], v7 offset:20480
 v_xor_b32 v8, 98688, v6
 v_mfma_f32_16x16x32_bf16 v[188:191], a[108:111], a[188:191], v[188:191]
 s_waitcnt lgkmcnt(6)
 ds_read_b64_tr_b16 a[88:89], v8 offset:0
 buffer_store_dwordx4 v[120:123], v1, s[12:15], s59 offen offset:1024 sc1
 v_mfma_f32_16x16x32_bf16 v[196:199], a[64:67], a[160:163], v[196:199]
 ds_read_b64_tr_b16 a[90:91], v8 offset:4096
 v_mfma_f32_16x16x32_bf16 v[196:199], a[68:71], a[168:171], v[196:199]
 ds_read_b64_tr_b16 a[92:93], v8 offset:16384
 v_mfma_f32_16x16x32_bf16 v[196:199], a[72:75], a[176:179], v[196:199]
 s_waitcnt lgkmcnt(7)
 ds_read_b64_tr_b16 a[94:95], v8 offset:20480
 v_xor_b32 v9, 33184, v6
 v_mfma_f32_16x16x32_bf16 v[196:199], a[76:79], a[184:187], v[196:199]
 ds_read_b64_tr_b16 a[96:97], v9 offset:0
 v_mfma_f32_16x16x32_bf16 v[204:207], a[64:67], a[164:167], v[204:207]
 ds_read_b64_tr_b16 a[98:99], v9 offset:4096
 v_mfma_f32_16x16x32_bf16 v[204:207], a[68:71], a[172:175], v[204:207]
 ds_read_b64_tr_b16 a[100:101], v9 offset:16384
 v_mfma_f32_16x16x32_bf16 v[204:207], a[72:75], a[180:183], v[204:207]
 ds_read_b64_tr_b16 a[102:103], v9 offset:20480
 v_xor_b32 v10, 98720, v6
 v_mfma_f32_16x16x32_bf16 v[204:207], a[76:79], a[188:191], v[204:207]
 s_waitcnt lgkmcnt(6)
 ds_read_b64_tr_b16 a[104:105], v10 offset:0
 v_mfma_f32_16x16x32_bf16 v[212:215], a[80:83], a[160:163], v[212:215]
 s_add_u32 s59, s56, 24576
 ds_read_b64_tr_b16 a[106:107], v10 offset:4096
 v_mfma_f32_16x16x32_bf16 v[212:215], a[84:87], a[168:171], v[212:215]
 ds_read_b64_tr_b16 a[108:109], v10 offset:16384
 buffer_store_dwordx4 v[128:131], v1, s[12:15], s59 offen offset:2048 sc1
 v_mfma_f32_16x16x32_bf16 v[212:215], a[88:91], a[176:179], v[212:215]
 s_waitcnt lgkmcnt(7)
 ds_read_b64_tr_b16 a[110:111], v10 offset:20480
 v_xor_b32 v7, 33216, v6
 v_mfma_f32_16x16x32_bf16 v[212:215], a[92:95], a[184:187], v[212:215]
 ds_read_b64_tr_b16 a[64:65], v7 offset:0
 v_lshrrev_b32 v120, 3, v0
 v_mfma_f32_16x16x32_bf16 v[220:223], a[80:83], a[164:167], v[220:223]
 ds_read_b64_tr_b16 a[66:67], v7 offset:4096
 v_mul_u32_u24 v120, 1792, v120
 v_mfma_f32_16x16x32_bf16 v[220:223], a[84:87], a[172:175], v[220:223]
 ds_read_b64_tr_b16 a[68:69], v7 offset:16384
 v_and_b32 v121, 7, v0
 v_mfma_f32_16x16x32_bf16 v[220:223], a[88:91], a[180:183], v[220:223]
 ds_read_b64_tr_b16 a[70:71], v7 offset:20480
 v_xor_b32 v8, 98752, v6
 v_mfma_f32_16x16x32_bf16 v[220:223], a[92:95], a[188:191], v[220:223]
 s_waitcnt lgkmcnt(6)
 ds_read_b64_tr_b16 a[72:73], v8 offset:0
 v_lshl_add_u32 v120, v121, 4, v120
 v_mfma_f32_16x16x32_bf16 v[228:231], a[96:99], a[160:163], v[228:231]
 ds_read_b64_tr_b16 a[74:75], v8 offset:4096
 v_add_u32 v120, s38, v120
 v_mfma_f32_16x16x32_bf16 v[228:231], a[100:103], a[168:171], v[228:231]
 s_add_u32 s59, s56, 16384
 ds_read_b64_tr_b16 a[76:77], v8 offset:16384
 v_lshlrev_b32 v121, 6, v121
 v_mfma_f32_16x16x32_bf16 v[228:231], a[104:107], a[176:179], v[228:231]
 s_waitcnt lgkmcnt(7)
 ds_read_b64_tr_b16 a[78:79], v8 offset:20480
 v_xor_b32 v9, 33248, v6
 v_mfma_f32_16x16x32_bf16 v[228:231], a[108:111], a[184:187], v[228:231]
 ds_read_b64_tr_b16 a[80:81], v9 offset:0
 buffer_store_dwordx4 v[136:139], v1, s[12:15], s59 offen offset:2048 sc1
 v_mfma_f32_16x16x32_bf16 v[236:239], a[96:99], a[164:167], v[236:239]
 ds_read_b64_tr_b16 a[82:83], v9 offset:4096
 v_subrev_u32 v122, 2688, v120
 v_mfma_f32_16x16x32_bf16 v[236:239], a[100:103], a[172:175], v[236:239]
 ds_read_b64_tr_b16 a[84:85], v9 offset:16384
 v_subrev_u32 v123, 1792, v120
 v_mfma_f32_16x16x32_bf16 v[236:239], a[104:107], a[180:183], v[236:239]
 ds_read_b64_tr_b16 a[86:87], v9 offset:20480
 v_xor_b32 v10, 98784, v6
 v_mfma_f32_16x16x32_bf16 v[236:239], a[108:111], a[188:191], v[236:239]
 s_waitcnt lgkmcnt(6)
 ds_read_b64_tr_b16 a[88:89], v10 offset:0
 v_subrev_u32 v128, 896, v120
 v_mfma_f32_16x16x32_bf16 v[244:247], a[64:67], a[160:163], v[244:247]
 ds_read_b64_tr_b16 a[90:91], v10 offset:4096
 buffer_load_dwordx4 v[32:35], v122, s[4:7], 0 offen
 v_mfma_f32_16x16x32_bf16 v[244:247], a[68:71], a[168:171], v[244:247]
 s_waitcnt vmcnt(4)
 ds_read_b64_tr_b16 a[92:93], v10 offset:16384
 v_xor_b32 v7, 131072, v6
 v_mfma_f32_16x16x32_bf16 v[244:247], a[72:75], a[176:179], v[244:247]
 s_waitcnt lgkmcnt(7)
 s_barrier
 ds_read_b64_tr_b16 a[94:95], v10 offset:20480
 v_mfma_f32_16x16x32_bf16 v[244:247], a[76:79], a[184:187], v[244:247]
 s_and_b32 s58, s92, ~127
 ds_read_b64_tr_b16 a[96:97], v7 offset:0
 v_mfma_f32_16x16x32_bf16 v[252:255], a[64:67], a[164:167], v[252:255]
 s_add_u32 s59, s56, 8192
 ds_read_b64_tr_b16 a[98:99], v7 offset:4096
 v_mfma_f32_16x16x32_bf16 v[252:255], a[68:71], a[172:175], v[252:255]
 ds_read_b64_tr_b16 a[100:101], v7 offset:16384
 buffer_store_dwordx4 v[144:147], v1, s[12:15], s59 offen offset:2048 sc1
 v_mfma_f32_16x16x32_bf16 v[252:255], a[72:75], a[180:183], v[252:255]
 s_lshl_b32 s37, s25, 1
 ds_read_b64_tr_b16 a[102:103], v7 offset:20480
 v_xor_b32 v8, 0, v6
 v_mfma_f32_16x16x32_bf16 v[252:255], a[76:79], a[188:191], v[252:255]
 s_waitcnt lgkmcnt(6)
 ds_read_b64_tr_b16 a[104:105], v8 offset:0
 buffer_load_dwordx4 v[40:43], v123, s[4:7], 0 offen
 v_mfma_f32_16x16x32_bf16 v[16:19], a[80:83], a[160:163], v[16:19]
 s_sub_i32 s38, 12, s37
 ds_read_b64_tr_b16 a[106:107], v8 offset:4096
 v_mfma_f32_16x16x32_bf16 v[16:19], a[84:87], a[168:171], v[16:19]
 s_max_i32 s38, s38, 0
 ds_read_b64_tr_b16 a[108:109], v8 offset:16384
 v_mfma_f32_16x16x32_bf16 v[16:19], a[88:91], a[176:179], v[16:19]
 s_waitcnt lgkmcnt(7)
 ds_read_b64_tr_b16 a[110:111], v8 offset:20480
 v_xor_b32 v9, 65536, v6
 v_mfma_f32_16x16x32_bf16 v[16:19], a[92:95], a[184:187], v[16:19]
 ds_read_b64_tr_b16 a[64:65], v9 offset:0
 buffer_load_dwordx4 v[48:51], v128, s[4:7], 0 offen
 v_mfma_f32_16x16x32_bf16 v[24:27], a[80:83], a[164:167], v[24:27]
 s_mul_i32 s49, s26, 1048576
 ds_read_b64_tr_b16 a[66:67], v9 offset:4096
 v_mfma_f32_16x16x32_bf16 v[24:27], a[84:87], a[172:175], v[24:27]
 s_lshl_b32 s50, s3, 13
 ds_read_b64_tr_b16 a[68:69], v9 offset:16384
 v_mfma_f32_16x16x32_bf16 v[24:27], a[88:91], a[180:183], v[24:27]
 s_add_u32 s59, s56, 0
 ds_read_b64_tr_b16 a[70:71], v9 offset:20480
 v_xor_b32 v10, 131104, v6
 v_mfma_f32_16x16x32_bf16 v[24:27], a[92:95], a[188:191], v[24:27]
 s_waitcnt lgkmcnt(6)
 ds_read_b64_tr_b16 a[72:73], v10 offset:0
 buffer_store_dwordx4 v[152:155], v1, s[12:15], s59 offen offset:2048 sc1
 v_mfma_f32_16x16x32_bf16 v[28:31], a[96:99], a[192:195], v[28:31]
 s_add_u32 s49, s49, s50
 ds_read_b64_tr_b16 a[74:75], v10 offset:4096
 v_mfma_f32_16x16x32_bf16 v[28:31], a[100:103], a[200:203], v[28:31]
 ds_read_b64_tr_b16 a[76:77], v10 offset:16384
 buffer_load_dwordx4 v[56:59], v120, s[4:7], 0 offen offset:0
 v_mfma_f32_16x16x32_bf16 v[28:31], a[104:107], a[208:211], v[28:31]
 s_waitcnt lgkmcnt(3)
 ds_read_b64_tr_b16 a[78:79], v10 offset:20480
 v_xor_b32 v7, 32, v6
 v_mfma_f32_16x16x32_bf16 v[28:31], a[108:111], a[216:219], v[28:31]
 s_mov_b32 s54, 0
 ds_read_b64_tr_b16 a[80:81], v7 offset:0
 v_mfma_f32_16x16x32_bf16 v[28:31], a[64:67], a[112:115], v[28:31]
 s_add_u32 s44, s37, 1
 ds_read_b64_tr_b16 a[82:83], v7 offset:4096
 v_mfma_f32_16x16x32_bf16 v[28:31], a[68:71], a[120:123], v[28:31]
 ds_read_b64_tr_b16 a[84:85], v7 offset:16384
 buffer_load_dwordx4 v[64:67], v120, s[4:7], 0 offen offset:896
 v_mfma_f32_16x16x32_bf16 v[44:47], a[96:99], a[196:199], v[44:47]
 s_mov_b32 s42, s49
 ds_read_b64_tr_b16 a[86:87], v7 offset:20480
 v_xor_b32 v8, 65568, v6
 v_mfma_f32_16x16x32_bf16 v[44:47], a[100:103], a[204:207], v[44:47]
 s_add_u32 s60, s94, 4
 ds_read_b64_tr_b16 a[88:89], v8 offset:0
 v_mfma_f32_16x16x32_bf16 v[44:47], a[104:107], a[212:215], v[44:47]
 s_add_u32 s59, s56, 24576
 ds_read_b64_tr_b16 a[90:91], v8 offset:4096
 v_mfma_f32_16x16x32_bf16 v[44:47], a[108:111], a[220:223], v[44:47]
 ds_read_b64_tr_b16 a[92:93], v8 offset:16384
 buffer_store_dwordx4 v[160:163], v1, s[12:15], s59 offen offset:3072 sc1
 v_mfma_f32_16x16x32_bf16 v[44:47], a[64:67], a[116:119], v[44:47]
 s_mov_b32 s45, 2
 ds_read_b64_tr_b16 a[94:95], v8 offset:20480
 v_xor_b32 v9, 131136, v6
 v_mfma_f32_16x16x32_bf16 v[44:47], a[68:71], a[124:127], v[44:47]
 s_waitcnt lgkmcnt(6)
 ds_read_b64_tr_b16 a[96:97], v9 offset:0
 buffer_load_dwordx4 v[72:75], v120, s[8:11], 0 offen offset:0
 v_mfma_f32_16x16x32_bf16 v[52:55], a[72:75], a[192:195], v[52:55]
 s_mov_b32 s66, 1
 ds_read_b64_tr_b16 a[98:99], v9 offset:4096
 v_mfma_f32_16x16x32_bf16 v[52:55], a[76:79], a[200:203], v[52:55]
 s_mov_b32 s68, 1
 ds_read_b64_tr_b16 a[100:101], v9 offset:16384
 v_mfma_f32_16x16x32_bf16 v[52:55], a[80:83], a[208:211], v[52:55]
 s_waitcnt lgkmcnt(3)
 ds_read_b64_tr_b16 a[102:103], v9 offset:20480
 v_xor_b32 v10, 64, v6
 v_mfma_f32_16x16x32_bf16 v[52:55], a[84:87], a[216:219], v[52:55]
 ds_read_b64_tr_b16 a[104:105], v10 offset:0
 buffer_load_dwordx4 v[80:83], v120, s[8:11], 0 offen offset:896
 v_mfma_f32_16x16x32_bf16 v[52:55], a[88:91], a[112:115], v[52:55]
 s_mov_b32 s70, 32768
 ds_read_b64_tr_b16 a[106:107], v10 offset:4096
 v_mfma_f32_16x16x32_bf16 v[52:55], a[92:95], a[120:123], v[52:55]
 s_mov_b32 s71, s70
 ds_read_b64_tr_b16 a[108:109], v10 offset:16384
 v_mfma_f32_16x16x32_bf16 v[60:63], a[72:75], a[196:199], v[60:63]
 s_add_u32 s59, s56, 16384
 ds_read_b64_tr_b16 a[110:111], v10 offset:20480
 v_xor_b32 v7, 65600, v6
 v_mfma_f32_16x16x32_bf16 v[60:63], a[76:79], a[204:207], v[60:63]
 ds_read_b64_tr_b16 a[64:65], v7 offset:0
 buffer_store_dwordx4 v[168:171], v1, s[12:15], s59 offen offset:3072 sc1
 v_mfma_f32_16x16x32_bf16 v[60:63], a[80:83], a[212:215], v[60:63]
 s_add_u32 s43, s42, 16777216
 ds_read_b64_tr_b16 a[66:67], v7 offset:4096
 v_mfma_f32_16x16x32_bf16 v[60:63], a[84:87], a[220:223], v[60:63]
 ds_read_b64_tr_b16 a[68:69], v7 offset:16384
 buffer_load_dwordx4 v[88:91], v121, s[20:23], s39 offen offset:0
 v_mfma_f32_16x16x32_bf16 v[60:63], a[88:91], a[116:119], v[60:63]
 s_mov_b32 s40, s50
 ds_read_b64_tr_b16 a[70:71], v7 offset:20480
 v_xor_b32 v8, 131168, v6
 v_mfma_f32_16x16x32_bf16 v[60:63], a[92:95], a[124:127], v[60:63]
 s_waitcnt lgkmcnt(6)
 ds_read_b64_tr_b16 a[72:73], v8 offset:0
 v_mfma_f32_16x16x32_bf16 v[20:23], a[96:99], a[192:195], v[20:23]
 s_add_u32 s41, s50, 0x10000
 ds_read_b64_tr_b16 a[74:75], v8 offset:4096
 v_mfma_f32_16x16x32_bf16 v[20:23], a[100:103], a[200:203], v[20:23]
 ds_read_b64_tr_b16 a[76:77], v8 offset:16384
 buffer_load_dwordx4 v[96:99], v121, s[20:23], s39 offen offset:16
 v_mfma_f32_16x16x32_bf16 v[20:23], a[104:107], a[208:211], v[20:23]
 s_waitcnt lgkmcnt(3)
 ds_read_b64_tr_b16 a[78:79], v8 offset:20480
 v_xor_b32 v9, 96, v6
 v_mfma_f32_16x16x32_bf16 v[20:23], a[108:111], a[216:219], v[20:23]
 s_lshr_b32 s61, s95, 4
 ds_read_b64_tr_b16 a[80:81], v9 offset:0
 v_mul_f32 v28, s34, v28
 v_mfma_f32_16x16x32_bf16 v[20:23], a[64:67], a[112:115], v[20:23]
 s_add_u32 s59, s56, 8192
 ds_read_b64_tr_b16 a[82:83], v9 offset:4096
 v_mul_f32 v29, s34, v29
 v_mfma_f32_16x16x32_bf16 v[20:23], a[68:71], a[120:123], v[20:23]
 ds_read_b64_tr_b16 a[84:85], v9 offset:16384
 buffer_store_dwordx4 v[176:179], v1, s[12:15], s59 offen offset:3072 sc1
 v_mfma_f32_16x16x32_bf16 v[36:39], a[96:99], a[196:199], v[36:39]
 s_lshl_b32 s61, s61, 7
 ds_read_b64_tr_b16 a[86:87], v9 offset:20480
 v_xor_b32 v10, 65632, v6
 v_mfma_f32_16x16x32_bf16 v[36:39], a[100:103], a[204:207], v[36:39]
 ds_read_b64_tr_b16 a[88:89], v10 offset:0
 buffer_load_dwordx4 v[104:107], v121, s[20:23], s39 offen offset:32
 v_mfma_f32_16x16x32_bf16 v[36:39], a[104:107], a[212:215], v[36:39]
 s_add_u32 s61, s61, 84959232
 ds_read_b64_tr_b16 a[90:91], v10 offset:4096
 v_mul_f32 v30, s34, v30
 v_mfma_f32_16x16x32_bf16 v[36:39], a[108:111], a[220:223], v[36:39]
 s_mov_b32 s47, 0x4b800000
 ds_read_b64_tr_b16 a[92:93], v10 offset:16384
 v_mul_f32 v31, s34, v31
 v_mfma_f32_16x16x32_bf16 v[36:39], a[64:67], a[116:119], v[36:39]
 s_lshl_b32 s30, s95, 1
 ds_read_b64_tr_b16 a[94:95], v10 offset:20480
 v_xor_b32 v7, 131200, v6
 v_mfma_f32_16x16x32_bf16 v[36:39], a[68:71], a[124:127], v[36:39]
 s_waitcnt lgkmcnt(6)
 ds_read_b64_tr_b16 a[96:97], v7 offset:0
 buffer_load_dwordx4 v[112:115], v121, s[20:23], s39 offen offset:48
 v_mfma_f32_16x16x32_bf16 v[68:71], a[72:75], a[192:195], v[68:71]
 s_lshr_b32 s31, s3, 1
 ds_read_b64_tr_b16 a[98:99], v7 offset:4096
 v_mul_f32 v52, s34, v52
 v_mfma_f32_16x16x32_bf16 v[68:71], a[76:79], a[200:203], v[68:71]
 s_add_u32 s59, s56, 0
 ds_read_b64_tr_b16 a[100:101], v7 offset:16384
 v_mul_f32 v53, s34, v53
 v_mfma_f32_16x16x32_bf16 v[68:71], a[80:83], a[208:211], v[68:71]
 s_waitcnt lgkmcnt(3)
 ds_read_b64_tr_b16 a[102:103], v7 offset:20480
 v_xor_b32 v8, 128, v6
 v_mfma_f32_16x16x32_bf16 v[68:71], a[84:87], a[216:219], v[68:71]
 ds_read_b64_tr_b16 a[104:105], v8 offset:0
 buffer_store_dwordx4 v[184:187], v1, s[12:15], s59 offen offset:3072 sc1
 v_mfma_f32_16x16x32_bf16 v[68:71], a[88:91], a[112:115], v[68:71]
 s_add_u32 s30, s30, s31
 ds_read_b64_tr_b16 a[106:107], v8 offset:4096
 v_mul_f32 v54, s34, v54
 v_mfma_f32_16x16x32_bf16 v[68:71], a[92:95], a[120:123], v[68:71]
 s_min_u32 s30, s30, 223
 ds_read_b64_tr_b16 a[108:109], v8 offset:16384
 v_mul_f32 v55, s34, v55
 v_mfma_f32_16x16x32_bf16 v[76:79], a[72:75], a[196:199], v[76:79]
 s_lshl_b32 s30, s30, 2
 ds_read_b64_tr_b16 a[110:111], v8 offset:20480
 v_xor_b32 v9, 65664, v6
 v_mfma_f32_16x16x32_bf16 v[76:79], a[76:79], a[204:207], v[76:79]
 s_and_b32 s4, s2, 127
 ds_read_b64_tr_b16 a[64:65], v9 offset:0
 v_cvt_pk_bf16_f32 v28, v28, v29
 v_mfma_f32_16x16x32_bf16 v[76:79], a[80:83], a[212:215], v[76:79]
 s_lshl_b32 s4, s4, 2
 ds_read_b64_tr_b16 a[66:67], v9 offset:4096
 v_cvt_pk_bf16_f32 v29, v30, v31
 v_mfma_f32_16x16x32_bf16 v[76:79], a[84:87], a[220:223], v[76:79]
 s_add_u32 s4, s4, s3
 ds_read_b64_tr_b16 a[68:69], v9 offset:16384
 v_cvt_pk_bf16_f32 v30, v52, v53
 v_mfma_f32_16x16x32_bf16 v[76:79], a[88:91], a[116:119], v[76:79]
 s_mul_i32 s5, s4, 17408
 ds_read_b64_tr_b16 a[70:71], v9 offset:20480
 v_xor_b32 v10, 131232, v6
 v_mfma_f32_16x16x32_bf16 v[76:79], a[92:95], a[124:127], v[76:79]
 s_waitcnt lgkmcnt(6)
 ds_read_b64_tr_b16 a[72:73], v10 offset:0
 v_cvt_pk_bf16_f32 v31, v54, v55
 v_mfma_f32_16x16x32_bf16 v[84:87], a[96:99], a[192:195], v[84:87]
 s_add_u32 s59, s56, 57344
 ds_read_b64_tr_b16 a[74:75], v10 offset:4096
 v_accvgpr_write_b32 a0, v28
 v_mfma_f32_16x16x32_bf16 v[84:87], a[100:103], a[200:203], v[84:87]
 ds_read_b64_tr_b16 a[76:77], v10 offset:16384
 buffer_store_dwordx4 v[192:195], v1, s[12:15], s59 offen offset:2048 sc1
 v_mfma_f32_16x16x32_bf16 v[84:87], a[104:107], a[208:211], v[84:87]
 s_waitcnt lgkmcnt(3)
 ds_read_b64_tr_b16 a[78:79], v10 offset:20480
 v_xor_b32 v7, 160, v6
 v_mfma_f32_16x16x32_bf16 v[84:87], a[108:111], a[216:219], v[84:87]
 s_add_u32 s5, s5, 50331648
 ds_read_b64_tr_b16 a[80:81], v7 offset:0
 v_accvgpr_write_b32 a1, v29
 v_mfma_f32_16x16x32_bf16 v[84:87], a[64:67], a[112:115], v[84:87]
 s_add_u32 s4, s5, 0x2000
 ds_read_b64_tr_b16 a[82:83], v7 offset:4096
 v_accvgpr_write_b32 a2, v30
 v_mfma_f32_16x16x32_bf16 v[84:87], a[68:71], a[120:123], v[84:87]
 s_mov_b32 s6, 2.0
 ds_read_b64_tr_b16 a[84:85], v7 offset:16384
 v_accvgpr_write_b32 a3, v31
 v_mfma_f32_16x16x32_bf16 v[92:95], a[96:99], a[196:199], v[92:95]
 s_min_u32 s7, s38, 1
 ds_read_b64_tr_b16 a[86:87], v7 offset:20480
 v_xor_b32 v8, 65696, v6
 v_mfma_f32_16x16x32_bf16 v[92:95], a[100:103], a[204:207], v[92:95]
 s_cmp_eq_u32 s44, 1
 s_cselect_b32 s53, 1, 0
 ds_read_b64_tr_b16 a[88:89], v8 offset:0
 v_mfma_f32_16x16x32_bf16 v[92:95], a[104:107], a[212:215], v[92:95]
 s_cmp_eq_u32 s38, 0
 s_cmov_b32 s4, 2.0
 ds_read_b64_tr_b16 a[90:91], v8 offset:4096
 v_mfma_f32_16x16x32_bf16 v[92:95], a[108:111], a[220:223], v[92:95]
 s_cmp_eq_u32 s38, 0
 s_cmov_b32 s5, 2.0
 ds_read_b64_tr_b16 a[92:93], v8 offset:16384
 v_mfma_f32_16x16x32_bf16 v[92:95], a[64:67], a[116:119], v[92:95]
 s_add_u32 s59, s56, 49152
 ds_read_b64_tr_b16 a[94:95], v8 offset:20480
 v_xor_b32 v9, 131264, v6
 v_mfma_f32_16x16x32_bf16 v[92:95], a[68:71], a[124:127], v[92:95]
 s_waitcnt lgkmcnt(6)
 ds_read_b64_tr_b16 a[96:97], v9 offset:0
 buffer_store_dwordx4 v[200:203], v1, s[12:15], s59 offen offset:2048 sc1
 v_mfma_f32_16x16x32_bf16 v[100:103], a[72:75], a[192:195], v[100:103]
 s_cmp_eq_u32 s38, 0
 s_cmov_b32 s60, s58
 ds_read_b64_tr_b16 a[98:99], v9 offset:4096
 v_mfma_f32_16x16x32_bf16 v[100:103], a[76:79], a[200:203], v[100:103]
 s_mov_b64 s[8:9], s[12:13]
 ds_read_b64_tr_b16 a[100:101], v9 offset:16384
 v_mul_f32 v44, s34, v44
 v_mfma_f32_16x16x32_bf16 v[100:103], a[80:83], a[208:211], v[100:103]
 s_waitcnt lgkmcnt(3)
 ds_read_b64_tr_b16 a[102:103], v9 offset:20480
 v_xor_b32 v10, 192, v6
 v_mfma_f32_16x16x32_bf16 v[100:103], a[84:87], a[216:219], v[100:103]
 s_mov_b32 s10, s14
 ds_read_b64_tr_b16 a[104:105], v10 offset:0
 v_mul_f32 v45, s34, v45
 v_mfma_f32_16x16x32_bf16 v[100:103], a[88:91], a[112:115], v[100:103]
 s_mov_b32 s76, 0
 ds_read_b64_tr_b16 a[106:107], v10 offset:4096
 v_mul_f32 v46, s34, v46
 v_mfma_f32_16x16x32_bf16 v[100:103], a[92:95], a[120:123], v[100:103]
 s_movk_i32 s77, 0x1000
 ds_read_b64_tr_b16 a[108:109], v10 offset:16384
 v_mul_f32 v47, s34, v47
 v_mfma_f32_16x16x32_bf16 v[108:111], a[72:75], a[196:199], v[108:111]
 s_mov_b32 s51, 0
 ds_read_b64_tr_b16 a[110:111], v10 offset:20480
 v_xor_b32 v7, 65728, v6
 v_mfma_f32_16x16x32_bf16 v[108:111], a[76:79], a[204:207], v[108:111]
 s_mul_i32 s78, s26, 229376
 ds_read_b64_tr_b16 a[64:65], v7 offset:0
 v_mul_f32 v60, s34, v60
 v_mfma_f32_16x16x32_bf16 v[108:111], a[80:83], a[212:215], v[108:111]
 s_add_u32 s59, s56, 40960
 ds_read_b64_tr_b16 a[66:67], v7 offset:4096
 v_mul_f32 v61, s34, v61
 v_mfma_f32_16x16x32_bf16 v[108:111], a[84:87], a[220:223], v[108:111]
 ds_read_b64_tr_b16 a[68:69], v7 offset:16384
 buffer_store_dwordx4 v[208:211], v1, s[12:15], s59 offen offset:2048 sc1
 v_mfma_f32_16x16x32_bf16 v[108:111], a[88:91], a[116:119], v[108:111]
 s_add_u32 s79, s78, 28672
 ds_read_b64_tr_b16 a[70:71], v7 offset:20480
 v_xor_b32 v8, 131296, v6
 v_mfma_f32_16x16x32_bf16 v[108:111], a[92:95], a[124:127], v[108:111]
 s_waitcnt lgkmcnt(6)
 ds_read_b64_tr_b16 a[72:73], v8 offset:0
 v_mul_f32 v62, s34, v62
 v_mfma_f32_16x16x32_bf16 v[116:119], a[96:99], a[192:195], v[116:119]
 s_add_u32 s80, s78, 57344
 ds_read_b64_tr_b16 a[74:75], v8 offset:4096
 v_mul_f32 v63, s34, v63
 v_mfma_f32_16x16x32_bf16 v[116:119], a[100:103], a[200:203], v[116:119]
 s_add_u32 s81, s78, 86016
 ds_read_b64_tr_b16 a[76:77], v8 offset:16384
 v_cvt_pk_bf16_f32 v44, v44, v45
 v_mfma_f32_16x16x32_bf16 v[116:119], a[104:107], a[208:211], v[116:119]
 s_waitcnt lgkmcnt(3)
 ds_read_b64_tr_b16 a[78:79], v8 offset:20480
 v_xor_b32 v9, 224, v6
 v_mfma_f32_16x16x32_bf16 v[116:119], a[108:111], a[216:219], v[116:119]
 s_add_u32 s82, s78, 114688
 ds_read_b64_tr_b16 a[80:81], v9 offset:0
 v_cvt_pk_bf16_f32 v45, v46, v47
 v_mfma_f32_16x16x32_bf16 v[116:119], a[64:67], a[112:115], v[116:119]
 s_add_u32 s83, s78, 143360
 ds_read_b64_tr_b16 a[82:83], v9 offset:4096
 v_cvt_pk_bf16_f32 v46, v60, v61
 v_mfma_f32_16x16x32_bf16 v[116:119], a[68:71], a[120:123], v[116:119]
 s_add_u32 s84, s78, 172032
 ds_read_b64_tr_b16 a[84:85], v9 offset:16384
 v_cvt_pk_bf16_f32 v47, v62, v63
 v_mfma_f32_16x16x32_bf16 v[124:127], a[96:99], a[196:199], v[124:127]
 s_add_u32 s59, s56, 32768
 ds_read_b64_tr_b16 a[86:87], v9 offset:20480
 v_xor_b32 v10, 65760, v6
 v_mfma_f32_16x16x32_bf16 v[124:127], a[100:103], a[204:207], v[124:127]
 ds_read_b64_tr_b16 a[88:89], v10 offset:0
 buffer_store_dwordx4 v[216:219], v1, s[12:15], s59 offen offset:2048 sc1
 v_mfma_f32_16x16x32_bf16 v[124:127], a[104:107], a[212:215], v[124:127]
 s_add_u32 s85, s78, 200704
 ds_read_b64_tr_b16 a[90:91], v10 offset:4096
 v_accvgpr_write_b32 a32, v44
 v_mfma_f32_16x16x32_bf16 v[124:127], a[108:111], a[220:223], v[124:127]
 ds_read_b64_tr_b16 a[92:93], v10 offset:16384
 v_accvgpr_write_b32 a33, v45
 v_mfma_f32_16x16x32_bf16 v[124:127], a[64:67], a[116:119], v[124:127]
 ds_read_b64_tr_b16 a[94:95], v10 offset:20480
 v_xor_b32 v7, 131328, v6
 v_mfma_f32_16x16x32_bf16 v[124:127], a[68:71], a[124:127], v[124:127]
 s_waitcnt lgkmcnt(6)
 ds_read_b64_tr_b16 a[96:97], v7 offset:0
 v_accvgpr_write_b32 a34, v46
 v_mfma_f32_16x16x32_bf16 v[132:135], a[72:75], a[192:195], v[132:135]
 ds_read_b64_tr_b16 a[98:99], v7 offset:4096
 v_accvgpr_write_b32 a35, v47
 v_mfma_f32_16x16x32_bf16 v[132:135], a[76:79], a[200:203], v[132:135]
 ds_read_b64_tr_b16 a[100:101], v7 offset:16384
 v_mul_f32 v20, s34, v20
 v_mfma_f32_16x16x32_bf16 v[132:135], a[80:83], a[208:211], v[132:135]
 s_waitcnt lgkmcnt(3)
 ds_read_b64_tr_b16 a[102:103], v7 offset:20480
 v_xor_b32 v8, 256, v6
 v_mfma_f32_16x16x32_bf16 v[132:135], a[84:87], a[216:219], v[132:135]
 ds_read_b64_tr_b16 a[104:105], v8 offset:0
 v_mul_f32 v21, s34, v21
 v_mfma_f32_16x16x32_bf16 v[132:135], a[88:91], a[112:115], v[132:135]
 s_add_u32 s59, s56, 57344
 ds_read_b64_tr_b16 a[106:107], v8 offset:4096
 v_mul_f32 v22, s34, v22
 v_mfma_f32_16x16x32_bf16 v[132:135], a[92:95], a[120:123], v[132:135]
 ds_read_b64_tr_b16 a[108:109], v8 offset:16384
 buffer_store_dwordx4 v[224:227], v1, s[12:15], s59 offen offset:3072 sc1
 v_mfma_f32_16x16x32_bf16 v[140:143], a[72:75], a[196:199], v[140:143]
 ds_read_b64_tr_b16 a[110:111], v8 offset:20480
 v_xor_b32 v9, 65792, v6
 v_mfma_f32_16x16x32_bf16 v[140:143], a[76:79], a[204:207], v[140:143]
 ds_read_b64_tr_b16 a[64:65], v9 offset:0
 v_mul_f32 v23, s34, v23
 v_mfma_f32_16x16x32_bf16 v[140:143], a[80:83], a[212:215], v[140:143]
 ds_read_b64_tr_b16 a[66:67], v9 offset:4096
 v_mul_f32 v68, s34, v68
 v_mfma_f32_16x16x32_bf16 v[140:143], a[84:87], a[220:223], v[140:143]
 ds_read_b64_tr_b16 a[68:69], v9 offset:16384
 v_mul_f32 v69, s34, v69
 v_mfma_f32_16x16x32_bf16 v[140:143], a[88:91], a[116:119], v[140:143]
 ds_read_b64_tr_b16 a[70:71], v9 offset:20480
 v_xor_b32 v10, 131360, v6
 v_mfma_f32_16x16x32_bf16 v[140:143], a[92:95], a[124:127], v[140:143]
 s_waitcnt lgkmcnt(6)
 ds_read_b64_tr_b16 a[72:73], v10 offset:0
 v_mul_f32 v70, s34, v70
 v_mfma_f32_16x16x32_bf16 v[148:151], a[96:99], a[192:195], v[148:151]
 ds_read_b64_tr_b16 a[74:75], v10 offset:4096
 v_mul_f32 v71, s34, v71
 v_mfma_f32_16x16x32_bf16 v[148:151], a[100:103], a[200:203], v[148:151]
 s_add_u32 s59, s56, 49152
 ds_read_b64_tr_b16 a[76:77], v10 offset:16384
 v_cvt_pk_bf16_f32 v20, v20, v21
 v_mfma_f32_16x16x32_bf16 v[148:151], a[104:107], a[208:211], v[148:151]
 s_waitcnt lgkmcnt(3)
 ds_read_b64_tr_b16 a[78:79], v10 offset:20480
 v_xor_b32 v7, 288, v6
 v_mfma_f32_16x16x32_bf16 v[148:151], a[108:111], a[216:219], v[148:151]
 ds_read_b64_tr_b16 a[80:81], v7 offset:0
 buffer_store_dwordx4 v[232:235], v1, s[12:15], s59 offen offset:3072 sc1
 v_mfma_f32_16x16x32_bf16 v[148:151], a[64:67], a[112:115], v[148:151]
 ds_read_b64_tr_b16 a[82:83], v7 offset:4096
 v_cvt_pk_bf16_f32 v21, v22, v23
 v_mfma_f32_16x16x32_bf16 v[148:151], a[68:71], a[120:123], v[148:151]
 ds_read_b64_tr_b16 a[84:85], v7 offset:16384
 v_cvt_pk_bf16_f32 v22, v68, v69
 v_mfma_f32_16x16x32_bf16 v[156:159], a[96:99], a[196:199], v[156:159]
 ds_read_b64_tr_b16 a[86:87], v7 offset:20480
 v_xor_b32 v8, 65824, v6
 v_mfma_f32_16x16x32_bf16 v[156:159], a[100:103], a[204:207], v[156:159]
 ds_read_b64_tr_b16 a[88:89], v8 offset:0
 v_cvt_pk_bf16_f32 v23, v70, v71
 v_mfma_f32_16x16x32_bf16 v[156:159], a[104:107], a[212:215], v[156:159]
 ds_read_b64_tr_b16 a[90:91], v8 offset:4096
 v_accvgpr_write_b32 a4, v20
 v_mfma_f32_16x16x32_bf16 v[156:159], a[108:111], a[220:223], v[156:159]
 ds_read_b64_tr_b16 a[92:93], v8 offset:16384
 v_accvgpr_write_b32 a5, v21
 v_mfma_f32_16x16x32_bf16 v[156:159], a[64:67], a[116:119], v[156:159]
 ds_read_b64_tr_b16 a[94:95], v8 offset:20480
 v_xor_b32 v9, 131392, v6
 v_mfma_f32_16x16x32_bf16 v[156:159], a[68:71], a[124:127], v[156:159]
 s_waitcnt lgkmcnt(6)
 ds_read_b64_tr_b16 a[96:97], v9 offset:0
 v_accvgpr_write_b32 a6, v22
 v_mfma_f32_16x16x32_bf16 v[164:167], a[72:75], a[192:195], v[164:167]
 s_add_u32 s59, s56, 40960
 ds_read_b64_tr_b16 a[98:99], v9 offset:4096
 v_accvgpr_write_b32 a7, v23
 v_mfma_f32_16x16x32_bf16 v[164:167], a[76:79], a[200:203], v[164:167]
 ds_read_b64_tr_b16 a[100:101], v9 offset:16384
 buffer_store_dwordx4 v[240:243], v1, s[12:15], s59 offen offset:3072 sc1
 v_mfma_f32_16x16x32_bf16 v[164:167], a[80:83], a[208:211], v[164:167]
 s_waitcnt lgkmcnt(3)
 ds_read_b64_tr_b16 a[102:103], v9 offset:20480
 v_xor_b32 v10, 320, v6
 v_mfma_f32_16x16x32_bf16 v[164:167], a[84:87], a[216:219], v[164:167]
 ds_read_b64_tr_b16 a[104:105], v10 offset:0
 v_mul_f32 v36, s34, v36
 v_mfma_f32_16x16x32_bf16 v[164:167], a[88:91], a[112:115], v[164:167]
 ds_read_b64_tr_b16 a[106:107], v10 offset:4096
 v_mul_f32 v37, s34, v37
 v_mfma_f32_16x16x32_bf16 v[164:167], a[92:95], a[120:123], v[164:167]
 ds_read_b64_tr_b16 a[108:109], v10 offset:16384
 v_mul_f32 v38, s34, v38
 v_mfma_f32_16x16x32_bf16 v[172:175], a[72:75], a[196:199], v[172:175]
 ds_read_b64_tr_b16 a[110:111], v10 offset:20480
 v_xor_b32 v7, 65856, v6
 v_mfma_f32_16x16x32_bf16 v[172:175], a[76:79], a[204:207], v[172:175]
 ds_read_b64_tr_b16 a[64:65], v7 offset:0
 v_mul_f32 v39, s34, v39
 v_mfma_f32_16x16x32_bf16 v[172:175], a[80:83], a[212:215], v[172:175]
 ds_read_b64_tr_b16 a[66:67], v7 offset:4096
 v_mul_f32 v76, s34, v76
 v_mfma_f32_16x16x32_bf16 v[172:175], a[84:87], a[220:223], v[172:175]
 ds_read_b64_tr_b16 a[68:69], v7 offset:16384
 v_mul_f32 v77, s34, v77
 v_mfma_f32_16x16x32_bf16 v[172:175], a[88:91], a[116:119], v[172:175]
 s_add_u32 s59, s56, 32768
 ds_read_b64_tr_b16 a[70:71], v7 offset:20480
 v_xor_b32 v8, 131424, v6
 v_mfma_f32_16x16x32_bf16 v[172:175], a[92:95], a[124:127], v[172:175]
 s_waitcnt lgkmcnt(6)
 ds_read_b64_tr_b16 a[72:73], v8 offset:0
 buffer_store_dwordx4 v[248:251], v1, s[12:15], s59 offen offset:3072 sc1
 v_mfma_f32_16x16x32_bf16 v[180:183], a[96:99], a[192:195], v[180:183]
 ds_read_b64_tr_b16 a[74:75], v8 offset:4096
 v_mul_f32 v78, s34, v78
 v_mfma_f32_16x16x32_bf16 v[180:183], a[100:103], a[200:203], v[180:183]
 ds_read_b64_tr_b16 a[76:77], v8 offset:16384
 v_mul_f32 v79, s34, v79
 v_mfma_f32_16x16x32_bf16 v[180:183], a[104:107], a[208:211], v[180:183]
 s_waitcnt lgkmcnt(3)
 ds_read_b64_tr_b16 a[78:79], v8 offset:20480
 v_xor_b32 v9, 352, v6
 v_mfma_f32_16x16x32_bf16 v[180:183], a[108:111], a[216:219], v[180:183]
 ds_read_b64_tr_b16 a[80:81], v9 offset:0
 v_cvt_pk_bf16_f32 v36, v36, v37
 v_mfma_f32_16x16x32_bf16 v[180:183], a[64:67], a[112:115], v[180:183]
 ds_read_b64_tr_b16 a[82:83], v9 offset:4096
 v_cvt_pk_bf16_f32 v37, v38, v39
 v_mfma_f32_16x16x32_bf16 v[180:183], a[68:71], a[120:123], v[180:183]
 ds_read_b64_tr_b16 a[84:85], v9 offset:16384
 v_cvt_pk_bf16_f32 v38, v76, v77
 v_mfma_f32_16x16x32_bf16 v[188:191], a[96:99], a[196:199], v[188:191]
 ds_read_b64_tr_b16 a[86:87], v9 offset:20480
 v_xor_b32 v10, 65888, v6
 v_mfma_f32_16x16x32_bf16 v[188:191], a[100:103], a[204:207], v[188:191]
 ds_read_b64_tr_b16 a[88:89], v10 offset:0
 v_cvt_pk_bf16_f32 v39, v78, v79
 v_mfma_f32_16x16x32_bf16 v[188:191], a[104:107], a[212:215], v[188:191]
 ds_read_b64_tr_b16 a[90:91], v10 offset:4096
 v_accvgpr_write_b32 a36, v36
 v_mfma_f32_16x16x32_bf16 v[188:191], a[108:111], a[220:223], v[188:191]
 ds_read_b64_tr_b16 a[92:93], v10 offset:16384
 v_accvgpr_write_b32 a37, v37
 v_mfma_f32_16x16x32_bf16 v[188:191], a[64:67], a[116:119], v[188:191]
 ds_read_b64_tr_b16 a[94:95], v10 offset:20480
 v_xor_b32 v7, 131456, v6
 v_mfma_f32_16x16x32_bf16 v[188:191], a[68:71], a[124:127], v[188:191]
 s_waitcnt lgkmcnt(6)
 ds_read_b64_tr_b16 a[96:97], v7 offset:0
 v_accvgpr_write_b32 a38, v38
 v_mfma_f32_16x16x32_bf16 v[196:199], a[72:75], a[192:195], v[196:199]
 ds_read_b64_tr_b16 a[98:99], v7 offset:4096
 v_accvgpr_write_b32 a39, v39
 v_mfma_f32_16x16x32_bf16 v[196:199], a[76:79], a[200:203], v[196:199]
 ds_read_b64_tr_b16 a[100:101], v7 offset:16384
 v_mul_f32 v84, s34, v84
 v_mfma_f32_16x16x32_bf16 v[196:199], a[80:83], a[208:211], v[196:199]
 s_waitcnt lgkmcnt(3)
 ds_read_b64_tr_b16 a[102:103], v7 offset:20480
 v_xor_b32 v8, 384, v6
 v_mfma_f32_16x16x32_bf16 v[196:199], a[84:87], a[216:219], v[196:199]
 ds_read_b64_tr_b16 a[104:105], v8 offset:0
 v_mul_f32 v85, s34, v85
 v_mfma_f32_16x16x32_bf16 v[196:199], a[88:91], a[112:115], v[196:199]
 ds_read_b64_tr_b16 a[106:107], v8 offset:4096
 v_mul_f32 v86, s34, v86
 v_mfma_f32_16x16x32_bf16 v[196:199], a[92:95], a[120:123], v[196:199]
 ds_read_b64_tr_b16 a[108:109], v8 offset:16384
 v_mul_f32 v87, s34, v87
 v_mfma_f32_16x16x32_bf16 v[204:207], a[72:75], a[196:199], v[204:207]
 ds_read_b64_tr_b16 a[110:111], v8 offset:20480
 v_xor_b32 v9, 65920, v6
 v_mfma_f32_16x16x32_bf16 v[204:207], a[76:79], a[204:207], v[204:207]
 ds_read_b64_tr_b16 a[64:65], v9 offset:0
 v_mul_f32 v100, s34, v100
 v_mfma_f32_16x16x32_bf16 v[204:207], a[80:83], a[212:215], v[204:207]
 ds_read_b64_tr_b16 a[66:67], v9 offset:4096
 v_mul_f32 v101, s34, v101
 v_mfma_f32_16x16x32_bf16 v[204:207], a[84:87], a[220:223], v[204:207]
 ds_read_b64_tr_b16 a[68:69], v9 offset:16384
 v_mul_f32 v102, s34, v102
 v_mfma_f32_16x16x32_bf16 v[204:207], a[88:91], a[116:119], v[204:207]
 ds_read_b64_tr_b16 a[70:71], v9 offset:20480
 v_xor_b32 v10, 131488, v6
 v_mfma_f32_16x16x32_bf16 v[204:207], a[92:95], a[124:127], v[204:207]
 s_waitcnt lgkmcnt(6)
 ds_read_b64_tr_b16 a[72:73], v10 offset:0
 v_mul_f32 v103, s34, v103
 v_mfma_f32_16x16x32_bf16 v[212:215], a[96:99], a[192:195], v[212:215]
 ds_read_b64_tr_b16 a[74:75], v10 offset:4096
 v_cvt_pk_bf16_f32 v84, v84, v85
 v_mfma_f32_16x16x32_bf16 v[212:215], a[100:103], a[200:203], v[212:215]
 ds_read_b64_tr_b16 a[76:77], v10 offset:16384
 v_cvt_pk_bf16_f32 v85, v86, v87
 v_mfma_f32_16x16x32_bf16 v[212:215], a[104:107], a[208:211], v[212:215]
 s_waitcnt lgkmcnt(3)
 ds_read_b64_tr_b16 a[78:79], v10 offset:20480
 v_xor_b32 v7, 416, v6
 v_mfma_f32_16x16x32_bf16 v[212:215], a[108:111], a[216:219], v[212:215]
 ds_read_b64_tr_b16 a[80:81], v7 offset:0
 v_cvt_pk_bf16_f32 v86, v100, v101
 v_mfma_f32_16x16x32_bf16 v[212:215], a[64:67], a[112:115], v[212:215]
 ds_read_b64_tr_b16 a[82:83], v7 offset:4096
 v_cvt_pk_bf16_f32 v87, v102, v103
 v_mfma_f32_16x16x32_bf16 v[212:215], a[68:71], a[120:123], v[212:215]
 ds_read_b64_tr_b16 a[84:85], v7 offset:16384
 v_accvgpr_write_b32 a8, v84
 v_mfma_f32_16x16x32_bf16 v[220:223], a[96:99], a[196:199], v[220:223]
 ds_read_b64_tr_b16 a[86:87], v7 offset:20480
 v_xor_b32 v8, 65952, v6
 v_mfma_f32_16x16x32_bf16 v[220:223], a[100:103], a[204:207], v[220:223]
 ds_read_b64_tr_b16 a[88:89], v8 offset:0
 v_accvgpr_write_b32 a9, v85
 v_mfma_f32_16x16x32_bf16 v[220:223], a[104:107], a[212:215], v[220:223]
 ds_read_b64_tr_b16 a[90:91], v8 offset:4096
 v_accvgpr_write_b32 a10, v86
 v_mfma_f32_16x16x32_bf16 v[220:223], a[108:111], a[220:223], v[220:223]
 ds_read_b64_tr_b16 a[92:93], v8 offset:16384
 v_accvgpr_write_b32 a11, v87
 v_mfma_f32_16x16x32_bf16 v[220:223], a[64:67], a[116:119], v[220:223]
 ds_read_b64_tr_b16 a[94:95], v8 offset:20480
 v_xor_b32 v9, 131520, v6
 v_mfma_f32_16x16x32_bf16 v[220:223], a[68:71], a[124:127], v[220:223]
 s_waitcnt lgkmcnt(6)
 ds_read_b64_tr_b16 a[96:97], v9 offset:0
 v_mul_f32 v92, s34, v92
 v_mfma_f32_16x16x32_bf16 v[228:231], a[72:75], a[192:195], v[228:231]
 ds_read_b64_tr_b16 a[98:99], v9 offset:4096
 v_mul_f32 v93, s34, v93
 v_mfma_f32_16x16x32_bf16 v[228:231], a[76:79], a[200:203], v[228:231]
 ds_read_b64_tr_b16 a[100:101], v9 offset:16384
 v_mul_f32 v94, s34, v94
 v_mfma_f32_16x16x32_bf16 v[228:231], a[80:83], a[208:211], v[228:231]
 s_waitcnt lgkmcnt(3)
 ds_read_b64_tr_b16 a[102:103], v9 offset:20480
 v_xor_b32 v10, 448, v6
 v_mfma_f32_16x16x32_bf16 v[228:231], a[84:87], a[216:219], v[228:231]
 ds_read_b64_tr_b16 a[104:105], v10 offset:0
 v_mul_f32 v95, s34, v95
 v_mfma_f32_16x16x32_bf16 v[228:231], a[88:91], a[112:115], v[228:231]
 ds_read_b64_tr_b16 a[106:107], v10 offset:4096
 v_mul_f32 v108, s34, v108
 v_mfma_f32_16x16x32_bf16 v[228:231], a[92:95], a[120:123], v[228:231]
 ds_read_b64_tr_b16 a[108:109], v10 offset:16384
 v_mul_f32 v109, s34, v109
 v_mfma_f32_16x16x32_bf16 v[236:239], a[72:75], a[196:199], v[236:239]
 ds_read_b64_tr_b16 a[110:111], v10 offset:20480
 v_xor_b32 v7, 65984, v6
 v_mfma_f32_16x16x32_bf16 v[236:239], a[76:79], a[204:207], v[236:239]
 ds_read_b64_tr_b16 a[64:65], v7 offset:0
 buffer_load_dword v13, v12, s[12:15], s58 offen sc1
 v_mfma_f32_16x16x32_bf16 v[236:239], a[80:83], a[212:215], v[236:239]
 ds_read_b64_tr_b16 a[66:67], v7 offset:4096
 v_mul_f32 v110, s34, v110
 v_mfma_f32_16x16x32_bf16 v[236:239], a[84:87], a[220:223], v[236:239]
 ds_read_b64_tr_b16 a[68:69], v7 offset:16384
 v_mul_f32 v111, s34, v111
 v_mfma_f32_16x16x32_bf16 v[236:239], a[88:91], a[116:119], v[236:239]
 ds_read_b64_tr_b16 a[70:71], v7 offset:20480
 v_xor_b32 v8, 131552, v6
 v_mfma_f32_16x16x32_bf16 v[236:239], a[92:95], a[124:127], v[236:239]
 s_waitcnt lgkmcnt(6)
 ds_read_b64_tr_b16 a[72:73], v8 offset:0
 v_cvt_pk_bf16_f32 v92, v92, v93
 v_mfma_f32_16x16x32_bf16 v[244:247], a[96:99], a[192:195], v[244:247]
 ds_read_b64_tr_b16 a[74:75], v8 offset:4096
 v_cvt_pk_bf16_f32 v93, v94, v95
 v_mfma_f32_16x16x32_bf16 v[244:247], a[100:103], a[200:203], v[244:247]
 ds_read_b64_tr_b16 a[76:77], v8 offset:16384
 v_cvt_pk_bf16_f32 v94, v108, v109
 v_mfma_f32_16x16x32_bf16 v[244:247], a[104:107], a[208:211], v[244:247]
 s_waitcnt lgkmcnt(3)
 ds_read_b64_tr_b16 a[78:79], v8 offset:20480
 v_xor_b32 v9, 480, v6
 v_mfma_f32_16x16x32_bf16 v[244:247], a[108:111], a[216:219], v[244:247]
 ds_read_b64_tr_b16 a[80:81], v9 offset:0
 v_cvt_pk_bf16_f32 v95, v110, v111
 v_mfma_f32_16x16x32_bf16 v[244:247], a[64:67], a[112:115], v[244:247]
 ds_read_b64_tr_b16 a[82:83], v9 offset:4096
 v_accvgpr_write_b32 a40, v92
 v_mfma_f32_16x16x32_bf16 v[244:247], a[68:71], a[120:123], v[244:247]
 ds_read_b64_tr_b16 a[84:85], v9 offset:16384
 v_accvgpr_write_b32 a41, v93
 v_mfma_f32_16x16x32_bf16 v[252:255], a[96:99], a[196:199], v[252:255]
 ds_read_b64_tr_b16 a[86:87], v9 offset:20480
 v_xor_b32 v10, 66016, v6
 v_mfma_f32_16x16x32_bf16 v[252:255], a[100:103], a[204:207], v[252:255]
 ds_read_b64_tr_b16 a[88:89], v10 offset:0
 v_accvgpr_write_b32 a42, v94
 v_mfma_f32_16x16x32_bf16 v[252:255], a[104:107], a[212:215], v[252:255]
 ds_read_b64_tr_b16 a[90:91], v10 offset:4096
 v_accvgpr_write_b32 a43, v95
 v_mfma_f32_16x16x32_bf16 v[252:255], a[108:111], a[220:223], v[252:255]
 ds_read_b64_tr_b16 a[92:93], v10 offset:16384
 v_mfma_f32_16x16x32_bf16 v[252:255], a[64:67], a[116:119], v[252:255]
 ds_read_b64_tr_b16 a[94:95], v10 offset:20480
 v_mfma_f32_16x16x32_bf16 v[252:255], a[68:71], a[124:127], v[252:255]
 s_waitcnt lgkmcnt(6)
 v_mfma_f32_16x16x32_bf16 v[16:19], a[72:75], a[192:195], v[16:19]
 v_mfma_f32_16x16x32_bf16 v[16:19], a[76:79], a[200:203], v[16:19]
 v_mfma_f32_16x16x32_bf16 v[16:19], a[80:83], a[208:211], v[16:19]
 s_waitcnt lgkmcnt(0)
 v_mfma_f32_16x16x32_bf16 v[16:19], a[84:87], a[216:219], v[16:19]
 v_mfma_f32_16x16x32_bf16 v[16:19], a[88:91], a[112:115], v[16:19]
 v_mfma_f32_16x16x32_bf16 v[16:19], a[92:95], a[120:123], v[16:19]
 v_mfma_f32_16x16x32_bf16 v[24:27], a[72:75], a[196:199], v[24:27]
 v_mfma_f32_16x16x32_bf16 v[24:27], a[76:79], a[204:207], v[24:27]
 v_mfma_f32_16x16x32_bf16 v[24:27], a[80:83], a[212:215], v[24:27]
 v_mfma_f32_16x16x32_bf16 v[24:27], a[84:87], a[220:223], v[24:27]
 s_waitcnt lgkmcnt(0)
 v_mfma_f32_16x16x32_bf16 v[24:27], a[88:91], a[116:119], v[24:27]
 s_barrier
 v_mfma_f32_16x16x32_bf16 v[24:27], a[92:95], a[124:127], v[24:27]
 s_waitcnt vmcnt(0)
 v_cmp_ne_u32 s[16:17], 0, v13
 v_cmp_gt_u32 vcc, 256, v5
 s_or_b64 vcc, vcc, s[16:17]
 s_mov_b32 m0, s40
 s_cselect_b32 s48, 0, 1
 s_cselect_b32 s52, 2.0, s42
 buffer_load_dwordx4 v1, s[12:15], s52 offen offset:0 sc1 lds
 v_pk_mul_f32 v[116:117], v[116:117], s[34:35]
 v_pk_mul_f32 v[118:119], v[118:119], s[34:35]
 v_pk_mul_f32 v[132:133], v[132:133], s[34:35]
 v_pk_mul_f32 v[134:135], v[134:135], s[34:35]
 v_cvt_pk_bf16_f32 v116, v116, v117
 v_cvt_pk_bf16_f32 v117, v118, v119
 v_cvt_pk_bf16_f32 v118, v132, v133
 v_cvt_pk_bf16_f32 v119, v134, v135
 v_accvgpr_write_b32 a12, v116
 v_accvgpr_write_b32 a13, v117
 v_accvgpr_write_b32 a14, v118
 v_accvgpr_write_b32 a15, v119
 v_pk_mul_f32 v[124:125], v[124:125], s[34:35]
 v_pk_mul_f32 v[126:127], v[126:127], s[34:35]
 v_pk_mul_f32 v[140:141], v[140:141], s[34:35]
 buffer_load_dwordx4 v1, s[12:15], s52 offen offset:1024 sc1 lds
 v_pk_mul_f32 v[142:143], v[142:143], s[34:35]
 v_cvt_pk_bf16_f32 v124, v124, v125
 v_cvt_pk_bf16_f32 v125, v126, v127
 v_cvt_pk_bf16_f32 v126, v140, v141
 v_cvt_pk_bf16_f32 v127, v142, v143
 v_accvgpr_write_b32 a44, v124
 v_accvgpr_write_b32 a45, v125
 v_accvgpr_write_b32 a46, v126
 v_accvgpr_write_b32 a47, v127
 v_pk_mul_f32 v[148:149], v[148:149], s[34:35]
 v_pk_mul_f32 v[150:151], v[150:151], s[34:35]
 v_pk_mul_f32 v[164:165], v[164:165], s[34:35]
 v_pk_mul_f32 v[166:167], v[166:167], s[34:35]
 v_cvt_pk_bf16_f32 v148, v148, v149
 v_cvt_pk_bf16_f32 v149, v150, v151
 buffer_load_dwordx4 v1, s[12:15], s52 offen offset:2048 sc1 lds
 v_cvt_pk_bf16_f32 v150, v164, v165
 v_cvt_pk_bf16_f32 v151, v166, v167
 v_accvgpr_write_b32 a16, v148
 v_accvgpr_write_b32 a17, v149
 v_accvgpr_write_b32 a18, v150
 v_accvgpr_write_b32 a19, v151
 v_pk_mul_f32 v[156:157], v[156:157], s[34:35]
 v_pk_mul_f32 v[158:159], v[158:159], s[34:35]
 v_pk_mul_f32 v[172:173], v[172:173], s[34:35]
 v_pk_mul_f32 v[174:175], v[174:175], s[34:35]
 v_cvt_pk_bf16_f32 v156, v156, v157
 v_cvt_pk_bf16_f32 v157, v158, v159
 v_cvt_pk_bf16_f32 v158, v172, v173
 v_cvt_pk_bf16_f32 v159, v174, v175
 v_accvgpr_write_b32 a48, v156
 buffer_load_dwordx4 v1, s[12:15], s52 offen offset:3072 sc1 lds
 v_accvgpr_write_b32 a49, v157
 v_accvgpr_write_b32 a50, v158
 v_accvgpr_write_b32 a51, v159
 v_pk_mul_f32 v[180:181], v[180:181], s[34:35]
 v_pk_mul_f32 v[182:183], v[182:183], s[34:35]
 v_pk_mul_f32 v[196:197], v[196:197], s[34:35]
 v_pk_mul_f32 v[198:199], v[198:199], s[34:35]
 v_cvt_pk_bf16_f32 v180, v180, v181
 v_cvt_pk_bf16_f32 v181, v182, v183
 v_cvt_pk_bf16_f32 v182, v196, v197
 v_cvt_pk_bf16_f32 v183, v198, v199
 v_accvgpr_write_b32 a20, v180
 v_accvgpr_write_b32 a21, v181
 v_accvgpr_write_b32 a22, v182
 v_accvgpr_write_b32 a23, v183
 s_bitset1_b32 m0, 12
 s_nop 0
 buffer_load_dwordx4 v4, s[12:15], s52 offen offset:0 sc1 lds
 v_pk_mul_f32 v[188:189], v[188:189], s[34:35]
 v_pk_mul_f32 v[190:191], v[190:191], s[34:35]
 v_pk_mul_f32 v[204:205], v[204:205], s[34:35]
 v_pk_mul_f32 v[206:207], v[206:207], s[34:35]
 v_cvt_pk_bf16_f32 v188, v188, v189
 v_cvt_pk_bf16_f32 v189, v190, v191
 v_cvt_pk_bf16_f32 v190, v204, v205
 v_cvt_pk_bf16_f32 v191, v206, v207
 v_accvgpr_write_b32 a52, v188
 v_accvgpr_write_b32 a53, v189
 v_accvgpr_write_b32 a54, v190
 v_accvgpr_write_b32 a55, v191
 v_pk_mul_f32 v[212:213], v[212:213], s[34:35]
 v_pk_mul_f32 v[214:215], v[214:215], s[34:35]
 v_pk_mul_f32 v[228:229], v[228:229], s[34:35]
 buffer_load_dwordx4 v4, s[12:15], s52 offen offset:1024 sc1 lds
 v_pk_mul_f32 v[230:231], v[230:231], s[34:35]
 v_cvt_pk_bf16_f32 v212, v212, v213
 v_cvt_pk_bf16_f32 v213, v214, v215
 v_cvt_pk_bf16_f32 v214, v228, v229
 v_cvt_pk_bf16_f32 v215, v230, v231
 v_accvgpr_write_b32 a24, v212
 v_accvgpr_write_b32 a25, v213
 v_accvgpr_write_b32 a26, v214
 v_accvgpr_write_b32 a27, v215
 v_pk_mul_f32 v[220:221], v[220:221], s[34:35]
 v_pk_mul_f32 v[222:223], v[222:223], s[34:35]
 v_pk_mul_f32 v[236:237], v[236:237], s[34:35]
 v_pk_mul_f32 v[238:239], v[238:239], s[34:35]
 v_cvt_pk_bf16_f32 v220, v220, v221
 v_cvt_pk_bf16_f32 v221, v222, v223
 buffer_load_dwordx4 v4, s[12:15], s52 offen offset:2048 sc1 lds
 v_cvt_pk_bf16_f32 v222, v236, v237
 v_cvt_pk_bf16_f32 v223, v238, v239
 v_accvgpr_write_b32 a56, v220
 v_accvgpr_write_b32 a57, v221
 v_accvgpr_write_b32 a58, v222
 v_accvgpr_write_b32 a59, v223
 v_pk_mul_f32 v[244:245], v[244:245], s[34:35]
 v_pk_mul_f32 v[246:247], v[246:247], s[34:35]
 v_pk_mul_f32 v[16:17], v[16:17], s[34:35]
 v_pk_mul_f32 v[18:19], v[18:19], s[34:35]
 v_cvt_pk_bf16_f32 v244, v244, v245
 v_cvt_pk_bf16_f32 v245, v246, v247
 v_cvt_pk_bf16_f32 v246, v16, v17
 v_cvt_pk_bf16_f32 v247, v18, v19
 v_accvgpr_write_b32 a28, v244
 buffer_load_dwordx4 v4, s[12:15], s52 offen offset:3072 sc1 lds
 v_accvgpr_write_b32 a29, v245
 v_accvgpr_write_b32 a30, v246
 v_accvgpr_write_b32 a31, v247
 v_pk_mul_f32 v[252:253], v[252:253], s[34:35]
 v_pk_mul_f32 v[254:255], v[254:255], s[34:35]
 v_pk_mul_f32 v[24:25], v[24:25], s[34:35]
 v_pk_mul_f32 v[26:27], v[26:27], s[34:35]
 v_cvt_pk_bf16_f32 v252, v252, v253
 v_cvt_pk_bf16_f32 v253, v254, v255
 v_cvt_pk_bf16_f32 v254, v24, v25
 v_cvt_pk_bf16_f32 v255, v26, v27
 v_accvgpr_write_b32 a60, v252
 v_accvgpr_write_b32 a61, v253
 v_accvgpr_write_b32 a62, v254
 v_accvgpr_write_b32 a63, v255
 s_branch L_kvdone
L_kloop_side:
 s_mov_b64 exec, 1
 global_atomic_add v3, v15, s[90:91] offset:128 sc1
 s_mov_b64 exec, -1
 s_mov_b32 s55, 6
 s_branch L_kloop
L_vloop_side:
 s_mov_b64 exec, 1
 global_atomic_add v3, v15, s[90:91] offset:128 sc1
 s_mov_b64 exec, -1
 s_mov_b32 s55, 6
 s_branch L_vloop
L_vloop_head:
 v_mfma_f32_16x16x32_bf16 v[64:67], a[64:67], a[0:3], 0
 s_add_u32 m0, s29, 118784
 ds_read_b64_tr_b16 a[24:25], v9 offset:0
 v_mfma_f32_16x16x32_bf16 v[64:67], a[68:71], a[4:7], v[64:67]
 ds_read_b64_tr_b16 a[26:27], v9 offset:4096
 buffer_load_dwordx4 v2, s[8:11], s52 offen  lds
 v_mfma_f32_16x16x32_bf16 v[68:71], a[76:79], a[4:7], 0
 ds_read_b64_tr_b16 a[28:29], v9 offset:16384
 v_mfma_f32_16x16x32_bf16 v[68:71], a[72:75], a[0:3], v[68:71]
 ds_read_b64_tr_b16 a[30:31], v9 offset:20480
 v_mfma_f32_16x16x32_bf16 v[72:75], a[80:83], a[0:3], 0
 s_add_u32 m0, s29, 53248
 ds_read_b128 a[96:99], v4 offset:8192
 v_mfma_f32_16x16x32_bf16 v[72:75], a[84:87], a[4:7], v[72:75]
 buffer_load_dwordx4 v1, s[4:7], s45 offen  lds
 v_mfma_f32_16x16x32_bf16 v[76:79], a[92:95], a[4:7], 0
 ds_read_b128 a[100:103], v5 offset:8192
 v_mfma_f32_16x16x32_bf16 v[76:79], a[88:91], a[0:3], v[76:79]
 v_mfma_f32_16x16x32_bf16 v[84:87], a[88:91], a[8:11], 0
 s_add_u32 m0, s29, 122880
 ds_read_b128 a[108:111], v5 offset:10240
 v_mfma_f32_16x16x32_bf16 v[84:87], a[92:95], a[12:15], v[84:87]
 buffer_load_dwordx4 v2, s[8:11], s53 offen  lds
 v_mfma_f32_16x16x32_bf16 v[80:83], a[84:87], a[12:15], 0
 ds_read_b128 a[104:107], v4 offset:10240
 v_mfma_f32_16x16x32_bf16 v[80:83], a[80:83], a[8:11], v[80:83]
 v_mfma_f32_16x16x32_bf16 v[92:95], a[72:75], a[8:11], 0
 s_add_u32 m0, s29, 57344
 ds_read_b128 a[112:115], v4 offset:12288
 v_mfma_f32_16x16x32_bf16 v[92:95], a[76:79], a[12:15], v[92:95]
 buffer_load_dwordx4 v1, s[4:7], s46 offen  lds
 v_mfma_f32_16x16x32_bf16 v[88:91], a[68:71], a[12:15], 0
 ds_read_b128 a[116:119], v5 offset:12288
 v_mfma_f32_16x16x32_bf16 v[88:91], a[64:67], a[8:11], v[88:91]
 v_mfma_f32_16x16x32_bf16 v[96:99], a[64:67], a[16:19], 0
 s_add_u32 m0, s29, 126976
 ds_read_b128 a[124:127], v5 offset:14336
 v_mfma_f32_16x16x32_bf16 v[96:99], a[68:71], a[20:23], v[96:99]
 buffer_load_dwordx4 v2, s[8:11], s54 offen  lds
 v_mfma_f32_16x16x32_bf16 v[100:103], a[76:79], a[20:23], 0
 ds_read_b128 a[120:123], v4 offset:14336
 v_mfma_f32_16x16x32_bf16 v[100:103], a[72:75], a[16:19], v[100:103]
 v_mfma_f32_16x16x32_bf16 v[104:107], a[80:83], a[16:19], 0
 s_add_u32 m0, s29, 61440
 ds_read_b64_tr_b16 a[32:33], v10 offset:0
 v_mfma_f32_16x16x32_bf16 v[104:107], a[84:87], a[20:23], v[104:107]
 ds_read_b64_tr_b16 a[34:35], v10 offset:4096
 buffer_load_dwordx4 v1, s[4:7], s47 offen  lds
 v_mfma_f32_16x16x32_bf16 v[108:111], a[92:95], a[20:23], 0
 ds_read_b64_tr_b16 a[36:37], v10 offset:16384
 v_add_u32 v1, 128, v1
 v_mfma_f32_16x16x32_bf16 v[108:111], a[88:91], a[16:19], v[108:111]
 s_waitcnt lgkmcnt(8)
 ds_read_b64_tr_b16 a[38:39], v10 offset:20480
 v_add_u32 v2, 0x80000, v2
 v_mfma_f32_16x16x32_bf16 v[116:119], a[88:91], a[24:27], 0
 ds_read_b64_tr_b16 a[40:41], v11 offset:0
 v_mfma_f32_16x16x32_bf16 v[116:119], a[92:95], a[28:31], v[116:119]
 ds_read_b64_tr_b16 a[42:43], v11 offset:4096
 v_mfma_f32_16x16x32_bf16 v[112:115], a[84:87], a[28:31], 0
 ds_read_b64_tr_b16 a[44:45], v11 offset:16384
 v_mfma_f32_16x16x32_bf16 v[112:115], a[80:83], a[24:27], v[112:115]
 ds_read_b64_tr_b16 a[46:47], v11 offset:20480
 v_mfma_f32_16x16x32_bf16 v[124:127], a[72:75], a[24:27], 0
 ds_read_b64_tr_b16 a[48:49], v12 offset:0
 v_mfma_f32_16x16x32_bf16 v[124:127], a[76:79], a[28:31], v[124:127]
 ds_read_b64_tr_b16 a[50:51], v12 offset:4096
 v_mfma_f32_16x16x32_bf16 v[120:123], a[68:71], a[28:31], 0
 ds_read_b64_tr_b16 a[52:53], v12 offset:16384
 v_mfma_f32_16x16x32_bf16 v[120:123], a[64:67], a[24:27], v[120:123]
 ds_read_b64_tr_b16 a[54:55], v12 offset:20480
 v_mfma_f32_16x16x32_bf16 v[16:19], a[96:99], a[0:3], 0
 ds_read_b64_tr_b16 a[56:57], v13 offset:0
 v_mfma_f32_16x16x32_bf16 v[16:19], a[100:103], a[4:7], v[16:19]
 ds_read_b64_tr_b16 a[58:59], v13 offset:4096
 v_mfma_f32_16x16x32_bf16 v[20:23], a[108:111], a[4:7], 0
 s_waitcnt lgkmcnt(8)
 ds_read_b64_tr_b16 a[60:61], v13 offset:16384
 v_mfma_f32_16x16x32_bf16 v[20:23], a[104:107], a[0:3], v[20:23]
 ds_read_b64_tr_b16 a[62:63], v13 offset:20480
 v_mfma_f32_16x16x32_bf16 v[24:27], a[112:115], a[0:3], 0
 v_mfma_f32_16x16x32_bf16 v[24:27], a[116:119], a[4:7], v[24:27]
 v_mfma_f32_16x16x32_bf16 v[28:31], a[124:127], a[4:7], 0
 v_mfma_f32_16x16x32_bf16 v[28:31], a[120:123], a[0:3], v[28:31]
 s_waitcnt lgkmcnt(0)
 v_mfma_f32_16x16x32_bf16 a[228:231], a[120:123], a[8:11], 0
 s_barrier
 v_mfma_f32_16x16x32_bf16 a[228:231], a[124:127], a[12:15], a[228:231]
 s_add_u32 m0, s29, 65536
 v_mfma_f32_16x16x32_bf16 a[224:227], a[116:119], a[12:15], 0
 buffer_load_dwordx4 v2, s[8:11], 0 offen  lds
 v_mfma_f32_16x16x32_bf16 a[224:227], a[112:115], a[8:11], a[224:227]
 v_mfma_f32_16x16x32_bf16 a[236:239], a[104:107], a[8:11], 0
 v_mfma_f32_16x16x32_bf16 a[236:239], a[108:111], a[12:15], a[236:239]
 v_mfma_f32_16x16x32_bf16 a[232:235], a[100:103], a[12:15], 0
 s_add_u32 m0, s29, 0
 v_mfma_f32_16x16x32_bf16 a[232:235], a[96:99], a[8:11], a[232:235]
 buffer_load_dwordx4 v1, s[4:7], 0 offen  lds
 v_mfma_f32_16x16x32_bf16 v[32:35], a[96:99], a[16:19], 0
 v_mfma_f32_16x16x32_bf16 v[32:35], a[100:103], a[20:23], v[32:35]
 v_mfma_f32_16x16x32_bf16 v[36:39], a[108:111], a[20:23], 0
 v_mfma_f32_16x16x32_bf16 v[36:39], a[104:107], a[16:19], v[36:39]
 s_add_u32 m0, s29, 69632
 v_mfma_f32_16x16x32_bf16 v[40:43], a[112:115], a[16:19], 0
 buffer_load_dwordx4 v2, s[8:11], s48 offen  lds
 v_mfma_f32_16x16x32_bf16 v[40:43], a[116:119], a[20:23], v[40:43]
 v_mfma_f32_16x16x32_bf16 v[44:47], a[124:127], a[20:23], 0
 v_mfma_f32_16x16x32_bf16 v[44:47], a[120:123], a[16:19], v[44:47]
 v_mfma_f32_16x16x32_bf16 v[52:55], a[120:123], a[24:27], 0
 s_add_u32 m0, s29, 4096
 v_mfma_f32_16x16x32_bf16 v[52:55], a[124:127], a[28:31], v[52:55]
 buffer_load_dwordx4 v1, s[4:7], s41 offen  lds
 v_mfma_f32_16x16x32_bf16 v[48:51], a[116:119], a[28:31], 0
 v_mfma_f32_16x16x32_bf16 v[48:51], a[112:115], a[24:27], v[48:51]
 v_mfma_f32_16x16x32_bf16 v[60:63], a[104:107], a[24:27], 0
 v_mfma_f32_16x16x32_bf16 v[60:63], a[108:111], a[28:31], v[60:63]
 s_add_u32 m0, s29, 73728
 v_mfma_f32_16x16x32_bf16 v[56:59], a[100:103], a[28:31], 0
 buffer_load_dwordx4 v2, s[8:11], s49 offen  lds
 v_mfma_f32_16x16x32_bf16 v[56:59], a[96:99], a[24:27], v[56:59]
 v_mfma_f32_16x16x32_bf16 v[192:195], a[96:99], a[32:35], 0
 v_mfma_f32_16x16x32_bf16 v[192:195], a[100:103], a[36:39], v[192:195]
 v_mfma_f32_16x16x32_bf16 v[196:199], a[108:111], a[36:39], 0
 s_add_u32 m0, s29, 8192
 v_mfma_f32_16x16x32_bf16 v[196:199], a[104:107], a[32:35], v[196:199]
 buffer_load_dwordx4 v1, s[4:7], s42 offen  lds
 v_mfma_f32_16x16x32_bf16 v[200:203], a[112:115], a[32:35], 0
 v_mfma_f32_16x16x32_bf16 v[200:203], a[116:119], a[36:39], v[200:203]
 v_mfma_f32_16x16x32_bf16 v[204:207], a[124:127], a[36:39], 0
 v_mfma_f32_16x16x32_bf16 v[204:207], a[120:123], a[32:35], v[204:207]
 s_add_u32 m0, s29, 77824
 v_mfma_f32_16x16x32_bf16 v[212:215], a[120:123], a[40:43], 0
 buffer_load_dwordx4 v2, s[8:11], s50 offen  lds
 v_mfma_f32_16x16x32_bf16 v[212:215], a[124:127], a[44:47], v[212:215]
 v_mfma_f32_16x16x32_bf16 v[208:211], a[116:119], a[44:47], 0
 v_mfma_f32_16x16x32_bf16 v[208:211], a[112:115], a[40:43], v[208:211]
 v_mfma_f32_16x16x32_bf16 v[220:223], a[104:107], a[40:43], 0
 s_add_u32 m0, s29, 12288
 v_mfma_f32_16x16x32_bf16 v[220:223], a[108:111], a[44:47], v[220:223]
 buffer_load_dwordx4 v1, s[4:7], s43 offen  lds
 v_mfma_f32_16x16x32_bf16 v[216:219], a[100:103], a[44:47], 0
 v_mfma_f32_16x16x32_bf16 v[216:219], a[96:99], a[40:43], v[216:219]
 v_mfma_f32_16x16x32_bf16 v[224:227], a[96:99], a[48:51], 0
 v_mfma_f32_16x16x32_bf16 v[224:227], a[100:103], a[52:55], v[224:227]
 s_add_u32 m0, s29, 81920
 v_mfma_f32_16x16x32_bf16 v[228:231], a[108:111], a[52:55], 0
 buffer_load_dwordx4 v2, s[8:11], s51 offen  lds
 v_mfma_f32_16x16x32_bf16 v[228:231], a[104:107], a[48:51], v[228:231]
 v_mfma_f32_16x16x32_bf16 v[232:235], a[112:115], a[48:51], 0
 v_mfma_f32_16x16x32_bf16 v[232:235], a[116:119], a[52:55], v[232:235]
 v_mfma_f32_16x16x32_bf16 v[236:239], a[124:127], a[52:55], 0
 s_add_u32 m0, s29, 16384
 v_mfma_f32_16x16x32_bf16 v[236:239], a[120:123], a[48:51], v[236:239]
 buffer_load_dwordx4 v1, s[4:7], s44 offen  lds
 v_mfma_f32_16x16x32_bf16 v[244:247], a[120:123], a[56:59], 0
 v_mfma_f32_16x16x32_bf16 v[244:247], a[124:127], a[60:63], v[244:247]
 v_mfma_f32_16x16x32_bf16 v[240:243], a[116:119], a[60:63], 0
 v_mfma_f32_16x16x32_bf16 v[240:243], a[112:115], a[56:59], v[240:243]
 s_add_u32 m0, s29, 86016
 v_mfma_f32_16x16x32_bf16 v[252:255], a[104:107], a[56:59], 0
 s_waitcnt vmcnt(10)
 buffer_load_dwordx4 v2, s[8:11], s52 offen  lds
 v_mfma_f32_16x16x32_bf16 v[252:255], a[108:111], a[60:63], v[252:255]
 s_barrier
 ds_read_b64_tr_b16 a[0:1], v6 offset:32768
 v_mfma_f32_16x16x32_bf16 v[248:251], a[100:103], a[60:63], 0
 ds_read_b64_tr_b16 a[2:3], v6 offset:36864
 v_mfma_f32_16x16x32_bf16 v[248:251], a[96:99], a[56:59], v[248:251]
 ds_read_b128 a[96:99], v4 offset:40960
 v_mfma_f32_16x16x32_bf16 v[128:131], a[64:67], a[32:35], 0
 s_add_u32 m0, s29, 20480
 v_mfma_f32_16x16x32_bf16 v[128:131], a[68:71], a[36:39], v[128:131]
 buffer_load_dwordx4 v1, s[4:7], s45 offen  lds
 v_mfma_f32_16x16x32_bf16 v[132:135], a[76:79], a[36:39], 0
 ds_read_b64_tr_b16 a[4:5], v6 offset:49152
 v_mfma_f32_16x16x32_bf16 v[132:135], a[72:75], a[32:35], v[132:135]
 ds_read_b64_tr_b16 a[6:7], v6 offset:53248
 v_mfma_f32_16x16x32_bf16 v[136:139], a[80:83], a[32:35], 0
 ds_read_b128 a[100:103], v5 offset:40960
 v_mfma_f32_16x16x32_bf16 v[136:139], a[84:87], a[36:39], v[136:139]
 s_add_u32 m0, s29, 90112
 v_mfma_f32_16x16x32_bf16 v[140:143], a[92:95], a[36:39], 0
 buffer_load_dwordx4 v2, s[8:11], s53 offen  lds
 v_mfma_f32_16x16x32_bf16 v[140:143], a[88:91], a[32:35], v[140:143]
 ds_read_b128 a[108:111], v5 offset:43008
 v_mfma_f32_16x16x32_bf16 v[148:151], a[88:91], a[40:43], 0
 v_mfma_f32_16x16x32_bf16 v[148:151], a[92:95], a[44:47], v[148:151]
 ds_read_b128 a[104:107], v4 offset:43008
 v_mfma_f32_16x16x32_bf16 v[144:147], a[84:87], a[44:47], 0
 s_add_u32 m0, s29, 24576
 v_mfma_f32_16x16x32_bf16 v[144:147], a[80:83], a[40:43], v[144:147]
 buffer_load_dwordx4 v1, s[4:7], s46 offen  lds
 v_mfma_f32_16x16x32_bf16 v[156:159], a[72:75], a[40:43], 0
 ds_read_b128 a[112:115], v4 offset:45056
 v_mfma_f32_16x16x32_bf16 v[156:159], a[76:79], a[44:47], v[156:159]
 v_mfma_f32_16x16x32_bf16 v[152:155], a[68:71], a[44:47], 0
 ds_read_b128 a[116:119], v5 offset:45056
 v_mfma_f32_16x16x32_bf16 v[152:155], a[64:67], a[40:43], v[152:155]
 s_add_u32 m0, s29, 94208
 v_mfma_f32_16x16x32_bf16 v[160:163], a[64:67], a[48:51], 0
 buffer_load_dwordx4 v2, s[8:11], s54 offen  lds
 v_mfma_f32_16x16x32_bf16 v[160:163], a[68:71], a[52:55], v[160:163]
 ds_read_b128 a[124:127], v5 offset:47104
 v_mfma_f32_16x16x32_bf16 v[164:167], a[76:79], a[52:55], 0
 v_mfma_f32_16x16x32_bf16 v[164:167], a[72:75], a[48:51], v[164:167]
 ds_read_b128 a[120:123], v4 offset:47104
 v_mfma_f32_16x16x32_bf16 v[168:171], a[80:83], a[48:51], 0
 s_add_u32 m0, s29, 28672
 v_mfma_f32_16x16x32_bf16 v[168:171], a[84:87], a[52:55], v[168:171]
 buffer_load_dwordx4 v1, s[4:7], s47 offen  lds
 v_mfma_f32_16x16x32_bf16 v[172:175], a[92:95], a[52:55], 0
 v_mfma_f32_16x16x32_bf16 v[172:175], a[88:91], a[48:51], v[172:175]
 ds_read_b64_tr_b16 a[8:9], v7 offset:32768
 v_mfma_f32_16x16x32_bf16 v[180:183], a[88:91], a[56:59], 0
 v_mfma_f32_16x16x32_bf16 v[180:183], a[92:95], a[60:63], v[180:183]
 ds_read_b64_tr_b16 a[10:11], v7 offset:36864
 v_mfma_f32_16x16x32_bf16 v[176:179], a[84:87], a[60:63], 0
 ds_read_b64_tr_b16 a[12:13], v7 offset:49152
 v_mfma_f32_16x16x32_bf16 v[176:179], a[80:83], a[56:59], v[176:179]
 ds_read_b64_tr_b16 a[14:15], v7 offset:53248
 v_mfma_f32_16x16x32_bf16 v[188:191], a[72:75], a[56:59], 0
 ds_read_b64_tr_b16 a[16:17], v8 offset:32768
 v_mfma_f32_16x16x32_bf16 v[188:191], a[76:79], a[60:63], v[188:191]
 ds_read_b64_tr_b16 a[18:19], v8 offset:36864
 v_mfma_f32_16x16x32_bf16 v[184:187], a[68:71], a[60:63], 0
 ds_read_b64_tr_b16 a[20:21], v8 offset:49152
 v_mfma_f32_16x16x32_bf16 v[184:187], a[64:67], a[56:59], v[184:187]
 s_waitcnt lgkmcnt(8)
 ds_read_b64_tr_b16 a[22:23], v8 offset:53248
 v_add_u32 v1, 128, v1
 v_add_u32 v2, 0x80000, v2
 s_add_u32 s56, s56, s30
 buffer_load_dword a243, v14, s[36:39], s56 offen
 s_add_u32 s56, s56, s30
 buffer_load_dword a243, v14, s[36:39], s56 offen
 s_add_u32 s56, s56, s30
 s_branch L_vloop_mid
.p2align 6
L_vloop:
 v_mfma_f32_16x16x32_bf16 v[64:67], a[64:67], a[0:3], v[64:67]
 ds_read_b64_tr_b16 a[24:25], v9 offset:0
 v_mfma_f32_16x16x32_bf16 v[64:67], a[68:71], a[4:7], v[64:67]
 ds_read_b64_tr_b16 a[26:27], v9 offset:4096
 v_mfma_f32_16x16x32_bf16 v[68:71], a[76:79], a[4:7], v[68:71]
 ds_read_b64_tr_b16 a[28:29], v9 offset:16384
 v_mfma_f32_16x16x32_bf16 v[68:71], a[72:75], a[0:3], v[68:71]
 ds_read_b64_tr_b16 a[30:31], v9 offset:20480
 v_mfma_f32_16x16x32_bf16 v[72:75], a[80:83], a[0:3], v[72:75]
 ds_read_b128 a[96:99], v4 offset:8192
 v_mfma_f32_16x16x32_bf16 v[72:75], a[84:87], a[4:7], v[72:75]
 v_mfma_f32_16x16x32_bf16 v[76:79], a[92:95], a[4:7], v[76:79]
 s_waitcnt lgkmcnt(8)
 ds_read_b128 a[100:103], v5 offset:8192
 v_mfma_f32_16x16x32_bf16 v[76:79], a[88:91], a[0:3], v[76:79]
 v_mfma_f32_16x16x32_bf16 v[84:87], a[88:91], a[8:11], v[84:87]
 ds_read_b128 a[108:111], v5 offset:10240
 v_mfma_f32_16x16x32_bf16 v[84:87], a[92:95], a[12:15], v[84:87]
 v_mfma_f32_16x16x32_bf16 v[80:83], a[84:87], a[12:15], v[80:83]
 ds_read_b128 a[104:107], v4 offset:10240
 v_mfma_f32_16x16x32_bf16 v[80:83], a[80:83], a[8:11], v[80:83]
 v_mfma_f32_16x16x32_bf16 v[92:95], a[72:75], a[8:11], v[92:95]
 ds_read_b128 a[112:115], v4 offset:12288
 v_mfma_f32_16x16x32_bf16 v[92:95], a[76:79], a[12:15], v[92:95]
 v_mfma_f32_16x16x32_bf16 v[88:91], a[68:71], a[12:15], v[88:91]
 ds_read_b128 a[116:119], v5 offset:12288
 v_mfma_f32_16x16x32_bf16 v[88:91], a[64:67], a[8:11], v[88:91]
 s_waitcnt lgkmcnt(8)
 v_mfma_f32_16x16x32_bf16 v[96:99], a[64:67], a[16:19], v[96:99]
 ds_read_b128 a[124:127], v5 offset:14336
 v_mfma_f32_16x16x32_bf16 v[96:99], a[68:71], a[20:23], v[96:99]
 v_mfma_f32_16x16x32_bf16 v[100:103], a[76:79], a[20:23], v[100:103]
 ds_read_b128 a[120:123], v4 offset:14336
 v_mfma_f32_16x16x32_bf16 v[100:103], a[72:75], a[16:19], v[100:103]
 v_mfma_f32_16x16x32_bf16 v[104:107], a[80:83], a[16:19], v[104:107]
 ds_read_b64_tr_b16 a[32:33], v10 offset:0
 v_mfma_f32_16x16x32_bf16 v[104:107], a[84:87], a[20:23], v[104:107]
 ds_read_b64_tr_b16 a[34:35], v10 offset:4096
 v_mfma_f32_16x16x32_bf16 v[108:111], a[92:95], a[20:23], v[108:111]
 ds_read_b64_tr_b16 a[36:37], v10 offset:16384
 v_mfma_f32_16x16x32_bf16 v[108:111], a[88:91], a[16:19], v[108:111]
 ds_read_b64_tr_b16 a[38:39], v10 offset:20480
 v_mfma_f32_16x16x32_bf16 v[116:119], a[88:91], a[24:27], v[116:119]
 s_waitcnt lgkmcnt(8)
 ds_read_b64_tr_b16 a[40:41], v11 offset:0
 v_mfma_f32_16x16x32_bf16 v[116:119], a[92:95], a[28:31], v[116:119]
 ds_read_b64_tr_b16 a[42:43], v11 offset:4096
 v_mfma_f32_16x16x32_bf16 v[112:115], a[84:87], a[28:31], v[112:115]
 ds_read_b64_tr_b16 a[44:45], v11 offset:16384
 v_mfma_f32_16x16x32_bf16 v[112:115], a[80:83], a[24:27], v[112:115]
 ds_read_b64_tr_b16 a[46:47], v11 offset:20480
 v_mfma_f32_16x16x32_bf16 v[124:127], a[72:75], a[24:27], v[124:127]
 ds_read_b64_tr_b16 a[48:49], v12 offset:0
 v_mfma_f32_16x16x32_bf16 v[124:127], a[76:79], a[28:31], v[124:127]
 ds_read_b64_tr_b16 a[50:51], v12 offset:4096
 v_mfma_f32_16x16x32_bf16 v[120:123], a[68:71], a[28:31], v[120:123]
 ds_read_b64_tr_b16 a[52:53], v12 offset:16384
 v_mfma_f32_16x16x32_bf16 v[120:123], a[64:67], a[24:27], v[120:123]
 ds_read_b64_tr_b16 a[54:55], v12 offset:20480
 v_mfma_f32_16x16x32_bf16 v[16:19], a[96:99], a[0:3], v[16:19]
 ds_read_b64_tr_b16 a[56:57], v13 offset:0
 v_mfma_f32_16x16x32_bf16 v[16:19], a[100:103], a[4:7], v[16:19]
 ds_read_b64_tr_b16 a[58:59], v13 offset:4096
 v_mfma_f32_16x16x32_bf16 v[20:23], a[108:111], a[4:7], v[20:23]
 ds_read_b64_tr_b16 a[60:61], v13 offset:16384
 v_mfma_f32_16x16x32_bf16 v[20:23], a[104:107], a[0:3], v[20:23]
 s_waitcnt lgkmcnt(8)
 ds_read_b64_tr_b16 a[62:63], v13 offset:20480
 v_mfma_f32_16x16x32_bf16 v[24:27], a[112:115], a[0:3], v[24:27]
 v_mfma_f32_16x16x32_bf16 v[24:27], a[116:119], a[4:7], v[24:27]
 v_mfma_f32_16x16x32_bf16 v[28:31], a[124:127], a[4:7], v[28:31]
 v_mfma_f32_16x16x32_bf16 v[28:31], a[120:123], a[0:3], v[28:31]
 s_waitcnt lgkmcnt(0)
 v_mfma_f32_16x16x32_bf16 a[228:231], a[120:123], a[8:11], a[228:231]
 s_barrier
 v_mfma_f32_16x16x32_bf16 a[228:231], a[124:127], a[12:15], a[228:231]
 s_add_u32 m0, s29, 65536
 v_mfma_f32_16x16x32_bf16 a[224:227], a[116:119], a[12:15], a[224:227]
 buffer_load_dwordx4 v2, s[8:11], 0 offen  lds
 v_mfma_f32_16x16x32_bf16 a[224:227], a[112:115], a[8:11], a[224:227]
 v_mfma_f32_16x16x32_bf16 a[236:239], a[104:107], a[8:11], a[236:239]
 v_mfma_f32_16x16x32_bf16 a[236:239], a[108:111], a[12:15], a[236:239]
 v_mfma_f32_16x16x32_bf16 a[232:235], a[100:103], a[12:15], a[232:235]
 s_add_u32 m0, s29, 0
 v_mfma_f32_16x16x32_bf16 a[232:235], a[96:99], a[8:11], a[232:235]
 buffer_load_dwordx4 v1, s[4:7], 0 offen  lds
 v_mfma_f32_16x16x32_bf16 v[32:35], a[96:99], a[16:19], v[32:35]
 v_mfma_f32_16x16x32_bf16 v[32:35], a[100:103], a[20:23], v[32:35]
 v_mfma_f32_16x16x32_bf16 v[36:39], a[108:111], a[20:23], v[36:39]
 v_mfma_f32_16x16x32_bf16 v[36:39], a[104:107], a[16:19], v[36:39]
 s_add_u32 m0, s29, 69632
 v_mfma_f32_16x16x32_bf16 v[40:43], a[112:115], a[16:19], v[40:43]
 buffer_load_dwordx4 v2, s[8:11], s48 offen  lds
 v_mfma_f32_16x16x32_bf16 v[40:43], a[116:119], a[20:23], v[40:43]
 v_mfma_f32_16x16x32_bf16 v[44:47], a[124:127], a[20:23], v[44:47]
 v_mfma_f32_16x16x32_bf16 v[44:47], a[120:123], a[16:19], v[44:47]
 v_mfma_f32_16x16x32_bf16 v[52:55], a[120:123], a[24:27], v[52:55]
 s_add_u32 m0, s29, 4096
 v_mfma_f32_16x16x32_bf16 v[52:55], a[124:127], a[28:31], v[52:55]
 buffer_load_dwordx4 v1, s[4:7], s41 offen  lds
 v_mfma_f32_16x16x32_bf16 v[48:51], a[116:119], a[28:31], v[48:51]
 v_mfma_f32_16x16x32_bf16 v[48:51], a[112:115], a[24:27], v[48:51]
 v_mfma_f32_16x16x32_bf16 v[60:63], a[104:107], a[24:27], v[60:63]
 v_mfma_f32_16x16x32_bf16 v[60:63], a[108:111], a[28:31], v[60:63]
 s_add_u32 m0, s29, 73728
 v_mfma_f32_16x16x32_bf16 v[56:59], a[100:103], a[28:31], v[56:59]
 buffer_load_dwordx4 v2, s[8:11], s49 offen  lds
 v_mfma_f32_16x16x32_bf16 v[56:59], a[96:99], a[24:27], v[56:59]
 v_mfma_f32_16x16x32_bf16 v[192:195], a[96:99], a[32:35], v[192:195]
 v_mfma_f32_16x16x32_bf16 v[192:195], a[100:103], a[36:39], v[192:195]
 v_mfma_f32_16x16x32_bf16 v[196:199], a[108:111], a[36:39], v[196:199]
 s_add_u32 m0, s29, 8192
 v_mfma_f32_16x16x32_bf16 v[196:199], a[104:107], a[32:35], v[196:199]
 buffer_load_dwordx4 v1, s[4:7], s42 offen  lds
 v_mfma_f32_16x16x32_bf16 v[200:203], a[112:115], a[32:35], v[200:203]
 v_mfma_f32_16x16x32_bf16 v[200:203], a[116:119], a[36:39], v[200:203]
 v_mfma_f32_16x16x32_bf16 v[204:207], a[124:127], a[36:39], v[204:207]
 v_mfma_f32_16x16x32_bf16 v[204:207], a[120:123], a[32:35], v[204:207]
 s_add_u32 m0, s29, 77824
 v_mfma_f32_16x16x32_bf16 v[212:215], a[120:123], a[40:43], v[212:215]
 buffer_load_dwordx4 v2, s[8:11], s50 offen  lds
 v_mfma_f32_16x16x32_bf16 v[212:215], a[124:127], a[44:47], v[212:215]
 v_mfma_f32_16x16x32_bf16 v[208:211], a[116:119], a[44:47], v[208:211]
 v_mfma_f32_16x16x32_bf16 v[208:211], a[112:115], a[40:43], v[208:211]
 v_mfma_f32_16x16x32_bf16 v[220:223], a[104:107], a[40:43], v[220:223]
 s_add_u32 m0, s29, 12288
 v_mfma_f32_16x16x32_bf16 v[220:223], a[108:111], a[44:47], v[220:223]
 buffer_load_dwordx4 v1, s[4:7], s43 offen  lds
 v_mfma_f32_16x16x32_bf16 v[216:219], a[100:103], a[44:47], v[216:219]
 v_mfma_f32_16x16x32_bf16 v[216:219], a[96:99], a[40:43], v[216:219]
 v_mfma_f32_16x16x32_bf16 v[224:227], a[96:99], a[48:51], v[224:227]
 v_mfma_f32_16x16x32_bf16 v[224:227], a[100:103], a[52:55], v[224:227]
 s_add_u32 m0, s29, 81920
 v_mfma_f32_16x16x32_bf16 v[228:231], a[108:111], a[52:55], v[228:231]
 buffer_load_dwordx4 v2, s[8:11], s51 offen  lds
 v_mfma_f32_16x16x32_bf16 v[228:231], a[104:107], a[48:51], v[228:231]
 v_mfma_f32_16x16x32_bf16 v[232:235], a[112:115], a[48:51], v[232:235]
 v_mfma_f32_16x16x32_bf16 v[232:235], a[116:119], a[52:55], v[232:235]
 v_mfma_f32_16x16x32_bf16 v[236:239], a[124:127], a[52:55], v[236:239]
 s_add_u32 m0, s29, 16384
 v_mfma_f32_16x16x32_bf16 v[236:239], a[120:123], a[48:51], v[236:239]
 buffer_load_dwordx4 v1, s[4:7], s44 offen  lds
 v_mfma_f32_16x16x32_bf16 v[244:247], a[120:123], a[56:59], v[244:247]
 v_mfma_f32_16x16x32_bf16 v[244:247], a[124:127], a[60:63], v[244:247]
 v_mfma_f32_16x16x32_bf16 v[240:243], a[116:119], a[60:63], v[240:243]
 v_mfma_f32_16x16x32_bf16 v[240:243], a[112:115], a[56:59], v[240:243]
 s_add_u32 m0, s29, 86016
 v_mfma_f32_16x16x32_bf16 v[252:255], a[104:107], a[56:59], v[252:255]
 s_waitcnt vmcnt(11)
 buffer_load_dwordx4 v2, s[8:11], s52 offen  lds
 v_mfma_f32_16x16x32_bf16 v[252:255], a[108:111], a[60:63], v[252:255]
 s_barrier
 ds_read_b64_tr_b16 a[0:1], v6 offset:32768
 v_mfma_f32_16x16x32_bf16 v[248:251], a[100:103], a[60:63], v[248:251]
 ds_read_b64_tr_b16 a[2:3], v6 offset:36864
 v_mfma_f32_16x16x32_bf16 v[248:251], a[96:99], a[56:59], v[248:251]
 ds_read_b128 a[96:99], v4 offset:40960
 v_mfma_f32_16x16x32_bf16 v[128:131], a[64:67], a[32:35], v[128:131]
 s_add_u32 m0, s29, 20480
 v_mfma_f32_16x16x32_bf16 v[128:131], a[68:71], a[36:39], v[128:131]
 buffer_load_dwordx4 v1, s[4:7], s45 offen  lds
 v_mfma_f32_16x16x32_bf16 v[132:135], a[76:79], a[36:39], v[132:135]
 ds_read_b64_tr_b16 a[4:5], v6 offset:49152
 v_mfma_f32_16x16x32_bf16 v[132:135], a[72:75], a[32:35], v[132:135]
 ds_read_b64_tr_b16 a[6:7], v6 offset:53248
 v_mfma_f32_16x16x32_bf16 v[136:139], a[80:83], a[32:35], v[136:139]
 ds_read_b128 a[100:103], v5 offset:40960
 v_mfma_f32_16x16x32_bf16 v[136:139], a[84:87], a[36:39], v[136:139]
 s_add_u32 m0, s29, 90112
 v_mfma_f32_16x16x32_bf16 v[140:143], a[92:95], a[36:39], v[140:143]
 buffer_load_dwordx4 v2, s[8:11], s53 offen  lds
 v_mfma_f32_16x16x32_bf16 v[140:143], a[88:91], a[32:35], v[140:143]
 ds_read_b128 a[108:111], v5 offset:43008
 v_mfma_f32_16x16x32_bf16 v[148:151], a[88:91], a[40:43], v[148:151]
 v_mfma_f32_16x16x32_bf16 v[148:151], a[92:95], a[44:47], v[148:151]
 ds_read_b128 a[104:107], v4 offset:43008
 v_mfma_f32_16x16x32_bf16 v[144:147], a[84:87], a[44:47], v[144:147]
 s_add_u32 m0, s29, 24576
 v_mfma_f32_16x16x32_bf16 v[144:147], a[80:83], a[40:43], v[144:147]
 buffer_load_dwordx4 v1, s[4:7], s46 offen  lds
 v_mfma_f32_16x16x32_bf16 v[156:159], a[72:75], a[40:43], v[156:159]
 ds_read_b128 a[112:115], v4 offset:45056
 v_mfma_f32_16x16x32_bf16 v[156:159], a[76:79], a[44:47], v[156:159]
 v_mfma_f32_16x16x32_bf16 v[152:155], a[68:71], a[44:47], v[152:155]
 ds_read_b128 a[116:119], v5 offset:45056
 v_mfma_f32_16x16x32_bf16 v[152:155], a[64:67], a[40:43], v[152:155]
 s_add_u32 m0, s29, 94208
 v_mfma_f32_16x16x32_bf16 v[160:163], a[64:67], a[48:51], v[160:163]
 buffer_load_dwordx4 v2, s[8:11], s54 offen  lds
 v_mfma_f32_16x16x32_bf16 v[160:163], a[68:71], a[52:55], v[160:163]
 ds_read_b128 a[124:127], v5 offset:47104
 v_mfma_f32_16x16x32_bf16 v[164:167], a[76:79], a[52:55], v[164:167]
 v_mfma_f32_16x16x32_bf16 v[164:167], a[72:75], a[48:51], v[164:167]
 ds_read_b128 a[120:123], v4 offset:47104
 v_mfma_f32_16x16x32_bf16 v[168:171], a[80:83], a[48:51], v[168:171]
 s_add_u32 m0, s29, 28672
 v_mfma_f32_16x16x32_bf16 v[168:171], a[84:87], a[52:55], v[168:171]
 buffer_load_dwordx4 v1, s[4:7], s47 offen  lds
 v_mfma_f32_16x16x32_bf16 v[172:175], a[92:95], a[52:55], v[172:175]
 v_add_u32 v1, 128, v1
 v_add_u32 v2, 0x80000, v2
 v_mfma_f32_16x16x32_bf16 v[172:175], a[88:91], a[48:51], v[172:175]
 ds_read_b64_tr_b16 a[8:9], v7 offset:32768
 v_mfma_f32_16x16x32_bf16 v[180:183], a[88:91], a[56:59], v[180:183]
 buffer_load_dword a243, v14, s[36:39], s56 offen
 v_mfma_f32_16x16x32_bf16 v[180:183], a[92:95], a[60:63], v[180:183]
 s_add_u32 s56, s56, s30
 ds_read_b64_tr_b16 a[10:11], v7 offset:36864
 v_mfma_f32_16x16x32_bf16 v[176:179], a[84:87], a[60:63], v[176:179]
 ds_read_b64_tr_b16 a[12:13], v7 offset:49152
 v_mfma_f32_16x16x32_bf16 v[176:179], a[80:83], a[56:59], v[176:179]
 ds_read_b64_tr_b16 a[14:15], v7 offset:53248
 v_mfma_f32_16x16x32_bf16 v[188:191], a[72:75], a[56:59], v[188:191]
 ds_read_b64_tr_b16 a[16:17], v8 offset:32768
 v_mfma_f32_16x16x32_bf16 v[188:191], a[76:79], a[60:63], v[188:191]
 ds_read_b64_tr_b16 a[18:19], v8 offset:36864
 v_mfma_f32_16x16x32_bf16 v[184:187], a[68:71], a[60:63], v[184:187]
 ds_read_b64_tr_b16 a[20:21], v8 offset:49152
 v_mfma_f32_16x16x32_bf16 v[184:187], a[64:67], a[56:59], v[184:187]
 s_waitcnt lgkmcnt(8)
 ds_read_b64_tr_b16 a[22:23], v8 offset:53248
L_vloop_mid:
 v_mfma_f32_16x16x32_bf16 v[16:19], a[96:99], a[0:3], v[16:19]
 ds_read_b64_tr_b16 a[24:25], v9 offset:32768
 v_mfma_f32_16x16x32_bf16 v[16:19], a[100:103], a[4:7], v[16:19]
 ds_read_b64_tr_b16 a[26:27], v9 offset:36864
 v_mfma_f32_16x16x32_bf16 v[20:23], a[108:111], a[4:7], v[20:23]
 ds_read_b64_tr_b16 a[28:29], v9 offset:49152
 v_mfma_f32_16x16x32_bf16 v[20:23], a[104:107], a[0:3], v[20:23]
 ds_read_b64_tr_b16 a[30:31], v9 offset:53248
 v_mfma_f32_16x16x32_bf16 v[24:27], a[112:115], a[0:3], v[24:27]
 ds_read_b128 a[64:67], v4 offset:32768
 v_mfma_f32_16x16x32_bf16 v[24:27], a[116:119], a[4:7], v[24:27]
 v_mfma_f32_16x16x32_bf16 v[28:31], a[124:127], a[4:7], v[28:31]
 s_waitcnt lgkmcnt(8)
 ds_read_b128 a[68:71], v5 offset:32768
 v_mfma_f32_16x16x32_bf16 v[28:31], a[120:123], a[0:3], v[28:31]
 v_mfma_f32_16x16x32_bf16 a[228:231], a[120:123], a[8:11], a[228:231]
 ds_read_b128 a[76:79], v5 offset:34816
 v_mfma_f32_16x16x32_bf16 a[228:231], a[124:127], a[12:15], a[228:231]
 v_mfma_f32_16x16x32_bf16 a[224:227], a[116:119], a[12:15], a[224:227]
 ds_read_b128 a[72:75], v4 offset:34816
 v_mfma_f32_16x16x32_bf16 a[224:227], a[112:115], a[8:11], a[224:227]
 v_mfma_f32_16x16x32_bf16 a[236:239], a[104:107], a[8:11], a[236:239]
 ds_read_b128 a[80:83], v4 offset:36864
 v_mfma_f32_16x16x32_bf16 a[236:239], a[108:111], a[12:15], a[236:239]
 v_mfma_f32_16x16x32_bf16 a[232:235], a[100:103], a[12:15], a[232:235]
 ds_read_b128 a[84:87], v5 offset:36864
 v_mfma_f32_16x16x32_bf16 a[232:235], a[96:99], a[8:11], a[232:235]
 s_waitcnt lgkmcnt(8)
 v_mfma_f32_16x16x32_bf16 v[32:35], a[96:99], a[16:19], v[32:35]
 ds_read_b128 a[92:95], v5 offset:38912
 v_mfma_f32_16x16x32_bf16 v[32:35], a[100:103], a[20:23], v[32:35]
 v_mfma_f32_16x16x32_bf16 v[36:39], a[108:111], a[20:23], v[36:39]
 ds_read_b128 a[88:91], v4 offset:38912
 v_mfma_f32_16x16x32_bf16 v[36:39], a[104:107], a[16:19], v[36:39]
 v_mfma_f32_16x16x32_bf16 v[40:43], a[112:115], a[16:19], v[40:43]
 ds_read_b64_tr_b16 a[32:33], v10 offset:32768
 v_mfma_f32_16x16x32_bf16 v[40:43], a[116:119], a[20:23], v[40:43]
 ds_read_b64_tr_b16 a[34:35], v10 offset:36864
 v_mfma_f32_16x16x32_bf16 v[44:47], a[124:127], a[20:23], v[44:47]
 ds_read_b64_tr_b16 a[36:37], v10 offset:49152
 v_mfma_f32_16x16x32_bf16 v[44:47], a[120:123], a[16:19], v[44:47]
 ds_read_b64_tr_b16 a[38:39], v10 offset:53248
 v_mfma_f32_16x16x32_bf16 v[52:55], a[120:123], a[24:27], v[52:55]
 s_waitcnt lgkmcnt(8)
 ds_read_b64_tr_b16 a[40:41], v11 offset:32768
 v_mfma_f32_16x16x32_bf16 v[52:55], a[124:127], a[28:31], v[52:55]
 ds_read_b64_tr_b16 a[42:43], v11 offset:36864
 v_mfma_f32_16x16x32_bf16 v[48:51], a[116:119], a[28:31], v[48:51]
 ds_read_b64_tr_b16 a[44:45], v11 offset:49152
 v_mfma_f32_16x16x32_bf16 v[48:51], a[112:115], a[24:27], v[48:51]
 ds_read_b64_tr_b16 a[46:47], v11 offset:53248
 v_mfma_f32_16x16x32_bf16 v[60:63], a[104:107], a[24:27], v[60:63]
 ds_read_b64_tr_b16 a[48:49], v12 offset:32768
 v_mfma_f32_16x16x32_bf16 v[60:63], a[108:111], a[28:31], v[60:63]
 ds_read_b64_tr_b16 a[50:51], v12 offset:36864
 v_mfma_f32_16x16x32_bf16 v[56:59], a[100:103], a[28:31], v[56:59]
 ds_read_b64_tr_b16 a[52:53], v12 offset:49152
 v_mfma_f32_16x16x32_bf16 v[56:59], a[96:99], a[24:27], v[56:59]
 ds_read_b64_tr_b16 a[54:55], v12 offset:53248
 v_mfma_f32_16x16x32_bf16 v[64:67], a[64:67], a[0:3], v[64:67]
 ds_read_b64_tr_b16 a[56:57], v13 offset:32768
 v_mfma_f32_16x16x32_bf16 v[64:67], a[68:71], a[4:7], v[64:67]
 ds_read_b64_tr_b16 a[58:59], v13 offset:36864
 v_mfma_f32_16x16x32_bf16 v[68:71], a[76:79], a[4:7], v[68:71]
 ds_read_b64_tr_b16 a[60:61], v13 offset:49152
 v_mfma_f32_16x16x32_bf16 v[68:71], a[72:75], a[0:3], v[68:71]
 s_waitcnt lgkmcnt(8)
 ds_read_b64_tr_b16 a[62:63], v13 offset:53248
 v_mfma_f32_16x16x32_bf16 v[72:75], a[80:83], a[0:3], v[72:75]
 v_mfma_f32_16x16x32_bf16 v[72:75], a[84:87], a[4:7], v[72:75]
 v_mfma_f32_16x16x32_bf16 v[76:79], a[92:95], a[4:7], v[76:79]
 v_mfma_f32_16x16x32_bf16 v[76:79], a[88:91], a[0:3], v[76:79]
 s_waitcnt lgkmcnt(0)
 v_mfma_f32_16x16x32_bf16 v[84:87], a[88:91], a[8:11], v[84:87]
 s_barrier
 v_mfma_f32_16x16x32_bf16 v[84:87], a[92:95], a[12:15], v[84:87]
 s_add_u32 m0, s29, 98304
 v_mfma_f32_16x16x32_bf16 v[80:83], a[84:87], a[12:15], v[80:83]
 buffer_load_dwordx4 v2, s[8:11], 0 offen  lds
 v_mfma_f32_16x16x32_bf16 v[80:83], a[80:83], a[8:11], v[80:83]
 v_mfma_f32_16x16x32_bf16 v[92:95], a[72:75], a[8:11], v[92:95]
 v_mfma_f32_16x16x32_bf16 v[92:95], a[76:79], a[12:15], v[92:95]
 v_mfma_f32_16x16x32_bf16 v[88:91], a[68:71], a[12:15], v[88:91]
 s_add_u32 m0, s29, 32768
 v_mfma_f32_16x16x32_bf16 v[88:91], a[64:67], a[8:11], v[88:91]
 buffer_load_dwordx4 v1, s[4:7], 0 offen  lds
 v_mfma_f32_16x16x32_bf16 v[96:99], a[64:67], a[16:19], v[96:99]
 v_mfma_f32_16x16x32_bf16 v[96:99], a[68:71], a[20:23], v[96:99]
 v_mfma_f32_16x16x32_bf16 v[100:103], a[76:79], a[20:23], v[100:103]
 v_mfma_f32_16x16x32_bf16 v[100:103], a[72:75], a[16:19], v[100:103]
 s_add_u32 m0, s29, 102400
 v_mfma_f32_16x16x32_bf16 v[104:107], a[80:83], a[16:19], v[104:107]
 buffer_load_dwordx4 v2, s[8:11], s48 offen  lds
 v_mfma_f32_16x16x32_bf16 v[104:107], a[84:87], a[20:23], v[104:107]
 v_mfma_f32_16x16x32_bf16 v[108:111], a[92:95], a[20:23], v[108:111]
 v_mfma_f32_16x16x32_bf16 v[108:111], a[88:91], a[16:19], v[108:111]
 v_mfma_f32_16x16x32_bf16 v[116:119], a[88:91], a[24:27], v[116:119]
 s_add_u32 m0, s29, 36864
 v_mfma_f32_16x16x32_bf16 v[116:119], a[92:95], a[28:31], v[116:119]
 buffer_load_dwordx4 v1, s[4:7], s41 offen  lds
 v_mfma_f32_16x16x32_bf16 v[112:115], a[84:87], a[28:31], v[112:115]
 v_mfma_f32_16x16x32_bf16 v[112:115], a[80:83], a[24:27], v[112:115]
 v_mfma_f32_16x16x32_bf16 v[124:127], a[72:75], a[24:27], v[124:127]
 v_mfma_f32_16x16x32_bf16 v[124:127], a[76:79], a[28:31], v[124:127]
 s_add_u32 m0, s29, 106496
 v_mfma_f32_16x16x32_bf16 v[120:123], a[68:71], a[28:31], v[120:123]
 buffer_load_dwordx4 v2, s[8:11], s49 offen  lds
 v_mfma_f32_16x16x32_bf16 v[120:123], a[64:67], a[24:27], v[120:123]
 v_mfma_f32_16x16x32_bf16 v[128:131], a[64:67], a[32:35], v[128:131]
 v_mfma_f32_16x16x32_bf16 v[128:131], a[68:71], a[36:39], v[128:131]
 v_mfma_f32_16x16x32_bf16 v[132:135], a[76:79], a[36:39], v[132:135]
 s_add_u32 m0, s29, 40960
 v_mfma_f32_16x16x32_bf16 v[132:135], a[72:75], a[32:35], v[132:135]
 buffer_load_dwordx4 v1, s[4:7], s42 offen  lds
 v_mfma_f32_16x16x32_bf16 v[136:139], a[80:83], a[32:35], v[136:139]
 v_mfma_f32_16x16x32_bf16 v[136:139], a[84:87], a[36:39], v[136:139]
 v_mfma_f32_16x16x32_bf16 v[140:143], a[92:95], a[36:39], v[140:143]
 v_mfma_f32_16x16x32_bf16 v[140:143], a[88:91], a[32:35], v[140:143]
 s_add_u32 m0, s29, 110592
 v_mfma_f32_16x16x32_bf16 v[148:151], a[88:91], a[40:43], v[148:151]
 buffer_load_dwordx4 v2, s[8:11], s50 offen  lds
 v_mfma_f32_16x16x32_bf16 v[148:151], a[92:95], a[44:47], v[148:151]
 v_mfma_f32_16x16x32_bf16 v[144:147], a[84:87], a[44:47], v[144:147]
 v_mfma_f32_16x16x32_bf16 v[144:147], a[80:83], a[40:43], v[144:147]
 v_mfma_f32_16x16x32_bf16 v[156:159], a[72:75], a[40:43], v[156:159]
 s_add_u32 m0, s29, 45056
 v_mfma_f32_16x16x32_bf16 v[156:159], a[76:79], a[44:47], v[156:159]
 buffer_load_dwordx4 v1, s[4:7], s43 offen  lds
 v_mfma_f32_16x16x32_bf16 v[152:155], a[68:71], a[44:47], v[152:155]
 v_mfma_f32_16x16x32_bf16 v[152:155], a[64:67], a[40:43], v[152:155]
 v_mfma_f32_16x16x32_bf16 v[160:163], a[64:67], a[48:51], v[160:163]
 v_mfma_f32_16x16x32_bf16 v[160:163], a[68:71], a[52:55], v[160:163]
 s_add_u32 m0, s29, 114688
 v_mfma_f32_16x16x32_bf16 v[164:167], a[76:79], a[52:55], v[164:167]
 buffer_load_dwordx4 v2, s[8:11], s51 offen  lds
 v_mfma_f32_16x16x32_bf16 v[164:167], a[72:75], a[48:51], v[164:167]
 v_mfma_f32_16x16x32_bf16 v[168:171], a[80:83], a[48:51], v[168:171]
 v_mfma_f32_16x16x32_bf16 v[168:171], a[84:87], a[52:55], v[168:171]
 v_mfma_f32_16x16x32_bf16 v[172:175], a[92:95], a[52:55], v[172:175]
 s_add_u32 m0, s29, 49152
 v_mfma_f32_16x16x32_bf16 v[172:175], a[88:91], a[48:51], v[172:175]
 buffer_load_dwordx4 v1, s[4:7], s44 offen  lds
 v_mfma_f32_16x16x32_bf16 v[180:183], a[88:91], a[56:59], v[180:183]
 v_mfma_f32_16x16x32_bf16 v[180:183], a[92:95], a[60:63], v[180:183]
 v_mfma_f32_16x16x32_bf16 v[176:179], a[84:87], a[60:63], v[176:179]
 v_mfma_f32_16x16x32_bf16 v[176:179], a[80:83], a[56:59], v[176:179]
 s_add_u32 m0, s29, 118784
 v_mfma_f32_16x16x32_bf16 v[188:191], a[72:75], a[56:59], v[188:191]
 s_waitcnt vmcnt(11)
 buffer_load_dwordx4 v2, s[8:11], s52 offen  lds
 v_mfma_f32_16x16x32_bf16 v[188:191], a[76:79], a[60:63], v[188:191]
 s_barrier
 ds_read_b64_tr_b16 a[0:1], v6 offset:0
 v_mfma_f32_16x16x32_bf16 v[184:187], a[68:71], a[60:63], v[184:187]
 ds_read_b64_tr_b16 a[2:3], v6 offset:4096
 v_mfma_f32_16x16x32_bf16 v[184:187], a[64:67], a[56:59], v[184:187]
 ds_read_b128 a[64:67], v4 offset:0
 v_mfma_f32_16x16x32_bf16 v[192:195], a[96:99], a[32:35], v[192:195]
 s_add_u32 m0, s29, 53248
 v_mfma_f32_16x16x32_bf16 v[192:195], a[100:103], a[36:39], v[192:195]
 buffer_load_dwordx4 v1, s[4:7], s45 offen  lds
 v_mfma_f32_16x16x32_bf16 v[196:199], a[108:111], a[36:39], v[196:199]
 ds_read_b64_tr_b16 a[4:5], v6 offset:16384
 v_mfma_f32_16x16x32_bf16 v[196:199], a[104:107], a[32:35], v[196:199]
 ds_read_b64_tr_b16 a[6:7], v6 offset:20480
 v_mfma_f32_16x16x32_bf16 v[200:203], a[112:115], a[32:35], v[200:203]
 ds_read_b128 a[68:71], v5 offset:0
 v_mfma_f32_16x16x32_bf16 v[200:203], a[116:119], a[36:39], v[200:203]
 s_add_u32 m0, s29, 122880
 v_mfma_f32_16x16x32_bf16 v[204:207], a[124:127], a[36:39], v[204:207]
 buffer_load_dwordx4 v2, s[8:11], s53 offen  lds
 v_mfma_f32_16x16x32_bf16 v[204:207], a[120:123], a[32:35], v[204:207]
 ds_read_b128 a[76:79], v5 offset:2048
 v_mfma_f32_16x16x32_bf16 v[212:215], a[120:123], a[40:43], v[212:215]
 v_mfma_f32_16x16x32_bf16 v[212:215], a[124:127], a[44:47], v[212:215]
 ds_read_b128 a[72:75], v4 offset:2048
 v_mfma_f32_16x16x32_bf16 v[208:211], a[116:119], a[44:47], v[208:211]
 s_add_u32 m0, s29, 57344
 v_mfma_f32_16x16x32_bf16 v[208:211], a[112:115], a[40:43], v[208:211]
 buffer_load_dwordx4 v1, s[4:7], s46 offen  lds
 v_mfma_f32_16x16x32_bf16 v[220:223], a[104:107], a[40:43], v[220:223]
 ds_read_b128 a[80:83], v4 offset:4096
 v_mfma_f32_16x16x32_bf16 v[220:223], a[108:111], a[44:47], v[220:223]
 v_mfma_f32_16x16x32_bf16 v[216:219], a[100:103], a[44:47], v[216:219]
 ds_read_b128 a[84:87], v5 offset:4096
 v_mfma_f32_16x16x32_bf16 v[216:219], a[96:99], a[40:43], v[216:219]
 s_add_u32 m0, s29, 126976
 v_mfma_f32_16x16x32_bf16 v[224:227], a[96:99], a[48:51], v[224:227]
 buffer_load_dwordx4 v2, s[8:11], s54 offen  lds
 v_mfma_f32_16x16x32_bf16 v[224:227], a[100:103], a[52:55], v[224:227]
 ds_read_b128 a[92:95], v5 offset:6144
 v_mfma_f32_16x16x32_bf16 v[228:231], a[108:111], a[52:55], v[228:231]
 v_mfma_f32_16x16x32_bf16 v[228:231], a[104:107], a[48:51], v[228:231]
 ds_read_b128 a[88:91], v4 offset:6144
 v_mfma_f32_16x16x32_bf16 v[232:235], a[112:115], a[48:51], v[232:235]
 s_add_u32 m0, s29, 61440
 v_mfma_f32_16x16x32_bf16 v[232:235], a[116:119], a[52:55], v[232:235]
 buffer_load_dwordx4 v1, s[4:7], s47 offen  lds
 v_mfma_f32_16x16x32_bf16 v[236:239], a[124:127], a[52:55], v[236:239]
 v_add_u32 v1, 128, v1
 v_add_u32 v2, 0x80000, v2
 v_mfma_f32_16x16x32_bf16 v[236:239], a[120:123], a[48:51], v[236:239]
 ds_read_b64_tr_b16 a[8:9], v7 offset:0
 v_mfma_f32_16x16x32_bf16 v[244:247], a[120:123], a[56:59], v[244:247]
 buffer_load_dword a243, v14, s[36:39], s56 offen
 v_mfma_f32_16x16x32_bf16 v[244:247], a[124:127], a[60:63], v[244:247]
 s_add_u32 s56, s56, s30
 ds_read_b64_tr_b16 a[10:11], v7 offset:4096
 v_mfma_f32_16x16x32_bf16 v[240:243], a[116:119], a[60:63], v[240:243]
 ds_read_b64_tr_b16 a[12:13], v7 offset:16384
 v_mfma_f32_16x16x32_bf16 v[240:243], a[112:115], a[56:59], v[240:243]
 ds_read_b64_tr_b16 a[14:15], v7 offset:20480
 v_mfma_f32_16x16x32_bf16 v[252:255], a[104:107], a[56:59], v[252:255]
 ds_read_b64_tr_b16 a[16:17], v8 offset:0
 v_mfma_f32_16x16x32_bf16 v[252:255], a[108:111], a[60:63], v[252:255]
 s_add_u32 s61, s61, 1
 ds_read_b64_tr_b16 a[18:19], v8 offset:4096
 v_mfma_f32_16x16x32_bf16 v[248:251], a[100:103], a[60:63], v[248:251]
 s_cmp_lt_u32 s61, s55
 ds_read_b64_tr_b16 a[20:21], v8 offset:16384
 v_mfma_f32_16x16x32_bf16 v[248:251], a[96:99], a[56:59], v[248:251]
 s_waitcnt lgkmcnt(8)
 ds_read_b64_tr_b16 a[22:23], v8 offset:20480
 s_cbranch_scc1 L_vloop
 s_cmp_lt_u32 s61, 6
 s_cbranch_scc1 L_vloop_side
 v_mfma_f32_16x16x32_bf16 v[64:67], a[64:67], a[0:3], v[64:67]
 ds_read_b64_tr_b16 a[24:25], v9 offset:0
 v_accvgpr_read_b32 v15, a240
 v_mfma_f32_16x16x32_bf16 v[64:67], a[68:71], a[4:7], v[64:67]
 ds_read_b64_tr_b16 a[26:27], v9 offset:4096
 v_accvgpr_read_b32 v14, a242
 v_mfma_f32_16x16x32_bf16 v[68:71], a[76:79], a[4:7], v[68:71]
 s_waitcnt lgkmcnt(12)
 ds_read_b64_tr_b16 a[28:29], v9 offset:16384
 v_xor_b32 v3, 64, v14
 v_mfma_f32_16x16x32_bf16 v[68:71], a[72:75], a[0:3], v[68:71]
 ds_read_b64_tr_b16 a[30:31], v9 offset:20480
 v_mfma_f32_16x16x32_bf16 v[72:75], a[80:83], a[0:3], v[72:75]
 s_add_u32 m0, s33, 0x0
 ds_read_b128 a[96:99], v4 offset:8192
 v_mfma_f32_16x16x32_bf16 v[72:75], a[84:87], a[4:7], v[72:75]
 s_waitcnt lgkmcnt(11)
 v_mfma_f32_16x16x32_bf16 v[76:79], a[92:95], a[4:7], v[76:79]
 ds_read_b128 a[100:103], v5 offset:8192
 buffer_load_dwordx4 v15, s[20:23], 0 offen offset:0 lds
 v_mfma_f32_16x16x32_bf16 v[76:79], a[88:91], a[0:3], v[76:79]
 v_mfma_f32_16x16x32_bf16 v[84:87], a[88:91], a[8:11], v[84:87]
 s_waitcnt lgkmcnt(10)
 ds_read_b128 a[108:111], v5 offset:10240
 v_mfma_f32_16x16x32_bf16 v[84:87], a[92:95], a[12:15], v[84:87]
 s_add_u32 m0, s33, 0x80
 v_mfma_f32_16x16x32_bf16 v[80:83], a[84:87], a[12:15], v[80:83]
 ds_read_b128 a[104:107], v4 offset:10240
 buffer_load_dwordx4 v15, s[20:23], 0 offen offset:896 lds
 v_mfma_f32_16x16x32_bf16 v[80:83], a[80:83], a[8:11], v[80:83]
 v_mfma_f32_16x16x32_bf16 v[92:95], a[72:75], a[8:11], v[92:95]
 ds_read_b128 a[112:115], v4 offset:12288
 v_mfma_f32_16x16x32_bf16 v[92:95], a[76:79], a[12:15], v[92:95]
 s_add_u32 m0, s33, 0x800
 v_mfma_f32_16x16x32_bf16 v[88:91], a[68:71], a[12:15], v[88:91]
 ds_read_b128 a[116:119], v5 offset:12288
 buffer_load_dwordx4 v15, s[20:23], s57 offen offset:0 lds
 v_mfma_f32_16x16x32_bf16 v[88:91], a[64:67], a[8:11], v[88:91]
 s_waitcnt lgkmcnt(10)
 v_mfma_f32_16x16x32_bf16 v[96:99], a[64:67], a[16:19], v[96:99]
 ds_read_b128 a[124:127], v5 offset:14336
 v_mfma_f32_16x16x32_bf16 v[96:99], a[68:71], a[20:23], v[96:99]
 s_add_u32 m0, s33, 0x880
 v_mfma_f32_16x16x32_bf16 v[100:103], a[76:79], a[20:23], v[100:103]
 ds_read_b128 a[120:123], v4 offset:14336
 buffer_load_dwordx4 v15, s[20:23], s57 offen offset:896 lds
 v_mfma_f32_16x16x32_bf16 v[100:103], a[72:75], a[16:19], v[100:103]
 v_mfma_f32_16x16x32_bf16 v[104:107], a[80:83], a[16:19], v[104:107]
 ds_read_b64_tr_b16 a[32:33], v10 offset:0
 v_mfma_f32_16x16x32_bf16 v[104:107], a[84:87], a[20:23], v[104:107]
 s_add_u32 m0, s33, 0xf80
 ds_read_b64_tr_b16 a[34:35], v10 offset:4096
 v_mfma_f32_16x16x32_bf16 v[108:111], a[92:95], a[20:23], v[108:111]
 ds_read_b64_tr_b16 a[36:37], v10 offset:16384
 buffer_load_dwordx4 v15, s[20:23], 0 offen offset:128 lds
 v_mfma_f32_16x16x32_bf16 v[108:111], a[88:91], a[16:19], v[108:111]
 s_waitcnt lgkmcnt(11)
 ds_read_b64_tr_b16 a[38:39], v10 offset:20480
 v_mfma_f32_16x16x32_bf16 v[116:119], a[88:91], a[24:27], v[116:119]
 ds_read_b64_tr_b16 a[40:41], v11 offset:0
 v_mfma_f32_16x16x32_bf16 v[116:119], a[92:95], a[28:31], v[116:119]
 s_add_u32 m0, s33, 0x1000
 ds_read_b64_tr_b16 a[42:43], v11 offset:4096
 v_mfma_f32_16x16x32_bf16 v[112:115], a[84:87], a[28:31], v[112:115]
 ds_read_b64_tr_b16 a[44:45], v11 offset:16384
 buffer_load_dwordx4 v15, s[20:23], 0 offen offset:1024 lds
 v_mfma_f32_16x16x32_bf16 v[112:115], a[80:83], a[24:27], v[112:115]
 ds_read_b64_tr_b16 a[46:47], v11 offset:20480
 v_mfma_f32_16x16x32_bf16 v[124:127], a[72:75], a[24:27], v[124:127]
 ds_read_b64_tr_b16 a[48:49], v12 offset:0
 v_mfma_f32_16x16x32_bf16 v[124:127], a[76:79], a[28:31], v[124:127]
 s_add_u32 m0, s33, 0x1780
 ds_read_b64_tr_b16 a[50:51], v12 offset:4096
 v_mfma_f32_16x16x32_bf16 v[120:123], a[68:71], a[28:31], v[120:123]
 ds_read_b64_tr_b16 a[52:53], v12 offset:16384
 buffer_load_dwordx4 v15, s[20:23], s57 offen offset:128 lds
 v_mfma_f32_16x16x32_bf16 v[120:123], a[64:67], a[24:27], v[120:123]
 s_waitcnt lgkmcnt(15)
 ds_read_b64_tr_b16 a[54:55], v12 offset:20480
 v_mfma_f32_16x16x32_bf16 v[16:19], a[96:99], a[0:3], v[16:19]
 ds_read_b64_tr_b16 a[56:57], v13 offset:0
 v_mfma_f32_16x16x32_bf16 v[16:19], a[100:103], a[4:7], v[16:19]
 s_add_u32 m0, s33, 0x1800
 ds_read_b64_tr_b16 a[58:59], v13 offset:4096
 v_mfma_f32_16x16x32_bf16 v[20:23], a[108:111], a[4:7], v[20:23]
 ds_read_b64_tr_b16 a[60:61], v13 offset:16384
 buffer_load_dwordx4 v15, s[20:23], s57 offen offset:1024 lds
 v_mfma_f32_16x16x32_bf16 v[20:23], a[104:107], a[0:3], v[20:23]
 s_waitcnt lgkmcnt(15)
 ds_read_b64_tr_b16 a[62:63], v13 offset:20480
 v_mfma_f32_16x16x32_bf16 v[24:27], a[112:115], a[0:3], v[24:27]
 v_mfma_f32_16x16x32_bf16 v[24:27], a[116:119], a[4:7], v[24:27]
 v_mfma_f32_16x16x32_bf16 v[28:31], a[124:127], a[4:7], v[28:31]
 v_mfma_f32_16x16x32_bf16 v[28:31], a[120:123], a[0:3], v[28:31]
 s_waitcnt lgkmcnt(0)
 v_mfma_f32_16x16x32_bf16 a[228:231], a[120:123], a[8:11], a[228:231]
 s_barrier
 v_mfma_f32_16x16x32_bf16 a[228:231], a[124:127], a[12:15], a[228:231]
 s_add_u32 m0, s29, 65536
 v_mfma_f32_16x16x32_bf16 a[224:227], a[116:119], a[12:15], a[224:227]
 buffer_load_dwordx4 v2, s[8:11], 0 offen  lds
 v_mfma_f32_16x16x32_bf16 a[224:227], a[112:115], a[8:11], a[224:227]
 v_mfma_f32_16x16x32_bf16 a[236:239], a[104:107], a[8:11], a[236:239]
 v_mfma_f32_16x16x32_bf16 a[236:239], a[108:111], a[12:15], a[236:239]
 v_mfma_f32_16x16x32_bf16 a[232:235], a[100:103], a[12:15], a[232:235]
 s_add_u32 m0, s29, 0
 v_mfma_f32_16x16x32_bf16 a[232:235], a[96:99], a[8:11], a[232:235]
 buffer_load_dwordx4 v1, s[4:7], 0 offen  lds
 v_mfma_f32_16x16x32_bf16 v[32:35], a[96:99], a[16:19], v[32:35]
 v_mfma_f32_16x16x32_bf16 v[32:35], a[100:103], a[20:23], v[32:35]
 v_mfma_f32_16x16x32_bf16 v[36:39], a[108:111], a[20:23], v[36:39]
 v_mfma_f32_16x16x32_bf16 v[36:39], a[104:107], a[16:19], v[36:39]
 s_add_u32 m0, s29, 69632
 v_mfma_f32_16x16x32_bf16 v[40:43], a[112:115], a[16:19], v[40:43]
 buffer_load_dwordx4 v2, s[8:11], s48 offen  lds
 v_mfma_f32_16x16x32_bf16 v[40:43], a[116:119], a[20:23], v[40:43]
 v_mfma_f32_16x16x32_bf16 v[44:47], a[124:127], a[20:23], v[44:47]
 v_mfma_f32_16x16x32_bf16 v[44:47], a[120:123], a[16:19], v[44:47]
 v_mfma_f32_16x16x32_bf16 v[52:55], a[120:123], a[24:27], v[52:55]
 s_add_u32 m0, s29, 4096
 v_mfma_f32_16x16x32_bf16 v[52:55], a[124:127], a[28:31], v[52:55]
 buffer_load_dwordx4 v1, s[4:7], s41 offen  lds
 v_mfma_f32_16x16x32_bf16 v[48:51], a[116:119], a[28:31], v[48:51]
 v_mfma_f32_16x16x32_bf16 v[48:51], a[112:115], a[24:27], v[48:51]
 v_mfma_f32_16x16x32_bf16 v[60:63], a[104:107], a[24:27], v[60:63]
 v_mfma_f32_16x16x32_bf16 v[60:63], a[108:111], a[28:31], v[60:63]
 s_add_u32 m0, s29, 73728
 v_mfma_f32_16x16x32_bf16 v[56:59], a[100:103], a[28:31], v[56:59]
 buffer_load_dwordx4 v2, s[8:11], s49 offen  lds
 v_mfma_f32_16x16x32_bf16 v[56:59], a[96:99], a[24:27], v[56:59]
 v_mfma_f32_16x16x32_bf16 v[192:195], a[96:99], a[32:35], v[192:195]
 v_mfma_f32_16x16x32_bf16 v[192:195], a[100:103], a[36:39], v[192:195]
 v_mfma_f32_16x16x32_bf16 v[196:199], a[108:111], a[36:39], v[196:199]
 s_add_u32 m0, s29, 8192
 v_mfma_f32_16x16x32_bf16 v[196:199], a[104:107], a[32:35], v[196:199]
 buffer_load_dwordx4 v1, s[4:7], s42 offen  lds
 v_mfma_f32_16x16x32_bf16 v[200:203], a[112:115], a[32:35], v[200:203]
 v_mfma_f32_16x16x32_bf16 v[200:203], a[116:119], a[36:39], v[200:203]
 v_mfma_f32_16x16x32_bf16 v[204:207], a[124:127], a[36:39], v[204:207]
 v_mfma_f32_16x16x32_bf16 v[204:207], a[120:123], a[32:35], v[204:207]
 s_add_u32 m0, s29, 77824
 v_mfma_f32_16x16x32_bf16 v[212:215], a[120:123], a[40:43], v[212:215]
 buffer_load_dwordx4 v2, s[8:11], s50 offen  lds
 v_mfma_f32_16x16x32_bf16 v[212:215], a[124:127], a[44:47], v[212:215]
 v_mfma_f32_16x16x32_bf16 v[208:211], a[116:119], a[44:47], v[208:211]
 v_mfma_f32_16x16x32_bf16 v[208:211], a[112:115], a[40:43], v[208:211]
 v_mfma_f32_16x16x32_bf16 v[220:223], a[104:107], a[40:43], v[220:223]
 s_add_u32 m0, s29, 12288
 v_mfma_f32_16x16x32_bf16 v[220:223], a[108:111], a[44:47], v[220:223]
 buffer_load_dwordx4 v1, s[4:7], s43 offen  lds
 v_mfma_f32_16x16x32_bf16 v[216:219], a[100:103], a[44:47], v[216:219]
 v_mfma_f32_16x16x32_bf16 v[216:219], a[96:99], a[40:43], v[216:219]
 v_mfma_f32_16x16x32_bf16 v[224:227], a[96:99], a[48:51], v[224:227]
 v_mfma_f32_16x16x32_bf16 v[224:227], a[100:103], a[52:55], v[224:227]
 s_add_u32 m0, s29, 81920
 v_mfma_f32_16x16x32_bf16 v[228:231], a[108:111], a[52:55], v[228:231]
 buffer_load_dwordx4 v2, s[8:11], s51 offen  lds
 v_mfma_f32_16x16x32_bf16 v[228:231], a[104:107], a[48:51], v[228:231]
 v_mfma_f32_16x16x32_bf16 v[232:235], a[112:115], a[48:51], v[232:235]
 v_mfma_f32_16x16x32_bf16 v[232:235], a[116:119], a[52:55], v[232:235]
 v_mfma_f32_16x16x32_bf16 v[236:239], a[124:127], a[52:55], v[236:239]
 s_add_u32 m0, s29, 16384
 v_mfma_f32_16x16x32_bf16 v[236:239], a[120:123], a[48:51], v[236:239]
 buffer_load_dwordx4 v1, s[4:7], s44 offen  lds
 v_mfma_f32_16x16x32_bf16 v[244:247], a[120:123], a[56:59], v[244:247]
 v_mfma_f32_16x16x32_bf16 v[244:247], a[124:127], a[60:63], v[244:247]
 v_mfma_f32_16x16x32_bf16 v[240:243], a[116:119], a[60:63], v[240:243]
 v_mfma_f32_16x16x32_bf16 v[240:243], a[112:115], a[56:59], v[240:243]
 s_add_u32 m0, s29, 86016
 v_mfma_f32_16x16x32_bf16 v[252:255], a[104:107], a[56:59], v[252:255]
 s_waitcnt vmcnt(10)
 buffer_load_dwordx4 v2, s[8:11], s52 offen  lds
 v_mfma_f32_16x16x32_bf16 v[252:255], a[108:111], a[60:63], v[252:255]
 s_barrier
 ds_read_b64_tr_b16 a[0:1], v6 offset:32768
 v_mfma_f32_16x16x32_bf16 v[248:251], a[100:103], a[60:63], v[248:251]
 ds_read_b64_tr_b16 a[2:3], v6 offset:36864
 v_mfma_f32_16x16x32_bf16 v[248:251], a[96:99], a[56:59], v[248:251]
 ds_read_b128 a[96:99], v4 offset:40960
 v_mfma_f32_16x16x32_bf16 v[128:131], a[64:67], a[32:35], v[128:131]
 s_add_u32 m0, s29, 20480
 ds_read_b128 a[128:131], v14 offset:0
 v_mfma_f32_16x16x32_bf16 v[128:131], a[68:71], a[36:39], v[128:131]
 buffer_load_dwordx4 v1, s[4:7], s45 offen  lds
 v_mfma_f32_16x16x32_bf16 v[132:135], a[76:79], a[36:39], v[132:135]
 ds_read_b64_tr_b16 a[4:5], v6 offset:49152
 v_mfma_f32_16x16x32_bf16 v[132:135], a[72:75], a[32:35], v[132:135]
 ds_read_b64_tr_b16 a[6:7], v6 offset:53248
 v_mfma_f32_16x16x32_bf16 v[136:139], a[80:83], a[32:35], v[136:139]
 ds_read_b128 a[100:103], v5 offset:40960
 v_mfma_f32_16x16x32_bf16 v[136:139], a[84:87], a[36:39], v[136:139]
 s_add_u32 m0, s29, 90112
 ds_read_b128 a[136:139], v3 offset:0
 v_mfma_f32_16x16x32_bf16 v[140:143], a[92:95], a[36:39], v[140:143]
 buffer_load_dwordx4 v2, s[8:11], s53 offen  lds
 v_mfma_f32_16x16x32_bf16 v[140:143], a[88:91], a[32:35], v[140:143]
 ds_read_b128 a[108:111], v5 offset:43008
 v_mfma_f32_16x16x32_bf16 v[148:151], a[88:91], a[40:43], v[148:151]
 ds_read_b128 a[132:135], v14 offset:2048
 v_mfma_f32_16x16x32_bf16 v[148:151], a[92:95], a[44:47], v[148:151]
 ds_read_b128 a[104:107], v4 offset:43008
 v_mfma_f32_16x16x32_bf16 v[144:147], a[84:87], a[44:47], v[144:147]
 s_add_u32 m0, s29, 24576
 ds_read_b128 a[140:143], v3 offset:2048
 v_mfma_f32_16x16x32_bf16 v[144:147], a[80:83], a[40:43], v[144:147]
 buffer_load_dwordx4 v1, s[4:7], s46 offen  lds
 v_mfma_f32_16x16x32_bf16 v[156:159], a[72:75], a[40:43], v[156:159]
 ds_read_b128 a[112:115], v4 offset:45056
 v_mfma_f32_16x16x32_bf16 v[156:159], a[76:79], a[44:47], v[156:159]
 ds_read_b128 a[144:147], v14 offset:4096
 v_mfma_f32_16x16x32_bf16 v[152:155], a[68:71], a[44:47], v[152:155]
 ds_read_b128 a[116:119], v5 offset:45056
 v_mfma_f32_16x16x32_bf16 v[152:155], a[64:67], a[40:43], v[152:155]
 s_add_u32 m0, s29, 94208
 ds_read_b128 a[152:155], v3 offset:4096
 v_mfma_f32_16x16x32_bf16 v[160:163], a[64:67], a[48:51], v[160:163]
 buffer_load_dwordx4 v2, s[8:11], s54 offen  lds
 v_mfma_f32_16x16x32_bf16 v[160:163], a[68:71], a[52:55], v[160:163]
 ds_read_b128 a[124:127], v5 offset:47104
 v_mfma_f32_16x16x32_bf16 v[164:167], a[76:79], a[52:55], v[164:167]
 ds_read_b128 a[148:151], v14 offset:6144
 v_mfma_f32_16x16x32_bf16 v[164:167], a[72:75], a[48:51], v[164:167]
 ds_read_b128 a[120:123], v4 offset:47104
 v_mfma_f32_16x16x32_bf16 v[168:171], a[80:83], a[48:51], v[168:171]
 s_add_u32 m0, s29, 28672
 ds_read_b128 a[156:159], v3 offset:6144
 v_mfma_f32_16x16x32_bf16 v[168:171], a[84:87], a[52:55], v[168:171]
 buffer_load_dwordx4 v1, s[4:7], s47 offen  lds
 v_mfma_f32_16x16x32_bf16 v[172:175], a[92:95], a[52:55], v[172:175]
 v_add_u32 v1, 128, v1
 v_add_u32 v2, 0x80000, v2
 v_mfma_f32_16x16x32_bf16 v[172:175], a[88:91], a[48:51], v[172:175]
 ds_read_b64_tr_b16 a[8:9], v7 offset:32768
 v_mfma_f32_16x16x32_bf16 v[180:183], a[88:91], a[56:59], v[180:183]
 v_mfma_f32_16x16x32_bf16 v[180:183], a[92:95], a[60:63], v[180:183]
 ds_read_b64_tr_b16 a[10:11], v7 offset:36864
 v_mfma_f32_16x16x32_bf16 v[176:179], a[84:87], a[60:63], v[176:179]
 ds_read_b64_tr_b16 a[12:13], v7 offset:49152
 v_mfma_f32_16x16x32_bf16 v[176:179], a[80:83], a[56:59], v[176:179]
 ds_read_b64_tr_b16 a[14:15], v7 offset:53248
 v_mfma_f32_16x16x32_bf16 v[188:191], a[72:75], a[56:59], v[188:191]
 ds_read_b64_tr_b16 a[16:17], v8 offset:32768
 v_mfma_f32_16x16x32_bf16 v[188:191], a[76:79], a[60:63], v[188:191]
 ds_read_b64_tr_b16 a[18:19], v8 offset:36864
 v_mfma_f32_16x16x32_bf16 v[184:187], a[68:71], a[60:63], v[184:187]
 ds_read_b64_tr_b16 a[20:21], v8 offset:49152
 v_mfma_f32_16x16x32_bf16 v[184:187], a[64:67], a[56:59], v[184:187]
 s_waitcnt lgkmcnt(15)
 ds_read_b64_tr_b16 a[22:23], v8 offset:53248
 v_mfma_f32_16x16x32_bf16 v[16:19], a[96:99], a[0:3], v[16:19]
 ds_read_b64_tr_b16 a[24:25], v9 offset:32768
 v_mfma_f32_16x16x32_bf16 v[16:19], a[100:103], a[4:7], v[16:19]
 s_add_u32 m0, s33, 0xffffff00
 ds_read_b64_tr_b16 a[26:27], v9 offset:36864
 v_mfma_f32_16x16x32_bf16 v[20:23], a[108:111], a[4:7], v[20:23]
 s_waitcnt lgkmcnt(10)
 ds_read_b64_tr_b16 a[28:29], v9 offset:49152
 v_mfma_f32_16x16x32_bf16 v[20:23], a[104:107], a[0:3], v[20:23]
 ds_read_b64_tr_b16 a[30:31], v9 offset:53248
 buffer_load_dwordx4 v15, s[20:23], 0 offen offset:256 lds
 v_mfma_f32_16x16x32_bf16 v[24:27], a[112:115], a[0:3], v[24:27]
 ds_read_b128 a[64:67], v4 offset:32768
 v_mfma_f32_16x16x32_bf16 v[24:27], a[116:119], a[4:7], v[24:27]
 v_mfma_f32_16x16x32_bf16 v[28:31], a[124:127], a[4:7], v[28:31]
 s_add_u32 m0, s33, 0xffffff80
 ds_read_b128 a[68:71], v5 offset:32768
 v_mfma_f32_16x16x32_bf16 v[28:31], a[120:123], a[0:3], v[28:31]
 s_waitcnt lgkmcnt(10)
 buffer_load_dwordx4 v15, s[20:23], 0 offen offset:1152 lds
 v_mfma_f32_16x16x32_bf16 a[228:231], a[120:123], a[8:11], a[228:231]
 ds_read_b128 a[76:79], v5 offset:34816
 v_mfma_f32_16x16x32_bf16 a[228:231], a[124:127], a[12:15], a[228:231]
 v_mfma_f32_16x16x32_bf16 a[224:227], a[116:119], a[12:15], a[224:227]
 s_add_u32 m0, s33, 0x700
 ds_read_b128 a[72:75], v4 offset:34816
 v_mfma_f32_16x16x32_bf16 a[224:227], a[112:115], a[8:11], a[224:227]
 buffer_load_dwordx4 v15, s[20:23], s57 offen offset:256 lds
 v_mfma_f32_16x16x32_bf16 a[236:239], a[104:107], a[8:11], a[236:239]
 ds_read_b128 a[80:83], v4 offset:36864
 v_mfma_f32_16x16x32_bf16 a[236:239], a[108:111], a[12:15], a[236:239]
 v_mfma_f32_16x16x32_bf16 a[232:235], a[100:103], a[12:15], a[232:235]
 s_add_u32 m0, s33, 0x780
 ds_read_b128 a[84:87], v5 offset:36864
 v_mfma_f32_16x16x32_bf16 a[232:235], a[96:99], a[8:11], a[232:235]
 s_waitcnt lgkmcnt(10)
 buffer_load_dwordx4 v15, s[20:23], s57 offen offset:1152 lds
 v_mfma_f32_16x16x32_bf16 v[32:35], a[96:99], a[16:19], v[32:35]
 ds_read_b128 a[92:95], v5 offset:38912
 v_mfma_f32_16x16x32_bf16 v[32:35], a[100:103], a[20:23], v[32:35]
 v_mfma_f32_16x16x32_bf16 v[36:39], a[108:111], a[20:23], v[36:39]
 s_add_u32 m0, s33, 0xe80
 ds_read_b128 a[88:91], v4 offset:38912
 v_mfma_f32_16x16x32_bf16 v[36:39], a[104:107], a[16:19], v[36:39]
 buffer_load_dwordx4 v15, s[20:23], 0 offen offset:384 lds
 v_mfma_f32_16x16x32_bf16 v[40:43], a[112:115], a[16:19], v[40:43]
 ds_read_b64_tr_b16 a[32:33], v10 offset:32768
 v_mfma_f32_16x16x32_bf16 v[40:43], a[116:119], a[20:23], v[40:43]
 ds_read_b64_tr_b16 a[34:35], v10 offset:36864
 v_mfma_f32_16x16x32_bf16 v[44:47], a[124:127], a[20:23], v[44:47]
 s_add_u32 m0, s33, 0xf00
 ds_read_b64_tr_b16 a[36:37], v10 offset:49152
 v_mfma_f32_16x16x32_bf16 v[44:47], a[120:123], a[16:19], v[44:47]
 s_waitcnt lgkmcnt(11)
 ds_read_b64_tr_b16 a[38:39], v10 offset:53248
 buffer_load_dwordx4 v15, s[20:23], 0 offen offset:1280 lds
 v_mfma_f32_16x16x32_bf16 v[52:55], a[120:123], a[24:27], v[52:55]
 ds_read_b64_tr_b16 a[40:41], v11 offset:32768
 v_mfma_f32_16x16x32_bf16 v[52:55], a[124:127], a[28:31], v[52:55]
 ds_read_b64_tr_b16 a[42:43], v11 offset:36864
 v_mfma_f32_16x16x32_bf16 v[48:51], a[116:119], a[28:31], v[48:51]
 s_add_u32 m0, s33, 0x1680
 ds_read_b64_tr_b16 a[44:45], v11 offset:49152
 v_mfma_f32_16x16x32_bf16 v[48:51], a[112:115], a[24:27], v[48:51]
 ds_read_b64_tr_b16 a[46:47], v11 offset:53248
 buffer_load_dwordx4 v15, s[20:23], s57 offen offset:384 lds
 v_mfma_f32_16x16x32_bf16 v[60:63], a[104:107], a[24:27], v[60:63]
 ds_read_b64_tr_b16 a[48:49], v12 offset:32768
 v_mfma_f32_16x16x32_bf16 v[60:63], a[108:111], a[28:31], v[60:63]
 ds_read_b64_tr_b16 a[50:51], v12 offset:36864
 v_mfma_f32_16x16x32_bf16 v[56:59], a[100:103], a[28:31], v[56:59]
 s_add_u32 m0, s33, 0x1700
 ds_read_b64_tr_b16 a[52:53], v12 offset:49152
 v_mfma_f32_16x16x32_bf16 v[56:59], a[96:99], a[24:27], v[56:59]
 s_waitcnt lgkmcnt(15)
 ds_read_b64_tr_b16 a[54:55], v12 offset:53248
 buffer_load_dwordx4 v15, s[20:23], s57 offen offset:1280 lds
 v_mfma_f32_16x16x32_bf16 v[64:67], a[64:67], a[0:3], v[64:67]
 ds_read_b64_tr_b16 a[56:57], v13 offset:32768
 v_mfma_f32_16x16x32_bf16 v[64:67], a[68:71], a[4:7], v[64:67]
 ds_read_b64_tr_b16 a[58:59], v13 offset:36864
 v_mfma_f32_16x16x32_bf16 v[68:71], a[76:79], a[4:7], v[68:71]
 ds_read_b64_tr_b16 a[60:61], v13 offset:49152
 v_mfma_f32_16x16x32_bf16 v[68:71], a[72:75], a[0:3], v[68:71]
 s_waitcnt lgkmcnt(15)
 ds_read_b64_tr_b16 a[62:63], v13 offset:53248
 v_mfma_f32_16x16x32_bf16 v[72:75], a[80:83], a[0:3], v[72:75]
 v_mfma_f32_16x16x32_bf16 v[72:75], a[84:87], a[4:7], v[72:75]
 v_mfma_f32_16x16x32_bf16 v[76:79], a[92:95], a[4:7], v[76:79]
 v_mfma_f32_16x16x32_bf16 v[76:79], a[88:91], a[0:3], v[76:79]
 s_waitcnt lgkmcnt(0)
 v_mfma_f32_16x16x32_bf16 v[84:87], a[88:91], a[8:11], v[84:87]
 s_barrier
 v_mfma_f32_16x16x32_bf16 v[84:87], a[92:95], a[12:15], v[84:87]
 s_add_u32 m0, s29, 98304
 v_mfma_f32_16x16x32_bf16 v[80:83], a[84:87], a[12:15], v[80:83]
 buffer_load_dwordx4 v2, s[8:11], 0 offen  lds
 v_mfma_f32_16x16x32_bf16 v[80:83], a[80:83], a[8:11], v[80:83]
 v_mfma_f32_16x16x32_bf16 v[92:95], a[72:75], a[8:11], v[92:95]
 v_mfma_f32_16x16x32_bf16 v[92:95], a[76:79], a[12:15], v[92:95]
 v_mfma_f32_16x16x32_bf16 v[88:91], a[68:71], a[12:15], v[88:91]
 s_add_u32 m0, s29, 32768
 v_mfma_f32_16x16x32_bf16 v[88:91], a[64:67], a[8:11], v[88:91]
 buffer_load_dwordx4 v1, s[4:7], 0 offen  lds
 v_mfma_f32_16x16x32_bf16 v[96:99], a[64:67], a[16:19], v[96:99]
 v_mfma_f32_16x16x32_bf16 v[96:99], a[68:71], a[20:23], v[96:99]
 v_mfma_f32_16x16x32_bf16 v[100:103], a[76:79], a[20:23], v[100:103]
 v_mfma_f32_16x16x32_bf16 v[100:103], a[72:75], a[16:19], v[100:103]
 s_add_u32 m0, s29, 102400
 v_mfma_f32_16x16x32_bf16 v[104:107], a[80:83], a[16:19], v[104:107]
 buffer_load_dwordx4 v2, s[8:11], s48 offen  lds
 v_mfma_f32_16x16x32_bf16 v[104:107], a[84:87], a[20:23], v[104:107]
 v_mfma_f32_16x16x32_bf16 v[108:111], a[92:95], a[20:23], v[108:111]
 v_mfma_f32_16x16x32_bf16 v[108:111], a[88:91], a[16:19], v[108:111]
 v_mfma_f32_16x16x32_bf16 v[116:119], a[88:91], a[24:27], v[116:119]
 s_add_u32 m0, s29, 36864
 v_mfma_f32_16x16x32_bf16 v[116:119], a[92:95], a[28:31], v[116:119]
 buffer_load_dwordx4 v1, s[4:7], s41 offen  lds
 v_mfma_f32_16x16x32_bf16 v[112:115], a[84:87], a[28:31], v[112:115]
 v_mfma_f32_16x16x32_bf16 v[112:115], a[80:83], a[24:27], v[112:115]
 v_mfma_f32_16x16x32_bf16 v[124:127], a[72:75], a[24:27], v[124:127]
 v_mfma_f32_16x16x32_bf16 v[124:127], a[76:79], a[28:31], v[124:127]
 s_add_u32 m0, s29, 106496
 v_mfma_f32_16x16x32_bf16 v[120:123], a[68:71], a[28:31], v[120:123]
 buffer_load_dwordx4 v2, s[8:11], s49 offen  lds
 v_mfma_f32_16x16x32_bf16 v[120:123], a[64:67], a[24:27], v[120:123]
 v_mfma_f32_16x16x32_bf16 v[128:131], a[64:67], a[32:35], v[128:131]
 v_mfma_f32_16x16x32_bf16 v[128:131], a[68:71], a[36:39], v[128:131]
 v_mfma_f32_16x16x32_bf16 v[132:135], a[76:79], a[36:39], v[132:135]
 s_add_u32 m0, s29, 40960
 v_mfma_f32_16x16x32_bf16 v[132:135], a[72:75], a[32:35], v[132:135]
 buffer_load_dwordx4 v1, s[4:7], s42 offen  lds
 v_mfma_f32_16x16x32_bf16 v[136:139], a[80:83], a[32:35], v[136:139]
 v_mfma_f32_16x16x32_bf16 v[136:139], a[84:87], a[36:39], v[136:139]
 v_mfma_f32_16x16x32_bf16 v[140:143], a[92:95], a[36:39], v[140:143]
 v_mfma_f32_16x16x32_bf16 v[140:143], a[88:91], a[32:35], v[140:143]
 s_add_u32 m0, s29, 110592
 v_mfma_f32_16x16x32_bf16 v[148:151], a[88:91], a[40:43], v[148:151]
 buffer_load_dwordx4 v2, s[8:11], s50 offen  lds
 v_mfma_f32_16x16x32_bf16 v[148:151], a[92:95], a[44:47], v[148:151]
 v_mfma_f32_16x16x32_bf16 v[144:147], a[84:87], a[44:47], v[144:147]
 v_mfma_f32_16x16x32_bf16 v[144:147], a[80:83], a[40:43], v[144:147]
 v_mfma_f32_16x16x32_bf16 v[156:159], a[72:75], a[40:43], v[156:159]
 s_add_u32 m0, s29, 45056
 v_mfma_f32_16x16x32_bf16 v[156:159], a[76:79], a[44:47], v[156:159]
 buffer_load_dwordx4 v1, s[4:7], s43 offen  lds
 v_mfma_f32_16x16x32_bf16 v[152:155], a[68:71], a[44:47], v[152:155]
 v_mfma_f32_16x16x32_bf16 v[152:155], a[64:67], a[40:43], v[152:155]
 v_mfma_f32_16x16x32_bf16 v[160:163], a[64:67], a[48:51], v[160:163]
 v_mfma_f32_16x16x32_bf16 v[160:163], a[68:71], a[52:55], v[160:163]
 s_add_u32 m0, s29, 114688
 v_mfma_f32_16x16x32_bf16 v[164:167], a[76:79], a[52:55], v[164:167]
 buffer_load_dwordx4 v2, s[8:11], s51 offen  lds
 v_mfma_f32_16x16x32_bf16 v[164:167], a[72:75], a[48:51], v[164:167]
 v_mfma_f32_16x16x32_bf16 v[168:171], a[80:83], a[48:51], v[168:171]
 v_mfma_f32_16x16x32_bf16 v[168:171], a[84:87], a[52:55], v[168:171]
 v_mfma_f32_16x16x32_bf16 v[172:175], a[92:95], a[52:55], v[172:175]
 s_add_u32 m0, s29, 49152
 v_mfma_f32_16x16x32_bf16 v[172:175], a[88:91], a[48:51], v[172:175]
 buffer_load_dwordx4 v1, s[4:7], s44 offen  lds
 v_mfma_f32_16x16x32_bf16 v[180:183], a[88:91], a[56:59], v[180:183]
 v_mfma_f32_16x16x32_bf16 v[180:183], a[92:95], a[60:63], v[180:183]
 v_mfma_f32_16x16x32_bf16 v[176:179], a[84:87], a[60:63], v[176:179]
 v_mfma_f32_16x16x32_bf16 v[176:179], a[80:83], a[56:59], v[176:179]
 s_add_u32 m0, s29, 118784
 v_mfma_f32_16x16x32_bf16 v[188:191], a[72:75], a[56:59], v[188:191]
 s_waitcnt vmcnt(10)
 buffer_load_dwordx4 v2, s[8:11], s52 offen  lds
 v_mfma_f32_16x16x32_bf16 v[188:191], a[76:79], a[60:63], v[188:191]
 s_barrier
 ds_read_b64_tr_b16 a[0:1], v6 offset:0
 v_mfma_f32_16x16x32_bf16 v[184:187], a[68:71], a[60:63], v[184:187]
 ds_read_b64_tr_b16 a[2:3], v6 offset:4096
 v_mfma_f32_16x16x32_bf16 v[184:187], a[64:67], a[56:59], v[184:187]
 ds_read_b128 a[64:67], v4 offset:0
 v_mfma_f32_16x16x32_bf16 v[192:195], a[96:99], a[32:35], v[192:195]
 s_add_u32 m0, s29, 53248
 ds_read_b128 a[160:163], v14 offset:0
 v_mfma_f32_16x16x32_bf16 v[192:195], a[100:103], a[36:39], v[192:195]
 buffer_load_dwordx4 v1, s[4:7], s45 offen  lds
 v_mfma_f32_16x16x32_bf16 v[196:199], a[108:111], a[36:39], v[196:199]
 ds_read_b64_tr_b16 a[4:5], v6 offset:16384
 v_mfma_f32_16x16x32_bf16 v[196:199], a[104:107], a[32:35], v[196:199]
 ds_read_b64_tr_b16 a[6:7], v6 offset:20480
 v_mfma_f32_16x16x32_bf16 v[200:203], a[112:115], a[32:35], v[200:203]
 ds_read_b128 a[68:71], v5 offset:0
 v_mfma_f32_16x16x32_bf16 v[200:203], a[116:119], a[36:39], v[200:203]
 s_add_u32 m0, s29, 122880
 ds_read_b128 a[168:171], v3 offset:0
 v_mfma_f32_16x16x32_bf16 v[204:207], a[124:127], a[36:39], v[204:207]
 buffer_load_dwordx4 v2, s[8:11], s53 offen  lds
 v_mfma_f32_16x16x32_bf16 v[204:207], a[120:123], a[32:35], v[204:207]
 ds_read_b128 a[76:79], v5 offset:2048
 v_mfma_f32_16x16x32_bf16 v[212:215], a[120:123], a[40:43], v[212:215]
 ds_read_b128 a[164:167], v14 offset:2048
 v_mfma_f32_16x16x32_bf16 v[212:215], a[124:127], a[44:47], v[212:215]
 ds_read_b128 a[72:75], v4 offset:2048
 v_mfma_f32_16x16x32_bf16 v[208:211], a[116:119], a[44:47], v[208:211]
 s_add_u32 m0, s29, 57344
 ds_read_b128 a[172:175], v3 offset:2048
 v_mfma_f32_16x16x32_bf16 v[208:211], a[112:115], a[40:43], v[208:211]
 buffer_load_dwordx4 v1, s[4:7], s46 offen  lds
 v_mfma_f32_16x16x32_bf16 v[220:223], a[104:107], a[40:43], v[220:223]
 ds_read_b128 a[80:83], v4 offset:4096
 v_mfma_f32_16x16x32_bf16 v[220:223], a[108:111], a[44:47], v[220:223]
 ds_read_b128 a[176:179], v14 offset:4096
 v_mfma_f32_16x16x32_bf16 v[216:219], a[100:103], a[44:47], v[216:219]
 ds_read_b128 a[84:87], v5 offset:4096
 v_mfma_f32_16x16x32_bf16 v[216:219], a[96:99], a[40:43], v[216:219]
 s_add_u32 m0, s29, 126976
 ds_read_b128 a[184:187], v3 offset:4096
 v_mfma_f32_16x16x32_bf16 v[224:227], a[96:99], a[48:51], v[224:227]
 buffer_load_dwordx4 v2, s[8:11], s54 offen  lds
 v_mfma_f32_16x16x32_bf16 v[224:227], a[100:103], a[52:55], v[224:227]
 ds_read_b128 a[92:95], v5 offset:6144
 v_mfma_f32_16x16x32_bf16 v[228:231], a[108:111], a[52:55], v[228:231]
 ds_read_b128 a[180:183], v14 offset:6144
 v_mfma_f32_16x16x32_bf16 v[228:231], a[104:107], a[48:51], v[228:231]
 ds_read_b128 a[88:91], v4 offset:6144
 v_mfma_f32_16x16x32_bf16 v[232:235], a[112:115], a[48:51], v[232:235]
 s_add_u32 m0, s29, 61440
 ds_read_b128 a[188:191], v3 offset:6144
 v_mfma_f32_16x16x32_bf16 v[232:235], a[116:119], a[52:55], v[232:235]
 buffer_load_dwordx4 v1, s[4:7], s47 offen  lds
 v_mfma_f32_16x16x32_bf16 v[236:239], a[124:127], a[52:55], v[236:239]
 v_add_u32 v1, 128, v1
 v_add_u32 v2, 0x80000, v2
 v_mfma_f32_16x16x32_bf16 v[236:239], a[120:123], a[48:51], v[236:239]
 ds_read_b64_tr_b16 a[8:9], v7 offset:0
 v_mfma_f32_16x16x32_bf16 v[244:247], a[120:123], a[56:59], v[244:247]
 v_mfma_f32_16x16x32_bf16 v[244:247], a[124:127], a[60:63], v[244:247]
 ds_read_b64_tr_b16 a[10:11], v7 offset:4096
 v_mfma_f32_16x16x32_bf16 v[240:243], a[116:119], a[60:63], v[240:243]
 ds_read_b64_tr_b16 a[12:13], v7 offset:16384
 v_mfma_f32_16x16x32_bf16 v[240:243], a[112:115], a[56:59], v[240:243]
 ds_read_b64_tr_b16 a[14:15], v7 offset:20480
 v_mfma_f32_16x16x32_bf16 v[252:255], a[104:107], a[56:59], v[252:255]
 ds_read_b64_tr_b16 a[16:17], v8 offset:0
 v_mfma_f32_16x16x32_bf16 v[252:255], a[108:111], a[60:63], v[252:255]
 ds_read_b64_tr_b16 a[18:19], v8 offset:4096
 v_mfma_f32_16x16x32_bf16 v[248:251], a[100:103], a[60:63], v[248:251]
 ds_read_b64_tr_b16 a[20:21], v8 offset:16384
 v_mfma_f32_16x16x32_bf16 v[248:251], a[96:99], a[56:59], v[248:251]
 s_waitcnt lgkmcnt(15)
 ds_read_b64_tr_b16 a[22:23], v8 offset:20480
 v_mfma_f32_16x16x32_bf16 v[64:67], a[64:67], a[0:3], v[64:67]
 ds_read_b64_tr_b16 a[24:25], v9 offset:0
 v_lshlrev_b32 v1, 4, v0
 v_mfma_f32_16x16x32_bf16 v[64:67], a[68:71], a[4:7], v[64:67]
 s_add_u32 m0, s33, 0xfffffe00
 ds_read_b64_tr_b16 a[26:27], v9 offset:4096
 v_mfma_f32_16x16x32_bf16 v[68:71], a[76:79], a[4:7], v[68:71]
 s_waitcnt lgkmcnt(10)
 ds_read_b64_tr_b16 a[28:29], v9 offset:16384
 v_mfma_f32_16x16x32_bf16 v[68:71], a[72:75], a[0:3], v[68:71]
 ds_read_b64_tr_b16 a[30:31], v9 offset:20480
 buffer_load_dwordx4 v15, s[20:23], 0 offen offset:512 lds
 v_mfma_f32_16x16x32_bf16 v[72:75], a[80:83], a[0:3], v[72:75]
 ds_read_b128 a[96:99], v4 offset:8192
 v_mfma_f32_16x16x32_bf16 v[72:75], a[84:87], a[4:7], v[72:75]
 v_mfma_f32_16x16x32_bf16 v[76:79], a[92:95], a[4:7], v[76:79]
 s_add_u32 m0, s33, 0xfffffe80
 ds_read_b128 a[100:103], v5 offset:8192
 v_mfma_f32_16x16x32_bf16 v[76:79], a[88:91], a[0:3], v[76:79]
 s_waitcnt lgkmcnt(10)
 buffer_load_dwordx4 v15, s[20:23], 0 offen offset:1408 lds
 v_mfma_f32_16x16x32_bf16 v[84:87], a[88:91], a[8:11], v[84:87]
 ds_read_b128 a[108:111], v5 offset:10240
 v_mfma_f32_16x16x32_bf16 v[84:87], a[92:95], a[12:15], v[84:87]
 v_mfma_f32_16x16x32_bf16 v[80:83], a[84:87], a[12:15], v[80:83]
 s_add_u32 m0, s33, 0x600
 ds_read_b128 a[104:107], v4 offset:10240
 v_mfma_f32_16x16x32_bf16 v[80:83], a[80:83], a[8:11], v[80:83]
 buffer_load_dwordx4 v15, s[20:23], s57 offen offset:512 lds
 v_mfma_f32_16x16x32_bf16 v[92:95], a[72:75], a[8:11], v[92:95]
 ds_read_b128 a[112:115], v4 offset:12288
 v_mfma_f32_16x16x32_bf16 v[92:95], a[76:79], a[12:15], v[92:95]
 v_mfma_f32_16x16x32_bf16 v[88:91], a[68:71], a[12:15], v[88:91]
 s_add_u32 m0, s33, 0x680
 ds_read_b128 a[116:119], v5 offset:12288
 v_mfma_f32_16x16x32_bf16 v[88:91], a[64:67], a[8:11], v[88:91]
 s_waitcnt lgkmcnt(10)
 buffer_load_dwordx4 v15, s[20:23], s57 offen offset:1408 lds
 v_mfma_f32_16x16x32_bf16 v[96:99], a[64:67], a[16:19], v[96:99]
 ds_read_b128 a[124:127], v5 offset:14336
 v_mfma_f32_16x16x32_bf16 v[96:99], a[68:71], a[20:23], v[96:99]
 v_mfma_f32_16x16x32_bf16 v[100:103], a[76:79], a[20:23], v[100:103]
 s_add_u32 m0, s33, 0xd80
 ds_read_b128 a[120:123], v4 offset:14336
 v_mfma_f32_16x16x32_bf16 v[100:103], a[72:75], a[16:19], v[100:103]
 buffer_load_dwordx4 v15, s[20:23], 0 offen offset:640 lds
 v_mfma_f32_16x16x32_bf16 v[104:107], a[80:83], a[16:19], v[104:107]
 ds_read_b64_tr_b16 a[32:33], v10 offset:0
 v_mfma_f32_16x16x32_bf16 v[104:107], a[84:87], a[20:23], v[104:107]
 ds_read_b64_tr_b16 a[34:35], v10 offset:4096
 v_mfma_f32_16x16x32_bf16 v[108:111], a[92:95], a[20:23], v[108:111]
 s_add_u32 m0, s33, 0xe00
 ds_read_b64_tr_b16 a[36:37], v10 offset:16384
 v_mfma_f32_16x16x32_bf16 v[108:111], a[88:91], a[16:19], v[108:111]
 s_waitcnt lgkmcnt(11)
 ds_read_b64_tr_b16 a[38:39], v10 offset:20480
 buffer_load_dwordx4 v15, s[20:23], 0 offen offset:1536 lds
 v_mfma_f32_16x16x32_bf16 v[116:119], a[88:91], a[24:27], v[116:119]
 ds_read_b64_tr_b16 a[40:41], v11 offset:0
 v_mfma_f32_16x16x32_bf16 v[116:119], a[92:95], a[28:31], v[116:119]
 ds_read_b64_tr_b16 a[42:43], v11 offset:4096
 v_mfma_f32_16x16x32_bf16 v[112:115], a[84:87], a[28:31], v[112:115]
 s_add_u32 m0, s33, 0x1580
 ds_read_b64_tr_b16 a[44:45], v11 offset:16384
 v_mfma_f32_16x16x32_bf16 v[112:115], a[80:83], a[24:27], v[112:115]
 ds_read_b64_tr_b16 a[46:47], v11 offset:20480
 buffer_load_dwordx4 v15, s[20:23], s57 offen offset:640 lds
 v_mfma_f32_16x16x32_bf16 v[124:127], a[72:75], a[24:27], v[124:127]
 ds_read_b64_tr_b16 a[48:49], v12 offset:0
 v_mfma_f32_16x16x32_bf16 v[124:127], a[76:79], a[28:31], v[124:127]
 ds_read_b64_tr_b16 a[50:51], v12 offset:4096
 v_mfma_f32_16x16x32_bf16 v[120:123], a[68:71], a[28:31], v[120:123]
 s_add_u32 m0, s33, 0x1600
 ds_read_b64_tr_b16 a[52:53], v12 offset:16384
 v_mfma_f32_16x16x32_bf16 v[120:123], a[64:67], a[24:27], v[120:123]
 s_waitcnt lgkmcnt(15)
 ds_read_b64_tr_b16 a[54:55], v12 offset:20480
 buffer_load_dwordx4 v15, s[20:23], s57 offen offset:1536 lds
 v_mfma_f32_16x16x32_bf16 v[16:19], a[96:99], a[0:3], v[16:19]
 ds_read_b64_tr_b16 a[56:57], v13 offset:0
 v_mfma_f32_16x16x32_bf16 v[16:19], a[100:103], a[4:7], v[16:19]
 ds_read_b64_tr_b16 a[58:59], v13 offset:4096
 v_mfma_f32_16x16x32_bf16 v[20:23], a[108:111], a[4:7], v[20:23]
 ds_read_b64_tr_b16 a[60:61], v13 offset:16384
 v_mfma_f32_16x16x32_bf16 v[20:23], a[104:107], a[0:3], v[20:23]
 s_waitcnt lgkmcnt(15)
 ds_read_b64_tr_b16 a[62:63], v13 offset:20480
 v_mfma_f32_16x16x32_bf16 v[24:27], a[112:115], a[0:3], v[24:27]
 v_mfma_f32_16x16x32_bf16 v[24:27], a[116:119], a[4:7], v[24:27]
 v_mfma_f32_16x16x32_bf16 v[28:31], a[124:127], a[4:7], v[28:31]
 v_mfma_f32_16x16x32_bf16 v[28:31], a[120:123], a[0:3], v[28:31]
 s_waitcnt lgkmcnt(0)
 v_mfma_f32_16x16x32_bf16 a[228:231], a[120:123], a[8:11], a[228:231]
 s_barrier
 v_mfma_f32_16x16x32_bf16 a[228:231], a[124:127], a[12:15], a[228:231]
 s_add_u32 m0, s29, 0
 v_add_u32 v2, 0xff800000, v2
 v_mfma_f32_16x16x32_bf16 a[224:227], a[116:119], a[12:15], a[224:227]
 buffer_load_dwordx4 v2, s[16:19], 0 offen lds
 v_mfma_f32_16x16x32_bf16 a[224:227], a[112:115], a[8:11], a[224:227]
 v_mfma_f32_16x16x32_bf16 a[236:239], a[104:107], a[8:11], a[236:239]
 v_mfma_f32_16x16x32_bf16 a[236:239], a[108:111], a[12:15], a[236:239]
 v_mfma_f32_16x16x32_bf16 a[232:235], a[100:103], a[12:15], a[232:235]
 s_add_u32 m0, s29, 4096
 v_mfma_f32_16x16x32_bf16 a[232:235], a[96:99], a[8:11], a[232:235]
 buffer_load_dwordx4 v2, s[16:19], s48 offen lds
 v_mfma_f32_16x16x32_bf16 v[32:35], a[96:99], a[16:19], v[32:35]
 v_mfma_f32_16x16x32_bf16 v[32:35], a[100:103], a[20:23], v[32:35]
 v_mfma_f32_16x16x32_bf16 v[36:39], a[108:111], a[20:23], v[36:39]
 v_mfma_f32_16x16x32_bf16 v[36:39], a[104:107], a[16:19], v[36:39]
 s_add_u32 m0, s29, 8192
 v_mfma_f32_16x16x32_bf16 v[40:43], a[112:115], a[16:19], v[40:43]
 buffer_load_dwordx4 v2, s[16:19], s49 offen lds
 v_mfma_f32_16x16x32_bf16 v[40:43], a[116:119], a[20:23], v[40:43]
 v_mfma_f32_16x16x32_bf16 v[44:47], a[124:127], a[20:23], v[44:47]
 v_mfma_f32_16x16x32_bf16 v[44:47], a[120:123], a[16:19], v[44:47]
 v_mfma_f32_16x16x32_bf16 v[52:55], a[120:123], a[24:27], v[52:55]
 s_add_u32 m0, s29, 12288
 v_mfma_f32_16x16x32_bf16 v[52:55], a[124:127], a[28:31], v[52:55]
 buffer_load_dwordx4 v2, s[16:19], s50 offen lds
 v_mfma_f32_16x16x32_bf16 v[48:51], a[116:119], a[28:31], v[48:51]
 v_mfma_f32_16x16x32_bf16 v[48:51], a[112:115], a[24:27], v[48:51]
 v_mfma_f32_16x16x32_bf16 v[60:63], a[104:107], a[24:27], v[60:63]
 v_mfma_f32_16x16x32_bf16 v[60:63], a[108:111], a[28:31], v[60:63]
 s_add_u32 m0, s29, 16384
 v_mfma_f32_16x16x32_bf16 v[56:59], a[100:103], a[28:31], v[56:59]
 buffer_load_dwordx4 v2, s[16:19], s51 offen lds
 v_mfma_f32_16x16x32_bf16 v[56:59], a[96:99], a[24:27], v[56:59]
 v_mfma_f32_16x16x32_bf16 v[192:195], a[96:99], a[32:35], v[192:195]
 v_mfma_f32_16x16x32_bf16 v[192:195], a[100:103], a[36:39], v[192:195]
 v_mfma_f32_16x16x32_bf16 v[196:199], a[108:111], a[36:39], v[196:199]
 s_add_u32 m0, s29, 20480
 v_mfma_f32_16x16x32_bf16 v[196:199], a[104:107], a[32:35], v[196:199]
 buffer_load_dwordx4 v2, s[16:19], s52 offen lds
 v_mfma_f32_16x16x32_bf16 v[200:203], a[112:115], a[32:35], v[200:203]
 v_mfma_f32_16x16x32_bf16 v[200:203], a[116:119], a[36:39], v[200:203]
 v_mfma_f32_16x16x32_bf16 v[204:207], a[124:127], a[36:39], v[204:207]
 v_mfma_f32_16x16x32_bf16 v[204:207], a[120:123], a[32:35], v[204:207]
 s_add_u32 m0, s29, 24576
 v_mfma_f32_16x16x32_bf16 v[212:215], a[120:123], a[40:43], v[212:215]
 buffer_load_dwordx4 v2, s[16:19], s53 offen lds
 v_mfma_f32_16x16x32_bf16 v[212:215], a[124:127], a[44:47], v[212:215]
 v_mfma_f32_16x16x32_bf16 v[208:211], a[116:119], a[44:47], v[208:211]
 v_mfma_f32_16x16x32_bf16 v[208:211], a[112:115], a[40:43], v[208:211]
 v_mfma_f32_16x16x32_bf16 v[220:223], a[104:107], a[40:43], v[220:223]
 s_add_u32 m0, s29, 28672
 v_mfma_f32_16x16x32_bf16 v[220:223], a[108:111], a[44:47], v[220:223]
 buffer_load_dwordx4 v2, s[16:19], s54 offen lds
 v_mfma_f32_16x16x32_bf16 v[216:219], a[100:103], a[44:47], v[216:219]
 v_mfma_f32_16x16x32_bf16 v[216:219], a[96:99], a[40:43], v[216:219]
 v_mfma_f32_16x16x32_bf16 v[224:227], a[96:99], a[48:51], v[224:227]
 s_add_u32 m0, s29, 65536
 v_add_u32 v2, 0x80000, v2
 v_mfma_f32_16x16x32_bf16 v[224:227], a[100:103], a[52:55], v[224:227]
 buffer_load_dwordx4 v2, s[16:19], 0 offen lds
 v_mfma_f32_16x16x32_bf16 v[228:231], a[108:111], a[52:55], v[228:231]
 v_mfma_f32_16x16x32_bf16 v[228:231], a[104:107], a[48:51], v[228:231]
 v_mfma_f32_16x16x32_bf16 v[232:235], a[112:115], a[48:51], v[232:235]
 v_mfma_f32_16x16x32_bf16 v[232:235], a[116:119], a[52:55], v[232:235]
 s_add_u32 m0, s29, 69632
 v_mfma_f32_16x16x32_bf16 v[236:239], a[124:127], a[52:55], v[236:239]
 buffer_load_dwordx4 v2, s[16:19], s48 offen lds
 v_mfma_f32_16x16x32_bf16 v[236:239], a[120:123], a[48:51], v[236:239]
 v_mfma_f32_16x16x32_bf16 v[244:247], a[120:123], a[56:59], v[244:247]
 v_mfma_f32_16x16x32_bf16 v[244:247], a[124:127], a[60:63], v[244:247]
 v_mfma_f32_16x16x32_bf16 v[240:243], a[116:119], a[60:63], v[240:243]
 s_add_u32 m0, s29, 73728
 v_mfma_f32_16x16x32_bf16 v[240:243], a[112:115], a[56:59], v[240:243]
 buffer_load_dwordx4 v2, s[16:19], s49 offen lds
 v_mfma_f32_16x16x32_bf16 v[252:255], a[104:107], a[56:59], v[252:255]
 s_waitcnt vmcnt(11)
 v_mfma_f32_16x16x32_bf16 v[252:255], a[108:111], a[60:63], v[252:255]
 s_barrier
 ds_read_b64_tr_b16 a[0:1], v6 offset:32768
 v_mfma_f32_16x16x32_bf16 v[248:251], a[100:103], a[60:63], v[248:251]
 ds_read_b64_tr_b16 a[2:3], v6 offset:36864
 v_mfma_f32_16x16x32_bf16 v[248:251], a[96:99], a[56:59], v[248:251]
 s_add_u32 m0, s29, 77824
 ds_read_b128 a[96:99], v4 offset:40960
 v_mfma_f32_16x16x32_bf16 v[128:131], a[64:67], a[32:35], v[128:131]
 ds_read_b128 a[192:195], v14 offset:0
 buffer_load_dwordx4 v2, s[16:19], s50 offen lds
 v_mfma_f32_16x16x32_bf16 v[128:131], a[68:71], a[36:39], v[128:131]
 ds_read_b128 a[200:203], v3 offset:0
 v_mfma_f32_16x16x32_bf16 v[132:135], a[76:79], a[36:39], v[132:135]
 s_mov_b32 s56, s58
 ds_read_b64_tr_b16 a[4:5], v6 offset:49152
 v_mfma_f32_16x16x32_bf16 v[132:135], a[72:75], a[32:35], v[132:135]
 ds_read_b64_tr_b16 a[6:7], v6 offset:53248
 v_mfma_f32_16x16x32_bf16 v[136:139], a[80:83], a[32:35], v[136:139]
 s_add_u32 m0, s29, 81920
 ds_read_b128 a[100:103], v5 offset:40960
 v_mfma_f32_16x16x32_bf16 v[136:139], a[84:87], a[36:39], v[136:139]
 ds_read_b128 a[196:199], v14 offset:2048
 buffer_load_dwordx4 v2, s[16:19], s51 offen lds
 v_mfma_f32_16x16x32_bf16 v[140:143], a[92:95], a[36:39], v[140:143]
 ds_read_b128 a[204:207], v3 offset:2048
 v_mfma_f32_16x16x32_bf16 v[140:143], a[88:91], a[32:35], v[140:143]
 ds_read_b128 a[108:111], v5 offset:43008
 v_mfma_f32_16x16x32_bf16 v[148:151], a[88:91], a[40:43], v[148:151]
 ds_read_b128 a[208:211], v14 offset:4096
 v_mfma_f32_16x16x32_bf16 v[148:151], a[92:95], a[44:47], v[148:151]
 s_add_u32 m0, s29, 86016
 ds_read_b128 a[104:107], v4 offset:43008
 v_mfma_f32_16x16x32_bf16 v[144:147], a[84:87], a[44:47], v[144:147]
 ds_read_b128 a[216:219], v3 offset:4096
 buffer_load_dwordx4 v2, s[16:19], s52 offen lds
 v_mfma_f32_16x16x32_bf16 v[144:147], a[80:83], a[40:43], v[144:147]
 ds_read_b128 a[212:215], v14 offset:6144
 v_mfma_f32_16x16x32_bf16 v[156:159], a[72:75], a[40:43], v[156:159]
 s_cmp_lt_u32 s25, 4
 s_cselect_b32 s1, 2.0, s92
 ds_read_b128 a[112:115], v4 offset:45056
 v_mfma_f32_16x16x32_bf16 v[156:159], a[76:79], a[44:47], v[156:159]
 ds_read_b128 a[220:223], v3 offset:6144
 v_mfma_f32_16x16x32_bf16 v[152:155], a[68:71], a[44:47], v[152:155]
 s_add_u32 m0, s29, 90112
 ds_read_b128 a[116:119], v5 offset:45056
 v_mfma_f32_16x16x32_bf16 v[152:155], a[64:67], a[40:43], v[152:155]
 buffer_load_dwordx4 v2, s[16:19], s53 offen lds
 v_mfma_f32_16x16x32_bf16 v[160:163], a[64:67], a[48:51], v[160:163]
 v_mfma_f32_16x16x32_bf16 v[160:163], a[68:71], a[52:55], v[160:163]
 ds_read_b128 a[124:127], v5 offset:47104
 v_mfma_f32_16x16x32_bf16 v[164:167], a[76:79], a[52:55], v[164:167]
 v_mfma_f32_16x16x32_bf16 v[164:167], a[72:75], a[48:51], v[164:167]
 s_add_u32 m0, s29, 94208
 ds_read_b128 a[120:123], v4 offset:47104
 v_mfma_f32_16x16x32_bf16 v[168:171], a[80:83], a[48:51], v[168:171]
 buffer_load_dwordx4 v2, s[16:19], s54 offen lds
 v_mfma_f32_16x16x32_bf16 v[168:171], a[84:87], a[52:55], v[168:171]
 v_mfma_f32_16x16x32_bf16 v[172:175], a[92:95], a[52:55], v[172:175]
 v_mfma_f32_16x16x32_bf16 v[172:175], a[88:91], a[48:51], v[172:175]
 ds_read_b64_tr_b16 a[8:9], v7 offset:32768
 v_mfma_f32_16x16x32_bf16 v[180:183], a[88:91], a[56:59], v[180:183]
 v_mfma_f32_16x16x32_bf16 v[180:183], a[92:95], a[60:63], v[180:183]
 ds_read_b64_tr_b16 a[10:11], v7 offset:36864
 v_mfma_f32_16x16x32_bf16 v[176:179], a[84:87], a[60:63], v[176:179]
 ds_read_b64_tr_b16 a[12:13], v7 offset:49152
 v_mfma_f32_16x16x32_bf16 v[176:179], a[80:83], a[56:59], v[176:179]
 ds_read_b64_tr_b16 a[14:15], v7 offset:53248
 v_mfma_f32_16x16x32_bf16 v[188:191], a[72:75], a[56:59], v[188:191]
 ds_read_b64_tr_b16 a[16:17], v8 offset:32768
 v_mfma_f32_16x16x32_bf16 v[188:191], a[76:79], a[60:63], v[188:191]
 ds_read_b64_tr_b16 a[18:19], v8 offset:36864
 v_mfma_f32_16x16x32_bf16 v[184:187], a[68:71], a[60:63], v[184:187]
 ds_read_b64_tr_b16 a[20:21], v8 offset:49152
 v_mfma_f32_16x16x32_bf16 v[184:187], a[64:67], a[56:59], v[184:187]
 s_waitcnt lgkmcnt(15)
 ds_read_b64_tr_b16 a[22:23], v8 offset:53248
 s_cmp_ge_u32 s25, 4
 s_cbranch_scc1 L_late1
 v_mfma_f32_16x16x32_bf16 v[16:19], a[96:99], a[0:3], v[16:19]
 ds_read_b64_tr_b16 a[24:25], v9 offset:32768
 v_mfma_f32_16x16x32_bf16 v[16:19], a[100:103], a[4:7], v[16:19]
 s_add_u32 m0, s33, 0xfffffd00
 ds_read_b64_tr_b16 a[26:27], v9 offset:36864
 v_mfma_f32_16x16x32_bf16 v[20:23], a[108:111], a[4:7], v[20:23]
 s_waitcnt lgkmcnt(13)
 ds_read_b64_tr_b16 a[28:29], v9 offset:49152
 v_mfma_f32_16x16x32_bf16 v[20:23], a[104:107], a[0:3], v[20:23]
 ds_read_b64_tr_b16 a[30:31], v9 offset:53248
 buffer_load_dwordx4 v15, s[20:23], 0 offen offset:768 lds
 v_mfma_f32_16x16x32_bf16 v[24:27], a[112:115], a[0:3], v[24:27]
 s_waitcnt lgkmcnt(12)
 ds_read_b128 a[64:67], v4 offset:32768
 v_mfma_f32_16x16x32_bf16 v[24:27], a[116:119], a[4:7], v[24:27]
 v_mfma_f32_16x16x32_bf16 v[28:31], a[124:127], a[4:7], v[28:31]
 s_add_u32 m0, s33, 0xfffffd80
 ds_read_b128 a[68:71], v5 offset:32768
 v_mfma_f32_16x16x32_bf16 v[28:31], a[120:123], a[0:3], v[28:31]
 s_waitcnt lgkmcnt(10)
 buffer_load_dwordx4 v15, s[20:23], 0 offen offset:1664 lds
 v_mfma_f32_16x16x32_bf16 a[228:231], a[120:123], a[8:11], a[228:231]
 ds_read_b128 a[76:79], v5 offset:34816
 v_mfma_f32_16x16x32_bf16 a[228:231], a[124:127], a[12:15], a[228:231]
 v_mfma_f32_16x16x32_bf16 a[224:227], a[116:119], a[12:15], a[224:227]
 s_add_u32 m0, s33, 0x500
 ds_read_b128 a[72:75], v4 offset:34816
 v_mfma_f32_16x16x32_bf16 a[224:227], a[112:115], a[8:11], a[224:227]
 buffer_load_dwordx4 v15, s[20:23], s57 offen offset:768 lds
 v_mfma_f32_16x16x32_bf16 a[236:239], a[104:107], a[8:11], a[236:239]
 ds_read_b128 a[80:83], v4 offset:36864
 v_cvt_pk_bf16_f32 v16, v16, v17
 v_mfma_f32_16x16x32_bf16 a[236:239], a[108:111], a[12:15], a[236:239]
 v_cvt_pk_bf16_f32 v17, v18, v19
 v_cvt_pk_bf16_f32 v18, v20, v21
 v_mfma_f32_16x16x32_bf16 a[232:235], a[100:103], a[12:15], a[232:235]
 s_add_u32 m0, s33, 0x580
 ds_read_b128 a[84:87], v5 offset:36864
 v_cvt_pk_bf16_f32 v19, v22, v23
 v_mfma_f32_16x16x32_bf16 a[232:235], a[96:99], a[8:11], a[232:235]
 s_waitcnt lgkmcnt(10)
 buffer_load_dwordx4 v15, s[20:23], s57 offen offset:1664 lds
 v_mfma_f32_16x16x32_bf16 v[32:35], a[96:99], a[16:19], v[32:35]
 ds_read_b128 a[92:95], v5 offset:38912
 v_cvt_pk_bf16_f32 v24, v24, v25
 v_mfma_f32_16x16x32_bf16 v[32:35], a[100:103], a[20:23], v[32:35]
 v_cvt_pk_bf16_f32 v25, v26, v27
 v_cvt_pk_bf16_f32 v26, v28, v29
 v_mfma_f32_16x16x32_bf16 v[36:39], a[108:111], a[20:23], v[36:39]
 ds_read_b128 a[88:91], v4 offset:38912
 v_cvt_pk_bf16_f32 v27, v30, v31
 v_mfma_f32_16x16x32_bf16 v[36:39], a[104:107], a[16:19], v[36:39]
 v_accvgpr_read_b32 v20, a224
 v_accvgpr_read_b32 v21, a225
 v_mfma_f32_16x16x32_bf16 v[40:43], a[112:115], a[16:19], v[40:43]
 ds_read_b64_tr_b16 a[32:33], v10 offset:32768
 v_accvgpr_read_b32 v22, a226
 v_mfma_f32_16x16x32_bf16 v[40:43], a[116:119], a[20:23], v[40:43]
 ds_read_b64_tr_b16 a[34:35], v10 offset:36864
 v_accvgpr_read_b32 v23, a227
 v_mfma_f32_16x16x32_bf16 v[44:47], a[124:127], a[20:23], v[44:47]
 s_add_u32 s59, s56, 32768
 ds_read_b64_tr_b16 a[36:37], v10 offset:49152
 v_accvgpr_read_b32 v28, a228
 v_mfma_f32_16x16x32_bf16 v[44:47], a[120:123], a[16:19], v[44:47]
 s_waitcnt lgkmcnt(11)
 ds_read_b64_tr_b16 a[38:39], v10 offset:53248
 v_accvgpr_read_b32 v29, a229
 v_mfma_f32_16x16x32_bf16 v[52:55], a[120:123], a[24:27], v[52:55]
 ds_read_b64_tr_b16 a[40:41], v11 offset:32768
 buffer_store_dwordx4 v[16:19], v1, s[12:15], s59 offen offset:0 sc1
 v_mfma_f32_16x16x32_bf16 v[52:55], a[124:127], a[28:31], v[52:55]
 ds_read_b64_tr_b16 a[42:43], v11 offset:36864
 v_accvgpr_read_b32 v30, a230
 v_mfma_f32_16x16x32_bf16 v[48:51], a[116:119], a[28:31], v[48:51]
 ds_read_b64_tr_b16 a[44:45], v11 offset:49152
 v_accvgpr_read_b32 v31, a231
 v_mfma_f32_16x16x32_bf16 v[48:51], a[112:115], a[24:27], v[48:51]
 ds_read_b64_tr_b16 a[46:47], v11 offset:53248
 v_cvt_pk_bf16_f32 v20, v20, v21
 v_mfma_f32_16x16x32_bf16 v[60:63], a[104:107], a[24:27], v[60:63]
 ds_read_b64_tr_b16 a[48:49], v12 offset:32768
 v_cvt_pk_bf16_f32 v21, v22, v23
 v_mfma_f32_16x16x32_bf16 v[60:63], a[108:111], a[28:31], v[60:63]
 ds_read_b64_tr_b16 a[50:51], v12 offset:36864
 v_cvt_pk_bf16_f32 v22, v28, v29
 v_mfma_f32_16x16x32_bf16 v[56:59], a[100:103], a[28:31], v[56:59]
 s_add_u32 s59, s56, 49152
 ds_read_b64_tr_b16 a[52:53], v12 offset:49152
 v_cvt_pk_bf16_f32 v23, v30, v31
 v_mfma_f32_16x16x32_bf16 v[56:59], a[96:99], a[24:27], v[56:59]
 s_waitcnt lgkmcnt(15)
 ds_read_b64_tr_b16 a[54:55], v12 offset:53248
 buffer_store_dwordx4 v[24:27], v1, s[12:15], s59 offen offset:0 sc1
 v_mfma_f32_16x16x32_bf16 v[64:67], a[64:67], a[0:3], v[64:67]
 ds_read_b64_tr_b16 a[56:57], v13 offset:32768
 v_cvt_pk_bf16_f32 v32, v32, v33
 v_mfma_f32_16x16x32_bf16 v[64:67], a[68:71], a[4:7], v[64:67]
 ds_read_b64_tr_b16 a[58:59], v13 offset:36864
 v_cvt_pk_bf16_f32 v33, v34, v35
 v_mfma_f32_16x16x32_bf16 v[68:71], a[76:79], a[4:7], v[68:71]
 ds_read_b64_tr_b16 a[60:61], v13 offset:49152
 v_cvt_pk_bf16_f32 v34, v36, v37
 v_mfma_f32_16x16x32_bf16 v[68:71], a[72:75], a[0:3], v[68:71]
 s_waitcnt lgkmcnt(15)
 ds_read_b64_tr_b16 a[62:63], v13 offset:53248
 v_cvt_pk_bf16_f32 v35, v38, v39
 v_mfma_f32_16x16x32_bf16 v[72:75], a[80:83], a[0:3], v[72:75]
 v_cvt_pk_bf16_f32 v40, v40, v41
 v_cvt_pk_bf16_f32 v41, v42, v43
 v_mfma_f32_16x16x32_bf16 v[72:75], a[84:87], a[4:7], v[72:75]
 s_add_u32 s59, s56, 49152
 v_cvt_pk_bf16_f32 v42, v44, v45
 v_cvt_pk_bf16_f32 v43, v46, v47
 v_mfma_f32_16x16x32_bf16 v[76:79], a[92:95], a[4:7], v[76:79]
 buffer_store_dwordx4 v[20:23], v1, s[12:15], s59 offen offset:1024 sc1
 v_mfma_f32_16x16x32_bf16 v[76:79], a[88:91], a[0:3], v[76:79]
 s_waitcnt lgkmcnt(0)
 v_accvgpr_read_b32 v36, a232
 v_accvgpr_read_b32 v37, a233
 v_mfma_f32_16x16x32_bf16 v[84:87], a[88:91], a[8:11], v[84:87]
 s_barrier
 v_xor_b32 v6, s60, v6
 v_accvgpr_read_b32 v38, a234
 v_mfma_f32_16x16x32_bf16 v[84:87], a[92:95], a[12:15], v[84:87]
 s_add_u32 m0, s29, 32768
 v_add_u32 v2, 0x80000, v2
 v_accvgpr_read_b32 v39, a235
 v_mfma_f32_16x16x32_bf16 v[80:83], a[84:87], a[12:15], v[80:83]
 buffer_load_dwordx4 v2, s[16:19], 0 offen lds
 v_mfma_f32_16x16x32_bf16 v[80:83], a[80:83], a[8:11], v[80:83]
 v_accvgpr_read_b32 v44, a236
 v_accvgpr_read_b32 v45, a237
 v_mfma_f32_16x16x32_bf16 v[92:95], a[72:75], a[8:11], v[92:95]
 s_add_u32 s59, s56, 32768
 v_accvgpr_read_b32 v46, a238
 v_accvgpr_read_b32 v47, a239
 v_mfma_f32_16x16x32_bf16 v[92:95], a[76:79], a[12:15], v[92:95]
 buffer_store_dwordx4 v[32:35], v1, s[12:15], s59 offen offset:2048 sc1
 v_mfma_f32_16x16x32_bf16 v[88:91], a[68:71], a[12:15], v[88:91]
 s_add_u32 m0, s29, 36864
 v_cvt_pk_bf16_f32 v36, v36, v37
 v_cvt_pk_bf16_f32 v37, v38, v39
 v_mfma_f32_16x16x32_bf16 v[88:91], a[64:67], a[8:11], v[88:91]
 buffer_load_dwordx4 v2, s[16:19], s48 offen lds
 v_mfma_f32_16x16x32_bf16 v[96:99], a[64:67], a[16:19], v[96:99]
 v_cvt_pk_bf16_f32 v38, v44, v45
 v_cvt_pk_bf16_f32 v39, v46, v47
 v_mfma_f32_16x16x32_bf16 v[96:99], a[68:71], a[20:23], v[96:99]
 v_cvt_pk_bf16_f32 v48, v48, v49
 v_cvt_pk_bf16_f32 v49, v50, v51
 v_mfma_f32_16x16x32_bf16 v[100:103], a[76:79], a[20:23], v[100:103]
 v_cvt_pk_bf16_f32 v50, v52, v53
 v_cvt_pk_bf16_f32 v51, v54, v55
 v_mfma_f32_16x16x32_bf16 v[100:103], a[72:75], a[16:19], v[100:103]
 s_add_u32 m0, s29, 40960
 v_cvt_pk_bf16_f32 v56, v56, v57
 v_cvt_pk_bf16_f32 v57, v58, v59
 v_mfma_f32_16x16x32_bf16 v[104:107], a[80:83], a[16:19], v[104:107]
 buffer_load_dwordx4 v2, s[16:19], s49 offen lds
 v_mfma_f32_16x16x32_bf16 v[104:107], a[84:87], a[20:23], v[104:107]
 s_add_u32 s59, s56, 49152
 v_cvt_pk_bf16_f32 v58, v60, v61
 v_cvt_pk_bf16_f32 v59, v62, v63
 v_mfma_f32_16x16x32_bf16 v[108:111], a[92:95], a[20:23], v[108:111]
 buffer_store_dwordx4 v[40:43], v1, s[12:15], s59 offen offset:2048 sc1
 v_mfma_f32_16x16x32_bf16 v[108:111], a[88:91], a[16:19], v[108:111]
 v_cvt_pk_bf16_f32 v64, v64, v65
 v_cvt_pk_bf16_f32 v65, v66, v67
 v_mfma_f32_16x16x32_bf16 v[116:119], a[88:91], a[24:27], v[116:119]
 s_add_u32 m0, s29, 45056
 v_cvt_pk_bf16_f32 v66, v68, v69
 v_cvt_pk_bf16_f32 v67, v70, v71
 v_mfma_f32_16x16x32_bf16 v[116:119], a[92:95], a[28:31], v[116:119]
 buffer_load_dwordx4 v2, s[16:19], s50 offen lds
 v_mfma_f32_16x16x32_bf16 v[112:115], a[84:87], a[28:31], v[112:115]
 v_cvt_pk_bf16_f32 v72, v72, v73
 v_cvt_pk_bf16_f32 v73, v74, v75
 v_mfma_f32_16x16x32_bf16 v[112:115], a[80:83], a[24:27], v[112:115]
 v_cvt_pk_bf16_f32 v74, v76, v77
 v_cvt_pk_bf16_f32 v75, v78, v79
 v_mfma_f32_16x16x32_bf16 v[124:127], a[72:75], a[24:27], v[124:127]
 v_cvt_pk_bf16_f32 v80, v80, v81
 v_cvt_pk_bf16_f32 v81, v82, v83
 v_mfma_f32_16x16x32_bf16 v[124:127], a[76:79], a[28:31], v[124:127]
 s_add_u32 m0, s29, 49152
 v_cvt_pk_bf16_f32 v82, v84, v85
 v_cvt_pk_bf16_f32 v83, v86, v87
 v_mfma_f32_16x16x32_bf16 v[120:123], a[68:71], a[28:31], v[120:123]
 buffer_load_dwordx4 v2, s[16:19], s51 offen lds
 v_mfma_f32_16x16x32_bf16 v[120:123], a[64:67], a[24:27], v[120:123]
 s_add_u32 s59, s56, 32768
 v_cvt_pk_bf16_f32 v88, v88, v89
 v_cvt_pk_bf16_f32 v89, v90, v91
 v_mfma_f32_16x16x32_bf16 v[128:131], a[64:67], a[32:35], v[128:131]
 buffer_store_dwordx4 v[36:39], v1, s[12:15], s59 offen offset:1024 sc1
 v_mfma_f32_16x16x32_bf16 v[128:131], a[68:71], a[36:39], v[128:131]
 v_cvt_pk_bf16_f32 v90, v92, v93
 v_cvt_pk_bf16_f32 v91, v94, v95
 v_mfma_f32_16x16x32_bf16 v[132:135], a[76:79], a[36:39], v[132:135]
 s_add_u32 m0, s29, 53248
 v_cvt_pk_bf16_f32 v96, v96, v97
 v_cvt_pk_bf16_f32 v97, v98, v99
 v_mfma_f32_16x16x32_bf16 v[132:135], a[72:75], a[32:35], v[132:135]
 buffer_load_dwordx4 v2, s[16:19], s52 offen lds
 v_mfma_f32_16x16x32_bf16 v[136:139], a[80:83], a[32:35], v[136:139]
 v_cvt_pk_bf16_f32 v98, v100, v101
 v_cvt_pk_bf16_f32 v99, v102, v103
 v_mfma_f32_16x16x32_bf16 v[136:139], a[84:87], a[36:39], v[136:139]
 v_cvt_pk_bf16_f32 v104, v104, v105
 v_cvt_pk_bf16_f32 v105, v106, v107
 v_mfma_f32_16x16x32_bf16 v[140:143], a[92:95], a[36:39], v[140:143]
 v_cvt_pk_bf16_f32 v106, v108, v109
 v_cvt_pk_bf16_f32 v107, v110, v111
 v_mfma_f32_16x16x32_bf16 v[140:143], a[88:91], a[32:35], v[140:143]
 s_add_u32 m0, s29, 57344
 v_cvt_pk_bf16_f32 v112, v112, v113
 v_cvt_pk_bf16_f32 v113, v114, v115
 v_mfma_f32_16x16x32_bf16 v[148:151], a[88:91], a[40:43], v[148:151]
 buffer_load_dwordx4 v2, s[16:19], s53 offen lds
 v_mfma_f32_16x16x32_bf16 v[148:151], a[92:95], a[44:47], v[148:151]
 s_add_u32 s59, s56, 49152
 v_cvt_pk_bf16_f32 v114, v116, v117
 v_cvt_pk_bf16_f32 v115, v118, v119
 v_mfma_f32_16x16x32_bf16 v[144:147], a[84:87], a[44:47], v[144:147]
 buffer_store_dwordx4 v[48:51], v1, s[12:15], s59 offen offset:3072 sc1
 v_mfma_f32_16x16x32_bf16 v[144:147], a[80:83], a[40:43], v[144:147]
 v_cvt_pk_bf16_f32 v120, v120, v121
 v_cvt_pk_bf16_f32 v121, v122, v123
 v_mfma_f32_16x16x32_bf16 v[156:159], a[72:75], a[40:43], v[156:159]
 s_add_u32 m0, s29, 61440
 v_cvt_pk_bf16_f32 v122, v124, v125
 v_cvt_pk_bf16_f32 v123, v126, v127
 v_mfma_f32_16x16x32_bf16 v[156:159], a[76:79], a[44:47], v[156:159]
 buffer_load_dwordx4 v2, s[16:19], s54 offen lds
 v_mfma_f32_16x16x32_bf16 v[152:155], a[68:71], a[44:47], v[152:155]
 v_cvt_pk_bf16_f32 v128, v128, v129
 v_cvt_pk_bf16_f32 v129, v130, v131
 v_mfma_f32_16x16x32_bf16 v[152:155], a[64:67], a[40:43], v[152:155]
 v_cvt_pk_bf16_f32 v130, v132, v133
 v_cvt_pk_bf16_f32 v131, v134, v135
 v_mfma_f32_16x16x32_bf16 v[160:163], a[64:67], a[48:51], v[160:163]
 s_add_u32 m0, s29, 98304
 v_add_u32 v2, 0x80000, v2
 v_cvt_pk_bf16_f32 v136, v136, v137
 v_mfma_f32_16x16x32_bf16 v[160:163], a[68:71], a[52:55], v[160:163]
 buffer_load_dwordx4 v2, s[16:19], 0 offen lds
 v_mfma_f32_16x16x32_bf16 v[164:167], a[76:79], a[52:55], v[164:167]
 s_add_u32 s59, s56, 32768
 v_cvt_pk_bf16_f32 v137, v138, v139
 v_cvt_pk_bf16_f32 v138, v140, v141
 v_mfma_f32_16x16x32_bf16 v[164:167], a[72:75], a[48:51], v[164:167]
 buffer_store_dwordx4 v[56:59], v1, s[12:15], s59 offen offset:3072 sc1
 v_mfma_f32_16x16x32_bf16 v[168:171], a[80:83], a[48:51], v[168:171]
 v_cvt_pk_bf16_f32 v139, v142, v143
 v_cvt_pk_bf16_f32 v144, v144, v145
 v_mfma_f32_16x16x32_bf16 v[168:171], a[84:87], a[52:55], v[168:171]
 s_add_u32 m0, s29, 102400
 v_cvt_pk_bf16_f32 v145, v146, v147
 v_cvt_pk_bf16_f32 v146, v148, v149
 v_mfma_f32_16x16x32_bf16 v[172:175], a[92:95], a[52:55], v[172:175]
 buffer_load_dwordx4 v2, s[16:19], s48 offen lds
 v_mfma_f32_16x16x32_bf16 v[172:175], a[88:91], a[48:51], v[172:175]
 v_cvt_pk_bf16_f32 v147, v150, v151
 v_cvt_pk_bf16_f32 v152, v152, v153
 v_mfma_f32_16x16x32_bf16 v[180:183], a[88:91], a[56:59], v[180:183]
 v_cvt_pk_bf16_f32 v153, v154, v155
 v_cvt_pk_bf16_f32 v154, v156, v157
 v_mfma_f32_16x16x32_bf16 v[180:183], a[92:95], a[60:63], v[180:183]
 v_cvt_pk_bf16_f32 v155, v158, v159
 v_mfma_f32_16x16x32_bf16 v[176:179], a[84:87], a[60:63], v[176:179]
 s_add_u32 m0, s29, 106496
 v_mfma_f32_16x16x32_bf16 v[176:179], a[80:83], a[56:59], v[176:179]
 buffer_load_dwordx4 v2, s[16:19], s49 offen lds
 v_mfma_f32_16x16x32_bf16 v[188:191], a[72:75], a[56:59], v[188:191]
 s_add_u32 s59, s56, 0
 v_cvt_pk_bf16_f32 v160, v160, v161
 v_cvt_pk_bf16_f32 v161, v162, v163
 v_mfma_f32_16x16x32_bf16 v[188:191], a[76:79], a[60:63], v[188:191]
 buffer_store_dwordx4 v[64:67], v1, s[12:15], s59 offen offset:0 sc1
 v_mfma_f32_16x16x32_bf16 v[184:187], a[68:71], a[60:63], v[184:187]
 v_cvt_pk_bf16_f32 v162, v164, v165
 v_cvt_pk_bf16_f32 v163, v166, v167
 v_mfma_f32_16x16x32_bf16 v[184:187], a[64:67], a[56:59], v[184:187]
 s_add_u32 m0, s29, 110592
 v_cvt_pk_bf16_f32 v168, v168, v169
 v_cvt_pk_bf16_f32 v169, v170, v171
 v_mfma_f32_16x16x32_bf16 v[192:195], a[96:99], a[32:35], v[192:195]
 buffer_load_dwordx4 v2, s[16:19], s50 offen lds
 v_mfma_f32_16x16x32_bf16 v[192:195], a[100:103], a[36:39], v[192:195]
 v_cvt_pk_bf16_f32 v170, v172, v173
 v_cvt_pk_bf16_f32 v171, v174, v175
 v_mfma_f32_16x16x32_bf16 v[196:199], a[108:111], a[36:39], v[196:199]
 v_mfma_f32_16x16x32_bf16 v[196:199], a[104:107], a[32:35], v[196:199]
 v_cvt_pk_bf16_f32 v176, v176, v177
 v_cvt_pk_bf16_f32 v177, v178, v179
 v_mfma_f32_16x16x32_bf16 v[200:203], a[112:115], a[32:35], v[200:203]
 s_add_u32 m0, s29, 114688
 v_cvt_pk_bf16_f32 v178, v180, v181
 v_cvt_pk_bf16_f32 v179, v182, v183
 v_mfma_f32_16x16x32_bf16 v[200:203], a[116:119], a[36:39], v[200:203]
 buffer_load_dwordx4 v2, s[16:19], s51 offen lds
 v_mfma_f32_16x16x32_bf16 v[204:207], a[124:127], a[36:39], v[204:207]
 s_add_u32 s59, s56, 16384
 v_mfma_f32_16x16x32_bf16 v[204:207], a[120:123], a[32:35], v[204:207]
 buffer_store_dwordx4 v[72:75], v1, s[12:15], s59 offen offset:0 sc1
 v_mfma_f32_16x16x32_bf16 v[212:215], a[120:123], a[40:43], v[212:215]
 v_cvt_pk_bf16_f32 v184, v184, v185
 v_cvt_pk_bf16_f32 v185, v186, v187
 v_mfma_f32_16x16x32_bf16 v[212:215], a[124:127], a[44:47], v[212:215]
 s_add_u32 m0, s29, 118784
 v_cvt_pk_bf16_f32 v186, v188, v189
 v_cvt_pk_bf16_f32 v187, v190, v191
 v_mfma_f32_16x16x32_bf16 v[208:211], a[116:119], a[44:47], v[208:211]
 buffer_load_dwordx4 v2, s[16:19], s52 offen lds
 v_mfma_f32_16x16x32_bf16 v[208:211], a[112:115], a[40:43], v[208:211]
 v_cvt_pk_bf16_f32 v192, v192, v193
 v_cvt_pk_bf16_f32 v193, v194, v195
 v_mfma_f32_16x16x32_bf16 v[220:223], a[104:107], a[40:43], v[220:223]
 v_cvt_pk_bf16_f32 v194, v196, v197
 v_cvt_pk_bf16_f32 v195, v198, v199
 v_mfma_f32_16x16x32_bf16 v[220:223], a[108:111], a[44:47], v[220:223]
 v_mfma_f32_16x16x32_bf16 v[216:219], a[100:103], a[44:47], v[216:219]
 s_add_u32 m0, s29, 122880
 v_mfma_f32_16x16x32_bf16 v[216:219], a[96:99], a[40:43], v[216:219]
 buffer_load_dwordx4 v2, s[16:19], s53 offen lds
 v_mfma_f32_16x16x32_bf16 v[224:227], a[96:99], a[48:51], v[224:227]
 s_add_u32 s59, s56, 16384
 v_cvt_pk_bf16_f32 v200, v200, v201
 v_cvt_pk_bf16_f32 v201, v202, v203
 v_mfma_f32_16x16x32_bf16 v[224:227], a[100:103], a[52:55], v[224:227]
 s_waitcnt vmcnt(25)
 buffer_store_dwordx4 v[80:83], v1, s[12:15], s59 offen offset:1024 sc1
 v_mfma_f32_16x16x32_bf16 v[228:231], a[108:111], a[52:55], v[228:231]
 s_barrier
 v_xor_b32 v7, 0, v6
 v_cvt_pk_bf16_f32 v202, v204, v205
 v_mfma_f32_16x16x32_bf16 v[228:231], a[104:107], a[48:51], v[228:231]
 s_add_u32 m0, s29, 126976
 ds_read_b64_tr_b16 a[64:65], v7 offset:0
 v_cvt_pk_bf16_f32 v203, v206, v207
 v_mfma_f32_16x16x32_bf16 v[232:235], a[112:115], a[48:51], v[232:235]
 ds_read_b64_tr_b16 a[66:67], v7 offset:4096
 buffer_load_dwordx4 v2, s[16:19], s54 offen lds
 v_mfma_f32_16x16x32_bf16 v[232:235], a[116:119], a[52:55], v[232:235]
 ds_read_b64_tr_b16 a[68:69], v7 offset:16384
 v_cvt_pk_bf16_f32 v208, v208, v209
 v_mfma_f32_16x16x32_bf16 v[236:239], a[124:127], a[52:55], v[236:239]
 ds_read_b64_tr_b16 a[70:71], v7 offset:20480
 v_xor_b32 v8, 65536, v6
 v_mfma_f32_16x16x32_bf16 v[236:239], a[120:123], a[48:51], v[236:239]
 s_add_u32 s59, s56, 0
 ds_read_b64_tr_b16 a[72:73], v8 offset:0
 v_cvt_pk_bf16_f32 v209, v210, v211
 v_mfma_f32_16x16x32_bf16 v[244:247], a[120:123], a[56:59], v[244:247]
 ds_read_b64_tr_b16 a[74:75], v8 offset:4096
 buffer_store_dwordx4 v[88:91], v1, s[12:15], s59 offen offset:1024 sc1
 v_mfma_f32_16x16x32_bf16 v[244:247], a[124:127], a[60:63], v[244:247]
 ds_read_b64_tr_b16 a[76:77], v8 offset:16384
 v_cvt_pk_bf16_f32 v210, v212, v213
 v_mfma_f32_16x16x32_bf16 v[240:243], a[116:119], a[60:63], v[240:243]
 ds_read_b64_tr_b16 a[78:79], v8 offset:20480
 v_xor_b32 v9, 32, v6
 v_mfma_f32_16x16x32_bf16 v[240:243], a[112:115], a[56:59], v[240:243]
 ds_read_b64_tr_b16 a[80:81], v9 offset:0
 v_cvt_pk_bf16_f32 v211, v214, v215
 v_mfma_f32_16x16x32_bf16 v[252:255], a[104:107], a[56:59], v[252:255]
 ds_read_b64_tr_b16 a[82:83], v9 offset:4096
 v_cvt_pk_bf16_f32 v216, v216, v217
 v_mfma_f32_16x16x32_bf16 v[252:255], a[108:111], a[60:63], v[252:255]
 ds_read_b64_tr_b16 a[84:85], v9 offset:16384
 v_cvt_pk_bf16_f32 v217, v218, v219
 v_mfma_f32_16x16x32_bf16 v[248:251], a[100:103], a[60:63], v[248:251]
 s_add_u32 s59, s56, 0
 ds_read_b64_tr_b16 a[86:87], v9 offset:20480
 v_xor_b32 v10, 65568, v6
 v_mfma_f32_16x16x32_bf16 v[248:251], a[96:99], a[56:59], v[248:251]
 s_waitcnt lgkmcnt(6)
 ds_read_b64_tr_b16 a[88:89], v10 offset:0
 buffer_store_dwordx4 v[96:99], v1, s[12:15], s59 offen offset:2048 sc1
 v_mfma_f32_16x16x32_bf16 v[28:31], a[64:67], a[128:131], 0
 ds_read_b64_tr_b16 a[90:91], v10 offset:4096
 v_cvt_pk_bf16_f32 v218, v220, v221
 v_mfma_f32_16x16x32_bf16 v[28:31], a[68:71], a[136:139], v[28:31]
 ds_read_b64_tr_b16 a[92:93], v10 offset:16384
 v_xor_b32 v7, 64, v6
 v_mfma_f32_16x16x32_bf16 v[28:31], a[72:75], a[144:147], v[28:31]
 s_waitcnt lgkmcnt(7)
 ds_read_b128 a[112:115], v14 offset:0
 ds_read_b64_tr_b16 a[94:95], v10 offset:20480
 v_mfma_f32_16x16x32_bf16 v[28:31], a[76:79], a[152:155], v[28:31]
 ds_read_b64_tr_b16 a[96:97], v7 offset:0
 v_cvt_pk_bf16_f32 v219, v222, v223
 v_mfma_f32_16x16x32_bf16 v[44:47], a[64:67], a[132:135], 0
 ds_read_b128 a[120:123], v3 offset:0
 ds_read_b64_tr_b16 a[98:99], v7 offset:4096
 v_mfma_f32_16x16x32_bf16 v[44:47], a[68:71], a[140:143], v[44:47]
 s_add_u32 s59, s56, 16384
 ds_read_b64_tr_b16 a[100:101], v7 offset:16384
 v_xor_b32 v8, 65600, v6
 v_mfma_f32_16x16x32_bf16 v[44:47], a[72:75], a[148:151], v[44:47]
 ds_read_b128 a[116:119], v14 offset:2048
 ds_read_b64_tr_b16 a[102:103], v7 offset:20480
 buffer_store_dwordx4 v[104:107], v1, s[12:15], s59 offen offset:2048 sc1
 v_mfma_f32_16x16x32_bf16 v[44:47], a[76:79], a[156:159], v[44:47]
 s_waitcnt lgkmcnt(9)
 ds_read_b64_tr_b16 a[104:105], v8 offset:0
 v_cvt_pk_bf16_f32 v224, v224, v225
 v_mfma_f32_16x16x32_bf16 v[52:55], a[80:83], a[128:131], 0
 ds_read_b128 a[124:127], v3 offset:2048
 ds_read_b64_tr_b16 a[106:107], v8 offset:4096
 v_mfma_f32_16x16x32_bf16 v[52:55], a[84:87], a[136:139], v[52:55]
 ds_read_b64_tr_b16 a[108:109], v8 offset:16384
 v_cvt_pk_bf16_f32 v225, v226, v227
 v_mfma_f32_16x16x32_bf16 v[52:55], a[88:91], a[144:147], v[52:55]
 s_waitcnt lgkmcnt(10)
 ds_read_b64_tr_b16 a[110:111], v8 offset:20480
 v_xor_b32 v9, 96, v6
 v_mfma_f32_16x16x32_bf16 v[52:55], a[92:95], a[152:155], v[52:55]
 ds_read_b64_tr_b16 a[64:65], v9 offset:0
 v_cvt_pk_bf16_f32 v226, v228, v229
 v_mfma_f32_16x16x32_bf16 v[60:63], a[80:83], a[132:135], 0
 s_add_u32 s59, s56, 16384
 ds_read_b64_tr_b16 a[66:67], v9 offset:4096
 v_cvt_pk_bf16_f32 v227, v230, v231
 v_mfma_f32_16x16x32_bf16 v[60:63], a[84:87], a[140:143], v[60:63]
 ds_read_b64_tr_b16 a[68:69], v9 offset:16384
 buffer_store_dwordx4 v[112:115], v1, s[12:15], s59 offen offset:3072 sc1
 v_mfma_f32_16x16x32_bf16 v[60:63], a[88:91], a[148:151], v[60:63]
 ds_read_b64_tr_b16 a[70:71], v9 offset:20480
 v_xor_b32 v10, 65632, v6
 v_mfma_f32_16x16x32_bf16 v[60:63], a[92:95], a[156:159], v[60:63]
 s_waitcnt lgkmcnt(6)
 ds_read_b64_tr_b16 a[72:73], v10 offset:0
 v_cvt_pk_bf16_f32 v232, v232, v233
 v_mfma_f32_16x16x32_bf16 v[20:23], a[96:99], a[128:131], 0
 ds_read_b64_tr_b16 a[74:75], v10 offset:4096
 v_cvt_pk_bf16_f32 v233, v234, v235
 v_mfma_f32_16x16x32_bf16 v[20:23], a[100:103], a[136:139], v[20:23]
 s_waitcnt lgkmcnt(8)
 ds_read_b64_tr_b16 a[76:77], v10 offset:16384
 v_xor_b32 v7, 128, v6
 v_mfma_f32_16x16x32_bf16 v[20:23], a[104:107], a[144:147], v[20:23]
 s_waitcnt lgkmcnt(7)
 s_barrier
 ds_read_b64_tr_b16 a[78:79], v10 offset:20480
 v_mfma_f32_16x16x32_bf16 v[20:23], a[108:111], a[152:155], v[20:23]
 s_add_u32 m0, s29, 131072
 ds_read_b64_tr_b16 a[80:81], v7 offset:0
 v_add_u32 v2, 0x80000, v2
 v_mfma_f32_16x16x32_bf16 v[36:39], a[96:99], a[132:135], 0
 ds_read_b64_tr_b16 a[82:83], v7 offset:4096
 buffer_load_dwordx4 v2, s[16:19], 0 offen lds
 v_mfma_f32_16x16x32_bf16 v[36:39], a[100:103], a[140:143], v[36:39]
 ds_read_b64_tr_b16 a[84:85], v7 offset:16384
 v_cvt_pk_bf16_f32 v234, v236, v237
 v_mfma_f32_16x16x32_bf16 v[36:39], a[104:107], a[148:151], v[36:39]
 s_add_u32 s59, s56, 0
 ds_read_b64_tr_b16 a[86:87], v7 offset:20480
 v_xor_b32 v8, 65664, v6
 v_mfma_f32_16x16x32_bf16 v[36:39], a[108:111], a[156:159], v[36:39]
 s_waitcnt lgkmcnt(6)
 ds_read_b64_tr_b16 a[88:89], v8 offset:0
 buffer_store_dwordx4 v[120:123], v1, s[12:15], s59 offen offset:3072 sc1
 v_mfma_f32_16x16x32_bf16 v[68:71], a[64:67], a[128:131], 0
 ds_read_b64_tr_b16 a[90:91], v8 offset:4096
 v_cvt_pk_bf16_f32 v235, v238, v239
 v_mfma_f32_16x16x32_bf16 v[68:71], a[68:71], a[136:139], v[68:71]
 s_add_u32 m0, s29, 135168
 ds_read_b64_tr_b16 a[92:93], v8 offset:16384
 v_cvt_pk_bf16_f32 v240, v240, v241
 v_mfma_f32_16x16x32_bf16 v[68:71], a[72:75], a[144:147], v[68:71]
 s_waitcnt lgkmcnt(7)
 ds_read_b64_tr_b16 a[94:95], v8 offset:20480
 v_xor_b32 v9, 160, v6
 v_mfma_f32_16x16x32_bf16 v[68:71], a[76:79], a[152:155], v[68:71]
 ds_read_b64_tr_b16 a[96:97], v9 offset:0
 buffer_load_dwordx4 v2, s[16:19], s48 offen lds
 v_mfma_f32_16x16x32_bf16 v[76:79], a[64:67], a[132:135], 0
 ds_read_b64_tr_b16 a[98:99], v9 offset:4096
 v_cvt_pk_bf16_f32 v241, v242, v243
 v_mfma_f32_16x16x32_bf16 v[76:79], a[68:71], a[140:143], v[76:79]
 ds_read_b64_tr_b16 a[100:101], v9 offset:16384
 v_cvt_pk_bf16_f32 v242, v244, v245
 v_mfma_f32_16x16x32_bf16 v[76:79], a[72:75], a[148:151], v[76:79]
 s_add_u32 s59, s56, 4096
 ds_read_b64_tr_b16 a[102:103], v9 offset:20480
 v_xor_b32 v10, 65696, v6
 v_mfma_f32_16x16x32_bf16 v[76:79], a[76:79], a[156:159], v[76:79]
 s_waitcnt lgkmcnt(6)
 ds_read_b64_tr_b16 a[104:105], v10 offset:0
 buffer_store_dwordx4 v[128:131], v1, s[12:15], s59 offen offset:0 sc1
 v_mfma_f32_16x16x32_bf16 v[84:87], a[80:83], a[128:131], 0
 s_add_u32 m0, s29, 139264
 ds_read_b64_tr_b16 a[106:107], v10 offset:4096
 v_cvt_pk_bf16_f32 v243, v246, v247
 v_mfma_f32_16x16x32_bf16 v[84:87], a[84:87], a[136:139], v[84:87]
 ds_read_b64_tr_b16 a[108:109], v10 offset:16384
 buffer_load_dwordx4 v2, s[16:19], s49 offen lds
 v_mfma_f32_16x16x32_bf16 v[84:87], a[88:91], a[144:147], v[84:87]
 s_waitcnt lgkmcnt(7)
 ds_read_b64_tr_b16 a[110:111], v10 offset:20480
 v_xor_b32 v7, 192, v6
 v_mfma_f32_16x16x32_bf16 v[84:87], a[92:95], a[152:155], v[84:87]
 ds_read_b64_tr_b16 a[64:65], v7 offset:0
 v_cvt_pk_bf16_f32 v248, v248, v249
 v_mfma_f32_16x16x32_bf16 v[92:95], a[80:83], a[132:135], 0
 ds_read_b64_tr_b16 a[66:67], v7 offset:4096
 v_cvt_pk_bf16_f32 v249, v250, v251
 v_mfma_f32_16x16x32_bf16 v[92:95], a[84:87], a[140:143], v[92:95]
 ds_read_b64_tr_b16 a[68:69], v7 offset:16384
 v_cvt_pk_bf16_f32 v250, v252, v253
 v_mfma_f32_16x16x32_bf16 v[92:95], a[88:91], a[148:151], v[92:95]
 s_add_u32 m0, s29, 143360
 ds_read_b64_tr_b16 a[70:71], v7 offset:20480
 v_xor_b32 v8, 65728, v6
 v_mfma_f32_16x16x32_bf16 v[92:95], a[92:95], a[156:159], v[92:95]
 s_waitcnt lgkmcnt(6)
 ds_read_b64_tr_b16 a[72:73], v8 offset:0
 buffer_load_dwordx4 v2, s[16:19], s50 offen lds
 v_mfma_f32_16x16x32_bf16 v[100:103], a[96:99], a[128:131], 0
 s_add_u32 s59, s56, 20480
 ds_read_b64_tr_b16 a[74:75], v8 offset:4096
 v_cvt_pk_bf16_f32 v251, v254, v255
 v_mfma_f32_16x16x32_bf16 v[100:103], a[100:103], a[136:139], v[100:103]
 ds_read_b64_tr_b16 a[76:77], v8 offset:16384
 buffer_store_dwordx4 v[136:139], v1, s[12:15], s59 offen offset:0 sc1
 v_mfma_f32_16x16x32_bf16 v[100:103], a[104:107], a[144:147], v[100:103]
 s_waitcnt lgkmcnt(7)
 ds_read_b64_tr_b16 a[78:79], v8 offset:20480
 v_xor_b32 v9, 224, v6
 v_mfma_f32_16x16x32_bf16 v[100:103], a[108:111], a[152:155], v[100:103]
 s_and_b32 s36, s95, 31
 ds_read_b64_tr_b16 a[80:81], v9 offset:0
 v_accvgpr_read_b32 v11, a245
 v_mfma_f32_16x16x32_bf16 v[108:111], a[96:99], a[132:135], 0
 s_add_u32 m0, s29, 147456
 ds_read_b64_tr_b16 a[82:83], v9 offset:4096
 v_mov_b32 v12, 0
 v_mfma_f32_16x16x32_bf16 v[108:111], a[100:103], a[140:143], v[108:111]
 ds_read_b64_tr_b16 a[84:85], v9 offset:16384
 buffer_load_dwordx4 v2, s[16:19], s51 offen lds
 v_mfma_f32_16x16x32_bf16 v[108:111], a[104:107], a[148:151], v[108:111]
 s_add_u32 s59, s56, 20480
 ds_read_b64_tr_b16 a[86:87], v9 offset:20480
 v_xor_b32 v10, 65760, v6
 v_mfma_f32_16x16x32_bf16 v[108:111], a[108:111], a[156:159], v[108:111]
 s_waitcnt lgkmcnt(6)
 ds_read_b64_tr_b16 a[88:89], v10 offset:0
 v_and_b32 v14, 15, v0
 v_mfma_f32_16x16x32_bf16 v[116:119], a[64:67], a[128:131], 0
 ds_read_b64_tr_b16 a[90:91], v10 offset:4096
 buffer_store_dwordx4 v[144:147], v1, s[12:15], s59 offen offset:1024 sc1
 v_mfma_f32_16x16x32_bf16 v[116:119], a[68:71], a[136:139], v[116:119]
 s_add_u32 m0, s29, 151552
 ds_read_b64_tr_b16 a[92:93], v10 offset:16384
 v_lshrrev_b32 v3, 4, v0
 v_mfma_f32_16x16x32_bf16 v[116:119], a[72:75], a[144:147], v[116:119]
 s_waitcnt lgkmcnt(7)
 ds_read_b64_tr_b16 a[94:95], v10 offset:20480
 v_xor_b32 v7, 256, v6
 v_mfma_f32_16x16x32_bf16 v[116:119], a[76:79], a[152:155], v[116:119]
 ds_read_b64_tr_b16 a[96:97], v7 offset:0
 buffer_load_dwordx4 v2, s[16:19], s52 offen lds
 v_mfma_f32_16x16x32_bf16 v[124:127], a[64:67], a[132:135], 0
 s_lshr_b32 s37, s95, 5
 ds_read_b64_tr_b16 a[98:99], v7 offset:4096
 v_lshlrev_b32 v3, 2, v3
 v_mfma_f32_16x16x32_bf16 v[124:127], a[68:71], a[140:143], v[124:127]
 ds_read_b64_tr_b16 a[100:101], v7 offset:16384
 global_load_dword v5, v12, s[90:91] offset:128 sc1
 v_mfma_f32_16x16x32_bf16 v[124:127], a[72:75], a[148:151], v[124:127]
 s_add_u32 s59, s56, 4096
 ds_read_b64_tr_b16 a[102:103], v7 offset:20480
 v_xor_b32 v8, 65792, v6
 v_mfma_f32_16x16x32_bf16 v[124:127], a[76:79], a[156:159], v[124:127]
 s_waitcnt lgkmcnt(6)
 ds_read_b64_tr_b16 a[104:105], v8 offset:0
 buffer_store_dwordx4 v[152:155], v1, s[12:15], s59 offen offset:1024 sc1
 v_mfma_f32_16x16x32_bf16 v[132:135], a[80:83], a[128:131], 0
 s_add_u32 m0, s29, 155648
 ds_read_b64_tr_b16 a[106:107], v8 offset:4096
 v_and_b32 v12, 11, v0
 v_mfma_f32_16x16x32_bf16 v[132:135], a[84:87], a[136:139], v[132:135]
 ds_read_b64_tr_b16 a[108:109], v8 offset:16384
 buffer_load_dwordx4 v2, s[16:19], s53 offen lds
 v_mfma_f32_16x16x32_bf16 v[132:135], a[88:91], a[144:147], v[132:135]
 s_waitcnt lgkmcnt(7)
 ds_read_b64_tr_b16 a[110:111], v8 offset:20480
 v_xor_b32 v9, 288, v6
 v_mfma_f32_16x16x32_bf16 v[132:135], a[92:95], a[152:155], v[132:135]
 s_lshl_b32 s38, s3, 4
 ds_read_b64_tr_b16 a[64:65], v9 offset:0
 v_lshlrev_b32 v12, 2, v12
 v_mfma_f32_16x16x32_bf16 v[140:143], a[80:83], a[132:135], 0
 s_lshl_b32 s39, s36, 6
 ds_read_b64_tr_b16 a[66:67], v9 offset:4096
 v_sub_u32 v14, v14, v3
 v_mfma_f32_16x16x32_bf16 v[140:143], a[84:87], a[140:143], v[140:143]
 s_add_u32 s38, s38, s39
 ds_read_b64_tr_b16 a[68:69], v9 offset:16384
 v_lshrrev_b32_e64 v3, 6, s29
 v_mfma_f32_16x16x32_bf16 v[140:143], a[88:91], a[148:151], v[140:143]
 s_add_u32 m0, s29, 159744
 ds_read_b64_tr_b16 a[70:71], v9 offset:20480
 v_xor_b32 v10, 65824, v6
 v_mfma_f32_16x16x32_bf16 v[140:143], a[92:95], a[156:159], v[140:143]
 s_waitcnt lgkmcnt(6)
 ds_read_b64_tr_b16 a[72:73], v10 offset:0
 buffer_load_dwordx4 v2, s[16:19], s54 offen lds
 v_mfma_f32_16x16x32_bf16 v[148:151], a[96:99], a[128:131], 0
 s_add_u32 s59, s56, 4096
 ds_read_b64_tr_b16 a[74:75], v10 offset:4096
 v_add_u32 v14, v3, v14
 v_mfma_f32_16x16x32_bf16 v[148:151], a[100:103], a[136:139], v[148:151]
 ds_read_b64_tr_b16 a[76:77], v10 offset:16384
 buffer_store_dwordx4 v[160:163], v1, s[12:15], s59 offen offset:2048 sc1
 v_mfma_f32_16x16x32_bf16 v[148:151], a[104:107], a[144:147], v[148:151]
 s_waitcnt lgkmcnt(7)
 ds_read_b64_tr_b16 a[78:79], v10 offset:20480
 v_xor_b32 v7, 320, v6
 v_mfma_f32_16x16x32_bf16 v[148:151], a[108:111], a[152:155], v[148:151]
 s_mul_i32 s38, s38, 896
 ds_read_b64_tr_b16 a[80:81], v7 offset:0
 v_mov_b32 v15, 0xf149f2ca
 v_mfma_f32_16x16x32_bf16 v[156:159], a[96:99], a[132:135], 0
 s_lshl_b32 s39, s37, 7
 ds_read_b64_tr_b16 a[82:83], v7 offset:4096
 v_cmp_gt_i32 vcc, 0, v14
 v_mfma_f32_16x16x32_bf16 v[156:159], a[100:103], a[140:143], v[156:159]
 s_add_u32 s38, s38, s39
 ds_read_b64_tr_b16 a[84:85], v7 offset:16384
 v_cndmask_b32 v3, 0, v15, vcc
 v_mfma_f32_16x16x32_bf16 v[156:159], a[104:107], a[148:151], v[156:159]
 s_add_u32 s59, s56, 20480
 ds_read_b64_tr_b16 a[86:87], v7 offset:20480
 v_xor_b32 v8, 65856, v6
 v_mfma_f32_16x16x32_bf16 v[156:159], a[108:111], a[156:159], v[156:159]
 s_waitcnt lgkmcnt(6)
 ds_read_b64_tr_b16 a[88:89], v8 offset:0
 v_accvgpr_write_b32 a224, v3
 v_mfma_f32_16x16x32_bf16 v[164:167], a[64:67], a[128:131], 0
 ds_read_b64_tr_b16 a[90:91], v8 offset:4096
 buffer_store_dwordx4 v[168:171], v1, s[12:15], s59 offen offset:2048 sc1
 v_mfma_f32_16x16x32_bf16 v[164:167], a[68:71], a[136:139], v[164:167]
 s_lshl_b32 s39, s37, 9
 ds_read_b64_tr_b16 a[92:93], v8 offset:16384
 v_cmp_gt_i32 vcc, 1, v14
 v_mfma_f32_16x16x32_bf16 v[164:167], a[72:75], a[144:147], v[164:167]
 s_waitcnt lgkmcnt(7)
 ds_read_b64_tr_b16 a[94:95], v8 offset:20480
 v_xor_b32 v9, 352, v6
 v_mfma_f32_16x16x32_bf16 v[164:167], a[76:79], a[152:155], v[164:167]
 s_mov_b32 s4, s66
 ds_read_b64_tr_b16 a[96:97], v9 offset:0
 v_cndmask_b32 v3, 0, v15, vcc
 v_mfma_f32_16x16x32_bf16 v[172:175], a[64:67], a[132:135], 0
 s_mov_b32 s5, s67
 ds_read_b64_tr_b16 a[98:99], v9 offset:4096
 v_accvgpr_write_b32 a225, v3
 v_mfma_f32_16x16x32_bf16 v[172:175], a[68:71], a[140:143], v[172:175]
 s_mov_b32 s6, 1835008
 ds_read_b64_tr_b16 a[100:101], v9 offset:16384
 v_cmp_gt_i32 vcc, 2, v14
 v_mfma_f32_16x16x32_bf16 v[172:175], a[72:75], a[148:151], v[172:175]
 s_add_u32 s59, s56, 20480
 ds_read_b64_tr_b16 a[102:103], v9 offset:20480
 v_xor_b32 v10, 65888, v6
 v_mfma_f32_16x16x32_bf16 v[172:175], a[76:79], a[156:159], v[172:175]
 s_waitcnt lgkmcnt(6)
 ds_read_b64_tr_b16 a[104:105], v10 offset:0
 buffer_store_dwordx4 v[176:179], v1, s[12:15], s59 offen offset:3072 sc1
 v_mfma_f32_16x16x32_bf16 v[180:183], a[80:83], a[128:131], 0
 s_mov_b32 s7, 0x20000
 ds_read_b64_tr_b16 a[106:107], v10 offset:4096
 v_cndmask_b32 v3, 0, v15, vcc
 v_mfma_f32_16x16x32_bf16 v[180:183], a[84:87], a[136:139], v[180:183]
 s_mov_b32 s8, s68
 ds_read_b64_tr_b16 a[108:109], v10 offset:16384
 v_accvgpr_write_b32 a226, v3
 v_mfma_f32_16x16x32_bf16 v[180:183], a[88:91], a[144:147], v[180:183]
 s_waitcnt lgkmcnt(7)
 ds_read_b64_tr_b16 a[110:111], v10 offset:20480
 v_xor_b32 v7, 384, v6
 v_mfma_f32_16x16x32_bf16 v[180:183], a[92:95], a[152:155], v[180:183]
 s_mov_b32 s9, s69
 ds_read_b64_tr_b16 a[64:65], v7 offset:0
 v_cmp_gt_i32 vcc, 3, v14
 v_mfma_f32_16x16x32_bf16 v[188:191], a[80:83], a[132:135], 0
 s_mov_b32 s10, 1835008
 ds_read_b64_tr_b16 a[66:67], v7 offset:4096
 v_cndmask_b32 v3, 0, v15, vcc
 v_mfma_f32_16x16x32_bf16 v[188:191], a[84:87], a[140:143], v[188:191]
 s_mov_b32 s11, 0x20000
 ds_read_b64_tr_b16 a[68:69], v7 offset:16384
 v_accvgpr_write_b32 a227, v3
 v_mfma_f32_16x16x32_bf16 v[188:191], a[88:91], a[148:151], v[188:191]
 s_add_u32 s59, s56, 4096
 ds_read_b64_tr_b16 a[70:71], v7 offset:20480
 v_xor_b32 v8, 65920, v6
 v_mfma_f32_16x16x32_bf16 v[188:191], a[92:95], a[156:159], v[188:191]
 s_waitcnt lgkmcnt(6)
 ds_read_b64_tr_b16 a[72:73], v8 offset:0
 buffer_store_dwordx4 v[184:187], v1, s[12:15], s59 offen offset:3072 sc1
 v_mfma_f32_16x16x32_bf16 v[196:199], a[96:99], a[128:131], 0
 s_mov_b32 s20, s70
 ds_read_b64_tr_b16 a[74:75], v8 offset:4096
 v_cmp_gt_i32 vcc, 16, v14
 v_mfma_f32_16x16x32_bf16 v[196:199], a[100:103], a[136:139], v[196:199]
 s_mov_b32 s21, s71
 ds_read_b64_tr_b16 a[76:77], v8 offset:16384
 v_cndmask_b32 v3, 0, v15, vcc
 v_mfma_f32_16x16x32_bf16 v[196:199], a[104:107], a[144:147], v[196:199]
 s_waitcnt lgkmcnt(7)
 ds_read_b64_tr_b16 a[78:79], v8 offset:20480
 v_xor_b32 v9, 416, v6
 v_mfma_f32_16x16x32_bf16 v[196:199], a[108:111], a[152:155], v[196:199]
 s_mov_b32 s22, 3584
 ds_read_b64_tr_b16 a[80:81], v9 offset:0
 v_accvgpr_write_b32 a228, v3
 v_mfma_f32_16x16x32_bf16 v[204:207], a[96:99], a[132:135], 0
 s_mov_b32 s23, 0x20000
 ds_read_b64_tr_b16 a[82:83], v9 offset:4096
 v_cmp_gt_i32 vcc, 17, v14
 v_mfma_f32_16x16x32_bf16 v[204:207], a[100:103], a[140:143], v[204:207]
 ds_read_b64_tr_b16 a[84:85], v9 offset:16384
 v_lshrrev_b32 v120, 3, v0
 v_mfma_f32_16x16x32_bf16 v[204:207], a[104:107], a[148:151], v[204:207]
 s_add_u32 s59, s56, 36864
 ds_read_b64_tr_b16 a[86:87], v9 offset:20480
 v_xor_b32 v10, 65952, v6
 v_mfma_f32_16x16x32_bf16 v[204:207], a[108:111], a[156:159], v[204:207]
 s_waitcnt lgkmcnt(6)
 ds_read_b64_tr_b16 a[88:89], v10 offset:0
 buffer_store_dwordx4 v[192:195], v1, s[12:15], s59 offen offset:0 sc1
 v_mfma_f32_16x16x32_bf16 v[212:215], a[64:67], a[128:131], 0
 ds_read_b64_tr_b16 a[90:91], v10 offset:4096
 v_mul_u32_u24 v120, 1792, v120
 v_mfma_f32_16x16x32_bf16 v[212:215], a[68:71], a[136:139], v[212:215]
 ds_read_b64_tr_b16 a[92:93], v10 offset:16384
 v_and_b32 v121, 7, v0
 v_mfma_f32_16x16x32_bf16 v[212:215], a[72:75], a[144:147], v[212:215]
 s_waitcnt lgkmcnt(7)
 ds_read_b64_tr_b16 a[94:95], v10 offset:20480
 v_xor_b32 v7, 448, v6
 v_mfma_f32_16x16x32_bf16 v[212:215], a[76:79], a[152:155], v[212:215]
 ds_read_b64_tr_b16 a[96:97], v7 offset:0
 v_lshl_add_u32 v120, v121, 4, v120
 v_mfma_f32_16x16x32_bf16 v[220:223], a[64:67], a[132:135], 0
 ds_read_b64_tr_b16 a[98:99], v7 offset:4096
 v_add_u32 v120, s38, v120
 v_mfma_f32_16x16x32_bf16 v[220:223], a[68:71], a[140:143], v[220:223]
 ds_read_b64_tr_b16 a[100:101], v7 offset:16384
 v_lshlrev_b32 v121, 6, v121
 v_mfma_f32_16x16x32_bf16 v[220:223], a[72:75], a[148:151], v[220:223]
 s_add_u32 s59, s56, 53248
 ds_read_b64_tr_b16 a[102:103], v7 offset:20480
 v_xor_b32 v8, 65984, v6
 v_mfma_f32_16x16x32_bf16 v[220:223], a[76:79], a[156:159], v[220:223]
 s_waitcnt lgkmcnt(6)
 ds_read_b64_tr_b16 a[104:105], v8 offset:0
 buffer_store_dwordx4 v[200:203], v1, s[12:15], s59 offen offset:0 sc1
 v_mfma_f32_16x16x32_bf16 v[228:231], a[80:83], a[128:131], 0
 ds_read_b64_tr_b16 a[106:107], v8 offset:4096
 v_subrev_u32 v122, 2688, v120
 v_mfma_f32_16x16x32_bf16 v[228:231], a[84:87], a[136:139], v[228:231]
 ds_read_b64_tr_b16 a[108:109], v8 offset:16384
 v_subrev_u32 v123, 1792, v120
 v_mfma_f32_16x16x32_bf16 v[228:231], a[88:91], a[144:147], v[228:231]
 s_waitcnt lgkmcnt(7)
 ds_read_b64_tr_b16 a[110:111], v8 offset:20480
 v_xor_b32 v9, 480, v6
 v_mfma_f32_16x16x32_bf16 v[228:231], a[92:95], a[152:155], v[228:231]
 ds_read_b64_tr_b16 a[64:65], v9 offset:0
 v_subrev_u32 v128, 896, v120
 v_mfma_f32_16x16x32_bf16 v[236:239], a[80:83], a[132:135], 0
 ds_read_b64_tr_b16 a[66:67], v9 offset:4096
 v_cndmask_b32 v3, 0, v15, vcc
 v_mfma_f32_16x16x32_bf16 v[236:239], a[84:87], a[140:143], v[236:239]
 ds_read_b64_tr_b16 a[68:69], v9 offset:16384
 v_accvgpr_write_b32 a229, v3
 v_mfma_f32_16x16x32_bf16 v[236:239], a[88:91], a[148:151], v[236:239]
 s_add_u32 s59, s56, 53248
 ds_read_b64_tr_b16 a[70:71], v9 offset:20480
 v_xor_b32 v10, 66016, v6
 v_mfma_f32_16x16x32_bf16 v[236:239], a[92:95], a[156:159], v[236:239]
 s_waitcnt lgkmcnt(6)
 ds_read_b64_tr_b16 a[72:73], v10 offset:0
 buffer_store_dwordx4 v[208:211], v1, s[12:15], s59 offen offset:1024 sc1
 v_mfma_f32_16x16x32_bf16 v[244:247], a[96:99], a[128:131], 0
 ds_read_b64_tr_b16 a[74:75], v10 offset:4096
 v_cmp_gt_i32 vcc, 18, v14
 v_mfma_f32_16x16x32_bf16 v[244:247], a[100:103], a[136:139], v[244:247]
 s_waitcnt vmcnt(25)
 ds_read_b64_tr_b16 a[76:77], v10 offset:16384
 v_xor_b32 v7, 32768, v6
 v_mfma_f32_16x16x32_bf16 v[244:247], a[104:107], a[144:147], v[244:247]
 s_waitcnt lgkmcnt(7)
 s_barrier
 ds_read_b64_tr_b16 a[78:79], v10 offset:20480
 v_mfma_f32_16x16x32_bf16 v[244:247], a[108:111], a[152:155], v[244:247]
 ds_read_b64_tr_b16 a[80:81], v7 offset:0
 v_cndmask_b32 v3, 0, v15, vcc
 v_mfma_f32_16x16x32_bf16 v[252:255], a[96:99], a[132:135], 0
 ds_read_b64_tr_b16 a[82:83], v7 offset:4096
 v_accvgpr_write_b32 a230, v3
 v_mfma_f32_16x16x32_bf16 v[252:255], a[100:103], a[140:143], v[252:255]
 ds_read_b64_tr_b16 a[84:85], v7 offset:16384
 v_cmp_gt_i32 vcc, 19, v14
 v_mfma_f32_16x16x32_bf16 v[252:255], a[104:107], a[148:151], v[252:255]
 s_add_u32 s59, s56, 36864
 ds_read_b64_tr_b16 a[86:87], v7 offset:20480
 v_xor_b32 v8, 98304, v6
 v_mfma_f32_16x16x32_bf16 v[252:255], a[108:111], a[156:159], v[252:255]
 s_waitcnt lgkmcnt(6)
 ds_read_b64_tr_b16 a[88:89], v8 offset:0
 buffer_store_dwordx4 v[216:219], v1, s[12:15], s59 offen offset:1024 sc1
 v_mfma_f32_16x16x32_bf16 v[16:19], a[64:67], a[128:131], 0
 ds_read_b64_tr_b16 a[90:91], v8 offset:4096
 v_cndmask_b32 v3, 0, v15, vcc
 v_mfma_f32_16x16x32_bf16 v[16:19], a[68:71], a[136:139], v[16:19]
 ds_read_b64_tr_b16 a[92:93], v8 offset:16384
 v_accvgpr_write_b32 a231, v3
 v_mfma_f32_16x16x32_bf16 v[16:19], a[72:75], a[144:147], v[16:19]
 s_waitcnt lgkmcnt(7)
 ds_read_b64_tr_b16 a[94:95], v8 offset:20480
 v_xor_b32 v9, 32800, v6
 v_mfma_f32_16x16x32_bf16 v[16:19], a[76:79], a[152:155], v[16:19]
 ds_read_b64_tr_b16 a[96:97], v9 offset:0
 v_cmp_gt_i32 vcc, 32, v14
 v_mfma_f32_16x16x32_bf16 v[24:27], a[64:67], a[132:135], 0
 s_waitcnt lgkmcnt(9)
 ds_read_b64_tr_b16 a[98:99], v9 offset:4096
 v_cndmask_b32 v3, 0, v15, vcc
 v_mfma_f32_16x16x32_bf16 v[24:27], a[68:71], a[140:143], v[24:27]
 s_barrier
 ds_read_b64_tr_b16 a[100:101], v9 offset:16384
 v_accvgpr_write_b32 a232, v3
 v_mfma_f32_16x16x32_bf16 v[24:27], a[72:75], a[148:151], v[24:27]
 s_add_u32 m0, s29, 0
 ds_read_b64_tr_b16 a[102:103], v9 offset:20480
 v_xor_b32 v10, 98336, v6
 v_mfma_f32_16x16x32_bf16 v[24:27], a[76:79], a[156:159], v[24:27]
 s_waitcnt lgkmcnt(6)
 ds_read_b64_tr_b16 a[104:105], v10 offset:0
 v_add_u32 v2, 0x80000, v2
 v_mfma_f32_16x16x32_bf16 v[28:31], a[80:83], a[160:163], v[28:31]
 ds_read_b64_tr_b16 a[106:107], v10 offset:4096
 buffer_load_dwordx4 v2, s[16:19], 0 offen lds
 v_mfma_f32_16x16x32_bf16 v[28:31], a[84:87], a[168:171], v[28:31]
 s_add_u32 s59, s56, 36864
 ds_read_b64_tr_b16 a[108:109], v10 offset:16384
 v_cmp_gt_i32 vcc, 33, v14
 v_mfma_f32_16x16x32_bf16 v[28:31], a[88:91], a[176:179], v[28:31]
 s_waitcnt lgkmcnt(7)
 ds_read_b64_tr_b16 a[110:111], v10 offset:20480
 v_xor_b32 v7, 32832, v6
 v_mfma_f32_16x16x32_bf16 v[28:31], a[92:95], a[184:187], v[28:31]
 ds_read_b64_tr_b16 a[64:65], v7 offset:0
 buffer_store_dwordx4 v[224:227], v1, s[12:15], s59 offen offset:2048 sc1
 v_mfma_f32_16x16x32_bf16 v[44:47], a[80:83], a[164:167], v[44:47]
 s_add_u32 m0, s29, 4096
 ds_read_b64_tr_b16 a[66:67], v7 offset:4096
 v_add_u32 v4, 4096, v1
 v_mfma_f32_16x16x32_bf16 v[44:47], a[84:87], a[172:175], v[44:47]
 ds_read_b64_tr_b16 a[68:69], v7 offset:16384
 buffer_load_dwordx4 v2, s[16:19], s48 offen lds
 v_mfma_f32_16x16x32_bf16 v[44:47], a[88:91], a[180:183], v[44:47]
 ds_read_b64_tr_b16 a[70:71], v7 offset:20480
 v_xor_b32 v8, 98368, v6
 v_mfma_f32_16x16x32_bf16 v[44:47], a[92:95], a[188:191], v[44:47]
 s_waitcnt lgkmcnt(6)
 ds_read_b64_tr_b16 a[72:73], v8 offset:0
 v_cndmask_b32 v3, 0, v15, vcc
 v_mfma_f32_16x16x32_bf16 v[52:55], a[96:99], a[160:163], v[52:55]
 ds_read_b64_tr_b16 a[74:75], v8 offset:4096
 v_accvgpr_write_b32 a233, v3
 v_mfma_f32_16x16x32_bf16 v[52:55], a[100:103], a[168:171], v[52:55]
 s_add_u32 m0, s29, 8192
 ds_read_b64_tr_b16 a[76:77], v8 offset:16384
 v_cmp_gt_i32 vcc, 34, v14
 v_mfma_f32_16x16x32_bf16 v[52:55], a[104:107], a[176:179], v[52:55]
 s_waitcnt lgkmcnt(7)
 ds_read_b64_tr_b16 a[78:79], v8 offset:20480
 v_xor_b32 v9, 32864, v6
 v_mfma_f32_16x16x32_bf16 v[52:55], a[108:111], a[184:187], v[52:55]
 ds_read_b64_tr_b16 a[80:81], v9 offset:0
 buffer_load_dwordx4 v2, s[16:19], s49 offen lds
 v_mfma_f32_16x16x32_bf16 v[60:63], a[96:99], a[164:167], v[60:63]
 s_add_u32 s59, s56, 53248
 ds_read_b64_tr_b16 a[82:83], v9 offset:4096
 v_cndmask_b32 v3, 0, v15, vcc
 v_mfma_f32_16x16x32_bf16 v[60:63], a[100:103], a[172:175], v[60:63]
 ds_read_b64_tr_b16 a[84:85], v9 offset:16384
 buffer_store_dwordx4 v[232:235], v1, s[12:15], s59 offen offset:2048 sc1
 v_mfma_f32_16x16x32_bf16 v[60:63], a[104:107], a[180:183], v[60:63]
 s_add_u32 m0, s29, 12288
 ds_read_b64_tr_b16 a[86:87], v9 offset:20480
 v_xor_b32 v10, 98400, v6
 v_mfma_f32_16x16x32_bf16 v[60:63], a[108:111], a[188:191], v[60:63]
 s_waitcnt lgkmcnt(6)
 ds_read_b64_tr_b16 a[88:89], v10 offset:0
 v_accvgpr_write_b32 a234, v3
 v_mfma_f32_16x16x32_bf16 v[20:23], a[64:67], a[160:163], v[20:23]
 ds_read_b64_tr_b16 a[90:91], v10 offset:4096
 buffer_load_dwordx4 v2, s[16:19], s50 offen lds
 v_mfma_f32_16x16x32_bf16 v[20:23], a[68:71], a[168:171], v[20:23]
 ds_read_b64_tr_b16 a[92:93], v10 offset:16384
 v_cmp_gt_i32 vcc, 35, v14
 v_mfma_f32_16x16x32_bf16 v[20:23], a[72:75], a[176:179], v[20:23]
 s_waitcnt lgkmcnt(7)
 ds_read_b64_tr_b16 a[94:95], v10 offset:20480
 v_xor_b32 v7, 32896, v6
 v_mfma_f32_16x16x32_bf16 v[20:23], a[76:79], a[184:187], v[20:23]
 ds_read_b64_tr_b16 a[96:97], v7 offset:0
 v_cndmask_b32 v3, 0, v15, vcc
 v_mfma_f32_16x16x32_bf16 v[36:39], a[64:67], a[164:167], v[36:39]
 s_add_u32 m0, s29, 16384
 ds_read_b64_tr_b16 a[98:99], v7 offset:4096
 v_accvgpr_write_b32 a235, v3
 v_mfma_f32_16x16x32_bf16 v[36:39], a[68:71], a[172:175], v[36:39]
 ds_read_b64_tr_b16 a[100:101], v7 offset:16384
 buffer_load_dwordx4 v2, s[16:19], s51 offen lds
 v_mfma_f32_16x16x32_bf16 v[36:39], a[72:75], a[180:183], v[36:39]
 s_add_u32 s59, s56, 53248
 ds_read_b64_tr_b16 a[102:103], v7 offset:20480
 v_xor_b32 v8, 98432, v6
 v_mfma_f32_16x16x32_bf16 v[36:39], a[76:79], a[188:191], v[36:39]
 s_waitcnt lgkmcnt(6)
 ds_read_b64_tr_b16 a[104:105], v8 offset:0
 buffer_store_dwordx4 v[240:243], v1, s[12:15], s59 offen offset:3072 sc1
 v_mfma_f32_16x16x32_bf16 v[68:71], a[80:83], a[160:163], v[68:71]
 ds_read_b64_tr_b16 a[106:107], v8 offset:4096
 v_cmp_gt_i32 vcc, 48, v14
 v_mfma_f32_16x16x32_bf16 v[68:71], a[84:87], a[168:171], v[68:71]
 s_add_u32 m0, s29, 20480
 ds_read_b64_tr_b16 a[108:109], v8 offset:16384
 v_cndmask_b32 v3, 0, v15, vcc
 v_mfma_f32_16x16x32_bf16 v[68:71], a[88:91], a[176:179], v[68:71]
 s_waitcnt lgkmcnt(7)
 ds_read_b64_tr_b16 a[110:111], v8 offset:20480
 v_xor_b32 v9, 32928, v6
 v_mfma_f32_16x16x32_bf16 v[68:71], a[92:95], a[184:187], v[68:71]
 ds_read_b64_tr_b16 a[64:65], v9 offset:0
 buffer_load_dwordx4 v2, s[16:19], s52 offen lds
 v_mfma_f32_16x16x32_bf16 v[76:79], a[80:83], a[164:167], v[76:79]
 ds_read_b64_tr_b16 a[66:67], v9 offset:4096
 v_accvgpr_write_b32 a236, v3
 v_mfma_f32_16x16x32_bf16 v[76:79], a[84:87], a[172:175], v[76:79]
 ds_read_b64_tr_b16 a[68:69], v9 offset:16384
 v_cmp_gt_i32 vcc, 49, v14
 v_mfma_f32_16x16x32_bf16 v[76:79], a[88:91], a[180:183], v[76:79]
 s_add_u32 m0, s29, 24576
 ds_read_b64_tr_b16 a[70:71], v9 offset:20480
 v_xor_b32 v10, 98464, v6
 v_mfma_f32_16x16x32_bf16 v[76:79], a[92:95], a[188:191], v[76:79]
 s_waitcnt lgkmcnt(6)
 ds_read_b64_tr_b16 a[72:73], v10 offset:0
 v_cndmask_b32 v3, 0, v15, vcc
 v_mfma_f32_16x16x32_bf16 v[84:87], a[96:99], a[160:163], v[84:87]
 ds_read_b64_tr_b16 a[74:75], v10 offset:4096
 buffer_load_dwordx4 v2, s[16:19], s53 offen lds
 v_mfma_f32_16x16x32_bf16 v[84:87], a[100:103], a[168:171], v[84:87]
 s_add_u32 s59, s56, 36864
 ds_read_b64_tr_b16 a[76:77], v10 offset:16384
 v_accvgpr_write_b32 a237, v3
 v_mfma_f32_16x16x32_bf16 v[84:87], a[104:107], a[176:179], v[84:87]
 s_waitcnt lgkmcnt(7)
 ds_read_b64_tr_b16 a[78:79], v10 offset:20480
 v_xor_b32 v7, 32960, v6
 v_mfma_f32_16x16x32_bf16 v[84:87], a[108:111], a[184:187], v[84:87]
 ds_read_b64_tr_b16 a[80:81], v7 offset:0
 buffer_store_dwordx4 v[248:251], v1, s[12:15], s59 offen offset:3072 sc1
 v_mfma_f32_16x16x32_bf16 v[92:95], a[96:99], a[164:167], v[92:95]
 s_add_u32 m0, s29, 28672
 ds_read_b64_tr_b16 a[82:83], v7 offset:4096
 v_cmp_gt_i32 vcc, 50, v14
 v_mfma_f32_16x16x32_bf16 v[92:95], a[100:103], a[172:175], v[92:95]
 ds_read_b64_tr_b16 a[84:85], v7 offset:16384
 buffer_load_dwordx4 v2, s[16:19], s54 offen lds
 v_mfma_f32_16x16x32_bf16 v[92:95], a[104:107], a[180:183], v[92:95]
 ds_read_b64_tr_b16 a[86:87], v7 offset:20480
 v_xor_b32 v8, 98496, v6
 v_mfma_f32_16x16x32_bf16 v[92:95], a[108:111], a[188:191], v[92:95]
 s_waitcnt lgkmcnt(6)
 ds_read_b64_tr_b16 a[88:89], v8 offset:0
 v_cndmask_b32 v3, 0, v15, vcc
 v_mfma_f32_16x16x32_bf16 v[100:103], a[64:67], a[160:163], v[100:103]
 s_add_u32 m0, s29, 65536
 ds_read_b64_tr_b16 a[90:91], v8 offset:4096
 v_add_u32 v2, 0x80000, v2
 v_mfma_f32_16x16x32_bf16 v[100:103], a[68:71], a[168:171], v[100:103]
 ds_read_b64_tr_b16 a[92:93], v8 offset:16384
 buffer_load_dwordx4 v2, s[16:19], 0 offen lds
 v_mfma_f32_16x16x32_bf16 v[100:103], a[72:75], a[176:179], v[100:103]
 s_waitcnt lgkmcnt(7)
 ds_read_b64_tr_b16 a[94:95], v8 offset:20480
 v_xor_b32 v9, 32992, v6
 v_mfma_f32_16x16x32_bf16 v[100:103], a[76:79], a[184:187], v[100:103]
 ds_read_b64_tr_b16 a[96:97], v9 offset:0
 v_accvgpr_write_b32 a238, v3
 v_mfma_f32_16x16x32_bf16 v[108:111], a[64:67], a[164:167], v[108:111]
 ds_read_b64_tr_b16 a[98:99], v9 offset:4096
 v_cmp_gt_i32 vcc, 51, v14
 v_mfma_f32_16x16x32_bf16 v[108:111], a[68:71], a[172:175], v[108:111]
 ds_read_b64_tr_b16 a[100:101], v9 offset:16384
 v_cndmask_b32 v3, 0, v15, vcc
 v_mfma_f32_16x16x32_bf16 v[108:111], a[72:75], a[180:183], v[108:111]
 s_add_u32 m0, s29, 69632
 ds_read_b64_tr_b16 a[102:103], v9 offset:20480
 v_xor_b32 v10, 98528, v6
 v_mfma_f32_16x16x32_bf16 v[108:111], a[76:79], a[188:191], v[108:111]
 s_waitcnt lgkmcnt(6)
 ds_read_b64_tr_b16 a[104:105], v10 offset:0
 buffer_load_dwordx4 v2, s[16:19], s48 offen lds
 v_mfma_f32_16x16x32_bf16 v[116:119], a[80:83], a[160:163], v[116:119]
 ds_read_b64_tr_b16 a[106:107], v10 offset:4096
 v_accvgpr_write_b32 a239, v3
 v_mfma_f32_16x16x32_bf16 v[116:119], a[84:87], a[168:171], v[116:119]
 ds_read_b64_tr_b16 a[108:109], v10 offset:16384
 v_mfma_f32_16x16x32_bf16 v[116:119], a[88:91], a[176:179], v[116:119]
 s_waitcnt lgkmcnt(7)
 ds_read_b64_tr_b16 a[110:111], v10 offset:20480
 v_xor_b32 v7, 33024, v6
 v_mfma_f32_16x16x32_bf16 v[116:119], a[92:95], a[184:187], v[116:119]
 s_add_u32 m0, s29, 73728
 ds_read_b64_tr_b16 a[64:65], v7 offset:0
 v_mfma_f32_16x16x32_bf16 v[124:127], a[80:83], a[164:167], v[124:127]
 ds_read_b64_tr_b16 a[66:67], v7 offset:4096
 buffer_load_dwordx4 v2, s[16:19], s49 offen lds
 v_mfma_f32_16x16x32_bf16 v[124:127], a[84:87], a[172:175], v[124:127]
 ds_read_b64_tr_b16 a[68:69], v7 offset:16384
 v_mfma_f32_16x16x32_bf16 v[124:127], a[88:91], a[180:183], v[124:127]
 ds_read_b64_tr_b16 a[70:71], v7 offset:20480
 v_xor_b32 v8, 98560, v6
 v_mfma_f32_16x16x32_bf16 v[124:127], a[92:95], a[188:191], v[124:127]
 s_waitcnt lgkmcnt(6)
 ds_read_b64_tr_b16 a[72:73], v8 offset:0
 v_mfma_f32_16x16x32_bf16 v[132:135], a[96:99], a[160:163], v[132:135]
 s_add_u32 m0, s29, 77824
 ds_read_b64_tr_b16 a[74:75], v8 offset:4096
 v_mfma_f32_16x16x32_bf16 v[132:135], a[100:103], a[168:171], v[132:135]
 ds_read_b64_tr_b16 a[76:77], v8 offset:16384
 buffer_load_dwordx4 v2, s[16:19], s50 offen lds
 v_mfma_f32_16x16x32_bf16 v[132:135], a[104:107], a[176:179], v[132:135]
 s_waitcnt lgkmcnt(7)
 ds_read_b64_tr_b16 a[78:79], v8 offset:20480
 v_xor_b32 v9, 33056, v6
 v_mfma_f32_16x16x32_bf16 v[132:135], a[108:111], a[184:187], v[132:135]
 ds_read_b64_tr_b16 a[80:81], v9 offset:0
 v_mfma_f32_16x16x32_bf16 v[140:143], a[96:99], a[164:167], v[140:143]
 ds_read_b64_tr_b16 a[82:83], v9 offset:4096
 v_mfma_f32_16x16x32_bf16 v[140:143], a[100:103], a[172:175], v[140:143]
 ds_read_b64_tr_b16 a[84:85], v9 offset:16384
 v_mfma_f32_16x16x32_bf16 v[140:143], a[104:107], a[180:183], v[140:143]
 s_add_u32 m0, s29, 81920
 ds_read_b64_tr_b16 a[86:87], v9 offset:20480
 v_xor_b32 v10, 98592, v6
 v_mfma_f32_16x16x32_bf16 v[140:143], a[108:111], a[188:191], v[140:143]
 s_waitcnt lgkmcnt(6)
 ds_read_b64_tr_b16 a[88:89], v10 offset:0
 buffer_load_dwordx4 v2, s[16:19], s51 offen lds
 v_mfma_f32_16x16x32_bf16 v[148:151], a[64:67], a[160:163], v[148:151]
 ds_read_b64_tr_b16 a[90:91], v10 offset:4096
 v_mfma_f32_16x16x32_bf16 v[148:151], a[68:71], a[168:171], v[148:151]
 ds_read_b64_tr_b16 a[92:93], v10 offset:16384
 v_mfma_f32_16x16x32_bf16 v[148:151], a[72:75], a[176:179], v[148:151]
 s_waitcnt lgkmcnt(7)
 ds_read_b64_tr_b16 a[94:95], v10 offset:20480
 v_xor_b32 v7, 33088, v6
 v_mfma_f32_16x16x32_bf16 v[148:151], a[76:79], a[184:187], v[148:151]
 s_add_u32 m0, s29, 86016
 ds_read_b64_tr_b16 a[96:97], v7 offset:0
 v_mfma_f32_16x16x32_bf16 v[156:159], a[64:67], a[164:167], v[156:159]
 ds_read_b64_tr_b16 a[98:99], v7 offset:4096
 buffer_load_dwordx4 v2, s[16:19], s52 offen lds
 v_mfma_f32_16x16x32_bf16 v[156:159], a[68:71], a[172:175], v[156:159]
 ds_read_b64_tr_b16 a[100:101], v7 offset:16384
 v_mfma_f32_16x16x32_bf16 v[156:159], a[72:75], a[180:183], v[156:159]
 ds_read_b64_tr_b16 a[102:103], v7 offset:20480
 v_xor_b32 v8, 98624, v6
 v_mfma_f32_16x16x32_bf16 v[156:159], a[76:79], a[188:191], v[156:159]
 s_waitcnt lgkmcnt(6)
 ds_read_b64_tr_b16 a[104:105], v8 offset:0
 v_mfma_f32_16x16x32_bf16 v[164:167], a[80:83], a[160:163], v[164:167]
 s_add_u32 m0, s29, 90112
 ds_read_b64_tr_b16 a[106:107], v8 offset:4096
 v_mfma_f32_16x16x32_bf16 v[164:167], a[84:87], a[168:171], v[164:167]
 ds_read_b64_tr_b16 a[108:109], v8 offset:16384
 buffer_load_dwordx4 v2, s[16:19], s53 offen lds
 v_mfma_f32_16x16x32_bf16 v[164:167], a[88:91], a[176:179], v[164:167]
 s_waitcnt lgkmcnt(7)
 ds_read_b64_tr_b16 a[110:111], v8 offset:20480
 v_xor_b32 v9, 33120, v6
 v_mfma_f32_16x16x32_bf16 v[164:167], a[92:95], a[184:187], v[164:167]
 s_waitcnt vmcnt(8)
 ds_read_b64_tr_b16 a[64:65], v9 offset:0
 v_mfma_f32_16x16x32_bf16 v[172:175], a[80:83], a[164:167], v[172:175]
 s_barrier
 ds_read_b64_tr_b16 a[66:67], v9 offset:4096
 v_mfma_f32_16x16x32_bf16 v[172:175], a[84:87], a[172:175], v[172:175]
 ds_read_b64_tr_b16 a[68:69], v9 offset:16384
 buffer_store_dword v11, v11, s[12:15], s92 offen sc1
 v_mfma_f32_16x16x32_bf16 v[172:175], a[88:91], a[180:183], v[172:175]
 s_add_u32 m0, s29, 94208
 ds_read_b64_tr_b16 a[70:71], v9 offset:20480
 v_xor_b32 v10, 98656, v6
 v_mfma_f32_16x16x32_bf16 v[172:175], a[92:95], a[188:191], v[172:175]
 s_waitcnt lgkmcnt(6)
 ds_read_b64_tr_b16 a[72:73], v10 offset:0
 buffer_load_dwordx4 v2, s[16:19], s54 offen lds
 v_mfma_f32_16x16x32_bf16 v[180:183], a[96:99], a[160:163], v[180:183]
 ds_read_b64_tr_b16 a[74:75], v10 offset:4096
 v_mfma_f32_16x16x32_bf16 v[180:183], a[100:103], a[168:171], v[180:183]
 ds_read_b64_tr_b16 a[76:77], v10 offset:16384
 v_mfma_f32_16x16x32_bf16 v[180:183], a[104:107], a[176:179], v[180:183]
 s_waitcnt lgkmcnt(7)
 ds_read_b64_tr_b16 a[78:79], v10 offset:20480
 v_xor_b32 v7, 33152, v6
 v_mfma_f32_16x16x32_bf16 v[180:183], a[108:111], a[184:187], v[180:183]
 ds_read_b64_tr_b16 a[80:81], v7 offset:0
 v_mfma_f32_16x16x32_bf16 v[188:191], a[96:99], a[164:167], v[188:191]
 ds_read_b64_tr_b16 a[82:83], v7 offset:4096
 v_mfma_f32_16x16x32_bf16 v[188:191], a[100:103], a[172:175], v[188:191]
 ds_read_b64_tr_b16 a[84:85], v7 offset:16384
 v_mfma_f32_16x16x32_bf16 v[188:191], a[104:107], a[180:183], v[188:191]
 ds_read_b64_tr_b16 a[86:87], v7 offset:20480
 v_xor_b32 v8, 98688, v6
 v_mfma_f32_16x16x32_bf16 v[188:191], a[108:111], a[188:191], v[188:191]
 s_waitcnt lgkmcnt(6)
 ds_read_b64_tr_b16 a[88:89], v8 offset:0
 v_mfma_f32_16x16x32_bf16 v[196:199], a[64:67], a[160:163], v[196:199]
 s_and_b32 s58, s92, ~127
 ds_read_b64_tr_b16 a[90:91], v8 offset:4096
 v_mfma_f32_16x16x32_bf16 v[196:199], a[68:71], a[168:171], v[196:199]
 s_lshl_b32 s37, s25, 1
 ds_read_b64_tr_b16 a[92:93], v8 offset:16384
 v_mfma_f32_16x16x32_bf16 v[196:199], a[72:75], a[176:179], v[196:199]
 s_waitcnt lgkmcnt(7)
 ds_read_b64_tr_b16 a[94:95], v8 offset:20480
 v_xor_b32 v9, 33184, v6
 v_mfma_f32_16x16x32_bf16 v[196:199], a[76:79], a[184:187], v[196:199]
 s_sub_i32 s38, 12, s37
 ds_read_b64_tr_b16 a[96:97], v9 offset:0
 v_mfma_f32_16x16x32_bf16 v[204:207], a[64:67], a[164:167], v[204:207]
 s_max_i32 s38, s38, 0
 ds_read_b64_tr_b16 a[98:99], v9 offset:4096
 v_mfma_f32_16x16x32_bf16 v[204:207], a[68:71], a[172:175], v[204:207]
 s_mul_i32 s49, s26, 1048576
 ds_read_b64_tr_b16 a[100:101], v9 offset:16384
 v_mfma_f32_16x16x32_bf16 v[204:207], a[72:75], a[180:183], v[204:207]
 s_lshl_b32 s50, s3, 13
 ds_read_b64_tr_b16 a[102:103], v9 offset:20480
 v_xor_b32 v10, 98720, v6
 v_mfma_f32_16x16x32_bf16 v[204:207], a[76:79], a[188:191], v[204:207]
 s_waitcnt lgkmcnt(6)
 ds_read_b64_tr_b16 a[104:105], v10 offset:0
 v_mfma_f32_16x16x32_bf16 v[212:215], a[80:83], a[160:163], v[212:215]
 s_add_u32 s49, s49, s50
 ds_read_b64_tr_b16 a[106:107], v10 offset:4096
 v_mfma_f32_16x16x32_bf16 v[212:215], a[84:87], a[168:171], v[212:215]
 s_mov_b32 s54, 2
 ds_read_b64_tr_b16 a[108:109], v10 offset:16384
 v_mfma_f32_16x16x32_bf16 v[212:215], a[88:91], a[176:179], v[212:215]
 s_waitcnt lgkmcnt(7)
 ds_read_b64_tr_b16 a[110:111], v10 offset:20480
 v_xor_b32 v7, 33216, v6
 v_mfma_f32_16x16x32_bf16 v[212:215], a[92:95], a[184:187], v[212:215]
 s_sub_u32 s44, 31, s37
 ds_read_b64_tr_b16 a[64:65], v7 offset:0
 v_mfma_f32_16x16x32_bf16 v[220:223], a[80:83], a[164:167], v[220:223]
 s_sub_u32 s44, s44, s38
 ds_read_b64_tr_b16 a[66:67], v7 offset:4096
 v_mfma_f32_16x16x32_bf16 v[220:223], a[84:87], a[172:175], v[220:223]
 s_mul_i32 s55, s38, 32768
 ds_read_b64_tr_b16 a[68:69], v7 offset:16384
 v_mfma_f32_16x16x32_bf16 v[220:223], a[88:91], a[180:183], v[220:223]
 s_add_u32 s42, s55, s49
 ds_read_b64_tr_b16 a[70:71], v7 offset:20480
 v_xor_b32 v8, 98752, v6
 v_mfma_f32_16x16x32_bf16 v[220:223], a[92:95], a[188:191], v[220:223]
 s_waitcnt lgkmcnt(6)
 ds_read_b64_tr_b16 a[72:73], v8 offset:0
 buffer_load_dwordx4 v[32:35], v122, s[4:7], 0 offen
 v_mfma_f32_16x16x32_bf16 v[228:231], a[96:99], a[160:163], v[228:231]
 s_add_u32 s60, s58, 16
 ds_read_b64_tr_b16 a[74:75], v8 offset:4096
 v_mfma_f32_16x16x32_bf16 v[228:231], a[100:103], a[168:171], v[228:231]
 s_sub_u32 s45, 17, s37
 ds_read_b64_tr_b16 a[76:77], v8 offset:16384
 v_mfma_f32_16x16x32_bf16 v[228:231], a[104:107], a[176:179], v[228:231]
 s_waitcnt lgkmcnt(7)
 ds_read_b64_tr_b16 a[78:79], v8 offset:20480
 v_xor_b32 v9, 33248, v6
 v_mfma_f32_16x16x32_bf16 v[228:231], a[108:111], a[184:187], v[228:231]
 ds_read_b64_tr_b16 a[80:81], v9 offset:0
 buffer_load_dwordx4 v[40:43], v123, s[4:7], 0 offen
 v_mfma_f32_16x16x32_bf16 v[236:239], a[96:99], a[164:167], v[236:239]
 s_sub_u32 s66, s42, 32768
 ds_read_b64_tr_b16 a[82:83], v9 offset:4096
 v_mfma_f32_16x16x32_bf16 v[236:239], a[100:103], a[172:175], v[236:239]
 s_add_u32 s42, s49, 491520
 ds_read_b64_tr_b16 a[84:85], v9 offset:16384
 v_mfma_f32_16x16x32_bf16 v[236:239], a[104:107], a[180:183], v[236:239]
 s_add_u32 s67, s49, 524288
 ds_read_b64_tr_b16 a[86:87], v9 offset:20480
 v_xor_b32 v10, 98784, v6
 v_mfma_f32_16x16x32_bf16 v[236:239], a[108:111], a[188:191], v[236:239]
 s_waitcnt lgkmcnt(6)
 ds_read_b64_tr_b16 a[88:89], v10 offset:0
 buffer_load_dwordx4 v[48:51], v128, s[4:7], 0 offen
 v_mfma_f32_16x16x32_bf16 v[244:247], a[64:67], a[160:163], v[244:247]
 s_add_u32 s68, s66, 16777216
 ds_read_b64_tr_b16 a[90:91], v10 offset:4096
 v_mfma_f32_16x16x32_bf16 v[244:247], a[68:71], a[168:171], v[244:247]
 s_waitcnt vmcnt(3)
 ds_read_b64_tr_b16 a[92:93], v10 offset:16384
 v_xor_b32 v7, 131072, v6
 v_mfma_f32_16x16x32_bf16 v[244:247], a[72:75], a[176:179], v[244:247]
 s_waitcnt lgkmcnt(7)
 s_barrier
 ds_read_b64_tr_b16 a[94:95], v10 offset:20480
 v_mfma_f32_16x16x32_bf16 v[244:247], a[76:79], a[184:187], v[244:247]
 ds_read_b64_tr_b16 a[96:97], v7 offset:0
 buffer_load_dwordx4 v[56:59], v120, s[4:7], 0 offen offset:0
 v_mfma_f32_16x16x32_bf16 v[252:255], a[64:67], a[164:167], v[252:255]
 s_add_u32 s69, s67, 16777216
 ds_read_b64_tr_b16 a[98:99], v7 offset:4096
 v_mfma_f32_16x16x32_bf16 v[252:255], a[68:71], a[172:175], v[252:255]
 s_mov_b32 s70, 0xffff8000
 ds_read_b64_tr_b16 a[100:101], v7 offset:16384
 v_mfma_f32_16x16x32_bf16 v[252:255], a[72:75], a[180:183], v[252:255]
 s_mov_b32 s71, s70
 ds_read_b64_tr_b16 a[102:103], v7 offset:20480
 v_xor_b32 v8, 0, v6
 v_mfma_f32_16x16x32_bf16 v[252:255], a[76:79], a[188:191], v[252:255]
 s_waitcnt lgkmcnt(6)
 ds_read_b64_tr_b16 a[104:105], v8 offset:0
 buffer_load_dwordx4 v[64:67], v120, s[4:7], 0 offen offset:896
 v_mfma_f32_16x16x32_bf16 v[16:19], a[80:83], a[160:163], v[16:19]
 s_add_u32 s43, s42, 16777216
 ds_read_b64_tr_b16 a[106:107], v8 offset:4096
 v_mfma_f32_16x16x32_bf16 v[16:19], a[84:87], a[168:171], v[16:19]
 s_mov_b32 s40, s50
 ds_read_b64_tr_b16 a[108:109], v8 offset:16384
 v_mfma_f32_16x16x32_bf16 v[16:19], a[88:91], a[176:179], v[16:19]
 s_waitcnt lgkmcnt(7)
 ds_read_b64_tr_b16 a[110:111], v8 offset:20480
 v_xor_b32 v9, 65536, v6
 v_mfma_f32_16x16x32_bf16 v[16:19], a[92:95], a[184:187], v[16:19]
 ds_read_b64_tr_b16 a[64:65], v9 offset:0
 buffer_load_dwordx4 v[72:75], v120, s[8:11], 0 offen offset:0
 v_mfma_f32_16x16x32_bf16 v[24:27], a[80:83], a[164:167], v[24:27]
 s_add_u32 s41, s50, 0x10000
 ds_read_b64_tr_b16 a[66:67], v9 offset:4096
 v_mfma_f32_16x16x32_bf16 v[24:27], a[84:87], a[172:175], v[24:27]
 s_lshr_b32 s61, s95, 4
 ds_read_b64_tr_b16 a[68:69], v9 offset:16384
 v_mfma_f32_16x16x32_bf16 v[24:27], a[88:91], a[180:183], v[24:27]
 s_lshl_b32 s61, s61, 7
 ds_read_b64_tr_b16 a[70:71], v9 offset:20480
 v_xor_b32 v10, 131104, v6
 v_mfma_f32_16x16x32_bf16 v[24:27], a[92:95], a[188:191], v[24:27]
 s_waitcnt lgkmcnt(6)
 ds_read_b64_tr_b16 a[72:73], v10 offset:0
 buffer_load_dwordx4 v[80:83], v120, s[8:11], 0 offen offset:896
 v_mfma_f32_16x16x32_bf16 v[28:31], a[96:99], a[192:195], v[28:31]
 s_add_u32 s61, s61, 84959232
 ds_read_b64_tr_b16 a[74:75], v10 offset:4096
 v_mfma_f32_16x16x32_bf16 v[28:31], a[100:103], a[200:203], v[28:31]
 s_mov_b32 s47, 0x4b800000
 ds_read_b64_tr_b16 a[76:77], v10 offset:16384
 v_mfma_f32_16x16x32_bf16 v[28:31], a[104:107], a[208:211], v[28:31]
 s_waitcnt lgkmcnt(3)
 ds_read_b64_tr_b16 a[78:79], v10 offset:20480
 v_xor_b32 v7, 32, v6
 v_mfma_f32_16x16x32_bf16 v[28:31], a[108:111], a[216:219], v[28:31]
 ds_read_b64_tr_b16 a[80:81], v7 offset:0
 buffer_load_dwordx4 v[88:91], v121, s[20:23], s39 offen offset:0
 v_mfma_f32_16x16x32_bf16 v[28:31], a[64:67], a[112:115], v[28:31]
 s_lshl_b32 s30, s95, 1
 ds_read_b64_tr_b16 a[82:83], v7 offset:4096
 v_mfma_f32_16x16x32_bf16 v[28:31], a[68:71], a[120:123], v[28:31]
 s_lshr_b32 s31, s3, 1
 ds_read_b64_tr_b16 a[84:85], v7 offset:16384
 v_mfma_f32_16x16x32_bf16 v[44:47], a[96:99], a[196:199], v[44:47]
 s_add_u32 s30, s30, s31
 ds_read_b64_tr_b16 a[86:87], v7 offset:20480
 v_xor_b32 v8, 65568, v6
 v_mfma_f32_16x16x32_bf16 v[44:47], a[100:103], a[204:207], v[44:47]
 ds_read_b64_tr_b16 a[88:89], v8 offset:0
 buffer_load_dwordx4 v[96:99], v121, s[20:23], s39 offen offset:16
 v_mfma_f32_16x16x32_bf16 v[44:47], a[104:107], a[212:215], v[44:47]
 s_min_u32 s30, s30, 223
 ds_read_b64_tr_b16 a[90:91], v8 offset:4096
 v_mfma_f32_16x16x32_bf16 v[44:47], a[108:111], a[220:223], v[44:47]
 s_lshl_b32 s30, s30, 2
 ds_read_b64_tr_b16 a[92:93], v8 offset:16384
 v_mfma_f32_16x16x32_bf16 v[44:47], a[64:67], a[116:119], v[44:47]
 ds_read_b64_tr_b16 a[94:95], v8 offset:20480
 v_xor_b32 v9, 131136, v6
 v_mfma_f32_16x16x32_bf16 v[44:47], a[68:71], a[124:127], v[44:47]
 s_waitcnt lgkmcnt(6)
 ds_read_b64_tr_b16 a[96:97], v9 offset:0
 buffer_load_dwordx4 v[104:107], v121, s[20:23], s39 offen offset:32
 v_mfma_f32_16x16x32_bf16 v[52:55], a[72:75], a[192:195], v[52:55]
 ds_read_b64_tr_b16 a[98:99], v9 offset:4096
 v_mfma_f32_16x16x32_bf16 v[52:55], a[76:79], a[200:203], v[52:55]
 ds_read_b64_tr_b16 a[100:101], v9 offset:16384
 v_mfma_f32_16x16x32_bf16 v[52:55], a[80:83], a[208:211], v[52:55]
 s_waitcnt lgkmcnt(3)
 ds_read_b64_tr_b16 a[102:103], v9 offset:20480
 v_xor_b32 v10, 64, v6
 v_mfma_f32_16x16x32_bf16 v[52:55], a[84:87], a[216:219], v[52:55]
 ds_read_b64_tr_b16 a[104:105], v10 offset:0
 buffer_load_dwordx4 v[112:115], v121, s[20:23], s39 offen offset:48
 v_mfma_f32_16x16x32_bf16 v[52:55], a[88:91], a[112:115], v[52:55]
 ds_read_b64_tr_b16 a[106:107], v10 offset:4096
 v_mfma_f32_16x16x32_bf16 v[52:55], a[92:95], a[120:123], v[52:55]
 ds_read_b64_tr_b16 a[108:109], v10 offset:16384
 v_mfma_f32_16x16x32_bf16 v[60:63], a[72:75], a[196:199], v[60:63]
 ds_read_b64_tr_b16 a[110:111], v10 offset:20480
 v_xor_b32 v7, 65600, v6
 v_mfma_f32_16x16x32_bf16 v[60:63], a[76:79], a[204:207], v[60:63]
 ds_read_b64_tr_b16 a[64:65], v7 offset:0
 v_mfma_f32_16x16x32_bf16 v[60:63], a[80:83], a[212:215], v[60:63]
 s_and_b32 s4, s2, 127
 ds_read_b64_tr_b16 a[66:67], v7 offset:4096
 v_mfma_f32_16x16x32_bf16 v[60:63], a[84:87], a[220:223], v[60:63]
 s_lshl_b32 s4, s4, 2
 ds_read_b64_tr_b16 a[68:69], v7 offset:16384
 v_mfma_f32_16x16x32_bf16 v[60:63], a[88:91], a[116:119], v[60:63]
 s_add_u32 s4, s4, s3
 ds_read_b64_tr_b16 a[70:71], v7 offset:20480
 v_xor_b32 v8, 131168, v6
 v_mfma_f32_16x16x32_bf16 v[60:63], a[92:95], a[124:127], v[60:63]
 s_waitcnt lgkmcnt(6)
 ds_read_b64_tr_b16 a[72:73], v8 offset:0
 v_mfma_f32_16x16x32_bf16 v[20:23], a[96:99], a[192:195], v[20:23]
 s_lshl_b32 s6, s4, 10
 ds_read_b64_tr_b16 a[74:75], v8 offset:4096
 v_mfma_f32_16x16x32_bf16 v[20:23], a[100:103], a[200:203], v[20:23]
 s_add_u32 s6, s6, 83886080
 ds_read_b64_tr_b16 a[76:77], v8 offset:16384
 v_mul_f32 v28, s34, v28
 v_mfma_f32_16x16x32_bf16 v[20:23], a[104:107], a[208:211], v[20:23]
 s_waitcnt lgkmcnt(3)
 ds_read_b64_tr_b16 a[78:79], v8 offset:20480
 v_xor_b32 v9, 96, v6
 v_mfma_f32_16x16x32_bf16 v[20:23], a[108:111], a[216:219], v[20:23]
 s_mul_i32 s4, s4, 17408
 ds_read_b64_tr_b16 a[80:81], v9 offset:0
 v_mul_f32 v29, s34, v29
 v_mfma_f32_16x16x32_bf16 v[20:23], a[64:67], a[112:115], v[20:23]
 s_add_u32 s4, s4, 67108864
 ds_read_b64_tr_b16 a[82:83], v9 offset:4096
 v_mul_f32 v30, s34, v30
 v_mfma_f32_16x16x32_bf16 v[20:23], a[68:71], a[120:123], v[20:23]
 s_add_u32 s5, s4, 0x2000
 ds_read_b64_tr_b16 a[84:85], v9 offset:16384
 v_mul_f32 v31, s34, v31
 v_mfma_f32_16x16x32_bf16 v[36:39], a[96:99], a[196:199], v[36:39]
 s_mov_b32 s7, 0
 ds_read_b64_tr_b16 a[86:87], v9 offset:20480
 v_xor_b32 v10, 65632, v6
 v_mfma_f32_16x16x32_bf16 v[36:39], a[100:103], a[204:207], v[36:39]
 s_mov_b32 s53, 0
 ds_read_b64_tr_b16 a[88:89], v10 offset:0
 v_mul_f32 v52, s34, v52
 v_mfma_f32_16x16x32_bf16 v[36:39], a[104:107], a[212:215], v[36:39]
 s_cmp_eq_u32 s38, 0
 s_cmov_b32 s4, 2.0
 ds_read_b64_tr_b16 a[90:91], v10 offset:4096
 v_mfma_f32_16x16x32_bf16 v[36:39], a[108:111], a[220:223], v[36:39]
 s_cmp_eq_u32 s38, 0
 s_cmov_b32 s5, 2.0
 ds_read_b64_tr_b16 a[92:93], v10 offset:16384
 v_mfma_f32_16x16x32_bf16 v[36:39], a[64:67], a[116:119], v[36:39]
 s_cmp_eq_u32 s38, 0
 s_cmov_b32 s6, 2.0
 ds_read_b64_tr_b16 a[94:95], v10 offset:20480
 v_xor_b32 v7, 131200, v6
 v_mfma_f32_16x16x32_bf16 v[36:39], a[68:71], a[124:127], v[36:39]
 s_waitcnt lgkmcnt(6)
 ds_read_b64_tr_b16 a[96:97], v7 offset:0
 v_mul_f32 v53, s34, v53
 v_mfma_f32_16x16x32_bf16 v[68:71], a[72:75], a[192:195], v[68:71]
 s_mov_b64 s[8:9], s[12:13]
 ds_read_b64_tr_b16 a[98:99], v7 offset:4096
 v_mul_f32 v54, s34, v54
 v_mfma_f32_16x16x32_bf16 v[68:71], a[76:79], a[200:203], v[68:71]
 s_mov_b32 s10, s14
 ds_read_b64_tr_b16 a[100:101], v7 offset:16384
 v_mul_f32 v55, s34, v55
 v_mfma_f32_16x16x32_bf16 v[68:71], a[80:83], a[208:211], v[68:71]
 s_waitcnt lgkmcnt(3)
 ds_read_b64_tr_b16 a[102:103], v7 offset:20480
 v_xor_b32 v8, 128, v6
 v_mfma_f32_16x16x32_bf16 v[68:71], a[84:87], a[216:219], v[68:71]
 s_mov_b32 s76, 0
 ds_read_b64_tr_b16 a[104:105], v8 offset:0
 v_cvt_pk_bf16_f32 v28, v28, v29
 v_mfma_f32_16x16x32_bf16 v[68:71], a[88:91], a[112:115], v[68:71]
 s_movk_i32 s77, 0x1000
 ds_read_b64_tr_b16 a[106:107], v8 offset:4096
 v_cvt_pk_bf16_f32 v29, v30, v31
 v_mfma_f32_16x16x32_bf16 v[68:71], a[92:95], a[120:123], v[68:71]
 s_mov_b32 s51, 0
 ds_read_b64_tr_b16 a[108:109], v8 offset:16384
 v_cvt_pk_bf16_f32 v30, v52, v53
 v_mfma_f32_16x16x32_bf16 v[76:79], a[72:75], a[196:199], v[76:79]
 s_mul_i32 s78, s26, 229376
 ds_read_b64_tr_b16 a[110:111], v8 offset:20480
 v_xor_b32 v9, 65664, v6
 v_mfma_f32_16x16x32_bf16 v[76:79], a[76:79], a[204:207], v[76:79]
 s_add_u32 s79, s78, 28672
 ds_read_b64_tr_b16 a[64:65], v9 offset:0
 v_cvt_pk_bf16_f32 v31, v54, v55
 v_mfma_f32_16x16x32_bf16 v[76:79], a[80:83], a[212:215], v[76:79]
 s_add_u32 s80, s78, 57344
 ds_read_b64_tr_b16 a[66:67], v9 offset:4096
 v_accvgpr_write_b32 a0, v28
 v_mfma_f32_16x16x32_bf16 v[76:79], a[84:87], a[220:223], v[76:79]
 s_add_u32 s81, s78, 86016
 ds_read_b64_tr_b16 a[68:69], v9 offset:16384
 v_accvgpr_write_b32 a1, v29
 v_mfma_f32_16x16x32_bf16 v[76:79], a[88:91], a[116:119], v[76:79]
 s_add_u32 s82, s78, 114688
 ds_read_b64_tr_b16 a[70:71], v9 offset:20480
 v_xor_b32 v10, 131232, v6
 v_mfma_f32_16x16x32_bf16 v[76:79], a[92:95], a[124:127], v[76:79]
 s_waitcnt lgkmcnt(6)
 ds_read_b64_tr_b16 a[72:73], v10 offset:0
 v_accvgpr_write_b32 a2, v30
 v_mfma_f32_16x16x32_bf16 v[84:87], a[96:99], a[192:195], v[84:87]
 s_add_u32 s83, s78, 143360
 ds_read_b64_tr_b16 a[74:75], v10 offset:4096
 v_accvgpr_write_b32 a3, v31
 v_mfma_f32_16x16x32_bf16 v[84:87], a[100:103], a[200:203], v[84:87]
 s_add_u32 s84, s78, 172032
 ds_read_b64_tr_b16 a[76:77], v10 offset:16384
 v_mul_f32 v44, s34, v44
 v_mfma_f32_16x16x32_bf16 v[84:87], a[104:107], a[208:211], v[84:87]
 s_waitcnt lgkmcnt(3)
 ds_read_b64_tr_b16 a[78:79], v10 offset:20480
 v_xor_b32 v7, 160, v6
 v_mfma_f32_16x16x32_bf16 v[84:87], a[108:111], a[216:219], v[84:87]
 s_add_u32 s85, s78, 200704
 ds_read_b64_tr_b16 a[80:81], v7 offset:0
 v_mul_f32 v45, s34, v45
 v_mfma_f32_16x16x32_bf16 v[84:87], a[64:67], a[112:115], v[84:87]
 s_add_u32 s59, s62, 0
 ds_read_b64_tr_b16 a[82:83], v7 offset:4096
 v_mul_f32 v46, s34, v46
 v_mfma_f32_16x16x32_bf16 v[84:87], a[68:71], a[120:123], v[84:87]
 ds_read_b64_tr_b16 a[84:85], v7 offset:16384
 buffer_store_dwordx4 v[28:31], v1, s[12:15], s59 offen offset:0 sc1
 v_mfma_f32_16x16x32_bf16 v[92:95], a[96:99], a[196:199], v[92:95]
 ds_read_b64_tr_b16 a[86:87], v7 offset:20480
 v_xor_b32 v8, 65696, v6
 v_mfma_f32_16x16x32_bf16 v[92:95], a[100:103], a[204:207], v[92:95]
 ds_read_b64_tr_b16 a[88:89], v8 offset:0
 v_mul_f32 v47, s34, v47
 v_mfma_f32_16x16x32_bf16 v[92:95], a[104:107], a[212:215], v[92:95]
 ds_read_b64_tr_b16 a[90:91], v8 offset:4096
 v_mul_f32 v60, s34, v60
 v_mfma_f32_16x16x32_bf16 v[92:95], a[108:111], a[220:223], v[92:95]
 ds_read_b64_tr_b16 a[92:93], v8 offset:16384
 v_mul_f32 v61, s34, v61
 v_mfma_f32_16x16x32_bf16 v[92:95], a[64:67], a[116:119], v[92:95]
 ds_read_b64_tr_b16 a[94:95], v8 offset:20480
 v_xor_b32 v9, 131264, v6
 v_mfma_f32_16x16x32_bf16 v[92:95], a[68:71], a[124:127], v[92:95]
 s_waitcnt lgkmcnt(6)
 ds_read_b64_tr_b16 a[96:97], v9 offset:0
 v_mul_f32 v62, s34, v62
 v_mfma_f32_16x16x32_bf16 v[100:103], a[72:75], a[192:195], v[100:103]
 ds_read_b64_tr_b16 a[98:99], v9 offset:4096
 v_mul_f32 v63, s34, v63
 v_mfma_f32_16x16x32_bf16 v[100:103], a[76:79], a[200:203], v[100:103]
 ds_read_b64_tr_b16 a[100:101], v9 offset:16384
 v_cvt_pk_bf16_f32 v44, v44, v45
 v_mfma_f32_16x16x32_bf16 v[100:103], a[80:83], a[208:211], v[100:103]
 s_waitcnt lgkmcnt(3)
 ds_read_b64_tr_b16 a[102:103], v9 offset:20480
 v_xor_b32 v10, 192, v6
 v_mfma_f32_16x16x32_bf16 v[100:103], a[84:87], a[216:219], v[100:103]
 ds_read_b64_tr_b16 a[104:105], v10 offset:0
 v_cvt_pk_bf16_f32 v45, v46, v47
 v_mfma_f32_16x16x32_bf16 v[100:103], a[88:91], a[112:115], v[100:103]
 ds_read_b64_tr_b16 a[106:107], v10 offset:4096
 v_cvt_pk_bf16_f32 v46, v60, v61
 v_mfma_f32_16x16x32_bf16 v[100:103], a[92:95], a[120:123], v[100:103]
 ds_read_b64_tr_b16 a[108:109], v10 offset:16384
 v_cvt_pk_bf16_f32 v47, v62, v63
 v_mfma_f32_16x16x32_bf16 v[108:111], a[72:75], a[196:199], v[108:111]
 s_add_u32 s59, s62, 8192
 ds_read_b64_tr_b16 a[110:111], v10 offset:20480
 v_xor_b32 v7, 65728, v6
 v_mfma_f32_16x16x32_bf16 v[108:111], a[76:79], a[204:207], v[108:111]
 ds_read_b64_tr_b16 a[64:65], v7 offset:0
 buffer_store_dwordx4 v[44:47], v1, s[12:15], s59 offen offset:0 sc1
 v_mfma_f32_16x16x32_bf16 v[108:111], a[80:83], a[212:215], v[108:111]
 ds_read_b64_tr_b16 a[66:67], v7 offset:4096
 v_accvgpr_write_b32 a32, v44
 v_mfma_f32_16x16x32_bf16 v[108:111], a[84:87], a[220:223], v[108:111]
 ds_read_b64_tr_b16 a[68:69], v7 offset:16384
 v_accvgpr_write_b32 a33, v45
 v_mfma_f32_16x16x32_bf16 v[108:111], a[88:91], a[116:119], v[108:111]
 ds_read_b64_tr_b16 a[70:71], v7 offset:20480
 v_xor_b32 v8, 131296, v6
 v_mfma_f32_16x16x32_bf16 v[108:111], a[92:95], a[124:127], v[108:111]
 s_waitcnt lgkmcnt(6)
 ds_read_b64_tr_b16 a[72:73], v8 offset:0
 v_accvgpr_write_b32 a34, v46
 v_mfma_f32_16x16x32_bf16 v[116:119], a[96:99], a[192:195], v[116:119]
 ds_read_b64_tr_b16 a[74:75], v8 offset:4096
 v_accvgpr_write_b32 a35, v47
 v_mfma_f32_16x16x32_bf16 v[116:119], a[100:103], a[200:203], v[116:119]
 ds_read_b64_tr_b16 a[76:77], v8 offset:16384
 v_mul_f32 v20, s34, v20
 v_mfma_f32_16x16x32_bf16 v[116:119], a[104:107], a[208:211], v[116:119]
 s_waitcnt lgkmcnt(3)
 ds_read_b64_tr_b16 a[78:79], v8 offset:20480
 v_xor_b32 v9, 224, v6
 v_mfma_f32_16x16x32_bf16 v[116:119], a[108:111], a[216:219], v[116:119]
 ds_read_b64_tr_b16 a[80:81], v9 offset:0
 v_mul_f32 v21, s34, v21
 v_mfma_f32_16x16x32_bf16 v[116:119], a[64:67], a[112:115], v[116:119]
 ds_read_b64_tr_b16 a[82:83], v9 offset:4096
 v_mul_f32 v22, s34, v22
 v_mfma_f32_16x16x32_bf16 v[116:119], a[68:71], a[120:123], v[116:119]
 ds_read_b64_tr_b16 a[84:85], v9 offset:16384
 v_mul_f32 v23, s34, v23
 v_mfma_f32_16x16x32_bf16 v[124:127], a[96:99], a[196:199], v[124:127]
 ds_read_b64_tr_b16 a[86:87], v9 offset:20480
 v_xor_b32 v10, 65760, v6
 v_mfma_f32_16x16x32_bf16 v[124:127], a[100:103], a[204:207], v[124:127]
 ds_read_b64_tr_b16 a[88:89], v10 offset:0
 v_mul_f32 v68, s34, v68
 v_mfma_f32_16x16x32_bf16 v[124:127], a[104:107], a[212:215], v[124:127]
 ds_read_b64_tr_b16 a[90:91], v10 offset:4096
 v_mul_f32 v69, s34, v69
 v_mfma_f32_16x16x32_bf16 v[124:127], a[108:111], a[220:223], v[124:127]
 ds_read_b64_tr_b16 a[92:93], v10 offset:16384
 v_mul_f32 v70, s34, v70
 v_mfma_f32_16x16x32_bf16 v[124:127], a[64:67], a[116:119], v[124:127]
 ds_read_b64_tr_b16 a[94:95], v10 offset:20480
 v_xor_b32 v7, 131328, v6
 v_mfma_f32_16x16x32_bf16 v[124:127], a[68:71], a[124:127], v[124:127]
 s_waitcnt lgkmcnt(6)
 ds_read_b64_tr_b16 a[96:97], v7 offset:0
 v_mul_f32 v71, s34, v71
 v_mfma_f32_16x16x32_bf16 v[132:135], a[72:75], a[192:195], v[132:135]
 ds_read_b64_tr_b16 a[98:99], v7 offset:4096
 v_cvt_pk_bf16_f32 v20, v20, v21
 v_mfma_f32_16x16x32_bf16 v[132:135], a[76:79], a[200:203], v[132:135]
 ds_read_b64_tr_b16 a[100:101], v7 offset:16384
 v_cvt_pk_bf16_f32 v21, v22, v23
 v_mfma_f32_16x16x32_bf16 v[132:135], a[80:83], a[208:211], v[132:135]
 s_waitcnt lgkmcnt(3)
 ds_read_b64_tr_b16 a[102:103], v7 offset:20480
 v_xor_b32 v8, 256, v6
 v_mfma_f32_16x16x32_bf16 v[132:135], a[84:87], a[216:219], v[132:135]
 ds_read_b64_tr_b16 a[104:105], v8 offset:0
 v_cvt_pk_bf16_f32 v22, v68, v69
 v_mfma_f32_16x16x32_bf16 v[132:135], a[88:91], a[112:115], v[132:135]
 s_add_u32 s59, s62, 0
 ds_read_b64_tr_b16 a[106:107], v8 offset:4096
 v_cvt_pk_bf16_f32 v23, v70, v71
 v_mfma_f32_16x16x32_bf16 v[132:135], a[92:95], a[120:123], v[132:135]
 ds_read_b64_tr_b16 a[108:109], v8 offset:16384
 buffer_store_dwordx4 v[20:23], v1, s[12:15], s59 offen offset:1024 sc1
 v_mfma_f32_16x16x32_bf16 v[140:143], a[72:75], a[196:199], v[140:143]
 ds_read_b64_tr_b16 a[110:111], v8 offset:20480
 v_xor_b32 v9, 65792, v6
 v_mfma_f32_16x16x32_bf16 v[140:143], a[76:79], a[204:207], v[140:143]
 ds_read_b64_tr_b16 a[64:65], v9 offset:0
 v_accvgpr_write_b32 a4, v20
 v_mfma_f32_16x16x32_bf16 v[140:143], a[80:83], a[212:215], v[140:143]
 ds_read_b64_tr_b16 a[66:67], v9 offset:4096
 v_accvgpr_write_b32 a5, v21
 v_mfma_f32_16x16x32_bf16 v[140:143], a[84:87], a[220:223], v[140:143]
 ds_read_b64_tr_b16 a[68:69], v9 offset:16384
 v_accvgpr_write_b32 a6, v22
 v_mfma_f32_16x16x32_bf16 v[140:143], a[88:91], a[116:119], v[140:143]
 ds_read_b64_tr_b16 a[70:71], v9 offset:20480
 v_xor_b32 v10, 131360, v6
 v_mfma_f32_16x16x32_bf16 v[140:143], a[92:95], a[124:127], v[140:143]
 s_waitcnt lgkmcnt(6)
 ds_read_b64_tr_b16 a[72:73], v10 offset:0
 v_accvgpr_write_b32 a7, v23
 v_mfma_f32_16x16x32_bf16 v[148:151], a[96:99], a[192:195], v[148:151]
 ds_read_b64_tr_b16 a[74:75], v10 offset:4096
 v_mul_f32 v36, s34, v36
 v_mfma_f32_16x16x32_bf16 v[148:151], a[100:103], a[200:203], v[148:151]
 ds_read_b64_tr_b16 a[76:77], v10 offset:16384
 v_mul_f32 v37, s34, v37
 v_mfma_f32_16x16x32_bf16 v[148:151], a[104:107], a[208:211], v[148:151]
 s_waitcnt lgkmcnt(3)
 ds_read_b64_tr_b16 a[78:79], v10 offset:20480
 v_xor_b32 v7, 288, v6
 v_mfma_f32_16x16x32_bf16 v[148:151], a[108:111], a[216:219], v[148:151]
 ds_read_b64_tr_b16 a[80:81], v7 offset:0
 v_mul_f32 v38, s34, v38
 v_mfma_f32_16x16x32_bf16 v[148:151], a[64:67], a[112:115], v[148:151]
 ds_read_b64_tr_b16 a[82:83], v7 offset:4096
 v_mul_f32 v39, s34, v39
 v_mfma_f32_16x16x32_bf16 v[148:151], a[68:71], a[120:123], v[148:151]
 ds_read_b64_tr_b16 a[84:85], v7 offset:16384
 v_mul_f32 v76, s34, v76
 v_mfma_f32_16x16x32_bf16 v[156:159], a[96:99], a[196:199], v[156:159]
 ds_read_b64_tr_b16 a[86:87], v7 offset:20480
 v_xor_b32 v8, 65824, v6
 v_mfma_f32_16x16x32_bf16 v[156:159], a[100:103], a[204:207], v[156:159]
 ds_read_b64_tr_b16 a[88:89], v8 offset:0
 v_mul_f32 v77, s34, v77
 v_mfma_f32_16x16x32_bf16 v[156:159], a[104:107], a[212:215], v[156:159]
 ds_read_b64_tr_b16 a[90:91], v8 offset:4096
 v_mul_f32 v78, s34, v78
 v_mfma_f32_16x16x32_bf16 v[156:159], a[108:111], a[220:223], v[156:159]
 ds_read_b64_tr_b16 a[92:93], v8 offset:16384
 v_mul_f32 v79, s34, v79
 v_mfma_f32_16x16x32_bf16 v[156:159], a[64:67], a[116:119], v[156:159]
 ds_read_b64_tr_b16 a[94:95], v8 offset:20480
 v_xor_b32 v9, 131392, v6
 v_mfma_f32_16x16x32_bf16 v[156:159], a[68:71], a[124:127], v[156:159]
 s_waitcnt lgkmcnt(6)
 ds_read_b64_tr_b16 a[96:97], v9 offset:0
 v_cvt_pk_bf16_f32 v36, v36, v37
 v_mfma_f32_16x16x32_bf16 v[164:167], a[72:75], a[192:195], v[164:167]
 ds_read_b64_tr_b16 a[98:99], v9 offset:4096
 v_cvt_pk_bf16_f32 v37, v38, v39
 v_mfma_f32_16x16x32_bf16 v[164:167], a[76:79], a[200:203], v[164:167]
 ds_read_b64_tr_b16 a[100:101], v9 offset:16384
 v_cvt_pk_bf16_f32 v38, v76, v77
 v_mfma_f32_16x16x32_bf16 v[164:167], a[80:83], a[208:211], v[164:167]
 s_waitcnt lgkmcnt(3)
 ds_read_b64_tr_b16 a[102:103], v9 offset:20480
 v_xor_b32 v10, 320, v6
 v_mfma_f32_16x16x32_bf16 v[164:167], a[84:87], a[216:219], v[164:167]
 s_add_u32 s59, s62, 8192
 ds_read_b64_tr_b16 a[104:105], v10 offset:0
 v_cvt_pk_bf16_f32 v39, v78, v79
 v_mfma_f32_16x16x32_bf16 v[164:167], a[88:91], a[112:115], v[164:167]
 ds_read_b64_tr_b16 a[106:107], v10 offset:4096
 buffer_store_dwordx4 v[36:39], v1, s[12:15], s59 offen offset:1024 sc1
 v_mfma_f32_16x16x32_bf16 v[164:167], a[92:95], a[120:123], v[164:167]
 ds_read_b64_tr_b16 a[108:109], v10 offset:16384
 v_accvgpr_write_b32 a36, v36
 v_mfma_f32_16x16x32_bf16 v[172:175], a[72:75], a[196:199], v[172:175]
 ds_read_b64_tr_b16 a[110:111], v10 offset:20480
 v_xor_b32 v7, 65856, v6
 v_mfma_f32_16x16x32_bf16 v[172:175], a[76:79], a[204:207], v[172:175]
 ds_read_b64_tr_b16 a[64:65], v7 offset:0
 v_accvgpr_write_b32 a37, v37
 v_mfma_f32_16x16x32_bf16 v[172:175], a[80:83], a[212:215], v[172:175]
 ds_read_b64_tr_b16 a[66:67], v7 offset:4096
 v_accvgpr_write_b32 a38, v38
 v_mfma_f32_16x16x32_bf16 v[172:175], a[84:87], a[220:223], v[172:175]
 ds_read_b64_tr_b16 a[68:69], v7 offset:16384
 v_accvgpr_write_b32 a39, v39
 v_mfma_f32_16x16x32_bf16 v[172:175], a[88:91], a[116:119], v[172:175]
 ds_read_b64_tr_b16 a[70:71], v7 offset:20480
 v_xor_b32 v8, 131424, v6
 v_mfma_f32_16x16x32_bf16 v[172:175], a[92:95], a[124:127], v[172:175]
 s_waitcnt lgkmcnt(6)
 ds_read_b64_tr_b16 a[72:73], v8 offset:0
 v_mul_f32 v84, s34, v84
 v_mfma_f32_16x16x32_bf16 v[180:183], a[96:99], a[192:195], v[180:183]
 ds_read_b64_tr_b16 a[74:75], v8 offset:4096
 v_mul_f32 v85, s34, v85
 v_mfma_f32_16x16x32_bf16 v[180:183], a[100:103], a[200:203], v[180:183]
 ds_read_b64_tr_b16 a[76:77], v8 offset:16384
 v_mul_f32 v86, s34, v86
 v_mfma_f32_16x16x32_bf16 v[180:183], a[104:107], a[208:211], v[180:183]
 s_waitcnt lgkmcnt(3)
 ds_read_b64_tr_b16 a[78:79], v8 offset:20480
 v_xor_b32 v9, 352, v6
 v_mfma_f32_16x16x32_bf16 v[180:183], a[108:111], a[216:219], v[180:183]
 ds_read_b64_tr_b16 a[80:81], v9 offset:0
 v_mul_f32 v87, s34, v87
 v_mfma_f32_16x16x32_bf16 v[180:183], a[64:67], a[112:115], v[180:183]
 ds_read_b64_tr_b16 a[82:83], v9 offset:4096
 v_mul_f32 v100, s34, v100
 v_mfma_f32_16x16x32_bf16 v[180:183], a[68:71], a[120:123], v[180:183]
 ds_read_b64_tr_b16 a[84:85], v9 offset:16384
 v_mul_f32 v101, s34, v101
 v_mfma_f32_16x16x32_bf16 v[188:191], a[96:99], a[196:199], v[188:191]
 ds_read_b64_tr_b16 a[86:87], v9 offset:20480
 v_xor_b32 v10, 65888, v6
 v_mfma_f32_16x16x32_bf16 v[188:191], a[100:103], a[204:207], v[188:191]
 ds_read_b64_tr_b16 a[88:89], v10 offset:0
 v_mul_f32 v102, s34, v102
 v_mfma_f32_16x16x32_bf16 v[188:191], a[104:107], a[212:215], v[188:191]
 ds_read_b64_tr_b16 a[90:91], v10 offset:4096
 v_mul_f32 v103, s34, v103
 v_mfma_f32_16x16x32_bf16 v[188:191], a[108:111], a[220:223], v[188:191]
 ds_read_b64_tr_b16 a[92:93], v10 offset:16384
 v_cvt_pk_bf16_f32 v84, v84, v85
 v_mfma_f32_16x16x32_bf16 v[188:191], a[64:67], a[116:119], v[188:191]
 ds_read_b64_tr_b16 a[94:95], v10 offset:20480
 v_xor_b32 v7, 131456, v6
 v_mfma_f32_16x16x32_bf16 v[188:191], a[68:71], a[124:127], v[188:191]
 s_waitcnt lgkmcnt(6)
 ds_read_b64_tr_b16 a[96:97], v7 offset:0
 v_cvt_pk_bf16_f32 v85, v86, v87
 v_mfma_f32_16x16x32_bf16 v[196:199], a[72:75], a[192:195], v[196:199]
 ds_read_b64_tr_b16 a[98:99], v7 offset:4096
 v_cvt_pk_bf16_f32 v86, v100, v101
 v_mfma_f32_16x16x32_bf16 v[196:199], a[76:79], a[200:203], v[196:199]
 s_add_u32 s59, s62, 0
 ds_read_b64_tr_b16 a[100:101], v7 offset:16384
 v_cvt_pk_bf16_f32 v87, v102, v103
 v_mfma_f32_16x16x32_bf16 v[196:199], a[80:83], a[208:211], v[196:199]
 s_waitcnt lgkmcnt(3)
 ds_read_b64_tr_b16 a[102:103], v7 offset:20480
 v_xor_b32 v8, 384, v6
 v_mfma_f32_16x16x32_bf16 v[196:199], a[84:87], a[216:219], v[196:199]
 ds_read_b64_tr_b16 a[104:105], v8 offset:0
 buffer_store_dwordx4 v[84:87], v1, s[12:15], s59 offen offset:2048 sc1
 v_mfma_f32_16x16x32_bf16 v[196:199], a[88:91], a[112:115], v[196:199]
 ds_read_b64_tr_b16 a[106:107], v8 offset:4096
 v_accvgpr_write_b32 a8, v84
 v_mfma_f32_16x16x32_bf16 v[196:199], a[92:95], a[120:123], v[196:199]
 ds_read_b64_tr_b16 a[108:109], v8 offset:16384
 v_accvgpr_write_b32 a9, v85
 v_mfma_f32_16x16x32_bf16 v[204:207], a[72:75], a[196:199], v[204:207]
 ds_read_b64_tr_b16 a[110:111], v8 offset:20480
 v_xor_b32 v9, 65920, v6
 v_mfma_f32_16x16x32_bf16 v[204:207], a[76:79], a[204:207], v[204:207]
 ds_read_b64_tr_b16 a[64:65], v9 offset:0
 v_accvgpr_write_b32 a10, v86
 v_mfma_f32_16x16x32_bf16 v[204:207], a[80:83], a[212:215], v[204:207]
 ds_read_b64_tr_b16 a[66:67], v9 offset:4096
 v_accvgpr_write_b32 a11, v87
 v_mfma_f32_16x16x32_bf16 v[204:207], a[84:87], a[220:223], v[204:207]
 ds_read_b64_tr_b16 a[68:69], v9 offset:16384
 v_mul_f32 v92, s34, v92
 v_mfma_f32_16x16x32_bf16 v[204:207], a[88:91], a[116:119], v[204:207]
 ds_read_b64_tr_b16 a[70:71], v9 offset:20480
 v_xor_b32 v10, 131488, v6
 v_mfma_f32_16x16x32_bf16 v[204:207], a[92:95], a[124:127], v[204:207]
 s_waitcnt lgkmcnt(6)
 ds_read_b64_tr_b16 a[72:73], v10 offset:0
 v_mul_f32 v93, s34, v93
 v_mfma_f32_16x16x32_bf16 v[212:215], a[96:99], a[192:195], v[212:215]
 ds_read_b64_tr_b16 a[74:75], v10 offset:4096
 v_mul_f32 v94, s34, v94
 v_mfma_f32_16x16x32_bf16 v[212:215], a[100:103], a[200:203], v[212:215]
 ds_read_b64_tr_b16 a[76:77], v10 offset:16384
 v_mul_f32 v95, s34, v95
 v_mfma_f32_16x16x32_bf16 v[212:215], a[104:107], a[208:211], v[212:215]
 s_waitcnt lgkmcnt(3)
 ds_read_b64_tr_b16 a[78:79], v10 offset:20480
 v_xor_b32 v7, 416, v6
 v_mfma_f32_16x16x32_bf16 v[212:215], a[108:111], a[216:219], v[212:215]
 ds_read_b64_tr_b16 a[80:81], v7 offset:0
 v_mul_f32 v108, s34, v108
 v_mfma_f32_16x16x32_bf16 v[212:215], a[64:67], a[112:115], v[212:215]
 ds_read_b64_tr_b16 a[82:83], v7 offset:4096
 v_mul_f32 v109, s34, v109
 v_mfma_f32_16x16x32_bf16 v[212:215], a[68:71], a[120:123], v[212:215]
 ds_read_b64_tr_b16 a[84:85], v7 offset:16384
 v_mul_f32 v110, s34, v110
 v_mfma_f32_16x16x32_bf16 v[220:223], a[96:99], a[196:199], v[220:223]
 ds_read_b64_tr_b16 a[86:87], v7 offset:20480
 v_xor_b32 v8, 65952, v6
 v_mfma_f32_16x16x32_bf16 v[220:223], a[100:103], a[204:207], v[220:223]
 ds_read_b64_tr_b16 a[88:89], v8 offset:0
 v_mul_f32 v111, s34, v111
 v_mfma_f32_16x16x32_bf16 v[220:223], a[104:107], a[212:215], v[220:223]
 ds_read_b64_tr_b16 a[90:91], v8 offset:4096
 v_cvt_pk_bf16_f32 v92, v92, v93
 v_mfma_f32_16x16x32_bf16 v[220:223], a[108:111], a[220:223], v[220:223]
 ds_read_b64_tr_b16 a[92:93], v8 offset:16384
 v_cvt_pk_bf16_f32 v93, v94, v95
 v_mfma_f32_16x16x32_bf16 v[220:223], a[64:67], a[116:119], v[220:223]
 ds_read_b64_tr_b16 a[94:95], v8 offset:20480
 v_xor_b32 v9, 131520, v6
 v_mfma_f32_16x16x32_bf16 v[220:223], a[68:71], a[124:127], v[220:223]
 s_waitcnt lgkmcnt(6)
 ds_read_b64_tr_b16 a[96:97], v9 offset:0
 v_cvt_pk_bf16_f32 v94, v108, v109
 v_mfma_f32_16x16x32_bf16 v[228:231], a[72:75], a[192:195], v[228:231]
 s_add_u32 s59, s62, 8192
 ds_read_b64_tr_b16 a[98:99], v9 offset:4096
 v_cvt_pk_bf16_f32 v95, v110, v111
 v_mfma_f32_16x16x32_bf16 v[228:231], a[76:79], a[200:203], v[228:231]
 ds_read_b64_tr_b16 a[100:101], v9 offset:16384
 buffer_store_dwordx4 v[92:95], v1, s[12:15], s59 offen offset:2048 sc1
 v_mfma_f32_16x16x32_bf16 v[228:231], a[80:83], a[208:211], v[228:231]
 s_waitcnt lgkmcnt(3)
 ds_read_b64_tr_b16 a[102:103], v9 offset:20480
 v_xor_b32 v10, 448, v6
 v_mfma_f32_16x16x32_bf16 v[228:231], a[84:87], a[216:219], v[228:231]
 ds_read_b64_tr_b16 a[104:105], v10 offset:0
 v_accvgpr_write_b32 a40, v92
 v_mfma_f32_16x16x32_bf16 v[228:231], a[88:91], a[112:115], v[228:231]
 ds_read_b64_tr_b16 a[106:107], v10 offset:4096
 v_accvgpr_write_b32 a41, v93
 v_mfma_f32_16x16x32_bf16 v[228:231], a[92:95], a[120:123], v[228:231]
 ds_read_b64_tr_b16 a[108:109], v10 offset:16384
 v_accvgpr_write_b32 a42, v94
 v_mfma_f32_16x16x32_bf16 v[236:239], a[72:75], a[196:199], v[236:239]
 ds_read_b64_tr_b16 a[110:111], v10 offset:20480
 v_xor_b32 v7, 65984, v6
 v_mfma_f32_16x16x32_bf16 v[236:239], a[76:79], a[204:207], v[236:239]
 ds_read_b64_tr_b16 a[64:65], v7 offset:0
 buffer_load_dword v13, v12, s[12:15], s58 offen sc1
 v_mfma_f32_16x16x32_bf16 v[236:239], a[80:83], a[212:215], v[236:239]
 ds_read_b64_tr_b16 a[66:67], v7 offset:4096
 v_accvgpr_write_b32 a43, v95
 v_mfma_f32_16x16x32_bf16 v[236:239], a[84:87], a[220:223], v[236:239]
 ds_read_b64_tr_b16 a[68:69], v7 offset:16384
 v_mul_f32 v116, s34, v116
 v_mfma_f32_16x16x32_bf16 v[236:239], a[88:91], a[116:119], v[236:239]
 ds_read_b64_tr_b16 a[70:71], v7 offset:20480
 v_xor_b32 v8, 131552, v6
 v_mfma_f32_16x16x32_bf16 v[236:239], a[92:95], a[124:127], v[236:239]
 s_waitcnt lgkmcnt(6)
 ds_read_b64_tr_b16 a[72:73], v8 offset:0
 v_mul_f32 v117, s34, v117
 v_mfma_f32_16x16x32_bf16 v[244:247], a[96:99], a[192:195], v[244:247]
 ds_read_b64_tr_b16 a[74:75], v8 offset:4096
 v_mul_f32 v118, s34, v118
 v_mfma_f32_16x16x32_bf16 v[244:247], a[100:103], a[200:203], v[244:247]
 ds_read_b64_tr_b16 a[76:77], v8 offset:16384
 v_mul_f32 v119, s34, v119
 v_mfma_f32_16x16x32_bf16 v[244:247], a[104:107], a[208:211], v[244:247]
 s_waitcnt lgkmcnt(3)
 ds_read_b64_tr_b16 a[78:79], v8 offset:20480
 v_xor_b32 v9, 480, v6
 v_mfma_f32_16x16x32_bf16 v[244:247], a[108:111], a[216:219], v[244:247]
 ds_read_b64_tr_b16 a[80:81], v9 offset:0
 v_mul_f32 v132, s34, v132
 v_mfma_f32_16x16x32_bf16 v[244:247], a[64:67], a[112:115], v[244:247]
 ds_read_b64_tr_b16 a[82:83], v9 offset:4096
 v_mul_f32 v133, s34, v133
 v_mfma_f32_16x16x32_bf16 v[244:247], a[68:71], a[120:123], v[244:247]
 ds_read_b64_tr_b16 a[84:85], v9 offset:16384
 v_mul_f32 v134, s34, v134
 v_mfma_f32_16x16x32_bf16 v[252:255], a[96:99], a[196:199], v[252:255]
 ds_read_b64_tr_b16 a[86:87], v9 offset:20480
 v_xor_b32 v10, 66016, v6
 v_mfma_f32_16x16x32_bf16 v[252:255], a[100:103], a[204:207], v[252:255]
 ds_read_b64_tr_b16 a[88:89], v10 offset:0
 v_mul_f32 v135, s34, v135
 v_mfma_f32_16x16x32_bf16 v[252:255], a[104:107], a[212:215], v[252:255]
 ds_read_b64_tr_b16 a[90:91], v10 offset:4096
 v_cvt_pk_bf16_f32 v116, v116, v117
 v_mfma_f32_16x16x32_bf16 v[252:255], a[108:111], a[220:223], v[252:255]
 ds_read_b64_tr_b16 a[92:93], v10 offset:16384
 v_cvt_pk_bf16_f32 v117, v118, v119
 v_mfma_f32_16x16x32_bf16 v[252:255], a[64:67], a[116:119], v[252:255]
 s_add_u32 s59, s62, 0
 ds_read_b64_tr_b16 a[94:95], v10 offset:20480
 v_cvt_pk_bf16_f32 v118, v132, v133
 v_mfma_f32_16x16x32_bf16 v[252:255], a[68:71], a[124:127], v[252:255]
 s_waitcnt lgkmcnt(6)
 v_cvt_pk_bf16_f32 v119, v134, v135
 v_accvgpr_write_b32 a12, v116
 v_mfma_f32_16x16x32_bf16 v[16:19], a[72:75], a[192:195], v[16:19]
 buffer_store_dwordx4 v[116:119], v1, s[12:15], s59 offen offset:3072 sc1
 v_mfma_f32_16x16x32_bf16 v[16:19], a[76:79], a[200:203], v[16:19]
 v_accvgpr_write_b32 a13, v117
 v_accvgpr_write_b32 a14, v118
 v_mfma_f32_16x16x32_bf16 v[16:19], a[80:83], a[208:211], v[16:19]
 s_waitcnt lgkmcnt(0)
 v_accvgpr_write_b32 a15, v119
 v_mfma_f32_16x16x32_bf16 v[16:19], a[84:87], a[216:219], v[16:19]
 v_mfma_f32_16x16x32_bf16 v[16:19], a[88:91], a[112:115], v[16:19]
 v_mfma_f32_16x16x32_bf16 v[16:19], a[92:95], a[120:123], v[16:19]
 v_mfma_f32_16x16x32_bf16 v[24:27], a[72:75], a[196:199], v[24:27]
 v_mfma_f32_16x16x32_bf16 v[24:27], a[76:79], a[204:207], v[24:27]
 v_mfma_f32_16x16x32_bf16 v[24:27], a[80:83], a[212:215], v[24:27]
 v_mfma_f32_16x16x32_bf16 v[24:27], a[84:87], a[220:223], v[24:27]
 s_waitcnt lgkmcnt(0)
 v_mfma_f32_16x16x32_bf16 v[24:27], a[88:91], a[116:119], v[24:27]
 s_barrier
 v_mfma_f32_16x16x32_bf16 v[24:27], a[92:95], a[124:127], v[24:27]
 s_waitcnt vmcnt(1)
 v_cmp_ne_u32 s[16:17], 0, v13
 v_cmp_gt_u32 vcc, 256, v5
 s_or_b64 vcc, vcc, s[16:17]
 s_mov_b32 m0, s40
 s_cselect_b32 s48, 0, 1
 s_cselect_b32 s52, 2.0, s42
 buffer_load_dwordx4 v1, s[12:15], s52 offen offset:0 sc1 lds
 v_pk_mul_f32 v[124:125], v[124:125], s[34:35]
 v_pk_mul_f32 v[126:127], v[126:127], s[34:35]
 v_pk_mul_f32 v[140:141], v[140:141], s[34:35]
 v_pk_mul_f32 v[142:143], v[142:143], s[34:35]
 v_cvt_pk_bf16_f32 v124, v124, v125
 v_cvt_pk_bf16_f32 v125, v126, v127
 v_cvt_pk_bf16_f32 v126, v140, v141
 v_cvt_pk_bf16_f32 v127, v142, v143
 s_add_u32 s59, s62, 8192
 buffer_store_dwordx4 v[124:127], v1, s[12:15], s59 offen offset:3072 sc1
 v_accvgpr_write_b32 a44, v124
 v_accvgpr_write_b32 a45, v125
 v_accvgpr_write_b32 a46, v126
 v_accvgpr_write_b32 a47, v127
 v_pk_mul_f32 v[148:149], v[148:149], s[34:35]
 v_pk_mul_f32 v[150:151], v[150:151], s[34:35]
 buffer_load_dwordx4 v1, s[12:15], s52 offen offset:1024 sc1 lds
 v_pk_mul_f32 v[164:165], v[164:165], s[34:35]
 v_pk_mul_f32 v[166:167], v[166:167], s[34:35]
 v_cvt_pk_bf16_f32 v148, v148, v149
 v_cvt_pk_bf16_f32 v149, v150, v151
 v_cvt_pk_bf16_f32 v150, v164, v165
 v_cvt_pk_bf16_f32 v151, v166, v167
 s_add_u32 s59, s62, 4096
 buffer_store_dwordx4 v[148:151], v1, s[12:15], s59 offen offset:0 sc1
 v_accvgpr_write_b32 a16, v148
 v_accvgpr_write_b32 a17, v149
 v_accvgpr_write_b32 a18, v150
 v_accvgpr_write_b32 a19, v151
 v_pk_mul_f32 v[156:157], v[156:157], s[34:35]
 v_pk_mul_f32 v[158:159], v[158:159], s[34:35]
 v_pk_mul_f32 v[172:173], v[172:173], s[34:35]
 v_pk_mul_f32 v[174:175], v[174:175], s[34:35]
 buffer_load_dwordx4 v1, s[12:15], s52 offen offset:2048 sc1 lds
 v_cvt_pk_bf16_f32 v156, v156, v157
 v_cvt_pk_bf16_f32 v157, v158, v159
 v_cvt_pk_bf16_f32 v158, v172, v173
 v_cvt_pk_bf16_f32 v159, v174, v175
 s_add_u32 s59, s62, 12288
 buffer_store_dwordx4 v[156:159], v1, s[12:15], s59 offen offset:0 sc1
 v_accvgpr_write_b32 a48, v156
 v_accvgpr_write_b32 a49, v157
 v_accvgpr_write_b32 a50, v158
 v_accvgpr_write_b32 a51, v159
 v_pk_mul_f32 v[180:181], v[180:181], s[34:35]
 v_pk_mul_f32 v[182:183], v[182:183], s[34:35]
 v_pk_mul_f32 v[196:197], v[196:197], s[34:35]
 v_pk_mul_f32 v[198:199], v[198:199], s[34:35]
 v_cvt_pk_bf16_f32 v180, v180, v181
 v_cvt_pk_bf16_f32 v181, v182, v183
 buffer_load_dwordx4 v1, s[12:15], s52 offen offset:3072 sc1 lds
 v_cvt_pk_bf16_f32 v182, v196, v197
 v_cvt_pk_bf16_f32 v183, v198, v199
 s_add_u32 s59, s62, 4096
 buffer_store_dwordx4 v[180:183], v1, s[12:15], s59 offen offset:1024 sc1
 v_accvgpr_write_b32 a20, v180
 v_accvgpr_write_b32 a21, v181
 v_accvgpr_write_b32 a22, v182
 v_accvgpr_write_b32 a23, v183
 v_pk_mul_f32 v[188:189], v[188:189], s[34:35]
 v_pk_mul_f32 v[190:191], v[190:191], s[34:35]
 v_pk_mul_f32 v[204:205], v[204:205], s[34:35]
 v_pk_mul_f32 v[206:207], v[206:207], s[34:35]
 v_cvt_pk_bf16_f32 v188, v188, v189
 v_cvt_pk_bf16_f32 v189, v190, v191
 v_cvt_pk_bf16_f32 v190, v204, v205
 s_bitset1_b32 m0, 12
 s_nop 0
 buffer_load_dwordx4 v4, s[12:15], s52 offen offset:0 sc1 lds
 v_cvt_pk_bf16_f32 v191, v206, v207
 s_add_u32 s59, s62, 12288
 buffer_store_dwordx4 v[188:191], v1, s[12:15], s59 offen offset:1024 sc1
 v_accvgpr_write_b32 a52, v188
 v_accvgpr_write_b32 a53, v189
 v_accvgpr_write_b32 a54, v190
 v_accvgpr_write_b32 a55, v191
 v_pk_mul_f32 v[212:213], v[212:213], s[34:35]
 v_pk_mul_f32 v[214:215], v[214:215], s[34:35]
 v_pk_mul_f32 v[228:229], v[228:229], s[34:35]
 v_pk_mul_f32 v[230:231], v[230:231], s[34:35]
 v_cvt_pk_bf16_f32 v212, v212, v213
 v_cvt_pk_bf16_f32 v213, v214, v215
 v_cvt_pk_bf16_f32 v214, v228, v229
 v_cvt_pk_bf16_f32 v215, v230, v231
 s_add_u32 s59, s62, 4096
 buffer_load_dwordx4 v4, s[12:15], s52 offen offset:1024 sc1 lds
 buffer_store_dwordx4 v[212:215], v1, s[12:15], s59 offen offset:2048 sc1
 v_accvgpr_write_b32 a24, v212
 v_accvgpr_write_b32 a25, v213
 v_accvgpr_write_b32 a26, v214
 v_accvgpr_write_b32 a27, v215
 v_pk_mul_f32 v[220:221], v[220:221], s[34:35]
 v_pk_mul_f32 v[222:223], v[222:223], s[34:35]
 v_pk_mul_f32 v[236:237], v[236:237], s[34:35]
 v_pk_mul_f32 v[238:239], v[238:239], s[34:35]
 v_cvt_pk_bf16_f32 v220, v220, v221
 v_cvt_pk_bf16_f32 v221, v222, v223
 v_cvt_pk_bf16_f32 v222, v236, v237
 v_cvt_pk_bf16_f32 v223, v238, v239
 s_add_u32 s59, s62, 12288
 buffer_store_dwordx4 v[220:223], v1, s[12:15], s59 offen offset:2048 sc1
 v_accvgpr_write_b32 a56, v220
 buffer_load_dwordx4 v4, s[12:15], s52 offen offset:2048 sc1 lds
 v_accvgpr_write_b32 a57, v221
 v_accvgpr_write_b32 a58, v222
 v_accvgpr_write_b32 a59, v223
 v_pk_mul_f32 v[244:245], v[244:245], s[34:35]
 v_pk_mul_f32 v[246:247], v[246:247], s[34:35]
 v_pk_mul_f32 v[16:17], v[16:17], s[34:35]
 v_pk_mul_f32 v[18:19], v[18:19], s[34:35]
 v_cvt_pk_bf16_f32 v244, v244, v245
 v_cvt_pk_bf16_f32 v245, v246, v247
 v_cvt_pk_bf16_f32 v246, v16, v17
 v_cvt_pk_bf16_f32 v247, v18, v19
 s_add_u32 s59, s62, 4096
 buffer_store_dwordx4 v[244:247], v1, s[12:15], s59 offen offset:3072 sc1
 v_accvgpr_write_b32 a28, v244
 v_accvgpr_write_b32 a29, v245
 v_accvgpr_write_b32 a30, v246
 buffer_load_dwordx4 v4, s[12:15], s52 offen offset:3072 sc1 lds
 v_accvgpr_write_b32 a31, v247
 v_pk_mul_f32 v[252:253], v[252:253], s[34:35]
 v_pk_mul_f32 v[254:255], v[254:255], s[34:35]
 v_pk_mul_f32 v[24:25], v[24:25], s[34:35]
 v_pk_mul_f32 v[26:27], v[26:27], s[34:35]
 v_cvt_pk_bf16_f32 v252, v252, v253
 v_cvt_pk_bf16_f32 v253, v254, v255
 v_cvt_pk_bf16_f32 v254, v24, v25
 v_cvt_pk_bf16_f32 v255, v26, v27
 s_add_u32 s59, s62, 12288
 buffer_store_dwordx4 v[252:255], v1, s[12:15], s59 offen offset:3072 sc1
 v_accvgpr_write_b32 a60, v252
 v_accvgpr_write_b32 a61, v253
 v_accvgpr_write_b32 a62, v254
 v_accvgpr_write_b32 a63, v255
 s_branch L_kvdone
L_late1:
 v_mfma_f32_16x16x32_bf16 v[16:19], a[96:99], a[0:3], v[16:19]
 ds_read_b64_tr_b16 a[24:25], v9 offset:32768
 v_mfma_f32_16x16x32_bf16 v[16:19], a[100:103], a[4:7], v[16:19]
 s_add_u32 m0, s33, 0xfffffd00
 ds_read_b64_tr_b16 a[26:27], v9 offset:36864
 v_mfma_f32_16x16x32_bf16 v[20:23], a[108:111], a[4:7], v[20:23]
 s_waitcnt lgkmcnt(13)
 ds_read_b64_tr_b16 a[28:29], v9 offset:49152
 v_mfma_f32_16x16x32_bf16 v[20:23], a[104:107], a[0:3], v[20:23]
 ds_read_b64_tr_b16 a[30:31], v9 offset:53248
 buffer_load_dwordx4 v15, s[20:23], 0 offen offset:768 lds
 v_mfma_f32_16x16x32_bf16 v[24:27], a[112:115], a[0:3], v[24:27]
 s_waitcnt lgkmcnt(12)
 ds_read_b128 a[64:67], v4 offset:32768
 v_mfma_f32_16x16x32_bf16 v[24:27], a[116:119], a[4:7], v[24:27]
 v_mfma_f32_16x16x32_bf16 v[28:31], a[124:127], a[4:7], v[28:31]
 s_add_u32 m0, s33, 0xfffffd80
 ds_read_b128 a[68:71], v5 offset:32768
 v_mfma_f32_16x16x32_bf16 v[28:31], a[120:123], a[0:3], v[28:31]
 s_waitcnt lgkmcnt(10)
 buffer_load_dwordx4 v15, s[20:23], 0 offen offset:1664 lds
 v_mfma_f32_16x16x32_bf16 a[228:231], a[120:123], a[8:11], a[228:231]
 ds_read_b128 a[76:79], v5 offset:34816
 v_mfma_f32_16x16x32_bf16 a[228:231], a[124:127], a[12:15], a[228:231]
 v_mfma_f32_16x16x32_bf16 a[224:227], a[116:119], a[12:15], a[224:227]
 s_add_u32 m0, s33, 0x500
 ds_read_b128 a[72:75], v4 offset:34816
 v_mfma_f32_16x16x32_bf16 a[224:227], a[112:115], a[8:11], a[224:227]
 buffer_load_dwordx4 v15, s[20:23], s57 offen offset:768 lds
 v_mfma_f32_16x16x32_bf16 a[236:239], a[104:107], a[8:11], a[236:239]
 ds_read_b128 a[80:83], v4 offset:36864
 v_cvt_pk_bf16_f32 v16, v16, v17
 v_mfma_f32_16x16x32_bf16 a[236:239], a[108:111], a[12:15], a[236:239]
 v_cvt_pk_bf16_f32 v17, v18, v19
 v_cvt_pk_bf16_f32 v18, v20, v21
 v_mfma_f32_16x16x32_bf16 a[232:235], a[100:103], a[12:15], a[232:235]
 s_add_u32 m0, s33, 0x580
 ds_read_b128 a[84:87], v5 offset:36864
 v_cvt_pk_bf16_f32 v19, v22, v23
 v_mfma_f32_16x16x32_bf16 a[232:235], a[96:99], a[8:11], a[232:235]
 s_waitcnt lgkmcnt(10)
 buffer_load_dwordx4 v15, s[20:23], s57 offen offset:1664 lds
 v_mfma_f32_16x16x32_bf16 v[32:35], a[96:99], a[16:19], v[32:35]
 ds_read_b128 a[92:95], v5 offset:38912
 v_cvt_pk_bf16_f32 v24, v24, v25
 v_mfma_f32_16x16x32_bf16 v[32:35], a[100:103], a[20:23], v[32:35]
 v_cvt_pk_bf16_f32 v25, v26, v27
 v_cvt_pk_bf16_f32 v26, v28, v29
 v_mfma_f32_16x16x32_bf16 v[36:39], a[108:111], a[20:23], v[36:39]
 ds_read_b128 a[88:91], v4 offset:38912
 v_cvt_pk_bf16_f32 v27, v30, v31
 v_mfma_f32_16x16x32_bf16 v[36:39], a[104:107], a[16:19], v[36:39]
 v_accvgpr_read_b32 v20, a224
 v_accvgpr_read_b32 v21, a225
 v_mfma_f32_16x16x32_bf16 v[40:43], a[112:115], a[16:19], v[40:43]
 ds_read_b64_tr_b16 a[32:33], v10 offset:32768
 v_accvgpr_read_b32 v22, a226
 v_mfma_f32_16x16x32_bf16 v[40:43], a[116:119], a[20:23], v[40:43]
 ds_read_b64_tr_b16 a[34:35], v10 offset:36864
 v_accvgpr_read_b32 v23, a227
 v_mfma_f32_16x16x32_bf16 v[44:47], a[124:127], a[20:23], v[44:47]
 s_add_u32 s59, s56, 32768
 ds_read_b64_tr_b16 a[36:37], v10 offset:49152
 v_accvgpr_read_b32 v28, a228
 v_mfma_f32_16x16x32_bf16 v[44:47], a[120:123], a[16:19], v[44:47]
 s_waitcnt lgkmcnt(11)
 ds_read_b64_tr_b16 a[38:39], v10 offset:53248
 v_accvgpr_read_b32 v29, a229
 v_mfma_f32_16x16x32_bf16 v[52:55], a[120:123], a[24:27], v[52:55]
 ds_read_b64_tr_b16 a[40:41], v11 offset:32768
 buffer_store_dwordx4 v[16:19], v1, s[12:15], s59 offen offset:0 sc1
 v_mfma_f32_16x16x32_bf16 v[52:55], a[124:127], a[28:31], v[52:55]
 ds_read_b64_tr_b16 a[42:43], v11 offset:36864
 v_accvgpr_read_b32 v30, a230
 v_mfma_f32_16x16x32_bf16 v[48:51], a[116:119], a[28:31], v[48:51]
 ds_read_b64_tr_b16 a[44:45], v11 offset:49152
 v_accvgpr_read_b32 v31, a231
 v_mfma_f32_16x16x32_bf16 v[48:51], a[112:115], a[24:27], v[48:51]
 ds_read_b64_tr_b16 a[46:47], v11 offset:53248
 v_cvt_pk_bf16_f32 v20, v20, v21
 v_mfma_f32_16x16x32_bf16 v[60:63], a[104:107], a[24:27], v[60:63]
 ds_read_b64_tr_b16 a[48:49], v12 offset:32768
 v_cvt_pk_bf16_f32 v21, v22, v23
 v_mfma_f32_16x16x32_bf16 v[60:63], a[108:111], a[28:31], v[60:63]
 ds_read_b64_tr_b16 a[50:51], v12 offset:36864
 v_cvt_pk_bf16_f32 v22, v28, v29
 v_mfma_f32_16x16x32_bf16 v[56:59], a[100:103], a[28:31], v[56:59]
 s_add_u32 s59, s56, 49152
 ds_read_b64_tr_b16 a[52:53], v12 offset:49152
 v_cvt_pk_bf16_f32 v23, v30, v31
 v_mfma_f32_16x16x32_bf16 v[56:59], a[96:99], a[24:27], v[56:59]
 s_waitcnt lgkmcnt(15)
 ds_read_b64_tr_b16 a[54:55], v12 offset:53248
 buffer_store_dwordx4 v[24:27], v1, s[12:15], s59 offen offset:0 sc1
 v_mfma_f32_16x16x32_bf16 v[64:67], a[64:67], a[0:3], v[64:67]
 ds_read_b64_tr_b16 a[56:57], v13 offset:32768
 v_cvt_pk_bf16_f32 v32, v32, v33
 v_mfma_f32_16x16x32_bf16 v[64:67], a[68:71], a[4:7], v[64:67]
 ds_read_b64_tr_b16 a[58:59], v13 offset:36864
 v_cvt_pk_bf16_f32 v33, v34, v35
 v_mfma_f32_16x16x32_bf16 v[68:71], a[76:79], a[4:7], v[68:71]
 ds_read_b64_tr_b16 a[60:61], v13 offset:49152
 v_cvt_pk_bf16_f32 v34, v36, v37
 v_mfma_f32_16x16x32_bf16 v[68:71], a[72:75], a[0:3], v[68:71]
 s_waitcnt lgkmcnt(15)
 ds_read_b64_tr_b16 a[62:63], v13 offset:53248
 v_cvt_pk_bf16_f32 v35, v38, v39
 v_mfma_f32_16x16x32_bf16 v[72:75], a[80:83], a[0:3], v[72:75]
 v_cvt_pk_bf16_f32 v40, v40, v41
 v_cvt_pk_bf16_f32 v41, v42, v43
 v_mfma_f32_16x16x32_bf16 v[72:75], a[84:87], a[4:7], v[72:75]
 s_add_u32 s59, s56, 49152
 v_cvt_pk_bf16_f32 v42, v44, v45
 v_cvt_pk_bf16_f32 v43, v46, v47
 v_mfma_f32_16x16x32_bf16 v[76:79], a[92:95], a[4:7], v[76:79]
 buffer_store_dwordx4 v[20:23], v1, s[12:15], s59 offen offset:1024 sc1
 v_mfma_f32_16x16x32_bf16 v[76:79], a[88:91], a[0:3], v[76:79]
 s_waitcnt lgkmcnt(0)
 v_accvgpr_read_b32 v36, a232
 v_accvgpr_read_b32 v37, a233
 v_mfma_f32_16x16x32_bf16 v[84:87], a[88:91], a[8:11], v[84:87]
 s_barrier
 v_xor_b32 v6, s60, v6
 v_accvgpr_read_b32 v38, a234
 v_mfma_f32_16x16x32_bf16 v[84:87], a[92:95], a[12:15], v[84:87]
 s_add_u32 m0, s29, 32768
 v_add_u32 v2, 0x80000, v2
 v_accvgpr_read_b32 v39, a235
 v_mfma_f32_16x16x32_bf16 v[80:83], a[84:87], a[12:15], v[80:83]
 buffer_load_dwordx4 v2, s[16:19], 0 offen lds
 v_mfma_f32_16x16x32_bf16 v[80:83], a[80:83], a[8:11], v[80:83]
 v_accvgpr_read_b32 v44, a236
 v_accvgpr_read_b32 v45, a237
 v_mfma_f32_16x16x32_bf16 v[92:95], a[72:75], a[8:11], v[92:95]
 v_accvgpr_read_b32 v46, a238
 v_accvgpr_read_b32 v47, a239
 v_mfma_f32_16x16x32_bf16 v[92:95], a[76:79], a[12:15], v[92:95]
 v_cvt_pk_bf16_f32 v36, v36, v37
 v_cvt_pk_bf16_f32 v37, v38, v39
 v_mfma_f32_16x16x32_bf16 v[88:91], a[68:71], a[12:15], v[88:91]
 s_add_u32 m0, s29, 36864
 v_cvt_pk_bf16_f32 v38, v44, v45
 v_cvt_pk_bf16_f32 v39, v46, v47
 v_mfma_f32_16x16x32_bf16 v[88:91], a[64:67], a[8:11], v[88:91]
 buffer_load_dwordx4 v2, s[16:19], s48 offen lds
 v_mfma_f32_16x16x32_bf16 v[96:99], a[64:67], a[16:19], v[96:99]
 v_cvt_pk_bf16_f32 v48, v48, v49
 v_cvt_pk_bf16_f32 v49, v50, v51
 v_mfma_f32_16x16x32_bf16 v[96:99], a[68:71], a[20:23], v[96:99]
 v_cvt_pk_bf16_f32 v50, v52, v53
 v_cvt_pk_bf16_f32 v51, v54, v55
 v_mfma_f32_16x16x32_bf16 v[100:103], a[76:79], a[20:23], v[100:103]
 v_cvt_pk_bf16_f32 v56, v56, v57
 v_cvt_pk_bf16_f32 v57, v58, v59
 v_mfma_f32_16x16x32_bf16 v[100:103], a[72:75], a[16:19], v[100:103]
 s_add_u32 m0, s29, 40960
 v_cvt_pk_bf16_f32 v58, v60, v61
 v_cvt_pk_bf16_f32 v59, v62, v63
 v_mfma_f32_16x16x32_bf16 v[104:107], a[80:83], a[16:19], v[104:107]
 buffer_load_dwordx4 v2, s[16:19], s49 offen lds
 v_mfma_f32_16x16x32_bf16 v[104:107], a[84:87], a[20:23], v[104:107]
 v_cvt_pk_bf16_f32 v64, v64, v65
 v_cvt_pk_bf16_f32 v65, v66, v67
 v_mfma_f32_16x16x32_bf16 v[108:111], a[92:95], a[20:23], v[108:111]
 v_cvt_pk_bf16_f32 v66, v68, v69
 v_cvt_pk_bf16_f32 v67, v70, v71
 v_mfma_f32_16x16x32_bf16 v[108:111], a[88:91], a[16:19], v[108:111]
 v_cvt_pk_bf16_f32 v72, v72, v73
 v_cvt_pk_bf16_f32 v73, v74, v75
 v_mfma_f32_16x16x32_bf16 v[116:119], a[88:91], a[24:27], v[116:119]
 s_add_u32 m0, s29, 45056
 v_cvt_pk_bf16_f32 v74, v76, v77
 v_cvt_pk_bf16_f32 v75, v78, v79
 v_mfma_f32_16x16x32_bf16 v[116:119], a[92:95], a[28:31], v[116:119]
 buffer_load_dwordx4 v2, s[16:19], s50 offen lds
 v_mfma_f32_16x16x32_bf16 v[112:115], a[84:87], a[28:31], v[112:115]
 s_add_u32 s59, s56, 32768
 v_cvt_pk_bf16_f32 v80, v80, v81
 v_cvt_pk_bf16_f32 v81, v82, v83
 v_mfma_f32_16x16x32_bf16 v[112:115], a[80:83], a[24:27], v[112:115]
 buffer_store_dwordx4 v[36:39], v1, s[12:15], s59 offen offset:1024 sc1
 v_mfma_f32_16x16x32_bf16 v[124:127], a[72:75], a[24:27], v[124:127]
 v_cvt_pk_bf16_f32 v82, v84, v85
 v_cvt_pk_bf16_f32 v83, v86, v87
 v_mfma_f32_16x16x32_bf16 v[124:127], a[76:79], a[28:31], v[124:127]
 s_add_u32 m0, s29, 49152
 v_cvt_pk_bf16_f32 v88, v88, v89
 v_cvt_pk_bf16_f32 v89, v90, v91
 v_mfma_f32_16x16x32_bf16 v[120:123], a[68:71], a[28:31], v[120:123]
 buffer_load_dwordx4 v2, s[16:19], s51 offen lds
 v_mfma_f32_16x16x32_bf16 v[120:123], a[64:67], a[24:27], v[120:123]
 v_cvt_pk_bf16_f32 v90, v92, v93
 v_cvt_pk_bf16_f32 v91, v94, v95
 v_mfma_f32_16x16x32_bf16 v[128:131], a[64:67], a[32:35], v[128:131]
 v_cvt_pk_bf16_f32 v96, v96, v97
 v_cvt_pk_bf16_f32 v97, v98, v99
 v_mfma_f32_16x16x32_bf16 v[128:131], a[68:71], a[36:39], v[128:131]
 v_cvt_pk_bf16_f32 v98, v100, v101
 v_cvt_pk_bf16_f32 v99, v102, v103
 v_mfma_f32_16x16x32_bf16 v[132:135], a[76:79], a[36:39], v[132:135]
 s_add_u32 m0, s29, 53248
 v_cvt_pk_bf16_f32 v104, v104, v105
 v_cvt_pk_bf16_f32 v105, v106, v107
 v_mfma_f32_16x16x32_bf16 v[132:135], a[72:75], a[32:35], v[132:135]
 buffer_load_dwordx4 v2, s[16:19], s52 offen lds
 v_mfma_f32_16x16x32_bf16 v[136:139], a[80:83], a[32:35], v[136:139]
 v_cvt_pk_bf16_f32 v106, v108, v109
 v_cvt_pk_bf16_f32 v107, v110, v111
 v_mfma_f32_16x16x32_bf16 v[136:139], a[84:87], a[36:39], v[136:139]
 v_cvt_pk_bf16_f32 v112, v112, v113
 v_cvt_pk_bf16_f32 v113, v114, v115
 v_mfma_f32_16x16x32_bf16 v[140:143], a[92:95], a[36:39], v[140:143]
 v_cvt_pk_bf16_f32 v114, v116, v117
 v_cvt_pk_bf16_f32 v115, v118, v119
 v_mfma_f32_16x16x32_bf16 v[140:143], a[88:91], a[32:35], v[140:143]
 s_add_u32 m0, s29, 57344
 v_cvt_pk_bf16_f32 v120, v120, v121
 v_cvt_pk_bf16_f32 v121, v122, v123
 v_mfma_f32_16x16x32_bf16 v[148:151], a[88:91], a[40:43], v[148:151]
 buffer_load_dwordx4 v2, s[16:19], s53 offen lds
 v_mfma_f32_16x16x32_bf16 v[148:151], a[92:95], a[44:47], v[148:151]
 v_cvt_pk_bf16_f32 v122, v124, v125
 v_cvt_pk_bf16_f32 v123, v126, v127
 v_mfma_f32_16x16x32_bf16 v[144:147], a[84:87], a[44:47], v[144:147]
 v_mfma_f32_16x16x32_bf16 v[144:147], a[80:83], a[40:43], v[144:147]
 v_cvt_pk_bf16_f32 v128, v128, v129
 v_cvt_pk_bf16_f32 v129, v130, v131
 v_mfma_f32_16x16x32_bf16 v[156:159], a[72:75], a[40:43], v[156:159]
 s_add_u32 m0, s29, 61440
 v_cvt_pk_bf16_f32 v130, v132, v133
 v_cvt_pk_bf16_f32 v131, v134, v135
 v_mfma_f32_16x16x32_bf16 v[156:159], a[76:79], a[44:47], v[156:159]
 buffer_load_dwordx4 v2, s[16:19], s54 offen lds
 v_mfma_f32_16x16x32_bf16 v[152:155], a[68:71], a[44:47], v[152:155]
 v_mfma_f32_16x16x32_bf16 v[152:155], a[64:67], a[40:43], v[152:155]
 v_cvt_pk_bf16_f32 v136, v136, v137
 v_cvt_pk_bf16_f32 v137, v138, v139
 v_mfma_f32_16x16x32_bf16 v[160:163], a[64:67], a[48:51], v[160:163]
 s_add_u32 m0, s29, 98304
 v_add_u32 v2, 0x80000, v2
 v_cvt_pk_bf16_f32 v138, v140, v141
 v_mfma_f32_16x16x32_bf16 v[160:163], a[68:71], a[52:55], v[160:163]
 buffer_load_dwordx4 v2, s[16:19], 0 offen lds
 v_mfma_f32_16x16x32_bf16 v[164:167], a[76:79], a[52:55], v[164:167]
 v_cvt_pk_bf16_f32 v139, v142, v143
 v_mfma_f32_16x16x32_bf16 v[164:167], a[72:75], a[48:51], v[164:167]
 v_cvt_pk_bf16_f32 v144, v144, v145
 v_cvt_pk_bf16_f32 v145, v146, v147
 v_mfma_f32_16x16x32_bf16 v[168:171], a[80:83], a[48:51], v[168:171]
 v_cvt_pk_bf16_f32 v146, v148, v149
 v_cvt_pk_bf16_f32 v147, v150, v151
 v_mfma_f32_16x16x32_bf16 v[168:171], a[84:87], a[52:55], v[168:171]
 s_add_u32 m0, s29, 102400
 v_mfma_f32_16x16x32_bf16 v[172:175], a[92:95], a[52:55], v[172:175]
 buffer_load_dwordx4 v2, s[16:19], s48 offen lds
 v_mfma_f32_16x16x32_bf16 v[172:175], a[88:91], a[48:51], v[172:175]
 v_cvt_pk_bf16_f32 v152, v152, v153
 v_cvt_pk_bf16_f32 v153, v154, v155
 v_mfma_f32_16x16x32_bf16 v[180:183], a[88:91], a[56:59], v[180:183]
 v_cvt_pk_bf16_f32 v154, v156, v157
 v_cvt_pk_bf16_f32 v155, v158, v159
 v_mfma_f32_16x16x32_bf16 v[180:183], a[92:95], a[60:63], v[180:183]
 v_mfma_f32_16x16x32_bf16 v[176:179], a[84:87], a[60:63], v[176:179]
 s_add_u32 m0, s29, 106496
 v_mfma_f32_16x16x32_bf16 v[176:179], a[80:83], a[56:59], v[176:179]
 buffer_load_dwordx4 v2, s[16:19], s49 offen lds
 v_mfma_f32_16x16x32_bf16 v[188:191], a[72:75], a[56:59], v[188:191]
 v_cvt_pk_bf16_f32 v160, v160, v161
 v_cvt_pk_bf16_f32 v161, v162, v163
 v_mfma_f32_16x16x32_bf16 v[188:191], a[76:79], a[60:63], v[188:191]
 v_cvt_pk_bf16_f32 v162, v164, v165
 v_cvt_pk_bf16_f32 v163, v166, v167
 v_mfma_f32_16x16x32_bf16 v[184:187], a[68:71], a[60:63], v[184:187]
 v_mfma_f32_16x16x32_bf16 v[184:187], a[64:67], a[56:59], v[184:187]
 s_add_u32 m0, s29, 110592
 v_cvt_pk_bf16_f32 v168, v168, v169
 v_cvt_pk_bf16_f32 v169, v170, v171
 v_mfma_f32_16x16x32_bf16 v[192:195], a[96:99], a[32:35], v[192:195]
 buffer_load_dwordx4 v2, s[16:19], s50 offen lds
 v_mfma_f32_16x16x32_bf16 v[192:195], a[100:103], a[36:39], v[192:195]
 v_cvt_pk_bf16_f32 v170, v172, v173
 v_cvt_pk_bf16_f32 v171, v174, v175
 v_mfma_f32_16x16x32_bf16 v[196:199], a[108:111], a[36:39], v[196:199]
 v_mfma_f32_16x16x32_bf16 v[196:199], a[104:107], a[32:35], v[196:199]
 v_cvt_pk_bf16_f32 v176, v176, v177
 v_cvt_pk_bf16_f32 v177, v178, v179
 v_mfma_f32_16x16x32_bf16 v[200:203], a[112:115], a[32:35], v[200:203]
 s_add_u32 m0, s29, 114688
 v_cvt_pk_bf16_f32 v178, v180, v181
 v_cvt_pk_bf16_f32 v179, v182, v183
 v_mfma_f32_16x16x32_bf16 v[200:203], a[116:119], a[36:39], v[200:203]
 buffer_load_dwordx4 v2, s[16:19], s51 offen lds
 v_mfma_f32_16x16x32_bf16 v[204:207], a[124:127], a[36:39], v[204:207]
 v_mfma_f32_16x16x32_bf16 v[204:207], a[120:123], a[32:35], v[204:207]
 v_cvt_pk_bf16_f32 v184, v184, v185
 v_cvt_pk_bf16_f32 v185, v186, v187
 v_mfma_f32_16x16x32_bf16 v[212:215], a[120:123], a[40:43], v[212:215]
 v_cvt_pk_bf16_f32 v186, v188, v189
 v_cvt_pk_bf16_f32 v187, v190, v191
 v_mfma_f32_16x16x32_bf16 v[212:215], a[124:127], a[44:47], v[212:215]
 s_add_u32 m0, s29, 118784
 v_mfma_f32_16x16x32_bf16 v[208:211], a[116:119], a[44:47], v[208:211]
 buffer_load_dwordx4 v2, s[16:19], s52 offen lds
 v_mfma_f32_16x16x32_bf16 v[208:211], a[112:115], a[40:43], v[208:211]
 v_cvt_pk_bf16_f32 v192, v192, v193
 v_cvt_pk_bf16_f32 v193, v194, v195
 v_mfma_f32_16x16x32_bf16 v[220:223], a[104:107], a[40:43], v[220:223]
 v_cvt_pk_bf16_f32 v194, v196, v197
 v_cvt_pk_bf16_f32 v195, v198, v199
 v_mfma_f32_16x16x32_bf16 v[220:223], a[108:111], a[44:47], v[220:223]
 v_mfma_f32_16x16x32_bf16 v[216:219], a[100:103], a[44:47], v[216:219]
 s_add_u32 m0, s29, 122880
 v_mfma_f32_16x16x32_bf16 v[216:219], a[96:99], a[40:43], v[216:219]
 buffer_load_dwordx4 v2, s[16:19], s53 offen lds
 v_mfma_f32_16x16x32_bf16 v[224:227], a[96:99], a[48:51], v[224:227]
 v_cvt_pk_bf16_f32 v200, v200, v201
 v_cvt_pk_bf16_f32 v201, v202, v203
 v_mfma_f32_16x16x32_bf16 v[224:227], a[100:103], a[52:55], v[224:227]
 s_waitcnt vmcnt(19)
 v_cvt_pk_bf16_f32 v202, v204, v205
 v_cvt_pk_bf16_f32 v203, v206, v207
 v_mfma_f32_16x16x32_bf16 v[228:231], a[108:111], a[52:55], v[228:231]
 s_barrier
 v_xor_b32 v7, 0, v6
 v_mfma_f32_16x16x32_bf16 v[228:231], a[104:107], a[48:51], v[228:231]
 s_add_u32 m0, s29, 126976
 ds_read_b64_tr_b16 a[64:65], v7 offset:0
 v_cvt_pk_bf16_f32 v208, v208, v209
 v_mfma_f32_16x16x32_bf16 v[232:235], a[112:115], a[48:51], v[232:235]
 ds_read_b64_tr_b16 a[66:67], v7 offset:4096
 buffer_load_dwordx4 v2, s[16:19], s54 offen lds
 v_mfma_f32_16x16x32_bf16 v[232:235], a[116:119], a[52:55], v[232:235]
 ds_read_b64_tr_b16 a[68:69], v7 offset:16384
 v_cvt_pk_bf16_f32 v209, v210, v211
 v_mfma_f32_16x16x32_bf16 v[236:239], a[124:127], a[52:55], v[236:239]
 ds_read_b64_tr_b16 a[70:71], v7 offset:20480
 v_xor_b32 v8, 65536, v6
 v_mfma_f32_16x16x32_bf16 v[236:239], a[120:123], a[48:51], v[236:239]
 ds_read_b64_tr_b16 a[72:73], v8 offset:0
 v_cvt_pk_bf16_f32 v210, v212, v213
 v_mfma_f32_16x16x32_bf16 v[244:247], a[120:123], a[56:59], v[244:247]
 ds_read_b64_tr_b16 a[74:75], v8 offset:4096
 v_cvt_pk_bf16_f32 v211, v214, v215
 v_mfma_f32_16x16x32_bf16 v[244:247], a[124:127], a[60:63], v[244:247]
 ds_read_b64_tr_b16 a[76:77], v8 offset:16384
 v_cvt_pk_bf16_f32 v216, v216, v217
 v_mfma_f32_16x16x32_bf16 v[240:243], a[116:119], a[60:63], v[240:243]
 ds_read_b64_tr_b16 a[78:79], v8 offset:20480
 v_xor_b32 v9, 32, v6
 v_mfma_f32_16x16x32_bf16 v[240:243], a[112:115], a[56:59], v[240:243]
 ds_read_b64_tr_b16 a[80:81], v9 offset:0
 v_cvt_pk_bf16_f32 v217, v218, v219
 v_mfma_f32_16x16x32_bf16 v[252:255], a[104:107], a[56:59], v[252:255]
 ds_read_b64_tr_b16 a[82:83], v9 offset:4096
 v_cvt_pk_bf16_f32 v218, v220, v221
 v_mfma_f32_16x16x32_bf16 v[252:255], a[108:111], a[60:63], v[252:255]
 ds_read_b64_tr_b16 a[84:85], v9 offset:16384
 v_cvt_pk_bf16_f32 v219, v222, v223
 v_mfma_f32_16x16x32_bf16 v[248:251], a[100:103], a[60:63], v[248:251]
 ds_read_b64_tr_b16 a[86:87], v9 offset:20480
 v_xor_b32 v10, 65568, v6
 v_mfma_f32_16x16x32_bf16 v[248:251], a[96:99], a[56:59], v[248:251]
 s_waitcnt lgkmcnt(6)
 ds_read_b64_tr_b16 a[88:89], v10 offset:0
 v_cvt_pk_bf16_f32 v224, v224, v225
 v_mfma_f32_16x16x32_bf16 v[28:31], a[64:67], a[128:131], 0
 ds_read_b64_tr_b16 a[90:91], v10 offset:4096
 v_cvt_pk_bf16_f32 v225, v226, v227
 v_mfma_f32_16x16x32_bf16 v[28:31], a[68:71], a[136:139], v[28:31]
 ds_read_b64_tr_b16 a[92:93], v10 offset:16384
 v_xor_b32 v7, 64, v6
 v_mfma_f32_16x16x32_bf16 v[28:31], a[72:75], a[144:147], v[28:31]
 s_waitcnt lgkmcnt(7)
 ds_read_b128 a[112:115], v14 offset:0
 ds_read_b64_tr_b16 a[94:95], v10 offset:20480
 v_mfma_f32_16x16x32_bf16 v[28:31], a[76:79], a[152:155], v[28:31]
 ds_read_b64_tr_b16 a[96:97], v7 offset:0
 v_cvt_pk_bf16_f32 v226, v228, v229
 v_mfma_f32_16x16x32_bf16 v[44:47], a[64:67], a[132:135], 0
 ds_read_b128 a[120:123], v3 offset:0
 ds_read_b64_tr_b16 a[98:99], v7 offset:4096
 v_mfma_f32_16x16x32_bf16 v[44:47], a[68:71], a[140:143], v[44:47]
 ds_read_b64_tr_b16 a[100:101], v7 offset:16384
 v_xor_b32 v8, 65600, v6
 v_mfma_f32_16x16x32_bf16 v[44:47], a[72:75], a[148:151], v[44:47]
 ds_read_b128 a[116:119], v14 offset:2048
 ds_read_b64_tr_b16 a[102:103], v7 offset:20480
 v_mfma_f32_16x16x32_bf16 v[44:47], a[76:79], a[156:159], v[44:47]
 s_waitcnt lgkmcnt(9)
 ds_read_b64_tr_b16 a[104:105], v8 offset:0
 v_cvt_pk_bf16_f32 v227, v230, v231
 v_mfma_f32_16x16x32_bf16 v[52:55], a[80:83], a[128:131], 0
 ds_read_b128 a[124:127], v3 offset:2048
 ds_read_b64_tr_b16 a[106:107], v8 offset:4096
 v_mfma_f32_16x16x32_bf16 v[52:55], a[84:87], a[136:139], v[52:55]
 ds_read_b64_tr_b16 a[108:109], v8 offset:16384
 v_cvt_pk_bf16_f32 v232, v232, v233
 v_mfma_f32_16x16x32_bf16 v[52:55], a[88:91], a[144:147], v[52:55]
 s_waitcnt lgkmcnt(10)
 ds_read_b64_tr_b16 a[110:111], v8 offset:20480
 v_xor_b32 v9, 96, v6
 v_mfma_f32_16x16x32_bf16 v[52:55], a[92:95], a[152:155], v[52:55]
 ds_read_b64_tr_b16 a[64:65], v9 offset:0
 v_cvt_pk_bf16_f32 v233, v234, v235
 v_mfma_f32_16x16x32_bf16 v[60:63], a[80:83], a[132:135], 0
 ds_read_b64_tr_b16 a[66:67], v9 offset:4096
 v_cvt_pk_bf16_f32 v234, v236, v237
 v_mfma_f32_16x16x32_bf16 v[60:63], a[84:87], a[140:143], v[60:63]
 ds_read_b64_tr_b16 a[68:69], v9 offset:16384
 v_cvt_pk_bf16_f32 v235, v238, v239
 v_mfma_f32_16x16x32_bf16 v[60:63], a[88:91], a[148:151], v[60:63]
 ds_read_b64_tr_b16 a[70:71], v9 offset:20480
 v_xor_b32 v10, 65632, v6
 v_mfma_f32_16x16x32_bf16 v[60:63], a[92:95], a[156:159], v[60:63]
 s_waitcnt lgkmcnt(6)
 ds_read_b64_tr_b16 a[72:73], v10 offset:0
 v_cvt_pk_bf16_f32 v240, v240, v241
 v_mfma_f32_16x16x32_bf16 v[20:23], a[96:99], a[128:131], 0
 ds_read_b64_tr_b16 a[74:75], v10 offset:4096
 v_cvt_pk_bf16_f32 v241, v242, v243
 v_mfma_f32_16x16x32_bf16 v[20:23], a[100:103], a[136:139], v[20:23]
 s_waitcnt lgkmcnt(8)
 ds_read_b64_tr_b16 a[76:77], v10 offset:16384
 v_xor_b32 v7, 128, v6
 v_mfma_f32_16x16x32_bf16 v[20:23], a[104:107], a[144:147], v[20:23]
 s_waitcnt lgkmcnt(7)
 s_barrier
 ds_read_b64_tr_b16 a[78:79], v10 offset:20480
 v_mfma_f32_16x16x32_bf16 v[20:23], a[108:111], a[152:155], v[20:23]
 s_add_u32 m0, s29, 131072
 ds_read_b64_tr_b16 a[80:81], v7 offset:0
 v_add_u32 v2, 0x80000, v2
 v_mfma_f32_16x16x32_bf16 v[36:39], a[96:99], a[132:135], 0
 ds_read_b64_tr_b16 a[82:83], v7 offset:4096
 buffer_load_dwordx4 v2, s[16:19], 0 offen lds
 v_mfma_f32_16x16x32_bf16 v[36:39], a[100:103], a[140:143], v[36:39]
 ds_read_b64_tr_b16 a[84:85], v7 offset:16384
 v_cvt_pk_bf16_f32 v242, v244, v245
 v_mfma_f32_16x16x32_bf16 v[36:39], a[104:107], a[148:151], v[36:39]
 ds_read_b64_tr_b16 a[86:87], v7 offset:20480
 v_xor_b32 v8, 65664, v6
 v_mfma_f32_16x16x32_bf16 v[36:39], a[108:111], a[156:159], v[36:39]
 s_waitcnt lgkmcnt(6)
 ds_read_b64_tr_b16 a[88:89], v8 offset:0
 v_cvt_pk_bf16_f32 v243, v246, v247
 v_mfma_f32_16x16x32_bf16 v[68:71], a[64:67], a[128:131], 0
 ds_read_b64_tr_b16 a[90:91], v8 offset:4096
 v_cvt_pk_bf16_f32 v248, v248, v249
 v_mfma_f32_16x16x32_bf16 v[68:71], a[68:71], a[136:139], v[68:71]
 s_add_u32 m0, s29, 135168
 ds_read_b64_tr_b16 a[92:93], v8 offset:16384
 v_cvt_pk_bf16_f32 v249, v250, v251
 v_mfma_f32_16x16x32_bf16 v[68:71], a[72:75], a[144:147], v[68:71]
 s_waitcnt lgkmcnt(7)
 ds_read_b64_tr_b16 a[94:95], v8 offset:20480
 v_xor_b32 v9, 160, v6
 v_mfma_f32_16x16x32_bf16 v[68:71], a[76:79], a[152:155], v[68:71]
 ds_read_b64_tr_b16 a[96:97], v9 offset:0
 buffer_load_dwordx4 v2, s[16:19], s48 offen lds
 v_mfma_f32_16x16x32_bf16 v[76:79], a[64:67], a[132:135], 0
 ds_read_b64_tr_b16 a[98:99], v9 offset:4096
 v_cvt_pk_bf16_f32 v250, v252, v253
 v_mfma_f32_16x16x32_bf16 v[76:79], a[68:71], a[140:143], v[76:79]
 ds_read_b64_tr_b16 a[100:101], v9 offset:16384
 v_cvt_pk_bf16_f32 v251, v254, v255
 v_mfma_f32_16x16x32_bf16 v[76:79], a[72:75], a[148:151], v[76:79]
 ds_read_b64_tr_b16 a[102:103], v9 offset:20480
 v_xor_b32 v10, 65696, v6
 v_mfma_f32_16x16x32_bf16 v[76:79], a[76:79], a[156:159], v[76:79]
 s_waitcnt lgkmcnt(6)
 ds_read_b64_tr_b16 a[104:105], v10 offset:0
 v_mov_b32 v12, 0
 v_mfma_f32_16x16x32_bf16 v[84:87], a[80:83], a[128:131], 0
 s_add_u32 m0, s29, 139264
 ds_read_b64_tr_b16 a[106:107], v10 offset:4096
 v_mfma_f32_16x16x32_bf16 v[84:87], a[84:87], a[136:139], v[84:87]
 ds_read_b64_tr_b16 a[108:109], v10 offset:16384
 buffer_load_dwordx4 v2, s[16:19], s49 offen lds
 v_mfma_f32_16x16x32_bf16 v[84:87], a[88:91], a[144:147], v[84:87]
 s_waitcnt lgkmcnt(7)
 ds_read_b64_tr_b16 a[110:111], v10 offset:20480
 v_xor_b32 v7, 192, v6
 v_mfma_f32_16x16x32_bf16 v[84:87], a[92:95], a[152:155], v[84:87]
 ds_read_b64_tr_b16 a[64:65], v7 offset:0
 global_load_dword v5, v12, s[90:91] offset:128 sc1
 v_mfma_f32_16x16x32_bf16 v[92:95], a[80:83], a[132:135], 0
 ds_read_b64_tr_b16 a[66:67], v7 offset:4096
 v_and_b32 v12, 11, v0
 v_mfma_f32_16x16x32_bf16 v[92:95], a[84:87], a[140:143], v[92:95]
 ds_read_b64_tr_b16 a[68:69], v7 offset:16384
 v_lshlrev_b32 v12, 2, v12
 v_mfma_f32_16x16x32_bf16 v[92:95], a[88:91], a[148:151], v[92:95]
 s_add_u32 m0, s29, 143360
 ds_read_b64_tr_b16 a[70:71], v7 offset:20480
 v_xor_b32 v8, 65728, v6
 v_mfma_f32_16x16x32_bf16 v[92:95], a[92:95], a[156:159], v[92:95]
 s_waitcnt lgkmcnt(6)
 ds_read_b64_tr_b16 a[72:73], v8 offset:0
 buffer_load_dwordx4 v2, s[16:19], s50 offen lds
 v_mfma_f32_16x16x32_bf16 v[100:103], a[96:99], a[128:131], 0
 ds_read_b64_tr_b16 a[74:75], v8 offset:4096
 v_mfma_f32_16x16x32_bf16 v[100:103], a[100:103], a[136:139], v[100:103]
 s_and_b32 s36, s95, 31
 ds_read_b64_tr_b16 a[76:77], v8 offset:16384
 v_and_b32 v14, 15, v0
 v_mfma_f32_16x16x32_bf16 v[100:103], a[104:107], a[144:147], v[100:103]
 s_waitcnt lgkmcnt(7)
 ds_read_b64_tr_b16 a[78:79], v8 offset:20480
 v_xor_b32 v9, 224, v6
 v_mfma_f32_16x16x32_bf16 v[100:103], a[108:111], a[152:155], v[100:103]
 s_lshr_b32 s37, s95, 5
 ds_read_b64_tr_b16 a[80:81], v9 offset:0
 v_lshrrev_b32 v3, 4, v0
 v_mfma_f32_16x16x32_bf16 v[108:111], a[96:99], a[132:135], 0
 s_add_u32 m0, s29, 147456
 ds_read_b64_tr_b16 a[82:83], v9 offset:4096
 v_lshlrev_b32 v3, 2, v3
 v_mfma_f32_16x16x32_bf16 v[108:111], a[100:103], a[140:143], v[108:111]
 ds_read_b64_tr_b16 a[84:85], v9 offset:16384
 buffer_load_dwordx4 v2, s[16:19], s51 offen lds
 v_mfma_f32_16x16x32_bf16 v[108:111], a[104:107], a[148:151], v[108:111]
 s_lshl_b32 s38, s3, 4
 ds_read_b64_tr_b16 a[86:87], v9 offset:20480
 v_xor_b32 v10, 65760, v6
 v_mfma_f32_16x16x32_bf16 v[108:111], a[108:111], a[156:159], v[108:111]
 s_waitcnt lgkmcnt(6)
 ds_read_b64_tr_b16 a[88:89], v10 offset:0
 v_sub_u32 v14, v14, v3
 v_mfma_f32_16x16x32_bf16 v[116:119], a[64:67], a[128:131], 0
 s_lshl_b32 s39, s36, 6
 ds_read_b64_tr_b16 a[90:91], v10 offset:4096
 v_lshrrev_b32_e64 v3, 6, s29
 v_mfma_f32_16x16x32_bf16 v[116:119], a[68:71], a[136:139], v[116:119]
 s_add_u32 m0, s29, 151552
 ds_read_b64_tr_b16 a[92:93], v10 offset:16384
 v_add_u32 v14, v3, v14
 v_mfma_f32_16x16x32_bf16 v[116:119], a[72:75], a[144:147], v[116:119]
 s_waitcnt lgkmcnt(7)
 ds_read_b64_tr_b16 a[94:95], v10 offset:20480
 v_xor_b32 v7, 256, v6
 v_mfma_f32_16x16x32_bf16 v[116:119], a[76:79], a[152:155], v[116:119]
 ds_read_b64_tr_b16 a[96:97], v7 offset:0
 buffer_load_dwordx4 v2, s[16:19], s52 offen lds
 v_mfma_f32_16x16x32_bf16 v[124:127], a[64:67], a[132:135], 0
 s_add_u32 s38, s38, s39
 ds_read_b64_tr_b16 a[98:99], v7 offset:4096
 v_mov_b32 v15, 0xf149f2ca
 v_mfma_f32_16x16x32_bf16 v[124:127], a[68:71], a[140:143], v[124:127]
 s_mul_i32 s38, s38, 896
 ds_read_b64_tr_b16 a[100:101], v7 offset:16384
 v_cmp_gt_i32 vcc, 0, v14
 v_mfma_f32_16x16x32_bf16 v[124:127], a[72:75], a[148:151], v[124:127]
 s_lshl_b32 s39, s37, 7
 ds_read_b64_tr_b16 a[102:103], v7 offset:20480
 v_xor_b32 v8, 65792, v6
 v_mfma_f32_16x16x32_bf16 v[124:127], a[76:79], a[156:159], v[124:127]
 s_waitcnt lgkmcnt(6)
 ds_read_b64_tr_b16 a[104:105], v8 offset:0
 v_cndmask_b32 v3, 0, v15, vcc
 v_mfma_f32_16x16x32_bf16 v[132:135], a[80:83], a[128:131], 0
 s_add_u32 m0, s29, 155648
 ds_read_b64_tr_b16 a[106:107], v8 offset:4096
 v_accvgpr_write_b32 a224, v3
 v_mfma_f32_16x16x32_bf16 v[132:135], a[84:87], a[136:139], v[132:135]
 ds_read_b64_tr_b16 a[108:109], v8 offset:16384
 buffer_load_dwordx4 v2, s[16:19], s53 offen lds
 v_mfma_f32_16x16x32_bf16 v[132:135], a[88:91], a[144:147], v[132:135]
 s_waitcnt lgkmcnt(7)
 ds_read_b64_tr_b16 a[110:111], v8 offset:20480
 v_xor_b32 v9, 288, v6
 v_mfma_f32_16x16x32_bf16 v[132:135], a[92:95], a[152:155], v[132:135]
 s_add_u32 s38, s38, s39
 ds_read_b64_tr_b16 a[64:65], v9 offset:0
 v_cmp_gt_i32 vcc, 1, v14
 v_mfma_f32_16x16x32_bf16 v[140:143], a[80:83], a[132:135], 0
 s_lshl_b32 s39, s37, 9
 ds_read_b64_tr_b16 a[66:67], v9 offset:4096
 v_cndmask_b32 v3, 0, v15, vcc
 v_mfma_f32_16x16x32_bf16 v[140:143], a[84:87], a[140:143], v[140:143]
 s_mov_b32 s4, s66
 ds_read_b64_tr_b16 a[68:69], v9 offset:16384
 v_accvgpr_write_b32 a225, v3
 v_mfma_f32_16x16x32_bf16 v[140:143], a[88:91], a[148:151], v[140:143]
 s_add_u32 m0, s29, 159744
 ds_read_b64_tr_b16 a[70:71], v9 offset:20480
 v_xor_b32 v10, 65824, v6
 v_mfma_f32_16x16x32_bf16 v[140:143], a[92:95], a[156:159], v[140:143]
 s_waitcnt lgkmcnt(6)
 ds_read_b64_tr_b16 a[72:73], v10 offset:0
 buffer_load_dwordx4 v2, s[16:19], s54 offen lds
 v_mfma_f32_16x16x32_bf16 v[148:151], a[96:99], a[128:131], 0
 s_mov_b32 s5, s67
 ds_read_b64_tr_b16 a[74:75], v10 offset:4096
 v_cmp_gt_i32 vcc, 2, v14
 v_mfma_f32_16x16x32_bf16 v[148:151], a[100:103], a[136:139], v[148:151]
 s_mov_b32 s6, 1835008
 ds_read_b64_tr_b16 a[76:77], v10 offset:16384
 v_cndmask_b32 v3, 0, v15, vcc
 v_mfma_f32_16x16x32_bf16 v[148:151], a[104:107], a[144:147], v[148:151]
 s_waitcnt lgkmcnt(7)
 ds_read_b64_tr_b16 a[78:79], v10 offset:20480
 v_xor_b32 v7, 320, v6
 v_mfma_f32_16x16x32_bf16 v[148:151], a[108:111], a[152:155], v[148:151]
 s_mov_b32 s7, 0x20000
 ds_read_b64_tr_b16 a[80:81], v7 offset:0
 v_accvgpr_write_b32 a226, v3
 v_mfma_f32_16x16x32_bf16 v[156:159], a[96:99], a[132:135], 0
 s_mov_b32 s8, s68
 ds_read_b64_tr_b16 a[82:83], v7 offset:4096
 v_cmp_gt_i32 vcc, 3, v14
 v_mfma_f32_16x16x32_bf16 v[156:159], a[100:103], a[140:143], v[156:159]
 s_mov_b32 s9, s69
 ds_read_b64_tr_b16 a[84:85], v7 offset:16384
 v_cndmask_b32 v3, 0, v15, vcc
 v_mfma_f32_16x16x32_bf16 v[156:159], a[104:107], a[148:151], v[156:159]
 s_mov_b32 s10, 1835008
 ds_read_b64_tr_b16 a[86:87], v7 offset:20480
 v_xor_b32 v8, 65856, v6
 v_mfma_f32_16x16x32_bf16 v[156:159], a[108:111], a[156:159], v[156:159]
 s_waitcnt lgkmcnt(6)
 ds_read_b64_tr_b16 a[88:89], v8 offset:0
 v_accvgpr_write_b32 a227, v3
 v_mfma_f32_16x16x32_bf16 v[164:167], a[64:67], a[128:131], 0
 s_mov_b32 s11, 0x20000
 ds_read_b64_tr_b16 a[90:91], v8 offset:4096
 v_cmp_gt_i32 vcc, 16, v14
 v_mfma_f32_16x16x32_bf16 v[164:167], a[68:71], a[136:139], v[164:167]
 s_mov_b32 s20, s70
 ds_read_b64_tr_b16 a[92:93], v8 offset:16384
 v_cndmask_b32 v3, 0, v15, vcc
 v_mfma_f32_16x16x32_bf16 v[164:167], a[72:75], a[144:147], v[164:167]
 s_waitcnt lgkmcnt(7)
 ds_read_b64_tr_b16 a[94:95], v8 offset:20480
 v_xor_b32 v9, 352, v6
 v_mfma_f32_16x16x32_bf16 v[164:167], a[76:79], a[152:155], v[164:167]
 s_mov_b32 s21, s71
 ds_read_b64_tr_b16 a[96:97], v9 offset:0
 v_accvgpr_write_b32 a228, v3
 v_mfma_f32_16x16x32_bf16 v[172:175], a[64:67], a[132:135], 0
 s_mov_b32 s22, 3584
 ds_read_b64_tr_b16 a[98:99], v9 offset:4096
 v_cmp_gt_i32 vcc, 17, v14
 v_mfma_f32_16x16x32_bf16 v[172:175], a[68:71], a[140:143], v[172:175]
 s_mov_b32 s23, 0x20000
 ds_read_b64_tr_b16 a[100:101], v9 offset:16384
 v_cndmask_b32 v3, 0, v15, vcc
 v_mfma_f32_16x16x32_bf16 v[172:175], a[72:75], a[148:151], v[172:175]
 ds_read_b64_tr_b16 a[102:103], v9 offset:20480
 v_xor_b32 v10, 65888, v6
 v_mfma_f32_16x16x32_bf16 v[172:175], a[76:79], a[156:159], v[172:175]
 s_waitcnt lgkmcnt(6)
 ds_read_b64_tr_b16 a[104:105], v10 offset:0
 v_accvgpr_write_b32 a229, v3
 v_mfma_f32_16x16x32_bf16 v[180:183], a[80:83], a[128:131], 0
 ds_read_b64_tr_b16 a[106:107], v10 offset:4096
 v_cmp_gt_i32 vcc, 18, v14
 v_mfma_f32_16x16x32_bf16 v[180:183], a[84:87], a[136:139], v[180:183]
 ds_read_b64_tr_b16 a[108:109], v10 offset:16384
 v_cndmask_b32 v3, 0, v15, vcc
 v_mfma_f32_16x16x32_bf16 v[180:183], a[88:91], a[144:147], v[180:183]
 s_waitcnt lgkmcnt(7)
 ds_read_b64_tr_b16 a[110:111], v10 offset:20480
 v_xor_b32 v7, 384, v6
 v_mfma_f32_16x16x32_bf16 v[180:183], a[92:95], a[152:155], v[180:183]
 ds_read_b64_tr_b16 a[64:65], v7 offset:0
 v_accvgpr_write_b32 a230, v3
 v_mfma_f32_16x16x32_bf16 v[188:191], a[80:83], a[132:135], 0
 ds_read_b64_tr_b16 a[66:67], v7 offset:4096
 v_cmp_gt_i32 vcc, 19, v14
 v_mfma_f32_16x16x32_bf16 v[188:191], a[84:87], a[140:143], v[188:191]
 ds_read_b64_tr_b16 a[68:69], v7 offset:16384
 v_cndmask_b32 v3, 0, v15, vcc
 v_mfma_f32_16x16x32_bf16 v[188:191], a[88:91], a[148:151], v[188:191]
 ds_read_b64_tr_b16 a[70:71], v7 offset:20480
 v_xor_b32 v8, 65920, v6
 v_mfma_f32_16x16x32_bf16 v[188:191], a[92:95], a[156:159], v[188:191]
 s_waitcnt lgkmcnt(6)
 ds_read_b64_tr_b16 a[72:73], v8 offset:0
 v_accvgpr_write_b32 a231, v3
 v_mfma_f32_16x16x32_bf16 v[196:199], a[96:99], a[128:131], 0
 ds_read_b64_tr_b16 a[74:75], v8 offset:4096
 v_cmp_gt_i32 vcc, 32, v14
 v_mfma_f32_16x16x32_bf16 v[196:199], a[100:103], a[136:139], v[196:199]
 ds_read_b64_tr_b16 a[76:77], v8 offset:16384
 v_cndmask_b32 v3, 0, v15, vcc
 v_mfma_f32_16x16x32_bf16 v[196:199], a[104:107], a[144:147], v[196:199]
 s_waitcnt lgkmcnt(7)
 ds_read_b64_tr_b16 a[78:79], v8 offset:20480
 v_xor_b32 v9, 416, v6
 v_mfma_f32_16x16x32_bf16 v[196:199], a[108:111], a[152:155], v[196:199]
 ds_read_b64_tr_b16 a[80:81], v9 offset:0
 v_accvgpr_write_b32 a232, v3
 v_mfma_f32_16x16x32_bf16 v[204:207], a[96:99], a[132:135], 0
 ds_read_b64_tr_b16 a[82:83], v9 offset:4096
 v_cmp_gt_i32 vcc, 33, v14
 v_mfma_f32_16x16x32_bf16 v[204:207], a[100:103], a[140:143], v[204:207]
 ds_read_b64_tr_b16 a[84:85], v9 offset:16384
 v_cndmask_b32 v3, 0, v15, vcc
 v_mfma_f32_16x16x32_bf16 v[204:207], a[104:107], a[148:151], v[204:207]
 ds_read_b64_tr_b16 a[86:87], v9 offset:20480
 v_xor_b32 v10, 65952, v6
 v_mfma_f32_16x16x32_bf16 v[204:207], a[108:111], a[156:159], v[204:207]
 s_waitcnt lgkmcnt(6)
 ds_read_b64_tr_b16 a[88:89], v10 offset:0
 v_accvgpr_write_b32 a233, v3
 v_mfma_f32_16x16x32_bf16 v[212:215], a[64:67], a[128:131], 0
 ds_read_b64_tr_b16 a[90:91], v10 offset:4096
 v_cmp_gt_i32 vcc, 34, v14
 v_mfma_f32_16x16x32_bf16 v[212:215], a[68:71], a[136:139], v[212:215]
 ds_read_b64_tr_b16 a[92:93], v10 offset:16384
 v_cndmask_b32 v3, 0, v15, vcc
 v_mfma_f32_16x16x32_bf16 v[212:215], a[72:75], a[144:147], v[212:215]
 s_waitcnt lgkmcnt(7)
 ds_read_b64_tr_b16 a[94:95], v10 offset:20480
 v_xor_b32 v7, 448, v6
 v_mfma_f32_16x16x32_bf16 v[212:215], a[76:79], a[152:155], v[212:215]
 s_add_u32 s59, s56, 32768
 ds_read_b64_tr_b16 a[96:97], v7 offset:0
 v_accvgpr_write_b32 a234, v3
 v_mfma_f32_16x16x32_bf16 v[220:223], a[64:67], a[132:135], 0
 ds_read_b64_tr_b16 a[98:99], v7 offset:4096
 buffer_store_dwordx4 v[32:35], v1, s[12:15], s59 offen offset:2048 sc1
 v_mfma_f32_16x16x32_bf16 v[220:223], a[68:71], a[140:143], v[220:223]
 ds_read_b64_tr_b16 a[100:101], v7 offset:16384
 v_cmp_gt_i32 vcc, 35, v14
 v_mfma_f32_16x16x32_bf16 v[220:223], a[72:75], a[148:151], v[220:223]
 ds_read_b64_tr_b16 a[102:103], v7 offset:20480
 v_xor_b32 v8, 65984, v6
 v_mfma_f32_16x16x32_bf16 v[220:223], a[76:79], a[156:159], v[220:223]
 s_waitcnt lgkmcnt(6)
 ds_read_b64_tr_b16 a[104:105], v8 offset:0
 v_cndmask_b32 v3, 0, v15, vcc
 v_mfma_f32_16x16x32_bf16 v[228:231], a[80:83], a[128:131], 0
 ds_read_b64_tr_b16 a[106:107], v8 offset:4096
 v_accvgpr_write_b32 a235, v3
 v_mfma_f32_16x16x32_bf16 v[228:231], a[84:87], a[136:139], v[228:231]
 ds_read_b64_tr_b16 a[108:109], v8 offset:16384
 v_cmp_gt_i32 vcc, 48, v14
 v_mfma_f32_16x16x32_bf16 v[228:231], a[88:91], a[144:147], v[228:231]
 s_waitcnt lgkmcnt(7)
 ds_read_b64_tr_b16 a[110:111], v8 offset:20480
 v_xor_b32 v9, 480, v6
 v_mfma_f32_16x16x32_bf16 v[228:231], a[92:95], a[152:155], v[228:231]
 ds_read_b64_tr_b16 a[64:65], v9 offset:0
 v_cndmask_b32 v3, 0, v15, vcc
 v_mfma_f32_16x16x32_bf16 v[236:239], a[80:83], a[132:135], 0
 ds_read_b64_tr_b16 a[66:67], v9 offset:4096
 v_accvgpr_write_b32 a236, v3
 v_mfma_f32_16x16x32_bf16 v[236:239], a[84:87], a[140:143], v[236:239]
 ds_read_b64_tr_b16 a[68:69], v9 offset:16384
 v_cmp_gt_i32 vcc, 49, v14
 v_mfma_f32_16x16x32_bf16 v[236:239], a[88:91], a[148:151], v[236:239]
 s_add_u32 s59, s56, 49152
 ds_read_b64_tr_b16 a[70:71], v9 offset:20480
 v_xor_b32 v10, 66016, v6
 v_mfma_f32_16x16x32_bf16 v[236:239], a[92:95], a[156:159], v[236:239]
 s_waitcnt lgkmcnt(6)
 ds_read_b64_tr_b16 a[72:73], v10 offset:0
 buffer_store_dwordx4 v[40:43], v1, s[12:15], s59 offen offset:2048 sc1
 v_mfma_f32_16x16x32_bf16 v[244:247], a[96:99], a[128:131], 0
 ds_read_b64_tr_b16 a[74:75], v10 offset:4096
 v_cndmask_b32 v3, 0, v15, vcc
 v_mfma_f32_16x16x32_bf16 v[244:247], a[100:103], a[136:139], v[244:247]
 s_waitcnt vmcnt(11)
 ds_read_b64_tr_b16 a[76:77], v10 offset:16384
 v_xor_b32 v7, 32768, v6
 v_mfma_f32_16x16x32_bf16 v[244:247], a[104:107], a[144:147], v[244:247]
 s_waitcnt lgkmcnt(7)
 s_barrier
 ds_read_b64_tr_b16 a[78:79], v10 offset:20480
 v_mfma_f32_16x16x32_bf16 v[244:247], a[108:111], a[152:155], v[244:247]
 ds_read_b64_tr_b16 a[80:81], v7 offset:0
 v_accvgpr_write_b32 a237, v3
 v_mfma_f32_16x16x32_bf16 v[252:255], a[96:99], a[132:135], 0
 ds_read_b64_tr_b16 a[82:83], v7 offset:4096
 v_cmp_gt_i32 vcc, 50, v14
 v_mfma_f32_16x16x32_bf16 v[252:255], a[100:103], a[140:143], v[252:255]
 ds_read_b64_tr_b16 a[84:85], v7 offset:16384
 v_cndmask_b32 v3, 0, v15, vcc
 v_mfma_f32_16x16x32_bf16 v[252:255], a[104:107], a[148:151], v[252:255]
 ds_read_b64_tr_b16 a[86:87], v7 offset:20480
 v_xor_b32 v8, 98304, v6
 v_mfma_f32_16x16x32_bf16 v[252:255], a[108:111], a[156:159], v[252:255]
 s_waitcnt lgkmcnt(6)
 ds_read_b64_tr_b16 a[88:89], v8 offset:0
 v_accvgpr_write_b32 a238, v3
 v_mfma_f32_16x16x32_bf16 v[16:19], a[64:67], a[128:131], 0
 s_add_u32 s59, s56, 49152
 ds_read_b64_tr_b16 a[90:91], v8 offset:4096
 v_cmp_gt_i32 vcc, 51, v14
 v_mfma_f32_16x16x32_bf16 v[16:19], a[68:71], a[136:139], v[16:19]
 ds_read_b64_tr_b16 a[92:93], v8 offset:16384
 buffer_store_dwordx4 v[48:51], v1, s[12:15], s59 offen offset:3072 sc1
 v_mfma_f32_16x16x32_bf16 v[16:19], a[72:75], a[144:147], v[16:19]
 s_waitcnt lgkmcnt(7)
 ds_read_b64_tr_b16 a[94:95], v8 offset:20480
 v_xor_b32 v9, 32800, v6
 v_mfma_f32_16x16x32_bf16 v[16:19], a[76:79], a[152:155], v[16:19]
 ds_read_b64_tr_b16 a[96:97], v9 offset:0
 v_cndmask_b32 v3, 0, v15, vcc
 v_mfma_f32_16x16x32_bf16 v[24:27], a[64:67], a[132:135], 0
 s_waitcnt lgkmcnt(9)
 ds_read_b64_tr_b16 a[98:99], v9 offset:4096
 v_accvgpr_write_b32 a239, v3
 v_mfma_f32_16x16x32_bf16 v[24:27], a[68:71], a[140:143], v[24:27]
 s_barrier
 ds_read_b64_tr_b16 a[100:101], v9 offset:16384
 v_mfma_f32_16x16x32_bf16 v[24:27], a[72:75], a[148:151], v[24:27]
 s_add_u32 m0, s29, 0
 ds_read_b64_tr_b16 a[102:103], v9 offset:20480
 v_xor_b32 v10, 98336, v6
 v_mfma_f32_16x16x32_bf16 v[24:27], a[76:79], a[156:159], v[24:27]
 s_waitcnt lgkmcnt(6)
 ds_read_b64_tr_b16 a[104:105], v10 offset:0
 v_add_u32 v2, 0x80000, v2
 v_mfma_f32_16x16x32_bf16 v[28:31], a[80:83], a[160:163], v[28:31]
 ds_read_b64_tr_b16 a[106:107], v10 offset:4096
 buffer_load_dwordx4 v2, s[16:19], 0 offen lds
 v_mfma_f32_16x16x32_bf16 v[28:31], a[84:87], a[168:171], v[28:31]
 s_add_u32 s59, s56, 32768
 ds_read_b64_tr_b16 a[108:109], v10 offset:16384
 v_mfma_f32_16x16x32_bf16 v[28:31], a[88:91], a[176:179], v[28:31]
 s_waitcnt lgkmcnt(7)
 ds_read_b64_tr_b16 a[110:111], v10 offset:20480
 v_xor_b32 v7, 32832, v6
 v_mfma_f32_16x16x32_bf16 v[28:31], a[92:95], a[184:187], v[28:31]
 ds_read_b64_tr_b16 a[64:65], v7 offset:0
 buffer_store_dwordx4 v[56:59], v1, s[12:15], s59 offen offset:3072 sc1
 v_mfma_f32_16x16x32_bf16 v[44:47], a[80:83], a[164:167], v[44:47]
 s_add_u32 m0, s29, 4096
 ds_read_b64_tr_b16 a[66:67], v7 offset:4096
 v_add_u32 v4, 4096, v1
 v_mfma_f32_16x16x32_bf16 v[44:47], a[84:87], a[172:175], v[44:47]
 ds_read_b64_tr_b16 a[68:69], v7 offset:16384
 buffer_load_dwordx4 v2, s[16:19], s48 offen lds
 v_mfma_f32_16x16x32_bf16 v[44:47], a[88:91], a[180:183], v[44:47]
 ds_read_b64_tr_b16 a[70:71], v7 offset:20480
 v_xor_b32 v8, 98368, v6
 v_mfma_f32_16x16x32_bf16 v[44:47], a[92:95], a[188:191], v[44:47]
 s_waitcnt lgkmcnt(6)
 ds_read_b64_tr_b16 a[72:73], v8 offset:0
 v_mfma_f32_16x16x32_bf16 v[52:55], a[96:99], a[160:163], v[52:55]
 ds_read_b64_tr_b16 a[74:75], v8 offset:4096
 v_mfma_f32_16x16x32_bf16 v[52:55], a[100:103], a[168:171], v[52:55]
 s_add_u32 m0, s29, 8192
 ds_read_b64_tr_b16 a[76:77], v8 offset:16384
 v_mfma_f32_16x16x32_bf16 v[52:55], a[104:107], a[176:179], v[52:55]
 s_waitcnt lgkmcnt(7)
 ds_read_b64_tr_b16 a[78:79], v8 offset:20480
 v_xor_b32 v9, 32864, v6
 v_mfma_f32_16x16x32_bf16 v[52:55], a[108:111], a[184:187], v[52:55]
 ds_read_b64_tr_b16 a[80:81], v9 offset:0
 buffer_load_dwordx4 v2, s[16:19], s49 offen lds
 v_mfma_f32_16x16x32_bf16 v[60:63], a[96:99], a[164:167], v[60:63]
 s_add_u32 s59, s56, 0
 ds_read_b64_tr_b16 a[82:83], v9 offset:4096
 v_mfma_f32_16x16x32_bf16 v[60:63], a[100:103], a[172:175], v[60:63]
 ds_read_b64_tr_b16 a[84:85], v9 offset:16384
 buffer_store_dwordx4 v[64:67], v1, s[12:15], s59 offen offset:0 sc1
 v_mfma_f32_16x16x32_bf16 v[60:63], a[104:107], a[180:183], v[60:63]
 s_add_u32 m0, s29, 12288
 ds_read_b64_tr_b16 a[86:87], v9 offset:20480
 v_xor_b32 v10, 98400, v6
 v_mfma_f32_16x16x32_bf16 v[60:63], a[108:111], a[188:191], v[60:63]
 s_waitcnt lgkmcnt(6)
 ds_read_b64_tr_b16 a[88:89], v10 offset:0
 v_mfma_f32_16x16x32_bf16 v[20:23], a[64:67], a[160:163], v[20:23]
 ds_read_b64_tr_b16 a[90:91], v10 offset:4096
 buffer_load_dwordx4 v2, s[16:19], s50 offen lds
 v_mfma_f32_16x16x32_bf16 v[20:23], a[68:71], a[168:171], v[20:23]
 ds_read_b64_tr_b16 a[92:93], v10 offset:16384
 v_mfma_f32_16x16x32_bf16 v[20:23], a[72:75], a[176:179], v[20:23]
 s_waitcnt lgkmcnt(7)
 ds_read_b64_tr_b16 a[94:95], v10 offset:20480
 v_xor_b32 v7, 32896, v6
 v_mfma_f32_16x16x32_bf16 v[20:23], a[76:79], a[184:187], v[20:23]
 ds_read_b64_tr_b16 a[96:97], v7 offset:0
 v_mfma_f32_16x16x32_bf16 v[36:39], a[64:67], a[164:167], v[36:39]
 s_add_u32 m0, s29, 16384
 ds_read_b64_tr_b16 a[98:99], v7 offset:4096
 v_mfma_f32_16x16x32_bf16 v[36:39], a[68:71], a[172:175], v[36:39]
 ds_read_b64_tr_b16 a[100:101], v7 offset:16384
 buffer_load_dwordx4 v2, s[16:19], s51 offen lds
 v_mfma_f32_16x16x32_bf16 v[36:39], a[72:75], a[180:183], v[36:39]
 s_add_u32 s59, s56, 16384
 ds_read_b64_tr_b16 a[102:103], v7 offset:20480
 v_xor_b32 v8, 98432, v6
 v_mfma_f32_16x16x32_bf16 v[36:39], a[76:79], a[188:191], v[36:39]
 s_waitcnt lgkmcnt(6)
 ds_read_b64_tr_b16 a[104:105], v8 offset:0
 buffer_store_dwordx4 v[72:75], v1, s[12:15], s59 offen offset:0 sc1
 v_mfma_f32_16x16x32_bf16 v[68:71], a[80:83], a[160:163], v[68:71]
 ds_read_b64_tr_b16 a[106:107], v8 offset:4096
 v_mfma_f32_16x16x32_bf16 v[68:71], a[84:87], a[168:171], v[68:71]
 s_add_u32 m0, s29, 20480
 ds_read_b64_tr_b16 a[108:109], v8 offset:16384
 v_mfma_f32_16x16x32_bf16 v[68:71], a[88:91], a[176:179], v[68:71]
 s_waitcnt lgkmcnt(7)
 ds_read_b64_tr_b16 a[110:111], v8 offset:20480
 v_xor_b32 v9, 32928, v6
 v_mfma_f32_16x16x32_bf16 v[68:71], a[92:95], a[184:187], v[68:71]
 ds_read_b64_tr_b16 a[64:65], v9 offset:0
 buffer_load_dwordx4 v2, s[16:19], s52 offen lds
 v_mfma_f32_16x16x32_bf16 v[76:79], a[80:83], a[164:167], v[76:79]
 ds_read_b64_tr_b16 a[66:67], v9 offset:4096
 v_mfma_f32_16x16x32_bf16 v[76:79], a[84:87], a[172:175], v[76:79]
 ds_read_b64_tr_b16 a[68:69], v9 offset:16384
 v_mfma_f32_16x16x32_bf16 v[76:79], a[88:91], a[180:183], v[76:79]
 s_add_u32 m0, s29, 24576
 ds_read_b64_tr_b16 a[70:71], v9 offset:20480
 v_xor_b32 v10, 98464, v6
 v_mfma_f32_16x16x32_bf16 v[76:79], a[92:95], a[188:191], v[76:79]
 s_waitcnt lgkmcnt(6)
 ds_read_b64_tr_b16 a[72:73], v10 offset:0
 v_mfma_f32_16x16x32_bf16 v[84:87], a[96:99], a[160:163], v[84:87]
 ds_read_b64_tr_b16 a[74:75], v10 offset:4096
 buffer_load_dwordx4 v2, s[16:19], s53 offen lds
 v_mfma_f32_16x16x32_bf16 v[84:87], a[100:103], a[168:171], v[84:87]
 s_add_u32 s59, s56, 16384
 ds_read_b64_tr_b16 a[76:77], v10 offset:16384
 v_mfma_f32_16x16x32_bf16 v[84:87], a[104:107], a[176:179], v[84:87]
 s_waitcnt lgkmcnt(7)
 ds_read_b64_tr_b16 a[78:79], v10 offset:20480
 v_xor_b32 v7, 32960, v6
 v_mfma_f32_16x16x32_bf16 v[84:87], a[108:111], a[184:187], v[84:87]
 ds_read_b64_tr_b16 a[80:81], v7 offset:0
 buffer_store_dwordx4 v[80:83], v1, s[12:15], s59 offen offset:1024 sc1
 v_mfma_f32_16x16x32_bf16 v[92:95], a[96:99], a[164:167], v[92:95]
 s_add_u32 m0, s29, 28672
 ds_read_b64_tr_b16 a[82:83], v7 offset:4096
 v_mfma_f32_16x16x32_bf16 v[92:95], a[100:103], a[172:175], v[92:95]
 ds_read_b64_tr_b16 a[84:85], v7 offset:16384
 buffer_load_dwordx4 v2, s[16:19], s54 offen lds
 v_mfma_f32_16x16x32_bf16 v[92:95], a[104:107], a[180:183], v[92:95]
 ds_read_b64_tr_b16 a[86:87], v7 offset:20480
 v_xor_b32 v8, 98496, v6
 v_mfma_f32_16x16x32_bf16 v[92:95], a[108:111], a[188:191], v[92:95]
 s_waitcnt lgkmcnt(6)
 ds_read_b64_tr_b16 a[88:89], v8 offset:0
 v_mfma_f32_16x16x32_bf16 v[100:103], a[64:67], a[160:163], v[100:103]
 s_add_u32 m0, s29, 65536
 ds_read_b64_tr_b16 a[90:91], v8 offset:4096
 v_add_u32 v2, 0x80000, v2
 v_mfma_f32_16x16x32_bf16 v[100:103], a[68:71], a[168:171], v[100:103]
 ds_read_b64_tr_b16 a[92:93], v8 offset:16384
 buffer_load_dwordx4 v2, s[16:19], 0 offen lds
 v_mfma_f32_16x16x32_bf16 v[100:103], a[72:75], a[176:179], v[100:103]
 s_waitcnt lgkmcnt(7)
 ds_read_b64_tr_b16 a[94:95], v8 offset:20480
 v_xor_b32 v9, 32992, v6
 v_mfma_f32_16x16x32_bf16 v[100:103], a[76:79], a[184:187], v[100:103]
 ds_read_b64_tr_b16 a[96:97], v9 offset:0
 v_mfma_f32_16x16x32_bf16 v[108:111], a[64:67], a[164:167], v[108:111]
 s_add_u32 s59, s56, 0
 ds_read_b64_tr_b16 a[98:99], v9 offset:4096
 v_mfma_f32_16x16x32_bf16 v[108:111], a[68:71], a[172:175], v[108:111]
 ds_read_b64_tr_b16 a[100:101], v9 offset:16384
 buffer_store_dwordx4 v[88:91], v1, s[12:15], s59 offen offset:1024 sc1
 v_mfma_f32_16x16x32_bf16 v[108:111], a[72:75], a[180:183], v[108:111]
 s_add_u32 m0, s29, 69632
 ds_read_b64_tr_b16 a[102:103], v9 offset:20480
 v_xor_b32 v10, 98528, v6
 v_mfma_f32_16x16x32_bf16 v[108:111], a[76:79], a[188:191], v[108:111]
 s_waitcnt lgkmcnt(6)
 ds_read_b64_tr_b16 a[104:105], v10 offset:0
 buffer_load_dwordx4 v2, s[16:19], s48 offen lds
 v_mfma_f32_16x16x32_bf16 v[116:119], a[80:83], a[160:163], v[116:119]
 ds_read_b64_tr_b16 a[106:107], v10 offset:4096
 v_mfma_f32_16x16x32_bf16 v[116:119], a[84:87], a[168:171], v[116:119]
 ds_read_b64_tr_b16 a[108:109], v10 offset:16384
 v_mfma_f32_16x16x32_bf16 v[116:119], a[88:91], a[176:179], v[116:119]
 s_waitcnt lgkmcnt(7)
 ds_read_b64_tr_b16 a[110:111], v10 offset:20480
 v_xor_b32 v7, 33024, v6
 v_mfma_f32_16x16x32_bf16 v[116:119], a[92:95], a[184:187], v[116:119]
 s_add_u32 m0, s29, 73728
 ds_read_b64_tr_b16 a[64:65], v7 offset:0
 v_mfma_f32_16x16x32_bf16 v[124:127], a[80:83], a[164:167], v[124:127]
 ds_read_b64_tr_b16 a[66:67], v7 offset:4096
 buffer_load_dwordx4 v2, s[16:19], s49 offen lds
 v_mfma_f32_16x16x32_bf16 v[124:127], a[84:87], a[172:175], v[124:127]
 ds_read_b64_tr_b16 a[68:69], v7 offset:16384
 v_mfma_f32_16x16x32_bf16 v[124:127], a[88:91], a[180:183], v[124:127]
 s_add_u32 s59, s56, 0
 ds_read_b64_tr_b16 a[70:71], v7 offset:20480
 v_xor_b32 v8, 98560, v6
 v_mfma_f32_16x16x32_bf16 v[124:127], a[92:95], a[188:191], v[124:127]
 s_waitcnt lgkmcnt(6)
 ds_read_b64_tr_b16 a[72:73], v8 offset:0
 buffer_store_dwordx4 v[96:99], v1, s[12:15], s59 offen offset:2048 sc1
 v_mfma_f32_16x16x32_bf16 v[132:135], a[96:99], a[160:163], v[132:135]
 s_add_u32 m0, s29, 77824
 ds_read_b64_tr_b16 a[74:75], v8 offset:4096
 v_mfma_f32_16x16x32_bf16 v[132:135], a[100:103], a[168:171], v[132:135]
 ds_read_b64_tr_b16 a[76:77], v8 offset:16384
 buffer_load_dwordx4 v2, s[16:19], s50 offen lds
 v_mfma_f32_16x16x32_bf16 v[132:135], a[104:107], a[176:179], v[132:135]
 s_waitcnt lgkmcnt(7)
 ds_read_b64_tr_b16 a[78:79], v8 offset:20480
 v_xor_b32 v9, 33056, v6
 v_mfma_f32_16x16x32_bf16 v[132:135], a[108:111], a[184:187], v[132:135]
 ds_read_b64_tr_b16 a[80:81], v9 offset:0
 v_mfma_f32_16x16x32_bf16 v[140:143], a[96:99], a[164:167], v[140:143]
 ds_read_b64_tr_b16 a[82:83], v9 offset:4096
 v_mfma_f32_16x16x32_bf16 v[140:143], a[100:103], a[172:175], v[140:143]
 ds_read_b64_tr_b16 a[84:85], v9 offset:16384
 v_mfma_f32_16x16x32_bf16 v[140:143], a[104:107], a[180:183], v[140:143]
 s_add_u32 m0, s29, 81920
 ds_read_b64_tr_b16 a[86:87], v9 offset:20480
 v_xor_b32 v10, 98592, v6
 v_mfma_f32_16x16x32_bf16 v[140:143], a[108:111], a[188:191], v[140:143]
 s_waitcnt lgkmcnt(6)
 ds_read_b64_tr_b16 a[88:89], v10 offset:0
 buffer_load_dwordx4 v2, s[16:19], s51 offen lds
 v_mfma_f32_16x16x32_bf16 v[148:151], a[64:67], a[160:163], v[148:151]
 s_add_u32 s59, s56, 16384
 ds_read_b64_tr_b16 a[90:91], v10 offset:4096
 v_mfma_f32_16x16x32_bf16 v[148:151], a[68:71], a[168:171], v[148:151]
 ds_read_b64_tr_b16 a[92:93], v10 offset:16384
 buffer_store_dwordx4 v[104:107], v1, s[12:15], s59 offen offset:2048 sc1
 v_mfma_f32_16x16x32_bf16 v[148:151], a[72:75], a[176:179], v[148:151]
 s_waitcnt lgkmcnt(7)
 ds_read_b64_tr_b16 a[94:95], v10 offset:20480
 v_xor_b32 v7, 33088, v6
 v_mfma_f32_16x16x32_bf16 v[148:151], a[76:79], a[184:187], v[148:151]
 s_add_u32 m0, s29, 86016
 ds_read_b64_tr_b16 a[96:97], v7 offset:0
 v_mfma_f32_16x16x32_bf16 v[156:159], a[64:67], a[164:167], v[156:159]
 ds_read_b64_tr_b16 a[98:99], v7 offset:4096
 buffer_load_dwordx4 v2, s[16:19], s52 offen lds
 v_mfma_f32_16x16x32_bf16 v[156:159], a[68:71], a[172:175], v[156:159]
 ds_read_b64_tr_b16 a[100:101], v7 offset:16384
 v_mfma_f32_16x16x32_bf16 v[156:159], a[72:75], a[180:183], v[156:159]
 ds_read_b64_tr_b16 a[102:103], v7 offset:20480
 v_xor_b32 v8, 98624, v6
 v_mfma_f32_16x16x32_bf16 v[156:159], a[76:79], a[188:191], v[156:159]
 s_waitcnt lgkmcnt(6)
 ds_read_b64_tr_b16 a[104:105], v8 offset:0
 v_mfma_f32_16x16x32_bf16 v[164:167], a[80:83], a[160:163], v[164:167]
 s_add_u32 m0, s29, 90112
 ds_read_b64_tr_b16 a[106:107], v8 offset:4096
 v_mfma_f32_16x16x32_bf16 v[164:167], a[84:87], a[168:171], v[164:167]
 ds_read_b64_tr_b16 a[108:109], v8 offset:16384
 buffer_load_dwordx4 v2, s[16:19], s53 offen lds
 v_mfma_f32_16x16x32_bf16 v[164:167], a[88:91], a[176:179], v[164:167]
 s_waitcnt lgkmcnt(7)
 ds_read_b64_tr_b16 a[110:111], v8 offset:20480
 v_xor_b32 v9, 33120, v6
 v_mfma_f32_16x16x32_bf16 v[164:167], a[92:95], a[184:187], v[164:167]
 s_add_u32 s59, s56, 16384
 ds_read_b64_tr_b16 a[64:65], v9 offset:0
 v_mfma_f32_16x16x32_bf16 v[172:175], a[80:83], a[164:167], v[172:175]
 ds_read_b64_tr_b16 a[66:67], v9 offset:4096
 buffer_store_dwordx4 v[112:115], v1, s[12:15], s59 offen offset:3072 sc1
 v_mfma_f32_16x16x32_bf16 v[172:175], a[84:87], a[172:175], v[172:175]
 ds_read_b64_tr_b16 a[68:69], v9 offset:16384
 v_mfma_f32_16x16x32_bf16 v[172:175], a[88:91], a[180:183], v[172:175]
 s_add_u32 m0, s29, 94208
 ds_read_b64_tr_b16 a[70:71], v9 offset:20480
 v_xor_b32 v10, 98656, v6
 v_mfma_f32_16x16x32_bf16 v[172:175], a[92:95], a[188:191], v[172:175]
 s_waitcnt lgkmcnt(6)
 ds_read_b64_tr_b16 a[72:73], v10 offset:0
 buffer_load_dwordx4 v2, s[16:19], s54 offen lds
 v_mfma_f32_16x16x32_bf16 v[180:183], a[96:99], a[160:163], v[180:183]
 ds_read_b64_tr_b16 a[74:75], v10 offset:4096
 v_mfma_f32_16x16x32_bf16 v[180:183], a[100:103], a[168:171], v[180:183]
 ds_read_b64_tr_b16 a[76:77], v10 offset:16384
 v_mfma_f32_16x16x32_bf16 v[180:183], a[104:107], a[176:179], v[180:183]
 s_waitcnt lgkmcnt(7)
 ds_read_b64_tr_b16 a[78:79], v10 offset:20480
 v_xor_b32 v7, 33152, v6
 v_mfma_f32_16x16x32_bf16 v[180:183], a[108:111], a[184:187], v[180:183]
 ds_read_b64_tr_b16 a[80:81], v7 offset:0
 v_mfma_f32_16x16x32_bf16 v[188:191], a[96:99], a[164:167], v[188:191]
 ds_read_b64_tr_b16 a[82:83], v7 offset:4096
 v_mfma_f32_16x16x32_bf16 v[188:191], a[100:103], a[172:175], v[188:191]
 ds_read_b64_tr_b16 a[84:85], v7 offset:16384
 v_mfma_f32_16x16x32_bf16 v[188:191], a[104:107], a[180:183], v[188:191]
 s_add_u32 s59, s56, 0
 ds_read_b64_tr_b16 a[86:87], v7 offset:20480
 v_xor_b32 v8, 98688, v6
 v_mfma_f32_16x16x32_bf16 v[188:191], a[108:111], a[188:191], v[188:191]
 s_waitcnt lgkmcnt(6)
 ds_read_b64_tr_b16 a[88:89], v8 offset:0
 buffer_store_dwordx4 v[120:123], v1, s[12:15], s59 offen offset:3072 sc1
 v_mfma_f32_16x16x32_bf16 v[196:199], a[64:67], a[160:163], v[196:199]
 ds_read_b64_tr_b16 a[90:91], v8 offset:4096
 v_mfma_f32_16x16x32_bf16 v[196:199], a[68:71], a[168:171], v[196:199]
 ds_read_b64_tr_b16 a[92:93], v8 offset:16384
 v_mfma_f32_16x16x32_bf16 v[196:199], a[72:75], a[176:179], v[196:199]
 s_waitcnt lgkmcnt(7)
 ds_read_b64_tr_b16 a[94:95], v8 offset:20480
 v_xor_b32 v9, 33184, v6
 v_mfma_f32_16x16x32_bf16 v[196:199], a[76:79], a[184:187], v[196:199]
 ds_read_b64_tr_b16 a[96:97], v9 offset:0
 v_mfma_f32_16x16x32_bf16 v[204:207], a[64:67], a[164:167], v[204:207]
 ds_read_b64_tr_b16 a[98:99], v9 offset:4096
 v_mfma_f32_16x16x32_bf16 v[204:207], a[68:71], a[172:175], v[204:207]
 ds_read_b64_tr_b16 a[100:101], v9 offset:16384
 v_mfma_f32_16x16x32_bf16 v[204:207], a[72:75], a[180:183], v[204:207]
 ds_read_b64_tr_b16 a[102:103], v9 offset:20480
 v_xor_b32 v10, 98720, v6
 v_mfma_f32_16x16x32_bf16 v[204:207], a[76:79], a[188:191], v[204:207]
 s_waitcnt lgkmcnt(6)
 ds_read_b64_tr_b16 a[104:105], v10 offset:0
 v_mfma_f32_16x16x32_bf16 v[212:215], a[80:83], a[160:163], v[212:215]
 s_add_u32 s59, s56, 4096
 ds_read_b64_tr_b16 a[106:107], v10 offset:4096
 v_mfma_f32_16x16x32_bf16 v[212:215], a[84:87], a[168:171], v[212:215]
 ds_read_b64_tr_b16 a[108:109], v10 offset:16384
 buffer_store_dwordx4 v[128:131], v1, s[12:15], s59 offen offset:0 sc1
 v_mfma_f32_16x16x32_bf16 v[212:215], a[88:91], a[176:179], v[212:215]
 s_waitcnt lgkmcnt(7)
 ds_read_b64_tr_b16 a[110:111], v10 offset:20480
 v_xor_b32 v7, 33216, v6
 v_mfma_f32_16x16x32_bf16 v[212:215], a[92:95], a[184:187], v[212:215]
 ds_read_b64_tr_b16 a[64:65], v7 offset:0
 v_lshrrev_b32 v120, 3, v0
 v_mfma_f32_16x16x32_bf16 v[220:223], a[80:83], a[164:167], v[220:223]
 ds_read_b64_tr_b16 a[66:67], v7 offset:4096
 v_mul_u32_u24 v120, 1792, v120
 v_mfma_f32_16x16x32_bf16 v[220:223], a[84:87], a[172:175], v[220:223]
 ds_read_b64_tr_b16 a[68:69], v7 offset:16384
 v_and_b32 v121, 7, v0
 v_mfma_f32_16x16x32_bf16 v[220:223], a[88:91], a[180:183], v[220:223]
 ds_read_b64_tr_b16 a[70:71], v7 offset:20480
 v_xor_b32 v8, 98752, v6
 v_mfma_f32_16x16x32_bf16 v[220:223], a[92:95], a[188:191], v[220:223]
 s_waitcnt lgkmcnt(6)
 ds_read_b64_tr_b16 a[72:73], v8 offset:0
 v_lshl_add_u32 v120, v121, 4, v120
 v_mfma_f32_16x16x32_bf16 v[228:231], a[96:99], a[160:163], v[228:231]
 ds_read_b64_tr_b16 a[74:75], v8 offset:4096
 v_add_u32 v120, s38, v120
 v_mfma_f32_16x16x32_bf16 v[228:231], a[100:103], a[168:171], v[228:231]
 s_add_u32 s59, s56, 20480
 ds_read_b64_tr_b16 a[76:77], v8 offset:16384
 v_lshlrev_b32 v121, 6, v121
 v_mfma_f32_16x16x32_bf16 v[228:231], a[104:107], a[176:179], v[228:231]
 s_waitcnt lgkmcnt(7)
 ds_read_b64_tr_b16 a[78:79], v8 offset:20480
 v_xor_b32 v9, 33248, v6
 v_mfma_f32_16x16x32_bf16 v[228:231], a[108:111], a[184:187], v[228:231]
 ds_read_b64_tr_b16 a[80:81], v9 offset:0
 buffer_store_dwordx4 v[136:139], v1, s[12:15], s59 offen offset:0 sc1
 v_mfma_f32_16x16x32_bf16 v[236:239], a[96:99], a[164:167], v[236:239]
 ds_read_b64_tr_b16 a[82:83], v9 offset:4096
 v_subrev_u32 v122, 2688, v120
 v_mfma_f32_16x16x32_bf16 v[236:239], a[100:103], a[172:175], v[236:239]
 ds_read_b64_tr_b16 a[84:85], v9 offset:16384
 v_subrev_u32 v123, 1792, v120
 v_mfma_f32_16x16x32_bf16 v[236:239], a[104:107], a[180:183], v[236:239]
 ds_read_b64_tr_b16 a[86:87], v9 offset:20480
 v_xor_b32 v10, 98784, v6
 v_mfma_f32_16x16x32_bf16 v[236:239], a[108:111], a[188:191], v[236:239]
 s_waitcnt lgkmcnt(6)
 ds_read_b64_tr_b16 a[88:89], v10 offset:0
 v_subrev_u32 v128, 896, v120
 v_mfma_f32_16x16x32_bf16 v[244:247], a[64:67], a[160:163], v[244:247]
 ds_read_b64_tr_b16 a[90:91], v10 offset:4096
 buffer_load_dwordx4 v[32:35], v122, s[4:7], 0 offen
 v_mfma_f32_16x16x32_bf16 v[244:247], a[68:71], a[168:171], v[244:247]
 s_waitcnt vmcnt(4)
 ds_read_b64_tr_b16 a[92:93], v10 offset:16384
 v_xor_b32 v7, 131072, v6
 v_mfma_f32_16x16x32_bf16 v[244:247], a[72:75], a[176:179], v[244:247]
 s_waitcnt lgkmcnt(7)
 s_barrier
 ds_read_b64_tr_b16 a[94:95], v10 offset:20480
 v_mfma_f32_16x16x32_bf16 v[244:247], a[76:79], a[184:187], v[244:247]
 s_and_b32 s58, s92, ~127
 ds_read_b64_tr_b16 a[96:97], v7 offset:0
 v_mfma_f32_16x16x32_bf16 v[252:255], a[64:67], a[164:167], v[252:255]
 s_add_u32 s59, s56, 20480
 ds_read_b64_tr_b16 a[98:99], v7 offset:4096
 v_mfma_f32_16x16x32_bf16 v[252:255], a[68:71], a[172:175], v[252:255]
 ds_read_b64_tr_b16 a[100:101], v7 offset:16384
 buffer_store_dwordx4 v[144:147], v1, s[12:15], s59 offen offset:1024 sc1
 v_mfma_f32_16x16x32_bf16 v[252:255], a[72:75], a[180:183], v[252:255]
 s_lshl_b32 s37, s25, 1
 ds_read_b64_tr_b16 a[102:103], v7 offset:20480
 v_xor_b32 v8, 0, v6
 v_mfma_f32_16x16x32_bf16 v[252:255], a[76:79], a[188:191], v[252:255]
 s_waitcnt lgkmcnt(6)
 ds_read_b64_tr_b16 a[104:105], v8 offset:0
 buffer_load_dwordx4 v[40:43], v123, s[4:7], 0 offen
 v_mfma_f32_16x16x32_bf16 v[16:19], a[80:83], a[160:163], v[16:19]
 s_sub_i32 s38, 12, s37
 ds_read_b64_tr_b16 a[106:107], v8 offset:4096
 v_mfma_f32_16x16x32_bf16 v[16:19], a[84:87], a[168:171], v[16:19]
 s_max_i32 s38, s38, 0
 ds_read_b64_tr_b16 a[108:109], v8 offset:16384
 v_mfma_f32_16x16x32_bf16 v[16:19], a[88:91], a[176:179], v[16:19]
 s_waitcnt lgkmcnt(7)
 ds_read_b64_tr_b16 a[110:111], v8 offset:20480
 v_xor_b32 v9, 65536, v6
 v_mfma_f32_16x16x32_bf16 v[16:19], a[92:95], a[184:187], v[16:19]
 ds_read_b64_tr_b16 a[64:65], v9 offset:0
 buffer_load_dwordx4 v[48:51], v128, s[4:7], 0 offen
 v_mfma_f32_16x16x32_bf16 v[24:27], a[80:83], a[164:167], v[24:27]
 s_mul_i32 s49, s26, 1048576
 ds_read_b64_tr_b16 a[66:67], v9 offset:4096
 v_mfma_f32_16x16x32_bf16 v[24:27], a[84:87], a[172:175], v[24:27]
 s_lshl_b32 s50, s3, 13
 ds_read_b64_tr_b16 a[68:69], v9 offset:16384
 v_mfma_f32_16x16x32_bf16 v[24:27], a[88:91], a[180:183], v[24:27]
 s_add_u32 s59, s56, 4096
 ds_read_b64_tr_b16 a[70:71], v9 offset:20480
 v_xor_b32 v10, 131104, v6
 v_mfma_f32_16x16x32_bf16 v[24:27], a[92:95], a[188:191], v[24:27]
 s_waitcnt lgkmcnt(6)
 ds_read_b64_tr_b16 a[72:73], v10 offset:0
 buffer_store_dwordx4 v[152:155], v1, s[12:15], s59 offen offset:1024 sc1
 v_mfma_f32_16x16x32_bf16 v[28:31], a[96:99], a[192:195], v[28:31]
 s_add_u32 s49, s49, s50
 ds_read_b64_tr_b16 a[74:75], v10 offset:4096
 v_mfma_f32_16x16x32_bf16 v[28:31], a[100:103], a[200:203], v[28:31]
 ds_read_b64_tr_b16 a[76:77], v10 offset:16384
 buffer_load_dwordx4 v[56:59], v120, s[4:7], 0 offen offset:0
 v_mfma_f32_16x16x32_bf16 v[28:31], a[104:107], a[208:211], v[28:31]
 s_waitcnt lgkmcnt(3)
 ds_read_b64_tr_b16 a[78:79], v10 offset:20480
 v_xor_b32 v7, 32, v6
 v_mfma_f32_16x16x32_bf16 v[28:31], a[108:111], a[216:219], v[28:31]
 s_mov_b32 s54, 2
 ds_read_b64_tr_b16 a[80:81], v7 offset:0
 v_mfma_f32_16x16x32_bf16 v[28:31], a[64:67], a[112:115], v[28:31]
 s_sub_u32 s44, 31, s37
 ds_read_b64_tr_b16 a[82:83], v7 offset:4096
 v_mfma_f32_16x16x32_bf16 v[28:31], a[68:71], a[120:123], v[28:31]
 ds_read_b64_tr_b16 a[84:85], v7 offset:16384
 buffer_load_dwordx4 v[64:67], v120, s[4:7], 0 offen offset:896
 v_mfma_f32_16x16x32_bf16 v[44:47], a[96:99], a[196:199], v[44:47]
 s_sub_u32 s44, s44, s38
 ds_read_b64_tr_b16 a[86:87], v7 offset:20480
 v_xor_b32 v8, 65568, v6
 v_mfma_f32_16x16x32_bf16 v[44:47], a[100:103], a[204:207], v[44:47]
 s_mul_i32 s55, s38, 32768
 ds_read_b64_tr_b16 a[88:89], v8 offset:0
 v_mfma_f32_16x16x32_bf16 v[44:47], a[104:107], a[212:215], v[44:47]
 s_add_u32 s59, s56, 4096
 ds_read_b64_tr_b16 a[90:91], v8 offset:4096
 v_mfma_f32_16x16x32_bf16 v[44:47], a[108:111], a[220:223], v[44:47]
 ds_read_b64_tr_b16 a[92:93], v8 offset:16384
 buffer_store_dwordx4 v[160:163], v1, s[12:15], s59 offen offset:2048 sc1
 v_mfma_f32_16x16x32_bf16 v[44:47], a[64:67], a[116:119], v[44:47]
 s_add_u32 s42, s55, s49
 ds_read_b64_tr_b16 a[94:95], v8 offset:20480
 v_xor_b32 v9, 131136, v6
 v_mfma_f32_16x16x32_bf16 v[44:47], a[68:71], a[124:127], v[44:47]
 s_waitcnt lgkmcnt(6)
 ds_read_b64_tr_b16 a[96:97], v9 offset:0
 buffer_load_dwordx4 v[72:75], v120, s[8:11], 0 offen offset:0
 v_mfma_f32_16x16x32_bf16 v[52:55], a[72:75], a[192:195], v[52:55]
 s_add_u32 s60, s58, 16
 ds_read_b64_tr_b16 a[98:99], v9 offset:4096
 v_mfma_f32_16x16x32_bf16 v[52:55], a[76:79], a[200:203], v[52:55]
 s_sub_u32 s45, 17, s37
 ds_read_b64_tr_b16 a[100:101], v9 offset:16384
 v_mfma_f32_16x16x32_bf16 v[52:55], a[80:83], a[208:211], v[52:55]
 s_waitcnt lgkmcnt(3)
 ds_read_b64_tr_b16 a[102:103], v9 offset:20480
 v_xor_b32 v10, 64, v6
 v_mfma_f32_16x16x32_bf16 v[52:55], a[84:87], a[216:219], v[52:55]
 ds_read_b64_tr_b16 a[104:105], v10 offset:0
 buffer_load_dwordx4 v[80:83], v120, s[8:11], 0 offen offset:896
 v_mfma_f32_16x16x32_bf16 v[52:55], a[88:91], a[112:115], v[52:55]
 s_sub_u32 s66, s42, 32768
 ds_read_b64_tr_b16 a[106:107], v10 offset:4096
 v_mfma_f32_16x16x32_bf16 v[52:55], a[92:95], a[120:123], v[52:55]
 s_add_u32 s42, s49, 491520
 ds_read_b64_tr_b16 a[108:109], v10 offset:16384
 v_mfma_f32_16x16x32_bf16 v[60:63], a[72:75], a[196:199], v[60:63]
 s_add_u32 s59, s56, 20480
 ds_read_b64_tr_b16 a[110:111], v10 offset:20480
 v_xor_b32 v7, 65600, v6
 v_mfma_f32_16x16x32_bf16 v[60:63], a[76:79], a[204:207], v[60:63]
 ds_read_b64_tr_b16 a[64:65], v7 offset:0
 buffer_store_dwordx4 v[168:171], v1, s[12:15], s59 offen offset:2048 sc1
 v_mfma_f32_16x16x32_bf16 v[60:63], a[80:83], a[212:215], v[60:63]
 s_add_u32 s67, s49, 524288
 ds_read_b64_tr_b16 a[66:67], v7 offset:4096
 v_mfma_f32_16x16x32_bf16 v[60:63], a[84:87], a[220:223], v[60:63]
 ds_read_b64_tr_b16 a[68:69], v7 offset:16384
 buffer_load_dwordx4 v[88:91], v121, s[20:23], s39 offen offset:0
 v_mfma_f32_16x16x32_bf16 v[60:63], a[88:91], a[116:119], v[60:63]
 s_add_u32 s68, s66, 16777216
 ds_read_b64_tr_b16 a[70:71], v7 offset:20480
 v_xor_b32 v8, 131168, v6
 v_mfma_f32_16x16x32_bf16 v[60:63], a[92:95], a[124:127], v[60:63]
 s_waitcnt lgkmcnt(6)
 ds_read_b64_tr_b16 a[72:73], v8 offset:0
 v_mfma_f32_16x16x32_bf16 v[20:23], a[96:99], a[192:195], v[20:23]
 s_add_u32 s69, s67, 16777216
 ds_read_b64_tr_b16 a[74:75], v8 offset:4096
 v_mfma_f32_16x16x32_bf16 v[20:23], a[100:103], a[200:203], v[20:23]
 ds_read_b64_tr_b16 a[76:77], v8 offset:16384
 buffer_load_dwordx4 v[96:99], v121, s[20:23], s39 offen offset:16
 v_mfma_f32_16x16x32_bf16 v[20:23], a[104:107], a[208:211], v[20:23]
 s_waitcnt lgkmcnt(3)
 ds_read_b64_tr_b16 a[78:79], v8 offset:20480
 v_xor_b32 v9, 96, v6
 v_mfma_f32_16x16x32_bf16 v[20:23], a[108:111], a[216:219], v[20:23]
 s_mov_b32 s70, 0xffff8000
 ds_read_b64_tr_b16 a[80:81], v9 offset:0
 v_mul_f32 v28, s34, v28
 v_mfma_f32_16x16x32_bf16 v[20:23], a[64:67], a[112:115], v[20:23]
 s_add_u32 s59, s56, 20480
 ds_read_b64_tr_b16 a[82:83], v9 offset:4096
 v_mul_f32 v29, s34, v29
 v_mfma_f32_16x16x32_bf16 v[20:23], a[68:71], a[120:123], v[20:23]
 ds_read_b64_tr_b16 a[84:85], v9 offset:16384
 buffer_store_dwordx4 v[176:179], v1, s[12:15], s59 offen offset:3072 sc1
 v_mfma_f32_16x16x32_bf16 v[36:39], a[96:99], a[196:199], v[36:39]
 s_mov_b32 s71, s70
 ds_read_b64_tr_b16 a[86:87], v9 offset:20480
 v_xor_b32 v10, 65632, v6
 v_mfma_f32_16x16x32_bf16 v[36:39], a[100:103], a[204:207], v[36:39]
 ds_read_b64_tr_b16 a[88:89], v10 offset:0
 buffer_load_dwordx4 v[104:107], v121, s[20:23], s39 offen offset:32
 v_mfma_f32_16x16x32_bf16 v[36:39], a[104:107], a[212:215], v[36:39]
 s_add_u32 s43, s42, 16777216
 ds_read_b64_tr_b16 a[90:91], v10 offset:4096
 v_mul_f32 v30, s34, v30
 v_mfma_f32_16x16x32_bf16 v[36:39], a[108:111], a[220:223], v[36:39]
 s_mov_b32 s40, s50
 ds_read_b64_tr_b16 a[92:93], v10 offset:16384
 v_mul_f32 v31, s34, v31
 v_mfma_f32_16x16x32_bf16 v[36:39], a[64:67], a[116:119], v[36:39]
 s_add_u32 s41, s50, 0x10000
 ds_read_b64_tr_b16 a[94:95], v10 offset:20480
 v_xor_b32 v7, 131200, v6
 v_mfma_f32_16x16x32_bf16 v[36:39], a[68:71], a[124:127], v[36:39]
 s_waitcnt lgkmcnt(6)
 ds_read_b64_tr_b16 a[96:97], v7 offset:0
 buffer_load_dwordx4 v[112:115], v121, s[20:23], s39 offen offset:48
 v_mfma_f32_16x16x32_bf16 v[68:71], a[72:75], a[192:195], v[68:71]
 s_lshr_b32 s61, s95, 4
 ds_read_b64_tr_b16 a[98:99], v7 offset:4096
 v_mul_f32 v52, s34, v52
 v_mfma_f32_16x16x32_bf16 v[68:71], a[76:79], a[200:203], v[68:71]
 s_add_u32 s59, s56, 4096
 ds_read_b64_tr_b16 a[100:101], v7 offset:16384
 v_mul_f32 v53, s34, v53
 v_mfma_f32_16x16x32_bf16 v[68:71], a[80:83], a[208:211], v[68:71]
 s_waitcnt lgkmcnt(3)
 ds_read_b64_tr_b16 a[102:103], v7 offset:20480
 v_xor_b32 v8, 128, v6
 v_mfma_f32_16x16x32_bf16 v[68:71], a[84:87], a[216:219], v[68:71]
 ds_read_b64_tr_b16 a[104:105], v8 offset:0
 buffer_store_dwordx4 v[184:187], v1, s[12:15], s59 offen offset:3072 sc1
 v_mfma_f32_16x16x32_bf16 v[68:71], a[88:91], a[112:115], v[68:71]
 s_lshl_b32 s61, s61, 7
 ds_read_b64_tr_b16 a[106:107], v8 offset:4096
 v_mul_f32 v54, s34, v54
 v_mfma_f32_16x16x32_bf16 v[68:71], a[92:95], a[120:123], v[68:71]
 s_add_u32 s61, s61, 84959232
 ds_read_b64_tr_b16 a[108:109], v8 offset:16384
 v_mul_f32 v55, s34, v55
 v_mfma_f32_16x16x32_bf16 v[76:79], a[72:75], a[196:199], v[76:79]
 s_mov_b32 s47, 0x4b800000
 ds_read_b64_tr_b16 a[110:111], v8 offset:20480
 v_xor_b32 v9, 65664, v6
 v_mfma_f32_16x16x32_bf16 v[76:79], a[76:79], a[204:207], v[76:79]
 s_lshl_b32 s30, s95, 1
 ds_read_b64_tr_b16 a[64:65], v9 offset:0
 v_cvt_pk_bf16_f32 v28, v28, v29
 v_mfma_f32_16x16x32_bf16 v[76:79], a[80:83], a[212:215], v[76:79]
 s_lshr_b32 s31, s3, 1
 ds_read_b64_tr_b16 a[66:67], v9 offset:4096
 v_cvt_pk_bf16_f32 v29, v30, v31
 v_mfma_f32_16x16x32_bf16 v[76:79], a[84:87], a[220:223], v[76:79]
 s_add_u32 s30, s30, s31
 ds_read_b64_tr_b16 a[68:69], v9 offset:16384
 v_cvt_pk_bf16_f32 v30, v52, v53
 v_mfma_f32_16x16x32_bf16 v[76:79], a[88:91], a[116:119], v[76:79]
 s_min_u32 s30, s30, 223
 ds_read_b64_tr_b16 a[70:71], v9 offset:20480
 v_xor_b32 v10, 131232, v6
 v_mfma_f32_16x16x32_bf16 v[76:79], a[92:95], a[124:127], v[76:79]
 s_waitcnt lgkmcnt(6)
 ds_read_b64_tr_b16 a[72:73], v10 offset:0
 v_cvt_pk_bf16_f32 v31, v54, v55
 v_mfma_f32_16x16x32_bf16 v[84:87], a[96:99], a[192:195], v[84:87]
 s_add_u32 s59, s56, 36864
 ds_read_b64_tr_b16 a[74:75], v10 offset:4096
 v_accvgpr_write_b32 a0, v28
 v_mfma_f32_16x16x32_bf16 v[84:87], a[100:103], a[200:203], v[84:87]
 ds_read_b64_tr_b16 a[76:77], v10 offset:16384
 buffer_store_dwordx4 v[192:195], v1, s[12:15], s59 offen offset:0 sc1
 v_mfma_f32_16x16x32_bf16 v[84:87], a[104:107], a[208:211], v[84:87]
 s_waitcnt lgkmcnt(3)
 ds_read_b64_tr_b16 a[78:79], v10 offset:20480
 v_xor_b32 v7, 160, v6
 v_mfma_f32_16x16x32_bf16 v[84:87], a[108:111], a[216:219], v[84:87]
 s_lshl_b32 s30, s30, 2
 ds_read_b64_tr_b16 a[80:81], v7 offset:0
 v_accvgpr_write_b32 a1, v29
 v_mfma_f32_16x16x32_bf16 v[84:87], a[64:67], a[112:115], v[84:87]
 s_and_b32 s4, s2, 127
 ds_read_b64_tr_b16 a[82:83], v7 offset:4096
 v_accvgpr_write_b32 a2, v30
 v_mfma_f32_16x16x32_bf16 v[84:87], a[68:71], a[120:123], v[84:87]
 s_lshl_b32 s4, s4, 2
 ds_read_b64_tr_b16 a[84:85], v7 offset:16384
 v_accvgpr_write_b32 a3, v31
 v_mfma_f32_16x16x32_bf16 v[92:95], a[96:99], a[196:199], v[92:95]
 s_add_u32 s4, s4, s3
 ds_read_b64_tr_b16 a[86:87], v7 offset:20480
 v_xor_b32 v8, 65696, v6
 v_mfma_f32_16x16x32_bf16 v[92:95], a[100:103], a[204:207], v[92:95]
 s_lshl_b32 s6, s4, 10
 ds_read_b64_tr_b16 a[88:89], v8 offset:0
 v_mul_f32 v44, s34, v44
 v_mfma_f32_16x16x32_bf16 v[92:95], a[104:107], a[212:215], v[92:95]
 s_add_u32 s6, s6, 83886080
 ds_read_b64_tr_b16 a[90:91], v8 offset:4096
 v_mul_f32 v45, s34, v45
 v_mfma_f32_16x16x32_bf16 v[92:95], a[108:111], a[220:223], v[92:95]
 s_mul_i32 s4, s4, 17408
 ds_read_b64_tr_b16 a[92:93], v8 offset:16384
 v_mul_f32 v46, s34, v46
 v_mfma_f32_16x16x32_bf16 v[92:95], a[64:67], a[116:119], v[92:95]
 s_add_u32 s59, s56, 53248
 ds_read_b64_tr_b16 a[94:95], v8 offset:20480
 v_xor_b32 v9, 131264, v6
 v_mfma_f32_16x16x32_bf16 v[92:95], a[68:71], a[124:127], v[92:95]
 s_waitcnt lgkmcnt(6)
 ds_read_b64_tr_b16 a[96:97], v9 offset:0
 buffer_store_dwordx4 v[200:203], v1, s[12:15], s59 offen offset:0 sc1
 v_mfma_f32_16x16x32_bf16 v[100:103], a[72:75], a[192:195], v[100:103]
 s_add_u32 s4, s4, 67108864
 ds_read_b64_tr_b16 a[98:99], v9 offset:4096
 v_mul_f32 v47, s34, v47
 v_mfma_f32_16x16x32_bf16 v[100:103], a[76:79], a[200:203], v[100:103]
 s_add_u32 s5, s4, 0x2000
 ds_read_b64_tr_b16 a[100:101], v9 offset:16384
 v_mul_f32 v60, s34, v60
 v_mfma_f32_16x16x32_bf16 v[100:103], a[80:83], a[208:211], v[100:103]
 s_waitcnt lgkmcnt(3)
 ds_read_b64_tr_b16 a[102:103], v9 offset:20480
 v_xor_b32 v10, 192, v6
 v_mfma_f32_16x16x32_bf16 v[100:103], a[84:87], a[216:219], v[100:103]
 s_mov_b32 s7, 0
 ds_read_b64_tr_b16 a[104:105], v10 offset:0
 v_mul_f32 v61, s34, v61
 v_mfma_f32_16x16x32_bf16 v[100:103], a[88:91], a[112:115], v[100:103]
 s_mov_b32 s53, 0
 ds_read_b64_tr_b16 a[106:107], v10 offset:4096
 v_mul_f32 v62, s34, v62
 v_mfma_f32_16x16x32_bf16 v[100:103], a[92:95], a[120:123], v[100:103]
 s_cmp_eq_u32 s38, 0
 s_cmov_b32 s4, 2.0
 ds_read_b64_tr_b16 a[108:109], v10 offset:16384
 v_mfma_f32_16x16x32_bf16 v[108:111], a[72:75], a[196:199], v[108:111]
 s_cmp_eq_u32 s38, 0
 s_cmov_b32 s5, 2.0
 ds_read_b64_tr_b16 a[110:111], v10 offset:20480
 v_xor_b32 v7, 65728, v6
 v_mfma_f32_16x16x32_bf16 v[108:111], a[76:79], a[204:207], v[108:111]
 s_cmp_eq_u32 s38, 0
 s_cmov_b32 s6, 2.0
 ds_read_b64_tr_b16 a[64:65], v7 offset:0
 v_mfma_f32_16x16x32_bf16 v[108:111], a[80:83], a[212:215], v[108:111]
 s_add_u32 s59, s56, 53248
 ds_read_b64_tr_b16 a[66:67], v7 offset:4096
 v_mul_f32 v63, s34, v63
 v_mfma_f32_16x16x32_bf16 v[108:111], a[84:87], a[220:223], v[108:111]
 ds_read_b64_tr_b16 a[68:69], v7 offset:16384
 buffer_store_dwordx4 v[208:211], v1, s[12:15], s59 offen offset:1024 sc1
 v_mfma_f32_16x16x32_bf16 v[108:111], a[88:91], a[116:119], v[108:111]
 s_mov_b64 s[8:9], s[12:13]
 ds_read_b64_tr_b16 a[70:71], v7 offset:20480
 v_xor_b32 v8, 131296, v6
 v_mfma_f32_16x16x32_bf16 v[108:111], a[92:95], a[124:127], v[108:111]
 s_waitcnt lgkmcnt(6)
 ds_read_b64_tr_b16 a[72:73], v8 offset:0
 v_cvt_pk_bf16_f32 v44, v44, v45
 v_mfma_f32_16x16x32_bf16 v[116:119], a[96:99], a[192:195], v[116:119]
 s_mov_b32 s10, s14
 ds_read_b64_tr_b16 a[74:75], v8 offset:4096
 v_cvt_pk_bf16_f32 v45, v46, v47
 v_mfma_f32_16x16x32_bf16 v[116:119], a[100:103], a[200:203], v[116:119]
 s_mov_b32 s76, 0
 ds_read_b64_tr_b16 a[76:77], v8 offset:16384
 v_cvt_pk_bf16_f32 v46, v60, v61
 v_mfma_f32_16x16x32_bf16 v[116:119], a[104:107], a[208:211], v[116:119]
 s_waitcnt lgkmcnt(3)
 ds_read_b64_tr_b16 a[78:79], v8 offset:20480
 v_xor_b32 v9, 224, v6
 v_mfma_f32_16x16x32_bf16 v[116:119], a[108:111], a[216:219], v[116:119]
 s_movk_i32 s77, 0x1000
 ds_read_b64_tr_b16 a[80:81], v9 offset:0
 v_cvt_pk_bf16_f32 v47, v62, v63
 v_mfma_f32_16x16x32_bf16 v[116:119], a[64:67], a[112:115], v[116:119]
 s_mov_b32 s51, 0
 ds_read_b64_tr_b16 a[82:83], v9 offset:4096
 v_accvgpr_write_b32 a32, v44
 v_mfma_f32_16x16x32_bf16 v[116:119], a[68:71], a[120:123], v[116:119]
 s_mul_i32 s78, s26, 229376
 ds_read_b64_tr_b16 a[84:85], v9 offset:16384
 v_accvgpr_write_b32 a33, v45
 v_mfma_f32_16x16x32_bf16 v[124:127], a[96:99], a[196:199], v[124:127]
 s_add_u32 s59, s56, 36864
 ds_read_b64_tr_b16 a[86:87], v9 offset:20480
 v_xor_b32 v10, 65760, v6
 v_mfma_f32_16x16x32_bf16 v[124:127], a[100:103], a[204:207], v[124:127]
 ds_read_b64_tr_b16 a[88:89], v10 offset:0
 buffer_store_dwordx4 v[216:219], v1, s[12:15], s59 offen offset:1024 sc1
 v_mfma_f32_16x16x32_bf16 v[124:127], a[104:107], a[212:215], v[124:127]
 s_add_u32 s79, s78, 28672
 ds_read_b64_tr_b16 a[90:91], v10 offset:4096
 v_accvgpr_write_b32 a34, v46
 v_mfma_f32_16x16x32_bf16 v[124:127], a[108:111], a[220:223], v[124:127]
 s_add_u32 s80, s78, 57344
 ds_read_b64_tr_b16 a[92:93], v10 offset:16384
 v_accvgpr_write_b32 a35, v47
 v_mfma_f32_16x16x32_bf16 v[124:127], a[64:67], a[116:119], v[124:127]
 s_add_u32 s81, s78, 86016
 ds_read_b64_tr_b16 a[94:95], v10 offset:20480
 v_xor_b32 v7, 131328, v6
 v_mfma_f32_16x16x32_bf16 v[124:127], a[68:71], a[124:127], v[124:127]
 s_waitcnt lgkmcnt(6)
 ds_read_b64_tr_b16 a[96:97], v7 offset:0
 v_mul_f32 v20, s34, v20
 v_mfma_f32_16x16x32_bf16 v[132:135], a[72:75], a[192:195], v[132:135]
 s_add_u32 s82, s78, 114688
 ds_read_b64_tr_b16 a[98:99], v7 offset:4096
 v_mul_f32 v21, s34, v21
 v_mfma_f32_16x16x32_bf16 v[132:135], a[76:79], a[200:203], v[132:135]
 s_add_u32 s83, s78, 143360
 ds_read_b64_tr_b16 a[100:101], v7 offset:16384
 v_mul_f32 v22, s34, v22
 v_mfma_f32_16x16x32_bf16 v[132:135], a[80:83], a[208:211], v[132:135]
 s_waitcnt lgkmcnt(3)
 ds_read_b64_tr_b16 a[102:103], v7 offset:20480
 v_xor_b32 v8, 256, v6
 v_mfma_f32_16x16x32_bf16 v[132:135], a[84:87], a[216:219], v[132:135]
 s_add_u32 s84, s78, 172032
 ds_read_b64_tr_b16 a[104:105], v8 offset:0
 v_mul_f32 v23, s34, v23
 v_mfma_f32_16x16x32_bf16 v[132:135], a[88:91], a[112:115], v[132:135]
 s_add_u32 s59, s56, 36864
 ds_read_b64_tr_b16 a[106:107], v8 offset:4096
 v_mul_f32 v68, s34, v68
 v_mfma_f32_16x16x32_bf16 v[132:135], a[92:95], a[120:123], v[132:135]
 ds_read_b64_tr_b16 a[108:109], v8 offset:16384
 buffer_store_dwordx4 v[224:227], v1, s[12:15], s59 offen offset:2048 sc1
 v_mfma_f32_16x16x32_bf16 v[140:143], a[72:75], a[196:199], v[140:143]
 s_add_u32 s85, s78, 200704
 ds_read_b64_tr_b16 a[110:111], v8 offset:20480
 v_xor_b32 v9, 65792, v6
 v_mfma_f32_16x16x32_bf16 v[140:143], a[76:79], a[204:207], v[140:143]
 s_add_u32 s59, s62, 0
 ds_read_b64_tr_b16 a[64:65], v9 offset:0
 v_mul_f32 v69, s34, v69
 v_mfma_f32_16x16x32_bf16 v[140:143], a[80:83], a[212:215], v[140:143]
 ds_read_b64_tr_b16 a[66:67], v9 offset:4096
 buffer_store_dwordx4 v[28:31], v1, s[12:15], s59 offen offset:0 sc1
 v_mfma_f32_16x16x32_bf16 v[140:143], a[84:87], a[220:223], v[140:143]
 ds_read_b64_tr_b16 a[68:69], v9 offset:16384
 v_mul_f32 v70, s34, v70
 v_mfma_f32_16x16x32_bf16 v[140:143], a[88:91], a[116:119], v[140:143]
 s_add_u32 s59, s62, 8192
 ds_read_b64_tr_b16 a[70:71], v9 offset:20480
 v_xor_b32 v10, 131360, v6
 v_mfma_f32_16x16x32_bf16 v[140:143], a[92:95], a[124:127], v[140:143]
 s_waitcnt lgkmcnt(6)
 ds_read_b64_tr_b16 a[72:73], v10 offset:0
 buffer_store_dwordx4 v[44:47], v1, s[12:15], s59 offen offset:0 sc1
 v_mfma_f32_16x16x32_bf16 v[148:151], a[96:99], a[192:195], v[148:151]
 ds_read_b64_tr_b16 a[74:75], v10 offset:4096
 v_mul_f32 v71, s34, v71
 v_mfma_f32_16x16x32_bf16 v[148:151], a[100:103], a[200:203], v[148:151]
 s_add_u32 s59, s56, 53248
 ds_read_b64_tr_b16 a[76:77], v10 offset:16384
 v_cvt_pk_bf16_f32 v20, v20, v21
 v_mfma_f32_16x16x32_bf16 v[148:151], a[104:107], a[208:211], v[148:151]
 s_waitcnt lgkmcnt(3)
 ds_read_b64_tr_b16 a[78:79], v10 offset:20480
 v_xor_b32 v7, 288, v6
 v_mfma_f32_16x16x32_bf16 v[148:151], a[108:111], a[216:219], v[148:151]
 ds_read_b64_tr_b16 a[80:81], v7 offset:0
 buffer_store_dwordx4 v[232:235], v1, s[12:15], s59 offen offset:2048 sc1
 v_mfma_f32_16x16x32_bf16 v[148:151], a[64:67], a[112:115], v[148:151]
 ds_read_b64_tr_b16 a[82:83], v7 offset:4096
 v_cvt_pk_bf16_f32 v21, v22, v23
 v_mfma_f32_16x16x32_bf16 v[148:151], a[68:71], a[120:123], v[148:151]
 ds_read_b64_tr_b16 a[84:85], v7 offset:16384
 v_cvt_pk_bf16_f32 v22, v68, v69
 v_mfma_f32_16x16x32_bf16 v[156:159], a[96:99], a[196:199], v[156:159]
 ds_read_b64_tr_b16 a[86:87], v7 offset:20480
 v_xor_b32 v8, 65824, v6
 v_mfma_f32_16x16x32_bf16 v[156:159], a[100:103], a[204:207], v[156:159]
 s_add_u32 s59, s62, 0
 ds_read_b64_tr_b16 a[88:89], v8 offset:0
 v_cvt_pk_bf16_f32 v23, v70, v71
 v_mfma_f32_16x16x32_bf16 v[156:159], a[104:107], a[212:215], v[156:159]
 ds_read_b64_tr_b16 a[90:91], v8 offset:4096
 buffer_store_dwordx4 v[20:23], v1, s[12:15], s59 offen offset:1024 sc1
 v_mfma_f32_16x16x32_bf16 v[156:159], a[108:111], a[220:223], v[156:159]
 ds_read_b64_tr_b16 a[92:93], v8 offset:16384
 v_accvgpr_write_b32 a4, v20
 v_mfma_f32_16x16x32_bf16 v[156:159], a[64:67], a[116:119], v[156:159]
 ds_read_b64_tr_b16 a[94:95], v8 offset:20480
 v_xor_b32 v9, 131392, v6
 v_mfma_f32_16x16x32_bf16 v[156:159], a[68:71], a[124:127], v[156:159]
 s_waitcnt lgkmcnt(6)
 ds_read_b64_tr_b16 a[96:97], v9 offset:0
 v_accvgpr_write_b32 a5, v21
 v_mfma_f32_16x16x32_bf16 v[164:167], a[72:75], a[192:195], v[164:167]
 s_add_u32 s59, s56, 53248
 ds_read_b64_tr_b16 a[98:99], v9 offset:4096
 v_accvgpr_write_b32 a6, v22
 v_mfma_f32_16x16x32_bf16 v[164:167], a[76:79], a[200:203], v[164:167]
 ds_read_b64_tr_b16 a[100:101], v9 offset:16384
 buffer_store_dwordx4 v[240:243], v1, s[12:15], s59 offen offset:3072 sc1
 v_mfma_f32_16x16x32_bf16 v[164:167], a[80:83], a[208:211], v[164:167]
 s_waitcnt lgkmcnt(3)
 ds_read_b64_tr_b16 a[102:103], v9 offset:20480
 v_xor_b32 v10, 320, v6
 v_mfma_f32_16x16x32_bf16 v[164:167], a[84:87], a[216:219], v[164:167]
 ds_read_b64_tr_b16 a[104:105], v10 offset:0
 v_accvgpr_write_b32 a7, v23
 v_mfma_f32_16x16x32_bf16 v[164:167], a[88:91], a[112:115], v[164:167]
 ds_read_b64_tr_b16 a[106:107], v10 offset:4096
 v_mul_f32 v36, s34, v36
 v_mfma_f32_16x16x32_bf16 v[164:167], a[92:95], a[120:123], v[164:167]
 ds_read_b64_tr_b16 a[108:109], v10 offset:16384
 v_mul_f32 v37, s34, v37
 v_mfma_f32_16x16x32_bf16 v[172:175], a[72:75], a[196:199], v[172:175]
 ds_read_b64_tr_b16 a[110:111], v10 offset:20480
 v_xor_b32 v7, 65856, v6
 v_mfma_f32_16x16x32_bf16 v[172:175], a[76:79], a[204:207], v[172:175]
 ds_read_b64_tr_b16 a[64:65], v7 offset:0
 v_mul_f32 v38, s34, v38
 v_mfma_f32_16x16x32_bf16 v[172:175], a[80:83], a[212:215], v[172:175]
 ds_read_b64_tr_b16 a[66:67], v7 offset:4096
 v_mul_f32 v39, s34, v39
 v_mfma_f32_16x16x32_bf16 v[172:175], a[84:87], a[220:223], v[172:175]
 ds_read_b64_tr_b16 a[68:69], v7 offset:16384
 v_mul_f32 v76, s34, v76
 v_mfma_f32_16x16x32_bf16 v[172:175], a[88:91], a[116:119], v[172:175]
 s_add_u32 s59, s56, 36864
 ds_read_b64_tr_b16 a[70:71], v7 offset:20480
 v_xor_b32 v8, 131424, v6
 v_mfma_f32_16x16x32_bf16 v[172:175], a[92:95], a[124:127], v[172:175]
 s_waitcnt lgkmcnt(6)
 ds_read_b64_tr_b16 a[72:73], v8 offset:0
 buffer_store_dwordx4 v[248:251], v1, s[12:15], s59 offen offset:3072 sc1
 v_mfma_f32_16x16x32_bf16 v[180:183], a[96:99], a[192:195], v[180:183]
 ds_read_b64_tr_b16 a[74:75], v8 offset:4096
 v_mul_f32 v77, s34, v77
 v_mfma_f32_16x16x32_bf16 v[180:183], a[100:103], a[200:203], v[180:183]
 ds_read_b64_tr_b16 a[76:77], v8 offset:16384
 v_mul_f32 v78, s34, v78
 v_mfma_f32_16x16x32_bf16 v[180:183], a[104:107], a[208:211], v[180:183]
 s_waitcnt lgkmcnt(3)
 ds_read_b64_tr_b16 a[78:79], v8 offset:20480
 v_xor_b32 v9, 352, v6
 v_mfma_f32_16x16x32_bf16 v[180:183], a[108:111], a[216:219], v[180:183]
 ds_read_b64_tr_b16 a[80:81], v9 offset:0
 v_mul_f32 v79, s34, v79
 v_mfma_f32_16x16x32_bf16 v[180:183], a[64:67], a[112:115], v[180:183]
 ds_read_b64_tr_b16 a[82:83], v9 offset:4096
 v_cvt_pk_bf16_f32 v36, v36, v37
 v_mfma_f32_16x16x32_bf16 v[180:183], a[68:71], a[120:123], v[180:183]
 ds_read_b64_tr_b16 a[84:85], v9 offset:16384
 v_cvt_pk_bf16_f32 v37, v38, v39
 v_mfma_f32_16x16x32_bf16 v[188:191], a[96:99], a[196:199], v[188:191]
 ds_read_b64_tr_b16 a[86:87], v9 offset:20480
 v_xor_b32 v10, 65888, v6
 v_mfma_f32_16x16x32_bf16 v[188:191], a[100:103], a[204:207], v[188:191]
 ds_read_b64_tr_b16 a[88:89], v10 offset:0
 v_cvt_pk_bf16_f32 v38, v76, v77
 v_mfma_f32_16x16x32_bf16 v[188:191], a[104:107], a[212:215], v[188:191]
 s_add_u32 s59, s62, 8192
 ds_read_b64_tr_b16 a[90:91], v10 offset:4096
 v_cvt_pk_bf16_f32 v39, v78, v79
 v_mfma_f32_16x16x32_bf16 v[188:191], a[108:111], a[220:223], v[188:191]
 ds_read_b64_tr_b16 a[92:93], v10 offset:16384
 buffer_store_dwordx4 v[36:39], v1, s[12:15], s59 offen offset:1024 sc1
 v_mfma_f32_16x16x32_bf16 v[188:191], a[64:67], a[116:119], v[188:191]
 ds_read_b64_tr_b16 a[94:95], v10 offset:20480
 v_xor_b32 v7, 131456, v6
 v_mfma_f32_16x16x32_bf16 v[188:191], a[68:71], a[124:127], v[188:191]
 s_waitcnt lgkmcnt(6)
 ds_read_b64_tr_b16 a[96:97], v7 offset:0
 v_accvgpr_write_b32 a36, v36
 v_mfma_f32_16x16x32_bf16 v[196:199], a[72:75], a[192:195], v[196:199]
 ds_read_b64_tr_b16 a[98:99], v7 offset:4096
 v_accvgpr_write_b32 a37, v37
 v_mfma_f32_16x16x32_bf16 v[196:199], a[76:79], a[200:203], v[196:199]
 ds_read_b64_tr_b16 a[100:101], v7 offset:16384
 v_accvgpr_write_b32 a38, v38
 v_mfma_f32_16x16x32_bf16 v[196:199], a[80:83], a[208:211], v[196:199]
 s_waitcnt lgkmcnt(3)
 ds_read_b64_tr_b16 a[102:103], v7 offset:20480
 v_xor_b32 v8, 384, v6
 v_mfma_f32_16x16x32_bf16 v[196:199], a[84:87], a[216:219], v[196:199]
 ds_read_b64_tr_b16 a[104:105], v8 offset:0
 v_accvgpr_write_b32 a39, v39
 v_mfma_f32_16x16x32_bf16 v[196:199], a[88:91], a[112:115], v[196:199]
 ds_read_b64_tr_b16 a[106:107], v8 offset:4096
 v_mul_f32 v84, s34, v84
 v_mfma_f32_16x16x32_bf16 v[196:199], a[92:95], a[120:123], v[196:199]
 ds_read_b64_tr_b16 a[108:109], v8 offset:16384
 v_mul_f32 v85, s34, v85
 v_mfma_f32_16x16x32_bf16 v[204:207], a[72:75], a[196:199], v[204:207]
 ds_read_b64_tr_b16 a[110:111], v8 offset:20480
 v_xor_b32 v9, 65920, v6
 v_mfma_f32_16x16x32_bf16 v[204:207], a[76:79], a[204:207], v[204:207]
 ds_read_b64_tr_b16 a[64:65], v9 offset:0
 v_mul_f32 v86, s34, v86
 v_mfma_f32_16x16x32_bf16 v[204:207], a[80:83], a[212:215], v[204:207]
 ds_read_b64_tr_b16 a[66:67], v9 offset:4096
 v_mul_f32 v87, s34, v87
 v_mfma_f32_16x16x32_bf16 v[204:207], a[84:87], a[220:223], v[204:207]
 ds_read_b64_tr_b16 a[68:69], v9 offset:16384
 v_mul_f32 v100, s34, v100
 v_mfma_f32_16x16x32_bf16 v[204:207], a[88:91], a[116:119], v[204:207]
 ds_read_b64_tr_b16 a[70:71], v9 offset:20480
 v_xor_b32 v10, 131488, v6
 v_mfma_f32_16x16x32_bf16 v[204:207], a[92:95], a[124:127], v[204:207]
 s_waitcnt lgkmcnt(6)
 ds_read_b64_tr_b16 a[72:73], v10 offset:0
 v_mul_f32 v101, s34, v101
 v_mfma_f32_16x16x32_bf16 v[212:215], a[96:99], a[192:195], v[212:215]
 ds_read_b64_tr_b16 a[74:75], v10 offset:4096
 v_mul_f32 v102, s34, v102
 v_mfma_f32_16x16x32_bf16 v[212:215], a[100:103], a[200:203], v[212:215]
 ds_read_b64_tr_b16 a[76:77], v10 offset:16384
 v_mul_f32 v103, s34, v103
 v_mfma_f32_16x16x32_bf16 v[212:215], a[104:107], a[208:211], v[212:215]
 s_waitcnt lgkmcnt(3)
 ds_read_b64_tr_b16 a[78:79], v10 offset:20480
 v_xor_b32 v7, 416, v6
 v_mfma_f32_16x16x32_bf16 v[212:215], a[108:111], a[216:219], v[212:215]
 ds_read_b64_tr_b16 a[80:81], v7 offset:0
 v_cvt_pk_bf16_f32 v84, v84, v85
 v_mfma_f32_16x16x32_bf16 v[212:215], a[64:67], a[112:115], v[212:215]
 ds_read_b64_tr_b16 a[82:83], v7 offset:4096
 v_cvt_pk_bf16_f32 v85, v86, v87
 v_mfma_f32_16x16x32_bf16 v[212:215], a[68:71], a[120:123], v[212:215]
 ds_read_b64_tr_b16 a[84:85], v7 offset:16384
 v_cvt_pk_bf16_f32 v86, v100, v101
 v_mfma_f32_16x16x32_bf16 v[220:223], a[96:99], a[196:199], v[220:223]
 ds_read_b64_tr_b16 a[86:87], v7 offset:20480
 v_xor_b32 v8, 65952, v6
 v_mfma_f32_16x16x32_bf16 v[220:223], a[100:103], a[204:207], v[220:223]
 s_add_u32 s59, s62, 0
 ds_read_b64_tr_b16 a[88:89], v8 offset:0
 v_cvt_pk_bf16_f32 v87, v102, v103
 v_mfma_f32_16x16x32_bf16 v[220:223], a[104:107], a[212:215], v[220:223]
 ds_read_b64_tr_b16 a[90:91], v8 offset:4096
 buffer_store_dwordx4 v[84:87], v1, s[12:15], s59 offen offset:2048 sc1
 v_mfma_f32_16x16x32_bf16 v[220:223], a[108:111], a[220:223], v[220:223]
 ds_read_b64_tr_b16 a[92:93], v8 offset:16384
 v_accvgpr_write_b32 a8, v84
 v_mfma_f32_16x16x32_bf16 v[220:223], a[64:67], a[116:119], v[220:223]
 ds_read_b64_tr_b16 a[94:95], v8 offset:20480
 v_xor_b32 v9, 131520, v6
 v_mfma_f32_16x16x32_bf16 v[220:223], a[68:71], a[124:127], v[220:223]
 s_waitcnt lgkmcnt(6)
 ds_read_b64_tr_b16 a[96:97], v9 offset:0
 v_accvgpr_write_b32 a9, v85
 v_mfma_f32_16x16x32_bf16 v[228:231], a[72:75], a[192:195], v[228:231]
 ds_read_b64_tr_b16 a[98:99], v9 offset:4096
 v_accvgpr_write_b32 a10, v86
 v_mfma_f32_16x16x32_bf16 v[228:231], a[76:79], a[200:203], v[228:231]
 ds_read_b64_tr_b16 a[100:101], v9 offset:16384
 v_accvgpr_write_b32 a11, v87
 v_mfma_f32_16x16x32_bf16 v[228:231], a[80:83], a[208:211], v[228:231]
 s_waitcnt lgkmcnt(3)
 ds_read_b64_tr_b16 a[102:103], v9 offset:20480
 v_xor_b32 v10, 448, v6
 v_mfma_f32_16x16x32_bf16 v[228:231], a[84:87], a[216:219], v[228:231]
 ds_read_b64_tr_b16 a[104:105], v10 offset:0
 v_mul_f32 v92, s34, v92
 v_mfma_f32_16x16x32_bf16 v[228:231], a[88:91], a[112:115], v[228:231]
 ds_read_b64_tr_b16 a[106:107], v10 offset:4096
 v_mul_f32 v93, s34, v93
 v_mfma_f32_16x16x32_bf16 v[228:231], a[92:95], a[120:123], v[228:231]
 ds_read_b64_tr_b16 a[108:109], v10 offset:16384
 v_mul_f32 v94, s34, v94
 v_mfma_f32_16x16x32_bf16 v[236:239], a[72:75], a[196:199], v[236:239]
 ds_read_b64_tr_b16 a[110:111], v10 offset:20480
 v_xor_b32 v7, 65984, v6
 v_mfma_f32_16x16x32_bf16 v[236:239], a[76:79], a[204:207], v[236:239]
 ds_read_b64_tr_b16 a[64:65], v7 offset:0
 buffer_load_dword v13, v12, s[12:15], s58 offen sc1
 v_mfma_f32_16x16x32_bf16 v[236:239], a[80:83], a[212:215], v[236:239]
 ds_read_b64_tr_b16 a[66:67], v7 offset:4096
 v_mul_f32 v95, s34, v95
 v_mfma_f32_16x16x32_bf16 v[236:239], a[84:87], a[220:223], v[236:239]
 ds_read_b64_tr_b16 a[68:69], v7 offset:16384
 v_mul_f32 v108, s34, v108
 v_mfma_f32_16x16x32_bf16 v[236:239], a[88:91], a[116:119], v[236:239]
 ds_read_b64_tr_b16 a[70:71], v7 offset:20480
 v_xor_b32 v8, 131552, v6
 v_mfma_f32_16x16x32_bf16 v[236:239], a[92:95], a[124:127], v[236:239]
 s_waitcnt lgkmcnt(6)
 ds_read_b64_tr_b16 a[72:73], v8 offset:0
 v_mul_f32 v109, s34, v109
 v_mfma_f32_16x16x32_bf16 v[244:247], a[96:99], a[192:195], v[244:247]
 ds_read_b64_tr_b16 a[74:75], v8 offset:4096
 v_mul_f32 v110, s34, v110
 v_mfma_f32_16x16x32_bf16 v[244:247], a[100:103], a[200:203], v[244:247]
 ds_read_b64_tr_b16 a[76:77], v8 offset:16384
 v_mul_f32 v111, s34, v111
 v_mfma_f32_16x16x32_bf16 v[244:247], a[104:107], a[208:211], v[244:247]
 s_waitcnt lgkmcnt(3)
 ds_read_b64_tr_b16 a[78:79], v8 offset:20480
 v_xor_b32 v9, 480, v6
 v_mfma_f32_16x16x32_bf16 v[244:247], a[108:111], a[216:219], v[244:247]
 ds_read_b64_tr_b16 a[80:81], v9 offset:0
 v_cvt_pk_bf16_f32 v92, v92, v93
 v_mfma_f32_16x16x32_bf16 v[244:247], a[64:67], a[112:115], v[244:247]
 ds_read_b64_tr_b16 a[82:83], v9 offset:4096
 v_cvt_pk_bf16_f32 v93, v94, v95
 v_mfma_f32_16x16x32_bf16 v[244:247], a[68:71], a[120:123], v[244:247]
 ds_read_b64_tr_b16 a[84:85], v9 offset:16384
 v_cvt_pk_bf16_f32 v94, v108, v109
 v_mfma_f32_16x16x32_bf16 v[252:255], a[96:99], a[196:199], v[252:255]
 ds_read_b64_tr_b16 a[86:87], v9 offset:20480
 v_xor_b32 v10, 66016, v6
 v_mfma_f32_16x16x32_bf16 v[252:255], a[100:103], a[204:207], v[252:255]
 s_add_u32 s59, s62, 8192
 ds_read_b64_tr_b16 a[88:89], v10 offset:0
 v_cvt_pk_bf16_f32 v95, v110, v111
 v_mfma_f32_16x16x32_bf16 v[252:255], a[104:107], a[212:215], v[252:255]
 ds_read_b64_tr_b16 a[90:91], v10 offset:4096
 buffer_store_dwordx4 v[92:95], v1, s[12:15], s59 offen offset:2048 sc1
 v_mfma_f32_16x16x32_bf16 v[252:255], a[108:111], a[220:223], v[252:255]
 ds_read_b64_tr_b16 a[92:93], v10 offset:16384
 v_accvgpr_write_b32 a40, v92
 v_mfma_f32_16x16x32_bf16 v[252:255], a[64:67], a[116:119], v[252:255]
 ds_read_b64_tr_b16 a[94:95], v10 offset:20480
 v_accvgpr_write_b32 a41, v93
 v_mfma_f32_16x16x32_bf16 v[252:255], a[68:71], a[124:127], v[252:255]
 s_waitcnt lgkmcnt(6)
 v_accvgpr_write_b32 a42, v94
 v_accvgpr_write_b32 a43, v95
 v_mfma_f32_16x16x32_bf16 v[16:19], a[72:75], a[192:195], v[16:19]
 v_mfma_f32_16x16x32_bf16 v[16:19], a[76:79], a[200:203], v[16:19]
 v_mfma_f32_16x16x32_bf16 v[16:19], a[80:83], a[208:211], v[16:19]
 s_waitcnt lgkmcnt(0)
 v_mfma_f32_16x16x32_bf16 v[16:19], a[84:87], a[216:219], v[16:19]
 v_mfma_f32_16x16x32_bf16 v[16:19], a[88:91], a[112:115], v[16:19]
 v_mfma_f32_16x16x32_bf16 v[16:19], a[92:95], a[120:123], v[16:19]
 v_mfma_f32_16x16x32_bf16 v[24:27], a[72:75], a[196:199], v[24:27]
 v_mfma_f32_16x16x32_bf16 v[24:27], a[76:79], a[204:207], v[24:27]
 v_mfma_f32_16x16x32_bf16 v[24:27], a[80:83], a[212:215], v[24:27]
 v_mfma_f32_16x16x32_bf16 v[24:27], a[84:87], a[220:223], v[24:27]
 s_waitcnt lgkmcnt(0)
 v_mfma_f32_16x16x32_bf16 v[24:27], a[88:91], a[116:119], v[24:27]
 s_barrier
 v_mfma_f32_16x16x32_bf16 v[24:27], a[92:95], a[124:127], v[24:27]
 s_waitcnt vmcnt(1)
 v_cmp_ne_u32 s[16:17], 0, v13
 v_cmp_gt_u32 vcc, 256, v5
 s_or_b64 vcc, vcc, s[16:17]
 s_mov_b32 m0, s40
 s_cselect_b32 s48, 0, 1
 s_cselect_b32 s52, 2.0, s42
 buffer_load_dwordx4 v1, s[12:15], s52 offen offset:0 sc1 lds
 v_pk_mul_f32 v[116:117], v[116:117], s[34:35]
 v_pk_mul_f32 v[118:119], v[118:119], s[34:35]
 v_pk_mul_f32 v[132:133], v[132:133], s[34:35]
 v_pk_mul_f32 v[134:135], v[134:135], s[34:35]
 v_cvt_pk_bf16_f32 v116, v116, v117
 v_cvt_pk_bf16_f32 v117, v118, v119
 v_cvt_pk_bf16_f32 v118, v132, v133
 v_cvt_pk_bf16_f32 v119, v134, v135
 s_add_u32 s59, s62, 0
 buffer_store_dwordx4 v[116:119], v1, s[12:15], s59 offen offset:3072 sc1
 v_accvgpr_write_b32 a12, v116
 v_accvgpr_write_b32 a13, v117
 v_accvgpr_write_b32 a14, v118
 v_accvgpr_write_b32 a15, v119
 v_pk_mul_f32 v[124:125], v[124:125], s[34:35]
 v_pk_mul_f32 v[126:127], v[126:127], s[34:35]
 v_pk_mul_f32 v[140:141], v[140:141], s[34:35]
 v_pk_mul_f32 v[142:143], v[142:143], s[34:35]
 buffer_load_dwordx4 v1, s[12:15], s52 offen offset:1024 sc1 lds
 v_cvt_pk_bf16_f32 v124, v124, v125
 v_cvt_pk_bf16_f32 v125, v126, v127
 v_cvt_pk_bf16_f32 v126, v140, v141
 v_cvt_pk_bf16_f32 v127, v142, v143
 s_add_u32 s59, s62, 8192
 buffer_store_dwordx4 v[124:127], v1, s[12:15], s59 offen offset:3072 sc1
 v_accvgpr_write_b32 a44, v124
 v_accvgpr_write_b32 a45, v125
 v_accvgpr_write_b32 a46, v126
 v_accvgpr_write_b32 a47, v127
 v_pk_mul_f32 v[148:149], v[148:149], s[34:35]
 v_pk_mul_f32 v[150:151], v[150:151], s[34:35]
 v_pk_mul_f32 v[164:165], v[164:165], s[34:35]
 v_pk_mul_f32 v[166:167], v[166:167], s[34:35]
 v_cvt_pk_bf16_f32 v148, v148, v149
 v_cvt_pk_bf16_f32 v149, v150, v151
 v_cvt_pk_bf16_f32 v150, v164, v165
 buffer_load_dwordx4 v1, s[12:15], s52 offen offset:2048 sc1 lds
 v_cvt_pk_bf16_f32 v151, v166, v167
 s_add_u32 s59, s62, 4096
 buffer_store_dwordx4 v[148:151], v1, s[12:15], s59 offen offset:0 sc1
 v_accvgpr_write_b32 a16, v148
 v_accvgpr_write_b32 a17, v149
 v_accvgpr_write_b32 a18, v150
 v_accvgpr_write_b32 a19, v151
 v_pk_mul_f32 v[156:157], v[156:157], s[34:35]
 v_pk_mul_f32 v[158:159], v[158:159], s[34:35]
 v_pk_mul_f32 v[172:173], v[172:173], s[34:35]
 v_pk_mul_f32 v[174:175], v[174:175], s[34:35]
 v_cvt_pk_bf16_f32 v156, v156, v157
 v_cvt_pk_bf16_f32 v157, v158, v159
 v_cvt_pk_bf16_f32 v158, v172, v173
 v_cvt_pk_bf16_f32 v159, v174, v175
 s_add_u32 s59, s62, 12288
 buffer_store_dwordx4 v[156:159], v1, s[12:15], s59 offen offset:0 sc1
 v_accvgpr_write_b32 a48, v156
 buffer_load_dwordx4 v1, s[12:15], s52 offen offset:3072 sc1 lds
 v_accvgpr_write_b32 a49, v157
 v_accvgpr_write_b32 a50, v158
 v_accvgpr_write_b32 a51, v159
 v_pk_mul_f32 v[180:181], v[180:181], s[34:35]
 v_pk_mul_f32 v[182:183], v[182:183], s[34:35]
 v_pk_mul_f32 v[196:197], v[196:197], s[34:35]
 v_pk_mul_f32 v[198:199], v[198:199], s[34:35]
 v_cvt_pk_bf16_f32 v180, v180, v181
 v_cvt_pk_bf16_f32 v181, v182, v183
 v_cvt_pk_bf16_f32 v182, v196, v197
 v_cvt_pk_bf16_f32 v183, v198, v199
 s_add_u32 s59, s62, 4096
 buffer_store_dwordx4 v[180:183], v1, s[12:15], s59 offen offset:1024 sc1
 v_accvgpr_write_b32 a20, v180
 v_accvgpr_write_b32 a21, v181
 v_accvgpr_write_b32 a22, v182
 v_accvgpr_write_b32 a23, v183
 s_bitset1_b32 m0, 12
 s_nop 0
 buffer_load_dwordx4 v4, s[12:15], s52 offen offset:0 sc1 lds
 v_pk_mul_f32 v[188:189], v[188:189], s[34:35]
 v_pk_mul_f32 v[190:191], v[190:191], s[34:35]
 v_pk_mul_f32 v[204:205], v[204:205], s[34:35]
 v_pk_mul_f32 v[206:207], v[206:207], s[34:35]
 v_cvt_pk_bf16_f32 v188, v188, v189
 v_cvt_pk_bf16_f32 v189, v190, v191
 v_cvt_pk_bf16_f32 v190, v204, v205
 v_cvt_pk_bf16_f32 v191, v206, v207
 s_add_u32 s59, s62, 12288
 buffer_store_dwordx4 v[188:191], v1, s[12:15], s59 offen offset:1024 sc1
 v_accvgpr_write_b32 a52, v188
 v_accvgpr_write_b32 a53, v189
 v_accvgpr_write_b32 a54, v190
 v_accvgpr_write_b32 a55, v191
 v_pk_mul_f32 v[212:213], v[212:213], s[34:35]
 v_pk_mul_f32 v[214:215], v[214:215], s[34:35]
 v_pk_mul_f32 v[228:229], v[228:229], s[34:35]
 v_pk_mul_f32 v[230:231], v[230:231], s[34:35]
 buffer_load_dwordx4 v4, s[12:15], s52 offen offset:1024 sc1 lds
 v_cvt_pk_bf16_f32 v212, v212, v213
 v_cvt_pk_bf16_f32 v213, v214, v215
 v_cvt_pk_bf16_f32 v214, v228, v229
 v_cvt_pk_bf16_f32 v215, v230, v231
 s_add_u32 s59, s62, 4096
 buffer_store_dwordx4 v[212:215], v1, s[12:15], s59 offen offset:2048 sc1
 v_accvgpr_write_b32 a24, v212
 v_accvgpr_write_b32 a25, v213
 v_accvgpr_write_b32 a26, v214
 v_accvgpr_write_b32 a27, v215
 v_pk_mul_f32 v[220:221], v[220:221], s[34:35]
 v_pk_mul_f32 v[222:223], v[222:223], s[34:35]
 v_pk_mul_f32 v[236:237], v[236:237], s[34:35]
 v_pk_mul_f32 v[238:239], v[238:239], s[34:35]
 v_cvt_pk_bf16_f32 v220, v220, v221
 v_cvt_pk_bf16_f32 v221, v222, v223
 v_cvt_pk_bf16_f32 v222, v236, v237
 buffer_load_dwordx4 v4, s[12:15], s52 offen offset:2048 sc1 lds
 v_cvt_pk_bf16_f32 v223, v238, v239
 s_add_u32 s59, s62, 12288
 buffer_store_dwordx4 v[220:223], v1, s[12:15], s59 offen offset:2048 sc1
 v_accvgpr_write_b32 a56, v220
 v_accvgpr_write_b32 a57, v221
 v_accvgpr_write_b32 a58, v222
 v_accvgpr_write_b32 a59, v223
 v_pk_mul_f32 v[244:245], v[244:245], s[34:35]
 v_pk_mul_f32 v[246:247], v[246:247], s[34:35]
 v_pk_mul_f32 v[16:17], v[16:17], s[34:35]
 v_pk_mul_f32 v[18:19], v[18:19], s[34:35]
 v_cvt_pk_bf16_f32 v244, v244, v245
 v_cvt_pk_bf16_f32 v245, v246, v247
 v_cvt_pk_bf16_f32 v246, v16, v17
 v_cvt_pk_bf16_f32 v247, v18, v19
 s_add_u32 s59, s62, 4096
 buffer_store_dwordx4 v[244:247], v1, s[12:15], s59 offen offset:3072 sc1
 v_accvgpr_write_b32 a28, v244
 buffer_load_dwordx4 v4, s[12:15], s52 offen offset:3072 sc1 lds
 v_accvgpr_write_b32 a29, v245
 v_accvgpr_write_b32 a30, v246
 v_accvgpr_write_b32 a31, v247
 v_pk_mul_f32 v[252:253], v[252:253], s[34:35]
 v_pk_mul_f32 v[254:255], v[254:255], s[34:35]
 v_pk_mul_f32 v[24:25], v[24:25], s[34:35]
 v_pk_mul_f32 v[26:27], v[26:27], s[34:35]
 v_cvt_pk_bf16_f32 v252, v252, v253
 v_cvt_pk_bf16_f32 v253, v254, v255
 v_cvt_pk_bf16_f32 v254, v24, v25
 v_cvt_pk_bf16_f32 v255, v26, v27
 s_add_u32 s59, s62, 12288
 buffer_store_dwordx4 v[252:255], v1, s[12:15], s59 offen offset:3072 sc1
 v_accvgpr_write_b32 a60, v252
 v_accvgpr_write_b32 a61, v253
 v_accvgpr_write_b32 a62, v254
 v_accvgpr_write_b32 a63, v255
L_kvdone:
 s_load_dword s31, s[74:75], s30
 s_cmp_ge_u32 s28, 14
 s_cbranch_scc1 L_s1b
 s_mov_b32 s36, 0xffff0000
 s_and_b32 s33, s95, 31
 s_lshr_b32 s34, s95, 5
 v_lshlrev_b32 v128, 16, v32
 v_and_b32 v129, s36, v32
 v_lshlrev_b32 v130, 16, v40
 v_and_b32 v131, s36, v40
 v_lshlrev_b32 v132, 16, v48
 v_and_b32 v133, s36, v48
 v_lshlrev_b32 v134, 16, v56
 v_and_b32 v135, s36, v56
 v_lshlrev_b32 v136, 16, v64
 v_and_b32 v137, s36, v64
 v_lshlrev_b32 v138, 16, v72
 v_and_b32 v139, s36, v72
 v_lshlrev_b32 v140, 16, v80
 v_and_b32 v141, s36, v80
 v_lshlrev_b32 v142, 16, v88
 v_lshlrev_b32 v143, 16, v90
 v_and_b32 v144, s36, v88
 v_and_b32 v145, s36, v90
 v_lshlrev_b32 v146, 16, v89
 v_lshlrev_b32 v147, 16, v91
 v_and_b32 v148, s36, v89
 v_and_b32 v149, s36, v91
 v_pk_mul_f32 v[150:151], v[128:129], v[148:149]
 v_pk_fma_f32 v[150:151], v[130:131], v[146:147], v[150:151]
 v_pk_fma_f32 v[150:151], v[132:133], v[144:145], v[150:151]
 v_pk_fma_f32 v[150:151], v[134:135], v[142:143], v[150:151]
 v_pk_mul_f32 v[150:151], v[150:151], v[138:139]
 v_cvt_pk_bf16_f32 v16, v150, v151
 v_pk_mul_f32 v[152:153], v[130:131], v[148:149]
 v_pk_fma_f32 v[152:153], v[132:133], v[146:147], v[152:153]
 v_pk_fma_f32 v[152:153], v[134:135], v[144:145], v[152:153]
 v_pk_fma_f32 v[152:153], v[136:137], v[142:143], v[152:153]
 v_pk_mul_f32 v[152:153], v[152:153], v[140:141]
 v_cvt_pk_bf16_f32 v20, v152, v153
 v_lshlrev_b32 v128, 16, v33
 v_and_b32 v129, s36, v33
 v_lshlrev_b32 v130, 16, v41
 v_and_b32 v131, s36, v41
 v_lshlrev_b32 v132, 16, v49
 v_and_b32 v133, s36, v49
 v_lshlrev_b32 v134, 16, v57
 v_and_b32 v135, s36, v57
 v_lshlrev_b32 v136, 16, v65
 v_and_b32 v137, s36, v65
 v_lshlrev_b32 v138, 16, v73
 v_and_b32 v139, s36, v73
 v_lshlrev_b32 v140, 16, v81
 v_and_b32 v141, s36, v81
 v_lshlrev_b32 v142, 16, v96
 v_lshlrev_b32 v143, 16, v98
 v_and_b32 v144, s36, v96
 v_and_b32 v145, s36, v98
 v_lshlrev_b32 v146, 16, v97
 v_lshlrev_b32 v147, 16, v99
 v_and_b32 v148, s36, v97
 v_and_b32 v149, s36, v99
 v_pk_mul_f32 v[150:151], v[128:129], v[148:149]
 v_pk_fma_f32 v[150:151], v[130:131], v[146:147], v[150:151]
 v_pk_fma_f32 v[150:151], v[132:133], v[144:145], v[150:151]
 v_pk_fma_f32 v[150:151], v[134:135], v[142:143], v[150:151]
 v_pk_mul_f32 v[150:151], v[150:151], v[138:139]
 v_cvt_pk_bf16_f32 v17, v150, v151
 v_pk_mul_f32 v[152:153], v[130:131], v[148:149]
 v_pk_fma_f32 v[152:153], v[132:133], v[146:147], v[152:153]
 v_pk_fma_f32 v[152:153], v[134:135], v[144:145], v[152:153]
 v_pk_fma_f32 v[152:153], v[136:137], v[142:143], v[152:153]
 v_pk_mul_f32 v[152:153], v[152:153], v[140:141]
 v_cvt_pk_bf16_f32 v21, v152, v153
 v_lshlrev_b32 v128, 16, v34
 v_and_b32 v129, s36, v34
 v_lshlrev_b32 v130, 16, v42
 v_and_b32 v131, s36, v42
 v_lshlrev_b32 v132, 16, v50
 v_and_b32 v133, s36, v50
 v_lshlrev_b32 v134, 16, v58
 v_and_b32 v135, s36, v58
 v_lshlrev_b32 v136, 16, v66
 v_and_b32 v137, s36, v66
 v_lshlrev_b32 v138, 16, v74
 v_and_b32 v139, s36, v74
 v_lshlrev_b32 v140, 16, v82
 v_and_b32 v141, s36, v82
 v_lshlrev_b32 v142, 16, v104
 v_lshlrev_b32 v143, 16, v106
 v_and_b32 v144, s36, v104
 v_and_b32 v145, s36, v106
 v_lshlrev_b32 v146, 16, v105
 v_lshlrev_b32 v147, 16, v107
 v_and_b32 v148, s36, v105
 v_and_b32 v149, s36, v107
 v_pk_mul_f32 v[150:151], v[128:129], v[148:149]
 v_pk_fma_f32 v[150:151], v[130:131], v[146:147], v[150:151]
 v_pk_fma_f32 v[150:151], v[132:133], v[144:145], v[150:151]
 v_pk_fma_f32 v[150:151], v[134:135], v[142:143], v[150:151]
 v_pk_mul_f32 v[150:151], v[150:151], v[138:139]
 v_cvt_pk_bf16_f32 v18, v150, v151
 v_pk_mul_f32 v[152:153], v[130:131], v[148:149]
 v_pk_fma_f32 v[152:153], v[132:133], v[146:147], v[152:153]
 v_pk_fma_f32 v[152:153], v[134:135], v[144:145], v[152:153]
 v_pk_fma_f32 v[152:153], v[136:137], v[142:143], v[152:153]
 v_pk_mul_f32 v[152:153], v[152:153], v[140:141]
 v_cvt_pk_bf16_f32 v22, v152, v153
 v_lshlrev_b32 v128, 16, v35
 v_and_b32 v129, s36, v35
 v_lshlrev_b32 v130, 16, v43
 v_and_b32 v131, s36, v43
 v_lshlrev_b32 v132, 16, v51
 v_and_b32 v133, s36, v51
 v_lshlrev_b32 v134, 16, v59
 v_and_b32 v135, s36, v59
 v_lshlrev_b32 v136, 16, v67
 v_and_b32 v137, s36, v67
 v_lshlrev_b32 v138, 16, v75
 v_and_b32 v139, s36, v75
 v_lshlrev_b32 v140, 16, v83
 v_and_b32 v141, s36, v83
 v_lshlrev_b32 v142, 16, v112
 v_lshlrev_b32 v143, 16, v114
 v_and_b32 v144, s36, v112
 v_and_b32 v145, s36, v114
 v_lshlrev_b32 v146, 16, v113
 v_lshlrev_b32 v147, 16, v115
 v_and_b32 v148, s36, v113
 v_and_b32 v149, s36, v115
 v_pk_mul_f32 v[150:151], v[128:129], v[148:149]
 v_pk_fma_f32 v[150:151], v[130:131], v[146:147], v[150:151]
 v_pk_fma_f32 v[150:151], v[132:133], v[144:145], v[150:151]
 v_pk_fma_f32 v[150:151], v[134:135], v[142:143], v[150:151]
 v_pk_mul_f32 v[150:151], v[150:151], v[138:139]
 v_cvt_pk_bf16_f32 v19, v150, v151
 v_pk_mul_f32 v[152:153], v[130:131], v[148:149]
 v_pk_fma_f32 v[152:153], v[132:133], v[146:147], v[152:153]
 v_pk_fma_f32 v[152:153], v[134:135], v[144:145], v[152:153]
 v_pk_fma_f32 v[152:153], v[136:137], v[142:143], v[152:153]
 v_pk_mul_f32 v[152:153], v[152:153], v[140:141]
 v_cvt_pk_bf16_f32 v23, v152, v153
 v_lshrrev_b32 v26, 3, v0
 v_lshlrev_b32 v26, 8, v26
 v_and_b32 v25, 7, v0
 v_lshl_add_u32 v26, v25, 4, v26
 s_lshl_b32 s35, s3, 11
 s_add_u32 s35, s35, 0x20000
 v_add_u32 v26, s35, v26
 ds_write_b128 v26, v[16:19] offset:0
 ds_write_b128 v26, v[20:23] offset:128
 v_bfe_u32 v24, v0, 2, 2
 v_bfe_u32 v28, v0, 4, 1
 v_lshl_add_u32 v24, v28, 3, v24
 v_lshlrev_b32 v24, 2, v24
 v_lshrrev_b32 v28, 5, v0
 v_add_u32 v24, v24, v28
 v_lshlrev_b32 v24, 7, v24
 v_and_b32 v28, 3, v0
 v_lshl_add_u32 v24, v28, 3, v24
 s_lshl_b32 s35, s3, 5
 s_add_u32 s35, s35, 0x20000
 v_add_u32 v24, s35, v24
 v_and_b32 v25, 15, v0
 v_mul_u32_u24 v25, 4096, v25
 v_lshrrev_b32 v28, 4, v0
 v_lshl_add_u32 v25, v28, 4, v25
 s_lshl_b32 s35, s34, 2
 s_add_u32 s35, s35, s3
 s_mul_i32 s35, s35, 65536
 s_lshl_b32 s36, s33, 7
 s_add_u32 s35, s35, s36
 s_add_u32 s35, s35, 85983232
L_s1b:
 s_add_u32 s52, s52, s70
 s_or_b32 m0, s40, 0x8000
 s_nop 0
 buffer_load_dwordx4 v1, s[12:15], s52 offen offset:0 sc1 lds
 v_mov_b32 v2, v1
 v_add_u32 v3, 0x10000, v1
 v_mov_b64 v[96:97], 0
 v_mov_b64 v[98:99], 0
 v_mov_b64 v[100:101], 0
 v_mov_b64 v[102:103], 0
 v_mov_b64 v[104:105], 0
 v_mov_b64 v[106:107], 0
 v_mov_b64 v[108:109], 0
 v_mov_b64 v[110:111], 0
 v_mov_b64 v[112:113], 0
 v_mov_b64 v[114:115], 0
 buffer_load_dwordx4 v1, s[12:15], s52 offen offset:1024 sc1 lds
 v_mov_b64 v[116:117], 0
 v_mov_b64 v[118:119], 0
 v_mov_b64 v[120:121], 0
 v_mov_b64 v[122:123], 0
 v_mov_b64 v[124:125], 0
 v_mov_b64 v[126:127], 0
 v_mov_b64 v[128:129], 0
 v_mov_b64 v[130:131], 0
 v_mov_b64 v[132:133], 0
 v_mov_b64 v[134:135], 0
 v_mov_b64 v[136:137], 0
 v_mov_b64 v[138:139], 0
 buffer_load_dwordx4 v1, s[12:15], s52 offen offset:2048 sc1 lds
 v_mov_b64 v[140:141], 0
 v_mov_b64 v[142:143], 0
 v_mov_b64 v[144:145], 0
 v_mov_b64 v[146:147], 0
 v_mov_b64 v[148:149], 0
 v_mov_b64 v[150:151], 0
 v_mov_b64 v[152:153], 0
 v_mov_b64 v[154:155], 0
 v_mov_b64 v[156:157], 0
 v_mov_b64 v[158:159], 0
 v_mov_b64 v[160:161], 0
 buffer_load_dwordx4 v1, s[12:15], s52 offen offset:3072 sc1 lds
 v_mov_b64 v[162:163], 0
 v_mov_b64 v[164:165], 0
 v_mov_b64 v[166:167], 0
 v_mov_b64 v[168:169], 0
 v_mov_b64 v[170:171], 0
 v_mov_b64 v[172:173], 0
 v_mov_b64 v[174:175], 0
 v_mov_b64 v[176:177], 0
 v_mov_b64 v[178:179], 0
 v_mov_b64 v[180:181], 0
 v_mov_b64 v[182:183], 0
 v_mov_b64 v[184:185], 0
 s_bitset1_b32 m0, 12
 s_nop 0
 buffer_load_dwordx4 v4, s[12:15], s52 offen offset:0 sc1 lds
 v_mov_b64 v[186:187], 0
 v_mov_b64 v[188:189], 0
 v_mov_b64 v[190:191], 0
 v_mov_b64 v[192:193], 0
 v_mov_b64 v[194:195], 0
 v_mov_b64 v[196:197], 0
 v_mov_b64 v[198:199], 0
 v_mov_b64 v[200:201], 0
 v_mov_b64 v[202:203], 0
 v_mov_b64 v[204:205], 0
 v_mov_b64 v[206:207], 0
 v_mov_b64 v[208:209], 0
 buffer_load_dwordx4 v4, s[12:15], s52 offen offset:1024 sc1 lds
 v_mov_b64 v[210:211], 0
 v_mov_b64 v[212:213], 0
 v_mov_b64 v[214:215], 0
 v_mov_b64 v[216:217], 0
 v_mov_b64 v[218:219], 0
 v_mov_b64 v[220:221], 0
 v_mov_b64 v[222:223], 0
 v_mov_b64 v[224:225], 0
 v_mov_b64 v[226:227], 0
 v_mov_b64 v[228:229], 0
 v_mov_b64 v[230:231], 0
 buffer_load_dwordx4 v4, s[12:15], s52 offen offset:2048 sc1 lds
 v_mov_b64 v[232:233], 0
 v_mov_b64 v[234:235], 0
 v_mov_b64 v[236:237], 0
 v_mov_b64 v[238:239], 0
 v_mov_b64 v[240:241], 0
 v_mov_b64 v[242:243], 0
 v_mov_b64 v[244:245], 0
 v_mov_b64 v[246:247], 0
 v_mov_b64 v[248:249], 0
 v_mov_b64 v[250:251], 0
 v_mov_b64 v[252:253], 0
 v_mov_b64 v[254:255], 0
 buffer_load_dwordx4 v4, s[12:15], s52 offen offset:3072 sc1 lds
 v_mov_b32 v7, 0
 v_mov_b32 v8, 0
 v_mov_b32 v9, 0
 v_mov_b32 v10, 0
 v_mov_b32 v13, v1
 v_mul_u32_u24 v15, s27, v12
 v_accvgpr_write_b32 a246, 1
 v_accvgpr_write_b32 a247, 1
 s_cmp_lt_u32 s28, 14
 s_cselect_b32 s62, 1, 0
 s_andn2_b32 s62, s62, s27
 s_cmp_ge_u32 s44, 2
 s_cbranch_scc1 L_nomask0
 v_accvgpr_read_b32 v96, a224
 v_accvgpr_read_b32 v97, a225
 v_accvgpr_read_b32 v98, a226
 v_accvgpr_read_b32 v99, a227
 v_accvgpr_read_b32 v104, a228
 v_accvgpr_read_b32 v105, a229
 v_accvgpr_read_b32 v106, a230
 v_accvgpr_read_b32 v107, a231
 v_accvgpr_read_b32 v112, a232
 v_accvgpr_read_b32 v113, a233
 v_accvgpr_read_b32 v114, a234
 v_accvgpr_read_b32 v115, a235
 v_accvgpr_read_b32 v120, a236
 v_accvgpr_read_b32 v121, a237
 v_accvgpr_read_b32 v122, a238
 v_accvgpr_read_b32 v123, a239
L_nomask0:
 v_accvgpr_read_b32 v27, a245
 s_lshl_b32 s36, s95, 2
 s_add_u32 s36, s36, 84959232
 s_cmp_lt_u32 s28, 14
 s_cselect_b32 s36, s36, 2.0
 s_add_u32 s33, s94, 4
 s_cmp_eq_u32 s27, 1
 s_cselect_b32 s33, s33, 2.0
 s_cmp_eq_u32 s48, 0
 s_cbranch_scc1 L_kvlate
 s_add_u32 s42, s52, s70
L_kvok:
 s_waitcnt vmcnt(8) lgkmcnt(0)
 s_barrier
 ds_read_b128 a[64:67], v2 offset:0
 ds_read_b128 a[68:71], v2 offset:1024
 ds_read_b128 a[72:75], v2 offset:2048
 ds_read_b128 a[76:79], v2 offset:3072
 ds_read_b128 a[80:83], v2 offset:4096
 ds_read_b128 a[84:87], v2 offset:5120
 ds_read_b128 a[88:91], v2 offset:6144
 ds_read_b128 a[92:95], v2 offset:7168
 buffer_store_dword v27, v27, s[12:15], s1 offen sc1
 buffer_store_dword v27, v27, s[12:15], s33 offen sc1
 s_cmp_ge_u32 s28, 14
 s_cbranch_scc1 L_s1c
 ds_read_b64_tr_b16 v[16:17], v24 offset:0
 ds_read_b64_tr_b16 v[18:19], v24 offset:2048
 ds_read_b64_tr_b16 v[20:21], v24 offset:256
 ds_read_b64_tr_b16 v[22:23], v24 offset:2304
 s_waitcnt lgkmcnt(0)
 buffer_store_dwordx4 v[16:19], v25, s[12:15], s35 offen offset:0 sc1
 buffer_store_dwordx4 v[20:23], v25, s[12:15], s35 offen offset:64 sc1
L_s1c:
 s_mov_b32 m0, s41
 s_waitcnt lgkmcnt(0)
 v_mfma_f32_16x16x32_bf16 v[32:35], a[64:67], a[0:3], v[96:99]
 ds_read_b128 a[96:99], v2 offset:8192
 v_mfma_f32_16x16x32_bf16 v[32:35], a[68:71], a[4:7], v[32:35]
 buffer_load_dwordx4 v1, s[12:15], s43 offen offset:0 sc1 lds
 v_mfma_f32_16x16x32_bf16 v[32:35], a[72:75], a[8:11], v[32:35]
 ds_read_b128 a[100:103], v2 offset:9216
 v_mfma_f32_16x16x32_bf16 v[32:35], a[76:79], a[12:15], v[32:35]
 v_mfma_f32_16x16x32_bf16 v[32:35], a[80:83], a[16:19], v[32:35]
 ds_read_b128 a[104:107], v2 offset:10240
 v_mfma_f32_16x16x32_bf16 v[32:35], a[84:87], a[20:23], v[32:35]
 buffer_load_dwordx4 v1, s[12:15], s43 offen offset:1024 sc1 lds
 v_mfma_f32_16x16x32_bf16 v[32:35], a[88:91], a[24:27], v[32:35]
 ds_read_b128 a[108:111], v2 offset:11264
 v_mfma_f32_16x16x32_bf16 v[32:35], a[92:95], a[28:31], v[32:35]
 v_mfma_f32_16x16x32_bf16 v[36:39], a[64:67], a[32:35], v[100:103]
 ds_read_b128 a[112:115], v2 offset:12288
 v_mfma_f32_16x16x32_bf16 v[36:39], a[68:71], a[36:39], v[36:39]
 buffer_load_dwordx4 v1, s[12:15], s43 offen offset:2048 sc1 lds
 v_mfma_f32_16x16x32_bf16 v[36:39], a[72:75], a[40:43], v[36:39]
 ds_read_b128 a[116:119], v2 offset:13312
 v_mfma_f32_16x16x32_bf16 v[36:39], a[76:79], a[44:47], v[36:39]
 v_mfma_f32_16x16x32_bf16 v[36:39], a[80:83], a[48:51], v[36:39]
 ds_read_b128 a[120:123], v2 offset:14336
 v_mfma_f32_16x16x32_bf16 v[36:39], a[84:87], a[52:55], v[36:39]
 buffer_load_dwordx4 v1, s[12:15], s43 offen offset:3072 sc1 lds
 v_mfma_f32_16x16x32_bf16 v[36:39], a[88:91], a[56:59], v[36:39]
 ds_read_b128 a[124:127], v2 offset:15360
 v_mfma_f32_16x16x32_bf16 v[36:39], a[92:95], a[60:63], v[36:39]
 s_waitcnt lgkmcnt(6)
 v_exp_f32 v64, v32
 v_mfma_f32_16x16x32_bf16 v[40:43], a[96:99], a[0:3], v[104:107]
 s_bitset1_b32 m0, 12
 ds_read_b128 a[64:67], v2 offset:16384
 v_mfma_f32_16x16x32_bf16 v[40:43], a[100:103], a[4:7], v[40:43]
 s_waitcnt lgkmcnt(5)
 buffer_load_dwordx4 v4, s[12:15], s43 offen offset:0 sc1 lds
 v_mfma_f32_16x16x32_bf16 v[40:43], a[104:107], a[8:11], v[40:43]
 ds_read_b128 a[68:71], v2 offset:17408
 v_mfma_f32_16x16x32_bf16 v[40:43], a[108:111], a[12:15], v[40:43]
 s_waitcnt lgkmcnt(4)
 v_exp_f32 v65, v33
 v_mfma_f32_16x16x32_bf16 v[40:43], a[112:115], a[16:19], v[40:43]
 ds_read_b128 a[72:75], v2 offset:18432
 v_add_f32 v5, v64, v65
 v_mfma_f32_16x16x32_bf16 v[40:43], a[116:119], a[20:23], v[40:43]
 s_waitcnt lgkmcnt(3)
 buffer_load_dwordx4 v4, s[12:15], s43 offen offset:1024 sc1 lds
 v_mfma_f32_16x16x32_bf16 v[40:43], a[120:123], a[24:27], v[40:43]
 ds_read_b128 a[76:79], v2 offset:19456
 v_mfma_f32_16x16x32_bf16 v[40:43], a[124:127], a[28:31], v[40:43]
 v_exp_f32 v66, v34
 v_mfma_f32_16x16x32_bf16 v[44:47], a[96:99], a[32:35], v[108:111]
 ds_read_b128 a[80:83], v2 offset:20480
 v_add_f32 v5, v5, v66
 v_mfma_f32_16x16x32_bf16 v[44:47], a[100:103], a[36:39], v[44:47]
 buffer_load_dwordx4 v4, s[12:15], s43 offen offset:2048 sc1 lds
 v_mfma_f32_16x16x32_bf16 v[44:47], a[104:107], a[40:43], v[44:47]
 ds_read_b128 a[84:87], v2 offset:21504
 v_mfma_f32_16x16x32_bf16 v[44:47], a[108:111], a[44:47], v[44:47]
 v_exp_f32 v67, v35
 v_mfma_f32_16x16x32_bf16 v[44:47], a[112:115], a[48:51], v[44:47]
 ds_read_b128 a[88:91], v2 offset:22528
 v_add_f32 v5, v5, v67
 v_mfma_f32_16x16x32_bf16 v[44:47], a[116:119], a[52:55], v[44:47]
 buffer_load_dwordx4 v4, s[12:15], s43 offen offset:3072 sc1 lds
 v_mfma_f32_16x16x32_bf16 v[44:47], a[120:123], a[56:59], v[44:47]
 ds_read_b128 a[92:95], v2 offset:23552
 v_mfma_f32_16x16x32_bf16 v[44:47], a[124:127], a[60:63], v[44:47]
 s_waitcnt lgkmcnt(6)
 v_exp_f32 v68, v36
 v_mfma_f32_16x16x32_bf16 v[48:51], a[64:67], a[0:3], v[112:115]
 s_add_u32 s43, s43, s71
 ds_read_b128 a[96:99], v2 offset:24576
 v_mfma_f32_16x16x32_bf16 v[48:51], a[68:71], a[4:7], v[48:51]
 s_waitcnt lgkmcnt(5)
 v_exp_f32 v69, v37
 v_mfma_f32_16x16x32_bf16 v[48:51], a[72:75], a[8:11], v[48:51]
 s_xor_b32 s41, s41, 0x8000
 ds_read_b128 a[100:103], v2 offset:25600
 v_add_f32 v6, v68, v69
 v_mfma_f32_16x16x32_bf16 v[48:51], a[76:79], a[12:15], v[48:51]
 s_waitcnt lgkmcnt(4)
 v_exp_f32 v70, v38
 v_mfma_f32_16x16x32_bf16 v[48:51], a[80:83], a[16:19], v[48:51]
 ds_read_b128 a[104:107], v2 offset:26624
 v_add_f32 v6, v6, v70
 v_mfma_f32_16x16x32_bf16 v[48:51], a[84:87], a[20:23], v[48:51]
 s_waitcnt lgkmcnt(3)
 v_exp_f32 v71, v39
 v_mfma_f32_16x16x32_bf16 v[48:51], a[88:91], a[24:27], v[48:51]
 ds_read_b128 a[108:111], v2 offset:27648
 v_add_f32 v6, v6, v71
 v_mfma_f32_16x16x32_bf16 v[48:51], a[92:95], a[28:31], v[48:51]
 v_exp_f32 v72, v40
 v_mfma_f32_16x16x32_bf16 v[52:55], a[64:67], a[32:35], v[116:119]
 ds_read_b128 a[112:115], v2 offset:28672
 v_add_f32 v5, v5, v72
 v_mfma_f32_16x16x32_bf16 v[52:55], a[68:71], a[36:39], v[52:55]
 v_exp_f32 v73, v41
 v_mfma_f32_16x16x32_bf16 v[52:55], a[72:75], a[40:43], v[52:55]
 ds_read_b128 a[116:119], v2 offset:29696
 v_add_f32 v5, v5, v73
 v_mfma_f32_16x16x32_bf16 v[52:55], a[76:79], a[44:47], v[52:55]
 v_exp_f32 v74, v42
 v_mfma_f32_16x16x32_bf16 v[52:55], a[80:83], a[48:51], v[52:55]
 ds_read_b128 a[120:123], v2 offset:30720
 v_add_f32 v5, v5, v74
 v_mfma_f32_16x16x32_bf16 v[52:55], a[84:87], a[52:55], v[52:55]
 v_exp_f32 v75, v43
 v_mfma_f32_16x16x32_bf16 v[52:55], a[88:91], a[56:59], v[52:55]
 ds_read_b128 a[124:127], v2 offset:31744
 v_add_f32 v5, v5, v75
 v_mfma_f32_16x16x32_bf16 v[52:55], a[92:95], a[60:63], v[52:55]
 s_waitcnt lgkmcnt(6)
 v_exp_f32 v76, v44
 v_mfma_f32_16x16x32_bf16 v[56:59], a[96:99], a[0:3], v[120:123]
 v_exp_f32 v77, v45
 v_mfma_f32_16x16x32_bf16 v[56:59], a[100:103], a[4:7], v[56:59]
 s_waitcnt lgkmcnt(4)
 v_exp_f32 v78, v46
 v_mfma_f32_16x16x32_bf16 v[56:59], a[104:107], a[8:11], v[56:59]
 v_exp_f32 v79, v47
 v_mfma_f32_16x16x32_bf16 v[56:59], a[108:111], a[12:15], v[56:59]
 s_waitcnt lgkmcnt(2)
 v_exp_f32 v80, v48
 v_mfma_f32_16x16x32_bf16 v[56:59], a[112:115], a[16:19], v[56:59]
 v_exp_f32 v81, v49
 v_mfma_f32_16x16x32_bf16 v[56:59], a[116:119], a[20:23], v[56:59]
 s_waitcnt lgkmcnt(0)
 v_exp_f32 v82, v50
 v_mfma_f32_16x16x32_bf16 v[56:59], a[120:123], a[24:27], v[56:59]
 v_exp_f32 v83, v51
 v_mfma_f32_16x16x32_bf16 v[56:59], a[124:127], a[28:31], v[56:59]
 v_exp_f32 v84, v52
 v_mfma_f32_16x16x32_bf16 v[60:63], a[96:99], a[32:35], v[124:127]
 v_exp_f32 v85, v53
 v_mfma_f32_16x16x32_bf16 v[60:63], a[100:103], a[36:39], v[60:63]
 v_exp_f32 v86, v54
 v_mfma_f32_16x16x32_bf16 v[60:63], a[104:107], a[40:43], v[60:63]
 v_exp_f32 v87, v55
 v_mfma_f32_16x16x32_bf16 v[60:63], a[108:111], a[44:47], v[60:63]
 v_add_f32 v6, v6, v76
 v_mfma_f32_16x16x32_bf16 v[60:63], a[112:115], a[48:51], v[60:63]
 v_add_f32 v6, v6, v77
 v_mfma_f32_16x16x32_bf16 v[60:63], a[116:119], a[52:55], v[60:63]
 v_exp_f32 v88, v56
 v_mfma_f32_16x16x32_bf16 v[60:63], a[120:123], a[56:59], v[60:63]
 v_exp_f32 v89, v57
 v_mfma_f32_16x16x32_bf16 v[60:63], a[124:127], a[60:63], v[60:63]
 v_exp_f32 v90, v58
 v_xor_b32 v2, 0x8000, v2
 s_waitcnt vmcnt(8)
 s_barrier
 ds_read_b128 a[64:67], v2 offset:0
 ds_read_b128 a[68:71], v2 offset:1024
 ds_read_b128 a[72:75], v2 offset:2048
 ds_read_b128 a[76:79], v2 offset:3072
 ds_read_b128 a[80:83], v2 offset:4096
 ds_read_b128 a[84:87], v2 offset:5120
 ds_read_b128 a[88:91], v2 offset:6144
 ds_read_b128 a[92:95], v2 offset:7168
 buffer_store_dword v27, v27, s[12:15], s36 offen sc1
 v_exp_f32 v91, v59
 v_exp_f32 v92, v60
 v_exp_f32 v93, v61
 v_exp_f32 v94, v62
 v_exp_f32 v95, v63
 v_add_f32 v6, v6, v78
 v_add_f32 v6, v6, v79
 v_add_f32 v5, v5, v80
 v_add_f32 v5, v5, v81
 v_add_f32 v5, v5, v82
 v_add_f32 v5, v5, v83
 v_add_f32 v6, v6, v84
 v_add_f32 v6, v6, v85
 v_add_f32 v6, v6, v86
 v_add_f32 v6, v6, v87
 v_add_f32 v5, v5, v88
 v_add_f32 v5, v5, v89
 v_add_f32 v5, v5, v90
 v_add_f32 v5, v5, v91
 v_add_f32 v6, v6, v92
 v_add_f32 v6, v6, v93
 v_add_f32 v6, v6, v94
 v_add_f32 v6, v6, v95
L_first:
 v_add_f32 v11, v5, v6
 v_min_f32 v12, v5, v6
 v_cmp_nge_f32 vcc, s47, v11
 s_mov_b32 s46, 0xff800000
 s_cbranch_vccnz L_slow2
 v_cmp_gt_f32 vcc, 0x33800000, v12
 s_cbranch_vccnz L_rowchk
L_firstok:
 s_mov_b32 s46, 0
 s_waitcnt lgkmcnt(0)
 s_cmp_gt_u32 s44, s45
 s_cbranch_scc0 L_ret2
.p2align 6
L_loop:
 v_mfma_f32_16x16x32_bf16 v[32:35], a[64:67], a[0:3], v[96:99]
 s_mov_b32 m0, s40
 ds_read_b128 a[96:99], v2 offset:8192
 v_cvt_pk_bf16_f32 v16, v64, v65
 v_mfma_f32_16x16x32_bf16 v[32:35], a[68:71], a[4:7], v[32:35]
 s_waitcnt lgkmcnt(5)
 buffer_load_dwordx4 v13, s[8:11], s42 offen offset:0 sc1 lds
 v_mfma_f32_16x16x32_bf16 v[32:35], a[72:75], a[8:11], v[32:35]
 ds_read_b128 a[100:103], v2 offset:9216
 v_cvt_pk_bf16_f32 v17, v66, v67
 v_mfma_f32_16x16x32_bf16 v[32:35], a[76:79], a[12:15], v[32:35]
 s_waitcnt lgkmcnt(4)
 v_cvt_pk_bf16_f32 v20, v68, v69
 v_cvt_pk_bf16_f32 v21, v70, v71
 v_mfma_f32_16x16x32_bf16 v[32:35], a[80:83], a[16:19], v[32:35]
 s_add_u32 s39, s42, s76
 ds_read_b128 a[104:107], v2 offset:10240
 v_add_f32 v7, v7, v5
 v_mfma_f32_16x16x32_bf16 v[32:35], a[84:87], a[20:23], v[32:35]
 s_waitcnt lgkmcnt(3)
 v_add_f32 v8, v8, v6
 v_cvt_pk_bf16_f32 v18, v72, v73
 v_mfma_f32_16x16x32_bf16 v[32:35], a[88:91], a[24:27], v[32:35]
 ds_read_b128 a[108:111], v2 offset:11264
 v_cvt_pk_bf16_f32 v19, v74, v75
 v_mfma_f32_16x16x32_bf16 v[32:35], a[92:95], a[28:31], v[32:35]
 buffer_load_dwordx4 v13, s[8:11], s39 offen offset:1024 sc1 lds
 v_mfma_f32_16x16x32_bf16 v[36:39], a[64:67], a[32:35], v[100:103]
 ds_read_b128 a[112:115], v2 offset:12288
 v_cvt_pk_bf16_f32 v22, v76, v77
 v_mfma_f32_16x16x32_bf16 v[36:39], a[68:71], a[36:39], v[36:39]
 v_cvt_pk_bf16_f32 v23, v78, v79
 v_cvt_pk_bf16_f32 v24, v80, v81
 v_mfma_f32_16x16x32_bf16 v[36:39], a[72:75], a[40:43], v[36:39]
 s_add_u32 s39, s39, s76
 ds_read_b128 a[116:119], v2 offset:13312
 v_cvt_pk_bf16_f32 v25, v82, v83
 v_mfma_f32_16x16x32_bf16 v[36:39], a[76:79], a[44:47], v[36:39]
 v_cvt_pk_bf16_f32 v28, v84, v85
 v_cvt_pk_bf16_f32 v29, v86, v87
 v_mfma_f32_16x16x32_bf16 v[36:39], a[80:83], a[48:51], v[36:39]
 ds_read_b128 a[120:123], v2 offset:14336
 v_cvt_pk_bf16_f32 v26, v88, v89
 v_mfma_f32_16x16x32_bf16 v[36:39], a[84:87], a[52:55], v[36:39]
 buffer_load_dwordx4 v13, s[8:11], s39 offen offset:2048 sc1 lds
 v_mfma_f32_16x16x32_bf16 v[36:39], a[88:91], a[56:59], v[36:39]
 ds_read_b128 a[124:127], v2 offset:15360
 v_cvt_pk_bf16_f32 v27, v90, v91
 v_mfma_f32_16x16x32_bf16 v[36:39], a[92:95], a[60:63], v[36:39]
 s_waitcnt lgkmcnt(6)
 v_exp_f32 v64, v32
 v_mfma_f32_16x16x32_bf16 v[40:43], a[96:99], a[0:3], v[104:107]
 s_add_u32 s39, s39, s76
 ds_read_b128 a[64:67], v2 offset:16384
 v_cvt_pk_bf16_f32 v30, v92, v93
 v_mfma_f32_16x16x32_bf16 v[40:43], a[100:103], a[4:7], v[40:43]
 s_waitcnt lgkmcnt(5)
 v_exp_f32 v65, v33
 v_mfma_f32_16x16x32_bf16 v[40:43], a[104:107], a[8:11], v[40:43]
 ds_read_b128 a[68:71], v2 offset:17408
 v_cvt_pk_bf16_f32 v31, v94, v95
 v_mfma_f32_16x16x32_bf16 v[40:43], a[108:111], a[12:15], v[40:43]
 s_waitcnt lgkmcnt(4)
 buffer_load_dwordx4 v13, s[8:11], s39 offen offset:3072 sc1 lds
 v_mfma_f32_16x16x32_bf16 v[40:43], a[112:115], a[16:19], v[40:43]
 ds_read_b128 a[72:75], v2 offset:18432
 v_add_f32 v5, v64, v65
 v_mfma_f32_16x16x32_bf16 v[40:43], a[116:119], a[20:23], v[40:43]
 s_waitcnt lgkmcnt(3)
 v_exp_f32 v66, v34
 v_mfma_f32_16x16x32_bf16 v[40:43], a[120:123], a[24:27], v[40:43]
 s_add_u32 s39, s39, s77
 ds_read_b128 a[76:79], v2 offset:19456
 v_add_f32 v5, v5, v66
 v_mfma_f32_16x16x32_bf16 v[40:43], a[124:127], a[28:31], v[40:43]
 v_exp_f32 v67, v35
 v_mfma_f32_16x16x32_bf16 v[44:47], a[96:99], a[32:35], v[108:111]
 s_bitset1_b32 m0, 12
 ds_read_b128 a[80:83], v2 offset:20480
 v_add_f32 v5, v5, v67
 v_mfma_f32_16x16x32_bf16 v[44:47], a[100:103], a[36:39], v[44:47]
 buffer_load_dwordx4 v13, s[8:11], s39 offen offset:0 sc1 lds
 v_mfma_f32_16x16x32_bf16 v[44:47], a[104:107], a[40:43], v[44:47]
 ds_read_b128 a[84:87], v2 offset:21504
 v_mfma_f32_16x16x32_bf16 v[44:47], a[108:111], a[44:47], v[44:47]
 v_exp_f32 v68, v36
 v_mfma_f32_16x16x32_bf16 v[44:47], a[112:115], a[48:51], v[44:47]
 s_add_u32 s39, s39, s76
 ds_read_b128 a[88:91], v2 offset:22528
 v_mfma_f32_16x16x32_bf16 v[44:47], a[116:119], a[52:55], v[44:47]
 v_exp_f32 v69, v37
 v_mfma_f32_16x16x32_bf16 v[44:47], a[120:123], a[56:59], v[44:47]
 ds_read_b128 a[92:95], v2 offset:23552
 v_add_f32 v6, v68, v69
 v_mfma_f32_16x16x32_bf16 v[44:47], a[124:127], a[60:63], v[44:47]
 s_waitcnt lgkmcnt(6)
 buffer_load_dwordx4 v13, s[8:11], s39 offen offset:1024 sc1 lds
 v_mfma_f32_16x16x32_bf16 v[48:51], a[64:67], a[0:3], v[112:115]
 ds_read_b128 a[96:99], v2 offset:24576
 v_mfma_f32_16x16x32_bf16 v[48:51], a[68:71], a[4:7], v[48:51]
 s_waitcnt lgkmcnt(5)
 v_exp_f32 v70, v38
 v_mfma_f32_16x16x32_bf16 v[48:51], a[72:75], a[8:11], v[48:51]
 s_add_u32 s39, s39, s76
 ds_read_b128 a[100:103], v2 offset:25600
 v_add_f32 v6, v6, v70
 v_mfma_f32_16x16x32_bf16 v[48:51], a[76:79], a[12:15], v[48:51]
 s_waitcnt lgkmcnt(4)
 v_exp_f32 v71, v39
 v_mfma_f32_16x16x32_bf16 v[48:51], a[80:83], a[16:19], v[48:51]
 ds_read_b128 a[104:107], v2 offset:26624
 v_add_f32 v6, v6, v71
 v_mfma_f32_16x16x32_bf16 v[48:51], a[84:87], a[20:23], v[48:51]
 s_waitcnt lgkmcnt(3)
 buffer_load_dwordx4 v13, s[8:11], s39 offen offset:2048 sc1 lds
 v_mfma_f32_16x16x32_bf16 v[48:51], a[88:91], a[24:27], v[48:51]
 ds_read_b128 a[108:111], v2 offset:27648
 v_mfma_f32_16x16x32_bf16 v[48:51], a[92:95], a[28:31], v[48:51]
 v_exp_f32 v72, v40
 v_mfma_f32_16x16x32_bf16 v[52:55], a[64:67], a[32:35], v[116:119]
 s_add_u32 s39, s39, s76
 ds_read_b128 a[112:115], v2 offset:28672
 v_add_f32 v5, v5, v72
 v_mfma_f32_16x16x32_bf16 v[52:55], a[68:71], a[36:39], v[52:55]
 v_exp_f32 v73, v41
 v_mfma_f32_16x16x32_bf16 v[52:55], a[72:75], a[40:43], v[52:55]
 s_xor_b32 s40, s40, 0x8000
 ds_read_b128 a[116:119], v2 offset:29696
 v_add_f32 v5, v5, v73
 v_mfma_f32_16x16x32_bf16 v[52:55], a[76:79], a[44:47], v[52:55]
 buffer_load_dwordx4 v13, s[8:11], s39 offen offset:3072 sc1 lds
 v_mfma_f32_16x16x32_bf16 v[52:55], a[80:83], a[48:51], v[52:55]
 s_add_u32 s42, s42, s70
 ds_read_b128 a[120:123], v2 offset:30720
 v_mfma_f32_16x16x32_bf16 v[52:55], a[84:87], a[52:55], v[52:55]
 v_exp_f32 v74, v42
 v_mfma_f32_16x16x32_bf16 v[52:55], a[88:91], a[56:59], v[52:55]
 s_waitcnt vmcnt(8) lgkmcnt(5)
 ds_read_b128 a[124:127], v2 offset:31744
 v_add_f32 v5, v5, v74
 v_mfma_f32_16x16x32_bf16 v[52:55], a[92:95], a[60:63], v[52:55]
 s_barrier
 v_mfma_f32_16x16x32_bf16 v[56:59], a[96:99], a[0:3], v[120:123]
 s_mov_b32 m0, s41
 ds_read_b128 a[64:67], v3 offset:0
 v_xor_b32 v2, 0x8000, v2
 v_mfma_f32_16x16x32_bf16 v[56:59], a[100:103], a[4:7], v[56:59]
 s_waitcnt lgkmcnt(5)
 buffer_load_dwordx4 v1, s[12:15], s43 offen offset:0 sc1 lds
 v_mfma_f32_16x16x32_bf16 v[56:59], a[104:107], a[8:11], v[56:59]
 s_cmp_eq_u32 s42, s66
 ds_read_b128 a[68:71], v3 offset:16384
 v_mfma_f32_16x16x32_bf16 v[56:59], a[108:111], a[12:15], v[56:59]
 s_waitcnt lgkmcnt(4)
 v_exp_f32 v75, v43
 v_mfma_f32_16x16x32_bf16 v[56:59], a[112:115], a[16:19], v[56:59]
 s_cmov_b32 s42, s67
 ds_read_b128 a[72:75], v3 offset:1024
 v_add_f32 v5, v5, v75
 v_mfma_f32_16x16x32_bf16 v[56:59], a[116:119], a[20:23], v[56:59]
 s_waitcnt lgkmcnt(3)
 v_exp_f32 v76, v44
 v_mfma_f32_16x16x32_bf16 v[56:59], a[120:123], a[24:27], v[56:59]
 s_cmov_b32 s70, 32768
 ds_read_b128 a[76:79], v3 offset:17408
 v_add_f32 v6, v6, v76
 v_mfma_f32_16x16x32_bf16 v[56:59], a[124:127], a[28:31], v[56:59]
 buffer_load_dwordx4 v1, s[12:15], s43 offen offset:1024 sc1 lds
 v_mfma_f32_16x16x32_bf16 v[60:63], a[96:99], a[32:35], v[124:127]
 ds_read_b128 a[80:83], v3 offset:2048
 v_mfma_f32_16x16x32_bf16 v[60:63], a[100:103], a[36:39], v[60:63]
 v_exp_f32 v77, v45
 v_mfma_f32_16x16x32_bf16 v[60:63], a[104:107], a[40:43], v[60:63]
 ds_read_b128 a[84:87], v3 offset:18432
 v_add_f32 v6, v6, v77
 v_mfma_f32_16x16x32_bf16 v[60:63], a[108:111], a[44:47], v[60:63]
 v_exp_f32 v78, v46
 v_mfma_f32_16x16x32_bf16 v[60:63], a[112:115], a[48:51], v[60:63]
 ds_read_b128 a[88:91], v3 offset:3072
 v_add_f32 v6, v6, v78
 v_mfma_f32_16x16x32_bf16 v[60:63], a[116:119], a[52:55], v[60:63]
 buffer_load_dwordx4 v1, s[12:15], s43 offen offset:2048 sc1 lds
 v_mfma_f32_16x16x32_bf16 v[60:63], a[120:123], a[56:59], v[60:63]
 ds_read_b128 a[92:95], v3 offset:19456
 v_mfma_f32_16x16x32_bf16 v[60:63], a[124:127], a[60:63], v[60:63]
 s_waitcnt lgkmcnt(6)
 v_exp_f32 v79, v47
 v_mfma_f32_16x16x32_bf16 v[128:131], a[64:67], v[16:19], v[128:131]
 ds_read_b128 a[96:99], v3 offset:4096
 v_add_f32 v6, v6, v79
 v_mfma_f32_16x16x32_bf16 v[128:131], a[68:71], v[24:27], v[128:131]
 v_exp_f32 v80, v48
 v_mfma_f32_16x16x32_bf16 v[192:195], a[68:71], v[28:31], v[192:195]
 ds_read_b128 a[100:103], v3 offset:20480
 v_add_f32 v5, v5, v80
 v_mfma_f32_16x16x32_bf16 v[192:195], a[64:67], v[20:23], v[192:195]
 s_waitcnt lgkmcnt(6)
 buffer_load_dwordx4 v1, s[12:15], s43 offen offset:3072 sc1 lds
 v_mfma_f32_16x16x32_bf16 v[132:135], a[72:75], v[16:19], v[132:135]
 ds_read_b128 a[104:107], v3 offset:5120
 v_mfma_f32_16x16x32_bf16 v[132:135], a[76:79], v[24:27], v[132:135]
 v_exp_f32 v81, v49
 v_mfma_f32_16x16x32_bf16 v[196:199], a[76:79], v[28:31], v[196:199]
 ds_read_b128 a[108:111], v3 offset:21504
 v_add_f32 v5, v5, v81
 v_mfma_f32_16x16x32_bf16 v[196:199], a[72:75], v[20:23], v[196:199]
 s_waitcnt lgkmcnt(6)
 v_exp_f32 v82, v50
 v_mfma_f32_16x16x32_bf16 v[136:139], a[80:83], v[16:19], v[136:139]
 s_bitset1_b32 m0, 12
 ds_read_b128 a[112:115], v3 offset:6144
 v_add_f32 v5, v5, v82
 v_mfma_f32_16x16x32_bf16 v[136:139], a[84:87], v[24:27], v[136:139]
 buffer_load_dwordx4 v4, s[12:15], s43 offen offset:0 sc1 lds
 v_mfma_f32_16x16x32_bf16 v[200:203], a[84:87], v[28:31], v[200:203]
 ds_read_b128 a[116:119], v3 offset:22528
 v_mfma_f32_16x16x32_bf16 v[200:203], a[80:83], v[20:23], v[200:203]
 s_waitcnt lgkmcnt(6)
 v_exp_f32 v83, v51
 v_mfma_f32_16x16x32_bf16 v[140:143], a[88:91], v[16:19], v[140:143]
 ds_read_b128 a[120:123], v3 offset:7168
 v_add_f32 v5, v5, v83
 v_mfma_f32_16x16x32_bf16 v[140:143], a[92:95], v[24:27], v[140:143]
 v_exp_f32 v84, v52
 v_mfma_f32_16x16x32_bf16 v[204:207], a[92:95], v[28:31], v[204:207]
 ds_read_b128 a[124:127], v3 offset:23552
 v_add_f32 v6, v6, v84
 v_mfma_f32_16x16x32_bf16 v[204:207], a[88:91], v[20:23], v[204:207]
 s_waitcnt lgkmcnt(6)
 buffer_load_dwordx4 v4, s[12:15], s43 offen offset:1024 sc1 lds
 v_mfma_f32_16x16x32_bf16 v[144:147], a[96:99], v[16:19], v[144:147]
 ds_read_b128 a[64:67], v3 offset:8192
 v_mfma_f32_16x16x32_bf16 v[144:147], a[100:103], v[24:27], v[144:147]
 v_exp_f32 v85, v53
 v_mfma_f32_16x16x32_bf16 v[208:211], a[100:103], v[28:31], v[208:211]
 ds_read_b128 a[68:71], v3 offset:24576
 v_add_f32 v6, v6, v85
 v_mfma_f32_16x16x32_bf16 v[208:211], a[96:99], v[20:23], v[208:211]
 s_waitcnt lgkmcnt(6)
 v_exp_f32 v86, v54
 v_mfma_f32_16x16x32_bf16 v[148:151], a[104:107], v[16:19], v[148:151]
 ds_read_b128 a[72:75], v3 offset:9216
 v_add_f32 v6, v6, v86
 v_mfma_f32_16x16x32_bf16 v[148:151], a[108:111], v[24:27], v[148:151]
 buffer_load_dwordx4 v4, s[12:15], s43 offen offset:2048 sc1 lds
 v_mfma_f32_16x16x32_bf16 v[212:215], a[108:111], v[28:31], v[212:215]
 ds_read_b128 a[76:79], v3 offset:25600
 v_mfma_f32_16x16x32_bf16 v[212:215], a[104:107], v[20:23], v[212:215]
 s_waitcnt lgkmcnt(6)
 v_exp_f32 v87, v55
 v_mfma_f32_16x16x32_bf16 v[152:155], a[112:115], v[16:19], v[152:155]
 ds_read_b128 a[80:83], v3 offset:10240
 v_add_f32 v6, v6, v87
 v_mfma_f32_16x16x32_bf16 v[152:155], a[116:119], v[24:27], v[152:155]
 v_exp_f32 v88, v56
 v_mfma_f32_16x16x32_bf16 v[216:219], a[116:119], v[28:31], v[216:219]
 s_xor_b32 s41, s41, 0x8000
 ds_read_b128 a[84:87], v3 offset:26624
 v_add_f32 v5, v5, v88
 v_mfma_f32_16x16x32_bf16 v[216:219], a[112:115], v[20:23], v[216:219]
 s_waitcnt lgkmcnt(6)
 buffer_load_dwordx4 v4, s[12:15], s43 offen offset:3072 sc1 lds
 v_mfma_f32_16x16x32_bf16 v[156:159], a[120:123], v[16:19], v[156:159]
 s_add_u32 s43, s43, s71
 ds_read_b128 a[88:91], v3 offset:11264
 v_mfma_f32_16x16x32_bf16 v[156:159], a[124:127], v[24:27], v[156:159]
 v_exp_f32 v89, v57
 v_mfma_f32_16x16x32_bf16 v[220:223], a[124:127], v[28:31], v[220:223]
 s_cmp_eq_u32 s43, s68
 ds_read_b128 a[92:95], v3 offset:27648
 v_add_f32 v5, v5, v89
 v_mfma_f32_16x16x32_bf16 v[220:223], a[120:123], v[20:23], v[220:223]
 s_waitcnt lgkmcnt(6)
 v_exp_f32 v90, v58
 v_mfma_f32_16x16x32_bf16 v[160:163], a[64:67], v[16:19], v[160:163]
 s_cmov_b32 s43, s69
 ds_read_b128 a[96:99], v3 offset:12288
 v_add_f32 v5, v5, v90
 v_mfma_f32_16x16x32_bf16 v[160:163], a[68:71], v[24:27], v[160:163]
 s_cmov_b32 s71, 32768
 v_exp_f32 v91, v59
 v_mfma_f32_16x16x32_bf16 v[224:227], a[68:71], v[28:31], v[224:227]
 ds_read_b128 a[100:103], v3 offset:28672
 v_add_f32 v5, v5, v91
 v_mfma_f32_16x16x32_bf16 v[224:227], a[64:67], v[20:23], v[224:227]
 s_waitcnt lgkmcnt(6)
 v_exp_f32 v92, v60
 v_mfma_f32_16x16x32_bf16 v[164:167], a[72:75], v[16:19], v[164:167]
 ds_read_b128 a[104:107], v3 offset:13312
 v_add_f32 v6, v6, v92
 v_mfma_f32_16x16x32_bf16 v[164:167], a[76:79], v[24:27], v[164:167]
 v_exp_f32 v93, v61
 v_mfma_f32_16x16x32_bf16 v[228:231], a[76:79], v[28:31], v[228:231]
 ds_read_b128 a[108:111], v3 offset:29696
 v_add_f32 v6, v6, v93
 v_mfma_f32_16x16x32_bf16 v[228:231], a[72:75], v[20:23], v[228:231]
 s_waitcnt lgkmcnt(6)
 v_exp_f32 v94, v62
 v_mfma_f32_16x16x32_bf16 v[168:171], a[80:83], v[16:19], v[168:171]
 ds_read_b128 a[112:115], v3 offset:14336
 v_add_f32 v6, v6, v94
 v_mfma_f32_16x16x32_bf16 v[168:171], a[84:87], v[24:27], v[168:171]
 v_exp_f32 v95, v63
 v_mfma_f32_16x16x32_bf16 v[232:235], a[84:87], v[28:31], v[232:235]
 ds_read_b128 a[116:119], v3 offset:30720
 v_add_f32 v6, v6, v95
 v_mfma_f32_16x16x32_bf16 v[232:235], a[80:83], v[20:23], v[232:235]
 s_waitcnt lgkmcnt(6)
 v_add_f32 v11, v5, v6
 v_mfma_f32_16x16x32_bf16 v[172:175], a[88:91], v[16:19], v[172:175]
 ds_read_b128 a[120:123], v3 offset:15360
 v_cmp_nge_f32 vcc, s47, v11
 v_mfma_f32_16x16x32_bf16 v[172:175], a[92:95], v[24:27], v[172:175]
 buffer_load_dword a246, v15, s[12:15], s60 offen sc1
 v_mfma_f32_16x16x32_bf16 v[236:239], a[92:95], v[28:31], v[236:239]
 s_waitcnt vmcnt(9) lgkmcnt(5)
 ds_read_b128 a[124:127], v3 offset:31744
 v_mfma_f32_16x16x32_bf16 v[236:239], a[88:91], v[20:23], v[236:239]
 s_barrier
 v_mfma_f32_16x16x32_bf16 v[176:179], a[96:99], v[16:19], v[176:179]
 ds_read_b128 a[64:67], v2 offset:0
 v_xor_b32 v3, 0x8000, v3
 v_mfma_f32_16x16x32_bf16 v[176:179], a[100:103], v[24:27], v[176:179]
 v_mfma_f32_16x16x32_bf16 v[240:243], a[100:103], v[28:31], v[240:243]
 ds_read_b128 a[68:71], v2 offset:1024
 v_mfma_f32_16x16x32_bf16 v[240:243], a[96:99], v[20:23], v[240:243]
 s_waitcnt lgkmcnt(6)
 v_mfma_f32_16x16x32_bf16 v[180:183], a[104:107], v[16:19], v[180:183]
 ds_read_b128 a[72:75], v2 offset:2048
 v_mfma_f32_16x16x32_bf16 v[180:183], a[108:111], v[24:27], v[180:183]
 v_mfma_f32_16x16x32_bf16 v[244:247], a[108:111], v[28:31], v[244:247]
 ds_read_b128 a[76:79], v2 offset:3072
 v_mfma_f32_16x16x32_bf16 v[244:247], a[104:107], v[20:23], v[244:247]
 s_waitcnt lgkmcnt(6)
 v_mfma_f32_16x16x32_bf16 v[184:187], a[112:115], v[16:19], v[184:187]
 s_sub_u32 s44, s44, 1
 ds_read_b128 a[80:83], v2 offset:4096
 v_mfma_f32_16x16x32_bf16 v[184:187], a[116:119], v[24:27], v[184:187]
 v_mfma_f32_16x16x32_bf16 v[248:251], a[116:119], v[28:31], v[248:251]
 ds_read_b128 a[84:87], v2 offset:5120
 v_mfma_f32_16x16x32_bf16 v[248:251], a[112:115], v[20:23], v[248:251]
 s_waitcnt lgkmcnt(6)
 v_mfma_f32_16x16x32_bf16 v[188:191], a[120:123], v[16:19], v[188:191]
 s_cmp_gt_u32 s44, s45
 ds_read_b128 a[88:91], v2 offset:6144
 v_mfma_f32_16x16x32_bf16 v[188:191], a[124:127], v[24:27], v[188:191]
 s_cselect_b64 vcc, vcc, -1
 v_mfma_f32_16x16x32_bf16 v[252:255], a[124:127], v[28:31], v[252:255]
 s_waitcnt lgkmcnt(5)
 ds_read_b128 a[92:95], v2 offset:7168
 v_mfma_f32_16x16x32_bf16 v[252:255], a[120:123], v[20:23], v[252:255]
 s_cbranch_vccz L_loop
 v_cmp_nge_f32 vcc, s47, v11
 s_cbranch_vccnz L_slow
L_ret2:
 s_cmp_lg_u32 s44, 2
 s_cbranch_scc1 L_disp
 v_mfma_f32_16x16x32_bf16 v[36:39], a[64:67], a[32:35], v[100:103]
 s_mov_b32 m0, s40
 ds_read_b128 a[96:99], v2 offset:8192
 v_accvgpr_read_b32 v96, a224
 v_mfma_f32_16x16x32_bf16 v[36:39], a[68:71], a[36:39], v[36:39]
 s_waitcnt lgkmcnt(5)
 buffer_load_dwordx4 v1, s[12:15], s42 offen offset:0 sc1 lds
 v_mfma_f32_16x16x32_bf16 v[36:39], a[72:75], a[40:43], v[36:39]
 ds_read_b128 a[100:103], v2 offset:9216
 v_accvgpr_read_b32 v97, a225
 v_mfma_f32_16x16x32_bf16 v[36:39], a[76:79], a[44:47], v[36:39]
 s_waitcnt lgkmcnt(4)
 v_accvgpr_read_b32 v98, a226
 v_accvgpr_read_b32 v99, a227
 v_mfma_f32_16x16x32_bf16 v[36:39], a[80:83], a[48:51], v[36:39]
 ds_read_b128 a[104:107], v2 offset:10240
 v_cvt_pk_bf16_f32 v20, v68, v69
 v_mfma_f32_16x16x32_bf16 v[36:39], a[84:87], a[52:55], v[36:39]
 s_waitcnt lgkmcnt(3)
 v_cvt_pk_bf16_f32 v21, v70, v71
 v_cvt_pk_bf16_f32 v16, v64, v65
 v_mfma_f32_16x16x32_bf16 v[36:39], a[88:91], a[56:59], v[36:39]
 ds_read_b128 a[108:111], v2 offset:11264
 v_cvt_pk_bf16_f32 v17, v66, v67
 v_mfma_f32_16x16x32_bf16 v[36:39], a[92:95], a[60:63], v[36:39]
 buffer_load_dwordx4 v1, s[12:15], s42 offen offset:1024 sc1 lds
 v_mfma_f32_16x16x32_bf16 v[32:35], a[64:67], a[0:3], v[96:99]
 ds_read_b128 a[112:115], v2 offset:12288
 v_add_f32 v7, v7, v5
 v_mfma_f32_16x16x32_bf16 v[32:35], a[68:71], a[4:7], v[32:35]
 v_add_f32 v8, v8, v6
 v_accvgpr_read_b32 v104, a228
 v_mfma_f32_16x16x32_bf16 v[32:35], a[72:75], a[8:11], v[32:35]
 ds_read_b128 a[116:119], v2 offset:13312
 v_accvgpr_read_b32 v105, a229
 v_mfma_f32_16x16x32_bf16 v[32:35], a[76:79], a[12:15], v[32:35]
 v_accvgpr_read_b32 v106, a230
 v_accvgpr_read_b32 v107, a231
 v_mfma_f32_16x16x32_bf16 v[32:35], a[80:83], a[16:19], v[32:35]
 ds_read_b128 a[120:123], v2 offset:14336
 v_cvt_pk_bf16_f32 v22, v76, v77
 v_mfma_f32_16x16x32_bf16 v[32:35], a[84:87], a[20:23], v[32:35]
 buffer_load_dwordx4 v1, s[12:15], s42 offen offset:2048 sc1 lds
 v_mfma_f32_16x16x32_bf16 v[32:35], a[88:91], a[24:27], v[32:35]
 ds_read_b128 a[124:127], v2 offset:15360
 v_cvt_pk_bf16_f32 v23, v78, v79
 v_mfma_f32_16x16x32_bf16 v[32:35], a[92:95], a[28:31], v[32:35]
 s_waitcnt lgkmcnt(6)
 v_exp_f32 v68, v36
 v_mfma_f32_16x16x32_bf16 v[44:47], a[96:99], a[32:35], v[108:111]
 ds_read_b128 a[64:67], v2 offset:16384
 v_cvt_pk_bf16_f32 v18, v72, v73
 v_mfma_f32_16x16x32_bf16 v[44:47], a[100:103], a[36:39], v[44:47]
 s_waitcnt lgkmcnt(5)
 v_exp_f32 v69, v37
 v_mfma_f32_16x16x32_bf16 v[44:47], a[104:107], a[40:43], v[44:47]
 ds_read_b128 a[68:71], v2 offset:17408
 v_cvt_pk_bf16_f32 v19, v74, v75
 v_add_f32 v6, v68, v69
 v_mfma_f32_16x16x32_bf16 v[44:47], a[108:111], a[44:47], v[44:47]
 s_waitcnt lgkmcnt(4)
 buffer_load_dwordx4 v1, s[12:15], s42 offen offset:3072 sc1 lds
 v_mfma_f32_16x16x32_bf16 v[44:47], a[112:115], a[48:51], v[44:47]
 ds_read_b128 a[72:75], v2 offset:18432
 v_accvgpr_read_b32 v112, a232
 v_mfma_f32_16x16x32_bf16 v[44:47], a[116:119], a[52:55], v[44:47]
 s_waitcnt lgkmcnt(3)
 v_exp_f32 v70, v38
 v_mfma_f32_16x16x32_bf16 v[44:47], a[120:123], a[56:59], v[44:47]
 ds_read_b128 a[76:79], v2 offset:19456
 v_accvgpr_read_b32 v113, a233
 v_add_f32 v6, v6, v70
 v_mfma_f32_16x16x32_bf16 v[44:47], a[124:127], a[60:63], v[44:47]
 v_exp_f32 v71, v39
 v_mfma_f32_16x16x32_bf16 v[40:43], a[96:99], a[0:3], v[104:107]
 s_bitset1_b32 m0, 12
 ds_read_b128 a[80:83], v2 offset:20480
 v_accvgpr_read_b32 v114, a234
 v_add_f32 v6, v6, v71
 v_mfma_f32_16x16x32_bf16 v[40:43], a[100:103], a[4:7], v[40:43]
 buffer_load_dwordx4 v4, s[12:15], s42 offen offset:0 sc1 lds
 v_mfma_f32_16x16x32_bf16 v[40:43], a[104:107], a[8:11], v[40:43]
 ds_read_b128 a[84:87], v2 offset:21504
 v_accvgpr_read_b32 v115, a235
 v_mfma_f32_16x16x32_bf16 v[40:43], a[108:111], a[12:15], v[40:43]
 v_exp_f32 v64, v32
 v_mfma_f32_16x16x32_bf16 v[40:43], a[112:115], a[16:19], v[40:43]
 ds_read_b128 a[88:91], v2 offset:22528
 v_cvt_pk_bf16_f32 v28, v84, v85
 v_mfma_f32_16x16x32_bf16 v[40:43], a[116:119], a[20:23], v[40:43]
 v_exp_f32 v65, v33
 v_mfma_f32_16x16x32_bf16 v[40:43], a[120:123], a[24:27], v[40:43]
 ds_read_b128 a[92:95], v2 offset:23552
 v_cvt_pk_bf16_f32 v29, v86, v87
 v_add_f32 v5, v64, v65
 v_mfma_f32_16x16x32_bf16 v[40:43], a[124:127], a[28:31], v[40:43]
 s_waitcnt lgkmcnt(6)
 buffer_load_dwordx4 v4, s[12:15], s42 offen offset:1024 sc1 lds
 v_mfma_f32_16x16x32_bf16 v[52:55], a[64:67], a[32:35], v[116:119]
 ds_read_b128 a[96:99], v2 offset:24576
 v_cvt_pk_bf16_f32 v24, v80, v81
 v_mfma_f32_16x16x32_bf16 v[52:55], a[68:71], a[36:39], v[52:55]
 s_waitcnt lgkmcnt(5)
 v_exp_f32 v66, v34
 v_mfma_f32_16x16x32_bf16 v[52:55], a[72:75], a[40:43], v[52:55]
 ds_read_b128 a[100:103], v2 offset:25600
 v_cvt_pk_bf16_f32 v25, v82, v83
 v_add_f32 v5, v5, v66
 v_mfma_f32_16x16x32_bf16 v[52:55], a[76:79], a[44:47], v[52:55]
 s_waitcnt lgkmcnt(4)
 v_exp_f32 v67, v35
 v_mfma_f32_16x16x32_bf16 v[52:55], a[80:83], a[48:51], v[52:55]
 ds_read_b128 a[104:107], v2 offset:26624
 v_accvgpr_read_b32 v120, a236
 v_add_f32 v5, v5, v67
 v_mfma_f32_16x16x32_bf16 v[52:55], a[84:87], a[52:55], v[52:55]
 s_waitcnt lgkmcnt(3)
 buffer_load_dwordx4 v4, s[12:15], s42 offen offset:2048 sc1 lds
 v_mfma_f32_16x16x32_bf16 v[52:55], a[88:91], a[56:59], v[52:55]
 ds_read_b128 a[108:111], v2 offset:27648
 v_accvgpr_read_b32 v121, a237
 v_mfma_f32_16x16x32_bf16 v[52:55], a[92:95], a[60:63], v[52:55]
 v_exp_f32 v76, v44
 v_mfma_f32_16x16x32_bf16 v[48:51], a[64:67], a[0:3], v[112:115]
 ds_read_b128 a[112:115], v2 offset:28672
 v_accvgpr_read_b32 v122, a238
 v_add_f32 v6, v6, v76
 v_mfma_f32_16x16x32_bf16 v[48:51], a[68:71], a[4:7], v[48:51]
 v_exp_f32 v77, v45
 v_mfma_f32_16x16x32_bf16 v[48:51], a[72:75], a[8:11], v[48:51]
 ds_read_b128 a[116:119], v2 offset:29696
 v_accvgpr_read_b32 v123, a239
 v_add_f32 v6, v6, v77
 v_mfma_f32_16x16x32_bf16 v[48:51], a[76:79], a[12:15], v[48:51]
 buffer_load_dwordx4 v4, s[12:15], s42 offen offset:3072 sc1 lds
 v_mfma_f32_16x16x32_bf16 v[48:51], a[80:83], a[16:19], v[48:51]
 ds_read_b128 a[120:123], v2 offset:30720
 v_cvt_pk_bf16_f32 v30, v92, v93
 v_mfma_f32_16x16x32_bf16 v[48:51], a[84:87], a[20:23], v[48:51]
 v_exp_f32 v78, v46
 v_mfma_f32_16x16x32_bf16 v[48:51], a[88:91], a[24:27], v[48:51]
 s_waitcnt vmcnt(8)
 ds_read_b128 a[124:127], v2 offset:31744
 v_xor_b32 v2, 0x8000, v2
 v_add_f32 v6, v6, v78
 v_mfma_f32_16x16x32_bf16 v[48:51], a[92:95], a[28:31], v[48:51]
 s_waitcnt lgkmcnt(6)
 s_barrier
 v_exp_f32 v79, v47
 v_mfma_f32_16x16x32_bf16 v[60:63], a[96:99], a[32:35], v[124:127]
 s_mov_b32 m0, s41
 ds_read_b128 a[64:67], v3 offset:0
 v_accvgpr_read_b32 v12, a246
 v_add_f32 v6, v6, v79
 v_mfma_f32_16x16x32_bf16 v[60:63], a[100:103], a[36:39], v[60:63]
 s_waitcnt lgkmcnt(5)
 buffer_load_dwordx4 v1, s[12:15], s43 offen offset:0 sc1 lds
 v_mfma_f32_16x16x32_bf16 v[60:63], a[104:107], a[40:43], v[60:63]
 ds_read_b128 a[68:71], v3 offset:16384
 v_cmp_ne_u32 s[20:21], 0, v12
 v_mfma_f32_16x16x32_bf16 v[60:63], a[108:111], a[44:47], v[60:63]
 s_waitcnt lgkmcnt(4)
 v_exp_f32 v72, v40
 v_mfma_f32_16x16x32_bf16 v[60:63], a[112:115], a[48:51], v[60:63]
 s_cmp_eq_u64 s[20:21], 0
 ds_read_b128 a[72:75], v3 offset:1024
 v_cvt_pk_bf16_f32 v31, v94, v95
 v_add_f32 v5, v5, v72
 v_mfma_f32_16x16x32_bf16 v[60:63], a[116:119], a[52:55], v[60:63]
 s_waitcnt lgkmcnt(3)
 buffer_load_dwordx4 v1, s[12:15], s43 offen offset:1024 sc1 lds
 v_mfma_f32_16x16x32_bf16 v[60:63], a[120:123], a[56:59], v[60:63]
 s_cselect_b32 s51, 1, 0
 ds_read_b128 a[76:79], v3 offset:17408
 v_cvt_pk_bf16_f32 v26, v88, v89
 v_mfma_f32_16x16x32_bf16 v[60:63], a[124:127], a[60:63], v[60:63]
 s_cselect_b32 s55, s4, 2.0
 v_exp_f32 v73, v41
 v_mfma_f32_16x16x32_bf16 v[56:59], a[96:99], a[0:3], v[120:123]
 s_cselect_b32 s56, s5, 2.0
 ds_read_b128 a[80:83], v3 offset:2048
 v_cvt_pk_bf16_f32 v27, v90, v91
 v_mfma_f32_16x16x32_bf16 v[56:59], a[100:103], a[4:7], v[56:59]
 buffer_load_dwordx4 v1, s[12:15], s43 offen offset:2048 sc1 lds
 v_mfma_f32_16x16x32_bf16 v[56:59], a[104:107], a[8:11], v[56:59]
 s_cselect_b32 s57, s6, 2.0
 ds_read_b128 a[84:87], v3 offset:18432
 v_add_f32 v5, v5, v73
 v_mfma_f32_16x16x32_bf16 v[56:59], a[108:111], a[12:15], v[56:59]
 v_exp_f32 v74, v42
 v_mfma_f32_16x16x32_bf16 v[56:59], a[112:115], a[16:19], v[56:59]
 ds_read_b128 a[88:91], v3 offset:3072
 v_accvgpr_read_b32 v13, a244
 v_mfma_f32_16x16x32_bf16 v[56:59], a[116:119], a[20:23], v[56:59]
 buffer_load_dwordx4 v1, s[12:15], s43 offen offset:3072 sc1 lds
 v_mfma_f32_16x16x32_bf16 v[56:59], a[120:123], a[24:27], v[56:59]
 ds_read_b128 a[92:95], v3 offset:19456
 v_add_f32 v5, v5, v74
 v_mfma_f32_16x16x32_bf16 v[56:59], a[124:127], a[28:31], v[56:59]
 s_waitcnt lgkmcnt(6)
 v_exp_f32 v75, v43
 v_mfma_f32_16x16x32_bf16 v[128:131], a[64:67], v[16:19], v[128:131]
 s_bitset1_b32 m0, 12
 ds_read_b128 a[96:99], v3 offset:4096
 v_add_f32 v5, v5, v75
 v_mfma_f32_16x16x32_bf16 v[128:131], a[68:71], v[24:27], v[128:131]
 buffer_load_dwordx4 v4, s[12:15], s43 offen offset:0 sc1 lds
 v_mfma_f32_16x16x32_bf16 v[192:195], a[68:71], v[28:31], v[192:195]
 ds_read_b128 a[100:103], v3 offset:20480
 v_sub_f32 v12, v10, v9
 v_mfma_f32_16x16x32_bf16 v[192:195], a[64:67], v[20:23], v[192:195]
 s_waitcnt lgkmcnt(6)
 v_exp_f32 v84, v52
 v_add_f32 v127, v123, v12
 v_mfma_f32_16x16x32_bf16 v[132:135], a[72:75], v[16:19], v[132:135]
 ds_read_b128 a[104:107], v3 offset:5120
 v_add_f32 v6, v6, v84
 v_mfma_f32_16x16x32_bf16 v[132:135], a[76:79], v[24:27], v[132:135]
 buffer_load_dwordx4 v4, s[12:15], s43 offen offset:1024 sc1 lds
 v_mfma_f32_16x16x32_bf16 v[196:199], a[76:79], v[28:31], v[196:199]
 ds_read_b128 a[108:111], v3 offset:21504
 v_add_f32 v100, v96, v12
 v_mfma_f32_16x16x32_bf16 v[196:199], a[72:75], v[20:23], v[196:199]
 s_waitcnt lgkmcnt(6)
 v_exp_f32 v85, v53
 v_mfma_f32_16x16x32_bf16 v[136:139], a[80:83], v[16:19], v[136:139]
 ds_read_b128 a[112:115], v3 offset:6144
 v_add_f32 v6, v6, v85
 v_mfma_f32_16x16x32_bf16 v[136:139], a[84:87], v[24:27], v[136:139]
 buffer_load_dwordx4 v4, s[12:15], s43 offen offset:2048 sc1 lds
 v_mfma_f32_16x16x32_bf16 v[200:203], a[84:87], v[28:31], v[200:203]
 ds_read_b128 a[116:119], v3 offset:22528
 v_add_f32 v101, v97, v12
 v_mfma_f32_16x16x32_bf16 v[200:203], a[80:83], v[20:23], v[200:203]
 s_waitcnt lgkmcnt(6)
 v_exp_f32 v86, v54
 v_mfma_f32_16x16x32_bf16 v[140:143], a[88:91], v[16:19], v[140:143]
 ds_read_b128 a[120:123], v3 offset:7168
 v_add_f32 v6, v6, v86
 v_mfma_f32_16x16x32_bf16 v[140:143], a[92:95], v[24:27], v[140:143]
 buffer_load_dwordx4 v4, s[12:15], s43 offen offset:3072 sc1 lds
 v_mfma_f32_16x16x32_bf16 v[204:207], a[92:95], v[28:31], v[204:207]
 s_add_u32 s43, s43, 32768
 ds_read_b128 a[124:127], v3 offset:23552
 v_add_f32 v102, v98, v12
 v_mfma_f32_16x16x32_bf16 v[204:207], a[88:91], v[20:23], v[204:207]
 s_waitcnt lgkmcnt(6)
 v_exp_f32 v87, v55
 v_mfma_f32_16x16x32_bf16 v[144:147], a[96:99], v[16:19], v[144:147]
 s_xor_b32 s41, s41, 0x8000
 ds_read_b128 a[64:67], v3 offset:8192
 v_add_f32 v6, v6, v87
 v_mfma_f32_16x16x32_bf16 v[144:147], a[100:103], v[24:27], v[144:147]
 buffer_load_dwordx4 a[192:195], v1, s[12:15], s57 offen sc1
 v_mfma_f32_16x16x32_bf16 v[208:211], a[100:103], v[28:31], v[208:211]
 s_xor_b32 s40, s40, 0x8000
 ds_read_b128 a[68:71], v3 offset:24576
 v_add_f32 v103, v99, v12
 v_mfma_f32_16x16x32_bf16 v[208:211], a[96:99], v[20:23], v[208:211]
 s_waitcnt lgkmcnt(6)
 v_exp_f32 v80, v48
 v_mfma_f32_16x16x32_bf16 v[148:151], a[104:107], v[16:19], v[148:151]
 s_add_u32 s52, s50, 131072
 ds_read_b128 a[72:75], v3 offset:9216
 v_add_f32 v5, v5, v80
 v_mfma_f32_16x16x32_bf16 v[148:151], a[108:111], v[24:27], v[148:151]
 buffer_load_dwordx4 a[128:131], v1, s[12:15], s55 offen offset:0 sc1
 v_mfma_f32_16x16x32_bf16 v[212:215], a[108:111], v[28:31], v[212:215]
 s_mul_i32 s58, s3, 50176
 ds_read_b128 a[76:79], v3 offset:25600
 v_add_f32 v108, v104, v12
 v_mfma_f32_16x16x32_bf16 v[212:215], a[104:107], v[20:23], v[212:215]
 s_waitcnt lgkmcnt(6)
 v_exp_f32 v81, v49
 v_mfma_f32_16x16x32_bf16 v[152:155], a[112:115], v[16:19], v[152:155]
 s_sub_u32 s58, 128, s58
 ds_read_b128 a[80:83], v3 offset:10240
 v_add_f32 v5, v5, v81
 v_mfma_f32_16x16x32_bf16 v[152:155], a[116:119], v[24:27], v[152:155]
 buffer_load_dwordx4 a[132:135], v1, s[12:15], s55 offen offset:1024 sc1
 v_mfma_f32_16x16x32_bf16 v[216:219], a[116:119], v[28:31], v[216:219]
 s_cmp_eq_u32 s7, 0
 ds_read_b128 a[84:87], v3 offset:26624
 v_add_f32 v109, v105, v12
 v_mfma_f32_16x16x32_bf16 v[216:219], a[112:115], v[20:23], v[216:219]
 s_waitcnt lgkmcnt(6)
 v_exp_f32 v82, v50
 v_mfma_f32_16x16x32_bf16 v[156:159], a[120:123], v[16:19], v[156:159]
 s_cselect_b32 s42, s78, s49
 ds_read_b128 a[88:91], v3 offset:11264
 v_add_f32 v5, v5, v82
 v_mfma_f32_16x16x32_bf16 v[156:159], a[124:127], v[24:27], v[156:159]
 buffer_load_dwordx4 a[136:139], v1, s[12:15], s55 offen offset:2048 sc1
 v_mfma_f32_16x16x32_bf16 v[220:223], a[124:127], v[28:31], v[220:223]
 s_cmov_b32 s40, s52
 ds_read_b128 a[92:95], v3 offset:27648
 v_add_f32 v110, v106, v12
 v_mfma_f32_16x16x32_bf16 v[220:223], a[120:123], v[20:23], v[220:223]
 s_waitcnt lgkmcnt(6)
 v_exp_f32 v83, v51
 v_mfma_f32_16x16x32_bf16 v[160:163], a[64:67], v[16:19], v[160:163]
 s_cmov_b64 s[8:9], s[86:87]
 ds_read_b128 a[96:99], v3 offset:12288
 v_add_f32 v5, v5, v83
 v_mfma_f32_16x16x32_bf16 v[160:163], a[68:71], v[24:27], v[160:163]
 buffer_load_dwordx4 a[140:143], v1, s[12:15], s55 offen offset:3072 sc1
 v_mfma_f32_16x16x32_bf16 v[224:227], a[68:71], v[28:31], v[224:227]
 s_cmov_b32 s10, 3670016
 ds_read_b128 a[100:103], v3 offset:28672
 v_add_f32 v111, v107, v12
 v_mfma_f32_16x16x32_bf16 v[224:227], a[64:67], v[20:23], v[224:227]
 s_waitcnt lgkmcnt(6)
 v_exp_f32 v92, v60
 v_mfma_f32_16x16x32_bf16 v[164:167], a[72:75], v[16:19], v[164:167]
 s_cmov_b32 s76, 6144
 ds_read_b128 a[104:107], v3 offset:13312
 v_add_f32 v6, v6, v92
 v_mfma_f32_16x16x32_bf16 v[164:167], a[76:79], v[24:27], v[164:167]
 buffer_load_dwordx4 a[144:147], v4, s[12:15], s55 offen offset:0 sc1
 v_mfma_f32_16x16x32_bf16 v[228:231], a[76:79], v[28:31], v[228:231]
 s_cmov_b32 s77, 10240
 ds_read_b128 a[108:111], v3 offset:29696
 v_add_f32 v116, v112, v12
 v_mfma_f32_16x16x32_bf16 v[228:231], a[72:75], v[20:23], v[228:231]
 s_waitcnt lgkmcnt(6)
 v_exp_f32 v93, v61
 v_mfma_f32_16x16x32_bf16 v[168:171], a[80:83], v[16:19], v[168:171]
 s_mov_b32 s44, 1
 ds_read_b128 a[112:115], v3 offset:14336
 v_add_f32 v6, v6, v93
 v_mfma_f32_16x16x32_bf16 v[168:171], a[84:87], v[24:27], v[168:171]
 buffer_load_dwordx4 a[148:151], v4, s[12:15], s55 offen offset:1024 sc1
 v_mfma_f32_16x16x32_bf16 v[232:235], a[84:87], v[28:31], v[232:235]
 s_cmp_eq_u32 s51, 1
 ds_read_b128 a[116:119], v3 offset:30720
 v_add_f32 v117, v113, v12
 v_mfma_f32_16x16x32_bf16 v[232:235], a[80:83], v[20:23], v[232:235]
 s_waitcnt lgkmcnt(6)
 v_exp_f32 v94, v62
 v_mfma_f32_16x16x32_bf16 v[172:175], a[88:91], v[16:19], v[172:175]
 ds_read_b128 a[120:123], v3 offset:15360
 v_add_f32 v6, v6, v94
 v_mfma_f32_16x16x32_bf16 v[172:175], a[92:95], v[24:27], v[172:175]
 buffer_load_dwordx4 a[152:155], v4, s[12:15], s55 offen offset:2048 sc1
 v_mfma_f32_16x16x32_bf16 v[236:239], a[92:95], v[28:31], v[236:239]
 s_waitcnt vmcnt(16)
 ds_read_b128 a[124:127], v3 offset:31744
 v_xor_b32 v3, 0x8000, v3
 v_mfma_f32_16x16x32_bf16 v[236:239], a[88:91], v[20:23], v[236:239]
 s_waitcnt lgkmcnt(6)
 s_barrier
 v_exp_f32 v95, v63
 v_mfma_f32_16x16x32_bf16 v[176:179], a[96:99], v[16:19], v[176:179]
 ds_read_b128 a[64:67], v2 offset:0
 v_add_f32 v6, v6, v95
 v_mfma_f32_16x16x32_bf16 v[176:179], a[100:103], v[24:27], v[176:179]
 buffer_load_dwordx4 a[156:159], v4, s[12:15], s55 offen offset:3072 sc1
 v_mfma_f32_16x16x32_bf16 v[240:243], a[100:103], v[28:31], v[240:243]
 s_waitcnt vmcnt(9)
 ds_read_b128 a[68:71], v2 offset:1024
 v_add_f32 v118, v114, v12
 v_mfma_f32_16x16x32_bf16 v[240:243], a[96:99], v[20:23], v[240:243]
 s_waitcnt lgkmcnt(6)
 s_barrier
 v_exp_f32 v88, v56
 v_mfma_f32_16x16x32_bf16 v[180:183], a[104:107], v[16:19], v[180:183]
 ds_read_b128 a[72:75], v2 offset:2048
 v_exp_f32 v89, v57
 v_add_f32 v5, v5, v88
 v_mfma_f32_16x16x32_bf16 v[180:183], a[108:111], v[24:27], v[180:183]
 ds_read_b128 a[96:99], v3 offset:0
 v_exp_f32 v90, v58
 v_add_f32 v5, v5, v89
 v_mfma_f32_16x16x32_bf16 v[244:247], a[108:111], v[28:31], v[244:247]
 ds_read_b128 a[76:79], v2 offset:3072
 v_exp_f32 v91, v59
 v_mfma_f32_16x16x32_bf16 v[244:247], a[104:107], v[20:23], v[244:247]
 s_waitcnt lgkmcnt(7)
 ds_read_b128 a[100:103], v3 offset:16384
 v_add_f32 v5, v5, v90
 v_mfma_f32_16x16x32_bf16 v[184:187], a[112:115], v[16:19], v[184:187]
 ds_read_b128 a[80:83], v2 offset:4096
 v_add_f32 v5, v5, v91
 v_mfma_f32_16x16x32_bf16 v[184:187], a[116:119], v[24:27], v[184:187]
 ds_read_b128 a[104:107], v3 offset:1024
 v_add_f32 v11, v5, v6
 v_mfma_f32_16x16x32_bf16 v[248:251], a[116:119], v[28:31], v[248:251]
 ds_read_b128 a[84:87], v2 offset:5120
 v_cmp_nge_f32 vcc, s47, v11
 v_mfma_f32_16x16x32_bf16 v[248:251], a[112:115], v[20:23], v[248:251]
 s_waitcnt lgkmcnt(9)
 ds_read_b128 a[108:111], v3 offset:17408
 v_add_f32 v119, v115, v12
 v_mfma_f32_16x16x32_bf16 v[188:191], a[120:123], v[16:19], v[188:191]
 s_cselect_b64 vcc, vcc, -1
 ds_read_b128 a[88:91], v2 offset:6144
 v_add_f32 v124, v120, v12
 v_mfma_f32_16x16x32_bf16 v[188:191], a[124:127], v[24:27], v[188:191]
 ds_read_b128 a[112:115], v3 offset:2048
 v_add_f32 v125, v121, v12
 v_mfma_f32_16x16x32_bf16 v[252:255], a[124:127], v[28:31], v[252:255]
 ds_read_b128 a[92:95], v2 offset:7168
 v_add_f32 v126, v122, v12
 v_mfma_f32_16x16x32_bf16 v[252:255], a[120:123], v[20:23], v[252:255]
 s_waitcnt lgkmcnt(11)
 ds_read_b128 a[116:119], v3 offset:18432
 s_cbranch_vccnz L_g0x
L_p1:
 v_mfma_f32_16x16x32_bf16 v[36:39], a[64:67], a[32:35], v[100:103]
 s_mov_b32 m0, s40
 ds_read_b128 a[120:123], v3 offset:3072
 v_cvt_pk_bf16_f32 v16, v64, v65
 v_cvt_pk_bf16_f32 v24, v80, v81
 v_mfma_f32_16x16x32_bf16 v[36:39], a[68:71], a[36:39], v[36:39]
 s_waitcnt lgkmcnt(10)
 ds_read_b128 a[124:127], v3 offset:19456
 buffer_load_dwordx4 v13, s[8:11], s42 offen offset:0 sc1 lds
 v_mfma_f32_16x16x32_bf16 v[36:39], a[72:75], a[40:43], v[36:39]
 s_add_u32 s39, s42, s76
 ds_read_b128 a[64:67], v2 offset:8192
 v_cvt_pk_bf16_f32 v17, v66, v67
 v_cvt_pk_bf16_f32 v25, v82, v83
 v_mfma_f32_16x16x32_bf16 v[36:39], a[76:79], a[44:47], v[36:39]
 s_waitcnt lgkmcnt(8)
 ds_read_b128 a[68:71], v2 offset:9216
 v_cvt_pk_bf16_f32 v18, v72, v73
 v_cvt_pk_bf16_f32 v26, v88, v89
 v_mfma_f32_16x16x32_bf16 v[36:39], a[80:83], a[48:51], v[36:39]
 buffer_load_dwordx4 v13, s[8:11], s39 offen offset:1024 sc1 lds
 v_mfma_f32_16x16x32_bf16 v[36:39], a[84:87], a[52:55], v[36:39]
 s_waitcnt lgkmcnt(5)
 ds_read_b128 a[72:75], v2 offset:10240
 v_cvt_pk_bf16_f32 v19, v74, v75
 v_cvt_pk_bf16_f32 v27, v90, v91
 v_mfma_f32_16x16x32_bf16 v[36:39], a[88:91], a[56:59], v[36:39]
 ds_read_b128 a[76:79], v2 offset:11264
 v_cvt_pk_bf16_f32 v20, v68, v69
 v_mfma_f32_16x16x32_bf16 v[36:39], a[92:95], a[60:63], v[36:39]
 s_add_u32 s39, s39, s76
 v_cvt_pk_bf16_f32 v21, v70, v71
 v_cvt_pk_bf16_f32 v22, v76, v77
 v_mfma_f32_16x16x32_bf16 v[128:131], a[96:99], v[16:19], v[128:131]
 ds_read_b128 a[80:83], v2 offset:12288
 buffer_load_dwordx4 v13, s[8:11], s39 offen offset:2048 sc1 lds
 v_mfma_f32_16x16x32_bf16 v[128:131], a[100:103], v[24:27], v[128:131]
 ds_read_b128 a[84:87], v2 offset:13312
 v_cvt_pk_bf16_f32 v23, v78, v79
 v_mfma_f32_16x16x32_bf16 v[132:135], a[104:107], v[16:19], v[132:135]
 v_cvt_pk_bf16_f32 v28, v84, v85
 v_cvt_pk_bf16_f32 v29, v86, v87
 v_mfma_f32_16x16x32_bf16 v[132:135], a[108:111], v[24:27], v[132:135]
 s_add_u32 s39, s39, s76
 ds_read_b128 a[88:91], v2 offset:14336
 v_cvt_pk_bf16_f32 v30, v92, v93
 v_mfma_f32_16x16x32_bf16 v[136:139], a[112:115], v[16:19], v[136:139]
 s_waitcnt lgkmcnt(8)
 ds_read_b128 a[92:95], v2 offset:15360
 v_cvt_pk_bf16_f32 v31, v94, v95
 v_mfma_f32_16x16x32_bf16 v[136:139], a[116:119], v[24:27], v[136:139]
 buffer_load_dwordx4 v13, s[8:11], s39 offen offset:3072 sc1 lds
 v_mfma_f32_16x16x32_bf16 v[140:143], a[120:123], v[16:19], v[140:143]
 s_waitcnt lgkmcnt(8)
 v_add_f32 v7, v7, v5
 v_add_f32 v8, v8, v6
 v_mfma_f32_16x16x32_bf16 v[140:143], a[124:127], v[24:27], v[140:143]
 s_bitset1_b32 m0, 12
 v_exp_f32 v68, v36
 v_mfma_f32_16x16x32_bf16 v[192:195], a[96:99], v[20:23], v[192:195]
 s_add_u32 s39, s39, s77
 ds_read_b128 a[96:99], v3 offset:4096
 v_mfma_f32_16x16x32_bf16 v[192:195], a[100:103], v[28:31], v[192:195]
 ds_read_b128 a[100:103], v3 offset:20480
 buffer_load_dwordx4 v13, s[8:11], s39 offen offset:0 sc1 lds
 v_mfma_f32_16x16x32_bf16 v[196:199], a[104:107], v[20:23], v[196:199]
 s_add_u32 s39, s39, s76
 v_exp_f32 v69, v37
 v_mfma_f32_16x16x32_bf16 v[196:199], a[108:111], v[28:31], v[196:199]
 ds_read_b128 a[104:107], v3 offset:5120
 buffer_load_dwordx4 v13, s[8:11], s39 offen offset:1024 sc1 lds
 v_mfma_f32_16x16x32_bf16 v[200:203], a[112:115], v[20:23], v[200:203]
 ds_read_b128 a[108:111], v3 offset:21504
 v_add_f32 v6, v68, v69
 v_mfma_f32_16x16x32_bf16 v[200:203], a[116:119], v[28:31], v[200:203]
 v_exp_f32 v70, v38
 v_mfma_f32_16x16x32_bf16 v[204:207], a[120:123], v[20:23], v[204:207]
 s_add_u32 s39, s39, s76
 ds_read_b128 a[112:115], v3 offset:6144
 v_add_f32 v6, v6, v70
 v_mfma_f32_16x16x32_bf16 v[204:207], a[124:127], v[28:31], v[204:207]
 s_waitcnt lgkmcnt(11)
 ds_read_b128 a[116:119], v3 offset:22528
 v_exp_f32 v71, v39
 v_mfma_f32_16x16x32_bf16 v[44:47], a[64:67], a[32:35], v[108:111]
 buffer_load_dwordx4 v13, s[8:11], s39 offen offset:2048 sc1 lds
 v_mfma_f32_16x16x32_bf16 v[44:47], a[68:71], a[36:39], v[44:47]
 s_waitcnt lgkmcnt(10)
 ds_read_b128 a[120:123], v3 offset:7168
 v_add_f32 v6, v6, v71
 v_mfma_f32_16x16x32_bf16 v[44:47], a[72:75], a[40:43], v[44:47]
 s_barrier
 ds_read_b128 a[124:127], v3 offset:23552
 v_mfma_f32_16x16x32_bf16 v[44:47], a[76:79], a[44:47], v[44:47]
 s_waitcnt lgkmcnt(10)
 v_mfma_f32_16x16x32_bf16 v[44:47], a[80:83], a[48:51], v[44:47]
 s_add_u32 s39, s39, s76
 ds_read_b128 a[64:67], v2 offset:16384
 v_mfma_f32_16x16x32_bf16 v[44:47], a[84:87], a[52:55], v[44:47]
 s_waitcnt lgkmcnt(9)
 ds_read_b128 a[68:71], v2 offset:17408
 buffer_load_dwordx4 v13, s[8:11], s39 offen offset:3072 sc1 lds
 v_mfma_f32_16x16x32_bf16 v[44:47], a[88:91], a[56:59], v[44:47]
 v_mfma_f32_16x16x32_bf16 v[44:47], a[92:95], a[60:63], v[44:47]
 s_waitcnt lgkmcnt(8)
 ds_read_b128 a[72:75], v2 offset:18432
 buffer_load_dwordx4 a[0:3], v1, s[12:15], s56 offen offset:0 sc1
 v_mfma_f32_16x16x32_bf16 v[144:147], a[96:99], v[16:19], v[144:147]
 ds_read_b128 a[76:79], v2 offset:19456
 v_mfma_f32_16x16x32_bf16 v[144:147], a[100:103], v[24:27], v[144:147]
 v_mfma_f32_16x16x32_bf16 v[208:211], a[100:103], v[28:31], v[208:211]
 ds_read_b128 a[80:83], v2 offset:20480
 buffer_load_dwordx4 a[4:7], v1, s[12:15], s56 offen offset:1024 sc1
 v_mfma_f32_16x16x32_bf16 v[208:211], a[96:99], v[20:23], v[208:211]
 s_waitcnt lgkmcnt(9)
 ds_read_b128 a[84:87], v2 offset:21504
 v_mfma_f32_16x16x32_bf16 v[148:151], a[104:107], v[16:19], v[148:151]
 v_exp_f32 v76, v44
 v_mfma_f32_16x16x32_bf16 v[148:151], a[108:111], v[24:27], v[148:151]
 ds_read_b128 a[88:91], v2 offset:22528
 v_add_f32 v6, v6, v76
 v_mfma_f32_16x16x32_bf16 v[212:215], a[108:111], v[28:31], v[212:215]
 ds_read_b128 a[92:95], v2 offset:23552
 v_exp_f32 v77, v45
 v_mfma_f32_16x16x32_bf16 v[212:215], a[104:107], v[20:23], v[212:215]
 s_waitcnt lgkmcnt(10)
 buffer_load_dwordx4 a[8:11], v1, s[12:15], s56 offen offset:2048 sc1
 v_mfma_f32_16x16x32_bf16 v[152:155], a[112:115], v[16:19], v[152:155]
 ds_read_b128 a[96:99], v3 offset:8192
 v_add_f32 v6, v6, v77
 v_mfma_f32_16x16x32_bf16 v[152:155], a[116:119], v[24:27], v[152:155]
 ds_read_b128 a[100:103], v3 offset:24576
 v_exp_f32 v78, v46
 v_mfma_f32_16x16x32_bf16 v[216:219], a[116:119], v[28:31], v[216:219]
 buffer_load_dwordx4 a[12:15], v1, s[12:15], s56 offen offset:3072 sc1
 v_mfma_f32_16x16x32_bf16 v[216:219], a[112:115], v[20:23], v[216:219]
 s_waitcnt lgkmcnt(10)
 ds_read_b128 a[104:107], v3 offset:9216
 v_add_f32 v6, v6, v78
 v_mfma_f32_16x16x32_bf16 v[156:159], a[120:123], v[16:19], v[156:159]
 ds_read_b128 a[108:111], v3 offset:25600
 v_exp_f32 v79, v47
 v_mfma_f32_16x16x32_bf16 v[156:159], a[124:127], v[24:27], v[156:159]
 buffer_load_dwordx4 a[16:19], v4, s[12:15], s56 offen offset:0 sc1
 v_mfma_f32_16x16x32_bf16 v[220:223], a[124:127], v[28:31], v[220:223]
 ds_read_b128 a[112:115], v3 offset:10240
 v_add_f32 v6, v6, v79
 v_mfma_f32_16x16x32_bf16 v[220:223], a[120:123], v[20:23], v[220:223]
 s_waitcnt lgkmcnt(11)
 ds_read_b128 a[116:119], v3 offset:26624
 v_mfma_f32_16x16x32_bf16 v[52:55], a[64:67], a[32:35], v[116:119]
 v_mfma_f32_16x16x32_bf16 v[52:55], a[68:71], a[36:39], v[52:55]
 s_waitcnt lgkmcnt(10)
 ds_read_b128 a[120:123], v3 offset:11264
 buffer_load_dwordx4 a[20:23], v4, s[12:15], s56 offen offset:1024 sc1
 v_mfma_f32_16x16x32_bf16 v[52:55], a[72:75], a[40:43], v[52:55]
 ds_read_b128 a[124:127], v3 offset:27648
 v_mfma_f32_16x16x32_bf16 v[52:55], a[76:79], a[44:47], v[52:55]
 s_waitcnt lgkmcnt(10)
 v_mfma_f32_16x16x32_bf16 v[52:55], a[80:83], a[48:51], v[52:55]
 ds_read_b128 a[64:67], v2 offset:24576
 buffer_load_dwordx4 a[24:27], v4, s[12:15], s56 offen offset:2048 sc1
 v_mfma_f32_16x16x32_bf16 v[52:55], a[84:87], a[52:55], v[52:55]
 s_waitcnt lgkmcnt(9)
 ds_read_b128 a[68:71], v2 offset:25600
 v_mfma_f32_16x16x32_bf16 v[52:55], a[88:91], a[56:59], v[52:55]
 v_mfma_f32_16x16x32_bf16 v[52:55], a[92:95], a[60:63], v[52:55]
 s_waitcnt lgkmcnt(8)
 ds_read_b128 a[72:75], v2 offset:26624
 v_mfma_f32_16x16x32_bf16 v[160:163], a[96:99], v[16:19], v[160:163]
 ds_read_b128 a[76:79], v2 offset:27648
 v_mfma_f32_16x16x32_bf16 v[160:163], a[100:103], v[24:27], v[160:163]
 buffer_load_dwordx4 a[28:31], v4, s[12:15], s56 offen offset:3072 sc1
 v_mfma_f32_16x16x32_bf16 v[224:227], a[100:103], v[28:31], v[224:227]
 s_mov_b32 m0, s41
 ds_read_b128 a[80:83], v2 offset:28672
 v_mfma_f32_16x16x32_bf16 v[224:227], a[96:99], v[20:23], v[224:227]
 s_waitcnt lgkmcnt(9)
 ds_read_b128 a[84:87], v2 offset:29696
 v_mfma_f32_16x16x32_bf16 v[164:167], a[104:107], v[16:19], v[164:167]
 buffer_load_dwordx4 v1, s[12:15], s43 offen offset:0 sc1 lds
 v_mfma_f32_16x16x32_bf16 v[164:167], a[108:111], v[24:27], v[164:167]
 ds_read_b128 a[88:91], v2 offset:30720
 v_exp_f32 v84, v52
 v_mfma_f32_16x16x32_bf16 v[228:231], a[108:111], v[28:31], v[228:231]
 ds_read_b128 a[92:95], v2 offset:31744
 v_xor_b32 v2, 0x8000, v2
 v_add_f32 v6, v6, v84
 v_mfma_f32_16x16x32_bf16 v[228:231], a[104:107], v[20:23], v[228:231]
 s_waitcnt lgkmcnt(10)
 buffer_load_dwordx4 v1, s[12:15], s43 offen offset:1024 sc1 lds
 v_mfma_f32_16x16x32_bf16 v[168:171], a[112:115], v[16:19], v[168:171]
 ds_read_b128 a[96:99], v3 offset:12288
 v_exp_f32 v85, v53
 v_mfma_f32_16x16x32_bf16 v[168:171], a[116:119], v[24:27], v[168:171]
 ds_read_b128 a[100:103], v3 offset:28672
 v_add_f32 v6, v6, v85
 v_mfma_f32_16x16x32_bf16 v[232:235], a[116:119], v[28:31], v[232:235]
 v_exp_f32 v86, v54
 v_mfma_f32_16x16x32_bf16 v[232:235], a[112:115], v[20:23], v[232:235]
 s_waitcnt lgkmcnt(10)
 ds_read_b128 a[104:107], v3 offset:13312
 buffer_load_dwordx4 v1, s[12:15], s43 offen offset:2048 sc1 lds
 v_mfma_f32_16x16x32_bf16 v[172:175], a[120:123], v[16:19], v[172:175]
 ds_read_b128 a[108:111], v3 offset:29696
 v_add_f32 v6, v6, v86
 v_mfma_f32_16x16x32_bf16 v[172:175], a[124:127], v[24:27], v[172:175]
 v_exp_f32 v87, v55
 v_mfma_f32_16x16x32_bf16 v[236:239], a[124:127], v[28:31], v[236:239]
 s_mov_b32 s44, 0
 ds_read_b128 a[112:115], v3 offset:14336
 v_add_f32 v6, v6, v87
 v_mfma_f32_16x16x32_bf16 v[236:239], a[120:123], v[20:23], v[236:239]
 s_waitcnt lgkmcnt(11)
 ds_read_b128 a[116:119], v3 offset:30720
 v_mfma_f32_16x16x32_bf16 v[60:63], a[64:67], a[32:35], v[124:127]
 buffer_load_dwordx4 v1, s[12:15], s43 offen offset:3072 sc1 lds
 v_mfma_f32_16x16x32_bf16 v[60:63], a[68:71], a[36:39], v[60:63]
 s_waitcnt lgkmcnt(10)
 ds_read_b128 a[120:123], v3 offset:15360
 v_mfma_f32_16x16x32_bf16 v[60:63], a[72:75], a[40:43], v[60:63]
 s_bitset1_b32 m0, 12
 ds_read_b128 a[124:127], v3 offset:31744
 v_xor_b32 v3, 0x8000, v3
 v_mfma_f32_16x16x32_bf16 v[60:63], a[76:79], a[44:47], v[60:63]
 s_waitcnt lgkmcnt(10)
 buffer_load_dwordx4 v4, s[12:15], s43 offen offset:0 sc1 lds
 v_mfma_f32_16x16x32_bf16 v[60:63], a[80:83], a[48:51], v[60:63]
 v_mfma_f32_16x16x32_bf16 v[60:63], a[84:87], a[52:55], v[60:63]
 s_waitcnt lgkmcnt(8)
 v_mfma_f32_16x16x32_bf16 v[60:63], a[88:91], a[56:59], v[60:63]
 buffer_load_dwordx4 v4, s[12:15], s43 offen offset:1024 sc1 lds
 v_mfma_f32_16x16x32_bf16 v[60:63], a[92:95], a[60:63], v[60:63]
 s_waitcnt lgkmcnt(6)
 v_mfma_f32_16x16x32_bf16 v[176:179], a[96:99], v[16:19], v[176:179]
 s_waitcnt vmcnt(14)
 v_mfma_f32_16x16x32_bf16 v[176:179], a[100:103], v[24:27], v[176:179]
 s_barrier
 v_mfma_f32_16x16x32_bf16 v[240:243], a[100:103], v[28:31], v[240:243]
 ds_read_b128 a[64:67], v2 offset:0
 buffer_load_dwordx4 v4, s[12:15], s43 offen offset:2048 sc1 lds
 v_mfma_f32_16x16x32_bf16 v[240:243], a[96:99], v[20:23], v[240:243]
 s_waitcnt lgkmcnt(5)
 ds_read_b128 a[68:71], v2 offset:1024
 v_mfma_f32_16x16x32_bf16 v[180:183], a[104:107], v[16:19], v[180:183]
 v_exp_f32 v92, v60
 v_mfma_f32_16x16x32_bf16 v[180:183], a[108:111], v[24:27], v[180:183]
 ds_read_b128 a[72:75], v2 offset:2048
 v_add_f32 v6, v6, v92
 v_mfma_f32_16x16x32_bf16 v[244:247], a[108:111], v[28:31], v[244:247]
 ds_read_b128 a[76:79], v2 offset:3072
 v_exp_f32 v93, v61
 v_mfma_f32_16x16x32_bf16 v[244:247], a[104:107], v[20:23], v[244:247]
 s_waitcnt lgkmcnt(6)
 buffer_load_dwordx4 v4, s[12:15], s43 offen offset:3072 sc1 lds
 v_mfma_f32_16x16x32_bf16 v[184:187], a[112:115], v[16:19], v[184:187]
 ds_read_b128 a[80:83], v2 offset:4096
 v_add_f32 v6, v6, v93
 v_exp_f32 v94, v62
 v_mfma_f32_16x16x32_bf16 v[184:187], a[116:119], v[24:27], v[184:187]
 v_add_f32 v6, v6, v94
 v_exp_f32 v95, v63
 v_mfma_f32_16x16x32_bf16 v[248:251], a[116:119], v[28:31], v[248:251]
 ds_read_b128 a[84:87], v2 offset:5120
 v_add_f32 v6, v6, v95
 v_mfma_f32_16x16x32_bf16 v[248:251], a[112:115], v[20:23], v[248:251]
 s_waitcnt lgkmcnt(6)
 ds_read_b128 a[88:91], v2 offset:6144
 v_cmp_nge_f32 vcc, s47, v6
 v_mfma_f32_16x16x32_bf16 v[188:191], a[120:123], v[16:19], v[188:191]
 v_mfma_f32_16x16x32_bf16 v[188:191], a[124:127], v[24:27], v[188:191]
 ds_read_b128 a[92:95], v2 offset:7168
 v_mfma_f32_16x16x32_bf16 v[252:255], a[124:127], v[28:31], v[252:255]
 v_mfma_f32_16x16x32_bf16 v[252:255], a[120:123], v[20:23], v[252:255]
 s_cbranch_vccnz L_slow
L_p2:
 s_cmp_lg_u32 s7, 0
 s_cbranch_scc1 L_switch
 v_and_b32 v11, 31, v0
 v_lshlrev_b32 v11, 2, v11
 buffer_load_dword a247, v11, s[12:15], s61 offen sc1
 v_accvgpr_read_b32 v32, a192
 v_accvgpr_read_b32 v33, a193
 v_accvgpr_read_b32 v34, a194
 v_accvgpr_read_b32 v35, a195
 v_add_u32 v2, s58, v13
 v_cmp_neq_f32 vcc, v34, v9
 v_cmp_neq_f32 s[20:21], v35, v10
 s_or_b64 vcc, vcc, s[20:21]
 s_cmp_eq_u32 s51, 1
 s_cselect_b64 vcc, vcc, -1
 s_cmp_eq_u32 s38, 0
 s_cselect_b64 vcc, 0, vcc
 s_cbranch_vccnz L_fagen
 v_mfma_f32_16x16x32_bf16 v[128:131], a[250:253], a[128:131], v[128:131]
 v_cvt_pk_bf16_f32 v20, v68, v69
 v_cvt_pk_bf16_f32 v21, v70, v71
 v_mfma_f32_16x16x32_bf16 v[132:135], a[248:251], a[128:131], v[132:135]
 v_cvt_pk_bf16_f32 v22, v76, v77
 v_cvt_pk_bf16_f32 v23, v78, v79
 v_mfma_f32_16x16x32_bf16 v[136:139], a[250:253], a[132:135], v[136:139]
 v_cvt_pk_bf16_f32 v28, v84, v85
 v_cvt_pk_bf16_f32 v29, v86, v87
 v_mfma_f32_16x16x32_bf16 v[140:143], a[248:251], a[132:135], v[140:143]
 v_cvt_pk_bf16_f32 v30, v92, v93
 v_cvt_pk_bf16_f32 v31, v94, v95
 v_mfma_f32_16x16x32_bf16 v[144:147], a[250:253], a[136:139], v[144:147]
 s_waitcnt vmcnt(0)
 v_add_f32 v8, v8, v6
 v_accvgpr_read_b32 v44, a254
 v_mfma_f32_16x16x32_bf16 v[148:151], a[248:251], a[136:139], v[148:151]
 s_barrier
 ds_read_b128 a[64:67], v3 offset:0
 v_mfma_f32_16x16x32_bf16 v[152:155], a[250:253], a[140:143], v[152:155]
 s_add_u32 m0, s29, 0
 ds_read_b128 a[68:71], v3 offset:16384
 v_mov_b32 v40, v7
 v_mfma_f32_16x16x32_bf16 v[156:159], a[248:251], a[140:143], v[156:159]
 buffer_load_dwordx4 v2, s[8:11], s78 offen lds
 v_mfma_f32_16x16x32_bf16 v[160:163], a[250:253], a[144:147], v[160:163]
 ds_read_b128 a[72:75], v3 offset:1024
 v_mov_b32 v41, v8
 v_mfma_f32_16x16x32_bf16 v[164:167], a[248:251], a[144:147], v[164:167]
 ds_read_b128 a[76:79], v3 offset:17408
 v_cvt_pk_bf16_f32 v128, v128, v129
 v_mfma_f32_16x16x32_bf16 v[168:171], a[250:253], a[148:151], v[168:171]
 s_add_u32 m0, s29, 4096
 v_permlane32_swap_b32 v7, v40
 v_permlane32_swap_b32 v8, v41
 v_mfma_f32_16x16x32_bf16 v[172:175], a[248:251], a[148:151], v[172:175]
 ds_read_b128 a[80:83], v3 offset:2048
 buffer_load_dwordx4 v2, s[8:11], s79 offen lds
 v_mfma_f32_16x16x32_bf16 v[176:179], a[250:253], a[152:155], v[176:179]
 ds_read_b128 a[84:87], v3 offset:18432
 v_add_f32 v7, v7, v40
 v_mfma_f32_16x16x32_bf16 v[180:183], a[248:251], a[152:155], v[180:183]
 v_add_f32 v8, v8, v41
 v_cvt_pk_bf16_f32 v129, v130, v131
 v_mfma_f32_16x16x32_bf16 v[184:187], a[250:253], a[156:159], v[184:187]
 s_add_u32 m0, s29, 8192
 ds_read_b128 a[88:91], v3 offset:3072
 v_cvt_pk_bf16_f32 v130, v132, v133
 v_mfma_f32_16x16x32_bf16 v[188:191], a[248:251], a[156:159], v[188:191]
 s_waitcnt lgkmcnt(5)
 ds_read_b128 a[92:95], v3 offset:19456
 v_mov_b32 v40, v7
 v_mfma_f32_16x16x32_bf16 v[192:195], a[64:67], v[20:23], v[192:195]
 s_waitcnt vmcnt(10)
 buffer_load_dwordx4 v2, s[8:11], s80 offen lds
 v_mfma_f32_16x16x32_bf16 v[192:195], a[68:71], v[28:31], v[192:195]
 ds_read_b128 a[96:99], v3 offset:4096
 v_mov_b32 v41, v8
 v_mfma_f32_16x16x32_bf16 v[192:195], a[250:253], a[0:3], v[192:195]
 s_waitcnt lgkmcnt(5)
 ds_read_b128 a[100:103], v3 offset:20480
 v_cvt_pk_bf16_f32 v131, v134, v135
 v_mfma_f32_16x16x32_bf16 v[196:199], a[72:75], v[20:23], v[196:199]
 s_add_u32 m0, s29, 12288
 v_permlane16_swap_b32 v7, v40
 v_permlane16_swap_b32 v8, v41
 v_mfma_f32_16x16x32_bf16 v[196:199], a[76:79], v[28:31], v[196:199]
 ds_read_b128 a[104:107], v3 offset:5120
 buffer_load_dwordx4 v2, s[8:11], s81 offen lds
 v_mfma_f32_16x16x32_bf16 v[196:199], a[248:251], a[0:3], v[196:199]
 s_waitcnt lgkmcnt(5)
 ds_read_b128 a[108:111], v3 offset:21504
 v_add_f32 v7, v7, v40
 v_mfma_f32_16x16x32_bf16 v[200:203], a[80:83], v[20:23], v[200:203]
 v_add_f32 v8, v8, v41
 v_cvt_pk_bf16_f32 v136, v136, v137
 v_mfma_f32_16x16x32_bf16 v[200:203], a[84:87], v[28:31], v[200:203]
 s_add_u32 m0, s29, 16384
 ds_read_b128 a[112:115], v3 offset:6144
 v_cvt_pk_bf16_f32 v137, v138, v139
 v_mfma_f32_16x16x32_bf16 v[200:203], a[250:253], a[4:7], v[200:203]
 s_waitcnt lgkmcnt(5)
 ds_read_b128 a[116:119], v3 offset:22528
 v_add_f32 v7, v7, v32
 v_mfma_f32_16x16x32_bf16 v[204:207], a[88:91], v[20:23], v[204:207]
 buffer_load_dwordx4 v2, s[8:11], s82 offen lds
 v_mfma_f32_16x16x32_bf16 v[204:207], a[92:95], v[28:31], v[204:207]
 ds_read_b128 a[120:123], v3 offset:7168
 v_add_f32 v8, v8, v33
 v_mfma_f32_16x16x32_bf16 v[204:207], a[248:251], a[4:7], v[204:207]
 s_waitcnt lgkmcnt(5)
 ds_read_b128 a[124:127], v3 offset:23552
 v_cvt_pk_bf16_f32 v138, v140, v141
 v_mfma_f32_16x16x32_bf16 v[208:211], a[96:99], v[20:23], v[208:211]
 s_add_u32 m0, s29, 20480
 v_cvt_pk_bf16_f32 v139, v142, v143
 v_cvt_pk_bf16_f32 v144, v144, v145
 v_mfma_f32_16x16x32_bf16 v[208:211], a[100:103], v[28:31], v[208:211]
 ds_read_b128 a[64:67], v3 offset:8192
 buffer_load_dwordx4 v2, s[8:11], s83 offen lds
 v_mfma_f32_16x16x32_bf16 v[208:211], a[250:253], a[8:11], v[208:211]
 s_waitcnt lgkmcnt(5)
 ds_read_b128 a[68:71], v3 offset:24576
 v_cvt_pk_bf16_f32 v145, v146, v147
 v_mfma_f32_16x16x32_bf16 v[212:215], a[104:107], v[20:23], v[212:215]
 v_cvt_pk_bf16_f32 v146, v148, v149
 v_cvt_pk_bf16_f32 v147, v150, v151
 v_mfma_f32_16x16x32_bf16 v[212:215], a[108:111], v[28:31], v[212:215]
 s_add_u32 m0, s29, 24576
 ds_read_b128 a[72:75], v3 offset:9216
 v_cvt_pk_bf16_f32 v152, v152, v153
 v_mfma_f32_16x16x32_bf16 v[212:215], a[248:251], a[8:11], v[212:215]
 s_waitcnt lgkmcnt(5)
 ds_read_b128 a[76:79], v3 offset:25600
 v_cvt_pk_bf16_f32 v153, v154, v155
 v_mfma_f32_16x16x32_bf16 v[216:219], a[112:115], v[20:23], v[216:219]
 buffer_load_dwordx4 v2, s[8:11], s84 offen lds
 v_mfma_f32_16x16x32_bf16 v[216:219], a[116:119], v[28:31], v[216:219]
 ds_read_b128 a[80:83], v3 offset:10240
 v_cvt_pk_bf16_f32 v154, v156, v157
 v_mfma_f32_16x16x32_bf16 v[216:219], a[250:253], a[12:15], v[216:219]
 s_waitcnt lgkmcnt(5)
 ds_read_b128 a[84:87], v3 offset:26624
 v_cvt_pk_bf16_f32 v155, v158, v159
 v_mfma_f32_16x16x32_bf16 v[220:223], a[120:123], v[20:23], v[220:223]
 s_add_u32 m0, s29, 28672
 v_cvt_pk_bf16_f32 v160, v160, v161
 v_cvt_pk_bf16_f32 v161, v162, v163
 v_mfma_f32_16x16x32_bf16 v[220:223], a[124:127], v[28:31], v[220:223]
 ds_read_b128 a[88:91], v3 offset:11264
 buffer_load_dwordx4 v2, s[8:11], s85 offen lds
 v_mfma_f32_16x16x32_bf16 v[220:223], a[248:251], a[12:15], v[220:223]
 s_waitcnt lgkmcnt(5)
 ds_read_b128 a[92:95], v3 offset:27648
 v_add_u32 v2, 128, v2
 v_mfma_f32_16x16x32_bf16 v[224:227], a[64:67], v[20:23], v[224:227]
 v_cvt_pk_bf16_f32 v162, v164, v165
 v_cvt_pk_bf16_f32 v163, v166, v167
 v_mfma_f32_16x16x32_bf16 v[224:227], a[68:71], v[28:31], v[224:227]
 ds_read_b128 a[96:99], v3 offset:12288
 v_cvt_pk_bf16_f32 v168, v168, v169
 v_mfma_f32_16x16x32_bf16 v[224:227], a[250:253], a[16:19], v[224:227]
 s_waitcnt lgkmcnt(5)
 ds_read_b128 a[100:103], v3 offset:28672
 v_cvt_pk_bf16_f32 v169, v170, v171
 v_mfma_f32_16x16x32_bf16 v[228:231], a[72:75], v[20:23], v[228:231]
 v_cvt_pk_bf16_f32 v170, v172, v173
 v_cvt_pk_bf16_f32 v171, v174, v175
 v_mfma_f32_16x16x32_bf16 v[228:231], a[76:79], v[28:31], v[228:231]
 ds_read_b128 a[104:107], v3 offset:13312
 v_cvt_pk_bf16_f32 v176, v176, v177
 v_mfma_f32_16x16x32_bf16 v[228:231], a[248:251], a[16:19], v[228:231]
 s_waitcnt lgkmcnt(5)
 ds_read_b128 a[108:111], v3 offset:29696
 v_cvt_pk_bf16_f32 v177, v178, v179
 v_mfma_f32_16x16x32_bf16 v[232:235], a[80:83], v[20:23], v[232:235]
 v_cvt_pk_bf16_f32 v178, v180, v181
 v_cvt_pk_bf16_f32 v179, v182, v183
 v_mfma_f32_16x16x32_bf16 v[232:235], a[84:87], v[28:31], v[232:235]
 ds_read_b128 a[112:115], v3 offset:14336
 v_cvt_pk_bf16_f32 v184, v184, v185
 v_mfma_f32_16x16x32_bf16 v[232:235], a[250:253], a[20:23], v[232:235]
 s_waitcnt lgkmcnt(5)
 ds_read_b128 a[116:119], v3 offset:30720
 v_cvt_pk_bf16_f32 v185, v186, v187
 v_mfma_f32_16x16x32_bf16 v[236:239], a[88:91], v[20:23], v[236:239]
 v_cvt_pk_bf16_f32 v186, v188, v189
 v_cvt_pk_bf16_f32 v187, v190, v191
 v_mfma_f32_16x16x32_bf16 v[236:239], a[92:95], v[28:31], v[236:239]
 ds_read_b128 a[120:123], v3 offset:15360
 v_cvt_pk_bf16_f32 v192, v192, v193
 v_mfma_f32_16x16x32_bf16 v[236:239], a[248:251], a[20:23], v[236:239]
 s_waitcnt lgkmcnt(5)
 ds_read_b128 a[124:127], v3 offset:31744
 v_cvt_pk_bf16_f32 v193, v194, v195
 v_mfma_f32_16x16x32_bf16 v[240:243], a[96:99], v[20:23], v[240:243]
 v_cvt_pk_bf16_f32 v194, v196, v197
 v_cvt_pk_bf16_f32 v195, v198, v199
 v_mfma_f32_16x16x32_bf16 v[240:243], a[100:103], v[28:31], v[240:243]
 v_cvt_pk_bf16_f32 v200, v200, v201
 v_cvt_pk_bf16_f32 v201, v202, v203
 v_mfma_f32_16x16x32_bf16 v[240:243], a[250:253], a[24:27], v[240:243]
 s_waitcnt lgkmcnt(4)
 v_cvt_pk_bf16_f32 v202, v204, v205
 v_cvt_pk_bf16_f32 v203, v206, v207
 v_mfma_f32_16x16x32_bf16 v[244:247], a[104:107], v[20:23], v[244:247]
 v_cvt_pk_bf16_f32 v208, v208, v209
 v_cvt_pk_bf16_f32 v209, v210, v211
 v_mfma_f32_16x16x32_bf16 v[244:247], a[108:111], v[28:31], v[244:247]
 v_cvt_pk_bf16_f32 v210, v212, v213
 v_cvt_pk_bf16_f32 v211, v214, v215
 v_mfma_f32_16x16x32_bf16 v[244:247], a[248:251], a[24:27], v[244:247]
 s_waitcnt lgkmcnt(2)
 v_cvt_pk_bf16_f32 v216, v216, v217
 v_cvt_pk_bf16_f32 v217, v218, v219
 v_mfma_f32_16x16x32_bf16 v[248:251], a[112:115], v[20:23], v[248:251]
 v_cvt_pk_bf16_f32 v218, v220, v221
 v_cvt_pk_bf16_f32 v219, v222, v223
 v_mfma_f32_16x16x32_bf16 v[248:251], a[116:119], v[28:31], v[248:251]
 v_cvt_pk_bf16_f32 v224, v224, v225
 v_cvt_pk_bf16_f32 v225, v226, v227
 v_mfma_f32_16x16x32_bf16 v[248:251], a[250:253], a[28:31], v[248:251]
 s_waitcnt lgkmcnt(0)
 v_cvt_pk_bf16_f32 v226, v228, v229
 v_cvt_pk_bf16_f32 v227, v230, v231
 v_mfma_f32_16x16x32_bf16 v[252:255], a[120:123], v[20:23], v[252:255]
 v_cvt_pk_bf16_f32 v232, v232, v233
 v_cvt_pk_bf16_f32 v233, v234, v235
 v_mfma_f32_16x16x32_bf16 v[252:255], a[124:127], v[28:31], v[252:255]
 v_cvt_pk_bf16_f32 v234, v236, v237
 v_cvt_pk_bf16_f32 v235, v238, v239
 v_mfma_f32_16x16x32_bf16 v[252:255], a[248:251], a[28:31], v[252:255]
 v_cvt_pk_bf16_f32 v240, v240, v241
 v_cvt_pk_bf16_f32 v241, v242, v243
 ds_read_b64_tr_b16 a[160:161], v44 offset:0
 ds_read_b64_tr_b16 a[162:163], v44 offset:2048
 ds_read_b64_tr_b16 a[164:165], v44 offset:4096
 ds_read_b64_tr_b16 a[166:167], v44 offset:6144
 ds_read_b64_tr_b16 a[168:169], v44 offset:8192
 ds_read_b64_tr_b16 a[170:171], v44 offset:10240
 ds_read_b64_tr_b16 a[172:173], v44 offset:12288
 ds_read_b64_tr_b16 a[174:175], v44 offset:14336
 ds_read_b64_tr_b16 a[176:177], v44 offset:16384
 ds_read_b64_tr_b16 a[178:179], v44 offset:18432
 ds_read_b64_tr_b16 a[180:181], v44 offset:20480
 ds_read_b64_tr_b16 a[182:183], v44 offset:22528
 ds_read_b64_tr_b16 a[184:185], v44 offset:24576
 ds_read_b64_tr_b16 a[186:187], v44 offset:26624
 s_nop 1
 v_rcp_f32 v64, v7
 v_rcp_f32 v65, v8
 v_cvt_pk_bf16_f32 v242, v244, v245
 v_cvt_pk_bf16_f32 v243, v246, v247
 v_cvt_pk_bf16_f32 v248, v248, v249
 v_cvt_pk_bf16_f32 v249, v250, v251
 v_cvt_pk_bf16_f32 v250, v252, v253
 v_cvt_pk_bf16_f32 v251, v254, v255
 s_cmp_lg_u32 s27, 0
 s_cbranch_scc1 L_op1in
 s_waitcnt vmcnt(0) lgkmcnt(0)
 s_mov_b32 s59, 2.0
 s_cmp_eq_u32 s62, 0
 s_cbranch_scc1 L_t1park
 v_accvgpr_read_b32 v12, a247
 v_cmp_ne_u32 vcc, 0, v12
 s_cbranch_vccz L_poll1_ok
 v_and_b32 v11, 31, v0
 v_lshlrev_b32 v11, 2, v11
 s_mov_b32 s32, 0
L_poll1:
 buffer_load_dword v12, v11, s[12:15], s61 offen sc1
 s_waitcnt vmcnt(0)
 v_cmp_ne_u32 vcc, 0, v12
 s_cbranch_vccz L_poll1_ok
 s_sleep 6
 s_add_u32 s32, s32, 1
 s_cmp_lt_u32 s32, 0x80000
 s_cbranch_scc1 L_poll1
L_poll1_ok:
 s_branch L_t1park
L_kvlate:
 v_cmp_gt_u32 vcc, 256, v5
 v_mov_b32 v29, 0
 s_mov_b32 s32, 0
 s_cbranch_vccz L_armed
L_pollA:
 global_load_dword v28, v29, s[90:91] offset:128 sc1
 s_add_u32 s32, s32, 1
 s_waitcnt vmcnt(0)
 v_cmp_gt_u32 vcc, 256, v28
 s_cmp_lt_u32 s32, 0x80000
 s_cselect_b64 vcc, vcc, 0
 s_cbranch_vccnz L_pollA
L_armed:
 v_and_b32 v28, 11, v0
 v_lshlrev_b32 v28, 2, v28
 s_mov_b32 s32, 0
L_poll0:
 buffer_load_dword v29, v28, s[12:15], s58 offen sc1
 s_waitcnt vmcnt(0)
 v_cmp_ne_u32 vcc, 0, v29
 s_cbranch_vccz L_poll0_ok
 s_sleep 6
 s_add_u32 s32, s32, 1
 s_cmp_lt_u32 s32, 0x80000
 s_cbranch_scc1 L_poll0
L_poll0_ok:
 s_mov_b32 m0, s40
 s_nop 0
 buffer_load_dwordx4 v1, s[12:15], s42 offen offset:0 sc1 lds
 buffer_load_dwordx4 v1, s[12:15], s42 offen offset:1024 sc1 lds
 buffer_load_dwordx4 v1, s[12:15], s42 offen offset:2048 sc1 lds
 buffer_load_dwordx4 v1, s[12:15], s42 offen offset:3072 sc1 lds
 s_bitset1_b32 m0, 12
 s_nop 0
 buffer_load_dwordx4 v4, s[12:15], s42 offen offset:0 sc1 lds
 buffer_load_dwordx4 v4, s[12:15], s42 offen offset:1024 sc1 lds
 buffer_load_dwordx4 v4, s[12:15], s42 offen offset:2048 sc1 lds
 buffer_load_dwordx4 v4, s[12:15], s42 offen offset:3072 sc1 lds
 s_add_u32 s42, s42, s70
 s_xor_b32 s40, s40, 0x8000
 s_mov_b32 m0, s40
 s_nop 0
 buffer_load_dwordx4 v1, s[12:15], s42 offen offset:0 sc1 lds
 buffer_load_dwordx4 v1, s[12:15], s42 offen offset:1024 sc1 lds
 buffer_load_dwordx4 v1, s[12:15], s42 offen offset:2048 sc1 lds
 buffer_load_dwordx4 v1, s[12:15], s42 offen offset:3072 sc1 lds
 s_bitset1_b32 m0, 12
 s_nop 0
 buffer_load_dwordx4 v4, s[12:15], s42 offen offset:0 sc1 lds
 buffer_load_dwordx4 v4, s[12:15], s42 offen offset:1024 sc1 lds
 buffer_load_dwordx4 v4, s[12:15], s42 offen offset:2048 sc1 lds
 buffer_load_dwordx4 v4, s[12:15], s42 offen offset:3072 sc1 lds
 s_add_u32 s42, s42, s70
 s_xor_b32 s40, s40, 0x8000
 s_branch L_kvok
L_rowchk:
 v_mov_b32 v16, v5
 v_mov_b32 v17, v6
 v_mov_b32 v18, v16
 v_mov_b32 v19, v17
 s_nop 0
 v_permlane32_swap_b32 v16, v18
 v_permlane32_swap_b32 v17, v19
 s_nop 0
 v_add_f32 v16, v16, v18
 v_add_f32 v17, v17, v19
 v_mov_b32 v18, v16
 v_mov_b32 v19, v17
 s_nop 0
 v_permlane16_swap_b32 v16, v18
 v_permlane16_swap_b32 v17, v19
 s_nop 0
 v_add_f32 v16, v16, v18
 v_add_f32 v17, v17, v19
 v_min_f32 v16, v16, v17
 v_cmp_gt_f32 vcc, 0x33800000, v16
 s_cbranch_vccz L_firstok
 s_branch L_slow2
L_slow:
 s_cmp_lg_u32 s47, 0x4b800000
 s_cbranch_scc1 L_switched
 s_nop 5
L_slow2:
 v_max3_f32 v11, v32, v33, v34
 v_max3_f32 v11, v11, v35, v40
 v_max3_f32 v11, v11, v41, v42
 v_max3_f32 v11, v11, v43, v48
 v_max3_f32 v11, v11, v49, v50
 v_max3_f32 v11, v11, v51, v56
 v_max3_f32 v11, v11, v57, v58
 v_max_f32 v11, v11, v59
 v_mov_b32 v16, v11
 s_nop 1
 v_permlane32_swap_b32 v11, v16
 s_nop 1
 v_max_f32 v11, v11, v16
 v_mov_b32 v16, v11
 s_nop 1
 v_permlane16_swap_b32 v11, v16
 s_nop 1
 v_max_f32 v11, v11, v16
 v_max_f32 v11, s46, v11
 v_sub_f32 v9, v9, v11
 v_sub_f32 v32, v32, v11
 v_sub_f32 v33, v33, v11
 v_sub_f32 v34, v34, v11
 v_sub_f32 v35, v35, v11
 v_sub_f32 v40, v40, v11
 v_sub_f32 v41, v41, v11
 v_sub_f32 v42, v42, v11
 v_sub_f32 v43, v43, v11
 v_sub_f32 v48, v48, v11
 v_sub_f32 v49, v49, v11
 v_sub_f32 v50, v50, v11
 v_sub_f32 v51, v51, v11
 v_sub_f32 v56, v56, v11
 v_sub_f32 v57, v57, v11
 v_sub_f32 v58, v58, v11
 v_sub_f32 v59, v59, v11
 v_exp_f32 v64, v32
 v_mov_b32 v96, v9
 v_exp_f32 v65, v33
 v_mov_b32 v97, v9
 v_exp_f32 v66, v34
 v_mov_b32 v98, v9
 v_exp_f32 v67, v35
 v_mov_b32 v99, v9
 v_exp_f32 v72, v40
 v_mov_b32 v104, v9
 v_exp_f32 v73, v41
 v_mov_b32 v105, v9
 v_exp_f32 v74, v42
 v_mov_b32 v106, v9
 v_exp_f32 v75, v43
 v_mov_b32 v107, v9
 v_exp_f32 v80, v48
 v_mov_b32 v112, v9
 v_exp_f32 v81, v49
 v_mov_b32 v113, v9
 v_exp_f32 v82, v50
 v_mov_b32 v114, v9
 v_exp_f32 v83, v51
 v_mov_b32 v115, v9
 v_exp_f32 v88, v56
 v_mov_b32 v120, v9
 v_exp_f32 v89, v57
 v_mov_b32 v121, v9
 v_exp_f32 v90, v58
 v_mov_b32 v122, v9
 v_exp_f32 v91, v59
 v_mov_b32 v123, v9
 v_add_f32 v5, v64, v65
 v_add_f32 v5, v5, v66
 v_add_f32 v5, v5, v67
 v_add_f32 v5, v5, v72
 v_add_f32 v5, v5, v73
 v_add_f32 v5, v5, v74
 v_add_f32 v5, v5, v75
 v_add_f32 v5, v5, v80
 v_add_f32 v5, v5, v81
 v_add_f32 v5, v5, v82
 v_add_f32 v5, v5, v83
 v_add_f32 v5, v5, v88
 v_add_f32 v5, v5, v89
 v_add_f32 v5, v5, v90
 v_add_f32 v5, v5, v91
 v_max3_f32 v12, v36, v37, v38
 v_max3_f32 v12, v12, v39, v44
 v_max3_f32 v12, v12, v45, v46
 v_max3_f32 v12, v12, v47, v52
 v_max3_f32 v12, v12, v53, v54
 v_max3_f32 v12, v12, v55, v60
 v_max3_f32 v12, v12, v61, v62
 v_max_f32 v12, v12, v63
 v_mov_b32 v16, v12
 s_nop 1
 v_permlane32_swap_b32 v12, v16
 s_nop 1
 v_max_f32 v12, v12, v16
 v_mov_b32 v16, v12
 s_nop 1
 v_permlane16_swap_b32 v12, v16
 s_nop 1
 v_max_f32 v12, v12, v16
 v_max_f32 v12, s46, v12
 v_sub_f32 v10, v10, v12
 v_sub_f32 v36, v36, v12
 v_sub_f32 v37, v37, v12
 v_sub_f32 v38, v38, v12
 v_sub_f32 v39, v39, v12
 v_sub_f32 v44, v44, v12
 v_sub_f32 v45, v45, v12
 v_sub_f32 v46, v46, v12
 v_sub_f32 v47, v47, v12
 v_sub_f32 v52, v52, v12
 v_sub_f32 v53, v53, v12
 v_sub_f32 v54, v54, v12
 v_sub_f32 v55, v55, v12
 v_sub_f32 v60, v60, v12
 v_sub_f32 v61, v61, v12
 v_sub_f32 v62, v62, v12
 v_sub_f32 v63, v63, v12
 v_exp_f32 v68, v36
 v_mov_b32 v100, v10
 v_exp_f32 v69, v37
 v_mov_b32 v101, v10
 v_exp_f32 v70, v38
 v_mov_b32 v102, v10
 v_exp_f32 v71, v39
 v_mov_b32 v103, v10
 v_exp_f32 v76, v44
 v_mov_b32 v108, v10
 v_exp_f32 v77, v45
 v_mov_b32 v109, v10
 v_exp_f32 v78, v46
 v_mov_b32 v110, v10
 v_exp_f32 v79, v47
 v_mov_b32 v111, v10
 v_exp_f32 v84, v52
 v_mov_b32 v116, v10
 v_exp_f32 v85, v53
 v_mov_b32 v117, v10
 v_exp_f32 v86, v54
 v_mov_b32 v118, v10
 v_exp_f32 v87, v55
 v_mov_b32 v119, v10
 v_exp_f32 v92, v60
 v_mov_b32 v124, v10
 v_exp_f32 v93, v61
 v_mov_b32 v125, v10
 v_exp_f32 v94, v62
 v_mov_b32 v126, v10
 v_exp_f32 v95, v63
 v_mov_b32 v127, v10
 v_add_f32 v6, v68, v69
 v_add_f32 v6, v6, v70
 v_add_f32 v6, v6, v71
 v_add_f32 v6, v6, v76
 v_add_f32 v6, v6, v77
 v_add_f32 v6, v6, v78
 v_add_f32 v6, v6, v79
 v_add_f32 v6, v6, v84
 v_add_f32 v6, v6, v85
 v_add_f32 v6, v6, v86
 v_add_f32 v6, v6, v87
 v_add_f32 v6, v6, v92
 v_add_f32 v6, v6, v93
 v_add_f32 v6, v6, v94
 v_add_f32 v6, v6, v95
 v_mov_b32 v16, 0xf149f2ca
 v_cmp_gt_i32 s[16:17], 0, v14
 v_cmp_gt_i32 s[18:19], 1, v14
 v_cmp_gt_i32 s[20:21], 2, v14
 v_cmp_gt_i32 s[22:23], 3, v14
 v_cndmask_b32 v20, v9, v16, s[16:17]
 v_cndmask_b32 v21, v9, v16, s[18:19]
 v_cndmask_b32 v22, v9, v16, s[20:21]
 v_cndmask_b32 v23, v9, v16, s[22:23]
 v_accvgpr_write_b32 a224, v20
 v_accvgpr_write_b32 a225, v21
 v_accvgpr_write_b32 a226, v22
 v_accvgpr_write_b32 a227, v23
 v_cmp_gt_i32 s[16:17], 16, v14
 v_cmp_gt_i32 s[18:19], 17, v14
 v_cmp_gt_i32 s[20:21], 18, v14
 v_cmp_gt_i32 s[22:23], 19, v14
 v_cndmask_b32 v20, v9, v16, s[16:17]
 v_cndmask_b32 v21, v9, v16, s[18:19]
 v_cndmask_b32 v22, v9, v16, s[20:21]
 v_cndmask_b32 v23, v9, v16, s[22:23]
 v_accvgpr_write_b32 a228, v20
 v_accvgpr_write_b32 a229, v21
 v_accvgpr_write_b32 a230, v22
 v_accvgpr_write_b32 a231, v23
 v_cmp_gt_i32 s[16:17], 32, v14
 v_cmp_gt_i32 s[18:19], 33, v14
 v_cmp_gt_i32 s[20:21], 34, v14
 v_cmp_gt_i32 s[22:23], 35, v14
 v_cndmask_b32 v20, v9, v16, s[16:17]
 v_cndmask_b32 v21, v9, v16, s[18:19]
 v_cndmask_b32 v22, v9, v16, s[20:21]
 v_cndmask_b32 v23, v9, v16, s[22:23]
 v_accvgpr_write_b32 a232, v20
 v_accvgpr_write_b32 a233, v21
 v_accvgpr_write_b32 a234, v22
 v_accvgpr_write_b32 a235, v23
 v_cmp_gt_i32 s[16:17], 48, v14
 v_cmp_gt_i32 s[18:19], 49, v14
 v_cmp_gt_i32 s[20:21], 50, v14
 v_cmp_gt_i32 s[22:23], 51, v14
 v_cndmask_b32 v20, v9, v16, s[16:17]
 v_cndmask_b32 v21, v9, v16, s[18:19]
 v_cndmask_b32 v22, v9, v16, s[20:21]
 v_cndmask_b32 v23, v9, v16, s[22:23]
 v_accvgpr_write_b32 a236, v20
 v_accvgpr_write_b32 a237, v21
 v_accvgpr_write_b32 a238, v22
 v_accvgpr_write_b32 a239, v23
 s_waitcnt lgkmcnt(0)
 s_cmp_lg_u32 s46, 0
 s_mov_b32 s46, 0
 s_cbranch_scc1 L_ret
 v_exp_f32 v11, -v11
 s_nop 0
 v_mul_f32 v7, v7, v11
 v_mul_f32 v128, v128, v11
 v_mul_f32 v129, v129, v11
 v_mul_f32 v130, v130, v11
 v_mul_f32 v131, v131, v11
 v_mul_f32 v132, v132, v11
 v_mul_f32 v133, v133, v11
 v_mul_f32 v134, v134, v11
 v_mul_f32 v135, v135, v11
 v_mul_f32 v136, v136, v11
 v_mul_f32 v137, v137, v11
 v_mul_f32 v138, v138, v11
 v_mul_f32 v139, v139, v11
 v_mul_f32 v140, v140, v11
 v_mul_f32 v141, v141, v11
 v_mul_f32 v142, v142, v11
 v_mul_f32 v143, v143, v11
 v_mul_f32 v144, v144, v11
 v_mul_f32 v145, v145, v11
 v_mul_f32 v146, v146, v11
 v_mul_f32 v147, v147, v11
 v_mul_f32 v148, v148, v11
 v_mul_f32 v149, v149, v11
 v_mul_f32 v150, v150, v11
 v_mul_f32 v151, v151, v11
 v_mul_f32 v152, v152, v11
 v_mul_f32 v153, v153, v11
 v_mul_f32 v154, v154, v11
 v_mul_f32 v155, v155, v11
 v_mul_f32 v156, v156, v11
 v_mul_f32 v157, v157, v11
 v_mul_f32 v158, v158, v11
 v_mul_f32 v159, v159, v11
 v_mul_f32 v160, v160, v11
 v_mul_f32 v161, v161, v11
 v_mul_f32 v162, v162, v11
 v_mul_f32 v163, v163, v11
 v_mul_f32 v164, v164, v11
 v_mul_f32 v165, v165, v11
 v_mul_f32 v166, v166, v11
 v_mul_f32 v167, v167, v11
 v_mul_f32 v168, v168, v11
 v_mul_f32 v169, v169, v11
 v_mul_f32 v170, v170, v11
 v_mul_f32 v171, v171, v11
 v_mul_f32 v172, v172, v11
 v_mul_f32 v173, v173, v11
 v_mul_f32 v174, v174, v11
 v_mul_f32 v175, v175, v11
 v_mul_f32 v176, v176, v11
 v_mul_f32 v177, v177, v11
 v_mul_f32 v178, v178, v11
 v_mul_f32 v179, v179, v11
 v_mul_f32 v180, v180, v11
 v_mul_f32 v181, v181, v11
 v_mul_f32 v182, v182, v11
 v_mul_f32 v183, v183, v11
 v_mul_f32 v184, v184, v11
 v_mul_f32 v185, v185, v11
 v_mul_f32 v186, v186, v11
 v_mul_f32 v187, v187, v11
 v_mul_f32 v188, v188, v11
 v_mul_f32 v189, v189, v11
 v_mul_f32 v190, v190, v11
 v_mul_f32 v191, v191, v11
 v_exp_f32 v12, -v12
 s_nop 0
 v_mul_f32 v8, v8, v12
 v_mul_f32 v192, v192, v12
 v_mul_f32 v193, v193, v12
 v_mul_f32 v194, v194, v12
 v_mul_f32 v195, v195, v12
 v_mul_f32 v196, v196, v12
 v_mul_f32 v197, v197, v12
 v_mul_f32 v198, v198, v12
 v_mul_f32 v199, v199, v12
 v_mul_f32 v200, v200, v12
 v_mul_f32 v201, v201, v12
 v_mul_f32 v202, v202, v12
 v_mul_f32 v203, v203, v12
 v_mul_f32 v204, v204, v12
 v_mul_f32 v205, v205, v12
 v_mul_f32 v206, v206, v12
 v_mul_f32 v207, v207, v12
 v_mul_f32 v208, v208, v12
 v_mul_f32 v209, v209, v12
 v_mul_f32 v210, v210, v12
 v_mul_f32 v211, v211, v12
 v_mul_f32 v212, v212, v12
 v_mul_f32 v213, v213, v12
 v_mul_f32 v214, v214, v12
 v_mul_f32 v215, v215, v12
 v_mul_f32 v216, v216, v12
 v_mul_f32 v217, v217, v12
 v_mul_f32 v218, v218, v12
 v_mul_f32 v219, v219, v12
 v_mul_f32 v220, v220, v12
 v_mul_f32 v221, v221, v12
 v_mul_f32 v222, v222, v12
 v_mul_f32 v223, v223, v12
 v_mul_f32 v224, v224, v12
 v_mul_f32 v225, v225, v12
 v_mul_f32 v226, v226, v12
 v_mul_f32 v227, v227, v12
 v_mul_f32 v228, v228, v12
 v_mul_f32 v229, v229, v12
 v_mul_f32 v230, v230, v12
 v_mul_f32 v231, v231, v12
 v_mul_f32 v232, v232, v12
 v_mul_f32 v233, v233, v12
 v_mul_f32 v234, v234, v12
 v_mul_f32 v235, v235, v12
 v_mul_f32 v236, v236, v12
 v_mul_f32 v237, v237, v12
 v_mul_f32 v238, v238, v12
 v_mul_f32 v239, v239, v12
 v_mul_f32 v240, v240, v12
 v_mul_f32 v241, v241, v12
 v_mul_f32 v242, v242, v12
 v_mul_f32 v243, v243, v12
 v_mul_f32 v244, v244, v12
 v_mul_f32 v245, v245, v12
 v_mul_f32 v246, v246, v12
 v_mul_f32 v247, v247, v12
 v_mul_f32 v248, v248, v12
 v_mul_f32 v249, v249, v12
 v_mul_f32 v250, v250, v12
 v_mul_f32 v251, v251, v12
 v_mul_f32 v252, v252, v12
 v_mul_f32 v253, v253, v12
 v_mul_f32 v254, v254, v12
 v_mul_f32 v255, v255, v12
 s_branch L_ret
L_ret:
 s_cmp_gt_u32 s44, s45
 s_cbranch_scc1 L_loop
 s_branch L_ret2
L_disp:
 s_cmp_lt_u32 s44, 2
 s_cbranch_scc1 L_d1
 s_waitcnt vmcnt(0)
 v_accvgpr_read_b32 v12, a246
 v_cmp_ne_u32 vcc, 0, v12
 s_cbranch_vccz L_poll2_ok
 v_and_b32 v11, 11, v0
 v_lshlrev_b32 v11, 2, v11
 s_mov_b32 s32, 0
L_poll2:
 buffer_load_dword v12, v11, s[12:15], s60 offen sc1
 s_waitcnt vmcnt(0)
 v_cmp_ne_u32 vcc, 0, v12
 s_cbranch_vccz L_poll2_ok
 s_sleep 6
 s_add_u32 s32, s32, 1
 s_cmp_lt_u32 s32, 0x80000
 s_cbranch_scc1 L_poll2
L_poll2_ok:
 s_cmp_eq_u32 s38, 0
 s_cselect_b32 s60, s60, s94
 v_mov_b32 v15, 0
 s_mov_b32 s45, 2
 s_branch L_loop
L_d1:
 s_cmp_eq_u32 s54, 1
 s_cbranch_scc1 L_seg2
 s_cmp_eq_u32 s44, 0
 s_cbranch_scc1 L_p2
 s_cmp_eq_u32 s53, 0
 s_cbranch_scc1 L_g0y
 s_mov_b32 s53, 0
 s_add_u32 s52, s50, 131072
 s_mul_i32 s58, s3, 50176
 s_sub_u32 s58, 128, s58
 s_cmp_eq_u32 s7, 0
 s_cselect_b32 s42, s78, s49
 s_cmov_b32 s40, s52
 s_cmov_b64 s[8:9], s[86:87]
 s_cmov_b32 s10, 3670016
 s_cmov_b32 s76, 6144
 s_cmov_b32 s77, 10240
 s_mov_b32 s44, 1
 s_waitcnt vmcnt(0)
 s_barrier
 ds_read_b128 a[96:99], v3 offset:0
 ds_read_b128 a[100:103], v3 offset:16384
 ds_read_b128 a[104:107], v3 offset:1024
 ds_read_b128 a[108:111], v3 offset:17408
 ds_read_b128 a[112:115], v3 offset:2048
 ds_read_b128 a[116:119], v3 offset:18432
 s_branch L_g0y
L_g0x:
 v_cmp_nge_f32 vcc, s47, v11
 s_cbranch_vccnz L_slow
L_g0y:
 v_mov_b32 v16, 0xf149f2ca
 v_cmp_gt_i32 s[16:17], 0, v14
 v_cmp_gt_i32 s[18:19], 1, v14
 v_cmp_gt_i32 s[20:21], 2, v14
 v_cmp_gt_i32 s[22:23], 3, v14
 v_cndmask_b32 v100, v10, v16, s[16:17]
 v_cndmask_b32 v101, v10, v16, s[18:19]
 v_cndmask_b32 v102, v10, v16, s[20:21]
 v_cndmask_b32 v103, v10, v16, s[22:23]
 v_cmp_gt_i32 s[16:17], 16, v14
 v_cmp_gt_i32 s[18:19], 17, v14
 v_cmp_gt_i32 s[20:21], 18, v14
 v_cmp_gt_i32 s[22:23], 19, v14
 v_cndmask_b32 v108, v10, v16, s[16:17]
 v_cndmask_b32 v109, v10, v16, s[18:19]
 v_cndmask_b32 v110, v10, v16, s[20:21]
 v_cndmask_b32 v111, v10, v16, s[22:23]
 v_cmp_gt_i32 s[16:17], 32, v14
 v_cmp_gt_i32 s[18:19], 33, v14
 v_cmp_gt_i32 s[20:21], 34, v14
 v_cmp_gt_i32 s[22:23], 35, v14
 v_cndmask_b32 v116, v10, v16, s[16:17]
 v_cndmask_b32 v117, v10, v16, s[18:19]
 v_cndmask_b32 v118, v10, v16, s[20:21]
 v_cndmask_b32 v119, v10, v16, s[22:23]
 v_cmp_gt_i32 s[16:17], 48, v14
 v_cmp_gt_i32 s[18:19], 49, v14
 v_cmp_gt_i32 s[20:21], 50, v14
 v_cmp_gt_i32 s[22:23], 51, v14
 v_cndmask_b32 v124, v10, v16, s[16:17]
 v_cndmask_b32 v125, v10, v16, s[18:19]
 v_cndmask_b32 v126, v10, v16, s[20:21]
 v_cndmask_b32 v127, v10, v16, s[22:23]
 s_waitcnt lgkmcnt(0)
 s_cmp_eq_u32 s51, 1
 s_cbranch_scc1 L_p1
 s_cmp_eq_u32 s7, 0
 s_cbranch_scc1 L_g0z
 v_and_b32 v11, 0, v0
 v_lshlrev_b32 v11, 2, v11
 s_mov_b32 s32, 0
L_poll3:
 buffer_load_dword v12, v11, s[12:15], s60 offen sc1
 s_waitcnt vmcnt(0)
 v_cmp_ne_u32 vcc, 0, v12
 s_cbranch_vccz L_poll3_ok
 s_sleep 1
 s_add_u32 s32, s32, 1
 s_cmp_lt_u32 s32, 0x80000
 s_cbranch_scc1 L_poll3
L_poll3_ok:
 s_branch L_g0w
L_g0z:
 buffer_load_dword v12, v15, s[12:15], s60 offen sc1
 s_waitcnt vmcnt(0)
 v_cmp_ne_u32 vcc, 0, v12
L_g0w:
 s_cmp_eq_u64 vcc, 0
 s_cselect_b32 s51, 1, 0
 s_cselect_b32 s55, s4, 2.0
 s_cselect_b32 s56, s5, 2.0
 s_cselect_b32 s57, s6, 2.0
 buffer_load_dwordx4 a[192:195], v1, s[12:15], s57 offen sc1
 buffer_load_dwordx4 a[128:131], v1, s[12:15], s55 offen offset:0 sc1
 buffer_load_dwordx4 a[132:135], v1, s[12:15], s55 offen offset:1024 sc1
 buffer_load_dwordx4 a[136:139], v1, s[12:15], s55 offen offset:2048 sc1
 buffer_load_dwordx4 a[140:143], v1, s[12:15], s55 offen offset:3072 sc1
 buffer_load_dwordx4 a[144:147], v4, s[12:15], s55 offen offset:0 sc1
 buffer_load_dwordx4 a[148:151], v4, s[12:15], s55 offen offset:1024 sc1
 buffer_load_dwordx4 a[152:155], v4, s[12:15], s55 offen offset:2048 sc1
 buffer_load_dwordx4 a[156:159], v4, s[12:15], s55 offen offset:3072 sc1
 s_branch L_p1
L_seg2:
 s_cmp_eq_u32 s44, 0
 s_cbranch_scc1 L_tail
L_last:
 v_and_b32 v11, 31, v0
 v_lshlrev_b32 v11, 2, v11
 buffer_load_dword a247, v11, s[12:15], s61 offen sc1
 v_accvgpr_read_b32 v13, a241
 s_mov_b64 s[8:9], s[86:87]
 s_mov_b32 s10, 3670016
 s_mov_b32 s42, s78
 s_add_u32 s40, s50, 131072
 s_movk_i32 s76, 6144
 s_movk_i32 s77, 10240
 s_branch L_loop
L_switch:
 v_accvgpr_mov_b32 a32, a128
 v_accvgpr_mov_b32 a33, a129
 v_accvgpr_mov_b32 a34, a130
 v_accvgpr_mov_b32 a35, a131
 v_accvgpr_mov_b32 a36, a132
 v_accvgpr_mov_b32 a37, a133
 v_accvgpr_mov_b32 a38, a134
 v_accvgpr_mov_b32 a39, a135
 v_accvgpr_mov_b32 a40, a136
 v_accvgpr_mov_b32 a41, a137
 v_accvgpr_mov_b32 a42, a138
 v_accvgpr_mov_b32 a43, a139
 v_accvgpr_mov_b32 a44, a140
 v_accvgpr_mov_b32 a45, a141
 v_accvgpr_mov_b32 a46, a142
 v_accvgpr_mov_b32 a47, a143
 v_accvgpr_mov_b32 a48, a144
 v_accvgpr_mov_b32 a49, a145
 v_accvgpr_mov_b32 a50, a146
 v_accvgpr_mov_b32 a51, a147
 v_accvgpr_mov_b32 a52, a148
 v_accvgpr_mov_b32 a53, a149
 v_accvgpr_mov_b32 a54, a150
 v_accvgpr_mov_b32 a55, a151
 v_accvgpr_mov_b32 a56, a152
 v_accvgpr_mov_b32 a57, a153
 v_accvgpr_mov_b32 a58, a154
 v_accvgpr_mov_b32 a59, a155
 v_accvgpr_mov_b32 a60, a156
 v_accvgpr_mov_b32 a61, a157
 v_accvgpr_mov_b32 a62, a158
 v_accvgpr_mov_b32 a63, a159
 v_mov_b64 v[96:97], 0
 v_mov_b64 v[98:99], 0
 v_mov_b64 v[100:101], 0
 v_mov_b64 v[102:103], 0
 v_mov_b64 v[104:105], 0
 v_mov_b64 v[106:107], 0
 v_mov_b64 v[108:109], 0
 v_mov_b64 v[110:111], 0
 v_mov_b64 v[112:113], 0
 v_mov_b64 v[114:115], 0
 v_mov_b64 v[116:117], 0
 v_mov_b64 v[118:119], 0
 v_mov_b64 v[120:121], 0
 v_mov_b64 v[122:123], 0
 v_mov_b64 v[124:125], 0
 v_mov_b64 v[126:127], 0
 v_mov_b64 v[64:65], 0
 v_mov_b64 v[66:67], 0
 v_mov_b64 v[72:73], 0
 v_mov_b64 v[74:75], 0
 v_mov_b64 v[80:81], 0
 v_mov_b64 v[82:83], 0
 v_mov_b64 v[88:89], 0
 v_mov_b64 v[90:91], 0
 v_mov_b32 v5, 0
 s_add_u32 s42, s49, 32768
 s_xor_b32 s40, s40, 0x8000
 s_xor_b32 s41, s41, 0x8000
 s_add_u32 s43, s49, 16777216
 s_mov_b32 s44, s38
 s_mov_b32 s45, 1
 s_mov_b32 s47, -1.0
 s_waitcnt vmcnt(8) lgkmcnt(0)
 s_cmp_eq_u32 s38, 1
 s_cbranch_scc1 L_last
 s_branch L_loop
L_switched:
 v_mov_b32 v18, v7
 v_mov_b32 v19, v8
 s_nop 0
 v_permlane32_swap_b32 v7, v18
 v_permlane32_swap_b32 v8, v19
 s_nop 0
 v_add_f32 v7, v7, v18
 v_add_f32 v8, v8, v19
 s_nop 0
 v_mov_b32 v18, v7
 v_mov_b32 v19, v8
 s_nop 0
 v_permlane16_swap_b32 v7, v18
 v_permlane16_swap_b32 v8, v19
 s_nop 0
 v_add_f32 v7, v7, v18
 v_add_f32 v8, v8, v19
 s_nop 0
 v_rcp_f32 v16, v7
 v_rcp_f32 v17, v8
 s_mov_b32 s47, 0x4b800000
 s_mov_b32 s54, 1
 v_accvgpr_write_b32 a200, v16
 v_cvt_pk_bf16_f32 v128, v128, v129
 v_cvt_pk_bf16_f32 v129, v130, v131
 v_cvt_pk_bf16_f32 v130, v132, v133
 v_cvt_pk_bf16_f32 v131, v134, v135
 v_accvgpr_write_b32 a128, v128
 v_accvgpr_write_b32 a129, v129
 v_accvgpr_write_b32 a130, v130
 v_accvgpr_write_b32 a131, v131
 v_cvt_pk_bf16_f32 v136, v136, v137
 v_cvt_pk_bf16_f32 v137, v138, v139
 v_cvt_pk_bf16_f32 v138, v140, v141
 v_cvt_pk_bf16_f32 v139, v142, v143
 v_accvgpr_write_b32 a132, v136
 v_accvgpr_write_b32 a133, v137
 v_accvgpr_write_b32 a134, v138
 v_accvgpr_write_b32 a135, v139
 v_cvt_pk_bf16_f32 v144, v144, v145
 v_cvt_pk_bf16_f32 v145, v146, v147
 v_cvt_pk_bf16_f32 v146, v148, v149
 v_cvt_pk_bf16_f32 v147, v150, v151
 v_accvgpr_write_b32 a136, v144
 v_accvgpr_write_b32 a137, v145
 v_accvgpr_write_b32 a138, v146
 v_accvgpr_write_b32 a139, v147
 v_cvt_pk_bf16_f32 v152, v152, v153
 v_cvt_pk_bf16_f32 v153, v154, v155
 v_cvt_pk_bf16_f32 v154, v156, v157
 v_cvt_pk_bf16_f32 v155, v158, v159
 v_accvgpr_write_b32 a140, v152
 v_accvgpr_write_b32 a141, v153
 v_accvgpr_write_b32 a142, v154
 v_accvgpr_write_b32 a143, v155
 v_cvt_pk_bf16_f32 v160, v160, v161
 v_cvt_pk_bf16_f32 v161, v162, v163
 v_cvt_pk_bf16_f32 v162, v164, v165
 v_cvt_pk_bf16_f32 v163, v166, v167
 v_accvgpr_write_b32 a144, v160
 v_accvgpr_write_b32 a145, v161
 v_accvgpr_write_b32 a146, v162
 v_accvgpr_write_b32 a147, v163
 v_cvt_pk_bf16_f32 v168, v168, v169
 v_cvt_pk_bf16_f32 v169, v170, v171
 v_cvt_pk_bf16_f32 v170, v172, v173
 v_cvt_pk_bf16_f32 v171, v174, v175
 v_accvgpr_write_b32 a148, v168
 v_accvgpr_write_b32 a149, v169
 v_accvgpr_write_b32 a150, v170
 v_accvgpr_write_b32 a151, v171
 v_cvt_pk_bf16_f32 v176, v176, v177
 v_cvt_pk_bf16_f32 v177, v178, v179
 v_cvt_pk_bf16_f32 v178, v180, v181
 v_cvt_pk_bf16_f32 v179, v182, v183
 v_accvgpr_write_b32 a152, v176
 v_accvgpr_write_b32 a153, v177
 v_accvgpr_write_b32 a154, v178
 v_accvgpr_write_b32 a155, v179
 v_cvt_pk_bf16_f32 v184, v184, v185
 v_cvt_pk_bf16_f32 v185, v186, v187
 v_cvt_pk_bf16_f32 v186, v188, v189
 v_cvt_pk_bf16_f32 v187, v190, v191
 v_accvgpr_write_b32 a156, v184
 v_accvgpr_write_b32 a157, v185
 v_accvgpr_write_b32 a158, v186
 v_accvgpr_write_b32 a159, v187
 v_accvgpr_write_b32 a201, v17
 v_cvt_pk_bf16_f32 v192, v192, v193
 v_cvt_pk_bf16_f32 v193, v194, v195
 v_cvt_pk_bf16_f32 v194, v196, v197
 v_cvt_pk_bf16_f32 v195, v198, v199
 v_accvgpr_write_b32 a160, v192
 v_accvgpr_write_b32 a161, v193
 v_accvgpr_write_b32 a162, v194
 v_accvgpr_write_b32 a163, v195
 v_cvt_pk_bf16_f32 v200, v200, v201
 v_cvt_pk_bf16_f32 v201, v202, v203
 v_cvt_pk_bf16_f32 v202, v204, v205
 v_cvt_pk_bf16_f32 v203, v206, v207
 v_accvgpr_write_b32 a164, v200
 v_accvgpr_write_b32 a165, v201
 v_accvgpr_write_b32 a166, v202
 v_accvgpr_write_b32 a167, v203
 v_cvt_pk_bf16_f32 v208, v208, v209
 v_cvt_pk_bf16_f32 v209, v210, v211
 v_cvt_pk_bf16_f32 v210, v212, v213
 v_cvt_pk_bf16_f32 v211, v214, v215
 v_accvgpr_write_b32 a168, v208
 v_accvgpr_write_b32 a169, v209
 v_accvgpr_write_b32 a170, v210
 v_accvgpr_write_b32 a171, v211
 v_cvt_pk_bf16_f32 v216, v216, v217
 v_cvt_pk_bf16_f32 v217, v218, v219
 v_cvt_pk_bf16_f32 v218, v220, v221
 v_cvt_pk_bf16_f32 v219, v222, v223
 v_accvgpr_write_b32 a172, v216
 v_accvgpr_write_b32 a173, v217
 v_accvgpr_write_b32 a174, v218
 v_accvgpr_write_b32 a175, v219
 v_cvt_pk_bf16_f32 v224, v224, v225
 v_cvt_pk_bf16_f32 v225, v226, v227
 v_cvt_pk_bf16_f32 v226, v228, v229
 v_cvt_pk_bf16_f32 v227, v230, v231
 v_accvgpr_write_b32 a176, v224
 v_accvgpr_write_b32 a177, v225
 v_accvgpr_write_b32 a178, v226
 v_accvgpr_write_b32 a179, v227
 v_cvt_pk_bf16_f32 v232, v232, v233
 v_cvt_pk_bf16_f32 v233, v234, v235
 v_cvt_pk_bf16_f32 v234, v236, v237
 v_cvt_pk_bf16_f32 v235, v238, v239
 v_accvgpr_write_b32 a180, v232
 v_accvgpr_write_b32 a181, v233
 v_accvgpr_write_b32 a182, v234
 v_accvgpr_write_b32 a183, v235
 v_cvt_pk_bf16_f32 v240, v240, v241
 v_cvt_pk_bf16_f32 v241, v242, v243
 v_cvt_pk_bf16_f32 v242, v244, v245
 v_cvt_pk_bf16_f32 v243, v246, v247
 v_accvgpr_write_b32 a184, v240
 v_accvgpr_write_b32 a185, v241
 v_accvgpr_write_b32 a186, v242
 v_accvgpr_write_b32 a187, v243
 v_cvt_pk_bf16_f32 v248, v248, v249
 v_cvt_pk_bf16_f32 v249, v250, v251
 v_cvt_pk_bf16_f32 v250, v252, v253
 v_cvt_pk_bf16_f32 v251, v254, v255
 v_accvgpr_write_b32 a188, v248
 v_accvgpr_write_b32 a189, v249
 v_accvgpr_write_b32 a190, v250
 v_accvgpr_write_b32 a191, v251
 v_mov_b64 v[128:129], 0
 v_mov_b64 v[130:131], 0
 v_mov_b64 v[132:133], 0
 v_mov_b64 v[134:135], 0
 v_mov_b64 v[136:137], 0
 v_mov_b64 v[138:139], 0
 v_mov_b64 v[140:141], 0
 v_mov_b64 v[142:143], 0
 v_mov_b64 v[144:145], 0
 v_mov_b64 v[146:147], 0
 v_mov_b64 v[148:149], 0
 v_mov_b64 v[150:151], 0
 v_mov_b64 v[152:153], 0
 v_mov_b64 v[154:155], 0
 v_mov_b64 v[156:157], 0
 v_mov_b64 v[158:159], 0
 v_mov_b64 v[160:161], 0
 v_mov_b64 v[162:163], 0
 v_mov_b64 v[164:165], 0
 v_mov_b64 v[166:167], 0
 v_mov_b64 v[168:169], 0
 v_mov_b64 v[170:171], 0
 v_mov_b64 v[172:173], 0
 v_mov_b64 v[174:175], 0
 v_mov_b64 v[176:177], 0
 v_mov_b64 v[178:179], 0
 v_mov_b64 v[180:181], 0
 v_mov_b64 v[182:183], 0
 v_mov_b64 v[184:185], 0
 v_mov_b64 v[186:187], 0
 v_mov_b64 v[188:189], 0
 v_mov_b64 v[190:191], 0
 v_mov_b64 v[192:193], 0
 v_mov_b64 v[194:195], 0
 v_mov_b64 v[196:197], 0
 v_mov_b64 v[198:199], 0
 v_mov_b64 v[200:201], 0
 v_mov_b64 v[202:203], 0
 v_mov_b64 v[204:205], 0
 v_mov_b64 v[206:207], 0
 v_mov_b64 v[208:209], 0
 v_mov_b64 v[210:211], 0
 v_mov_b64 v[212:213], 0
 v_mov_b64 v[214:215], 0
 v_mov_b64 v[216:217], 0
 v_mov_b64 v[218:219], 0
 v_mov_b64 v[220:221], 0
 v_mov_b64 v[222:223], 0
 v_mov_b64 v[224:225], 0
 v_mov_b64 v[226:227], 0
 v_mov_b64 v[228:229], 0
 v_mov_b64 v[230:231], 0
 v_mov_b64 v[232:233], 0
 v_mov_b64 v[234:235], 0
 v_mov_b64 v[236:237], 0
 v_mov_b64 v[238:239], 0
 v_mov_b64 v[240:241], 0
 v_mov_b64 v[242:243], 0
 v_mov_b64 v[244:245], 0
 v_mov_b64 v[246:247], 0
 v_mov_b64 v[248:249], 0
 v_mov_b64 v[250:251], 0
 v_mov_b64 v[252:253], 0
 v_mov_b64 v[254:255], 0
 v_mov_b32 v7, 0
 v_mov_b32 v8, 0
 v_mov_b32 v9, 0
 v_mov_b32 v10, 0
 s_branch L_first
L_fagen:
 v_mov_b32 v5, 0
 buffer_load_dword a246, v15, s[12:15], s60 offen sc1
 v_mov_b32 v64, 0
 v_mov_b32 v65, 0
 v_mov_b32 v66, 0
 v_mov_b32 v67, 0
 v_mov_b32 v72, 0
 v_mov_b32 v73, 0
 v_mov_b32 v74, 0
 v_mov_b32 v75, 0
 v_mov_b32 v80, 0
 v_mov_b32 v81, 0
 v_mov_b32 v82, 0
 v_mov_b32 v83, 0
 v_mov_b32 v88, 0
 v_mov_b32 v89, 0
 v_mov_b32 v90, 0
 v_mov_b32 v91, 0
L_tail:
 s_and_b32 s55, s2, 127
 s_lshl_b32 s57, s55, 2
 s_add_u32 s57, s57, s3
 s_mul_i32 s55, s57, 17408
 s_add_u32 s55, s55, 67108864
 s_lshl_b32 s57, s57, 10
 s_add_u32 s57, s57, 83886080
 s_mul_i32 s58, s3, 50176
 s_sub_u32 s58, 128, s58
 v_add_u32 v2, s58, v13
 v_cvt_pk_bf16_f32 v16, v64, v65
 v_cvt_pk_bf16_f32 v17, v66, v67
 v_cvt_pk_bf16_f32 v20, v68, v69
 v_cvt_pk_bf16_f32 v21, v70, v71
 v_cvt_pk_bf16_f32 v18, v72, v73
 v_cvt_pk_bf16_f32 v19, v74, v75
 v_cvt_pk_bf16_f32 v22, v76, v77
 v_cvt_pk_bf16_f32 v23, v78, v79
 v_cvt_pk_bf16_f32 v24, v80, v81
 v_cvt_pk_bf16_f32 v25, v82, v83
 v_cvt_pk_bf16_f32 v28, v84, v85
 v_cvt_pk_bf16_f32 v29, v86, v87
 v_cvt_pk_bf16_f32 v26, v88, v89
 v_cvt_pk_bf16_f32 v27, v90, v91
 v_cvt_pk_bf16_f32 v30, v92, v93
 v_cvt_pk_bf16_f32 v31, v94, v95
 v_add_f32 v7, v7, v5
 v_add_f32 v8, v8, v6
 s_waitcnt vmcnt(0) lgkmcnt(0)
 s_barrier
 ds_read_b128 a[64:67], v3 offset:0
 ds_read_b128 a[68:71], v3 offset:16384
 ds_read_b128 a[72:75], v3 offset:1024
 ds_read_b128 a[76:79], v3 offset:17408
 ds_read_b128 a[80:83], v3 offset:2048
 ds_read_b128 a[84:87], v3 offset:18432
 ds_read_b128 a[88:91], v3 offset:3072
 ds_read_b128 a[92:95], v3 offset:19456
 s_cmp_lg_u32 s38, 0
 s_cselect_b32 s58, s54, 0
 s_cmp_eq_u32 s58, 2
 s_cbranch_scc1 L_tail2
 s_cmp_eq_u32 s62, 0
 s_cbranch_scc1 L_nou
 v_accvgpr_read_b32 v12, a247
 v_cmp_ne_u32 vcc, 0, v12
 s_cbranch_vccz L_poll4_ok
 v_and_b32 v11, 31, v0
 v_lshlrev_b32 v11, 2, v11
 s_mov_b32 s32, 0
L_poll4:
 buffer_load_dword v12, v11, s[12:15], s61 offen sc1
 s_waitcnt vmcnt(0)
 v_cmp_ne_u32 vcc, 0, v12
 s_cbranch_vccz L_poll4_ok
 s_sleep 6
 s_add_u32 s32, s32, 1
 s_cmp_lt_u32 s32, 0x80000
 s_cbranch_scc1 L_poll4
L_poll4_ok:
L_nou:
 s_cmp_eq_u32 s54, 1
 s_cselect_b32 s55, s55, 2.0
 s_cselect_b32 s57, s57, 2.0
 s_cselect_b32 s59, s94, 2.0
 s_add_u32 s56, s55, 0x2000
 s_waitcnt lgkmcnt(0)
 v_mfma_f32_16x16x32_bf16 v[128:131], a[64:67], v[16:19], v[128:131]
 s_add_u32 m0, s29, 0
 ds_read_b128 a[96:99], v3 offset:4096
 v_mov_b32 v72, v7
 v_mfma_f32_16x16x32_bf16 v[128:131], a[68:71], v[24:27], v[128:131]
 buffer_load_dwordx4 v2, s[8:11], s78 offen lds
 v_mfma_f32_16x16x32_bf16 v[192:195], a[68:71], v[28:31], v[192:195]
 ds_read_b128 a[100:103], v3 offset:20480
 v_mov_b32 v73, v8
 v_mfma_f32_16x16x32_bf16 v[192:195], a[64:67], v[20:23], v[192:195]
 v_permlane32_swap_b32 v7, v72
 v_permlane32_swap_b32 v8, v73
 v_mfma_f32_16x16x32_bf16 v[132:135], a[72:75], v[16:19], v[132:135]
 s_add_u32 m0, s29, 4096
 ds_read_b128 a[104:107], v3 offset:5120
 v_accvgpr_read_b32 v44, a254
 v_mfma_f32_16x16x32_bf16 v[132:135], a[76:79], v[24:27], v[132:135]
 buffer_load_dwordx4 v2, s[8:11], s79 offen lds
 v_mfma_f32_16x16x32_bf16 v[196:199], a[76:79], v[28:31], v[196:199]
 ds_read_b128 a[108:111], v3 offset:21504
 v_add_f32 v7, v7, v72
 v_mfma_f32_16x16x32_bf16 v[196:199], a[72:75], v[20:23], v[196:199]
 v_add_f32 v8, v8, v73
 v_mfma_f32_16x16x32_bf16 v[136:139], a[80:83], v[16:19], v[136:139]
 s_add_u32 m0, s29, 8192
 ds_read_b128 a[112:115], v3 offset:6144
 v_mov_b32 v72, v7
 v_mfma_f32_16x16x32_bf16 v[136:139], a[84:87], v[24:27], v[136:139]
 buffer_load_dwordx4 v2, s[8:11], s80 offen lds
 v_mfma_f32_16x16x32_bf16 v[200:203], a[84:87], v[28:31], v[200:203]
 s_add_u32 m0, s29, 12288
 ds_read_b128 a[116:119], v3 offset:22528
 v_mov_b32 v73, v8
 v_mfma_f32_16x16x32_bf16 v[200:203], a[80:83], v[20:23], v[200:203]
 buffer_load_dwordx4 v2, s[8:11], s81 offen lds
 v_mfma_f32_16x16x32_bf16 v[140:143], a[88:91], v[16:19], v[140:143]
 s_add_u32 m0, s29, 16384
 ds_read_b128 a[120:123], v3 offset:7168
 v_mfma_f32_16x16x32_bf16 v[140:143], a[92:95], v[24:27], v[140:143]
 buffer_load_dwordx4 v2, s[8:11], s82 offen lds
 v_mfma_f32_16x16x32_bf16 v[204:207], a[92:95], v[28:31], v[204:207]
 ds_read_b128 a[124:127], v3 offset:23552
 v_permlane16_swap_b32 v7, v72
 v_mfma_f32_16x16x32_bf16 v[204:207], a[88:91], v[20:23], v[204:207]
 s_waitcnt lgkmcnt(6)
 v_permlane16_swap_b32 v8, v73
 v_cvt_pk_bf16_f32 v128, v128, v129
 v_mfma_f32_16x16x32_bf16 v[144:147], a[96:99], v[16:19], v[144:147]
 s_add_u32 m0, s29, 20480
 ds_read_b128 a[64:67], v3 offset:8192
 v_cvt_pk_bf16_f32 v129, v130, v131
 v_mfma_f32_16x16x32_bf16 v[144:147], a[100:103], v[24:27], v[144:147]
 buffer_load_dwordx4 v2, s[8:11], s83 offen lds
 v_mfma_f32_16x16x32_bf16 v[208:211], a[100:103], v[28:31], v[208:211]
 s_add_u32 m0, s29, 24576
 ds_read_b128 a[68:71], v3 offset:24576
 v_add_f32 v7, v7, v72
 v_mfma_f32_16x16x32_bf16 v[208:211], a[96:99], v[20:23], v[208:211]
 s_waitcnt lgkmcnt(6)
 buffer_load_dwordx4 v2, s[8:11], s84 offen lds
 v_mfma_f32_16x16x32_bf16 v[148:151], a[104:107], v[16:19], v[148:151]
 s_add_u32 m0, s29, 28672
 ds_read_b128 a[72:75], v3 offset:9216
 v_add_f32 v8, v8, v73
 v_mfma_f32_16x16x32_bf16 v[148:151], a[108:111], v[24:27], v[148:151]
 buffer_load_dwordx4 v2, s[8:11], s85 offen lds
 v_mfma_f32_16x16x32_bf16 v[212:215], a[108:111], v[28:31], v[212:215]
 ds_read_b128 a[76:79], v3 offset:25600
 v_add_u32 v2, 128, v2
 v_mfma_f32_16x16x32_bf16 v[212:215], a[104:107], v[20:23], v[212:215]
 s_waitcnt lgkmcnt(6)
 v_cvt_pk_bf16_f32 v130, v132, v133
 v_cvt_pk_bf16_f32 v131, v134, v135
 v_mfma_f32_16x16x32_bf16 v[152:155], a[112:115], v[16:19], v[152:155]
 ds_read_b128 a[80:83], v3 offset:10240
 v_cvt_pk_bf16_f32 v192, v192, v193
 v_mfma_f32_16x16x32_bf16 v[152:155], a[116:119], v[24:27], v[152:155]
 buffer_store_dwordx4 v[128:131], v1, s[12:15], s55 offen offset:0 sc1
 v_mfma_f32_16x16x32_bf16 v[216:219], a[116:119], v[28:31], v[216:219]
 ds_read_b128 a[84:87], v3 offset:26624
 v_cvt_pk_bf16_f32 v193, v194, v195
 v_mfma_f32_16x16x32_bf16 v[216:219], a[112:115], v[20:23], v[216:219]
 s_waitcnt lgkmcnt(6)
 v_cvt_pk_bf16_f32 v194, v196, v197
 v_cvt_pk_bf16_f32 v195, v198, v199
 v_mfma_f32_16x16x32_bf16 v[156:159], a[120:123], v[16:19], v[156:159]
 ds_read_b128 a[88:91], v3 offset:11264
 v_cvt_pk_bf16_f32 v136, v136, v137
 v_mfma_f32_16x16x32_bf16 v[156:159], a[124:127], v[24:27], v[156:159]
 buffer_store_dwordx4 v[192:195], v1, s[12:15], s56 offen offset:0 sc1
 v_mfma_f32_16x16x32_bf16 v[220:223], a[124:127], v[28:31], v[220:223]
 ds_read_b128 a[92:95], v3 offset:27648
 v_cvt_pk_bf16_f32 v137, v138, v139
 v_mfma_f32_16x16x32_bf16 v[220:223], a[120:123], v[20:23], v[220:223]
 s_waitcnt lgkmcnt(6)
 v_cvt_pk_bf16_f32 v138, v140, v141
 v_cvt_pk_bf16_f32 v139, v142, v143
 v_mfma_f32_16x16x32_bf16 v[160:163], a[64:67], v[16:19], v[160:163]
 ds_read_b128 a[96:99], v3 offset:12288
 v_cvt_pk_bf16_f32 v200, v200, v201
 v_mfma_f32_16x16x32_bf16 v[160:163], a[68:71], v[24:27], v[160:163]
 buffer_store_dwordx4 v[136:139], v1, s[12:15], s55 offen offset:1024 sc1
 v_mfma_f32_16x16x32_bf16 v[224:227], a[68:71], v[28:31], v[224:227]
 ds_read_b128 a[100:103], v3 offset:28672
 v_cvt_pk_bf16_f32 v201, v202, v203
 v_mfma_f32_16x16x32_bf16 v[224:227], a[64:67], v[20:23], v[224:227]
 s_waitcnt lgkmcnt(6)
 v_cvt_pk_bf16_f32 v202, v204, v205
 v_cvt_pk_bf16_f32 v203, v206, v207
 v_mfma_f32_16x16x32_bf16 v[164:167], a[72:75], v[16:19], v[164:167]
 ds_read_b128 a[104:107], v3 offset:13312
 v_cvt_pk_bf16_f32 v144, v144, v145
 v_mfma_f32_16x16x32_bf16 v[164:167], a[76:79], v[24:27], v[164:167]
 buffer_store_dwordx4 v[200:203], v1, s[12:15], s56 offen offset:1024 sc1
 v_mfma_f32_16x16x32_bf16 v[228:231], a[76:79], v[28:31], v[228:231]
 ds_read_b128 a[108:111], v3 offset:29696
 v_cvt_pk_bf16_f32 v145, v146, v147
 v_mfma_f32_16x16x32_bf16 v[228:231], a[72:75], v[20:23], v[228:231]
 s_waitcnt lgkmcnt(6)
 v_cvt_pk_bf16_f32 v146, v148, v149
 v_cvt_pk_bf16_f32 v147, v150, v151
 v_mfma_f32_16x16x32_bf16 v[168:171], a[80:83], v[16:19], v[168:171]
 ds_read_b128 a[112:115], v3 offset:14336
 v_cvt_pk_bf16_f32 v208, v208, v209
 v_mfma_f32_16x16x32_bf16 v[168:171], a[84:87], v[24:27], v[168:171]
 buffer_store_dwordx4 v[144:147], v1, s[12:15], s55 offen offset:2048 sc1
 v_mfma_f32_16x16x32_bf16 v[232:235], a[84:87], v[28:31], v[232:235]
 ds_read_b128 a[116:119], v3 offset:30720
 v_cvt_pk_bf16_f32 v209, v210, v211
 v_mfma_f32_16x16x32_bf16 v[232:235], a[80:83], v[20:23], v[232:235]
 s_waitcnt lgkmcnt(6)
 v_cvt_pk_bf16_f32 v210, v212, v213
 v_cvt_pk_bf16_f32 v211, v214, v215
 v_mfma_f32_16x16x32_bf16 v[172:175], a[88:91], v[16:19], v[172:175]
 ds_read_b128 a[120:123], v3 offset:15360
 v_cvt_pk_bf16_f32 v152, v152, v153
 v_mfma_f32_16x16x32_bf16 v[172:175], a[92:95], v[24:27], v[172:175]
 buffer_store_dwordx4 v[208:211], v1, s[12:15], s56 offen offset:2048 sc1
 v_mfma_f32_16x16x32_bf16 v[236:239], a[92:95], v[28:31], v[236:239]
 ds_read_b128 a[124:127], v3 offset:31744
 v_cvt_pk_bf16_f32 v153, v154, v155
 v_mfma_f32_16x16x32_bf16 v[236:239], a[88:91], v[20:23], v[236:239]
 s_waitcnt lgkmcnt(6)
 v_cvt_pk_bf16_f32 v154, v156, v157
 v_cvt_pk_bf16_f32 v155, v158, v159
 v_mfma_f32_16x16x32_bf16 v[176:179], a[96:99], v[16:19], v[176:179]
 v_cvt_pk_bf16_f32 v216, v216, v217
 v_cvt_pk_bf16_f32 v217, v218, v219
 v_mfma_f32_16x16x32_bf16 v[176:179], a[100:103], v[24:27], v[176:179]
 buffer_store_dwordx4 v[152:155], v1, s[12:15], s55 offen offset:3072 sc1
 v_mfma_f32_16x16x32_bf16 v[240:243], a[100:103], v[28:31], v[240:243]
 v_cvt_pk_bf16_f32 v218, v220, v221
 v_cvt_pk_bf16_f32 v219, v222, v223
 v_mfma_f32_16x16x32_bf16 v[240:243], a[96:99], v[20:23], v[240:243]
 s_waitcnt lgkmcnt(4)
 v_cvt_pk_bf16_f32 v160, v160, v161
 v_cvt_pk_bf16_f32 v161, v162, v163
 v_mfma_f32_16x16x32_bf16 v[180:183], a[104:107], v[16:19], v[180:183]
 v_cvt_pk_bf16_f32 v162, v164, v165
 v_cvt_pk_bf16_f32 v163, v166, v167
 v_mfma_f32_16x16x32_bf16 v[180:183], a[108:111], v[24:27], v[180:183]
 buffer_store_dwordx4 v[216:219], v1, s[12:15], s56 offen offset:3072 sc1
 v_mfma_f32_16x16x32_bf16 v[244:247], a[108:111], v[28:31], v[244:247]
 v_cvt_pk_bf16_f32 v224, v224, v225
 v_cvt_pk_bf16_f32 v225, v226, v227
 v_mfma_f32_16x16x32_bf16 v[244:247], a[104:107], v[20:23], v[244:247]
 s_waitcnt lgkmcnt(2)
 v_cvt_pk_bf16_f32 v226, v228, v229
 v_cvt_pk_bf16_f32 v227, v230, v231
 v_mfma_f32_16x16x32_bf16 v[184:187], a[112:115], v[16:19], v[184:187]
 v_cvt_pk_bf16_f32 v168, v168, v169
 v_cvt_pk_bf16_f32 v169, v170, v171
 v_mfma_f32_16x16x32_bf16 v[184:187], a[116:119], v[24:27], v[184:187]
 buffer_store_dwordx4 v[160:163], v4, s[12:15], s55 offen offset:0 sc1
 v_mfma_f32_16x16x32_bf16 v[248:251], a[116:119], v[28:31], v[248:251]
 v_cvt_pk_bf16_f32 v170, v172, v173
 v_cvt_pk_bf16_f32 v171, v174, v175
 v_mfma_f32_16x16x32_bf16 v[248:251], a[112:115], v[20:23], v[248:251]
 s_waitcnt lgkmcnt(0)
 v_cvt_pk_bf16_f32 v232, v232, v233
 v_cvt_pk_bf16_f32 v233, v234, v235
 v_mfma_f32_16x16x32_bf16 v[188:191], a[120:123], v[16:19], v[188:191]
 v_cvt_pk_bf16_f32 v234, v236, v237
 v_cvt_pk_bf16_f32 v235, v238, v239
 v_mfma_f32_16x16x32_bf16 v[188:191], a[124:127], v[24:27], v[188:191]
 buffer_store_dwordx4 v[224:227], v4, s[12:15], s56 offen offset:0 sc1
 v_mfma_f32_16x16x32_bf16 v[252:255], a[124:127], v[28:31], v[252:255]
 v_mfma_f32_16x16x32_bf16 v[252:255], a[120:123], v[20:23], v[252:255]
 ds_read_b64_tr_b16 a[0:1], v44 offset:0
 ds_read_b64_tr_b16 a[2:3], v44 offset:2048
 ds_read_b64_tr_b16 a[4:5], v44 offset:4096
 ds_read_b64_tr_b16 a[6:7], v44 offset:6144
 ds_read_b64_tr_b16 a[8:9], v44 offset:8192
 ds_read_b64_tr_b16 a[10:11], v44 offset:10240
 ds_read_b64_tr_b16 a[12:13], v44 offset:12288
 ds_read_b64_tr_b16 a[14:15], v44 offset:14336
 ds_read_b64_tr_b16 a[16:17], v44 offset:16384
 ds_read_b64_tr_b16 a[18:19], v44 offset:18432
 ds_read_b64_tr_b16 a[20:21], v44 offset:20480
 ds_read_b64_tr_b16 a[22:23], v44 offset:22528
 ds_read_b64_tr_b16 a[24:25], v44 offset:24576
 ds_read_b64_tr_b16 a[26:27], v44 offset:26624
 v_mov_b32 v68, v7
 v_mov_b32 v69, v8
 v_mov_b32 v70, v9
 v_mov_b32 v71, v10
 v_accvgpr_read_b32 v64, a200
 v_accvgpr_read_b32 v65, a201
 v_cvt_pk_bf16_f32 v176, v176, v177
 v_cvt_pk_bf16_f32 v177, v178, v179
 v_cvt_pk_bf16_f32 v178, v180, v181
 v_cvt_pk_bf16_f32 v179, v182, v183
 v_cvt_pk_bf16_f32 v240, v240, v241
 v_cvt_pk_bf16_f32 v241, v242, v243
 v_cvt_pk_bf16_f32 v242, v244, v245
 v_cvt_pk_bf16_f32 v243, v246, v247
 v_cvt_pk_bf16_f32 v184, v184, v185
 v_cvt_pk_bf16_f32 v185, v186, v187
 v_cvt_pk_bf16_f32 v186, v188, v189
 v_cvt_pk_bf16_f32 v187, v190, v191
 v_cvt_pk_bf16_f32 v248, v248, v249
 v_cvt_pk_bf16_f32 v249, v250, v251
 v_cvt_pk_bf16_f32 v250, v252, v253
 v_cvt_pk_bf16_f32 v251, v254, v255
 s_branch L_op0in
L_t1park:
 v_accvgpr_write_b32 a128, v128
 v_accvgpr_write_b32 a129, v129
 v_accvgpr_write_b32 a130, v130
 v_accvgpr_write_b32 a131, v131
 v_accvgpr_write_b32 a160, v192
 v_accvgpr_write_b32 a161, v193
 v_accvgpr_write_b32 a162, v194
 v_accvgpr_write_b32 a163, v195
 v_accvgpr_write_b32 a132, v136
 v_accvgpr_write_b32 a133, v137
 v_accvgpr_write_b32 a134, v138
 v_accvgpr_write_b32 a135, v139
 v_accvgpr_write_b32 a164, v200
 v_accvgpr_write_b32 a165, v201
 v_accvgpr_write_b32 a166, v202
 v_accvgpr_write_b32 a167, v203
 v_accvgpr_write_b32 a136, v144
 v_accvgpr_write_b32 a137, v145
 v_accvgpr_write_b32 a138, v146
 v_accvgpr_write_b32 a139, v147
 v_accvgpr_write_b32 a168, v208
 v_accvgpr_write_b32 a169, v209
 v_accvgpr_write_b32 a170, v210
 v_accvgpr_write_b32 a171, v211
 v_accvgpr_write_b32 a140, v152
 v_accvgpr_write_b32 a141, v153
 v_accvgpr_write_b32 a142, v154
 v_accvgpr_write_b32 a143, v155
 v_accvgpr_write_b32 a172, v216
 v_accvgpr_write_b32 a173, v217
 v_accvgpr_write_b32 a174, v218
 v_accvgpr_write_b32 a175, v219
 v_accvgpr_write_b32 a144, v160
 v_accvgpr_write_b32 a145, v161
 v_accvgpr_write_b32 a146, v162
 v_accvgpr_write_b32 a147, v163
 v_accvgpr_write_b32 a176, v224
 v_accvgpr_write_b32 a177, v225
 v_accvgpr_write_b32 a178, v226
 v_accvgpr_write_b32 a179, v227
 v_accvgpr_write_b32 a148, v168
 v_accvgpr_write_b32 a149, v169
 v_accvgpr_write_b32 a150, v170
 v_accvgpr_write_b32 a151, v171
 v_accvgpr_write_b32 a180, v232
 v_accvgpr_write_b32 a181, v233
 v_accvgpr_write_b32 a182, v234
 v_accvgpr_write_b32 a183, v235
 v_accvgpr_write_b32 a152, v176
 v_accvgpr_write_b32 a153, v177
 v_accvgpr_write_b32 a154, v178
 v_accvgpr_write_b32 a155, v179
 v_accvgpr_write_b32 a184, v240
 v_accvgpr_write_b32 a185, v241
 v_accvgpr_write_b32 a186, v242
 v_accvgpr_write_b32 a187, v243
 v_accvgpr_write_b32 a156, v184
 v_accvgpr_write_b32 a157, v185
 v_accvgpr_write_b32 a158, v186
 v_accvgpr_write_b32 a159, v187
 v_accvgpr_write_b32 a188, v248
 v_accvgpr_write_b32 a189, v249
 v_accvgpr_write_b32 a190, v250
 v_accvgpr_write_b32 a191, v251
 s_branch L_opB
L_tail2:
 v_accvgpr_read_b32 v11, a246
 s_mov_b32 s52, s55
 s_mov_b32 s53, s57
 v_readfirstlane_b32 s58, v11
 s_mov_b32 s59, 2.0
 s_nop 1
 s_cmp_eq_u32 s58, 0
 s_cselect_b32 s55, s55, 2.0
 s_cselect_b32 s57, s57, 2.0
 s_add_u32 s56, s55, 0x2000
 buffer_load_dwordx4 v[68:71], v1, s[12:15], s57 offen sc1
 s_waitcnt lgkmcnt(0)
 v_mfma_f32_16x16x32_bf16 v[128:131], a[64:67], v[16:19], v[128:131]
 ds_read_b128 a[96:99], v3 offset:4096
 v_mfma_f32_16x16x32_bf16 v[128:131], a[68:71], v[24:27], v[128:131]
 buffer_load_dwordx4 v[32:35], v1, s[12:15], s55 offen offset:0 sc1
 v_mfma_f32_16x16x32_bf16 v[192:195], a[68:71], v[28:31], v[192:195]
 ds_read_b128 a[100:103], v3 offset:20480
 v_mfma_f32_16x16x32_bf16 v[192:195], a[64:67], v[20:23], v[192:195]
 v_mov_b32 v72, v7
 v_mov_b32 v73, v8
 v_mfma_f32_16x16x32_bf16 v[132:135], a[72:75], v[16:19], v[132:135]
 ds_read_b128 a[104:107], v3 offset:5120
 v_mfma_f32_16x16x32_bf16 v[132:135], a[76:79], v[24:27], v[132:135]
 buffer_load_dwordx4 v[96:99], v1, s[12:15], s56 offen offset:0 sc1
 v_mfma_f32_16x16x32_bf16 v[196:199], a[76:79], v[28:31], v[196:199]
 ds_read_b128 a[108:111], v3 offset:21504
 v_mfma_f32_16x16x32_bf16 v[196:199], a[72:75], v[20:23], v[196:199]
 v_permlane32_swap_b32 v7, v72
 v_permlane32_swap_b32 v8, v73
 v_mfma_f32_16x16x32_bf16 v[136:139], a[80:83], v[16:19], v[136:139]
 ds_read_b128 a[112:115], v3 offset:6144
 v_mfma_f32_16x16x32_bf16 v[136:139], a[84:87], v[24:27], v[136:139]
 buffer_load_dwordx4 v[36:39], v1, s[12:15], s55 offen offset:1024 sc1
 v_mfma_f32_16x16x32_bf16 v[200:203], a[84:87], v[28:31], v[200:203]
 ds_read_b128 a[116:119], v3 offset:22528
 v_mfma_f32_16x16x32_bf16 v[200:203], a[80:83], v[20:23], v[200:203]
 v_add_f32 v7, v7, v72
 v_add_f32 v8, v8, v73
 v_mfma_f32_16x16x32_bf16 v[140:143], a[88:91], v[16:19], v[140:143]
 ds_read_b128 a[120:123], v3 offset:7168
 v_mfma_f32_16x16x32_bf16 v[140:143], a[92:95], v[24:27], v[140:143]
 buffer_load_dwordx4 v[100:103], v1, s[12:15], s56 offen offset:1024 sc1
 v_mfma_f32_16x16x32_bf16 v[204:207], a[92:95], v[28:31], v[204:207]
 ds_read_b128 a[124:127], v3 offset:23552
 v_mfma_f32_16x16x32_bf16 v[204:207], a[88:91], v[20:23], v[204:207]
 s_waitcnt lgkmcnt(6)
 v_mov_b32 v72, v7
 v_mov_b32 v73, v8
 v_mfma_f32_16x16x32_bf16 v[144:147], a[96:99], v[16:19], v[144:147]
 ds_read_b128 a[64:67], v3 offset:8192
 v_mfma_f32_16x16x32_bf16 v[144:147], a[100:103], v[24:27], v[144:147]
 buffer_load_dwordx4 v[40:43], v1, s[12:15], s55 offen offset:2048 sc1
 v_mfma_f32_16x16x32_bf16 v[208:211], a[100:103], v[28:31], v[208:211]
 ds_read_b128 a[68:71], v3 offset:24576
 v_mfma_f32_16x16x32_bf16 v[208:211], a[96:99], v[20:23], v[208:211]
 s_waitcnt lgkmcnt(6)
 v_permlane16_swap_b32 v7, v72
 v_permlane16_swap_b32 v8, v73
 v_mfma_f32_16x16x32_bf16 v[148:151], a[104:107], v[16:19], v[148:151]
 ds_read_b128 a[72:75], v3 offset:9216
 v_mfma_f32_16x16x32_bf16 v[148:151], a[108:111], v[24:27], v[148:151]
 buffer_load_dwordx4 v[104:107], v1, s[12:15], s56 offen offset:2048 sc1
 v_mfma_f32_16x16x32_bf16 v[212:215], a[108:111], v[28:31], v[212:215]
 ds_read_b128 a[76:79], v3 offset:25600
 v_mfma_f32_16x16x32_bf16 v[212:215], a[104:107], v[20:23], v[212:215]
 s_waitcnt lgkmcnt(6)
 v_add_f32 v7, v7, v72
 v_add_f32 v8, v8, v73
 v_mfma_f32_16x16x32_bf16 v[152:155], a[112:115], v[16:19], v[152:155]
 ds_read_b128 a[80:83], v3 offset:10240
 v_mfma_f32_16x16x32_bf16 v[152:155], a[116:119], v[24:27], v[152:155]
 buffer_load_dwordx4 v[44:47], v1, s[12:15], s55 offen offset:3072 sc1
 v_mfma_f32_16x16x32_bf16 v[216:219], a[116:119], v[28:31], v[216:219]
 ds_read_b128 a[84:87], v3 offset:26624
 v_mfma_f32_16x16x32_bf16 v[216:219], a[112:115], v[20:23], v[216:219]
 s_waitcnt lgkmcnt(6)
 v_mfma_f32_16x16x32_bf16 v[156:159], a[120:123], v[16:19], v[156:159]
 ds_read_b128 a[88:91], v3 offset:11264
 v_mfma_f32_16x16x32_bf16 v[156:159], a[124:127], v[24:27], v[156:159]
 buffer_load_dwordx4 v[108:111], v1, s[12:15], s56 offen offset:3072 sc1
 v_mfma_f32_16x16x32_bf16 v[220:223], a[124:127], v[28:31], v[220:223]
 ds_read_b128 a[92:95], v3 offset:27648
 v_mfma_f32_16x16x32_bf16 v[220:223], a[120:123], v[20:23], v[220:223]
 s_waitcnt lgkmcnt(6)
 v_mfma_f32_16x16x32_bf16 v[160:163], a[64:67], v[16:19], v[160:163]
 ds_read_b128 a[96:99], v3 offset:12288
 v_mfma_f32_16x16x32_bf16 v[160:163], a[68:71], v[24:27], v[160:163]
 buffer_load_dwordx4 v[48:51], v4, s[12:15], s55 offen offset:0 sc1
 v_mfma_f32_16x16x32_bf16 v[224:227], a[68:71], v[28:31], v[224:227]
 ds_read_b128 a[100:103], v3 offset:28672
 v_mfma_f32_16x16x32_bf16 v[224:227], a[64:67], v[20:23], v[224:227]
 s_waitcnt lgkmcnt(6)
 v_mfma_f32_16x16x32_bf16 v[164:167], a[72:75], v[16:19], v[164:167]
 ds_read_b128 a[104:107], v3 offset:13312
 v_mfma_f32_16x16x32_bf16 v[164:167], a[76:79], v[24:27], v[164:167]
 buffer_load_dwordx4 v[112:115], v4, s[12:15], s56 offen offset:0 sc1
 v_mfma_f32_16x16x32_bf16 v[228:231], a[76:79], v[28:31], v[228:231]
 ds_read_b128 a[108:111], v3 offset:29696
 v_mfma_f32_16x16x32_bf16 v[228:231], a[72:75], v[20:23], v[228:231]
 s_waitcnt lgkmcnt(6)
 v_mfma_f32_16x16x32_bf16 v[168:171], a[80:83], v[16:19], v[168:171]
 ds_read_b128 a[112:115], v3 offset:14336
 v_mfma_f32_16x16x32_bf16 v[168:171], a[84:87], v[24:27], v[168:171]
 buffer_load_dwordx4 v[52:55], v4, s[12:15], s55 offen offset:1024 sc1
 v_mfma_f32_16x16x32_bf16 v[232:235], a[84:87], v[28:31], v[232:235]
 ds_read_b128 a[116:119], v3 offset:30720
 v_mfma_f32_16x16x32_bf16 v[232:235], a[80:83], v[20:23], v[232:235]
 s_waitcnt lgkmcnt(6)
 v_mfma_f32_16x16x32_bf16 v[172:175], a[88:91], v[16:19], v[172:175]
 ds_read_b128 a[120:123], v3 offset:15360
 v_mfma_f32_16x16x32_bf16 v[172:175], a[92:95], v[24:27], v[172:175]
 buffer_load_dwordx4 v[116:119], v4, s[12:15], s56 offen offset:1024 sc1
 v_mfma_f32_16x16x32_bf16 v[236:239], a[92:95], v[28:31], v[236:239]
 ds_read_b128 a[124:127], v3 offset:31744
 v_mfma_f32_16x16x32_bf16 v[236:239], a[88:91], v[20:23], v[236:239]
 s_waitcnt lgkmcnt(6)
 v_mfma_f32_16x16x32_bf16 v[176:179], a[96:99], v[16:19], v[176:179]
 v_mfma_f32_16x16x32_bf16 v[176:179], a[100:103], v[24:27], v[176:179]
 buffer_load_dwordx4 v[56:59], v4, s[12:15], s55 offen offset:2048 sc1
 v_mfma_f32_16x16x32_bf16 v[240:243], a[100:103], v[28:31], v[240:243]
 v_mfma_f32_16x16x32_bf16 v[240:243], a[96:99], v[20:23], v[240:243]
 s_waitcnt lgkmcnt(4)
 v_mfma_f32_16x16x32_bf16 v[180:183], a[104:107], v[16:19], v[180:183]
 v_mfma_f32_16x16x32_bf16 v[180:183], a[108:111], v[24:27], v[180:183]
 buffer_load_dwordx4 v[120:123], v4, s[12:15], s56 offen offset:2048 sc1
 v_mfma_f32_16x16x32_bf16 v[244:247], a[108:111], v[28:31], v[244:247]
 v_mfma_f32_16x16x32_bf16 v[244:247], a[104:107], v[20:23], v[244:247]
 s_waitcnt lgkmcnt(2)
 v_mfma_f32_16x16x32_bf16 v[184:187], a[112:115], v[16:19], v[184:187]
 v_mfma_f32_16x16x32_bf16 v[184:187], a[116:119], v[24:27], v[184:187]
 buffer_load_dwordx4 v[60:63], v4, s[12:15], s55 offen offset:3072 sc1
 v_mfma_f32_16x16x32_bf16 v[248:251], a[116:119], v[28:31], v[248:251]
 v_mfma_f32_16x16x32_bf16 v[248:251], a[112:115], v[20:23], v[248:251]
 s_waitcnt lgkmcnt(0)
 v_mfma_f32_16x16x32_bf16 v[188:191], a[120:123], v[16:19], v[188:191]
 v_mfma_f32_16x16x32_bf16 v[188:191], a[124:127], v[24:27], v[188:191]
 v_mfma_f32_16x16x32_bf16 v[252:255], a[124:127], v[28:31], v[252:255]
 v_mfma_f32_16x16x32_bf16 v[252:255], a[120:123], v[20:23], v[252:255]
 buffer_load_dwordx4 v[124:127], v4, s[12:15], s56 offen offset:3072 sc1
 s_cmp_eq_u32 s58, 0
 s_cbranch_scc1 L_merge2
 v_and_b32 v11, 0, v0
 v_lshlrev_b32 v11, 2, v11
 s_mov_b32 s32, 0
L_poll5:
 buffer_load_dword v12, v11, s[12:15], s94 offen sc1
 s_waitcnt vmcnt(0)
 v_cmp_ne_u32 vcc, 0, v12
 s_cbranch_vccz L_poll5_ok
 s_sleep 6
 s_add_u32 s32, s32, 1
 s_cmp_lt_u32 s32, 0x80000
 s_cbranch_scc1 L_poll5
L_poll5_ok:
 s_mov_b32 s55, s52
 s_mov_b32 s57, s53
 s_add_u32 s56, s55, 0x2000
 buffer_load_dwordx4 v[68:71], v1, s[12:15], s57 offen sc1
 buffer_load_dwordx4 v[32:35], v1, s[12:15], s55 offen offset:0 sc1
 buffer_load_dwordx4 v[96:99], v1, s[12:15], s56 offen offset:0 sc1
 buffer_load_dwordx4 v[36:39], v1, s[12:15], s55 offen offset:1024 sc1
 buffer_load_dwordx4 v[100:103], v1, s[12:15], s56 offen offset:1024 sc1
 buffer_load_dwordx4 v[40:43], v1, s[12:15], s55 offen offset:2048 sc1
 buffer_load_dwordx4 v[104:107], v1, s[12:15], s56 offen offset:2048 sc1
 buffer_load_dwordx4 v[44:47], v1, s[12:15], s55 offen offset:3072 sc1
 buffer_load_dwordx4 v[108:111], v1, s[12:15], s56 offen offset:3072 sc1
 buffer_load_dwordx4 v[48:51], v4, s[12:15], s55 offen offset:0 sc1
 buffer_load_dwordx4 v[112:115], v4, s[12:15], s56 offen offset:0 sc1
 buffer_load_dwordx4 v[52:55], v4, s[12:15], s55 offen offset:1024 sc1
 buffer_load_dwordx4 v[116:119], v4, s[12:15], s56 offen offset:1024 sc1
 buffer_load_dwordx4 v[56:59], v4, s[12:15], s55 offen offset:2048 sc1
 buffer_load_dwordx4 v[120:123], v4, s[12:15], s56 offen offset:2048 sc1
 buffer_load_dwordx4 v[60:63], v4, s[12:15], s55 offen offset:3072 sc1
 buffer_load_dwordx4 v[124:127], v4, s[12:15], s56 offen offset:3072 sc1
L_merge2:
 s_waitcnt vmcnt(14)
 v_cmp_neq_f32 vcc, v70, v9
 v_cmp_neq_f32 s[20:21], v71, v10
 s_or_b64 vcc, vcc, s[20:21]
 s_cbranch_vccnz L_mslow
 v_mfma_f32_16x16x32_bf16 v[128:131], a[250:253], v[32:35], v[128:131]
 s_add_u32 m0, s29, 0
 v_add_f32 v7, v7, v68
 v_add_f32 v8, v8, v69
 v_mfma_f32_16x16x32_bf16 v[132:135], a[248:251], v[32:35], v[132:135]
 buffer_load_dwordx4 v2, s[8:11], s78 offen lds
 v_mfma_f32_16x16x32_bf16 v[192:195], a[250:253], v[96:99], v[192:195]
 v_rcp_f32 v64, v7
 v_mfma_f32_16x16x32_bf16 v[196:199], a[248:251], v[96:99], v[196:199]
 s_waitcnt vmcnt(13)
 v_rcp_f32 v65, v8
 v_mfma_f32_16x16x32_bf16 v[136:139], a[250:253], v[36:39], v[136:139]
 s_add_u32 m0, s29, 4096
 v_mfma_f32_16x16x32_bf16 v[140:143], a[248:251], v[36:39], v[140:143]
 buffer_load_dwordx4 v2, s[8:11], s79 offen lds
 v_mfma_f32_16x16x32_bf16 v[200:203], a[250:253], v[100:103], v[200:203]
 v_cvt_pk_bf16_f32 v128, v128, v129
 v_cvt_pk_bf16_f32 v129, v130, v131
 v_mfma_f32_16x16x32_bf16 v[204:207], a[248:251], v[100:103], v[204:207]
 s_waitcnt vmcnt(12)
 v_cvt_pk_bf16_f32 v130, v132, v133
 v_cvt_pk_bf16_f32 v131, v134, v135
 v_mfma_f32_16x16x32_bf16 v[144:147], a[250:253], v[40:43], v[144:147]
 s_add_u32 m0, s29, 8192
 v_cvt_pk_bf16_f32 v192, v192, v193
 v_cvt_pk_bf16_f32 v193, v194, v195
 v_mfma_f32_16x16x32_bf16 v[148:151], a[248:251], v[40:43], v[148:151]
 buffer_load_dwordx4 v2, s[8:11], s80 offen lds
 v_mfma_f32_16x16x32_bf16 v[208:211], a[250:253], v[104:107], v[208:211]
 v_cvt_pk_bf16_f32 v194, v196, v197
 v_cvt_pk_bf16_f32 v195, v198, v199
 v_mfma_f32_16x16x32_bf16 v[212:215], a[248:251], v[104:107], v[212:215]
 s_waitcnt vmcnt(11)
 v_cvt_pk_bf16_f32 v136, v136, v137
 v_cvt_pk_bf16_f32 v137, v138, v139
 v_mfma_f32_16x16x32_bf16 v[152:155], a[250:253], v[44:47], v[152:155]
 s_add_u32 m0, s29, 12288
 v_cvt_pk_bf16_f32 v138, v140, v141
 v_cvt_pk_bf16_f32 v139, v142, v143
 v_mfma_f32_16x16x32_bf16 v[156:159], a[248:251], v[44:47], v[156:159]
 buffer_load_dwordx4 v2, s[8:11], s81 offen lds
 v_mfma_f32_16x16x32_bf16 v[216:219], a[250:253], v[108:111], v[216:219]
 v_cvt_pk_bf16_f32 v200, v200, v201
 v_cvt_pk_bf16_f32 v201, v202, v203
 v_mfma_f32_16x16x32_bf16 v[220:223], a[248:251], v[108:111], v[220:223]
 s_waitcnt vmcnt(10)
 v_cvt_pk_bf16_f32 v202, v204, v205
 v_cvt_pk_bf16_f32 v203, v206, v207
 v_mfma_f32_16x16x32_bf16 v[160:163], a[250:253], v[48:51], v[160:163]
 s_add_u32 m0, s29, 16384
 v_cvt_pk_bf16_f32 v144, v144, v145
 v_cvt_pk_bf16_f32 v145, v146, v147
 v_mfma_f32_16x16x32_bf16 v[164:167], a[248:251], v[48:51], v[164:167]
 buffer_load_dwordx4 v2, s[8:11], s82 offen lds
 v_mfma_f32_16x16x32_bf16 v[224:227], a[250:253], v[112:115], v[224:227]
 v_cvt_pk_bf16_f32 v146, v148, v149
 v_cvt_pk_bf16_f32 v147, v150, v151
 v_mfma_f32_16x16x32_bf16 v[228:231], a[248:251], v[112:115], v[228:231]
 s_waitcnt vmcnt(9)
 v_cvt_pk_bf16_f32 v208, v208, v209
 v_cvt_pk_bf16_f32 v209, v210, v211
 v_mfma_f32_16x16x32_bf16 v[168:171], a[250:253], v[52:55], v[168:171]
 s_add_u32 m0, s29, 20480
 v_cvt_pk_bf16_f32 v210, v212, v213
 v_cvt_pk_bf16_f32 v211, v214, v215
 v_mfma_f32_16x16x32_bf16 v[172:175], a[248:251], v[52:55], v[172:175]
 buffer_load_dwordx4 v2, s[8:11], s83 offen lds
 v_mfma_f32_16x16x32_bf16 v[232:235], a[250:253], v[116:119], v[232:235]
 v_cvt_pk_bf16_f32 v152, v152, v153
 v_cvt_pk_bf16_f32 v153, v154, v155
 v_mfma_f32_16x16x32_bf16 v[236:239], a[248:251], v[116:119], v[236:239]
 s_waitcnt vmcnt(8)
 v_cvt_pk_bf16_f32 v154, v156, v157
 v_cvt_pk_bf16_f32 v155, v158, v159
 v_mfma_f32_16x16x32_bf16 v[176:179], a[250:253], v[56:59], v[176:179]
 s_add_u32 m0, s29, 24576
 v_cvt_pk_bf16_f32 v216, v216, v217
 v_cvt_pk_bf16_f32 v217, v218, v219
 v_mfma_f32_16x16x32_bf16 v[180:183], a[248:251], v[56:59], v[180:183]
 buffer_load_dwordx4 v2, s[8:11], s84 offen lds
 v_mfma_f32_16x16x32_bf16 v[240:243], a[250:253], v[120:123], v[240:243]
 v_cvt_pk_bf16_f32 v218, v220, v221
 v_cvt_pk_bf16_f32 v219, v222, v223
 v_mfma_f32_16x16x32_bf16 v[244:247], a[248:251], v[120:123], v[244:247]
 s_waitcnt vmcnt(7)
 v_cvt_pk_bf16_f32 v160, v160, v161
 v_cvt_pk_bf16_f32 v161, v162, v163
 v_mfma_f32_16x16x32_bf16 v[184:187], a[250:253], v[60:63], v[184:187]
 s_add_u32 m0, s29, 28672
 v_cvt_pk_bf16_f32 v162, v164, v165
 v_cvt_pk_bf16_f32 v163, v166, v167
 v_mfma_f32_16x16x32_bf16 v[188:191], a[248:251], v[60:63], v[188:191]
 buffer_load_dwordx4 v2, s[8:11], s85 offen lds
 v_mfma_f32_16x16x32_bf16 v[248:251], a[250:253], v[124:127], v[248:251]
 v_cvt_pk_bf16_f32 v224, v224, v225
 v_cvt_pk_bf16_f32 v225, v226, v227
 v_mfma_f32_16x16x32_bf16 v[252:255], a[248:251], v[124:127], v[252:255]
 v_cvt_pk_bf16_f32 v226, v228, v229
 v_cvt_pk_bf16_f32 v227, v230, v231
 v_add_u32 v2, 128, v2
 v_cvt_pk_bf16_f32 v168, v168, v169
 v_cvt_pk_bf16_f32 v169, v170, v171
 v_cvt_pk_bf16_f32 v170, v172, v173
 v_cvt_pk_bf16_f32 v171, v174, v175
 v_cvt_pk_bf16_f32 v232, v232, v233
 v_cvt_pk_bf16_f32 v233, v234, v235
 v_cvt_pk_bf16_f32 v234, v236, v237
 v_cvt_pk_bf16_f32 v235, v238, v239
 v_cvt_pk_bf16_f32 v176, v176, v177
 v_cvt_pk_bf16_f32 v177, v178, v179
 v_cvt_pk_bf16_f32 v178, v180, v181
 v_cvt_pk_bf16_f32 v179, v182, v183
 v_cvt_pk_bf16_f32 v240, v240, v241
 v_cvt_pk_bf16_f32 v241, v242, v243
 v_cvt_pk_bf16_f32 v242, v244, v245
 v_cvt_pk_bf16_f32 v243, v246, v247
 v_cvt_pk_bf16_f32 v184, v184, v185
 v_cvt_pk_bf16_f32 v185, v186, v187
 v_cvt_pk_bf16_f32 v186, v188, v189
 v_cvt_pk_bf16_f32 v187, v190, v191
 v_cvt_pk_bf16_f32 v248, v248, v249
 v_cvt_pk_bf16_f32 v249, v250, v251
 v_cvt_pk_bf16_f32 v250, v252, v253
 v_cvt_pk_bf16_f32 v251, v254, v255
 s_waitcnt vmcnt(0)
 s_branch L_attdone
L_mslow:
 s_add_u32 m0, s29, 0
 s_nop 0
 buffer_load_dwordx4 v2, s[8:11], s78 offen lds
 s_add_u32 m0, s29, 4096
 s_nop 0
 buffer_load_dwordx4 v2, s[8:11], s79 offen lds
 s_add_u32 m0, s29, 8192
 s_nop 0
 buffer_load_dwordx4 v2, s[8:11], s80 offen lds
 s_add_u32 m0, s29, 12288
 s_nop 0
 buffer_load_dwordx4 v2, s[8:11], s81 offen lds
 s_add_u32 m0, s29, 16384
 s_nop 0
 buffer_load_dwordx4 v2, s[8:11], s82 offen lds
 s_add_u32 m0, s29, 20480
 s_nop 0
 buffer_load_dwordx4 v2, s[8:11], s83 offen lds
 s_add_u32 m0, s29, 24576
 s_nop 0
 buffer_load_dwordx4 v2, s[8:11], s84 offen lds
 s_add_u32 m0, s29, 28672
 s_nop 0
 buffer_load_dwordx4 v2, s[8:11], s85 offen lds
 v_add_u32 v2, 128, v2
 s_mov_b32 s58, 0xffff0000
 s_waitcnt vmcnt(0)
 v_min_f32 v20, v70, v9
 v_sub_f32 v21, v20, v9
 v_sub_f32 v22, v20, v70
 v_exp_f32 v16, v21
 v_exp_f32 v18, v22
 s_nop 0
 v_mul_f32 v7, v7, v16
 v_fmac_f32 v7, v68, v18
 v_rcp_f32 v64, v7
 v_min_f32 v20, v71, v10
 v_sub_f32 v21, v20, v10
 v_sub_f32 v22, v20, v71
 v_exp_f32 v17, v21
 v_exp_f32 v19, v22
 s_nop 0
 v_mul_f32 v8, v8, v17
 v_fmac_f32 v8, v69, v19
 v_rcp_f32 v65, v8
 v_lshlrev_b32 v24, 16, v32
 v_and_b32 v25, s58, v32
 v_pk_mul_f32 v[24:25], v[24:25], v[18:19] op_sel:[0,0] op_sel_hi:[1,0]
 v_pk_fma_f32 v[128:129], v[128:129], v[16:17], v[24:25] op_sel:[0,0,0] op_sel_hi:[1,0,1]
 v_lshlrev_b32 v26, 16, v33
 v_and_b32 v27, s58, v33
 v_pk_mul_f32 v[26:27], v[26:27], v[18:19] op_sel:[0,0] op_sel_hi:[1,0]
 v_pk_fma_f32 v[130:131], v[130:131], v[16:17], v[26:27] op_sel:[0,0,0] op_sel_hi:[1,0,1]
 v_lshlrev_b32 v28, 16, v34
 v_and_b32 v29, s58, v34
 v_pk_mul_f32 v[28:29], v[28:29], v[18:19] op_sel:[0,0] op_sel_hi:[1,0]
 v_pk_fma_f32 v[132:133], v[132:133], v[16:17], v[28:29] op_sel:[0,0,0] op_sel_hi:[1,0,1]
 v_lshlrev_b32 v30, 16, v35
 v_and_b32 v31, s58, v35
 v_pk_mul_f32 v[30:31], v[30:31], v[18:19] op_sel:[0,0] op_sel_hi:[1,0]
 v_pk_fma_f32 v[134:135], v[134:135], v[16:17], v[30:31] op_sel:[0,0,0] op_sel_hi:[1,0,1]
 v_cvt_pk_bf16_f32 v128, v128, v129
 v_cvt_pk_bf16_f32 v129, v130, v131
 v_cvt_pk_bf16_f32 v130, v132, v133
 v_cvt_pk_bf16_f32 v131, v134, v135
 v_lshlrev_b32 v24, 16, v36
 v_and_b32 v25, s58, v36
 v_pk_mul_f32 v[24:25], v[24:25], v[18:19] op_sel:[0,0] op_sel_hi:[1,0]
 v_pk_fma_f32 v[136:137], v[136:137], v[16:17], v[24:25] op_sel:[0,0,0] op_sel_hi:[1,0,1]
 v_lshlrev_b32 v26, 16, v37
 v_and_b32 v27, s58, v37
 v_pk_mul_f32 v[26:27], v[26:27], v[18:19] op_sel:[0,0] op_sel_hi:[1,0]
 v_pk_fma_f32 v[138:139], v[138:139], v[16:17], v[26:27] op_sel:[0,0,0] op_sel_hi:[1,0,1]
 v_lshlrev_b32 v28, 16, v38
 v_and_b32 v29, s58, v38
 v_pk_mul_f32 v[28:29], v[28:29], v[18:19] op_sel:[0,0] op_sel_hi:[1,0]
 v_pk_fma_f32 v[140:141], v[140:141], v[16:17], v[28:29] op_sel:[0,0,0] op_sel_hi:[1,0,1]
 v_lshlrev_b32 v30, 16, v39
 v_and_b32 v31, s58, v39
 v_pk_mul_f32 v[30:31], v[30:31], v[18:19] op_sel:[0,0] op_sel_hi:[1,0]
 v_pk_fma_f32 v[142:143], v[142:143], v[16:17], v[30:31] op_sel:[0,0,0] op_sel_hi:[1,0,1]
 v_cvt_pk_bf16_f32 v136, v136, v137
 v_cvt_pk_bf16_f32 v137, v138, v139
 v_cvt_pk_bf16_f32 v138, v140, v141
 v_cvt_pk_bf16_f32 v139, v142, v143
 v_lshlrev_b32 v24, 16, v40
 v_and_b32 v25, s58, v40
 v_pk_mul_f32 v[24:25], v[24:25], v[18:19] op_sel:[0,0] op_sel_hi:[1,0]
 v_pk_fma_f32 v[144:145], v[144:145], v[16:17], v[24:25] op_sel:[0,0,0] op_sel_hi:[1,0,1]
 v_lshlrev_b32 v26, 16, v41
 v_and_b32 v27, s58, v41
 v_pk_mul_f32 v[26:27], v[26:27], v[18:19] op_sel:[0,0] op_sel_hi:[1,0]
 v_pk_fma_f32 v[146:147], v[146:147], v[16:17], v[26:27] op_sel:[0,0,0] op_sel_hi:[1,0,1]
 v_lshlrev_b32 v28, 16, v42
 v_and_b32 v29, s58, v42
 v_pk_mul_f32 v[28:29], v[28:29], v[18:19] op_sel:[0,0] op_sel_hi:[1,0]
 v_pk_fma_f32 v[148:149], v[148:149], v[16:17], v[28:29] op_sel:[0,0,0] op_sel_hi:[1,0,1]
 v_lshlrev_b32 v30, 16, v43
 v_and_b32 v31, s58, v43
 v_pk_mul_f32 v[30:31], v[30:31], v[18:19] op_sel:[0,0] op_sel_hi:[1,0]
 v_pk_fma_f32 v[150:151], v[150:151], v[16:17], v[30:31] op_sel:[0,0,0] op_sel_hi:[1,0,1]
 v_cvt_pk_bf16_f32 v144, v144, v145
 v_cvt_pk_bf16_f32 v145, v146, v147
 v_cvt_pk_bf16_f32 v146, v148, v149
 v_cvt_pk_bf16_f32 v147, v150, v151
 v_lshlrev_b32 v24, 16, v44
 v_and_b32 v25, s58, v44
 v_pk_mul_f32 v[24:25], v[24:25], v[18:19] op_sel:[0,0] op_sel_hi:[1,0]
 v_pk_fma_f32 v[152:153], v[152:153], v[16:17], v[24:25] op_sel:[0,0,0] op_sel_hi:[1,0,1]
 v_lshlrev_b32 v26, 16, v45
 v_and_b32 v27, s58, v45
 v_pk_mul_f32 v[26:27], v[26:27], v[18:19] op_sel:[0,0] op_sel_hi:[1,0]
 v_pk_fma_f32 v[154:155], v[154:155], v[16:17], v[26:27] op_sel:[0,0,0] op_sel_hi:[1,0,1]
 v_lshlrev_b32 v28, 16, v46
 v_and_b32 v29, s58, v46
 v_pk_mul_f32 v[28:29], v[28:29], v[18:19] op_sel:[0,0] op_sel_hi:[1,0]
 v_pk_fma_f32 v[156:157], v[156:157], v[16:17], v[28:29] op_sel:[0,0,0] op_sel_hi:[1,0,1]
 v_lshlrev_b32 v30, 16, v47
 v_and_b32 v31, s58, v47
 v_pk_mul_f32 v[30:31], v[30:31], v[18:19] op_sel:[0,0] op_sel_hi:[1,0]
 v_pk_fma_f32 v[158:159], v[158:159], v[16:17], v[30:31] op_sel:[0,0,0] op_sel_hi:[1,0,1]
 v_cvt_pk_bf16_f32 v152, v152, v153
 v_cvt_pk_bf16_f32 v153, v154, v155
 v_cvt_pk_bf16_f32 v154, v156, v157
 v_cvt_pk_bf16_f32 v155, v158, v159
 v_lshlrev_b32 v24, 16, v48
 v_and_b32 v25, s58, v48
 v_pk_mul_f32 v[24:25], v[24:25], v[18:19] op_sel:[0,0] op_sel_hi:[1,0]
 v_pk_fma_f32 v[160:161], v[160:161], v[16:17], v[24:25] op_sel:[0,0,0] op_sel_hi:[1,0,1]
 v_lshlrev_b32 v26, 16, v49
 v_and_b32 v27, s58, v49
 v_pk_mul_f32 v[26:27], v[26:27], v[18:19] op_sel:[0,0] op_sel_hi:[1,0]
 v_pk_fma_f32 v[162:163], v[162:163], v[16:17], v[26:27] op_sel:[0,0,0] op_sel_hi:[1,0,1]
 v_lshlrev_b32 v28, 16, v50
 v_and_b32 v29, s58, v50
 v_pk_mul_f32 v[28:29], v[28:29], v[18:19] op_sel:[0,0] op_sel_hi:[1,0]
 v_pk_fma_f32 v[164:165], v[164:165], v[16:17], v[28:29] op_sel:[0,0,0] op_sel_hi:[1,0,1]
 v_lshlrev_b32 v30, 16, v51
 v_and_b32 v31, s58, v51
 v_pk_mul_f32 v[30:31], v[30:31], v[18:19] op_sel:[0,0] op_sel_hi:[1,0]
 v_pk_fma_f32 v[166:167], v[166:167], v[16:17], v[30:31] op_sel:[0,0,0] op_sel_hi:[1,0,1]
 v_cvt_pk_bf16_f32 v160, v160, v161
 v_cvt_pk_bf16_f32 v161, v162, v163
 v_cvt_pk_bf16_f32 v162, v164, v165
 v_cvt_pk_bf16_f32 v163, v166, v167
 v_lshlrev_b32 v24, 16, v52
 v_and_b32 v25, s58, v52
 v_pk_mul_f32 v[24:25], v[24:25], v[18:19] op_sel:[0,0] op_sel_hi:[1,0]
 v_pk_fma_f32 v[168:169], v[168:169], v[16:17], v[24:25] op_sel:[0,0,0] op_sel_hi:[1,0,1]
 v_lshlrev_b32 v26, 16, v53
 v_and_b32 v27, s58, v53
 v_pk_mul_f32 v[26:27], v[26:27], v[18:19] op_sel:[0,0] op_sel_hi:[1,0]
 v_pk_fma_f32 v[170:171], v[170:171], v[16:17], v[26:27] op_sel:[0,0,0] op_sel_hi:[1,0,1]
 v_lshlrev_b32 v28, 16, v54
 v_and_b32 v29, s58, v54
 v_pk_mul_f32 v[28:29], v[28:29], v[18:19] op_sel:[0,0] op_sel_hi:[1,0]
 v_pk_fma_f32 v[172:173], v[172:173], v[16:17], v[28:29] op_sel:[0,0,0] op_sel_hi:[1,0,1]
 v_lshlrev_b32 v30, 16, v55
 v_and_b32 v31, s58, v55
 v_pk_mul_f32 v[30:31], v[30:31], v[18:19] op_sel:[0,0] op_sel_hi:[1,0]
 v_pk_fma_f32 v[174:175], v[174:175], v[16:17], v[30:31] op_sel:[0,0,0] op_sel_hi:[1,0,1]
 v_cvt_pk_bf16_f32 v168, v168, v169
 v_cvt_pk_bf16_f32 v169, v170, v171
 v_cvt_pk_bf16_f32 v170, v172, v173
 v_cvt_pk_bf16_f32 v171, v174, v175
 v_lshlrev_b32 v24, 16, v56
 v_and_b32 v25, s58, v56
 v_pk_mul_f32 v[24:25], v[24:25], v[18:19] op_sel:[0,0] op_sel_hi:[1,0]
 v_pk_fma_f32 v[176:177], v[176:177], v[16:17], v[24:25] op_sel:[0,0,0] op_sel_hi:[1,0,1]
 v_lshlrev_b32 v26, 16, v57
 v_and_b32 v27, s58, v57
 v_pk_mul_f32 v[26:27], v[26:27], v[18:19] op_sel:[0,0] op_sel_hi:[1,0]
 v_pk_fma_f32 v[178:179], v[178:179], v[16:17], v[26:27] op_sel:[0,0,0] op_sel_hi:[1,0,1]
 v_lshlrev_b32 v28, 16, v58
 v_and_b32 v29, s58, v58
 v_pk_mul_f32 v[28:29], v[28:29], v[18:19] op_sel:[0,0] op_sel_hi:[1,0]
 v_pk_fma_f32 v[180:181], v[180:181], v[16:17], v[28:29] op_sel:[0,0,0] op_sel_hi:[1,0,1]
 v_lshlrev_b32 v30, 16, v59
 v_and_b32 v31, s58, v59
 v_pk_mul_f32 v[30:31], v[30:31], v[18:19] op_sel:[0,0] op_sel_hi:[1,0]
 v_pk_fma_f32 v[182:183], v[182:183], v[16:17], v[30:31] op_sel:[0,0,0] op_sel_hi:[1,0,1]
 v_cvt_pk_bf16_f32 v176, v176, v177
 v_cvt_pk_bf16_f32 v177, v178, v179
 v_cvt_pk_bf16_f32 v178, v180, v181
 v_cvt_pk_bf16_f32 v179, v182, v183
 v_lshlrev_b32 v24, 16, v60
 v_and_b32 v25, s58, v60
 v_pk_mul_f32 v[24:25], v[24:25], v[18:19] op_sel:[0,0] op_sel_hi:[1,0]
 v_pk_fma_f32 v[184:185], v[184:185], v[16:17], v[24:25] op_sel:[0,0,0] op_sel_hi:[1,0,1]
 v_lshlrev_b32 v26, 16, v61
 v_and_b32 v27, s58, v61
 v_pk_mul_f32 v[26:27], v[26:27], v[18:19] op_sel:[0,0] op_sel_hi:[1,0]
 v_pk_fma_f32 v[186:187], v[186:187], v[16:17], v[26:27] op_sel:[0,0,0] op_sel_hi:[1,0,1]
 v_lshlrev_b32 v28, 16, v62
 v_and_b32 v29, s58, v62
 v_pk_mul_f32 v[28:29], v[28:29], v[18:19] op_sel:[0,0] op_sel_hi:[1,0]
 v_pk_fma_f32 v[188:189], v[188:189], v[16:17], v[28:29] op_sel:[0,0,0] op_sel_hi:[1,0,1]
 v_lshlrev_b32 v30, 16, v63
 v_and_b32 v31, s58, v63
 v_pk_mul_f32 v[30:31], v[30:31], v[18:19] op_sel:[0,0] op_sel_hi:[1,0]
 v_pk_fma_f32 v[190:191], v[190:191], v[16:17], v[30:31] op_sel:[0,0,0] op_sel_hi:[1,0,1]
 v_cvt_pk_bf16_f32 v184, v184, v185
 v_cvt_pk_bf16_f32 v185, v186, v187
 v_cvt_pk_bf16_f32 v186, v188, v189
 v_cvt_pk_bf16_f32 v187, v190, v191
 v_lshlrev_b32 v24, 16, v96
 v_and_b32 v25, s58, v96
 v_pk_mul_f32 v[24:25], v[24:25], v[18:19] op_sel:[0,1] op_sel_hi:[1,1]
 v_pk_fma_f32 v[192:193], v[192:193], v[16:17], v[24:25] op_sel:[0,1,0] op_sel_hi:[1,1,1]
 v_lshlrev_b32 v26, 16, v97
 v_and_b32 v27, s58, v97
 v_pk_mul_f32 v[26:27], v[26:27], v[18:19] op_sel:[0,1] op_sel_hi:[1,1]
 v_pk_fma_f32 v[194:195], v[194:195], v[16:17], v[26:27] op_sel:[0,1,0] op_sel_hi:[1,1,1]
 v_lshlrev_b32 v28, 16, v98
 v_and_b32 v29, s58, v98
 v_pk_mul_f32 v[28:29], v[28:29], v[18:19] op_sel:[0,1] op_sel_hi:[1,1]
 v_pk_fma_f32 v[196:197], v[196:197], v[16:17], v[28:29] op_sel:[0,1,0] op_sel_hi:[1,1,1]
 v_lshlrev_b32 v30, 16, v99
 v_and_b32 v31, s58, v99
 v_pk_mul_f32 v[30:31], v[30:31], v[18:19] op_sel:[0,1] op_sel_hi:[1,1]
 v_pk_fma_f32 v[198:199], v[198:199], v[16:17], v[30:31] op_sel:[0,1,0] op_sel_hi:[1,1,1]
 v_cvt_pk_bf16_f32 v192, v192, v193
 v_cvt_pk_bf16_f32 v193, v194, v195
 v_cvt_pk_bf16_f32 v194, v196, v197
 v_cvt_pk_bf16_f32 v195, v198, v199
 v_lshlrev_b32 v24, 16, v100
 v_and_b32 v25, s58, v100
 v_pk_mul_f32 v[24:25], v[24:25], v[18:19] op_sel:[0,1] op_sel_hi:[1,1]
 v_pk_fma_f32 v[200:201], v[200:201], v[16:17], v[24:25] op_sel:[0,1,0] op_sel_hi:[1,1,1]
 v_lshlrev_b32 v26, 16, v101
 v_and_b32 v27, s58, v101
 v_pk_mul_f32 v[26:27], v[26:27], v[18:19] op_sel:[0,1] op_sel_hi:[1,1]
 v_pk_fma_f32 v[202:203], v[202:203], v[16:17], v[26:27] op_sel:[0,1,0] op_sel_hi:[1,1,1]
 v_lshlrev_b32 v28, 16, v102
 v_and_b32 v29, s58, v102
 v_pk_mul_f32 v[28:29], v[28:29], v[18:19] op_sel:[0,1] op_sel_hi:[1,1]
 v_pk_fma_f32 v[204:205], v[204:205], v[16:17], v[28:29] op_sel:[0,1,0] op_sel_hi:[1,1,1]
 v_lshlrev_b32 v30, 16, v103
 v_and_b32 v31, s58, v103
 v_pk_mul_f32 v[30:31], v[30:31], v[18:19] op_sel:[0,1] op_sel_hi:[1,1]
 v_pk_fma_f32 v[206:207], v[206:207], v[16:17], v[30:31] op_sel:[0,1,0] op_sel_hi:[1,1,1]
 v_cvt_pk_bf16_f32 v200, v200, v201
 v_cvt_pk_bf16_f32 v201, v202, v203
 v_cvt_pk_bf16_f32 v202, v204, v205
 v_cvt_pk_bf16_f32 v203, v206, v207
 v_lshlrev_b32 v24, 16, v104
 v_and_b32 v25, s58, v104
 v_pk_mul_f32 v[24:25], v[24:25], v[18:19] op_sel:[0,1] op_sel_hi:[1,1]
 v_pk_fma_f32 v[208:209], v[208:209], v[16:17], v[24:25] op_sel:[0,1,0] op_sel_hi:[1,1,1]
 v_lshlrev_b32 v26, 16, v105
 v_and_b32 v27, s58, v105
 v_pk_mul_f32 v[26:27], v[26:27], v[18:19] op_sel:[0,1] op_sel_hi:[1,1]
 v_pk_fma_f32 v[210:211], v[210:211], v[16:17], v[26:27] op_sel:[0,1,0] op_sel_hi:[1,1,1]
 v_lshlrev_b32 v28, 16, v106
 v_and_b32 v29, s58, v106
 v_pk_mul_f32 v[28:29], v[28:29], v[18:19] op_sel:[0,1] op_sel_hi:[1,1]
 v_pk_fma_f32 v[212:213], v[212:213], v[16:17], v[28:29] op_sel:[0,1,0] op_sel_hi:[1,1,1]
 v_lshlrev_b32 v30, 16, v107
 v_and_b32 v31, s58, v107
 v_pk_mul_f32 v[30:31], v[30:31], v[18:19] op_sel:[0,1] op_sel_hi:[1,1]
 v_pk_fma_f32 v[214:215], v[214:215], v[16:17], v[30:31] op_sel:[0,1,0] op_sel_hi:[1,1,1]
 v_cvt_pk_bf16_f32 v208, v208, v209
 v_cvt_pk_bf16_f32 v209, v210, v211
 v_cvt_pk_bf16_f32 v210, v212, v213
 v_cvt_pk_bf16_f32 v211, v214, v215
 v_lshlrev_b32 v24, 16, v108
 v_and_b32 v25, s58, v108
 v_pk_mul_f32 v[24:25], v[24:25], v[18:19] op_sel:[0,1] op_sel_hi:[1,1]
 v_pk_fma_f32 v[216:217], v[216:217], v[16:17], v[24:25] op_sel:[0,1,0] op_sel_hi:[1,1,1]
 v_lshlrev_b32 v26, 16, v109
 v_and_b32 v27, s58, v109
 v_pk_mul_f32 v[26:27], v[26:27], v[18:19] op_sel:[0,1] op_sel_hi:[1,1]
 v_pk_fma_f32 v[218:219], v[218:219], v[16:17], v[26:27] op_sel:[0,1,0] op_sel_hi:[1,1,1]
 v_lshlrev_b32 v28, 16, v110
 v_and_b32 v29, s58, v110
 v_pk_mul_f32 v[28:29], v[28:29], v[18:19] op_sel:[0,1] op_sel_hi:[1,1]
 v_pk_fma_f32 v[220:221], v[220:221], v[16:17], v[28:29] op_sel:[0,1,0] op_sel_hi:[1,1,1]
 v_lshlrev_b32 v30, 16, v111
 v_and_b32 v31, s58, v111
 v_pk_mul_f32 v[30:31], v[30:31], v[18:19] op_sel:[0,1] op_sel_hi:[1,1]
 v_pk_fma_f32 v[222:223], v[222:223], v[16:17], v[30:31] op_sel:[0,1,0] op_sel_hi:[1,1,1]
 v_cvt_pk_bf16_f32 v216, v216, v217
 v_cvt_pk_bf16_f32 v217, v218, v219
 v_cvt_pk_bf16_f32 v218, v220, v221
 v_cvt_pk_bf16_f32 v219, v222, v223
 v_lshlrev_b32 v24, 16, v112
 v_and_b32 v25, s58, v112
 v_pk_mul_f32 v[24:25], v[24:25], v[18:19] op_sel:[0,1] op_sel_hi:[1,1]
 v_pk_fma_f32 v[224:225], v[224:225], v[16:17], v[24:25] op_sel:[0,1,0] op_sel_hi:[1,1,1]
 v_lshlrev_b32 v26, 16, v113
 v_and_b32 v27, s58, v113
 v_pk_mul_f32 v[26:27], v[26:27], v[18:19] op_sel:[0,1] op_sel_hi:[1,1]
 v_pk_fma_f32 v[226:227], v[226:227], v[16:17], v[26:27] op_sel:[0,1,0] op_sel_hi:[1,1,1]
 v_lshlrev_b32 v28, 16, v114
 v_and_b32 v29, s58, v114
 v_pk_mul_f32 v[28:29], v[28:29], v[18:19] op_sel:[0,1] op_sel_hi:[1,1]
 v_pk_fma_f32 v[228:229], v[228:229], v[16:17], v[28:29] op_sel:[0,1,0] op_sel_hi:[1,1,1]
 v_lshlrev_b32 v30, 16, v115
 v_and_b32 v31, s58, v115
 v_pk_mul_f32 v[30:31], v[30:31], v[18:19] op_sel:[0,1] op_sel_hi:[1,1]
 v_pk_fma_f32 v[230:231], v[230:231], v[16:17], v[30:31] op_sel:[0,1,0] op_sel_hi:[1,1,1]
 v_cvt_pk_bf16_f32 v224, v224, v225
 v_cvt_pk_bf16_f32 v225, v226, v227
 v_cvt_pk_bf16_f32 v226, v228, v229
 v_cvt_pk_bf16_f32 v227, v230, v231
 v_lshlrev_b32 v24, 16, v116
 v_and_b32 v25, s58, v116
 v_pk_mul_f32 v[24:25], v[24:25], v[18:19] op_sel:[0,1] op_sel_hi:[1,1]
 v_pk_fma_f32 v[232:233], v[232:233], v[16:17], v[24:25] op_sel:[0,1,0] op_sel_hi:[1,1,1]
 v_lshlrev_b32 v26, 16, v117
 v_and_b32 v27, s58, v117
 v_pk_mul_f32 v[26:27], v[26:27], v[18:19] op_sel:[0,1] op_sel_hi:[1,1]
 v_pk_fma_f32 v[234:235], v[234:235], v[16:17], v[26:27] op_sel:[0,1,0] op_sel_hi:[1,1,1]
 v_lshlrev_b32 v28, 16, v118
 v_and_b32 v29, s58, v118
 v_pk_mul_f32 v[28:29], v[28:29], v[18:19] op_sel:[0,1] op_sel_hi:[1,1]
 v_pk_fma_f32 v[236:237], v[236:237], v[16:17], v[28:29] op_sel:[0,1,0] op_sel_hi:[1,1,1]
 v_lshlrev_b32 v30, 16, v119
 v_and_b32 v31, s58, v119
 v_pk_mul_f32 v[30:31], v[30:31], v[18:19] op_sel:[0,1] op_sel_hi:[1,1]
 v_pk_fma_f32 v[238:239], v[238:239], v[16:17], v[30:31] op_sel:[0,1,0] op_sel_hi:[1,1,1]
 v_cvt_pk_bf16_f32 v232, v232, v233
 v_cvt_pk_bf16_f32 v233, v234, v235
 v_cvt_pk_bf16_f32 v234, v236, v237
 v_cvt_pk_bf16_f32 v235, v238, v239
 v_lshlrev_b32 v24, 16, v120
 v_and_b32 v25, s58, v120
 v_pk_mul_f32 v[24:25], v[24:25], v[18:19] op_sel:[0,1] op_sel_hi:[1,1]
 v_pk_fma_f32 v[240:241], v[240:241], v[16:17], v[24:25] op_sel:[0,1,0] op_sel_hi:[1,1,1]
 v_lshlrev_b32 v26, 16, v121
 v_and_b32 v27, s58, v121
 v_pk_mul_f32 v[26:27], v[26:27], v[18:19] op_sel:[0,1] op_sel_hi:[1,1]
 v_pk_fma_f32 v[242:243], v[242:243], v[16:17], v[26:27] op_sel:[0,1,0] op_sel_hi:[1,1,1]
 v_lshlrev_b32 v28, 16, v122
 v_and_b32 v29, s58, v122
 v_pk_mul_f32 v[28:29], v[28:29], v[18:19] op_sel:[0,1] op_sel_hi:[1,1]
 v_pk_fma_f32 v[244:245], v[244:245], v[16:17], v[28:29] op_sel:[0,1,0] op_sel_hi:[1,1,1]
 v_lshlrev_b32 v30, 16, v123
 v_and_b32 v31, s58, v123
 v_pk_mul_f32 v[30:31], v[30:31], v[18:19] op_sel:[0,1] op_sel_hi:[1,1]
 v_pk_fma_f32 v[246:247], v[246:247], v[16:17], v[30:31] op_sel:[0,1,0] op_sel_hi:[1,1,1]
 v_cvt_pk_bf16_f32 v240, v240, v241
 v_cvt_pk_bf16_f32 v241, v242, v243
 v_cvt_pk_bf16_f32 v242, v244, v245
 v_cvt_pk_bf16_f32 v243, v246, v247
 v_lshlrev_b32 v24, 16, v124
 v_and_b32 v25, s58, v124
 v_pk_mul_f32 v[24:25], v[24:25], v[18:19] op_sel:[0,1] op_sel_hi:[1,1]
 v_pk_fma_f32 v[248:249], v[248:249], v[16:17], v[24:25] op_sel:[0,1,0] op_sel_hi:[1,1,1]
 v_lshlrev_b32 v26, 16, v125
 v_and_b32 v27, s58, v125
 v_pk_mul_f32 v[26:27], v[26:27], v[18:19] op_sel:[0,1] op_sel_hi:[1,1]
 v_pk_fma_f32 v[250:251], v[250:251], v[16:17], v[26:27] op_sel:[0,1,0] op_sel_hi:[1,1,1]
 v_lshlrev_b32 v28, 16, v126
 v_and_b32 v29, s58, v126
 v_pk_mul_f32 v[28:29], v[28:29], v[18:19] op_sel:[0,1] op_sel_hi:[1,1]
 v_pk_fma_f32 v[252:253], v[252:253], v[16:17], v[28:29] op_sel:[0,1,0] op_sel_hi:[1,1,1]
 v_lshlrev_b32 v30, 16, v127
 v_and_b32 v31, s58, v127
 v_pk_mul_f32 v[30:31], v[30:31], v[18:19] op_sel:[0,1] op_sel_hi:[1,1]
 v_pk_fma_f32 v[254:255], v[254:255], v[16:17], v[30:31] op_sel:[0,1,0] op_sel_hi:[1,1,1]
 v_cvt_pk_bf16_f32 v248, v248, v249
 v_cvt_pk_bf16_f32 v249, v250, v251
 v_cvt_pk_bf16_f32 v250, v252, v253
 v_cvt_pk_bf16_f32 v251, v254, v255
L_attdone:
 v_accvgpr_read_b32 v44, a254
 ds_read_b64_tr_b16 a[160:161], v44 offset:0
 ds_read_b64_tr_b16 a[162:163], v44 offset:2048
 ds_read_b64_tr_b16 a[164:165], v44 offset:4096
 ds_read_b64_tr_b16 a[166:167], v44 offset:6144
 ds_read_b64_tr_b16 a[168:169], v44 offset:8192
 ds_read_b64_tr_b16 a[170:171], v44 offset:10240
 ds_read_b64_tr_b16 a[172:173], v44 offset:12288
 ds_read_b64_tr_b16 a[174:175], v44 offset:14336
 ds_read_b64_tr_b16 a[176:177], v44 offset:16384
 ds_read_b64_tr_b16 a[178:179], v44 offset:18432
 ds_read_b64_tr_b16 a[180:181], v44 offset:20480
 ds_read_b64_tr_b16 a[182:183], v44 offset:22528
 ds_read_b64_tr_b16 a[184:185], v44 offset:24576
 ds_read_b64_tr_b16 a[186:187], v44 offset:26624
L_op1in:
 s_waitcnt lgkmcnt(7)
 v_mfma_f32_16x16x32_bf16 v[72:75], a[160:163], v[128:131], 0
 s_lshl_b32 s48, s63, 3
 ds_read_b64_tr_b16 a[188:189], v44 offset:28672
 v_xor_b32 v45, 32, v44
 v_mfma_f32_16x16x32_bf16 v[72:75], a[164:167], v[136:139], v[72:75]
 s_add_u32 s48, s48, s3
 ds_read_b64_tr_b16 a[190:191], v44 offset:30720
 v_xor_b32 v46, 64, v44
 v_mfma_f32_16x16x32_bf16 v[72:75], a[168:171], v[144:147], v[72:75]
 s_waitcnt lgkmcnt(4)
 ds_read_b64_tr_b16 a[192:193], v45 offset:0
 v_xor_b32 v47, 96, v44
 v_mfma_f32_16x16x32_bf16 v[72:75], a[172:175], v[152:155], v[72:75]
 s_add_u32 m0, s29, 32768
 ds_read_b64_tr_b16 a[194:195], v45 offset:2048
 v_accvgpr_read_b32 v9, a245
 v_mfma_f32_16x16x32_bf16 v[72:75], a[176:179], v[160:163], v[72:75]
 ds_read_b64_tr_b16 a[196:197], v45 offset:4096
 buffer_load_dwordx4 v2, s[8:11], s78 offen lds
 v_mfma_f32_16x16x32_bf16 v[72:75], a[180:183], v[168:171], v[72:75]
 s_waitcnt lgkmcnt(3)
 ds_read_b64_tr_b16 a[198:199], v45 offset:6144
 v_mfma_f32_16x16x32_bf16 v[72:75], a[184:187], v[176:179], v[72:75]
 s_mul_i32 s48, s48, 243712
 ds_read_b64_tr_b16 a[200:201], v45 offset:8192
 v_mfma_f32_16x16x32_bf16 v[72:75], a[188:191], v[184:187], v[72:75]
 s_lshl_b32 s58, s26, 10
 ds_read_b64_tr_b16 a[202:203], v45 offset:10240
 v_mfma_f32_16x16x32_bf16 v[80:83], a[160:163], v[192:195], 0
 s_add_u32 s48, s48, s58
 ds_read_b64_tr_b16 a[204:205], v45 offset:12288
 v_mfma_f32_16x16x32_bf16 v[80:83], a[164:167], v[200:203], v[80:83]
 s_add_u32 s48, s48, 117440512
 ds_read_b64_tr_b16 a[206:207], v45 offset:14336
 v_mfma_f32_16x16x32_bf16 v[80:83], a[168:171], v[208:211], v[80:83]
 s_add_u32 m0, s29, 36864
 ds_read_b64_tr_b16 a[208:209], v45 offset:16384
 v_mfma_f32_16x16x32_bf16 v[80:83], a[172:175], v[216:219], v[80:83]
 ds_read_b64_tr_b16 a[210:211], v45 offset:18432
 buffer_load_dwordx4 v2, s[8:11], s79 offen lds
 v_mfma_f32_16x16x32_bf16 v[80:83], a[176:179], v[224:227], v[80:83]
 ds_read_b64_tr_b16 a[212:213], v45 offset:20480
 v_mul_f32 v72, v72, v64
 v_mfma_f32_16x16x32_bf16 v[80:83], a[180:183], v[232:235], v[80:83]
 ds_read_b64_tr_b16 a[214:215], v45 offset:22528
 v_mul_f32 v73, v73, v64
 v_mfma_f32_16x16x32_bf16 v[80:83], a[184:187], v[240:243], v[80:83]
 ds_read_b64_tr_b16 a[216:217], v45 offset:24576
 v_mul_f32 v74, v74, v64
 v_mfma_f32_16x16x32_bf16 v[80:83], a[188:191], v[248:251], v[80:83]
 s_waitcnt lgkmcnt(7)
 ds_read_b64_tr_b16 a[218:219], v45 offset:26624
 v_mul_f32 v75, v75, v64
 v_mfma_f32_16x16x32_bf16 v[76:79], a[192:195], v[128:131], 0
 ds_read_b64_tr_b16 a[220:221], v45 offset:28672
 v_mfma_f32_16x16x32_bf16 v[76:79], a[196:199], v[136:139], v[76:79]
 s_add_u32 m0, s29, 40960
 ds_read_b64_tr_b16 a[222:223], v45 offset:30720
 v_mfma_f32_16x16x32_bf16 v[76:79], a[200:203], v[144:147], v[76:79]
 s_waitcnt lgkmcnt(4)
 ds_read_b64_tr_b16 a[160:161], v46 offset:0
 buffer_load_dwordx4 v2, s[8:11], s80 offen lds
 v_mfma_f32_16x16x32_bf16 v[76:79], a[204:207], v[152:155], v[76:79]
 ds_read_b64_tr_b16 a[162:163], v46 offset:2048
 v_mfma_f32_16x16x32_bf16 v[76:79], a[208:211], v[160:163], v[76:79]
 ds_read_b64_tr_b16 a[164:165], v46 offset:4096
 v_mul_f32 v80, v80, v65
 v_mfma_f32_16x16x32_bf16 v[76:79], a[212:215], v[168:171], v[76:79]
 s_waitcnt lgkmcnt(3)
 ds_read_b64_tr_b16 a[166:167], v46 offset:6144
 v_mul_f32 v81, v81, v65
 v_mfma_f32_16x16x32_bf16 v[76:79], a[216:219], v[176:179], v[76:79]
 ds_read_b64_tr_b16 a[168:169], v46 offset:8192
 v_mul_f32 v82, v82, v65
 v_mfma_f32_16x16x32_bf16 v[76:79], a[220:223], v[184:187], v[76:79]
 ds_read_b64_tr_b16 a[170:171], v46 offset:10240
 v_mul_f32 v83, v83, v65
 v_mfma_f32_16x16x32_bf16 v[84:87], a[192:195], v[192:195], 0
 s_add_u32 m0, s29, 45056
 ds_read_b64_tr_b16 a[172:173], v46 offset:12288
 v_mfma_f32_16x16x32_bf16 v[84:87], a[196:199], v[200:203], v[84:87]
 ds_read_b64_tr_b16 a[174:175], v46 offset:14336
 buffer_load_dwordx4 v2, s[8:11], s81 offen lds
 v_mfma_f32_16x16x32_bf16 v[84:87], a[200:203], v[208:211], v[84:87]
 ds_read_b64_tr_b16 a[176:177], v46 offset:16384
 v_mfma_f32_16x16x32_bf16 v[84:87], a[204:207], v[216:219], v[84:87]
 ds_read_b64_tr_b16 a[178:179], v46 offset:18432
 v_mfma_f32_16x16x32_bf16 v[84:87], a[208:211], v[224:227], v[84:87]
 ds_read_b64_tr_b16 a[180:181], v46 offset:20480
 v_mul_f32 v76, v76, v64
 v_mfma_f32_16x16x32_bf16 v[84:87], a[212:215], v[232:235], v[84:87]
 ds_read_b64_tr_b16 a[182:183], v46 offset:22528
 v_mul_f32 v77, v77, v64
 v_mfma_f32_16x16x32_bf16 v[84:87], a[216:219], v[240:243], v[84:87]
 s_add_u32 m0, s29, 49152
 ds_read_b64_tr_b16 a[184:185], v46 offset:24576
 v_mul_f32 v78, v78, v64
 v_mfma_f32_16x16x32_bf16 v[84:87], a[220:223], v[248:251], v[84:87]
 s_waitcnt lgkmcnt(7)
 ds_read_b64_tr_b16 a[186:187], v46 offset:26624
 v_mul_f32 v79, v79, v64
 v_mfma_f32_16x16x32_bf16 v[88:91], a[160:163], v[128:131], 0
 ds_read_b64_tr_b16 a[188:189], v46 offset:28672
 buffer_load_dwordx4 v2, s[8:11], s82 offen lds
 v_mfma_f32_16x16x32_bf16 v[88:91], a[164:167], v[136:139], v[88:91]
 ds_read_b64_tr_b16 a[190:191], v46 offset:30720
 v_cvt_pk_bf16_f32 v72, v72, v73
 v_mfma_f32_16x16x32_bf16 v[88:91], a[168:171], v[144:147], v[88:91]
 s_waitcnt lgkmcnt(4)
 ds_read_b64_tr_b16 a[192:193], v47 offset:0
 v_cvt_pk_bf16_f32 v73, v74, v75
 v_mfma_f32_16x16x32_bf16 v[88:91], a[172:175], v[152:155], v[88:91]
 ds_read_b64_tr_b16 a[194:195], v47 offset:2048
 v_cvt_pk_bf16_f32 v74, v76, v77
 v_mfma_f32_16x16x32_bf16 v[88:91], a[176:179], v[160:163], v[88:91]
 s_add_u32 s58, s48, 0
 ds_read_b64_tr_b16 a[196:197], v47 offset:4096
 v_cvt_pk_bf16_f32 v75, v78, v79
 v_mfma_f32_16x16x32_bf16 v[88:91], a[180:183], v[168:171], v[88:91]
 s_waitcnt lgkmcnt(3)
 ds_read_b64_tr_b16 a[198:199], v47 offset:6144
 buffer_store_dwordx4 v[72:75], v1, s[12:15], s58 offen sc1
 v_mfma_f32_16x16x32_bf16 v[88:91], a[184:187], v[176:179], v[88:91]
 s_add_u32 m0, s29, 53248
 ds_read_b64_tr_b16 a[200:201], v47 offset:8192
 v_mul_f32 v84, v84, v65
 v_mfma_f32_16x16x32_bf16 v[88:91], a[188:191], v[184:187], v[88:91]
 ds_read_b64_tr_b16 a[202:203], v47 offset:10240
 buffer_load_dwordx4 v2, s[8:11], s83 offen lds
 v_mfma_f32_16x16x32_bf16 v[96:99], a[160:163], v[192:195], 0
 ds_read_b64_tr_b16 a[204:205], v47 offset:12288
 v_mul_f32 v85, v85, v65
 v_mfma_f32_16x16x32_bf16 v[96:99], a[164:167], v[200:203], v[96:99]
 ds_read_b64_tr_b16 a[206:207], v47 offset:14336
 v_mul_f32 v86, v86, v65
 v_mfma_f32_16x16x32_bf16 v[96:99], a[168:171], v[208:211], v[96:99]
 ds_read_b64_tr_b16 a[208:209], v47 offset:16384
 v_mul_f32 v87, v87, v65
 v_mfma_f32_16x16x32_bf16 v[96:99], a[172:175], v[216:219], v[96:99]
 ds_read_b64_tr_b16 a[210:211], v47 offset:18432
 v_cvt_pk_bf16_f32 v80, v80, v81
 v_mfma_f32_16x16x32_bf16 v[96:99], a[176:179], v[224:227], v[96:99]
 ds_read_b64_tr_b16 a[212:213], v47 offset:20480
 v_cvt_pk_bf16_f32 v81, v82, v83
 v_mfma_f32_16x16x32_bf16 v[96:99], a[180:183], v[232:235], v[96:99]
 s_add_u32 m0, s29, 57344
 ds_read_b64_tr_b16 a[214:215], v47 offset:22528
 v_cvt_pk_bf16_f32 v82, v84, v85
 v_mfma_f32_16x16x32_bf16 v[96:99], a[184:187], v[240:243], v[96:99]
 ds_read_b64_tr_b16 a[216:217], v47 offset:24576
 buffer_load_dwordx4 v2, s[8:11], s84 offen lds
 v_mfma_f32_16x16x32_bf16 v[96:99], a[188:191], v[248:251], v[96:99]
 s_waitcnt lgkmcnt(7)
 ds_read_b64_tr_b16 a[218:219], v47 offset:26624
 v_cvt_pk_bf16_f32 v83, v86, v87
 v_mfma_f32_16x16x32_bf16 v[92:95], a[192:195], v[128:131], 0
 s_waitcnt vmcnt(8)
 ds_read_b64_tr_b16 a[220:221], v47 offset:28672
 v_mul_f32 v88, v88, v64
 v_mfma_f32_16x16x32_bf16 v[92:95], a[196:199], v[136:139], v[92:95]
 s_barrier
 ds_read_b64_tr_b16 a[222:223], v47 offset:30720
 v_xor_b32 v44, 0x20000, v44
 v_mfma_f32_16x16x32_bf16 v[92:95], a[200:203], v[144:147], v[92:95]
 s_waitcnt lgkmcnt(4)
 ds_read_b64_tr_b16 a[160:161], v44 offset:0
 v_mul_f32 v89, v89, v64
 v_mfma_f32_16x16x32_bf16 v[92:95], a[204:207], v[152:155], v[92:95]
 ds_read_b64_tr_b16 a[162:163], v44 offset:2048
 v_mul_f32 v90, v90, v64
 v_mfma_f32_16x16x32_bf16 v[92:95], a[208:211], v[160:163], v[92:95]
 s_add_u32 m0, s29, 61440
 ds_read_b64_tr_b16 a[164:165], v44 offset:4096
 v_mul_f32 v91, v91, v64
 v_mfma_f32_16x16x32_bf16 v[92:95], a[212:215], v[168:171], v[92:95]
 s_waitcnt lgkmcnt(3)
 ds_read_b64_tr_b16 a[166:167], v44 offset:6144
 buffer_load_dwordx4 v2, s[8:11], s85 offen lds
 v_mfma_f32_16x16x32_bf16 v[92:95], a[216:219], v[176:179], v[92:95]
 s_add_u32 s58, s48, 974848
 ds_read_b64_tr_b16 a[168:169], v44 offset:8192
 v_add_u32 v2, 128, v2
 v_mfma_f32_16x16x32_bf16 v[92:95], a[220:223], v[184:187], v[92:95]
 ds_read_b64_tr_b16 a[170:171], v44 offset:10240
 buffer_store_dwordx4 v[80:83], v1, s[12:15], s58 offen sc1
 v_mfma_f32_16x16x32_bf16 v[100:103], a[192:195], v[192:195], 0
 ds_read_b64_tr_b16 a[172:173], v44 offset:12288
 v_mul_f32 v96, v96, v65
 v_mfma_f32_16x16x32_bf16 v[100:103], a[196:199], v[200:203], v[100:103]
 ds_read_b64_tr_b16 a[174:175], v44 offset:14336
 v_mul_f32 v97, v97, v65
 v_mfma_f32_16x16x32_bf16 v[100:103], a[200:203], v[208:211], v[100:103]
 ds_read_b64_tr_b16 a[176:177], v44 offset:16384
 v_mul_f32 v98, v98, v65
 v_mfma_f32_16x16x32_bf16 v[100:103], a[204:207], v[216:219], v[100:103]
 ds_read_b64_tr_b16 a[178:179], v44 offset:18432
 v_mul_f32 v99, v99, v65
 v_mfma_f32_16x16x32_bf16 v[100:103], a[208:211], v[224:227], v[100:103]
 ds_read_b64_tr_b16 a[180:181], v44 offset:20480
 v_mul_f32 v92, v92, v64
 v_mfma_f32_16x16x32_bf16 v[100:103], a[212:215], v[232:235], v[100:103]
 ds_read_b64_tr_b16 a[182:183], v44 offset:22528
 v_mul_f32 v93, v93, v64
 v_mfma_f32_16x16x32_bf16 v[100:103], a[216:219], v[240:243], v[100:103]
 ds_read_b64_tr_b16 a[184:185], v44 offset:24576
 v_mul_f32 v94, v94, v64
 v_mfma_f32_16x16x32_bf16 v[100:103], a[220:223], v[248:251], v[100:103]
 s_waitcnt lgkmcnt(7)
 ds_read_b64_tr_b16 a[186:187], v44 offset:26624
 v_mul_f32 v95, v95, v64
 v_mfma_f32_16x16x32_bf16 v[104:107], a[160:163], v[128:131], 0
 ds_read_b64_tr_b16 a[188:189], v44 offset:28672
 v_cvt_pk_bf16_f32 v88, v88, v89
 v_mfma_f32_16x16x32_bf16 v[104:107], a[164:167], v[136:139], v[104:107]
 ds_read_b64_tr_b16 a[190:191], v44 offset:30720
 v_xor_b32 v45, 0x20000, v45
 v_mfma_f32_16x16x32_bf16 v[104:107], a[168:171], v[144:147], v[104:107]
 s_waitcnt lgkmcnt(4)
 ds_read_b64_tr_b16 a[192:193], v45 offset:0
 v_cvt_pk_bf16_f32 v89, v90, v91
 v_mfma_f32_16x16x32_bf16 v[104:107], a[172:175], v[152:155], v[104:107]
 s_add_u32 m0, s29, 65536
 ds_read_b64_tr_b16 a[194:195], v45 offset:2048
 v_cvt_pk_bf16_f32 v90, v92, v93
 v_mfma_f32_16x16x32_bf16 v[104:107], a[176:179], v[160:163], v[104:107]
 ds_read_b64_tr_b16 a[196:197], v45 offset:4096
 buffer_load_dwordx4 v2, s[8:11], s78 offen lds
 v_mfma_f32_16x16x32_bf16 v[104:107], a[180:183], v[168:171], v[104:107]
 s_waitcnt lgkmcnt(3)
 ds_read_b64_tr_b16 a[198:199], v45 offset:6144
 v_cvt_pk_bf16_f32 v91, v94, v95
 v_mfma_f32_16x16x32_bf16 v[104:107], a[184:187], v[176:179], v[104:107]
 s_add_u32 s58, s48, 17408
 ds_read_b64_tr_b16 a[200:201], v45 offset:8192
 v_mul_f32 v100, v100, v65
 v_mfma_f32_16x16x32_bf16 v[104:107], a[188:191], v[184:187], v[104:107]
 ds_read_b64_tr_b16 a[202:203], v45 offset:10240
 buffer_store_dwordx4 v[88:91], v1, s[12:15], s58 offen sc1
 v_mfma_f32_16x16x32_bf16 v[112:115], a[160:163], v[192:195], 0
 ds_read_b64_tr_b16 a[204:205], v45 offset:12288
 v_mul_f32 v101, v101, v65
 v_mfma_f32_16x16x32_bf16 v[112:115], a[164:167], v[200:203], v[112:115]
 ds_read_b64_tr_b16 a[206:207], v45 offset:14336
 v_mul_f32 v102, v102, v65
 v_mfma_f32_16x16x32_bf16 v[112:115], a[168:171], v[208:211], v[112:115]
 s_add_u32 m0, s29, 69632
 ds_read_b64_tr_b16 a[208:209], v45 offset:16384
 v_mul_f32 v103, v103, v65
 v_mfma_f32_16x16x32_bf16 v[112:115], a[172:175], v[216:219], v[112:115]
 ds_read_b64_tr_b16 a[210:211], v45 offset:18432
 buffer_load_dwordx4 v2, s[8:11], s79 offen lds
 v_mfma_f32_16x16x32_bf16 v[112:115], a[176:179], v[224:227], v[112:115]
 ds_read_b64_tr_b16 a[212:213], v45 offset:20480
 v_cvt_pk_bf16_f32 v96, v96, v97
 v_mfma_f32_16x16x32_bf16 v[112:115], a[180:183], v[232:235], v[112:115]
 ds_read_b64_tr_b16 a[214:215], v45 offset:22528
 v_cvt_pk_bf16_f32 v97, v98, v99
 v_mfma_f32_16x16x32_bf16 v[112:115], a[184:187], v[240:243], v[112:115]
 s_add_u32 s58, s48, 992256
 ds_read_b64_tr_b16 a[216:217], v45 offset:24576
 v_cvt_pk_bf16_f32 v98, v100, v101
 v_mfma_f32_16x16x32_bf16 v[112:115], a[188:191], v[248:251], v[112:115]
 s_waitcnt lgkmcnt(7)
 ds_read_b64_tr_b16 a[218:219], v45 offset:26624
 v_cvt_pk_bf16_f32 v99, v102, v103
 v_mfma_f32_16x16x32_bf16 v[108:111], a[192:195], v[128:131], 0
 ds_read_b64_tr_b16 a[220:221], v45 offset:28672
 buffer_store_dwordx4 v[96:99], v1, s[12:15], s58 offen sc1
 v_mfma_f32_16x16x32_bf16 v[108:111], a[196:199], v[136:139], v[108:111]
 s_add_u32 m0, s29, 73728
 ds_read_b64_tr_b16 a[222:223], v45 offset:30720
 v_xor_b32 v46, 0x20000, v46
 v_mfma_f32_16x16x32_bf16 v[108:111], a[200:203], v[144:147], v[108:111]
 s_waitcnt lgkmcnt(4)
 ds_read_b64_tr_b16 a[160:161], v46 offset:0
 buffer_load_dwordx4 v2, s[8:11], s80 offen lds
 v_mfma_f32_16x16x32_bf16 v[108:111], a[204:207], v[152:155], v[108:111]
 ds_read_b64_tr_b16 a[162:163], v46 offset:2048
 v_mul_f32 v104, v104, v64
 v_mfma_f32_16x16x32_bf16 v[108:111], a[208:211], v[160:163], v[108:111]
 ds_read_b64_tr_b16 a[164:165], v46 offset:4096
 v_mul_f32 v105, v105, v64
 v_mfma_f32_16x16x32_bf16 v[108:111], a[212:215], v[168:171], v[108:111]
 s_waitcnt lgkmcnt(3)
 ds_read_b64_tr_b16 a[166:167], v46 offset:6144
 v_mul_f32 v106, v106, v64
 v_mfma_f32_16x16x32_bf16 v[108:111], a[216:219], v[176:179], v[108:111]
 ds_read_b64_tr_b16 a[168:169], v46 offset:8192
 v_mul_f32 v107, v107, v64
 v_mfma_f32_16x16x32_bf16 v[108:111], a[220:223], v[184:187], v[108:111]
 ds_read_b64_tr_b16 a[170:171], v46 offset:10240
 v_mul_f32 v112, v112, v65
 v_mfma_f32_16x16x32_bf16 v[116:119], a[192:195], v[192:195], 0
 s_add_u32 m0, s29, 77824
 ds_read_b64_tr_b16 a[172:173], v46 offset:12288
 v_mul_f32 v113, v113, v65
 v_mfma_f32_16x16x32_bf16 v[116:119], a[196:199], v[200:203], v[116:119]
 ds_read_b64_tr_b16 a[174:175], v46 offset:14336
 buffer_load_dwordx4 v2, s[8:11], s81 offen lds
 v_mfma_f32_16x16x32_bf16 v[116:119], a[200:203], v[208:211], v[116:119]
 ds_read_b64_tr_b16 a[176:177], v46 offset:16384
 v_mul_f32 v114, v114, v65
 v_mfma_f32_16x16x32_bf16 v[116:119], a[204:207], v[216:219], v[116:119]
 ds_read_b64_tr_b16 a[178:179], v46 offset:18432
 v_mul_f32 v115, v115, v65
 v_mfma_f32_16x16x32_bf16 v[116:119], a[208:211], v[224:227], v[116:119]
 ds_read_b64_tr_b16 a[180:181], v46 offset:20480
 v_mul_f32 v108, v108, v64
 v_mfma_f32_16x16x32_bf16 v[116:119], a[212:215], v[232:235], v[116:119]
 ds_read_b64_tr_b16 a[182:183], v46 offset:22528
 v_mul_f32 v109, v109, v64
 v_mfma_f32_16x16x32_bf16 v[116:119], a[216:219], v[240:243], v[116:119]
 s_add_u32 m0, s29, 81920
 ds_read_b64_tr_b16 a[184:185], v46 offset:24576
 v_mul_f32 v110, v110, v64
 v_mfma_f32_16x16x32_bf16 v[116:119], a[220:223], v[248:251], v[116:119]
 s_waitcnt lgkmcnt(7)
 ds_read_b64_tr_b16 a[186:187], v46 offset:26624
 v_mul_f32 v111, v111, v64
 v_mfma_f32_16x16x32_bf16 v[72:75], a[160:163], v[128:131], 0
 ds_read_b64_tr_b16 a[188:189], v46 offset:28672
 buffer_load_dwordx4 v2, s[8:11], s82 offen lds
 v_mfma_f32_16x16x32_bf16 v[72:75], a[164:167], v[136:139], v[72:75]
 ds_read_b64_tr_b16 a[190:191], v46 offset:30720
 v_xor_b32 v47, 0x20000, v47
 v_mfma_f32_16x16x32_bf16 v[72:75], a[168:171], v[144:147], v[72:75]
 s_waitcnt lgkmcnt(4)
 ds_read_b64_tr_b16 a[192:193], v47 offset:0
 v_cvt_pk_bf16_f32 v104, v104, v105
 v_mfma_f32_16x16x32_bf16 v[72:75], a[172:175], v[152:155], v[72:75]
 ds_read_b64_tr_b16 a[194:195], v47 offset:2048
 v_cvt_pk_bf16_f32 v105, v106, v107
 v_mfma_f32_16x16x32_bf16 v[72:75], a[176:179], v[160:163], v[72:75]
 ds_read_b64_tr_b16 a[196:197], v47 offset:4096
 v_cvt_pk_bf16_f32 v106, v108, v109
 v_mfma_f32_16x16x32_bf16 v[72:75], a[180:183], v[168:171], v[72:75]
 s_waitcnt lgkmcnt(3)
 ds_read_b64_tr_b16 a[198:199], v47 offset:6144
 v_cvt_pk_bf16_f32 v107, v110, v111
 v_mfma_f32_16x16x32_bf16 v[72:75], a[184:187], v[176:179], v[72:75]
 s_add_u32 m0, s29, 86016
 ds_read_b64_tr_b16 a[200:201], v47 offset:8192
 v_mul_f32 v116, v116, v65
 v_mfma_f32_16x16x32_bf16 v[72:75], a[188:191], v[184:187], v[72:75]
 ds_read_b64_tr_b16 a[202:203], v47 offset:10240
 buffer_load_dwordx4 v2, s[8:11], s83 offen lds
 v_mfma_f32_16x16x32_bf16 v[80:83], a[160:163], v[192:195], 0
 s_add_u32 s58, s48, 34816
 ds_read_b64_tr_b16 a[204:205], v47 offset:12288
 v_mul_f32 v117, v117, v65
 v_mfma_f32_16x16x32_bf16 v[80:83], a[164:167], v[200:203], v[80:83]
 ds_read_b64_tr_b16 a[206:207], v47 offset:14336
 buffer_store_dwordx4 v[104:107], v1, s[12:15], s58 offen sc1
 v_mfma_f32_16x16x32_bf16 v[80:83], a[168:171], v[208:211], v[80:83]
 ds_read_b64_tr_b16 a[208:209], v47 offset:16384
 v_mul_f32 v118, v118, v65
 v_mfma_f32_16x16x32_bf16 v[80:83], a[172:175], v[216:219], v[80:83]
 ds_read_b64_tr_b16 a[210:211], v47 offset:18432
 v_mul_f32 v119, v119, v65
 v_mfma_f32_16x16x32_bf16 v[80:83], a[176:179], v[224:227], v[80:83]
 ds_read_b64_tr_b16 a[212:213], v47 offset:20480
 v_cvt_pk_bf16_f32 v112, v112, v113
 v_mfma_f32_16x16x32_bf16 v[80:83], a[180:183], v[232:235], v[80:83]
 s_add_u32 m0, s29, 90112
 ds_read_b64_tr_b16 a[214:215], v47 offset:22528
 v_cvt_pk_bf16_f32 v113, v114, v115
 v_mfma_f32_16x16x32_bf16 v[80:83], a[184:187], v[240:243], v[80:83]
 ds_read_b64_tr_b16 a[216:217], v47 offset:24576
 buffer_load_dwordx4 v2, s[8:11], s84 offen lds
 v_mfma_f32_16x16x32_bf16 v[80:83], a[188:191], v[248:251], v[80:83]
 s_waitcnt lgkmcnt(7)
 ds_read_b64_tr_b16 a[218:219], v47 offset:26624
 v_cvt_pk_bf16_f32 v114, v116, v117
 v_mfma_f32_16x16x32_bf16 v[76:79], a[192:195], v[128:131], 0
 s_waitcnt vmcnt(11)
 ds_read_b64_tr_b16 a[220:221], v47 offset:28672
 v_cvt_pk_bf16_f32 v115, v118, v119
 v_mfma_f32_16x16x32_bf16 v[76:79], a[196:199], v[136:139], v[76:79]
 s_barrier
 ds_read_b64_tr_b16 a[222:223], v47 offset:30720
 v_mul_f32 v72, v72, v64
 v_mfma_f32_16x16x32_bf16 v[76:79], a[200:203], v[144:147], v[76:79]
 s_waitcnt lgkmcnt(4)
 ds_read_b64_tr_b16 a[160:161], v44 offset:32768
 v_mul_f32 v73, v73, v64
 v_mfma_f32_16x16x32_bf16 v[76:79], a[204:207], v[152:155], v[76:79]
 ds_read_b64_tr_b16 a[162:163], v44 offset:34816
 v_mul_f32 v74, v74, v64
 v_mfma_f32_16x16x32_bf16 v[76:79], a[208:211], v[160:163], v[76:79]
 s_add_u32 m0, s29, 94208
 ds_read_b64_tr_b16 a[164:165], v44 offset:36864
 v_mul_f32 v75, v75, v64
 v_mfma_f32_16x16x32_bf16 v[76:79], a[212:215], v[168:171], v[76:79]
 s_waitcnt lgkmcnt(3)
 ds_read_b64_tr_b16 a[166:167], v44 offset:38912
 buffer_load_dwordx4 v2, s[8:11], s85 offen lds
 v_mfma_f32_16x16x32_bf16 v[76:79], a[216:219], v[176:179], v[76:79]
 s_add_u32 s58, s48, 1009664
 ds_read_b64_tr_b16 a[168:169], v44 offset:40960
 v_add_u32 v2, 128, v2
 v_mfma_f32_16x16x32_bf16 v[76:79], a[220:223], v[184:187], v[76:79]
 ds_read_b64_tr_b16 a[170:171], v44 offset:43008
 buffer_store_dwordx4 v[112:115], v1, s[12:15], s58 offen sc1
 v_mfma_f32_16x16x32_bf16 v[84:87], a[192:195], v[192:195], 0
 ds_read_b64_tr_b16 a[172:173], v44 offset:45056
 v_mul_f32 v80, v80, v65
 v_mfma_f32_16x16x32_bf16 v[84:87], a[196:199], v[200:203], v[84:87]
 ds_read_b64_tr_b16 a[174:175], v44 offset:47104
 v_mul_f32 v81, v81, v65
 v_mfma_f32_16x16x32_bf16 v[84:87], a[200:203], v[208:211], v[84:87]
 ds_read_b64_tr_b16 a[176:177], v44 offset:49152
 v_mul_f32 v82, v82, v65
 v_mfma_f32_16x16x32_bf16 v[84:87], a[204:207], v[216:219], v[84:87]
 ds_read_b64_tr_b16 a[178:179], v44 offset:51200
 v_mul_f32 v83, v83, v65
 v_mfma_f32_16x16x32_bf16 v[84:87], a[208:211], v[224:227], v[84:87]
 ds_read_b64_tr_b16 a[180:181], v44 offset:53248
 v_mul_f32 v76, v76, v64
 v_mfma_f32_16x16x32_bf16 v[84:87], a[212:215], v[232:235], v[84:87]
 ds_read_b64_tr_b16 a[182:183], v44 offset:55296
 v_mul_f32 v77, v77, v64
 v_mfma_f32_16x16x32_bf16 v[84:87], a[216:219], v[240:243], v[84:87]
 ds_read_b64_tr_b16 a[184:185], v44 offset:57344
 v_mul_f32 v78, v78, v64
 v_mfma_f32_16x16x32_bf16 v[84:87], a[220:223], v[248:251], v[84:87]
 s_waitcnt lgkmcnt(7)
 ds_read_b64_tr_b16 a[186:187], v44 offset:59392
 v_mul_f32 v79, v79, v64
 v_mfma_f32_16x16x32_bf16 v[88:91], a[160:163], v[128:131], 0
 ds_read_b64_tr_b16 a[188:189], v44 offset:61440
 v_cvt_pk_bf16_f32 v72, v72, v73
 v_mfma_f32_16x16x32_bf16 v[88:91], a[164:167], v[136:139], v[88:91]
 ds_read_b64_tr_b16 a[190:191], v44 offset:63488
 v_cvt_pk_bf16_f32 v73, v74, v75
 v_mfma_f32_16x16x32_bf16 v[88:91], a[168:171], v[144:147], v[88:91]
 s_waitcnt lgkmcnt(4)
 ds_read_b64_tr_b16 a[192:193], v45 offset:32768
 v_cvt_pk_bf16_f32 v74, v76, v77
 v_mfma_f32_16x16x32_bf16 v[88:91], a[172:175], v[152:155], v[88:91]
 s_add_u32 m0, s29, 98304
 ds_read_b64_tr_b16 a[194:195], v45 offset:34816
 v_cvt_pk_bf16_f32 v75, v78, v79
 v_mfma_f32_16x16x32_bf16 v[88:91], a[176:179], v[160:163], v[88:91]
 ds_read_b64_tr_b16 a[196:197], v45 offset:36864
 buffer_load_dwordx4 v2, s[8:11], s78 offen lds
 v_mfma_f32_16x16x32_bf16 v[88:91], a[180:183], v[168:171], v[88:91]
 s_waitcnt lgkmcnt(3)
 ds_read_b64_tr_b16 a[198:199], v45 offset:38912
 v_mul_f32 v84, v84, v65
 v_mfma_f32_16x16x32_bf16 v[88:91], a[184:187], v[176:179], v[88:91]
 s_add_u32 s58, s48, 52224
 ds_read_b64_tr_b16 a[200:201], v45 offset:40960
 v_mul_f32 v85, v85, v65
 v_mfma_f32_16x16x32_bf16 v[88:91], a[188:191], v[184:187], v[88:91]
 ds_read_b64_tr_b16 a[202:203], v45 offset:43008
 buffer_store_dwordx4 v[72:75], v1, s[12:15], s58 offen sc1
 v_mfma_f32_16x16x32_bf16 v[96:99], a[160:163], v[192:195], 0
 ds_read_b64_tr_b16 a[204:205], v45 offset:45056
 v_mul_f32 v86, v86, v65
 v_mfma_f32_16x16x32_bf16 v[96:99], a[164:167], v[200:203], v[96:99]
 ds_read_b64_tr_b16 a[206:207], v45 offset:47104
 v_mul_f32 v87, v87, v65
 v_mfma_f32_16x16x32_bf16 v[96:99], a[168:171], v[208:211], v[96:99]
 s_add_u32 m0, s29, 102400
 ds_read_b64_tr_b16 a[208:209], v45 offset:49152
 v_cvt_pk_bf16_f32 v80, v80, v81
 v_mfma_f32_16x16x32_bf16 v[96:99], a[172:175], v[216:219], v[96:99]
 ds_read_b64_tr_b16 a[210:211], v45 offset:51200
 buffer_load_dwordx4 v2, s[8:11], s79 offen lds
 v_mfma_f32_16x16x32_bf16 v[96:99], a[176:179], v[224:227], v[96:99]
 ds_read_b64_tr_b16 a[212:213], v45 offset:53248
 v_cvt_pk_bf16_f32 v81, v82, v83
 v_mfma_f32_16x16x32_bf16 v[96:99], a[180:183], v[232:235], v[96:99]
 ds_read_b64_tr_b16 a[214:215], v45 offset:55296
 v_cvt_pk_bf16_f32 v82, v84, v85
 v_mfma_f32_16x16x32_bf16 v[96:99], a[184:187], v[240:243], v[96:99]
 s_add_u32 s58, s48, 1027072
 ds_read_b64_tr_b16 a[216:217], v45 offset:57344
 v_cvt_pk_bf16_f32 v83, v86, v87
 v_mfma_f32_16x16x32_bf16 v[96:99], a[188:191], v[248:251], v[96:99]
 s_waitcnt lgkmcnt(7)
 ds_read_b64_tr_b16 a[218:219], v45 offset:59392
 buffer_store_dwordx4 v[80:83], v1, s[12:15], s58 offen sc1
 v_mfma_f32_16x16x32_bf16 v[92:95], a[192:195], v[128:131], 0
 ds_read_b64_tr_b16 a[220:221], v45 offset:61440
 v_mul_f32 v88, v88, v64
 v_mfma_f32_16x16x32_bf16 v[92:95], a[196:199], v[136:139], v[92:95]
 s_add_u32 m0, s29, 106496
 ds_read_b64_tr_b16 a[222:223], v45 offset:63488
 v_mul_f32 v89, v89, v64
 v_mfma_f32_16x16x32_bf16 v[92:95], a[200:203], v[144:147], v[92:95]
 s_waitcnt lgkmcnt(4)
 ds_read_b64_tr_b16 a[160:161], v46 offset:32768
 buffer_load_dwordx4 v2, s[8:11], s80 offen lds
 v_mfma_f32_16x16x32_bf16 v[92:95], a[204:207], v[152:155], v[92:95]
 ds_read_b64_tr_b16 a[162:163], v46 offset:34816
 v_mul_f32 v90, v90, v64
 v_mfma_f32_16x16x32_bf16 v[92:95], a[208:211], v[160:163], v[92:95]
 ds_read_b64_tr_b16 a[164:165], v46 offset:36864
 v_mul_f32 v91, v91, v64
 v_mfma_f32_16x16x32_bf16 v[92:95], a[212:215], v[168:171], v[92:95]
 s_waitcnt lgkmcnt(3)
 ds_read_b64_tr_b16 a[166:167], v46 offset:38912
 v_mul_f32 v96, v96, v65
 v_mfma_f32_16x16x32_bf16 v[92:95], a[216:219], v[176:179], v[92:95]
 ds_read_b64_tr_b16 a[168:169], v46 offset:40960
 v_mul_f32 v97, v97, v65
 v_mfma_f32_16x16x32_bf16 v[92:95], a[220:223], v[184:187], v[92:95]
 ds_read_b64_tr_b16 a[170:171], v46 offset:43008
 v_mul_f32 v98, v98, v65
 v_mfma_f32_16x16x32_bf16 v[100:103], a[192:195], v[192:195], 0
 s_add_u32 m0, s29, 110592
 ds_read_b64_tr_b16 a[172:173], v46 offset:45056
 v_mul_f32 v99, v99, v65
 v_mfma_f32_16x16x32_bf16 v[100:103], a[196:199], v[200:203], v[100:103]
 ds_read_b64_tr_b16 a[174:175], v46 offset:47104
 buffer_load_dwordx4 v2, s[8:11], s81 offen lds
 v_mfma_f32_16x16x32_bf16 v[100:103], a[200:203], v[208:211], v[100:103]
 ds_read_b64_tr_b16 a[176:177], v46 offset:49152
 v_mfma_f32_16x16x32_bf16 v[100:103], a[204:207], v[216:219], v[100:103]
 ds_read_b64_tr_b16 a[178:179], v46 offset:51200
 v_mfma_f32_16x16x32_bf16 v[100:103], a[208:211], v[224:227], v[100:103]
 ds_read_b64_tr_b16 a[180:181], v46 offset:53248
 v_mul_f32 v92, v92, v64
 v_mfma_f32_16x16x32_bf16 v[100:103], a[212:215], v[232:235], v[100:103]
 ds_read_b64_tr_b16 a[182:183], v46 offset:55296
 v_mul_f32 v93, v93, v64
 v_mfma_f32_16x16x32_bf16 v[100:103], a[216:219], v[240:243], v[100:103]
 s_add_u32 m0, s29, 114688
 ds_read_b64_tr_b16 a[184:185], v46 offset:57344
 v_mul_f32 v94, v94, v64
 v_mfma_f32_16x16x32_bf16 v[100:103], a[220:223], v[248:251], v[100:103]
 s_waitcnt lgkmcnt(7)
 ds_read_b64_tr_b16 a[186:187], v46 offset:59392
 v_mul_f32 v95, v95, v64
 v_mfma_f32_16x16x32_bf16 v[104:107], a[160:163], v[128:131], 0
 ds_read_b64_tr_b16 a[188:189], v46 offset:61440
 buffer_load_dwordx4 v2, s[8:11], s82 offen lds
 v_mfma_f32_16x16x32_bf16 v[104:107], a[164:167], v[136:139], v[104:107]
 ds_read_b64_tr_b16 a[190:191], v46 offset:63488
 v_cvt_pk_bf16_f32 v88, v88, v89
 v_mfma_f32_16x16x32_bf16 v[104:107], a[168:171], v[144:147], v[104:107]
 s_waitcnt lgkmcnt(4)
 ds_read_b64_tr_b16 a[192:193], v47 offset:32768
 v_cvt_pk_bf16_f32 v89, v90, v91
 v_mfma_f32_16x16x32_bf16 v[104:107], a[172:175], v[152:155], v[104:107]
 ds_read_b64_tr_b16 a[194:195], v47 offset:34816
 v_cvt_pk_bf16_f32 v90, v92, v93
 v_mfma_f32_16x16x32_bf16 v[104:107], a[176:179], v[160:163], v[104:107]
 s_add_u32 s58, s48, 69632
 ds_read_b64_tr_b16 a[196:197], v47 offset:36864
 v_cvt_pk_bf16_f32 v91, v94, v95
 v_mfma_f32_16x16x32_bf16 v[104:107], a[180:183], v[168:171], v[104:107]
 s_waitcnt lgkmcnt(3)
 ds_read_b64_tr_b16 a[198:199], v47 offset:38912
 buffer_store_dwordx4 v[88:91], v1, s[12:15], s58 offen sc1
 v_mfma_f32_16x16x32_bf16 v[104:107], a[184:187], v[176:179], v[104:107]
 s_add_u32 m0, s29, 118784
 ds_read_b64_tr_b16 a[200:201], v47 offset:40960
 v_mul_f32 v100, v100, v65
 v_mfma_f32_16x16x32_bf16 v[104:107], a[188:191], v[184:187], v[104:107]
 ds_read_b64_tr_b16 a[202:203], v47 offset:43008
 buffer_load_dwordx4 v2, s[8:11], s83 offen lds
 v_mfma_f32_16x16x32_bf16 v[112:115], a[160:163], v[192:195], 0
 ds_read_b64_tr_b16 a[204:205], v47 offset:45056
 v_mul_f32 v101, v101, v65
 v_mfma_f32_16x16x32_bf16 v[112:115], a[164:167], v[200:203], v[112:115]
 ds_read_b64_tr_b16 a[206:207], v47 offset:47104
 v_mul_f32 v102, v102, v65
 v_mfma_f32_16x16x32_bf16 v[112:115], a[168:171], v[208:211], v[112:115]
 ds_read_b64_tr_b16 a[208:209], v47 offset:49152
 v_mul_f32 v103, v103, v65
 v_mfma_f32_16x16x32_bf16 v[112:115], a[172:175], v[216:219], v[112:115]
 ds_read_b64_tr_b16 a[210:211], v47 offset:51200
 v_cvt_pk_bf16_f32 v96, v96, v97
 v_mfma_f32_16x16x32_bf16 v[112:115], a[176:179], v[224:227], v[112:115]
 ds_read_b64_tr_b16 a[212:213], v47 offset:53248
 v_cvt_pk_bf16_f32 v97, v98, v99
 v_mfma_f32_16x16x32_bf16 v[112:115], a[180:183], v[232:235], v[112:115]
 s_add_u32 m0, s29, 122880
 ds_read_b64_tr_b16 a[214:215], v47 offset:55296
 v_cvt_pk_bf16_f32 v98, v100, v101
 v_mfma_f32_16x16x32_bf16 v[112:115], a[184:187], v[240:243], v[112:115]
 ds_read_b64_tr_b16 a[216:217], v47 offset:57344
 buffer_load_dwordx4 v2, s[8:11], s84 offen lds
 v_mfma_f32_16x16x32_bf16 v[112:115], a[188:191], v[248:251], v[112:115]
 s_waitcnt lgkmcnt(7)
 ds_read_b64_tr_b16 a[218:219], v47 offset:59392
 v_cvt_pk_bf16_f32 v99, v102, v103
 v_mfma_f32_16x16x32_bf16 v[108:111], a[192:195], v[128:131], 0
 s_waitcnt vmcnt(11)
 ds_read_b64_tr_b16 a[220:221], v47 offset:61440
 v_mul_f32 v104, v104, v64
 v_mfma_f32_16x16x32_bf16 v[108:111], a[196:199], v[136:139], v[108:111]
 s_barrier
 ds_read_b64_tr_b16 a[222:223], v47 offset:63488
 v_xor_b32 v44, 0x10000, v44
 v_mfma_f32_16x16x32_bf16 v[108:111], a[200:203], v[144:147], v[108:111]
 s_waitcnt lgkmcnt(4)
 ds_read_b64_tr_b16 a[160:161], v44 offset:0
 v_mul_f32 v105, v105, v64
 v_mfma_f32_16x16x32_bf16 v[108:111], a[204:207], v[152:155], v[108:111]
 ds_read_b64_tr_b16 a[162:163], v44 offset:2048
 v_mul_f32 v106, v106, v64
 v_mfma_f32_16x16x32_bf16 v[108:111], a[208:211], v[160:163], v[108:111]
 s_add_u32 m0, s29, 126976
 ds_read_b64_tr_b16 a[164:165], v44 offset:4096
 v_mul_f32 v107, v107, v64
 v_mfma_f32_16x16x32_bf16 v[108:111], a[212:215], v[168:171], v[108:111]
 s_waitcnt lgkmcnt(3)
 ds_read_b64_tr_b16 a[166:167], v44 offset:6144
 buffer_load_dwordx4 v2, s[8:11], s85 offen lds
 v_mfma_f32_16x16x32_bf16 v[108:111], a[216:219], v[176:179], v[108:111]
 s_add_u32 s58, s48, 1044480
 ds_read_b64_tr_b16 a[168:169], v44 offset:8192
 v_add_u32 v2, 128, v2
 v_mfma_f32_16x16x32_bf16 v[108:111], a[220:223], v[184:187], v[108:111]
 ds_read_b64_tr_b16 a[170:171], v44 offset:10240
 buffer_store_dwordx4 v[96:99], v1, s[12:15], s58 offen sc1
 v_mfma_f32_16x16x32_bf16 v[116:119], a[192:195], v[192:195], 0
 ds_read_b64_tr_b16 a[172:173], v44 offset:12288
 v_mul_f32 v112, v112, v65
 v_mfma_f32_16x16x32_bf16 v[116:119], a[196:199], v[200:203], v[116:119]
 ds_read_b64_tr_b16 a[174:175], v44 offset:14336
 v_mul_f32 v113, v113, v65
 v_mfma_f32_16x16x32_bf16 v[116:119], a[200:203], v[208:211], v[116:119]
 ds_read_b64_tr_b16 a[176:177], v44 offset:16384
 v_mul_f32 v114, v114, v65
 v_mfma_f32_16x16x32_bf16 v[116:119], a[204:207], v[216:219], v[116:119]
 ds_read_b64_tr_b16 a[178:179], v44 offset:18432
 v_mul_f32 v115, v115, v65
 v_mfma_f32_16x16x32_bf16 v[116:119], a[208:211], v[224:227], v[116:119]
 ds_read_b64_tr_b16 a[180:181], v44 offset:20480
 v_mul_f32 v108, v108, v64
 v_mfma_f32_16x16x32_bf16 v[116:119], a[212:215], v[232:235], v[116:119]
 ds_read_b64_tr_b16 a[182:183], v44 offset:22528
 v_mul_f32 v109, v109, v64
 v_mfma_f32_16x16x32_bf16 v[116:119], a[216:219], v[240:243], v[116:119]
 ds_read_b64_tr_b16 a[184:185], v44 offset:24576
 v_mul_f32 v110, v110, v64
 v_mfma_f32_16x16x32_bf16 v[116:119], a[220:223], v[248:251], v[116:119]
 s_waitcnt lgkmcnt(7)
 ds_read_b64_tr_b16 a[186:187], v44 offset:26624
 v_mul_f32 v111, v111, v64
 v_mfma_f32_16x16x32_bf16 v[72:75], a[160:163], v[128:131], 0
 ds_read_b64_tr_b16 a[188:189], v44 offset:28672
 v_cvt_pk_bf16_f32 v104, v104, v105
 v_mfma_f32_16x16x32_bf16 v[72:75], a[164:167], v[136:139], v[72:75]
 ds_read_b64_tr_b16 a[190:191], v44 offset:30720
 v_xor_b32 v45, 0x10000, v45
 v_mfma_f32_16x16x32_bf16 v[72:75], a[168:171], v[144:147], v[72:75]
 s_waitcnt lgkmcnt(4)
 ds_read_b64_tr_b16 a[192:193], v45 offset:0
 v_cvt_pk_bf16_f32 v105, v106, v107
 v_mfma_f32_16x16x32_bf16 v[72:75], a[172:175], v[152:155], v[72:75]
 s_add_u32 m0, s29, 131072
 ds_read_b64_tr_b16 a[194:195], v45 offset:2048
 v_cvt_pk_bf16_f32 v106, v108, v109
 v_mfma_f32_16x16x32_bf16 v[72:75], a[176:179], v[160:163], v[72:75]
 ds_read_b64_tr_b16 a[196:197], v45 offset:4096
 buffer_load_dwordx4 v2, s[8:11], s78 offen lds
 v_mfma_f32_16x16x32_bf16 v[72:75], a[180:183], v[168:171], v[72:75]
 s_waitcnt lgkmcnt(3)
 ds_read_b64_tr_b16 a[198:199], v45 offset:6144
 v_cvt_pk_bf16_f32 v107, v110, v111
 v_mfma_f32_16x16x32_bf16 v[72:75], a[184:187], v[176:179], v[72:75]
 s_add_u32 s58, s48, 87040
 ds_read_b64_tr_b16 a[200:201], v45 offset:8192
 v_mul_f32 v116, v116, v65
 v_mfma_f32_16x16x32_bf16 v[72:75], a[188:191], v[184:187], v[72:75]
 ds_read_b64_tr_b16 a[202:203], v45 offset:10240
 buffer_store_dwordx4 v[104:107], v1, s[12:15], s58 offen sc1
 v_mfma_f32_16x16x32_bf16 v[80:83], a[160:163], v[192:195], 0
 ds_read_b64_tr_b16 a[204:205], v45 offset:12288
 v_mul_f32 v117, v117, v65
 v_mfma_f32_16x16x32_bf16 v[80:83], a[164:167], v[200:203], v[80:83]
 ds_read_b64_tr_b16 a[206:207], v45 offset:14336
 v_mul_f32 v118, v118, v65
 v_mfma_f32_16x16x32_bf16 v[80:83], a[168:171], v[208:211], v[80:83]
 s_add_u32 m0, s29, 135168
 ds_read_b64_tr_b16 a[208:209], v45 offset:16384
 v_mul_f32 v119, v119, v65
 v_mfma_f32_16x16x32_bf16 v[80:83], a[172:175], v[216:219], v[80:83]
 ds_read_b64_tr_b16 a[210:211], v45 offset:18432
 buffer_load_dwordx4 v2, s[8:11], s79 offen lds
 v_mfma_f32_16x16x32_bf16 v[80:83], a[176:179], v[224:227], v[80:83]
 ds_read_b64_tr_b16 a[212:213], v45 offset:20480
 v_cvt_pk_bf16_f32 v112, v112, v113
 v_mfma_f32_16x16x32_bf16 v[80:83], a[180:183], v[232:235], v[80:83]
 ds_read_b64_tr_b16 a[214:215], v45 offset:22528
 v_cvt_pk_bf16_f32 v113, v114, v115
 v_mfma_f32_16x16x32_bf16 v[80:83], a[184:187], v[240:243], v[80:83]
 s_add_u32 s58, s48, 1061888
 ds_read_b64_tr_b16 a[216:217], v45 offset:24576
 v_cvt_pk_bf16_f32 v114, v116, v117
 v_mfma_f32_16x16x32_bf16 v[80:83], a[188:191], v[248:251], v[80:83]
 s_waitcnt lgkmcnt(7)
 ds_read_b64_tr_b16 a[218:219], v45 offset:26624
 v_cvt_pk_bf16_f32 v115, v118, v119
 v_mfma_f32_16x16x32_bf16 v[76:79], a[192:195], v[128:131], 0
 ds_read_b64_tr_b16 a[220:221], v45 offset:28672
 buffer_store_dwordx4 v[112:115], v1, s[12:15], s58 offen sc1
 v_mfma_f32_16x16x32_bf16 v[76:79], a[196:199], v[136:139], v[76:79]
 s_add_u32 m0, s29, 139264
 ds_read_b64_tr_b16 a[222:223], v45 offset:30720
 v_xor_b32 v46, 0x10000, v46
 v_mfma_f32_16x16x32_bf16 v[76:79], a[200:203], v[144:147], v[76:79]
 s_waitcnt lgkmcnt(4)
 ds_read_b64_tr_b16 a[160:161], v46 offset:0
 buffer_load_dwordx4 v2, s[8:11], s80 offen lds
 v_mfma_f32_16x16x32_bf16 v[76:79], a[204:207], v[152:155], v[76:79]
 ds_read_b64_tr_b16 a[162:163], v46 offset:2048
 v_mul_f32 v72, v72, v64
 v_mfma_f32_16x16x32_bf16 v[76:79], a[208:211], v[160:163], v[76:79]
 ds_read_b64_tr_b16 a[164:165], v46 offset:4096
 v_mul_f32 v73, v73, v64
 v_mfma_f32_16x16x32_bf16 v[76:79], a[212:215], v[168:171], v[76:79]
 s_waitcnt lgkmcnt(3)
 ds_read_b64_tr_b16 a[166:167], v46 offset:6144
 v_mul_f32 v74, v74, v64
 v_mfma_f32_16x16x32_bf16 v[76:79], a[216:219], v[176:179], v[76:79]
 ds_read_b64_tr_b16 a[168:169], v46 offset:8192
 v_mul_f32 v75, v75, v64
 v_mfma_f32_16x16x32_bf16 v[76:79], a[220:223], v[184:187], v[76:79]
 ds_read_b64_tr_b16 a[170:171], v46 offset:10240
 v_mul_f32 v80, v80, v65
 v_mfma_f32_16x16x32_bf16 v[84:87], a[192:195], v[192:195], 0
 s_add_u32 m0, s29, 143360
 ds_read_b64_tr_b16 a[172:173], v46 offset:12288
 v_mul_f32 v81, v81, v65
 v_mfma_f32_16x16x32_bf16 v[84:87], a[196:199], v[200:203], v[84:87]
 ds_read_b64_tr_b16 a[174:175], v46 offset:14336
 buffer_load_dwordx4 v2, s[8:11], s81 offen lds
 v_mfma_f32_16x16x32_bf16 v[84:87], a[200:203], v[208:211], v[84:87]
 ds_read_b64_tr_b16 a[176:177], v46 offset:16384
 v_mul_f32 v82, v82, v65
 v_mfma_f32_16x16x32_bf16 v[84:87], a[204:207], v[216:219], v[84:87]
 ds_read_b64_tr_b16 a[178:179], v46 offset:18432
 v_mul_f32 v83, v83, v65
 v_mfma_f32_16x16x32_bf16 v[84:87], a[208:211], v[224:227], v[84:87]
 ds_read_b64_tr_b16 a[180:181], v46 offset:20480
 v_mul_f32 v76, v76, v64
 v_mfma_f32_16x16x32_bf16 v[84:87], a[212:215], v[232:235], v[84:87]
 ds_read_b64_tr_b16 a[182:183], v46 offset:22528
 v_mul_f32 v77, v77, v64
 v_mfma_f32_16x16x32_bf16 v[84:87], a[216:219], v[240:243], v[84:87]
 s_add_u32 m0, s29, 147456
 ds_read_b64_tr_b16 a[184:185], v46 offset:24576
 v_mul_f32 v78, v78, v64
 v_mfma_f32_16x16x32_bf16 v[84:87], a[220:223], v[248:251], v[84:87]
 s_waitcnt lgkmcnt(7)
 ds_read_b64_tr_b16 a[186:187], v46 offset:26624
 v_mul_f32 v79, v79, v64
 v_mfma_f32_16x16x32_bf16 v[88:91], a[160:163], v[128:131], 0
 ds_read_b64_tr_b16 a[188:189], v46 offset:28672
 buffer_load_dwordx4 v2, s[8:11], s82 offen lds
 v_mfma_f32_16x16x32_bf16 v[88:91], a[164:167], v[136:139], v[88:91]
 ds_read_b64_tr_b16 a[190:191], v46 offset:30720
 v_xor_b32 v47, 0x10000, v47
 v_mfma_f32_16x16x32_bf16 v[88:91], a[168:171], v[144:147], v[88:91]
 s_waitcnt lgkmcnt(4)
 ds_read_b64_tr_b16 a[192:193], v47 offset:0
 v_cvt_pk_bf16_f32 v72, v72, v73
 v_mfma_f32_16x16x32_bf16 v[88:91], a[172:175], v[152:155], v[88:91]
 ds_read_b64_tr_b16 a[194:195], v47 offset:2048
 v_cvt_pk_bf16_f32 v73, v74, v75
 v_mfma_f32_16x16x32_bf16 v[88:91], a[176:179], v[160:163], v[88:91]
 ds_read_b64_tr_b16 a[196:197], v47 offset:4096
 v_cvt_pk_bf16_f32 v74, v76, v77
 v_mfma_f32_16x16x32_bf16 v[88:91], a[180:183], v[168:171], v[88:91]
 s_waitcnt lgkmcnt(3)
 ds_read_b64_tr_b16 a[198:199], v47 offset:6144
 v_cvt_pk_bf16_f32 v75, v78, v79
 v_mfma_f32_16x16x32_bf16 v[88:91], a[184:187], v[176:179], v[88:91]
 s_add_u32 m0, s29, 151552
 ds_read_b64_tr_b16 a[200:201], v47 offset:8192
 v_mul_f32 v84, v84, v65
 v_mfma_f32_16x16x32_bf16 v[88:91], a[188:191], v[184:187], v[88:91]
 ds_read_b64_tr_b16 a[202:203], v47 offset:10240
 buffer_load_dwordx4 v2, s[8:11], s83 offen lds
 v_mfma_f32_16x16x32_bf16 v[96:99], a[160:163], v[192:195], 0
 s_add_u32 s58, s48, 104448
 ds_read_b64_tr_b16 a[204:205], v47 offset:12288
 v_mul_f32 v85, v85, v65
 v_mfma_f32_16x16x32_bf16 v[96:99], a[164:167], v[200:203], v[96:99]
 ds_read_b64_tr_b16 a[206:207], v47 offset:14336
 buffer_store_dwordx4 v[72:75], v1, s[12:15], s58 offen sc1
 v_mfma_f32_16x16x32_bf16 v[96:99], a[168:171], v[208:211], v[96:99]
 ds_read_b64_tr_b16 a[208:209], v47 offset:16384
 v_mul_f32 v86, v86, v65
 v_mfma_f32_16x16x32_bf16 v[96:99], a[172:175], v[216:219], v[96:99]
 ds_read_b64_tr_b16 a[210:211], v47 offset:18432
 v_mul_f32 v87, v87, v65
 v_mfma_f32_16x16x32_bf16 v[96:99], a[176:179], v[224:227], v[96:99]
 ds_read_b64_tr_b16 a[212:213], v47 offset:20480
 v_cvt_pk_bf16_f32 v80, v80, v81
 v_mfma_f32_16x16x32_bf16 v[96:99], a[180:183], v[232:235], v[96:99]
 s_add_u32 m0, s29, 155648
 ds_read_b64_tr_b16 a[214:215], v47 offset:22528
 v_cvt_pk_bf16_f32 v81, v82, v83
 v_mfma_f32_16x16x32_bf16 v[96:99], a[184:187], v[240:243], v[96:99]
 ds_read_b64_tr_b16 a[216:217], v47 offset:24576
 buffer_load_dwordx4 v2, s[8:11], s84 offen lds
 v_mfma_f32_16x16x32_bf16 v[96:99], a[188:191], v[248:251], v[96:99]
 s_waitcnt lgkmcnt(7)
 ds_read_b64_tr_b16 a[218:219], v47 offset:26624
 v_cvt_pk_bf16_f32 v82, v84, v85
 v_mfma_f32_16x16x32_bf16 v[92:95], a[192:195], v[128:131], 0
 s_waitcnt vmcnt(11)
 ds_read_b64_tr_b16 a[220:221], v47 offset:28672
 v_cvt_pk_bf16_f32 v83, v86, v87
 v_mfma_f32_16x16x32_bf16 v[92:95], a[196:199], v[136:139], v[92:95]
 s_barrier
 ds_read_b64_tr_b16 a[222:223], v47 offset:30720
 v_mul_f32 v88, v88, v64
 v_mfma_f32_16x16x32_bf16 v[92:95], a[200:203], v[144:147], v[92:95]
 s_waitcnt lgkmcnt(4)
 ds_read_b64_tr_b16 a[160:161], v44 offset:32768
 v_mul_f32 v89, v89, v64
 v_mfma_f32_16x16x32_bf16 v[92:95], a[204:207], v[152:155], v[92:95]
 ds_read_b64_tr_b16 a[162:163], v44 offset:34816
 v_mul_f32 v90, v90, v64
 v_mfma_f32_16x16x32_bf16 v[92:95], a[208:211], v[160:163], v[92:95]
 s_add_u32 m0, s29, 159744
 ds_read_b64_tr_b16 a[164:165], v44 offset:36864
 v_mul_f32 v91, v91, v64
 v_mfma_f32_16x16x32_bf16 v[92:95], a[212:215], v[168:171], v[92:95]
 s_waitcnt lgkmcnt(3)
 ds_read_b64_tr_b16 a[166:167], v44 offset:38912
 buffer_load_dwordx4 v2, s[8:11], s85 offen lds
 v_mfma_f32_16x16x32_bf16 v[92:95], a[216:219], v[176:179], v[92:95]
 s_add_u32 s58, s48, 1079296
 ds_read_b64_tr_b16 a[168:169], v44 offset:40960
 v_add_u32 v2, 128, v2
 v_mfma_f32_16x16x32_bf16 v[92:95], a[220:223], v[184:187], v[92:95]
 ds_read_b64_tr_b16 a[170:171], v44 offset:43008
 buffer_store_dwordx4 v[80:83], v1, s[12:15], s58 offen sc1
 v_mfma_f32_16x16x32_bf16 v[100:103], a[192:195], v[192:195], 0
 ds_read_b64_tr_b16 a[172:173], v44 offset:45056
 v_mul_f32 v96, v96, v65
 v_mfma_f32_16x16x32_bf16 v[100:103], a[196:199], v[200:203], v[100:103]
 ds_read_b64_tr_b16 a[174:175], v44 offset:47104
 v_mul_f32 v97, v97, v65
 v_mfma_f32_16x16x32_bf16 v[100:103], a[200:203], v[208:211], v[100:103]
 ds_read_b64_tr_b16 a[176:177], v44 offset:49152
 v_mul_f32 v98, v98, v65
 v_mfma_f32_16x16x32_bf16 v[100:103], a[204:207], v[216:219], v[100:103]
 ds_read_b64_tr_b16 a[178:179], v44 offset:51200
 v_mul_f32 v99, v99, v65
 v_mfma_f32_16x16x32_bf16 v[100:103], a[208:211], v[224:227], v[100:103]
 ds_read_b64_tr_b16 a[180:181], v44 offset:53248
 v_mul_f32 v92, v92, v64
 v_mfma_f32_16x16x32_bf16 v[100:103], a[212:215], v[232:235], v[100:103]
 ds_read_b64_tr_b16 a[182:183], v44 offset:55296
 v_mul_f32 v93, v93, v64
 v_mfma_f32_16x16x32_bf16 v[100:103], a[216:219], v[240:243], v[100:103]
 ds_read_b64_tr_b16 a[184:185], v44 offset:57344
 v_mul_f32 v94, v94, v64
 v_mfma_f32_16x16x32_bf16 v[100:103], a[220:223], v[248:251], v[100:103]
 s_waitcnt lgkmcnt(7)
 ds_read_b64_tr_b16 a[186:187], v44 offset:59392
 v_mul_f32 v95, v95, v64
 v_mfma_f32_16x16x32_bf16 v[104:107], a[160:163], v[128:131], 0
 ds_read_b64_tr_b16 a[188:189], v44 offset:61440
 v_cvt_pk_bf16_f32 v88, v88, v89
 v_mfma_f32_16x16x32_bf16 v[104:107], a[164:167], v[136:139], v[104:107]
 ds_read_b64_tr_b16 a[190:191], v44 offset:63488
 v_cvt_pk_bf16_f32 v89, v90, v91
 v_mfma_f32_16x16x32_bf16 v[104:107], a[168:171], v[144:147], v[104:107]
 s_waitcnt lgkmcnt(4)
 ds_read_b64_tr_b16 a[192:193], v45 offset:32768
 v_cvt_pk_bf16_f32 v90, v92, v93
 v_mfma_f32_16x16x32_bf16 v[104:107], a[172:175], v[152:155], v[104:107]
 s_add_u32 m0, s29, 0
 ds_read_b64_tr_b16 a[194:195], v45 offset:34816
 v_cvt_pk_bf16_f32 v91, v94, v95
 v_mfma_f32_16x16x32_bf16 v[104:107], a[176:179], v[160:163], v[104:107]
 ds_read_b64_tr_b16 a[196:197], v45 offset:36864
 buffer_load_dwordx4 v2, s[8:11], s78 offen lds
 v_mfma_f32_16x16x32_bf16 v[104:107], a[180:183], v[168:171], v[104:107]
 s_waitcnt lgkmcnt(3)
 ds_read_b64_tr_b16 a[198:199], v45 offset:38912
 v_mul_f32 v100, v100, v65
 v_mfma_f32_16x16x32_bf16 v[104:107], a[184:187], v[176:179], v[104:107]
 s_add_u32 s58, s48, 121856
 ds_read_b64_tr_b16 a[200:201], v45 offset:40960
 v_mul_f32 v101, v101, v65
 v_mfma_f32_16x16x32_bf16 v[104:107], a[188:191], v[184:187], v[104:107]
 ds_read_b64_tr_b16 a[202:203], v45 offset:43008
 buffer_store_dwordx4 v[88:91], v1, s[12:15], s58 offen sc1
 v_mfma_f32_16x16x32_bf16 v[112:115], a[160:163], v[192:195], 0
 ds_read_b64_tr_b16 a[204:205], v45 offset:45056
 v_mul_f32 v102, v102, v65
 v_mfma_f32_16x16x32_bf16 v[112:115], a[164:167], v[200:203], v[112:115]
 ds_read_b64_tr_b16 a[206:207], v45 offset:47104
 v_mul_f32 v103, v103, v65
 v_mfma_f32_16x16x32_bf16 v[112:115], a[168:171], v[208:211], v[112:115]
 s_add_u32 m0, s29, 4096
 ds_read_b64_tr_b16 a[208:209], v45 offset:49152
 v_cvt_pk_bf16_f32 v96, v96, v97
 v_mfma_f32_16x16x32_bf16 v[112:115], a[172:175], v[216:219], v[112:115]
 ds_read_b64_tr_b16 a[210:211], v45 offset:51200
 buffer_load_dwordx4 v2, s[8:11], s79 offen lds
 v_mfma_f32_16x16x32_bf16 v[112:115], a[176:179], v[224:227], v[112:115]
 ds_read_b64_tr_b16 a[212:213], v45 offset:53248
 v_cvt_pk_bf16_f32 v97, v98, v99
 v_mfma_f32_16x16x32_bf16 v[112:115], a[180:183], v[232:235], v[112:115]
 ds_read_b64_tr_b16 a[214:215], v45 offset:55296
 v_cvt_pk_bf16_f32 v98, v100, v101
 v_mfma_f32_16x16x32_bf16 v[112:115], a[184:187], v[240:243], v[112:115]
 s_add_u32 s58, s48, 1096704
 ds_read_b64_tr_b16 a[216:217], v45 offset:57344
 v_cvt_pk_bf16_f32 v99, v102, v103
 v_mfma_f32_16x16x32_bf16 v[112:115], a[188:191], v[248:251], v[112:115]
 s_waitcnt lgkmcnt(7)
 ds_read_b64_tr_b16 a[218:219], v45 offset:59392
 buffer_store_dwordx4 v[96:99], v1, s[12:15], s58 offen sc1
 v_mfma_f32_16x16x32_bf16 v[108:111], a[192:195], v[128:131], 0
 ds_read_b64_tr_b16 a[220:221], v45 offset:61440
 v_mul_f32 v104, v104, v64
 v_mfma_f32_16x16x32_bf16 v[108:111], a[196:199], v[136:139], v[108:111]
 s_add_u32 m0, s29, 8192
 ds_read_b64_tr_b16 a[222:223], v45 offset:63488
 v_mul_f32 v105, v105, v64
 v_mfma_f32_16x16x32_bf16 v[108:111], a[200:203], v[144:147], v[108:111]
 s_waitcnt lgkmcnt(4)
 ds_read_b64_tr_b16 a[160:161], v46 offset:32768
 buffer_load_dwordx4 v2, s[8:11], s80 offen lds
 v_mfma_f32_16x16x32_bf16 v[108:111], a[204:207], v[152:155], v[108:111]
 ds_read_b64_tr_b16 a[162:163], v46 offset:34816
 v_mul_f32 v106, v106, v64
 v_mfma_f32_16x16x32_bf16 v[108:111], a[208:211], v[160:163], v[108:111]
 ds_read_b64_tr_b16 a[164:165], v46 offset:36864
 v_mul_f32 v107, v107, v64
 v_mfma_f32_16x16x32_bf16 v[108:111], a[212:215], v[168:171], v[108:111]
 s_waitcnt lgkmcnt(3)
 ds_read_b64_tr_b16 a[166:167], v46 offset:38912
 v_mul_f32 v112, v112, v65
 v_mfma_f32_16x16x32_bf16 v[108:111], a[216:219], v[176:179], v[108:111]
 ds_read_b64_tr_b16 a[168:169], v46 offset:40960
 v_mul_f32 v113, v113, v65
 v_mfma_f32_16x16x32_bf16 v[108:111], a[220:223], v[184:187], v[108:111]
 ds_read_b64_tr_b16 a[170:171], v46 offset:43008
 v_mul_f32 v114, v114, v65
 v_mfma_f32_16x16x32_bf16 v[116:119], a[192:195], v[192:195], 0
 s_add_u32 m0, s29, 12288
 ds_read_b64_tr_b16 a[172:173], v46 offset:45056
 v_mul_f32 v115, v115, v65
 v_mfma_f32_16x16x32_bf16 v[116:119], a[196:199], v[200:203], v[116:119]
 ds_read_b64_tr_b16 a[174:175], v46 offset:47104
 buffer_load_dwordx4 v2, s[8:11], s81 offen lds
 v_mfma_f32_16x16x32_bf16 v[116:119], a[200:203], v[208:211], v[116:119]
 ds_read_b64_tr_b16 a[176:177], v46 offset:49152
 v_mfma_f32_16x16x32_bf16 v[116:119], a[204:207], v[216:219], v[116:119]
 ds_read_b64_tr_b16 a[178:179], v46 offset:51200
 v_mfma_f32_16x16x32_bf16 v[116:119], a[208:211], v[224:227], v[116:119]
 ds_read_b64_tr_b16 a[180:181], v46 offset:53248
 v_mul_f32 v108, v108, v64
 v_mfma_f32_16x16x32_bf16 v[116:119], a[212:215], v[232:235], v[116:119]
 ds_read_b64_tr_b16 a[182:183], v46 offset:55296
 v_mul_f32 v109, v109, v64
 v_mfma_f32_16x16x32_bf16 v[116:119], a[216:219], v[240:243], v[116:119]
 s_add_u32 m0, s29, 16384
 ds_read_b64_tr_b16 a[184:185], v46 offset:57344
 v_mul_f32 v110, v110, v64
 v_mfma_f32_16x16x32_bf16 v[116:119], a[220:223], v[248:251], v[116:119]
 s_waitcnt lgkmcnt(7)
 ds_read_b64_tr_b16 a[186:187], v46 offset:59392
 v_mul_f32 v111, v111, v64
 v_mfma_f32_16x16x32_bf16 v[72:75], a[160:163], v[128:131], 0
 ds_read_b64_tr_b16 a[188:189], v46 offset:61440
 buffer_load_dwordx4 v2, s[8:11], s82 offen lds
 v_mfma_f32_16x16x32_bf16 v[72:75], a[164:167], v[136:139], v[72:75]
 ds_read_b64_tr_b16 a[190:191], v46 offset:63488
 v_cvt_pk_bf16_f32 v104, v104, v105
 v_mfma_f32_16x16x32_bf16 v[72:75], a[168:171], v[144:147], v[72:75]
 s_waitcnt lgkmcnt(4)
 ds_read_b64_tr_b16 a[192:193], v47 offset:32768
 v_cvt_pk_bf16_f32 v105, v106, v107
 v_mfma_f32_16x16x32_bf16 v[72:75], a[172:175], v[152:155], v[72:75]
 ds_read_b64_tr_b16 a[194:195], v47 offset:34816
 v_cvt_pk_bf16_f32 v106, v108, v109
 v_mfma_f32_16x16x32_bf16 v[72:75], a[176:179], v[160:163], v[72:75]
 s_add_u32 s58, s48, 139264
 ds_read_b64_tr_b16 a[196:197], v47 offset:36864
 v_cvt_pk_bf16_f32 v107, v110, v111
 v_mfma_f32_16x16x32_bf16 v[72:75], a[180:183], v[168:171], v[72:75]
 s_waitcnt lgkmcnt(3)
 ds_read_b64_tr_b16 a[198:199], v47 offset:38912
 buffer_store_dwordx4 v[104:107], v1, s[12:15], s58 offen sc1
 v_mfma_f32_16x16x32_bf16 v[72:75], a[184:187], v[176:179], v[72:75]
 s_add_u32 m0, s29, 20480
 ds_read_b64_tr_b16 a[200:201], v47 offset:40960
 v_mul_f32 v116, v116, v65
 v_mfma_f32_16x16x32_bf16 v[72:75], a[188:191], v[184:187], v[72:75]
 ds_read_b64_tr_b16 a[202:203], v47 offset:43008
 buffer_load_dwordx4 v2, s[8:11], s83 offen lds
 v_mfma_f32_16x16x32_bf16 v[80:83], a[160:163], v[192:195], 0
 ds_read_b64_tr_b16 a[204:205], v47 offset:45056
 v_mul_f32 v117, v117, v65
 v_mfma_f32_16x16x32_bf16 v[80:83], a[164:167], v[200:203], v[80:83]
 ds_read_b64_tr_b16 a[206:207], v47 offset:47104
 v_mul_f32 v118, v118, v65
 v_mfma_f32_16x16x32_bf16 v[80:83], a[168:171], v[208:211], v[80:83]
 ds_read_b64_tr_b16 a[208:209], v47 offset:49152
 v_mul_f32 v119, v119, v65
 v_mfma_f32_16x16x32_bf16 v[80:83], a[172:175], v[216:219], v[80:83]
 ds_read_b64_tr_b16 a[210:211], v47 offset:51200
 v_cvt_pk_bf16_f32 v112, v112, v113
 v_mfma_f32_16x16x32_bf16 v[80:83], a[176:179], v[224:227], v[80:83]
 ds_read_b64_tr_b16 a[212:213], v47 offset:53248
 v_cvt_pk_bf16_f32 v113, v114, v115
 v_mfma_f32_16x16x32_bf16 v[80:83], a[180:183], v[232:235], v[80:83]
 s_add_u32 m0, s29, 24576
 ds_read_b64_tr_b16 a[214:215], v47 offset:55296
 v_cvt_pk_bf16_f32 v114, v116, v117
 v_mfma_f32_16x16x32_bf16 v[80:83], a[184:187], v[240:243], v[80:83]
 ds_read_b64_tr_b16 a[216:217], v47 offset:57344
 buffer_load_dwordx4 v2, s[8:11], s84 offen lds
 v_mfma_f32_16x16x32_bf16 v[80:83], a[188:191], v[248:251], v[80:83]
 s_waitcnt lgkmcnt(7)
 ds_read_b64_tr_b16 a[218:219], v47 offset:59392
 v_cvt_pk_bf16_f32 v115, v118, v119
 v_mfma_f32_16x16x32_bf16 v[76:79], a[192:195], v[128:131], 0
 s_waitcnt vmcnt(10)
 ds_read_b64_tr_b16 a[220:221], v47 offset:61440
 v_mul_f32 v72, v72, v64
 v_mfma_f32_16x16x32_bf16 v[76:79], a[196:199], v[136:139], v[76:79]
 s_barrier
 ds_read_b64_tr_b16 a[222:223], v47 offset:63488
 v_xor_b32 v44, 0x30000, v44
 v_mfma_f32_16x16x32_bf16 v[76:79], a[200:203], v[144:147], v[76:79]
 s_waitcnt lgkmcnt(4)
 ds_read_b64_tr_b16 a[160:161], v44 offset:0
 buffer_store_dword v9, v9, s[12:15], s93 offen offset:64 sc1
 v_mfma_f32_16x16x32_bf16 v[76:79], a[204:207], v[152:155], v[76:79]
 ds_read_b64_tr_b16 a[162:163], v44 offset:2048
 v_mul_f32 v73, v73, v64
 v_mfma_f32_16x16x32_bf16 v[76:79], a[208:211], v[160:163], v[76:79]
 s_add_u32 m0, s29, 28672
 ds_read_b64_tr_b16 a[164:165], v44 offset:4096
 v_mul_f32 v74, v74, v64
 v_mfma_f32_16x16x32_bf16 v[76:79], a[212:215], v[168:171], v[76:79]
 s_waitcnt lgkmcnt(3)
 ds_read_b64_tr_b16 a[166:167], v44 offset:6144
 buffer_load_dwordx4 v2, s[8:11], s85 offen lds
 v_mfma_f32_16x16x32_bf16 v[76:79], a[216:219], v[176:179], v[76:79]
 s_add_u32 s58, s48, 1114112
 ds_read_b64_tr_b16 a[168:169], v44 offset:8192
 v_add_u32 v2, 128, v2
 v_mfma_f32_16x16x32_bf16 v[76:79], a[220:223], v[184:187], v[76:79]
 ds_read_b64_tr_b16 a[170:171], v44 offset:10240
 buffer_store_dwordx4 v[112:115], v1, s[12:15], s58 offen sc1
 v_mfma_f32_16x16x32_bf16 v[84:87], a[192:195], v[192:195], 0
 ds_read_b64_tr_b16 a[172:173], v44 offset:12288
 v_mul_f32 v75, v75, v64
 v_mfma_f32_16x16x32_bf16 v[84:87], a[196:199], v[200:203], v[84:87]
 ds_read_b64_tr_b16 a[174:175], v44 offset:14336
 v_mul_f32 v80, v80, v65
 v_mfma_f32_16x16x32_bf16 v[84:87], a[200:203], v[208:211], v[84:87]
 ds_read_b64_tr_b16 a[176:177], v44 offset:16384
 v_mul_f32 v81, v81, v65
 v_mfma_f32_16x16x32_bf16 v[84:87], a[204:207], v[216:219], v[84:87]
 ds_read_b64_tr_b16 a[178:179], v44 offset:18432
 v_mul_f32 v82, v82, v65
 v_mfma_f32_16x16x32_bf16 v[84:87], a[208:211], v[224:227], v[84:87]
 ds_read_b64_tr_b16 a[180:181], v44 offset:20480
 v_mul_f32 v76, v76, v64
 v_mfma_f32_16x16x32_bf16 v[84:87], a[212:215], v[232:235], v[84:87]
 ds_read_b64_tr_b16 a[182:183], v44 offset:22528
 v_mul_f32 v77, v77, v64
 v_mfma_f32_16x16x32_bf16 v[84:87], a[216:219], v[240:243], v[84:87]
 ds_read_b64_tr_b16 a[184:185], v44 offset:24576
 v_mul_f32 v78, v78, v64
 v_mfma_f32_16x16x32_bf16 v[84:87], a[220:223], v[248:251], v[84:87]
 s_waitcnt lgkmcnt(7)
 ds_read_b64_tr_b16 a[186:187], v44 offset:26624
 v_mul_f32 v79, v79, v64
 v_mfma_f32_16x16x32_bf16 v[88:91], a[160:163], v[128:131], 0
 ds_read_b64_tr_b16 a[188:189], v44 offset:28672
 v_cvt_pk_bf16_f32 v72, v72, v73
 v_mfma_f32_16x16x32_bf16 v[88:91], a[164:167], v[136:139], v[88:91]
 ds_read_b64_tr_b16 a[190:191], v44 offset:30720
 v_xor_b32 v45, 0x30000, v45
 v_mfma_f32_16x16x32_bf16 v[88:91], a[168:171], v[144:147], v[88:91]
 s_waitcnt lgkmcnt(4)
 ds_read_b64_tr_b16 a[192:193], v45 offset:0
 v_cvt_pk_bf16_f32 v73, v74, v75
 v_mfma_f32_16x16x32_bf16 v[88:91], a[172:175], v[152:155], v[88:91]
 ds_read_b64_tr_b16 a[194:195], v45 offset:2048
 v_cvt_pk_bf16_f32 v74, v76, v77
 v_mfma_f32_16x16x32_bf16 v[88:91], a[176:179], v[160:163], v[88:91]
 s_add_u32 s58, s48, 156672
 ds_read_b64_tr_b16 a[196:197], v45 offset:4096
 v_cvt_pk_bf16_f32 v75, v78, v79
 v_mfma_f32_16x16x32_bf16 v[88:91], a[180:183], v[168:171], v[88:91]
 s_waitcnt lgkmcnt(3)
 ds_read_b64_tr_b16 a[198:199], v45 offset:6144
 buffer_store_dwordx4 v[72:75], v1, s[12:15], s58 offen sc1
 v_mfma_f32_16x16x32_bf16 v[88:91], a[184:187], v[176:179], v[88:91]
 ds_read_b64_tr_b16 a[200:201], v45 offset:8192
 v_mul_f32 v83, v83, v65
 v_mfma_f32_16x16x32_bf16 v[88:91], a[188:191], v[184:187], v[88:91]
 ds_read_b64_tr_b16 a[202:203], v45 offset:10240
 v_mul_f32 v84, v84, v65
 v_mfma_f32_16x16x32_bf16 v[96:99], a[160:163], v[192:195], 0
 ds_read_b64_tr_b16 a[204:205], v45 offset:12288
 v_mul_f32 v85, v85, v65
 v_mfma_f32_16x16x32_bf16 v[96:99], a[164:167], v[200:203], v[96:99]
 ds_read_b64_tr_b16 a[206:207], v45 offset:14336
 v_mul_f32 v86, v86, v65
 v_mfma_f32_16x16x32_bf16 v[96:99], a[168:171], v[208:211], v[96:99]
 ds_read_b64_tr_b16 a[208:209], v45 offset:16384
 v_mul_f32 v87, v87, v65
 v_mfma_f32_16x16x32_bf16 v[96:99], a[172:175], v[216:219], v[96:99]
 ds_read_b64_tr_b16 a[210:211], v45 offset:18432
 v_cvt_pk_bf16_f32 v80, v80, v81
 v_mfma_f32_16x16x32_bf16 v[96:99], a[176:179], v[224:227], v[96:99]
 ds_read_b64_tr_b16 a[212:213], v45 offset:20480
 v_cvt_pk_bf16_f32 v81, v82, v83
 v_mfma_f32_16x16x32_bf16 v[96:99], a[180:183], v[232:235], v[96:99]
 ds_read_b64_tr_b16 a[214:215], v45 offset:22528
 v_cvt_pk_bf16_f32 v82, v84, v85
 v_mfma_f32_16x16x32_bf16 v[96:99], a[184:187], v[240:243], v[96:99]
 s_add_u32 s58, s48, 1131520
 ds_read_b64_tr_b16 a[216:217], v45 offset:24576
 v_cvt_pk_bf16_f32 v83, v86, v87
 v_mfma_f32_16x16x32_bf16 v[96:99], a[188:191], v[248:251], v[96:99]
 s_waitcnt lgkmcnt(7)
 ds_read_b64_tr_b16 a[218:219], v45 offset:26624
 buffer_store_dwordx4 v[80:83], v1, s[12:15], s58 offen sc1
 v_mfma_f32_16x16x32_bf16 v[92:95], a[192:195], v[128:131], 0
 ds_read_b64_tr_b16 a[220:221], v45 offset:28672
 v_mul_f32 v88, v88, v64
 v_mfma_f32_16x16x32_bf16 v[92:95], a[196:199], v[136:139], v[92:95]
 ds_read_b64_tr_b16 a[222:223], v45 offset:30720
 v_xor_b32 v46, 0x30000, v46
 v_mfma_f32_16x16x32_bf16 v[92:95], a[200:203], v[144:147], v[92:95]
 s_waitcnt lgkmcnt(4)
 ds_read_b64_tr_b16 a[160:161], v46 offset:0
 v_mul_f32 v89, v89, v64
 v_mfma_f32_16x16x32_bf16 v[92:95], a[204:207], v[152:155], v[92:95]
 ds_read_b64_tr_b16 a[162:163], v46 offset:2048
 v_mul_f32 v90, v90, v64
 v_mfma_f32_16x16x32_bf16 v[92:95], a[208:211], v[160:163], v[92:95]
 ds_read_b64_tr_b16 a[164:165], v46 offset:4096
 v_mul_f32 v91, v91, v64
 v_mfma_f32_16x16x32_bf16 v[92:95], a[212:215], v[168:171], v[92:95]
 s_waitcnt lgkmcnt(3)
 ds_read_b64_tr_b16 a[166:167], v46 offset:6144
 v_mul_f32 v96, v96, v65
 v_mfma_f32_16x16x32_bf16 v[92:95], a[216:219], v[176:179], v[92:95]
 ds_read_b64_tr_b16 a[168:169], v46 offset:8192
 v_mul_f32 v97, v97, v65
 v_mfma_f32_16x16x32_bf16 v[92:95], a[220:223], v[184:187], v[92:95]
 ds_read_b64_tr_b16 a[170:171], v46 offset:10240
 v_mul_f32 v98, v98, v65
 v_mfma_f32_16x16x32_bf16 v[100:103], a[192:195], v[192:195], 0
 ds_read_b64_tr_b16 a[172:173], v46 offset:12288
 v_mul_f32 v99, v99, v65
 v_mfma_f32_16x16x32_bf16 v[100:103], a[196:199], v[200:203], v[100:103]
 ds_read_b64_tr_b16 a[174:175], v46 offset:14336
 v_mfma_f32_16x16x32_bf16 v[100:103], a[200:203], v[208:211], v[100:103]
 ds_read_b64_tr_b16 a[176:177], v46 offset:16384
 v_mfma_f32_16x16x32_bf16 v[100:103], a[204:207], v[216:219], v[100:103]
 ds_read_b64_tr_b16 a[178:179], v46 offset:18432
 v_mfma_f32_16x16x32_bf16 v[100:103], a[208:211], v[224:227], v[100:103]
 ds_read_b64_tr_b16 a[180:181], v46 offset:20480
 v_mul_f32 v92, v92, v64
 v_mfma_f32_16x16x32_bf16 v[100:103], a[212:215], v[232:235], v[100:103]
 ds_read_b64_tr_b16 a[182:183], v46 offset:22528
 v_mul_f32 v93, v93, v64
 v_mfma_f32_16x16x32_bf16 v[100:103], a[216:219], v[240:243], v[100:103]
 ds_read_b64_tr_b16 a[184:185], v46 offset:24576
 v_mul_f32 v94, v94, v64
 v_mfma_f32_16x16x32_bf16 v[100:103], a[220:223], v[248:251], v[100:103]
 s_waitcnt lgkmcnt(7)
 ds_read_b64_tr_b16 a[186:187], v46 offset:26624
 v_mul_f32 v95, v95, v64
 v_mfma_f32_16x16x32_bf16 v[104:107], a[160:163], v[128:131], 0
 ds_read_b64_tr_b16 a[188:189], v46 offset:28672
 v_cvt_pk_bf16_f32 v88, v88, v89
 v_mfma_f32_16x16x32_bf16 v[104:107], a[164:167], v[136:139], v[104:107]
 ds_read_b64_tr_b16 a[190:191], v46 offset:30720
 v_xor_b32 v47, 0x30000, v47
 v_mfma_f32_16x16x32_bf16 v[104:107], a[168:171], v[144:147], v[104:107]
 s_waitcnt lgkmcnt(4)
 ds_read_b64_tr_b16 a[192:193], v47 offset:0
 v_cvt_pk_bf16_f32 v89, v90, v91
 v_mfma_f32_16x16x32_bf16 v[104:107], a[172:175], v[152:155], v[104:107]
 ds_read_b64_tr_b16 a[194:195], v47 offset:2048
 v_cvt_pk_bf16_f32 v90, v92, v93
 v_mfma_f32_16x16x32_bf16 v[104:107], a[176:179], v[160:163], v[104:107]
 s_add_u32 s58, s48, 174080
 ds_read_b64_tr_b16 a[196:197], v47 offset:4096
 v_cvt_pk_bf16_f32 v91, v94, v95
 v_mfma_f32_16x16x32_bf16 v[104:107], a[180:183], v[168:171], v[104:107]
 s_waitcnt lgkmcnt(3)
 ds_read_b64_tr_b16 a[198:199], v47 offset:6144
 buffer_store_dwordx4 v[88:91], v1, s[12:15], s58 offen sc1
 v_mfma_f32_16x16x32_bf16 v[104:107], a[184:187], v[176:179], v[104:107]
 ds_read_b64_tr_b16 a[200:201], v47 offset:8192
 v_mul_f32 v100, v100, v65
 v_mfma_f32_16x16x32_bf16 v[104:107], a[188:191], v[184:187], v[104:107]
 ds_read_b64_tr_b16 a[202:203], v47 offset:10240
 v_mul_f32 v101, v101, v65
 v_mfma_f32_16x16x32_bf16 v[112:115], a[160:163], v[192:195], 0
 ds_read_b64_tr_b16 a[204:205], v47 offset:12288
 v_mul_f32 v102, v102, v65
 v_mfma_f32_16x16x32_bf16 v[112:115], a[164:167], v[200:203], v[112:115]
 ds_read_b64_tr_b16 a[206:207], v47 offset:14336
 v_mul_f32 v103, v103, v65
 v_mfma_f32_16x16x32_bf16 v[112:115], a[168:171], v[208:211], v[112:115]
 ds_read_b64_tr_b16 a[208:209], v47 offset:16384
 v_cvt_pk_bf16_f32 v96, v96, v97
 v_mfma_f32_16x16x32_bf16 v[112:115], a[172:175], v[216:219], v[112:115]
 ds_read_b64_tr_b16 a[210:211], v47 offset:18432
 v_cvt_pk_bf16_f32 v97, v98, v99
 v_mfma_f32_16x16x32_bf16 v[112:115], a[176:179], v[224:227], v[112:115]
 ds_read_b64_tr_b16 a[212:213], v47 offset:20480
 v_cvt_pk_bf16_f32 v98, v100, v101
 v_mfma_f32_16x16x32_bf16 v[112:115], a[180:183], v[232:235], v[112:115]
 s_add_u32 s58, s48, 1148928
 ds_read_b64_tr_b16 a[214:215], v47 offset:22528
 v_cvt_pk_bf16_f32 v99, v102, v103
 v_mfma_f32_16x16x32_bf16 v[112:115], a[184:187], v[240:243], v[112:115]
 ds_read_b64_tr_b16 a[216:217], v47 offset:24576
 buffer_store_dwordx4 v[96:99], v1, s[12:15], s58 offen sc1
 v_mfma_f32_16x16x32_bf16 v[112:115], a[188:191], v[248:251], v[112:115]
 s_waitcnt lgkmcnt(7)
 ds_read_b64_tr_b16 a[218:219], v47 offset:26624
 v_mul_f32 v104, v104, v64
 v_mfma_f32_16x16x32_bf16 v[108:111], a[192:195], v[128:131], 0
 s_waitcnt vmcnt(5)
 ds_read_b64_tr_b16 a[220:221], v47 offset:28672
 v_mul_f32 v105, v105, v64
 v_mfma_f32_16x16x32_bf16 v[108:111], a[196:199], v[136:139], v[108:111]
 s_barrier
 ds_read_b64_tr_b16 a[222:223], v47 offset:30720
 v_xor_b32 v44, 0x20000, v44
 v_mfma_f32_16x16x32_bf16 v[108:111], a[200:203], v[144:147], v[108:111]
 s_waitcnt lgkmcnt(4)
 ds_read_b64_tr_b16 a[160:161], v44 offset:0
 v_mul_f32 v106, v106, v64
 v_mfma_f32_16x16x32_bf16 v[108:111], a[204:207], v[152:155], v[108:111]
 ds_read_b64_tr_b16 a[162:163], v44 offset:2048
 v_mul_f32 v107, v107, v64
 v_mfma_f32_16x16x32_bf16 v[108:111], a[208:211], v[160:163], v[108:111]
 ds_read_b64_tr_b16 a[164:165], v44 offset:4096
 v_mul_f32 v112, v112, v65
 v_mfma_f32_16x16x32_bf16 v[108:111], a[212:215], v[168:171], v[108:111]
 s_waitcnt lgkmcnt(3)
 ds_read_b64_tr_b16 a[166:167], v44 offset:6144
 v_mul_f32 v113, v113, v65
 v_mfma_f32_16x16x32_bf16 v[108:111], a[216:219], v[176:179], v[108:111]
 ds_read_b64_tr_b16 a[168:169], v44 offset:8192
 v_mul_f32 v114, v114, v65
 v_mfma_f32_16x16x32_bf16 v[108:111], a[220:223], v[184:187], v[108:111]
 ds_read_b64_tr_b16 a[170:171], v44 offset:10240
 v_mul_f32 v115, v115, v65
 v_mfma_f32_16x16x32_bf16 v[116:119], a[192:195], v[192:195], 0
 ds_read_b64_tr_b16 a[172:173], v44 offset:12288
 v_mfma_f32_16x16x32_bf16 v[116:119], a[196:199], v[200:203], v[116:119]
 ds_read_b64_tr_b16 a[174:175], v44 offset:14336
 v_mfma_f32_16x16x32_bf16 v[116:119], a[200:203], v[208:211], v[116:119]
 ds_read_b64_tr_b16 a[176:177], v44 offset:16384
 v_mfma_f32_16x16x32_bf16 v[116:119], a[204:207], v[216:219], v[116:119]
 ds_read_b64_tr_b16 a[178:179], v44 offset:18432
 v_mfma_f32_16x16x32_bf16 v[116:119], a[208:211], v[224:227], v[116:119]
 ds_read_b64_tr_b16 a[180:181], v44 offset:20480
 v_mul_f32 v108, v108, v64
 v_mfma_f32_16x16x32_bf16 v[116:119], a[212:215], v[232:235], v[116:119]
 ds_read_b64_tr_b16 a[182:183], v44 offset:22528
 v_mul_f32 v109, v109, v64
 v_mfma_f32_16x16x32_bf16 v[116:119], a[216:219], v[240:243], v[116:119]
 ds_read_b64_tr_b16 a[184:185], v44 offset:24576
 v_mul_f32 v110, v110, v64
 v_mfma_f32_16x16x32_bf16 v[116:119], a[220:223], v[248:251], v[116:119]
 s_waitcnt lgkmcnt(7)
 ds_read_b64_tr_b16 a[186:187], v44 offset:26624
 v_mul_f32 v111, v111, v64
 v_mfma_f32_16x16x32_bf16 v[72:75], a[160:163], v[128:131], 0
 ds_read_b64_tr_b16 a[188:189], v44 offset:28672
 v_cvt_pk_bf16_f32 v104, v104, v105
 v_mfma_f32_16x16x32_bf16 v[72:75], a[164:167], v[136:139], v[72:75]
 ds_read_b64_tr_b16 a[190:191], v44 offset:30720
 v_xor_b32 v45, 0x20000, v45
 v_mfma_f32_16x16x32_bf16 v[72:75], a[168:171], v[144:147], v[72:75]
 s_waitcnt lgkmcnt(4)
 ds_read_b64_tr_b16 a[192:193], v45 offset:0
 v_cvt_pk_bf16_f32 v105, v106, v107
 v_mfma_f32_16x16x32_bf16 v[72:75], a[172:175], v[152:155], v[72:75]
 ds_read_b64_tr_b16 a[194:195], v45 offset:2048
 v_cvt_pk_bf16_f32 v106, v108, v109
 v_mfma_f32_16x16x32_bf16 v[72:75], a[176:179], v[160:163], v[72:75]
 s_add_u32 s58, s48, 191488
 ds_read_b64_tr_b16 a[196:197], v45 offset:4096
 v_cvt_pk_bf16_f32 v107, v110, v111
 v_mfma_f32_16x16x32_bf16 v[72:75], a[180:183], v[168:171], v[72:75]
 s_waitcnt lgkmcnt(3)
 ds_read_b64_tr_b16 a[198:199], v45 offset:6144
 buffer_store_dwordx4 v[104:107], v1, s[12:15], s58 offen sc1
 v_mfma_f32_16x16x32_bf16 v[72:75], a[184:187], v[176:179], v[72:75]
 ds_read_b64_tr_b16 a[200:201], v45 offset:8192
 v_mul_f32 v116, v116, v65
 v_mfma_f32_16x16x32_bf16 v[72:75], a[188:191], v[184:187], v[72:75]
 ds_read_b64_tr_b16 a[202:203], v45 offset:10240
 v_mul_f32 v117, v117, v65
 v_mfma_f32_16x16x32_bf16 v[80:83], a[160:163], v[192:195], 0
 ds_read_b64_tr_b16 a[204:205], v45 offset:12288
 v_mul_f32 v118, v118, v65
 v_mfma_f32_16x16x32_bf16 v[80:83], a[164:167], v[200:203], v[80:83]
 ds_read_b64_tr_b16 a[206:207], v45 offset:14336
 v_mul_f32 v119, v119, v65
 v_mfma_f32_16x16x32_bf16 v[80:83], a[168:171], v[208:211], v[80:83]
 ds_read_b64_tr_b16 a[208:209], v45 offset:16384
 v_cvt_pk_bf16_f32 v112, v112, v113
 v_mfma_f32_16x16x32_bf16 v[80:83], a[172:175], v[216:219], v[80:83]
 ds_read_b64_tr_b16 a[210:211], v45 offset:18432
 v_cvt_pk_bf16_f32 v113, v114, v115
 v_mfma_f32_16x16x32_bf16 v[80:83], a[176:179], v[224:227], v[80:83]
 ds_read_b64_tr_b16 a[212:213], v45 offset:20480
 v_cvt_pk_bf16_f32 v114, v116, v117
 v_mfma_f32_16x16x32_bf16 v[80:83], a[180:183], v[232:235], v[80:83]
 s_add_u32 s58, s48, 1166336
 ds_read_b64_tr_b16 a[214:215], v45 offset:22528
 v_cvt_pk_bf16_f32 v115, v118, v119
 v_mfma_f32_16x16x32_bf16 v[80:83], a[184:187], v[240:243], v[80:83]
 ds_read_b64_tr_b16 a[216:217], v45 offset:24576
 buffer_store_dwordx4 v[112:115], v1, s[12:15], s58 offen sc1
 v_mfma_f32_16x16x32_bf16 v[80:83], a[188:191], v[248:251], v[80:83]
 s_waitcnt lgkmcnt(7)
 ds_read_b64_tr_b16 a[218:219], v45 offset:26624
 v_mul_f32 v72, v72, v64
 v_mfma_f32_16x16x32_bf16 v[76:79], a[192:195], v[128:131], 0
 ds_read_b64_tr_b16 a[220:221], v45 offset:28672
 v_mul_f32 v73, v73, v64
 v_mfma_f32_16x16x32_bf16 v[76:79], a[196:199], v[136:139], v[76:79]
 ds_read_b64_tr_b16 a[222:223], v45 offset:30720
 v_xor_b32 v46, 0x20000, v46
 v_mfma_f32_16x16x32_bf16 v[76:79], a[200:203], v[144:147], v[76:79]
 s_waitcnt lgkmcnt(4)
 ds_read_b64_tr_b16 a[160:161], v46 offset:0
 v_mul_f32 v74, v74, v64
 v_mfma_f32_16x16x32_bf16 v[76:79], a[204:207], v[152:155], v[76:79]
 ds_read_b64_tr_b16 a[162:163], v46 offset:2048
 v_mul_f32 v75, v75, v64
 v_mfma_f32_16x16x32_bf16 v[76:79], a[208:211], v[160:163], v[76:79]
 ds_read_b64_tr_b16 a[164:165], v46 offset:4096
 v_mul_f32 v80, v80, v65
 v_mfma_f32_16x16x32_bf16 v[76:79], a[212:215], v[168:171], v[76:79]
 s_waitcnt lgkmcnt(3)
 ds_read_b64_tr_b16 a[166:167], v46 offset:6144
 v_mul_f32 v81, v81, v65
 v_mfma_f32_16x16x32_bf16 v[76:79], a[216:219], v[176:179], v[76:79]
 ds_read_b64_tr_b16 a[168:169], v46 offset:8192
 v_mul_f32 v82, v82, v65
 v_mfma_f32_16x16x32_bf16 v[76:79], a[220:223], v[184:187], v[76:79]
 ds_read_b64_tr_b16 a[170:171], v46 offset:10240
 v_mul_f32 v83, v83, v65
 v_mfma_f32_16x16x32_bf16 v[84:87], a[192:195], v[192:195], 0
 ds_read_b64_tr_b16 a[172:173], v46 offset:12288
 v_mfma_f32_16x16x32_bf16 v[84:87], a[196:199], v[200:203], v[84:87]
 ds_read_b64_tr_b16 a[174:175], v46 offset:14336
 v_mfma_f32_16x16x32_bf16 v[84:87], a[200:203], v[208:211], v[84:87]
 ds_read_b64_tr_b16 a[176:177], v46 offset:16384
 v_mfma_f32_16x16x32_bf16 v[84:87], a[204:207], v[216:219], v[84:87]
 ds_read_b64_tr_b16 a[178:179], v46 offset:18432
 v_mfma_f32_16x16x32_bf16 v[84:87], a[208:211], v[224:227], v[84:87]
 ds_read_b64_tr_b16 a[180:181], v46 offset:20480
 v_mul_f32 v76, v76, v64
 v_mfma_f32_16x16x32_bf16 v[84:87], a[212:215], v[232:235], v[84:87]
 ds_read_b64_tr_b16 a[182:183], v46 offset:22528
 v_mul_f32 v77, v77, v64
 v_mfma_f32_16x16x32_bf16 v[84:87], a[216:219], v[240:243], v[84:87]
 ds_read_b64_tr_b16 a[184:185], v46 offset:24576
 v_mul_f32 v78, v78, v64
 v_mfma_f32_16x16x32_bf16 v[84:87], a[220:223], v[248:251], v[84:87]
 s_waitcnt lgkmcnt(7)
 ds_read_b64_tr_b16 a[186:187], v46 offset:26624
 v_mul_f32 v79, v79, v64
 v_mfma_f32_16x16x32_bf16 v[88:91], a[160:163], v[128:131], 0
 ds_read_b64_tr_b16 a[188:189], v46 offset:28672
 v_cvt_pk_bf16_f32 v72, v72, v73
 v_mfma_f32_16x16x32_bf16 v[88:91], a[164:167], v[136:139], v[88:91]
 ds_read_b64_tr_b16 a[190:191], v46 offset:30720
 v_xor_b32 v47, 0x20000, v47
 v_mfma_f32_16x16x32_bf16 v[88:91], a[168:171], v[144:147], v[88:91]
 s_waitcnt lgkmcnt(4)
 ds_read_b64_tr_b16 a[192:193], v47 offset:0
 v_cvt_pk_bf16_f32 v73, v74, v75
 v_mfma_f32_16x16x32_bf16 v[88:91], a[172:175], v[152:155], v[88:91]
 ds_read_b64_tr_b16 a[194:195], v47 offset:2048
 v_cvt_pk_bf16_f32 v74, v76, v77
 v_mfma_f32_16x16x32_bf16 v[88:91], a[176:179], v[160:163], v[88:91]
 s_add_u32 s58, s48, 208896
 ds_read_b64_tr_b16 a[196:197], v47 offset:4096
 v_cvt_pk_bf16_f32 v75, v78, v79
 v_mfma_f32_16x16x32_bf16 v[88:91], a[180:183], v[168:171], v[88:91]
 s_waitcnt lgkmcnt(3)
 ds_read_b64_tr_b16 a[198:199], v47 offset:6144
 buffer_store_dwordx4 v[72:75], v1, s[12:15], s58 offen sc1
 v_mfma_f32_16x16x32_bf16 v[88:91], a[184:187], v[176:179], v[88:91]
 ds_read_b64_tr_b16 a[200:201], v47 offset:8192
 v_mul_f32 v84, v84, v65
 v_mfma_f32_16x16x32_bf16 v[88:91], a[188:191], v[184:187], v[88:91]
 ds_read_b64_tr_b16 a[202:203], v47 offset:10240
 v_mul_f32 v85, v85, v65
 v_mfma_f32_16x16x32_bf16 v[96:99], a[160:163], v[192:195], 0
 ds_read_b64_tr_b16 a[204:205], v47 offset:12288
 v_mul_f32 v86, v86, v65
 v_mfma_f32_16x16x32_bf16 v[96:99], a[164:167], v[200:203], v[96:99]
 ds_read_b64_tr_b16 a[206:207], v47 offset:14336
 v_mul_f32 v87, v87, v65
 v_mfma_f32_16x16x32_bf16 v[96:99], a[168:171], v[208:211], v[96:99]
 ds_read_b64_tr_b16 a[208:209], v47 offset:16384
 v_cvt_pk_bf16_f32 v80, v80, v81
 v_mfma_f32_16x16x32_bf16 v[96:99], a[172:175], v[216:219], v[96:99]
 ds_read_b64_tr_b16 a[210:211], v47 offset:18432
 v_cvt_pk_bf16_f32 v81, v82, v83
 v_mfma_f32_16x16x32_bf16 v[96:99], a[176:179], v[224:227], v[96:99]
 ds_read_b64_tr_b16 a[212:213], v47 offset:20480
 v_cvt_pk_bf16_f32 v82, v84, v85
 v_mfma_f32_16x16x32_bf16 v[96:99], a[180:183], v[232:235], v[96:99]
 s_add_u32 s58, s48, 1183744
 ds_read_b64_tr_b16 a[214:215], v47 offset:22528
 v_cvt_pk_bf16_f32 v83, v86, v87
 v_mfma_f32_16x16x32_bf16 v[96:99], a[184:187], v[240:243], v[96:99]
 ds_read_b64_tr_b16 a[216:217], v47 offset:24576
 buffer_store_dwordx4 v[80:83], v1, s[12:15], s58 offen sc1
 v_mfma_f32_16x16x32_bf16 v[96:99], a[188:191], v[248:251], v[96:99]
 s_waitcnt lgkmcnt(7)
 ds_read_b64_tr_b16 a[218:219], v47 offset:26624
 v_mul_f32 v88, v88, v64
 v_mfma_f32_16x16x32_bf16 v[92:95], a[192:195], v[128:131], 0
 ds_read_b64_tr_b16 a[220:221], v47 offset:28672
 v_mul_f32 v89, v89, v64
 v_mfma_f32_16x16x32_bf16 v[92:95], a[196:199], v[136:139], v[92:95]
 ds_read_b64_tr_b16 a[222:223], v47 offset:30720
 v_mul_f32 v90, v90, v64
 v_mfma_f32_16x16x32_bf16 v[92:95], a[200:203], v[144:147], v[92:95]
 s_waitcnt lgkmcnt(4)
 v_mul_f32 v91, v91, v64
 v_mfma_f32_16x16x32_bf16 v[92:95], a[204:207], v[152:155], v[92:95]
 v_mfma_f32_16x16x32_bf16 v[92:95], a[208:211], v[160:163], v[92:95]
 v_mul_f32 v96, v96, v65
 v_mul_f32 v97, v97, v65
 v_mfma_f32_16x16x32_bf16 v[92:95], a[212:215], v[168:171], v[92:95]
 s_waitcnt lgkmcnt(0)
 v_mul_f32 v98, v98, v65
 v_mul_f32 v99, v99, v65
 v_mfma_f32_16x16x32_bf16 v[92:95], a[216:219], v[176:179], v[92:95]
 v_mfma_f32_16x16x32_bf16 v[92:95], a[220:223], v[184:187], v[92:95]
 v_mfma_f32_16x16x32_bf16 v[100:103], a[192:195], v[192:195], 0
 v_mfma_f32_16x16x32_bf16 v[100:103], a[196:199], v[200:203], v[100:103]
 v_mfma_f32_16x16x32_bf16 v[100:103], a[200:203], v[208:211], v[100:103]
 v_mfma_f32_16x16x32_bf16 v[100:103], a[204:207], v[216:219], v[100:103]
 v_mfma_f32_16x16x32_bf16 v[100:103], a[208:211], v[224:227], v[100:103]
 v_mfma_f32_16x16x32_bf16 v[100:103], a[212:215], v[232:235], v[100:103]
 v_mfma_f32_16x16x32_bf16 v[100:103], a[216:219], v[240:243], v[100:103]
 v_mfma_f32_16x16x32_bf16 v[100:103], a[220:223], v[248:251], v[100:103]
 s_nop 4
 v_mul_f32 v92, v92, v64
 v_mul_f32 v93, v93, v64
 v_mul_f32 v94, v94, v64
 v_mul_f32 v95, v95, v64
 v_cvt_pk_bf16_f32 v88, v88, v89
 v_cvt_pk_bf16_f32 v89, v90, v91
 v_cvt_pk_bf16_f32 v90, v92, v93
 v_cvt_pk_bf16_f32 v91, v94, v95
 s_add_u32 s58, s48, 226304
 buffer_store_dwordx4 v[88:91], v1, s[12:15], s58 offen sc1
 v_mul_f32 v100, v100, v65
 v_mul_f32 v101, v101, v65
 v_mul_f32 v102, v102, v65
 v_mul_f32 v103, v103, v65
 v_cvt_pk_bf16_f32 v96, v96, v97
 v_cvt_pk_bf16_f32 v97, v98, v99
 v_cvt_pk_bf16_f32 v98, v100, v101
 v_cvt_pk_bf16_f32 v99, v102, v103
 s_add_u32 s58, s48, 1201152
 buffer_store_dwordx4 v[96:99], v1, s[12:15], s58 offen sc1
L_nossm:
 s_bfe_u32 s40, s2, 0x20003
 s_lshl_b32 s38, s40, 12
 s_add_u32 s38, s38, 84967424
 v_mov_b32 v12, 1
 buffer_atomic_add v12, v9, s[12:15], s38 offen sc0 sc1
 v_and_b32 v2, 15, v0
 v_lshlrev_b32 v11, 2, v2
 v_mul_u32_u24 v7, 896, v2
 v_lshrrev_b32 v3, 4, v0
 v_lshlrev_b32 v8, 4, v3
 v_lshl_add_u32 v2, v7, 1, v8
 v_add_u32 v7, v7, v8
 v_and_b32 v4, 1, v0
 v_lshlrev_b32 v4, 4, v4
 v_mov_b32 v5, 0x3f80
 v_lshlrev_b32 v4, v4, v5
 v_bfe_u32 v5, v0, 3, 1
 v_bfe_u32 v6, v0, 1, 1
 v_lshl_add_u32 v5, v5, 1, v6
 v_bfe_u32 v6, v0, 2, 1
 v_lshlrev_b32 v6, 1, v6
 v_sub_u32 v6, v3, v6
 v_lshl_add_u32 v5, v6, 2, v5
 v_cmp_eq_u32 s[16:17], 0, v5
 v_cmp_eq_u32 s[18:19], 1, v5
 v_cmp_eq_u32 s[20:21], 2, v5
 v_cmp_eq_u32 s[22:23], 3, v5
 v_cndmask_b32 v24, 0, v4, s[16:17]
 v_cndmask_b32 v25, 0, v4, s[18:19]
 v_cndmask_b32 v26, 0, v4, s[20:21]
 v_cndmask_b32 v27, 0, v4, s[22:23]
 v_cmp_eq_u32 s[16:17], 4, v5
 v_cmp_eq_u32 s[18:19], 5, v5
 v_cmp_eq_u32 s[20:21], 6, v5
 v_cmp_eq_u32 s[22:23], 7, v5
 v_cndmask_b32 v28, 0, v4, s[16:17]
 v_cndmask_b32 v29, 0, v4, s[18:19]
 v_cndmask_b32 v30, 0, v4, s[20:21]
 v_cndmask_b32 v31, 0, v4, s[22:23]
 s_mov_b32 s8, s88
 s_mov_b32 s9, s89
 s_mov_b32 s10, 3670016
 s_mov_b32 s11, 0x20000
 s_mov_b32 s16, s64
 s_mov_b32 s17, s65
 s_mov_b32 s18, 1835008
 s_mov_b32 s19, 0x20000
 s_lshl_b32 s58, s3, 12
 s_add_u32 s58, s58, 0x20000
 s_mov_b32 s59, 0xffff0000
 v_lshrrev_b32 v8, 1, v0
 v_mul_u32_u24 v8, 4096, v8
 v_and_b32 v6, 1, v0
 v_lshl_add_u32 v8, v6, 4, v8
 v_lshlrev_b32 v10, 3, v3
 v_bfe_u32 v6, v0, 2, 2
 v_add_u32 v10, v10, v6
 v_lshlrev_b32 v10, 5, v10
 v_and_b32 v6, 3, v0
 v_lshl_add_u32 v10, v6, 3, v10
 v_add_u32 v10, s58, v10
 v_mov_b32 v5, 0x24000
 v_lshrrev_b32 v4, 2, v0
 v_lshl_add_u32 v11, v6, 4, v4
 v_lshlrev_b32 v11, 2, v11
 v_mul_u32_u24 v7, 896, v4
 v_lshlrev_b32 v6, 4, v6
 v_lshl_add_u32 v3, v7, 1, v6
 v_add_u32 v7, v7, v6
 s_branch L_pub
L_opB:
 v_accvgpr_read_b32 v44, a254
 ds_read_b64_tr_b16 a[0:1], v44 offset:0
 ds_read_b64_tr_b16 a[2:3], v44 offset:2048
 ds_read_b64_tr_b16 a[4:5], v44 offset:4096
 ds_read_b64_tr_b16 a[6:7], v44 offset:6144
 ds_read_b64_tr_b16 a[8:9], v44 offset:8192
 ds_read_b64_tr_b16 a[10:11], v44 offset:10240
 ds_read_b64_tr_b16 a[12:13], v44 offset:12288
 ds_read_b64_tr_b16 a[14:15], v44 offset:14336
 ds_read_b64_tr_b16 a[16:17], v44 offset:16384
 ds_read_b64_tr_b16 a[18:19], v44 offset:18432
 ds_read_b64_tr_b16 a[20:21], v44 offset:20480
 ds_read_b64_tr_b16 a[22:23], v44 offset:22528
 ds_read_b64_tr_b16 a[24:25], v44 offset:24576
 ds_read_b64_tr_b16 a[26:27], v44 offset:26624
L_op0in:
 s_waitcnt lgkmcnt(7)
 v_mfma_f32_16x16x32_bf16 v[72:75], a[0:3], a[128:131], 0
 ds_read_b64_tr_b16 a[28:29], v44 offset:28672
 buffer_store_dwordx4 v[68:71], v1, s[12:15], s57 offen sc1
 v_mfma_f32_16x16x32_bf16 v[72:75], a[4:7], a[132:135], v[72:75]
 s_lshl_b32 s48, s63, 3
 ds_read_b64_tr_b16 a[30:31], v44 offset:30720
 v_xor_b32 v45, 32, v44
 v_mfma_f32_16x16x32_bf16 v[72:75], a[8:11], a[136:139], v[72:75]
 s_waitcnt lgkmcnt(4)
 ds_read_b64_tr_b16 a[32:33], v45 offset:0
 v_xor_b32 v46, 64, v44
 v_mfma_f32_16x16x32_bf16 v[72:75], a[12:15], a[140:143], v[72:75]
 ds_read_b64_tr_b16 a[34:35], v45 offset:2048
 buffer_store_dwordx4 v[168:171], v4, s[12:15], s55 offen offset:1024 sc1
 v_mfma_f32_16x16x32_bf16 v[72:75], a[16:19], a[144:147], v[72:75]
 s_add_u32 s48, s48, s3
 ds_read_b64_tr_b16 a[36:37], v45 offset:4096
 v_xor_b32 v47, 96, v44
 v_mfma_f32_16x16x32_bf16 v[72:75], a[20:23], a[148:151], v[72:75]
 s_waitcnt lgkmcnt(3)
 ds_read_b64_tr_b16 a[38:39], v45 offset:6144
 v_accvgpr_read_b32 v9, a245
 v_mfma_f32_16x16x32_bf16 v[72:75], a[24:27], a[152:155], v[72:75]
 ds_read_b64_tr_b16 a[40:41], v45 offset:8192
 buffer_store_dwordx4 v[232:235], v4, s[12:15], s56 offen offset:1024 sc1
 v_mfma_f32_16x16x32_bf16 v[72:75], a[28:31], a[156:159], v[72:75]
 s_mul_i32 s48, s48, 243712
 ds_read_b64_tr_b16 a[42:43], v45 offset:10240
 v_mfma_f32_16x16x32_bf16 v[80:83], a[0:3], a[160:163], 0
 s_lshl_b32 s58, s26, 10
 ds_read_b64_tr_b16 a[44:45], v45 offset:12288
 v_mfma_f32_16x16x32_bf16 v[80:83], a[4:7], a[164:167], v[80:83]
 ds_read_b64_tr_b16 a[46:47], v45 offset:14336
 buffer_store_dwordx4 v[176:179], v4, s[12:15], s55 offen offset:2048 sc1
 v_mfma_f32_16x16x32_bf16 v[80:83], a[8:11], a[168:171], v[80:83]
 s_add_u32 s48, s48, s58
 ds_read_b64_tr_b16 a[48:49], v45 offset:16384
 v_mfma_f32_16x16x32_bf16 v[80:83], a[12:15], a[172:175], v[80:83]
 s_add_u32 s48, s48, 117440512
 ds_read_b64_tr_b16 a[50:51], v45 offset:18432
 v_mfma_f32_16x16x32_bf16 v[80:83], a[16:19], a[176:179], v[80:83]
 ds_read_b64_tr_b16 a[52:53], v45 offset:20480
 buffer_store_dwordx4 v[240:243], v4, s[12:15], s56 offen offset:2048 sc1
 v_mfma_f32_16x16x32_bf16 v[80:83], a[20:23], a[180:183], v[80:83]
 ds_read_b64_tr_b16 a[54:55], v45 offset:22528
 v_mul_f32 v72, v72, v64
 v_mfma_f32_16x16x32_bf16 v[80:83], a[24:27], a[184:187], v[80:83]
 ds_read_b64_tr_b16 a[56:57], v45 offset:24576
 v_mul_f32 v73, v73, v64
 v_mfma_f32_16x16x32_bf16 v[80:83], a[28:31], a[188:191], v[80:83]
 s_waitcnt lgkmcnt(7)
 ds_read_b64_tr_b16 a[58:59], v45 offset:26624
 buffer_store_dwordx4 v[184:187], v4, s[12:15], s55 offen offset:3072 sc1
 v_mfma_f32_16x16x32_bf16 v[76:79], a[32:35], a[128:131], 0
 ds_read_b64_tr_b16 a[60:61], v45 offset:28672
 v_mul_f32 v74, v74, v64
 v_mfma_f32_16x16x32_bf16 v[76:79], a[36:39], a[132:135], v[76:79]
 ds_read_b64_tr_b16 a[62:63], v45 offset:30720
 v_mul_f32 v75, v75, v64
 v_mfma_f32_16x16x32_bf16 v[76:79], a[40:43], a[136:139], v[76:79]
 s_waitcnt lgkmcnt(4)
 ds_read_b64_tr_b16 a[0:1], v46 offset:0
 buffer_store_dwordx4 v[248:251], v4, s[12:15], s56 offen offset:3072 sc1
 v_mfma_f32_16x16x32_bf16 v[76:79], a[44:47], a[140:143], v[76:79]
 ds_read_b64_tr_b16 a[2:3], v46 offset:2048
 v_mfma_f32_16x16x32_bf16 v[76:79], a[48:51], a[144:147], v[76:79]
 s_add_u32 m0, s29, 32768
 ds_read_b64_tr_b16 a[4:5], v46 offset:4096
 v_mul_f32 v80, v80, v65
 v_mfma_f32_16x16x32_bf16 v[76:79], a[52:55], a[148:151], v[76:79]
 s_waitcnt lgkmcnt(3)
 ds_read_b64_tr_b16 a[6:7], v46 offset:6144
 buffer_load_dwordx4 v2, s[8:11], s78 offen lds
 v_mfma_f32_16x16x32_bf16 v[76:79], a[56:59], a[152:155], v[76:79]
 ds_read_b64_tr_b16 a[8:9], v46 offset:8192
 v_mul_f32 v81, v81, v65
 v_mfma_f32_16x16x32_bf16 v[76:79], a[60:63], a[156:159], v[76:79]
 ds_read_b64_tr_b16 a[10:11], v46 offset:10240
 v_mul_f32 v82, v82, v65
 v_mfma_f32_16x16x32_bf16 v[84:87], a[32:35], a[160:163], 0
 ds_read_b64_tr_b16 a[12:13], v46 offset:12288
 v_mul_f32 v83, v83, v65
 v_mfma_f32_16x16x32_bf16 v[84:87], a[36:39], a[164:167], v[84:87]
 ds_read_b64_tr_b16 a[14:15], v46 offset:14336
 v_mfma_f32_16x16x32_bf16 v[84:87], a[40:43], a[168:171], v[84:87]
 ds_read_b64_tr_b16 a[16:17], v46 offset:16384
 v_mfma_f32_16x16x32_bf16 v[84:87], a[44:47], a[172:175], v[84:87]
 s_add_u32 m0, s29, 36864
 ds_read_b64_tr_b16 a[18:19], v46 offset:18432
 v_mfma_f32_16x16x32_bf16 v[84:87], a[48:51], a[176:179], v[84:87]
 ds_read_b64_tr_b16 a[20:21], v46 offset:20480
 buffer_load_dwordx4 v2, s[8:11], s79 offen lds
 v_mfma_f32_16x16x32_bf16 v[84:87], a[52:55], a[180:183], v[84:87]
 ds_read_b64_tr_b16 a[22:23], v46 offset:22528
 v_mul_f32 v76, v76, v64
 v_mfma_f32_16x16x32_bf16 v[84:87], a[56:59], a[184:187], v[84:87]
 ds_read_b64_tr_b16 a[24:25], v46 offset:24576
 v_mul_f32 v77, v77, v64
 v_mfma_f32_16x16x32_bf16 v[84:87], a[60:63], a[188:191], v[84:87]
 s_waitcnt lgkmcnt(7)
 ds_read_b64_tr_b16 a[26:27], v46 offset:26624
 v_mul_f32 v78, v78, v64
 v_mfma_f32_16x16x32_bf16 v[88:91], a[0:3], a[128:131], 0
 ds_read_b64_tr_b16 a[28:29], v46 offset:28672
 v_mul_f32 v79, v79, v64
 v_mfma_f32_16x16x32_bf16 v[88:91], a[4:7], a[132:135], v[88:91]
 s_add_u32 m0, s29, 40960
 ds_read_b64_tr_b16 a[30:31], v46 offset:30720
 v_cvt_pk_bf16_f32 v72, v72, v73
 v_mfma_f32_16x16x32_bf16 v[88:91], a[8:11], a[136:139], v[88:91]
 s_waitcnt lgkmcnt(4)
 ds_read_b64_tr_b16 a[32:33], v47 offset:0
 v_cvt_pk_bf16_f32 v73, v74, v75
 v_mfma_f32_16x16x32_bf16 v[88:91], a[12:15], a[140:143], v[88:91]
 ds_read_b64_tr_b16 a[34:35], v47 offset:2048
 buffer_load_dwordx4 v2, s[8:11], s80 offen lds
 v_mfma_f32_16x16x32_bf16 v[88:91], a[16:19], a[144:147], v[88:91]
 s_add_u32 s58, s48, 0
 ds_read_b64_tr_b16 a[36:37], v47 offset:4096
 v_cvt_pk_bf16_f32 v74, v76, v77
 v_mfma_f32_16x16x32_bf16 v[88:91], a[20:23], a[148:151], v[88:91]
 s_waitcnt lgkmcnt(3)
 ds_read_b64_tr_b16 a[38:39], v47 offset:6144
 v_cvt_pk_bf16_f32 v75, v78, v79
 v_mfma_f32_16x16x32_bf16 v[88:91], a[24:27], a[152:155], v[88:91]
 ds_read_b64_tr_b16 a[40:41], v47 offset:8192
 buffer_store_dwordx4 v[72:75], v1, s[12:15], s58 offen sc1
 v_mfma_f32_16x16x32_bf16 v[88:91], a[28:31], a[156:159], v[88:91]
 s_waitcnt vmcnt(4)
 ds_read_b64_tr_b16 a[42:43], v47 offset:10240
 v_mul_f32 v84, v84, v65
 v_mfma_f32_16x16x32_bf16 v[96:99], a[0:3], a[160:163], 0
 s_barrier
 ds_read_b64_tr_b16 a[44:45], v47 offset:12288
 v_mul_f32 v85, v85, v65
 v_mfma_f32_16x16x32_bf16 v[96:99], a[4:7], a[164:167], v[96:99]
 ds_read_b64_tr_b16 a[46:47], v47 offset:14336
 buffer_store_dword v9, v9, s[12:15], s59 offen sc1
 v_mfma_f32_16x16x32_bf16 v[96:99], a[8:11], a[168:171], v[96:99]
 s_add_u32 m0, s29, 45056
 ds_read_b64_tr_b16 a[48:49], v47 offset:16384
 v_mul_f32 v86, v86, v65
 v_mfma_f32_16x16x32_bf16 v[96:99], a[12:15], a[172:175], v[96:99]
 ds_read_b64_tr_b16 a[50:51], v47 offset:18432
 buffer_load_dwordx4 v2, s[8:11], s81 offen lds
 v_mfma_f32_16x16x32_bf16 v[96:99], a[16:19], a[176:179], v[96:99]
 ds_read_b64_tr_b16 a[52:53], v47 offset:20480
 v_mul_f32 v87, v87, v65
 v_mfma_f32_16x16x32_bf16 v[96:99], a[20:23], a[180:183], v[96:99]
 ds_read_b64_tr_b16 a[54:55], v47 offset:22528
 v_cvt_pk_bf16_f32 v80, v80, v81
 v_mfma_f32_16x16x32_bf16 v[96:99], a[24:27], a[184:187], v[96:99]
 ds_read_b64_tr_b16 a[56:57], v47 offset:24576
 v_cvt_pk_bf16_f32 v81, v82, v83
 v_mfma_f32_16x16x32_bf16 v[96:99], a[28:31], a[188:191], v[96:99]
 s_waitcnt lgkmcnt(7)
 ds_read_b64_tr_b16 a[58:59], v47 offset:26624
 v_cvt_pk_bf16_f32 v82, v84, v85
 v_mfma_f32_16x16x32_bf16 v[92:95], a[32:35], a[128:131], 0
 ds_read_b64_tr_b16 a[60:61], v47 offset:28672
 v_cvt_pk_bf16_f32 v83, v86, v87
 v_mfma_f32_16x16x32_bf16 v[92:95], a[36:39], a[132:135], v[92:95]
 s_add_u32 m0, s29, 49152
 ds_read_b64_tr_b16 a[62:63], v47 offset:30720
 v_xor_b32 v44, 0x20000, v44
 v_mfma_f32_16x16x32_bf16 v[92:95], a[40:43], a[136:139], v[92:95]
 s_waitcnt lgkmcnt(4)
 ds_read_b64_tr_b16 a[0:1], v44 offset:0
 buffer_load_dwordx4 v2, s[8:11], s82 offen lds
 v_mfma_f32_16x16x32_bf16 v[92:95], a[44:47], a[140:143], v[92:95]
 s_add_u32 s58, s48, 974848
 ds_read_b64_tr_b16 a[2:3], v44 offset:2048
 v_mul_f32 v88, v88, v64
 v_mfma_f32_16x16x32_bf16 v[92:95], a[48:51], a[144:147], v[92:95]
 ds_read_b64_tr_b16 a[4:5], v44 offset:4096
 buffer_store_dwordx4 v[80:83], v1, s[12:15], s58 offen sc1
 v_mfma_f32_16x16x32_bf16 v[92:95], a[52:55], a[148:151], v[92:95]
 s_waitcnt lgkmcnt(3)
 ds_read_b64_tr_b16 a[6:7], v44 offset:6144
 v_mul_f32 v89, v89, v64
 v_mfma_f32_16x16x32_bf16 v[92:95], a[56:59], a[152:155], v[92:95]
 ds_read_b64_tr_b16 a[8:9], v44 offset:8192
 v_mul_f32 v90, v90, v64
 v_mfma_f32_16x16x32_bf16 v[92:95], a[60:63], a[156:159], v[92:95]
 ds_read_b64_tr_b16 a[10:11], v44 offset:10240
 v_mul_f32 v91, v91, v64
 v_mfma_f32_16x16x32_bf16 v[100:103], a[32:35], a[160:163], 0
 s_add_u32 m0, s29, 53248
 ds_read_b64_tr_b16 a[12:13], v44 offset:12288
 v_mul_f32 v96, v96, v65
 v_mfma_f32_16x16x32_bf16 v[100:103], a[36:39], a[164:167], v[100:103]
 ds_read_b64_tr_b16 a[14:15], v44 offset:14336
 buffer_load_dwordx4 v2, s[8:11], s83 offen lds
 v_mfma_f32_16x16x32_bf16 v[100:103], a[40:43], a[168:171], v[100:103]
 ds_read_b64_tr_b16 a[16:17], v44 offset:16384
 v_mul_f32 v97, v97, v65
 v_mfma_f32_16x16x32_bf16 v[100:103], a[44:47], a[172:175], v[100:103]
 ds_read_b64_tr_b16 a[18:19], v44 offset:18432
 v_mul_f32 v98, v98, v65
 v_mfma_f32_16x16x32_bf16 v[100:103], a[48:51], a[176:179], v[100:103]
 ds_read_b64_tr_b16 a[20:21], v44 offset:20480
 v_mul_f32 v92, v92, v64
 v_mfma_f32_16x16x32_bf16 v[100:103], a[52:55], a[180:183], v[100:103]
 ds_read_b64_tr_b16 a[22:23], v44 offset:22528
 v_mul_f32 v93, v93, v64
 v_mfma_f32_16x16x32_bf16 v[100:103], a[56:59], a[184:187], v[100:103]
 s_add_u32 m0, s29, 57344
 ds_read_b64_tr_b16 a[24:25], v44 offset:24576
 v_mul_f32 v94, v94, v64
 v_mfma_f32_16x16x32_bf16 v[100:103], a[60:63], a[188:191], v[100:103]
 s_waitcnt lgkmcnt(7)
 ds_read_b64_tr_b16 a[26:27], v44 offset:26624
 v_mul_f32 v95, v95, v64
 v_mfma_f32_16x16x32_bf16 v[104:107], a[0:3], a[128:131], 0
 ds_read_b64_tr_b16 a[28:29], v44 offset:28672
 buffer_load_dwordx4 v2, s[8:11], s84 offen lds
 v_mfma_f32_16x16x32_bf16 v[104:107], a[4:7], a[132:135], v[104:107]
 ds_read_b64_tr_b16 a[30:31], v44 offset:30720
 v_xor_b32 v45, 0x20000, v45
 v_mfma_f32_16x16x32_bf16 v[104:107], a[8:11], a[136:139], v[104:107]
 s_waitcnt lgkmcnt(4)
 ds_read_b64_tr_b16 a[32:33], v45 offset:0
 v_cvt_pk_bf16_f32 v88, v88, v89
 v_mfma_f32_16x16x32_bf16 v[104:107], a[12:15], a[140:143], v[104:107]
 ds_read_b64_tr_b16 a[34:35], v45 offset:2048
 v_cvt_pk_bf16_f32 v89, v90, v91
 v_mfma_f32_16x16x32_bf16 v[104:107], a[16:19], a[144:147], v[104:107]
 ds_read_b64_tr_b16 a[36:37], v45 offset:4096
 v_cvt_pk_bf16_f32 v90, v92, v93
 v_mfma_f32_16x16x32_bf16 v[104:107], a[20:23], a[148:151], v[104:107]
 s_waitcnt lgkmcnt(3)
 ds_read_b64_tr_b16 a[38:39], v45 offset:6144
 v_cvt_pk_bf16_f32 v91, v94, v95
 v_mfma_f32_16x16x32_bf16 v[104:107], a[24:27], a[152:155], v[104:107]
 s_add_u32 m0, s29, 61440
 ds_read_b64_tr_b16 a[40:41], v45 offset:8192
 v_mul_f32 v99, v99, v65
 v_mfma_f32_16x16x32_bf16 v[104:107], a[28:31], a[156:159], v[104:107]
 ds_read_b64_tr_b16 a[42:43], v45 offset:10240
 buffer_load_dwordx4 v2, s[8:11], s85 offen lds
 v_mfma_f32_16x16x32_bf16 v[112:115], a[0:3], a[160:163], 0
 s_add_u32 s58, s48, 17408
 ds_read_b64_tr_b16 a[44:45], v45 offset:12288
 v_add_u32 v2, 128, v2
 v_mfma_f32_16x16x32_bf16 v[112:115], a[4:7], a[164:167], v[112:115]
 ds_read_b64_tr_b16 a[46:47], v45 offset:14336
 buffer_store_dwordx4 v[88:91], v1, s[12:15], s58 offen sc1
 v_mfma_f32_16x16x32_bf16 v[112:115], a[8:11], a[168:171], v[112:115]
 ds_read_b64_tr_b16 a[48:49], v45 offset:16384
 v_mul_f32 v100, v100, v65
 v_mfma_f32_16x16x32_bf16 v[112:115], a[12:15], a[172:175], v[112:115]
 ds_read_b64_tr_b16 a[50:51], v45 offset:18432
 v_mul_f32 v101, v101, v65
 v_mfma_f32_16x16x32_bf16 v[112:115], a[16:19], a[176:179], v[112:115]
 ds_read_b64_tr_b16 a[52:53], v45 offset:20480
 v_mul_f32 v102, v102, v65
 v_mfma_f32_16x16x32_bf16 v[112:115], a[20:23], a[180:183], v[112:115]
 s_add_u32 m0, s29, 65536
 ds_read_b64_tr_b16 a[54:55], v45 offset:22528
 v_mul_f32 v103, v103, v65
 v_mfma_f32_16x16x32_bf16 v[112:115], a[24:27], a[184:187], v[112:115]
 ds_read_b64_tr_b16 a[56:57], v45 offset:24576
 buffer_load_dwordx4 v2, s[8:11], s78 offen lds
 v_mfma_f32_16x16x32_bf16 v[112:115], a[28:31], a[188:191], v[112:115]
 s_waitcnt lgkmcnt(7)
 ds_read_b64_tr_b16 a[58:59], v45 offset:26624
 v_cvt_pk_bf16_f32 v96, v96, v97
 v_mfma_f32_16x16x32_bf16 v[108:111], a[32:35], a[128:131], 0
 ds_read_b64_tr_b16 a[60:61], v45 offset:28672
 v_cvt_pk_bf16_f32 v97, v98, v99
 v_mfma_f32_16x16x32_bf16 v[108:111], a[36:39], a[132:135], v[108:111]
 ds_read_b64_tr_b16 a[62:63], v45 offset:30720
 v_xor_b32 v46, 0x20000, v46
 v_mfma_f32_16x16x32_bf16 v[108:111], a[40:43], a[136:139], v[108:111]
 s_waitcnt lgkmcnt(4)
 ds_read_b64_tr_b16 a[0:1], v46 offset:0
 v_cvt_pk_bf16_f32 v98, v100, v101
 v_mfma_f32_16x16x32_bf16 v[108:111], a[44:47], a[140:143], v[108:111]
 ds_read_b64_tr_b16 a[2:3], v46 offset:2048
 v_cvt_pk_bf16_f32 v99, v102, v103
 v_mfma_f32_16x16x32_bf16 v[108:111], a[48:51], a[144:147], v[108:111]
 s_add_u32 m0, s29, 69632
 ds_read_b64_tr_b16 a[4:5], v46 offset:4096
 v_mul_f32 v104, v104, v64
 v_mfma_f32_16x16x32_bf16 v[108:111], a[52:55], a[148:151], v[108:111]
 s_waitcnt lgkmcnt(3)
 ds_read_b64_tr_b16 a[6:7], v46 offset:6144
 buffer_load_dwordx4 v2, s[8:11], s79 offen lds
 v_mfma_f32_16x16x32_bf16 v[108:111], a[56:59], a[152:155], v[108:111]
 s_add_u32 s58, s48, 992256
 ds_read_b64_tr_b16 a[8:9], v46 offset:8192
 v_mul_f32 v105, v105, v64
 v_mfma_f32_16x16x32_bf16 v[108:111], a[60:63], a[156:159], v[108:111]
 ds_read_b64_tr_b16 a[10:11], v46 offset:10240
 buffer_store_dwordx4 v[96:99], v1, s[12:15], s58 offen sc1
 v_mfma_f32_16x16x32_bf16 v[116:119], a[32:35], a[160:163], 0
 ds_read_b64_tr_b16 a[12:13], v46 offset:12288
 v_mul_f32 v106, v106, v64
 v_mfma_f32_16x16x32_bf16 v[116:119], a[36:39], a[164:167], v[116:119]
 ds_read_b64_tr_b16 a[14:15], v46 offset:14336
 v_mul_f32 v107, v107, v64
 v_mfma_f32_16x16x32_bf16 v[116:119], a[40:43], a[168:171], v[116:119]
 ds_read_b64_tr_b16 a[16:17], v46 offset:16384
 v_mul_f32 v112, v112, v65
 v_mfma_f32_16x16x32_bf16 v[116:119], a[44:47], a[172:175], v[116:119]
 s_add_u32 m0, s29, 73728
 ds_read_b64_tr_b16 a[18:19], v46 offset:18432
 v_mul_f32 v113, v113, v65
 v_mfma_f32_16x16x32_bf16 v[116:119], a[48:51], a[176:179], v[116:119]
 ds_read_b64_tr_b16 a[20:21], v46 offset:20480
 buffer_load_dwordx4 v2, s[8:11], s80 offen lds
 v_mfma_f32_16x16x32_bf16 v[116:119], a[52:55], a[180:183], v[116:119]
 ds_read_b64_tr_b16 a[22:23], v46 offset:22528
 v_mul_f32 v108, v108, v64
 v_mfma_f32_16x16x32_bf16 v[116:119], a[56:59], a[184:187], v[116:119]
 ds_read_b64_tr_b16 a[24:25], v46 offset:24576
 v_mul_f32 v109, v109, v64
 v_mfma_f32_16x16x32_bf16 v[116:119], a[60:63], a[188:191], v[116:119]
 s_waitcnt lgkmcnt(7)
 ds_read_b64_tr_b16 a[26:27], v46 offset:26624
 v_mul_f32 v110, v110, v64
 v_mfma_f32_16x16x32_bf16 v[72:75], a[0:3], a[128:131], 0
 ds_read_b64_tr_b16 a[28:29], v46 offset:28672
 v_mul_f32 v111, v111, v64
 v_mfma_f32_16x16x32_bf16 v[72:75], a[4:7], a[132:135], v[72:75]
 s_add_u32 m0, s29, 77824
 ds_read_b64_tr_b16 a[30:31], v46 offset:30720
 v_xor_b32 v47, 0x20000, v47
 v_mfma_f32_16x16x32_bf16 v[72:75], a[8:11], a[136:139], v[72:75]
 s_waitcnt lgkmcnt(4)
 ds_read_b64_tr_b16 a[32:33], v47 offset:0
 v_cvt_pk_bf16_f32 v104, v104, v105
 v_mfma_f32_16x16x32_bf16 v[72:75], a[12:15], a[140:143], v[72:75]
 ds_read_b64_tr_b16 a[34:35], v47 offset:2048
 buffer_load_dwordx4 v2, s[8:11], s81 offen lds
 v_mfma_f32_16x16x32_bf16 v[72:75], a[16:19], a[144:147], v[72:75]
 ds_read_b64_tr_b16 a[36:37], v47 offset:4096
 v_cvt_pk_bf16_f32 v105, v106, v107
 v_mfma_f32_16x16x32_bf16 v[72:75], a[20:23], a[148:151], v[72:75]
 s_waitcnt lgkmcnt(3)
 ds_read_b64_tr_b16 a[38:39], v47 offset:6144
 v_cvt_pk_bf16_f32 v106, v108, v109
 v_mfma_f32_16x16x32_bf16 v[72:75], a[24:27], a[152:155], v[72:75]
 s_add_u32 s58, s48, 34816
 ds_read_b64_tr_b16 a[40:41], v47 offset:8192
 v_cvt_pk_bf16_f32 v107, v110, v111
 v_mfma_f32_16x16x32_bf16 v[72:75], a[28:31], a[156:159], v[72:75]
 ds_read_b64_tr_b16 a[42:43], v47 offset:10240
 buffer_store_dwordx4 v[104:107], v1, s[12:15], s58 offen sc1
 v_mfma_f32_16x16x32_bf16 v[80:83], a[0:3], a[160:163], 0
 ds_read_b64_tr_b16 a[44:45], v47 offset:12288
 v_mul_f32 v114, v114, v65
 v_mfma_f32_16x16x32_bf16 v[80:83], a[4:7], a[164:167], v[80:83]
 s_add_u32 m0, s29, 81920
 ds_read_b64_tr_b16 a[46:47], v47 offset:14336
 v_mul_f32 v115, v115, v65
 v_mfma_f32_16x16x32_bf16 v[80:83], a[8:11], a[168:171], v[80:83]
 ds_read_b64_tr_b16 a[48:49], v47 offset:16384
 buffer_load_dwordx4 v2, s[8:11], s82 offen lds
 v_mfma_f32_16x16x32_bf16 v[80:83], a[12:15], a[172:175], v[80:83]
 ds_read_b64_tr_b16 a[50:51], v47 offset:18432
 v_mul_f32 v116, v116, v65
 v_mfma_f32_16x16x32_bf16 v[80:83], a[16:19], a[176:179], v[80:83]
 ds_read_b64_tr_b16 a[52:53], v47 offset:20480
 v_mul_f32 v117, v117, v65
 v_mfma_f32_16x16x32_bf16 v[80:83], a[20:23], a[180:183], v[80:83]
 ds_read_b64_tr_b16 a[54:55], v47 offset:22528
 v_mul_f32 v118, v118, v65
 v_mfma_f32_16x16x32_bf16 v[80:83], a[24:27], a[184:187], v[80:83]
 ds_read_b64_tr_b16 a[56:57], v47 offset:24576
 v_mul_f32 v119, v119, v65
 v_mfma_f32_16x16x32_bf16 v[80:83], a[28:31], a[188:191], v[80:83]
 s_waitcnt lgkmcnt(7)
 ds_read_b64_tr_b16 a[58:59], v47 offset:26624
 v_cvt_pk_bf16_f32 v112, v112, v113
 v_mfma_f32_16x16x32_bf16 v[76:79], a[32:35], a[128:131], 0
 s_waitcnt vmcnt(8)
 ds_read_b64_tr_b16 a[60:61], v47 offset:28672
 v_cvt_pk_bf16_f32 v113, v114, v115
 v_mfma_f32_16x16x32_bf16 v[76:79], a[36:39], a[132:135], v[76:79]
 s_barrier
 ds_read_b64_tr_b16 a[62:63], v47 offset:30720
 v_cvt_pk_bf16_f32 v114, v116, v117
 v_mfma_f32_16x16x32_bf16 v[76:79], a[40:43], a[136:139], v[76:79]
 s_waitcnt lgkmcnt(4)
 ds_read_b64_tr_b16 a[0:1], v44 offset:32768
 v_cvt_pk_bf16_f32 v115, v118, v119
 v_mfma_f32_16x16x32_bf16 v[76:79], a[44:47], a[140:143], v[76:79]
 s_add_u32 m0, s29, 86016
 ds_read_b64_tr_b16 a[2:3], v44 offset:34816
 v_mul_f32 v72, v72, v64
 v_mfma_f32_16x16x32_bf16 v[76:79], a[48:51], a[144:147], v[76:79]
 ds_read_b64_tr_b16 a[4:5], v44 offset:36864
 buffer_load_dwordx4 v2, s[8:11], s83 offen lds
 v_mfma_f32_16x16x32_bf16 v[76:79], a[52:55], a[148:151], v[76:79]
 s_waitcnt lgkmcnt(3)
 ds_read_b64_tr_b16 a[6:7], v44 offset:38912
 v_mul_f32 v73, v73, v64
 v_mfma_f32_16x16x32_bf16 v[76:79], a[56:59], a[152:155], v[76:79]
 s_add_u32 s58, s48, 1009664
 ds_read_b64_tr_b16 a[8:9], v44 offset:40960
 v_mul_f32 v74, v74, v64
 v_mfma_f32_16x16x32_bf16 v[76:79], a[60:63], a[156:159], v[76:79]
 ds_read_b64_tr_b16 a[10:11], v44 offset:43008
 buffer_store_dwordx4 v[112:115], v1, s[12:15], s58 offen sc1
 v_mfma_f32_16x16x32_bf16 v[84:87], a[32:35], a[160:163], 0
 ds_read_b64_tr_b16 a[12:13], v44 offset:45056
 v_mul_f32 v75, v75, v64
 v_mfma_f32_16x16x32_bf16 v[84:87], a[36:39], a[164:167], v[84:87]
 ds_read_b64_tr_b16 a[14:15], v44 offset:47104
 v_mul_f32 v80, v80, v65
 v_mfma_f32_16x16x32_bf16 v[84:87], a[40:43], a[168:171], v[84:87]
 s_add_u32 m0, s29, 90112
 ds_read_b64_tr_b16 a[16:17], v44 offset:49152
 v_mul_f32 v81, v81, v65
 v_mfma_f32_16x16x32_bf16 v[84:87], a[44:47], a[172:175], v[84:87]
 ds_read_b64_tr_b16 a[18:19], v44 offset:51200
 buffer_load_dwordx4 v2, s[8:11], s84 offen lds
 v_mfma_f32_16x16x32_bf16 v[84:87], a[48:51], a[176:179], v[84:87]
 ds_read_b64_tr_b16 a[20:21], v44 offset:53248
 v_mul_f32 v76, v76, v64
 v_mfma_f32_16x16x32_bf16 v[84:87], a[52:55], a[180:183], v[84:87]
 ds_read_b64_tr_b16 a[22:23], v44 offset:55296
 v_mul_f32 v77, v77, v64
 v_mfma_f32_16x16x32_bf16 v[84:87], a[56:59], a[184:187], v[84:87]
 ds_read_b64_tr_b16 a[24:25], v44 offset:57344
 v_mul_f32 v78, v78, v64
 v_mfma_f32_16x16x32_bf16 v[84:87], a[60:63], a[188:191], v[84:87]
 s_waitcnt lgkmcnt(7)
 ds_read_b64_tr_b16 a[26:27], v44 offset:59392
 v_mul_f32 v79, v79, v64
 v_mfma_f32_16x16x32_bf16 v[88:91], a[0:3], a[128:131], 0
 ds_read_b64_tr_b16 a[28:29], v44 offset:61440
 v_cvt_pk_bf16_f32 v72, v72, v73
 v_mfma_f32_16x16x32_bf16 v[88:91], a[4:7], a[132:135], v[88:91]
 s_add_u32 m0, s29, 94208
 ds_read_b64_tr_b16 a[30:31], v44 offset:63488
 v_cvt_pk_bf16_f32 v73, v74, v75
 v_mfma_f32_16x16x32_bf16 v[88:91], a[8:11], a[136:139], v[88:91]
 s_waitcnt lgkmcnt(4)
 ds_read_b64_tr_b16 a[32:33], v45 offset:32768
 buffer_load_dwordx4 v2, s[8:11], s85 offen lds
 v_mfma_f32_16x16x32_bf16 v[88:91], a[12:15], a[140:143], v[88:91]
 ds_read_b64_tr_b16 a[34:35], v45 offset:34816
 v_add_u32 v2, 128, v2
 v_mfma_f32_16x16x32_bf16 v[88:91], a[16:19], a[144:147], v[88:91]
 s_add_u32 s58, s48, 52224
 ds_read_b64_tr_b16 a[36:37], v45 offset:36864
 v_cvt_pk_bf16_f32 v74, v76, v77
 v_mfma_f32_16x16x32_bf16 v[88:91], a[20:23], a[148:151], v[88:91]
 s_waitcnt lgkmcnt(3)
 ds_read_b64_tr_b16 a[38:39], v45 offset:38912
 v_cvt_pk_bf16_f32 v75, v78, v79
 v_mfma_f32_16x16x32_bf16 v[88:91], a[24:27], a[152:155], v[88:91]
 ds_read_b64_tr_b16 a[40:41], v45 offset:40960
 buffer_store_dwordx4 v[72:75], v1, s[12:15], s58 offen sc1
 v_mfma_f32_16x16x32_bf16 v[88:91], a[28:31], a[156:159], v[88:91]
 ds_read_b64_tr_b16 a[42:43], v45 offset:43008
 v_mul_f32 v82, v82, v65
 v_mfma_f32_16x16x32_bf16 v[96:99], a[0:3], a[160:163], 0
 s_add_u32 m0, s29, 98304
 ds_read_b64_tr_b16 a[44:45], v45 offset:45056
 v_mul_f32 v83, v83, v65
 v_mfma_f32_16x16x32_bf16 v[96:99], a[4:7], a[164:167], v[96:99]
 ds_read_b64_tr_b16 a[46:47], v45 offset:47104
 buffer_load_dwordx4 v2, s[8:11], s78 offen lds
 v_mfma_f32_16x16x32_bf16 v[96:99], a[8:11], a[168:171], v[96:99]
 ds_read_b64_tr_b16 a[48:49], v45 offset:49152
 v_mul_f32 v84, v84, v65
 v_mfma_f32_16x16x32_bf16 v[96:99], a[12:15], a[172:175], v[96:99]
 ds_read_b64_tr_b16 a[50:51], v45 offset:51200
 v_mul_f32 v85, v85, v65
 v_mfma_f32_16x16x32_bf16 v[96:99], a[16:19], a[176:179], v[96:99]
 ds_read_b64_tr_b16 a[52:53], v45 offset:53248
 v_mul_f32 v86, v86, v65
 v_mfma_f32_16x16x32_bf16 v[96:99], a[20:23], a[180:183], v[96:99]
 ds_read_b64_tr_b16 a[54:55], v45 offset:55296
 v_mul_f32 v87, v87, v65
 v_mfma_f32_16x16x32_bf16 v[96:99], a[24:27], a[184:187], v[96:99]
 s_add_u32 m0, s29, 102400
 ds_read_b64_tr_b16 a[56:57], v45 offset:57344
 v_cvt_pk_bf16_f32 v80, v80, v81
 v_mfma_f32_16x16x32_bf16 v[96:99], a[28:31], a[188:191], v[96:99]
 s_waitcnt lgkmcnt(7)
 ds_read_b64_tr_b16 a[58:59], v45 offset:59392
 v_cvt_pk_bf16_f32 v81, v82, v83
 v_mfma_f32_16x16x32_bf16 v[92:95], a[32:35], a[128:131], 0
 ds_read_b64_tr_b16 a[60:61], v45 offset:61440
 buffer_load_dwordx4 v2, s[8:11], s79 offen lds
 v_mfma_f32_16x16x32_bf16 v[92:95], a[36:39], a[132:135], v[92:95]
 s_add_u32 s58, s48, 1027072
 ds_read_b64_tr_b16 a[62:63], v45 offset:63488
 v_cvt_pk_bf16_f32 v82, v84, v85
 v_mfma_f32_16x16x32_bf16 v[92:95], a[40:43], a[136:139], v[92:95]
 s_waitcnt lgkmcnt(4)
 ds_read_b64_tr_b16 a[0:1], v46 offset:32768
 v_cvt_pk_bf16_f32 v83, v86, v87
 v_mfma_f32_16x16x32_bf16 v[92:95], a[44:47], a[140:143], v[92:95]
 ds_read_b64_tr_b16 a[2:3], v46 offset:34816
 buffer_store_dwordx4 v[80:83], v1, s[12:15], s58 offen sc1
 v_mfma_f32_16x16x32_bf16 v[92:95], a[48:51], a[144:147], v[92:95]
 ds_read_b64_tr_b16 a[4:5], v46 offset:36864
 v_mul_f32 v88, v88, v64
 v_mfma_f32_16x16x32_bf16 v[92:95], a[52:55], a[148:151], v[92:95]
 s_waitcnt lgkmcnt(3)
 ds_read_b64_tr_b16 a[6:7], v46 offset:38912
 v_mul_f32 v89, v89, v64
 v_mfma_f32_16x16x32_bf16 v[92:95], a[56:59], a[152:155], v[92:95]
 s_add_u32 m0, s29, 106496
 ds_read_b64_tr_b16 a[8:9], v46 offset:40960
 v_mul_f32 v90, v90, v64
 v_mfma_f32_16x16x32_bf16 v[92:95], a[60:63], a[156:159], v[92:95]
 ds_read_b64_tr_b16 a[10:11], v46 offset:43008
 buffer_load_dwordx4 v2, s[8:11], s80 offen lds
 v_mfma_f32_16x16x32_bf16 v[100:103], a[32:35], a[160:163], 0
 ds_read_b64_tr_b16 a[12:13], v46 offset:45056
 v_mul_f32 v91, v91, v64
 v_mfma_f32_16x16x32_bf16 v[100:103], a[36:39], a[164:167], v[100:103]
 ds_read_b64_tr_b16 a[14:15], v46 offset:47104
 v_mul_f32 v96, v96, v65
 v_mfma_f32_16x16x32_bf16 v[100:103], a[40:43], a[168:171], v[100:103]
 ds_read_b64_tr_b16 a[16:17], v46 offset:49152
 v_mul_f32 v97, v97, v65
 v_mfma_f32_16x16x32_bf16 v[100:103], a[44:47], a[172:175], v[100:103]
 ds_read_b64_tr_b16 a[18:19], v46 offset:51200
 v_mul_f32 v98, v98, v65
 v_mfma_f32_16x16x32_bf16 v[100:103], a[48:51], a[176:179], v[100:103]
 ds_read_b64_tr_b16 a[20:21], v46 offset:53248
 v_mul_f32 v92, v92, v64
 v_mfma_f32_16x16x32_bf16 v[100:103], a[52:55], a[180:183], v[100:103]
 s_add_u32 m0, s29, 110592
 ds_read_b64_tr_b16 a[22:23], v46 offset:55296
 v_mul_f32 v93, v93, v64
 v_mfma_f32_16x16x32_bf16 v[100:103], a[56:59], a[184:187], v[100:103]
 ds_read_b64_tr_b16 a[24:25], v46 offset:57344
 buffer_load_dwordx4 v2, s[8:11], s81 offen lds
 v_mfma_f32_16x16x32_bf16 v[100:103], a[60:63], a[188:191], v[100:103]
 s_waitcnt lgkmcnt(7)
 ds_read_b64_tr_b16 a[26:27], v46 offset:59392
 v_mul_f32 v94, v94, v64
 v_mfma_f32_16x16x32_bf16 v[104:107], a[0:3], a[128:131], 0
 ds_read_b64_tr_b16 a[28:29], v46 offset:61440
 v_mul_f32 v95, v95, v64
 v_mfma_f32_16x16x32_bf16 v[104:107], a[4:7], a[132:135], v[104:107]
 ds_read_b64_tr_b16 a[30:31], v46 offset:63488
 v_cvt_pk_bf16_f32 v88, v88, v89
 v_mfma_f32_16x16x32_bf16 v[104:107], a[8:11], a[136:139], v[104:107]
 s_waitcnt lgkmcnt(4)
 ds_read_b64_tr_b16 a[32:33], v47 offset:32768
 v_cvt_pk_bf16_f32 v89, v90, v91
 v_mfma_f32_16x16x32_bf16 v[104:107], a[12:15], a[140:143], v[104:107]
 ds_read_b64_tr_b16 a[34:35], v47 offset:34816
 v_cvt_pk_bf16_f32 v90, v92, v93
 v_mfma_f32_16x16x32_bf16 v[104:107], a[16:19], a[144:147], v[104:107]
 s_add_u32 m0, s29, 114688
 ds_read_b64_tr_b16 a[36:37], v47 offset:36864
 v_cvt_pk_bf16_f32 v91, v94, v95
 v_mfma_f32_16x16x32_bf16 v[104:107], a[20:23], a[148:151], v[104:107]
 s_waitcnt lgkmcnt(3)
 ds_read_b64_tr_b16 a[38:39], v47 offset:38912
 buffer_load_dwordx4 v2, s[8:11], s82 offen lds
 v_mfma_f32_16x16x32_bf16 v[104:107], a[24:27], a[152:155], v[104:107]
 s_add_u32 s58, s48, 69632
 ds_read_b64_tr_b16 a[40:41], v47 offset:40960
 v_mul_f32 v99, v99, v65
 v_mfma_f32_16x16x32_bf16 v[104:107], a[28:31], a[156:159], v[104:107]
 ds_read_b64_tr_b16 a[42:43], v47 offset:43008
 buffer_store_dwordx4 v[88:91], v1, s[12:15], s58 offen sc1
 v_mfma_f32_16x16x32_bf16 v[112:115], a[0:3], a[160:163], 0
 ds_read_b64_tr_b16 a[44:45], v47 offset:45056
 v_mul_f32 v100, v100, v65
 v_mfma_f32_16x16x32_bf16 v[112:115], a[4:7], a[164:167], v[112:115]
 ds_read_b64_tr_b16 a[46:47], v47 offset:47104
 v_mul_f32 v101, v101, v65
 v_mfma_f32_16x16x32_bf16 v[112:115], a[8:11], a[168:171], v[112:115]
 ds_read_b64_tr_b16 a[48:49], v47 offset:49152
 v_mul_f32 v102, v102, v65
 v_mfma_f32_16x16x32_bf16 v[112:115], a[12:15], a[172:175], v[112:115]
 s_add_u32 m0, s29, 118784
 ds_read_b64_tr_b16 a[50:51], v47 offset:51200
 v_mul_f32 v103, v103, v65
 v_mfma_f32_16x16x32_bf16 v[112:115], a[16:19], a[176:179], v[112:115]
 ds_read_b64_tr_b16 a[52:53], v47 offset:53248
 buffer_load_dwordx4 v2, s[8:11], s83 offen lds
 v_mfma_f32_16x16x32_bf16 v[112:115], a[20:23], a[180:183], v[112:115]
 ds_read_b64_tr_b16 a[54:55], v47 offset:55296
 v_cvt_pk_bf16_f32 v96, v96, v97
 v_mfma_f32_16x16x32_bf16 v[112:115], a[24:27], a[184:187], v[112:115]
 ds_read_b64_tr_b16 a[56:57], v47 offset:57344
 v_cvt_pk_bf16_f32 v97, v98, v99
 v_mfma_f32_16x16x32_bf16 v[112:115], a[28:31], a[188:191], v[112:115]
 s_waitcnt lgkmcnt(7)
 ds_read_b64_tr_b16 a[58:59], v47 offset:59392
 v_cvt_pk_bf16_f32 v98, v100, v101
 v_mfma_f32_16x16x32_bf16 v[108:111], a[32:35], a[128:131], 0
 s_waitcnt vmcnt(9)
 ds_read_b64_tr_b16 a[60:61], v47 offset:61440
 v_cvt_pk_bf16_f32 v99, v102, v103
 v_mfma_f32_16x16x32_bf16 v[108:111], a[36:39], a[132:135], v[108:111]
 s_barrier
 ds_read_b64_tr_b16 a[62:63], v47 offset:63488
 v_xor_b32 v44, 0x10000, v44
 v_mfma_f32_16x16x32_bf16 v[108:111], a[40:43], a[136:139], v[108:111]
 s_waitcnt lgkmcnt(4)
 ds_read_b64_tr_b16 a[0:1], v44 offset:0
 v_mul_f32 v104, v104, v64
 v_mfma_f32_16x16x32_bf16 v[108:111], a[44:47], a[140:143], v[108:111]
 s_add_u32 m0, s29, 122880
 ds_read_b64_tr_b16 a[2:3], v44 offset:2048
 v_mul_f32 v105, v105, v64
 v_mfma_f32_16x16x32_bf16 v[108:111], a[48:51], a[144:147], v[108:111]
 ds_read_b64_tr_b16 a[4:5], v44 offset:4096
 buffer_load_dwordx4 v2, s[8:11], s84 offen lds
 v_mfma_f32_16x16x32_bf16 v[108:111], a[52:55], a[148:151], v[108:111]
 s_waitcnt lgkmcnt(3)
 ds_read_b64_tr_b16 a[6:7], v44 offset:6144
 v_mul_f32 v106, v106, v64
 v_mfma_f32_16x16x32_bf16 v[108:111], a[56:59], a[152:155], v[108:111]
 s_add_u32 s58, s48, 1044480
 ds_read_b64_tr_b16 a[8:9], v44 offset:8192
 v_mul_f32 v107, v107, v64
 v_mfma_f32_16x16x32_bf16 v[108:111], a[60:63], a[156:159], v[108:111]
 ds_read_b64_tr_b16 a[10:11], v44 offset:10240
 buffer_store_dwordx4 v[96:99], v1, s[12:15], s58 offen sc1
 v_mfma_f32_16x16x32_bf16 v[116:119], a[32:35], a[160:163], 0
 ds_read_b64_tr_b16 a[12:13], v44 offset:12288
 v_mul_f32 v112, v112, v65
 v_mfma_f32_16x16x32_bf16 v[116:119], a[36:39], a[164:167], v[116:119]
 ds_read_b64_tr_b16 a[14:15], v44 offset:14336
 v_mul_f32 v113, v113, v65
 v_mfma_f32_16x16x32_bf16 v[116:119], a[40:43], a[168:171], v[116:119]
 s_add_u32 m0, s29, 126976
 ds_read_b64_tr_b16 a[16:17], v44 offset:16384
 v_mul_f32 v114, v114, v65
 v_mfma_f32_16x16x32_bf16 v[116:119], a[44:47], a[172:175], v[116:119]
 ds_read_b64_tr_b16 a[18:19], v44 offset:18432
 buffer_load_dwordx4 v2, s[8:11], s85 offen lds
 v_mfma_f32_16x16x32_bf16 v[116:119], a[48:51], a[176:179], v[116:119]
 ds_read_b64_tr_b16 a[20:21], v44 offset:20480
 v_add_u32 v2, 128, v2
 v_mfma_f32_16x16x32_bf16 v[116:119], a[52:55], a[180:183], v[116:119]
 ds_read_b64_tr_b16 a[22:23], v44 offset:22528
 v_mul_f32 v108, v108, v64
 v_mfma_f32_16x16x32_bf16 v[116:119], a[56:59], a[184:187], v[116:119]
 ds_read_b64_tr_b16 a[24:25], v44 offset:24576
 v_mul_f32 v109, v109, v64
 v_mfma_f32_16x16x32_bf16 v[116:119], a[60:63], a[188:191], v[116:119]
 s_waitcnt lgkmcnt(7)
 ds_read_b64_tr_b16 a[26:27], v44 offset:26624
 v_mul_f32 v110, v110, v64
 v_mfma_f32_16x16x32_bf16 v[72:75], a[0:3], a[128:131], 0
 ds_read_b64_tr_b16 a[28:29], v44 offset:28672
 v_mul_f32 v111, v111, v64
 v_mfma_f32_16x16x32_bf16 v[72:75], a[4:7], a[132:135], v[72:75]
 ds_read_b64_tr_b16 a[30:31], v44 offset:30720
 v_xor_b32 v45, 0x10000, v45
 v_mfma_f32_16x16x32_bf16 v[72:75], a[8:11], a[136:139], v[72:75]
 s_waitcnt lgkmcnt(4)
 ds_read_b64_tr_b16 a[32:33], v45 offset:0
 v_cvt_pk_bf16_f32 v104, v104, v105
 v_mfma_f32_16x16x32_bf16 v[72:75], a[12:15], a[140:143], v[72:75]
 s_add_u32 m0, s29, 131072
 ds_read_b64_tr_b16 a[34:35], v45 offset:2048
 v_cvt_pk_bf16_f32 v105, v106, v107
 v_mfma_f32_16x16x32_bf16 v[72:75], a[16:19], a[144:147], v[72:75]
 ds_read_b64_tr_b16 a[36:37], v45 offset:4096
 buffer_load_dwordx4 v2, s[8:11], s78 offen lds
 v_mfma_f32_16x16x32_bf16 v[72:75], a[20:23], a[148:151], v[72:75]
 s_waitcnt lgkmcnt(3)
 ds_read_b64_tr_b16 a[38:39], v45 offset:6144
 v_cvt_pk_bf16_f32 v106, v108, v109
 v_mfma_f32_16x16x32_bf16 v[72:75], a[24:27], a[152:155], v[72:75]
 s_add_u32 s58, s48, 87040
 ds_read_b64_tr_b16 a[40:41], v45 offset:8192
 v_cvt_pk_bf16_f32 v107, v110, v111
 v_mfma_f32_16x16x32_bf16 v[72:75], a[28:31], a[156:159], v[72:75]
 ds_read_b64_tr_b16 a[42:43], v45 offset:10240
 buffer_store_dwordx4 v[104:107], v1, s[12:15], s58 offen sc1
 v_mfma_f32_16x16x32_bf16 v[80:83], a[0:3], a[160:163], 0
 ds_read_b64_tr_b16 a[44:45], v45 offset:12288
 v_mul_f32 v115, v115, v65
 v_mfma_f32_16x16x32_bf16 v[80:83], a[4:7], a[164:167], v[80:83]
 ds_read_b64_tr_b16 a[46:47], v45 offset:14336
 v_mul_f32 v116, v116, v65
 v_mfma_f32_16x16x32_bf16 v[80:83], a[8:11], a[168:171], v[80:83]
 s_add_u32 m0, s29, 135168
 ds_read_b64_tr_b16 a[48:49], v45 offset:16384
 v_mul_f32 v117, v117, v65
 v_mfma_f32_16x16x32_bf16 v[80:83], a[12:15], a[172:175], v[80:83]
 ds_read_b64_tr_b16 a[50:51], v45 offset:18432
 buffer_load_dwordx4 v2, s[8:11], s79 offen lds
 v_mfma_f32_16x16x32_bf16 v[80:83], a[16:19], a[176:179], v[80:83]
 ds_read_b64_tr_b16 a[52:53], v45 offset:20480
 v_mul_f32 v118, v118, v65
 v_mfma_f32_16x16x32_bf16 v[80:83], a[20:23], a[180:183], v[80:83]
 ds_read_b64_tr_b16 a[54:55], v45 offset:22528
 v_mul_f32 v119, v119, v65
 v_mfma_f32_16x16x32_bf16 v[80:83], a[24:27], a[184:187], v[80:83]
 ds_read_b64_tr_b16 a[56:57], v45 offset:24576
 v_cvt_pk_bf16_f32 v112, v112, v113
 v_mfma_f32_16x16x32_bf16 v[80:83], a[28:31], a[188:191], v[80:83]
 s_waitcnt lgkmcnt(7)
 ds_read_b64_tr_b16 a[58:59], v45 offset:26624
 v_cvt_pk_bf16_f32 v113, v114, v115
 v_mfma_f32_16x16x32_bf16 v[76:79], a[32:35], a[128:131], 0
 ds_read_b64_tr_b16 a[60:61], v45 offset:28672
 v_cvt_pk_bf16_f32 v114, v116, v117
 v_mfma_f32_16x16x32_bf16 v[76:79], a[36:39], a[132:135], v[76:79]
 s_add_u32 m0, s29, 139264
 ds_read_b64_tr_b16 a[62:63], v45 offset:30720
 v_xor_b32 v46, 0x10000, v46
 v_mfma_f32_16x16x32_bf16 v[76:79], a[40:43], a[136:139], v[76:79]
 s_waitcnt lgkmcnt(4)
 ds_read_b64_tr_b16 a[0:1], v46 offset:0
 buffer_load_dwordx4 v2, s[8:11], s80 offen lds
 v_mfma_f32_16x16x32_bf16 v[76:79], a[44:47], a[140:143], v[76:79]
 s_add_u32 s58, s48, 1061888
 ds_read_b64_tr_b16 a[2:3], v46 offset:2048
 v_cvt_pk_bf16_f32 v115, v118, v119
 v_mfma_f32_16x16x32_bf16 v[76:79], a[48:51], a[144:147], v[76:79]
 ds_read_b64_tr_b16 a[4:5], v46 offset:4096
 buffer_store_dwordx4 v[112:115], v1, s[12:15], s58 offen sc1
 v_mfma_f32_16x16x32_bf16 v[76:79], a[52:55], a[148:151], v[76:79]
 s_waitcnt lgkmcnt(3)
 ds_read_b64_tr_b16 a[6:7], v46 offset:6144
 v_mul_f32 v72, v72, v64
 v_mfma_f32_16x16x32_bf16 v[76:79], a[56:59], a[152:155], v[76:79]
 ds_read_b64_tr_b16 a[8:9], v46 offset:8192
 v_mul_f32 v73, v73, v64
 v_mfma_f32_16x16x32_bf16 v[76:79], a[60:63], a[156:159], v[76:79]
 ds_read_b64_tr_b16 a[10:11], v46 offset:10240
 v_mul_f32 v74, v74, v64
 v_mfma_f32_16x16x32_bf16 v[84:87], a[32:35], a[160:163], 0
 s_add_u32 m0, s29, 143360
 ds_read_b64_tr_b16 a[12:13], v46 offset:12288
 v_mul_f32 v75, v75, v64
 v_mfma_f32_16x16x32_bf16 v[84:87], a[36:39], a[164:167], v[84:87]
 ds_read_b64_tr_b16 a[14:15], v46 offset:14336
 buffer_load_dwordx4 v2, s[8:11], s81 offen lds
 v_mfma_f32_16x16x32_bf16 v[84:87], a[40:43], a[168:171], v[84:87]
 ds_read_b64_tr_b16 a[16:17], v46 offset:16384
 v_mul_f32 v80, v80, v65
 v_mfma_f32_16x16x32_bf16 v[84:87], a[44:47], a[172:175], v[84:87]
 ds_read_b64_tr_b16 a[18:19], v46 offset:18432
 v_mul_f32 v81, v81, v65
 v_mfma_f32_16x16x32_bf16 v[84:87], a[48:51], a[176:179], v[84:87]
 ds_read_b64_tr_b16 a[20:21], v46 offset:20480
 v_mul_f32 v76, v76, v64
 v_mfma_f32_16x16x32_bf16 v[84:87], a[52:55], a[180:183], v[84:87]
 ds_read_b64_tr_b16 a[22:23], v46 offset:22528
 v_mul_f32 v77, v77, v64
 v_mfma_f32_16x16x32_bf16 v[84:87], a[56:59], a[184:187], v[84:87]
 s_add_u32 m0, s29, 147456
 ds_read_b64_tr_b16 a[24:25], v46 offset:24576
 v_mul_f32 v78, v78, v64
 v_mfma_f32_16x16x32_bf16 v[84:87], a[60:63], a[188:191], v[84:87]
 s_waitcnt lgkmcnt(7)
 ds_read_b64_tr_b16 a[26:27], v46 offset:26624
 v_mul_f32 v79, v79, v64
 v_mfma_f32_16x16x32_bf16 v[88:91], a[0:3], a[128:131], 0
 ds_read_b64_tr_b16 a[28:29], v46 offset:28672
 buffer_load_dwordx4 v2, s[8:11], s82 offen lds
 v_mfma_f32_16x16x32_bf16 v[88:91], a[4:7], a[132:135], v[88:91]
 ds_read_b64_tr_b16 a[30:31], v46 offset:30720
 v_xor_b32 v47, 0x10000, v47
 v_mfma_f32_16x16x32_bf16 v[88:91], a[8:11], a[136:139], v[88:91]
 s_waitcnt lgkmcnt(4)
 ds_read_b64_tr_b16 a[32:33], v47 offset:0
 v_cvt_pk_bf16_f32 v72, v72, v73
 v_mfma_f32_16x16x32_bf16 v[88:91], a[12:15], a[140:143], v[88:91]
 ds_read_b64_tr_b16 a[34:35], v47 offset:2048
 v_cvt_pk_bf16_f32 v73, v74, v75
 v_mfma_f32_16x16x32_bf16 v[88:91], a[16:19], a[144:147], v[88:91]
 ds_read_b64_tr_b16 a[36:37], v47 offset:4096
 v_cvt_pk_bf16_f32 v74, v76, v77
 v_mfma_f32_16x16x32_bf16 v[88:91], a[20:23], a[148:151], v[88:91]
 s_waitcnt lgkmcnt(3)
 ds_read_b64_tr_b16 a[38:39], v47 offset:6144
 v_cvt_pk_bf16_f32 v75, v78, v79
 v_mfma_f32_16x16x32_bf16 v[88:91], a[24:27], a[152:155], v[88:91]
 s_add_u32 m0, s29, 151552
 ds_read_b64_tr_b16 a[40:41], v47 offset:8192
 v_mul_f32 v82, v82, v65
 v_mfma_f32_16x16x32_bf16 v[88:91], a[28:31], a[156:159], v[88:91]
 ds_read_b64_tr_b16 a[42:43], v47 offset:10240
 buffer_load_dwordx4 v2, s[8:11], s83 offen lds
 v_mfma_f32_16x16x32_bf16 v[96:99], a[0:3], a[160:163], 0
 s_add_u32 s58, s48, 104448
 ds_read_b64_tr_b16 a[44:45], v47 offset:12288
 v_mul_f32 v83, v83, v65
 v_mfma_f32_16x16x32_bf16 v[96:99], a[4:7], a[164:167], v[96:99]
 ds_read_b64_tr_b16 a[46:47], v47 offset:14336
 buffer_store_dwordx4 v[72:75], v1, s[12:15], s58 offen sc1
 v_mfma_f32_16x16x32_bf16 v[96:99], a[8:11], a[168:171], v[96:99]
 ds_read_b64_tr_b16 a[48:49], v47 offset:16384
 v_mul_f32 v84, v84, v65
 v_mfma_f32_16x16x32_bf16 v[96:99], a[12:15], a[172:175], v[96:99]
 ds_read_b64_tr_b16 a[50:51], v47 offset:18432
 v_mul_f32 v85, v85, v65
 v_mfma_f32_16x16x32_bf16 v[96:99], a[16:19], a[176:179], v[96:99]
 ds_read_b64_tr_b16 a[52:53], v47 offset:20480
 v_mul_f32 v86, v86, v65
 v_mfma_f32_16x16x32_bf16 v[96:99], a[20:23], a[180:183], v[96:99]
 s_add_u32 m0, s29, 155648
 ds_read_b64_tr_b16 a[54:55], v47 offset:22528
 v_mul_f32 v87, v87, v65
 v_mfma_f32_16x16x32_bf16 v[96:99], a[24:27], a[184:187], v[96:99]
 ds_read_b64_tr_b16 a[56:57], v47 offset:24576
 buffer_load_dwordx4 v2, s[8:11], s84 offen lds
 v_mfma_f32_16x16x32_bf16 v[96:99], a[28:31], a[188:191], v[96:99]
 s_waitcnt lgkmcnt(7)
 ds_read_b64_tr_b16 a[58:59], v47 offset:26624
 v_cvt_pk_bf16_f32 v80, v80, v81
 v_mfma_f32_16x16x32_bf16 v[92:95], a[32:35], a[128:131], 0
 s_waitcnt vmcnt(10)
 ds_read_b64_tr_b16 a[60:61], v47 offset:28672
 v_cvt_pk_bf16_f32 v81, v82, v83
 v_mfma_f32_16x16x32_bf16 v[92:95], a[36:39], a[132:135], v[92:95]
 s_barrier
 ds_read_b64_tr_b16 a[62:63], v47 offset:30720
 v_cvt_pk_bf16_f32 v82, v84, v85
 v_mfma_f32_16x16x32_bf16 v[92:95], a[40:43], a[136:139], v[92:95]
 s_waitcnt lgkmcnt(4)
 ds_read_b64_tr_b16 a[0:1], v44 offset:32768
 v_cvt_pk_bf16_f32 v83, v86, v87
 v_mfma_f32_16x16x32_bf16 v[92:95], a[44:47], a[140:143], v[92:95]
 s_lshl_b32 s34, s95, 2
 ds_read_b64_tr_b16 a[2:3], v44 offset:34816
 v_mul_f32 v88, v88, v64
 v_mfma_f32_16x16x32_bf16 v[92:95], a[48:51], a[144:147], v[92:95]
 s_add_u32 m0, s29, 159744
 ds_read_b64_tr_b16 a[4:5], v44 offset:36864
 v_mul_f32 v89, v89, v64
 v_mfma_f32_16x16x32_bf16 v[92:95], a[52:55], a[148:151], v[92:95]
 s_waitcnt lgkmcnt(3)
 ds_read_b64_tr_b16 a[6:7], v44 offset:38912
 buffer_load_dwordx4 v2, s[8:11], s85 offen lds
 v_mfma_f32_16x16x32_bf16 v[92:95], a[56:59], a[152:155], v[92:95]
 s_add_u32 s34, s34, s3
 ds_read_b64_tr_b16 a[8:9], v44 offset:40960
 v_add_u32 v2, 128, v2
 v_mfma_f32_16x16x32_bf16 v[92:95], a[60:63], a[156:159], v[92:95]
 s_mul_i32 s35, s34, 4096
 ds_read_b64_tr_b16 a[10:11], v44 offset:43008
 v_mul_f32 v90, v90, v64
 v_mfma_f32_16x16x32_bf16 v[100:103], a[32:35], a[160:163], 0
 s_lshl_b32 s34, s34, 12
 ds_read_b64_tr_b16 a[12:13], v44 offset:45056
 v_mul_f32 v91, v91, v64
 v_mfma_f32_16x16x32_bf16 v[100:103], a[36:39], a[164:167], v[100:103]
 s_cmp_eq_u32 s62, 0
 s_cmov_b32 s34, 2.0
 s_cmov_b32 s35, 2.0
 ds_read_b64_tr_b16 a[14:15], v44 offset:47104
 v_mfma_f32_16x16x32_bf16 v[100:103], a[40:43], a[168:171], v[100:103]
 s_add_u32 s35, s35, 85983232
 ds_read_b64_tr_b16 a[16:17], v44 offset:49152
 v_mul_f32 v96, v96, v65
 v_mfma_f32_16x16x32_bf16 v[100:103], a[44:47], a[172:175], v[100:103]
 s_mul_i32 s33, s3, 8736
 ds_read_b64_tr_b16 a[18:19], v44 offset:51200
 v_mul_f32 v97, v97, v65
 v_mfma_f32_16x16x32_bf16 v[100:103], a[48:51], a[176:179], v[100:103]
 s_add_u32 s33, s33, 0x10000
 ds_read_b64_tr_b16 a[20:21], v44 offset:53248
 v_mul_f32 v92, v92, v64
 v_mfma_f32_16x16x32_bf16 v[100:103], a[52:55], a[180:183], v[100:103]
 s_mov_b32 s4, s72
 ds_read_b64_tr_b16 a[22:23], v44 offset:55296
 v_mul_f32 v93, v93, v64
 v_mfma_f32_16x16x32_bf16 v[100:103], a[56:59], a[184:187], v[100:103]
 s_mov_b32 s5, s73
 ds_read_b64_tr_b16 a[24:25], v44 offset:57344
 v_mul_f32 v94, v94, v64
 v_mfma_f32_16x16x32_bf16 v[100:103], a[60:63], a[188:191], v[100:103]
 s_waitcnt lgkmcnt(7)
 ds_read_b64_tr_b16 a[26:27], v44 offset:59392
 v_mul_f32 v95, v95, v64
 v_mfma_f32_16x16x32_bf16 v[104:107], a[0:3], a[128:131], 0
 s_mov_b32 s6, 1835008
 ds_read_b64_tr_b16 a[28:29], v44 offset:61440
 v_cvt_pk_bf16_f32 v88, v88, v89
 v_mfma_f32_16x16x32_bf16 v[104:107], a[4:7], a[132:135], v[104:107]
 s_mov_b32 s7, 0x20000
 ds_read_b64_tr_b16 a[30:31], v44 offset:63488
 v_cvt_pk_bf16_f32 v89, v90, v91
 v_mfma_f32_16x16x32_bf16 v[104:107], a[8:11], a[136:139], v[104:107]
 s_waitcnt lgkmcnt(4)
 ds_read_b64_tr_b16 a[32:33], v45 offset:32768
 v_cvt_pk_bf16_f32 v90, v92, v93
 v_mfma_f32_16x16x32_bf16 v[104:107], a[12:15], a[140:143], v[104:107]
 s_add_u32 m0, s29, 0
 ds_read_b64_tr_b16 a[34:35], v45 offset:34816
 v_lshrrev_b32 v10, 1, v0
 v_mfma_f32_16x16x32_bf16 v[104:107], a[16:19], a[144:147], v[104:107]
 ds_read_b64_tr_b16 a[36:37], v45 offset:36864
 buffer_load_dwordx4 v2, s[8:11], s78 offen lds
 v_mfma_f32_16x16x32_bf16 v[104:107], a[20:23], a[148:151], v[104:107]
 s_waitcnt lgkmcnt(3)
 ds_read_b64_tr_b16 a[38:39], v45 offset:38912
 v_lshlrev_b32 v10, 7, v10
 v_mfma_f32_16x16x32_bf16 v[104:107], a[24:27], a[152:155], v[104:107]
 ds_read_b64_tr_b16 a[40:41], v45 offset:40960
 v_cvt_pk_bf16_f32 v91, v94, v95
 v_mfma_f32_16x16x32_bf16 v[104:107], a[28:31], a[156:159], v[104:107]
 s_add_u32 s58, s48, 1079296
 ds_read_b64_tr_b16 a[42:43], v45 offset:43008
 v_and_b32 v11, 1, v0
 v_mfma_f32_16x16x32_bf16 v[112:115], a[0:3], a[160:163], 0
 ds_read_b64_tr_b16 a[44:45], v45 offset:45056
 buffer_store_dwordx4 v[80:83], v1, s[12:15], s58 offen sc1
 v_mfma_f32_16x16x32_bf16 v[112:115], a[4:7], a[164:167], v[112:115]
 ds_read_b64_tr_b16 a[46:47], v45 offset:47104
 v_lshl_add_u32 v10, v11, 4, v10
 v_mfma_f32_16x16x32_bf16 v[112:115], a[8:11], a[168:171], v[112:115]
 s_add_u32 m0, s29, 4096
 ds_read_b64_tr_b16 a[48:49], v45 offset:49152
 v_mul_f32 v98, v98, v65
 v_mfma_f32_16x16x32_bf16 v[112:115], a[12:15], a[172:175], v[112:115]
 ds_read_b64_tr_b16 a[50:51], v45 offset:51200
 buffer_load_dwordx4 v2, s[8:11], s79 offen lds
 v_mfma_f32_16x16x32_bf16 v[112:115], a[16:19], a[176:179], v[112:115]
 s_add_u32 s58, s48, 121856
 ds_read_b64_tr_b16 a[52:53], v45 offset:53248
 v_and_b32 v11, 31, v0
 v_mfma_f32_16x16x32_bf16 v[112:115], a[20:23], a[180:183], v[112:115]
 ds_read_b64_tr_b16 a[54:55], v45 offset:55296
 buffer_store_dwordx4 v[88:91], v1, s[12:15], s58 offen sc1
 v_mfma_f32_16x16x32_bf16 v[112:115], a[24:27], a[184:187], v[112:115]
 ds_read_b64_tr_b16 a[56:57], v45 offset:57344
 v_lshl_add_u32 v11, v11, 2, s33
 v_mfma_f32_16x16x32_bf16 v[112:115], a[28:31], a[188:191], v[112:115]
 s_waitcnt lgkmcnt(7)
 ds_read_b64_tr_b16 a[58:59], v45 offset:59392
 v_mul_f32 v99, v99, v65
 v_mfma_f32_16x16x32_bf16 v[108:111], a[32:35], a[128:131], 0
 ds_read_b64_tr_b16 a[60:61], v45 offset:61440
 v_and_b32 v12, 7, v0
 v_mfma_f32_16x16x32_bf16 v[108:111], a[36:39], a[132:135], v[108:111]
 s_add_u32 m0, s29, 8192
 ds_read_b64_tr_b16 a[62:63], v45 offset:63488
 v_mul_f32 v100, v100, v65
 v_mfma_f32_16x16x32_bf16 v[108:111], a[40:43], a[136:139], v[108:111]
 s_waitcnt lgkmcnt(4)
 ds_read_b64_tr_b16 a[0:1], v46 offset:32768
 buffer_load_dwordx4 v2, s[8:11], s80 offen lds
 v_mfma_f32_16x16x32_bf16 v[108:111], a[44:47], a[140:143], v[108:111]
 ds_read_b64_tr_b16 a[2:3], v46 offset:34816
 v_lshl_add_u32 v12, v12, 2, s33
 v_mfma_f32_16x16x32_bf16 v[108:111], a[48:51], a[144:147], v[108:111]
 ds_read_b64_tr_b16 a[4:5], v46 offset:36864
 v_mul_f32 v101, v101, v65
 v_mfma_f32_16x16x32_bf16 v[108:111], a[52:55], a[148:151], v[108:111]
 s_waitcnt lgkmcnt(3)
 ds_read_b64_tr_b16 a[6:7], v46 offset:38912
 v_mov_b32 v13, 0
 v_mfma_f32_16x16x32_bf16 v[108:111], a[56:59], a[152:155], v[108:111]
 ds_read_b64_tr_b16 a[8:9], v46 offset:40960
 v_mul_f32 v102, v102, v65
 v_mfma_f32_16x16x32_bf16 v[108:111], a[60:63], a[156:159], v[108:111]
 ds_read_b64_tr_b16 a[10:11], v46 offset:43008
 v_mul_f32 v103, v103, v65
 v_mfma_f32_16x16x32_bf16 v[116:119], a[32:35], a[160:163], 0
 s_add_u32 m0, s29, 12288
 ds_read_b64_tr_b16 a[12:13], v46 offset:45056
 v_cvt_pk_bf16_f32 v96, v96, v97
 v_mfma_f32_16x16x32_bf16 v[116:119], a[36:39], a[164:167], v[116:119]
 ds_read_b64_tr_b16 a[14:15], v46 offset:47104
 buffer_load_dwordx4 v2, s[8:11], s81 offen lds
 v_mfma_f32_16x16x32_bf16 v[116:119], a[40:43], a[168:171], v[116:119]
 ds_read_b64_tr_b16 a[16:17], v46 offset:49152
 v_cvt_pk_bf16_f32 v97, v98, v99
 v_mfma_f32_16x16x32_bf16 v[116:119], a[44:47], a[172:175], v[116:119]
 ds_read_b64_tr_b16 a[18:19], v46 offset:51200
 v_cvt_pk_bf16_f32 v98, v100, v101
 v_mfma_f32_16x16x32_bf16 v[116:119], a[48:51], a[176:179], v[116:119]
 s_add_u32 s58, s48, 1096704
 ds_read_b64_tr_b16 a[20:21], v46 offset:53248
 v_cvt_pk_bf16_f32 v99, v102, v103
 v_mfma_f32_16x16x32_bf16 v[116:119], a[52:55], a[180:183], v[116:119]
 ds_read_b64_tr_b16 a[22:23], v46 offset:55296
 buffer_store_dwordx4 v[96:99], v1, s[12:15], s58 offen sc1
 v_mfma_f32_16x16x32_bf16 v[116:119], a[56:59], a[184:187], v[116:119]
 s_add_u32 m0, s29, 16384
 ds_read_b64_tr_b16 a[24:25], v46 offset:57344
 v_mul_f32 v104, v104, v64
 v_mfma_f32_16x16x32_bf16 v[116:119], a[60:63], a[188:191], v[116:119]
 s_waitcnt lgkmcnt(7)
 ds_read_b64_tr_b16 a[26:27], v46 offset:59392
 v_mul_f32 v105, v105, v64
 v_mfma_f32_16x16x32_bf16 v[72:75], a[0:3], a[128:131], 0
 ds_read_b64_tr_b16 a[28:29], v46 offset:61440
 buffer_load_dwordx4 v2, s[8:11], s82 offen lds
 v_mfma_f32_16x16x32_bf16 v[72:75], a[4:7], a[132:135], v[72:75]
 ds_read_b64_tr_b16 a[30:31], v46 offset:63488
 v_mul_f32 v106, v106, v64
 v_mfma_f32_16x16x32_bf16 v[72:75], a[8:11], a[136:139], v[72:75]
 s_waitcnt lgkmcnt(4)
 ds_read_b64_tr_b16 a[32:33], v47 offset:32768
 v_mul_f32 v107, v107, v64
 v_mfma_f32_16x16x32_bf16 v[72:75], a[12:15], a[140:143], v[72:75]
 ds_read_b64_tr_b16 a[34:35], v47 offset:34816
 v_mul_f32 v108, v108, v64
 v_mfma_f32_16x16x32_bf16 v[72:75], a[16:19], a[144:147], v[72:75]
 ds_read_b64_tr_b16 a[36:37], v47 offset:36864
 v_mul_f32 v109, v109, v64
 v_mfma_f32_16x16x32_bf16 v[72:75], a[20:23], a[148:151], v[72:75]
 s_waitcnt lgkmcnt(3)
 ds_read_b64_tr_b16 a[38:39], v47 offset:38912
 v_mul_f32 v110, v110, v64
 v_mfma_f32_16x16x32_bf16 v[72:75], a[24:27], a[152:155], v[72:75]
 s_add_u32 m0, s29, 20480
 ds_read_b64_tr_b16 a[40:41], v47 offset:40960
 v_mul_f32 v111, v111, v64
 v_mfma_f32_16x16x32_bf16 v[72:75], a[28:31], a[156:159], v[72:75]
 ds_read_b64_tr_b16 a[42:43], v47 offset:43008
 buffer_load_dwordx4 v2, s[8:11], s83 offen lds
 v_mfma_f32_16x16x32_bf16 v[80:83], a[0:3], a[160:163], 0
 ds_read_b64_tr_b16 a[44:45], v47 offset:45056
 v_cvt_pk_bf16_f32 v104, v104, v105
 v_mfma_f32_16x16x32_bf16 v[80:83], a[4:7], a[164:167], v[80:83]
 ds_read_b64_tr_b16 a[46:47], v47 offset:47104
 v_cvt_pk_bf16_f32 v105, v106, v107
 v_mfma_f32_16x16x32_bf16 v[80:83], a[8:11], a[168:171], v[80:83]
 ds_read_b64_tr_b16 a[48:49], v47 offset:49152
 v_cvt_pk_bf16_f32 v106, v108, v109
 v_mfma_f32_16x16x32_bf16 v[80:83], a[12:15], a[172:175], v[80:83]
 s_add_u32 s58, s48, 139264
 ds_read_b64_tr_b16 a[50:51], v47 offset:51200
 v_cvt_pk_bf16_f32 v107, v110, v111
 v_mfma_f32_16x16x32_bf16 v[80:83], a[16:19], a[176:179], v[80:83]
 ds_read_b64_tr_b16 a[52:53], v47 offset:53248
 buffer_store_dwordx4 v[104:107], v1, s[12:15], s58 offen sc1
 v_mfma_f32_16x16x32_bf16 v[80:83], a[20:23], a[180:183], v[80:83]
 s_add_u32 m0, s29, 24576
 ds_read_b64_tr_b16 a[54:55], v47 offset:55296
 v_mul_f32 v112, v112, v65
 v_mfma_f32_16x16x32_bf16 v[80:83], a[24:27], a[184:187], v[80:83]
 ds_read_b64_tr_b16 a[56:57], v47 offset:57344
 buffer_load_dwordx4 v2, s[8:11], s84 offen lds
 v_mfma_f32_16x16x32_bf16 v[80:83], a[28:31], a[188:191], v[80:83]
 s_waitcnt lgkmcnt(7)
 ds_read_b64_tr_b16 a[58:59], v47 offset:59392
 v_mul_f32 v113, v113, v65
 v_mfma_f32_16x16x32_bf16 v[76:79], a[32:35], a[128:131], 0
 s_waitcnt vmcnt(9)
 ds_read_b64_tr_b16 a[60:61], v47 offset:61440
 v_mul_f32 v114, v114, v65
 v_mfma_f32_16x16x32_bf16 v[76:79], a[36:39], a[132:135], v[76:79]
 s_barrier
 ds_read_b64_tr_b16 a[62:63], v47 offset:63488
 v_xor_b32 v44, 0x30000, v44
 v_mfma_f32_16x16x32_bf16 v[76:79], a[40:43], a[136:139], v[76:79]
 s_waitcnt lgkmcnt(4)
 ds_read_b64_tr_b16 a[0:1], v44 offset:0
 buffer_store_dword v9, v9, s[12:15], s93 offen offset:64 sc1
 v_mfma_f32_16x16x32_bf16 v[76:79], a[44:47], a[140:143], v[76:79]
 ds_read_b64_tr_b16 a[2:3], v44 offset:2048
 v_mul_f32 v115, v115, v65
 v_mfma_f32_16x16x32_bf16 v[76:79], a[48:51], a[144:147], v[76:79]
 s_add_u32 m0, s29, 28672
 ds_read_b64_tr_b16 a[4:5], v44 offset:4096
 v_mul_f32 v116, v116, v65
 v_mfma_f32_16x16x32_bf16 v[76:79], a[52:55], a[148:151], v[76:79]
 s_waitcnt lgkmcnt(3)
 ds_read_b64_tr_b16 a[6:7], v44 offset:6144
 buffer_load_dwordx4 v2, s[8:11], s85 offen lds
 v_mfma_f32_16x16x32_bf16 v[76:79], a[56:59], a[152:155], v[76:79]
 ds_read_b64_tr_b16 a[8:9], v44 offset:8192
 v_add_u32 v2, 128, v2
 v_mfma_f32_16x16x32_bf16 v[76:79], a[60:63], a[156:159], v[76:79]
 ds_read_b64_tr_b16 a[10:11], v44 offset:10240
 v_mul_f32 v117, v117, v65
 v_mfma_f32_16x16x32_bf16 v[84:87], a[32:35], a[160:163], 0
 ds_read_b64_tr_b16 a[12:13], v44 offset:12288
 v_mul_f32 v118, v118, v65
 v_mfma_f32_16x16x32_bf16 v[84:87], a[36:39], a[164:167], v[84:87]
 ds_read_b64_tr_b16 a[14:15], v44 offset:14336
 v_mul_f32 v119, v119, v65
 v_mfma_f32_16x16x32_bf16 v[84:87], a[40:43], a[168:171], v[84:87]
 ds_read_b64_tr_b16 a[16:17], v44 offset:16384
 v_cvt_pk_bf16_f32 v112, v112, v113
 v_mfma_f32_16x16x32_bf16 v[84:87], a[44:47], a[172:175], v[84:87]
 s_waitcnt lgkmcnt(9)
 ds_read_b64_tr_b16 a[18:19], v44 offset:18432
 v_cvt_pk_bf16_f32 v113, v114, v115
 v_mfma_f32_16x16x32_bf16 v[84:87], a[48:51], a[176:179], v[84:87]
 s_barrier
 ds_read_b64_tr_b16 a[20:21], v44 offset:20480
 v_cvt_pk_bf16_f32 v114, v116, v117
 v_mfma_f32_16x16x32_bf16 v[84:87], a[52:55], a[180:183], v[84:87]
 s_add_u32 m0, s33, 4640
 ds_read_b64_tr_b16 a[22:23], v44 offset:22528
 v_cvt_pk_bf16_f32 v115, v118, v119
 v_mfma_f32_16x16x32_bf16 v[84:87], a[56:59], a[184:187], v[84:87]
 ds_read_b64_tr_b16 a[24:25], v44 offset:24576
 buffer_load_dwordx4 v1, s[4:7], s34 offen offset:0 lds
 v_mfma_f32_16x16x32_bf16 v[84:87], a[60:63], a[188:191], v[84:87]
 s_waitcnt lgkmcnt(7)
 ds_read_b64_tr_b16 a[26:27], v44 offset:26624
 v_mul_f32 v72, v72, v64
 v_mfma_f32_16x16x32_bf16 v[88:91], a[0:3], a[128:131], 0
 ds_read_b64_tr_b16 a[28:29], v44 offset:28672
 v_mul_f32 v73, v73, v64
 v_mfma_f32_16x16x32_bf16 v[88:91], a[4:7], a[132:135], v[88:91]
 s_add_u32 s58, s48, 1114112
 ds_read_b64_tr_b16 a[30:31], v44 offset:30720
 v_xor_b32 v45, 0x30000, v45
 v_mfma_f32_16x16x32_bf16 v[88:91], a[8:11], a[136:139], v[88:91]
 s_waitcnt lgkmcnt(4)
 ds_read_b64_tr_b16 a[32:33], v45 offset:0
 buffer_store_dwordx4 v[112:115], v1, s[12:15], s58 offen sc1
 v_mfma_f32_16x16x32_bf16 v[88:91], a[12:15], a[140:143], v[88:91]
 ds_read_b64_tr_b16 a[34:35], v45 offset:2048
 v_mul_f32 v74, v74, v64
 v_mfma_f32_16x16x32_bf16 v[88:91], a[16:19], a[144:147], v[88:91]
 ds_read_b64_tr_b16 a[36:37], v45 offset:4096
 v_mul_f32 v75, v75, v64
 v_mfma_f32_16x16x32_bf16 v[88:91], a[20:23], a[148:151], v[88:91]
 s_waitcnt lgkmcnt(3)
 ds_read_b64_tr_b16 a[38:39], v45 offset:6144
 buffer_load_dwordx4 v1, s[4:7], s34 offen offset:1024 lds
 v_mfma_f32_16x16x32_bf16 v[88:91], a[24:27], a[152:155], v[88:91]
 ds_read_b64_tr_b16 a[40:41], v45 offset:8192
 v_mul_f32 v76, v76, v64
 v_mfma_f32_16x16x32_bf16 v[88:91], a[28:31], a[156:159], v[88:91]
 ds_read_b64_tr_b16 a[42:43], v45 offset:10240
 v_mul_f32 v77, v77, v64
 v_mfma_f32_16x16x32_bf16 v[96:99], a[0:3], a[160:163], 0
 ds_read_b64_tr_b16 a[44:45], v45 offset:12288
 v_mul_f32 v78, v78, v64
 v_mfma_f32_16x16x32_bf16 v[96:99], a[4:7], a[164:167], v[96:99]
 ds_read_b64_tr_b16 a[46:47], v45 offset:14336
 v_mul_f32 v79, v79, v64
 v_mfma_f32_16x16x32_bf16 v[96:99], a[8:11], a[168:171], v[96:99]
 ds_read_b64_tr_b16 a[48:49], v45 offset:16384
 v_cvt_pk_bf16_f32 v72, v72, v73
 v_mfma_f32_16x16x32_bf16 v[96:99], a[12:15], a[172:175], v[96:99]
 ds_read_b64_tr_b16 a[50:51], v45 offset:18432
 v_cvt_pk_bf16_f32 v73, v74, v75
 v_mfma_f32_16x16x32_bf16 v[96:99], a[16:19], a[176:179], v[96:99]
 ds_read_b64_tr_b16 a[52:53], v45 offset:20480
 buffer_load_dwordx4 v1, s[4:7], s34 offen offset:2048 lds
 v_mfma_f32_16x16x32_bf16 v[96:99], a[20:23], a[180:183], v[96:99]
 ds_read_b64_tr_b16 a[54:55], v45 offset:22528
 v_cvt_pk_bf16_f32 v74, v76, v77
 v_mfma_f32_16x16x32_bf16 v[96:99], a[24:27], a[184:187], v[96:99]
 s_add_u32 s58, s48, 156672
 ds_read_b64_tr_b16 a[56:57], v45 offset:24576
 v_cvt_pk_bf16_f32 v75, v78, v79
 v_mfma_f32_16x16x32_bf16 v[96:99], a[28:31], a[188:191], v[96:99]
 s_waitcnt lgkmcnt(7)
 ds_read_b64_tr_b16 a[58:59], v45 offset:26624
 buffer_store_dwordx4 v[72:75], v1, s[12:15], s58 offen sc1
 v_mfma_f32_16x16x32_bf16 v[92:95], a[32:35], a[128:131], 0
 ds_read_b64_tr_b16 a[60:61], v45 offset:28672
 v_mul_f32 v80, v80, v65
 v_mfma_f32_16x16x32_bf16 v[92:95], a[36:39], a[132:135], v[92:95]
 ds_read_b64_tr_b16 a[62:63], v45 offset:30720
 v_xor_b32 v46, 0x30000, v46
 v_mfma_f32_16x16x32_bf16 v[92:95], a[40:43], a[136:139], v[92:95]
 s_waitcnt lgkmcnt(4)
 ds_read_b64_tr_b16 a[0:1], v46 offset:0
 v_mul_f32 v81, v81, v65
 v_mfma_f32_16x16x32_bf16 v[92:95], a[44:47], a[140:143], v[92:95]
 ds_read_b64_tr_b16 a[2:3], v46 offset:2048
 buffer_load_dwordx4 v1, s[4:7], s34 offen offset:3072 lds
 v_mfma_f32_16x16x32_bf16 v[92:95], a[48:51], a[144:147], v[92:95]
 ds_read_b64_tr_b16 a[4:5], v46 offset:4096
 v_mul_f32 v82, v82, v65
 v_mfma_f32_16x16x32_bf16 v[92:95], a[52:55], a[148:151], v[92:95]
 s_waitcnt lgkmcnt(3)
 ds_read_b64_tr_b16 a[6:7], v46 offset:6144
 v_mul_f32 v83, v83, v65
 v_mfma_f32_16x16x32_bf16 v[92:95], a[56:59], a[152:155], v[92:95]
 ds_read_b64_tr_b16 a[8:9], v46 offset:8192
 v_mul_f32 v84, v84, v65
 v_mfma_f32_16x16x32_bf16 v[92:95], a[60:63], a[156:159], v[92:95]
 ds_read_b64_tr_b16 a[10:11], v46 offset:10240
 v_mul_f32 v85, v85, v65
 v_mfma_f32_16x16x32_bf16 v[100:103], a[32:35], a[160:163], 0
 ds_read_b64_tr_b16 a[12:13], v46 offset:12288
 v_mul_f32 v86, v86, v65
 v_mfma_f32_16x16x32_bf16 v[100:103], a[36:39], a[164:167], v[100:103]
 s_add_u32 m0, s33, 128
 ds_read_b64_tr_b16 a[14:15], v46 offset:14336
 v_mul_f32 v87, v87, v65
 v_mfma_f32_16x16x32_bf16 v[100:103], a[40:43], a[168:171], v[100:103]
 ds_read_b64_tr_b16 a[16:17], v46 offset:16384
 buffer_load_dwordx4 v10, s[12:15], s35 offen offset:0 sc1 lds
 v_mfma_f32_16x16x32_bf16 v[100:103], a[44:47], a[172:175], v[100:103]
 ds_read_b64_tr_b16 a[18:19], v46 offset:18432
 v_cvt_pk_bf16_f32 v80, v80, v81
 v_mfma_f32_16x16x32_bf16 v[100:103], a[48:51], a[176:179], v[100:103]
 ds_read_b64_tr_b16 a[20:21], v46 offset:20480
 v_cvt_pk_bf16_f32 v81, v82, v83
 v_mfma_f32_16x16x32_bf16 v[100:103], a[52:55], a[180:183], v[100:103]
 ds_read_b64_tr_b16 a[22:23], v46 offset:22528
 v_cvt_pk_bf16_f32 v82, v84, v85
 v_mfma_f32_16x16x32_bf16 v[100:103], a[56:59], a[184:187], v[100:103]
 s_add_u32 s58, s48, 1131520
 ds_read_b64_tr_b16 a[24:25], v46 offset:24576
 v_cvt_pk_bf16_f32 v83, v86, v87
 v_mfma_f32_16x16x32_bf16 v[100:103], a[60:63], a[188:191], v[100:103]
 s_waitcnt lgkmcnt(7)
 ds_read_b64_tr_b16 a[26:27], v46 offset:26624
 buffer_store_dwordx4 v[80:83], v1, s[12:15], s58 offen sc1
 v_mfma_f32_16x16x32_bf16 v[104:107], a[0:3], a[128:131], 0
 ds_read_b64_tr_b16 a[28:29], v46 offset:28672
 v_mul_f32 v88, v88, v64
 v_mfma_f32_16x16x32_bf16 v[104:107], a[4:7], a[132:135], v[104:107]
 s_add_u32 m0, s33, 1248
 ds_read_b64_tr_b16 a[30:31], v46 offset:30720
 v_xor_b32 v47, 0x30000, v47
 v_mfma_f32_16x16x32_bf16 v[104:107], a[8:11], a[136:139], v[104:107]
 s_waitcnt lgkmcnt(4)
 ds_read_b64_tr_b16 a[32:33], v47 offset:0
 buffer_load_dwordx4 v10, s[12:15], s35 offen offset:32 sc1 lds
 v_mfma_f32_16x16x32_bf16 v[104:107], a[12:15], a[140:143], v[104:107]
 ds_read_b64_tr_b16 a[34:35], v47 offset:2048
 v_mul_f32 v89, v89, v64
 v_mfma_f32_16x16x32_bf16 v[104:107], a[16:19], a[144:147], v[104:107]
 ds_read_b64_tr_b16 a[36:37], v47 offset:4096
 v_mul_f32 v90, v90, v64
 v_mfma_f32_16x16x32_bf16 v[104:107], a[20:23], a[148:151], v[104:107]
 s_waitcnt lgkmcnt(3)
 ds_read_b64_tr_b16 a[38:39], v47 offset:6144
 v_mul_f32 v91, v91, v64
 v_mfma_f32_16x16x32_bf16 v[104:107], a[24:27], a[152:155], v[104:107]
 ds_read_b64_tr_b16 a[40:41], v47 offset:8192
 v_mul_f32 v92, v92, v64
 v_mfma_f32_16x16x32_bf16 v[104:107], a[28:31], a[156:159], v[104:107]
 ds_read_b64_tr_b16 a[42:43], v47 offset:10240
 v_mul_f32 v93, v93, v64
 v_mfma_f32_16x16x32_bf16 v[112:115], a[0:3], a[160:163], 0
 s_add_u32 m0, s33, 2368
 ds_read_b64_tr_b16 a[44:45], v47 offset:12288
 v_mul_f32 v94, v94, v64
 v_mfma_f32_16x16x32_bf16 v[112:115], a[4:7], a[164:167], v[112:115]
 ds_read_b64_tr_b16 a[46:47], v47 offset:14336
 buffer_load_dwordx4 v10, s[12:15], s35 offen offset:64 sc1 lds
 v_mfma_f32_16x16x32_bf16 v[112:115], a[8:11], a[168:171], v[112:115]
 ds_read_b64_tr_b16 a[48:49], v47 offset:16384
 v_mul_f32 v95, v95, v64
 v_mfma_f32_16x16x32_bf16 v[112:115], a[12:15], a[172:175], v[112:115]
 ds_read_b64_tr_b16 a[50:51], v47 offset:18432
 v_cvt_pk_bf16_f32 v88, v88, v89
 v_mfma_f32_16x16x32_bf16 v[112:115], a[16:19], a[176:179], v[112:115]
 ds_read_b64_tr_b16 a[52:53], v47 offset:20480
 v_cvt_pk_bf16_f32 v89, v90, v91
 v_mfma_f32_16x16x32_bf16 v[112:115], a[20:23], a[180:183], v[112:115]
 ds_read_b64_tr_b16 a[54:55], v47 offset:22528
 v_cvt_pk_bf16_f32 v90, v92, v93
 v_mfma_f32_16x16x32_bf16 v[112:115], a[24:27], a[184:187], v[112:115]
 s_add_u32 m0, s33, 3488
 ds_read_b64_tr_b16 a[56:57], v47 offset:24576
 v_cvt_pk_bf16_f32 v91, v94, v95
 v_mfma_f32_16x16x32_bf16 v[112:115], a[28:31], a[188:191], v[112:115]
 s_waitcnt lgkmcnt(7)
 ds_read_b64_tr_b16 a[58:59], v47 offset:26624
 v_mul_f32 v96, v96, v65
 v_mfma_f32_16x16x32_bf16 v[108:111], a[32:35], a[128:131], 0
 s_waitcnt vmcnt(10)
 ds_read_b64_tr_b16 a[60:61], v47 offset:28672
 buffer_load_dwordx4 v10, s[12:15], s35 offen offset:96 sc1 lds
 v_mfma_f32_16x16x32_bf16 v[108:111], a[36:39], a[132:135], v[108:111]
 s_barrier
 ds_read_b64_tr_b16 a[62:63], v47 offset:30720
 v_xor_b32 v44, 0x20000, v44
 v_mfma_f32_16x16x32_bf16 v[108:111], a[40:43], a[136:139], v[108:111]
 s_waitcnt lgkmcnt(4)
 ds_read_b64_tr_b16 a[0:1], v44 offset:0
 v_mul_f32 v97, v97, v65
 v_mfma_f32_16x16x32_bf16 v[108:111], a[44:47], a[140:143], v[108:111]
 s_add_u32 s58, s48, 174080
 ds_read_b64_tr_b16 a[2:3], v44 offset:2048
 v_mul_f32 v98, v98, v65
 v_mfma_f32_16x16x32_bf16 v[108:111], a[48:51], a[144:147], v[108:111]
 ds_read_b64_tr_b16 a[4:5], v44 offset:4096
 buffer_store_dwordx4 v[88:91], v1, s[12:15], s58 offen sc1
 v_mfma_f32_16x16x32_bf16 v[108:111], a[52:55], a[148:151], v[108:111]
 s_waitcnt lgkmcnt(3)
 ds_read_b64_tr_b16 a[6:7], v44 offset:6144
 v_mul_f32 v99, v99, v65
 v_mfma_f32_16x16x32_bf16 v[108:111], a[56:59], a[152:155], v[108:111]
 ds_read_b64_tr_b16 a[8:9], v44 offset:8192
 v_mul_f32 v100, v100, v65
 v_mfma_f32_16x16x32_bf16 v[108:111], a[60:63], a[156:159], v[108:111]
 ds_read_b64_tr_b16 a[10:11], v44 offset:10240
 v_mul_f32 v101, v101, v65
 v_mfma_f32_16x16x32_bf16 v[116:119], a[32:35], a[160:163], 0
 ds_read_b64_tr_b16 a[12:13], v44 offset:12288
 v_mul_f32 v102, v102, v65
 v_mfma_f32_16x16x32_bf16 v[116:119], a[36:39], a[164:167], v[116:119]
 ds_read_b64_tr_b16 a[14:15], v44 offset:14336
 v_mul_f32 v103, v103, v65
 v_mfma_f32_16x16x32_bf16 v[116:119], a[40:43], a[168:171], v[116:119]
 ds_read_b64_tr_b16 a[16:17], v44 offset:16384
 v_cvt_pk_bf16_f32 v96, v96, v97
 v_mfma_f32_16x16x32_bf16 v[116:119], a[44:47], a[172:175], v[116:119]
 ds_read_b64_tr_b16 a[18:19], v44 offset:18432
 v_cvt_pk_bf16_f32 v97, v98, v99
 v_mfma_f32_16x16x32_bf16 v[116:119], a[48:51], a[176:179], v[116:119]
 ds_read_b64_tr_b16 a[20:21], v44 offset:20480
 v_cvt_pk_bf16_f32 v98, v100, v101
 v_mfma_f32_16x16x32_bf16 v[116:119], a[52:55], a[180:183], v[116:119]
 s_add_u32 s58, s48, 1148928
 ds_read_b64_tr_b16 a[22:23], v44 offset:22528
 v_cvt_pk_bf16_f32 v99, v102, v103
 v_mfma_f32_16x16x32_bf16 v[116:119], a[56:59], a[184:187], v[116:119]
 ds_read_b64_tr_b16 a[24:25], v44 offset:24576
 buffer_store_dwordx4 v[96:99], v1, s[12:15], s58 offen sc1
 v_mfma_f32_16x16x32_bf16 v[116:119], a[60:63], a[188:191], v[116:119]
 s_waitcnt lgkmcnt(7)
 ds_read_b64_tr_b16 a[26:27], v44 offset:26624
 v_mul_f32 v104, v104, v64
 v_mfma_f32_16x16x32_bf16 v[72:75], a[0:3], a[128:131], 0
 ds_read_b64_tr_b16 a[28:29], v44 offset:28672
 v_mul_f32 v105, v105, v64
 v_mfma_f32_16x16x32_bf16 v[72:75], a[4:7], a[132:135], v[72:75]
 ds_read_b64_tr_b16 a[30:31], v44 offset:30720
 v_xor_b32 v45, 0x20000, v45
 v_mfma_f32_16x16x32_bf16 v[72:75], a[8:11], a[136:139], v[72:75]
 s_waitcnt lgkmcnt(4)
 ds_read_b64_tr_b16 a[32:33], v45 offset:0
 v_mul_f32 v106, v106, v64
 v_mfma_f32_16x16x32_bf16 v[72:75], a[12:15], a[140:143], v[72:75]
 ds_read_b64_tr_b16 a[34:35], v45 offset:2048
 v_mul_f32 v107, v107, v64
 v_mfma_f32_16x16x32_bf16 v[72:75], a[16:19], a[144:147], v[72:75]
 ds_read_b64_tr_b16 a[36:37], v45 offset:4096
 v_mul_f32 v108, v108, v64
 v_mfma_f32_16x16x32_bf16 v[72:75], a[20:23], a[148:151], v[72:75]
 s_waitcnt lgkmcnt(3)
 ds_read_b64_tr_b16 a[38:39], v45 offset:6144
 v_mul_f32 v109, v109, v64
 v_mfma_f32_16x16x32_bf16 v[72:75], a[24:27], a[152:155], v[72:75]
 ds_read_b64_tr_b16 a[40:41], v45 offset:8192
 v_mul_f32 v110, v110, v64
 v_mfma_f32_16x16x32_bf16 v[72:75], a[28:31], a[156:159], v[72:75]
 ds_read_b64_tr_b16 a[42:43], v45 offset:10240
 v_mul_f32 v111, v111, v64
 v_mfma_f32_16x16x32_bf16 v[80:83], a[0:3], a[160:163], 0
 ds_read_b64_tr_b16 a[44:45], v45 offset:12288
 v_cvt_pk_bf16_f32 v104, v104, v105
 v_mfma_f32_16x16x32_bf16 v[80:83], a[4:7], a[164:167], v[80:83]
 ds_read_b64_tr_b16 a[46:47], v45 offset:14336
 v_cvt_pk_bf16_f32 v105, v106, v107
 v_mfma_f32_16x16x32_bf16 v[80:83], a[8:11], a[168:171], v[80:83]
 ds_read_b64_tr_b16 a[48:49], v45 offset:16384
 v_cvt_pk_bf16_f32 v106, v108, v109
 v_mfma_f32_16x16x32_bf16 v[80:83], a[12:15], a[172:175], v[80:83]
 s_add_u32 s58, s48, 191488
 ds_read_b64_tr_b16 a[50:51], v45 offset:18432
 v_cvt_pk_bf16_f32 v107, v110, v111
 v_mfma_f32_16x16x32_bf16 v[80:83], a[16:19], a[176:179], v[80:83]
 ds_read_b64_tr_b16 a[52:53], v45 offset:20480
 buffer_store_dwordx4 v[104:107], v1, s[12:15], s58 offen sc1
 v_mfma_f32_16x16x32_bf16 v[80:83], a[20:23], a[180:183], v[80:83]
 ds_read_b64_tr_b16 a[54:55], v45 offset:22528
 v_mul_f32 v112, v112, v65
 v_mfma_f32_16x16x32_bf16 v[80:83], a[24:27], a[184:187], v[80:83]
 ds_read_b64_tr_b16 a[56:57], v45 offset:24576
 v_mul_f32 v113, v113, v65
 v_mfma_f32_16x16x32_bf16 v[80:83], a[28:31], a[188:191], v[80:83]
 s_waitcnt lgkmcnt(7)
 ds_read_b64_tr_b16 a[58:59], v45 offset:26624
 v_mul_f32 v114, v114, v65
 v_mfma_f32_16x16x32_bf16 v[76:79], a[32:35], a[128:131], 0
 ds_read_b64_tr_b16 a[60:61], v45 offset:28672
 v_mul_f32 v115, v115, v65
 v_mfma_f32_16x16x32_bf16 v[76:79], a[36:39], a[132:135], v[76:79]
 ds_read_b64_tr_b16 a[62:63], v45 offset:30720
 v_xor_b32 v46, 0x20000, v46
 v_mfma_f32_16x16x32_bf16 v[76:79], a[40:43], a[136:139], v[76:79]
 s_waitcnt lgkmcnt(4)
 ds_read_b64_tr_b16 a[0:1], v46 offset:0
 v_mul_f32 v116, v116, v65
 v_mfma_f32_16x16x32_bf16 v[76:79], a[44:47], a[140:143], v[76:79]
 ds_read_b64_tr_b16 a[2:3], v46 offset:2048
 v_mul_f32 v117, v117, v65
 v_mfma_f32_16x16x32_bf16 v[76:79], a[48:51], a[144:147], v[76:79]
 ds_read_b64_tr_b16 a[4:5], v46 offset:4096
 v_mul_f32 v118, v118, v65
 v_mfma_f32_16x16x32_bf16 v[76:79], a[52:55], a[148:151], v[76:79]
 s_waitcnt lgkmcnt(3)
 ds_read_b64_tr_b16 a[6:7], v46 offset:6144
 v_mul_f32 v119, v119, v65
 v_mfma_f32_16x16x32_bf16 v[76:79], a[56:59], a[152:155], v[76:79]
 ds_read_b64_tr_b16 a[8:9], v46 offset:8192
 v_cvt_pk_bf16_f32 v112, v112, v113
 v_mfma_f32_16x16x32_bf16 v[76:79], a[60:63], a[156:159], v[76:79]
 ds_read_b64_tr_b16 a[10:11], v46 offset:10240
 v_cvt_pk_bf16_f32 v113, v114, v115
 v_mfma_f32_16x16x32_bf16 v[84:87], a[32:35], a[160:163], 0
 ds_read_b64_tr_b16 a[12:13], v46 offset:12288
 v_cvt_pk_bf16_f32 v114, v116, v117
 v_mfma_f32_16x16x32_bf16 v[84:87], a[36:39], a[164:167], v[84:87]
 s_add_u32 s58, s48, 1166336
 ds_read_b64_tr_b16 a[14:15], v46 offset:14336
 v_cvt_pk_bf16_f32 v115, v118, v119
 v_mfma_f32_16x16x32_bf16 v[84:87], a[40:43], a[168:171], v[84:87]
 ds_read_b64_tr_b16 a[16:17], v46 offset:16384
 buffer_store_dwordx4 v[112:115], v1, s[12:15], s58 offen sc1
 v_mfma_f32_16x16x32_bf16 v[84:87], a[44:47], a[172:175], v[84:87]
 ds_read_b64_tr_b16 a[18:19], v46 offset:18432
 v_mul_f32 v72, v72, v64
 v_mfma_f32_16x16x32_bf16 v[84:87], a[48:51], a[176:179], v[84:87]
 ds_read_b64_tr_b16 a[20:21], v46 offset:20480
 v_mul_f32 v73, v73, v64
 v_mfma_f32_16x16x32_bf16 v[84:87], a[52:55], a[180:183], v[84:87]
 ds_read_b64_tr_b16 a[22:23], v46 offset:22528
 v_mul_f32 v74, v74, v64
 v_mfma_f32_16x16x32_bf16 v[84:87], a[56:59], a[184:187], v[84:87]
 ds_read_b64_tr_b16 a[24:25], v46 offset:24576
 v_mul_f32 v75, v75, v64
 v_mfma_f32_16x16x32_bf16 v[84:87], a[60:63], a[188:191], v[84:87]
 s_waitcnt lgkmcnt(7)
 ds_read_b64_tr_b16 a[26:27], v46 offset:26624
 v_mul_f32 v76, v76, v64
 v_mfma_f32_16x16x32_bf16 v[88:91], a[0:3], a[128:131], 0
 ds_read_b64_tr_b16 a[28:29], v46 offset:28672
 v_mul_f32 v77, v77, v64
 v_mfma_f32_16x16x32_bf16 v[88:91], a[4:7], a[132:135], v[88:91]
 ds_read_b64_tr_b16 a[30:31], v46 offset:30720
 v_xor_b32 v47, 0x20000, v47
 v_mfma_f32_16x16x32_bf16 v[88:91], a[8:11], a[136:139], v[88:91]
 s_waitcnt lgkmcnt(4)
 ds_read_b64_tr_b16 a[32:33], v47 offset:0
 v_mul_f32 v78, v78, v64
 v_mfma_f32_16x16x32_bf16 v[88:91], a[12:15], a[140:143], v[88:91]
 ds_read_b64_tr_b16 a[34:35], v47 offset:2048
 v_mul_f32 v79, v79, v64
 v_mfma_f32_16x16x32_bf16 v[88:91], a[16:19], a[144:147], v[88:91]
 ds_read_b64_tr_b16 a[36:37], v47 offset:4096
 v_cvt_pk_bf16_f32 v72, v72, v73
 v_mfma_f32_16x16x32_bf16 v[88:91], a[20:23], a[148:151], v[88:91]
 s_waitcnt lgkmcnt(3)
 ds_read_b64_tr_b16 a[38:39], v47 offset:6144
 v_cvt_pk_bf16_f32 v73, v74, v75
 v_mfma_f32_16x16x32_bf16 v[88:91], a[24:27], a[152:155], v[88:91]
 ds_read_b64_tr_b16 a[40:41], v47 offset:8192
 v_cvt_pk_bf16_f32 v74, v76, v77
 v_mfma_f32_16x16x32_bf16 v[88:91], a[28:31], a[156:159], v[88:91]
 s_add_u32 s58, s48, 208896
 ds_read_b64_tr_b16 a[42:43], v47 offset:10240
 v_cvt_pk_bf16_f32 v75, v78, v79
 v_mfma_f32_16x16x32_bf16 v[96:99], a[0:3], a[160:163], 0
 ds_read_b64_tr_b16 a[44:45], v47 offset:12288
 buffer_store_dwordx4 v[72:75], v1, s[12:15], s58 offen sc1
 v_mfma_f32_16x16x32_bf16 v[96:99], a[4:7], a[164:167], v[96:99]
 ds_read_b64_tr_b16 a[46:47], v47 offset:14336
 v_mul_f32 v80, v80, v65
 v_mfma_f32_16x16x32_bf16 v[96:99], a[8:11], a[168:171], v[96:99]
 ds_read_b64_tr_b16 a[48:49], v47 offset:16384
 v_mul_f32 v81, v81, v65
 v_mfma_f32_16x16x32_bf16 v[96:99], a[12:15], a[172:175], v[96:99]
 ds_read_b64_tr_b16 a[50:51], v47 offset:18432
 v_mul_f32 v82, v82, v65
 v_mfma_f32_16x16x32_bf16 v[96:99], a[16:19], a[176:179], v[96:99]
 ds_read_b64_tr_b16 a[52:53], v47 offset:20480
 v_mul_f32 v83, v83, v65
 v_mfma_f32_16x16x32_bf16 v[96:99], a[20:23], a[180:183], v[96:99]
 ds_read_b64_tr_b16 a[54:55], v47 offset:22528
 v_mul_f32 v84, v84, v65
 v_mfma_f32_16x16x32_bf16 v[96:99], a[24:27], a[184:187], v[96:99]
 ds_read_b64_tr_b16 a[56:57], v47 offset:24576
 v_mul_f32 v85, v85, v65
 v_mfma_f32_16x16x32_bf16 v[96:99], a[28:31], a[188:191], v[96:99]
 s_waitcnt lgkmcnt(7)
 ds_read_b64_tr_b16 a[58:59], v47 offset:26624
 v_mul_f32 v86, v86, v65
 v_mfma_f32_16x16x32_bf16 v[92:95], a[32:35], a[128:131], 0
 ds_read_b64_tr_b16 a[60:61], v47 offset:28672
 v_mul_f32 v87, v87, v65
 v_mfma_f32_16x16x32_bf16 v[92:95], a[36:39], a[132:135], v[92:95]
 ds_read_b64_tr_b16 a[62:63], v47 offset:30720
 v_cvt_pk_bf16_f32 v80, v80, v81
 v_mfma_f32_16x16x32_bf16 v[92:95], a[40:43], a[136:139], v[92:95]
 s_waitcnt lgkmcnt(4)
 v_cvt_pk_bf16_f32 v81, v82, v83
 v_cvt_pk_bf16_f32 v82, v84, v85
 v_mfma_f32_16x16x32_bf16 v[92:95], a[44:47], a[140:143], v[92:95]
 s_add_u32 s58, s48, 1183744
 ds_write_b32 v11, v13 offset:0
 v_cvt_pk_bf16_f32 v83, v86, v87
 v_mul_f32 v88, v88, v64
 v_mfma_f32_16x16x32_bf16 v[92:95], a[48:51], a[144:147], v[92:95]
 ds_write_b32 v11, v13 offset:1152
 buffer_store_dwordx4 v[80:83], v1, s[12:15], s58 offen sc1
 v_mfma_f32_16x16x32_bf16 v[92:95], a[52:55], a[148:151], v[92:95]
 s_waitcnt lgkmcnt(0)
 ds_write_b32 v11, v13 offset:2304
 v_mul_f32 v89, v89, v64
 v_mul_f32 v90, v90, v64
 v_mfma_f32_16x16x32_bf16 v[92:95], a[56:59], a[152:155], v[92:95]
 ds_write_b32 v11, v13 offset:3456
 v_mul_f32 v91, v91, v64
 v_mul_f32 v96, v96, v65
 v_mfma_f32_16x16x32_bf16 v[92:95], a[60:63], a[156:159], v[92:95]
 ds_write_b32 v12, v13 offset:4608
 v_mul_f32 v97, v97, v65
 v_mul_f32 v98, v98, v65
 v_mfma_f32_16x16x32_bf16 v[100:103], a[32:35], a[160:163], 0
 v_mul_f32 v99, v99, v65
 v_mfma_f32_16x16x32_bf16 v[100:103], a[36:39], a[164:167], v[100:103]
 v_mfma_f32_16x16x32_bf16 v[100:103], a[40:43], a[168:171], v[100:103]
 v_mfma_f32_16x16x32_bf16 v[100:103], a[44:47], a[172:175], v[100:103]
 v_mfma_f32_16x16x32_bf16 v[100:103], a[48:51], a[176:179], v[100:103]
 v_mfma_f32_16x16x32_bf16 v[100:103], a[52:55], a[180:183], v[100:103]
 v_mfma_f32_16x16x32_bf16 v[100:103], a[56:59], a[184:187], v[100:103]
 v_mfma_f32_16x16x32_bf16 v[100:103], a[60:63], a[188:191], v[100:103]
 s_nop 4
 v_mul_f32 v92, v92, v64
 v_mul_f32 v93, v93, v64
 v_mul_f32 v94, v94, v64
 v_mul_f32 v95, v95, v64
 v_cvt_pk_bf16_f32 v88, v88, v89
 v_cvt_pk_bf16_f32 v89, v90, v91
 v_cvt_pk_bf16_f32 v90, v92, v93
 v_cvt_pk_bf16_f32 v91, v94, v95
 s_add_u32 s58, s48, 226304
 buffer_store_dwordx4 v[88:91], v1, s[12:15], s58 offen sc1
 v_mul_f32 v100, v100, v65
 v_mul_f32 v101, v101, v65
 v_mul_f32 v102, v102, v65
 v_mul_f32 v103, v103, v65
 v_cvt_pk_bf16_f32 v96, v96, v97
 v_cvt_pk_bf16_f32 v97, v98, v99
 v_cvt_pk_bf16_f32 v98, v100, v101
 v_cvt_pk_bf16_f32 v99, v102, v103
 s_add_u32 s58, s48, 1201152
 buffer_store_dwordx4 v[96:99], v1, s[12:15], s58 offen sc1
 s_cmp_eq_u32 s62, 0
 s_cbranch_scc1 L_nossm
 v_and_b32 v22, 15, v0
 v_lshrrev_b32 v23, 4, v0
 v_lshl_add_u32 v18, v22, 3, s33
 v_lshl_add_u32 v16, v23, 4, v18
 v_lshl_add_u32 v18, v23, 1, v18
 v_and_b32 v17, 3, v0
 v_bfe_u32 v24, v0, 2, 2
 v_sub_u32 v17, v17, v24
 v_lshlrev_b32 v24, 3, v23
 v_sub_u32 v17, v17, v24
 v_add_u32 v17, 32, v17
 v_lshl_add_u32 v17, v17, 3, s33
 v_lshlrev_b32 v20, 5, v22
 v_lshl_add_u32 v20, v23, 3, v20
 v_add_u32 v24, -1, v0
 v_and_b32 v24, 15, v24
 v_add_u32 v24, 48, v24
 v_add_u32 v19, -16, v0
 v_cmp_gt_u32 vcc, 16, v0
 v_accvgpr_read_b32 v21, a245
 s_add_u32 s34, s35, 4194304
 v_cndmask_b32 v19, v19, v24, vcc
 v_lshlrev_b32 v19, 2, v19
 v_cmp_eq_u32 vcc, 63, v0
 s_lshl_b32 s30, s31, 16
 s_and_b32 s31, s31, 0xffff0000
 s_bitcmp1_b32 s3, 0
 s_cselect_b32 s31, s31, s30
 v_mov_b64 v[224:225], 0
 v_mov_b64 v[226:227], 0
 v_mov_b64 v[228:229], 0
 v_mov_b64 v[230:231], 0
 v_mov_b64 v[232:233], 0
 v_mov_b64 v[234:235], 0
 v_mov_b64 v[236:237], 0
 v_mov_b64 v[238:239], 0
 v_mov_b64 v[240:241], 0
 v_mov_b64 v[242:243], 0
 v_mov_b64 v[244:245], 0
 v_mov_b64 v[246:247], 0
 v_mov_b64 v[248:249], 0
 v_mov_b64 v[250:251], 0
 v_mov_b64 v[252:253], 0
 v_mov_b64 v[254:255], 0
 s_waitcnt vmcnt(8) lgkmcnt(0)
 ds_read_b64_tr_b16 v[160:161], v17 offset:4608
 ds_read_b64_tr_b16 v[162:163], v17 offset:4576
 ds_read_b64_tr_b16 v[164:165], v17 offset:4864
 ds_read_b64_tr_b16 v[166:167], v17 offset:4832
 ds_read_b64 a[4:5], v16 offset:72
 ds_read_b64 a[6:7], v16 offset:80
 ds_read_b64 a[0:1], v16 offset:8
 ds_read_b64 a[2:3], v16 offset:16
 s_waitcnt lgkmcnt(6)
 ds_read_b64 a[68:69], v16 offset:1224
 ds_read_b64 a[70:71], v16 offset:1232
 ds_read_b64 a[64:65], v16 offset:1160
 ds_read_b64 a[66:67], v16 offset:1168
 ds_read_b64 a[132:133], v16 offset:2376
 ds_read_b64 a[134:135], v16 offset:2384
 ds_read_b64 a[128:129], v16 offset:2312
 ds_read_b64 a[130:131], v16 offset:2320
 s_waitcnt lgkmcnt(6)
 ds_read_b64 a[196:197], v16 offset:3528
 ds_read_b64 a[198:199], v16 offset:3536
 ds_read_b64 a[192:193], v16 offset:3464
 ds_read_b64 a[194:195], v16 offset:3472
 ds_read_b64_tr_b16 v[168:169], v17 offset:5120
 ds_read_b64_tr_b16 v[170:171], v17 offset:5088
 ds_read_b64_tr_b16 v[172:173], v17 offset:5376
 ds_read_b64_tr_b16 v[174:175], v17 offset:5344
 s_waitcnt lgkmcnt(6)
 ds_read_b64 a[12:13], v16 offset:200
 ds_read_b64 a[14:15], v16 offset:208
 ds_read_b64 a[8:9], v16 offset:136
 ds_read_b64 a[10:11], v16 offset:144
 ds_read_b64 a[76:77], v16 offset:1352
 ds_read_b64 a[78:79], v16 offset:1360
 ds_read_b64 a[72:73], v16 offset:1288
 ds_read_b64 a[74:75], v16 offset:1296
 s_waitcnt lgkmcnt(6)
 ds_read_b64 a[140:141], v16 offset:2504
 ds_read_b64 a[142:143], v16 offset:2512
 ds_read_b64 a[136:137], v16 offset:2440
 ds_read_b64 a[138:139], v16 offset:2448
 ds_read_b64 a[204:205], v16 offset:3656
 ds_read_b64 a[206:207], v16 offset:3664
 ds_read_b64 a[200:201], v16 offset:3592
 ds_read_b64 a[202:203], v16 offset:3600
 s_waitcnt lgkmcnt(6)
 ds_read_b64_tr_b16 v[176:177], v17 offset:5632
 ds_read_b64_tr_b16 v[178:179], v17 offset:5600
 ds_read_b64_tr_b16 v[180:181], v17 offset:5888
 ds_read_b64_tr_b16 v[182:183], v17 offset:5856
 s_waitcnt lgkmcnt(0)
 v_mfma_f32_16x16x32_bf16 v[32:35], v[160:163], a[4:7], 0
 ds_read_b64 a[20:21], v16 offset:328
 v_mfma_f32_16x16x32_bf16 v[32:35], v[164:167], a[0:3], v[32:35]
 ds_read_b64 a[22:23], v16 offset:336
 v_mfma_f32_16x16x32_bf16 v[36:39], v[160:163], a[68:71], 0
 ds_read_b64 a[16:17], v16 offset:264
 v_mfma_f32_16x16x32_bf16 v[36:39], v[164:167], a[64:67], v[36:39]
 ds_read_b64 a[18:19], v16 offset:272
 v_mfma_f32_16x16x32_bf16 v[40:43], v[160:163], a[132:135], 0
 ds_read_b64 a[84:85], v16 offset:1480
 v_mfma_f32_16x16x32_bf16 v[40:43], v[164:167], a[128:131], v[40:43]
 s_waitcnt vmcnt(0)
 ds_read_b64 a[86:87], v16 offset:1488
 v_mfma_f32_16x16x32_bf16 v[44:47], v[160:163], a[196:199], 0
 s_barrier
 ds_read_b64 a[80:81], v16 offset:1416
 v_mfma_f32_16x16x32_bf16 v[44:47], v[164:167], a[192:195], v[44:47]
 ds_read_b64 a[82:83], v16 offset:1424
 buffer_store_dword v21, v21, s[12:15], s93 offen sc1
 v_mfma_f32_16x16x32_bf16 v[48:51], v[160:163], a[12:15], 0
 ds_read_b64 a[148:149], v16 offset:2632
 v_mfma_f32_16x16x32_bf16 v[48:51], v[164:167], a[8:11], v[48:51]
 ds_read_b64 a[150:151], v16 offset:2640
 v_mfma_f32_16x16x32_bf16 v[48:51], v[168:171], a[4:7], v[48:51]
 ds_read_b64 a[144:145], v16 offset:2568
 v_and_b32 v2, 15, v0
 v_mfma_f32_16x16x32_bf16 v[48:51], v[172:175], a[0:3], v[48:51]
 ds_read_b64 a[146:147], v16 offset:2576
 v_lshlrev_b32 v11, 2, v2
 v_mfma_f32_16x16x32_bf16 v[52:55], v[160:163], a[76:79], 0
 ds_read_b64 a[212:213], v16 offset:3784
 v_mul_u32_u24 v7, 896, v2
 v_mfma_f32_16x16x32_bf16 v[52:55], v[164:167], a[72:75], v[52:55]
 ds_read_b64 a[214:215], v16 offset:3792
 v_lshrrev_b32 v3, 4, v0
 v_mfma_f32_16x16x32_bf16 v[52:55], v[168:171], a[68:71], v[52:55]
 ds_read_b64 a[208:209], v16 offset:3720
 v_lshlrev_b32 v8, 4, v3
 v_mfma_f32_16x16x32_bf16 v[52:55], v[172:175], a[64:67], v[52:55]
 ds_read_b64 a[210:211], v16 offset:3728
 v_lshl_add_u32 v2, v7, 1, v8
 v_mfma_f32_16x16x32_bf16 v[56:59], v[160:163], a[140:143], 0
 ds_read_b64_tr_b16 v[184:185], v17 offset:6144
 v_add_u32 v7, v7, v8
 v_mfma_f32_16x16x32_bf16 v[56:59], v[164:167], a[136:139], v[56:59]
 ds_read_b64_tr_b16 v[186:187], v17 offset:6112
 v_and_b32 v4, 1, v0
 v_mfma_f32_16x16x32_bf16 v[56:59], v[168:171], a[132:135], v[56:59]
 ds_read_b64_tr_b16 v[188:189], v17 offset:6400
 v_lshlrev_b32 v4, 4, v4
 v_mfma_f32_16x16x32_bf16 v[56:59], v[172:175], a[128:131], v[56:59]
 ds_read_b64_tr_b16 v[190:191], v17 offset:6368
 v_mov_b32 v5, 0x3f80
 v_mfma_f32_16x16x32_bf16 v[60:63], v[160:163], a[204:207], 0
 ds_read_b64 a[28:29], v16 offset:456
 v_lshlrev_b32 v4, v4, v5
 v_mfma_f32_16x16x32_bf16 v[60:63], v[164:167], a[200:203], v[60:63]
 ds_read_b64 a[30:31], v16 offset:464
 v_bfe_u32 v5, v0, 3, 1
 v_mfma_f32_16x16x32_bf16 v[60:63], v[168:171], a[196:199], v[60:63]
 ds_read_b64 a[24:25], v16 offset:392
 v_bfe_u32 v6, v0, 1, 1
 v_mfma_f32_16x16x32_bf16 v[60:63], v[172:175], a[192:195], v[60:63]
 s_waitcnt lgkmcnt(15)
 ds_read_b64 a[26:27], v16 offset:400
 v_lshl_add_u32 v5, v5, 1, v6
 v_mfma_f32_16x16x32_bf16 v[64:67], v[160:163], a[20:23], 0
 ds_read_b64 a[92:93], v16 offset:1608
 v_bfe_u32 v6, v0, 2, 1
 v_mfma_f32_16x16x32_bf16 v[64:67], v[164:167], a[16:19], v[64:67]
 ds_read_b64 a[94:95], v16 offset:1616
 v_lshlrev_b32 v6, 1, v6
 v_mfma_f32_16x16x32_bf16 v[64:67], v[168:171], a[12:15], v[64:67]
 ds_read_b64 a[88:89], v16 offset:1544
 v_sub_u32 v6, v3, v6
 v_mfma_f32_16x16x32_bf16 v[64:67], v[172:175], a[8:11], v[64:67]
 ds_read_b64 a[90:91], v16 offset:1552
 v_lshl_add_u32 v5, v6, 2, v5
 v_mfma_f32_16x16x32_bf16 v[64:67], v[176:179], a[4:7], v[64:67]
 ds_read_b64 a[156:157], v16 offset:2760
 v_cmp_eq_u32 s[16:17], 0, v5
 v_mfma_f32_16x16x32_bf16 v[64:67], v[180:183], a[0:3], v[64:67]
 ds_read_b64 a[158:159], v16 offset:2768
 v_cmp_eq_u32 s[18:19], 1, v5
 v_mfma_f32_16x16x32_bf16 v[68:71], v[160:163], a[84:87], 0
 ds_read_b64 a[152:153], v16 offset:2696
 v_cmp_eq_u32 s[20:21], 2, v5
 v_mfma_f32_16x16x32_bf16 v[68:71], v[164:167], a[80:83], v[68:71]
 ds_read_b64 a[154:155], v16 offset:2704
 v_cmp_eq_u32 s[22:23], 3, v5
 v_mfma_f32_16x16x32_bf16 v[68:71], v[168:171], a[76:79], v[68:71]
 ds_read_b64 a[220:221], v16 offset:3912
 v_cndmask_b32 v24, 0, v4, s[16:17]
 v_mfma_f32_16x16x32_bf16 v[68:71], v[172:175], a[72:75], v[68:71]
 ds_read_b64 a[222:223], v16 offset:3920
 v_cndmask_b32 v25, 0, v4, s[18:19]
 v_mfma_f32_16x16x32_bf16 v[68:71], v[176:179], a[68:71], v[68:71]
 ds_read_b64 a[216:217], v16 offset:3848
 v_cndmask_b32 v26, 0, v4, s[20:21]
 v_mfma_f32_16x16x32_bf16 v[68:71], v[180:183], a[64:67], v[68:71]
 s_waitcnt lgkmcnt(15)
 ds_read_b64 a[218:219], v16 offset:3856
 v_cndmask_b32 v27, 0, v4, s[22:23]
 v_mfma_f32_16x16x32_bf16 v[72:75], v[160:163], a[148:151], 0
 ds_read_b64_tr_b16 v[192:193], v17 offset:6656
 v_cmp_eq_u32 s[16:17], 4, v5
 v_mfma_f32_16x16x32_bf16 v[72:75], v[164:167], a[144:147], v[72:75]
 ds_read_b64_tr_b16 v[194:195], v17 offset:6624
 v_cmp_eq_u32 s[18:19], 5, v5
 v_mfma_f32_16x16x32_bf16 v[72:75], v[168:171], a[140:143], v[72:75]
 ds_read_b64_tr_b16 v[196:197], v17 offset:6912
 v_cmp_eq_u32 s[20:21], 6, v5
 v_mfma_f32_16x16x32_bf16 v[72:75], v[172:175], a[136:139], v[72:75]
 ds_read_b64_tr_b16 v[198:199], v17 offset:6880
 v_cmp_eq_u32 s[22:23], 7, v5
 v_mfma_f32_16x16x32_bf16 v[72:75], v[176:179], a[132:135], v[72:75]
 ds_read_b64 a[36:37], v16 offset:584
 v_cndmask_b32 v28, 0, v4, s[16:17]
 v_mfma_f32_16x16x32_bf16 v[72:75], v[180:183], a[128:131], v[72:75]
 ds_read_b64 a[38:39], v16 offset:592
 v_cndmask_b32 v29, 0, v4, s[18:19]
 v_mfma_f32_16x16x32_bf16 v[76:79], v[160:163], a[212:215], 0
 ds_read_b64 a[32:33], v16 offset:520
 v_cndmask_b32 v30, 0, v4, s[20:21]
 v_mfma_f32_16x16x32_bf16 v[76:79], v[164:167], a[208:211], v[76:79]
 ds_read_b64 a[34:35], v16 offset:528
 v_cndmask_b32 v31, 0, v4, s[22:23]
 v_mfma_f32_16x16x32_bf16 v[76:79], v[168:171], a[204:207], v[76:79]
 s_mov_b32 s8, s88
 ds_read_b64 a[100:101], v16 offset:1736
 v_mfma_f32_16x16x32_bf16 v[76:79], v[172:175], a[200:203], v[76:79]
 s_mov_b32 s9, s89
 ds_read_b64 a[102:103], v16 offset:1744
 v_mfma_f32_16x16x32_bf16 v[76:79], v[176:179], a[196:199], v[76:79]
 s_mov_b32 s10, 3670016
 ds_read_b64 a[96:97], v16 offset:1672
 v_mfma_f32_16x16x32_bf16 v[76:79], v[180:183], a[192:195], v[76:79]
 s_waitcnt lgkmcnt(15)
 ds_read_b64 a[98:99], v16 offset:1680
 v_mfma_f32_16x16x32_bf16 v[80:83], v[160:163], a[28:31], 0
 s_mov_b32 s11, 0x20000
 ds_read_b64 a[164:165], v16 offset:2888
 v_mfma_f32_16x16x32_bf16 v[80:83], v[164:167], a[24:27], v[80:83]
 s_mov_b32 s16, s64
 ds_read_b64 a[166:167], v16 offset:2896
 v_mfma_f32_16x16x32_bf16 v[80:83], v[168:171], a[20:23], v[80:83]
 s_mov_b32 s17, s65
 ds_read_b64 a[160:161], v16 offset:2824
 v_mfma_f32_16x16x32_bf16 v[80:83], v[172:175], a[16:19], v[80:83]
 s_mov_b32 s18, 1835008
 ds_read_b64 a[162:163], v16 offset:2832
 v_mfma_f32_16x16x32_bf16 v[80:83], v[176:179], a[12:15], v[80:83]
 s_mov_b32 s19, 0x20000
 ds_read_b64 a[228:229], v16 offset:4040
 v_mfma_f32_16x16x32_bf16 v[80:83], v[180:183], a[8:11], v[80:83]
 s_lshl_b32 s58, s3, 12
 ds_read_b64 a[230:231], v16 offset:4048
 v_mfma_f32_16x16x32_bf16 v[80:83], v[184:187], a[4:7], v[80:83]
 s_add_u32 s58, s58, 0x20000
 ds_read_b64 a[224:225], v16 offset:3976
 v_mfma_f32_16x16x32_bf16 v[80:83], v[188:191], a[0:3], v[80:83]
 s_mov_b32 s59, 0xffff0000
 ds_read_b64 a[226:227], v16 offset:3984
 v_lshrrev_b32 v8, 1, v0
 v_mfma_f32_16x16x32_bf16 v[84:87], v[160:163], a[92:95], 0
 ds_read_b64_tr_b16 v[200:201], v17 offset:7168
 v_mul_u32_u24 v8, 4096, v8
 v_mfma_f32_16x16x32_bf16 v[84:87], v[164:167], a[88:91], v[84:87]
 ds_read_b64_tr_b16 v[202:203], v17 offset:7136
 v_and_b32 v6, 1, v0
 v_mfma_f32_16x16x32_bf16 v[84:87], v[168:171], a[84:87], v[84:87]
 ds_read_b64_tr_b16 v[204:205], v17 offset:7424
 v_lshl_add_u32 v8, v6, 4, v8
 v_mfma_f32_16x16x32_bf16 v[84:87], v[172:175], a[80:83], v[84:87]
 ds_read_b64_tr_b16 v[206:207], v17 offset:7392
 v_lshlrev_b32 v10, 3, v3
 v_mfma_f32_16x16x32_bf16 v[84:87], v[176:179], a[76:79], v[84:87]
 ds_read_b64 a[44:45], v16 offset:712
 v_bfe_u32 v6, v0, 2, 2
 v_mfma_f32_16x16x32_bf16 v[84:87], v[180:183], a[72:75], v[84:87]
 ds_read_b64 a[46:47], v16 offset:720
 v_add_u32 v10, v10, v6
 v_mfma_f32_16x16x32_bf16 v[84:87], v[184:187], a[68:71], v[84:87]
 ds_read_b64 a[40:41], v16 offset:648
 v_lshlrev_b32 v10, 5, v10
 v_mfma_f32_16x16x32_bf16 v[84:87], v[188:191], a[64:67], v[84:87]
 ds_read_b64 a[42:43], v16 offset:656
 v_and_b32 v6, 3, v0
 v_mfma_f32_16x16x32_bf16 v[88:91], v[160:163], a[156:159], 0
 ds_read_b64 a[108:109], v16 offset:1864
 v_lshl_add_u32 v10, v6, 3, v10
 v_mfma_f32_16x16x32_bf16 v[88:91], v[164:167], a[152:155], v[88:91]
 ds_read_b64 a[110:111], v16 offset:1872
 v_add_u32 v10, s58, v10
 v_mfma_f32_16x16x32_bf16 v[88:91], v[168:171], a[148:151], v[88:91]
 ds_read_b64 a[104:105], v16 offset:1800
 v_mov_b32 v5, 0x24000
 v_mfma_f32_16x16x32_bf16 v[88:91], v[172:175], a[144:147], v[88:91]
 ds_read_b64 a[106:107], v16 offset:1808
 v_lshrrev_b32 v4, 2, v0
 v_mfma_f32_16x16x32_bf16 v[88:91], v[176:179], a[140:143], v[88:91]
 ds_read_b64 a[172:173], v16 offset:3016
 v_lshl_add_u32 v11, v6, 4, v4
 v_mfma_f32_16x16x32_bf16 v[88:91], v[180:183], a[136:139], v[88:91]
 ds_read_b64 a[174:175], v16 offset:3024
 v_lshlrev_b32 v11, 2, v11
 v_mfma_f32_16x16x32_bf16 v[88:91], v[184:187], a[132:135], v[88:91]
 ds_read_b64 a[168:169], v16 offset:2952
 v_mul_u32_u24 v7, 896, v4
 v_mfma_f32_16x16x32_bf16 v[88:91], v[188:191], a[128:131], v[88:91]
 s_waitcnt lgkmcnt(15)
 ds_read_b64 a[170:171], v16 offset:2960
 v_lshlrev_b32 v6, 4, v6
 v_mfma_f32_16x16x32_bf16 v[92:95], v[160:163], a[220:223], 0
 ds_read_b64 a[236:237], v16 offset:4168
 v_lshl_add_u32 v3, v7, 1, v6
 v_mfma_f32_16x16x32_bf16 v[92:95], v[164:167], a[216:219], v[92:95]
 ds_read_b64 a[238:239], v16 offset:4176
 v_add_u32 v7, v7, v6
 v_mfma_f32_16x16x32_bf16 v[92:95], v[168:171], a[212:215], v[92:95]
 s_bfe_u32 s40, s2, 0x20003
 ds_read_b64 a[232:233], v16 offset:4104
 v_mfma_f32_16x16x32_bf16 v[92:95], v[172:175], a[208:211], v[92:95]
 s_lshl_b32 s38, s40, 12
 ds_read_b64 a[234:235], v16 offset:4112
 v_mfma_f32_16x16x32_bf16 v[92:95], v[176:179], a[204:207], v[92:95]
 s_add_u32 s38, s38, 84967424
 ds_read_b64_tr_b16 v[208:209], v17 offset:7680
 v_mfma_f32_16x16x32_bf16 v[92:95], v[180:183], a[200:203], v[92:95]
 s_lshl_b32 s93, s95, 2
 ds_read_b64_tr_b16 v[210:211], v17 offset:7648
 v_mfma_f32_16x16x32_bf16 v[92:95], v[184:187], a[196:199], v[92:95]
 s_add_u32 s93, s93, 84963328
 ds_read_b64_tr_b16 v[212:213], v17 offset:7936
 v_mfma_f32_16x16x32_bf16 v[92:95], v[188:191], a[192:195], v[92:95]
 ds_read_b64_tr_b16 v[214:215], v17 offset:7904
 v_mfma_f32_16x16x32_bf16 v[96:99], v[160:163], a[36:39], 0
 ds_read_b64 a[52:53], v16 offset:840
 v_mfma_f32_16x16x32_bf16 v[96:99], v[164:167], a[32:35], v[96:99]
 ds_read_b64 a[54:55], v16 offset:848
 v_mfma_f32_16x16x32_bf16 v[96:99], v[168:171], a[28:31], v[96:99]
 ds_read_b64 a[48:49], v16 offset:776
 v_mfma_f32_16x16x32_bf16 v[96:99], v[172:175], a[24:27], v[96:99]
 ds_read_b64 a[50:51], v16 offset:784
 v_mfma_f32_16x16x32_bf16 v[96:99], v[176:179], a[20:23], v[96:99]
 ds_read_b64 a[116:117], v16 offset:1992
 v_mfma_f32_16x16x32_bf16 v[96:99], v[180:183], a[16:19], v[96:99]
 ds_read_b64 a[118:119], v16 offset:2000
 v_mfma_f32_16x16x32_bf16 v[96:99], v[184:187], a[12:15], v[96:99]
 ds_read_b64 a[112:113], v16 offset:1928
 v_add_f32 v39, v39, v42
 v_mfma_f32_16x16x32_bf16 v[96:99], v[188:191], a[8:11], v[96:99]
 ds_read_b64 a[114:115], v16 offset:1936
 v_add_f32 v43, v43, v46
 v_mfma_f32_16x16x32_bf16 v[96:99], v[192:195], a[4:7], v[96:99]
 ds_read_b64 a[180:181], v16 offset:3144
 v_add_f32 v39, v39, v45
 v_mfma_f32_16x16x32_bf16 v[96:99], v[196:199], a[0:3], v[96:99]
 ds_read_b64 a[182:183], v16 offset:3152
 v_cndmask_b32_e64 v224, v39, 0, vcc
 v_mfma_f32_16x16x32_bf16 v[100:103], v[160:163], a[100:103], 0
 ds_read_b64 a[176:177], v16 offset:3080
 v_cndmask_b32_e64 v225, v43, 0, vcc
 v_mfma_f32_16x16x32_bf16 v[100:103], v[164:167], a[96:99], v[100:103]
 ds_read_b64 a[178:179], v16 offset:3088
 v_cndmask_b32_e64 v226, v47, 0, vcc
 v_mfma_f32_16x16x32_bf16 v[100:103], v[168:171], a[92:95], v[100:103]
 ds_read_b64 a[244:245], v16 offset:4296
 v_add_f32 v33, v33, v36
 v_mfma_f32_16x16x32_bf16 v[100:103], v[172:175], a[88:91], v[100:103]
 ds_read_b64 a[246:247], v16 offset:4304
 v_add_f32 v34, v34, v37
 v_mfma_f32_16x16x32_bf16 v[100:103], v[176:179], a[84:87], v[100:103]
 ds_read_b64 a[240:241], v16 offset:4232
 v_add_f32 v35, v35, v38
 v_mfma_f32_16x16x32_bf16 v[100:103], v[180:183], a[80:83], v[100:103]
 ds_read_b64 a[242:243], v16 offset:4240
 v_add_f32 v34, v34, v40
 v_mfma_f32_16x16x32_bf16 v[100:103], v[184:187], a[76:79], v[100:103]
 ds_read_b64_tr_b16 v[216:217], v17 offset:8192
 v_add_f32 v35, v35, v41
 v_mfma_f32_16x16x32_bf16 v[100:103], v[188:191], a[72:75], v[100:103]
 ds_read_b64_tr_b16 v[218:219], v17 offset:8160
 v_add_f32 v35, v35, v44
 v_mfma_f32_16x16x32_bf16 v[100:103], v[192:195], a[68:71], v[100:103]
 ds_read_b64_tr_b16 v[220:221], v17 offset:8448
 v_add_f32 v55, v55, v58
 v_mfma_f32_16x16x32_bf16 v[100:103], v[196:199], a[64:67], v[100:103]
 ds_read_b64_tr_b16 v[222:223], v17 offset:8416
 v_add_f32 v59, v59, v62
 v_mfma_f32_16x16x32_bf16 v[104:107], v[160:163], a[164:167], 0
 ds_read_b64 a[60:61], v16 offset:968
 v_add_f32 v55, v55, v61
 v_mfma_f32_16x16x32_bf16 v[104:107], v[164:167], a[160:163], v[104:107]
 ds_read_b64 a[62:63], v16 offset:976
 v_cndmask_b32_e64 v232, v55, v39, vcc
 v_mfma_f32_16x16x32_bf16 v[104:107], v[168:171], a[156:159], v[104:107]
 ds_read_b64 a[56:57], v16 offset:904
 v_cndmask_b32_e64 v233, v59, v43, vcc
 v_mfma_f32_16x16x32_bf16 v[104:107], v[172:175], a[152:155], v[104:107]
 ds_read_b64 a[58:59], v16 offset:912
 v_cndmask_b32_e64 v234, v63, v47, vcc
 v_mfma_f32_16x16x32_bf16 v[104:107], v[176:179], a[148:151], v[104:107]
 ds_read_b64 a[124:125], v16 offset:2120
 v_add_f32 v49, v49, v52
 v_mfma_f32_16x16x32_bf16 v[104:107], v[180:183], a[144:147], v[104:107]
 ds_read_b64 a[126:127], v16 offset:2128
 v_add_f32 v50, v50, v53
 v_mfma_f32_16x16x32_bf16 v[104:107], v[184:187], a[140:143], v[104:107]
 ds_read_b64 a[120:121], v16 offset:2056
 v_add_f32 v51, v51, v54
 v_mfma_f32_16x16x32_bf16 v[104:107], v[188:191], a[136:139], v[104:107]
 ds_read_b64 a[122:123], v16 offset:2064
 v_add_f32 v50, v50, v56
 v_mfma_f32_16x16x32_bf16 v[104:107], v[192:195], a[132:135], v[104:107]
 ds_read_b64 a[188:189], v16 offset:3272
 v_add_f32 v51, v51, v57
 v_mfma_f32_16x16x32_bf16 v[104:107], v[196:199], a[128:131], v[104:107]
 ds_read_b64 a[190:191], v16 offset:3280
 v_add_f32 v51, v51, v60
 v_mfma_f32_16x16x32_bf16 v[108:111], v[160:163], a[228:231], 0
 ds_read_b64 a[184:185], v16 offset:3208
 v_add_f32 v71, v71, v74
 v_mfma_f32_16x16x32_bf16 v[108:111], v[164:167], a[224:227], v[108:111]
 ds_read_b64 a[186:187], v16 offset:3216
 v_add_f32 v75, v75, v78
 v_mfma_f32_16x16x32_bf16 v[108:111], v[168:171], a[220:223], v[108:111]
 ds_read_b64 v[12:13], v16 offset:4424
 v_add_f32 v71, v71, v77
 v_mfma_f32_16x16x32_bf16 v[108:111], v[172:175], a[216:219], v[108:111]
 ds_read_b64 v[14:15], v16 offset:4432
 v_cndmask_b32_e64 v240, v71, v55, vcc
 v_mfma_f32_16x16x32_bf16 v[108:111], v[176:179], a[212:215], v[108:111]
 ds_read_b64 a[248:249], v16 offset:4360
 v_cndmask_b32_e64 v241, v75, v59, vcc
 v_mfma_f32_16x16x32_bf16 v[108:111], v[180:183], a[208:211], v[108:111]
 ds_read_b64 a[250:251], v16 offset:4368
 v_cndmask_b32_e64 v242, v79, v63, vcc
 v_mfma_f32_16x16x32_bf16 v[108:111], v[184:187], a[204:207], v[108:111]
 ds_bpermute_b32 v224, v19, v224
 v_add_f32 v65, v65, v68
 v_mfma_f32_16x16x32_bf16 v[108:111], v[188:191], a[200:203], v[108:111]
 ds_bpermute_b32 v225, v19, v225
 v_add_f32 v66, v66, v69
 v_mfma_f32_16x16x32_bf16 v[108:111], v[192:195], a[196:199], v[108:111]
 ds_bpermute_b32 v226, v19, v226
 v_add_f32 v67, v67, v70
 v_mfma_f32_16x16x32_bf16 v[108:111], v[196:199], a[192:195], v[108:111]
 s_waitcnt lgkmcnt(15)
 ds_read_u16_d16_hi v228, v18 offset:128
 v_add_f32 v66, v66, v72
 v_mfma_f32_16x16x32_bf16 v[112:115], v[160:163], a[44:47], 0
 ds_read_u16_d16_hi v229, v18 offset:1280
 v_add_f32 v67, v67, v73
 v_mfma_f32_16x16x32_bf16 v[112:115], v[164:167], a[40:43], v[112:115]
 ds_read_u16_d16_hi v230, v18 offset:2432
 v_add_f32 v67, v67, v76
 v_mfma_f32_16x16x32_bf16 v[112:115], v[168:171], a[36:39], v[112:115]
 ds_read_u16_d16_hi v231, v18 offset:3584
 v_add_f32 v87, v87, v90
 v_mfma_f32_16x16x32_bf16 v[112:115], v[172:175], a[32:35], v[112:115]
 ds_bpermute_b32 v232, v19, v232
 v_add_f32 v91, v91, v94
 v_mfma_f32_16x16x32_bf16 v[112:115], v[176:179], a[28:31], v[112:115]
 ds_bpermute_b32 v233, v19, v233
 v_add_f32 v87, v87, v93
 v_mfma_f32_16x16x32_bf16 v[112:115], v[180:183], a[24:27], v[112:115]
 ds_bpermute_b32 v234, v19, v234
 v_cndmask_b32_e64 v248, v87, v71, vcc
 v_mfma_f32_16x16x32_bf16 v[112:115], v[184:187], a[20:23], v[112:115]
 ds_read_u16_d16_hi v236, v18 offset:256
 v_cndmask_b32_e64 v249, v91, v75, vcc
 v_mfma_f32_16x16x32_bf16 v[112:115], v[188:191], a[16:19], v[112:115]
 ds_read_u16_d16_hi v237, v18 offset:1408
 v_cndmask_b32_e64 v250, v95, v79, vcc
 v_mfma_f32_16x16x32_bf16 v[112:115], v[192:195], a[12:15], v[112:115]
 s_waitcnt lgkmcnt(10)
 v_add_f32 v32, v32, v224
 v_add_f32 v33, v33, v225
 v_mfma_f32_16x16x32_bf16 v[112:115], v[196:199], a[8:11], v[112:115]
 s_waitcnt lgkmcnt(8)
 v_add_f32 v34, v34, v226
 v_fmac_f32 v32, s31, v228
 v_mfma_f32_16x16x32_bf16 v[112:115], v[200:203], a[4:7], v[112:115]
 s_waitcnt lgkmcnt(6)
 v_fmac_f32 v33, s31, v229
 v_fmac_f32 v34, s31, v230
 v_mfma_f32_16x16x32_bf16 v[112:115], v[204:207], a[0:3], v[112:115]
 s_waitcnt lgkmcnt(5)
 v_fmac_f32 v35, s31, v231
 v_cvt_pk_bf16_f32 v32, v32, v33
 v_mfma_f32_16x16x32_bf16 v[116:119], v[160:163], a[108:111], 0
 ds_read_u16_d16_hi v238, v18 offset:2560
 v_cvt_pk_bf16_f32 v33, v34, v35
 v_mfma_f32_16x16x32_bf16 v[116:119], v[164:167], a[104:107], v[116:119]
 buffer_store_dwordx2 v[32:33], v20, s[12:15], s34 offen offset:0 sc1
 v_mfma_f32_16x16x32_bf16 v[116:119], v[168:171], a[100:103], v[116:119]
 ds_read_u16_d16_hi v239, v18 offset:3712
 v_add_f32 v81, v81, v84
 v_mfma_f32_16x16x32_bf16 v[116:119], v[172:175], a[96:99], v[116:119]
 ds_bpermute_b32 v240, v19, v240
 v_add_f32 v82, v82, v85
 v_mfma_f32_16x16x32_bf16 v[116:119], v[176:179], a[92:95], v[116:119]
 ds_bpermute_b32 v241, v19, v241
 v_add_f32 v83, v83, v86
 v_mfma_f32_16x16x32_bf16 v[116:119], v[180:183], a[88:91], v[116:119]
 ds_bpermute_b32 v242, v19, v242
 v_add_f32 v82, v82, v88
 v_mfma_f32_16x16x32_bf16 v[116:119], v[184:187], a[84:87], v[116:119]
 ds_read_u16_d16_hi v244, v18 offset:384
 v_add_f32 v83, v83, v89
 v_mfma_f32_16x16x32_bf16 v[116:119], v[188:191], a[80:83], v[116:119]
 ds_read_u16_d16_hi v245, v18 offset:1536
 v_add_f32 v83, v83, v92
 v_mfma_f32_16x16x32_bf16 v[116:119], v[192:195], a[76:79], v[116:119]
 s_waitcnt lgkmcnt(10)
 v_add_f32 v48, v48, v232
 v_add_f32 v49, v49, v233
 v_mfma_f32_16x16x32_bf16 v[116:119], v[196:199], a[72:75], v[116:119]
 s_waitcnt lgkmcnt(8)
 v_add_f32 v50, v50, v234
 v_fmac_f32 v48, s31, v236
 v_mfma_f32_16x16x32_bf16 v[116:119], v[200:203], a[68:71], v[116:119]
 s_waitcnt lgkmcnt(6)
 v_fmac_f32 v49, s31, v237
 v_fmac_f32 v50, s31, v238
 v_mfma_f32_16x16x32_bf16 v[116:119], v[204:207], a[64:67], v[116:119]
 s_waitcnt lgkmcnt(5)
 v_fmac_f32 v51, s31, v239
 v_cvt_pk_bf16_f32 v48, v48, v49
 v_mfma_f32_16x16x32_bf16 v[120:123], v[160:163], a[172:175], 0
 ds_read_u16_d16_hi v246, v18 offset:2688
 v_cvt_pk_bf16_f32 v49, v50, v51
 v_mfma_f32_16x16x32_bf16 v[120:123], v[164:167], a[168:171], v[120:123]
 buffer_store_dwordx2 v[48:49], v20, s[12:15], s34 offen offset:512 sc1
 v_mfma_f32_16x16x32_bf16 v[120:123], v[168:171], a[164:167], v[120:123]
 ds_read_u16_d16_hi v247, v18 offset:3840
 v_add_f32 v103, v103, v106
 v_mfma_f32_16x16x32_bf16 v[120:123], v[172:175], a[160:163], v[120:123]
 ds_bpermute_b32 v248, v19, v248
 v_add_f32 v107, v107, v110
 v_mfma_f32_16x16x32_bf16 v[120:123], v[176:179], a[156:159], v[120:123]
 ds_bpermute_b32 v249, v19, v249
 v_add_f32 v103, v103, v109
 v_mfma_f32_16x16x32_bf16 v[120:123], v[180:183], a[152:155], v[120:123]
 ds_bpermute_b32 v250, v19, v250
 v_cndmask_b32_e64 v224, v103, v87, vcc
 v_mfma_f32_16x16x32_bf16 v[120:123], v[184:187], a[148:151], v[120:123]
 ds_read_u16_d16_hi v252, v18 offset:512
 v_cndmask_b32_e64 v225, v107, v91, vcc
 v_mfma_f32_16x16x32_bf16 v[120:123], v[188:191], a[144:147], v[120:123]
 ds_read_u16_d16_hi v253, v18 offset:1664
 v_cndmask_b32_e64 v226, v111, v95, vcc
 v_mfma_f32_16x16x32_bf16 v[120:123], v[192:195], a[140:143], v[120:123]
 s_waitcnt lgkmcnt(10)
 v_add_f32 v64, v64, v240
 v_add_f32 v65, v65, v241
 v_mfma_f32_16x16x32_bf16 v[120:123], v[196:199], a[136:139], v[120:123]
 s_waitcnt lgkmcnt(8)
 v_add_f32 v66, v66, v242
 v_fmac_f32 v64, s31, v244
 v_mfma_f32_16x16x32_bf16 v[120:123], v[200:203], a[132:135], v[120:123]
 s_waitcnt lgkmcnt(6)
 v_fmac_f32 v65, s31, v245
 v_fmac_f32 v66, s31, v246
 v_mfma_f32_16x16x32_bf16 v[120:123], v[204:207], a[128:131], v[120:123]
 s_waitcnt lgkmcnt(5)
 v_fmac_f32 v67, s31, v247
 v_cvt_pk_bf16_f32 v64, v64, v65
 v_mfma_f32_16x16x32_bf16 v[124:127], v[160:163], a[236:239], 0
 ds_read_u16_d16_hi v254, v18 offset:2816
 v_cvt_pk_bf16_f32 v65, v66, v67
 v_mfma_f32_16x16x32_bf16 v[124:127], v[164:167], a[232:235], v[124:127]
 buffer_store_dwordx2 v[64:65], v20, s[12:15], s34 offen offset:1024 sc1
 v_mfma_f32_16x16x32_bf16 v[124:127], v[168:171], a[228:231], v[124:127]
 ds_read_u16_d16_hi v255, v18 offset:3968
 v_add_f32 v97, v97, v100
 v_mfma_f32_16x16x32_bf16 v[124:127], v[172:175], a[224:227], v[124:127]
 ds_bpermute_b32 v224, v19, v224
 v_add_f32 v98, v98, v101
 v_mfma_f32_16x16x32_bf16 v[124:127], v[176:179], a[220:223], v[124:127]
 ds_bpermute_b32 v225, v19, v225
 v_add_f32 v99, v99, v102
 v_mfma_f32_16x16x32_bf16 v[124:127], v[180:183], a[216:219], v[124:127]
 ds_bpermute_b32 v226, v19, v226
 v_add_f32 v98, v98, v104
 v_mfma_f32_16x16x32_bf16 v[124:127], v[184:187], a[212:215], v[124:127]
 ds_read_u16_d16_hi v228, v18 offset:640
 v_add_f32 v99, v99, v105
 v_mfma_f32_16x16x32_bf16 v[124:127], v[188:191], a[208:211], v[124:127]
 ds_read_u16_d16_hi v229, v18 offset:1792
 v_add_f32 v99, v99, v108
 v_mfma_f32_16x16x32_bf16 v[124:127], v[192:195], a[204:207], v[124:127]
 s_waitcnt lgkmcnt(10)
 v_add_f32 v80, v80, v248
 v_add_f32 v81, v81, v249
 v_mfma_f32_16x16x32_bf16 v[124:127], v[196:199], a[200:203], v[124:127]
 s_waitcnt lgkmcnt(8)
 v_add_f32 v82, v82, v250
 v_fmac_f32 v80, s31, v252
 v_mfma_f32_16x16x32_bf16 v[124:127], v[200:203], a[196:199], v[124:127]
 s_waitcnt lgkmcnt(6)
 v_fmac_f32 v81, s31, v253
 v_fmac_f32 v82, s31, v254
 v_mfma_f32_16x16x32_bf16 v[124:127], v[204:207], a[192:195], v[124:127]
 s_waitcnt lgkmcnt(5)
 v_fmac_f32 v83, s31, v255
 v_cvt_pk_bf16_f32 v80, v80, v81
 v_mfma_f32_16x16x32_bf16 v[128:131], v[160:163], a[52:55], 0
 ds_read_u16_d16_hi v230, v18 offset:2944
 v_cvt_pk_bf16_f32 v81, v82, v83
 v_mfma_f32_16x16x32_bf16 v[128:131], v[164:167], a[48:51], v[128:131]
 buffer_store_dwordx2 v[80:81], v20, s[12:15], s34 offen offset:1536 sc1
 v_mfma_f32_16x16x32_bf16 v[128:131], v[168:171], a[44:47], v[128:131]
 ds_read_u16_d16_hi v231, v18 offset:4096
 v_mfma_f32_16x16x32_bf16 v[128:131], v[172:175], a[40:43], v[128:131]
 v_mfma_f32_16x16x32_bf16 v[128:131], v[176:179], a[36:39], v[128:131]
 v_mfma_f32_16x16x32_bf16 v[128:131], v[180:183], a[32:35], v[128:131]
 v_mfma_f32_16x16x32_bf16 v[128:131], v[184:187], a[28:31], v[128:131]
 v_mfma_f32_16x16x32_bf16 v[128:131], v[188:191], a[24:27], v[128:131]
 v_add_f32 v119, v119, v122
 v_add_f32 v123, v123, v126
 v_mfma_f32_16x16x32_bf16 v[128:131], v[192:195], a[20:23], v[128:131]
 s_waitcnt lgkmcnt(5)
 v_add_f32 v96, v96, v224
 v_add_f32 v97, v97, v225
 v_mfma_f32_16x16x32_bf16 v[128:131], v[196:199], a[16:19], v[128:131]
 s_waitcnt lgkmcnt(3)
 v_add_f32 v98, v98, v226
 v_fmac_f32 v96, s31, v228
 v_mfma_f32_16x16x32_bf16 v[128:131], v[200:203], a[12:15], v[128:131]
 s_waitcnt lgkmcnt(1)
 v_fmac_f32 v97, s31, v229
 v_fmac_f32 v98, s31, v230
 v_mfma_f32_16x16x32_bf16 v[128:131], v[204:207], a[8:11], v[128:131]
 s_waitcnt lgkmcnt(0)
 v_fmac_f32 v99, s31, v231
 v_cvt_pk_bf16_f32 v96, v96, v97
 v_mfma_f32_16x16x32_bf16 v[128:131], v[208:211], a[4:7], v[128:131]
 v_cvt_pk_bf16_f32 v97, v98, v99
 v_add_f32 v119, v119, v125
 v_mfma_f32_16x16x32_bf16 v[128:131], v[212:215], a[0:3], v[128:131]
 buffer_store_dwordx2 v[96:97], v20, s[12:15], s34 offen offset:2048 sc1
 v_mfma_f32_16x16x32_bf16 v[132:135], v[160:163], a[116:119], 0
 v_cndmask_b32_e64 v232, v119, v103, vcc
 v_cndmask_b32_e64 v233, v123, v107, vcc
 v_mfma_f32_16x16x32_bf16 v[132:135], v[164:167], a[112:115], v[132:135]
 v_cndmask_b32_e64 v234, v127, v111, vcc
 v_add_f32 v113, v113, v116
 v_mfma_f32_16x16x32_bf16 v[132:135], v[168:171], a[108:111], v[132:135]
 ds_bpermute_b32 v232, v19, v232
 v_add_f32 v114, v114, v117
 v_mfma_f32_16x16x32_bf16 v[132:135], v[172:175], a[104:107], v[132:135]
 ds_bpermute_b32 v233, v19, v233
 v_add_f32 v115, v115, v118
 v_mfma_f32_16x16x32_bf16 v[132:135], v[176:179], a[100:103], v[132:135]
 ds_bpermute_b32 v234, v19, v234
 v_add_f32 v114, v114, v120
 v_mfma_f32_16x16x32_bf16 v[132:135], v[180:183], a[96:99], v[132:135]
 ds_read_u16_d16_hi v236, v18 offset:768
 v_add_f32 v115, v115, v121
 v_mfma_f32_16x16x32_bf16 v[132:135], v[184:187], a[92:95], v[132:135]
 ds_read_u16_d16_hi v237, v18 offset:1920
 v_add_f32 v115, v115, v124
 v_mfma_f32_16x16x32_bf16 v[132:135], v[188:191], a[88:91], v[132:135]
 ds_read_u16_d16_hi v238, v18 offset:3072
 v_mfma_f32_16x16x32_bf16 v[132:135], v[192:195], a[84:87], v[132:135]
 ds_read_u16_d16_hi v239, v18 offset:4224
 v_mfma_f32_16x16x32_bf16 v[132:135], v[196:199], a[80:83], v[132:135]
 v_mfma_f32_16x16x32_bf16 v[132:135], v[200:203], a[76:79], v[132:135]
 v_mfma_f32_16x16x32_bf16 v[132:135], v[204:207], a[72:75], v[132:135]
 v_mfma_f32_16x16x32_bf16 v[132:135], v[208:211], a[68:71], v[132:135]
 v_mfma_f32_16x16x32_bf16 v[132:135], v[212:215], a[64:67], v[132:135]
 v_mfma_f32_16x16x32_bf16 v[136:139], v[160:163], a[180:183], 0
 s_waitcnt lgkmcnt(5)
 v_add_f32 v112, v112, v232
 v_add_f32 v113, v113, v233
 v_mfma_f32_16x16x32_bf16 v[136:139], v[164:167], a[176:179], v[136:139]
 s_waitcnt lgkmcnt(3)
 v_add_f32 v114, v114, v234
 v_fmac_f32 v112, s31, v236
 v_mfma_f32_16x16x32_bf16 v[136:139], v[168:171], a[172:175], v[136:139]
 s_waitcnt lgkmcnt(1)
 v_fmac_f32 v113, s31, v237
 v_fmac_f32 v114, s31, v238
 v_mfma_f32_16x16x32_bf16 v[136:139], v[172:175], a[168:171], v[136:139]
 s_waitcnt lgkmcnt(0)
 v_fmac_f32 v115, s31, v239
 v_cvt_pk_bf16_f32 v112, v112, v113
 v_mfma_f32_16x16x32_bf16 v[136:139], v[176:179], a[164:167], v[136:139]
 v_cvt_pk_bf16_f32 v113, v114, v115
 v_mfma_f32_16x16x32_bf16 v[136:139], v[180:183], a[160:163], v[136:139]
 buffer_store_dwordx2 v[112:113], v20, s[12:15], s34 offen offset:2560 sc1
 v_mfma_f32_16x16x32_bf16 v[136:139], v[184:187], a[156:159], v[136:139]
 v_mfma_f32_16x16x32_bf16 v[136:139], v[188:191], a[152:155], v[136:139]
 v_mfma_f32_16x16x32_bf16 v[136:139], v[192:195], a[148:151], v[136:139]
 v_mfma_f32_16x16x32_bf16 v[136:139], v[196:199], a[144:147], v[136:139]
 v_mfma_f32_16x16x32_bf16 v[136:139], v[200:203], a[140:143], v[136:139]
 v_mfma_f32_16x16x32_bf16 v[136:139], v[204:207], a[136:139], v[136:139]
 v_mfma_f32_16x16x32_bf16 v[136:139], v[208:211], a[132:135], v[136:139]
 v_mfma_f32_16x16x32_bf16 v[136:139], v[212:215], a[128:131], v[136:139]
 v_mfma_f32_16x16x32_bf16 v[140:143], v[160:163], a[244:247], 0
 v_mfma_f32_16x16x32_bf16 v[140:143], v[164:167], a[240:243], v[140:143]
 v_mfma_f32_16x16x32_bf16 v[140:143], v[168:171], a[236:239], v[140:143]
 v_mfma_f32_16x16x32_bf16 v[140:143], v[172:175], a[232:235], v[140:143]
 v_mfma_f32_16x16x32_bf16 v[140:143], v[176:179], a[228:231], v[140:143]
 v_mfma_f32_16x16x32_bf16 v[140:143], v[180:183], a[224:227], v[140:143]
 v_mfma_f32_16x16x32_bf16 v[140:143], v[184:187], a[220:223], v[140:143]
 v_mfma_f32_16x16x32_bf16 v[140:143], v[188:191], a[216:219], v[140:143]
 v_mfma_f32_16x16x32_bf16 v[140:143], v[192:195], a[212:215], v[140:143]
 v_mfma_f32_16x16x32_bf16 v[140:143], v[196:199], a[208:211], v[140:143]
 v_mfma_f32_16x16x32_bf16 v[140:143], v[200:203], a[204:207], v[140:143]
 v_mfma_f32_16x16x32_bf16 v[140:143], v[204:207], a[200:203], v[140:143]
 v_mfma_f32_16x16x32_bf16 v[140:143], v[208:211], a[196:199], v[140:143]
 v_mfma_f32_16x16x32_bf16 v[140:143], v[212:215], a[192:195], v[140:143]
 v_mfma_f32_16x16x32_bf16 v[144:147], v[160:163], a[60:63], 0
 v_mfma_f32_16x16x32_bf16 v[144:147], v[164:167], a[56:59], v[144:147]
 v_mfma_f32_16x16x32_bf16 v[144:147], v[168:171], a[52:55], v[144:147]
 v_mfma_f32_16x16x32_bf16 v[144:147], v[172:175], a[48:51], v[144:147]
 v_mfma_f32_16x16x32_bf16 v[144:147], v[176:179], a[44:47], v[144:147]
 v_mfma_f32_16x16x32_bf16 v[144:147], v[180:183], a[40:43], v[144:147]
 v_mfma_f32_16x16x32_bf16 v[144:147], v[184:187], a[36:39], v[144:147]
 v_mfma_f32_16x16x32_bf16 v[144:147], v[188:191], a[32:35], v[144:147]
 v_add_f32 v135, v135, v138
 v_add_f32 v139, v139, v142
 v_mfma_f32_16x16x32_bf16 v[144:147], v[192:195], a[28:31], v[144:147]
 v_add_f32 v135, v135, v141
 v_cndmask_b32_e64 v240, v135, v119, vcc
 v_mfma_f32_16x16x32_bf16 v[144:147], v[196:199], a[24:27], v[144:147]
 v_cndmask_b32_e64 v241, v139, v123, vcc
 v_cndmask_b32_e64 v242, v143, v127, vcc
 v_mfma_f32_16x16x32_bf16 v[144:147], v[200:203], a[20:23], v[144:147]
 ds_bpermute_b32 v240, v19, v240
 v_add_f32 v129, v129, v132
 v_mfma_f32_16x16x32_bf16 v[144:147], v[204:207], a[16:19], v[144:147]
 ds_bpermute_b32 v241, v19, v241
 v_add_f32 v130, v130, v133
 v_mfma_f32_16x16x32_bf16 v[144:147], v[208:211], a[12:15], v[144:147]
 ds_bpermute_b32 v242, v19, v242
 v_add_f32 v131, v131, v134
 v_mfma_f32_16x16x32_bf16 v[144:147], v[212:215], a[8:11], v[144:147]
 ds_read_u16_d16_hi v244, v18 offset:896
 v_add_f32 v130, v130, v136
 v_mfma_f32_16x16x32_bf16 v[144:147], v[216:219], a[4:7], v[144:147]
 ds_read_u16_d16_hi v245, v18 offset:2048
 v_add_f32 v131, v131, v137
 v_mfma_f32_16x16x32_bf16 v[144:147], v[220:223], a[0:3], v[144:147]
 ds_read_u16_d16_hi v246, v18 offset:3200
 v_add_f32 v131, v131, v140
 v_mfma_f32_16x16x32_bf16 v[148:151], v[160:163], a[124:127], 0
 ds_read_u16_d16_hi v247, v18 offset:4352
 v_mfma_f32_16x16x32_bf16 v[148:151], v[164:167], a[120:123], v[148:151]
 v_mfma_f32_16x16x32_bf16 v[148:151], v[168:171], a[116:119], v[148:151]
 v_mfma_f32_16x16x32_bf16 v[148:151], v[172:175], a[112:115], v[148:151]
 v_mfma_f32_16x16x32_bf16 v[148:151], v[176:179], a[108:111], v[148:151]
 v_mfma_f32_16x16x32_bf16 v[148:151], v[180:183], a[104:107], v[148:151]
 v_mfma_f32_16x16x32_bf16 v[148:151], v[184:187], a[100:103], v[148:151]
 s_waitcnt lgkmcnt(5)
 v_add_f32 v128, v128, v240
 v_add_f32 v129, v129, v241
 v_mfma_f32_16x16x32_bf16 v[148:151], v[188:191], a[96:99], v[148:151]
 s_waitcnt lgkmcnt(3)
 v_add_f32 v130, v130, v242
 v_fmac_f32 v128, s31, v244
 v_mfma_f32_16x16x32_bf16 v[148:151], v[192:195], a[92:95], v[148:151]
 s_waitcnt lgkmcnt(1)
 v_fmac_f32 v129, s31, v245
 v_fmac_f32 v130, s31, v246
 v_mfma_f32_16x16x32_bf16 v[148:151], v[196:199], a[88:91], v[148:151]
 s_waitcnt lgkmcnt(0)
 v_fmac_f32 v131, s31, v247
 v_cvt_pk_bf16_f32 v128, v128, v129
 v_mfma_f32_16x16x32_bf16 v[148:151], v[200:203], a[84:87], v[148:151]
 v_cvt_pk_bf16_f32 v129, v130, v131
 v_mfma_f32_16x16x32_bf16 v[148:151], v[204:207], a[80:83], v[148:151]
 buffer_store_dwordx2 v[128:129], v20, s[12:15], s34 offen offset:3072 sc1
 v_mfma_f32_16x16x32_bf16 v[148:151], v[208:211], a[76:79], v[148:151]
 v_mfma_f32_16x16x32_bf16 v[148:151], v[212:215], a[72:75], v[148:151]
 v_mfma_f32_16x16x32_bf16 v[148:151], v[216:219], a[68:71], v[148:151]
 v_mfma_f32_16x16x32_bf16 v[148:151], v[220:223], a[64:67], v[148:151]
 v_mfma_f32_16x16x32_bf16 v[152:155], v[160:163], a[188:191], 0
 v_mfma_f32_16x16x32_bf16 v[152:155], v[164:167], a[184:187], v[152:155]
 v_mfma_f32_16x16x32_bf16 v[152:155], v[168:171], a[180:183], v[152:155]
 v_mfma_f32_16x16x32_bf16 v[152:155], v[172:175], a[176:179], v[152:155]
 v_mfma_f32_16x16x32_bf16 v[152:155], v[176:179], a[172:175], v[152:155]
 v_mfma_f32_16x16x32_bf16 v[152:155], v[180:183], a[168:171], v[152:155]
 v_mfma_f32_16x16x32_bf16 v[152:155], v[184:187], a[164:167], v[152:155]
 v_mfma_f32_16x16x32_bf16 v[152:155], v[188:191], a[160:163], v[152:155]
 v_mfma_f32_16x16x32_bf16 v[152:155], v[192:195], a[156:159], v[152:155]
 v_mfma_f32_16x16x32_bf16 v[152:155], v[196:199], a[152:155], v[152:155]
 v_mfma_f32_16x16x32_bf16 v[152:155], v[200:203], a[148:151], v[152:155]
 v_mfma_f32_16x16x32_bf16 v[152:155], v[204:207], a[144:147], v[152:155]
 v_mfma_f32_16x16x32_bf16 v[152:155], v[208:211], a[140:143], v[152:155]
 v_mfma_f32_16x16x32_bf16 v[152:155], v[212:215], a[136:139], v[152:155]
 v_mfma_f32_16x16x32_bf16 v[152:155], v[216:219], a[132:135], v[152:155]
 v_mfma_f32_16x16x32_bf16 v[152:155], v[220:223], a[128:131], v[152:155]
 v_mfma_f32_16x16x32_bf16 v[156:159], v[160:163], v[12:15], 0
 v_mfma_f32_16x16x32_bf16 v[156:159], v[164:167], a[248:251], v[156:159]
 v_mfma_f32_16x16x32_bf16 v[156:159], v[168:171], a[244:247], v[156:159]
 v_mfma_f32_16x16x32_bf16 v[156:159], v[172:175], a[240:243], v[156:159]
 v_mfma_f32_16x16x32_bf16 v[156:159], v[176:179], a[236:239], v[156:159]
 v_mfma_f32_16x16x32_bf16 v[156:159], v[180:183], a[232:235], v[156:159]
 v_mfma_f32_16x16x32_bf16 v[156:159], v[184:187], a[228:231], v[156:159]
 v_mfma_f32_16x16x32_bf16 v[156:159], v[188:191], a[224:227], v[156:159]
 v_mfma_f32_16x16x32_bf16 v[156:159], v[192:195], a[220:223], v[156:159]
 v_mfma_f32_16x16x32_bf16 v[156:159], v[196:199], a[216:219], v[156:159]
 v_mfma_f32_16x16x32_bf16 v[156:159], v[200:203], a[212:215], v[156:159]
 v_mfma_f32_16x16x32_bf16 v[156:159], v[204:207], a[208:211], v[156:159]
 v_mfma_f32_16x16x32_bf16 v[156:159], v[208:211], a[204:207], v[156:159]
 v_mfma_f32_16x16x32_bf16 v[156:159], v[212:215], a[200:203], v[156:159]
 v_mfma_f32_16x16x32_bf16 v[156:159], v[216:219], a[196:199], v[156:159]
 v_mfma_f32_16x16x32_bf16 v[156:159], v[220:223], a[192:195], v[156:159]
 s_nop 7
 v_add_f32 v151, v151, v154
 v_add_f32 v155, v155, v158
 v_add_f32 v151, v151, v157
 v_cndmask_b32_e64 v248, v151, v135, vcc
 v_cndmask_b32_e64 v249, v155, v139, vcc
 v_cndmask_b32_e64 v250, v159, v143, vcc
 ds_bpermute_b32 v248, v19, v248
 ds_bpermute_b32 v249, v19, v249
 ds_bpermute_b32 v250, v19, v250
 ds_read_u16_d16_hi v252, v18 offset:1024
 ds_read_u16_d16_hi v253, v18 offset:2176
 ds_read_u16_d16_hi v254, v18 offset:3328
 ds_read_u16_d16_hi v255, v18 offset:4480
 v_add_f32 v145, v145, v148
 v_add_f32 v146, v146, v149
 v_add_f32 v147, v147, v150
 v_add_f32 v146, v146, v152
 v_add_f32 v147, v147, v153
 v_add_f32 v147, v147, v156
 s_waitcnt lgkmcnt(0)
 v_add_f32 v144, v144, v248
 v_add_f32 v145, v145, v249
 v_add_f32 v146, v146, v250
 v_fmac_f32 v144, s31, v252
 v_fmac_f32 v145, s31, v253
 v_fmac_f32 v146, s31, v254
 v_fmac_f32 v147, s31, v255
 v_cvt_pk_bf16_f32 v144, v144, v145
 v_cvt_pk_bf16_f32 v145, v146, v147
 buffer_store_dwordx2 v[144:145], v20, s[12:15], s34 offen offset:3584 sc1
 v_mov_b32 v12, 1
 buffer_atomic_add v12, v9, s[12:15], s38 offen sc0 sc1
L_pub:
 s_waitcnt vmcnt(1)
 s_barrier
 buffer_store_dword v9, v9, s[12:15], s93 offen sc1
 s_waitcnt vmcnt(1)
L_job:
 s_cmp_lg_u32 s3, 0
 s_cbranch_scc1 L_jobw
 s_mov_b64 exec, 1
 ds_write_b32 v5, v12
 s_mov_b64 exec, -1
 s_waitcnt lgkmcnt(0)
L_jobw:
 s_barrier
 ds_read_b32 v13, v5
 v_xor_b32 v5, 4, v5
 s_waitcnt lgkmcnt(0)
 v_readfirstlane_b32 s41, v13
 v_mov_b32 v12, 1
 s_nop 2
 s_add_u32 s41, s41, -1
 s_cmp_ge_u32 s41, 140
 s_cbranch_scc1 L_fin
 s_mul_i32 s42, s41, 2341
 s_lshr_b32 s42, s42, 16
 s_mul_i32 s43, s42, 28
 s_sub_u32 s41, s41, s43
 s_mul_i32 s43, s41, 37
 s_lshr_b32 s43, s43, 8
 s_mul_i32 s44, s43, 7
 s_sub_u32 s41, s41, s44
 s_lshl_b32 s43, s43, 2
 s_add_u32 s43, s43, s40
 s_cmp_eq_u32 s42, 3
 s_cbranch_scc1 L_gate
 s_cmp_ge_u32 s42, 2
 s_cselect_b32 s44, 16, 0
 s_add_u32 s43, s43, s44
 s_lshr_b32 s44, 18, s42
 s_and_b32 s44, s44, 1
 s_lshr_b32 s45, s43, 1
 s_lshl_b32 s45, s45, 1
 s_sub_u32 s45, s45, s44
 s_lshl_b32 s45, s45, 6
 s_add_u32 s45, s45, 84938816
 s_mul_i32 s44, s44, 7
 s_add_u32 s41, s41, s44
 s_lshl_b32 s43, s43, 2
 s_add_u32 s43, s43, s3
 s_mul_i32 s37, s43, 14
 s_add_u32 s37, s37, s41
 s_mul_i32 s37, s37, 17408
 s_add_u32 s37, s37, 117440512
 s_mul_i32 s36, s43, 28672
 s_lshl_b32 s41, s41, 6
 s_add_u32 s36, s36, s41
L_rn:
 s_cmp_lg_u32 s3, 0
 s_cbranch_scc1 L_rx
 v_and_b32 v16, 15, v0
 v_lshlrev_b32 v16, 2, v16
 s_mov_b32 s32, 0
L_poll6:
 buffer_load_dword v17, v16, s[12:15], s45 offen sc1
 s_waitcnt vmcnt(0)
 v_cmp_ne_u32 vcc, 0, v17
 s_cbranch_vccz L_poll6_ok
 s_sleep 6
 s_add_u32 s32, s32, 1
 s_cmp_lt_u32 s32, 0x80000
 s_cbranch_scc1 L_poll6
L_poll6_ok:
L_rx:
 s_barrier
 s_cmp_eq_u32 s42, 4
 s_cbranch_scc1 L_rf
 buffer_load_dwordx4 a[0:3], v1, s[12:15], s37 offen offset:0 sc1
 buffer_load_dwordx4 a[4:7], v1, s[12:15], s37 offen offset:1024 sc1
 buffer_load_dwordx4 a[8:11], v1, s[12:15], s37 offen offset:2048 sc1
 buffer_load_dwordx4 a[12:15], v1, s[12:15], s37 offen offset:3072 sc1
 s_add_u32 s37, s37, 4096
 s_waitcnt vmcnt(3)
 buffer_load_dwordx4 a[16:19], v1, s[12:15], s37 offen offset:0 sc1
 s_waitcnt vmcnt(3)
 buffer_load_dwordx4 a[20:23], v1, s[12:15], s37 offen offset:1024 sc1
 s_waitcnt vmcnt(3)
 buffer_load_dwordx4 a[24:27], v1, s[12:15], s37 offen offset:2048 sc1
 s_waitcnt vmcnt(3)
 buffer_load_dwordx4 a[28:31], v1, s[12:15], s37 offen offset:3072 sc1
 s_add_u32 s37, s37, 4096
 s_waitcnt vmcnt(3)
 buffer_load_dwordx4 a[32:35], v1, s[12:15], s37 offen offset:0 sc1
 s_waitcnt vmcnt(3)
 buffer_load_dwordx4 a[36:39], v1, s[12:15], s37 offen offset:1024 sc1
 s_waitcnt vmcnt(3)
 buffer_load_dwordx4 a[40:43], v1, s[12:15], s37 offen offset:2048 sc1
 s_waitcnt vmcnt(3)
 buffer_load_dwordx4 a[44:47], v1, s[12:15], s37 offen offset:3072 sc1
 s_add_u32 s37, s37, 4096
 s_waitcnt vmcnt(3)
 buffer_load_dwordx4 a[48:51], v1, s[12:15], s37 offen offset:0 sc1
 s_waitcnt vmcnt(3)
 buffer_load_dwordx4 a[52:55], v1, s[12:15], s37 offen offset:1024 sc1
 s_waitcnt vmcnt(3)
 buffer_load_dwordx4 a[56:59], v1, s[12:15], s37 offen offset:2048 sc1
 s_waitcnt vmcnt(3)
 buffer_load_dwordx4 a[60:63], v1, s[12:15], s37 offen offset:3072 sc1
 s_add_u32 s37, s37, 4096
 s_branch L_rg
L_rf:
 buffer_load_dwordx4 a[0:3], v1, s[12:15], s37 offen offset:0 sc1
 buffer_load_dwordx4 a[4:7], v1, s[12:15], s37 offen offset:1024 sc1
 buffer_load_dwordx4 a[8:11], v1, s[12:15], s37 offen offset:2048 sc1
 buffer_load_dwordx4 a[12:15], v1, s[12:15], s37 offen offset:3072 sc1
 s_add_u32 s37, s37, 4096
 buffer_load_dwordx4 a[16:19], v1, s[12:15], s37 offen offset:0 sc1
 buffer_load_dwordx4 a[20:23], v1, s[12:15], s37 offen offset:1024 sc1
 buffer_load_dwordx4 a[24:27], v1, s[12:15], s37 offen offset:2048 sc1
 buffer_load_dwordx4 a[28:31], v1, s[12:15], s37 offen offset:3072 sc1
 s_add_u32 s37, s37, 4096
 buffer_load_dwordx4 a[32:35], v1, s[12:15], s37 offen offset:0 sc1
 buffer_load_dwordx4 a[36:39], v1, s[12:15], s37 offen offset:1024 sc1
 buffer_load_dwordx4 a[40:43], v1, s[12:15], s37 offen offset:2048 sc1
 buffer_load_dwordx4 a[44:47], v1, s[12:15], s37 offen offset:3072 sc1
 s_add_u32 s37, s37, 4096
 buffer_load_dwordx4 a[48:51], v1, s[12:15], s37 offen offset:0 sc1
 buffer_load_dwordx4 a[52:55], v1, s[12:15], s37 offen offset:1024 sc1
 buffer_load_dwordx4 a[56:59], v1, s[12:15], s37 offen offset:2048 sc1
 buffer_load_dwordx4 a[60:63], v1, s[12:15], s37 offen offset:3072 sc1
 s_add_u32 s37, s37, 4096
L_rg:
 buffer_atomic_add v12, v9, s[12:15], s38 offen sc0 sc1
 s_waitcnt vmcnt(16)
 v_mfma_f32_16x16x32_bf16 v[32:35], v[24:27], a[0:3], 0
 v_mfma_f32_16x16x32_bf16 v[36:39], v[28:31], a[0:3], 0
 s_waitcnt vmcnt(15)
 v_mfma_f32_16x16x32_bf16 v[32:35], v[24:27], a[4:7], v[32:35]
 v_mfma_f32_16x16x32_bf16 v[36:39], v[28:31], a[4:7], v[36:39]
 s_waitcnt vmcnt(14)
 v_mfma_f32_16x16x32_bf16 v[32:35], v[24:27], a[8:11], v[32:35]
 v_mfma_f32_16x16x32_bf16 v[36:39], v[28:31], a[8:11], v[36:39]
 s_waitcnt vmcnt(13)
 v_mfma_f32_16x16x32_bf16 v[32:35], v[24:27], a[12:15], v[32:35]
 v_mfma_f32_16x16x32_bf16 v[36:39], v[28:31], a[12:15], v[36:39]
 s_waitcnt vmcnt(12)
 v_mfma_f32_16x16x32_bf16 v[32:35], v[24:27], a[16:19], v[32:35]
 v_mfma_f32_16x16x32_bf16 v[36:39], v[28:31], a[16:19], v[36:39]
 s_waitcnt vmcnt(11)
 v_mfma_f32_16x16x32_bf16 v[32:35], v[24:27], a[20:23], v[32:35]
 v_mfma_f32_16x16x32_bf16 v[36:39], v[28:31], a[20:23], v[36:39]
 s_waitcnt vmcnt(10)
 v_mfma_f32_16x16x32_bf16 v[32:35], v[24:27], a[24:27], v[32:35]
 v_mfma_f32_16x16x32_bf16 v[36:39], v[28:31], a[24:27], v[36:39]
 s_waitcnt vmcnt(9)
 v_mfma_f32_16x16x32_bf16 v[32:35], v[24:27], a[28:31], v[32:35]
 v_mfma_f32_16x16x32_bf16 v[36:39], v[28:31], a[28:31], v[36:39]
 s_waitcnt vmcnt(8)
 v_mfma_f32_16x16x32_bf16 v[32:35], v[24:27], a[32:35], v[32:35]
 v_mfma_f32_16x16x32_bf16 v[36:39], v[28:31], a[32:35], v[36:39]
 s_waitcnt vmcnt(7)
 v_mfma_f32_16x16x32_bf16 v[32:35], v[24:27], a[36:39], v[32:35]
 v_mfma_f32_16x16x32_bf16 v[36:39], v[28:31], a[36:39], v[36:39]
 s_waitcnt vmcnt(6)
 v_mfma_f32_16x16x32_bf16 v[32:35], v[24:27], a[40:43], v[32:35]
 v_mfma_f32_16x16x32_bf16 v[36:39], v[28:31], a[40:43], v[36:39]
 s_waitcnt vmcnt(5)
 v_mfma_f32_16x16x32_bf16 v[32:35], v[24:27], a[44:47], v[32:35]
 v_mfma_f32_16x16x32_bf16 v[36:39], v[28:31], a[44:47], v[36:39]
 s_waitcnt vmcnt(4)
 v_mfma_f32_16x16x32_bf16 v[32:35], v[24:27], a[48:51], v[32:35]
 v_mfma_f32_16x16x32_bf16 v[36:39], v[28:31], a[48:51], v[36:39]
 s_waitcnt vmcnt(3)
 v_mfma_f32_16x16x32_bf16 v[32:35], v[24:27], a[52:55], v[32:35]
 v_mfma_f32_16x16x32_bf16 v[36:39], v[28:31], a[52:55], v[36:39]
 s_waitcnt vmcnt(2)
 v_mfma_f32_16x16x32_bf16 v[32:35], v[24:27], a[56:59], v[32:35]
 v_mfma_f32_16x16x32_bf16 v[36:39], v[28:31], a[56:59], v[36:39]
 s_waitcnt vmcnt(1)
 v_mfma_f32_16x16x32_bf16 v[32:35], v[24:27], a[60:63], v[32:35]
 v_mfma_f32_16x16x32_bf16 v[36:39], v[28:31], a[60:63], v[36:39]
 s_nop 7
 v_cvt_pk_bf16_f32 v32, v32, v33
 v_cvt_pk_bf16_f32 v33, v34, v35
 v_cvt_pk_bf16_f32 v34, v36, v37
 v_cvt_pk_bf16_f32 v35, v38, v39
 buffer_store_dwordx4 v[32:35], v2, s[8:11], s36 offen offset:896
L_rd:
 s_waitcnt vmcnt(1)
 s_branch L_job
L_gate:
 s_lshl_b32 s43, s43, 2
 s_add_u32 s43, s43, s3
 s_mul_i32 s46, s43, 14336
 s_lshl_b32 s44, s41, 7
 s_lshl_b32 s47, s46, 1
 s_add_u32 s46, s46, s44
 s_add_u32 s47, s47, s44
 s_add_u32 s54, s46, 917504
 s_add_u32 s55, s47, 1835008
 buffer_load_dwordx4 v[48:51], v7, s[16:19], s46 offen offset:0
 buffer_load_dwordx4 v[52:55], v7, s[16:19], s46 offen offset:64
 buffer_load_dwordx4 v[56:59], v7, s[16:19], s54 offen offset:0
 buffer_load_dwordx4 v[60:63], v7, s[16:19], s54 offen offset:64
 s_lshl_b32 s56, s43, 5
 s_mul_i32 s57, s41, 262144
 s_add_u32 s56, s56, s57
 s_add_u32 s56, s56, 90177536
 s_add_u32 s57, s56, 131072
 s_lshl_b32 s45, s41, 6
 s_add_u32 s45, s45, 84963328
 s_cmp_lg_u32 s3, 0
 s_cbranch_scc1 L_gw
 v_and_b32 v16, 15, v0
 v_lshlrev_b32 v16, 2, v16
 s_mov_b32 s32, 0
L_poll7:
 buffer_load_dword v17, v16, s[12:15], s45 offen sc1
 s_waitcnt vmcnt(0)
 v_cmp_ne_u32 vcc, 0, v17
 s_cbranch_vccz L_poll7_ok
 s_sleep 6
 s_add_u32 s32, s32, 1
 s_cmp_lt_u32 s32, 0x80000
 s_cbranch_scc1 L_poll7
L_poll7_ok:
L_gw:
 s_barrier
 s_add_u32 m0, s58, 0
 s_nop 0
 buffer_load_dwordx4 v8, s[12:15], s56 offen offset:0 sc1 lds
 s_add_u32 m0, s58, 1024
 s_nop 0
 buffer_load_dwordx4 v8, s[12:15], s57 offen offset:0 sc1 lds
 s_add_u32 m0, s58, 0
 s_nop 0
 buffer_load_dwordx4 v8, s[12:15], s56 offen offset:2048 sc1 lds
 s_add_u32 m0, s58, 1024
 s_nop 0
 buffer_load_dwordx4 v8, s[12:15], s57 offen offset:2048 sc1 lds
 buffer_atomic_add v12, v9, s[12:15], s38 offen sc0 sc1
 s_waitcnt vmcnt(1)
 ds_read_b64_tr_b16 v[64:65], v10 offset:0
 ds_read_b64_tr_b16 v[66:67], v10 offset:128
 ds_read_b64_tr_b16 v[68:69], v10 offset:1024
 ds_read_b64_tr_b16 v[70:71], v10 offset:1152
 ds_read_b64_tr_b16 v[72:73], v10 offset:2048
 ds_read_b64_tr_b16 v[74:75], v10 offset:2176
 ds_read_b64_tr_b16 v[76:77], v10 offset:3072
 ds_read_b64_tr_b16 v[78:79], v10 offset:3200
 s_waitcnt lgkmcnt(0)
 ds_bpermute_b32 v64, v11, v64
 ds_bpermute_b32 v65, v11, v65
 ds_bpermute_b32 v66, v11, v66
 ds_bpermute_b32 v67, v11, v67
 ds_bpermute_b32 v68, v11, v68
 ds_bpermute_b32 v69, v11, v69
 ds_bpermute_b32 v70, v11, v70
 ds_bpermute_b32 v71, v11, v71
 ds_bpermute_b32 v72, v11, v72
 ds_bpermute_b32 v73, v11, v73
 ds_bpermute_b32 v74, v11, v74
 ds_bpermute_b32 v75, v11, v75
 ds_bpermute_b32 v76, v11, v76
 ds_bpermute_b32 v77, v11, v77
 ds_bpermute_b32 v78, v11, v78
 ds_bpermute_b32 v79, v11, v79
 s_waitcnt lgkmcnt(12)
 v_lshlrev_b32 v16, 16, v48
 v_and_b32 v17, s59, v48
 v_lshlrev_b32 v18, 16, v64
 v_and_b32 v19, s59, v64
 v_pk_mul_f32 v[16:17], v[16:17], v[18:19]
 v_cvt_pk_bf16_f32 v48, v16, v17
 v_lshlrev_b32 v16, 16, v49
 v_and_b32 v17, s59, v49
 v_lshlrev_b32 v18, 16, v65
 v_and_b32 v19, s59, v65
 v_pk_mul_f32 v[16:17], v[16:17], v[18:19]
 v_cvt_pk_bf16_f32 v49, v16, v17
 v_lshlrev_b32 v16, 16, v50
 v_and_b32 v17, s59, v50
 v_lshlrev_b32 v18, 16, v66
 v_and_b32 v19, s59, v66
 v_pk_mul_f32 v[16:17], v[16:17], v[18:19]
 v_cvt_pk_bf16_f32 v50, v16, v17
 v_lshlrev_b32 v16, 16, v51
 v_and_b32 v17, s59, v51
 v_lshlrev_b32 v18, 16, v67
 v_and_b32 v19, s59, v67
 v_pk_mul_f32 v[16:17], v[16:17], v[18:19]
 v_cvt_pk_bf16_f32 v51, v16, v17
 buffer_store_dwordx4 v[48:51], v3, s[8:11], s47 offen offset:0
 s_waitcnt lgkmcnt(8)
 v_lshlrev_b32 v16, 16, v52
 v_and_b32 v17, s59, v52
 v_lshlrev_b32 v18, 16, v68
 v_and_b32 v19, s59, v68
 v_pk_mul_f32 v[16:17], v[16:17], v[18:19]
 v_cvt_pk_bf16_f32 v52, v16, v17
 v_lshlrev_b32 v16, 16, v53
 v_and_b32 v17, s59, v53
 v_lshlrev_b32 v18, 16, v69
 v_and_b32 v19, s59, v69
 v_pk_mul_f32 v[16:17], v[16:17], v[18:19]
 v_cvt_pk_bf16_f32 v53, v16, v17
 v_lshlrev_b32 v16, 16, v54
 v_and_b32 v17, s59, v54
 v_lshlrev_b32 v18, 16, v70
 v_and_b32 v19, s59, v70
 v_pk_mul_f32 v[16:17], v[16:17], v[18:19]
 v_cvt_pk_bf16_f32 v54, v16, v17
 v_lshlrev_b32 v16, 16, v55
 v_and_b32 v17, s59, v55
 v_lshlrev_b32 v18, 16, v71
 v_and_b32 v19, s59, v71
 v_pk_mul_f32 v[16:17], v[16:17], v[18:19]
 v_cvt_pk_bf16_f32 v55, v16, v17
 buffer_store_dwordx4 v[52:55], v3, s[8:11], s47 offen offset:64
 s_waitcnt lgkmcnt(4)
 v_lshlrev_b32 v16, 16, v56
 v_and_b32 v17, s59, v56
 v_lshlrev_b32 v18, 16, v72
 v_and_b32 v19, s59, v72
 v_pk_mul_f32 v[16:17], v[16:17], v[18:19]
 v_cvt_pk_bf16_f32 v56, v16, v17
 v_lshlrev_b32 v16, 16, v57
 v_and_b32 v17, s59, v57
 v_lshlrev_b32 v18, 16, v73
 v_and_b32 v19, s59, v73
 v_pk_mul_f32 v[16:17], v[16:17], v[18:19]
 v_cvt_pk_bf16_f32 v57, v16, v17
 v_lshlrev_b32 v16, 16, v58
 v_and_b32 v17, s59, v58
 v_lshlrev_b32 v18, 16, v74
 v_and_b32 v19, s59, v74
 v_pk_mul_f32 v[16:17], v[16:17], v[18:19]
 v_cvt_pk_bf16_f32 v58, v16, v17
 v_lshlrev_b32 v16, 16, v59
 v_and_b32 v17, s59, v59
 v_lshlrev_b32 v18, 16, v75
 v_and_b32 v19, s59, v75
 v_pk_mul_f32 v[16:17], v[16:17], v[18:19]
 v_cvt_pk_bf16_f32 v59, v16, v17
 buffer_store_dwordx4 v[56:59], v3, s[8:11], s55 offen offset:0
 s_waitcnt lgkmcnt(0)
 v_lshlrev_b32 v16, 16, v60
 v_and_b32 v17, s59, v60
 v_lshlrev_b32 v18, 16, v76
 v_and_b32 v19, s59, v76
 v_pk_mul_f32 v[16:17], v[16:17], v[18:19]
 v_cvt_pk_bf16_f32 v60, v16, v17
 v_lshlrev_b32 v16, 16, v61
 v_and_b32 v17, s59, v61
 v_lshlrev_b32 v18, 16, v77
 v_and_b32 v19, s59, v77
 v_pk_mul_f32 v[16:17], v[16:17], v[18:19]
 v_cvt_pk_bf16_f32 v61, v16, v17
 v_lshlrev_b32 v16, 16, v62
 v_and_b32 v17, s59, v62
 v_lshlrev_b32 v18, 16, v78
 v_and_b32 v19, s59, v78
 v_pk_mul_f32 v[16:17], v[16:17], v[18:19]
 v_cvt_pk_bf16_f32 v62, v16, v17
 v_lshlrev_b32 v16, 16, v63
 v_and_b32 v17, s59, v63
 v_lshlrev_b32 v18, 16, v79
 v_and_b32 v19, s59, v79
 v_pk_mul_f32 v[16:17], v[16:17], v[18:19]
 v_cvt_pk_bf16_f32 v63, v16, v17
 buffer_store_dwordx4 v[60:63], v3, s[8:11], s55 offen offset:64
 s_waitcnt vmcnt(4)
 s_branch L_job
L_fin:
 s_endpgm
L_codeend:
.section .rodata,"a"
.p2align 6
.amdhsa_kernel concat_heads__ssm_conv_h3__compressed_kv_cla__prompt_kernel
  .amdhsa_next_free_vgpr 512
  .amdhsa_next_free_sgpr 102
  .amdhsa_accum_offset 256
  .amdhsa_group_segment_fixed_size 0
  .amdhsa_kernarg_size 120
  .amdhsa_user_sgpr_count 2
  .amdhsa_user_sgpr_kernarg_segment_ptr 1
  .amdhsa_system_sgpr_workgroup_id_x 1
.end_amdhsa_kernel
```

```asm
; @launch grid=(256,1,1) block=(256,1,1) lds=163840
.amdgcn_target "amdgcn-amd-amdhsa--gfx950"
.text
.globl concat_heads__ssm_conv_h3__compressed_kv_cla__prompt_kernel
.p2align 8
.type concat_heads__ssm_conv_h3__compressed_kv_cla__prompt_kernel,@function
concat_heads__ssm_conv_h3__compressed_kv_cla__prompt_kernel:
 s_cmp_lt_u32 s2, 256
 s_cbranch_scc1 L_go
 s_endpgm
L_go:
 s_load_dwordx16 s[64:79], s[0:1], 0
 s_load_dwordx8 s[80:87], s[0:1], 64
 s_load_dwordx4 s[88:91], s[0:1], 96
 s_load_dwordx2 s[12:13], s[0:1], 112
 v_lshrrev_b32 v1, 6, v0
 v_and_b32 v0, 63, v0
 v_readfirstlane_b32 s3, v1
 s_and_b32 s24, s2, 7
 s_bfe_u32 s25, s2, 0x30003
 s_bfe_u32 s26, s2, 0x10006
 s_lshl_b32 s37, s24, 1
 s_add_u32 s26, s26, s37
 s_lshr_b32 s27, s2, 7
 s_bfe_u32 s28, s2, 0x40003
 s_lshl_b32 s29, s3, 10
 s_and_b32 s39, s3, 1
 s_lshr_b32 s40, s3, 1
 s_cmp_eq_u32 s27, 0
 s_cselect_b32 s37, 7, 7
 s_add_u32 s37, s37, s25
 s_and_b32 s37, s37, 7
 s_lshl_b32 s37, s37, 1
 s_lshr_b32 s28, s28, 3
 s_add_u32 s28, s28, s37
 s_getpc_b64 s[100:101]
L_pc:
 s_sub_u32 s100, s100, L_pc-L_go
 s_subb_u32 s101, s101, 0
 s_lshr_b32 s32, s2, 1
 s_and_b32 s32, s32, 124
 s_add_u32 s32, s32, s3
 s_mul_i32 s32, s32, 1152
 s_add_u32 s32, s32, 0
 v_min_u32 v14, 8, v0
 v_lshl_add_u32 v14, v14, 7, s32
 v_min_u32 v14, L_codeend-L_go-4, v14
 global_load_dword a243, v14, s[100:101]
 s_mov_b32 s41, 65536
 s_mov_b32 s48, 32768
 s_mov_b32 s42, 131072
 s_mov_b32 s49, 131072
 s_mov_b32 s43, 196608
 s_mov_b32 s50, 163840
 s_mov_b32 s44, 262144
 s_mov_b32 s51, 262144
 s_mov_b32 s45, 327680
 s_mov_b32 s52, 294912
 s_mov_b32 s46, 393216
 s_mov_b32 s53, 393216
 s_mov_b32 s47, 458752
 s_mov_b32 s54, 425984
 s_lshl_b32 s56, s39, 1
 s_lshl_b32 s57, s40, 3
 s_add_u32 s56, s56, s57
 s_lshl_b32 s60, s25, 8
 s_lshl_b32 s58, s3, 3
 s_add_u32 s58, s58, s60
 v_lshrrev_b32 v14, 3, v0
 v_add_u32 v14, s58, v14
 v_lshlrev_b32 v14, 11, v14
 s_lshl_b32 s58, s39, 2
 v_lshrrev_b32 v15, 4, v0
 v_add_u32 v15, s58, v15
 v_xor_b32 v15, v0, v15
 v_and_b32 v15, 7, v15
 v_lshl_add_u32 v1, v15, 4, v14
 v_lshrrev_b32 v14, 5, v0
 s_lshl_b32 s58, s3, 1
 v_add_u32 v15, s58, v14
 v_lshlrev_b32 v15, 1, v15
 v_xor_b32 v15, v0, v15
 v_and_b32 v15, 31, v15
 v_lshlrev_b32 v15, 4, v15
 v_add_u32 v14, s56, v14
 v_lshl_add_u32 v14, v14, 13, v15
 s_lshl_b32 s58, s26, 9
 v_add_u32 v2, s58, v14
 s_waitcnt lgkmcnt(0)
 s_cmp_eq_u32 s27, 0
 s_cselect_b32 s8, s82, s84
 s_cselect_b32 s9, s83, s85
 s_mov_b32 s10, 8388608
 s_mov_b32 s11, 0x20000
 s_mov_b32 s4, s78
 s_mov_b32 s5, s79
 s_mov_b32 s6, 4194304
 s_mov_b32 s7, 0x20000
 s_mov_b32 s14, 268435456
 s_mov_b32 s15, 0x20000
 s_add_u32 m0, s29, 65536
 s_nop 0
 buffer_load_dwordx4 v2, s[8:11], 0 offen  lds
 s_lshl_b32 s58, s27, 3
 s_add_u32 s59, s58, s25
 s_lshl_b32 s59, s59, 2
 s_lshl_b32 s92, s26, 7
 s_add_u32 s92, s92, s59
 s_add_u32 s92, s92, 84934656
 s_add_u32 s58, s58, s24
 s_mul_i32 s95, s58, 14
 s_add_u32 s95, s95, s28
 s_sub_u32 s63, 15, s25
 s_add_u32 m0, s29, 0
 s_nop 0
 buffer_load_dwordx4 v1, s[4:7], 0 offen  lds
 s_cmp_eq_u32 s27, 0
 s_cselect_b32 s63, s25, s63
 s_lshl_b32 s93, s63, 7
 s_lshl_b32 s59, s26, 2
 s_add_u32 s93, s93, s59
 s_add_u32 s93, s93, 84938752
 s_and_b32 s94, s2, 127
 s_lshl_b32 s94, s94, 7
 s_add_u32 s94, s94, 84942848
 s_cmp_lg_u32 s3, 0
 s_cbranch_scc1 L_noclr
 s_lshl_b32 s58, s95, 2
 s_add_u32 s59, s58, 84963328
 s_add_u32 s58, s58, 84959232
 s_lshl_b32 s61, s27, 2
 s_add_u32 s61, s61, s94
 s_cmp_lt_u32 s28, 14
 s_cselect_b32 s58, s58, s92
 s_cselect_b32 s59, s59, s92
 v_mov_b32 v14, s92
 v_writelane_b32 v14, s93, 1
 v_writelane_b32 v14, s61, 2
 v_writelane_b32 v14, s58, 3
 v_writelane_b32 v14, s59, 4
 s_add_u32 s58, s93, 64
 v_writelane_b32 v14, s58, 5
 s_lshl_b32 s58, s2, 12
 s_add_u32 s58, s58, 84967424
 s_cmp_lt_u32 s2, 4
 s_cselect_b32 s58, s58, s92
 v_writelane_b32 v14, s58, 6
 v_mov_b32 v15, 1
 s_mov_b64 exec, 127
 buffer_store_dword v15, v14, s[12:15], 0 offen sc1
 s_mov_b64 exec, -1
L_noclr:
 s_add_u32 m0, s29, 69632
 s_nop 0
 buffer_load_dwordx4 v2, s[8:11], s48 offen  lds
 s_add_u32 m0, s29, 4096
 s_nop 0
 buffer_load_dwordx4 v1, s[4:7], s41 offen  lds
 s_add_u32 m0, s29, 73728
 s_nop 0
 buffer_load_dwordx4 v2, s[8:11], s49 offen  lds
 s_cmp_eq_u32 s3, 0
 s_cselect_b32 s58, 0, 0x80000000
 s_add_u32 m0, s29, 8192
 s_nop 0
 buffer_load_dwordx4 v1, s[4:7], s42 offen  lds
 v_bfrev_b32 v14, 1
 v_writelane_b32 v14, s58, 0
 v_accvgpr_write_b32 a245, v14
 s_lshl_b32 s58, s39, 7
 s_lshl_b32 s59, s40, 3
 v_and_b32 v14, 15, v0
 v_lshrrev_b32 v15, 4, v0
 s_lshl_b32 s60, s63, 7
 s_lshl_b32 s62, s3, 4
 s_add_u32 s60, s60, s62
 s_add_u32 m0, s29, 77824
 s_nop 0
 buffer_load_dwordx4 v2, s[8:11], s50 offen  lds
 v_lshrrev_b32 v13, 3, v0
 v_lshlrev_b32 v13, 1, v13
 v_add_u32 v12, s60, v13
 v_mul_u32_u24 v12, 896, v12
 v_lshrrev_b32 v13, 1, v13
 v_xor_b32 v13, v0, v13
 v_and_b32 v13, 7, v13
 v_lshl_add_u32 v13, v13, 4, v12
 v_accvgpr_write_b32 a240, v13
 s_add_u32 m0, s29, 12288
 s_nop 0
 buffer_load_dwordx4 v1, s[4:7], s43 offen  lds
 v_lshrrev_b32 v13, 1, v14
 v_xor_b32 v12, v13, v15
 v_lshlrev_b32 v12, 4, v12
 v_lshl_add_u32 v12, v13, 7, v12
 v_and_b32 v13, 1, v14
 v_lshl_add_u32 v12, v13, 10, v12
 s_lshl_b32 s33, s3, 13
 s_add_u32 s33, s33, 0x20000
 v_add_u32 v12, s33, v12
 v_accvgpr_write_b32 a242, v12
 s_add_u32 m0, s29, 81920
 s_nop 0
 buffer_load_dwordx4 v2, s[8:11], s51 offen  lds
 v_lshrrev_b32 v5, 1, v14
 v_xor_b32 v5, v5, v15
 v_add_u32 v14, s58, v14
 v_lshlrev_b32 v14, 7, v14
 v_lshl_add_u32 v4, v5, 4, v14
 v_xor_b32 v5, 64, v4
 v_bfe_u32 v14, v0, 2, 3
 v_lshrrev_b32 v15, 5, v0
 v_lshl_add_u32 v13, v15, 4, v14
 s_add_u32 m0, s29, 16384
 s_nop 0
 buffer_load_dwordx4 v1, s[4:7], s44 offen  lds
 v_lshlrev_b32 v13, 9, v13
 v_xor_b32 v14, s59, v14
 v_lshl_add_u32 v13, v14, 5, v13
 v_and_b32 v14, 3, v0
 v_lshl_add_u32 v13, v14, 3, v13
 v_add_u32 v6, 0x10000, v13
 v_xor_b32 v7, 32, v6
 v_xor_b32 v8, 64, v6
 v_xor_b32 v9, 96, v6
 v_xor_b32 v10, 128, v6
 s_add_u32 m0, s29, 86016
 s_nop 0
 buffer_load_dwordx4 v2, s[8:11], s52 offen  lds
 v_xor_b32 v11, 160, v6
 v_xor_b32 v12, 192, v6
 v_xor_b32 v13, 224, v6
 s_mov_b32 s16, s80
 s_mov_b32 s17, s81
 s_mov_b32 s18, 3670016
 s_mov_b32 s19, 0x20000
 s_mov_b32 s20, s76
 s_mov_b32 s21, s77
 s_add_u32 m0, s29, 20480
 s_nop 0
 buffer_load_dwordx4 v1, s[4:7], s45 offen  lds
 s_mov_b32 s22, 1835008
 s_mov_b32 s23, 0x20000
 s_and_b32 s62, s2, 127
 s_lshl_b32 s62, s62, 2
 s_add_u32 s62, s62, s3
 s_mul_i32 s62, s62, 17408
 s_add_u32 s62, s62, 50331648
 s_mul_i32 s58, s26, 1048576
 s_mul_i32 s59, s25, 131072
 s_add_u32 s58, s58, s59
 s_add_u32 m0, s29, 90112
 s_nop 0
 buffer_load_dwordx4 v2, s[8:11], s53 offen  lds
 s_mul_i32 s59, s39, 65536
 s_add_u32 s58, s58, s59
 s_lshl_b32 s59, s40, 12
 s_lshl_b32 s59, s59, s27
 s_add_u32 s58, s58, s59
 s_mul_i32 s59, s27, 16777216
 s_add_u32 s58, s58, s59
 s_mov_b32 s57, 57344
 s_lshl_b32 s60, s40, 8
 s_add_u32 m0, s29, 24576
 s_nop 0
 buffer_load_dwordx4 v1, s[4:7], s46 offen  lds
 s_add_u32 s60, s60, 0x10000
 s_mov_b32 s34, 0x3db8aa3b
 s_mov_b32 s35, 0x3db8aa3b
 s_mul_i32 s55, s25, 5
 s_lshr_b32 s55, s55, 3
 s_add_u32 s55, s55, 1
 s_cmp_lg_u32 s3, 0
 s_cmov_b32 s55, 6
 v_mov_b32 v15, 1
 s_cmp_ge_u32 s25, 6
 s_cmov_b32 s62, 2.0
 s_add_u32 m0, s29, 94208
 s_nop 0
 buffer_load_dwordx4 v2, s[8:11], s54 offen  lds
 v_mov_b32 v20, 0
 v_mov_b32 v21, 0
 v_mov_b32 v24, 0
 v_mov_b32 v25, 0
 v_and_b32 v26, 1, v0
 v_lshlrev_b32 v26, 4, v26
 v_mov_b32 v27, 0x3f80
 v_lshlrev_b32 v26, v26, v27
 v_bfe_u32 v27, v0, 1, 3
 s_add_u32 m0, s29, 28672
 s_nop 0
 buffer_load_dwordx4 v1, s[4:7], s47 offen  lds
 v_add_u32 v1, 128, v1
 v_add_u32 v2, 0x80000, v2
 v_lshrrev_b32 v28, 4, v0
 v_lshlrev_b32 v28, 1, v28
 v_sub_u32 v27, v27, v28
 v_cmp_eq_u32 s[0:1], 0, v27
 v_cmp_eq_u32 vcc, 1, v27
 v_lshrrev_b32 v31, 3, v0
 s_lshl_b32 s31, s3, 6
 v_add_u32 v30, s31, v31
 v_mul_u32_u24 v30, 896, v30
 s_add_u32 m0, s29, 98304
 s_nop 0
 buffer_load_dwordx4 v2, s[8:11], 0 offen  lds
 v_and_b32 v31, 6, v31
 v_xor_b32 v31, v31, v0
 v_and_b32 v31, 7, v31
 v_lshl_add_u32 v30, v31, 4, v30
 v_cndmask_b32 v22, 0, v26, s[0:1]
 v_cndmask_b32 v23, 0, v26, vcc
 v_accvgpr_write_b32 a248, v20
 v_accvgpr_write_b32 a249, v21
 v_accvgpr_write_b32 a250, v22
 v_accvgpr_write_b32 a251, v23
 s_add_u32 m0, s29, 32768
 s_nop 0
 buffer_load_dwordx4 v1, s[4:7], 0 offen  lds
 v_accvgpr_write_b32 a252, v24
 v_accvgpr_write_b32 a253, v25
 v_accvgpr_write_b32 a241, v30
 s_lshl_b32 s31, s27, 3
 s_add_u32 s31, s31, s25
 s_cmp_lt_u32 s31, 6
 s_cselect_b64 vcc, -1, 0
 v_lshlrev_b32 v31, 4, v0
 v_cndmask_b32 v30, v30, v31, vcc
 s_add_u32 m0, s29, 102400
 s_nop 0
 buffer_load_dwordx4 v2, s[8:11], s48 offen  lds
 v_accvgpr_write_b32 a244, v30
 v_lshrrev_b32 v31, 2, v0
 v_lshlrev_b32 v30, 7, v31
 v_bfe_u32 v31, v31, 1, 2
 v_lshl_add_u32 v30, v31, 5, v30
 v_and_b32 v31, 3, v0
 v_lshl_add_u32 v30, v31, 3, v30
 v_add_u32 v30, 131072, v30
 v_accvgpr_write_b32 a254, v30
 s_lshl_b32 s31, s25, 16
 s_add_u32 m0, s29, 36864
 s_nop 0
 buffer_load_dwordx4 v1, s[4:7], s41 offen  lds
 s_lshl_b32 s32, s26, 9
 s_add_u32 s31, s31, s32
 v_lshrrev_b32 v15, 3, v0
 v_lshlrev_b32 v15, 13, v15
 v_and_b32 v14, 7, v0
 v_lshlrev_b32 v14, 6, v14
 v_add3_u32 v16, v14, v15, s31
 s_lshl_b32 s31, s25, 2
 s_lshr_b32 s32, s2, 6
 s_add_u32 m0, s29, 106496
 s_nop 0
 buffer_load_dwordx4 v2, s[8:11], s49 offen  lds
 s_add_u32 s31, s31, s32
 s_lshl_b32 s31, s31, 17
 v_lshlrev_b32 v17, 11, v0
 v_add_u32 v17, s31, v17
 s_mul_i32 s36, s2, 7282
 s_lshr_b32 s36, s36, 16
 s_mul_i32 s37, s36, 9
 s_sub_u32 s37, s2, s37
 s_lshl_b32 s38, s36, 16
 s_mov_b64 s[30:31], s[80:81]
 s_add_u32 m0, s29, 40960
 s_nop 0
 buffer_load_dwordx4 v1, s[4:7], s42 offen  lds
 s_cmp_eq_u32 s37, 2
 s_cmov_b64 s[30:31], s[76:77]
 s_cmp_eq_u32 s37, 3
 s_cmov_b64 s[30:31], s[66:67]
 s_cmp_eq_u32 s37, 4
 s_cmov_b64 s[30:31], s[68:69]
 s_cmp_eq_u32 s37, 5
 s_cmov_b64 s[30:31], s[86:87]
 s_cmp_eq_u32 s37, 6
 s_cmov_b64 s[30:31], s[86:87]
 s_add_u32 m0, s29, 110592
 s_nop 0
 buffer_load_dwordx4 v2, s[8:11], s50 offen  lds
 s_cmp_eq_u32 s37, 7
 s_cmov_b64 s[30:31], s[72:73]
 s_cmp_eq_u32 s37, 8
 s_cmov_b64 s[30:31], s[64:65]
 s_add_u32 s32, s38, 1835008
 s_cmp_eq_u32 s37, 1
 s_cmov_b32 s38, s32
 s_cmp_eq_u32 s37, 6
 s_cmov_b32 s38, s32
 s_add_u32 m0, s29, 45056
 s_nop 0
 buffer_load_dwordx4 v1, s[4:7], s43 offen  lds
 s_lshl_b32 s32, s39, 15
 s_add_u32 s38, s38, s32
 s_cmp_ge_u32 s37, 9
 s_cmov_b32 s36, 28
 s_cmp_lt_u32 s36, 28
 s_cselect_b32 s32, 0x8000, 0
 s_cselect_b32 s38, s38, 0
 s_add_u32 s36, s30, s38
 s_addc_u32 s37, s31, 0
 s_add_u32 m0, s29, 114688
 s_nop 0
 buffer_load_dwordx4 v2, s[8:11], s51 offen  lds
 s_mov_b32 s38, s32
 s_mov_b32 s39, 0x20000
 v_lshlrev_b32 v14, 6, v0
 s_mov_b32 s56, 0xffffc000
 s_movk_i32 s30, 0x1000
 s_cmp_ge_u32 s3, 2
 s_cbranch_scc1 L_pfset
 s_mov_b32 s38, 0
 s_cmp_eq_u32 s3, 0
 s_cselect_b64 s[36:37], s[8:9], s[4:5]
 s_cselect_b32 s38, s10, s6
 s_movk_i32 s30, 128
 s_cmov_b32 s30, 0x80000
 s_cselect_b64 vcc, -1, 0
 s_lshl_b32 s56, s30, 1
 v_cndmask_b32 v14, v17, v16, vcc
L_pfset:
 s_add_u32 m0, s29, 49152
 s_nop 0
 buffer_load_dwordx4 v1, s[4:7], s44 offen  lds
 v_mov_b32 v15, 1
 v_lshlrev_b32 v3, 21, v0
 s_cmp_eq_u32 s27, 0
 s_cbranch_scc0 L_vloop_head
L_kloop_head:
 s_mov_b32 s61, 0
 s_waitcnt vmcnt(10)
 s_barrier
 ds_read_b64_tr_b16 a[0:1], v6 offset:0
 ds_read_b64_tr_b16 a[2:3], v6 offset:4096
 ds_read_b64_tr_b16 a[4:5], v6 offset:16384
 ds_read_b64_tr_b16 a[6:7], v6 offset:20480
 ds_read_b128 a[64:67], v4 offset:0
 ds_read_b128 a[68:71], v5 offset:0
 ds_read_b128 a[76:79], v5 offset:2048
 ds_read_b128 a[72:75], v4 offset:2048
 ds_read_b128 a[80:83], v4 offset:4096
 ds_read_b128 a[84:87], v5 offset:4096
 ds_read_b128 a[92:95], v5 offset:6144
 ds_read_b128 a[88:91], v4 offset:6144
 ds_read_b64_tr_b16 a[8:9], v7 offset:0
 ds_read_b64_tr_b16 a[10:11], v7 offset:4096
 ds_read_b64_tr_b16 a[12:13], v7 offset:16384
 ds_read_b64_tr_b16 a[14:15], v7 offset:20480
 ds_read_b64_tr_b16 a[16:17], v8 offset:0
 ds_read_b64_tr_b16 a[18:19], v8 offset:4096
 ds_read_b64_tr_b16 a[20:21], v8 offset:16384
 ds_read_b64_tr_b16 a[22:23], v8 offset:20480
 ds_read_b64_tr_b16 a[24:25], v9 offset:0
 ds_read_b64_tr_b16 a[26:27], v9 offset:4096
 s_waitcnt lgkmcnt(0)
 v_mfma_f32_16x16x32_bf16 v[88:91], a[0:3], a[64:67], 0
 s_add_u32 m0, s29, 118784
 ds_read_b64_tr_b16 a[28:29], v9 offset:16384
 v_mfma_f32_16x16x32_bf16 v[88:91], a[4:7], a[68:71], v[88:91]
 ds_read_b64_tr_b16 a[30:31], v9 offset:20480
 buffer_load_dwordx4 v2, s[8:11], s52 offen  lds
 v_mfma_f32_16x16x32_bf16 v[80:83], a[4:7], a[76:79], 0
 ds_read_b128 a[96:99], v4 offset:8192
 v_mfma_f32_16x16x32_bf16 v[80:83], a[0:3], a[72:75], v[80:83]
 v_mfma_f32_16x16x32_bf16 v[72:75], a[0:3], a[80:83], 0
 s_add_u32 m0, s29, 53248
 ds_read_b128 a[100:103], v5 offset:8192
 v_mfma_f32_16x16x32_bf16 v[72:75], a[4:7], a[84:87], v[72:75]
 buffer_load_dwordx4 v1, s[4:7], s45 offen  lds
 v_mfma_f32_16x16x32_bf16 v[64:67], a[4:7], a[92:95], 0
 ds_read_b128 a[108:111], v5 offset:10240
 v_mfma_f32_16x16x32_bf16 v[64:67], a[0:3], a[88:91], v[64:67]
 v_mfma_f32_16x16x32_bf16 v[68:71], a[8:11], a[88:91], 0
 s_add_u32 m0, s29, 122880
 ds_read_b128 a[104:107], v4 offset:10240
 v_mfma_f32_16x16x32_bf16 v[68:71], a[12:15], a[92:95], v[68:71]
 buffer_load_dwordx4 v2, s[8:11], s53 offen  lds
 v_mfma_f32_16x16x32_bf16 v[76:79], a[12:15], a[84:87], 0
 ds_read_b128 a[112:115], v4 offset:12288
 v_mfma_f32_16x16x32_bf16 v[76:79], a[8:11], a[80:83], v[76:79]
 v_mfma_f32_16x16x32_bf16 v[84:87], a[8:11], a[72:75], 0
 s_add_u32 m0, s29, 57344
 ds_read_b128 a[116:119], v5 offset:12288
 v_mfma_f32_16x16x32_bf16 v[84:87], a[12:15], a[76:79], v[84:87]
 buffer_load_dwordx4 v1, s[4:7], s46 offen  lds
 v_mfma_f32_16x16x32_bf16 v[92:95], a[12:15], a[68:71], 0
 ds_read_b128 a[124:127], v5 offset:14336
 v_mfma_f32_16x16x32_bf16 v[92:95], a[8:11], a[64:67], v[92:95]
 v_mfma_f32_16x16x32_bf16 v[120:123], a[16:19], a[64:67], 0
 s_add_u32 m0, s29, 126976
 ds_read_b128 a[120:123], v4 offset:14336
 v_mfma_f32_16x16x32_bf16 v[120:123], a[20:23], a[68:71], v[120:123]
 buffer_load_dwordx4 v2, s[8:11], s54 offen  lds
 v_mfma_f32_16x16x32_bf16 v[112:115], a[20:23], a[76:79], 0
 ds_read_b64_tr_b16 a[32:33], v10 offset:0
 v_mfma_f32_16x16x32_bf16 v[112:115], a[16:19], a[72:75], v[112:115]
 ds_read_b64_tr_b16 a[34:35], v10 offset:4096
 v_mfma_f32_16x16x32_bf16 v[104:107], a[16:19], a[80:83], 0
 s_add_u32 m0, s29, 61440
 ds_read_b64_tr_b16 a[36:37], v10 offset:16384
 v_mfma_f32_16x16x32_bf16 v[104:107], a[20:23], a[84:87], v[104:107]
 ds_read_b64_tr_b16 a[38:39], v10 offset:20480
 buffer_load_dwordx4 v1, s[4:7], s47 offen  lds
 v_mfma_f32_16x16x32_bf16 v[96:99], a[20:23], a[92:95], 0
 ds_read_b64_tr_b16 a[40:41], v11 offset:0
 v_add_u32 v1, 128, v1
 v_mfma_f32_16x16x32_bf16 v[96:99], a[16:19], a[88:91], v[96:99]
 ds_read_b64_tr_b16 a[42:43], v11 offset:4096
 v_add_u32 v2, 0x80000, v2
 v_mfma_f32_16x16x32_bf16 v[100:103], a[24:27], a[88:91], 0
 s_waitcnt lgkmcnt(8)
 ds_read_b64_tr_b16 a[44:45], v11 offset:16384
 v_mfma_f32_16x16x32_bf16 v[100:103], a[28:31], a[92:95], v[100:103]
 ds_read_b64_tr_b16 a[46:47], v11 offset:20480
 v_mfma_f32_16x16x32_bf16 v[108:111], a[28:31], a[84:87], 0
 ds_read_b64_tr_b16 a[48:49], v12 offset:0
 v_mfma_f32_16x16x32_bf16 v[108:111], a[24:27], a[80:83], v[108:111]
 ds_read_b64_tr_b16 a[50:51], v12 offset:4096
 v_mfma_f32_16x16x32_bf16 v[116:119], a[24:27], a[72:75], 0
 ds_read_b64_tr_b16 a[52:53], v12 offset:16384
 v_mfma_f32_16x16x32_bf16 v[116:119], a[28:31], a[76:79], v[116:119]
 ds_read_b64_tr_b16 a[54:55], v12 offset:20480
 v_mfma_f32_16x16x32_bf16 v[124:127], a[28:31], a[68:71], 0
 ds_read_b64_tr_b16 a[56:57], v13 offset:0
 v_mfma_f32_16x16x32_bf16 v[124:127], a[24:27], a[64:67], v[124:127]
 ds_read_b64_tr_b16 a[58:59], v13 offset:4096
 v_mfma_f32_16x16x32_bf16 a[232:235], a[0:3], a[96:99], 0
 ds_read_b64_tr_b16 a[60:61], v13 offset:16384
 v_mfma_f32_16x16x32_bf16 a[232:235], a[4:7], a[100:103], a[232:235]
 ds_read_b64_tr_b16 a[62:63], v13 offset:20480
 v_mfma_f32_16x16x32_bf16 a[224:227], a[4:7], a[108:111], 0
 v_mfma_f32_16x16x32_bf16 a[224:227], a[0:3], a[104:107], a[224:227]
 v_mfma_f32_16x16x32_bf16 v[24:27], a[0:3], a[112:115], 0
 v_mfma_f32_16x16x32_bf16 v[24:27], a[4:7], a[116:119], v[24:27]
 s_waitcnt lgkmcnt(8)
 v_mfma_f32_16x16x32_bf16 v[16:19], a[4:7], a[124:127], 0
 v_mfma_f32_16x16x32_bf16 v[16:19], a[0:3], a[120:123], v[16:19]
 s_waitcnt lgkmcnt(0)
 v_mfma_f32_16x16x32_bf16 v[20:23], a[8:11], a[120:123], 0
 s_barrier
 v_mfma_f32_16x16x32_bf16 v[20:23], a[12:15], a[124:127], v[20:23]
 s_add_u32 m0, s29, 65536
 v_mfma_f32_16x16x32_bf16 v[28:31], a[12:15], a[116:119], 0
 buffer_load_dwordx4 v2, s[8:11], 0 offen  lds
 v_mfma_f32_16x16x32_bf16 v[28:31], a[8:11], a[112:115], v[28:31]
 v_mfma_f32_16x16x32_bf16 a[228:231], a[8:11], a[104:107], 0
 v_mfma_f32_16x16x32_bf16 a[228:231], a[12:15], a[108:111], a[228:231]
 v_mfma_f32_16x16x32_bf16 a[236:239], a[12:15], a[100:103], 0
 s_add_u32 m0, s29, 0
 v_mfma_f32_16x16x32_bf16 a[236:239], a[8:11], a[96:99], a[236:239]
 buffer_load_dwordx4 v1, s[4:7], 0 offen  lds
 v_mfma_f32_16x16x32_bf16 v[56:59], a[16:19], a[96:99], 0
 v_mfma_f32_16x16x32_bf16 v[56:59], a[20:23], a[100:103], v[56:59]
 v_mfma_f32_16x16x32_bf16 v[48:51], a[20:23], a[108:111], 0
 v_mfma_f32_16x16x32_bf16 v[48:51], a[16:19], a[104:107], v[48:51]
 s_add_u32 m0, s29, 69632
 v_mfma_f32_16x16x32_bf16 v[40:43], a[16:19], a[112:115], 0
 buffer_load_dwordx4 v2, s[8:11], s48 offen  lds
 v_mfma_f32_16x16x32_bf16 v[40:43], a[20:23], a[116:119], v[40:43]
 v_mfma_f32_16x16x32_bf16 v[32:35], a[20:23], a[124:127], 0
 v_mfma_f32_16x16x32_bf16 v[32:35], a[16:19], a[120:123], v[32:35]
 v_mfma_f32_16x16x32_bf16 v[36:39], a[24:27], a[120:123], 0
 s_add_u32 m0, s29, 4096
 v_mfma_f32_16x16x32_bf16 v[36:39], a[28:31], a[124:127], v[36:39]
 buffer_load_dwordx4 v1, s[4:7], s41 offen  lds
 v_mfma_f32_16x16x32_bf16 v[44:47], a[28:31], a[116:119], 0
 v_mfma_f32_16x16x32_bf16 v[44:47], a[24:27], a[112:115], v[44:47]
 v_mfma_f32_16x16x32_bf16 v[52:55], a[24:27], a[104:107], 0
 v_mfma_f32_16x16x32_bf16 v[52:55], a[28:31], a[108:111], v[52:55]
 s_add_u32 m0, s29, 73728
 v_mfma_f32_16x16x32_bf16 v[60:63], a[28:31], a[100:103], 0
 buffer_load_dwordx4 v2, s[8:11], s49 offen  lds
 v_mfma_f32_16x16x32_bf16 v[60:63], a[24:27], a[96:99], v[60:63]
 v_mfma_f32_16x16x32_bf16 v[216:219], a[32:35], a[96:99], 0
 v_mfma_f32_16x16x32_bf16 v[216:219], a[36:39], a[100:103], v[216:219]
 v_mfma_f32_16x16x32_bf16 v[208:211], a[36:39], a[108:111], 0
 s_add_u32 m0, s29, 8192
 v_mfma_f32_16x16x32_bf16 v[208:211], a[32:35], a[104:107], v[208:211]
 buffer_load_dwordx4 v1, s[4:7], s42 offen  lds
 v_mfma_f32_16x16x32_bf16 v[200:203], a[32:35], a[112:115], 0
 v_mfma_f32_16x16x32_bf16 v[200:203], a[36:39], a[116:119], v[200:203]
 v_mfma_f32_16x16x32_bf16 v[192:195], a[36:39], a[124:127], 0
 v_mfma_f32_16x16x32_bf16 v[192:195], a[32:35], a[120:123], v[192:195]
 s_add_u32 m0, s29, 77824
 v_mfma_f32_16x16x32_bf16 v[196:199], a[40:43], a[120:123], 0
 buffer_load_dwordx4 v2, s[8:11], s50 offen  lds
 v_mfma_f32_16x16x32_bf16 v[196:199], a[44:47], a[124:127], v[196:199]
 v_mfma_f32_16x16x32_bf16 v[204:207], a[44:47], a[116:119], 0
 v_mfma_f32_16x16x32_bf16 v[204:207], a[40:43], a[112:115], v[204:207]
 v_mfma_f32_16x16x32_bf16 v[212:215], a[40:43], a[104:107], 0
 s_add_u32 m0, s29, 12288
 v_mfma_f32_16x16x32_bf16 v[212:215], a[44:47], a[108:111], v[212:215]
 buffer_load_dwordx4 v1, s[4:7], s43 offen  lds
 v_mfma_f32_16x16x32_bf16 v[220:223], a[44:47], a[100:103], 0
 v_mfma_f32_16x16x32_bf16 v[220:223], a[40:43], a[96:99], v[220:223]
 v_mfma_f32_16x16x32_bf16 v[248:251], a[48:51], a[96:99], 0
 v_mfma_f32_16x16x32_bf16 v[248:251], a[52:55], a[100:103], v[248:251]
 s_add_u32 m0, s29, 81920
 v_mfma_f32_16x16x32_bf16 v[240:243], a[52:55], a[108:111], 0
 buffer_load_dwordx4 v2, s[8:11], s51 offen  lds
 v_mfma_f32_16x16x32_bf16 v[240:243], a[48:51], a[104:107], v[240:243]
 v_mfma_f32_16x16x32_bf16 v[232:235], a[48:51], a[112:115], 0
 v_mfma_f32_16x16x32_bf16 v[232:235], a[52:55], a[116:119], v[232:235]
 v_mfma_f32_16x16x32_bf16 v[224:227], a[52:55], a[124:127], 0
 s_add_u32 m0, s29, 16384
 v_mfma_f32_16x16x32_bf16 v[224:227], a[48:51], a[120:123], v[224:227]
 buffer_load_dwordx4 v1, s[4:7], s44 offen  lds
 v_mfma_f32_16x16x32_bf16 v[228:231], a[56:59], a[120:123], 0
 s_waitcnt vmcnt(10)
 v_mfma_f32_16x16x32_bf16 v[228:231], a[60:63], a[124:127], v[228:231]
 s_barrier
 v_mfma_f32_16x16x32_bf16 v[236:239], a[60:63], a[116:119], 0
 ds_read_b64_tr_b16 a[0:1], v6 offset:32768
 v_mfma_f32_16x16x32_bf16 v[236:239], a[56:59], a[112:115], v[236:239]
 s_add_u32 m0, s29, 86016
 ds_read_b64_tr_b16 a[2:3], v6 offset:36864
 v_mfma_f32_16x16x32_bf16 v[244:247], a[56:59], a[104:107], 0
 buffer_load_dwordx4 v2, s[8:11], s52 offen  lds
 v_mfma_f32_16x16x32_bf16 v[244:247], a[60:63], a[108:111], v[244:247]
 ds_read_b64_tr_b16 a[4:5], v6 offset:49152
 v_mfma_f32_16x16x32_bf16 v[252:255], a[60:63], a[100:103], 0
 ds_read_b64_tr_b16 a[6:7], v6 offset:53248
 v_mfma_f32_16x16x32_bf16 v[252:255], a[56:59], a[96:99], v[252:255]
 ds_read_b128 a[96:99], v4 offset:40960
 v_mfma_f32_16x16x32_bf16 v[152:155], a[32:35], a[64:67], 0
 s_add_u32 m0, s29, 20480
 v_mfma_f32_16x16x32_bf16 v[152:155], a[36:39], a[68:71], v[152:155]
 buffer_load_dwordx4 v1, s[4:7], s45 offen  lds
 v_mfma_f32_16x16x32_bf16 v[144:147], a[36:39], a[76:79], 0
 ds_read_b128 a[100:103], v5 offset:40960
 v_mfma_f32_16x16x32_bf16 v[144:147], a[32:35], a[72:75], v[144:147]
 v_mfma_f32_16x16x32_bf16 v[136:139], a[32:35], a[80:83], 0
 ds_read_b128 a[108:111], v5 offset:43008
 v_mfma_f32_16x16x32_bf16 v[136:139], a[36:39], a[84:87], v[136:139]
 s_add_u32 m0, s29, 90112
 v_mfma_f32_16x16x32_bf16 v[128:131], a[36:39], a[92:95], 0
 buffer_load_dwordx4 v2, s[8:11], s53 offen  lds
 v_mfma_f32_16x16x32_bf16 v[128:131], a[32:35], a[88:91], v[128:131]
 ds_read_b128 a[104:107], v4 offset:43008
 v_mfma_f32_16x16x32_bf16 v[132:135], a[40:43], a[88:91], 0
 v_mfma_f32_16x16x32_bf16 v[132:135], a[44:47], a[92:95], v[132:135]
 ds_read_b128 a[112:115], v4 offset:45056
 v_mfma_f32_16x16x32_bf16 v[140:143], a[44:47], a[84:87], 0
 s_add_u32 m0, s29, 24576
 v_mfma_f32_16x16x32_bf16 v[140:143], a[40:43], a[80:83], v[140:143]
 buffer_load_dwordx4 v1, s[4:7], s46 offen  lds
 v_mfma_f32_16x16x32_bf16 v[148:151], a[40:43], a[72:75], 0
 ds_read_b128 a[116:119], v5 offset:45056
 v_mfma_f32_16x16x32_bf16 v[148:151], a[44:47], a[76:79], v[148:151]
 v_mfma_f32_16x16x32_bf16 v[156:159], a[44:47], a[68:71], 0
 ds_read_b128 a[124:127], v5 offset:47104
 v_mfma_f32_16x16x32_bf16 v[156:159], a[40:43], a[64:67], v[156:159]
 s_add_u32 m0, s29, 94208
 v_mfma_f32_16x16x32_bf16 v[184:187], a[48:51], a[64:67], 0
 buffer_load_dwordx4 v2, s[8:11], s54 offen  lds
 v_mfma_f32_16x16x32_bf16 v[184:187], a[52:55], a[68:71], v[184:187]
 ds_read_b128 a[120:123], v4 offset:47104
 v_mfma_f32_16x16x32_bf16 v[176:179], a[52:55], a[76:79], 0
 v_mfma_f32_16x16x32_bf16 v[176:179], a[48:51], a[72:75], v[176:179]
 ds_read_b64_tr_b16 a[8:9], v7 offset:32768
 v_mfma_f32_16x16x32_bf16 v[168:171], a[48:51], a[80:83], 0
 s_add_u32 m0, s29, 28672
 ds_read_b64_tr_b16 a[10:11], v7 offset:36864
 v_mfma_f32_16x16x32_bf16 v[168:171], a[52:55], a[84:87], v[168:171]
 buffer_load_dwordx4 v1, s[4:7], s47 offen  lds
 v_mfma_f32_16x16x32_bf16 v[160:163], a[52:55], a[92:95], 0
 v_mfma_f32_16x16x32_bf16 v[160:163], a[48:51], a[88:91], v[160:163]
 ds_read_b64_tr_b16 a[12:13], v7 offset:49152
 v_mfma_f32_16x16x32_bf16 v[164:167], a[56:59], a[88:91], 0
 v_mfma_f32_16x16x32_bf16 v[164:167], a[60:63], a[92:95], v[164:167]
 ds_read_b64_tr_b16 a[14:15], v7 offset:53248
 v_mfma_f32_16x16x32_bf16 v[172:175], a[60:63], a[84:87], 0
 ds_read_b64_tr_b16 a[16:17], v8 offset:32768
 v_mfma_f32_16x16x32_bf16 v[172:175], a[56:59], a[80:83], v[172:175]
 ds_read_b64_tr_b16 a[18:19], v8 offset:36864
 v_mfma_f32_16x16x32_bf16 v[180:183], a[56:59], a[72:75], 0
 ds_read_b64_tr_b16 a[20:21], v8 offset:49152
 v_mfma_f32_16x16x32_bf16 v[180:183], a[60:63], a[76:79], v[180:183]
 ds_read_b64_tr_b16 a[22:23], v8 offset:53248
 v_mfma_f32_16x16x32_bf16 v[188:191], a[60:63], a[68:71], 0
 ds_read_b64_tr_b16 a[24:25], v9 offset:32768
 v_mfma_f32_16x16x32_bf16 v[188:191], a[56:59], a[64:67], v[188:191]
 s_waitcnt lgkmcnt(8)
 ds_read_b64_tr_b16 a[26:27], v9 offset:36864
 v_add_u32 v1, 128, v1
 v_add_u32 v2, 0x80000, v2
 s_add_u32 s56, s56, s30
 buffer_load_dword a243, v14, s[36:39], s56 offen
 s_add_u32 s56, s56, s30
 buffer_load_dword a243, v14, s[36:39], s56 offen
 s_add_u32 s56, s56, s30
 s_branch L_kloop_mid
.p2align 6
L_kloop:
 v_mfma_f32_16x16x32_bf16 v[88:91], a[0:3], a[64:67], v[88:91]
 ds_read_b64_tr_b16 a[28:29], v9 offset:16384
 v_mfma_f32_16x16x32_bf16 v[88:91], a[4:7], a[68:71], v[88:91]
 ds_read_b64_tr_b16 a[30:31], v9 offset:20480
 v_mfma_f32_16x16x32_bf16 v[80:83], a[4:7], a[76:79], v[80:83]
 ds_read_b128 a[96:99], v4 offset:8192
 v_mfma_f32_16x16x32_bf16 v[80:83], a[0:3], a[72:75], v[80:83]
 v_mfma_f32_16x16x32_bf16 v[72:75], a[0:3], a[80:83], v[72:75]
 ds_read_b128 a[100:103], v5 offset:8192
 v_mfma_f32_16x16x32_bf16 v[72:75], a[4:7], a[84:87], v[72:75]
 v_mfma_f32_16x16x32_bf16 v[64:67], a[4:7], a[92:95], v[64:67]
 ds_read_b128 a[108:111], v5 offset:10240
 v_mfma_f32_16x16x32_bf16 v[64:67], a[0:3], a[88:91], v[64:67]
 s_waitcnt lgkmcnt(8)
 v_mfma_f32_16x16x32_bf16 v[68:71], a[8:11], a[88:91], v[68:71]
 ds_read_b128 a[104:107], v4 offset:10240
 v_mfma_f32_16x16x32_bf16 v[68:71], a[12:15], a[92:95], v[68:71]
 v_mfma_f32_16x16x32_bf16 v[76:79], a[12:15], a[84:87], v[76:79]
 ds_read_b128 a[112:115], v4 offset:12288
 v_mfma_f32_16x16x32_bf16 v[76:79], a[8:11], a[80:83], v[76:79]
 v_mfma_f32_16x16x32_bf16 v[84:87], a[8:11], a[72:75], v[84:87]
 ds_read_b128 a[116:119], v5 offset:12288
 v_mfma_f32_16x16x32_bf16 v[84:87], a[12:15], a[76:79], v[84:87]
 v_mfma_f32_16x16x32_bf16 v[92:95], a[12:15], a[68:71], v[92:95]
 ds_read_b128 a[124:127], v5 offset:14336
 v_mfma_f32_16x16x32_bf16 v[92:95], a[8:11], a[64:67], v[92:95]
 v_mfma_f32_16x16x32_bf16 v[120:123], a[16:19], a[64:67], v[120:123]
 s_waitcnt lgkmcnt(8)
 ds_read_b128 a[120:123], v4 offset:14336
 v_mfma_f32_16x16x32_bf16 v[120:123], a[20:23], a[68:71], v[120:123]
 v_mfma_f32_16x16x32_bf16 v[112:115], a[20:23], a[76:79], v[112:115]
 ds_read_b64_tr_b16 a[32:33], v10 offset:0
 v_mfma_f32_16x16x32_bf16 v[112:115], a[16:19], a[72:75], v[112:115]
 ds_read_b64_tr_b16 a[34:35], v10 offset:4096
 v_mfma_f32_16x16x32_bf16 v[104:107], a[16:19], a[80:83], v[104:107]
 ds_read_b64_tr_b16 a[36:37], v10 offset:16384
 v_mfma_f32_16x16x32_bf16 v[104:107], a[20:23], a[84:87], v[104:107]
 ds_read_b64_tr_b16 a[38:39], v10 offset:20480
 v_mfma_f32_16x16x32_bf16 v[96:99], a[20:23], a[92:95], v[96:99]
 ds_read_b64_tr_b16 a[40:41], v11 offset:0
 v_mfma_f32_16x16x32_bf16 v[96:99], a[16:19], a[88:91], v[96:99]
 ds_read_b64_tr_b16 a[42:43], v11 offset:4096
 v_mfma_f32_16x16x32_bf16 v[100:103], a[24:27], a[88:91], v[100:103]
 s_waitcnt lgkmcnt(8)
 ds_read_b64_tr_b16 a[44:45], v11 offset:16384
 v_mfma_f32_16x16x32_bf16 v[100:103], a[28:31], a[92:95], v[100:103]
 ds_read_b64_tr_b16 a[46:47], v11 offset:20480
 v_mfma_f32_16x16x32_bf16 v[108:111], a[28:31], a[84:87], v[108:111]
 ds_read_b64_tr_b16 a[48:49], v12 offset:0
 v_mfma_f32_16x16x32_bf16 v[108:111], a[24:27], a[80:83], v[108:111]
 ds_read_b64_tr_b16 a[50:51], v12 offset:4096
 v_mfma_f32_16x16x32_bf16 v[116:119], a[24:27], a[72:75], v[116:119]
 ds_read_b64_tr_b16 a[52:53], v12 offset:16384
 v_mfma_f32_16x16x32_bf16 v[116:119], a[28:31], a[76:79], v[116:119]
 ds_read_b64_tr_b16 a[54:55], v12 offset:20480
 v_mfma_f32_16x16x32_bf16 v[124:127], a[28:31], a[68:71], v[124:127]
 ds_read_b64_tr_b16 a[56:57], v13 offset:0
 v_mfma_f32_16x16x32_bf16 v[124:127], a[24:27], a[64:67], v[124:127]
 ds_read_b64_tr_b16 a[58:59], v13 offset:4096
 v_mfma_f32_16x16x32_bf16 a[232:235], a[0:3], a[96:99], a[232:235]
 ds_read_b64_tr_b16 a[60:61], v13 offset:16384
 v_mfma_f32_16x16x32_bf16 a[232:235], a[4:7], a[100:103], a[232:235]
 ds_read_b64_tr_b16 a[62:63], v13 offset:20480
 v_mfma_f32_16x16x32_bf16 a[224:227], a[4:7], a[108:111], a[224:227]
 v_mfma_f32_16x16x32_bf16 a[224:227], a[0:3], a[104:107], a[224:227]
 v_mfma_f32_16x16x32_bf16 v[24:27], a[0:3], a[112:115], v[24:27]
 v_mfma_f32_16x16x32_bf16 v[24:27], a[4:7], a[116:119], v[24:27]
 s_waitcnt lgkmcnt(8)
 v_mfma_f32_16x16x32_bf16 v[16:19], a[4:7], a[124:127], v[16:19]
 v_mfma_f32_16x16x32_bf16 v[16:19], a[0:3], a[120:123], v[16:19]
 s_waitcnt lgkmcnt(0)
 v_mfma_f32_16x16x32_bf16 v[20:23], a[8:11], a[120:123], v[20:23]
 s_barrier
 v_mfma_f32_16x16x32_bf16 v[20:23], a[12:15], a[124:127], v[20:23]
 s_add_u32 m0, s29, 65536
 v_mfma_f32_16x16x32_bf16 v[28:31], a[12:15], a[116:119], v[28:31]
 buffer_load_dwordx4 v2, s[8:11], 0 offen  lds
 v_mfma_f32_16x16x32_bf16 v[28:31], a[8:11], a[112:115], v[28:31]
 v_mfma_f32_16x16x32_bf16 a[228:231], a[8:11], a[104:107], a[228:231]
 v_mfma_f32_16x16x32_bf16 a[228:231], a[12:15], a[108:111], a[228:231]
 v_mfma_f32_16x16x32_bf16 a[236:239], a[12:15], a[100:103], a[236:239]
 s_add_u32 m0, s29, 0
 v_mfma_f32_16x16x32_bf16 a[236:239], a[8:11], a[96:99], a[236:239]
 buffer_load_dwordx4 v1, s[4:7], 0 offen  lds
 v_mfma_f32_16x16x32_bf16 v[56:59], a[16:19], a[96:99], v[56:59]
 v_mfma_f32_16x16x32_bf16 v[56:59], a[20:23], a[100:103], v[56:59]
 v_mfma_f32_16x16x32_bf16 v[48:51], a[20:23], a[108:111], v[48:51]
 v_mfma_f32_16x16x32_bf16 v[48:51], a[16:19], a[104:107], v[48:51]
 s_add_u32 m0, s29, 69632
 v_mfma_f32_16x16x32_bf16 v[40:43], a[16:19], a[112:115], v[40:43]
 buffer_load_dwordx4 v2, s[8:11], s48 offen  lds
 v_mfma_f32_16x16x32_bf16 v[40:43], a[20:23], a[116:119], v[40:43]
 v_mfma_f32_16x16x32_bf16 v[32:35], a[20:23], a[124:127], v[32:35]
 v_mfma_f32_16x16x32_bf16 v[32:35], a[16:19], a[120:123], v[32:35]
 v_mfma_f32_16x16x32_bf16 v[36:39], a[24:27], a[120:123], v[36:39]
 s_add_u32 m0, s29, 4096
 v_mfma_f32_16x16x32_bf16 v[36:39], a[28:31], a[124:127], v[36:39]
 buffer_load_dwordx4 v1, s[4:7], s41 offen  lds
 v_mfma_f32_16x16x32_bf16 v[44:47], a[28:31], a[116:119], v[44:47]
 v_mfma_f32_16x16x32_bf16 v[44:47], a[24:27], a[112:115], v[44:47]
 v_mfma_f32_16x16x32_bf16 v[52:55], a[24:27], a[104:107], v[52:55]
 v_mfma_f32_16x16x32_bf16 v[52:55], a[28:31], a[108:111], v[52:55]
 s_add_u32 m0, s29, 73728
 v_mfma_f32_16x16x32_bf16 v[60:63], a[28:31], a[100:103], v[60:63]
 buffer_load_dwordx4 v2, s[8:11], s49 offen  lds
 v_mfma_f32_16x16x32_bf16 v[60:63], a[24:27], a[96:99], v[60:63]
 v_mfma_f32_16x16x32_bf16 v[216:219], a[32:35], a[96:99], v[216:219]
 v_mfma_f32_16x16x32_bf16 v[216:219], a[36:39], a[100:103], v[216:219]
 v_mfma_f32_16x16x32_bf16 v[208:211], a[36:39], a[108:111], v[208:211]
 s_add_u32 m0, s29, 8192
 v_mfma_f32_16x16x32_bf16 v[208:211], a[32:35], a[104:107], v[208:211]
 buffer_load_dwordx4 v1, s[4:7], s42 offen  lds
 v_mfma_f32_16x16x32_bf16 v[200:203], a[32:35], a[112:115], v[200:203]
 v_mfma_f32_16x16x32_bf16 v[200:203], a[36:39], a[116:119], v[200:203]
 v_mfma_f32_16x16x32_bf16 v[192:195], a[36:39], a[124:127], v[192:195]
 v_mfma_f32_16x16x32_bf16 v[192:195], a[32:35], a[120:123], v[192:195]
 s_add_u32 m0, s29, 77824
 v_mfma_f32_16x16x32_bf16 v[196:199], a[40:43], a[120:123], v[196:199]
 buffer_load_dwordx4 v2, s[8:11], s50 offen  lds
 v_mfma_f32_16x16x32_bf16 v[196:199], a[44:47], a[124:127], v[196:199]
 v_mfma_f32_16x16x32_bf16 v[204:207], a[44:47], a[116:119], v[204:207]
 v_mfma_f32_16x16x32_bf16 v[204:207], a[40:43], a[112:115], v[204:207]
 v_mfma_f32_16x16x32_bf16 v[212:215], a[40:43], a[104:107], v[212:215]
 s_add_u32 m0, s29, 12288
 v_mfma_f32_16x16x32_bf16 v[212:215], a[44:47], a[108:111], v[212:215]
 buffer_load_dwordx4 v1, s[4:7], s43 offen  lds
 v_mfma_f32_16x16x32_bf16 v[220:223], a[44:47], a[100:103], v[220:223]
 v_mfma_f32_16x16x32_bf16 v[220:223], a[40:43], a[96:99], v[220:223]
 v_mfma_f32_16x16x32_bf16 v[248:251], a[48:51], a[96:99], v[248:251]
 v_mfma_f32_16x16x32_bf16 v[248:251], a[52:55], a[100:103], v[248:251]
 s_add_u32 m0, s29, 81920
 v_mfma_f32_16x16x32_bf16 v[240:243], a[52:55], a[108:111], v[240:243]
 buffer_load_dwordx4 v2, s[8:11], s51 offen  lds
 v_mfma_f32_16x16x32_bf16 v[240:243], a[48:51], a[104:107], v[240:243]
 v_mfma_f32_16x16x32_bf16 v[232:235], a[48:51], a[112:115], v[232:235]
 v_mfma_f32_16x16x32_bf16 v[232:235], a[52:55], a[116:119], v[232:235]
 v_mfma_f32_16x16x32_bf16 v[224:227], a[52:55], a[124:127], v[224:227]
 s_add_u32 m0, s29, 16384
 v_mfma_f32_16x16x32_bf16 v[224:227], a[48:51], a[120:123], v[224:227]
 buffer_load_dwordx4 v1, s[4:7], s44 offen  lds
 v_mfma_f32_16x16x32_bf16 v[228:231], a[56:59], a[120:123], v[228:231]
 s_waitcnt vmcnt(11)
 v_mfma_f32_16x16x32_bf16 v[228:231], a[60:63], a[124:127], v[228:231]
 s_barrier
 v_mfma_f32_16x16x32_bf16 v[236:239], a[60:63], a[116:119], v[236:239]
 ds_read_b64_tr_b16 a[0:1], v6 offset:32768
 v_mfma_f32_16x16x32_bf16 v[236:239], a[56:59], a[112:115], v[236:239]
 s_add_u32 m0, s29, 86016
 ds_read_b64_tr_b16 a[2:3], v6 offset:36864
 v_mfma_f32_16x16x32_bf16 v[244:247], a[56:59], a[104:107], v[244:247]
 buffer_load_dwordx4 v2, s[8:11], s52 offen  lds
 v_mfma_f32_16x16x32_bf16 v[244:247], a[60:63], a[108:111], v[244:247]
 ds_read_b64_tr_b16 a[4:5], v6 offset:49152
 v_mfma_f32_16x16x32_bf16 v[252:255], a[60:63], a[100:103], v[252:255]
 ds_read_b64_tr_b16 a[6:7], v6 offset:53248
 v_mfma_f32_16x16x32_bf16 v[252:255], a[56:59], a[96:99], v[252:255]
 ds_read_b128 a[96:99], v4 offset:40960
 v_mfma_f32_16x16x32_bf16 v[152:155], a[32:35], a[64:67], v[152:155]
 s_add_u32 m0, s29, 20480
 v_mfma_f32_16x16x32_bf16 v[152:155], a[36:39], a[68:71], v[152:155]
 buffer_load_dwordx4 v1, s[4:7], s45 offen  lds
 v_mfma_f32_16x16x32_bf16 v[144:147], a[36:39], a[76:79], v[144:147]
 ds_read_b128 a[100:103], v5 offset:40960
 v_mfma_f32_16x16x32_bf16 v[144:147], a[32:35], a[72:75], v[144:147]
 v_mfma_f32_16x16x32_bf16 v[136:139], a[32:35], a[80:83], v[136:139]
 ds_read_b128 a[108:111], v5 offset:43008
 v_mfma_f32_16x16x32_bf16 v[136:139], a[36:39], a[84:87], v[136:139]
 s_add_u32 m0, s29, 90112
 v_mfma_f32_16x16x32_bf16 v[128:131], a[36:39], a[92:95], v[128:131]
 buffer_load_dwordx4 v2, s[8:11], s53 offen  lds
 v_mfma_f32_16x16x32_bf16 v[128:131], a[32:35], a[88:91], v[128:131]
 ds_read_b128 a[104:107], v4 offset:43008
 v_mfma_f32_16x16x32_bf16 v[132:135], a[40:43], a[88:91], v[132:135]
 v_mfma_f32_16x16x32_bf16 v[132:135], a[44:47], a[92:95], v[132:135]
 ds_read_b128 a[112:115], v4 offset:45056
 v_mfma_f32_16x16x32_bf16 v[140:143], a[44:47], a[84:87], v[140:143]
 s_add_u32 m0, s29, 24576
 v_mfma_f32_16x16x32_bf16 v[140:143], a[40:43], a[80:83], v[140:143]
 buffer_load_dwordx4 v1, s[4:7], s46 offen  lds
 v_mfma_f32_16x16x32_bf16 v[148:151], a[40:43], a[72:75], v[148:151]
 ds_read_b128 a[116:119], v5 offset:45056
 v_mfma_f32_16x16x32_bf16 v[148:151], a[44:47], a[76:79], v[148:151]
 v_mfma_f32_16x16x32_bf16 v[156:159], a[44:47], a[68:71], v[156:159]
 ds_read_b128 a[124:127], v5 offset:47104
 v_mfma_f32_16x16x32_bf16 v[156:159], a[40:43], a[64:67], v[156:159]
 s_add_u32 m0, s29, 94208
 v_mfma_f32_16x16x32_bf16 v[184:187], a[48:51], a[64:67], v[184:187]
 buffer_load_dwordx4 v2, s[8:11], s54 offen  lds
 v_mfma_f32_16x16x32_bf16 v[184:187], a[52:55], a[68:71], v[184:187]
 ds_read_b128 a[120:123], v4 offset:47104
 v_mfma_f32_16x16x32_bf16 v[176:179], a[52:55], a[76:79], v[176:179]
 v_mfma_f32_16x16x32_bf16 v[176:179], a[48:51], a[72:75], v[176:179]
 ds_read_b64_tr_b16 a[8:9], v7 offset:32768
 v_mfma_f32_16x16x32_bf16 v[168:171], a[48:51], a[80:83], v[168:171]
 s_add_u32 m0, s29, 28672
 ds_read_b64_tr_b16 a[10:11], v7 offset:36864
 v_mfma_f32_16x16x32_bf16 v[168:171], a[52:55], a[84:87], v[168:171]
 buffer_load_dwordx4 v1, s[4:7], s47 offen  lds
 v_mfma_f32_16x16x32_bf16 v[160:163], a[52:55], a[92:95], v[160:163]
 v_add_u32 v1, 128, v1
 v_add_u32 v2, 0x80000, v2
 v_mfma_f32_16x16x32_bf16 v[160:163], a[48:51], a[88:91], v[160:163]
 ds_read_b64_tr_b16 a[12:13], v7 offset:49152
 v_mfma_f32_16x16x32_bf16 v[164:167], a[56:59], a[88:91], v[164:167]
 buffer_load_dword a243, v14, s[36:39], s56 offen
 v_mfma_f32_16x16x32_bf16 v[164:167], a[60:63], a[92:95], v[164:167]
 s_add_u32 s56, s56, s30
 ds_read_b64_tr_b16 a[14:15], v7 offset:53248
 v_mfma_f32_16x16x32_bf16 v[172:175], a[60:63], a[84:87], v[172:175]
 ds_read_b64_tr_b16 a[16:17], v8 offset:32768
 v_mfma_f32_16x16x32_bf16 v[172:175], a[56:59], a[80:83], v[172:175]
 ds_read_b64_tr_b16 a[18:19], v8 offset:36864
 v_mfma_f32_16x16x32_bf16 v[180:183], a[56:59], a[72:75], v[180:183]
 ds_read_b64_tr_b16 a[20:21], v8 offset:49152
 v_mfma_f32_16x16x32_bf16 v[180:183], a[60:63], a[76:79], v[180:183]
 ds_read_b64_tr_b16 a[22:23], v8 offset:53248
 v_mfma_f32_16x16x32_bf16 v[188:191], a[60:63], a[68:71], v[188:191]
 ds_read_b64_tr_b16 a[24:25], v9 offset:32768
 v_mfma_f32_16x16x32_bf16 v[188:191], a[56:59], a[64:67], v[188:191]
 s_waitcnt lgkmcnt(8)
 ds_read_b64_tr_b16 a[26:27], v9 offset:36864
L_kloop_mid:
 v_mfma_f32_16x16x32_bf16 a[232:235], a[0:3], a[96:99], a[232:235]
 ds_read_b64_tr_b16 a[28:29], v9 offset:49152
 v_mfma_f32_16x16x32_bf16 a[232:235], a[4:7], a[100:103], a[232:235]
 ds_read_b64_tr_b16 a[30:31], v9 offset:53248
 v_mfma_f32_16x16x32_bf16 a[224:227], a[4:7], a[108:111], a[224:227]
 ds_read_b128 a[64:67], v4 offset:32768
 v_mfma_f32_16x16x32_bf16 a[224:227], a[0:3], a[104:107], a[224:227]
 v_mfma_f32_16x16x32_bf16 v[24:27], a[0:3], a[112:115], v[24:27]
 ds_read_b128 a[68:71], v5 offset:32768
 v_mfma_f32_16x16x32_bf16 v[24:27], a[4:7], a[116:119], v[24:27]
 v_mfma_f32_16x16x32_bf16 v[16:19], a[4:7], a[124:127], v[16:19]
 ds_read_b128 a[76:79], v5 offset:34816
 v_mfma_f32_16x16x32_bf16 v[16:19], a[0:3], a[120:123], v[16:19]
 s_waitcnt lgkmcnt(8)
 v_mfma_f32_16x16x32_bf16 v[20:23], a[8:11], a[120:123], v[20:23]
 ds_read_b128 a[72:75], v4 offset:34816
 v_mfma_f32_16x16x32_bf16 v[20:23], a[12:15], a[124:127], v[20:23]
 v_mfma_f32_16x16x32_bf16 v[28:31], a[12:15], a[116:119], v[28:31]
 ds_read_b128 a[80:83], v4 offset:36864
 v_mfma_f32_16x16x32_bf16 v[28:31], a[8:11], a[112:115], v[28:31]
 v_mfma_f32_16x16x32_bf16 a[228:231], a[8:11], a[104:107], a[228:231]
 ds_read_b128 a[84:87], v5 offset:36864
 v_mfma_f32_16x16x32_bf16 a[228:231], a[12:15], a[108:111], a[228:231]
 v_mfma_f32_16x16x32_bf16 a[236:239], a[12:15], a[100:103], a[236:239]
 ds_read_b128 a[92:95], v5 offset:38912
 v_mfma_f32_16x16x32_bf16 a[236:239], a[8:11], a[96:99], a[236:239]
 v_mfma_f32_16x16x32_bf16 v[56:59], a[16:19], a[96:99], v[56:59]
 s_waitcnt lgkmcnt(8)
 ds_read_b128 a[88:91], v4 offset:38912
 v_mfma_f32_16x16x32_bf16 v[56:59], a[20:23], a[100:103], v[56:59]
 v_mfma_f32_16x16x32_bf16 v[48:51], a[20:23], a[108:111], v[48:51]
 ds_read_b64_tr_b16 a[32:33], v10 offset:32768
 v_mfma_f32_16x16x32_bf16 v[48:51], a[16:19], a[104:107], v[48:51]
 ds_read_b64_tr_b16 a[34:35], v10 offset:36864
 v_mfma_f32_16x16x32_bf16 v[40:43], a[16:19], a[112:115], v[40:43]
 ds_read_b64_tr_b16 a[36:37], v10 offset:49152
 v_mfma_f32_16x16x32_bf16 v[40:43], a[20:23], a[116:119], v[40:43]
 ds_read_b64_tr_b16 a[38:39], v10 offset:53248
 v_mfma_f32_16x16x32_bf16 v[32:35], a[20:23], a[124:127], v[32:35]
 ds_read_b64_tr_b16 a[40:41], v11 offset:32768
 v_mfma_f32_16x16x32_bf16 v[32:35], a[16:19], a[120:123], v[32:35]
 ds_read_b64_tr_b16 a[42:43], v11 offset:36864
 v_mfma_f32_16x16x32_bf16 v[36:39], a[24:27], a[120:123], v[36:39]
 s_waitcnt lgkmcnt(8)
 ds_read_b64_tr_b16 a[44:45], v11 offset:49152
 v_mfma_f32_16x16x32_bf16 v[36:39], a[28:31], a[124:127], v[36:39]
 ds_read_b64_tr_b16 a[46:47], v11 offset:53248
 v_mfma_f32_16x16x32_bf16 v[44:47], a[28:31], a[116:119], v[44:47]
 ds_read_b64_tr_b16 a[48:49], v12 offset:32768
 v_mfma_f32_16x16x32_bf16 v[44:47], a[24:27], a[112:115], v[44:47]
 ds_read_b64_tr_b16 a[50:51], v12 offset:36864
 v_mfma_f32_16x16x32_bf16 v[52:55], a[24:27], a[104:107], v[52:55]
 ds_read_b64_tr_b16 a[52:53], v12 offset:49152
 v_mfma_f32_16x16x32_bf16 v[52:55], a[28:31], a[108:111], v[52:55]
 ds_read_b64_tr_b16 a[54:55], v12 offset:53248
 v_mfma_f32_16x16x32_bf16 v[60:63], a[28:31], a[100:103], v[60:63]
 ds_read_b64_tr_b16 a[56:57], v13 offset:32768
 v_mfma_f32_16x16x32_bf16 v[60:63], a[24:27], a[96:99], v[60:63]
 ds_read_b64_tr_b16 a[58:59], v13 offset:36864
 v_mfma_f32_16x16x32_bf16 v[88:91], a[0:3], a[64:67], v[88:91]
 ds_read_b64_tr_b16 a[60:61], v13 offset:49152
 v_mfma_f32_16x16x32_bf16 v[88:91], a[4:7], a[68:71], v[88:91]
 ds_read_b64_tr_b16 a[62:63], v13 offset:53248
 v_mfma_f32_16x16x32_bf16 v[80:83], a[4:7], a[76:79], v[80:83]
 v_mfma_f32_16x16x32_bf16 v[80:83], a[0:3], a[72:75], v[80:83]
 v_mfma_f32_16x16x32_bf16 v[72:75], a[0:3], a[80:83], v[72:75]
 v_mfma_f32_16x16x32_bf16 v[72:75], a[4:7], a[84:87], v[72:75]
 s_waitcnt lgkmcnt(8)
 v_mfma_f32_16x16x32_bf16 v[64:67], a[4:7], a[92:95], v[64:67]
 v_mfma_f32_16x16x32_bf16 v[64:67], a[0:3], a[88:91], v[64:67]
 s_waitcnt lgkmcnt(0)
 v_mfma_f32_16x16x32_bf16 v[68:71], a[8:11], a[88:91], v[68:71]
 s_barrier
 v_mfma_f32_16x16x32_bf16 v[68:71], a[12:15], a[92:95], v[68:71]
 s_add_u32 m0, s29, 98304
 v_mfma_f32_16x16x32_bf16 v[76:79], a[12:15], a[84:87], v[76:79]
 buffer_load_dwordx4 v2, s[8:11], 0 offen  lds
 v_mfma_f32_16x16x32_bf16 v[76:79], a[8:11], a[80:83], v[76:79]
 v_mfma_f32_16x16x32_bf16 v[84:87], a[8:11], a[72:75], v[84:87]
 v_mfma_f32_16x16x32_bf16 v[84:87], a[12:15], a[76:79], v[84:87]
 v_mfma_f32_16x16x32_bf16 v[92:95], a[12:15], a[68:71], v[92:95]
 s_add_u32 m0, s29, 32768
 v_mfma_f32_16x16x32_bf16 v[92:95], a[8:11], a[64:67], v[92:95]
 buffer_load_dwordx4 v1, s[4:7], 0 offen  lds
 v_mfma_f32_16x16x32_bf16 v[120:123], a[16:19], a[64:67], v[120:123]
 v_mfma_f32_16x16x32_bf16 v[120:123], a[20:23], a[68:71], v[120:123]
 v_mfma_f32_16x16x32_bf16 v[112:115], a[20:23], a[76:79], v[112:115]
 v_mfma_f32_16x16x32_bf16 v[112:115], a[16:19], a[72:75], v[112:115]
 s_add_u32 m0, s29, 102400
 v_mfma_f32_16x16x32_bf16 v[104:107], a[16:19], a[80:83], v[104:107]
 buffer_load_dwordx4 v2, s[8:11], s48 offen  lds
 v_mfma_f32_16x16x32_bf16 v[104:107], a[20:23], a[84:87], v[104:107]
 v_mfma_f32_16x16x32_bf16 v[96:99], a[20:23], a[92:95], v[96:99]
 v_mfma_f32_16x16x32_bf16 v[96:99], a[16:19], a[88:91], v[96:99]
 v_mfma_f32_16x16x32_bf16 v[100:103], a[24:27], a[88:91], v[100:103]
 s_add_u32 m0, s29, 36864
 v_mfma_f32_16x16x32_bf16 v[100:103], a[28:31], a[92:95], v[100:103]
 buffer_load_dwordx4 v1, s[4:7], s41 offen  lds
 v_mfma_f32_16x16x32_bf16 v[108:111], a[28:31], a[84:87], v[108:111]
 v_mfma_f32_16x16x32_bf16 v[108:111], a[24:27], a[80:83], v[108:111]
 v_mfma_f32_16x16x32_bf16 v[116:119], a[24:27], a[72:75], v[116:119]
 v_mfma_f32_16x16x32_bf16 v[116:119], a[28:31], a[76:79], v[116:119]
 s_add_u32 m0, s29, 106496
 v_mfma_f32_16x16x32_bf16 v[124:127], a[28:31], a[68:71], v[124:127]
 buffer_load_dwordx4 v2, s[8:11], s49 offen  lds
 v_mfma_f32_16x16x32_bf16 v[124:127], a[24:27], a[64:67], v[124:127]
 v_mfma_f32_16x16x32_bf16 v[152:155], a[32:35], a[64:67], v[152:155]
 v_mfma_f32_16x16x32_bf16 v[152:155], a[36:39], a[68:71], v[152:155]
 v_mfma_f32_16x16x32_bf16 v[144:147], a[36:39], a[76:79], v[144:147]
 s_add_u32 m0, s29, 40960
 v_mfma_f32_16x16x32_bf16 v[144:147], a[32:35], a[72:75], v[144:147]
 buffer_load_dwordx4 v1, s[4:7], s42 offen  lds
 v_mfma_f32_16x16x32_bf16 v[136:139], a[32:35], a[80:83], v[136:139]
 v_mfma_f32_16x16x32_bf16 v[136:139], a[36:39], a[84:87], v[136:139]
 v_mfma_f32_16x16x32_bf16 v[128:131], a[36:39], a[92:95], v[128:131]
 v_mfma_f32_16x16x32_bf16 v[128:131], a[32:35], a[88:91], v[128:131]
 s_add_u32 m0, s29, 110592
 v_mfma_f32_16x16x32_bf16 v[132:135], a[40:43], a[88:91], v[132:135]
 buffer_load_dwordx4 v2, s[8:11], s50 offen  lds
 v_mfma_f32_16x16x32_bf16 v[132:135], a[44:47], a[92:95], v[132:135]
 v_mfma_f32_16x16x32_bf16 v[140:143], a[44:47], a[84:87], v[140:143]
 v_mfma_f32_16x16x32_bf16 v[140:143], a[40:43], a[80:83], v[140:143]
 v_mfma_f32_16x16x32_bf16 v[148:151], a[40:43], a[72:75], v[148:151]
 s_add_u32 m0, s29, 45056
 v_mfma_f32_16x16x32_bf16 v[148:151], a[44:47], a[76:79], v[148:151]
 buffer_load_dwordx4 v1, s[4:7], s43 offen  lds
 v_mfma_f32_16x16x32_bf16 v[156:159], a[44:47], a[68:71], v[156:159]
 v_mfma_f32_16x16x32_bf16 v[156:159], a[40:43], a[64:67], v[156:159]
 v_mfma_f32_16x16x32_bf16 v[184:187], a[48:51], a[64:67], v[184:187]
 v_mfma_f32_16x16x32_bf16 v[184:187], a[52:55], a[68:71], v[184:187]
 s_add_u32 m0, s29, 114688
 v_mfma_f32_16x16x32_bf16 v[176:179], a[52:55], a[76:79], v[176:179]
 buffer_load_dwordx4 v2, s[8:11], s51 offen  lds
 v_mfma_f32_16x16x32_bf16 v[176:179], a[48:51], a[72:75], v[176:179]
 v_mfma_f32_16x16x32_bf16 v[168:171], a[48:51], a[80:83], v[168:171]
 v_mfma_f32_16x16x32_bf16 v[168:171], a[52:55], a[84:87], v[168:171]
 v_mfma_f32_16x16x32_bf16 v[160:163], a[52:55], a[92:95], v[160:163]
 s_add_u32 m0, s29, 49152
 v_mfma_f32_16x16x32_bf16 v[160:163], a[48:51], a[88:91], v[160:163]
 buffer_load_dwordx4 v1, s[4:7], s44 offen  lds
 v_mfma_f32_16x16x32_bf16 v[164:167], a[56:59], a[88:91], v[164:167]
 s_waitcnt vmcnt(11)
 v_mfma_f32_16x16x32_bf16 v[164:167], a[60:63], a[92:95], v[164:167]
 s_barrier
 v_mfma_f32_16x16x32_bf16 v[172:175], a[60:63], a[84:87], v[172:175]
 ds_read_b64_tr_b16 a[0:1], v6 offset:0
 v_mfma_f32_16x16x32_bf16 v[172:175], a[56:59], a[80:83], v[172:175]
 s_add_u32 m0, s29, 118784
 ds_read_b64_tr_b16 a[2:3], v6 offset:4096
 v_mfma_f32_16x16x32_bf16 v[180:183], a[56:59], a[72:75], v[180:183]
 buffer_load_dwordx4 v2, s[8:11], s52 offen  lds
 v_mfma_f32_16x16x32_bf16 v[180:183], a[60:63], a[76:79], v[180:183]
 ds_read_b64_tr_b16 a[4:5], v6 offset:16384
 v_mfma_f32_16x16x32_bf16 v[188:191], a[60:63], a[68:71], v[188:191]
 ds_read_b64_tr_b16 a[6:7], v6 offset:20480
 v_mfma_f32_16x16x32_bf16 v[188:191], a[56:59], a[64:67], v[188:191]
 ds_read_b128 a[64:67], v4 offset:0
 v_mfma_f32_16x16x32_bf16 v[216:219], a[32:35], a[96:99], v[216:219]
 s_add_u32 m0, s29, 53248
 v_mfma_f32_16x16x32_bf16 v[216:219], a[36:39], a[100:103], v[216:219]
 buffer_load_dwordx4 v1, s[4:7], s45 offen  lds
 v_mfma_f32_16x16x32_bf16 v[208:211], a[36:39], a[108:111], v[208:211]
 ds_read_b128 a[68:71], v5 offset:0
 v_mfma_f32_16x16x32_bf16 v[208:211], a[32:35], a[104:107], v[208:211]
 v_mfma_f32_16x16x32_bf16 v[200:203], a[32:35], a[112:115], v[200:203]
 ds_read_b128 a[76:79], v5 offset:2048
 v_mfma_f32_16x16x32_bf16 v[200:203], a[36:39], a[116:119], v[200:203]
 s_add_u32 m0, s29, 122880
 v_mfma_f32_16x16x32_bf16 v[192:195], a[36:39], a[124:127], v[192:195]
 buffer_load_dwordx4 v2, s[8:11], s53 offen  lds
 v_mfma_f32_16x16x32_bf16 v[192:195], a[32:35], a[120:123], v[192:195]
 ds_read_b128 a[72:75], v4 offset:2048
 v_mfma_f32_16x16x32_bf16 v[196:199], a[40:43], a[120:123], v[196:199]
 v_mfma_f32_16x16x32_bf16 v[196:199], a[44:47], a[124:127], v[196:199]
 ds_read_b128 a[80:83], v4 offset:4096
 v_mfma_f32_16x16x32_bf16 v[204:207], a[44:47], a[116:119], v[204:207]
 s_add_u32 m0, s29, 57344
 v_mfma_f32_16x16x32_bf16 v[204:207], a[40:43], a[112:115], v[204:207]
 buffer_load_dwordx4 v1, s[4:7], s46 offen  lds
 v_mfma_f32_16x16x32_bf16 v[212:215], a[40:43], a[104:107], v[212:215]
 ds_read_b128 a[84:87], v5 offset:4096
 v_mfma_f32_16x16x32_bf16 v[212:215], a[44:47], a[108:111], v[212:215]
 v_mfma_f32_16x16x32_bf16 v[220:223], a[44:47], a[100:103], v[220:223]
 ds_read_b128 a[92:95], v5 offset:6144
 v_mfma_f32_16x16x32_bf16 v[220:223], a[40:43], a[96:99], v[220:223]
 s_add_u32 m0, s29, 126976
 v_mfma_f32_16x16x32_bf16 v[248:251], a[48:51], a[96:99], v[248:251]
 buffer_load_dwordx4 v2, s[8:11], s54 offen  lds
 v_mfma_f32_16x16x32_bf16 v[248:251], a[52:55], a[100:103], v[248:251]
 ds_read_b128 a[88:91], v4 offset:6144
 v_mfma_f32_16x16x32_bf16 v[240:243], a[52:55], a[108:111], v[240:243]
 v_mfma_f32_16x16x32_bf16 v[240:243], a[48:51], a[104:107], v[240:243]
 ds_read_b64_tr_b16 a[8:9], v7 offset:0
 v_mfma_f32_16x16x32_bf16 v[232:235], a[48:51], a[112:115], v[232:235]
 s_add_u32 m0, s29, 61440
 ds_read_b64_tr_b16 a[10:11], v7 offset:4096
 v_mfma_f32_16x16x32_bf16 v[232:235], a[52:55], a[116:119], v[232:235]
 buffer_load_dwordx4 v1, s[4:7], s47 offen  lds
 v_mfma_f32_16x16x32_bf16 v[224:227], a[52:55], a[124:127], v[224:227]
 v_add_u32 v1, 128, v1
 v_add_u32 v2, 0x80000, v2
 v_mfma_f32_16x16x32_bf16 v[224:227], a[48:51], a[120:123], v[224:227]
 ds_read_b64_tr_b16 a[12:13], v7 offset:16384
 v_mfma_f32_16x16x32_bf16 v[228:231], a[56:59], a[120:123], v[228:231]
 buffer_load_dword a243, v14, s[36:39], s56 offen
 v_mfma_f32_16x16x32_bf16 v[228:231], a[60:63], a[124:127], v[228:231]
 s_add_u32 s56, s56, s30
 ds_read_b64_tr_b16 a[14:15], v7 offset:20480
 v_mfma_f32_16x16x32_bf16 v[236:239], a[60:63], a[116:119], v[236:239]
 ds_read_b64_tr_b16 a[16:17], v8 offset:0
 v_mfma_f32_16x16x32_bf16 v[236:239], a[56:59], a[112:115], v[236:239]
 ds_read_b64_tr_b16 a[18:19], v8 offset:4096
 v_mfma_f32_16x16x32_bf16 v[244:247], a[56:59], a[104:107], v[244:247]
 ds_read_b64_tr_b16 a[20:21], v8 offset:16384
 v_mfma_f32_16x16x32_bf16 v[244:247], a[60:63], a[108:111], v[244:247]
 s_add_u32 s61, s61, 1
 ds_read_b64_tr_b16 a[22:23], v8 offset:20480
 v_mfma_f32_16x16x32_bf16 v[252:255], a[60:63], a[100:103], v[252:255]
 s_cmp_lt_u32 s61, s55
 ds_read_b64_tr_b16 a[24:25], v9 offset:0
 v_mfma_f32_16x16x32_bf16 v[252:255], a[56:59], a[96:99], v[252:255]
 s_waitcnt lgkmcnt(8)
 ds_read_b64_tr_b16 a[26:27], v9 offset:4096
 s_cbranch_scc1 L_kloop
 s_cmp_lt_u32 s61, 6
 s_cbranch_scc1 L_kloop_side
 v_mfma_f32_16x16x32_bf16 v[88:91], a[0:3], a[64:67], v[88:91]
 ds_read_b64_tr_b16 a[28:29], v9 offset:16384
 v_accvgpr_read_b32 v15, a240
 v_mfma_f32_16x16x32_bf16 v[88:91], a[4:7], a[68:71], v[88:91]
 ds_read_b64_tr_b16 a[30:31], v9 offset:20480
 v_accvgpr_read_b32 v14, a242
 v_mfma_f32_16x16x32_bf16 v[80:83], a[4:7], a[76:79], v[80:83]
 s_waitcnt lgkmcnt(14)
 ds_read_b128 a[96:99], v4 offset:8192
 v_xor_b32 v3, 64, v14
 v_mfma_f32_16x16x32_bf16 v[80:83], a[0:3], a[72:75], v[80:83]
 v_mfma_f32_16x16x32_bf16 v[72:75], a[0:3], a[80:83], v[72:75]
 s_add_u32 m0, s33, 0x0
 ds_read_b128 a[100:103], v5 offset:8192
 v_mfma_f32_16x16x32_bf16 v[72:75], a[4:7], a[84:87], v[72:75]
 s_waitcnt lgkmcnt(12)
 v_mfma_f32_16x16x32_bf16 v[64:67], a[4:7], a[92:95], v[64:67]
 ds_read_b128 a[108:111], v5 offset:10240
 buffer_load_dwordx4 v15, s[20:23], 0 offen offset:0 lds
 v_mfma_f32_16x16x32_bf16 v[64:67], a[0:3], a[88:91], v[64:67]
 v_mfma_f32_16x16x32_bf16 v[68:71], a[8:11], a[88:91], v[68:71]
 s_waitcnt lgkmcnt(11)
 ds_read_b128 a[104:107], v4 offset:10240
 v_mfma_f32_16x16x32_bf16 v[68:71], a[12:15], a[92:95], v[68:71]
 s_add_u32 m0, s33, 0x80
 v_mfma_f32_16x16x32_bf16 v[76:79], a[12:15], a[84:87], v[76:79]
 ds_read_b128 a[112:115], v4 offset:12288
 buffer_load_dwordx4 v15, s[20:23], 0 offen offset:896 lds
 v_mfma_f32_16x16x32_bf16 v[76:79], a[8:11], a[80:83], v[76:79]
 v_mfma_f32_16x16x32_bf16 v[84:87], a[8:11], a[72:75], v[84:87]
 ds_read_b128 a[116:119], v5 offset:12288
 v_mfma_f32_16x16x32_bf16 v[84:87], a[12:15], a[76:79], v[84:87]
 s_add_u32 m0, s33, 0x800
 v_mfma_f32_16x16x32_bf16 v[92:95], a[12:15], a[68:71], v[92:95]
 ds_read_b128 a[124:127], v5 offset:14336
 buffer_load_dwordx4 v15, s[20:23], s57 offen offset:0 lds
 v_mfma_f32_16x16x32_bf16 v[92:95], a[8:11], a[64:67], v[92:95]
 s_waitcnt lgkmcnt(11)
 v_mfma_f32_16x16x32_bf16 v[120:123], a[16:19], a[64:67], v[120:123]
 ds_read_b128 a[120:123], v4 offset:14336
 v_mfma_f32_16x16x32_bf16 v[120:123], a[20:23], a[68:71], v[120:123]
 s_add_u32 m0, s33, 0x880
 v_mfma_f32_16x16x32_bf16 v[112:115], a[20:23], a[76:79], v[112:115]
 ds_read_b64_tr_b16 a[32:33], v10 offset:0
 buffer_load_dwordx4 v15, s[20:23], s57 offen offset:896 lds
 v_mfma_f32_16x16x32_bf16 v[112:115], a[16:19], a[72:75], v[112:115]
 ds_read_b64_tr_b16 a[34:35], v10 offset:4096
 v_mfma_f32_16x16x32_bf16 v[104:107], a[16:19], a[80:83], v[104:107]
 ds_read_b64_tr_b16 a[36:37], v10 offset:16384
 v_mfma_f32_16x16x32_bf16 v[104:107], a[20:23], a[84:87], v[104:107]
 s_add_u32 m0, s33, 0xf80
 ds_read_b64_tr_b16 a[38:39], v10 offset:20480
 v_mfma_f32_16x16x32_bf16 v[96:99], a[20:23], a[92:95], v[96:99]
 ds_read_b64_tr_b16 a[40:41], v11 offset:0
 buffer_load_dwordx4 v15, s[20:23], 0 offen offset:128 lds
 v_mfma_f32_16x16x32_bf16 v[96:99], a[16:19], a[88:91], v[96:99]
 s_waitcnt lgkmcnt(13)
 ds_read_b64_tr_b16 a[42:43], v11 offset:4096
 v_mfma_f32_16x16x32_bf16 v[100:103], a[24:27], a[88:91], v[100:103]
 ds_read_b64_tr_b16 a[44:45], v11 offset:16384
 v_mfma_f32_16x16x32_bf16 v[100:103], a[28:31], a[92:95], v[100:103]
 s_add_u32 m0, s33, 0x1000
 ds_read_b64_tr_b16 a[46:47], v11 offset:20480
 v_mfma_f32_16x16x32_bf16 v[108:111], a[28:31], a[84:87], v[108:111]
 ds_read_b64_tr_b16 a[48:49], v12 offset:0
 buffer_load_dwordx4 v15, s[20:23], 0 offen offset:1024 lds
 v_mfma_f32_16x16x32_bf16 v[108:111], a[24:27], a[80:83], v[108:111]
 ds_read_b64_tr_b16 a[50:51], v12 offset:4096
 v_mfma_f32_16x16x32_bf16 v[116:119], a[24:27], a[72:75], v[116:119]
 ds_read_b64_tr_b16 a[52:53], v12 offset:16384
 v_mfma_f32_16x16x32_bf16 v[116:119], a[28:31], a[76:79], v[116:119]
 s_add_u32 m0, s33, 0x1780
 ds_read_b64_tr_b16 a[54:55], v12 offset:20480
 v_mfma_f32_16x16x32_bf16 v[124:127], a[28:31], a[68:71], v[124:127]
 ds_read_b64_tr_b16 a[56:57], v13 offset:0
 buffer_load_dwordx4 v15, s[20:23], s57 offen offset:128 lds
 v_mfma_f32_16x16x32_bf16 v[124:127], a[24:27], a[64:67], v[124:127]
 s_waitcnt lgkmcnt(15)
 ds_read_b64_tr_b16 a[58:59], v13 offset:4096
 v_mfma_f32_16x16x32_bf16 a[232:235], a[0:3], a[96:99], a[232:235]
 ds_read_b64_tr_b16 a[60:61], v13 offset:16384
 v_mfma_f32_16x16x32_bf16 a[232:235], a[4:7], a[100:103], a[232:235]
 s_add_u32 m0, s33, 0x1800
 ds_read_b64_tr_b16 a[62:63], v13 offset:20480
 v_mfma_f32_16x16x32_bf16 a[224:227], a[4:7], a[108:111], a[224:227]
 buffer_load_dwordx4 v15, s[20:23], s57 offen offset:1024 lds
 v_mfma_f32_16x16x32_bf16 a[224:227], a[0:3], a[104:107], a[224:227]
 v_mfma_f32_16x16x32_bf16 v[24:27], a[0:3], a[112:115], v[24:27]
 v_mfma_f32_16x16x32_bf16 v[24:27], a[4:7], a[116:119], v[24:27]
 s_waitcnt lgkmcnt(15)
 v_mfma_f32_16x16x32_bf16 v[16:19], a[4:7], a[124:127], v[16:19]
 v_mfma_f32_16x16x32_bf16 v[16:19], a[0:3], a[120:123], v[16:19]
 s_waitcnt lgkmcnt(0)
 v_mfma_f32_16x16x32_bf16 v[20:23], a[8:11], a[120:123], v[20:23]
 s_barrier
 v_mfma_f32_16x16x32_bf16 v[20:23], a[12:15], a[124:127], v[20:23]
 s_add_u32 m0, s29, 65536
 v_mfma_f32_16x16x32_bf16 v[28:31], a[12:15], a[116:119], v[28:31]
 buffer_load_dwordx4 v2, s[8:11], 0 offen  lds
 v_mfma_f32_16x16x32_bf16 v[28:31], a[8:11], a[112:115], v[28:31]
 v_mfma_f32_16x16x32_bf16 a[228:231], a[8:11], a[104:107], a[228:231]
 v_mfma_f32_16x16x32_bf16 a[228:231], a[12:15], a[108:111], a[228:231]
 v_mfma_f32_16x16x32_bf16 a[236:239], a[12:15], a[100:103], a[236:239]
 s_add_u32 m0, s29, 0
 v_mfma_f32_16x16x32_bf16 a[236:239], a[8:11], a[96:99], a[236:239]
 buffer_load_dwordx4 v1, s[4:7], 0 offen  lds
 v_mfma_f32_16x16x32_bf16 v[56:59], a[16:19], a[96:99], v[56:59]
 v_mfma_f32_16x16x32_bf16 v[56:59], a[20:23], a[100:103], v[56:59]
 v_mfma_f32_16x16x32_bf16 v[48:51], a[20:23], a[108:111], v[48:51]
 v_mfma_f32_16x16x32_bf16 v[48:51], a[16:19], a[104:107], v[48:51]
 s_add_u32 m0, s29, 69632
 v_mfma_f32_16x16x32_bf16 v[40:43], a[16:19], a[112:115], v[40:43]
 buffer_load_dwordx4 v2, s[8:11], s48 offen  lds
 v_mfma_f32_16x16x32_bf16 v[40:43], a[20:23], a[116:119], v[40:43]
 v_mfma_f32_16x16x32_bf16 v[32:35], a[20:23], a[124:127], v[32:35]
 v_mfma_f32_16x16x32_bf16 v[32:35], a[16:19], a[120:123], v[32:35]
 v_mfma_f32_16x16x32_bf16 v[36:39], a[24:27], a[120:123], v[36:39]
 s_add_u32 m0, s29, 4096
 v_mfma_f32_16x16x32_bf16 v[36:39], a[28:31], a[124:127], v[36:39]
 buffer_load_dwordx4 v1, s[4:7], s41 offen  lds
 v_mfma_f32_16x16x32_bf16 v[44:47], a[28:31], a[116:119], v[44:47]
 v_mfma_f32_16x16x32_bf16 v[44:47], a[24:27], a[112:115], v[44:47]
 v_mfma_f32_16x16x32_bf16 v[52:55], a[24:27], a[104:107], v[52:55]
 v_mfma_f32_16x16x32_bf16 v[52:55], a[28:31], a[108:111], v[52:55]
 s_add_u32 m0, s29, 73728
 v_mfma_f32_16x16x32_bf16 v[60:63], a[28:31], a[100:103], v[60:63]
 buffer_load_dwordx4 v2, s[8:11], s49 offen  lds
 v_mfma_f32_16x16x32_bf16 v[60:63], a[24:27], a[96:99], v[60:63]
 v_mfma_f32_16x16x32_bf16 v[216:219], a[32:35], a[96:99], v[216:219]
 v_mfma_f32_16x16x32_bf16 v[216:219], a[36:39], a[100:103], v[216:219]
 v_mfma_f32_16x16x32_bf16 v[208:211], a[36:39], a[108:111], v[208:211]
 s_add_u32 m0, s29, 8192
 v_mfma_f32_16x16x32_bf16 v[208:211], a[32:35], a[104:107], v[208:211]
 buffer_load_dwordx4 v1, s[4:7], s42 offen  lds
 v_mfma_f32_16x16x32_bf16 v[200:203], a[32:35], a[112:115], v[200:203]
 v_mfma_f32_16x16x32_bf16 v[200:203], a[36:39], a[116:119], v[200:203]
 v_mfma_f32_16x16x32_bf16 v[192:195], a[36:39], a[124:127], v[192:195]
 v_mfma_f32_16x16x32_bf16 v[192:195], a[32:35], a[120:123], v[192:195]
 s_add_u32 m0, s29, 77824
 v_mfma_f32_16x16x32_bf16 v[196:199], a[40:43], a[120:123], v[196:199]
 buffer_load_dwordx4 v2, s[8:11], s50 offen  lds
 v_mfma_f32_16x16x32_bf16 v[196:199], a[44:47], a[124:127], v[196:199]
 v_mfma_f32_16x16x32_bf16 v[204:207], a[44:47], a[116:119], v[204:207]
 v_mfma_f32_16x16x32_bf16 v[204:207], a[40:43], a[112:115], v[204:207]
 v_mfma_f32_16x16x32_bf16 v[212:215], a[40:43], a[104:107], v[212:215]
 s_add_u32 m0, s29, 12288
 v_mfma_f32_16x16x32_bf16 v[212:215], a[44:47], a[108:111], v[212:215]
 buffer_load_dwordx4 v1, s[4:7], s43 offen  lds
 v_mfma_f32_16x16x32_bf16 v[220:223], a[44:47], a[100:103], v[220:223]
 v_mfma_f32_16x16x32_bf16 v[220:223], a[40:43], a[96:99], v[220:223]
 v_mfma_f32_16x16x32_bf16 v[248:251], a[48:51], a[96:99], v[248:251]
 v_mfma_f32_16x16x32_bf16 v[248:251], a[52:55], a[100:103], v[248:251]
 s_add_u32 m0, s29, 81920
 v_mfma_f32_16x16x32_bf16 v[240:243], a[52:55], a[108:111], v[240:243]
 buffer_load_dwordx4 v2, s[8:11], s51 offen  lds
 v_mfma_f32_16x16x32_bf16 v[240:243], a[48:51], a[104:107], v[240:243]
 v_mfma_f32_16x16x32_bf16 v[232:235], a[48:51], a[112:115], v[232:235]
 v_mfma_f32_16x16x32_bf16 v[232:235], a[52:55], a[116:119], v[232:235]
 v_mfma_f32_16x16x32_bf16 v[224:227], a[52:55], a[124:127], v[224:227]
 s_add_u32 m0, s29, 16384
 v_mfma_f32_16x16x32_bf16 v[224:227], a[48:51], a[120:123], v[224:227]
 buffer_load_dwordx4 v1, s[4:7], s44 offen  lds
 v_mfma_f32_16x16x32_bf16 v[228:231], a[56:59], a[120:123], v[228:231]
 s_waitcnt vmcnt(10)
 v_mfma_f32_16x16x32_bf16 v[228:231], a[60:63], a[124:127], v[228:231]
 s_barrier
 v_mfma_f32_16x16x32_bf16 v[236:239], a[60:63], a[116:119], v[236:239]
 ds_read_b64_tr_b16 a[0:1], v6 offset:32768
 v_mfma_f32_16x16x32_bf16 v[236:239], a[56:59], a[112:115], v[236:239]
 s_add_u32 m0, s29, 86016
 ds_read_b64_tr_b16 a[2:3], v6 offset:36864
 v_mfma_f32_16x16x32_bf16 v[244:247], a[56:59], a[104:107], v[244:247]
 buffer_load_dwordx4 v2, s[8:11], s52 offen  lds
 v_mfma_f32_16x16x32_bf16 v[244:247], a[60:63], a[108:111], v[244:247]
 ds_read_b64_tr_b16 a[4:5], v6 offset:49152
 v_mfma_f32_16x16x32_bf16 v[252:255], a[60:63], a[100:103], v[252:255]
 ds_read_b64_tr_b16 a[6:7], v6 offset:53248
 v_mfma_f32_16x16x32_bf16 v[252:255], a[56:59], a[96:99], v[252:255]
 ds_read_b128 a[96:99], v4 offset:40960
 v_mfma_f32_16x16x32_bf16 v[152:155], a[32:35], a[64:67], v[152:155]
 s_add_u32 m0, s29, 20480
 ds_read_b128 a[128:131], v14 offset:0
 v_mfma_f32_16x16x32_bf16 v[152:155], a[36:39], a[68:71], v[152:155]
 buffer_load_dwordx4 v1, s[4:7], s45 offen  lds
 v_mfma_f32_16x16x32_bf16 v[144:147], a[36:39], a[76:79], v[144:147]
 ds_read_b128 a[100:103], v5 offset:40960
 v_mfma_f32_16x16x32_bf16 v[144:147], a[32:35], a[72:75], v[144:147]
 ds_read_b128 a[136:139], v3 offset:0
 v_mfma_f32_16x16x32_bf16 v[136:139], a[32:35], a[80:83], v[136:139]
 ds_read_b128 a[108:111], v5 offset:43008
 v_mfma_f32_16x16x32_bf16 v[136:139], a[36:39], a[84:87], v[136:139]
 s_add_u32 m0, s29, 90112
 ds_read_b128 a[132:135], v14 offset:2048
 v_mfma_f32_16x16x32_bf16 v[128:131], a[36:39], a[92:95], v[128:131]
 buffer_load_dwordx4 v2, s[8:11], s53 offen  lds
 v_mfma_f32_16x16x32_bf16 v[128:131], a[32:35], a[88:91], v[128:131]
 ds_read_b128 a[104:107], v4 offset:43008
 v_mfma_f32_16x16x32_bf16 v[132:135], a[40:43], a[88:91], v[132:135]
 ds_read_b128 a[140:143], v3 offset:2048
 v_mfma_f32_16x16x32_bf16 v[132:135], a[44:47], a[92:95], v[132:135]
 ds_read_b128 a[112:115], v4 offset:45056
 v_mfma_f32_16x16x32_bf16 v[140:143], a[44:47], a[84:87], v[140:143]
 s_add_u32 m0, s29, 24576
 ds_read_b128 a[144:147], v14 offset:4096
 v_mfma_f32_16x16x32_bf16 v[140:143], a[40:43], a[80:83], v[140:143]
 buffer_load_dwordx4 v1, s[4:7], s46 offen  lds
 v_mfma_f32_16x16x32_bf16 v[148:151], a[40:43], a[72:75], v[148:151]
 ds_read_b128 a[116:119], v5 offset:45056
 v_mfma_f32_16x16x32_bf16 v[148:151], a[44:47], a[76:79], v[148:151]
 ds_read_b128 a[152:155], v3 offset:4096
 v_mfma_f32_16x16x32_bf16 v[156:159], a[44:47], a[68:71], v[156:159]
 ds_read_b128 a[124:127], v5 offset:47104
 v_mfma_f32_16x16x32_bf16 v[156:159], a[40:43], a[64:67], v[156:159]
 s_add_u32 m0, s29, 94208
 ds_read_b128 a[148:151], v14 offset:6144
 v_mfma_f32_16x16x32_bf16 v[184:187], a[48:51], a[64:67], v[184:187]
 buffer_load_dwordx4 v2, s[8:11], s54 offen  lds
 v_mfma_f32_16x16x32_bf16 v[184:187], a[52:55], a[68:71], v[184:187]
 ds_read_b128 a[120:123], v4 offset:47104
 v_mfma_f32_16x16x32_bf16 v[176:179], a[52:55], a[76:79], v[176:179]
 ds_read_b128 a[156:159], v3 offset:6144
 v_mfma_f32_16x16x32_bf16 v[176:179], a[48:51], a[72:75], v[176:179]
 ds_read_b64_tr_b16 a[8:9], v7 offset:32768
 v_mfma_f32_16x16x32_bf16 v[168:171], a[48:51], a[80:83], v[168:171]
 s_add_u32 m0, s29, 28672
 ds_read_b64_tr_b16 a[10:11], v7 offset:36864
 v_mfma_f32_16x16x32_bf16 v[168:171], a[52:55], a[84:87], v[168:171]
 buffer_load_dwordx4 v1, s[4:7], s47 offen  lds
 v_mfma_f32_16x16x32_bf16 v[160:163], a[52:55], a[92:95], v[160:163]
 v_add_u32 v1, 128, v1
 v_add_u32 v2, 0x80000, v2
 v_mfma_f32_16x16x32_bf16 v[160:163], a[48:51], a[88:91], v[160:163]
 ds_read_b64_tr_b16 a[12:13], v7 offset:49152
 v_mfma_f32_16x16x32_bf16 v[164:167], a[56:59], a[88:91], v[164:167]
 v_mfma_f32_16x16x32_bf16 v[164:167], a[60:63], a[92:95], v[164:167]
 ds_read_b64_tr_b16 a[14:15], v7 offset:53248
 v_mfma_f32_16x16x32_bf16 v[172:175], a[60:63], a[84:87], v[172:175]
 ds_read_b64_tr_b16 a[16:17], v8 offset:32768
 v_mfma_f32_16x16x32_bf16 v[172:175], a[56:59], a[80:83], v[172:175]
 ds_read_b64_tr_b16 a[18:19], v8 offset:36864
 v_mfma_f32_16x16x32_bf16 v[180:183], a[56:59], a[72:75], v[180:183]
 ds_read_b64_tr_b16 a[20:21], v8 offset:49152
 v_mfma_f32_16x16x32_bf16 v[180:183], a[60:63], a[76:79], v[180:183]
 ds_read_b64_tr_b16 a[22:23], v8 offset:53248
 v_mfma_f32_16x16x32_bf16 v[188:191], a[60:63], a[68:71], v[188:191]
 ds_read_b64_tr_b16 a[24:25], v9 offset:32768
 v_mfma_f32_16x16x32_bf16 v[188:191], a[56:59], a[64:67], v[188:191]
 s_waitcnt lgkmcnt(15)
 ds_read_b64_tr_b16 a[26:27], v9 offset:36864
 v_mfma_f32_16x16x32_bf16 a[232:235], a[0:3], a[96:99], a[232:235]
 ds_read_b64_tr_b16 a[28:29], v9 offset:49152
 v_mfma_f32_16x16x32_bf16 a[232:235], a[4:7], a[100:103], a[232:235]
 s_add_u32 m0, s33, 0xffffff00
 ds_read_b64_tr_b16 a[30:31], v9 offset:53248
 v_mfma_f32_16x16x32_bf16 a[224:227], a[4:7], a[108:111], a[224:227]
 s_waitcnt lgkmcnt(12)
 ds_read_b128 a[64:67], v4 offset:32768
 v_mfma_f32_16x16x32_bf16 a[224:227], a[0:3], a[104:107], a[224:227]
 buffer_load_dwordx4 v15, s[20:23], 0 offen offset:256 lds
 v_mfma_f32_16x16x32_bf16 v[24:27], a[0:3], a[112:115], v[24:27]
 ds_read_b128 a[68:71], v5 offset:32768
 v_mfma_f32_16x16x32_bf16 v[24:27], a[4:7], a[116:119], v[24:27]
 v_mfma_f32_16x16x32_bf16 v[16:19], a[4:7], a[124:127], v[16:19]
 s_add_u32 m0, s33, 0xffffff80
 ds_read_b128 a[76:79], v5 offset:34816
 v_mfma_f32_16x16x32_bf16 v[16:19], a[0:3], a[120:123], v[16:19]
 s_waitcnt lgkmcnt(11)
 buffer_load_dwordx4 v15, s[20:23], 0 offen offset:1152 lds
 v_mfma_f32_16x16x32_bf16 v[20:23], a[8:11], a[120:123], v[20:23]
 ds_read_b128 a[72:75], v4 offset:34816
 v_mfma_f32_16x16x32_bf16 v[20:23], a[12:15], a[124:127], v[20:23]
 v_mfma_f32_16x16x32_bf16 v[28:31], a[12:15], a[116:119], v[28:31]
 s_add_u32 m0, s33, 0x700
 ds_read_b128 a[80:83], v4 offset:36864
 v_mfma_f32_16x16x32_bf16 v[28:31], a[8:11], a[112:115], v[28:31]
 buffer_load_dwordx4 v15, s[20:23], s57 offen offset:256 lds
 v_mfma_f32_16x16x32_bf16 a[228:231], a[8:11], a[104:107], a[228:231]
 ds_read_b128 a[84:87], v5 offset:36864
 v_mfma_f32_16x16x32_bf16 a[228:231], a[12:15], a[108:111], a[228:231]
 v_mfma_f32_16x16x32_bf16 a[236:239], a[12:15], a[100:103], a[236:239]
 s_add_u32 m0, s33, 0x780
 ds_read_b128 a[92:95], v5 offset:38912
 v_mfma_f32_16x16x32_bf16 a[236:239], a[8:11], a[96:99], a[236:239]
 s_waitcnt lgkmcnt(11)
 buffer_load_dwordx4 v15, s[20:23], s57 offen offset:1152 lds
 v_mfma_f32_16x16x32_bf16 v[56:59], a[16:19], a[96:99], v[56:59]
 ds_read_b128 a[88:91], v4 offset:38912
 v_mfma_f32_16x16x32_bf16 v[56:59], a[20:23], a[100:103], v[56:59]
 v_mfma_f32_16x16x32_bf16 v[48:51], a[20:23], a[108:111], v[48:51]
 s_add_u32 m0, s33, 0xe80
 ds_read_b64_tr_b16 a[32:33], v10 offset:32768
 v_mfma_f32_16x16x32_bf16 v[48:51], a[16:19], a[104:107], v[48:51]
 ds_read_b64_tr_b16 a[34:35], v10 offset:36864
 buffer_load_dwordx4 v15, s[20:23], 0 offen offset:384 lds
 v_mfma_f32_16x16x32_bf16 v[40:43], a[16:19], a[112:115], v[40:43]
 ds_read_b64_tr_b16 a[36:37], v10 offset:49152
 v_mfma_f32_16x16x32_bf16 v[40:43], a[20:23], a[116:119], v[40:43]
 ds_read_b64_tr_b16 a[38:39], v10 offset:53248
 v_mfma_f32_16x16x32_bf16 v[32:35], a[20:23], a[124:127], v[32:35]
 s_add_u32 m0, s33, 0xf00
 ds_read_b64_tr_b16 a[40:41], v11 offset:32768
 v_mfma_f32_16x16x32_bf16 v[32:35], a[16:19], a[120:123], v[32:35]
 s_waitcnt lgkmcnt(13)
 ds_read_b64_tr_b16 a[42:43], v11 offset:36864
 buffer_load_dwordx4 v15, s[20:23], 0 offen offset:1280 lds
 v_mfma_f32_16x16x32_bf16 v[36:39], a[24:27], a[120:123], v[36:39]
 ds_read_b64_tr_b16 a[44:45], v11 offset:49152
 v_mfma_f32_16x16x32_bf16 v[36:39], a[28:31], a[124:127], v[36:39]
 ds_read_b64_tr_b16 a[46:47], v11 offset:53248
 v_mfma_f32_16x16x32_bf16 v[44:47], a[28:31], a[116:119], v[44:47]
 s_add_u32 m0, s33, 0x1680
 ds_read_b64_tr_b16 a[48:49], v12 offset:32768
 v_mfma_f32_16x16x32_bf16 v[44:47], a[24:27], a[112:115], v[44:47]
 ds_read_b64_tr_b16 a[50:51], v12 offset:36864
 buffer_load_dwordx4 v15, s[20:23], s57 offen offset:384 lds
 v_mfma_f32_16x16x32_bf16 v[52:55], a[24:27], a[104:107], v[52:55]
 ds_read_b64_tr_b16 a[52:53], v12 offset:49152
 v_mfma_f32_16x16x32_bf16 v[52:55], a[28:31], a[108:111], v[52:55]
 ds_read_b64_tr_b16 a[54:55], v12 offset:53248
 v_mfma_f32_16x16x32_bf16 v[60:63], a[28:31], a[100:103], v[60:63]
 s_add_u32 m0, s33, 0x1700
 ds_read_b64_tr_b16 a[56:57], v13 offset:32768
 v_mfma_f32_16x16x32_bf16 v[60:63], a[24:27], a[96:99], v[60:63]
 s_waitcnt lgkmcnt(15)
 ds_read_b64_tr_b16 a[58:59], v13 offset:36864
 buffer_load_dwordx4 v15, s[20:23], s57 offen offset:1280 lds
 v_mfma_f32_16x16x32_bf16 v[88:91], a[0:3], a[64:67], v[88:91]
 ds_read_b64_tr_b16 a[60:61], v13 offset:49152
 v_mfma_f32_16x16x32_bf16 v[88:91], a[4:7], a[68:71], v[88:91]
 ds_read_b64_tr_b16 a[62:63], v13 offset:53248
 v_mfma_f32_16x16x32_bf16 v[80:83], a[4:7], a[76:79], v[80:83]
 v_mfma_f32_16x16x32_bf16 v[80:83], a[0:3], a[72:75], v[80:83]
 v_mfma_f32_16x16x32_bf16 v[72:75], a[0:3], a[80:83], v[72:75]
 v_mfma_f32_16x16x32_bf16 v[72:75], a[4:7], a[84:87], v[72:75]
 s_waitcnt lgkmcnt(15)
 v_mfma_f32_16x16x32_bf16 v[64:67], a[4:7], a[92:95], v[64:67]
 v_mfma_f32_16x16x32_bf16 v[64:67], a[0:3], a[88:91], v[64:67]
 s_waitcnt lgkmcnt(0)
 v_mfma_f32_16x16x32_bf16 v[68:71], a[8:11], a[88:91], v[68:71]
 s_barrier
 v_mfma_f32_16x16x32_bf16 v[68:71], a[12:15], a[92:95], v[68:71]
 s_add_u32 m0, s29, 98304
 v_mfma_f32_16x16x32_bf16 v[76:79], a[12:15], a[84:87], v[76:79]
 buffer_load_dwordx4 v2, s[8:11], 0 offen  lds
 v_mfma_f32_16x16x32_bf16 v[76:79], a[8:11], a[80:83], v[76:79]
 v_mfma_f32_16x16x32_bf16 v[84:87], a[8:11], a[72:75], v[84:87]
 v_mfma_f32_16x16x32_bf16 v[84:87], a[12:15], a[76:79], v[84:87]
 v_mfma_f32_16x16x32_bf16 v[92:95], a[12:15], a[68:71], v[92:95]
 s_add_u32 m0, s29, 32768
 v_mfma_f32_16x16x32_bf16 v[92:95], a[8:11], a[64:67], v[92:95]
 buffer_load_dwordx4 v1, s[4:7], 0 offen  lds
 v_mfma_f32_16x16x32_bf16 v[120:123], a[16:19], a[64:67], v[120:123]
 v_mfma_f32_16x16x32_bf16 v[120:123], a[20:23], a[68:71], v[120:123]
 v_mfma_f32_16x16x32_bf16 v[112:115], a[20:23], a[76:79], v[112:115]
 v_mfma_f32_16x16x32_bf16 v[112:115], a[16:19], a[72:75], v[112:115]
 s_add_u32 m0, s29, 102400
 v_mfma_f32_16x16x32_bf16 v[104:107], a[16:19], a[80:83], v[104:107]
 buffer_load_dwordx4 v2, s[8:11], s48 offen  lds
 v_mfma_f32_16x16x32_bf16 v[104:107], a[20:23], a[84:87], v[104:107]
 v_mfma_f32_16x16x32_bf16 v[96:99], a[20:23], a[92:95], v[96:99]
 v_mfma_f32_16x16x32_bf16 v[96:99], a[16:19], a[88:91], v[96:99]
 v_mfma_f32_16x16x32_bf16 v[100:103], a[24:27], a[88:91], v[100:103]
 s_add_u32 m0, s29, 36864
 v_mfma_f32_16x16x32_bf16 v[100:103], a[28:31], a[92:95], v[100:103]
 buffer_load_dwordx4 v1, s[4:7], s41 offen  lds
 v_mfma_f32_16x16x32_bf16 v[108:111], a[28:31], a[84:87], v[108:111]
 v_mfma_f32_16x16x32_bf16 v[108:111], a[24:27], a[80:83], v[108:111]
 v_mfma_f32_16x16x32_bf16 v[116:119], a[24:27], a[72:75], v[116:119]
 v_mfma_f32_16x16x32_bf16 v[116:119], a[28:31], a[76:79], v[116:119]
 s_add_u32 m0, s29, 106496
 v_mfma_f32_16x16x32_bf16 v[124:127], a[28:31], a[68:71], v[124:127]
 buffer_load_dwordx4 v2, s[8:11], s49 offen  lds
 v_mfma_f32_16x16x32_bf16 v[124:127], a[24:27], a[64:67], v[124:127]
 v_mfma_f32_16x16x32_bf16 v[152:155], a[32:35], a[64:67], v[152:155]
 v_mfma_f32_16x16x32_bf16 v[152:155], a[36:39], a[68:71], v[152:155]
 v_mfma_f32_16x16x32_bf16 v[144:147], a[36:39], a[76:79], v[144:147]
 s_add_u32 m0, s29, 40960
 v_mfma_f32_16x16x32_bf16 v[144:147], a[32:35], a[72:75], v[144:147]
 buffer_load_dwordx4 v1, s[4:7], s42 offen  lds
 v_mfma_f32_16x16x32_bf16 v[136:139], a[32:35], a[80:83], v[136:139]
 v_mfma_f32_16x16x32_bf16 v[136:139], a[36:39], a[84:87], v[136:139]
 v_mfma_f32_16x16x32_bf16 v[128:131], a[36:39], a[92:95], v[128:131]
 v_mfma_f32_16x16x32_bf16 v[128:131], a[32:35], a[88:91], v[128:131]
 s_add_u32 m0, s29, 110592
 v_mfma_f32_16x16x32_bf16 v[132:135], a[40:43], a[88:91], v[132:135]
 buffer_load_dwordx4 v2, s[8:11], s50 offen  lds
 v_mfma_f32_16x16x32_bf16 v[132:135], a[44:47], a[92:95], v[132:135]
 v_mfma_f32_16x16x32_bf16 v[140:143], a[44:47], a[84:87], v[140:143]
 v_mfma_f32_16x16x32_bf16 v[140:143], a[40:43], a[80:83], v[140:143]
 v_mfma_f32_16x16x32_bf16 v[148:151], a[40:43], a[72:75], v[148:151]
 s_add_u32 m0, s29, 45056
 v_mfma_f32_16x16x32_bf16 v[148:151], a[44:47], a[76:79], v[148:151]
 buffer_load_dwordx4 v1, s[4:7], s43 offen  lds
 v_mfma_f32_16x16x32_bf16 v[156:159], a[44:47], a[68:71], v[156:159]
 v_mfma_f32_16x16x32_bf16 v[156:159], a[40:43], a[64:67], v[156:159]
 v_mfma_f32_16x16x32_bf16 v[184:187], a[48:51], a[64:67], v[184:187]
 v_mfma_f32_16x16x32_bf16 v[184:187], a[52:55], a[68:71], v[184:187]
 s_add_u32 m0, s29, 114688
 v_mfma_f32_16x16x32_bf16 v[176:179], a[52:55], a[76:79], v[176:179]
 buffer_load_dwordx4 v2, s[8:11], s51 offen  lds
 v_mfma_f32_16x16x32_bf16 v[176:179], a[48:51], a[72:75], v[176:179]
 v_mfma_f32_16x16x32_bf16 v[168:171], a[48:51], a[80:83], v[168:171]
 v_mfma_f32_16x16x32_bf16 v[168:171], a[52:55], a[84:87], v[168:171]
 v_mfma_f32_16x16x32_bf16 v[160:163], a[52:55], a[92:95], v[160:163]
 s_add_u32 m0, s29, 49152
 v_mfma_f32_16x16x32_bf16 v[160:163], a[48:51], a[88:91], v[160:163]
 buffer_load_dwordx4 v1, s[4:7], s44 offen  lds
 v_mfma_f32_16x16x32_bf16 v[164:167], a[56:59], a[88:91], v[164:167]
 s_waitcnt vmcnt(10)
 v_mfma_f32_16x16x32_bf16 v[164:167], a[60:63], a[92:95], v[164:167]
 s_barrier
 v_mfma_f32_16x16x32_bf16 v[172:175], a[60:63], a[84:87], v[172:175]
 ds_read_b64_tr_b16 a[0:1], v6 offset:0
 v_mfma_f32_16x16x32_bf16 v[172:175], a[56:59], a[80:83], v[172:175]
 s_add_u32 m0, s29, 118784
 ds_read_b64_tr_b16 a[2:3], v6 offset:4096
 v_mfma_f32_16x16x32_bf16 v[180:183], a[56:59], a[72:75], v[180:183]
 buffer_load_dwordx4 v2, s[8:11], s52 offen  lds
 v_mfma_f32_16x16x32_bf16 v[180:183], a[60:63], a[76:79], v[180:183]
 ds_read_b64_tr_b16 a[4:5], v6 offset:16384
 v_mfma_f32_16x16x32_bf16 v[188:191], a[60:63], a[68:71], v[188:191]
 ds_read_b64_tr_b16 a[6:7], v6 offset:20480
 v_mfma_f32_16x16x32_bf16 v[188:191], a[56:59], a[64:67], v[188:191]
 ds_read_b128 a[64:67], v4 offset:0
 v_mfma_f32_16x16x32_bf16 v[216:219], a[32:35], a[96:99], v[216:219]
 s_add_u32 m0, s29, 53248
 ds_read_b128 a[160:163], v14 offset:0
 v_mfma_f32_16x16x32_bf16 v[216:219], a[36:39], a[100:103], v[216:219]
 buffer_load_dwordx4 v1, s[4:7], s45 offen  lds
 v_mfma_f32_16x16x32_bf16 v[208:211], a[36:39], a[108:111], v[208:211]
 ds_read_b128 a[68:71], v5 offset:0
 v_mfma_f32_16x16x32_bf16 v[208:211], a[32:35], a[104:107], v[208:211]
 ds_read_b128 a[168:171], v3 offset:0
 v_mfma_f32_16x16x32_bf16 v[200:203], a[32:35], a[112:115], v[200:203]
 ds_read_b128 a[76:79], v5 offset:2048
 v_mfma_f32_16x16x32_bf16 v[200:203], a[36:39], a[116:119], v[200:203]
 s_add_u32 m0, s29, 122880
 ds_read_b128 a[164:167], v14 offset:2048
 v_mfma_f32_16x16x32_bf16 v[192:195], a[36:39], a[124:127], v[192:195]
 buffer_load_dwordx4 v2, s[8:11], s53 offen  lds
 v_mfma_f32_16x16x32_bf16 v[192:195], a[32:35], a[120:123], v[192:195]
 ds_read_b128 a[72:75], v4 offset:2048
 v_mfma_f32_16x16x32_bf16 v[196:199], a[40:43], a[120:123], v[196:199]
 ds_read_b128 a[172:175], v3 offset:2048
 v_mfma_f32_16x16x32_bf16 v[196:199], a[44:47], a[124:127], v[196:199]
 ds_read_b128 a[80:83], v4 offset:4096
 v_mfma_f32_16x16x32_bf16 v[204:207], a[44:47], a[116:119], v[204:207]
 s_add_u32 m0, s29, 57344
 ds_read_b128 a[176:179], v14 offset:4096
 v_mfma_f32_16x16x32_bf16 v[204:207], a[40:43], a[112:115], v[204:207]
 buffer_load_dwordx4 v1, s[4:7], s46 offen  lds
 v_mfma_f32_16x16x32_bf16 v[212:215], a[40:43], a[104:107], v[212:215]
 ds_read_b128 a[84:87], v5 offset:4096
 v_mfma_f32_16x16x32_bf16 v[212:215], a[44:47], a[108:111], v[212:215]
 ds_read_b128 a[184:187], v3 offset:4096
 v_mfma_f32_16x16x32_bf16 v[220:223], a[44:47], a[100:103], v[220:223]
 ds_read_b128 a[92:95], v5 offset:6144
 v_mfma_f32_16x16x32_bf16 v[220:223], a[40:43], a[96:99], v[220:223]
 s_add_u32 m0, s29, 126976
 ds_read_b128 a[180:183], v14 offset:6144
 v_mfma_f32_16x16x32_bf16 v[248:251], a[48:51], a[96:99], v[248:251]
 buffer_load_dwordx4 v2, s[8:11], s54 offen  lds
 v_mfma_f32_16x16x32_bf16 v[248:251], a[52:55], a[100:103], v[248:251]
 ds_read_b128 a[88:91], v4 offset:6144
 v_mfma_f32_16x16x32_bf16 v[240:243], a[52:55], a[108:111], v[240:243]
 ds_read_b128 a[188:191], v3 offset:6144
 v_mfma_f32_16x16x32_bf16 v[240:243], a[48:51], a[104:107], v[240:243]
 ds_read_b64_tr_b16 a[8:9], v7 offset:0
 v_mfma_f32_16x16x32_bf16 v[232:235], a[48:51], a[112:115], v[232:235]
 s_add_u32 m0, s29, 61440
 ds_read_b64_tr_b16 a[10:11], v7 offset:4096
 v_mfma_f32_16x16x32_bf16 v[232:235], a[52:55], a[116:119], v[232:235]
 buffer_load_dwordx4 v1, s[4:7], s47 offen  lds
 v_mfma_f32_16x16x32_bf16 v[224:227], a[52:55], a[124:127], v[224:227]
 v_add_u32 v1, 128, v1
 v_add_u32 v2, 0x80000, v2
 v_mfma_f32_16x16x32_bf16 v[224:227], a[48:51], a[120:123], v[224:227]
 ds_read_b64_tr_b16 a[12:13], v7 offset:16384
 v_mfma_f32_16x16x32_bf16 v[228:231], a[56:59], a[120:123], v[228:231]
 v_mfma_f32_16x16x32_bf16 v[228:231], a[60:63], a[124:127], v[228:231]
 ds_read_b64_tr_b16 a[14:15], v7 offset:20480
 v_mfma_f32_16x16x32_bf16 v[236:239], a[60:63], a[116:119], v[236:239]
 ds_read_b64_tr_b16 a[16:17], v8 offset:0
 v_mfma_f32_16x16x32_bf16 v[236:239], a[56:59], a[112:115], v[236:239]
 ds_read_b64_tr_b16 a[18:19], v8 offset:4096
 v_mfma_f32_16x16x32_bf16 v[244:247], a[56:59], a[104:107], v[244:247]
 ds_read_b64_tr_b16 a[20:21], v8 offset:16384
 v_mfma_f32_16x16x32_bf16 v[244:247], a[60:63], a[108:111], v[244:247]
 ds_read_b64_tr_b16 a[22:23], v8 offset:20480
 v_mfma_f32_16x16x32_bf16 v[252:255], a[60:63], a[100:103], v[252:255]
 ds_read_b64_tr_b16 a[24:25], v9 offset:0
 v_mfma_f32_16x16x32_bf16 v[252:255], a[56:59], a[96:99], v[252:255]
 s_waitcnt lgkmcnt(15)
 ds_read_b64_tr_b16 a[26:27], v9 offset:4096
 v_mfma_f32_16x16x32_bf16 v[88:91], a[0:3], a[64:67], v[88:91]
 ds_read_b64_tr_b16 a[28:29], v9 offset:16384
 v_lshlrev_b32 v1, 4, v0
 v_mfma_f32_16x16x32_bf16 v[88:91], a[4:7], a[68:71], v[88:91]
 s_add_u32 m0, s33, 0xfffffe00
 ds_read_b64_tr_b16 a[30:31], v9 offset:20480
 v_mfma_f32_16x16x32_bf16 v[80:83], a[4:7], a[76:79], v[80:83]
 s_waitcnt lgkmcnt(12)
 ds_read_b128 a[96:99], v4 offset:8192
 v_mfma_f32_16x16x32_bf16 v[80:83], a[0:3], a[72:75], v[80:83]
 buffer_load_dwordx4 v15, s[20:23], 0 offen offset:512 lds
 v_mfma_f32_16x16x32_bf16 v[72:75], a[0:3], a[80:83], v[72:75]
 ds_read_b128 a[100:103], v5 offset:8192
 v_mfma_f32_16x16x32_bf16 v[72:75], a[4:7], a[84:87], v[72:75]
 v_mfma_f32_16x16x32_bf16 v[64:67], a[4:7], a[92:95], v[64:67]
 s_add_u32 m0, s33, 0xfffffe80
 ds_read_b128 a[108:111], v5 offset:10240
 v_mfma_f32_16x16x32_bf16 v[64:67], a[0:3], a[88:91], v[64:67]
 s_waitcnt lgkmcnt(11)
 buffer_load_dwordx4 v15, s[20:23], 0 offen offset:1408 lds
 v_mfma_f32_16x16x32_bf16 v[68:71], a[8:11], a[88:91], v[68:71]
 ds_read_b128 a[104:107], v4 offset:10240
 v_mfma_f32_16x16x32_bf16 v[68:71], a[12:15], a[92:95], v[68:71]
 v_mfma_f32_16x16x32_bf16 v[76:79], a[12:15], a[84:87], v[76:79]
 s_add_u32 m0, s33, 0x600
 ds_read_b128 a[112:115], v4 offset:12288
 v_mfma_f32_16x16x32_bf16 v[76:79], a[8:11], a[80:83], v[76:79]
 buffer_load_dwordx4 v15, s[20:23], s57 offen offset:512 lds
 v_mfma_f32_16x16x32_bf16 v[84:87], a[8:11], a[72:75], v[84:87]
 ds_read_b128 a[116:119], v5 offset:12288
 v_mfma_f32_16x16x32_bf16 v[84:87], a[12:15], a[76:79], v[84:87]
 v_mfma_f32_16x16x32_bf16 v[92:95], a[12:15], a[68:71], v[92:95]
 s_add_u32 m0, s33, 0x680
 ds_read_b128 a[124:127], v5 offset:14336
 v_mfma_f32_16x16x32_bf16 v[92:95], a[8:11], a[64:67], v[92:95]
 s_waitcnt lgkmcnt(11)
 buffer_load_dwordx4 v15, s[20:23], s57 offen offset:1408 lds
 v_mfma_f32_16x16x32_bf16 v[120:123], a[16:19], a[64:67], v[120:123]
 ds_read_b128 a[120:123], v4 offset:14336
 v_mfma_f32_16x16x32_bf16 v[120:123], a[20:23], a[68:71], v[120:123]
 v_mfma_f32_16x16x32_bf16 v[112:115], a[20:23], a[76:79], v[112:115]
 s_add_u32 m0, s33, 0xd80
 ds_read_b64_tr_b16 a[32:33], v10 offset:0
 v_mfma_f32_16x16x32_bf16 v[112:115], a[16:19], a[72:75], v[112:115]
 ds_read_b64_tr_b16 a[34:35], v10 offset:4096
 buffer_load_dwordx4 v15, s[20:23], 0 offen offset:640 lds
 v_mfma_f32_16x16x32_bf16 v[104:107], a[16:19], a[80:83], v[104:107]
 ds_read_b64_tr_b16 a[36:37], v10 offset:16384
 v_mfma_f32_16x16x32_bf16 v[104:107], a[20:23], a[84:87], v[104:107]
 ds_read_b64_tr_b16 a[38:39], v10 offset:20480
 v_mfma_f32_16x16x32_bf16 v[96:99], a[20:23], a[92:95], v[96:99]
 s_add_u32 m0, s33, 0xe00
 ds_read_b64_tr_b16 a[40:41], v11 offset:0
 v_mfma_f32_16x16x32_bf16 v[96:99], a[16:19], a[88:91], v[96:99]
 s_waitcnt lgkmcnt(13)
 ds_read_b64_tr_b16 a[42:43], v11 offset:4096
 buffer_load_dwordx4 v15, s[20:23], 0 offen offset:1536 lds
 v_mfma_f32_16x16x32_bf16 v[100:103], a[24:27], a[88:91], v[100:103]
 ds_read_b64_tr_b16 a[44:45], v11 offset:16384
 v_mfma_f32_16x16x32_bf16 v[100:103], a[28:31], a[92:95], v[100:103]
 ds_read_b64_tr_b16 a[46:47], v11 offset:20480
 v_mfma_f32_16x16x32_bf16 v[108:111], a[28:31], a[84:87], v[108:111]
 s_add_u32 m0, s33, 0x1580
 ds_read_b64_tr_b16 a[48:49], v12 offset:0
 v_mfma_f32_16x16x32_bf16 v[108:111], a[24:27], a[80:83], v[108:111]
 ds_read_b64_tr_b16 a[50:51], v12 offset:4096
 buffer_load_dwordx4 v15, s[20:23], s57 offen offset:640 lds
 v_mfma_f32_16x16x32_bf16 v[116:119], a[24:27], a[72:75], v[116:119]
 ds_read_b64_tr_b16 a[52:53], v12 offset:16384
 v_mfma_f32_16x16x32_bf16 v[116:119], a[28:31], a[76:79], v[116:119]
 ds_read_b64_tr_b16 a[54:55], v12 offset:20480
 v_mfma_f32_16x16x32_bf16 v[124:127], a[28:31], a[68:71], v[124:127]
 s_add_u32 m0, s33, 0x1600
 ds_read_b64_tr_b16 a[56:57], v13 offset:0
 v_mfma_f32_16x16x32_bf16 v[124:127], a[24:27], a[64:67], v[124:127]
 s_waitcnt lgkmcnt(15)
 ds_read_b64_tr_b16 a[58:59], v13 offset:4096
 buffer_load_dwordx4 v15, s[20:23], s57 offen offset:1536 lds
 v_mfma_f32_16x16x32_bf16 a[232:235], a[0:3], a[96:99], a[232:235]
 ds_read_b64_tr_b16 a[60:61], v13 offset:16384
 v_mfma_f32_16x16x32_bf16 a[232:235], a[4:7], a[100:103], a[232:235]
 ds_read_b64_tr_b16 a[62:63], v13 offset:20480
 v_mfma_f32_16x16x32_bf16 a[224:227], a[4:7], a[108:111], a[224:227]
 v_mfma_f32_16x16x32_bf16 a[224:227], a[0:3], a[104:107], a[224:227]
 v_mfma_f32_16x16x32_bf16 v[24:27], a[0:3], a[112:115], v[24:27]
 v_mfma_f32_16x16x32_bf16 v[24:27], a[4:7], a[116:119], v[24:27]
 s_waitcnt lgkmcnt(15)
 v_mfma_f32_16x16x32_bf16 v[16:19], a[4:7], a[124:127], v[16:19]
 v_mfma_f32_16x16x32_bf16 v[16:19], a[0:3], a[120:123], v[16:19]
 s_waitcnt lgkmcnt(0)
 v_mfma_f32_16x16x32_bf16 v[20:23], a[8:11], a[120:123], v[20:23]
 s_barrier
 v_mfma_f32_16x16x32_bf16 v[20:23], a[12:15], a[124:127], v[20:23]
 s_add_u32 m0, s29, 0
 v_add_u32 v2, 0xff800000, v2
 v_mfma_f32_16x16x32_bf16 v[28:31], a[12:15], a[116:119], v[28:31]
 buffer_load_dwordx4 v2, s[16:19], 0 offen lds
 v_mfma_f32_16x16x32_bf16 v[28:31], a[8:11], a[112:115], v[28:31]
 v_mfma_f32_16x16x32_bf16 a[228:231], a[8:11], a[104:107], a[228:231]
 v_mfma_f32_16x16x32_bf16 a[228:231], a[12:15], a[108:111], a[228:231]
 v_mfma_f32_16x16x32_bf16 a[236:239], a[12:15], a[100:103], a[236:239]
 s_add_u32 m0, s29, 4096
 v_mfma_f32_16x16x32_bf16 a[236:239], a[8:11], a[96:99], a[236:239]
 buffer_load_dwordx4 v2, s[16:19], s48 offen lds
 v_mfma_f32_16x16x32_bf16 v[56:59], a[16:19], a[96:99], v[56:59]
 v_mfma_f32_16x16x32_bf16 v[56:59], a[20:23], a[100:103], v[56:59]
 v_mfma_f32_16x16x32_bf16 v[48:51], a[20:23], a[108:111], v[48:51]
 v_mfma_f32_16x16x32_bf16 v[48:51], a[16:19], a[104:107], v[48:51]
 s_add_u32 m0, s29, 8192
 v_mfma_f32_16x16x32_bf16 v[40:43], a[16:19], a[112:115], v[40:43]
 buffer_load_dwordx4 v2, s[16:19], s49 offen lds
 v_mfma_f32_16x16x32_bf16 v[40:43], a[20:23], a[116:119], v[40:43]
 v_mfma_f32_16x16x32_bf16 v[32:35], a[20:23], a[124:127], v[32:35]
 v_mfma_f32_16x16x32_bf16 v[32:35], a[16:19], a[120:123], v[32:35]
 v_mfma_f32_16x16x32_bf16 v[36:39], a[24:27], a[120:123], v[36:39]
 s_add_u32 m0, s29, 12288
 v_mfma_f32_16x16x32_bf16 v[36:39], a[28:31], a[124:127], v[36:39]
 buffer_load_dwordx4 v2, s[16:19], s50 offen lds
 v_mfma_f32_16x16x32_bf16 v[44:47], a[28:31], a[116:119], v[44:47]
 v_mfma_f32_16x16x32_bf16 v[44:47], a[24:27], a[112:115], v[44:47]
 v_mfma_f32_16x16x32_bf16 v[52:55], a[24:27], a[104:107], v[52:55]
 v_mfma_f32_16x16x32_bf16 v[52:55], a[28:31], a[108:111], v[52:55]
 s_add_u32 m0, s29, 16384
 v_mfma_f32_16x16x32_bf16 v[60:63], a[28:31], a[100:103], v[60:63]
 buffer_load_dwordx4 v2, s[16:19], s51 offen lds
 v_mfma_f32_16x16x32_bf16 v[60:63], a[24:27], a[96:99], v[60:63]
 v_mfma_f32_16x16x32_bf16 v[216:219], a[32:35], a[96:99], v[216:219]
 v_mfma_f32_16x16x32_bf16 v[216:219], a[36:39], a[100:103], v[216:219]
 v_mfma_f32_16x16x32_bf16 v[208:211], a[36:39], a[108:111], v[208:211]
 s_add_u32 m0, s29, 20480
 v_mfma_f32_16x16x32_bf16 v[208:211], a[32:35], a[104:107], v[208:211]
 buffer_load_dwordx4 v2, s[16:19], s52 offen lds
 v_mfma_f32_16x16x32_bf16 v[200:203], a[32:35], a[112:115], v[200:203]
 v_mfma_f32_16x16x32_bf16 v[200:203], a[36:39], a[116:119], v[200:203]
 v_mfma_f32_16x16x32_bf16 v[192:195], a[36:39], a[124:127], v[192:195]
 v_mfma_f32_16x16x32_bf16 v[192:195], a[32:35], a[120:123], v[192:195]
 s_add_u32 m0, s29, 24576
 v_mfma_f32_16x16x32_bf16 v[196:199], a[40:43], a[120:123], v[196:199]
 buffer_load_dwordx4 v2, s[16:19], s53 offen lds
 v_mfma_f32_16x16x32_bf16 v[196:199], a[44:47], a[124:127], v[196:199]
 v_mfma_f32_16x16x32_bf16 v[204:207], a[44:47], a[116:119], v[204:207]
 v_mfma_f32_16x16x32_bf16 v[204:207], a[40:43], a[112:115], v[204:207]
 v_mfma_f32_16x16x32_bf16 v[212:215], a[40:43], a[104:107], v[212:215]
 s_add_u32 m0, s29, 28672
 v_mfma_f32_16x16x32_bf16 v[212:215], a[44:47], a[108:111], v[212:215]
 buffer_load_dwordx4 v2, s[16:19], s54 offen lds
 v_mfma_f32_16x16x32_bf16 v[220:223], a[44:47], a[100:103], v[220:223]
 v_mfma_f32_16x16x32_bf16 v[220:223], a[40:43], a[96:99], v[220:223]
 v_mfma_f32_16x16x32_bf16 v[248:251], a[48:51], a[96:99], v[248:251]
 s_add_u32 m0, s29, 65536
 v_add_u32 v2, 0x80000, v2
 v_mfma_f32_16x16x32_bf16 v[248:251], a[52:55], a[100:103], v[248:251]
 buffer_load_dwordx4 v2, s[16:19], 0 offen lds
 v_mfma_f32_16x16x32_bf16 v[240:243], a[52:55], a[108:111], v[240:243]
 v_mfma_f32_16x16x32_bf16 v[240:243], a[48:51], a[104:107], v[240:243]
 v_mfma_f32_16x16x32_bf16 v[232:235], a[48:51], a[112:115], v[232:235]
 v_mfma_f32_16x16x32_bf16 v[232:235], a[52:55], a[116:119], v[232:235]
 s_add_u32 m0, s29, 69632
 v_mfma_f32_16x16x32_bf16 v[224:227], a[52:55], a[124:127], v[224:227]
 buffer_load_dwordx4 v2, s[16:19], s48 offen lds
 v_mfma_f32_16x16x32_bf16 v[224:227], a[48:51], a[120:123], v[224:227]
 v_mfma_f32_16x16x32_bf16 v[228:231], a[56:59], a[120:123], v[228:231]
 s_waitcnt vmcnt(10)
 v_mfma_f32_16x16x32_bf16 v[228:231], a[60:63], a[124:127], v[228:231]
 s_barrier
 v_mfma_f32_16x16x32_bf16 v[236:239], a[60:63], a[116:119], v[236:239]
 s_add_u32 m0, s29, 73728
 ds_read_b64_tr_b16 a[0:1], v6 offset:32768
 v_mfma_f32_16x16x32_bf16 v[236:239], a[56:59], a[112:115], v[236:239]
 ds_read_b64_tr_b16 a[2:3], v6 offset:36864
 buffer_load_dwordx4 v2, s[16:19], s49 offen lds
 v_mfma_f32_16x16x32_bf16 v[244:247], a[56:59], a[104:107], v[244:247]
 ds_read_b128 a[192:195], v14 offset:0
 v_mfma_f32_16x16x32_bf16 v[244:247], a[60:63], a[108:111], v[244:247]
 ds_read_b64_tr_b16 a[4:5], v6 offset:49152
 v_mfma_f32_16x16x32_bf16 v[252:255], a[60:63], a[100:103], v[252:255]
 ds_read_b64_tr_b16 a[6:7], v6 offset:53248
 v_mfma_f32_16x16x32_bf16 v[252:255], a[56:59], a[96:99], v[252:255]
 s_add_u32 m0, s29, 77824
 ds_read_b128 a[96:99], v4 offset:40960
 v_mfma_f32_16x16x32_bf16 v[152:155], a[32:35], a[64:67], v[152:155]
 ds_read_b128 a[200:203], v3 offset:0
 buffer_load_dwordx4 v2, s[16:19], s50 offen lds
 v_mfma_f32_16x16x32_bf16 v[152:155], a[36:39], a[68:71], v[152:155]
 ds_read_b128 a[196:199], v14 offset:2048
 v_mfma_f32_16x16x32_bf16 v[144:147], a[36:39], a[76:79], v[144:147]
 s_mov_b32 s56, s58
 ds_read_b128 a[100:103], v5 offset:40960
 v_mfma_f32_16x16x32_bf16 v[144:147], a[32:35], a[72:75], v[144:147]
 ds_read_b128 a[204:207], v3 offset:2048
 v_mfma_f32_16x16x32_bf16 v[136:139], a[32:35], a[80:83], v[136:139]
 s_add_u32 m0, s29, 81920
 ds_read_b128 a[108:111], v5 offset:43008
 v_mfma_f32_16x16x32_bf16 v[136:139], a[36:39], a[84:87], v[136:139]
 ds_read_b128 a[208:211], v14 offset:4096
 buffer_load_dwordx4 v2, s[16:19], s51 offen lds
 v_mfma_f32_16x16x32_bf16 v[128:131], a[36:39], a[92:95], v[128:131]
 ds_read_b128 a[216:219], v3 offset:4096
 v_mfma_f32_16x16x32_bf16 v[128:131], a[32:35], a[88:91], v[128:131]
 ds_read_b128 a[104:107], v4 offset:43008
 v_mfma_f32_16x16x32_bf16 v[132:135], a[40:43], a[88:91], v[132:135]
 ds_read_b128 a[212:215], v14 offset:6144
 v_mfma_f32_16x16x32_bf16 v[132:135], a[44:47], a[92:95], v[132:135]
 s_add_u32 m0, s29, 86016
 ds_read_b128 a[112:115], v4 offset:45056
 v_mfma_f32_16x16x32_bf16 v[140:143], a[44:47], a[84:87], v[140:143]
 ds_read_b128 a[220:223], v3 offset:6144
 buffer_load_dwordx4 v2, s[16:19], s52 offen lds
 v_mfma_f32_16x16x32_bf16 v[140:143], a[40:43], a[80:83], v[140:143]
 v_mfma_f32_16x16x32_bf16 v[148:151], a[40:43], a[72:75], v[148:151]
 s_cmp_lt_u32 s25, 4
 s_cselect_b32 s1, 2.0, s92
 ds_read_b128 a[116:119], v5 offset:45056
 v_mfma_f32_16x16x32_bf16 v[148:151], a[44:47], a[76:79], v[148:151]
 v_mfma_f32_16x16x32_bf16 v[156:159], a[44:47], a[68:71], v[156:159]
 s_add_u32 m0, s29, 90112
 ds_read_b128 a[124:127], v5 offset:47104
 v_mfma_f32_16x16x32_bf16 v[156:159], a[40:43], a[64:67], v[156:159]
 buffer_load_dwordx4 v2, s[16:19], s53 offen lds
 v_mfma_f32_16x16x32_bf16 v[184:187], a[48:51], a[64:67], v[184:187]
 v_mfma_f32_16x16x32_bf16 v[184:187], a[52:55], a[68:71], v[184:187]
 ds_read_b128 a[120:123], v4 offset:47104
 v_mfma_f32_16x16x32_bf16 v[176:179], a[52:55], a[76:79], v[176:179]
 v_mfma_f32_16x16x32_bf16 v[176:179], a[48:51], a[72:75], v[176:179]
 s_add_u32 m0, s29, 94208
 ds_read_b64_tr_b16 a[8:9], v7 offset:32768
 v_mfma_f32_16x16x32_bf16 v[168:171], a[48:51], a[80:83], v[168:171]
 ds_read_b64_tr_b16 a[10:11], v7 offset:36864
 buffer_load_dwordx4 v2, s[16:19], s54 offen lds
 v_mfma_f32_16x16x32_bf16 v[168:171], a[52:55], a[84:87], v[168:171]
 v_mfma_f32_16x16x32_bf16 v[160:163], a[52:55], a[92:95], v[160:163]
 v_mfma_f32_16x16x32_bf16 v[160:163], a[48:51], a[88:91], v[160:163]
 ds_read_b64_tr_b16 a[12:13], v7 offset:49152
 v_mfma_f32_16x16x32_bf16 v[164:167], a[56:59], a[88:91], v[164:167]
 v_mfma_f32_16x16x32_bf16 v[164:167], a[60:63], a[92:95], v[164:167]
 ds_read_b64_tr_b16 a[14:15], v7 offset:53248
 v_mfma_f32_16x16x32_bf16 v[172:175], a[60:63], a[84:87], v[172:175]
 ds_read_b64_tr_b16 a[16:17], v8 offset:32768
 v_mfma_f32_16x16x32_bf16 v[172:175], a[56:59], a[80:83], v[172:175]
 ds_read_b64_tr_b16 a[18:19], v8 offset:36864
 v_mfma_f32_16x16x32_bf16 v[180:183], a[56:59], a[72:75], v[180:183]
 ds_read_b64_tr_b16 a[20:21], v8 offset:49152
 v_mfma_f32_16x16x32_bf16 v[180:183], a[60:63], a[76:79], v[180:183]
 ds_read_b64_tr_b16 a[22:23], v8 offset:53248
 v_mfma_f32_16x16x32_bf16 v[188:191], a[60:63], a[68:71], v[188:191]
 ds_read_b64_tr_b16 a[24:25], v9 offset:32768
 v_mfma_f32_16x16x32_bf16 v[188:191], a[56:59], a[64:67], v[188:191]
 s_waitcnt lgkmcnt(15)
 ds_read_b64_tr_b16 a[26:27], v9 offset:36864
 s_cmp_ge_u32 s25, 4
 s_cbranch_scc1 L_late0
 v_mfma_f32_16x16x32_bf16 a[232:235], a[0:3], a[96:99], a[232:235]
 ds_read_b64_tr_b16 a[28:29], v9 offset:49152
 v_mfma_f32_16x16x32_bf16 a[232:235], a[4:7], a[100:103], a[232:235]
 s_add_u32 m0, s33, 0xfffffd00
 ds_read_b64_tr_b16 a[30:31], v9 offset:53248
 v_mfma_f32_16x16x32_bf16 a[224:227], a[4:7], a[108:111], a[224:227]
 s_waitcnt lgkmcnt(15)
 ds_read_b128 a[64:67], v4 offset:32768
 v_mfma_f32_16x16x32_bf16 a[224:227], a[0:3], a[104:107], a[224:227]
 buffer_load_dwordx4 v15, s[20:23], 0 offen offset:768 lds
 v_mfma_f32_16x16x32_bf16 v[24:27], a[0:3], a[112:115], v[24:27]
 s_waitcnt lgkmcnt(13)
 ds_read_b128 a[68:71], v5 offset:32768
 v_mfma_f32_16x16x32_bf16 v[24:27], a[4:7], a[116:119], v[24:27]
 v_mfma_f32_16x16x32_bf16 v[16:19], a[4:7], a[124:127], v[16:19]
 s_add_u32 m0, s33, 0xfffffd80
 ds_read_b128 a[76:79], v5 offset:34816
 v_mfma_f32_16x16x32_bf16 v[16:19], a[0:3], a[120:123], v[16:19]
 s_waitcnt lgkmcnt(11)
 buffer_load_dwordx4 v15, s[20:23], 0 offen offset:1664 lds
 v_mfma_f32_16x16x32_bf16 v[20:23], a[8:11], a[120:123], v[20:23]
 ds_read_b128 a[72:75], v4 offset:34816
 v_mfma_f32_16x16x32_bf16 v[20:23], a[12:15], a[124:127], v[20:23]
 v_mfma_f32_16x16x32_bf16 v[28:31], a[12:15], a[116:119], v[28:31]
 s_add_u32 m0, s33, 0x500
 ds_read_b128 a[80:83], v4 offset:36864
 v_mfma_f32_16x16x32_bf16 v[28:31], a[8:11], a[112:115], v[28:31]
 buffer_load_dwordx4 v15, s[20:23], s57 offen offset:768 lds
 v_mfma_f32_16x16x32_bf16 a[228:231], a[8:11], a[104:107], a[228:231]
 ds_read_b128 a[84:87], v5 offset:36864
 v_mfma_f32_16x16x32_bf16 a[228:231], a[12:15], a[108:111], a[228:231]
 v_mfma_f32_16x16x32_bf16 a[236:239], a[12:15], a[100:103], a[236:239]
 s_add_u32 m0, s33, 0x580
 ds_read_b128 a[92:95], v5 offset:38912
 v_mfma_f32_16x16x32_bf16 a[236:239], a[8:11], a[96:99], a[236:239]
 s_waitcnt lgkmcnt(11)
 buffer_load_dwordx4 v15, s[20:23], s57 offen offset:1664 lds
 v_mfma_f32_16x16x32_bf16 v[56:59], a[16:19], a[96:99], v[56:59]
 ds_read_b128 a[88:91], v4 offset:38912
 v_mfma_f32_16x16x32_bf16 v[56:59], a[20:23], a[100:103], v[56:59]
 v_cvt_pk_bf16_f32 v16, v16, v17
 v_cvt_pk_bf16_f32 v17, v18, v19
 v_mfma_f32_16x16x32_bf16 v[48:51], a[20:23], a[108:111], v[48:51]
 ds_read_b64_tr_b16 a[32:33], v10 offset:32768
 v_cvt_pk_bf16_f32 v18, v20, v21
 v_mfma_f32_16x16x32_bf16 v[48:51], a[16:19], a[104:107], v[48:51]
 ds_read_b64_tr_b16 a[34:35], v10 offset:36864
 v_cvt_pk_bf16_f32 v19, v22, v23
 v_mfma_f32_16x16x32_bf16 v[40:43], a[16:19], a[112:115], v[40:43]
 ds_read_b64_tr_b16 a[36:37], v10 offset:49152
 v_cvt_pk_bf16_f32 v24, v24, v25
 v_mfma_f32_16x16x32_bf16 v[40:43], a[20:23], a[116:119], v[40:43]
 ds_read_b64_tr_b16 a[38:39], v10 offset:53248
 v_cvt_pk_bf16_f32 v25, v26, v27
 v_mfma_f32_16x16x32_bf16 v[32:35], a[20:23], a[124:127], v[32:35]
 s_add_u32 s59, s56, 57344
 ds_read_b64_tr_b16 a[40:41], v11 offset:32768
 v_cvt_pk_bf16_f32 v26, v28, v29
 v_mfma_f32_16x16x32_bf16 v[32:35], a[16:19], a[120:123], v[32:35]
 s_waitcnt lgkmcnt(13)
 ds_read_b64_tr_b16 a[42:43], v11 offset:36864
 v_cvt_pk_bf16_f32 v27, v30, v31
 v_mfma_f32_16x16x32_bf16 v[36:39], a[24:27], a[120:123], v[36:39]
 ds_read_b64_tr_b16 a[44:45], v11 offset:49152
 buffer_store_dwordx4 v[16:19], v1, s[12:15], s59 offen offset:0 sc1
 v_mfma_f32_16x16x32_bf16 v[36:39], a[28:31], a[124:127], v[36:39]
 ds_read_b64_tr_b16 a[46:47], v11 offset:53248
 v_accvgpr_read_b32 v20, a224
 v_mfma_f32_16x16x32_bf16 v[44:47], a[28:31], a[116:119], v[44:47]
 ds_read_b64_tr_b16 a[48:49], v12 offset:32768
 v_accvgpr_read_b32 v21, a225
 v_mfma_f32_16x16x32_bf16 v[44:47], a[24:27], a[112:115], v[44:47]
 ds_read_b64_tr_b16 a[50:51], v12 offset:36864
 v_accvgpr_read_b32 v22, a226
 v_mfma_f32_16x16x32_bf16 v[52:55], a[24:27], a[104:107], v[52:55]
 ds_read_b64_tr_b16 a[52:53], v12 offset:49152
 v_accvgpr_read_b32 v23, a227
 v_mfma_f32_16x16x32_bf16 v[52:55], a[28:31], a[108:111], v[52:55]
 ds_read_b64_tr_b16 a[54:55], v12 offset:53248
 v_accvgpr_read_b32 v28, a228
 v_mfma_f32_16x16x32_bf16 v[60:63], a[28:31], a[100:103], v[60:63]
 s_add_u32 s59, s56, 49152
 ds_read_b64_tr_b16 a[56:57], v13 offset:32768
 v_accvgpr_read_b32 v29, a229
 v_mfma_f32_16x16x32_bf16 v[60:63], a[24:27], a[96:99], v[60:63]
 s_waitcnt lgkmcnt(15)
 ds_read_b64_tr_b16 a[58:59], v13 offset:36864
 buffer_store_dwordx4 v[24:27], v1, s[12:15], s59 offen offset:0 sc1
 v_mfma_f32_16x16x32_bf16 v[88:91], a[0:3], a[64:67], v[88:91]
 ds_read_b64_tr_b16 a[60:61], v13 offset:49152
 v_accvgpr_read_b32 v30, a230
 v_mfma_f32_16x16x32_bf16 v[88:91], a[4:7], a[68:71], v[88:91]
 ds_read_b64_tr_b16 a[62:63], v13 offset:53248
 v_accvgpr_read_b32 v31, a231
 v_mfma_f32_16x16x32_bf16 v[80:83], a[4:7], a[76:79], v[80:83]
 v_cvt_pk_bf16_f32 v20, v20, v21
 v_cvt_pk_bf16_f32 v21, v22, v23
 v_mfma_f32_16x16x32_bf16 v[80:83], a[0:3], a[72:75], v[80:83]
 v_cvt_pk_bf16_f32 v22, v28, v29
 v_cvt_pk_bf16_f32 v23, v30, v31
 v_mfma_f32_16x16x32_bf16 v[72:75], a[0:3], a[80:83], v[72:75]
 s_add_u32 s59, s56, 40960
 v_cvt_pk_bf16_f32 v32, v32, v33
 v_cvt_pk_bf16_f32 v33, v34, v35
 v_mfma_f32_16x16x32_bf16 v[72:75], a[4:7], a[84:87], v[72:75]
 s_waitcnt lgkmcnt(15)
 v_cvt_pk_bf16_f32 v34, v36, v37
 v_cvt_pk_bf16_f32 v35, v38, v39
 v_mfma_f32_16x16x32_bf16 v[64:67], a[4:7], a[92:95], v[64:67]
 buffer_store_dwordx4 v[20:23], v1, s[12:15], s59 offen offset:0 sc1
 v_mfma_f32_16x16x32_bf16 v[64:67], a[0:3], a[88:91], v[64:67]
 s_waitcnt lgkmcnt(0)
 v_cvt_pk_bf16_f32 v40, v40, v41
 v_cvt_pk_bf16_f32 v41, v42, v43
 v_mfma_f32_16x16x32_bf16 v[68:71], a[8:11], a[88:91], v[68:71]
 s_barrier
 v_xor_b32 v6, s60, v6
 v_cvt_pk_bf16_f32 v42, v44, v45
 v_mfma_f32_16x16x32_bf16 v[68:71], a[12:15], a[92:95], v[68:71]
 s_add_u32 m0, s29, 32768
 v_add_u32 v2, 0x80000, v2
 v_cvt_pk_bf16_f32 v43, v46, v47
 v_mfma_f32_16x16x32_bf16 v[76:79], a[12:15], a[84:87], v[76:79]
 buffer_load_dwordx4 v2, s[16:19], 0 offen lds
 v_mfma_f32_16x16x32_bf16 v[76:79], a[8:11], a[80:83], v[76:79]
 v_accvgpr_read_b32 v36, a232
 v_accvgpr_read_b32 v37, a233
 v_mfma_f32_16x16x32_bf16 v[84:87], a[8:11], a[72:75], v[84:87]
 s_add_u32 s59, s56, 57344
 v_accvgpr_read_b32 v38, a234
 v_accvgpr_read_b32 v39, a235
 v_mfma_f32_16x16x32_bf16 v[84:87], a[12:15], a[76:79], v[84:87]
 buffer_store_dwordx4 v[32:35], v1, s[12:15], s59 offen offset:1024 sc1
 v_mfma_f32_16x16x32_bf16 v[92:95], a[12:15], a[68:71], v[92:95]
 s_add_u32 m0, s29, 36864
 v_accvgpr_read_b32 v44, a236
 v_accvgpr_read_b32 v45, a237
 v_mfma_f32_16x16x32_bf16 v[92:95], a[8:11], a[64:67], v[92:95]
 buffer_load_dwordx4 v2, s[16:19], s48 offen lds
 v_mfma_f32_16x16x32_bf16 v[120:123], a[16:19], a[64:67], v[120:123]
 v_accvgpr_read_b32 v46, a238
 v_accvgpr_read_b32 v47, a239
 v_mfma_f32_16x16x32_bf16 v[120:123], a[20:23], a[68:71], v[120:123]
 v_cvt_pk_bf16_f32 v36, v36, v37
 v_cvt_pk_bf16_f32 v37, v38, v39
 v_mfma_f32_16x16x32_bf16 v[112:115], a[20:23], a[76:79], v[112:115]
 v_cvt_pk_bf16_f32 v38, v44, v45
 v_cvt_pk_bf16_f32 v39, v46, v47
 v_mfma_f32_16x16x32_bf16 v[112:115], a[16:19], a[72:75], v[112:115]
 s_add_u32 m0, s29, 40960
 v_cvt_pk_bf16_f32 v48, v48, v49
 v_cvt_pk_bf16_f32 v49, v50, v51
 v_mfma_f32_16x16x32_bf16 v[104:107], a[16:19], a[80:83], v[104:107]
 buffer_load_dwordx4 v2, s[16:19], s49 offen lds
 v_mfma_f32_16x16x32_bf16 v[104:107], a[20:23], a[84:87], v[104:107]
 s_add_u32 s59, s56, 49152
 v_cvt_pk_bf16_f32 v50, v52, v53
 v_cvt_pk_bf16_f32 v51, v54, v55
 v_mfma_f32_16x16x32_bf16 v[96:99], a[20:23], a[92:95], v[96:99]
 buffer_store_dwordx4 v[40:43], v1, s[12:15], s59 offen offset:1024 sc1
 v_mfma_f32_16x16x32_bf16 v[96:99], a[16:19], a[88:91], v[96:99]
 v_cvt_pk_bf16_f32 v56, v56, v57
 v_cvt_pk_bf16_f32 v57, v58, v59
 v_mfma_f32_16x16x32_bf16 v[100:103], a[24:27], a[88:91], v[100:103]
 s_add_u32 m0, s29, 45056
 v_cvt_pk_bf16_f32 v58, v60, v61
 v_cvt_pk_bf16_f32 v59, v62, v63
 v_mfma_f32_16x16x32_bf16 v[100:103], a[28:31], a[92:95], v[100:103]
 buffer_load_dwordx4 v2, s[16:19], s50 offen lds
 v_mfma_f32_16x16x32_bf16 v[108:111], a[28:31], a[84:87], v[108:111]
 v_cvt_pk_bf16_f32 v64, v64, v65
 v_cvt_pk_bf16_f32 v65, v66, v67
 v_mfma_f32_16x16x32_bf16 v[108:111], a[24:27], a[80:83], v[108:111]
 v_cvt_pk_bf16_f32 v66, v68, v69
 v_cvt_pk_bf16_f32 v67, v70, v71
 v_mfma_f32_16x16x32_bf16 v[116:119], a[24:27], a[72:75], v[116:119]
 v_cvt_pk_bf16_f32 v72, v72, v73
 v_cvt_pk_bf16_f32 v73, v74, v75
 v_mfma_f32_16x16x32_bf16 v[116:119], a[28:31], a[76:79], v[116:119]
 s_add_u32 m0, s29, 49152
 v_cvt_pk_bf16_f32 v74, v76, v77
 v_cvt_pk_bf16_f32 v75, v78, v79
 v_mfma_f32_16x16x32_bf16 v[124:127], a[28:31], a[68:71], v[124:127]
 buffer_load_dwordx4 v2, s[16:19], s51 offen lds
 v_mfma_f32_16x16x32_bf16 v[124:127], a[24:27], a[64:67], v[124:127]
 s_add_u32 s59, s56, 32768
 v_cvt_pk_bf16_f32 v80, v80, v81
 v_cvt_pk_bf16_f32 v81, v82, v83
 v_mfma_f32_16x16x32_bf16 v[152:155], a[32:35], a[64:67], v[152:155]
 buffer_store_dwordx4 v[36:39], v1, s[12:15], s59 offen offset:0 sc1
 v_mfma_f32_16x16x32_bf16 v[152:155], a[36:39], a[68:71], v[152:155]
 v_cvt_pk_bf16_f32 v82, v84, v85
 v_cvt_pk_bf16_f32 v83, v86, v87
 v_mfma_f32_16x16x32_bf16 v[144:147], a[36:39], a[76:79], v[144:147]
 s_add_u32 m0, s29, 53248
 v_cvt_pk_bf16_f32 v88, v88, v89
 v_cvt_pk_bf16_f32 v89, v90, v91
 v_mfma_f32_16x16x32_bf16 v[144:147], a[32:35], a[72:75], v[144:147]
 buffer_load_dwordx4 v2, s[16:19], s52 offen lds
 v_mfma_f32_16x16x32_bf16 v[136:139], a[32:35], a[80:83], v[136:139]
 v_cvt_pk_bf16_f32 v90, v92, v93
 v_cvt_pk_bf16_f32 v91, v94, v95
 v_mfma_f32_16x16x32_bf16 v[136:139], a[36:39], a[84:87], v[136:139]
 v_cvt_pk_bf16_f32 v96, v96, v97
 v_cvt_pk_bf16_f32 v97, v98, v99
 v_mfma_f32_16x16x32_bf16 v[128:131], a[36:39], a[92:95], v[128:131]
 v_cvt_pk_bf16_f32 v98, v100, v101
 v_cvt_pk_bf16_f32 v99, v102, v103
 v_mfma_f32_16x16x32_bf16 v[128:131], a[32:35], a[88:91], v[128:131]
 s_add_u32 m0, s29, 57344
 v_cvt_pk_bf16_f32 v104, v104, v105
 v_cvt_pk_bf16_f32 v105, v106, v107
 v_mfma_f32_16x16x32_bf16 v[132:135], a[40:43], a[88:91], v[132:135]
 buffer_load_dwordx4 v2, s[16:19], s53 offen lds
 v_mfma_f32_16x16x32_bf16 v[132:135], a[44:47], a[92:95], v[132:135]
 s_add_u32 s59, s56, 40960
 v_cvt_pk_bf16_f32 v106, v108, v109
 v_cvt_pk_bf16_f32 v107, v110, v111
 v_mfma_f32_16x16x32_bf16 v[140:143], a[44:47], a[84:87], v[140:143]
 buffer_store_dwordx4 v[48:51], v1, s[12:15], s59 offen offset:1024 sc1
 v_mfma_f32_16x16x32_bf16 v[140:143], a[40:43], a[80:83], v[140:143]
 v_cvt_pk_bf16_f32 v112, v112, v113
 v_cvt_pk_bf16_f32 v113, v114, v115
 v_mfma_f32_16x16x32_bf16 v[148:151], a[40:43], a[72:75], v[148:151]
 s_add_u32 m0, s29, 61440
 v_cvt_pk_bf16_f32 v114, v116, v117
 v_cvt_pk_bf16_f32 v115, v118, v119
 v_mfma_f32_16x16x32_bf16 v[148:151], a[44:47], a[76:79], v[148:151]
 buffer_load_dwordx4 v2, s[16:19], s54 offen lds
 v_mfma_f32_16x16x32_bf16 v[156:159], a[44:47], a[68:71], v[156:159]
 v_cvt_pk_bf16_f32 v120, v120, v121
 v_cvt_pk_bf16_f32 v121, v122, v123
 v_mfma_f32_16x16x32_bf16 v[156:159], a[40:43], a[64:67], v[156:159]
 v_cvt_pk_bf16_f32 v122, v124, v125
 v_cvt_pk_bf16_f32 v123, v126, v127
 v_mfma_f32_16x16x32_bf16 v[184:187], a[48:51], a[64:67], v[184:187]
 s_add_u32 m0, s29, 98304
 v_add_u32 v2, 0x80000, v2
 v_mfma_f32_16x16x32_bf16 v[184:187], a[52:55], a[68:71], v[184:187]
 buffer_load_dwordx4 v2, s[16:19], 0 offen lds
 v_mfma_f32_16x16x32_bf16 v[176:179], a[52:55], a[76:79], v[176:179]
 s_add_u32 s59, s56, 32768
 v_cvt_pk_bf16_f32 v128, v128, v129
 v_cvt_pk_bf16_f32 v129, v130, v131
 v_mfma_f32_16x16x32_bf16 v[176:179], a[48:51], a[72:75], v[176:179]
 buffer_store_dwordx4 v[56:59], v1, s[12:15], s59 offen offset:1024 sc1
 v_mfma_f32_16x16x32_bf16 v[168:171], a[48:51], a[80:83], v[168:171]
 v_cvt_pk_bf16_f32 v130, v132, v133
 v_cvt_pk_bf16_f32 v131, v134, v135
 v_mfma_f32_16x16x32_bf16 v[168:171], a[52:55], a[84:87], v[168:171]
 s_add_u32 m0, s29, 102400
 v_cvt_pk_bf16_f32 v136, v136, v137
 v_cvt_pk_bf16_f32 v137, v138, v139
 v_mfma_f32_16x16x32_bf16 v[160:163], a[52:55], a[92:95], v[160:163]
 buffer_load_dwordx4 v2, s[16:19], s48 offen lds
 v_mfma_f32_16x16x32_bf16 v[160:163], a[48:51], a[88:91], v[160:163]
 v_cvt_pk_bf16_f32 v138, v140, v141
 v_cvt_pk_bf16_f32 v139, v142, v143
 v_mfma_f32_16x16x32_bf16 v[164:167], a[56:59], a[88:91], v[164:167]
 v_cvt_pk_bf16_f32 v144, v144, v145
 v_cvt_pk_bf16_f32 v145, v146, v147
 v_mfma_f32_16x16x32_bf16 v[164:167], a[60:63], a[92:95], v[164:167]
 v_cvt_pk_bf16_f32 v146, v148, v149
 v_cvt_pk_bf16_f32 v147, v150, v151
 v_mfma_f32_16x16x32_bf16 v[172:175], a[60:63], a[84:87], v[172:175]
 s_add_u32 m0, s29, 106496
 v_cvt_pk_bf16_f32 v152, v152, v153
 v_cvt_pk_bf16_f32 v153, v154, v155
 v_mfma_f32_16x16x32_bf16 v[172:175], a[56:59], a[80:83], v[172:175]
 buffer_load_dwordx4 v2, s[16:19], s49 offen lds
 v_mfma_f32_16x16x32_bf16 v[180:183], a[56:59], a[72:75], v[180:183]
 s_add_u32 s59, s56, 24576
 v_cvt_pk_bf16_f32 v154, v156, v157
 v_cvt_pk_bf16_f32 v155, v158, v159
 v_mfma_f32_16x16x32_bf16 v[180:183], a[60:63], a[76:79], v[180:183]
 buffer_store_dwordx4 v[64:67], v1, s[12:15], s59 offen offset:0 sc1
 v_mfma_f32_16x16x32_bf16 v[188:191], a[60:63], a[68:71], v[188:191]
 v_mfma_f32_16x16x32_bf16 v[188:191], a[56:59], a[64:67], v[188:191]
 s_add_u32 m0, s29, 110592
 v_mfma_f32_16x16x32_bf16 v[216:219], a[32:35], a[96:99], v[216:219]
 buffer_load_dwordx4 v2, s[16:19], s50 offen lds
 v_mfma_f32_16x16x32_bf16 v[216:219], a[36:39], a[100:103], v[216:219]
 v_cvt_pk_bf16_f32 v160, v160, v161
 v_cvt_pk_bf16_f32 v161, v162, v163
 v_mfma_f32_16x16x32_bf16 v[208:211], a[36:39], a[108:111], v[208:211]
 v_cvt_pk_bf16_f32 v162, v164, v165
 v_cvt_pk_bf16_f32 v163, v166, v167
 v_mfma_f32_16x16x32_bf16 v[208:211], a[32:35], a[104:107], v[208:211]
 v_cvt_pk_bf16_f32 v168, v168, v169
 v_cvt_pk_bf16_f32 v169, v170, v171
 v_mfma_f32_16x16x32_bf16 v[200:203], a[32:35], a[112:115], v[200:203]
 s_add_u32 m0, s29, 114688
 v_cvt_pk_bf16_f32 v170, v172, v173
 v_cvt_pk_bf16_f32 v171, v174, v175
 v_mfma_f32_16x16x32_bf16 v[200:203], a[36:39], a[116:119], v[200:203]
 buffer_load_dwordx4 v2, s[16:19], s51 offen lds
 v_mfma_f32_16x16x32_bf16 v[192:195], a[36:39], a[124:127], v[192:195]
 s_add_u32 s59, s56, 16384
 v_cvt_pk_bf16_f32 v176, v176, v177
 v_cvt_pk_bf16_f32 v177, v178, v179
 v_mfma_f32_16x16x32_bf16 v[192:195], a[32:35], a[120:123], v[192:195]
 buffer_store_dwordx4 v[72:75], v1, s[12:15], s59 offen offset:0 sc1
 v_mfma_f32_16x16x32_bf16 v[196:199], a[40:43], a[120:123], v[196:199]
 v_cvt_pk_bf16_f32 v178, v180, v181
 v_cvt_pk_bf16_f32 v179, v182, v183
 v_mfma_f32_16x16x32_bf16 v[196:199], a[44:47], a[124:127], v[196:199]
 s_add_u32 m0, s29, 118784
 v_cvt_pk_bf16_f32 v184, v184, v185
 v_cvt_pk_bf16_f32 v185, v186, v187
 v_mfma_f32_16x16x32_bf16 v[204:207], a[44:47], a[116:119], v[204:207]
 buffer_load_dwordx4 v2, s[16:19], s52 offen lds
 v_mfma_f32_16x16x32_bf16 v[204:207], a[40:43], a[112:115], v[204:207]
 v_cvt_pk_bf16_f32 v186, v188, v189
 v_cvt_pk_bf16_f32 v187, v190, v191
 v_mfma_f32_16x16x32_bf16 v[212:215], a[40:43], a[104:107], v[212:215]
 v_mfma_f32_16x16x32_bf16 v[212:215], a[44:47], a[108:111], v[212:215]
 v_mfma_f32_16x16x32_bf16 v[220:223], a[44:47], a[100:103], v[220:223]
 s_add_u32 m0, s29, 122880
 v_mfma_f32_16x16x32_bf16 v[220:223], a[40:43], a[96:99], v[220:223]
 buffer_load_dwordx4 v2, s[16:19], s53 offen lds
 v_mfma_f32_16x16x32_bf16 v[248:251], a[48:51], a[96:99], v[248:251]
 s_add_u32 s59, s56, 8192
 v_mfma_f32_16x16x32_bf16 v[248:251], a[52:55], a[100:103], v[248:251]
 s_waitcnt vmcnt(25)
 buffer_store_dwordx4 v[80:83], v1, s[12:15], s59 offen offset:0 sc1
 v_mfma_f32_16x16x32_bf16 v[240:243], a[52:55], a[108:111], v[240:243]
 s_barrier
 v_xor_b32 v7, 0, v6
 v_cvt_pk_bf16_f32 v192, v192, v193
 v_mfma_f32_16x16x32_bf16 v[240:243], a[48:51], a[104:107], v[240:243]
 s_add_u32 m0, s29, 126976
 ds_read_b64_tr_b16 a[64:65], v7 offset:0
 v_cvt_pk_bf16_f32 v193, v194, v195
 v_mfma_f32_16x16x32_bf16 v[232:235], a[48:51], a[112:115], v[232:235]
 ds_read_b64_tr_b16 a[66:67], v7 offset:4096
 buffer_load_dwordx4 v2, s[16:19], s54 offen lds
 v_mfma_f32_16x16x32_bf16 v[232:235], a[52:55], a[116:119], v[232:235]
 ds_read_b64_tr_b16 a[68:69], v7 offset:16384
 v_cvt_pk_bf16_f32 v194, v196, v197
 v_mfma_f32_16x16x32_bf16 v[224:227], a[52:55], a[124:127], v[224:227]
 ds_read_b64_tr_b16 a[70:71], v7 offset:20480
 v_xor_b32 v8, 65536, v6
 v_mfma_f32_16x16x32_bf16 v[224:227], a[48:51], a[120:123], v[224:227]
 s_add_u32 s59, s56, 0
 ds_read_b64_tr_b16 a[72:73], v8 offset:0
 v_cvt_pk_bf16_f32 v195, v198, v199
 v_mfma_f32_16x16x32_bf16 v[228:231], a[56:59], a[120:123], v[228:231]
 ds_read_b64_tr_b16 a[74:75], v8 offset:4096
 buffer_store_dwordx4 v[88:91], v1, s[12:15], s59 offen offset:0 sc1
 v_mfma_f32_16x16x32_bf16 v[228:231], a[60:63], a[124:127], v[228:231]
 ds_read_b64_tr_b16 a[76:77], v8 offset:16384
 v_cvt_pk_bf16_f32 v200, v200, v201
 v_mfma_f32_16x16x32_bf16 v[236:239], a[60:63], a[116:119], v[236:239]
 ds_read_b64_tr_b16 a[78:79], v8 offset:20480
 v_xor_b32 v9, 32, v6
 v_mfma_f32_16x16x32_bf16 v[236:239], a[56:59], a[112:115], v[236:239]
 ds_read_b64_tr_b16 a[80:81], v9 offset:0
 v_cvt_pk_bf16_f32 v201, v202, v203
 v_mfma_f32_16x16x32_bf16 v[244:247], a[56:59], a[104:107], v[244:247]
 ds_read_b64_tr_b16 a[82:83], v9 offset:4096
 v_cvt_pk_bf16_f32 v202, v204, v205
 v_mfma_f32_16x16x32_bf16 v[244:247], a[60:63], a[108:111], v[244:247]
 ds_read_b64_tr_b16 a[84:85], v9 offset:16384
 v_cvt_pk_bf16_f32 v203, v206, v207
 v_mfma_f32_16x16x32_bf16 v[252:255], a[60:63], a[100:103], v[252:255]
 s_add_u32 s59, s56, 24576
 ds_read_b64_tr_b16 a[86:87], v9 offset:20480
 v_xor_b32 v10, 65568, v6
 v_mfma_f32_16x16x32_bf16 v[252:255], a[56:59], a[96:99], v[252:255]
 s_waitcnt lgkmcnt(6)
 ds_read_b64_tr_b16 a[88:89], v10 offset:0
 buffer_store_dwordx4 v[96:99], v1, s[12:15], s59 offen offset:1024 sc1
 v_mfma_f32_16x16x32_bf16 v[28:31], a[64:67], a[128:131], 0
 ds_read_b64_tr_b16 a[90:91], v10 offset:4096
 v_cvt_pk_bf16_f32 v208, v208, v209
 v_mfma_f32_16x16x32_bf16 v[28:31], a[68:71], a[136:139], v[28:31]
 ds_read_b64_tr_b16 a[92:93], v10 offset:16384
 v_xor_b32 v7, 64, v6
 v_mfma_f32_16x16x32_bf16 v[28:31], a[72:75], a[144:147], v[28:31]
 s_waitcnt lgkmcnt(7)
 ds_read_b128 a[112:115], v14 offset:0
 ds_read_b64_tr_b16 a[94:95], v10 offset:20480
 v_mfma_f32_16x16x32_bf16 v[28:31], a[76:79], a[152:155], v[28:31]
 ds_read_b64_tr_b16 a[96:97], v7 offset:0
 v_cvt_pk_bf16_f32 v209, v210, v211
 v_mfma_f32_16x16x32_bf16 v[44:47], a[64:67], a[132:135], 0
 ds_read_b128 a[120:123], v3 offset:0
 ds_read_b64_tr_b16 a[98:99], v7 offset:4096
 v_mfma_f32_16x16x32_bf16 v[44:47], a[68:71], a[140:143], v[44:47]
 s_add_u32 s59, s56, 16384
 ds_read_b64_tr_b16 a[100:101], v7 offset:16384
 v_xor_b32 v8, 65600, v6
 v_mfma_f32_16x16x32_bf16 v[44:47], a[72:75], a[148:151], v[44:47]
 ds_read_b128 a[116:119], v14 offset:2048
 ds_read_b64_tr_b16 a[102:103], v7 offset:20480
 buffer_store_dwordx4 v[104:107], v1, s[12:15], s59 offen offset:1024 sc1
 v_mfma_f32_16x16x32_bf16 v[44:47], a[76:79], a[156:159], v[44:47]
 s_waitcnt lgkmcnt(9)
 ds_read_b64_tr_b16 a[104:105], v8 offset:0
 v_cvt_pk_bf16_f32 v210, v212, v213
 v_mfma_f32_16x16x32_bf16 v[52:55], a[80:83], a[128:131], 0
 ds_read_b128 a[124:127], v3 offset:2048
 ds_read_b64_tr_b16 a[106:107], v8 offset:4096
 v_mfma_f32_16x16x32_bf16 v[52:55], a[84:87], a[136:139], v[52:55]
 ds_read_b64_tr_b16 a[108:109], v8 offset:16384
 v_cvt_pk_bf16_f32 v211, v214, v215
 v_mfma_f32_16x16x32_bf16 v[52:55], a[88:91], a[144:147], v[52:55]
 s_waitcnt lgkmcnt(10)
 ds_read_b64_tr_b16 a[110:111], v8 offset:20480
 v_xor_b32 v9, 96, v6
 v_mfma_f32_16x16x32_bf16 v[52:55], a[92:95], a[152:155], v[52:55]
 ds_read_b64_tr_b16 a[64:65], v9 offset:0
 v_cvt_pk_bf16_f32 v216, v216, v217
 v_mfma_f32_16x16x32_bf16 v[60:63], a[80:83], a[132:135], 0
 s_add_u32 s59, s56, 8192
 ds_read_b64_tr_b16 a[66:67], v9 offset:4096
 v_cvt_pk_bf16_f32 v217, v218, v219
 v_mfma_f32_16x16x32_bf16 v[60:63], a[84:87], a[140:143], v[60:63]
 ds_read_b64_tr_b16 a[68:69], v9 offset:16384
 buffer_store_dwordx4 v[112:115], v1, s[12:15], s59 offen offset:1024 sc1
 v_mfma_f32_16x16x32_bf16 v[60:63], a[88:91], a[148:151], v[60:63]
 ds_read_b64_tr_b16 a[70:71], v9 offset:20480
 v_xor_b32 v10, 65632, v6
 v_mfma_f32_16x16x32_bf16 v[60:63], a[92:95], a[156:159], v[60:63]
 s_waitcnt lgkmcnt(6)
 ds_read_b64_tr_b16 a[72:73], v10 offset:0
 v_cvt_pk_bf16_f32 v218, v220, v221
 v_mfma_f32_16x16x32_bf16 v[20:23], a[96:99], a[128:131], 0
 ds_read_b64_tr_b16 a[74:75], v10 offset:4096
 v_cvt_pk_bf16_f32 v219, v222, v223
 v_mfma_f32_16x16x32_bf16 v[20:23], a[100:103], a[136:139], v[20:23]
 s_waitcnt lgkmcnt(8)
 ds_read_b64_tr_b16 a[76:77], v10 offset:16384
 v_xor_b32 v7, 128, v6
 v_mfma_f32_16x16x32_bf16 v[20:23], a[104:107], a[144:147], v[20:23]
 s_waitcnt lgkmcnt(7)
 s_barrier
 ds_read_b64_tr_b16 a[78:79], v10 offset:20480
 v_mfma_f32_16x16x32_bf16 v[20:23], a[108:111], a[152:155], v[20:23]
 s_add_u32 m0, s29, 131072
 ds_read_b64_tr_b16 a[80:81], v7 offset:0
 v_add_u32 v2, 0x80000, v2
 v_mfma_f32_16x16x32_bf16 v[36:39], a[96:99], a[132:135], 0
 ds_read_b64_tr_b16 a[82:83], v7 offset:4096
 buffer_load_dwordx4 v2, s[16:19], 0 offen lds
 v_mfma_f32_16x16x32_bf16 v[36:39], a[100:103], a[140:143], v[36:39]
 ds_read_b64_tr_b16 a[84:85], v7 offset:16384
 v_cvt_pk_bf16_f32 v224, v224, v225
 v_mfma_f32_16x16x32_bf16 v[36:39], a[104:107], a[148:151], v[36:39]
 s_add_u32 s59, s56, 0
 ds_read_b64_tr_b16 a[86:87], v7 offset:20480
 v_xor_b32 v8, 65664, v6
 v_mfma_f32_16x16x32_bf16 v[36:39], a[108:111], a[156:159], v[36:39]
 s_waitcnt lgkmcnt(6)
 ds_read_b64_tr_b16 a[88:89], v8 offset:0
 buffer_store_dwordx4 v[120:123], v1, s[12:15], s59 offen offset:1024 sc1
 v_mfma_f32_16x16x32_bf16 v[68:71], a[64:67], a[128:131], 0
 ds_read_b64_tr_b16 a[90:91], v8 offset:4096
 v_cvt_pk_bf16_f32 v225, v226, v227
 v_mfma_f32_16x16x32_bf16 v[68:71], a[68:71], a[136:139], v[68:71]
 s_add_u32 m0, s29, 135168
 ds_read_b64_tr_b16 a[92:93], v8 offset:16384
 v_cvt_pk_bf16_f32 v226, v228, v229
 v_mfma_f32_16x16x32_bf16 v[68:71], a[72:75], a[144:147], v[68:71]
 s_waitcnt lgkmcnt(7)
 ds_read_b64_tr_b16 a[94:95], v8 offset:20480
 v_xor_b32 v9, 160, v6
 v_mfma_f32_16x16x32_bf16 v[68:71], a[76:79], a[152:155], v[68:71]
 ds_read_b64_tr_b16 a[96:97], v9 offset:0
 buffer_load_dwordx4 v2, s[16:19], s48 offen lds
 v_mfma_f32_16x16x32_bf16 v[76:79], a[64:67], a[132:135], 0
 ds_read_b64_tr_b16 a[98:99], v9 offset:4096
 v_cvt_pk_bf16_f32 v227, v230, v231
 v_mfma_f32_16x16x32_bf16 v[76:79], a[68:71], a[140:143], v[76:79]
 ds_read_b64_tr_b16 a[100:101], v9 offset:16384
 v_cvt_pk_bf16_f32 v232, v232, v233
 v_mfma_f32_16x16x32_bf16 v[76:79], a[72:75], a[148:151], v[76:79]
 s_add_u32 s59, s56, 24576
 ds_read_b64_tr_b16 a[102:103], v9 offset:20480
 v_xor_b32 v10, 65696, v6
 v_mfma_f32_16x16x32_bf16 v[76:79], a[76:79], a[156:159], v[76:79]
 s_waitcnt lgkmcnt(6)
 ds_read_b64_tr_b16 a[104:105], v10 offset:0
 buffer_store_dwordx4 v[128:131], v1, s[12:15], s59 offen offset:2048 sc1
 v_mfma_f32_16x16x32_bf16 v[84:87], a[80:83], a[128:131], 0
 s_add_u32 m0, s29, 139264
 ds_read_b64_tr_b16 a[106:107], v10 offset:4096
 v_cvt_pk_bf16_f32 v233, v234, v235
 v_mfma_f32_16x16x32_bf16 v[84:87], a[84:87], a[136:139], v[84:87]
 ds_read_b64_tr_b16 a[108:109], v10 offset:16384
 buffer_load_dwordx4 v2, s[16:19], s49 offen lds
 v_mfma_f32_16x16x32_bf16 v[84:87], a[88:91], a[144:147], v[84:87]
 s_waitcnt lgkmcnt(7)
 ds_read_b64_tr_b16 a[110:111], v10 offset:20480
 v_xor_b32 v7, 192, v6
 v_mfma_f32_16x16x32_bf16 v[84:87], a[92:95], a[152:155], v[84:87]
 ds_read_b64_tr_b16 a[64:65], v7 offset:0
 v_cvt_pk_bf16_f32 v234, v236, v237
 v_mfma_f32_16x16x32_bf16 v[92:95], a[80:83], a[132:135], 0
 ds_read_b64_tr_b16 a[66:67], v7 offset:4096
 v_cvt_pk_bf16_f32 v235, v238, v239
 v_mfma_f32_16x16x32_bf16 v[92:95], a[84:87], a[140:143], v[92:95]
 ds_read_b64_tr_b16 a[68:69], v7 offset:16384
 v_cvt_pk_bf16_f32 v240, v240, v241
 v_mfma_f32_16x16x32_bf16 v[92:95], a[88:91], a[148:151], v[92:95]
 s_add_u32 m0, s29, 143360
 ds_read_b64_tr_b16 a[70:71], v7 offset:20480
 v_xor_b32 v8, 65728, v6
 v_mfma_f32_16x16x32_bf16 v[92:95], a[92:95], a[156:159], v[92:95]
 s_waitcnt lgkmcnt(6)
 ds_read_b64_tr_b16 a[72:73], v8 offset:0
 buffer_load_dwordx4 v2, s[16:19], s50 offen lds
 v_mfma_f32_16x16x32_bf16 v[100:103], a[96:99], a[128:131], 0
 s_add_u32 s59, s56, 16384
 ds_read_b64_tr_b16 a[74:75], v8 offset:4096
 v_cvt_pk_bf16_f32 v241, v242, v243
 v_mfma_f32_16x16x32_bf16 v[100:103], a[100:103], a[136:139], v[100:103]
 ds_read_b64_tr_b16 a[76:77], v8 offset:16384
 buffer_store_dwordx4 v[136:139], v1, s[12:15], s59 offen offset:2048 sc1
 v_mfma_f32_16x16x32_bf16 v[100:103], a[104:107], a[144:147], v[100:103]
 s_waitcnt lgkmcnt(7)
 ds_read_b64_tr_b16 a[78:79], v8 offset:20480
 v_xor_b32 v9, 224, v6
 v_mfma_f32_16x16x32_bf16 v[100:103], a[108:111], a[152:155], v[100:103]
 s_and_b32 s36, s95, 31
 ds_read_b64_tr_b16 a[80:81], v9 offset:0
 v_cvt_pk_bf16_f32 v242, v244, v245
 v_mfma_f32_16x16x32_bf16 v[108:111], a[96:99], a[132:135], 0
 s_add_u32 m0, s29, 147456
 ds_read_b64_tr_b16 a[82:83], v9 offset:4096
 v_cvt_pk_bf16_f32 v243, v246, v247
 v_mfma_f32_16x16x32_bf16 v[108:111], a[100:103], a[140:143], v[108:111]
 ds_read_b64_tr_b16 a[84:85], v9 offset:16384
 buffer_load_dwordx4 v2, s[16:19], s51 offen lds
 v_mfma_f32_16x16x32_bf16 v[108:111], a[104:107], a[148:151], v[108:111]
 s_add_u32 s59, s56, 8192
 ds_read_b64_tr_b16 a[86:87], v9 offset:20480
 v_xor_b32 v10, 65760, v6
 v_mfma_f32_16x16x32_bf16 v[108:111], a[108:111], a[156:159], v[108:111]
 s_waitcnt lgkmcnt(6)
 ds_read_b64_tr_b16 a[88:89], v10 offset:0
 v_cvt_pk_bf16_f32 v248, v248, v249
 v_mfma_f32_16x16x32_bf16 v[116:119], a[64:67], a[128:131], 0
 ds_read_b64_tr_b16 a[90:91], v10 offset:4096
 buffer_store_dwordx4 v[144:147], v1, s[12:15], s59 offen offset:2048 sc1
 v_mfma_f32_16x16x32_bf16 v[116:119], a[68:71], a[136:139], v[116:119]
 s_add_u32 m0, s29, 151552
 ds_read_b64_tr_b16 a[92:93], v10 offset:16384
 v_cvt_pk_bf16_f32 v249, v250, v251
 v_mfma_f32_16x16x32_bf16 v[116:119], a[72:75], a[144:147], v[116:119]
 s_waitcnt lgkmcnt(7)
 ds_read_b64_tr_b16 a[94:95], v10 offset:20480
 v_xor_b32 v7, 256, v6
 v_mfma_f32_16x16x32_bf16 v[116:119], a[76:79], a[152:155], v[116:119]
 ds_read_b64_tr_b16 a[96:97], v7 offset:0
 buffer_load_dwordx4 v2, s[16:19], s52 offen lds
 v_mfma_f32_16x16x32_bf16 v[124:127], a[64:67], a[132:135], 0
 s_lshr_b32 s37, s95, 5
 ds_read_b64_tr_b16 a[98:99], v7 offset:4096
 v_cvt_pk_bf16_f32 v250, v252, v253
 v_mfma_f32_16x16x32_bf16 v[124:127], a[68:71], a[140:143], v[124:127]
 s_lshl_b32 s38, s3, 4
 ds_read_b64_tr_b16 a[100:101], v7 offset:16384
 v_cvt_pk_bf16_f32 v251, v254, v255
 v_mfma_f32_16x16x32_bf16 v[124:127], a[72:75], a[148:151], v[124:127]
 s_add_u32 s59, s56, 0
 ds_read_b64_tr_b16 a[102:103], v7 offset:20480
 v_xor_b32 v8, 65792, v6
 v_mfma_f32_16x16x32_bf16 v[124:127], a[76:79], a[156:159], v[124:127]
 s_waitcnt lgkmcnt(6)
 ds_read_b64_tr_b16 a[104:105], v8 offset:0
 buffer_store_dwordx4 v[152:155], v1, s[12:15], s59 offen offset:2048 sc1
 v_mfma_f32_16x16x32_bf16 v[132:135], a[80:83], a[128:131], 0
 s_add_u32 m0, s29, 155648
 ds_read_b64_tr_b16 a[106:107], v8 offset:4096
 v_accvgpr_read_b32 v11, a245
 v_mfma_f32_16x16x32_bf16 v[132:135], a[84:87], a[136:139], v[132:135]
 ds_read_b64_tr_b16 a[108:109], v8 offset:16384
 buffer_load_dwordx4 v2, s[16:19], s53 offen lds
 v_mfma_f32_16x16x32_bf16 v[132:135], a[88:91], a[144:147], v[132:135]
 s_waitcnt lgkmcnt(7)
 ds_read_b64_tr_b16 a[110:111], v8 offset:20480
 v_xor_b32 v9, 288, v6
 v_mfma_f32_16x16x32_bf16 v[132:135], a[92:95], a[152:155], v[132:135]
 s_lshl_b32 s39, s36, 6
 ds_read_b64_tr_b16 a[64:65], v9 offset:0
 v_mov_b32 v12, 0
 v_mfma_f32_16x16x32_bf16 v[140:143], a[80:83], a[132:135], 0
 ds_read_b64_tr_b16 a[66:67], v9 offset:4096
 global_load_dword v5, v12, s[90:91] offset:128 sc1
 v_mfma_f32_16x16x32_bf16 v[140:143], a[84:87], a[140:143], v[140:143]
 s_add_u32 s38, s38, s39
 ds_read_b64_tr_b16 a[68:69], v9 offset:16384
 v_and_b32 v12, 11, v0
 v_mfma_f32_16x16x32_bf16 v[140:143], a[88:91], a[148:151], v[140:143]
 s_add_u32 m0, s29, 159744
 ds_read_b64_tr_b16 a[70:71], v9 offset:20480
 v_xor_b32 v10, 65824, v6
 v_mfma_f32_16x16x32_bf16 v[140:143], a[92:95], a[156:159], v[140:143]
 s_waitcnt lgkmcnt(6)
 ds_read_b64_tr_b16 a[72:73], v10 offset:0
 buffer_load_dwordx4 v2, s[16:19], s54 offen lds
 v_mfma_f32_16x16x32_bf16 v[148:151], a[96:99], a[128:131], 0
 s_add_u32 s59, s56, 24576
 ds_read_b64_tr_b16 a[74:75], v10 offset:4096
 v_lshlrev_b32 v12, 2, v12
 v_mfma_f32_16x16x32_bf16 v[148:151], a[100:103], a[136:139], v[148:151]
 ds_read_b64_tr_b16 a[76:77], v10 offset:16384
 buffer_store_dwordx4 v[160:163], v1, s[12:15], s59 offen offset:3072 sc1
 v_mfma_f32_16x16x32_bf16 v[148:151], a[104:107], a[144:147], v[148:151]
 s_waitcnt lgkmcnt(7)
 ds_read_b64_tr_b16 a[78:79], v10 offset:20480
 v_xor_b32 v7, 320, v6
 v_mfma_f32_16x16x32_bf16 v[148:151], a[108:111], a[152:155], v[148:151]
 s_mul_i32 s38, s38, 896
 ds_read_b64_tr_b16 a[80:81], v7 offset:0
 v_and_b32 v14, 15, v0
 v_mfma_f32_16x16x32_bf16 v[156:159], a[96:99], a[132:135], 0
 s_lshl_b32 s39, s37, 7
 ds_read_b64_tr_b16 a[82:83], v7 offset:4096
 v_lshrrev_b32 v3, 4, v0
 v_mfma_f32_16x16x32_bf16 v[156:159], a[100:103], a[140:143], v[156:159]
 s_add_u32 s38, s38, s39
 ds_read_b64_tr_b16 a[84:85], v7 offset:16384
 v_lshlrev_b32 v3, 2, v3
 v_mfma_f32_16x16x32_bf16 v[156:159], a[104:107], a[148:151], v[156:159]
 s_add_u32 s59, s56, 16384
 ds_read_b64_tr_b16 a[86:87], v7 offset:20480
 v_xor_b32 v8, 65856, v6
 v_mfma_f32_16x16x32_bf16 v[156:159], a[108:111], a[156:159], v[156:159]
 s_waitcnt lgkmcnt(6)
 ds_read_b64_tr_b16 a[88:89], v8 offset:0
 v_sub_u32 v14, v14, v3
 v_mfma_f32_16x16x32_bf16 v[164:167], a[64:67], a[128:131], 0
 ds_read_b64_tr_b16 a[90:91], v8 offset:4096
 buffer_store_dwordx4 v[168:171], v1, s[12:15], s59 offen offset:3072 sc1
 v_mfma_f32_16x16x32_bf16 v[164:167], a[68:71], a[136:139], v[164:167]
 s_lshl_b32 s39, s37, 9
 ds_read_b64_tr_b16 a[92:93], v8 offset:16384
 v_lshrrev_b32_e64 v3, 6, s29
 v_mfma_f32_16x16x32_bf16 v[164:167], a[72:75], a[144:147], v[164:167]
 s_waitcnt lgkmcnt(7)
 ds_read_b64_tr_b16 a[94:95], v8 offset:20480
 v_xor_b32 v9, 352, v6
 v_mfma_f32_16x16x32_bf16 v[164:167], a[76:79], a[152:155], v[164:167]
 s_mov_b32 s4, s66
 ds_read_b64_tr_b16 a[96:97], v9 offset:0
 v_add_u32 v14, v3, v14
 v_mfma_f32_16x16x32_bf16 v[172:175], a[64:67], a[132:135], 0
 s_mov_b32 s5, s67
 ds_read_b64_tr_b16 a[98:99], v9 offset:4096
 v_mov_b32 v15, 0xf149f2ca
 v_mfma_f32_16x16x32_bf16 v[172:175], a[68:71], a[140:143], v[172:175]
 s_mov_b32 s6, 1835008
 ds_read_b64_tr_b16 a[100:101], v9 offset:16384
 v_cmp_gt_i32 vcc, 0, v14
 v_mfma_f32_16x16x32_bf16 v[172:175], a[72:75], a[148:151], v[172:175]
 s_add_u32 s59, s56, 8192
 ds_read_b64_tr_b16 a[102:103], v9 offset:20480
 v_xor_b32 v10, 65888, v6
 v_mfma_f32_16x16x32_bf16 v[172:175], a[76:79], a[156:159], v[172:175]
 s_waitcnt lgkmcnt(6)
 ds_read_b64_tr_b16 a[104:105], v10 offset:0
 buffer_store_dwordx4 v[176:179], v1, s[12:15], s59 offen offset:3072 sc1
 v_mfma_f32_16x16x32_bf16 v[180:183], a[80:83], a[128:131], 0
 s_mov_b32 s7, 0x20000
 ds_read_b64_tr_b16 a[106:107], v10 offset:4096
 v_cndmask_b32 v3, 0, v15, vcc
 v_mfma_f32_16x16x32_bf16 v[180:183], a[84:87], a[136:139], v[180:183]
 s_mov_b32 s8, s68
 ds_read_b64_tr_b16 a[108:109], v10 offset:16384
 v_accvgpr_write_b32 a224, v3
 v_mfma_f32_16x16x32_bf16 v[180:183], a[88:91], a[144:147], v[180:183]
 s_waitcnt lgkmcnt(7)
 ds_read_b64_tr_b16 a[110:111], v10 offset:20480
 v_xor_b32 v7, 384, v6
 v_mfma_f32_16x16x32_bf16 v[180:183], a[92:95], a[152:155], v[180:183]
 s_mov_b32 s9, s69
 ds_read_b64_tr_b16 a[64:65], v7 offset:0
 v_cmp_gt_i32 vcc, 1, v14
 v_mfma_f32_16x16x32_bf16 v[188:191], a[80:83], a[132:135], 0
 s_mov_b32 s10, 1835008
 ds_read_b64_tr_b16 a[66:67], v7 offset:4096
 v_cndmask_b32 v3, 0, v15, vcc
 v_mfma_f32_16x16x32_bf16 v[188:191], a[84:87], a[140:143], v[188:191]
 s_mov_b32 s11, 0x20000
 ds_read_b64_tr_b16 a[68:69], v7 offset:16384
 v_accvgpr_write_b32 a225, v3
 v_mfma_f32_16x16x32_bf16 v[188:191], a[88:91], a[148:151], v[188:191]
 s_add_u32 s59, s56, 0
 ds_read_b64_tr_b16 a[70:71], v7 offset:20480
 v_xor_b32 v8, 65920, v6
 v_mfma_f32_16x16x32_bf16 v[188:191], a[92:95], a[156:159], v[188:191]
 s_waitcnt lgkmcnt(6)
 ds_read_b64_tr_b16 a[72:73], v8 offset:0
 buffer_store_dwordx4 v[184:187], v1, s[12:15], s59 offen offset:3072 sc1
 v_mfma_f32_16x16x32_bf16 v[196:199], a[96:99], a[128:131], 0
 s_mov_b32 s20, s70
 ds_read_b64_tr_b16 a[74:75], v8 offset:4096
 v_cmp_gt_i32 vcc, 2, v14
 v_mfma_f32_16x16x32_bf16 v[196:199], a[100:103], a[136:139], v[196:199]
 s_mov_b32 s21, s71
 ds_read_b64_tr_b16 a[76:77], v8 offset:16384
 v_cndmask_b32 v3, 0, v15, vcc
 v_mfma_f32_16x16x32_bf16 v[196:199], a[104:107], a[144:147], v[196:199]
 s_waitcnt lgkmcnt(7)
 ds_read_b64_tr_b16 a[78:79], v8 offset:20480
 v_xor_b32 v9, 416, v6
 v_mfma_f32_16x16x32_bf16 v[196:199], a[108:111], a[152:155], v[196:199]
 s_mov_b32 s22, 3584
 ds_read_b64_tr_b16 a[80:81], v9 offset:0
 v_accvgpr_write_b32 a226, v3
 v_mfma_f32_16x16x32_bf16 v[204:207], a[96:99], a[132:135], 0
 s_mov_b32 s23, 0x20000
 ds_read_b64_tr_b16 a[82:83], v9 offset:4096
 v_cmp_gt_i32 vcc, 3, v14
 v_mfma_f32_16x16x32_bf16 v[204:207], a[100:103], a[140:143], v[204:207]
 ds_read_b64_tr_b16 a[84:85], v9 offset:16384
 v_lshrrev_b32 v120, 3, v0
 v_mfma_f32_16x16x32_bf16 v[204:207], a[104:107], a[148:151], v[204:207]
 s_add_u32 s59, s56, 57344
 ds_read_b64_tr_b16 a[86:87], v9 offset:20480
 v_xor_b32 v10, 65952, v6
 v_mfma_f32_16x16x32_bf16 v[204:207], a[108:111], a[156:159], v[204:207]
 s_waitcnt lgkmcnt(6)
 ds_read_b64_tr_b16 a[88:89], v10 offset:0
 buffer_store_dwordx4 v[192:195], v1, s[12:15], s59 offen offset:2048 sc1
 v_mfma_f32_16x16x32_bf16 v[212:215], a[64:67], a[128:131], 0
 ds_read_b64_tr_b16 a[90:91], v10 offset:4096
 v_mul_u32_u24 v120, 1792, v120
 v_mfma_f32_16x16x32_bf16 v[212:215], a[68:71], a[136:139], v[212:215]
 ds_read_b64_tr_b16 a[92:93], v10 offset:16384
 v_and_b32 v121, 7, v0
 v_mfma_f32_16x16x32_bf16 v[212:215], a[72:75], a[144:147], v[212:215]
 s_waitcnt lgkmcnt(7)
 ds_read_b64_tr_b16 a[94:95], v10 offset:20480
 v_xor_b32 v7, 448, v6
 v_mfma_f32_16x16x32_bf16 v[212:215], a[76:79], a[152:155], v[212:215]
 ds_read_b64_tr_b16 a[96:97], v7 offset:0
 v_lshl_add_u32 v120, v121, 4, v120
 v_mfma_f32_16x16x32_bf16 v[220:223], a[64:67], a[132:135], 0
 ds_read_b64_tr_b16 a[98:99], v7 offset:4096
 v_add_u32 v120, s38, v120
 v_mfma_f32_16x16x32_bf16 v[220:223], a[68:71], a[140:143], v[220:223]
 ds_read_b64_tr_b16 a[100:101], v7 offset:16384
 v_lshlrev_b32 v121, 6, v121
 v_mfma_f32_16x16x32_bf16 v[220:223], a[72:75], a[148:151], v[220:223]
 s_add_u32 s59, s56, 49152
 ds_read_b64_tr_b16 a[102:103], v7 offset:20480
 v_xor_b32 v8, 65984, v6
 v_mfma_f32_16x16x32_bf16 v[220:223], a[76:79], a[156:159], v[220:223]
 s_waitcnt lgkmcnt(6)
 ds_read_b64_tr_b16 a[104:105], v8 offset:0
 buffer_store_dwordx4 v[200:203], v1, s[12:15], s59 offen offset:2048 sc1
 v_mfma_f32_16x16x32_bf16 v[228:231], a[80:83], a[128:131], 0
 ds_read_b64_tr_b16 a[106:107], v8 offset:4096
 v_subrev_u32 v122, 2688, v120
 v_mfma_f32_16x16x32_bf16 v[228:231], a[84:87], a[136:139], v[228:231]
 ds_read_b64_tr_b16 a[108:109], v8 offset:16384
 v_subrev_u32 v123, 1792, v120
 v_mfma_f32_16x16x32_bf16 v[228:231], a[88:91], a[144:147], v[228:231]
 s_waitcnt lgkmcnt(7)
 ds_read_b64_tr_b16 a[110:111], v8 offset:20480
 v_xor_b32 v9, 480, v6
 v_mfma_f32_16x16x32_bf16 v[228:231], a[92:95], a[152:155], v[228:231]
 ds_read_b64_tr_b16 a[64:65], v9 offset:0
 v_subrev_u32 v128, 896, v120
 v_mfma_f32_16x16x32_bf16 v[236:239], a[80:83], a[132:135], 0
 ds_read_b64_tr_b16 a[66:67], v9 offset:4096
 v_cndmask_b32 v3, 0, v15, vcc
 v_mfma_f32_16x16x32_bf16 v[236:239], a[84:87], a[140:143], v[236:239]
 ds_read_b64_tr_b16 a[68:69], v9 offset:16384
 v_accvgpr_write_b32 a227, v3
 v_mfma_f32_16x16x32_bf16 v[236:239], a[88:91], a[148:151], v[236:239]
 s_add_u32 s59, s56, 40960
 ds_read_b64_tr_b16 a[70:71], v9 offset:20480
 v_xor_b32 v10, 66016, v6
 v_mfma_f32_16x16x32_bf16 v[236:239], a[92:95], a[156:159], v[236:239]
 s_waitcnt lgkmcnt(6)
 ds_read_b64_tr_b16 a[72:73], v10 offset:0
 buffer_store_dwordx4 v[208:211], v1, s[12:15], s59 offen offset:2048 sc1
 v_mfma_f32_16x16x32_bf16 v[244:247], a[96:99], a[128:131], 0
 ds_read_b64_tr_b16 a[74:75], v10 offset:4096
 v_cmp_gt_i32 vcc, 16, v14
 v_mfma_f32_16x16x32_bf16 v[244:247], a[100:103], a[136:139], v[244:247]
 s_waitcnt vmcnt(25)
 ds_read_b64_tr_b16 a[76:77], v10 offset:16384
 v_xor_b32 v7, 32768, v6
 v_mfma_f32_16x16x32_bf16 v[244:247], a[104:107], a[144:147], v[244:247]
 s_waitcnt lgkmcnt(7)
 s_barrier
 ds_read_b64_tr_b16 a[78:79], v10 offset:20480
 v_mfma_f32_16x16x32_bf16 v[244:247], a[108:111], a[152:155], v[244:247]
 ds_read_b64_tr_b16 a[80:81], v7 offset:0
 v_cndmask_b32 v3, 0, v15, vcc
 v_mfma_f32_16x16x32_bf16 v[252:255], a[96:99], a[132:135], 0
 ds_read_b64_tr_b16 a[82:83], v7 offset:4096
 v_accvgpr_write_b32 a228, v3
 v_mfma_f32_16x16x32_bf16 v[252:255], a[100:103], a[140:143], v[252:255]
 ds_read_b64_tr_b16 a[84:85], v7 offset:16384
 v_cmp_gt_i32 vcc, 17, v14
 v_mfma_f32_16x16x32_bf16 v[252:255], a[104:107], a[148:151], v[252:255]
 s_add_u32 s59, s56, 32768
 ds_read_b64_tr_b16 a[86:87], v7 offset:20480
 v_xor_b32 v8, 98304, v6
 v_mfma_f32_16x16x32_bf16 v[252:255], a[108:111], a[156:159], v[252:255]
 s_waitcnt lgkmcnt(6)
 ds_read_b64_tr_b16 a[88:89], v8 offset:0
 buffer_store_dwordx4 v[216:219], v1, s[12:15], s59 offen offset:2048 sc1
 v_mfma_f32_16x16x32_bf16 v[16:19], a[64:67], a[128:131], 0
 ds_read_b64_tr_b16 a[90:91], v8 offset:4096
 v_cndmask_b32 v3, 0, v15, vcc
 v_mfma_f32_16x16x32_bf16 v[16:19], a[68:71], a[136:139], v[16:19]
 ds_read_b64_tr_b16 a[92:93], v8 offset:16384
 v_accvgpr_write_b32 a229, v3
 v_mfma_f32_16x16x32_bf16 v[16:19], a[72:75], a[144:147], v[16:19]
 s_waitcnt lgkmcnt(7)
 ds_read_b64_tr_b16 a[94:95], v8 offset:20480
 v_xor_b32 v9, 32800, v6
 v_mfma_f32_16x16x32_bf16 v[16:19], a[76:79], a[152:155], v[16:19]
 ds_read_b64_tr_b16 a[96:97], v9 offset:0
 v_cmp_gt_i32 vcc, 18, v14
 v_mfma_f32_16x16x32_bf16 v[24:27], a[64:67], a[132:135], 0
 s_waitcnt lgkmcnt(9)
 ds_read_b64_tr_b16 a[98:99], v9 offset:4096
 v_cndmask_b32 v3, 0, v15, vcc
 v_mfma_f32_16x16x32_bf16 v[24:27], a[68:71], a[140:143], v[24:27]
 s_barrier
 ds_read_b64_tr_b16 a[100:101], v9 offset:16384
 v_accvgpr_write_b32 a230, v3
 v_mfma_f32_16x16x32_bf16 v[24:27], a[72:75], a[148:151], v[24:27]
 s_add_u32 m0, s29, 0
 ds_read_b64_tr_b16 a[102:103], v9 offset:20480
 v_xor_b32 v10, 98336, v6
 v_mfma_f32_16x16x32_bf16 v[24:27], a[76:79], a[156:159], v[24:27]
 s_waitcnt lgkmcnt(6)
 ds_read_b64_tr_b16 a[104:105], v10 offset:0
 v_add_u32 v2, 0x80000, v2
 v_mfma_f32_16x16x32_bf16 v[28:31], a[80:83], a[160:163], v[28:31]
 ds_read_b64_tr_b16 a[106:107], v10 offset:4096
 buffer_load_dwordx4 v2, s[16:19], 0 offen lds
 v_mfma_f32_16x16x32_bf16 v[28:31], a[84:87], a[168:171], v[28:31]
 s_add_u32 s59, s56, 57344
 ds_read_b64_tr_b16 a[108:109], v10 offset:16384
 v_cmp_gt_i32 vcc, 19, v14
 v_mfma_f32_16x16x32_bf16 v[28:31], a[88:91], a[176:179], v[28:31]
 s_waitcnt lgkmcnt(7)
 ds_read_b64_tr_b16 a[110:111], v10 offset:20480
 v_xor_b32 v7, 32832, v6
 v_mfma_f32_16x16x32_bf16 v[28:31], a[92:95], a[184:187], v[28:31]
 ds_read_b64_tr_b16 a[64:65], v7 offset:0
 buffer_store_dwordx4 v[224:227], v1, s[12:15], s59 offen offset:3072 sc1
 v_mfma_f32_16x16x32_bf16 v[44:47], a[80:83], a[164:167], v[44:47]
 s_add_u32 m0, s29, 4096
 ds_read_b64_tr_b16 a[66:67], v7 offset:4096
 v_add_u32 v4, 4096, v1
 v_mfma_f32_16x16x32_bf16 v[44:47], a[84:87], a[172:175], v[44:47]
 ds_read_b64_tr_b16 a[68:69], v7 offset:16384
 buffer_load_dwordx4 v2, s[16:19], s48 offen lds
 v_mfma_f32_16x16x32_bf16 v[44:47], a[88:91], a[180:183], v[44:47]
 ds_read_b64_tr_b16 a[70:71], v7 offset:20480
 v_xor_b32 v8, 98368, v6
 v_mfma_f32_16x16x32_bf16 v[44:47], a[92:95], a[188:191], v[44:47]
 s_waitcnt lgkmcnt(6)
 ds_read_b64_tr_b16 a[72:73], v8 offset:0
 v_cndmask_b32 v3, 0, v15, vcc
 v_mfma_f32_16x16x32_bf16 v[52:55], a[96:99], a[160:163], v[52:55]
 ds_read_b64_tr_b16 a[74:75], v8 offset:4096
 v_accvgpr_write_b32 a231, v3
 v_mfma_f32_16x16x32_bf16 v[52:55], a[100:103], a[168:171], v[52:55]
 s_add_u32 m0, s29, 8192
 ds_read_b64_tr_b16 a[76:77], v8 offset:16384
 v_cmp_gt_i32 vcc, 32, v14
 v_mfma_f32_16x16x32_bf16 v[52:55], a[104:107], a[176:179], v[52:55]
 s_waitcnt lgkmcnt(7)
 ds_read_b64_tr_b16 a[78:79], v8 offset:20480
 v_xor_b32 v9, 32864, v6
 v_mfma_f32_16x16x32_bf16 v[52:55], a[108:111], a[184:187], v[52:55]
 ds_read_b64_tr_b16 a[80:81], v9 offset:0
 buffer_load_dwordx4 v2, s[16:19], s49 offen lds
 v_mfma_f32_16x16x32_bf16 v[60:63], a[96:99], a[164:167], v[60:63]
 s_add_u32 s59, s56, 49152
 ds_read_b64_tr_b16 a[82:83], v9 offset:4096
 v_cndmask_b32 v3, 0, v15, vcc
 v_mfma_f32_16x16x32_bf16 v[60:63], a[100:103], a[172:175], v[60:63]
 ds_read_b64_tr_b16 a[84:85], v9 offset:16384
 buffer_store_dwordx4 v[232:235], v1, s[12:15], s59 offen offset:3072 sc1
 v_mfma_f32_16x16x32_bf16 v[60:63], a[104:107], a[180:183], v[60:63]
 s_add_u32 m0, s29, 12288
 ds_read_b64_tr_b16 a[86:87], v9 offset:20480
 v_xor_b32 v10, 98400, v6
 v_mfma_f32_16x16x32_bf16 v[60:63], a[108:111], a[188:191], v[60:63]
 s_waitcnt lgkmcnt(6)
 ds_read_b64_tr_b16 a[88:89], v10 offset:0
 v_accvgpr_write_b32 a232, v3
 v_mfma_f32_16x16x32_bf16 v[20:23], a[64:67], a[160:163], v[20:23]
 ds_read_b64_tr_b16 a[90:91], v10 offset:4096
 buffer_load_dwordx4 v2, s[16:19], s50 offen lds
 v_mfma_f32_16x16x32_bf16 v[20:23], a[68:71], a[168:171], v[20:23]
 ds_read_b64_tr_b16 a[92:93], v10 offset:16384
 v_cmp_gt_i32 vcc, 33, v14
 v_mfma_f32_16x16x32_bf16 v[20:23], a[72:75], a[176:179], v[20:23]
 s_waitcnt lgkmcnt(7)
 ds_read_b64_tr_b16 a[94:95], v10 offset:20480
 v_xor_b32 v7, 32896, v6
 v_mfma_f32_16x16x32_bf16 v[20:23], a[76:79], a[184:187], v[20:23]
 ds_read_b64_tr_b16 a[96:97], v7 offset:0
 v_cndmask_b32 v3, 0, v15, vcc
 v_mfma_f32_16x16x32_bf16 v[36:39], a[64:67], a[164:167], v[36:39]
 s_add_u32 m0, s29, 16384
 ds_read_b64_tr_b16 a[98:99], v7 offset:4096
 v_accvgpr_write_b32 a233, v3
 v_mfma_f32_16x16x32_bf16 v[36:39], a[68:71], a[172:175], v[36:39]
 ds_read_b64_tr_b16 a[100:101], v7 offset:16384
 buffer_load_dwordx4 v2, s[16:19], s51 offen lds
 v_mfma_f32_16x16x32_bf16 v[36:39], a[72:75], a[180:183], v[36:39]
 s_add_u32 s59, s56, 40960
 ds_read_b64_tr_b16 a[102:103], v7 offset:20480
 v_xor_b32 v8, 98432, v6
 v_mfma_f32_16x16x32_bf16 v[36:39], a[76:79], a[188:191], v[36:39]
 s_waitcnt lgkmcnt(6)
 ds_read_b64_tr_b16 a[104:105], v8 offset:0
 buffer_store_dwordx4 v[240:243], v1, s[12:15], s59 offen offset:3072 sc1
 v_mfma_f32_16x16x32_bf16 v[68:71], a[80:83], a[160:163], v[68:71]
 ds_read_b64_tr_b16 a[106:107], v8 offset:4096
 v_cmp_gt_i32 vcc, 34, v14
 v_mfma_f32_16x16x32_bf16 v[68:71], a[84:87], a[168:171], v[68:71]
 s_add_u32 m0, s29, 20480
 ds_read_b64_tr_b16 a[108:109], v8 offset:16384
 v_cndmask_b32 v3, 0, v15, vcc
 v_mfma_f32_16x16x32_bf16 v[68:71], a[88:91], a[176:179], v[68:71]
 s_waitcnt lgkmcnt(7)
 ds_read_b64_tr_b16 a[110:111], v8 offset:20480
 v_xor_b32 v9, 32928, v6
 v_mfma_f32_16x16x32_bf16 v[68:71], a[92:95], a[184:187], v[68:71]
 ds_read_b64_tr_b16 a[64:65], v9 offset:0
 buffer_load_dwordx4 v2, s[16:19], s52 offen lds
 v_mfma_f32_16x16x32_bf16 v[76:79], a[80:83], a[164:167], v[76:79]
 ds_read_b64_tr_b16 a[66:67], v9 offset:4096
 v_accvgpr_write_b32 a234, v3
 v_mfma_f32_16x16x32_bf16 v[76:79], a[84:87], a[172:175], v[76:79]
 ds_read_b64_tr_b16 a[68:69], v9 offset:16384
 v_cmp_gt_i32 vcc, 35, v14
 v_mfma_f32_16x16x32_bf16 v[76:79], a[88:91], a[180:183], v[76:79]
 s_add_u32 m0, s29, 24576
 ds_read_b64_tr_b16 a[70:71], v9 offset:20480
 v_xor_b32 v10, 98464, v6
 v_mfma_f32_16x16x32_bf16 v[76:79], a[92:95], a[188:191], v[76:79]
 s_waitcnt lgkmcnt(6)
 ds_read_b64_tr_b16 a[72:73], v10 offset:0
 v_cndmask_b32 v3, 0, v15, vcc
 v_mfma_f32_16x16x32_bf16 v[84:87], a[96:99], a[160:163], v[84:87]
 ds_read_b64_tr_b16 a[74:75], v10 offset:4096
 buffer_load_dwordx4 v2, s[16:19], s53 offen lds
 v_mfma_f32_16x16x32_bf16 v[84:87], a[100:103], a[168:171], v[84:87]
 s_add_u32 s59, s56, 32768
 ds_read_b64_tr_b16 a[76:77], v10 offset:16384
 v_accvgpr_write_b32 a235, v3
 v_mfma_f32_16x16x32_bf16 v[84:87], a[104:107], a[176:179], v[84:87]
 s_waitcnt lgkmcnt(7)
 ds_read_b64_tr_b16 a[78:79], v10 offset:20480
 v_xor_b32 v7, 32960, v6
 v_mfma_f32_16x16x32_bf16 v[84:87], a[108:111], a[184:187], v[84:87]
 ds_read_b64_tr_b16 a[80:81], v7 offset:0
 buffer_store_dwordx4 v[248:251], v1, s[12:15], s59 offen offset:3072 sc1
 v_mfma_f32_16x16x32_bf16 v[92:95], a[96:99], a[164:167], v[92:95]
 s_add_u32 m0, s29, 28672
 ds_read_b64_tr_b16 a[82:83], v7 offset:4096
 v_cmp_gt_i32 vcc, 48, v14
 v_mfma_f32_16x16x32_bf16 v[92:95], a[100:103], a[172:175], v[92:95]
 ds_read_b64_tr_b16 a[84:85], v7 offset:16384
 buffer_load_dwordx4 v2, s[16:19], s54 offen lds
 v_mfma_f32_16x16x32_bf16 v[92:95], a[104:107], a[180:183], v[92:95]
 ds_read_b64_tr_b16 a[86:87], v7 offset:20480
 v_xor_b32 v8, 98496, v6
 v_mfma_f32_16x16x32_bf16 v[92:95], a[108:111], a[188:191], v[92:95]
 s_waitcnt lgkmcnt(6)
 ds_read_b64_tr_b16 a[88:89], v8 offset:0
 v_cndmask_b32 v3, 0, v15, vcc
 v_mfma_f32_16x16x32_bf16 v[100:103], a[64:67], a[160:163], v[100:103]
 s_add_u32 m0, s29, 65536
 ds_read_b64_tr_b16 a[90:91], v8 offset:4096
 v_add_u32 v2, 0x80000, v2
 v_mfma_f32_16x16x32_bf16 v[100:103], a[68:71], a[168:171], v[100:103]
 ds_read_b64_tr_b16 a[92:93], v8 offset:16384
 buffer_load_dwordx4 v2, s[16:19], 0 offen lds
 v_mfma_f32_16x16x32_bf16 v[100:103], a[72:75], a[176:179], v[100:103]
 s_waitcnt lgkmcnt(7)
 ds_read_b64_tr_b16 a[94:95], v8 offset:20480
 v_xor_b32 v9, 32992, v6
 v_mfma_f32_16x16x32_bf16 v[100:103], a[76:79], a[184:187], v[100:103]
 ds_read_b64_tr_b16 a[96:97], v9 offset:0
 v_accvgpr_write_b32 a236, v3
 v_mfma_f32_16x16x32_bf16 v[108:111], a[64:67], a[164:167], v[108:111]
 ds_read_b64_tr_b16 a[98:99], v9 offset:4096
 v_cmp_gt_i32 vcc, 49, v14
 v_mfma_f32_16x16x32_bf16 v[108:111], a[68:71], a[172:175], v[108:111]
 ds_read_b64_tr_b16 a[100:101], v9 offset:16384
 v_cndmask_b32 v3, 0, v15, vcc
 v_mfma_f32_16x16x32_bf16 v[108:111], a[72:75], a[180:183], v[108:111]
 s_add_u32 m0, s29, 69632
 ds_read_b64_tr_b16 a[102:103], v9 offset:20480
 v_xor_b32 v10, 98528, v6
 v_mfma_f32_16x16x32_bf16 v[108:111], a[76:79], a[188:191], v[108:111]
 s_waitcnt lgkmcnt(6)
 ds_read_b64_tr_b16 a[104:105], v10 offset:0
 buffer_load_dwordx4 v2, s[16:19], s48 offen lds
 v_mfma_f32_16x16x32_bf16 v[116:119], a[80:83], a[160:163], v[116:119]
 ds_read_b64_tr_b16 a[106:107], v10 offset:4096
 v_accvgpr_write_b32 a237, v3
 v_mfma_f32_16x16x32_bf16 v[116:119], a[84:87], a[168:171], v[116:119]
 ds_read_b64_tr_b16 a[108:109], v10 offset:16384
 v_cmp_gt_i32 vcc, 50, v14
 v_mfma_f32_16x16x32_bf16 v[116:119], a[88:91], a[176:179], v[116:119]
 s_waitcnt lgkmcnt(7)
 ds_read_b64_tr_b16 a[110:111], v10 offset:20480
 v_xor_b32 v7, 33024, v6
 v_mfma_f32_16x16x32_bf16 v[116:119], a[92:95], a[184:187], v[116:119]
 s_add_u32 m0, s29, 73728
 ds_read_b64_tr_b16 a[64:65], v7 offset:0
 v_cndmask_b32 v3, 0, v15, vcc
 v_mfma_f32_16x16x32_bf16 v[124:127], a[80:83], a[164:167], v[124:127]
 ds_read_b64_tr_b16 a[66:67], v7 offset:4096
 buffer_load_dwordx4 v2, s[16:19], s49 offen lds
 v_mfma_f32_16x16x32_bf16 v[124:127], a[84:87], a[172:175], v[124:127]
 ds_read_b64_tr_b16 a[68:69], v7 offset:16384
 v_accvgpr_write_b32 a238, v3
 v_mfma_f32_16x16x32_bf16 v[124:127], a[88:91], a[180:183], v[124:127]
 ds_read_b64_tr_b16 a[70:71], v7 offset:20480
 v_xor_b32 v8, 98560, v6
 v_mfma_f32_16x16x32_bf16 v[124:127], a[92:95], a[188:191], v[124:127]
 s_waitcnt lgkmcnt(6)
 ds_read_b64_tr_b16 a[72:73], v8 offset:0
 v_cmp_gt_i32 vcc, 51, v14
 v_mfma_f32_16x16x32_bf16 v[132:135], a[96:99], a[160:163], v[132:135]
 s_add_u32 m0, s29, 77824
 ds_read_b64_tr_b16 a[74:75], v8 offset:4096
 v_cndmask_b32 v3, 0, v15, vcc
 v_mfma_f32_16x16x32_bf16 v[132:135], a[100:103], a[168:171], v[132:135]
 ds_read_b64_tr_b16 a[76:77], v8 offset:16384
 buffer_load_dwordx4 v2, s[16:19], s50 offen lds
 v_mfma_f32_16x16x32_bf16 v[132:135], a[104:107], a[176:179], v[132:135]
 s_waitcnt lgkmcnt(7)
 ds_read_b64_tr_b16 a[78:79], v8 offset:20480
 v_xor_b32 v9, 33056, v6
 v_mfma_f32_16x16x32_bf16 v[132:135], a[108:111], a[184:187], v[132:135]
 ds_read_b64_tr_b16 a[80:81], v9 offset:0
 v_accvgpr_write_b32 a239, v3
 v_mfma_f32_16x16x32_bf16 v[140:143], a[96:99], a[164:167], v[140:143]
 ds_read_b64_tr_b16 a[82:83], v9 offset:4096
 v_mfma_f32_16x16x32_bf16 v[140:143], a[100:103], a[172:175], v[140:143]
 ds_read_b64_tr_b16 a[84:85], v9 offset:16384
 v_mfma_f32_16x16x32_bf16 v[140:143], a[104:107], a[180:183], v[140:143]
 s_add_u32 m0, s29, 81920
 ds_read_b64_tr_b16 a[86:87], v9 offset:20480
 v_xor_b32 v10, 98592, v6
 v_mfma_f32_16x16x32_bf16 v[140:143], a[108:111], a[188:191], v[140:143]
 s_waitcnt lgkmcnt(6)
 ds_read_b64_tr_b16 a[88:89], v10 offset:0
 buffer_load_dwordx4 v2, s[16:19], s51 offen lds
 v_mfma_f32_16x16x32_bf16 v[148:151], a[64:67], a[160:163], v[148:151]
 ds_read_b64_tr_b16 a[90:91], v10 offset:4096
 v_mfma_f32_16x16x32_bf16 v[148:151], a[68:71], a[168:171], v[148:151]
 ds_read_b64_tr_b16 a[92:93], v10 offset:16384
 v_mfma_f32_16x16x32_bf16 v[148:151], a[72:75], a[176:179], v[148:151]
 s_waitcnt lgkmcnt(7)
 ds_read_b64_tr_b16 a[94:95], v10 offset:20480
 v_xor_b32 v7, 33088, v6
 v_mfma_f32_16x16x32_bf16 v[148:151], a[76:79], a[184:187], v[148:151]
 s_add_u32 m0, s29, 86016
 ds_read_b64_tr_b16 a[96:97], v7 offset:0
 v_mfma_f32_16x16x32_bf16 v[156:159], a[64:67], a[164:167], v[156:159]
 ds_read_b64_tr_b16 a[98:99], v7 offset:4096
 buffer_load_dwordx4 v2, s[16:19], s52 offen lds
 v_mfma_f32_16x16x32_bf16 v[156:159], a[68:71], a[172:175], v[156:159]
 ds_read_b64_tr_b16 a[100:101], v7 offset:16384
 v_mfma_f32_16x16x32_bf16 v[156:159], a[72:75], a[180:183], v[156:159]
 ds_read_b64_tr_b16 a[102:103], v7 offset:20480
 v_xor_b32 v8, 98624, v6
 v_mfma_f32_16x16x32_bf16 v[156:159], a[76:79], a[188:191], v[156:159]
 s_waitcnt lgkmcnt(6)
 ds_read_b64_tr_b16 a[104:105], v8 offset:0
 v_mfma_f32_16x16x32_bf16 v[164:167], a[80:83], a[160:163], v[164:167]
 s_add_u32 m0, s29, 90112
 ds_read_b64_tr_b16 a[106:107], v8 offset:4096
 v_mfma_f32_16x16x32_bf16 v[164:167], a[84:87], a[168:171], v[164:167]
 ds_read_b64_tr_b16 a[108:109], v8 offset:16384
 buffer_load_dwordx4 v2, s[16:19], s53 offen lds
 v_mfma_f32_16x16x32_bf16 v[164:167], a[88:91], a[176:179], v[164:167]
 s_waitcnt lgkmcnt(7)
 ds_read_b64_tr_b16 a[110:111], v8 offset:20480
 v_xor_b32 v9, 33120, v6
 v_mfma_f32_16x16x32_bf16 v[164:167], a[92:95], a[184:187], v[164:167]
 s_waitcnt vmcnt(8)
 ds_read_b64_tr_b16 a[64:65], v9 offset:0
 v_mfma_f32_16x16x32_bf16 v[172:175], a[80:83], a[164:167], v[172:175]
 s_barrier
 ds_read_b64_tr_b16 a[66:67], v9 offset:4096
 v_mfma_f32_16x16x32_bf16 v[172:175], a[84:87], a[172:175], v[172:175]
 ds_read_b64_tr_b16 a[68:69], v9 offset:16384
 buffer_store_dword v11, v11, s[12:15], s92 offen sc1
 v_mfma_f32_16x16x32_bf16 v[172:175], a[88:91], a[180:183], v[172:175]
 s_add_u32 m0, s29, 94208
 ds_read_b64_tr_b16 a[70:71], v9 offset:20480
 v_xor_b32 v10, 98656, v6
 v_mfma_f32_16x16x32_bf16 v[172:175], a[92:95], a[188:191], v[172:175]
 s_waitcnt lgkmcnt(6)
 ds_read_b64_tr_b16 a[72:73], v10 offset:0
 buffer_load_dwordx4 v2, s[16:19], s54 offen lds
 v_mfma_f32_16x16x32_bf16 v[180:183], a[96:99], a[160:163], v[180:183]
 ds_read_b64_tr_b16 a[74:75], v10 offset:4096
 v_mfma_f32_16x16x32_bf16 v[180:183], a[100:103], a[168:171], v[180:183]
 ds_read_b64_tr_b16 a[76:77], v10 offset:16384
 v_mfma_f32_16x16x32_bf16 v[180:183], a[104:107], a[176:179], v[180:183]
 s_waitcnt lgkmcnt(7)
 ds_read_b64_tr_b16 a[78:79], v10 offset:20480
 v_xor_b32 v7, 33152, v6
 v_mfma_f32_16x16x32_bf16 v[180:183], a[108:111], a[184:187], v[180:183]
 ds_read_b64_tr_b16 a[80:81], v7 offset:0
 v_mfma_f32_16x16x32_bf16 v[188:191], a[96:99], a[164:167], v[188:191]
 ds_read_b64_tr_b16 a[82:83], v7 offset:4096
 v_mfma_f32_16x16x32_bf16 v[188:191], a[100:103], a[172:175], v[188:191]
 ds_read_b64_tr_b16 a[84:85], v7 offset:16384
 v_mfma_f32_16x16x32_bf16 v[188:191], a[104:107], a[180:183], v[188:191]
 ds_read_b64_tr_b16 a[86:87], v7 offset:20480
 v_xor_b32 v8, 98688, v6
 v_mfma_f32_16x16x32_bf16 v[188:191], a[108:111], a[188:191], v[188:191]
 s_waitcnt lgkmcnt(6)
 ds_read_b64_tr_b16 a[88:89], v8 offset:0
 v_mfma_f32_16x16x32_bf16 v[196:199], a[64:67], a[160:163], v[196:199]
 s_and_b32 s58, s92, ~127
 ds_read_b64_tr_b16 a[90:91], v8 offset:4096
 v_mfma_f32_16x16x32_bf16 v[196:199], a[68:71], a[168:171], v[196:199]
 s_lshl_b32 s37, s25, 1
 ds_read_b64_tr_b16 a[92:93], v8 offset:16384
 v_mfma_f32_16x16x32_bf16 v[196:199], a[72:75], a[176:179], v[196:199]
 s_waitcnt lgkmcnt(7)
 ds_read_b64_tr_b16 a[94:95], v8 offset:20480
 v_xor_b32 v9, 33184, v6
 v_mfma_f32_16x16x32_bf16 v[196:199], a[76:79], a[184:187], v[196:199]
 s_sub_i32 s38, 12, s37
 ds_read_b64_tr_b16 a[96:97], v9 offset:0
 v_mfma_f32_16x16x32_bf16 v[204:207], a[64:67], a[164:167], v[204:207]
 s_max_i32 s38, s38, 0
 ds_read_b64_tr_b16 a[98:99], v9 offset:4096
 v_mfma_f32_16x16x32_bf16 v[204:207], a[68:71], a[172:175], v[204:207]
 s_mul_i32 s49, s26, 1048576
 ds_read_b64_tr_b16 a[100:101], v9 offset:16384
 v_mfma_f32_16x16x32_bf16 v[204:207], a[72:75], a[180:183], v[204:207]
 s_lshl_b32 s50, s3, 13
 ds_read_b64_tr_b16 a[102:103], v9 offset:20480
 v_xor_b32 v10, 98720, v6
 v_mfma_f32_16x16x32_bf16 v[204:207], a[76:79], a[188:191], v[204:207]
 s_waitcnt lgkmcnt(6)
 ds_read_b64_tr_b16 a[104:105], v10 offset:0
 v_mfma_f32_16x16x32_bf16 v[212:215], a[80:83], a[160:163], v[212:215]
 s_add_u32 s49, s49, s50
 ds_read_b64_tr_b16 a[106:107], v10 offset:4096
 v_mfma_f32_16x16x32_bf16 v[212:215], a[84:87], a[168:171], v[212:215]
 s_mov_b32 s54, 0
 ds_read_b64_tr_b16 a[108:109], v10 offset:16384
 v_mfma_f32_16x16x32_bf16 v[212:215], a[88:91], a[176:179], v[212:215]
 s_waitcnt lgkmcnt(7)
 ds_read_b64_tr_b16 a[110:111], v10 offset:20480
 v_xor_b32 v7, 33216, v6
 v_mfma_f32_16x16x32_bf16 v[212:215], a[92:95], a[184:187], v[212:215]
 s_add_u32 s44, s37, 1
 ds_read_b64_tr_b16 a[64:65], v7 offset:0
 v_mfma_f32_16x16x32_bf16 v[220:223], a[80:83], a[164:167], v[220:223]
 s_mov_b32 s42, s49
 ds_read_b64_tr_b16 a[66:67], v7 offset:4096
 v_mfma_f32_16x16x32_bf16 v[220:223], a[84:87], a[172:175], v[220:223]
 s_add_u32 s60, s94, 4
 ds_read_b64_tr_b16 a[68:69], v7 offset:16384
 v_mfma_f32_16x16x32_bf16 v[220:223], a[88:91], a[180:183], v[220:223]
 s_mov_b32 s45, 2
 ds_read_b64_tr_b16 a[70:71], v7 offset:20480
 v_xor_b32 v8, 98752, v6
 v_mfma_f32_16x16x32_bf16 v[220:223], a[92:95], a[188:191], v[220:223]
 s_waitcnt lgkmcnt(6)
 ds_read_b64_tr_b16 a[72:73], v8 offset:0
 buffer_load_dwordx4 v[32:35], v122, s[4:7], 0 offen
 v_mfma_f32_16x16x32_bf16 v[228:231], a[96:99], a[160:163], v[228:231]
 s_mov_b32 s66, 1
 ds_read_b64_tr_b16 a[74:75], v8 offset:4096
 v_mfma_f32_16x16x32_bf16 v[228:231], a[100:103], a[168:171], v[228:231]
 s_mov_b32 s68, 1
 ds_read_b64_tr_b16 a[76:77], v8 offset:16384
 v_mfma_f32_16x16x32_bf16 v[228:231], a[104:107], a[176:179], v[228:231]
 s_waitcnt lgkmcnt(7)
 ds_read_b64_tr_b16 a[78:79], v8 offset:20480
 v_xor_b32 v9, 33248, v6
 v_mfma_f32_16x16x32_bf16 v[228:231], a[108:111], a[184:187], v[228:231]
 ds_read_b64_tr_b16 a[80:81], v9 offset:0
 buffer_load_dwordx4 v[40:43], v123, s[4:7], 0 offen
 v_mfma_f32_16x16x32_bf16 v[236:239], a[96:99], a[164:167], v[236:239]
 s_mov_b32 s70, 32768
 ds_read_b64_tr_b16 a[82:83], v9 offset:4096
 v_mfma_f32_16x16x32_bf16 v[236:239], a[100:103], a[172:175], v[236:239]
 s_mov_b32 s71, s70
 ds_read_b64_tr_b16 a[84:85], v9 offset:16384
 v_mfma_f32_16x16x32_bf16 v[236:239], a[104:107], a[180:183], v[236:239]
 s_add_u32 s43, s42, 16777216
 ds_read_b64_tr_b16 a[86:87], v9 offset:20480
 v_xor_b32 v10, 98784, v6
 v_mfma_f32_16x16x32_bf16 v[236:239], a[108:111], a[188:191], v[236:239]
 s_waitcnt lgkmcnt(6)
 ds_read_b64_tr_b16 a[88:89], v10 offset:0
 buffer_load_dwordx4 v[48:51], v128, s[4:7], 0 offen
 v_mfma_f32_16x16x32_bf16 v[244:247], a[64:67], a[160:163], v[244:247]
 s_mov_b32 s40, s50
 ds_read_b64_tr_b16 a[90:91], v10 offset:4096
 v_mfma_f32_16x16x32_bf16 v[244:247], a[68:71], a[168:171], v[244:247]
 s_waitcnt vmcnt(3)
 ds_read_b64_tr_b16 a[92:93], v10 offset:16384
 v_xor_b32 v7, 131072, v6
 v_mfma_f32_16x16x32_bf16 v[244:247], a[72:75], a[176:179], v[244:247]
 s_waitcnt lgkmcnt(7)
 s_barrier
 ds_read_b64_tr_b16 a[94:95], v10 offset:20480
 v_mfma_f32_16x16x32_bf16 v[244:247], a[76:79], a[184:187], v[244:247]
 ds_read_b64_tr_b16 a[96:97], v7 offset:0
 buffer_load_dwordx4 v[56:59], v120, s[4:7], 0 offen offset:0
 v_mfma_f32_16x16x32_bf16 v[252:255], a[64:67], a[164:167], v[252:255]
 s_add_u32 s41, s50, 0x10000
 ds_read_b64_tr_b16 a[98:99], v7 offset:4096
 v_mfma_f32_16x16x32_bf16 v[252:255], a[68:71], a[172:175], v[252:255]
 s_lshr_b32 s61, s95, 4
 ds_read_b64_tr_b16 a[100:101], v7 offset:16384
 v_mfma_f32_16x16x32_bf16 v[252:255], a[72:75], a[180:183], v[252:255]
 s_lshl_b32 s61, s61, 7
 ds_read_b64_tr_b16 a[102:103], v7 offset:20480
 v_xor_b32 v8, 0, v6
 v_mfma_f32_16x16x32_bf16 v[252:255], a[76:79], a[188:191], v[252:255]
 s_waitcnt lgkmcnt(6)
 ds_read_b64_tr_b16 a[104:105], v8 offset:0
 buffer_load_dwordx4 v[64:67], v120, s[4:7], 0 offen offset:896
 v_mfma_f32_16x16x32_bf16 v[16:19], a[80:83], a[160:163], v[16:19]
 s_add_u32 s61, s61, 84959232
 ds_read_b64_tr_b16 a[106:107], v8 offset:4096
 v_mfma_f32_16x16x32_bf16 v[16:19], a[84:87], a[168:171], v[16:19]
 s_mov_b32 s47, 0x4b800000
 ds_read_b64_tr_b16 a[108:109], v8 offset:16384
 v_mfma_f32_16x16x32_bf16 v[16:19], a[88:91], a[176:179], v[16:19]
 s_waitcnt lgkmcnt(7)
 ds_read_b64_tr_b16 a[110:111], v8 offset:20480
 v_xor_b32 v9, 65536, v6
 v_mfma_f32_16x16x32_bf16 v[16:19], a[92:95], a[184:187], v[16:19]
 ds_read_b64_tr_b16 a[64:65], v9 offset:0
 buffer_load_dwordx4 v[72:75], v120, s[8:11], 0 offen offset:0
 v_mfma_f32_16x16x32_bf16 v[24:27], a[80:83], a[164:167], v[24:27]
 s_lshl_b32 s30, s95, 1
 ds_read_b64_tr_b16 a[66:67], v9 offset:4096
 v_mfma_f32_16x16x32_bf16 v[24:27], a[84:87], a[172:175], v[24:27]
 s_lshr_b32 s31, s3, 1
 ds_read_b64_tr_b16 a[68:69], v9 offset:16384
 v_mfma_f32_16x16x32_bf16 v[24:27], a[88:91], a[180:183], v[24:27]
 s_add_u32 s30, s30, s31
 ds_read_b64_tr_b16 a[70:71], v9 offset:20480
 v_xor_b32 v10, 131104, v6
 v_mfma_f32_16x16x32_bf16 v[24:27], a[92:95], a[188:191], v[24:27]
 s_waitcnt lgkmcnt(6)
 ds_read_b64_tr_b16 a[72:73], v10 offset:0
 buffer_load_dwordx4 v[80:83], v120, s[8:11], 0 offen offset:896
 v_mfma_f32_16x16x32_bf16 v[28:31], a[96:99], a[192:195], v[28:31]
 s_min_u32 s30, s30, 223
 ds_read_b64_tr_b16 a[74:75], v10 offset:4096
 v_mfma_f32_16x16x32_bf16 v[28:31], a[100:103], a[200:203], v[28:31]
 s_lshl_b32 s30, s30, 2
 ds_read_b64_tr_b16 a[76:77], v10 offset:16384
 v_mfma_f32_16x16x32_bf16 v[28:31], a[104:107], a[208:211], v[28:31]
 s_waitcnt lgkmcnt(3)
 ds_read_b64_tr_b16 a[78:79], v10 offset:20480
 v_xor_b32 v7, 32, v6
 v_mfma_f32_16x16x32_bf16 v[28:31], a[108:111], a[216:219], v[28:31]
 ds_read_b64_tr_b16 a[80:81], v7 offset:0
 buffer_load_dwordx4 v[88:91], v121, s[20:23], s39 offen offset:0
 v_mfma_f32_16x16x32_bf16 v[28:31], a[64:67], a[112:115], v[28:31]
 ds_read_b64_tr_b16 a[82:83], v7 offset:4096
 v_mfma_f32_16x16x32_bf16 v[28:31], a[68:71], a[120:123], v[28:31]
 ds_read_b64_tr_b16 a[84:85], v7 offset:16384
 v_mfma_f32_16x16x32_bf16 v[44:47], a[96:99], a[196:199], v[44:47]
 ds_read_b64_tr_b16 a[86:87], v7 offset:20480
 v_xor_b32 v8, 65568, v6
 v_mfma_f32_16x16x32_bf16 v[44:47], a[100:103], a[204:207], v[44:47]
 ds_read_b64_tr_b16 a[88:89], v8 offset:0
 buffer_load_dwordx4 v[96:99], v121, s[20:23], s39 offen offset:16
 v_mfma_f32_16x16x32_bf16 v[44:47], a[104:107], a[212:215], v[44:47]
 ds_read_b64_tr_b16 a[90:91], v8 offset:4096
 v_mfma_f32_16x16x32_bf16 v[44:47], a[108:111], a[220:223], v[44:47]
 ds_read_b64_tr_b16 a[92:93], v8 offset:16384
 v_mfma_f32_16x16x32_bf16 v[44:47], a[64:67], a[116:119], v[44:47]
 ds_read_b64_tr_b16 a[94:95], v8 offset:20480
 v_xor_b32 v9, 131136, v6
 v_mfma_f32_16x16x32_bf16 v[44:47], a[68:71], a[124:127], v[44:47]
 s_waitcnt lgkmcnt(6)
 ds_read_b64_tr_b16 a[96:97], v9 offset:0
 buffer_load_dwordx4 v[104:107], v121, s[20:23], s39 offen offset:32
 v_mfma_f32_16x16x32_bf16 v[52:55], a[72:75], a[192:195], v[52:55]
 ds_read_b64_tr_b16 a[98:99], v9 offset:4096
 v_mfma_f32_16x16x32_bf16 v[52:55], a[76:79], a[200:203], v[52:55]
 ds_read_b64_tr_b16 a[100:101], v9 offset:16384
 v_mfma_f32_16x16x32_bf16 v[52:55], a[80:83], a[208:211], v[52:55]
 s_waitcnt lgkmcnt(3)
 ds_read_b64_tr_b16 a[102:103], v9 offset:20480
 v_xor_b32 v10, 64, v6
 v_mfma_f32_16x16x32_bf16 v[52:55], a[84:87], a[216:219], v[52:55]
 ds_read_b64_tr_b16 a[104:105], v10 offset:0
 buffer_load_dwordx4 v[112:115], v121, s[20:23], s39 offen offset:48
 v_mfma_f32_16x16x32_bf16 v[52:55], a[88:91], a[112:115], v[52:55]
 ds_read_b64_tr_b16 a[106:107], v10 offset:4096
 v_mfma_f32_16x16x32_bf16 v[52:55], a[92:95], a[120:123], v[52:55]
 ds_read_b64_tr_b16 a[108:109], v10 offset:16384
 v_mfma_f32_16x16x32_bf16 v[60:63], a[72:75], a[196:199], v[60:63]
 ds_read_b64_tr_b16 a[110:111], v10 offset:20480
 v_xor_b32 v7, 65600, v6
 v_mfma_f32_16x16x32_bf16 v[60:63], a[76:79], a[204:207], v[60:63]
 ds_read_b64_tr_b16 a[64:65], v7 offset:0
 v_mfma_f32_16x16x32_bf16 v[60:63], a[80:83], a[212:215], v[60:63]
 s_and_b32 s4, s2, 127
 ds_read_b64_tr_b16 a[66:67], v7 offset:4096
 v_mfma_f32_16x16x32_bf16 v[60:63], a[84:87], a[220:223], v[60:63]
 s_lshl_b32 s4, s4, 2
 ds_read_b64_tr_b16 a[68:69], v7 offset:16384
 v_mfma_f32_16x16x32_bf16 v[60:63], a[88:91], a[116:119], v[60:63]
 s_add_u32 s4, s4, s3
 ds_read_b64_tr_b16 a[70:71], v7 offset:20480
 v_xor_b32 v8, 131168, v6
 v_mfma_f32_16x16x32_bf16 v[60:63], a[92:95], a[124:127], v[60:63]
 s_waitcnt lgkmcnt(6)
 ds_read_b64_tr_b16 a[72:73], v8 offset:0
 v_mfma_f32_16x16x32_bf16 v[20:23], a[96:99], a[192:195], v[20:23]
 s_mul_i32 s5, s4, 17408
 ds_read_b64_tr_b16 a[74:75], v8 offset:4096
 v_mfma_f32_16x16x32_bf16 v[20:23], a[100:103], a[200:203], v[20:23]
 s_add_u32 s5, s5, 50331648
 ds_read_b64_tr_b16 a[76:77], v8 offset:16384
 v_mul_f32 v28, s34, v28
 v_mfma_f32_16x16x32_bf16 v[20:23], a[104:107], a[208:211], v[20:23]
 s_waitcnt lgkmcnt(3)
 ds_read_b64_tr_b16 a[78:79], v8 offset:20480
 v_xor_b32 v9, 96, v6
 v_mfma_f32_16x16x32_bf16 v[20:23], a[108:111], a[216:219], v[20:23]
 s_add_u32 s4, s5, 0x2000
 ds_read_b64_tr_b16 a[80:81], v9 offset:0
 v_mul_f32 v29, s34, v29
 v_mfma_f32_16x16x32_bf16 v[20:23], a[64:67], a[112:115], v[20:23]
 s_mov_b32 s6, 2.0
 ds_read_b64_tr_b16 a[82:83], v9 offset:4096
 v_mul_f32 v30, s34, v30
 v_mfma_f32_16x16x32_bf16 v[20:23], a[68:71], a[120:123], v[20:23]
 s_min_u32 s7, s38, 1
 ds_read_b64_tr_b16 a[84:85], v9 offset:16384
 v_mul_f32 v31, s34, v31
 v_mfma_f32_16x16x32_bf16 v[36:39], a[96:99], a[196:199], v[36:39]
 s_cmp_eq_u32 s44, 1
 s_cselect_b32 s53, 1, 0
 ds_read_b64_tr_b16 a[86:87], v9 offset:20480
 v_xor_b32 v10, 65632, v6
 v_mfma_f32_16x16x32_bf16 v[36:39], a[100:103], a[204:207], v[36:39]
 s_cmp_eq_u32 s38, 0
 s_cmov_b32 s4, 2.0
 ds_read_b64_tr_b16 a[88:89], v10 offset:0
 v_mfma_f32_16x16x32_bf16 v[36:39], a[104:107], a[212:215], v[36:39]
 s_cmp_eq_u32 s38, 0
 s_cmov_b32 s5, 2.0
 ds_read_b64_tr_b16 a[90:91], v10 offset:4096
 v_mfma_f32_16x16x32_bf16 v[36:39], a[108:111], a[220:223], v[36:39]
 s_cmp_eq_u32 s38, 0
 s_cmov_b32 s60, s58
 ds_read_b64_tr_b16 a[92:93], v10 offset:16384
 v_mfma_f32_16x16x32_bf16 v[36:39], a[64:67], a[116:119], v[36:39]
 s_mov_b64 s[8:9], s[12:13]
 ds_read_b64_tr_b16 a[94:95], v10 offset:20480
 v_xor_b32 v7, 131200, v6
 v_mfma_f32_16x16x32_bf16 v[36:39], a[68:71], a[124:127], v[36:39]
 s_waitcnt lgkmcnt(6)
 ds_read_b64_tr_b16 a[96:97], v7 offset:0
 v_mul_f32 v52, s34, v52
 v_mfma_f32_16x16x32_bf16 v[68:71], a[72:75], a[192:195], v[68:71]
 s_mov_b32 s10, s14
 ds_read_b64_tr_b16 a[98:99], v7 offset:4096
 v_mul_f32 v53, s34, v53
 v_mfma_f32_16x16x32_bf16 v[68:71], a[76:79], a[200:203], v[68:71]
 s_mov_b32 s76, 0
 ds_read_b64_tr_b16 a[100:101], v7 offset:16384
 v_mul_f32 v54, s34, v54
 v_mfma_f32_16x16x32_bf16 v[68:71], a[80:83], a[208:211], v[68:71]
 s_waitcnt lgkmcnt(3)
 ds_read_b64_tr_b16 a[102:103], v7 offset:20480
 v_xor_b32 v8, 128, v6
 v_mfma_f32_16x16x32_bf16 v[68:71], a[84:87], a[216:219], v[68:71]
 s_movk_i32 s77, 0x1000
 ds_read_b64_tr_b16 a[104:105], v8 offset:0
 v_mul_f32 v55, s34, v55
 v_mfma_f32_16x16x32_bf16 v[68:71], a[88:91], a[112:115], v[68:71]
 s_mov_b32 s51, 0
 ds_read_b64_tr_b16 a[106:107], v8 offset:4096
 v_cvt_pk_bf16_f32 v28, v28, v29
 v_mfma_f32_16x16x32_bf16 v[68:71], a[92:95], a[120:123], v[68:71]
 s_mul_i32 s78, s26, 229376
 ds_read_b64_tr_b16 a[108:109], v8 offset:16384
 v_cvt_pk_bf16_f32 v29, v30, v31
 v_mfma_f32_16x16x32_bf16 v[76:79], a[72:75], a[196:199], v[76:79]
 s_add_u32 s79, s78, 28672
 ds_read_b64_tr_b16 a[110:111], v8 offset:20480
 v_xor_b32 v9, 65664, v6
 v_mfma_f32_16x16x32_bf16 v[76:79], a[76:79], a[204:207], v[76:79]
 s_add_u32 s80, s78, 57344
 ds_read_b64_tr_b16 a[64:65], v9 offset:0
 v_cvt_pk_bf16_f32 v30, v52, v53
 v_mfma_f32_16x16x32_bf16 v[76:79], a[80:83], a[212:215], v[76:79]
 s_add_u32 s81, s78, 86016
 ds_read_b64_tr_b16 a[66:67], v9 offset:4096
 v_cvt_pk_bf16_f32 v31, v54, v55
 v_mfma_f32_16x16x32_bf16 v[76:79], a[84:87], a[220:223], v[76:79]
 s_add_u32 s82, s78, 114688
 ds_read_b64_tr_b16 a[68:69], v9 offset:16384
 v_accvgpr_write_b32 a0, v28
 v_mfma_f32_16x16x32_bf16 v[76:79], a[88:91], a[116:119], v[76:79]
 s_add_u32 s83, s78, 143360
 ds_read_b64_tr_b16 a[70:71], v9 offset:20480
 v_xor_b32 v10, 131232, v6
 v_mfma_f32_16x16x32_bf16 v[76:79], a[92:95], a[124:127], v[76:79]
 s_waitcnt lgkmcnt(6)
 ds_read_b64_tr_b16 a[72:73], v10 offset:0
 v_accvgpr_write_b32 a1, v29
 v_mfma_f32_16x16x32_bf16 v[84:87], a[96:99], a[192:195], v[84:87]
 s_add_u32 s84, s78, 172032
 ds_read_b64_tr_b16 a[74:75], v10 offset:4096
 v_accvgpr_write_b32 a2, v30
 v_mfma_f32_16x16x32_bf16 v[84:87], a[100:103], a[200:203], v[84:87]
 s_add_u32 s85, s78, 200704
 ds_read_b64_tr_b16 a[76:77], v10 offset:16384
 v_accvgpr_write_b32 a3, v31
 v_mfma_f32_16x16x32_bf16 v[84:87], a[104:107], a[208:211], v[84:87]
 s_waitcnt lgkmcnt(3)
 ds_read_b64_tr_b16 a[78:79], v10 offset:20480
 v_xor_b32 v7, 160, v6
 v_mfma_f32_16x16x32_bf16 v[84:87], a[108:111], a[216:219], v[84:87]
 ds_read_b64_tr_b16 a[80:81], v7 offset:0
 v_mul_f32 v44, s34, v44
 v_mfma_f32_16x16x32_bf16 v[84:87], a[64:67], a[112:115], v[84:87]
 ds_read_b64_tr_b16 a[82:83], v7 offset:4096
 v_mul_f32 v45, s34, v45
 v_mfma_f32_16x16x32_bf16 v[84:87], a[68:71], a[120:123], v[84:87]
 ds_read_b64_tr_b16 a[84:85], v7 offset:16384
 v_mul_f32 v46, s34, v46
 v_mfma_f32_16x16x32_bf16 v[92:95], a[96:99], a[196:199], v[92:95]
 ds_read_b64_tr_b16 a[86:87], v7 offset:20480
 v_xor_b32 v8, 65696, v6
 v_mfma_f32_16x16x32_bf16 v[92:95], a[100:103], a[204:207], v[92:95]
 ds_read_b64_tr_b16 a[88:89], v8 offset:0
 v_mul_f32 v47, s34, v47
 v_mfma_f32_16x16x32_bf16 v[92:95], a[104:107], a[212:215], v[92:95]
 ds_read_b64_tr_b16 a[90:91], v8 offset:4096
 v_mul_f32 v60, s34, v60
 v_mfma_f32_16x16x32_bf16 v[92:95], a[108:111], a[220:223], v[92:95]
 ds_read_b64_tr_b16 a[92:93], v8 offset:16384
 v_mul_f32 v61, s34, v61
 v_mfma_f32_16x16x32_bf16 v[92:95], a[64:67], a[116:119], v[92:95]
 ds_read_b64_tr_b16 a[94:95], v8 offset:20480
 v_xor_b32 v9, 131264, v6
 v_mfma_f32_16x16x32_bf16 v[92:95], a[68:71], a[124:127], v[92:95]
 s_waitcnt lgkmcnt(6)
 ds_read_b64_tr_b16 a[96:97], v9 offset:0
 v_mul_f32 v62, s34, v62
 v_mfma_f32_16x16x32_bf16 v[100:103], a[72:75], a[192:195], v[100:103]
 ds_read_b64_tr_b16 a[98:99], v9 offset:4096
 v_mul_f32 v63, s34, v63
 v_mfma_f32_16x16x32_bf16 v[100:103], a[76:79], a[200:203], v[100:103]
 ds_read_b64_tr_b16 a[100:101], v9 offset:16384
 v_cvt_pk_bf16_f32 v44, v44, v45
 v_mfma_f32_16x16x32_bf16 v[100:103], a[80:83], a[208:211], v[100:103]
 s_waitcnt lgkmcnt(3)
 ds_read_b64_tr_b16 a[102:103], v9 offset:20480
 v_xor_b32 v10, 192, v6
 v_mfma_f32_16x16x32_bf16 v[100:103], a[84:87], a[216:219], v[100:103]
 ds_read_b64_tr_b16 a[104:105], v10 offset:0
 v_cvt_pk_bf16_f32 v45, v46, v47
 v_mfma_f32_16x16x32_bf16 v[100:103], a[88:91], a[112:115], v[100:103]
 ds_read_b64_tr_b16 a[106:107], v10 offset:4096
 v_cvt_pk_bf16_f32 v46, v60, v61
 v_mfma_f32_16x16x32_bf16 v[100:103], a[92:95], a[120:123], v[100:103]
 ds_read_b64_tr_b16 a[108:109], v10 offset:16384
 v_cvt_pk_bf16_f32 v47, v62, v63
 v_mfma_f32_16x16x32_bf16 v[108:111], a[72:75], a[196:199], v[108:111]
 ds_read_b64_tr_b16 a[110:111], v10 offset:20480
 v_xor_b32 v7, 65728, v6
 v_mfma_f32_16x16x32_bf16 v[108:111], a[76:79], a[204:207], v[108:111]
 ds_read_b64_tr_b16 a[64:65], v7 offset:0
 v_accvgpr_write_b32 a32, v44
 v_mfma_f32_16x16x32_bf16 v[108:111], a[80:83], a[212:215], v[108:111]
 ds_read_b64_tr_b16 a[66:67], v7 offset:4096
 v_accvgpr_write_b32 a33, v45
 v_mfma_f32_16x16x32_bf16 v[108:111], a[84:87], a[220:223], v[108:111]
 ds_read_b64_tr_b16 a[68:69], v7 offset:16384
 v_accvgpr_write_b32 a34, v46
 v_mfma_f32_16x16x32_bf16 v[108:111], a[88:91], a[116:119], v[108:111]
 ds_read_b64_tr_b16 a[70:71], v7 offset:20480
 v_xor_b32 v8, 131296, v6
 v_mfma_f32_16x16x32_bf16 v[108:111], a[92:95], a[124:127], v[108:111]
 s_waitcnt lgkmcnt(6)
 ds_read_b64_tr_b16 a[72:73], v8 offset:0
 v_accvgpr_write_b32 a35, v47
 v_mfma_f32_16x16x32_bf16 v[116:119], a[96:99], a[192:195], v[116:119]
 ds_read_b64_tr_b16 a[74:75], v8 offset:4096
 v_mul_f32 v20, s34, v20
 v_mfma_f32_16x16x32_bf16 v[116:119], a[100:103], a[200:203], v[116:119]
 ds_read_b64_tr_b16 a[76:77], v8 offset:16384
 v_mul_f32 v21, s34, v21
 v_mfma_f32_16x16x32_bf16 v[116:119], a[104:107], a[208:211], v[116:119]
 s_waitcnt lgkmcnt(3)
 ds_read_b64_tr_b16 a[78:79], v8 offset:20480
 v_xor_b32 v9, 224, v6
 v_mfma_f32_16x16x32_bf16 v[116:119], a[108:111], a[216:219], v[116:119]
 ds_read_b64_tr_b16 a[80:81], v9 offset:0
 v_mul_f32 v22, s34, v22
 v_mfma_f32_16x16x32_bf16 v[116:119], a[64:67], a[112:115], v[116:119]
 ds_read_b64_tr_b16 a[82:83], v9 offset:4096
 v_mul_f32 v23, s34, v23
 v_mfma_f32_16x16x32_bf16 v[116:119], a[68:71], a[120:123], v[116:119]
 ds_read_b64_tr_b16 a[84:85], v9 offset:16384
 v_mul_f32 v68, s34, v68
 v_mfma_f32_16x16x32_bf16 v[124:127], a[96:99], a[196:199], v[124:127]
 ds_read_b64_tr_b16 a[86:87], v9 offset:20480
 v_xor_b32 v10, 65760, v6
 v_mfma_f32_16x16x32_bf16 v[124:127], a[100:103], a[204:207], v[124:127]
 ds_read_b64_tr_b16 a[88:89], v10 offset:0
 v_mul_f32 v69, s34, v69
 v_mfma_f32_16x16x32_bf16 v[124:127], a[104:107], a[212:215], v[124:127]
 ds_read_b64_tr_b16 a[90:91], v10 offset:4096
 v_mul_f32 v70, s34, v70
 v_mfma_f32_16x16x32_bf16 v[124:127], a[108:111], a[220:223], v[124:127]
 ds_read_b64_tr_b16 a[92:93], v10 offset:16384
 v_mul_f32 v71, s34, v71
 v_mfma_f32_16x16x32_bf16 v[124:127], a[64:67], a[116:119], v[124:127]
 ds_read_b64_tr_b16 a[94:95], v10 offset:20480
 v_xor_b32 v7, 131328, v6
 v_mfma_f32_16x16x32_bf16 v[124:127], a[68:71], a[124:127], v[124:127]
 s_waitcnt lgkmcnt(6)
 ds_read_b64_tr_b16 a[96:97], v7 offset:0
 v_cvt_pk_bf16_f32 v20, v20, v21
 v_mfma_f32_16x16x32_bf16 v[132:135], a[72:75], a[192:195], v[132:135]
 ds_read_b64_tr_b16 a[98:99], v7 offset:4096
 v_cvt_pk_bf16_f32 v21, v22, v23
 v_mfma_f32_16x16x32_bf16 v[132:135], a[76:79], a[200:203], v[132:135]
 ds_read_b64_tr_b16 a[100:101], v7 offset:16384
 v_cvt_pk_bf16_f32 v22, v68, v69
 v_mfma_f32_16x16x32_bf16 v[132:135], a[80:83], a[208:211], v[132:135]
 s_waitcnt lgkmcnt(3)
 ds_read_b64_tr_b16 a[102:103], v7 offset:20480
 v_xor_b32 v8, 256, v6
 v_mfma_f32_16x16x32_bf16 v[132:135], a[84:87], a[216:219], v[132:135]
 ds_read_b64_tr_b16 a[104:105], v8 offset:0
 v_cvt_pk_bf16_f32 v23, v70, v71
 v_mfma_f32_16x16x32_bf16 v[132:135], a[88:91], a[112:115], v[132:135]
 ds_read_b64_tr_b16 a[106:107], v8 offset:4096
 v_accvgpr_write_b32 a4, v20
 v_mfma_f32_16x16x32_bf16 v[132:135], a[92:95], a[120:123], v[132:135]
 ds_read_b64_tr_b16 a[108:109], v8 offset:16384
 v_accvgpr_write_b32 a5, v21
 v_mfma_f32_16x16x32_bf16 v[140:143], a[72:75], a[196:199], v[140:143]
 ds_read_b64_tr_b16 a[110:111], v8 offset:20480
 v_xor_b32 v9, 65792, v6
 v_mfma_f32_16x16x32_bf16 v[140:143], a[76:79], a[204:207], v[140:143]
 ds_read_b64_tr_b16 a[64:65], v9 offset:0
 v_accvgpr_write_b32 a6, v22
 v_mfma_f32_16x16x32_bf16 v[140:143], a[80:83], a[212:215], v[140:143]
 ds_read_b64_tr_b16 a[66:67], v9 offset:4096
 v_accvgpr_write_b32 a7, v23
 v_mfma_f32_16x16x32_bf16 v[140:143], a[84:87], a[220:223], v[140:143]
 ds_read_b64_tr_b16 a[68:69], v9 offset:16384
 v_mul_f32 v36, s34, v36
 v_mfma_f32_16x16x32_bf16 v[140:143], a[88:91], a[116:119], v[140:143]
 ds_read_b64_tr_b16 a[70:71], v9 offset:20480
 v_xor_b32 v10, 131360, v6
 v_mfma_f32_16x16x32_bf16 v[140:143], a[92:95], a[124:127], v[140:143]
 s_waitcnt lgkmcnt(6)
 ds_read_b64_tr_b16 a[72:73], v10 offset:0
 v_mul_f32 v37, s34, v37
 v_mfma_f32_16x16x32_bf16 v[148:151], a[96:99], a[192:195], v[148:151]
 ds_read_b64_tr_b16 a[74:75], v10 offset:4096
 v_mul_f32 v38, s34, v38
 v_mfma_f32_16x16x32_bf16 v[148:151], a[100:103], a[200:203], v[148:151]
 ds_read_b64_tr_b16 a[76:77], v10 offset:16384
 v_mul_f32 v39, s34, v39
 v_mfma_f32_16x16x32_bf16 v[148:151], a[104:107], a[208:211], v[148:151]
 s_waitcnt lgkmcnt(3)
 ds_read_b64_tr_b16 a[78:79], v10 offset:20480
 v_xor_b32 v7, 288, v6
 v_mfma_f32_16x16x32_bf16 v[148:151], a[108:111], a[216:219], v[148:151]
 ds_read_b64_tr_b16 a[80:81], v7 offset:0
 v_mul_f32 v76, s34, v76
 v_mfma_f32_16x16x32_bf16 v[148:151], a[64:67], a[112:115], v[148:151]
 ds_read_b64_tr_b16 a[82:83], v7 offset:4096
 v_mul_f32 v77, s34, v77
 v_mfma_f32_16x16x32_bf16 v[148:151], a[68:71], a[120:123], v[148:151]
 ds_read_b64_tr_b16 a[84:85], v7 offset:16384
 v_mul_f32 v78, s34, v78
 v_mfma_f32_16x16x32_bf16 v[156:159], a[96:99], a[196:199], v[156:159]
 ds_read_b64_tr_b16 a[86:87], v7 offset:20480
 v_xor_b32 v8, 65824, v6
 v_mfma_f32_16x16x32_bf16 v[156:159], a[100:103], a[204:207], v[156:159]
 ds_read_b64_tr_b16 a[88:89], v8 offset:0
 v_mul_f32 v79, s34, v79
 v_mfma_f32_16x16x32_bf16 v[156:159], a[104:107], a[212:215], v[156:159]
 ds_read_b64_tr_b16 a[90:91], v8 offset:4096
 v_cvt_pk_bf16_f32 v36, v36, v37
 v_mfma_f32_16x16x32_bf16 v[156:159], a[108:111], a[220:223], v[156:159]
 ds_read_b64_tr_b16 a[92:93], v8 offset:16384
 v_cvt_pk_bf16_f32 v37, v38, v39
 v_mfma_f32_16x16x32_bf16 v[156:159], a[64:67], a[116:119], v[156:159]
 ds_read_b64_tr_b16 a[94:95], v8 offset:20480
 v_xor_b32 v9, 131392, v6
 v_mfma_f32_16x16x32_bf16 v[156:159], a[68:71], a[124:127], v[156:159]
 s_waitcnt lgkmcnt(6)
 ds_read_b64_tr_b16 a[96:97], v9 offset:0
 v_cvt_pk_bf16_f32 v38, v76, v77
 v_mfma_f32_16x16x32_bf16 v[164:167], a[72:75], a[192:195], v[164:167]
 ds_read_b64_tr_b16 a[98:99], v9 offset:4096
 v_cvt_pk_bf16_f32 v39, v78, v79
 v_mfma_f32_16x16x32_bf16 v[164:167], a[76:79], a[200:203], v[164:167]
 ds_read_b64_tr_b16 a[100:101], v9 offset:16384
 v_accvgpr_write_b32 a36, v36
 v_mfma_f32_16x16x32_bf16 v[164:167], a[80:83], a[208:211], v[164:167]
 s_waitcnt lgkmcnt(3)
 ds_read_b64_tr_b16 a[102:103], v9 offset:20480
 v_xor_b32 v10, 320, v6
 v_mfma_f32_16x16x32_bf16 v[164:167], a[84:87], a[216:219], v[164:167]
 ds_read_b64_tr_b16 a[104:105], v10 offset:0
 v_accvgpr_write_b32 a37, v37
 v_mfma_f32_16x16x32_bf16 v[164:167], a[88:91], a[112:115], v[164:167]
 ds_read_b64_tr_b16 a[106:107], v10 offset:4096
 v_accvgpr_write_b32 a38, v38
 v_mfma_f32_16x16x32_bf16 v[164:167], a[92:95], a[120:123], v[164:167]
 ds_read_b64_tr_b16 a[108:109], v10 offset:16384
 v_accvgpr_write_b32 a39, v39
 v_mfma_f32_16x16x32_bf16 v[172:175], a[72:75], a[196:199], v[172:175]
 ds_read_b64_tr_b16 a[110:111], v10 offset:20480
 v_xor_b32 v7, 65856, v6
 v_mfma_f32_16x16x32_bf16 v[172:175], a[76:79], a[204:207], v[172:175]
 ds_read_b64_tr_b16 a[64:65], v7 offset:0
 v_mul_f32 v84, s34, v84
 v_mfma_f32_16x16x32_bf16 v[172:175], a[80:83], a[212:215], v[172:175]
 ds_read_b64_tr_b16 a[66:67], v7 offset:4096
 v_mul_f32 v85, s34, v85
 v_mfma_f32_16x16x32_bf16 v[172:175], a[84:87], a[220:223], v[172:175]
 ds_read_b64_tr_b16 a[68:69], v7 offset:16384
 v_mul_f32 v86, s34, v86
 v_mfma_f32_16x16x32_bf16 v[172:175], a[88:91], a[116:119], v[172:175]
 ds_read_b64_tr_b16 a[70:71], v7 offset:20480
 v_xor_b32 v8, 131424, v6
 v_mfma_f32_16x16x32_bf16 v[172:175], a[92:95], a[124:127], v[172:175]
 s_waitcnt lgkmcnt(6)
 ds_read_b64_tr_b16 a[72:73], v8 offset:0
 v_mul_f32 v87, s34, v87
 v_mfma_f32_16x16x32_bf16 v[180:183], a[96:99], a[192:195], v[180:183]
 ds_read_b64_tr_b16 a[74:75], v8 offset:4096
 v_mul_f32 v100, s34, v100
 v_mfma_f32_16x16x32_bf16 v[180:183], a[100:103], a[200:203], v[180:183]
 ds_read_b64_tr_b16 a[76:77], v8 offset:16384
 v_mul_f32 v101, s34, v101
 v_mfma_f32_16x16x32_bf16 v[180:183], a[104:107], a[208:211], v[180:183]
 s_waitcnt lgkmcnt(3)
 ds_read_b64_tr_b16 a[78:79], v8 offset:20480
 v_xor_b32 v9, 352, v6
 v_mfma_f32_16x16x32_bf16 v[180:183], a[108:111], a[216:219], v[180:183]
 ds_read_b64_tr_b16 a[80:81], v9 offset:0
 v_mul_f32 v102, s34, v102
 v_mfma_f32_16x16x32_bf16 v[180:183], a[64:67], a[112:115], v[180:183]
 ds_read_b64_tr_b16 a[82:83], v9 offset:4096
 v_mul_f32 v103, s34, v103
 v_mfma_f32_16x16x32_bf16 v[180:183], a[68:71], a[120:123], v[180:183]
 ds_read_b64_tr_b16 a[84:85], v9 offset:16384
 v_cvt_pk_bf16_f32 v84, v84, v85
 v_mfma_f32_16x16x32_bf16 v[188:191], a[96:99], a[196:199], v[188:191]
 ds_read_b64_tr_b16 a[86:87], v9 offset:20480
 v_xor_b32 v10, 65888, v6
 v_mfma_f32_16x16x32_bf16 v[188:191], a[100:103], a[204:207], v[188:191]
 ds_read_b64_tr_b16 a[88:89], v10 offset:0
 v_cvt_pk_bf16_f32 v85, v86, v87
 v_mfma_f32_16x16x32_bf16 v[188:191], a[104:107], a[212:215], v[188:191]
 ds_read_b64_tr_b16 a[90:91], v10 offset:4096
 v_cvt_pk_bf16_f32 v86, v100, v101
 v_mfma_f32_16x16x32_bf16 v[188:191], a[108:111], a[220:223], v[188:191]
 ds_read_b64_tr_b16 a[92:93], v10 offset:16384
 v_cvt_pk_bf16_f32 v87, v102, v103
 v_mfma_f32_16x16x32_bf16 v[188:191], a[64:67], a[116:119], v[188:191]
 ds_read_b64_tr_b16 a[94:95], v10 offset:20480
 v_xor_b32 v7, 131456, v6
 v_mfma_f32_16x16x32_bf16 v[188:191], a[68:71], a[124:127], v[188:191]
 s_waitcnt lgkmcnt(6)
 ds_read_b64_tr_b16 a[96:97], v7 offset:0
 v_accvgpr_write_b32 a8, v84
 v_mfma_f32_16x16x32_bf16 v[196:199], a[72:75], a[192:195], v[196:199]
 ds_read_b64_tr_b16 a[98:99], v7 offset:4096
 v_accvgpr_write_b32 a9, v85
 v_mfma_f32_16x16x32_bf16 v[196:199], a[76:79], a[200:203], v[196:199]
 ds_read_b64_tr_b16 a[100:101], v7 offset:16384
 v_accvgpr_write_b32 a10, v86
 v_mfma_f32_16x16x32_bf16 v[196:199], a[80:83], a[208:211], v[196:199]
 s_waitcnt lgkmcnt(3)
 ds_read_b64_tr_b16 a[102:103], v7 offset:20480
 v_xor_b32 v8, 384, v6
 v_mfma_f32_16x16x32_bf16 v[196:199], a[84:87], a[216:219], v[196:199]
 ds_read_b64_tr_b16 a[104:105], v8 offset:0
 v_accvgpr_write_b32 a11, v87
 v_mfma_f32_16x16x32_bf16 v[196:199], a[88:91], a[112:115], v[196:199]
 ds_read_b64_tr_b16 a[106:107], v8 offset:4096
 v_mul_f32 v92, s34, v92
 v_mfma_f32_16x16x32_bf16 v[196:199], a[92:95], a[120:123], v[196:199]
 ds_read_b64_tr_b16 a[108:109], v8 offset:16384
 v_mul_f32 v93, s34, v93
 v_mfma_f32_16x16x32_bf16 v[204:207], a[72:75], a[196:199], v[204:207]
 ds_read_b64_tr_b16 a[110:111], v8 offset:20480
 v_xor_b32 v9, 65920, v6
 v_mfma_f32_16x16x32_bf16 v[204:207], a[76:79], a[204:207], v[204:207]
 ds_read_b64_tr_b16 a[64:65], v9 offset:0
 v_mul_f32 v94, s34, v94
 v_mfma_f32_16x16x32_bf16 v[204:207], a[80:83], a[212:215], v[204:207]
 ds_read_b64_tr_b16 a[66:67], v9 offset:4096
 v_mul_f32 v95, s34, v95
 v_mfma_f32_16x16x32_bf16 v[204:207], a[84:87], a[220:223], v[204:207]
 ds_read_b64_tr_b16 a[68:69], v9 offset:16384
 v_mul_f32 v108, s34, v108
 v_mfma_f32_16x16x32_bf16 v[204:207], a[88:91], a[116:119], v[204:207]
 ds_read_b64_tr_b16 a[70:71], v9 offset:20480
 v_xor_b32 v10, 131488, v6
 v_mfma_f32_16x16x32_bf16 v[204:207], a[92:95], a[124:127], v[204:207]
 s_waitcnt lgkmcnt(6)
 ds_read_b64_tr_b16 a[72:73], v10 offset:0
 v_mul_f32 v109, s34, v109
 v_mfma_f32_16x16x32_bf16 v[212:215], a[96:99], a[192:195], v[212:215]
 ds_read_b64_tr_b16 a[74:75], v10 offset:4096
 v_mul_f32 v110, s34, v110
 v_mfma_f32_16x16x32_bf16 v[212:215], a[100:103], a[200:203], v[212:215]
 ds_read_b64_tr_b16 a[76:77], v10 offset:16384
 v_mul_f32 v111, s34, v111
 v_mfma_f32_16x16x32_bf16 v[212:215], a[104:107], a[208:211], v[212:215]
 s_waitcnt lgkmcnt(3)
 ds_read_b64_tr_b16 a[78:79], v10 offset:20480
 v_xor_b32 v7, 416, v6
 v_mfma_f32_16x16x32_bf16 v[212:215], a[108:111], a[216:219], v[212:215]
 ds_read_b64_tr_b16 a[80:81], v7 offset:0
 v_cvt_pk_bf16_f32 v92, v92, v93
 v_mfma_f32_16x16x32_bf16 v[212:215], a[64:67], a[112:115], v[212:215]
 ds_read_b64_tr_b16 a[82:83], v7 offset:4096
 v_cvt_pk_bf16_f32 v93, v94, v95
 v_mfma_f32_16x16x32_bf16 v[212:215], a[68:71], a[120:123], v[212:215]
 ds_read_b64_tr_b16 a[84:85], v7 offset:16384
 v_cvt_pk_bf16_f32 v94, v108, v109
 v_mfma_f32_16x16x32_bf16 v[220:223], a[96:99], a[196:199], v[220:223]
 ds_read_b64_tr_b16 a[86:87], v7 offset:20480
 v_xor_b32 v8, 65952, v6
 v_mfma_f32_16x16x32_bf16 v[220:223], a[100:103], a[204:207], v[220:223]
 ds_read_b64_tr_b16 a[88:89], v8 offset:0
 v_cvt_pk_bf16_f32 v95, v110, v111
 v_mfma_f32_16x16x32_bf16 v[220:223], a[104:107], a[212:215], v[220:223]
 ds_read_b64_tr_b16 a[90:91], v8 offset:4096
 v_accvgpr_write_b32 a40, v92
 v_mfma_f32_16x16x32_bf16 v[220:223], a[108:111], a[220:223], v[220:223]
 ds_read_b64_tr_b16 a[92:93], v8 offset:16384
 v_accvgpr_write_b32 a41, v93
 v_mfma_f32_16x16x32_bf16 v[220:223], a[64:67], a[116:119], v[220:223]
 ds_read_b64_tr_b16 a[94:95], v8 offset:20480
 v_xor_b32 v9, 131520, v6
 v_mfma_f32_16x16x32_bf16 v[220:223], a[68:71], a[124:127], v[220:223]
 s_waitcnt lgkmcnt(6)
 ds_read_b64_tr_b16 a[96:97], v9 offset:0
 v_accvgpr_write_b32 a42, v94
 v_mfma_f32_16x16x32_bf16 v[228:231], a[72:75], a[192:195], v[228:231]
 ds_read_b64_tr_b16 a[98:99], v9 offset:4096
 v_accvgpr_write_b32 a43, v95
 v_mfma_f32_16x16x32_bf16 v[228:231], a[76:79], a[200:203], v[228:231]
 ds_read_b64_tr_b16 a[100:101], v9 offset:16384
 v_mul_f32 v116, s34, v116
 v_mfma_f32_16x16x32_bf16 v[228:231], a[80:83], a[208:211], v[228:231]
 s_waitcnt lgkmcnt(3)
 ds_read_b64_tr_b16 a[102:103], v9 offset:20480
 v_xor_b32 v10, 448, v6
 v_mfma_f32_16x16x32_bf16 v[228:231], a[84:87], a[216:219], v[228:231]
 ds_read_b64_tr_b16 a[104:105], v10 offset:0
 v_mul_f32 v117, s34, v117
 v_mfma_f32_16x16x32_bf16 v[228:231], a[88:91], a[112:115], v[228:231]
 ds_read_b64_tr_b16 a[106:107], v10 offset:4096
 v_mul_f32 v118, s34, v118
 v_mfma_f32_16x16x32_bf16 v[228:231], a[92:95], a[120:123], v[228:231]
 ds_read_b64_tr_b16 a[108:109], v10 offset:16384
 v_mul_f32 v119, s34, v119
 v_mfma_f32_16x16x32_bf16 v[236:239], a[72:75], a[196:199], v[236:239]
 ds_read_b64_tr_b16 a[110:111], v10 offset:20480
 v_xor_b32 v7, 65984, v6
 v_mfma_f32_16x16x32_bf16 v[236:239], a[76:79], a[204:207], v[236:239]
 ds_read_b64_tr_b16 a[64:65], v7 offset:0
 buffer_load_dword v13, v12, s[12:15], s58 offen sc1
 v_mfma_f32_16x16x32_bf16 v[236:239], a[80:83], a[212:215], v[236:239]
 ds_read_b64_tr_b16 a[66:67], v7 offset:4096
 v_mul_f32 v132, s34, v132
 v_mfma_f32_16x16x32_bf16 v[236:239], a[84:87], a[220:223], v[236:239]
 ds_read_b64_tr_b16 a[68:69], v7 offset:16384
 v_mul_f32 v133, s34, v133
 v_mfma_f32_16x16x32_bf16 v[236:239], a[88:91], a[116:119], v[236:239]
 ds_read_b64_tr_b16 a[70:71], v7 offset:20480
 v_xor_b32 v8, 131552, v6
 v_mfma_f32_16x16x32_bf16 v[236:239], a[92:95], a[124:127], v[236:239]
 s_waitcnt lgkmcnt(6)
 ds_read_b64_tr_b16 a[72:73], v8 offset:0
 v_mul_f32 v134, s34, v134
 v_mfma_f32_16x16x32_bf16 v[244:247], a[96:99], a[192:195], v[244:247]
 ds_read_b64_tr_b16 a[74:75], v8 offset:4096
 v_mul_f32 v135, s34, v135
 v_mfma_f32_16x16x32_bf16 v[244:247], a[100:103], a[200:203], v[244:247]
 ds_read_b64_tr_b16 a[76:77], v8 offset:16384
 v_cvt_pk_bf16_f32 v116, v116, v117
 v_mfma_f32_16x16x32_bf16 v[244:247], a[104:107], a[208:211], v[244:247]
 s_waitcnt lgkmcnt(3)
 ds_read_b64_tr_b16 a[78:79], v8 offset:20480
 v_xor_b32 v9, 480, v6
 v_mfma_f32_16x16x32_bf16 v[244:247], a[108:111], a[216:219], v[244:247]
 ds_read_b64_tr_b16 a[80:81], v9 offset:0
 v_cvt_pk_bf16_f32 v117, v118, v119
 v_mfma_f32_16x16x32_bf16 v[244:247], a[64:67], a[112:115], v[244:247]
 ds_read_b64_tr_b16 a[82:83], v9 offset:4096
 v_cvt_pk_bf16_f32 v118, v132, v133
 v_mfma_f32_16x16x32_bf16 v[244:247], a[68:71], a[120:123], v[244:247]
 ds_read_b64_tr_b16 a[84:85], v9 offset:16384
 v_cvt_pk_bf16_f32 v119, v134, v135
 v_mfma_f32_16x16x32_bf16 v[252:255], a[96:99], a[196:199], v[252:255]
 ds_read_b64_tr_b16 a[86:87], v9 offset:20480
 v_xor_b32 v10, 66016, v6
 v_mfma_f32_16x16x32_bf16 v[252:255], a[100:103], a[204:207], v[252:255]
 ds_read_b64_tr_b16 a[88:89], v10 offset:0
 v_accvgpr_write_b32 a12, v116
 v_mfma_f32_16x16x32_bf16 v[252:255], a[104:107], a[212:215], v[252:255]
 ds_read_b64_tr_b16 a[90:91], v10 offset:4096
 v_accvgpr_write_b32 a13, v117
 v_mfma_f32_16x16x32_bf16 v[252:255], a[108:111], a[220:223], v[252:255]
 ds_read_b64_tr_b16 a[92:93], v10 offset:16384
 v_accvgpr_write_b32 a14, v118
 v_mfma_f32_16x16x32_bf16 v[252:255], a[64:67], a[116:119], v[252:255]
 ds_read_b64_tr_b16 a[94:95], v10 offset:20480
 v_accvgpr_write_b32 a15, v119
 v_mfma_f32_16x16x32_bf16 v[252:255], a[68:71], a[124:127], v[252:255]
 s_waitcnt lgkmcnt(6)
 v_mfma_f32_16x16x32_bf16 v[16:19], a[72:75], a[192:195], v[16:19]
 v_mfma_f32_16x16x32_bf16 v[16:19], a[76:79], a[200:203], v[16:19]
 v_mfma_f32_16x16x32_bf16 v[16:19], a[80:83], a[208:211], v[16:19]
 s_waitcnt lgkmcnt(0)
 v_mfma_f32_16x16x32_bf16 v[16:19], a[84:87], a[216:219], v[16:19]
 v_mfma_f32_16x16x32_bf16 v[16:19], a[88:91], a[112:115], v[16:19]
 v_mfma_f32_16x16x32_bf16 v[16:19], a[92:95], a[120:123], v[16:19]
 v_mfma_f32_16x16x32_bf16 v[24:27], a[72:75], a[196:199], v[24:27]
 v_mfma_f32_16x16x32_bf16 v[24:27], a[76:79], a[204:207], v[24:27]
 v_mfma_f32_16x16x32_bf16 v[24:27], a[80:83], a[212:215], v[24:27]
 v_mfma_f32_16x16x32_bf16 v[24:27], a[84:87], a[220:223], v[24:27]
 s_waitcnt lgkmcnt(0)
 v_mfma_f32_16x16x32_bf16 v[24:27], a[88:91], a[116:119], v[24:27]
 s_barrier
 v_mfma_f32_16x16x32_bf16 v[24:27], a[92:95], a[124:127], v[24:27]
 s_waitcnt vmcnt(0)
 v_cmp_ne_u32 s[16:17], 0, v13
 v_cmp_gt_u32 vcc, 256, v5
 s_or_b64 vcc, vcc, s[16:17]
 s_mov_b32 m0, s40
 s_cselect_b32 s48, 0, 1
 s_cselect_b32 s52, 2.0, s42
 buffer_load_dwordx4 v1, s[12:15], s52 offen offset:0 sc1 lds
 v_pk_mul_f32 v[124:125], v[124:125], s[34:35]
 v_pk_mul_f32 v[126:127], v[126:127], s[34:35]
 v_pk_mul_f32 v[140:141], v[140:141], s[34:35]
 v_pk_mul_f32 v[142:143], v[142:143], s[34:35]
 v_cvt_pk_bf16_f32 v124, v124, v125
 v_cvt_pk_bf16_f32 v125, v126, v127
 v_cvt_pk_bf16_f32 v126, v140, v141
 v_cvt_pk_bf16_f32 v127, v142, v143
 v_accvgpr_write_b32 a44, v124
 v_accvgpr_write_b32 a45, v125
 v_accvgpr_write_b32 a46, v126
 v_accvgpr_write_b32 a47, v127
 v_pk_mul_f32 v[148:149], v[148:149], s[34:35]
 v_pk_mul_f32 v[150:151], v[150:151], s[34:35]
 buffer_load_dwordx4 v1, s[12:15], s52 offen offset:1024 sc1 lds
 v_pk_mul_f32 v[164:165], v[164:165], s[34:35]
 v_pk_mul_f32 v[166:167], v[166:167], s[34:35]
 v_cvt_pk_bf16_f32 v148, v148, v149
 v_cvt_pk_bf16_f32 v149, v150, v151
 v_cvt_pk_bf16_f32 v150, v164, v165
 v_cvt_pk_bf16_f32 v151, v166, v167
 v_accvgpr_write_b32 a16, v148
 v_accvgpr_write_b32 a17, v149
 v_accvgpr_write_b32 a18, v150
 v_accvgpr_write_b32 a19, v151
 v_pk_mul_f32 v[156:157], v[156:157], s[34:35]
 v_pk_mul_f32 v[158:159], v[158:159], s[34:35]
 v_pk_mul_f32 v[172:173], v[172:173], s[34:35]
 buffer_load_dwordx4 v1, s[12:15], s52 offen offset:2048 sc1 lds
 v_pk_mul_f32 v[174:175], v[174:175], s[34:35]
 v_cvt_pk_bf16_f32 v156, v156, v157
 v_cvt_pk_bf16_f32 v157, v158, v159
 v_cvt_pk_bf16_f32 v158, v172, v173
 v_cvt_pk_bf16_f32 v159, v174, v175
 v_accvgpr_write_b32 a48, v156
 v_accvgpr_write_b32 a49, v157
 v_accvgpr_write_b32 a50, v158
 v_accvgpr_write_b32 a51, v159
 v_pk_mul_f32 v[180:181], v[180:181], s[34:35]
 v_pk_mul_f32 v[182:183], v[182:183], s[34:35]
 v_pk_mul_f32 v[196:197], v[196:197], s[34:35]
 v_pk_mul_f32 v[198:199], v[198:199], s[34:35]
 v_cvt_pk_bf16_f32 v180, v180, v181
 buffer_load_dwordx4 v1, s[12:15], s52 offen offset:3072 sc1 lds
 v_cvt_pk_bf16_f32 v181, v182, v183
 v_cvt_pk_bf16_f32 v182, v196, v197
 v_cvt_pk_bf16_f32 v183, v198, v199
 v_accvgpr_write_b32 a20, v180
 v_accvgpr_write_b32 a21, v181
 v_accvgpr_write_b32 a22, v182
 v_accvgpr_write_b32 a23, v183
 v_pk_mul_f32 v[188:189], v[188:189], s[34:35]
 v_pk_mul_f32 v[190:191], v[190:191], s[34:35]
 v_pk_mul_f32 v[204:205], v[204:205], s[34:35]
 v_pk_mul_f32 v[206:207], v[206:207], s[34:35]
 v_cvt_pk_bf16_f32 v188, v188, v189
 v_cvt_pk_bf16_f32 v189, v190, v191
 s_bitset1_b32 m0, 12
 s_nop 0
 buffer_load_dwordx4 v4, s[12:15], s52 offen offset:0 sc1 lds
 v_cvt_pk_bf16_f32 v190, v204, v205
 v_cvt_pk_bf16_f32 v191, v206, v207
 v_accvgpr_write_b32 a52, v188
 v_accvgpr_write_b32 a53, v189
 v_accvgpr_write_b32 a54, v190
 v_accvgpr_write_b32 a55, v191
 v_pk_mul_f32 v[212:213], v[212:213], s[34:35]
 v_pk_mul_f32 v[214:215], v[214:215], s[34:35]
 v_pk_mul_f32 v[228:229], v[228:229], s[34:35]
 v_pk_mul_f32 v[230:231], v[230:231], s[34:35]
 v_cvt_pk_bf16_f32 v212, v212, v213
 v_cvt_pk_bf16_f32 v213, v214, v215
 v_cvt_pk_bf16_f32 v214, v228, v229
 v_cvt_pk_bf16_f32 v215, v230, v231
 buffer_load_dwordx4 v4, s[12:15], s52 offen offset:1024 sc1 lds
 v_accvgpr_write_b32 a24, v212
 v_accvgpr_write_b32 a25, v213
 v_accvgpr_write_b32 a26, v214
 v_accvgpr_write_b32 a27, v215
 v_pk_mul_f32 v[220:221], v[220:221], s[34:35]
 v_pk_mul_f32 v[222:223], v[222:223], s[34:35]
 v_pk_mul_f32 v[236:237], v[236:237], s[34:35]
 v_pk_mul_f32 v[238:239], v[238:239], s[34:35]
 v_cvt_pk_bf16_f32 v220, v220, v221
 v_cvt_pk_bf16_f32 v221, v222, v223
 v_cvt_pk_bf16_f32 v222, v236, v237
 v_cvt_pk_bf16_f32 v223, v238, v239
 v_accvgpr_write_b32 a56, v220
 buffer_load_dwordx4 v4, s[12:15], s52 offen offset:2048 sc1 lds
 v_accvgpr_write_b32 a57, v221
 v_accvgpr_write_b32 a58, v222
 v_accvgpr_write_b32 a59, v223
 v_pk_mul_f32 v[244:245], v[244:245], s[34:35]
 v_pk_mul_f32 v[246:247], v[246:247], s[34:35]
 v_pk_mul_f32 v[16:17], v[16:17], s[34:35]
 v_pk_mul_f32 v[18:19], v[18:19], s[34:35]
 v_cvt_pk_bf16_f32 v244, v244, v245
 v_cvt_pk_bf16_f32 v245, v246, v247
 v_cvt_pk_bf16_f32 v246, v16, v17
 v_cvt_pk_bf16_f32 v247, v18, v19
 v_accvgpr_write_b32 a28, v244
 v_accvgpr_write_b32 a29, v245
 v_accvgpr_write_b32 a30, v246
 buffer_load_dwordx4 v4, s[12:15], s52 offen offset:3072 sc1 lds
 v_accvgpr_write_b32 a31, v247
 v_pk_mul_f32 v[252:253], v[252:253], s[34:35]
 v_pk_mul_f32 v[254:255], v[254:255], s[34:35]
 v_pk_mul_f32 v[24:25], v[24:25], s[34:35]
 v_pk_mul_f32 v[26:27], v[26:27], s[34:35]
 v_cvt_pk_bf16_f32 v252, v252, v253
 v_cvt_pk_bf16_f32 v253, v254, v255
 v_cvt_pk_bf16_f32 v254, v24, v25
 v_cvt_pk_bf16_f32 v255, v26, v27
 v_accvgpr_write_b32 a60, v252
 v_accvgpr_write_b32 a61, v253
 v_accvgpr_write_b32 a62, v254
 v_accvgpr_write_b32 a63, v255
 s_branch L_kvdone
L_late0:
 v_mfma_f32_16x16x32_bf16 a[232:235], a[0:3], a[96:99], a[232:235]
 ds_read_b64_tr_b16 a[28:29], v9 offset:49152
 v_mfma_f32_16x16x32_bf16 a[232:235], a[4:7], a[100:103], a[232:235]
 s_add_u32 m0, s33, 0xfffffd00
 ds_read_b64_tr_b16 a[30:31], v9 offset:53248
 v_mfma_f32_16x16x32_bf16 a[224:227], a[4:7], a[108:111], a[224:227]
 s_waitcnt lgkmcnt(15)
 ds_read_b128 a[64:67], v4 offset:32768
 v_mfma_f32_16x16x32_bf16 a[224:227], a[0:3], a[104:107], a[224:227]
 buffer_load_dwordx4 v15, s[20:23], 0 offen offset:768 lds
 v_mfma_f32_16x16x32_bf16 v[24:27], a[0:3], a[112:115], v[24:27]
 s_waitcnt lgkmcnt(13)
 ds_read_b128 a[68:71], v5 offset:32768
 v_mfma_f32_16x16x32_bf16 v[24:27], a[4:7], a[116:119], v[24:27]
 v_mfma_f32_16x16x32_bf16 v[16:19], a[4:7], a[124:127], v[16:19]
 s_add_u32 m0, s33, 0xfffffd80
 ds_read_b128 a[76:79], v5 offset:34816
 v_mfma_f32_16x16x32_bf16 v[16:19], a[0:3], a[120:123], v[16:19]
 s_waitcnt lgkmcnt(11)
 buffer_load_dwordx4 v15, s[20:23], 0 offen offset:1664 lds
 v_mfma_f32_16x16x32_bf16 v[20:23], a[8:11], a[120:123], v[20:23]
 ds_read_b128 a[72:75], v4 offset:34816
 v_mfma_f32_16x16x32_bf16 v[20:23], a[12:15], a[124:127], v[20:23]
 v_mfma_f32_16x16x32_bf16 v[28:31], a[12:15], a[116:119], v[28:31]
 s_add_u32 m0, s33, 0x500
 ds_read_b128 a[80:83], v4 offset:36864
 v_mfma_f32_16x16x32_bf16 v[28:31], a[8:11], a[112:115], v[28:31]
 buffer_load_dwordx4 v15, s[20:23], s57 offen offset:768 lds
 v_mfma_f32_16x16x32_bf16 a[228:231], a[8:11], a[104:107], a[228:231]
 ds_read_b128 a[84:87], v5 offset:36864
 v_mfma_f32_16x16x32_bf16 a[228:231], a[12:15], a[108:111], a[228:231]
 v_mfma_f32_16x16x32_bf16 a[236:239], a[12:15], a[100:103], a[236:239]
 s_add_u32 m0, s33, 0x580
 ds_read_b128 a[92:95], v5 offset:38912
 v_mfma_f32_16x16x32_bf16 a[236:239], a[8:11], a[96:99], a[236:239]
 s_waitcnt lgkmcnt(11)
 buffer_load_dwordx4 v15, s[20:23], s57 offen offset:1664 lds
 v_mfma_f32_16x16x32_bf16 v[56:59], a[16:19], a[96:99], v[56:59]
 ds_read_b128 a[88:91], v4 offset:38912
 v_mfma_f32_16x16x32_bf16 v[56:59], a[20:23], a[100:103], v[56:59]
 v_cvt_pk_bf16_f32 v16, v16, v17
 v_cvt_pk_bf16_f32 v17, v18, v19
 v_mfma_f32_16x16x32_bf16 v[48:51], a[20:23], a[108:111], v[48:51]
 ds_read_b64_tr_b16 a[32:33], v10 offset:32768
 v_cvt_pk_bf16_f32 v18, v20, v21
 v_mfma_f32_16x16x32_bf16 v[48:51], a[16:19], a[104:107], v[48:51]
 ds_read_b64_tr_b16 a[34:35], v10 offset:36864
 v_cvt_pk_bf16_f32 v19, v22, v23
 v_mfma_f32_16x16x32_bf16 v[40:43], a[16:19], a[112:115], v[40:43]
 ds_read_b64_tr_b16 a[36:37], v10 offset:49152
 v_cvt_pk_bf16_f32 v24, v24, v25
 v_mfma_f32_16x16x32_bf16 v[40:43], a[20:23], a[116:119], v[40:43]
 ds_read_b64_tr_b16 a[38:39], v10 offset:53248
 v_cvt_pk_bf16_f32 v25, v26, v27
 v_mfma_f32_16x16x32_bf16 v[32:35], a[20:23], a[124:127], v[32:35]
 s_add_u32 s59, s56, 57344
 ds_read_b64_tr_b16 a[40:41], v11 offset:32768
 v_cvt_pk_bf16_f32 v26, v28, v29
 v_mfma_f32_16x16x32_bf16 v[32:35], a[16:19], a[120:123], v[32:35]
 s_waitcnt lgkmcnt(13)
 ds_read_b64_tr_b16 a[42:43], v11 offset:36864
 v_cvt_pk_bf16_f32 v27, v30, v31
 v_mfma_f32_16x16x32_bf16 v[36:39], a[24:27], a[120:123], v[36:39]
 ds_read_b64_tr_b16 a[44:45], v11 offset:49152
 buffer_store_dwordx4 v[16:19], v1, s[12:15], s59 offen offset:0 sc1
 v_mfma_f32_16x16x32_bf16 v[36:39], a[28:31], a[124:127], v[36:39]
 ds_read_b64_tr_b16 a[46:47], v11 offset:53248
 v_accvgpr_read_b32 v20, a224
 v_mfma_f32_16x16x32_bf16 v[44:47], a[28:31], a[116:119], v[44:47]
 ds_read_b64_tr_b16 a[48:49], v12 offset:32768
 v_accvgpr_read_b32 v21, a225
 v_mfma_f32_16x16x32_bf16 v[44:47], a[24:27], a[112:115], v[44:47]
 ds_read_b64_tr_b16 a[50:51], v12 offset:36864
 v_accvgpr_read_b32 v22, a226
 v_mfma_f32_16x16x32_bf16 v[52:55], a[24:27], a[104:107], v[52:55]
 ds_read_b64_tr_b16 a[52:53], v12 offset:49152
 v_accvgpr_read_b32 v23, a227
 v_mfma_f32_16x16x32_bf16 v[52:55], a[28:31], a[108:111], v[52:55]
 ds_read_b64_tr_b16 a[54:55], v12 offset:53248
 v_accvgpr_read_b32 v28, a228
 v_mfma_f32_16x16x32_bf16 v[60:63], a[28:31], a[100:103], v[60:63]
 s_add_u32 s59, s56, 49152
 ds_read_b64_tr_b16 a[56:57], v13 offset:32768
 v_accvgpr_read_b32 v29, a229
 v_mfma_f32_16x16x32_bf16 v[60:63], a[24:27], a[96:99], v[60:63]
 s_waitcnt lgkmcnt(15)
 ds_read_b64_tr_b16 a[58:59], v13 offset:36864
 buffer_store_dwordx4 v[24:27], v1, s[12:15], s59 offen offset:0 sc1
 v_mfma_f32_16x16x32_bf16 v[88:91], a[0:3], a[64:67], v[88:91]
 ds_read_b64_tr_b16 a[60:61], v13 offset:49152
 v_accvgpr_read_b32 v30, a230
 v_mfma_f32_16x16x32_bf16 v[88:91], a[4:7], a[68:71], v[88:91]
 ds_read_b64_tr_b16 a[62:63], v13 offset:53248
 v_accvgpr_read_b32 v31, a231
 v_mfma_f32_16x16x32_bf16 v[80:83], a[4:7], a[76:79], v[80:83]
 v_cvt_pk_bf16_f32 v20, v20, v21
 v_cvt_pk_bf16_f32 v21, v22, v23
 v_mfma_f32_16x16x32_bf16 v[80:83], a[0:3], a[72:75], v[80:83]
 v_cvt_pk_bf16_f32 v22, v28, v29
 v_cvt_pk_bf16_f32 v23, v30, v31
 v_mfma_f32_16x16x32_bf16 v[72:75], a[0:3], a[80:83], v[72:75]
 s_add_u32 s59, s56, 40960
 v_cvt_pk_bf16_f32 v32, v32, v33
 v_cvt_pk_bf16_f32 v33, v34, v35
 v_mfma_f32_16x16x32_bf16 v[72:75], a[4:7], a[84:87], v[72:75]
 s_waitcnt lgkmcnt(15)
 v_cvt_pk_bf16_f32 v34, v36, v37
 v_cvt_pk_bf16_f32 v35, v38, v39
 v_mfma_f32_16x16x32_bf16 v[64:67], a[4:7], a[92:95], v[64:67]
 buffer_store_dwordx4 v[20:23], v1, s[12:15], s59 offen offset:0 sc1
 v_mfma_f32_16x16x32_bf16 v[64:67], a[0:3], a[88:91], v[64:67]
 s_waitcnt lgkmcnt(0)
 v_cvt_pk_bf16_f32 v40, v40, v41
 v_cvt_pk_bf16_f32 v41, v42, v43
 v_mfma_f32_16x16x32_bf16 v[68:71], a[8:11], a[88:91], v[68:71]
 s_barrier
 v_xor_b32 v6, s60, v6
 v_cvt_pk_bf16_f32 v42, v44, v45
 v_mfma_f32_16x16x32_bf16 v[68:71], a[12:15], a[92:95], v[68:71]
 s_add_u32 m0, s29, 32768
 v_add_u32 v2, 0x80000, v2
 v_cvt_pk_bf16_f32 v43, v46, v47
 v_mfma_f32_16x16x32_bf16 v[76:79], a[12:15], a[84:87], v[76:79]
 buffer_load_dwordx4 v2, s[16:19], 0 offen lds
 v_mfma_f32_16x16x32_bf16 v[76:79], a[8:11], a[80:83], v[76:79]
 v_accvgpr_read_b32 v36, a232
 v_accvgpr_read_b32 v37, a233
 v_mfma_f32_16x16x32_bf16 v[84:87], a[8:11], a[72:75], v[84:87]
 v_accvgpr_read_b32 v38, a234
 v_accvgpr_read_b32 v39, a235
 v_mfma_f32_16x16x32_bf16 v[84:87], a[12:15], a[76:79], v[84:87]
 v_accvgpr_read_b32 v44, a236
 v_accvgpr_read_b32 v45, a237
 v_mfma_f32_16x16x32_bf16 v[92:95], a[12:15], a[68:71], v[92:95]
 s_add_u32 m0, s29, 36864
 v_accvgpr_read_b32 v46, a238
 v_accvgpr_read_b32 v47, a239
 v_mfma_f32_16x16x32_bf16 v[92:95], a[8:11], a[64:67], v[92:95]
 buffer_load_dwordx4 v2, s[16:19], s48 offen lds
 v_mfma_f32_16x16x32_bf16 v[120:123], a[16:19], a[64:67], v[120:123]
 v_cvt_pk_bf16_f32 v36, v36, v37
 v_cvt_pk_bf16_f32 v37, v38, v39
 v_mfma_f32_16x16x32_bf16 v[120:123], a[20:23], a[68:71], v[120:123]
 v_cvt_pk_bf16_f32 v38, v44, v45
 v_cvt_pk_bf16_f32 v39, v46, v47
 v_mfma_f32_16x16x32_bf16 v[112:115], a[20:23], a[76:79], v[112:115]
 v_cvt_pk_bf16_f32 v48, v48, v49
 v_cvt_pk_bf16_f32 v49, v50, v51
 v_mfma_f32_16x16x32_bf16 v[112:115], a[16:19], a[72:75], v[112:115]
 s_add_u32 m0, s29, 40960
 v_cvt_pk_bf16_f32 v50, v52, v53
 v_cvt_pk_bf16_f32 v51, v54, v55
 v_mfma_f32_16x16x32_bf16 v[104:107], a[16:19], a[80:83], v[104:107]
 buffer_load_dwordx4 v2, s[16:19], s49 offen lds
 v_mfma_f32_16x16x32_bf16 v[104:107], a[20:23], a[84:87], v[104:107]
 v_cvt_pk_bf16_f32 v56, v56, v57
 v_cvt_pk_bf16_f32 v57, v58, v59
 v_mfma_f32_16x16x32_bf16 v[96:99], a[20:23], a[92:95], v[96:99]
 v_cvt_pk_bf16_f32 v58, v60, v61
 v_cvt_pk_bf16_f32 v59, v62, v63
 v_mfma_f32_16x16x32_bf16 v[96:99], a[16:19], a[88:91], v[96:99]
 v_cvt_pk_bf16_f32 v64, v64, v65
 v_cvt_pk_bf16_f32 v65, v66, v67
 v_mfma_f32_16x16x32_bf16 v[100:103], a[24:27], a[88:91], v[100:103]
 s_add_u32 m0, s29, 45056
 v_cvt_pk_bf16_f32 v66, v68, v69
 v_cvt_pk_bf16_f32 v67, v70, v71
 v_mfma_f32_16x16x32_bf16 v[100:103], a[28:31], a[92:95], v[100:103]
 buffer_load_dwordx4 v2, s[16:19], s50 offen lds
 v_mfma_f32_16x16x32_bf16 v[108:111], a[28:31], a[84:87], v[108:111]
 s_add_u32 s59, s56, 32768
 v_cvt_pk_bf16_f32 v72, v72, v73
 v_cvt_pk_bf16_f32 v73, v74, v75
 v_mfma_f32_16x16x32_bf16 v[108:111], a[24:27], a[80:83], v[108:111]
 buffer_store_dwordx4 v[36:39], v1, s[12:15], s59 offen offset:0 sc1
 v_mfma_f32_16x16x32_bf16 v[116:119], a[24:27], a[72:75], v[116:119]
 v_cvt_pk_bf16_f32 v74, v76, v77
 v_cvt_pk_bf16_f32 v75, v78, v79
 v_mfma_f32_16x16x32_bf16 v[116:119], a[28:31], a[76:79], v[116:119]
 s_add_u32 m0, s29, 49152
 v_cvt_pk_bf16_f32 v80, v80, v81
 v_cvt_pk_bf16_f32 v81, v82, v83
 v_mfma_f32_16x16x32_bf16 v[124:127], a[28:31], a[68:71], v[124:127]
 buffer_load_dwordx4 v2, s[16:19], s51 offen lds
 v_mfma_f32_16x16x32_bf16 v[124:127], a[24:27], a[64:67], v[124:127]
 v_cvt_pk_bf16_f32 v82, v84, v85
 v_cvt_pk_bf16_f32 v83, v86, v87
 v_mfma_f32_16x16x32_bf16 v[152:155], a[32:35], a[64:67], v[152:155]
 v_cvt_pk_bf16_f32 v88, v88, v89
 v_cvt_pk_bf16_f32 v89, v90, v91
 v_mfma_f32_16x16x32_bf16 v[152:155], a[36:39], a[68:71], v[152:155]
 v_cvt_pk_bf16_f32 v90, v92, v93
 v_cvt_pk_bf16_f32 v91, v94, v95
 v_mfma_f32_16x16x32_bf16 v[144:147], a[36:39], a[76:79], v[144:147]
 s_add_u32 m0, s29, 53248
 v_cvt_pk_bf16_f32 v96, v96, v97
 v_cvt_pk_bf16_f32 v97, v98, v99
 v_mfma_f32_16x16x32_bf16 v[144:147], a[32:35], a[72:75], v[144:147]
 buffer_load_dwordx4 v2, s[16:19], s52 offen lds
 v_mfma_f32_16x16x32_bf16 v[136:139], a[32:35], a[80:83], v[136:139]
 v_cvt_pk_bf16_f32 v98, v100, v101
 v_cvt_pk_bf16_f32 v99, v102, v103
 v_mfma_f32_16x16x32_bf16 v[136:139], a[36:39], a[84:87], v[136:139]
 v_cvt_pk_bf16_f32 v104, v104, v105
 v_cvt_pk_bf16_f32 v105, v106, v107
 v_mfma_f32_16x16x32_bf16 v[128:131], a[36:39], a[92:95], v[128:131]
 v_cvt_pk_bf16_f32 v106, v108, v109
 v_cvt_pk_bf16_f32 v107, v110, v111
 v_mfma_f32_16x16x32_bf16 v[128:131], a[32:35], a[88:91], v[128:131]
 s_add_u32 m0, s29, 57344
 v_cvt_pk_bf16_f32 v112, v112, v113
 v_cvt_pk_bf16_f32 v113, v114, v115
 v_mfma_f32_16x16x32_bf16 v[132:135], a[40:43], a[88:91], v[132:135]
 buffer_load_dwordx4 v2, s[16:19], s53 offen lds
 v_mfma_f32_16x16x32_bf16 v[132:135], a[44:47], a[92:95], v[132:135]
 v_cvt_pk_bf16_f32 v114, v116, v117
 v_cvt_pk_bf16_f32 v115, v118, v119
 v_mfma_f32_16x16x32_bf16 v[140:143], a[44:47], a[84:87], v[140:143]
 v_cvt_pk_bf16_f32 v120, v120, v121
 v_cvt_pk_bf16_f32 v121, v122, v123
 v_mfma_f32_16x16x32_bf16 v[140:143], a[40:43], a[80:83], v[140:143]
 v_cvt_pk_bf16_f32 v122, v124, v125
 v_cvt_pk_bf16_f32 v123, v126, v127
 v_mfma_f32_16x16x32_bf16 v[148:151], a[40:43], a[72:75], v[148:151]
 s_add_u32 m0, s29, 61440
 v_mfma_f32_16x16x32_bf16 v[148:151], a[44:47], a[76:79], v[148:151]
 buffer_load_dwordx4 v2, s[16:19], s54 offen lds
 v_mfma_f32_16x16x32_bf16 v[156:159], a[44:47], a[68:71], v[156:159]
 v_mfma_f32_16x16x32_bf16 v[156:159], a[40:43], a[64:67], v[156:159]
 v_mfma_f32_16x16x32_bf16 v[184:187], a[48:51], a[64:67], v[184:187]
 s_add_u32 m0, s29, 98304
 v_add_u32 v2, 0x80000, v2
 v_mfma_f32_16x16x32_bf16 v[184:187], a[52:55], a[68:71], v[184:187]
 buffer_load_dwordx4 v2, s[16:19], 0 offen lds
 v_mfma_f32_16x16x32_bf16 v[176:179], a[52:55], a[76:79], v[176:179]
 v_cvt_pk_bf16_f32 v128, v128, v129
 v_cvt_pk_bf16_f32 v129, v130, v131
 v_mfma_f32_16x16x32_bf16 v[176:179], a[48:51], a[72:75], v[176:179]
 v_cvt_pk_bf16_f32 v130, v132, v133
 v_cvt_pk_bf16_f32 v131, v134, v135
 v_mfma_f32_16x16x32_bf16 v[168:171], a[48:51], a[80:83], v[168:171]
 v_cvt_pk_bf16_f32 v136, v136, v137
 v_cvt_pk_bf16_f32 v137, v138, v139
 v_mfma_f32_16x16x32_bf16 v[168:171], a[52:55], a[84:87], v[168:171]
 s_add_u32 m0, s29, 102400
 v_cvt_pk_bf16_f32 v138, v140, v141
 v_cvt_pk_bf16_f32 v139, v142, v143
 v_mfma_f32_16x16x32_bf16 v[160:163], a[52:55], a[92:95], v[160:163]
 buffer_load_dwordx4 v2, s[16:19], s48 offen lds
 v_mfma_f32_16x16x32_bf16 v[160:163], a[48:51], a[88:91], v[160:163]
 v_cvt_pk_bf16_f32 v144, v144, v145
 v_cvt_pk_bf16_f32 v145, v146, v147
 v_mfma_f32_16x16x32_bf16 v[164:167], a[56:59], a[88:91], v[164:167]
 v_cvt_pk_bf16_f32 v146, v148, v149
 v_cvt_pk_bf16_f32 v147, v150, v151
 v_mfma_f32_16x16x32_bf16 v[164:167], a[60:63], a[92:95], v[164:167]
 v_cvt_pk_bf16_f32 v152, v152, v153
 v_cvt_pk_bf16_f32 v153, v154, v155
 v_mfma_f32_16x16x32_bf16 v[172:175], a[60:63], a[84:87], v[172:175]
 s_add_u32 m0, s29, 106496
 v_cvt_pk_bf16_f32 v154, v156, v157
 v_cvt_pk_bf16_f32 v155, v158, v159
 v_mfma_f32_16x16x32_bf16 v[172:175], a[56:59], a[80:83], v[172:175]
 buffer_load_dwordx4 v2, s[16:19], s49 offen lds
 v_mfma_f32_16x16x32_bf16 v[180:183], a[56:59], a[72:75], v[180:183]
 v_mfma_f32_16x16x32_bf16 v[180:183], a[60:63], a[76:79], v[180:183]
 v_mfma_f32_16x16x32_bf16 v[188:191], a[60:63], a[68:71], v[188:191]
 v_mfma_f32_16x16x32_bf16 v[188:191], a[56:59], a[64:67], v[188:191]
 s_add_u32 m0, s29, 110592
 v_mfma_f32_16x16x32_bf16 v[216:219], a[32:35], a[96:99], v[216:219]
 buffer_load_dwordx4 v2, s[16:19], s50 offen lds
 v_mfma_f32_16x16x32_bf16 v[216:219], a[36:39], a[100:103], v[216:219]
 v_cvt_pk_bf16_f32 v160, v160, v161
 v_cvt_pk_bf16_f32 v161, v162, v163
 v_mfma_f32_16x16x32_bf16 v[208:211], a[36:39], a[108:111], v[208:211]
 v_cvt_pk_bf16_f32 v162, v164, v165
 v_cvt_pk_bf16_f32 v163, v166, v167
 v_mfma_f32_16x16x32_bf16 v[208:211], a[32:35], a[104:107], v[208:211]
 v_cvt_pk_bf16_f32 v168, v168, v169
 v_cvt_pk_bf16_f32 v169, v170, v171
 v_mfma_f32_16x16x32_bf16 v[200:203], a[32:35], a[112:115], v[200:203]
 s_add_u32 m0, s29, 114688
 v_cvt_pk_bf16_f32 v170, v172, v173
 v_cvt_pk_bf16_f32 v171, v174, v175
 v_mfma_f32_16x16x32_bf16 v[200:203], a[36:39], a[116:119], v[200:203]
 buffer_load_dwordx4 v2, s[16:19], s51 offen lds
 v_mfma_f32_16x16x32_bf16 v[192:195], a[36:39], a[124:127], v[192:195]
 v_cvt_pk_bf16_f32 v176, v176, v177
 v_cvt_pk_bf16_f32 v177, v178, v179
 v_mfma_f32_16x16x32_bf16 v[192:195], a[32:35], a[120:123], v[192:195]
 v_cvt_pk_bf16_f32 v178, v180, v181
 v_cvt_pk_bf16_f32 v179, v182, v183
 v_mfma_f32_16x16x32_bf16 v[196:199], a[40:43], a[120:123], v[196:199]
 v_cvt_pk_bf16_f32 v184, v184, v185
 v_cvt_pk_bf16_f32 v185, v186, v187
 v_mfma_f32_16x16x32_bf16 v[196:199], a[44:47], a[124:127], v[196:199]
 s_add_u32 m0, s29, 118784
 v_cvt_pk_bf16_f32 v186, v188, v189
 v_cvt_pk_bf16_f32 v187, v190, v191
 v_mfma_f32_16x16x32_bf16 v[204:207], a[44:47], a[116:119], v[204:207]
 buffer_load_dwordx4 v2, s[16:19], s52 offen lds
 v_mfma_f32_16x16x32_bf16 v[204:207], a[40:43], a[112:115], v[204:207]
 v_mfma_f32_16x16x32_bf16 v[212:215], a[40:43], a[104:107], v[212:215]
 v_mfma_f32_16x16x32_bf16 v[212:215], a[44:47], a[108:111], v[212:215]
 v_mfma_f32_16x16x32_bf16 v[220:223], a[44:47], a[100:103], v[220:223]
 s_add_u32 m0, s29, 122880
 v_mfma_f32_16x16x32_bf16 v[220:223], a[40:43], a[96:99], v[220:223]
 buffer_load_dwordx4 v2, s[16:19], s53 offen lds
 v_mfma_f32_16x16x32_bf16 v[248:251], a[48:51], a[96:99], v[248:251]
 v_mfma_f32_16x16x32_bf16 v[248:251], a[52:55], a[100:103], v[248:251]
 s_waitcnt vmcnt(19)
 v_cvt_pk_bf16_f32 v192, v192, v193
 v_cvt_pk_bf16_f32 v193, v194, v195
 v_mfma_f32_16x16x32_bf16 v[240:243], a[52:55], a[108:111], v[240:243]
 s_barrier
 v_xor_b32 v7, 0, v6
 v_cvt_pk_bf16_f32 v194, v196, v197
 v_mfma_f32_16x16x32_bf16 v[240:243], a[48:51], a[104:107], v[240:243]
 s_add_u32 m0, s29, 126976
 ds_read_b64_tr_b16 a[64:65], v7 offset:0
 v_cvt_pk_bf16_f32 v195, v198, v199
 v_mfma_f32_16x16x32_bf16 v[232:235], a[48:51], a[112:115], v[232:235]
 ds_read_b64_tr_b16 a[66:67], v7 offset:4096
 buffer_load_dwordx4 v2, s[16:19], s54 offen lds
 v_mfma_f32_16x16x32_bf16 v[232:235], a[52:55], a[116:119], v[232:235]
 ds_read_b64_tr_b16 a[68:69], v7 offset:16384
 v_cvt_pk_bf16_f32 v200, v200, v201
 v_mfma_f32_16x16x32_bf16 v[224:227], a[52:55], a[124:127], v[224:227]
 ds_read_b64_tr_b16 a[70:71], v7 offset:20480
 v_xor_b32 v8, 65536, v6
 v_mfma_f32_16x16x32_bf16 v[224:227], a[48:51], a[120:123], v[224:227]
 ds_read_b64_tr_b16 a[72:73], v8 offset:0
 v_cvt_pk_bf16_f32 v201, v202, v203
 v_mfma_f32_16x16x32_bf16 v[228:231], a[56:59], a[120:123], v[228:231]
 ds_read_b64_tr_b16 a[74:75], v8 offset:4096
 v_cvt_pk_bf16_f32 v202, v204, v205
 v_mfma_f32_16x16x32_bf16 v[228:231], a[60:63], a[124:127], v[228:231]
 ds_read_b64_tr_b16 a[76:77], v8 offset:16384
 v_cvt_pk_bf16_f32 v203, v206, v207
 v_mfma_f32_16x16x32_bf16 v[236:239], a[60:63], a[116:119], v[236:239]
 ds_read_b64_tr_b16 a[78:79], v8 offset:20480
 v_xor_b32 v9, 32, v6
 v_mfma_f32_16x16x32_bf16 v[236:239], a[56:59], a[112:115], v[236:239]
 ds_read_b64_tr_b16 a[80:81], v9 offset:0
 v_cvt_pk_bf16_f32 v208, v208, v209
 v_mfma_f32_16x16x32_bf16 v[244:247], a[56:59], a[104:107], v[244:247]
 ds_read_b64_tr_b16 a[82:83], v9 offset:4096
 v_cvt_pk_bf16_f32 v209, v210, v211
 v_mfma_f32_16x16x32_bf16 v[244:247], a[60:63], a[108:111], v[244:247]
 ds_read_b64_tr_b16 a[84:85], v9 offset:16384
 v_cvt_pk_bf16_f32 v210, v212, v213
 v_mfma_f32_16x16x32_bf16 v[252:255], a[60:63], a[100:103], v[252:255]
 ds_read_b64_tr_b16 a[86:87], v9 offset:20480
 v_xor_b32 v10, 65568, v6
 v_mfma_f32_16x16x32_bf16 v[252:255], a[56:59], a[96:99], v[252:255]
 s_waitcnt lgkmcnt(6)
 ds_read_b64_tr_b16 a[88:89], v10 offset:0
 v_cvt_pk_bf16_f32 v211, v214, v215
 v_mfma_f32_16x16x32_bf16 v[28:31], a[64:67], a[128:131], 0
 ds_read_b64_tr_b16 a[90:91], v10 offset:4096
 v_cvt_pk_bf16_f32 v216, v216, v217
 v_mfma_f32_16x16x32_bf16 v[28:31], a[68:71], a[136:139], v[28:31]
 ds_read_b64_tr_b16 a[92:93], v10 offset:16384
 v_xor_b32 v7, 64, v6
 v_mfma_f32_16x16x32_bf16 v[28:31], a[72:75], a[144:147], v[28:31]
 s_waitcnt lgkmcnt(7)
 ds_read_b128 a[112:115], v14 offset:0
 ds_read_b64_tr_b16 a[94:95], v10 offset:20480
 v_mfma_f32_16x16x32_bf16 v[28:31], a[76:79], a[152:155], v[28:31]
 ds_read_b64_tr_b16 a[96:97], v7 offset:0
 v_cvt_pk_bf16_f32 v217, v218, v219
 v_mfma_f32_16x16x32_bf16 v[44:47], a[64:67], a[132:135], 0
 ds_read_b128 a[120:123], v3 offset:0
 ds_read_b64_tr_b16 a[98:99], v7 offset:4096
 v_mfma_f32_16x16x32_bf16 v[44:47], a[68:71], a[140:143], v[44:47]
 ds_read_b64_tr_b16 a[100:101], v7 offset:16384
 v_xor_b32 v8, 65600, v6
 v_mfma_f32_16x16x32_bf16 v[44:47], a[72:75], a[148:151], v[44:47]
 ds_read_b128 a[116:119], v14 offset:2048
 ds_read_b64_tr_b16 a[102:103], v7 offset:20480
 v_mfma_f32_16x16x32_bf16 v[44:47], a[76:79], a[156:159], v[44:47]
 s_waitcnt lgkmcnt(9)
 ds_read_b64_tr_b16 a[104:105], v8 offset:0
 v_cvt_pk_bf16_f32 v218, v220, v221
 v_mfma_f32_16x16x32_bf16 v[52:55], a[80:83], a[128:131], 0
 ds_read_b128 a[124:127], v3 offset:2048
 ds_read_b64_tr_b16 a[106:107], v8 offset:4096
 v_mfma_f32_16x16x32_bf16 v[52:55], a[84:87], a[136:139], v[52:55]
 ds_read_b64_tr_b16 a[108:109], v8 offset:16384
 v_cvt_pk_bf16_f32 v219, v222, v223
 v_mfma_f32_16x16x32_bf16 v[52:55], a[88:91], a[144:147], v[52:55]
 s_waitcnt lgkmcnt(10)
 ds_read_b64_tr_b16 a[110:111], v8 offset:20480
 v_xor_b32 v9, 96, v6
 v_mfma_f32_16x16x32_bf16 v[52:55], a[92:95], a[152:155], v[52:55]
 ds_read_b64_tr_b16 a[64:65], v9 offset:0
 v_cvt_pk_bf16_f32 v224, v224, v225
 v_mfma_f32_16x16x32_bf16 v[60:63], a[80:83], a[132:135], 0
 ds_read_b64_tr_b16 a[66:67], v9 offset:4096
 v_cvt_pk_bf16_f32 v225, v226, v227
 v_mfma_f32_16x16x32_bf16 v[60:63], a[84:87], a[140:143], v[60:63]
 ds_read_b64_tr_b16 a[68:69], v9 offset:16384
 v_cvt_pk_bf16_f32 v226, v228, v229
 v_mfma_f32_16x16x32_bf16 v[60:63], a[88:91], a[148:151], v[60:63]
 ds_read_b64_tr_b16 a[70:71], v9 offset:20480
 v_xor_b32 v10, 65632, v6
 v_mfma_f32_16x16x32_bf16 v[60:63], a[92:95], a[156:159], v[60:63]
 s_waitcnt lgkmcnt(6)
 ds_read_b64_tr_b16 a[72:73], v10 offset:0
 v_cvt_pk_bf16_f32 v227, v230, v231
 v_mfma_f32_16x16x32_bf16 v[20:23], a[96:99], a[128:131], 0
 ds_read_b64_tr_b16 a[74:75], v10 offset:4096
 v_cvt_pk_bf16_f32 v232, v232, v233
 v_mfma_f32_16x16x32_bf16 v[20:23], a[100:103], a[136:139], v[20:23]
 s_waitcnt lgkmcnt(8)
 ds_read_b64_tr_b16 a[76:77], v10 offset:16384
 v_xor_b32 v7, 128, v6
 v_mfma_f32_16x16x32_bf16 v[20:23], a[104:107], a[144:147], v[20:23]
 s_waitcnt lgkmcnt(7)
 s_barrier
 ds_read_b64_tr_b16 a[78:79], v10 offset:20480
 v_mfma_f32_16x16x32_bf16 v[20:23], a[108:111], a[152:155], v[20:23]
 s_add_u32 m0, s29, 131072
 ds_read_b64_tr_b16 a[80:81], v7 offset:0
 v_add_u32 v2, 0x80000, v2
 v_mfma_f32_16x16x32_bf16 v[36:39], a[96:99], a[132:135], 0
 ds_read_b64_tr_b16 a[82:83], v7 offset:4096
 buffer_load_dwordx4 v2, s[16:19], 0 offen lds
 v_mfma_f32_16x16x32_bf16 v[36:39], a[100:103], a[140:143], v[36:39]
 ds_read_b64_tr_b16 a[84:85], v7 offset:16384
 v_cvt_pk_bf16_f32 v233, v234, v235
 v_mfma_f32_16x16x32_bf16 v[36:39], a[104:107], a[148:151], v[36:39]
 ds_read_b64_tr_b16 a[86:87], v7 offset:20480
 v_xor_b32 v8, 65664, v6
 v_mfma_f32_16x16x32_bf16 v[36:39], a[108:111], a[156:159], v[36:39]
 s_waitcnt lgkmcnt(6)
 ds_read_b64_tr_b16 a[88:89], v8 offset:0
 v_cvt_pk_bf16_f32 v234, v236, v237
 v_mfma_f32_16x16x32_bf16 v[68:71], a[64:67], a[128:131], 0
 ds_read_b64_tr_b16 a[90:91], v8 offset:4096
 v_cvt_pk_bf16_f32 v235, v238, v239
 v_mfma_f32_16x16x32_bf16 v[68:71], a[68:71], a[136:139], v[68:71]
 s_add_u32 m0, s29, 135168
 ds_read_b64_tr_b16 a[92:93], v8 offset:16384
 v_cvt_pk_bf16_f32 v240, v240, v241
 v_mfma_f32_16x16x32_bf16 v[68:71], a[72:75], a[144:147], v[68:71]
 s_waitcnt lgkmcnt(7)
 ds_read_b64_tr_b16 a[94:95], v8 offset:20480
 v_xor_b32 v9, 160, v6
 v_mfma_f32_16x16x32_bf16 v[68:71], a[76:79], a[152:155], v[68:71]
 ds_read_b64_tr_b16 a[96:97], v9 offset:0
 buffer_load_dwordx4 v2, s[16:19], s48 offen lds
 v_mfma_f32_16x16x32_bf16 v[76:79], a[64:67], a[132:135], 0
 ds_read_b64_tr_b16 a[98:99], v9 offset:4096
 v_cvt_pk_bf16_f32 v241, v242, v243
 v_mfma_f32_16x16x32_bf16 v[76:79], a[68:71], a[140:143], v[76:79]
 ds_read_b64_tr_b16 a[100:101], v9 offset:16384
 v_cvt_pk_bf16_f32 v242, v244, v245
 v_mfma_f32_16x16x32_bf16 v[76:79], a[72:75], a[148:151], v[76:79]
 ds_read_b64_tr_b16 a[102:103], v9 offset:20480
 v_xor_b32 v10, 65696, v6
 v_mfma_f32_16x16x32_bf16 v[76:79], a[76:79], a[156:159], v[76:79]
 s_waitcnt lgkmcnt(6)
 ds_read_b64_tr_b16 a[104:105], v10 offset:0
 v_cvt_pk_bf16_f32 v243, v246, v247
 v_mfma_f32_16x16x32_bf16 v[84:87], a[80:83], a[128:131], 0
 s_add_u32 m0, s29, 139264
 ds_read_b64_tr_b16 a[106:107], v10 offset:4096
 v_cvt_pk_bf16_f32 v248, v248, v249
 v_mfma_f32_16x16x32_bf16 v[84:87], a[84:87], a[136:139], v[84:87]
 ds_read_b64_tr_b16 a[108:109], v10 offset:16384
 buffer_load_dwordx4 v2, s[16:19], s49 offen lds
 v_mfma_f32_16x16x32_bf16 v[84:87], a[88:91], a[144:147], v[84:87]
 s_waitcnt lgkmcnt(7)
 ds_read_b64_tr_b16 a[110:111], v10 offset:20480
 v_xor_b32 v7, 192, v6
 v_mfma_f32_16x16x32_bf16 v[84:87], a[92:95], a[152:155], v[84:87]
 ds_read_b64_tr_b16 a[64:65], v7 offset:0
 v_cvt_pk_bf16_f32 v249, v250, v251
 v_mfma_f32_16x16x32_bf16 v[92:95], a[80:83], a[132:135], 0
 ds_read_b64_tr_b16 a[66:67], v7 offset:4096
 v_cvt_pk_bf16_f32 v250, v252, v253
 v_mfma_f32_16x16x32_bf16 v[92:95], a[84:87], a[140:143], v[92:95]
 ds_read_b64_tr_b16 a[68:69], v7 offset:16384
 v_cvt_pk_bf16_f32 v251, v254, v255
 v_mfma_f32_16x16x32_bf16 v[92:95], a[88:91], a[148:151], v[92:95]
 s_add_u32 m0, s29, 143360
 ds_read_b64_tr_b16 a[70:71], v7 offset:20480
 v_xor_b32 v8, 65728, v6
 v_mfma_f32_16x16x32_bf16 v[92:95], a[92:95], a[156:159], v[92:95]
 s_waitcnt lgkmcnt(6)
 ds_read_b64_tr_b16 a[72:73], v8 offset:0
 buffer_load_dwordx4 v2, s[16:19], s50 offen lds
 v_mfma_f32_16x16x32_bf16 v[100:103], a[96:99], a[128:131], 0
 ds_read_b64_tr_b16 a[74:75], v8 offset:4096
 v_mov_b32 v12, 0
 v_mfma_f32_16x16x32_bf16 v[100:103], a[100:103], a[136:139], v[100:103]
 ds_read_b64_tr_b16 a[76:77], v8 offset:16384
 global_load_dword v5, v12, s[90:91] offset:128 sc1
 v_mfma_f32_16x16x32_bf16 v[100:103], a[104:107], a[144:147], v[100:103]
 s_waitcnt lgkmcnt(7)
 ds_read_b64_tr_b16 a[78:79], v8 offset:20480
 v_xor_b32 v9, 224, v6
 v_mfma_f32_16x16x32_bf16 v[100:103], a[108:111], a[152:155], v[100:103]
 s_and_b32 s36, s95, 31
 ds_read_b64_tr_b16 a[80:81], v9 offset:0
 v_and_b32 v12, 11, v0
 v_mfma_f32_16x16x32_bf16 v[108:111], a[96:99], a[132:135], 0
 s_add_u32 m0, s29, 147456
 ds_read_b64_tr_b16 a[82:83], v9 offset:4096
 v_lshlrev_b32 v12, 2, v12
 v_mfma_f32_16x16x32_bf16 v[108:111], a[100:103], a[140:143], v[108:111]
 ds_read_b64_tr_b16 a[84:85], v9 offset:16384
 buffer_load_dwordx4 v2, s[16:19], s51 offen lds
 v_mfma_f32_16x16x32_bf16 v[108:111], a[104:107], a[148:151], v[108:111]
 s_lshr_b32 s37, s95, 5
 ds_read_b64_tr_b16 a[86:87], v9 offset:20480
 v_xor_b32 v10, 65760, v6
 v_mfma_f32_16x16x32_bf16 v[108:111], a[108:111], a[156:159], v[108:111]
 s_waitcnt lgkmcnt(6)
 ds_read_b64_tr_b16 a[88:89], v10 offset:0
 v_and_b32 v14, 15, v0
 v_mfma_f32_16x16x32_bf16 v[116:119], a[64:67], a[128:131], 0
 s_lshl_b32 s38, s3, 4
 ds_read_b64_tr_b16 a[90:91], v10 offset:4096
 v_lshrrev_b32 v3, 4, v0
 v_mfma_f32_16x16x32_bf16 v[116:119], a[68:71], a[136:139], v[116:119]
 s_add_u32 m0, s29, 151552
 ds_read_b64_tr_b16 a[92:93], v10 offset:16384
 v_lshlrev_b32 v3, 2, v3
 v_mfma_f32_16x16x32_bf16 v[116:119], a[72:75], a[144:147], v[116:119]
 s_waitcnt lgkmcnt(7)
 ds_read_b64_tr_b16 a[94:95], v10 offset:20480
 v_xor_b32 v7, 256, v6
 v_mfma_f32_16x16x32_bf16 v[116:119], a[76:79], a[152:155], v[116:119]
 ds_read_b64_tr_b16 a[96:97], v7 offset:0
 buffer_load_dwordx4 v2, s[16:19], s52 offen lds
 v_mfma_f32_16x16x32_bf16 v[124:127], a[64:67], a[132:135], 0
 s_lshl_b32 s39, s36, 6
 ds_read_b64_tr_b16 a[98:99], v7 offset:4096
 v_sub_u32 v14, v14, v3
 v_mfma_f32_16x16x32_bf16 v[124:127], a[68:71], a[140:143], v[124:127]
 s_add_u32 s38, s38, s39
 ds_read_b64_tr_b16 a[100:101], v7 offset:16384
 v_lshrrev_b32_e64 v3, 6, s29
 v_mfma_f32_16x16x32_bf16 v[124:127], a[72:75], a[148:151], v[124:127]
 s_mul_i32 s38, s38, 896
 ds_read_b64_tr_b16 a[102:103], v7 offset:20480
 v_xor_b32 v8, 65792, v6
 v_mfma_f32_16x16x32_bf16 v[124:127], a[76:79], a[156:159], v[124:127]
 s_waitcnt lgkmcnt(6)
 ds_read_b64_tr_b16 a[104:105], v8 offset:0
 v_add_u32 v14, v3, v14
 v_mfma_f32_16x16x32_bf16 v[132:135], a[80:83], a[128:131], 0
 s_add_u32 m0, s29, 155648
 ds_read_b64_tr_b16 a[106:107], v8 offset:4096
 v_mov_b32 v15, 0xf149f2ca
 v_mfma_f32_16x16x32_bf16 v[132:135], a[84:87], a[136:139], v[132:135]
 ds_read_b64_tr_b16 a[108:109], v8 offset:16384
 buffer_load_dwordx4 v2, s[16:19], s53 offen lds
 v_mfma_f32_16x16x32_bf16 v[132:135], a[88:91], a[144:147], v[132:135]
 s_waitcnt lgkmcnt(7)
 ds_read_b64_tr_b16 a[110:111], v8 offset:20480
 v_xor_b32 v9, 288, v6
 v_mfma_f32_16x16x32_bf16 v[132:135], a[92:95], a[152:155], v[132:135]
 s_lshl_b32 s39, s37, 7
 ds_read_b64_tr_b16 a[64:65], v9 offset:0
 v_cmp_gt_i32 vcc, 0, v14
 v_mfma_f32_16x16x32_bf16 v[140:143], a[80:83], a[132:135], 0
 s_add_u32 s38, s38, s39
 ds_read_b64_tr_b16 a[66:67], v9 offset:4096
 v_cndmask_b32 v3, 0, v15, vcc
 v_mfma_f32_16x16x32_bf16 v[140:143], a[84:87], a[140:143], v[140:143]
 s_lshl_b32 s39, s37, 9
 ds_read_b64_tr_b16 a[68:69], v9 offset:16384
 v_accvgpr_write_b32 a224, v3
 v_mfma_f32_16x16x32_bf16 v[140:143], a[88:91], a[148:151], v[140:143]
 s_add_u32 m0, s29, 159744
 ds_read_b64_tr_b16 a[70:71], v9 offset:20480
 v_xor_b32 v10, 65824, v6
 v_mfma_f32_16x16x32_bf16 v[140:143], a[92:95], a[156:159], v[140:143]
 s_waitcnt lgkmcnt(6)
 ds_read_b64_tr_b16 a[72:73], v10 offset:0
 buffer_load_dwordx4 v2, s[16:19], s54 offen lds
 v_mfma_f32_16x16x32_bf16 v[148:151], a[96:99], a[128:131], 0
 s_mov_b32 s4, s66
 ds_read_b64_tr_b16 a[74:75], v10 offset:4096
 v_cmp_gt_i32 vcc, 1, v14
 v_mfma_f32_16x16x32_bf16 v[148:151], a[100:103], a[136:139], v[148:151]
 s_mov_b32 s5, s67
 ds_read_b64_tr_b16 a[76:77], v10 offset:16384
 v_cndmask_b32 v3, 0, v15, vcc
 v_mfma_f32_16x16x32_bf16 v[148:151], a[104:107], a[144:147], v[148:151]
 s_waitcnt lgkmcnt(7)
 ds_read_b64_tr_b16 a[78:79], v10 offset:20480
 v_xor_b32 v7, 320, v6
 v_mfma_f32_16x16x32_bf16 v[148:151], a[108:111], a[152:155], v[148:151]
 s_mov_b32 s6, 1835008
 ds_read_b64_tr_b16 a[80:81], v7 offset:0
 v_accvgpr_write_b32 a225, v3
 v_mfma_f32_16x16x32_bf16 v[156:159], a[96:99], a[132:135], 0
 s_mov_b32 s7, 0x20000
 ds_read_b64_tr_b16 a[82:83], v7 offset:4096
 v_cmp_gt_i32 vcc, 2, v14
 v_mfma_f32_16x16x32_bf16 v[156:159], a[100:103], a[140:143], v[156:159]
 s_mov_b32 s8, s68
 ds_read_b64_tr_b16 a[84:85], v7 offset:16384
 v_cndmask_b32 v3, 0, v15, vcc
 v_mfma_f32_16x16x32_bf16 v[156:159], a[104:107], a[148:151], v[156:159]
 s_mov_b32 s9, s69
 ds_read_b64_tr_b16 a[86:87], v7 offset:20480
 v_xor_b32 v8, 65856, v6
 v_mfma_f32_16x16x32_bf16 v[156:159], a[108:111], a[156:159], v[156:159]
 s_waitcnt lgkmcnt(6)
 ds_read_b64_tr_b16 a[88:89], v8 offset:0
 v_accvgpr_write_b32 a226, v3
 v_mfma_f32_16x16x32_bf16 v[164:167], a[64:67], a[128:131], 0
 s_mov_b32 s10, 1835008
 ds_read_b64_tr_b16 a[90:91], v8 offset:4096
 v_cmp_gt_i32 vcc, 3, v14
 v_mfma_f32_16x16x32_bf16 v[164:167], a[68:71], a[136:139], v[164:167]
 s_mov_b32 s11, 0x20000
 ds_read_b64_tr_b16 a[92:93], v8 offset:16384
 v_cndmask_b32 v3, 0, v15, vcc
 v_mfma_f32_16x16x32_bf16 v[164:167], a[72:75], a[144:147], v[164:167]
 s_waitcnt lgkmcnt(7)
 ds_read_b64_tr_b16 a[94:95], v8 offset:20480
 v_xor_b32 v9, 352, v6
 v_mfma_f32_16x16x32_bf16 v[164:167], a[76:79], a[152:155], v[164:167]
 s_mov_b32 s20, s70
 ds_read_b64_tr_b16 a[96:97], v9 offset:0
 v_accvgpr_write_b32 a227, v3
 v_mfma_f32_16x16x32_bf16 v[172:175], a[64:67], a[132:135], 0
 s_mov_b32 s21, s71
 ds_read_b64_tr_b16 a[98:99], v9 offset:4096
 v_cmp_gt_i32 vcc, 16, v14
 v_mfma_f32_16x16x32_bf16 v[172:175], a[68:71], a[140:143], v[172:175]
 s_mov_b32 s22, 3584
 ds_read_b64_tr_b16 a[100:101], v9 offset:16384
 v_cndmask_b32 v3, 0, v15, vcc
 v_mfma_f32_16x16x32_bf16 v[172:175], a[72:75], a[148:151], v[172:175]
 s_mov_b32 s23, 0x20000
 ds_read_b64_tr_b16 a[102:103], v9 offset:20480
 v_xor_b32 v10, 65888, v6
 v_mfma_f32_16x16x32_bf16 v[172:175], a[76:79], a[156:159], v[172:175]
 s_waitcnt lgkmcnt(6)
 ds_read_b64_tr_b16 a[104:105], v10 offset:0
 v_accvgpr_write_b32 a228, v3
 v_mfma_f32_16x16x32_bf16 v[180:183], a[80:83], a[128:131], 0
 ds_read_b64_tr_b16 a[106:107], v10 offset:4096
 v_cmp_gt_i32 vcc, 17, v14
 v_mfma_f32_16x16x32_bf16 v[180:183], a[84:87], a[136:139], v[180:183]
 ds_read_b64_tr_b16 a[108:109], v10 offset:16384
 v_cndmask_b32 v3, 0, v15, vcc
 v_mfma_f32_16x16x32_bf16 v[180:183], a[88:91], a[144:147], v[180:183]
 s_waitcnt lgkmcnt(7)
 ds_read_b64_tr_b16 a[110:111], v10 offset:20480
 v_xor_b32 v7, 384, v6
 v_mfma_f32_16x16x32_bf16 v[180:183], a[92:95], a[152:155], v[180:183]
 ds_read_b64_tr_b16 a[64:65], v7 offset:0
 v_accvgpr_write_b32 a229, v3
 v_mfma_f32_16x16x32_bf16 v[188:191], a[80:83], a[132:135], 0
 ds_read_b64_tr_b16 a[66:67], v7 offset:4096
 v_cmp_gt_i32 vcc, 18, v14
 v_mfma_f32_16x16x32_bf16 v[188:191], a[84:87], a[140:143], v[188:191]
 ds_read_b64_tr_b16 a[68:69], v7 offset:16384
 v_cndmask_b32 v3, 0, v15, vcc
 v_mfma_f32_16x16x32_bf16 v[188:191], a[88:91], a[148:151], v[188:191]
 ds_read_b64_tr_b16 a[70:71], v7 offset:20480
 v_xor_b32 v8, 65920, v6
 v_mfma_f32_16x16x32_bf16 v[188:191], a[92:95], a[156:159], v[188:191]
 s_waitcnt lgkmcnt(6)
 ds_read_b64_tr_b16 a[72:73], v8 offset:0
 v_accvgpr_write_b32 a230, v3
 v_mfma_f32_16x16x32_bf16 v[196:199], a[96:99], a[128:131], 0
 ds_read_b64_tr_b16 a[74:75], v8 offset:4096
 v_cmp_gt_i32 vcc, 19, v14
 v_mfma_f32_16x16x32_bf16 v[196:199], a[100:103], a[136:139], v[196:199]
 ds_read_b64_tr_b16 a[76:77], v8 offset:16384
 v_cndmask_b32 v3, 0, v15, vcc
 v_mfma_f32_16x16x32_bf16 v[196:199], a[104:107], a[144:147], v[196:199]
 s_waitcnt lgkmcnt(7)
 ds_read_b64_tr_b16 a[78:79], v8 offset:20480
 v_xor_b32 v9, 416, v6
 v_mfma_f32_16x16x32_bf16 v[196:199], a[108:111], a[152:155], v[196:199]
 ds_read_b64_tr_b16 a[80:81], v9 offset:0
 v_accvgpr_write_b32 a231, v3
 v_mfma_f32_16x16x32_bf16 v[204:207], a[96:99], a[132:135], 0
 ds_read_b64_tr_b16 a[82:83], v9 offset:4096
 v_cmp_gt_i32 vcc, 32, v14
 v_mfma_f32_16x16x32_bf16 v[204:207], a[100:103], a[140:143], v[204:207]
 ds_read_b64_tr_b16 a[84:85], v9 offset:16384
 v_cndmask_b32 v3, 0, v15, vcc
 v_mfma_f32_16x16x32_bf16 v[204:207], a[104:107], a[148:151], v[204:207]
 ds_read_b64_tr_b16 a[86:87], v9 offset:20480
 v_xor_b32 v10, 65952, v6
 v_mfma_f32_16x16x32_bf16 v[204:207], a[108:111], a[156:159], v[204:207]
 s_waitcnt lgkmcnt(6)
 ds_read_b64_tr_b16 a[88:89], v10 offset:0
 v_accvgpr_write_b32 a232, v3
 v_mfma_f32_16x16x32_bf16 v[212:215], a[64:67], a[128:131], 0
 ds_read_b64_tr_b16 a[90:91], v10 offset:4096
 v_cmp_gt_i32 vcc, 33, v14
 v_mfma_f32_16x16x32_bf16 v[212:215], a[68:71], a[136:139], v[212:215]
 ds_read_b64_tr_b16 a[92:93], v10 offset:16384
 v_cndmask_b32 v3, 0, v15, vcc
 v_mfma_f32_16x16x32_bf16 v[212:215], a[72:75], a[144:147], v[212:215]
 s_waitcnt lgkmcnt(7)
 ds_read_b64_tr_b16 a[94:95], v10 offset:20480
 v_xor_b32 v7, 448, v6
 v_mfma_f32_16x16x32_bf16 v[212:215], a[76:79], a[152:155], v[212:215]
 s_add_u32 s59, s56, 57344
 ds_read_b64_tr_b16 a[96:97], v7 offset:0
 v_accvgpr_write_b32 a233, v3
 v_mfma_f32_16x16x32_bf16 v[220:223], a[64:67], a[132:135], 0
 ds_read_b64_tr_b16 a[98:99], v7 offset:4096
 buffer_store_dwordx4 v[32:35], v1, s[12:15], s59 offen offset:1024 sc1
 v_mfma_f32_16x16x32_bf16 v[220:223], a[68:71], a[140:143], v[220:223]
 ds_read_b64_tr_b16 a[100:101], v7 offset:16384
 v_cmp_gt_i32 vcc, 34, v14
 v_mfma_f32_16x16x32_bf16 v[220:223], a[72:75], a[148:151], v[220:223]
 ds_read_b64_tr_b16 a[102:103], v7 offset:20480
 v_xor_b32 v8, 65984, v6
 v_mfma_f32_16x16x32_bf16 v[220:223], a[76:79], a[156:159], v[220:223]
 s_waitcnt lgkmcnt(6)
 ds_read_b64_tr_b16 a[104:105], v8 offset:0
 v_cndmask_b32 v3, 0, v15, vcc
 v_mfma_f32_16x16x32_bf16 v[228:231], a[80:83], a[128:131], 0
 ds_read_b64_tr_b16 a[106:107], v8 offset:4096
 v_accvgpr_write_b32 a234, v3
 v_mfma_f32_16x16x32_bf16 v[228:231], a[84:87], a[136:139], v[228:231]
 ds_read_b64_tr_b16 a[108:109], v8 offset:16384
 v_cmp_gt_i32 vcc, 35, v14
 v_mfma_f32_16x16x32_bf16 v[228:231], a[88:91], a[144:147], v[228:231]
 s_waitcnt lgkmcnt(7)
 ds_read_b64_tr_b16 a[110:111], v8 offset:20480
 v_xor_b32 v9, 480, v6
 v_mfma_f32_16x16x32_bf16 v[228:231], a[92:95], a[152:155], v[228:231]
 ds_read_b64_tr_b16 a[64:65], v9 offset:0
 v_cndmask_b32 v3, 0, v15, vcc
 v_mfma_f32_16x16x32_bf16 v[236:239], a[80:83], a[132:135], 0
 ds_read_b64_tr_b16 a[66:67], v9 offset:4096
 v_accvgpr_write_b32 a235, v3
 v_mfma_f32_16x16x32_bf16 v[236:239], a[84:87], a[140:143], v[236:239]
 ds_read_b64_tr_b16 a[68:69], v9 offset:16384
 v_cmp_gt_i32 vcc, 48, v14
 v_mfma_f32_16x16x32_bf16 v[236:239], a[88:91], a[148:151], v[236:239]
 s_add_u32 s59, s56, 49152
 ds_read_b64_tr_b16 a[70:71], v9 offset:20480
 v_xor_b32 v10, 66016, v6
 v_mfma_f32_16x16x32_bf16 v[236:239], a[92:95], a[156:159], v[236:239]
 s_waitcnt lgkmcnt(6)
 ds_read_b64_tr_b16 a[72:73], v10 offset:0
 buffer_store_dwordx4 v[40:43], v1, s[12:15], s59 offen offset:1024 sc1
 v_mfma_f32_16x16x32_bf16 v[244:247], a[96:99], a[128:131], 0
 ds_read_b64_tr_b16 a[74:75], v10 offset:4096
 v_cndmask_b32 v3, 0, v15, vcc
 v_mfma_f32_16x16x32_bf16 v[244:247], a[100:103], a[136:139], v[244:247]
 s_waitcnt vmcnt(11)
 ds_read_b64_tr_b16 a[76:77], v10 offset:16384
 v_xor_b32 v7, 32768, v6
 v_mfma_f32_16x16x32_bf16 v[244:247], a[104:107], a[144:147], v[244:247]
 s_waitcnt lgkmcnt(7)
 s_barrier
 ds_read_b64_tr_b16 a[78:79], v10 offset:20480
 v_mfma_f32_16x16x32_bf16 v[244:247], a[108:111], a[152:155], v[244:247]
 ds_read_b64_tr_b16 a[80:81], v7 offset:0
 v_accvgpr_write_b32 a236, v3
 v_mfma_f32_16x16x32_bf16 v[252:255], a[96:99], a[132:135], 0
 ds_read_b64_tr_b16 a[82:83], v7 offset:4096
 v_cmp_gt_i32 vcc, 49, v14
 v_mfma_f32_16x16x32_bf16 v[252:255], a[100:103], a[140:143], v[252:255]
 ds_read_b64_tr_b16 a[84:85], v7 offset:16384
 v_cndmask_b32 v3, 0, v15, vcc
 v_mfma_f32_16x16x32_bf16 v[252:255], a[104:107], a[148:151], v[252:255]
 ds_read_b64_tr_b16 a[86:87], v7 offset:20480
 v_xor_b32 v8, 98304, v6
 v_mfma_f32_16x16x32_bf16 v[252:255], a[108:111], a[156:159], v[252:255]
 s_waitcnt lgkmcnt(6)
 ds_read_b64_tr_b16 a[88:89], v8 offset:0
 v_accvgpr_write_b32 a237, v3
 v_mfma_f32_16x16x32_bf16 v[16:19], a[64:67], a[128:131], 0
 s_add_u32 s59, s56, 40960
 ds_read_b64_tr_b16 a[90:91], v8 offset:4096
 v_cmp_gt_i32 vcc, 50, v14
 v_mfma_f32_16x16x32_bf16 v[16:19], a[68:71], a[136:139], v[16:19]
 ds_read_b64_tr_b16 a[92:93], v8 offset:16384
 buffer_store_dwordx4 v[48:51], v1, s[12:15], s59 offen offset:1024 sc1
 v_mfma_f32_16x16x32_bf16 v[16:19], a[72:75], a[144:147], v[16:19]
 s_waitcnt lgkmcnt(7)
 ds_read_b64_tr_b16 a[94:95], v8 offset:20480
 v_xor_b32 v9, 32800, v6
 v_mfma_f32_16x16x32_bf16 v[16:19], a[76:79], a[152:155], v[16:19]
 ds_read_b64_tr_b16 a[96:97], v9 offset:0
 v_cndmask_b32 v3, 0, v15, vcc
 v_mfma_f32_16x16x32_bf16 v[24:27], a[64:67], a[132:135], 0
 s_waitcnt lgkmcnt(9)
 ds_read_b64_tr_b16 a[98:99], v9 offset:4096
 v_accvgpr_write_b32 a238, v3
 v_mfma_f32_16x16x32_bf16 v[24:27], a[68:71], a[140:143], v[24:27]
 s_barrier
 ds_read_b64_tr_b16 a[100:101], v9 offset:16384
 v_cmp_gt_i32 vcc, 51, v14
 v_mfma_f32_16x16x32_bf16 v[24:27], a[72:75], a[148:151], v[24:27]
 s_add_u32 m0, s29, 0
 ds_read_b64_tr_b16 a[102:103], v9 offset:20480
 v_xor_b32 v10, 98336, v6
 v_mfma_f32_16x16x32_bf16 v[24:27], a[76:79], a[156:159], v[24:27]
 s_waitcnt lgkmcnt(6)
 ds_read_b64_tr_b16 a[104:105], v10 offset:0
 v_add_u32 v2, 0x80000, v2
 v_mfma_f32_16x16x32_bf16 v[28:31], a[80:83], a[160:163], v[28:31]
 ds_read_b64_tr_b16 a[106:107], v10 offset:4096
 buffer_load_dwordx4 v2, s[16:19], 0 offen lds
 v_mfma_f32_16x16x32_bf16 v[28:31], a[84:87], a[168:171], v[28:31]
 s_add_u32 s59, s56, 32768
 ds_read_b64_tr_b16 a[108:109], v10 offset:16384
 v_cndmask_b32 v3, 0, v15, vcc
 v_mfma_f32_16x16x32_bf16 v[28:31], a[88:91], a[176:179], v[28:31]
 s_waitcnt lgkmcnt(7)
 ds_read_b64_tr_b16 a[110:111], v10 offset:20480
 v_xor_b32 v7, 32832, v6
 v_mfma_f32_16x16x32_bf16 v[28:31], a[92:95], a[184:187], v[28:31]
 ds_read_b64_tr_b16 a[64:65], v7 offset:0
 buffer_store_dwordx4 v[56:59], v1, s[12:15], s59 offen offset:1024 sc1
 v_mfma_f32_16x16x32_bf16 v[44:47], a[80:83], a[164:167], v[44:47]
 s_add_u32 m0, s29, 4096
 ds_read_b64_tr_b16 a[66:67], v7 offset:4096
 v_add_u32 v4, 4096, v1
 v_mfma_f32_16x16x32_bf16 v[44:47], a[84:87], a[172:175], v[44:47]
 ds_read_b64_tr_b16 a[68:69], v7 offset:16384
 buffer_load_dwordx4 v2, s[16:19], s48 offen lds
 v_mfma_f32_16x16x32_bf16 v[44:47], a[88:91], a[180:183], v[44:47]
 ds_read_b64_tr_b16 a[70:71], v7 offset:20480
 v_xor_b32 v8, 98368, v6
 v_mfma_f32_16x16x32_bf16 v[44:47], a[92:95], a[188:191], v[44:47]
 s_waitcnt lgkmcnt(6)
 ds_read_b64_tr_b16 a[72:73], v8 offset:0
 v_accvgpr_write_b32 a239, v3
 v_mfma_f32_16x16x32_bf16 v[52:55], a[96:99], a[160:163], v[52:55]
 ds_read_b64_tr_b16 a[74:75], v8 offset:4096
 v_mfma_f32_16x16x32_bf16 v[52:55], a[100:103], a[168:171], v[52:55]
 s_add_u32 m0, s29, 8192
 ds_read_b64_tr_b16 a[76:77], v8 offset:16384
 v_mfma_f32_16x16x32_bf16 v[52:55], a[104:107], a[176:179], v[52:55]
 s_waitcnt lgkmcnt(7)
 ds_read_b64_tr_b16 a[78:79], v8 offset:20480
 v_xor_b32 v9, 32864, v6
 v_mfma_f32_16x16x32_bf16 v[52:55], a[108:111], a[184:187], v[52:55]
 ds_read_b64_tr_b16 a[80:81], v9 offset:0
 buffer_load_dwordx4 v2, s[16:19], s49 offen lds
 v_mfma_f32_16x16x32_bf16 v[60:63], a[96:99], a[164:167], v[60:63]
 s_add_u32 s59, s56, 24576
 ds_read_b64_tr_b16 a[82:83], v9 offset:4096
 v_mfma_f32_16x16x32_bf16 v[60:63], a[100:103], a[172:175], v[60:63]
 ds_read_b64_tr_b16 a[84:85], v9 offset:16384
 buffer_store_dwordx4 v[64:67], v1, s[12:15], s59 offen offset:0 sc1
 v_mfma_f32_16x16x32_bf16 v[60:63], a[104:107], a[180:183], v[60:63]
 s_add_u32 m0, s29, 12288
 ds_read_b64_tr_b16 a[86:87], v9 offset:20480
 v_xor_b32 v10, 98400, v6
 v_mfma_f32_16x16x32_bf16 v[60:63], a[108:111], a[188:191], v[60:63]
 s_waitcnt lgkmcnt(6)
 ds_read_b64_tr_b16 a[88:89], v10 offset:0
 v_mfma_f32_16x16x32_bf16 v[20:23], a[64:67], a[160:163], v[20:23]
 ds_read_b64_tr_b16 a[90:91], v10 offset:4096
 buffer_load_dwordx4 v2, s[16:19], s50 offen lds
 v_mfma_f32_16x16x32_bf16 v[20:23], a[68:71], a[168:171], v[20:23]
 ds_read_b64_tr_b16 a[92:93], v10 offset:16384
 v_mfma_f32_16x16x32_bf16 v[20:23], a[72:75], a[176:179], v[20:23]
 s_waitcnt lgkmcnt(7)
 ds_read_b64_tr_b16 a[94:95], v10 offset:20480
 v_xor_b32 v7, 32896, v6
 v_mfma_f32_16x16x32_bf16 v[20:23], a[76:79], a[184:187], v[20:23]
 ds_read_b64_tr_b16 a[96:97], v7 offset:0
 v_mfma_f32_16x16x32_bf16 v[36:39], a[64:67], a[164:167], v[36:39]
 s_add_u32 m0, s29, 16384
 ds_read_b64_tr_b16 a[98:99], v7 offset:4096
 v_mfma_f32_16x16x32_bf16 v[36:39], a[68:71], a[172:175], v[36:39]
 ds_read_b64_tr_b16 a[100:101], v7 offset:16384
 buffer_load_dwordx4 v2, s[16:19], s51 offen lds
 v_mfma_f32_16x16x32_bf16 v[36:39], a[72:75], a[180:183], v[36:39]
 s_add_u32 s59, s56, 16384
 ds_read_b64_tr_b16 a[102:103], v7 offset:20480
 v_xor_b32 v8, 98432, v6
 v_mfma_f32_16x16x32_bf16 v[36:39], a[76:79], a[188:191], v[36:39]
 s_waitcnt lgkmcnt(6)
 ds_read_b64_tr_b16 a[104:105], v8 offset:0
 buffer_store_dwordx4 v[72:75], v1, s[12:15], s59 offen offset:0 sc1
 v_mfma_f32_16x16x32_bf16 v[68:71], a[80:83], a[160:163], v[68:71]
 ds_read_b64_tr_b16 a[106:107], v8 offset:4096
 v_mfma_f32_16x16x32_bf16 v[68:71], a[84:87], a[168:171], v[68:71]
 s_add_u32 m0, s29, 20480
 ds_read_b64_tr_b16 a[108:109], v8 offset:16384
 v_mfma_f32_16x16x32_bf16 v[68:71], a[88:91], a[176:179], v[68:71]
 s_waitcnt lgkmcnt(7)
 ds_read_b64_tr_b16 a[110:111], v8 offset:20480
 v_xor_b32 v9, 32928, v6
 v_mfma_f32_16x16x32_bf16 v[68:71], a[92:95], a[184:187], v[68:71]
 ds_read_b64_tr_b16 a[64:65], v9 offset:0
 buffer_load_dwordx4 v2, s[16:19], s52 offen lds
 v_mfma_f32_16x16x32_bf16 v[76:79], a[80:83], a[164:167], v[76:79]
 ds_read_b64_tr_b16 a[66:67], v9 offset:4096
 v_mfma_f32_16x16x32_bf16 v[76:79], a[84:87], a[172:175], v[76:79]
 ds_read_b64_tr_b16 a[68:69], v9 offset:16384
 v_mfma_f32_16x16x32_bf16 v[76:79], a[88:91], a[180:183], v[76:79]
 s_add_u32 m0, s29, 24576
 ds_read_b64_tr_b16 a[70:71], v9 offset:20480
 v_xor_b32 v10, 98464, v6
 v_mfma_f32_16x16x32_bf16 v[76:79], a[92:95], a[188:191], v[76:79]
 s_waitcnt lgkmcnt(6)
 ds_read_b64_tr_b16 a[72:73], v10 offset:0
 v_mfma_f32_16x16x32_bf16 v[84:87], a[96:99], a[160:163], v[84:87]
 ds_read_b64_tr_b16 a[74:75], v10 offset:4096
 buffer_load_dwordx4 v2, s[16:19], s53 offen lds
 v_mfma_f32_16x16x32_bf16 v[84:87], a[100:103], a[168:171], v[84:87]
 s_add_u32 s59, s56, 8192
 ds_read_b64_tr_b16 a[76:77], v10 offset:16384
 v_mfma_f32_16x16x32_bf16 v[84:87], a[104:107], a[176:179], v[84:87]
 s_waitcnt lgkmcnt(7)
 ds_read_b64_tr_b16 a[78:79], v10 offset:20480
 v_xor_b32 v7, 32960, v6
 v_mfma_f32_16x16x32_bf16 v[84:87], a[108:111], a[184:187], v[84:87]
 ds_read_b64_tr_b16 a[80:81], v7 offset:0
 buffer_store_dwordx4 v[80:83], v1, s[12:15], s59 offen offset:0 sc1
 v_mfma_f32_16x16x32_bf16 v[92:95], a[96:99], a[164:167], v[92:95]
 s_add_u32 m0, s29, 28672
 ds_read_b64_tr_b16 a[82:83], v7 offset:4096
 v_mfma_f32_16x16x32_bf16 v[92:95], a[100:103], a[172:175], v[92:95]
 ds_read_b64_tr_b16 a[84:85], v7 offset:16384
 buffer_load_dwordx4 v2, s[16:19], s54 offen lds
 v_mfma_f32_16x16x32_bf16 v[92:95], a[104:107], a[180:183], v[92:95]
 ds_read_b64_tr_b16 a[86:87], v7 offset:20480
 v_xor_b32 v8, 98496, v6
 v_mfma_f32_16x16x32_bf16 v[92:95], a[108:111], a[188:191], v[92:95]
 s_waitcnt lgkmcnt(6)
 ds_read_b64_tr_b16 a[88:89], v8 offset:0
 v_mfma_f32_16x16x32_bf16 v[100:103], a[64:67], a[160:163], v[100:103]
 s_add_u32 m0, s29, 65536
 ds_read_b64_tr_b16 a[90:91], v8 offset:4096
 v_add_u32 v2, 0x80000, v2
 v_mfma_f32_16x16x32_bf16 v[100:103], a[68:71], a[168:171], v[100:103]
 ds_read_b64_tr_b16 a[92:93], v8 offset:16384
 buffer_load_dwordx4 v2, s[16:19], 0 offen lds
 v_mfma_f32_16x16x32_bf16 v[100:103], a[72:75], a[176:179], v[100:103]
 s_waitcnt lgkmcnt(7)
 ds_read_b64_tr_b16 a[94:95], v8 offset:20480
 v_xor_b32 v9, 32992, v6
 v_mfma_f32_16x16x32_bf16 v[100:103], a[76:79], a[184:187], v[100:103]
 ds_read_b64_tr_b16 a[96:97], v9 offset:0
 v_mfma_f32_16x16x32_bf16 v[108:111], a[64:67], a[164:167], v[108:111]
 s_add_u32 s59, s56, 0
 ds_read_b64_tr_b16 a[98:99], v9 offset:4096
 v_mfma_f32_16x16x32_bf16 v[108:111], a[68:71], a[172:175], v[108:111]
 ds_read_b64_tr_b16 a[100:101], v9 offset:16384
 buffer_store_dwordx4 v[88:91], v1, s[12:15], s59 offen offset:0 sc1
 v_mfma_f32_16x16x32_bf16 v[108:111], a[72:75], a[180:183], v[108:111]
 s_add_u32 m0, s29, 69632
 ds_read_b64_tr_b16 a[102:103], v9 offset:20480
 v_xor_b32 v10, 98528, v6
 v_mfma_f32_16x16x32_bf16 v[108:111], a[76:79], a[188:191], v[108:111]
 s_waitcnt lgkmcnt(6)
 ds_read_b64_tr_b16 a[104:105], v10 offset:0
 buffer_load_dwordx4 v2, s[16:19], s48 offen lds
 v_mfma_f32_16x16x32_bf16 v[116:119], a[80:83], a[160:163], v[116:119]
 ds_read_b64_tr_b16 a[106:107], v10 offset:4096
 v_mfma_f32_16x16x32_bf16 v[116:119], a[84:87], a[168:171], v[116:119]
 ds_read_b64_tr_b16 a[108:109], v10 offset:16384
 v_mfma_f32_16x16x32_bf16 v[116:119], a[88:91], a[176:179], v[116:119]
 s_waitcnt lgkmcnt(7)
 ds_read_b64_tr_b16 a[110:111], v10 offset:20480
 v_xor_b32 v7, 33024, v6
 v_mfma_f32_16x16x32_bf16 v[116:119], a[92:95], a[184:187], v[116:119]
 s_add_u32 m0, s29, 73728
 ds_read_b64_tr_b16 a[64:65], v7 offset:0
 v_mfma_f32_16x16x32_bf16 v[124:127], a[80:83], a[164:167], v[124:127]
 ds_read_b64_tr_b16 a[66:67], v7 offset:4096
 buffer_load_dwordx4 v2, s[16:19], s49 offen lds
 v_mfma_f32_16x16x32_bf16 v[124:127], a[84:87], a[172:175], v[124:127]
 ds_read_b64_tr_b16 a[68:69], v7 offset:16384
 v_mfma_f32_16x16x32_bf16 v[124:127], a[88:91], a[180:183], v[124:127]
 s_add_u32 s59, s56, 24576
 ds_read_b64_tr_b16 a[70:71], v7 offset:20480
 v_xor_b32 v8, 98560, v6
 v_mfma_f32_16x16x32_bf16 v[124:127], a[92:95], a[188:191], v[124:127]
 s_waitcnt lgkmcnt(6)
 ds_read_b64_tr_b16 a[72:73], v8 offset:0
 buffer_store_dwordx4 v[96:99], v1, s[12:15], s59 offen offset:1024 sc1
 v_mfma_f32_16x16x32_bf16 v[132:135], a[96:99], a[160:163], v[132:135]
 s_add_u32 m0, s29, 77824
 ds_read_b64_tr_b16 a[74:75], v8 offset:4096
 v_mfma_f32_16x16x32_bf16 v[132:135], a[100:103], a[168:171], v[132:135]
 ds_read_b64_tr_b16 a[76:77], v8 offset:16384
 buffer_load_dwordx4 v2, s[16:19], s50 offen lds
 v_mfma_f32_16x16x32_bf16 v[132:135], a[104:107], a[176:179], v[132:135]
 s_waitcnt lgkmcnt(7)
 ds_read_b64_tr_b16 a[78:79], v8 offset:20480
 v_xor_b32 v9, 33056, v6
 v_mfma_f32_16x16x32_bf16 v[132:135], a[108:111], a[184:187], v[132:135]
 ds_read_b64_tr_b16 a[80:81], v9 offset:0
 v_mfma_f32_16x16x32_bf16 v[140:143], a[96:99], a[164:167], v[140:143]
 ds_read_b64_tr_b16 a[82:83], v9 offset:4096
 v_mfma_f32_16x16x32_bf16 v[140:143], a[100:103], a[172:175], v[140:143]
 ds_read_b64_tr_b16 a[84:85], v9 offset:16384
 v_mfma_f32_16x16x32_bf16 v[140:143], a[104:107], a[180:183], v[140:143]
 s_add_u32 m0, s29, 81920
 ds_read_b64_tr_b16 a[86:87], v9 offset:20480
 v_xor_b32 v10, 98592, v6
 v_mfma_f32_16x16x32_bf16 v[140:143], a[108:111], a[188:191], v[140:143]
 s_waitcnt lgkmcnt(6)
 ds_read_b64_tr_b16 a[88:89], v10 offset:0
 buffer_load_dwordx4 v2, s[16:19], s51 offen lds
 v_mfma_f32_16x16x32_bf16 v[148:151], a[64:67], a[160:163], v[148:151]
 s_add_u32 s59, s56, 16384
 ds_read_b64_tr_b16 a[90:91], v10 offset:4096
 v_mfma_f32_16x16x32_bf16 v[148:151], a[68:71], a[168:171], v[148:151]
 ds_read_b64_tr_b16 a[92:93], v10 offset:16384
 buffer_store_dwordx4 v[104:107], v1, s[12:15], s59 offen offset:1024 sc1
 v_mfma_f32_16x16x32_bf16 v[148:151], a[72:75], a[176:179], v[148:151]
 s_waitcnt lgkmcnt(7)
 ds_read_b64_tr_b16 a[94:95], v10 offset:20480
 v_xor_b32 v7, 33088, v6
 v_mfma_f32_16x16x32_bf16 v[148:151], a[76:79], a[184:187], v[148:151]
 s_add_u32 m0, s29, 86016
 ds_read_b64_tr_b16 a[96:97], v7 offset:0
 v_mfma_f32_16x16x32_bf16 v[156:159], a[64:67], a[164:167], v[156:159]
 ds_read_b64_tr_b16 a[98:99], v7 offset:4096
 buffer_load_dwordx4 v2, s[16:19], s52 offen lds
 v_mfma_f32_16x16x32_bf16 v[156:159], a[68:71], a[172:175], v[156:159]
 ds_read_b64_tr_b16 a[100:101], v7 offset:16384
 v_mfma_f32_16x16x32_bf16 v[156:159], a[72:75], a[180:183], v[156:159]
 ds_read_b64_tr_b16 a[102:103], v7 offset:20480
 v_xor_b32 v8, 98624, v6
 v_mfma_f32_16x16x32_bf16 v[156:159], a[76:79], a[188:191], v[156:159]
 s_waitcnt lgkmcnt(6)
 ds_read_b64_tr_b16 a[104:105], v8 offset:0
 v_mfma_f32_16x16x32_bf16 v[164:167], a[80:83], a[160:163], v[164:167]
 s_add_u32 m0, s29, 90112
 ds_read_b64_tr_b16 a[106:107], v8 offset:4096
 v_mfma_f32_16x16x32_bf16 v[164:167], a[84:87], a[168:171], v[164:167]
 ds_read_b64_tr_b16 a[108:109], v8 offset:16384
 buffer_load_dwordx4 v2, s[16:19], s53 offen lds
 v_mfma_f32_16x16x32_bf16 v[164:167], a[88:91], a[176:179], v[164:167]
 s_waitcnt lgkmcnt(7)
 ds_read_b64_tr_b16 a[110:111], v8 offset:20480
 v_xor_b32 v9, 33120, v6
 v_mfma_f32_16x16x32_bf16 v[164:167], a[92:95], a[184:187], v[164:167]
 s_add_u32 s59, s56, 8192
 ds_read_b64_tr_b16 a[64:65], v9 offset:0
 v_mfma_f32_16x16x32_bf16 v[172:175], a[80:83], a[164:167], v[172:175]
 ds_read_b64_tr_b16 a[66:67], v9 offset:4096
 buffer_store_dwordx4 v[112:115], v1, s[12:15], s59 offen offset:1024 sc1
 v_mfma_f32_16x16x32_bf16 v[172:175], a[84:87], a[172:175], v[172:175]
 ds_read_b64_tr_b16 a[68:69], v9 offset:16384
 v_mfma_f32_16x16x32_bf16 v[172:175], a[88:91], a[180:183], v[172:175]
 s_add_u32 m0, s29, 94208
 ds_read_b64_tr_b16 a[70:71], v9 offset:20480
 v_xor_b32 v10, 98656, v6
 v_mfma_f32_16x16x32_bf16 v[172:175], a[92:95], a[188:191], v[172:175]
 s_waitcnt lgkmcnt(6)
 ds_read_b64_tr_b16 a[72:73], v10 offset:0
 buffer_load_dwordx4 v2, s[16:19], s54 offen lds
 v_mfma_f32_16x16x32_bf16 v[180:183], a[96:99], a[160:163], v[180:183]
 ds_read_b64_tr_b16 a[74:75], v10 offset:4096
 v_mfma_f32_16x16x32_bf16 v[180:183], a[100:103], a[168:171], v[180:183]
 ds_read_b64_tr_b16 a[76:77], v10 offset:16384
 v_mfma_f32_16x16x32_bf16 v[180:183], a[104:107], a[176:179], v[180:183]
 s_waitcnt lgkmcnt(7)
 ds_read_b64_tr_b16 a[78:79], v10 offset:20480
 v_xor_b32 v7, 33152, v6
 v_mfma_f32_16x16x32_bf16 v[180:183], a[108:111], a[184:187], v[180:183]
 ds_read_b64_tr_b16 a[80:81], v7 offset:0
 v_mfma_f32_16x16x32_bf16 v[188:191], a[96:99], a[164:167], v[188:191]
 ds_read_b64_tr_b16 a[82:83], v7 offset:4096
 v_mfma_f32_16x16x32_bf16 v[188:191], a[100:103], a[172:175], v[188:191]
 ds_read_b64_tr_b16 a[84:85], v7 offset:16384
 v_mfma_f32_16x16x32_bf16 v[188:191], a[104:107], a[180:183], v[188:191]
 s_add_u32 s59, s56, 0
 ds_read_b64_tr_b16 a[86:87], v7 offset:20480
 v_xor_b32 v8, 98688, v6
 v_mfma_f32_16x16x32_bf16 v[188:191], a[108:111], a[188:191], v[188:191]
 s_waitcnt lgkmcnt(6)
 ds_read_b64_tr_b16 a[88:89], v8 offset:0
 buffer_store_dwordx4 v[120:123], v1, s[12:15], s59 offen offset:1024 sc1
 v_mfma_f32_16x16x32_bf16 v[196:199], a[64:67], a[160:163], v[196:199]
 ds_read_b64_tr_b16 a[90:91], v8 offset:4096
 v_mfma_f32_16x16x32_bf16 v[196:199], a[68:71], a[168:171], v[196:199]
 ds_read_b64_tr_b16 a[92:93], v8 offset:16384
 v_mfma_f32_16x16x32_bf16 v[196:199], a[72:75], a[176:179], v[196:199]
 s_waitcnt lgkmcnt(7)
 ds_read_b64_tr_b16 a[94:95], v8 offset:20480
 v_xor_b32 v9, 33184, v6
 v_mfma_f32_16x16x32_bf16 v[196:199], a[76:79], a[184:187], v[196:199]
 ds_read_b64_tr_b16 a[96:97], v9 offset:0
 v_mfma_f32_16x16x32_bf16 v[204:207], a[64:67], a[164:167], v[204:207]
 ds_read_b64_tr_b16 a[98:99], v9 offset:4096
 v_mfma_f32_16x16x32_bf16 v[204:207], a[68:71], a[172:175], v[204:207]
 ds_read_b64_tr_b16 a[100:101], v9 offset:16384
 v_mfma_f32_16x16x32_bf16 v[204:207], a[72:75], a[180:183], v[204:207]
 ds_read_b64_tr_b16 a[102:103], v9 offset:20480
 v_xor_b32 v10, 98720, v6
 v_mfma_f32_16x16x32_bf16 v[204:207], a[76:79], a[188:191], v[204:207]
 s_waitcnt lgkmcnt(6)
 ds_read_b64_tr_b16 a[104:105], v10 offset:0
 v_mfma_f32_16x16x32_bf16 v[212:215], a[80:83], a[160:163], v[212:215]
 s_add_u32 s59, s56, 24576
 ds_read_b64_tr_b16 a[106:107], v10 offset:4096
 v_mfma_f32_16x16x32_bf16 v[212:215], a[84:87], a[168:171], v[212:215]
 ds_read_b64_tr_b16 a[108:109], v10 offset:16384
 buffer_store_dwordx4 v[128:131], v1, s[12:15], s59 offen offset:2048 sc1
 v_mfma_f32_16x16x32_bf16 v[212:215], a[88:91], a[176:179], v[212:215]
 s_waitcnt lgkmcnt(7)
 ds_read_b64_tr_b16 a[110:111], v10 offset:20480
 v_xor_b32 v7, 33216, v6
 v_mfma_f32_16x16x32_bf16 v[212:215], a[92:95], a[184:187], v[212:215]
 ds_read_b64_tr_b16 a[64:65], v7 offset:0
 v_lshrrev_b32 v120, 3, v0
 v_mfma_f32_16x16x32_bf16 v[220:223], a[80:83], a[164:167], v[220:223]
 ds_read_b64_tr_b16 a[66:67], v7 offset:4096
 v_mul_u32_u24 v120, 1792, v120
 v_mfma_f32_16x16x32_bf16 v[220:223], a[84:87], a[172:175], v[220:223]
 ds_read_b64_tr_b16 a[68:69], v7 offset:16384
 v_and_b32 v121, 7, v0
 v_mfma_f32_16x16x32_bf16 v[220:223], a[88:91], a[180:183], v[220:223]
 ds_read_b64_tr_b16 a[70:71], v7 offset:20480
 v_xor_b32 v8, 98752, v6
 v_mfma_f32_16x16x32_bf16 v[220:223], a[92:95], a[188:191], v[220:223]
 s_waitcnt lgkmcnt(6)
 ds_read_b64_tr_b16 a[72:73], v8 offset:0
 v_lshl_add_u32 v120, v121, 4, v120
 v_mfma_f32_16x16x32_bf16 v[228:231], a[96:99], a[160:163], v[228:231]
 ds_read_b64_tr_b16 a[74:75], v8 offset:4096
 v_add_u32 v120, s38, v120
 v_mfma_f32_16x16x32_bf16 v[228:231], a[100:103], a[168:171], v[228:231]
 s_add_u32 s59, s56, 16384
 ds_read_b64_tr_b16 a[76:77], v8 offset:16384
 v_lshlrev_b32 v121, 6, v121
 v_mfma_f32_16x16x32_bf16 v[228:231], a[104:107], a[176:179], v[228:231]
 s_waitcnt lgkmcnt(7)
 ds_read_b64_tr_b16 a[78:79], v8 offset:20480
 v_xor_b32 v9, 33248, v6
 v_mfma_f32_16x16x32_bf16 v[228:231], a[108:111], a[184:187], v[228:231]
 ds_read_b64_tr_b16 a[80:81], v9 offset:0
 buffer_store_dwordx4 v[136:139], v1, s[12:15], s59 offen offset:2048 sc1
 v_mfma_f32_16x16x32_bf16 v[236:239], a[96:99], a[164:167], v[236:239]
 ds_read_b64_tr_b16 a[82:83], v9 offset:4096
 v_subrev_u32 v122, 2688, v120
 v_mfma_f32_16x16x32_bf16 v[236:239], a[100:103], a[172:175], v[236:239]
 ds_read_b64_tr_b16 a[84:85], v9 offset:16384
 v_subrev_u32 v123, 1792, v120
 v_mfma_f32_16x16x32_bf16 v[236:239], a[104:107], a[180:183], v[236:239]
 ds_read_b64_tr_b16 a[86:87], v9 offset:20480
 v_xor_b32 v10, 98784, v6
 v_mfma_f32_16x16x32_bf16 v[236:239], a[108:111], a[188:191], v[236:239]
 s_waitcnt lgkmcnt(6)
 ds_read_b64_tr_b16 a[88:89], v10 offset:0
 v_subrev_u32 v128, 896, v120
 v_mfma_f32_16x16x32_bf16 v[244:247], a[64:67], a[160:163], v[244:247]
 ds_read_b64_tr_b16 a[90:91], v10 offset:4096
 buffer_load_dwordx4 v[32:35], v122, s[4:7], 0 offen
 v_mfma_f32_16x16x32_bf16 v[244:247], a[68:71], a[168:171], v[244:247]
 s_waitcnt vmcnt(4)
 ds_read_b64_tr_b16 a[92:93], v10 offset:16384
 v_xor_b32 v7, 131072, v6
 v_mfma_f32_16x16x32_bf16 v[244:247], a[72:75], a[176:179], v[244:247]
 s_waitcnt lgkmcnt(7)
 s_barrier
 ds_read_b64_tr_b16 a[94:95], v10 offset:20480
 v_mfma_f32_16x16x32_bf16 v[244:247], a[76:79], a[184:187], v[244:247]
 s_and_b32 s58, s92, ~127
 ds_read_b64_tr_b16 a[96:97], v7 offset:0
 v_mfma_f32_16x16x32_bf16 v[252:255], a[64:67], a[164:167], v[252:255]
 s_add_u32 s59, s56, 8192
 ds_read_b64_tr_b16 a[98:99], v7 offset:4096
 v_mfma_f32_16x16x32_bf16 v[252:255], a[68:71], a[172:175], v[252:255]
 ds_read_b64_tr_b16 a[100:101], v7 offset:16384
 buffer_store_dwordx4 v[144:147], v1, s[12:15], s59 offen offset:2048 sc1
 v_mfma_f32_16x16x32_bf16 v[252:255], a[72:75], a[180:183], v[252:255]
 s_lshl_b32 s37, s25, 1
 ds_read_b64_tr_b16 a[102:103], v7 offset:20480
 v_xor_b32 v8, 0, v6
 v_mfma_f32_16x16x32_bf16 v[252:255], a[76:79], a[188:191], v[252:255]
 s_waitcnt lgkmcnt(6)
 ds_read_b64_tr_b16 a[104:105], v8 offset:0
 buffer_load_dwordx4 v[40:43], v123, s[4:7], 0 offen
 v_mfma_f32_16x16x32_bf16 v[16:19], a[80:83], a[160:163], v[16:19]
 s_sub_i32 s38, 12, s37
 ds_read_b64_tr_b16 a[106:107], v8 offset:4096
 v_mfma_f32_16x16x32_bf16 v[16:19], a[84:87], a[168:171], v[16:19]
 s_max_i32 s38, s38, 0
 ds_read_b64_tr_b16 a[108:109], v8 offset:16384
 v_mfma_f32_16x16x32_bf16 v[16:19], a[88:91], a[176:179], v[16:19]
 s_waitcnt lgkmcnt(7)
 ds_read_b64_tr_b16 a[110:111], v8 offset:20480
 v_xor_b32 v9, 65536, v6
 v_mfma_f32_16x16x32_bf16 v[16:19], a[92:95], a[184:187], v[16:19]
 ds_read_b64_tr_b16 a[64:65], v9 offset:0
 buffer_load_dwordx4 v[48:51], v128, s[4:7], 0 offen
 v_mfma_f32_16x16x32_bf16 v[24:27], a[80:83], a[164:167], v[24:27]
 s_mul_i32 s49, s26, 1048576
 ds_read_b64_tr_b16 a[66:67], v9 offset:4096
 v_mfma_f32_16x16x32_bf16 v[24:27], a[84:87], a[172:175], v[24:27]
 s_lshl_b32 s50, s3, 13
 ds_read_b64_tr_b16 a[68:69], v9 offset:16384
 v_mfma_f32_16x16x32_bf16 v[24:27], a[88:91], a[180:183], v[24:27]
 s_add_u32 s59, s56, 0
 ds_read_b64_tr_b16 a[70:71], v9 offset:20480
 v_xor_b32 v10, 131104, v6
 v_mfma_f32_16x16x32_bf16 v[24:27], a[92:95], a[188:191], v[24:27]
 s_waitcnt lgkmcnt(6)
 ds_read_b64_tr_b16 a[72:73], v10 offset:0
 buffer_store_dwordx4 v[152:155], v1, s[12:15], s59 offen offset:2048 sc1
 v_mfma_f32_16x16x32_bf16 v[28:31], a[96:99], a[192:195], v[28:31]
 s_add_u32 s49, s49, s50
 ds_read_b64_tr_b16 a[74:75], v10 offset:4096
 v_mfma_f32_16x16x32_bf16 v[28:31], a[100:103], a[200:203], v[28:31]
 ds_read_b64_tr_b16 a[76:77], v10 offset:16384
 buffer_load_dwordx4 v[56:59], v120, s[4:7], 0 offen offset:0
 v_mfma_f32_16x16x32_bf16 v[28:31], a[104:107], a[208:211], v[28:31]
 s_waitcnt lgkmcnt(3)
 ds_read_b64_tr_b16 a[78:79], v10 offset:20480
 v_xor_b32 v7, 32, v6
 v_mfma_f32_16x16x32_bf16 v[28:31], a[108:111], a[216:219], v[28:31]
 s_mov_b32 s54, 0
 ds_read_b64_tr_b16 a[80:81], v7 offset:0
 v_mfma_f32_16x16x32_bf16 v[28:31], a[64:67], a[112:115], v[28:31]
 s_add_u32 s44, s37, 1
 ds_read_b64_tr_b16 a[82:83], v7 offset:4096
 v_mfma_f32_16x16x32_bf16 v[28:31], a[68:71], a[120:123], v[28:31]
 ds_read_b64_tr_b16 a[84:85], v7 offset:16384
 buffer_load_dwordx4 v[64:67], v120, s[4:7], 0 offen offset:896
 v_mfma_f32_16x16x32_bf16 v[44:47], a[96:99], a[196:199], v[44:47]
 s_mov_b32 s42, s49
 ds_read_b64_tr_b16 a[86:87], v7 offset:20480
 v_xor_b32 v8, 65568, v6
 v_mfma_f32_16x16x32_bf16 v[44:47], a[100:103], a[204:207], v[44:47]
 s_add_u32 s60, s94, 4
 ds_read_b64_tr_b16 a[88:89], v8 offset:0
 v_mfma_f32_16x16x32_bf16 v[44:47], a[104:107], a[212:215], v[44:47]
 s_add_u32 s59, s56, 24576
 ds_read_b64_tr_b16 a[90:91], v8 offset:4096
 v_mfma_f32_16x16x32_bf16 v[44:47], a[108:111], a[220:223], v[44:47]
 ds_read_b64_tr_b16 a[92:93], v8 offset:16384
 buffer_store_dwordx4 v[160:163], v1, s[12:15], s59 offen offset:3072 sc1
 v_mfma_f32_16x16x32_bf16 v[44:47], a[64:67], a[116:119], v[44:47]
 s_mov_b32 s45, 2
 ds_read_b64_tr_b16 a[94:95], v8 offset:20480
 v_xor_b32 v9, 131136, v6
 v_mfma_f32_16x16x32_bf16 v[44:47], a[68:71], a[124:127], v[44:47]
 s_waitcnt lgkmcnt(6)
 ds_read_b64_tr_b16 a[96:97], v9 offset:0
 buffer_load_dwordx4 v[72:75], v120, s[8:11], 0 offen offset:0
 v_mfma_f32_16x16x32_bf16 v[52:55], a[72:75], a[192:195], v[52:55]
 s_mov_b32 s66, 1
 ds_read_b64_tr_b16 a[98:99], v9 offset:4096
 v_mfma_f32_16x16x32_bf16 v[52:55], a[76:79], a[200:203], v[52:55]
 s_mov_b32 s68, 1
 ds_read_b64_tr_b16 a[100:101], v9 offset:16384
 v_mfma_f32_16x16x32_bf16 v[52:55], a[80:83], a[208:211], v[52:55]
 s_waitcnt lgkmcnt(3)
 ds_read_b64_tr_b16 a[102:103], v9 offset:20480
 v_xor_b32 v10, 64, v6
 v_mfma_f32_16x16x32_bf16 v[52:55], a[84:87], a[216:219], v[52:55]
 ds_read_b64_tr_b16 a[104:105], v10 offset:0
 buffer_load_dwordx4 v[80:83], v120, s[8:11], 0 offen offset:896
 v_mfma_f32_16x16x32_bf16 v[52:55], a[88:91], a[112:115], v[52:55]
 s_mov_b32 s70, 32768
 ds_read_b64_tr_b16 a[106:107], v10 offset:4096
 v_mfma_f32_16x16x32_bf16 v[52:55], a[92:95], a[120:123], v[52:55]
 s_mov_b32 s71, s70
 ds_read_b64_tr_b16 a[108:109], v10 offset:16384
 v_mfma_f32_16x16x32_bf16 v[60:63], a[72:75], a[196:199], v[60:63]
 s_add_u32 s59, s56, 16384
 ds_read_b64_tr_b16 a[110:111], v10 offset:20480
 v_xor_b32 v7, 65600, v6
 v_mfma_f32_16x16x32_bf16 v[60:63], a[76:79], a[204:207], v[60:63]
 ds_read_b64_tr_b16 a[64:65], v7 offset:0
 buffer_store_dwordx4 v[168:171], v1, s[12:15], s59 offen offset:3072 sc1
 v_mfma_f32_16x16x32_bf16 v[60:63], a[80:83], a[212:215], v[60:63]
 s_add_u32 s43, s42, 16777216
 ds_read_b64_tr_b16 a[66:67], v7 offset:4096
 v_mfma_f32_16x16x32_bf16 v[60:63], a[84:87], a[220:223], v[60:63]
 ds_read_b64_tr_b16 a[68:69], v7 offset:16384
 buffer_load_dwordx4 v[88:91], v121, s[20:23], s39 offen offset:0
 v_mfma_f32_16x16x32_bf16 v[60:63], a[88:91], a[116:119], v[60:63]
 s_mov_b32 s40, s50
 ds_read_b64_tr_b16 a[70:71], v7 offset:20480
 v_xor_b32 v8, 131168, v6
 v_mfma_f32_16x16x32_bf16 v[60:63], a[92:95], a[124:127], v[60:63]
 s_waitcnt lgkmcnt(6)
 ds_read_b64_tr_b16 a[72:73], v8 offset:0
 v_mfma_f32_16x16x32_bf16 v[20:23], a[96:99], a[192:195], v[20:23]
 s_add_u32 s41, s50, 0x10000
 ds_read_b64_tr_b16 a[74:75], v8 offset:4096
 v_mfma_f32_16x16x32_bf16 v[20:23], a[100:103], a[200:203], v[20:23]
 ds_read_b64_tr_b16 a[76:77], v8 offset:16384
 buffer_load_dwordx4 v[96:99], v121, s[20:23], s39 offen offset:16
 v_mfma_f32_16x16x32_bf16 v[20:23], a[104:107], a[208:211], v[20:23]
 s_waitcnt lgkmcnt(3)
 ds_read_b64_tr_b16 a[78:79], v8 offset:20480
 v_xor_b32 v9, 96, v6
 v_mfma_f32_16x16x32_bf16 v[20:23], a[108:111], a[216:219], v[20:23]
 s_lshr_b32 s61, s95, 4
 ds_read_b64_tr_b16 a[80:81], v9 offset:0
 v_mul_f32 v28, s34, v28
 v_mfma_f32_16x16x32_bf16 v[20:23], a[64:67], a[112:115], v[20:23]
 s_add_u32 s59, s56, 8192
 ds_read_b64_tr_b16 a[82:83], v9 offset:4096
 v_mul_f32 v29, s34, v29
 v_mfma_f32_16x16x32_bf16 v[20:23], a[68:71], a[120:123], v[20:23]
 ds_read_b64_tr_b16 a[84:85], v9 offset:16384
 buffer_store_dwordx4 v[176:179], v1, s[12:15], s59 offen offset:3072 sc1
 v_mfma_f32_16x16x32_bf16 v[36:39], a[96:99], a[196:199], v[36:39]
 s_lshl_b32 s61, s61, 7
 ds_read_b64_tr_b16 a[86:87], v9 offset:20480
 v_xor_b32 v10, 65632, v6
 v_mfma_f32_16x16x32_bf16 v[36:39], a[100:103], a[204:207], v[36:39]
 ds_read_b64_tr_b16 a[88:89], v10 offset:0
 buffer_load_dwordx4 v[104:107], v121, s[20:23], s39 offen offset:32
 v_mfma_f32_16x16x32_bf16 v[36:39], a[104:107], a[212:215], v[36:39]
 s_add_u32 s61, s61, 84959232
 ds_read_b64_tr_b16 a[90:91], v10 offset:4096
 v_mul_f32 v30, s34, v30
 v_mfma_f32_16x16x32_bf16 v[36:39], a[108:111], a[220:223], v[36:39]
 s_mov_b32 s47, 0x4b800000
 ds_read_b64_tr_b16 a[92:93], v10 offset:16384
 v_mul_f32 v31, s34, v31
 v_mfma_f32_16x16x32_bf16 v[36:39], a[64:67], a[116:119], v[36:39]
 s_lshl_b32 s30, s95, 1
 ds_read_b64_tr_b16 a[94:95], v10 offset:20480
 v_xor_b32 v7, 131200, v6
 v_mfma_f32_16x16x32_bf16 v[36:39], a[68:71], a[124:127], v[36:39]
 s_waitcnt lgkmcnt(6)
 ds_read_b64_tr_b16 a[96:97], v7 offset:0
 buffer_load_dwordx4 v[112:115], v121, s[20:23], s39 offen offset:48
 v_mfma_f32_16x16x32_bf16 v[68:71], a[72:75], a[192:195], v[68:71]
 s_lshr_b32 s31, s3, 1
 ds_read_b64_tr_b16 a[98:99], v7 offset:4096
 v_mul_f32 v52, s34, v52
 v_mfma_f32_16x16x32_bf16 v[68:71], a[76:79], a[200:203], v[68:71]
 s_add_u32 s59, s56, 0
 ds_read_b64_tr_b16 a[100:101], v7 offset:16384
 v_mul_f32 v53, s34, v53
 v_mfma_f32_16x16x32_bf16 v[68:71], a[80:83], a[208:211], v[68:71]
 s_waitcnt lgkmcnt(3)
 ds_read_b64_tr_b16 a[102:103], v7 offset:20480
 v_xor_b32 v8, 128, v6
 v_mfma_f32_16x16x32_bf16 v[68:71], a[84:87], a[216:219], v[68:71]
 ds_read_b64_tr_b16 a[104:105], v8 offset:0
 buffer_store_dwordx4 v[184:187], v1, s[12:15], s59 offen offset:3072 sc1
 v_mfma_f32_16x16x32_bf16 v[68:71], a[88:91], a[112:115], v[68:71]
 s_add_u32 s30, s30, s31
 ds_read_b64_tr_b16 a[106:107], v8 offset:4096
 v_mul_f32 v54, s34, v54
 v_mfma_f32_16x16x32_bf16 v[68:71], a[92:95], a[120:123], v[68:71]
 s_min_u32 s30, s30, 223
 ds_read_b64_tr_b16 a[108:109], v8 offset:16384
 v_mul_f32 v55, s34, v55
 v_mfma_f32_16x16x32_bf16 v[76:79], a[72:75], a[196:199], v[76:79]
 s_lshl_b32 s30, s30, 2
 ds_read_b64_tr_b16 a[110:111], v8 offset:20480
 v_xor_b32 v9, 65664, v6
 v_mfma_f32_16x16x32_bf16 v[76:79], a[76:79], a[204:207], v[76:79]
 s_and_b32 s4, s2, 127
 ds_read_b64_tr_b16 a[64:65], v9 offset:0
 v_cvt_pk_bf16_f32 v28, v28, v29
 v_mfma_f32_16x16x32_bf16 v[76:79], a[80:83], a[212:215], v[76:79]
 s_lshl_b32 s4, s4, 2
 ds_read_b64_tr_b16 a[66:67], v9 offset:4096
 v_cvt_pk_bf16_f32 v29, v30, v31
 v_mfma_f32_16x16x32_bf16 v[76:79], a[84:87], a[220:223], v[76:79]
 s_add_u32 s4, s4, s3
 ds_read_b64_tr_b16 a[68:69], v9 offset:16384
 v_cvt_pk_bf16_f32 v30, v52, v53
 v_mfma_f32_16x16x32_bf16 v[76:79], a[88:91], a[116:119], v[76:79]
 s_mul_i32 s5, s4, 17408
 ds_read_b64_tr_b16 a[70:71], v9 offset:20480
 v_xor_b32 v10, 131232, v6
 v_mfma_f32_16x16x32_bf16 v[76:79], a[92:95], a[124:127], v[76:79]
 s_waitcnt lgkmcnt(6)
 ds_read_b64_tr_b16 a[72:73], v10 offset:0
 v_cvt_pk_bf16_f32 v31, v54, v55
 v_mfma_f32_16x16x32_bf16 v[84:87], a[96:99], a[192:195], v[84:87]
 s_add_u32 s59, s56, 57344
 ds_read_b64_tr_b16 a[74:75], v10 offset:4096
 v_accvgpr_write_b32 a0, v28
 v_mfma_f32_16x16x32_bf16 v[84:87], a[100:103], a[200:203], v[84:87]
 ds_read_b64_tr_b16 a[76:77], v10 offset:16384
 buffer_store_dwordx4 v[192:195], v1, s[12:15], s59 offen offset:2048 sc1
 v_mfma_f32_16x16x32_bf16 v[84:87], a[104:107], a[208:211], v[84:87]
 s_waitcnt lgkmcnt(3)
 ds_read_b64_tr_b16 a[78:79], v10 offset:20480
 v_xor_b32 v7, 160, v6
 v_mfma_f32_16x16x32_bf16 v[84:87], a[108:111], a[216:219], v[84:87]
 s_add_u32 s5, s5, 50331648
 ds_read_b64_tr_b16 a[80:81], v7 offset:0
 v_accvgpr_write_b32 a1, v29
 v_mfma_f32_16x16x32_bf16 v[84:87], a[64:67], a[112:115], v[84:87]
 s_add_u32 s4, s5, 0x2000
 ds_read_b64_tr_b16 a[82:83], v7 offset:4096
 v_accvgpr_write_b32 a2, v30
 v_mfma_f32_16x16x32_bf16 v[84:87], a[68:71], a[120:123], v[84:87]
 s_mov_b32 s6, 2.0
 ds_read_b64_tr_b16 a[84:85], v7 offset:16384
 v_accvgpr_write_b32 a3, v31
 v_mfma_f32_16x16x32_bf16 v[92:95], a[96:99], a[196:199], v[92:95]
 s_min_u32 s7, s38, 1
 ds_read_b64_tr_b16 a[86:87], v7 offset:20480
 v_xor_b32 v8, 65696, v6
 v_mfma_f32_16x16x32_bf16 v[92:95], a[100:103], a[204:207], v[92:95]
 s_cmp_eq_u32 s44, 1
 s_cselect_b32 s53, 1, 0
 ds_read_b64_tr_b16 a[88:89], v8 offset:0
 v_mfma_f32_16x16x32_bf16 v[92:95], a[104:107], a[212:215], v[92:95]
 s_cmp_eq_u32 s38, 0
 s_cmov_b32 s4, 2.0
 ds_read_b64_tr_b16 a[90:91], v8 offset:4096
 v_mfma_f32_16x16x32_bf16 v[92:95], a[108:111], a[220:223], v[92:95]
 s_cmp_eq_u32 s38, 0
 s_cmov_b32 s5, 2.0
 ds_read_b64_tr_b16 a[92:93], v8 offset:16384
 v_mfma_f32_16x16x32_bf16 v[92:95], a[64:67], a[116:119], v[92:95]
 s_add_u32 s59, s56, 49152
 ds_read_b64_tr_b16 a[94:95], v8 offset:20480
 v_xor_b32 v9, 131264, v6
 v_mfma_f32_16x16x32_bf16 v[92:95], a[68:71], a[124:127], v[92:95]
 s_waitcnt lgkmcnt(6)
 ds_read_b64_tr_b16 a[96:97], v9 offset:0
 buffer_store_dwordx4 v[200:203], v1, s[12:15], s59 offen offset:2048 sc1
 v_mfma_f32_16x16x32_bf16 v[100:103], a[72:75], a[192:195], v[100:103]
 s_cmp_eq_u32 s38, 0
 s_cmov_b32 s60, s58
 ds_read_b64_tr_b16 a[98:99], v9 offset:4096
 v_mfma_f32_16x16x32_bf16 v[100:103], a[76:79], a[200:203], v[100:103]
 s_mov_b64 s[8:9], s[12:13]
 ds_read_b64_tr_b16 a[100:101], v9 offset:16384
 v_mul_f32 v44, s34, v44
 v_mfma_f32_16x16x32_bf16 v[100:103], a[80:83], a[208:211], v[100:103]
 s_waitcnt lgkmcnt(3)
 ds_read_b64_tr_b16 a[102:103], v9 offset:20480
 v_xor_b32 v10, 192, v6
 v_mfma_f32_16x16x32_bf16 v[100:103], a[84:87], a[216:219], v[100:103]
 s_mov_b32 s10, s14
 ds_read_b64_tr_b16 a[104:105], v10 offset:0
 v_mul_f32 v45, s34, v45
 v_mfma_f32_16x16x32_bf16 v[100:103], a[88:91], a[112:115], v[100:103]
 s_mov_b32 s76, 0
 ds_read_b64_tr_b16 a[106:107], v10 offset:4096
 v_mul_f32 v46, s34, v46
 v_mfma_f32_16x16x32_bf16 v[100:103], a[92:95], a[120:123], v[100:103]
 s_movk_i32 s77, 0x1000
 ds_read_b64_tr_b16 a[108:109], v10 offset:16384
 v_mul_f32 v47, s34, v47
 v_mfma_f32_16x16x32_bf16 v[108:111], a[72:75], a[196:199], v[108:111]
 s_mov_b32 s51, 0
 ds_read_b64_tr_b16 a[110:111], v10 offset:20480
 v_xor_b32 v7, 65728, v6
 v_mfma_f32_16x16x32_bf16 v[108:111], a[76:79], a[204:207], v[108:111]
 s_mul_i32 s78, s26, 229376
 ds_read_b64_tr_b16 a[64:65], v7 offset:0
 v_mul_f32 v60, s34, v60
 v_mfma_f32_16x16x32_bf16 v[108:111], a[80:83], a[212:215], v[108:111]
 s_add_u32 s59, s56, 40960
 ds_read_b64_tr_b16 a[66:67], v7 offset:4096
 v_mul_f32 v61, s34, v61
 v_mfma_f32_16x16x32_bf16 v[108:111], a[84:87], a[220:223], v[108:111]
 ds_read_b64_tr_b16 a[68:69], v7 offset:16384
 buffer_store_dwordx4 v[208:211], v1, s[12:15], s59 offen offset:2048 sc1
 v_mfma_f32_16x16x32_bf16 v[108:111], a[88:91], a[116:119], v[108:111]
 s_add_u32 s79, s78, 28672
 ds_read_b64_tr_b16 a[70:71], v7 offset:20480
 v_xor_b32 v8, 131296, v6
 v_mfma_f32_16x16x32_bf16 v[108:111], a[92:95], a[124:127], v[108:111]
 s_waitcnt lgkmcnt(6)
 ds_read_b64_tr_b16 a[72:73], v8 offset:0
 v_mul_f32 v62, s34, v62
 v_mfma_f32_16x16x32_bf16 v[116:119], a[96:99], a[192:195], v[116:119]
 s_add_u32 s80, s78, 57344
 ds_read_b64_tr_b16 a[74:75], v8 offset:4096
 v_mul_f32 v63, s34, v63
 v_mfma_f32_16x16x32_bf16 v[116:119], a[100:103], a[200:203], v[116:119]
 s_add_u32 s81, s78, 86016
 ds_read_b64_tr_b16 a[76:77], v8 offset:16384
 v_cvt_pk_bf16_f32 v44, v44, v45
 v_mfma_f32_16x16x32_bf16 v[116:119], a[104:107], a[208:211], v[116:119]
 s_waitcnt lgkmcnt(3)
 ds_read_b64_tr_b16 a[78:79], v8 offset:20480
 v_xor_b32 v9, 224, v6
 v_mfma_f32_16x16x32_bf16 v[116:119], a[108:111], a[216:219], v[116:119]
 s_add_u32 s82, s78, 114688
 ds_read_b64_tr_b16 a[80:81], v9 offset:0
 v_cvt_pk_bf16_f32 v45, v46, v47
 v_mfma_f32_16x16x32_bf16 v[116:119], a[64:67], a[112:115], v[116:119]
 s_add_u32 s83, s78, 143360
 ds_read_b64_tr_b16 a[82:83], v9 offset:4096
 v_cvt_pk_bf16_f32 v46, v60, v61
 v_mfma_f32_16x16x32_bf16 v[116:119], a[68:71], a[120:123], v[116:119]
 s_add_u32 s84, s78, 172032
 ds_read_b64_tr_b16 a[84:85], v9 offset:16384
 v_cvt_pk_bf16_f32 v47, v62, v63
 v_mfma_f32_16x16x32_bf16 v[124:127], a[96:99], a[196:199], v[124:127]
 s_add_u32 s59, s56, 32768
 ds_read_b64_tr_b16 a[86:87], v9 offset:20480
 v_xor_b32 v10, 65760, v6
 v_mfma_f32_16x16x32_bf16 v[124:127], a[100:103], a[204:207], v[124:127]
 ds_read_b64_tr_b16 a[88:89], v10 offset:0
 buffer_store_dwordx4 v[216:219], v1, s[12:15], s59 offen offset:2048 sc1
 v_mfma_f32_16x16x32_bf16 v[124:127], a[104:107], a[212:215], v[124:127]
 s_add_u32 s85, s78, 200704
 ds_read_b64_tr_b16 a[90:91], v10 offset:4096
 v_accvgpr_write_b32 a32, v44
 v_mfma_f32_16x16x32_bf16 v[124:127], a[108:111], a[220:223], v[124:127]
 ds_read_b64_tr_b16 a[92:93], v10 offset:16384
 v_accvgpr_write_b32 a33, v45
 v_mfma_f32_16x16x32_bf16 v[124:127], a[64:67], a[116:119], v[124:127]
 ds_read_b64_tr_b16 a[94:95], v10 offset:20480
 v_xor_b32 v7, 131328, v6
 v_mfma_f32_16x16x32_bf16 v[124:127], a[68:71], a[124:127], v[124:127]
 s_waitcnt lgkmcnt(6)
 ds_read_b64_tr_b16 a[96:97], v7 offset:0
 v_accvgpr_write_b32 a34, v46
 v_mfma_f32_16x16x32_bf16 v[132:135], a[72:75], a[192:195], v[132:135]
 ds_read_b64_tr_b16 a[98:99], v7 offset:4096
 v_accvgpr_write_b32 a35, v47
 v_mfma_f32_16x16x32_bf16 v[132:135], a[76:79], a[200:203], v[132:135]
 ds_read_b64_tr_b16 a[100:101], v7 offset:16384
 v_mul_f32 v20, s34, v20
 v_mfma_f32_16x16x32_bf16 v[132:135], a[80:83], a[208:211], v[132:135]
 s_waitcnt lgkmcnt(3)
 ds_read_b64_tr_b16 a[102:103], v7 offset:20480
 v_xor_b32 v8, 256, v6
 v_mfma_f32_16x16x32_bf16 v[132:135], a[84:87], a[216:219], v[132:135]
 ds_read_b64_tr_b16 a[104:105], v8 offset:0
 v_mul_f32 v21, s34, v21
 v_mfma_f32_16x16x32_bf16 v[132:135], a[88:91], a[112:115], v[132:135]
 s_add_u32 s59, s56, 57344
 ds_read_b64_tr_b16 a[106:107], v8 offset:4096
 v_mul_f32 v22, s34, v22
 v_mfma_f32_16x16x32_bf16 v[132:135], a[92:95], a[120:123], v[132:135]
 ds_read_b64_tr_b16 a[108:109], v8 offset:16384
 buffer_store_dwordx4 v[224:227], v1, s[12:15], s59 offen offset:3072 sc1
 v_mfma_f32_16x16x32_bf16 v[140:143], a[72:75], a[196:199], v[140:143]
 ds_read_b64_tr_b16 a[110:111], v8 offset:20480
 v_xor_b32 v9, 65792, v6
 v_mfma_f32_16x16x32_bf16 v[140:143], a[76:79], a[204:207], v[140:143]
 ds_read_b64_tr_b16 a[64:65], v9 offset:0
 v_mul_f32 v23, s34, v23
 v_mfma_f32_16x16x32_bf16 v[140:143], a[80:83], a[212:215], v[140:143]
 ds_read_b64_tr_b16 a[66:67], v9 offset:4096
 v_mul_f32 v68, s34, v68
 v_mfma_f32_16x16x32_bf16 v[140:143], a[84:87], a[220:223], v[140:143]
 ds_read_b64_tr_b16 a[68:69], v9 offset:16384
 v_mul_f32 v69, s34, v69
 v_mfma_f32_16x16x32_bf16 v[140:143], a[88:91], a[116:119], v[140:143]
 ds_read_b64_tr_b16 a[70:71], v9 offset:20480
 v_xor_b32 v10, 131360, v6
 v_mfma_f32_16x16x32_bf16 v[140:143], a[92:95], a[124:127], v[140:143]
 s_waitcnt lgkmcnt(6)
 ds_read_b64_tr_b16 a[72:73], v10 offset:0
 v_mul_f32 v70, s34, v70
 v_mfma_f32_16x16x32_bf16 v[148:151], a[96:99], a[192:195], v[148:151]
 ds_read_b64_tr_b16 a[74:75], v10 offset:4096
 v_mul_f32 v71, s34, v71
 v_mfma_f32_16x16x32_bf16 v[148:151], a[100:103], a[200:203], v[148:151]
 s_add_u32 s59, s56, 49152
 ds_read_b64_tr_b16 a[76:77], v10 offset:16384
 v_cvt_pk_bf16_f32 v20, v20, v21
 v_mfma_f32_16x16x32_bf16 v[148:151], a[104:107], a[208:211], v[148:151]
 s_waitcnt lgkmcnt(3)
 ds_read_b64_tr_b16 a[78:79], v10 offset:20480
 v_xor_b32 v7, 288, v6
 v_mfma_f32_16x16x32_bf16 v[148:151], a[108:111], a[216:219], v[148:151]
 ds_read_b64_tr_b16 a[80:81], v7 offset:0
 buffer_store_dwordx4 v[232:235], v1, s[12:15], s59 offen offset:3072 sc1
 v_mfma_f32_16x16x32_bf16 v[148:151], a[64:67], a[112:115], v[148:151]
 ds_read_b64_tr_b16 a[82:83], v7 offset:4096
 v_cvt_pk_bf16_f32 v21, v22, v23
 v_mfma_f32_16x16x32_bf16 v[148:151], a[68:71], a[120:123], v[148:151]
 ds_read_b64_tr_b16 a[84:85], v7 offset:16384
 v_cvt_pk_bf16_f32 v22, v68, v69
 v_mfma_f32_16x16x32_bf16 v[156:159], a[96:99], a[196:199], v[156:159]
 ds_read_b64_tr_b16 a[86:87], v7 offset:20480
 v_xor_b32 v8, 65824, v6
 v_mfma_f32_16x16x32_bf16 v[156:159], a[100:103], a[204:207], v[156:159]
 ds_read_b64_tr_b16 a[88:89], v8 offset:0
 v_cvt_pk_bf16_f32 v23, v70, v71
 v_mfma_f32_16x16x32_bf16 v[156:159], a[104:107], a[212:215], v[156:159]
 ds_read_b64_tr_b16 a[90:91], v8 offset:4096
 v_accvgpr_write_b32 a4, v20
 v_mfma_f32_16x16x32_bf16 v[156:159], a[108:111], a[220:223], v[156:159]
 ds_read_b64_tr_b16 a[92:93], v8 offset:16384
 v_accvgpr_write_b32 a5, v21
 v_mfma_f32_16x16x32_bf16 v[156:159], a[64:67], a[116:119], v[156:159]
 ds_read_b64_tr_b16 a[94:95], v8 offset:20480
 v_xor_b32 v9, 131392, v6
 v_mfma_f32_16x16x32_bf16 v[156:159], a[68:71], a[124:127], v[156:159]
 s_waitcnt lgkmcnt(6)
 ds_read_b64_tr_b16 a[96:97], v9 offset:0
 v_accvgpr_write_b32 a6, v22
 v_mfma_f32_16x16x32_bf16 v[164:167], a[72:75], a[192:195], v[164:167]
 s_add_u32 s59, s56, 40960
 ds_read_b64_tr_b16 a[98:99], v9 offset:4096
 v_accvgpr_write_b32 a7, v23
 v_mfma_f32_16x16x32_bf16 v[164:167], a[76:79], a[200:203], v[164:167]
 ds_read_b64_tr_b16 a[100:101], v9 offset:16384
 buffer_store_dwordx4 v[240:243], v1, s[12:15], s59 offen offset:3072 sc1
 v_mfma_f32_16x16x32_bf16 v[164:167], a[80:83], a[208:211], v[164:167]
 s_waitcnt lgkmcnt(3)
 ds_read_b64_tr_b16 a[102:103], v9 offset:20480
 v_xor_b32 v10, 320, v6
 v_mfma_f32_16x16x32_bf16 v[164:167], a[84:87], a[216:219], v[164:167]
 ds_read_b64_tr_b16 a[104:105], v10 offset:0
 v_mul_f32 v36, s34, v36
 v_mfma_f32_16x16x32_bf16 v[164:167], a[88:91], a[112:115], v[164:167]
 ds_read_b64_tr_b16 a[106:107], v10 offset:4096
 v_mul_f32 v37, s34, v37
 v_mfma_f32_16x16x32_bf16 v[164:167], a[92:95], a[120:123], v[164:167]
 ds_read_b64_tr_b16 a[108:109], v10 offset:16384
 v_mul_f32 v38, s34, v38
 v_mfma_f32_16x16x32_bf16 v[172:175], a[72:75], a[196:199], v[172:175]
 ds_read_b64_tr_b16 a[110:111], v10 offset:20480
 v_xor_b32 v7, 65856, v6
 v_mfma_f32_16x16x32_bf16 v[172:175], a[76:79], a[204:207], v[172:175]
 ds_read_b64_tr_b16 a[64:65], v7 offset:0
 v_mul_f32 v39, s34, v39
 v_mfma_f32_16x16x32_bf16 v[172:175], a[80:83], a[212:215], v[172:175]
 ds_read_b64_tr_b16 a[66:67], v7 offset:4096
 v_mul_f32 v76, s34, v76
 v_mfma_f32_16x16x32_bf16 v[172:175], a[84:87], a[220:223], v[172:175]
 ds_read_b64_tr_b16 a[68:69], v7 offset:16384
 v_mul_f32 v77, s34, v77
 v_mfma_f32_16x16x32_bf16 v[172:175], a[88:91], a[116:119], v[172:175]
 s_add_u32 s59, s56, 32768
 ds_read_b64_tr_b16 a[70:71], v7 offset:20480
 v_xor_b32 v8, 131424, v6
 v_mfma_f32_16x16x32_bf16 v[172:175], a[92:95], a[124:127], v[172:175]
 s_waitcnt lgkmcnt(6)
 ds_read_b64_tr_b16 a[72:73], v8 offset:0
 buffer_store_dwordx4 v[248:251], v1, s[12:15], s59 offen offset:3072 sc1
 v_mfma_f32_16x16x32_bf16 v[180:183], a[96:99], a[192:195], v[180:183]
 ds_read_b64_tr_b16 a[74:75], v8 offset:4096
 v_mul_f32 v78, s34, v78
 v_mfma_f32_16x16x32_bf16 v[180:183], a[100:103], a[200:203], v[180:183]
 ds_read_b64_tr_b16 a[76:77], v8 offset:16384
 v_mul_f32 v79, s34, v79
 v_mfma_f32_16x16x32_bf16 v[180:183], a[104:107], a[208:211], v[180:183]
 s_waitcnt lgkmcnt(3)
 ds_read_b64_tr_b16 a[78:79], v8 offset:20480
 v_xor_b32 v9, 352, v6
 v_mfma_f32_16x16x32_bf16 v[180:183], a[108:111], a[216:219], v[180:183]
 ds_read_b64_tr_b16 a[80:81], v9 offset:0
 v_cvt_pk_bf16_f32 v36, v36, v37
 v_mfma_f32_16x16x32_bf16 v[180:183], a[64:67], a[112:115], v[180:183]
 ds_read_b64_tr_b16 a[82:83], v9 offset:4096
 v_cvt_pk_bf16_f32 v37, v38, v39
 v_mfma_f32_16x16x32_bf16 v[180:183], a[68:71], a[120:123], v[180:183]
 ds_read_b64_tr_b16 a[84:85], v9 offset:16384
 v_cvt_pk_bf16_f32 v38, v76, v77
 v_mfma_f32_16x16x32_bf16 v[188:191], a[96:99], a[196:199], v[188:191]
 ds_read_b64_tr_b16 a[86:87], v9 offset:20480
 v_xor_b32 v10, 65888, v6
 v_mfma_f32_16x16x32_bf16 v[188:191], a[100:103], a[204:207], v[188:191]
 ds_read_b64_tr_b16 a[88:89], v10 offset:0
 v_cvt_pk_bf16_f32 v39, v78, v79
 v_mfma_f32_16x16x32_bf16 v[188:191], a[104:107], a[212:215], v[188:191]
 ds_read_b64_tr_b16 a[90:91], v10 offset:4096
 v_accvgpr_write_b32 a36, v36
 v_mfma_f32_16x16x32_bf16 v[188:191], a[108:111], a[220:223], v[188:191]
 ds_read_b64_tr_b16 a[92:93], v10 offset:16384
 v_accvgpr_write_b32 a37, v37
 v_mfma_f32_16x16x32_bf16 v[188:191], a[64:67], a[116:119], v[188:191]
 ds_read_b64_tr_b16 a[94:95], v10 offset:20480
 v_xor_b32 v7, 131456, v6
 v_mfma_f32_16x16x32_bf16 v[188:191], a[68:71], a[124:127], v[188:191]
 s_waitcnt lgkmcnt(6)
 ds_read_b64_tr_b16 a[96:97], v7 offset:0
 v_accvgpr_write_b32 a38, v38
 v_mfma_f32_16x16x32_bf16 v[196:199], a[72:75], a[192:195], v[196:199]
 ds_read_b64_tr_b16 a[98:99], v7 offset:4096
 v_accvgpr_write_b32 a39, v39
 v_mfma_f32_16x16x32_bf16 v[196:199], a[76:79], a[200:203], v[196:199]
 ds_read_b64_tr_b16 a[100:101], v7 offset:16384
 v_mul_f32 v84, s34, v84
 v_mfma_f32_16x16x32_bf16 v[196:199], a[80:83], a[208:211], v[196:199]
 s_waitcnt lgkmcnt(3)
 ds_read_b64_tr_b16 a[102:103], v7 offset:20480
 v_xor_b32 v8, 384, v6
 v_mfma_f32_16x16x32_bf16 v[196:199], a[84:87], a[216:219], v[196:199]
 ds_read_b64_tr_b16 a[104:105], v8 offset:0
 v_mul_f32 v85, s34, v85
 v_mfma_f32_16x16x32_bf16 v[196:199], a[88:91], a[112:115], v[196:199]
 ds_read_b64_tr_b16 a[106:107], v8 offset:4096
 v_mul_f32 v86, s34, v86
 v_mfma_f32_16x16x32_bf16 v[196:199], a[92:95], a[120:123], v[196:199]
 ds_read_b64_tr_b16 a[108:109], v8 offset:16384
 v_mul_f32 v87, s34, v87
 v_mfma_f32_16x16x32_bf16 v[204:207], a[72:75], a[196:199], v[204:207]
 ds_read_b64_tr_b16 a[110:111], v8 offset:20480
 v_xor_b32 v9, 65920, v6
 v_mfma_f32_16x16x32_bf16 v[204:207], a[76:79], a[204:207], v[204:207]
 ds_read_b64_tr_b16 a[64:65], v9 offset:0
 v_mul_f32 v100, s34, v100
 v_mfma_f32_16x16x32_bf16 v[204:207], a[80:83], a[212:215], v[204:207]
 ds_read_b64_tr_b16 a[66:67], v9 offset:4096
 v_mul_f32 v101, s34, v101
 v_mfma_f32_16x16x32_bf16 v[204:207], a[84:87], a[220:223], v[204:207]
 ds_read_b64_tr_b16 a[68:69], v9 offset:16384
 v_mul_f32 v102, s34, v102
 v_mfma_f32_16x16x32_bf16 v[204:207], a[88:91], a[116:119], v[204:207]
 ds_read_b64_tr_b16 a[70:71], v9 offset:20480
 v_xor_b32 v10, 131488, v6
 v_mfma_f32_16x16x32_bf16 v[204:207], a[92:95], a[124:127], v[204:207]
 s_waitcnt lgkmcnt(6)
 ds_read_b64_tr_b16 a[72:73], v10 offset:0
 v_mul_f32 v103, s34, v103
 v_mfma_f32_16x16x32_bf16 v[212:215], a[96:99], a[192:195], v[212:215]
 ds_read_b64_tr_b16 a[74:75], v10 offset:4096
 v_cvt_pk_bf16_f32 v84, v84, v85
 v_mfma_f32_16x16x32_bf16 v[212:215], a[100:103], a[200:203], v[212:215]
 ds_read_b64_tr_b16 a[76:77], v10 offset:16384
 v_cvt_pk_bf16_f32 v85, v86, v87
 v_mfma_f32_16x16x32_bf16 v[212:215], a[104:107], a[208:211], v[212:215]
 s_waitcnt lgkmcnt(3)
 ds_read_b64_tr_b16 a[78:79], v10 offset:20480
 v_xor_b32 v7, 416, v6
 v_mfma_f32_16x16x32_bf16 v[212:215], a[108:111], a[216:219], v[212:215]
 ds_read_b64_tr_b16 a[80:81], v7 offset:0
 v_cvt_pk_bf16_f32 v86, v100, v101
 v_mfma_f32_16x16x32_bf16 v[212:215], a[64:67], a[112:115], v[212:215]
 ds_read_b64_tr_b16 a[82:83], v7 offset:4096
 v_cvt_pk_bf16_f32 v87, v102, v103
 v_mfma_f32_16x16x32_bf16 v[212:215], a[68:71], a[120:123], v[212:215]
 ds_read_b64_tr_b16 a[84:85], v7 offset:16384
 v_accvgpr_write_b32 a8, v84
 v_mfma_f32_16x16x32_bf16 v[220:223], a[96:99], a[196:199], v[220:223]
 ds_read_b64_tr_b16 a[86:87], v7 offset:20480
 v_xor_b32 v8, 65952, v6
 v_mfma_f32_16x16x32_bf16 v[220:223], a[100:103], a[204:207], v[220:223]
 ds_read_b64_tr_b16 a[88:89], v8 offset:0
 v_accvgpr_write_b32 a9, v85
 v_mfma_f32_16x16x32_bf16 v[220:223], a[104:107], a[212:215], v[220:223]
 ds_read_b64_tr_b16 a[90:91], v8 offset:4096
 v_accvgpr_write_b32 a10, v86
 v_mfma_f32_16x16x32_bf16 v[220:223], a[108:111], a[220:223], v[220:223]
 ds_read_b64_tr_b16 a[92:93], v8 offset:16384
 v_accvgpr_write_b32 a11, v87
 v_mfma_f32_16x16x32_bf16 v[220:223], a[64:67], a[116:119], v[220:223]
 ds_read_b64_tr_b16 a[94:95], v8 offset:20480
 v_xor_b32 v9, 131520, v6
 v_mfma_f32_16x16x32_bf16 v[220:223], a[68:71], a[124:127], v[220:223]
 s_waitcnt lgkmcnt(6)
 ds_read_b64_tr_b16 a[96:97], v9 offset:0
 v_mul_f32 v92, s34, v92
 v_mfma_f32_16x16x32_bf16 v[228:231], a[72:75], a[192:195], v[228:231]
 ds_read_b64_tr_b16 a[98:99], v9 offset:4096
 v_mul_f32 v93, s34, v93
 v_mfma_f32_16x16x32_bf16 v[228:231], a[76:79], a[200:203], v[228:231]
 ds_read_b64_tr_b16 a[100:101], v9 offset:16384
 v_mul_f32 v94, s34, v94
 v_mfma_f32_16x16x32_bf16 v[228:231], a[80:83], a[208:211], v[228:231]
 s_waitcnt lgkmcnt(3)
 ds_read_b64_tr_b16 a[102:103], v9 offset:20480
 v_xor_b32 v10, 448, v6
 v_mfma_f32_16x16x32_bf16 v[228:231], a[84:87], a[216:219], v[228:231]
 ds_read_b64_tr_b16 a[104:105], v10 offset:0
 v_mul_f32 v95, s34, v95
 v_mfma_f32_16x16x32_bf16 v[228:231], a[88:91], a[112:115], v[228:231]
 ds_read_b64_tr_b16 a[106:107], v10 offset:4096
 v_mul_f32 v108, s34, v108
 v_mfma_f32_16x16x32_bf16 v[228:231], a[92:95], a[120:123], v[228:231]
 ds_read_b64_tr_b16 a[108:109], v10 offset:16384
 v_mul_f32 v109, s34, v109
 v_mfma_f32_16x16x32_bf16 v[236:239], a[72:75], a[196:199], v[236:239]
 ds_read_b64_tr_b16 a[110:111], v10 offset:20480
 v_xor_b32 v7, 65984, v6
 v_mfma_f32_16x16x32_bf16 v[236:239], a[76:79], a[204:207], v[236:239]
 ds_read_b64_tr_b16 a[64:65], v7 offset:0
 buffer_load_dword v13, v12, s[12:15], s58 offen sc1
 v_mfma_f32_16x16x32_bf16 v[236:239], a[80:83], a[212:215], v[236:239]
 ds_read_b64_tr_b16 a[66:67], v7 offset:4096
 v_mul_f32 v110, s34, v110
 v_mfma_f32_16x16x32_bf16 v[236:239], a[84:87], a[220:223], v[236:239]
 ds_read_b64_tr_b16 a[68:69], v7 offset:16384
 v_mul_f32 v111, s34, v111
 v_mfma_f32_16x16x32_bf16 v[236:239], a[88:91], a[116:119], v[236:239]
 ds_read_b64_tr_b16 a[70:71], v7 offset:20480
 v_xor_b32 v8, 131552, v6
 v_mfma_f32_16x16x32_bf16 v[236:239], a[92:95], a[124:127], v[236:239]
 s_waitcnt lgkmcnt(6)
 ds_read_b64_tr_b16 a[72:73], v8 offset:0
 v_cvt_pk_bf16_f32 v92, v92, v93
 v_mfma_f32_16x16x32_bf16 v[244:247], a[96:99], a[192:195], v[244:247]
 ds_read_b64_tr_b16 a[74:75], v8 offset:4096
 v_cvt_pk_bf16_f32 v93, v94, v95
 v_mfma_f32_16x16x32_bf16 v[244:247], a[100:103], a[200:203], v[244:247]
 ds_read_b64_tr_b16 a[76:77], v8 offset:16384
 v_cvt_pk_bf16_f32 v94, v108, v109
 v_mfma_f32_16x16x32_bf16 v[244:247], a[104:107], a[208:211], v[244:247]
 s_waitcnt lgkmcnt(3)
 ds_read_b64_tr_b16 a[78:79], v8 offset:20480
 v_xor_b32 v9, 480, v6
 v_mfma_f32_16x16x32_bf16 v[244:247], a[108:111], a[216:219], v[244:247]
 ds_read_b64_tr_b16 a[80:81], v9 offset:0
 v_cvt_pk_bf16_f32 v95, v110, v111
 v_mfma_f32_16x16x32_bf16 v[244:247], a[64:67], a[112:115], v[244:247]
 ds_read_b64_tr_b16 a[82:83], v9 offset:4096
 v_accvgpr_write_b32 a40, v92
 v_mfma_f32_16x16x32_bf16 v[244:247], a[68:71], a[120:123], v[244:247]
 ds_read_b64_tr_b16 a[84:85], v9 offset:16384
 v_accvgpr_write_b32 a41, v93
 v_mfma_f32_16x16x32_bf16 v[252:255], a[96:99], a[196:199], v[252:255]
 ds_read_b64_tr_b16 a[86:87], v9 offset:20480
 v_xor_b32 v10, 66016, v6
 v_mfma_f32_16x16x32_bf16 v[252:255], a[100:103], a[204:207], v[252:255]
 ds_read_b64_tr_b16 a[88:89], v10 offset:0
 v_accvgpr_write_b32 a42, v94
 v_mfma_f32_16x16x32_bf16 v[252:255], a[104:107], a[212:215], v[252:255]
 ds_read_b64_tr_b16 a[90:91], v10 offset:4096
 v_accvgpr_write_b32 a43, v95
 v_mfma_f32_16x16x32_bf16 v[252:255], a[108:111], a[220:223], v[252:255]
 ds_read_b64_tr_b16 a[92:93], v10 offset:16384
 v_mfma_f32_16x16x32_bf16 v[252:255], a[64:67], a[116:119], v[252:255]
 ds_read_b64_tr_b16 a[94:95], v10 offset:20480
 v_mfma_f32_16x16x32_bf16 v[252:255], a[68:71], a[124:127], v[252:255]
 s_waitcnt lgkmcnt(6)
 v_mfma_f32_16x16x32_bf16 v[16:19], a[72:75], a[192:195], v[16:19]
 v_mfma_f32_16x16x32_bf16 v[16:19], a[76:79], a[200:203], v[16:19]
 v_mfma_f32_16x16x32_bf16 v[16:19], a[80:83], a[208:211], v[16:19]
 s_waitcnt lgkmcnt(0)
 v_mfma_f32_16x16x32_bf16 v[16:19], a[84:87], a[216:219], v[16:19]
 v_mfma_f32_16x16x32_bf16 v[16:19], a[88:91], a[112:115], v[16:19]
 v_mfma_f32_16x16x32_bf16 v[16:19], a[92:95], a[120:123], v[16:19]
 v_mfma_f32_16x16x32_bf16 v[24:27], a[72:75], a[196:199], v[24:27]
 v_mfma_f32_16x16x32_bf16 v[24:27], a[76:79], a[204:207], v[24:27]
 v_mfma_f32_16x16x32_bf16 v[24:27], a[80:83], a[212:215], v[24:27]
 v_mfma_f32_16x16x32_bf16 v[24:27], a[84:87], a[220:223], v[24:27]
 s_waitcnt lgkmcnt(0)
 v_mfma_f32_16x16x32_bf16 v[24:27], a[88:91], a[116:119], v[24:27]
 s_barrier
 v_mfma_f32_16x16x32_bf16 v[24:27], a[92:95], a[124:127], v[24:27]
 s_waitcnt vmcnt(0)
 v_cmp_ne_u32 s[16:17], 0, v13
 v_cmp_gt_u32 vcc, 256, v5
 s_or_b64 vcc, vcc, s[16:17]
 s_mov_b32 m0, s40
 s_cselect_b32 s48, 0, 1
 s_cselect_b32 s52, 2.0, s42
 buffer_load_dwordx4 v1, s[12:15], s52 offen offset:0 sc1 lds
 v_pk_mul_f32 v[116:117], v[116:117], s[34:35]
 v_pk_mul_f32 v[118:119], v[118:119], s[34:35]
 v_pk_mul_f32 v[132:133], v[132:133], s[34:35]
 v_pk_mul_f32 v[134:135], v[134:135], s[34:35]
 v_cvt_pk_bf16_f32 v116, v116, v117
 v_cvt_pk_bf16_f32 v117, v118, v119
 v_cvt_pk_bf16_f32 v118, v132, v133
 v_cvt_pk_bf16_f32 v119, v134, v135
 v_accvgpr_write_b32 a12, v116
 v_accvgpr_write_b32 a13, v117
 v_accvgpr_write_b32 a14, v118
 v_accvgpr_write_b32 a15, v119
 v_pk_mul_f32 v[124:125], v[124:125], s[34:35]
 v_pk_mul_f32 v[126:127], v[126:127], s[34:35]
 v_pk_mul_f32 v[140:141], v[140:141], s[34:35]
 buffer_load_dwordx4 v1, s[12:15], s52 offen offset:1024 sc1 lds
 v_pk_mul_f32 v[142:143], v[142:143], s[34:35]
 v_cvt_pk_bf16_f32 v124, v124, v125
 v_cvt_pk_bf16_f32 v125, v126, v127
 v_cvt_pk_bf16_f32 v126, v140, v141
 v_cvt_pk_bf16_f32 v127, v142, v143
 v_accvgpr_write_b32 a44, v124
 v_accvgpr_write_b32 a45, v125
 v_accvgpr_write_b32 a46, v126
 v_accvgpr_write_b32 a47, v127
 v_pk_mul_f32 v[148:149], v[148:149], s[34:35]
 v_pk_mul_f32 v[150:151], v[150:151], s[34:35]
 v_pk_mul_f32 v[164:165], v[164:165], s[34:35]
 v_pk_mul_f32 v[166:167], v[166:167], s[34:35]
 v_cvt_pk_bf16_f32 v148, v148, v149
 v_cvt_pk_bf16_f32 v149, v150, v151
 buffer_load_dwordx4 v1, s[12:15], s52 offen offset:2048 sc1 lds
 v_cvt_pk_bf16_f32 v150, v164, v165
 v_cvt_pk_bf16_f32 v151, v166, v167
 v_accvgpr_write_b32 a16, v148
 v_accvgpr_write_b32 a17, v149
 v_accvgpr_write_b32 a18, v150
 v_accvgpr_write_b32 a19, v151
 v_pk_mul_f32 v[156:157], v[156:157], s[34:35]
 v_pk_mul_f32 v[158:159], v[158:159], s[34:35]
 v_pk_mul_f32 v[172:173], v[172:173], s[34:35]
 v_pk_mul_f32 v[174:175], v[174:175], s[34:35]
 v_cvt_pk_bf16_f32 v156, v156, v157
 v_cvt_pk_bf16_f32 v157, v158, v159
 v_cvt_pk_bf16_f32 v158, v172, v173
 v_cvt_pk_bf16_f32 v159, v174, v175
 v_accvgpr_write_b32 a48, v156
 buffer_load_dwordx4 v1, s[12:15], s52 offen offset:3072 sc1 lds
 v_accvgpr_write_b32 a49, v157
 v_accvgpr_write_b32 a50, v158
 v_accvgpr_write_b32 a51, v159
 v_pk_mul_f32 v[180:181], v[180:181], s[34:35]
 v_pk_mul_f32 v[182:183], v[182:183], s[34:35]
 v_pk_mul_f32 v[196:197], v[196:197], s[34:35]
 v_pk_mul_f32 v[198:199], v[198:199], s[34:35]
 v_cvt_pk_bf16_f32 v180, v180, v181
 v_cvt_pk_bf16_f32 v181, v182, v183
 v_cvt_pk_bf16_f32 v182, v196, v197
 v_cvt_pk_bf16_f32 v183, v198, v199
 v_accvgpr_write_b32 a20, v180
 v_accvgpr_write_b32 a21, v181
 v_accvgpr_write_b32 a22, v182
 v_accvgpr_write_b32 a23, v183
 s_bitset1_b32 m0, 12
 s_nop 0
 buffer_load_dwordx4 v4, s[12:15], s52 offen offset:0 sc1 lds
 v_pk_mul_f32 v[188:189], v[188:189], s[34:35]
 v_pk_mul_f32 v[190:191], v[190:191], s[34:35]
 v_pk_mul_f32 v[204:205], v[204:205], s[34:35]
 v_pk_mul_f32 v[206:207], v[206:207], s[34:35]
 v_cvt_pk_bf16_f32 v188, v188, v189
 v_cvt_pk_bf16_f32 v189, v190, v191
 v_cvt_pk_bf16_f32 v190, v204, v205
 v_cvt_pk_bf16_f32 v191, v206, v207
 v_accvgpr_write_b32 a52, v188
 v_accvgpr_write_b32 a53, v189
 v_accvgpr_write_b32 a54, v190
 v_accvgpr_write_b32 a55, v191
 v_pk_mul_f32 v[212:213], v[212:213], s[34:35]
 v_pk_mul_f32 v[214:215], v[214:215], s[34:35]
 v_pk_mul_f32 v[228:229], v[228:229], s[34:35]
 buffer_load_dwordx4 v4, s[12:15], s52 offen offset:1024 sc1 lds
 v_pk_mul_f32 v[230:231], v[230:231], s[34:35]
 v_cvt_pk_bf16_f32 v212, v212, v213
 v_cvt_pk_bf16_f32 v213, v214, v215
 v_cvt_pk_bf16_f32 v214, v228, v229
 v_cvt_pk_bf16_f32 v215, v230, v231
 v_accvgpr_write_b32 a24, v212
 v_accvgpr_write_b32 a25, v213
 v_accvgpr_write_b32 a26, v214
 v_accvgpr_write_b32 a27, v215
 v_pk_mul_f32 v[220:221], v[220:221], s[34:35]
 v_pk_mul_f32 v[222:223], v[222:223], s[34:35]
 v_pk_mul_f32 v[236:237], v[236:237], s[34:35]
 v_pk_mul_f32 v[238:239], v[238:239], s[34:35]
 v_cvt_pk_bf16_f32 v220, v220, v221
 v_cvt_pk_bf16_f32 v221, v222, v223
 buffer_load_dwordx4 v4, s[12:15], s52 offen offset:2048 sc1 lds
 v_cvt_pk_bf16_f32 v222, v236, v237
 v_cvt_pk_bf16_f32 v223, v238, v239
 v_accvgpr_write_b32 a56, v220
 v_accvgpr_write_b32 a57, v221
 v_accvgpr_write_b32 a58, v222
 v_accvgpr_write_b32 a59, v223
 v_pk_mul_f32 v[244:245], v[244:245], s[34:35]
 v_pk_mul_f32 v[246:247], v[246:247], s[34:35]
 v_pk_mul_f32 v[16:17], v[16:17], s[34:35]
 v_pk_mul_f32 v[18:19], v[18:19], s[34:35]
 v_cvt_pk_bf16_f32 v244, v244, v245
 v_cvt_pk_bf16_f32 v245, v246, v247
 v_cvt_pk_bf16_f32 v246, v16, v17
 v_cvt_pk_bf16_f32 v247, v18, v19
 v_accvgpr_write_b32 a28, v244
 buffer_load_dwordx4 v4, s[12:15], s52 offen offset:3072 sc1 lds
 v_accvgpr_write_b32 a29, v245
 v_accvgpr_write_b32 a30, v246
 v_accvgpr_write_b32 a31, v247
 v_pk_mul_f32 v[252:253], v[252:253], s[34:35]
 v_pk_mul_f32 v[254:255], v[254:255], s[34:35]
 v_pk_mul_f32 v[24:25], v[24:25], s[34:35]
 v_pk_mul_f32 v[26:27], v[26:27], s[34:35]
 v_cvt_pk_bf16_f32 v252, v252, v253
 v_cvt_pk_bf16_f32 v253, v254, v255
 v_cvt_pk_bf16_f32 v254, v24, v25
 v_cvt_pk_bf16_f32 v255, v26, v27
 v_accvgpr_write_b32 a60, v252
 v_accvgpr_write_b32 a61, v253
 v_accvgpr_write_b32 a62, v254
 v_accvgpr_write_b32 a63, v255
 s_branch L_kvdone
L_kloop_side:
 s_mov_b64 exec, 1
 global_atomic_add v3, v15, s[90:91] offset:128 sc1
 s_mov_b64 exec, -1
 s_mov_b32 s55, 6
 s_branch L_kloop
L_vloop_side:
 s_mov_b64 exec, 1
 global_atomic_add v3, v15, s[90:91] offset:128 sc1
 s_mov_b64 exec, -1
 s_mov_b32 s55, 6
 s_branch L_vloop
L_vloop_head:
 s_mov_b32 s61, 0
 s_waitcnt vmcnt(10)
 s_barrier
 ds_read_b64_tr_b16 a[0:1], v6 offset:0
 ds_read_b64_tr_b16 a[2:3], v6 offset:4096
 ds_read_b64_tr_b16 a[4:5], v6 offset:16384
 ds_read_b64_tr_b16 a[6:7], v6 offset:20480
 ds_read_b128 a[64:67], v4 offset:0
 ds_read_b128 a[68:71], v5 offset:0
 ds_read_b128 a[76:79], v5 offset:2048
 ds_read_b128 a[72:75], v4 offset:2048
 ds_read_b128 a[80:83], v4 offset:4096
 ds_read_b128 a[84:87], v5 offset:4096
 ds_read_b128 a[92:95], v5 offset:6144
 ds_read_b128 a[88:91], v4 offset:6144
 ds_read_b64_tr_b16 a[8:9], v7 offset:0
 ds_read_b64_tr_b16 a[10:11], v7 offset:4096
 ds_read_b64_tr_b16 a[12:13], v7 offset:16384
 ds_read_b64_tr_b16 a[14:15], v7 offset:20480
 ds_read_b64_tr_b16 a[16:17], v8 offset:0
 ds_read_b64_tr_b16 a[18:19], v8 offset:4096
 ds_read_b64_tr_b16 a[20:21], v8 offset:16384
 ds_read_b64_tr_b16 a[22:23], v8 offset:20480
 ds_read_b64_tr_b16 a[24:25], v9 offset:0
 ds_read_b64_tr_b16 a[26:27], v9 offset:4096
 s_waitcnt lgkmcnt(0)
 v_mfma_f32_16x16x32_bf16 v[64:67], a[64:67], a[0:3], 0
 s_add_u32 m0, s29, 118784
 ds_read_b64_tr_b16 a[28:29], v9 offset:16384
 v_mfma_f32_16x16x32_bf16 v[64:67], a[68:71], a[4:7], v[64:67]
 ds_read_b64_tr_b16 a[30:31], v9 offset:20480
 buffer_load_dwordx4 v2, s[8:11], s52 offen  lds
 v_mfma_f32_16x16x32_bf16 v[68:71], a[76:79], a[4:7], 0
 ds_read_b128 a[96:99], v4 offset:8192
 v_mfma_f32_16x16x32_bf16 v[68:71], a[72:75], a[0:3], v[68:71]
 v_mfma_f32_16x16x32_bf16 v[72:75], a[80:83], a[0:3], 0
 s_add_u32 m0, s29, 53248
 ds_read_b128 a[100:103], v5 offset:8192
 v_mfma_f32_16x16x32_bf16 v[72:75], a[84:87], a[4:7], v[72:75]
 buffer_load_dwordx4 v1, s[4:7], s45 offen  lds
 v_mfma_f32_16x16x32_bf16 v[76:79], a[92:95], a[4:7], 0
 ds_read_b128 a[108:111], v5 offset:10240
 v_mfma_f32_16x16x32_bf16 v[76:79], a[88:91], a[0:3], v[76:79]
 v_mfma_f32_16x16x32_bf16 v[84:87], a[88:91], a[8:11], 0
 s_add_u32 m0, s29, 122880
 ds_read_b128 a[104:107], v4 offset:10240
 v_mfma_f32_16x16x32_bf16 v[84:87], a[92:95], a[12:15], v[84:87]
 buffer_load_dwordx4 v2, s[8:11], s53 offen  lds
 v_mfma_f32_16x16x32_bf16 v[80:83], a[84:87], a[12:15], 0
 ds_read_b128 a[112:115], v4 offset:12288
 v_mfma_f32_16x16x32_bf16 v[80:83], a[80:83], a[8:11], v[80:83]
 v_mfma_f32_16x16x32_bf16 v[92:95], a[72:75], a[8:11], 0
 s_add_u32 m0, s29, 57344
 ds_read_b128 a[116:119], v5 offset:12288
 v_mfma_f32_16x16x32_bf16 v[92:95], a[76:79], a[12:15], v[92:95]
 buffer_load_dwordx4 v1, s[4:7], s46 offen  lds
 v_mfma_f32_16x16x32_bf16 v[88:91], a[68:71], a[12:15], 0
 ds_read_b128 a[124:127], v5 offset:14336
 v_mfma_f32_16x16x32_bf16 v[88:91], a[64:67], a[8:11], v[88:91]
 v_mfma_f32_16x16x32_bf16 v[96:99], a[64:67], a[16:19], 0
 s_add_u32 m0, s29, 126976
 ds_read_b128 a[120:123], v4 offset:14336
 v_mfma_f32_16x16x32_bf16 v[96:99], a[68:71], a[20:23], v[96:99]
 buffer_load_dwordx4 v2, s[8:11], s54 offen  lds
 v_mfma_f32_16x16x32_bf16 v[100:103], a[76:79], a[20:23], 0
 ds_read_b64_tr_b16 a[32:33], v10 offset:0
 v_mfma_f32_16x16x32_bf16 v[100:103], a[72:75], a[16:19], v[100:103]
 ds_read_b64_tr_b16 a[34:35], v10 offset:4096
 v_mfma_f32_16x16x32_bf16 v[104:107], a[80:83], a[16:19], 0
 s_add_u32 m0, s29, 61440
 ds_read_b64_tr_b16 a[36:37], v10 offset:16384
 v_mfma_f32_16x16x32_bf16 v[104:107], a[84:87], a[20:23], v[104:107]
 ds_read_b64_tr_b16 a[38:39], v10 offset:20480
 buffer_load_dwordx4 v1, s[4:7], s47 offen  lds
 v_mfma_f32_16x16x32_bf16 v[108:111], a[92:95], a[20:23], 0
 ds_read_b64_tr_b16 a[40:41], v11 offset:0
 v_add_u32 v1, 128, v1
 v_mfma_f32_16x16x32_bf16 v[108:111], a[88:91], a[16:19], v[108:111]
 ds_read_b64_tr_b16 a[42:43], v11 offset:4096
 v_add_u32 v2, 0x80000, v2
 v_mfma_f32_16x16x32_bf16 v[116:119], a[88:91], a[24:27], 0
 s_waitcnt lgkmcnt(8)
 ds_read_b64_tr_b16 a[44:45], v11 offset:16384
 v_mfma_f32_16x16x32_bf16 v[116:119], a[92:95], a[28:31], v[116:119]
 ds_read_b64_tr_b16 a[46:47], v11 offset:20480
 v_mfma_f32_16x16x32_bf16 v[112:115], a[84:87], a[28:31], 0
 ds_read_b64_tr_b16 a[48:49], v12 offset:0
 v_mfma_f32_16x16x32_bf16 v[112:115], a[80:83], a[24:27], v[112:115]
 ds_read_b64_tr_b16 a[50:51], v12 offset:4096
 v_mfma_f32_16x16x32_bf16 v[124:127], a[72:75], a[24:27], 0
 ds_read_b64_tr_b16 a[52:53], v12 offset:16384
 v_mfma_f32_16x16x32_bf16 v[124:127], a[76:79], a[28:31], v[124:127]
 ds_read_b64_tr_b16 a[54:55], v12 offset:20480
 v_mfma_f32_16x16x32_bf16 v[120:123], a[68:71], a[28:31], 0
 ds_read_b64_tr_b16 a[56:57], v13 offset:0
 v_mfma_f32_16x16x32_bf16 v[120:123], a[64:67], a[24:27], v[120:123]
 ds_read_b64_tr_b16 a[58:59], v13 offset:4096
 v_mfma_f32_16x16x32_bf16 v[16:19], a[96:99], a[0:3], 0
 ds_read_b64_tr_b16 a[60:61], v13 offset:16384
 v_mfma_f32_16x16x32_bf16 v[16:19], a[100:103], a[4:7], v[16:19]
 ds_read_b64_tr_b16 a[62:63], v13 offset:20480
 v_mfma_f32_16x16x32_bf16 v[20:23], a[108:111], a[4:7], 0
 v_mfma_f32_16x16x32_bf16 v[20:23], a[104:107], a[0:3], v[20:23]
 v_mfma_f32_16x16x32_bf16 v[24:27], a[112:115], a[0:3], 0
 v_mfma_f32_16x16x32_bf16 v[24:27], a[116:119], a[4:7], v[24:27]
 s_waitcnt lgkmcnt(8)
 v_mfma_f32_16x16x32_bf16 v[28:31], a[124:127], a[4:7], 0
 v_mfma_f32_16x16x32_bf16 v[28:31], a[120:123], a[0:3], v[28:31]
 s_waitcnt lgkmcnt(0)
 v_mfma_f32_16x16x32_bf16 a[228:231], a[120:123], a[8:11], 0
 s_barrier
 v_mfma_f32_16x16x32_bf16 a[228:231], a[124:127], a[12:15], a[228:231]
 s_add_u32 m0, s29, 65536
 v_mfma_f32_16x16x32_bf16 a[224:227], a[116:119], a[12:15], 0
 buffer_load_dwordx4 v2, s[8:11], 0 offen  lds
 v_mfma_f32_16x16x32_bf16 a[224:227], a[112:115], a[8:11], a[224:227]
 v_mfma_f32_16x16x32_bf16 a[236:239], a[104:107], a[8:11], 0
 v_mfma_f32_16x16x32_bf16 a[236:239], a[108:111], a[12:15], a[236:239]
 v_mfma_f32_16x16x32_bf16 a[232:235], a[100:103], a[12:15], 0
 s_add_u32 m0, s29, 0
 v_mfma_f32_16x16x32_bf16 a[232:235], a[96:99], a[8:11], a[232:235]
 buffer_load_dwordx4 v1, s[4:7], 0 offen  lds
 v_mfma_f32_16x16x32_bf16 v[32:35], a[96:99], a[16:19], 0
 v_mfma_f32_16x16x32_bf16 v[32:35], a[100:103], a[20:23], v[32:35]
 v_mfma_f32_16x16x32_bf16 v[36:39], a[108:111], a[20:23], 0
 v_mfma_f32_16x16x32_bf16 v[36:39], a[104:107], a[16:19], v[36:39]
 s_add_u32 m0, s29, 69632
 v_mfma_f32_16x16x32_bf16 v[40:43], a[112:115], a[16:19], 0
 buffer_load_dwordx4 v2, s[8:11], s48 offen  lds
 v_mfma_f32_16x16x32_bf16 v[40:43], a[116:119], a[20:23], v[40:43]
 v_mfma_f32_16x16x32_bf16 v[44:47], a[124:127], a[20:23], 0
 v_mfma_f32_16x16x32_bf16 v[44:47], a[120:123], a[16:19], v[44:47]
 v_mfma_f32_16x16x32_bf16 v[52:55], a[120:123], a[24:27], 0
 s_add_u32 m0, s29, 4096
 v_mfma_f32_16x16x32_bf16 v[52:55], a[124:127], a[28:31], v[52:55]
 buffer_load_dwordx4 v1, s[4:7], s41 offen  lds
 v_mfma_f32_16x16x32_bf16 v[48:51], a[116:119], a[28:31], 0
 v_mfma_f32_16x16x32_bf16 v[48:51], a[112:115], a[24:27], v[48:51]
 v_mfma_f32_16x16x32_bf16 v[60:63], a[104:107], a[24:27], 0
 v_mfma_f32_16x16x32_bf16 v[60:63], a[108:111], a[28:31], v[60:63]
 s_add_u32 m0, s29, 73728
 v_mfma_f32_16x16x32_bf16 v[56:59], a[100:103], a[28:31], 0
 buffer_load_dwordx4 v2, s[8:11], s49 offen  lds
 v_mfma_f32_16x16x32_bf16 v[56:59], a[96:99], a[24:27], v[56:59]
 v_mfma_f32_16x16x32_bf16 v[192:195], a[96:99], a[32:35], 0
 v_mfma_f32_16x16x32_bf16 v[192:195], a[100:103], a[36:39], v[192:195]
 v_mfma_f32_16x16x32_bf16 v[196:199], a[108:111], a[36:39], 0
 s_add_u32 m0, s29, 8192
 v_mfma_f32_16x16x32_bf16 v[196:199], a[104:107], a[32:35], v[196:199]
 buffer_load_dwordx4 v1, s[4:7], s42 offen  lds
 v_mfma_f32_16x16x32_bf16 v[200:203], a[112:115], a[32:35], 0
 v_mfma_f32_16x16x32_bf16 v[200:203], a[116:119], a[36:39], v[200:203]
 v_mfma_f32_16x16x32_bf16 v[204:207], a[124:127], a[36:39], 0
 v_mfma_f32_16x16x32_bf16 v[204:207], a[120:123], a[32:35], v[204:207]
 s_add_u32 m0, s29, 77824
 v_mfma_f32_16x16x32_bf16 v[212:215], a[120:123], a[40:43], 0
 buffer_load_dwordx4 v2, s[8:11], s50 offen  lds
 v_mfma_f32_16x16x32_bf16 v[212:215], a[124:127], a[44:47], v[212:215]
 v_mfma_f32_16x16x32_bf16 v[208:211], a[116:119], a[44:47], 0
 v_mfma_f32_16x16x32_bf16 v[208:211], a[112:115], a[40:43], v[208:211]
 v_mfma_f32_16x16x32_bf16 v[220:223], a[104:107], a[40:43], 0
 s_add_u32 m0, s29, 12288
 v_mfma_f32_16x16x32_bf16 v[220:223], a[108:111], a[44:47], v[220:223]
 buffer_load_dwordx4 v1, s[4:7], s43 offen  lds
 v_mfma_f32_16x16x32_bf16 v[216:219], a[100:103], a[44:47], 0
 v_mfma_f32_16x16x32_bf16 v[216:219], a[96:99], a[40:43], v[216:219]
 v_mfma_f32_16x16x32_bf16 v[224:227], a[96:99], a[48:51], 0
 v_mfma_f32_16x16x32_bf16 v[224:227], a[100:103], a[52:55], v[224:227]
 s_add_u32 m0, s29, 81920
 v_mfma_f32_16x16x32_bf16 v[228:231], a[108:111], a[52:55], 0
 buffer_load_dwordx4 v2, s[8:11], s51 offen  lds
 v_mfma_f32_16x16x32_bf16 v[228:231], a[104:107], a[48:51], v[228:231]
 v_mfma_f32_16x16x32_bf16 v[232:235], a[112:115], a[48:51], 0
 v_mfma_f32_16x16x32_bf16 v[232:235], a[116:119], a[52:55], v[232:235]
 v_mfma_f32_16x16x32_bf16 v[236:239], a[124:127], a[52:55], 0
 s_add_u32 m0, s29, 16384
 v_mfma_f32_16x16x32_bf16 v[236:239], a[120:123], a[48:51], v[236:239]
 buffer_load_dwordx4 v1, s[4:7], s44 offen  lds
 v_mfma_f32_16x16x32_bf16 v[244:247], a[120:123], a[56:59], 0
 s_waitcnt vmcnt(10)
 v_mfma_f32_16x16x32_bf16 v[244:247], a[124:127], a[60:63], v[244:247]
 s_barrier
 v_mfma_f32_16x16x32_bf16 v[240:243], a[116:119], a[60:63], 0
 ds_read_b64_tr_b16 a[0:1], v6 offset:32768
 v_mfma_f32_16x16x32_bf16 v[240:243], a[112:115], a[56:59], v[240:243]
 s_add_u32 m0, s29, 86016
 ds_read_b64_tr_b16 a[2:3], v6 offset:36864
 v_mfma_f32_16x16x32_bf16 v[252:255], a[104:107], a[56:59], 0
 buffer_load_dwordx4 v2, s[8:11], s52 offen  lds
 v_mfma_f32_16x16x32_bf16 v[252:255], a[108:111], a[60:63], v[252:255]
 ds_read_b64_tr_b16 a[4:5], v6 offset:49152
 v_mfma_f32_16x16x32_bf16 v[248:251], a[100:103], a[60:63], 0
 ds_read_b64_tr_b16 a[6:7], v6 offset:53248
 v_mfma_f32_16x16x32_bf16 v[248:251], a[96:99], a[56:59], v[248:251]
 ds_read_b128 a[96:99], v4 offset:40960
 v_mfma_f32_16x16x32_bf16 v[128:131], a[64:67], a[32:35], 0
 s_add_u32 m0, s29, 20480
 v_mfma_f32_16x16x32_bf16 v[128:131], a[68:71], a[36:39], v[128:131]
 buffer_load_dwordx4 v1, s[4:7], s45 offen  lds
 v_mfma_f32_16x16x32_bf16 v[132:135], a[76:79], a[36:39], 0
 ds_read_b128 a[100:103], v5 offset:40960
 v_mfma_f32_16x16x32_bf16 v[132:135], a[72:75], a[32:35], v[132:135]
 v_mfma_f32_16x16x32_bf16 v[136:139], a[80:83], a[32:35], 0
 ds_read_b128 a[108:111], v5 offset:43008
 v_mfma_f32_16x16x32_bf16 v[136:139], a[84:87], a[36:39], v[136:139]
 s_add_u32 m0, s29, 90112
 v_mfma_f32_16x16x32_bf16 v[140:143], a[92:95], a[36:39], 0
 buffer_load_dwordx4 v2, s[8:11], s53 offen  lds
 v_mfma_f32_16x16x32_bf16 v[140:143], a[88:91], a[32:35], v[140:143]
 ds_read_b128 a[104:107], v4 offset:43008
 v_mfma_f32_16x16x32_bf16 v[148:151], a[88:91], a[40:43], 0
 v_mfma_f32_16x16x32_bf16 v[148:151], a[92:95], a[44:47], v[148:151]
 ds_read_b128 a[112:115], v4 offset:45056
 v_mfma_f32_16x16x32_bf16 v[144:147], a[84:87], a[44:47], 0
 s_add_u32 m0, s29, 24576
 v_mfma_f32_16x16x32_bf16 v[144:147], a[80:83], a[40:43], v[144:147]
 buffer_load_dwordx4 v1, s[4:7], s46 offen  lds
 v_mfma_f32_16x16x32_bf16 v[156:159], a[72:75], a[40:43], 0
 ds_read_b128 a[116:119], v5 offset:45056
 v_mfma_f32_16x16x32_bf16 v[156:159], a[76:79], a[44:47], v[156:159]
 v_mfma_f32_16x16x32_bf16 v[152:155], a[68:71], a[44:47], 0
 ds_read_b128 a[124:127], v5 offset:47104
 v_mfma_f32_16x16x32_bf16 v[152:155], a[64:67], a[40:43], v[152:155]
 s_add_u32 m0, s29, 94208
 v_mfma_f32_16x16x32_bf16 v[160:163], a[64:67], a[48:51], 0
 buffer_load_dwordx4 v2, s[8:11], s54 offen  lds
 v_mfma_f32_16x16x32_bf16 v[160:163], a[68:71], a[52:55], v[160:163]
 ds_read_b128 a[120:123], v4 offset:47104
 v_mfma_f32_16x16x32_bf16 v[164:167], a[76:79], a[52:55], 0
 v_mfma_f32_16x16x32_bf16 v[164:167], a[72:75], a[48:51], v[164:167]
 ds_read_b64_tr_b16 a[8:9], v7 offset:32768
 v_mfma_f32_16x16x32_bf16 v[168:171], a[80:83], a[48:51], 0
 s_add_u32 m0, s29, 28672
 ds_read_b64_tr_b16 a[10:11], v7 offset:36864
 v_mfma_f32_16x16x32_bf16 v[168:171], a[84:87], a[52:55], v[168:171]
 buffer_load_dwordx4 v1, s[4:7], s47 offen  lds
 v_mfma_f32_16x16x32_bf16 v[172:175], a[92:95], a[52:55], 0
 v_mfma_f32_16x16x32_bf16 v[172:175], a[88:91], a[48:51], v[172:175]
 ds_read_b64_tr_b16 a[12:13], v7 offset:49152
 v_mfma_f32_16x16x32_bf16 v[180:183], a[88:91], a[56:59], 0
 v_mfma_f32_16x16x32_bf16 v[180:183], a[92:95], a[60:63], v[180:183]
 ds_read_b64_tr_b16 a[14:15], v7 offset:53248
 v_mfma_f32_16x16x32_bf16 v[176:179], a[84:87], a[60:63], 0
 ds_read_b64_tr_b16 a[16:17], v8 offset:32768
 v_mfma_f32_16x16x32_bf16 v[176:179], a[80:83], a[56:59], v[176:179]
 ds_read_b64_tr_b16 a[18:19], v8 offset:36864
 v_mfma_f32_16x16x32_bf16 v[188:191], a[72:75], a[56:59], 0
 ds_read_b64_tr_b16 a[20:21], v8 offset:49152
 v_mfma_f32_16x16x32_bf16 v[188:191], a[76:79], a[60:63], v[188:191]
 ds_read_b64_tr_b16 a[22:23], v8 offset:53248
 v_mfma_f32_16x16x32_bf16 v[184:187], a[68:71], a[60:63], 0
 ds_read_b64_tr_b16 a[24:25], v9 offset:32768
 v_mfma_f32_16x16x32_bf16 v[184:187], a[64:67], a[56:59], v[184:187]
 s_waitcnt lgkmcnt(8)
 ds_read_b64_tr_b16 a[26:27], v9 offset:36864
 v_add_u32 v1, 128, v1
 v_add_u32 v2, 0x80000, v2
 s_add_u32 s56, s56, s30
 buffer_load_dword a243, v14, s[36:39], s56 offen
 s_add_u32 s56, s56, s30
 buffer_load_dword a243, v14, s[36:39], s56 offen
 s_add_u32 s56, s56, s30
 s_branch L_vloop_mid
.p2align 6
L_vloop:
 v_mfma_f32_16x16x32_bf16 v[64:67], a[64:67], a[0:3], v[64:67]
 ds_read_b64_tr_b16 a[28:29], v9 offset:16384
 v_mfma_f32_16x16x32_bf16 v[64:67], a[68:71], a[4:7], v[64:67]
 ds_read_b64_tr_b16 a[30:31], v9 offset:20480
 v_mfma_f32_16x16x32_bf16 v[68:71], a[76:79], a[4:7], v[68:71]
 ds_read_b128 a[96:99], v4 offset:8192
 v_mfma_f32_16x16x32_bf16 v[68:71], a[72:75], a[0:3], v[68:71]
 v_mfma_f32_16x16x32_bf16 v[72:75], a[80:83], a[0:3], v[72:75]
 ds_read_b128 a[100:103], v5 offset:8192
 v_mfma_f32_16x16x32_bf16 v[72:75], a[84:87], a[4:7], v[72:75]
 v_mfma_f32_16x16x32_bf16 v[76:79], a[92:95], a[4:7], v[76:79]
 ds_read_b128 a[108:111], v5 offset:10240
 v_mfma_f32_16x16x32_bf16 v[76:79], a[88:91], a[0:3], v[76:79]
 s_waitcnt lgkmcnt(8)
 v_mfma_f32_16x16x32_bf16 v[84:87], a[88:91], a[8:11], v[84:87]
 ds_read_b128 a[104:107], v4 offset:10240
 v_mfma_f32_16x16x32_bf16 v[84:87], a[92:95], a[12:15], v[84:87]
 v_mfma_f32_16x16x32_bf16 v[80:83], a[84:87], a[12:15], v[80:83]
 ds_read_b128 a[112:115], v4 offset:12288
 v_mfma_f32_16x16x32_bf16 v[80:83], a[80:83], a[8:11], v[80:83]
 v_mfma_f32_16x16x32_bf16 v[92:95], a[72:75], a[8:11], v[92:95]
 ds_read_b128 a[116:119], v5 offset:12288
 v_mfma_f32_16x16x32_bf16 v[92:95], a[76:79], a[12:15], v[92:95]
 v_mfma_f32_16x16x32_bf16 v[88:91], a[68:71], a[12:15], v[88:91]
 ds_read_b128 a[124:127], v5 offset:14336
 v_mfma_f32_16x16x32_bf16 v[88:91], a[64:67], a[8:11], v[88:91]
 v_mfma_f32_16x16x32_bf16 v[96:99], a[64:67], a[16:19], v[96:99]
 s_waitcnt lgkmcnt(8)
 ds_read_b128 a[120:123], v4 offset:14336
 v_mfma_f32_16x16x32_bf16 v[96:99], a[68:71], a[20:23], v[96:99]
 v_mfma_f32_16x16x32_bf16 v[100:103], a[76:79], a[20:23], v[100:103]
 ds_read_b64_tr_b16 a[32:33], v10 offset:0
 v_mfma_f32_16x16x32_bf16 v[100:103], a[72:75], a[16:19], v[100:103]
 ds_read_b64_tr_b16 a[34:35], v10 offset:4096
 v_mfma_f32_16x16x32_bf16 v[104:107], a[80:83], a[16:19], v[104:107]
 ds_read_b64_tr_b16 a[36:37], v10 offset:16384
 v_mfma_f32_16x16x32_bf16 v[104:107], a[84:87], a[20:23], v[104:107]
 ds_read_b64_tr_b16 a[38:39], v10 offset:20480
 v_mfma_f32_16x16x32_bf16 v[108:111], a[92:95], a[20:23], v[108:111]
 ds_read_b64_tr_b16 a[40:41], v11 offset:0
 v_mfma_f32_16x16x32_bf16 v[108:111], a[88:91], a[16:19], v[108:111]
 ds_read_b64_tr_b16 a[42:43], v11 offset:4096
 v_mfma_f32_16x16x32_bf16 v[116:119], a[88:91], a[24:27], v[116:119]
 s_waitcnt lgkmcnt(8)
 ds_read_b64_tr_b16 a[44:45], v11 offset:16384
 v_mfma_f32_16x16x32_bf16 v[116:119], a[92:95], a[28:31], v[116:119]
 ds_read_b64_tr_b16 a[46:47], v11 offset:20480
 v_mfma_f32_16x16x32_bf16 v[112:115], a[84:87], a[28:31], v[112:115]
 ds_read_b64_tr_b16 a[48:49], v12 offset:0
 v_mfma_f32_16x16x32_bf16 v[112:115], a[80:83], a[24:27], v[112:115]
 ds_read_b64_tr_b16 a[50:51], v12 offset:4096
 v_mfma_f32_16x16x32_bf16 v[124:127], a[72:75], a[24:27], v[124:127]
 ds_read_b64_tr_b16 a[52:53], v12 offset:16384
 v_mfma_f32_16x16x32_bf16 v[124:127], a[76:79], a[28:31], v[124:127]
 ds_read_b64_tr_b16 a[54:55], v12 offset:20480
 v_mfma_f32_16x16x32_bf16 v[120:123], a[68:71], a[28:31], v[120:123]
 ds_read_b64_tr_b16 a[56:57], v13 offset:0
 v_mfma_f32_16x16x32_bf16 v[120:123], a[64:67], a[24:27], v[120:123]
 ds_read_b64_tr_b16 a[58:59], v13 offset:4096
 v_mfma_f32_16x16x32_bf16 v[16:19], a[96:99], a[0:3], v[16:19]
 ds_read_b64_tr_b16 a[60:61], v13 offset:16384
 v_mfma_f32_16x16x32_bf16 v[16:19], a[100:103], a[4:7], v[16:19]
 ds_read_b64_tr_b16 a[62:63], v13 offset:20480
 v_mfma_f32_16x16x32_bf16 v[20:23], a[108:111], a[4:7], v[20:23]
 v_mfma_f32_16x16x32_bf16 v[20:23], a[104:107], a[0:3], v[20:23]
 v_mfma_f32_16x16x32_bf16 v[24:27], a[112:115], a[0:3], v[24:27]
 v_mfma_f32_16x16x32_bf16 v[24:27], a[116:119], a[4:7], v[24:27]
 s_waitcnt lgkmcnt(8)
 v_mfma_f32_16x16x32_bf16 v[28:31], a[124:127], a[4:7], v[28:31]
 v_mfma_f32_16x16x32_bf16 v[28:31], a[120:123], a[0:3], v[28:31]
 s_waitcnt lgkmcnt(0)
 v_mfma_f32_16x16x32_bf16 a[228:231], a[120:123], a[8:11], a[228:231]
 s_barrier
 v_mfma_f32_16x16x32_bf16 a[228:231], a[124:127], a[12:15], a[228:231]
 s_add_u32 m0, s29, 65536
 v_mfma_f32_16x16x32_bf16 a[224:227], a[116:119], a[12:15], a[224:227]
 buffer_load_dwordx4 v2, s[8:11], 0 offen  lds
 v_mfma_f32_16x16x32_bf16 a[224:227], a[112:115], a[8:11], a[224:227]
 v_mfma_f32_16x16x32_bf16 a[236:239], a[104:107], a[8:11], a[236:239]
 v_mfma_f32_16x16x32_bf16 a[236:239], a[108:111], a[12:15], a[236:239]
 v_mfma_f32_16x16x32_bf16 a[232:235], a[100:103], a[12:15], a[232:235]
 s_add_u32 m0, s29, 0
 v_mfma_f32_16x16x32_bf16 a[232:235], a[96:99], a[8:11], a[232:235]
 buffer_load_dwordx4 v1, s[4:7], 0 offen  lds
 v_mfma_f32_16x16x32_bf16 v[32:35], a[96:99], a[16:19], v[32:35]
 v_mfma_f32_16x16x32_bf16 v[32:35], a[100:103], a[20:23], v[32:35]
 v_mfma_f32_16x16x32_bf16 v[36:39], a[108:111], a[20:23], v[36:39]
 v_mfma_f32_16x16x32_bf16 v[36:39], a[104:107], a[16:19], v[36:39]
 s_add_u32 m0, s29, 69632
 v_mfma_f32_16x16x32_bf16 v[40:43], a[112:115], a[16:19], v[40:43]
 buffer_load_dwordx4 v2, s[8:11], s48 offen  lds
 v_mfma_f32_16x16x32_bf16 v[40:43], a[116:119], a[20:23], v[40:43]
 v_mfma_f32_16x16x32_bf16 v[44:47], a[124:127], a[20:23], v[44:47]
 v_mfma_f32_16x16x32_bf16 v[44:47], a[120:123], a[16:19], v[44:47]
 v_mfma_f32_16x16x32_bf16 v[52:55], a[120:123], a[24:27], v[52:55]
 s_add_u32 m0, s29, 4096
 v_mfma_f32_16x16x32_bf16 v[52:55], a[124:127], a[28:31], v[52:55]
 buffer_load_dwordx4 v1, s[4:7], s41 offen  lds
 v_mfma_f32_16x16x32_bf16 v[48:51], a[116:119], a[28:31], v[48:51]
 v_mfma_f32_16x16x32_bf16 v[48:51], a[112:115], a[24:27], v[48:51]
 v_mfma_f32_16x16x32_bf16 v[60:63], a[104:107], a[24:27], v[60:63]
 v_mfma_f32_16x16x32_bf16 v[60:63], a[108:111], a[28:31], v[60:63]
 s_add_u32 m0, s29, 73728
 v_mfma_f32_16x16x32_bf16 v[56:59], a[100:103], a[28:31], v[56:59]
 buffer_load_dwordx4 v2, s[8:11], s49 offen  lds
 v_mfma_f32_16x16x32_bf16 v[56:59], a[96:99], a[24:27], v[56:59]
 v_mfma_f32_16x16x32_bf16 v[192:195], a[96:99], a[32:35], v[192:195]
 v_mfma_f32_16x16x32_bf16 v[192:195], a[100:103], a[36:39], v[192:195]
 v_mfma_f32_16x16x32_bf16 v[196:199], a[108:111], a[36:39], v[196:199]
 s_add_u32 m0, s29, 8192
 v_mfma_f32_16x16x32_bf16 v[196:199], a[104:107], a[32:35], v[196:199]
 buffer_load_dwordx4 v1, s[4:7], s42 offen  lds
 v_mfma_f32_16x16x32_bf16 v[200:203], a[112:115], a[32:35], v[200:203]
 v_mfma_f32_16x16x32_bf16 v[200:203], a[116:119], a[36:39], v[200:203]
 v_mfma_f32_16x16x32_bf16 v[204:207], a[124:127], a[36:39], v[204:207]
 v_mfma_f32_16x16x32_bf16 v[204:207], a[120:123], a[32:35], v[204:207]
 s_add_u32 m0, s29, 77824
 v_mfma_f32_16x16x32_bf16 v[212:215], a[120:123], a[40:43], v[212:215]
 buffer_load_dwordx4 v2, s[8:11], s50 offen  lds
 v_mfma_f32_16x16x32_bf16 v[212:215], a[124:127], a[44:47], v[212:215]
 v_mfma_f32_16x16x32_bf16 v[208:211], a[116:119], a[44:47], v[208:211]
 v_mfma_f32_16x16x32_bf16 v[208:211], a[112:115], a[40:43], v[208:211]
 v_mfma_f32_16x16x32_bf16 v[220:223], a[104:107], a[40:43], v[220:223]
 s_add_u32 m0, s29, 12288
 v_mfma_f32_16x16x32_bf16 v[220:223], a[108:111], a[44:47], v[220:223]
 buffer_load_dwordx4 v1, s[4:7], s43 offen  lds
 v_mfma_f32_16x16x32_bf16 v[216:219], a[100:103], a[44:47], v[216:219]
 v_mfma_f32_16x16x32_bf16 v[216:219], a[96:99], a[40:43], v[216:219]
 v_mfma_f32_16x16x32_bf16 v[224:227], a[96:99], a[48:51], v[224:227]
 v_mfma_f32_16x16x32_bf16 v[224:227], a[100:103], a[52:55], v[224:227]
 s_add_u32 m0, s29, 81920
 v_mfma_f32_16x16x32_bf16 v[228:231], a[108:111], a[52:55], v[228:231]
 buffer_load_dwordx4 v2, s[8:11], s51 offen  lds
 v_mfma_f32_16x16x32_bf16 v[228:231], a[104:107], a[48:51], v[228:231]
 v_mfma_f32_16x16x32_bf16 v[232:235], a[112:115], a[48:51], v[232:235]
 v_mfma_f32_16x16x32_bf16 v[232:235], a[116:119], a[52:55], v[232:235]
 v_mfma_f32_16x16x32_bf16 v[236:239], a[124:127], a[52:55], v[236:239]
 s_add_u32 m0, s29, 16384
 v_mfma_f32_16x16x32_bf16 v[236:239], a[120:123], a[48:51], v[236:239]
 buffer_load_dwordx4 v1, s[4:7], s44 offen  lds
 v_mfma_f32_16x16x32_bf16 v[244:247], a[120:123], a[56:59], v[244:247]
 s_waitcnt vmcnt(11)
 v_mfma_f32_16x16x32_bf16 v[244:247], a[124:127], a[60:63], v[244:247]
 s_barrier
 v_mfma_f32_16x16x32_bf16 v[240:243], a[116:119], a[60:63], v[240:243]
 ds_read_b64_tr_b16 a[0:1], v6 offset:32768
 v_mfma_f32_16x16x32_bf16 v[240:243], a[112:115], a[56:59], v[240:243]
 s_add_u32 m0, s29, 86016
 ds_read_b64_tr_b16 a[2:3], v6 offset:36864
 v_mfma_f32_16x16x32_bf16 v[252:255], a[104:107], a[56:59], v[252:255]
 buffer_load_dwordx4 v2, s[8:11], s52 offen  lds
 v_mfma_f32_16x16x32_bf16 v[252:255], a[108:111], a[60:63], v[252:255]
 ds_read_b64_tr_b16 a[4:5], v6 offset:49152
 v_mfma_f32_16x16x32_bf16 v[248:251], a[100:103], a[60:63], v[248:251]
 ds_read_b64_tr_b16 a[6:7], v6 offset:53248
 v_mfma_f32_16x16x32_bf16 v[248:251], a[96:99], a[56:59], v[248:251]
 ds_read_b128 a[96:99], v4 offset:40960
 v_mfma_f32_16x16x32_bf16 v[128:131], a[64:67], a[32:35], v[128:131]
 s_add_u32 m0, s29, 20480
 v_mfma_f32_16x16x32_bf16 v[128:131], a[68:71], a[36:39], v[128:131]
 buffer_load_dwordx4 v1, s[4:7], s45 offen  lds
 v_mfma_f32_16x16x32_bf16 v[132:135], a[76:79], a[36:39], v[132:135]
 ds_read_b128 a[100:103], v5 offset:40960
 v_mfma_f32_16x16x32_bf16 v[132:135], a[72:75], a[32:35], v[132:135]
 v_mfma_f32_16x16x32_bf16 v[136:139], a[80:83], a[32:35], v[136:139]
 ds_read_b128 a[108:111], v5 offset:43008
 v_mfma_f32_16x16x32_bf16 v[136:139], a[84:87], a[36:39], v[136:139]
 s_add_u32 m0, s29, 90112
 v_mfma_f32_16x16x32_bf16 v[140:143], a[92:95], a[36:39], v[140:143]
 buffer_load_dwordx4 v2, s[8:11], s53 offen  lds
 v_mfma_f32_16x16x32_bf16 v[140:143], a[88:91], a[32:35], v[140:143]
 ds_read_b128 a[104:107], v4 offset:43008
 v_mfma_f32_16x16x32_bf16 v[148:151], a[88:91], a[40:43], v[148:151]
 v_mfma_f32_16x16x32_bf16 v[148:151], a[92:95], a[44:47], v[148:151]
 ds_read_b128 a[112:115], v4 offset:45056
 v_mfma_f32_16x16x32_bf16 v[144:147], a[84:87], a[44:47], v[144:147]
 s_add_u32 m0, s29, 24576
 v_mfma_f32_16x16x32_bf16 v[144:147], a[80:83], a[40:43], v[144:147]
 buffer_load_dwordx4 v1, s[4:7], s46 offen  lds
 v_mfma_f32_16x16x32_bf16 v[156:159], a[72:75], a[40:43], v[156:159]
 ds_read_b128 a[116:119], v5 offset:45056
 v_mfma_f32_16x16x32_bf16 v[156:159], a[76:79], a[44:47], v[156:159]
 v_mfma_f32_16x16x32_bf16 v[152:155], a[68:71], a[44:47], v[152:155]
 ds_read_b128 a[124:127], v5 offset:47104
 v_mfma_f32_16x16x32_bf16 v[152:155], a[64:67], a[40:43], v[152:155]
 s_add_u32 m0, s29, 94208
 v_mfma_f32_16x16x32_bf16 v[160:163], a[64:67], a[48:51], v[160:163]
 buffer_load_dwordx4 v2, s[8:11], s54 offen  lds
 v_mfma_f32_16x16x32_bf16 v[160:163], a[68:71], a[52:55], v[160:163]
 ds_read_b128 a[120:123], v4 offset:47104
 v_mfma_f32_16x16x32_bf16 v[164:167], a[76:79], a[52:55], v[164:167]
 v_mfma_f32_16x16x32_bf16 v[164:167], a[72:75], a[48:51], v[164:167]
 ds_read_b64_tr_b16 a[8:9], v7 offset:32768
 v_mfma_f32_16x16x32_bf16 v[168:171], a[80:83], a[48:51], v[168:171]
 s_add_u32 m0, s29, 28672
 ds_read_b64_tr_b16 a[10:11], v7 offset:36864
 v_mfma_f32_16x16x32_bf16 v[168:171], a[84:87], a[52:55], v[168:171]
 buffer_load_dwordx4 v1, s[4:7], s47 offen  lds
 v_mfma_f32_16x16x32_bf16 v[172:175], a[92:95], a[52:55], v[172:175]
 v_add_u32 v1, 128, v1
 v_add_u32 v2, 0x80000, v2
 v_mfma_f32_16x16x32_bf16 v[172:175], a[88:91], a[48:51], v[172:175]
 ds_read_b64_tr_b16 a[12:13], v7 offset:49152
 v_mfma_f32_16x16x32_bf16 v[180:183], a[88:91], a[56:59], v[180:183]
 buffer_load_dword a243, v14, s[36:39], s56 offen
 v_mfma_f32_16x16x32_bf16 v[180:183], a[92:95], a[60:63], v[180:183]
 s_add_u32 s56, s56, s30
 ds_read_b64_tr_b16 a[14:15], v7 offset:53248
 v_mfma_f32_16x16x32_bf16 v[176:179], a[84:87], a[60:63], v[176:179]
 ds_read_b64_tr_b16 a[16:17], v8 offset:32768
 v_mfma_f32_16x16x32_bf16 v[176:179], a[80:83], a[56:59], v[176:179]
 ds_read_b64_tr_b16 a[18:19], v8 offset:36864
 v_mfma_f32_16x16x32_bf16 v[188:191], a[72:75], a[56:59], v[188:191]
 ds_read_b64_tr_b16 a[20:21], v8 offset:49152
 v_mfma_f32_16x16x32_bf16 v[188:191], a[76:79], a[60:63], v[188:191]
 ds_read_b64_tr_b16 a[22:23], v8 offset:53248
 v_mfma_f32_16x16x32_bf16 v[184:187], a[68:71], a[60:63], v[184:187]
 ds_read_b64_tr_b16 a[24:25], v9 offset:32768
 v_mfma_f32_16x16x32_bf16 v[184:187], a[64:67], a[56:59], v[184:187]
 s_waitcnt lgkmcnt(8)
 ds_read_b64_tr_b16 a[26:27], v9 offset:36864
L_vloop_mid:
 v_mfma_f32_16x16x32_bf16 v[16:19], a[96:99], a[0:3], v[16:19]
 ds_read_b64_tr_b16 a[28:29], v9 offset:49152
 v_mfma_f32_16x16x32_bf16 v[16:19], a[100:103], a[4:7], v[16:19]
 ds_read_b64_tr_b16 a[30:31], v9 offset:53248
 v_mfma_f32_16x16x32_bf16 v[20:23], a[108:111], a[4:7], v[20:23]
 ds_read_b128 a[64:67], v4 offset:32768
 v_mfma_f32_16x16x32_bf16 v[20:23], a[104:107], a[0:3], v[20:23]
 v_mfma_f32_16x16x32_bf16 v[24:27], a[112:115], a[0:3], v[24:27]
 ds_read_b128 a[68:71], v5 offset:32768
 v_mfma_f32_16x16x32_bf16 v[24:27], a[116:119], a[4:7], v[24:27]
 v_mfma_f32_16x16x32_bf16 v[28:31], a[124:127], a[4:7], v[28:31]
 ds_read_b128 a[76:79], v5 offset:34816
 v_mfma_f32_16x16x32_bf16 v[28:31], a[120:123], a[0:3], v[28:31]
 s_waitcnt lgkmcnt(8)
 v_mfma_f32_16x16x32_bf16 a[228:231], a[120:123], a[8:11], a[228:231]
 ds_read_b128 a[72:75], v4 offset:34816
 v_mfma_f32_16x16x32_bf16 a[228:231], a[124:127], a[12:15], a[228:231]
 v_mfma_f32_16x16x32_bf16 a[224:227], a[116:119], a[12:15], a[224:227]
 ds_read_b128 a[80:83], v4 offset:36864
 v_mfma_f32_16x16x32_bf16 a[224:227], a[112:115], a[8:11], a[224:227]
 v_mfma_f32_16x16x32_bf16 a[236:239], a[104:107], a[8:11], a[236:239]
 ds_read_b128 a[84:87], v5 offset:36864
 v_mfma_f32_16x16x32_bf16 a[236:239], a[108:111], a[12:15], a[236:239]
 v_mfma_f32_16x16x32_bf16 a[232:235], a[100:103], a[12:15], a[232:235]
 ds_read_b128 a[92:95], v5 offset:38912
 v_mfma_f32_16x16x32_bf16 a[232:235], a[96:99], a[8:11], a[232:235]
 v_mfma_f32_16x16x32_bf16 v[32:35], a[96:99], a[16:19], v[32:35]
 s_waitcnt lgkmcnt(8)
 ds_read_b128 a[88:91], v4 offset:38912
 v_mfma_f32_16x16x32_bf16 v[32:35], a[100:103], a[20:23], v[32:35]
 v_mfma_f32_16x16x32_bf16 v[36:39], a[108:111], a[20:23], v[36:39]
 ds_read_b64_tr_b16 a[32:33], v10 offset:32768
 v_mfma_f32_16x16x32_bf16 v[36:39], a[104:107], a[16:19], v[36:39]
 ds_read_b64_tr_b16 a[34:35], v10 offset:36864
 v_mfma_f32_16x16x32_bf16 v[40:43], a[112:115], a[16:19], v[40:43]
 ds_read_b64_tr_b16 a[36:37], v10 offset:49152
 v_mfma_f32_16x16x32_bf16 v[40:43], a[116:119], a[20:23], v[40:43]
 ds_read_b64_tr_b16 a[38:39], v10 offset:53248
 v_mfma_f32_16x16x32_bf16 v[44:47], a[124:127], a[20:23], v[44:47]
 ds_read_b64_tr_b16 a[40:41], v11 offset:32768
 v_mfma_f32_16x16x32_bf16 v[44:47], a[120:123], a[16:19], v[44:47]
 ds_read_b64_tr_b16 a[42:43], v11 offset:36864
 v_mfma_f32_16x16x32_bf16 v[52:55], a[120:123], a[24:27], v[52:55]
 s_waitcnt lgkmcnt(8)
 ds_read_b64_tr_b16 a[44:45], v11 offset:49152
 v_mfma_f32_16x16x32_bf16 v[52:55], a[124:127], a[28:31], v[52:55]
 ds_read_b64_tr_b16 a[46:47], v11 offset:53248
 v_mfma_f32_16x16x32_bf16 v[48:51], a[116:119], a[28:31], v[48:51]
 ds_read_b64_tr_b16 a[48:49], v12 offset:32768
 v_mfma_f32_16x16x32_bf16 v[48:51], a[112:115], a[24:27], v[48:51]
 ds_read_b64_tr_b16 a[50:51], v12 offset:36864
 v_mfma_f32_16x16x32_bf16 v[60:63], a[104:107], a[24:27], v[60:63]
 ds_read_b64_tr_b16 a[52:53], v12 offset:49152
 v_mfma_f32_16x16x32_bf16 v[60:63], a[108:111], a[28:31], v[60:63]
 ds_read_b64_tr_b16 a[54:55], v12 offset:53248
 v_mfma_f32_16x16x32_bf16 v[56:59], a[100:103], a[28:31], v[56:59]
 ds_read_b64_tr_b16 a[56:57], v13 offset:32768
 v_mfma_f32_16x16x32_bf16 v[56:59], a[96:99], a[24:27], v[56:59]
 ds_read_b64_tr_b16 a[58:59], v13 offset:36864
 v_mfma_f32_16x16x32_bf16 v[64:67], a[64:67], a[0:3], v[64:67]
 ds_read_b64_tr_b16 a[60:61], v13 offset:49152
 v_mfma_f32_16x16x32_bf16 v[64:67], a[68:71], a[4:7], v[64:67]
 ds_read_b64_tr_b16 a[62:63], v13 offset:53248
 v_mfma_f32_16x16x32_bf16 v[68:71], a[76:79], a[4:7], v[68:71]
 v_mfma_f32_16x16x32_bf16 v[68:71], a[72:75], a[0:3], v[68:71]
 v_mfma_f32_16x16x32_bf16 v[72:75], a[80:83], a[0:3], v[72:75]
 v_mfma_f32_16x16x32_bf16 v[72:75], a[84:87], a[4:7], v[72:75]
 s_waitcnt lgkmcnt(8)
 v_mfma_f32_16x16x32_bf16 v[76:79], a[92:95], a[4:7], v[76:79]
 v_mfma_f32_16x16x32_bf16 v[76:79], a[88:91], a[0:3], v[76:79]
 s_waitcnt lgkmcnt(0)
 v_mfma_f32_16x16x32_bf16 v[84:87], a[88:91], a[8:11], v[84:87]
 s_barrier
 v_mfma_f32_16x16x32_bf16 v[84:87], a[92:95], a[12:15], v[84:87]
 s_add_u32 m0, s29, 98304
 v_mfma_f32_16x16x32_bf16 v[80:83], a[84:87], a[12:15], v[80:83]
 buffer_load_dwordx4 v2, s[8:11], 0 offen  lds
 v_mfma_f32_16x16x32_bf16 v[80:83], a[80:83], a[8:11], v[80:83]
 v_mfma_f32_16x16x32_bf16 v[92:95], a[72:75], a[8:11], v[92:95]
 v_mfma_f32_16x16x32_bf16 v[92:95], a[76:79], a[12:15], v[92:95]
 v_mfma_f32_16x16x32_bf16 v[88:91], a[68:71], a[12:15], v[88:91]
 s_add_u32 m0, s29, 32768
 v_mfma_f32_16x16x32_bf16 v[88:91], a[64:67], a[8:11], v[88:91]
 buffer_load_dwordx4 v1, s[4:7], 0 offen  lds
 v_mfma_f32_16x16x32_bf16 v[96:99], a[64:67], a[16:19], v[96:99]
 v_mfma_f32_16x16x32_bf16 v[96:99], a[68:71], a[20:23], v[96:99]
 v_mfma_f32_16x16x32_bf16 v[100:103], a[76:79], a[20:23], v[100:103]
 v_mfma_f32_16x16x32_bf16 v[100:103], a[72:75], a[16:19], v[100:103]
 s_add_u32 m0, s29, 102400
 v_mfma_f32_16x16x32_bf16 v[104:107], a[80:83], a[16:19], v[104:107]
 buffer_load_dwordx4 v2, s[8:11], s48 offen  lds
 v_mfma_f32_16x16x32_bf16 v[104:107], a[84:87], a[20:23], v[104:107]
 v_mfma_f32_16x16x32_bf16 v[108:111], a[92:95], a[20:23], v[108:111]
 v_mfma_f32_16x16x32_bf16 v[108:111], a[88:91], a[16:19], v[108:111]
 v_mfma_f32_16x16x32_bf16 v[116:119], a[88:91], a[24:27], v[116:119]
 s_add_u32 m0, s29, 36864
 v_mfma_f32_16x16x32_bf16 v[116:119], a[92:95], a[28:31], v[116:119]
 buffer_load_dwordx4 v1, s[4:7], s41 offen  lds
 v_mfma_f32_16x16x32_bf16 v[112:115], a[84:87], a[28:31], v[112:115]
 v_mfma_f32_16x16x32_bf16 v[112:115], a[80:83], a[24:27], v[112:115]
 v_mfma_f32_16x16x32_bf16 v[124:127], a[72:75], a[24:27], v[124:127]
 v_mfma_f32_16x16x32_bf16 v[124:127], a[76:79], a[28:31], v[124:127]
 s_add_u32 m0, s29, 106496
 v_mfma_f32_16x16x32_bf16 v[120:123], a[68:71], a[28:31], v[120:123]
 buffer_load_dwordx4 v2, s[8:11], s49 offen  lds
 v_mfma_f32_16x16x32_bf16 v[120:123], a[64:67], a[24:27], v[120:123]
 v_mfma_f32_16x16x32_bf16 v[128:131], a[64:67], a[32:35], v[128:131]
 v_mfma_f32_16x16x32_bf16 v[128:131], a[68:71], a[36:39], v[128:131]
 v_mfma_f32_16x16x32_bf16 v[132:135], a[76:79], a[36:39], v[132:135]
 s_add_u32 m0, s29, 40960
 v_mfma_f32_16x16x32_bf16 v[132:135], a[72:75], a[32:35], v[132:135]
 buffer_load_dwordx4 v1, s[4:7], s42 offen  lds
 v_mfma_f32_16x16x32_bf16 v[136:139], a[80:83], a[32:35], v[136:139]
 v_mfma_f32_16x16x32_bf16 v[136:139], a[84:87], a[36:39], v[136:139]
 v_mfma_f32_16x16x32_bf16 v[140:143], a[92:95], a[36:39], v[140:143]
 v_mfma_f32_16x16x32_bf16 v[140:143], a[88:91], a[32:35], v[140:143]
 s_add_u32 m0, s29, 110592
 v_mfma_f32_16x16x32_bf16 v[148:151], a[88:91], a[40:43], v[148:151]
 buffer_load_dwordx4 v2, s[8:11], s50 offen  lds
 v_mfma_f32_16x16x32_bf16 v[148:151], a[92:95], a[44:47], v[148:151]
 v_mfma_f32_16x16x32_bf16 v[144:147], a[84:87], a[44:47], v[144:147]
 v_mfma_f32_16x16x32_bf16 v[144:147], a[80:83], a[40:43], v[144:147]
 v_mfma_f32_16x16x32_bf16 v[156:159], a[72:75], a[40:43], v[156:159]
 s_add_u32 m0, s29, 45056
 v_mfma_f32_16x16x32_bf16 v[156:159], a[76:79], a[44:47], v[156:159]
 buffer_load_dwordx4 v1, s[4:7], s43 offen  lds
 v_mfma_f32_16x16x32_bf16 v[152:155], a[68:71], a[44:47], v[152:155]
 v_mfma_f32_16x16x32_bf16 v[152:155], a[64:67], a[40:43], v[152:155]
 v_mfma_f32_16x16x32_bf16 v[160:163], a[64:67], a[48:51], v[160:163]
 v_mfma_f32_16x16x32_bf16 v[160:163], a[68:71], a[52:55], v[160:163]
 s_add_u32 m0, s29, 114688
 v_mfma_f32_16x16x32_bf16 v[164:167], a[76:79], a[52:55], v[164:167]
 buffer_load_dwordx4 v2, s[8:11], s51 offen  lds
 v_mfma_f32_16x16x32_bf16 v[164:167], a[72:75], a[48:51], v[164:167]
 v_mfma_f32_16x16x32_bf16 v[168:171], a[80:83], a[48:51], v[168:171]
 v_mfma_f32_16x16x32_bf16 v[168:171], a[84:87], a[52:55], v[168:171]
 v_mfma_f32_16x16x32_bf16 v[172:175], a[92:95], a[52:55], v[172:175]
 s_add_u32 m0, s29, 49152
 v_mfma_f32_16x16x32_bf16 v[172:175], a[88:91], a[48:51], v[172:175]
 buffer_load_dwordx4 v1, s[4:7], s44 offen  lds
 v_mfma_f32_16x16x32_bf16 v[180:183], a[88:91], a[56:59], v[180:183]
 s_waitcnt vmcnt(11)
 v_mfma_f32_16x16x32_bf16 v[180:183], a[92:95], a[60:63], v[180:183]
 s_barrier
 v_mfma_f32_16x16x32_bf16 v[176:179], a[84:87], a[60:63], v[176:179]
 ds_read_b64_tr_b16 a[0:1], v6 offset:0
 v_mfma_f32_16x16x32_bf16 v[176:179], a[80:83], a[56:59], v[176:179]
 s_add_u32 m0, s29, 118784
 ds_read_b64_tr_b16 a[2:3], v6 offset:4096
 v_mfma_f32_16x16x32_bf16 v[188:191], a[72:75], a[56:59], v[188:191]
 buffer_load_dwordx4 v2, s[8:11], s52 offen  lds
 v_mfma_f32_16x16x32_bf16 v[188:191], a[76:79], a[60:63], v[188:191]
 ds_read_b64_tr_b16 a[4:5], v6 offset:16384
 v_mfma_f32_16x16x32_bf16 v[184:187], a[68:71], a[60:63], v[184:187]
 ds_read_b64_tr_b16 a[6:7], v6 offset:20480
 v_mfma_f32_16x16x32_bf16 v[184:187], a[64:67], a[56:59], v[184:187]
 ds_read_b128 a[64:67], v4 offset:0
 v_mfma_f32_16x16x32_bf16 v[192:195], a[96:99], a[32:35], v[192:195]
 s_add_u32 m0, s29, 53248
 v_mfma_f32_16x16x32_bf16 v[192:195], a[100:103], a[36:39], v[192:195]
 buffer_load_dwordx4 v1, s[4:7], s45 offen  lds
 v_mfma_f32_16x16x32_bf16 v[196:199], a[108:111], a[36:39], v[196:199]
 ds_read_b128 a[68:71], v5 offset:0
 v_mfma_f32_16x16x32_bf16 v[196:199], a[104:107], a[32:35], v[196:199]
 v_mfma_f32_16x16x32_bf16 v[200:203], a[112:115], a[32:35], v[200:203]
 ds_read_b128 a[76:79], v5 offset:2048
 v_mfma_f32_16x16x32_bf16 v[200:203], a[116:119], a[36:39], v[200:203]
 s_add_u32 m0, s29, 122880
 v_mfma_f32_16x16x32_bf16 v[204:207], a[124:127], a[36:39], v[204:207]
 buffer_load_dwordx4 v2, s[8:11], s53 offen  lds
 v_mfma_f32_16x16x32_bf16 v[204:207], a[120:123], a[32:35], v[204:207]
 ds_read_b128 a[72:75], v4 offset:2048
 v_mfma_f32_16x16x32_bf16 v[212:215], a[120:123], a[40:43], v[212:215]
 v_mfma_f32_16x16x32_bf16 v[212:215], a[124:127], a[44:47], v[212:215]
 ds_read_b128 a[80:83], v4 offset:4096
 v_mfma_f32_16x16x32_bf16 v[208:211], a[116:119], a[44:47], v[208:211]
 s_add_u32 m0, s29, 57344
 v_mfma_f32_16x16x32_bf16 v[208:211], a[112:115], a[40:43], v[208:211]
 buffer_load_dwordx4 v1, s[4:7], s46 offen  lds
 v_mfma_f32_16x16x32_bf16 v[220:223], a[104:107], a[40:43], v[220:223]
 ds_read_b128 a[84:87], v5 offset:4096
 v_mfma_f32_16x16x32_bf16 v[220:223], a[108:111], a[44:47], v[220:223]
 v_mfma_f32_16x16x32_bf16 v[216:219], a[100:103], a[44:47], v[216:219]
 ds_read_b128 a[92:95], v5 offset:6144
 v_mfma_f32_16x16x32_bf16 v[216:219], a[96:99], a[40:43], v[216:219]
 s_add_u32 m0, s29, 126976
 v_mfma_f32_16x16x32_bf16 v[224:227], a[96:99], a[48:51], v[224:227]
 buffer_load_dwordx4 v2, s[8:11], s54 offen  lds
 v_mfma_f32_16x16x32_bf16 v[224:227], a[100:103], a[52:55], v[224:227]
 ds_read_b128 a[88:91], v4 offset:6144
 v_mfma_f32_16x16x32_bf16 v[228:231], a[108:111], a[52:55], v[228:231]
 v_mfma_f32_16x16x32_bf16 v[228:231], a[104:107], a[48:51], v[228:231]
 ds_read_b64_tr_b16 a[8:9], v7 offset:0
 v_mfma_f32_16x16x32_bf16 v[232:235], a[112:115], a[48:51], v[232:235]
 s_add_u32 m0, s29, 61440
 ds_read_b64_tr_b16 a[10:11], v7 offset:4096
 v_mfma_f32_16x16x32_bf16 v[232:235], a[116:119], a[52:55], v[232:235]
 buffer_load_dwordx4 v1, s[4:7], s47 offen  lds
 v_mfma_f32_16x16x32_bf16 v[236:239], a[124:127], a[52:55], v[236:239]
 v_add_u32 v1, 128, v1
 v_add_u32 v2, 0x80000, v2
 v_mfma_f32_16x16x32_bf16 v[236:239], a[120:123], a[48:51], v[236:239]
 ds_read_b64_tr_b16 a[12:13], v7 offset:16384
 v_mfma_f32_16x16x32_bf16 v[244:247], a[120:123], a[56:59], v[244:247]
 buffer_load_dword a243, v14, s[36:39], s56 offen
 v_mfma_f32_16x16x32_bf16 v[244:247], a[124:127], a[60:63], v[244:247]
 s_add_u32 s56, s56, s30
 ds_read_b64_tr_b16 a[14:15], v7 offset:20480
 v_mfma_f32_16x16x32_bf16 v[240:243], a[116:119], a[60:63], v[240:243]
 ds_read_b64_tr_b16 a[16:17], v8 offset:0
 v_mfma_f32_16x16x32_bf16 v[240:243], a[112:115], a[56:59], v[240:243]
 ds_read_b64_tr_b16 a[18:19], v8 offset:4096
 v_mfma_f32_16x16x32_bf16 v[252:255], a[104:107], a[56:59], v[252:255]
 ds_read_b64_tr_b16 a[20:21], v8 offset:16384
 v_mfma_f32_16x16x32_bf16 v[252:255], a[108:111], a[60:63], v[252:255]
 s_add_u32 s61, s61, 1
 ds_read_b64_tr_b16 a[22:23], v8 offset:20480
 v_mfma_f32_16x16x32_bf16 v[248:251], a[100:103], a[60:63], v[248:251]
 s_cmp_lt_u32 s61, s55
 ds_read_b64_tr_b16 a[24:25], v9 offset:0
 v_mfma_f32_16x16x32_bf16 v[248:251], a[96:99], a[56:59], v[248:251]
 s_waitcnt lgkmcnt(8)
 ds_read_b64_tr_b16 a[26:27], v9 offset:4096
 s_cbranch_scc1 L_vloop
 s_cmp_lt_u32 s61, 6
 s_cbranch_scc1 L_vloop_side
 v_mfma_f32_16x16x32_bf16 v[64:67], a[64:67], a[0:3], v[64:67]
 ds_read_b64_tr_b16 a[28:29], v9 offset:16384
 v_accvgpr_read_b32 v15, a240
 v_mfma_f32_16x16x32_bf16 v[64:67], a[68:71], a[4:7], v[64:67]
 ds_read_b64_tr_b16 a[30:31], v9 offset:20480
 v_accvgpr_read_b32 v14, a242
 v_mfma_f32_16x16x32_bf16 v[68:71], a[76:79], a[4:7], v[68:71]
 s_waitcnt lgkmcnt(14)
 ds_read_b128 a[96:99], v4 offset:8192
 v_xor_b32 v3, 64, v14
 v_mfma_f32_16x16x32_bf16 v[68:71], a[72:75], a[0:3], v[68:71]
 v_mfma_f32_16x16x32_bf16 v[72:75], a[80:83], a[0:3], v[72:75]
 s_add_u32 m0, s33, 0x0
 ds_read_b128 a[100:103], v5 offset:8192
 v_mfma_f32_16x16x32_bf16 v[72:75], a[84:87], a[4:7], v[72:75]
 s_waitcnt lgkmcnt(12)
 v_mfma_f32_16x16x32_bf16 v[76:79], a[92:95], a[4:7], v[76:79]
 ds_read_b128 a[108:111], v5 offset:10240
 buffer_load_dwordx4 v15, s[20:23], 0 offen offset:0 lds
 v_mfma_f32_16x16x32_bf16 v[76:79], a[88:91], a[0:3], v[76:79]
 v_mfma_f32_16x16x32_bf16 v[84:87], a[88:91], a[8:11], v[84:87]
 s_waitcnt lgkmcnt(11)
 ds_read_b128 a[104:107], v4 offset:10240
 v_mfma_f32_16x16x32_bf16 v[84:87], a[92:95], a[12:15], v[84:87]
 s_add_u32 m0, s33, 0x80
 v_mfma_f32_16x16x32_bf16 v[80:83], a[84:87], a[12:15], v[80:83]
 ds_read_b128 a[112:115], v4 offset:12288
 buffer_load_dwordx4 v15, s[20:23], 0 offen offset:896 lds
 v_mfma_f32_16x16x32_bf16 v[80:83], a[80:83], a[8:11], v[80:83]
 v_mfma_f32_16x16x32_bf16 v[92:95], a[72:75], a[8:11], v[92:95]
 ds_read_b128 a[116:119], v5 offset:12288
 v_mfma_f32_16x16x32_bf16 v[92:95], a[76:79], a[12:15], v[92:95]
 s_add_u32 m0, s33, 0x800
 v_mfma_f32_16x16x32_bf16 v[88:91], a[68:71], a[12:15], v[88:91]
 ds_read_b128 a[124:127], v5 offset:14336
 buffer_load_dwordx4 v15, s[20:23], s57 offen offset:0 lds
 v_mfma_f32_16x16x32_bf16 v[88:91], a[64:67], a[8:11], v[88:91]
 s_waitcnt lgkmcnt(11)
 v_mfma_f32_16x16x32_bf16 v[96:99], a[64:67], a[16:19], v[96:99]
 ds_read_b128 a[120:123], v4 offset:14336
 v_mfma_f32_16x16x32_bf16 v[96:99], a[68:71], a[20:23], v[96:99]
 s_add_u32 m0, s33, 0x880
 v_mfma_f32_16x16x32_bf16 v[100:103], a[76:79], a[20:23], v[100:103]
 ds_read_b64_tr_b16 a[32:33], v10 offset:0
 buffer_load_dwordx4 v15, s[20:23], s57 offen offset:896 lds
 v_mfma_f32_16x16x32_bf16 v[100:103], a[72:75], a[16:19], v[100:103]
 ds_read_b64_tr_b16 a[34:35], v10 offset:4096
 v_mfma_f32_16x16x32_bf16 v[104:107], a[80:83], a[16:19], v[104:107]
 ds_read_b64_tr_b16 a[36:37], v10 offset:16384
 v_mfma_f32_16x16x32_bf16 v[104:107], a[84:87], a[20:23], v[104:107]
 s_add_u32 m0, s33, 0xf80
 ds_read_b64_tr_b16 a[38:39], v10 offset:20480
 v_mfma_f32_16x16x32_bf16 v[108:111], a[92:95], a[20:23], v[108:111]
 ds_read_b64_tr_b16 a[40:41], v11 offset:0
 buffer_load_dwordx4 v15, s[20:23], 0 offen offset:128 lds
 v_mfma_f32_16x16x32_bf16 v[108:111], a[88:91], a[16:19], v[108:111]
 s_waitcnt lgkmcnt(13)
 ds_read_b64_tr_b16 a[42:43], v11 offset:4096
 v_mfma_f32_16x16x32_bf16 v[116:119], a[88:91], a[24:27], v[116:119]
 ds_read_b64_tr_b16 a[44:45], v11 offset:16384
 v_mfma_f32_16x16x32_bf16 v[116:119], a[92:95], a[28:31], v[116:119]
 s_add_u32 m0, s33, 0x1000
 ds_read_b64_tr_b16 a[46:47], v11 offset:20480
 v_mfma_f32_16x16x32_bf16 v[112:115], a[84:87], a[28:31], v[112:115]
 ds_read_b64_tr_b16 a[48:49], v12 offset:0
 buffer_load_dwordx4 v15, s[20:23], 0 offen offset:1024 lds
 v_mfma_f32_16x16x32_bf16 v[112:115], a[80:83], a[24:27], v[112:115]
 ds_read_b64_tr_b16 a[50:51], v12 offset:4096
 v_mfma_f32_16x16x32_bf16 v[124:127], a[72:75], a[24:27], v[124:127]
 ds_read_b64_tr_b16 a[52:53], v12 offset:16384
 v_mfma_f32_16x16x32_bf16 v[124:127], a[76:79], a[28:31], v[124:127]
 s_add_u32 m0, s33, 0x1780
 ds_read_b64_tr_b16 a[54:55], v12 offset:20480
 v_mfma_f32_16x16x32_bf16 v[120:123], a[68:71], a[28:31], v[120:123]
 ds_read_b64_tr_b16 a[56:57], v13 offset:0
 buffer_load_dwordx4 v15, s[20:23], s57 offen offset:128 lds
 v_mfma_f32_16x16x32_bf16 v[120:123], a[64:67], a[24:27], v[120:123]
 s_waitcnt lgkmcnt(15)
 ds_read_b64_tr_b16 a[58:59], v13 offset:4096
 v_mfma_f32_16x16x32_bf16 v[16:19], a[96:99], a[0:3], v[16:19]
 ds_read_b64_tr_b16 a[60:61], v13 offset:16384
 v_mfma_f32_16x16x32_bf16 v[16:19], a[100:103], a[4:7], v[16:19]
 s_add_u32 m0, s33, 0x1800
 ds_read_b64_tr_b16 a[62:63], v13 offset:20480
 v_mfma_f32_16x16x32_bf16 v[20:23], a[108:111], a[4:7], v[20:23]
 buffer_load_dwordx4 v15, s[20:23], s57 offen offset:1024 lds
 v_mfma_f32_16x16x32_bf16 v[20:23], a[104:107], a[0:3], v[20:23]
 v_mfma_f32_16x16x32_bf16 v[24:27], a[112:115], a[0:3], v[24:27]
 v_mfma_f32_16x16x32_bf16 v[24:27], a[116:119], a[4:7], v[24:27]
 s_waitcnt lgkmcnt(15)
 v_mfma_f32_16x16x32_bf16 v[28:31], a[124:127], a[4:7], v[28:31]
 v_mfma_f32_16x16x32_bf16 v[28:31], a[120:123], a[0:3], v[28:31]
 s_waitcnt lgkmcnt(0)
 v_mfma_f32_16x16x32_bf16 a[228:231], a[120:123], a[8:11], a[228:231]
 s_barrier
 v_mfma_f32_16x16x32_bf16 a[228:231], a[124:127], a[12:15], a[228:231]
 s_add_u32 m0, s29, 65536
 v_mfma_f32_16x16x32_bf16 a[224:227], a[116:119], a[12:15], a[224:227]
 buffer_load_dwordx4 v2, s[8:11], 0 offen  lds
 v_mfma_f32_16x16x32_bf16 a[224:227], a[112:115], a[8:11], a[224:227]
 v_mfma_f32_16x16x32_bf16 a[236:239], a[104:107], a[8:11], a[236:239]
 v_mfma_f32_16x16x32_bf16 a[236:239], a[108:111], a[12:15], a[236:239]
 v_mfma_f32_16x16x32_bf16 a[232:235], a[100:103], a[12:15], a[232:235]
 s_add_u32 m0, s29, 0
 v_mfma_f32_16x16x32_bf16 a[232:235], a[96:99], a[8:11], a[232:235]
 buffer_load_dwordx4 v1, s[4:7], 0 offen  lds
 v_mfma_f32_16x16x32_bf16 v[32:35], a[96:99], a[16:19], v[32:35]
 v_mfma_f32_16x16x32_bf16 v[32:35], a[100:103], a[20:23], v[32:35]
 v_mfma_f32_16x16x32_bf16 v[36:39], a[108:111], a[20:23], v[36:39]
 v_mfma_f32_16x16x32_bf16 v[36:39], a[104:107], a[16:19], v[36:39]
 s_add_u32 m0, s29, 69632
 v_mfma_f32_16x16x32_bf16 v[40:43], a[112:115], a[16:19], v[40:43]
 buffer_load_dwordx4 v2, s[8:11], s48 offen  lds
 v_mfma_f32_16x16x32_bf16 v[40:43], a[116:119], a[20:23], v[40:43]
 v_mfma_f32_16x16x32_bf16 v[44:47], a[124:127], a[20:23], v[44:47]
 v_mfma_f32_16x16x32_bf16 v[44:47], a[120:123], a[16:19], v[44:47]
 v_mfma_f32_16x16x32_bf16 v[52:55], a[120:123], a[24:27], v[52:55]
 s_add_u32 m0, s29, 4096
 v_mfma_f32_16x16x32_bf16 v[52:55], a[124:127], a[28:31], v[52:55]
 buffer_load_dwordx4 v1, s[4:7], s41 offen  lds
 v_mfma_f32_16x16x32_bf16 v[48:51], a[116:119], a[28:31], v[48:51]
 v_mfma_f32_16x16x32_bf16 v[48:51], a[112:115], a[24:27], v[48:51]
 v_mfma_f32_16x16x32_bf16 v[60:63], a[104:107], a[24:27], v[60:63]
 v_mfma_f32_16x16x32_bf16 v[60:63], a[108:111], a[28:31], v[60:63]
 s_add_u32 m0, s29, 73728
 v_mfma_f32_16x16x32_bf16 v[56:59], a[100:103], a[28:31], v[56:59]
 buffer_load_dwordx4 v2, s[8:11], s49 offen  lds
 v_mfma_f32_16x16x32_bf16 v[56:59], a[96:99], a[24:27], v[56:59]
 v_mfma_f32_16x16x32_bf16 v[192:195], a[96:99], a[32:35], v[192:195]
 v_mfma_f32_16x16x32_bf16 v[192:195], a[100:103], a[36:39], v[192:195]
 v_mfma_f32_16x16x32_bf16 v[196:199], a[108:111], a[36:39], v[196:199]
 s_add_u32 m0, s29, 8192
 v_mfma_f32_16x16x32_bf16 v[196:199], a[104:107], a[32:35], v[196:199]
 buffer_load_dwordx4 v1, s[4:7], s42 offen  lds
 v_mfma_f32_16x16x32_bf16 v[200:203], a[112:115], a[32:35], v[200:203]
 v_mfma_f32_16x16x32_bf16 v[200:203], a[116:119], a[36:39], v[200:203]
 v_mfma_f32_16x16x32_bf16 v[204:207], a[124:127], a[36:39], v[204:207]
 v_mfma_f32_16x16x32_bf16 v[204:207], a[120:123], a[32:35], v[204:207]
 s_add_u32 m0, s29, 77824
 v_mfma_f32_16x16x32_bf16 v[212:215], a[120:123], a[40:43], v[212:215]
 buffer_load_dwordx4 v2, s[8:11], s50 offen  lds
 v_mfma_f32_16x16x32_bf16 v[212:215], a[124:127], a[44:47], v[212:215]
 v_mfma_f32_16x16x32_bf16 v[208:211], a[116:119], a[44:47], v[208:211]
 v_mfma_f32_16x16x32_bf16 v[208:211], a[112:115], a[40:43], v[208:211]
 v_mfma_f32_16x16x32_bf16 v[220:223], a[104:107], a[40:43], v[220:223]
 s_add_u32 m0, s29, 12288
 v_mfma_f32_16x16x32_bf16 v[220:223], a[108:111], a[44:47], v[220:223]
 buffer_load_dwordx4 v1, s[4:7], s43 offen  lds
 v_mfma_f32_16x16x32_bf16 v[216:219], a[100:103], a[44:47], v[216:219]
 v_mfma_f32_16x16x32_bf16 v[216:219], a[96:99], a[40:43], v[216:219]
 v_mfma_f32_16x16x32_bf16 v[224:227], a[96:99], a[48:51], v[224:227]
 v_mfma_f32_16x16x32_bf16 v[224:227], a[100:103], a[52:55], v[224:227]
 s_add_u32 m0, s29, 81920
 v_mfma_f32_16x16x32_bf16 v[228:231], a[108:111], a[52:55], v[228:231]
 buffer_load_dwordx4 v2, s[8:11], s51 offen  lds
 v_mfma_f32_16x16x32_bf16 v[228:231], a[104:107], a[48:51], v[228:231]
 v_mfma_f32_16x16x32_bf16 v[232:235], a[112:115], a[48:51], v[232:235]
 v_mfma_f32_16x16x32_bf16 v[232:235], a[116:119], a[52:55], v[232:235]
 v_mfma_f32_16x16x32_bf16 v[236:239], a[124:127], a[52:55], v[236:239]
 s_add_u32 m0, s29, 16384
 v_mfma_f32_16x16x32_bf16 v[236:239], a[120:123], a[48:51], v[236:239]
 buffer_load_dwordx4 v1, s[4:7], s44 offen  lds
 v_mfma_f32_16x16x32_bf16 v[244:247], a[120:123], a[56:59], v[244:247]
 s_waitcnt vmcnt(10)
 v_mfma_f32_16x16x32_bf16 v[244:247], a[124:127], a[60:63], v[244:247]
 s_barrier
 v_mfma_f32_16x16x32_bf16 v[240:243], a[116:119], a[60:63], v[240:243]
 ds_read_b64_tr_b16 a[0:1], v6 offset:32768
 v_mfma_f32_16x16x32_bf16 v[240:243], a[112:115], a[56:59], v[240:243]
 s_add_u32 m0, s29, 86016
 ds_read_b64_tr_b16 a[2:3], v6 offset:36864
 v_mfma_f32_16x16x32_bf16 v[252:255], a[104:107], a[56:59], v[252:255]
 buffer_load_dwordx4 v2, s[8:11], s52 offen  lds
 v_mfma_f32_16x16x32_bf16 v[252:255], a[108:111], a[60:63], v[252:255]
 ds_read_b64_tr_b16 a[4:5], v6 offset:49152
 v_mfma_f32_16x16x32_bf16 v[248:251], a[100:103], a[60:63], v[248:251]
 ds_read_b64_tr_b16 a[6:7], v6 offset:53248
 v_mfma_f32_16x16x32_bf16 v[248:251], a[96:99], a[56:59], v[248:251]
 ds_read_b128 a[96:99], v4 offset:40960
 v_mfma_f32_16x16x32_bf16 v[128:131], a[64:67], a[32:35], v[128:131]
 s_add_u32 m0, s29, 20480
 ds_read_b128 a[128:131], v14 offset:0
 v_mfma_f32_16x16x32_bf16 v[128:131], a[68:71], a[36:39], v[128:131]
 buffer_load_dwordx4 v1, s[4:7], s45 offen  lds
 v_mfma_f32_16x16x32_bf16 v[132:135], a[76:79], a[36:39], v[132:135]
 ds_read_b128 a[100:103], v5 offset:40960
 v_mfma_f32_16x16x32_bf16 v[132:135], a[72:75], a[32:35], v[132:135]
 ds_read_b128 a[136:139], v3 offset:0
 v_mfma_f32_16x16x32_bf16 v[136:139], a[80:83], a[32:35], v[136:139]
 ds_read_b128 a[108:111], v5 offset:43008
 v_mfma_f32_16x16x32_bf16 v[136:139], a[84:87], a[36:39], v[136:139]
 s_add_u32 m0, s29, 90112
 ds_read_b128 a[132:135], v14 offset:2048
 v_mfma_f32_16x16x32_bf16 v[140:143], a[92:95], a[36:39], v[140:143]
 buffer_load_dwordx4 v2, s[8:11], s53 offen  lds
 v_mfma_f32_16x16x32_bf16 v[140:143], a[88:91], a[32:35], v[140:143]
 ds_read_b128 a[104:107], v4 offset:43008
 v_mfma_f32_16x16x32_bf16 v[148:151], a[88:91], a[40:43], v[148:151]
 ds_read_b128 a[140:143], v3 offset:2048
 v_mfma_f32_16x16x32_bf16 v[148:151], a[92:95], a[44:47], v[148:151]
 ds_read_b128 a[112:115], v4 offset:45056
 v_mfma_f32_16x16x32_bf16 v[144:147], a[84:87], a[44:47], v[144:147]
 s_add_u32 m0, s29, 24576
 ds_read_b128 a[144:147], v14 offset:4096
 v_mfma_f32_16x16x32_bf16 v[144:147], a[80:83], a[40:43], v[144:147]
 buffer_load_dwordx4 v1, s[4:7], s46 offen  lds
 v_mfma_f32_16x16x32_bf16 v[156:159], a[72:75], a[40:43], v[156:159]
 ds_read_b128 a[116:119], v5 offset:45056
 v_mfma_f32_16x16x32_bf16 v[156:159], a[76:79], a[44:47], v[156:159]
 ds_read_b128 a[152:155], v3 offset:4096
 v_mfma_f32_16x16x32_bf16 v[152:155], a[68:71], a[44:47], v[152:155]
 ds_read_b128 a[124:127], v5 offset:47104
 v_mfma_f32_16x16x32_bf16 v[152:155], a[64:67], a[40:43], v[152:155]
 s_add_u32 m0, s29, 94208
 ds_read_b128 a[148:151], v14 offset:6144
 v_mfma_f32_16x16x32_bf16 v[160:163], a[64:67], a[48:51], v[160:163]
 buffer_load_dwordx4 v2, s[8:11], s54 offen  lds
 v_mfma_f32_16x16x32_bf16 v[160:163], a[68:71], a[52:55], v[160:163]
 ds_read_b128 a[120:123], v4 offset:47104
 v_mfma_f32_16x16x32_bf16 v[164:167], a[76:79], a[52:55], v[164:167]
 ds_read_b128 a[156:159], v3 offset:6144
 v_mfma_f32_16x16x32_bf16 v[164:167], a[72:75], a[48:51], v[164:167]
 ds_read_b64_tr_b16 a[8:9], v7 offset:32768
 v_mfma_f32_16x16x32_bf16 v[168:171], a[80:83], a[48:51], v[168:171]
 s_add_u32 m0, s29, 28672
 ds_read_b64_tr_b16 a[10:11], v7 offset:36864
 v_mfma_f32_16x16x32_bf16 v[168:171], a[84:87], a[52:55], v[168:171]
 buffer_load_dwordx4 v1, s[4:7], s47 offen  lds
 v_mfma_f32_16x16x32_bf16 v[172:175], a[92:95], a[52:55], v[172:175]
 v_add_u32 v1, 128, v1
 v_add_u32 v2, 0x80000, v2
 v_mfma_f32_16x16x32_bf16 v[172:175], a[88:91], a[48:51], v[172:175]
 ds_read_b64_tr_b16 a[12:13], v7 offset:49152
 v_mfma_f32_16x16x32_bf16 v[180:183], a[88:91], a[56:59], v[180:183]
 v_mfma_f32_16x16x32_bf16 v[180:183], a[92:95], a[60:63], v[180:183]
 ds_read_b64_tr_b16 a[14:15], v7 offset:53248
 v_mfma_f32_16x16x32_bf16 v[176:179], a[84:87], a[60:63], v[176:179]
 ds_read_b64_tr_b16 a[16:17], v8 offset:32768
 v_mfma_f32_16x16x32_bf16 v[176:179], a[80:83], a[56:59], v[176:179]
 ds_read_b64_tr_b16 a[18:19], v8 offset:36864
 v_mfma_f32_16x16x32_bf16 v[188:191], a[72:75], a[56:59], v[188:191]
 ds_read_b64_tr_b16 a[20:21], v8 offset:49152
 v_mfma_f32_16x16x32_bf16 v[188:191], a[76:79], a[60:63], v[188:191]
 ds_read_b64_tr_b16 a[22:23], v8 offset:53248
 v_mfma_f32_16x16x32_bf16 v[184:187], a[68:71], a[60:63], v[184:187]
 ds_read_b64_tr_b16 a[24:25], v9 offset:32768
 v_mfma_f32_16x16x32_bf16 v[184:187], a[64:67], a[56:59], v[184:187]
 s_waitcnt lgkmcnt(15)
 ds_read_b64_tr_b16 a[26:27], v9 offset:36864
 v_mfma_f32_16x16x32_bf16 v[16:19], a[96:99], a[0:3], v[16:19]
 ds_read_b64_tr_b16 a[28:29], v9 offset:49152
 v_mfma_f32_16x16x32_bf16 v[16:19], a[100:103], a[4:7], v[16:19]
 s_add_u32 m0, s33, 0xffffff00
 ds_read_b64_tr_b16 a[30:31], v9 offset:53248
 v_mfma_f32_16x16x32_bf16 v[20:23], a[108:111], a[4:7], v[20:23]
 s_waitcnt lgkmcnt(12)
 ds_read_b128 a[64:67], v4 offset:32768
 v_mfma_f32_16x16x32_bf16 v[20:23], a[104:107], a[0:3], v[20:23]
 buffer_load_dwordx4 v15, s[20:23], 0 offen offset:256 lds
 v_mfma_f32_16x16x32_bf16 v[24:27], a[112:115], a[0:3], v[24:27]
 ds_read_b128 a[68:71], v5 offset:32768
 v_mfma_f32_16x16x32_bf16 v[24:27], a[116:119], a[4:7], v[24:27]
 v_mfma_f32_16x16x32_bf16 v[28:31], a[124:127], a[4:7], v[28:31]
 s_add_u32 m0, s33, 0xffffff80
 ds_read_b128 a[76:79], v5 offset:34816
 v_mfma_f32_16x16x32_bf16 v[28:31], a[120:123], a[0:3], v[28:31]
 s_waitcnt lgkmcnt(11)
 buffer_load_dwordx4 v15, s[20:23], 0 offen offset:1152 lds
 v_mfma_f32_16x16x32_bf16 a[228:231], a[120:123], a[8:11], a[228:231]
 ds_read_b128 a[72:75], v4 offset:34816
 v_mfma_f32_16x16x32_bf16 a[228:231], a[124:127], a[12:15], a[228:231]
 v_mfma_f32_16x16x32_bf16 a[224:227], a[116:119], a[12:15], a[224:227]
 s_add_u32 m0, s33, 0x700
 ds_read_b128 a[80:83], v4 offset:36864
 v_mfma_f32_16x16x32_bf16 a[224:227], a[112:115], a[8:11], a[224:227]
 buffer_load_dwordx4 v15, s[20:23], s57 offen offset:256 lds
 v_mfma_f32_16x16x32_bf16 a[236:239], a[104:107], a[8:11], a[236:239]
 ds_read_b128 a[84:87], v5 offset:36864
 v_mfma_f32_16x16x32_bf16 a[236:239], a[108:111], a[12:15], a[236:239]
 v_mfma_f32_16x16x32_bf16 a[232:235], a[100:103], a[12:15], a[232:235]
 s_add_u32 m0, s33, 0x780
 ds_read_b128 a[92:95], v5 offset:38912
 v_mfma_f32_16x16x32_bf16 a[232:235], a[96:99], a[8:11], a[232:235]
 s_waitcnt lgkmcnt(11)
 buffer_load_dwordx4 v15, s[20:23], s57 offen offset:1152 lds
 v_mfma_f32_16x16x32_bf16 v[32:35], a[96:99], a[16:19], v[32:35]
 ds_read_b128 a[88:91], v4 offset:38912
 v_mfma_f32_16x16x32_bf16 v[32:35], a[100:103], a[20:23], v[32:35]
 v_mfma_f32_16x16x32_bf16 v[36:39], a[108:111], a[20:23], v[36:39]
 s_add_u32 m0, s33, 0xe80
 ds_read_b64_tr_b16 a[32:33], v10 offset:32768
 v_mfma_f32_16x16x32_bf16 v[36:39], a[104:107], a[16:19], v[36:39]
 ds_read_b64_tr_b16 a[34:35], v10 offset:36864
 buffer_load_dwordx4 v15, s[20:23], 0 offen offset:384 lds
 v_mfma_f32_16x16x32_bf16 v[40:43], a[112:115], a[16:19], v[40:43]
 ds_read_b64_tr_b16 a[36:37], v10 offset:49152
 v_mfma_f32_16x16x32_bf16 v[40:43], a[116:119], a[20:23], v[40:43]
 ds_read_b64_tr_b16 a[38:39], v10 offset:53248
 v_mfma_f32_16x16x32_bf16 v[44:47], a[124:127], a[20:23], v[44:47]
 s_add_u32 m0, s33, 0xf00
 ds_read_b64_tr_b16 a[40:41], v11 offset:32768
 v_mfma_f32_16x16x32_bf16 v[44:47], a[120:123], a[16:19], v[44:47]
 s_waitcnt lgkmcnt(13)
 ds_read_b64_tr_b16 a[42:43], v11 offset:36864
 buffer_load_dwordx4 v15, s[20:23], 0 offen offset:1280 lds
 v_mfma_f32_16x16x32_bf16 v[52:55], a[120:123], a[24:27], v[52:55]
 ds_read_b64_tr_b16 a[44:45], v11 offset:49152
 v_mfma_f32_16x16x32_bf16 v[52:55], a[124:127], a[28:31], v[52:55]
 ds_read_b64_tr_b16 a[46:47], v11 offset:53248
 v_mfma_f32_16x16x32_bf16 v[48:51], a[116:119], a[28:31], v[48:51]
 s_add_u32 m0, s33, 0x1680
 ds_read_b64_tr_b16 a[48:49], v12 offset:32768
 v_mfma_f32_16x16x32_bf16 v[48:51], a[112:115], a[24:27], v[48:51]
 ds_read_b64_tr_b16 a[50:51], v12 offset:36864
 buffer_load_dwordx4 v15, s[20:23], s57 offen offset:384 lds
 v_mfma_f32_16x16x32_bf16 v[60:63], a[104:107], a[24:27], v[60:63]
 ds_read_b64_tr_b16 a[52:53], v12 offset:49152
 v_mfma_f32_16x16x32_bf16 v[60:63], a[108:111], a[28:31], v[60:63]
 ds_read_b64_tr_b16 a[54:55], v12 offset:53248
 v_mfma_f32_16x16x32_bf16 v[56:59], a[100:103], a[28:31], v[56:59]
 s_add_u32 m0, s33, 0x1700
 ds_read_b64_tr_b16 a[56:57], v13 offset:32768
 v_mfma_f32_16x16x32_bf16 v[56:59], a[96:99], a[24:27], v[56:59]
 s_waitcnt lgkmcnt(15)
 ds_read_b64_tr_b16 a[58:59], v13 offset:36864
 buffer_load_dwordx4 v15, s[20:23], s57 offen offset:1280 lds
 v_mfma_f32_16x16x32_bf16 v[64:67], a[64:67], a[0:3], v[64:67]
 ds_read_b64_tr_b16 a[60:61], v13 offset:49152
 v_mfma_f32_16x16x32_bf16 v[64:67], a[68:71], a[4:7], v[64:67]
 ds_read_b64_tr_b16 a[62:63], v13 offset:53248
 v_mfma_f32_16x16x32_bf16 v[68:71], a[76:79], a[4:7], v[68:71]
 v_mfma_f32_16x16x32_bf16 v[68:71], a[72:75], a[0:3], v[68:71]
 v_mfma_f32_16x16x32_bf16 v[72:75], a[80:83], a[0:3], v[72:75]
 v_mfma_f32_16x16x32_bf16 v[72:75], a[84:87], a[4:7], v[72:75]
 s_waitcnt lgkmcnt(15)
 v_mfma_f32_16x16x32_bf16 v[76:79], a[92:95], a[4:7], v[76:79]
 v_mfma_f32_16x16x32_bf16 v[76:79], a[88:91], a[0:3], v[76:79]
 s_waitcnt lgkmcnt(0)
 v_mfma_f32_16x16x32_bf16 v[84:87], a[88:91], a[8:11], v[84:87]
 s_barrier
 v_mfma_f32_16x16x32_bf16 v[84:87], a[92:95], a[12:15], v[84:87]
 s_add_u32 m0, s29, 98304
 v_mfma_f32_16x16x32_bf16 v[80:83], a[84:87], a[12:15], v[80:83]
 buffer_load_dwordx4 v2, s[8:11], 0 offen  lds
 v_mfma_f32_16x16x32_bf16 v[80:83], a[80:83], a[8:11], v[80:83]
 v_mfma_f32_16x16x32_bf16 v[92:95], a[72:75], a[8:11], v[92:95]
 v_mfma_f32_16x16x32_bf16 v[92:95], a[76:79], a[12:15], v[92:95]
 v_mfma_f32_16x16x32_bf16 v[88:91], a[68:71], a[12:15], v[88:91]
 s_add_u32 m0, s29, 32768
 v_mfma_f32_16x16x32_bf16 v[88:91], a[64:67], a[8:11], v[88:91]
 buffer_load_dwordx4 v1, s[4:7], 0 offen  lds
 v_mfma_f32_16x16x32_bf16 v[96:99], a[64:67], a[16:19], v[96:99]
 v_mfma_f32_16x16x32_bf16 v[96:99], a[68:71], a[20:23], v[96:99]
 v_mfma_f32_16x16x32_bf16 v[100:103], a[76:79], a[20:23], v[100:103]
 v_mfma_f32_16x16x32_bf16 v[100:103], a[72:75], a[16:19], v[100:103]
 s_add_u32 m0, s29, 102400
 v_mfma_f32_16x16x32_bf16 v[104:107], a[80:83], a[16:19], v[104:107]
 buffer_load_dwordx4 v2, s[8:11], s48 offen  lds
 v_mfma_f32_16x16x32_bf16 v[104:107], a[84:87], a[20:23], v[104:107]
 v_mfma_f32_16x16x32_bf16 v[108:111], a[92:95], a[20:23], v[108:111]
 v_mfma_f32_16x16x32_bf16 v[108:111], a[88:91], a[16:19], v[108:111]
 v_mfma_f32_16x16x32_bf16 v[116:119], a[88:91], a[24:27], v[116:119]
 s_add_u32 m0, s29, 36864
 v_mfma_f32_16x16x32_bf16 v[116:119], a[92:95], a[28:31], v[116:119]
 buffer_load_dwordx4 v1, s[4:7], s41 offen  lds
 v_mfma_f32_16x16x32_bf16 v[112:115], a[84:87], a[28:31], v[112:115]
 v_mfma_f32_16x16x32_bf16 v[112:115], a[80:83], a[24:27], v[112:115]
 v_mfma_f32_16x16x32_bf16 v[124:127], a[72:75], a[24:27], v[124:127]
 v_mfma_f32_16x16x32_bf16 v[124:127], a[76:79], a[28:31], v[124:127]
 s_add_u32 m0, s29, 106496
 v_mfma_f32_16x16x32_bf16 v[120:123], a[68:71], a[28:31], v[120:123]
 buffer_load_dwordx4 v2, s[8:11], s49 offen  lds
 v_mfma_f32_16x16x32_bf16 v[120:123], a[64:67], a[24:27], v[120:123]
 v_mfma_f32_16x16x32_bf16 v[128:131], a[64:67], a[32:35], v[128:131]
 v_mfma_f32_16x16x32_bf16 v[128:131], a[68:71], a[36:39], v[128:131]
 v_mfma_f32_16x16x32_bf16 v[132:135], a[76:79], a[36:39], v[132:135]
 s_add_u32 m0, s29, 40960
 v_mfma_f32_16x16x32_bf16 v[132:135], a[72:75], a[32:35], v[132:135]
 buffer_load_dwordx4 v1, s[4:7], s42 offen  lds
 v_mfma_f32_16x16x32_bf16 v[136:139], a[80:83], a[32:35], v[136:139]
 v_mfma_f32_16x16x32_bf16 v[136:139], a[84:87], a[36:39], v[136:139]
 v_mfma_f32_16x16x32_bf16 v[140:143], a[92:95], a[36:39], v[140:143]
 v_mfma_f32_16x16x32_bf16 v[140:143], a[88:91], a[32:35], v[140:143]
 s_add_u32 m0, s29, 110592
 v_mfma_f32_16x16x32_bf16 v[148:151], a[88:91], a[40:43], v[148:151]
 buffer_load_dwordx4 v2, s[8:11], s50 offen  lds
 v_mfma_f32_16x16x32_bf16 v[148:151], a[92:95], a[44:47], v[148:151]
 v_mfma_f32_16x16x32_bf16 v[144:147], a[84:87], a[44:47], v[144:147]
 v_mfma_f32_16x16x32_bf16 v[144:147], a[80:83], a[40:43], v[144:147]
 v_mfma_f32_16x16x32_bf16 v[156:159], a[72:75], a[40:43], v[156:159]
 s_add_u32 m0, s29, 45056
 v_mfma_f32_16x16x32_bf16 v[156:159], a[76:79], a[44:47], v[156:159]
 buffer_load_dwordx4 v1, s[4:7], s43 offen  lds
 v_mfma_f32_16x16x32_bf16 v[152:155], a[68:71], a[44:47], v[152:155]
 v_mfma_f32_16x16x32_bf16 v[152:155], a[64:67], a[40:43], v[152:155]
 v_mfma_f32_16x16x32_bf16 v[160:163], a[64:67], a[48:51], v[160:163]
 v_mfma_f32_16x16x32_bf16 v[160:163], a[68:71], a[52:55], v[160:163]
 s_add_u32 m0, s29, 114688
 v_mfma_f32_16x16x32_bf16 v[164:167], a[76:79], a[52:55], v[164:167]
 buffer_load_dwordx4 v2, s[8:11], s51 offen  lds
 v_mfma_f32_16x16x32_bf16 v[164:167], a[72:75], a[48:51], v[164:167]
 v_mfma_f32_16x16x32_bf16 v[168:171], a[80:83], a[48:51], v[168:171]
 v_mfma_f32_16x16x32_bf16 v[168:171], a[84:87], a[52:55], v[168:171]
 v_mfma_f32_16x16x32_bf16 v[172:175], a[92:95], a[52:55], v[172:175]
 s_add_u32 m0, s29, 49152
 v_mfma_f32_16x16x32_bf16 v[172:175], a[88:91], a[48:51], v[172:175]
 buffer_load_dwordx4 v1, s[4:7], s44 offen  lds
 v_mfma_f32_16x16x32_bf16 v[180:183], a[88:91], a[56:59], v[180:183]
 s_waitcnt vmcnt(10)
 v_mfma_f32_16x16x32_bf16 v[180:183], a[92:95], a[60:63], v[180:183]
 s_barrier
 v_mfma_f32_16x16x32_bf16 v[176:179], a[84:87], a[60:63], v[176:179]
 ds_read_b64_tr_b16 a[0:1], v6 offset:0
 v_mfma_f32_16x16x32_bf16 v[176:179], a[80:83], a[56:59], v[176:179]
 s_add_u32 m0, s29, 118784
 ds_read_b64_tr_b16 a[2:3], v6 offset:4096
 v_mfma_f32_16x16x32_bf16 v[188:191], a[72:75], a[56:59], v[188:191]
 buffer_load_dwordx4 v2, s[8:11], s52 offen  lds
 v_mfma_f32_16x16x32_bf16 v[188:191], a[76:79], a[60:63], v[188:191]
 ds_read_b64_tr_b16 a[4:5], v6 offset:16384
 v_mfma_f32_16x16x32_bf16 v[184:187], a[68:71], a[60:63], v[184:187]
 ds_read_b64_tr_b16 a[6:7], v6 offset:20480
 v_mfma_f32_16x16x32_bf16 v[184:187], a[64:67], a[56:59], v[184:187]
 ds_read_b128 a[64:67], v4 offset:0
 v_mfma_f32_16x16x32_bf16 v[192:195], a[96:99], a[32:35], v[192:195]
 s_add_u32 m0, s29, 53248
 ds_read_b128 a[160:163], v14 offset:0
 v_mfma_f32_16x16x32_bf16 v[192:195], a[100:103], a[36:39], v[192:195]
 buffer_load_dwordx4 v1, s[4:7], s45 offen  lds
 v_mfma_f32_16x16x32_bf16 v[196:199], a[108:111], a[36:39], v[196:199]
 ds_read_b128 a[68:71], v5 offset:0
 v_mfma_f32_16x16x32_bf16 v[196:199], a[104:107], a[32:35], v[196:199]
 ds_read_b128 a[168:171], v3 offset:0
 v_mfma_f32_16x16x32_bf16 v[200:203], a[112:115], a[32:35], v[200:203]
 ds_read_b128 a[76:79], v5 offset:2048
 v_mfma_f32_16x16x32_bf16 v[200:203], a[116:119], a[36:39], v[200:203]
 s_add_u32 m0, s29, 122880
 ds_read_b128 a[164:167], v14 offset:2048
 v_mfma_f32_16x16x32_bf16 v[204:207], a[124:127], a[36:39], v[204:207]
 buffer_load_dwordx4 v2, s[8:11], s53 offen  lds
 v_mfma_f32_16x16x32_bf16 v[204:207], a[120:123], a[32:35], v[204:207]
 ds_read_b128 a[72:75], v4 offset:2048
 v_mfma_f32_16x16x32_bf16 v[212:215], a[120:123], a[40:43], v[212:215]
 ds_read_b128 a[172:175], v3 offset:2048
 v_mfma_f32_16x16x32_bf16 v[212:215], a[124:127], a[44:47], v[212:215]
 ds_read_b128 a[80:83], v4 offset:4096
 v_mfma_f32_16x16x32_bf16 v[208:211], a[116:119], a[44:47], v[208:211]
 s_add_u32 m0, s29, 57344
 ds_read_b128 a[176:179], v14 offset:4096
 v_mfma_f32_16x16x32_bf16 v[208:211], a[112:115], a[40:43], v[208:211]
 buffer_load_dwordx4 v1, s[4:7], s46 offen  lds
 v_mfma_f32_16x16x32_bf16 v[220:223], a[104:107], a[40:43], v[220:223]
 ds_read_b128 a[84:87], v5 offset:4096
 v_mfma_f32_16x16x32_bf16 v[220:223], a[108:111], a[44:47], v[220:223]
 ds_read_b128 a[184:187], v3 offset:4096
 v_mfma_f32_16x16x32_bf16 v[216:219], a[100:103], a[44:47], v[216:219]
 ds_read_b128 a[92:95], v5 offset:6144
 v_mfma_f32_16x16x32_bf16 v[216:219], a[96:99], a[40:43], v[216:219]
 s_add_u32 m0, s29, 126976
 ds_read_b128 a[180:183], v14 offset:6144
 v_mfma_f32_16x16x32_bf16 v[224:227], a[96:99], a[48:51], v[224:227]
 buffer_load_dwordx4 v2, s[8:11], s54 offen  lds
 v_mfma_f32_16x16x32_bf16 v[224:227], a[100:103], a[52:55], v[224:227]
 ds_read_b128 a[88:91], v4 offset:6144
 v_mfma_f32_16x16x32_bf16 v[228:231], a[108:111], a[52:55], v[228:231]
 ds_read_b128 a[188:191], v3 offset:6144
 v_mfma_f32_16x16x32_bf16 v[228:231], a[104:107], a[48:51], v[228:231]
 ds_read_b64_tr_b16 a[8:9], v7 offset:0
 v_mfma_f32_16x16x32_bf16 v[232:235], a[112:115], a[48:51], v[232:235]
 s_add_u32 m0, s29, 61440
 ds_read_b64_tr_b16 a[10:11], v7 offset:4096
 v_mfma_f32_16x16x32_bf16 v[232:235], a[116:119], a[52:55], v[232:235]
 buffer_load_dwordx4 v1, s[4:7], s47 offen  lds
 v_mfma_f32_16x16x32_bf16 v[236:239], a[124:127], a[52:55], v[236:239]
 v_add_u32 v1, 128, v1
 v_add_u32 v2, 0x80000, v2
 v_mfma_f32_16x16x32_bf16 v[236:239], a[120:123], a[48:51], v[236:239]
 ds_read_b64_tr_b16 a[12:13], v7 offset:16384
 v_mfma_f32_16x16x32_bf16 v[244:247], a[120:123], a[56:59], v[244:247]
 v_mfma_f32_16x16x32_bf16 v[244:247], a[124:127], a[60:63], v[244:247]
 ds_read_b64_tr_b16 a[14:15], v7 offset:20480
 v_mfma_f32_16x16x32_bf16 v[240:243], a[116:119], a[60:63], v[240:243]
 ds_read_b64_tr_b16 a[16:17], v8 offset:0
 v_mfma_f32_16x16x32_bf16 v[240:243], a[112:115], a[56:59], v[240:243]
 ds_read_b64_tr_b16 a[18:19], v8 offset:4096
 v_mfma_f32_16x16x32_bf16 v[252:255], a[104:107], a[56:59], v[252:255]
 ds_read_b64_tr_b16 a[20:21], v8 offset:16384
 v_mfma_f32_16x16x32_bf16 v[252:255], a[108:111], a[60:63], v[252:255]
 ds_read_b64_tr_b16 a[22:23], v8 offset:20480
 v_mfma_f32_16x16x32_bf16 v[248:251], a[100:103], a[60:63], v[248:251]
 ds_read_b64_tr_b16 a[24:25], v9 offset:0
 v_mfma_f32_16x16x32_bf16 v[248:251], a[96:99], a[56:59], v[248:251]
 s_waitcnt lgkmcnt(15)
 ds_read_b64_tr_b16 a[26:27], v9 offset:4096
 v_mfma_f32_16x16x32_bf16 v[64:67], a[64:67], a[0:3], v[64:67]
 ds_read_b64_tr_b16 a[28:29], v9 offset:16384
 v_lshlrev_b32 v1, 4, v0
 v_mfma_f32_16x16x32_bf16 v[64:67], a[68:71], a[4:7], v[64:67]
 s_add_u32 m0, s33, 0xfffffe00
 ds_read_b64_tr_b16 a[30:31], v9 offset:20480
 v_mfma_f32_16x16x32_bf16 v[68:71], a[76:79], a[4:7], v[68:71]
 s_waitcnt lgkmcnt(12)
 ds_read_b128 a[96:99], v4 offset:8192
 v_mfma_f32_16x16x32_bf16 v[68:71], a[72:75], a[0:3], v[68:71]
 buffer_load_dwordx4 v15, s[20:23], 0 offen offset:512 lds
 v_mfma_f32_16x16x32_bf16 v[72:75], a[80:83], a[0:3], v[72:75]
 ds_read_b128 a[100:103], v5 offset:8192
 v_mfma_f32_16x16x32_bf16 v[72:75], a[84:87], a[4:7], v[72:75]
 v_mfma_f32_16x16x32_bf16 v[76:79], a[92:95], a[4:7], v[76:79]
 s_add_u32 m0, s33, 0xfffffe80
 ds_read_b128 a[108:111], v5 offset:10240
 v_mfma_f32_16x16x32_bf16 v[76:79], a[88:91], a[0:3], v[76:79]
 s_waitcnt lgkmcnt(11)
 buffer_load_dwordx4 v15, s[20:23], 0 offen offset:1408 lds
 v_mfma_f32_16x16x32_bf16 v[84:87], a[88:91], a[8:11], v[84:87]
 ds_read_b128 a[104:107], v4 offset:10240
 v_mfma_f32_16x16x32_bf16 v[84:87], a[92:95], a[12:15], v[84:87]
 v_mfma_f32_16x16x32_bf16 v[80:83], a[84:87], a[12:15], v[80:83]
 s_add_u32 m0, s33, 0x600
 ds_read_b128 a[112:115], v4 offset:12288
 v_mfma_f32_16x16x32_bf16 v[80:83], a[80:83], a[8:11], v[80:83]
 buffer_load_dwordx4 v15, s[20:23], s57 offen offset:512 lds
 v_mfma_f32_16x16x32_bf16 v[92:95], a[72:75], a[8:11], v[92:95]
 ds_read_b128 a[116:119], v5 offset:12288
 v_mfma_f32_16x16x32_bf16 v[92:95], a[76:79], a[12:15], v[92:95]
 v_mfma_f32_16x16x32_bf16 v[88:91], a[68:71], a[12:15], v[88:91]
 s_add_u32 m0, s33, 0x680
 ds_read_b128 a[124:127], v5 offset:14336
 v_mfma_f32_16x16x32_bf16 v[88:91], a[64:67], a[8:11], v[88:91]
 s_waitcnt lgkmcnt(11)
 buffer_load_dwordx4 v15, s[20:23], s57 offen offset:1408 lds
 v_mfma_f32_16x16x32_bf16 v[96:99], a[64:67], a[16:19], v[96:99]
 ds_read_b128 a[120:123], v4 offset:14336
 v_mfma_f32_16x16x32_bf16 v[96:99], a[68:71], a[20:23], v[96:99]
 v_mfma_f32_16x16x32_bf16 v[100:103], a[76:79], a[20:23], v[100:103]
 s_add_u32 m0, s33, 0xd80
 ds_read_b64_tr_b16 a[32:33], v10 offset:0
 v_mfma_f32_16x16x32_bf16 v[100:103], a[72:75], a[16:19], v[100:103]
 ds_read_b64_tr_b16 a[34:35], v10 offset:4096
 buffer_load_dwordx4 v15, s[20:23], 0 offen offset:640 lds
 v_mfma_f32_16x16x32_bf16 v[104:107], a[80:83], a[16:19], v[104:107]
 ds_read_b64_tr_b16 a[36:37], v10 offset:16384
 v_mfma_f32_16x16x32_bf16 v[104:107], a[84:87], a[20:23], v[104:107]
 ds_read_b64_tr_b16 a[38:39], v10 offset:20480
 v_mfma_f32_16x16x32_bf16 v[108:111], a[92:95], a[20:23], v[108:111]
 s_add_u32 m0, s33, 0xe00
 ds_read_b64_tr_b16 a[40:41], v11 offset:0
 v_mfma_f32_16x16x32_bf16 v[108:111], a[88:91], a[16:19], v[108:111]
 s_waitcnt lgkmcnt(13)
 ds_read_b64_tr_b16 a[42:43], v11 offset:4096
 buffer_load_dwordx4 v15, s[20:23], 0 offen offset:1536 lds
 v_mfma_f32_16x16x32_bf16 v[116:119], a[88:91], a[24:27], v[116:119]
 ds_read_b64_tr_b16 a[44:45], v11 offset:16384
 v_mfma_f32_16x16x32_bf16 v[116:119], a[92:95], a[28:31], v[116:119]
 ds_read_b64_tr_b16 a[46:47], v11 offset:20480
 v_mfma_f32_16x16x32_bf16 v[112:115], a[84:87], a[28:31], v[112:115]
 s_add_u32 m0, s33, 0x1580
 ds_read_b64_tr_b16 a[48:49], v12 offset:0
 v_mfma_f32_16x16x32_bf16 v[112:115], a[80:83], a[24:27], v[112:115]
 ds_read_b64_tr_b16 a[50:51], v12 offset:4096
 buffer_load_dwordx4 v15, s[20:23], s57 offen offset:640 lds
 v_mfma_f32_16x16x32_bf16 v[124:127], a[72:75], a[24:27], v[124:127]
 ds_read_b64_tr_b16 a[52:53], v12 offset:16384
 v_mfma_f32_16x16x32_bf16 v[124:127], a[76:79], a[28:31], v[124:127]
 ds_read_b64_tr_b16 a[54:55], v12 offset:20480
 v_mfma_f32_16x16x32_bf16 v[120:123], a[68:71], a[28:31], v[120:123]
 s_add_u32 m0, s33, 0x1600
 ds_read_b64_tr_b16 a[56:57], v13 offset:0
 v_mfma_f32_16x16x32_bf16 v[120:123], a[64:67], a[24:27], v[120:123]
 s_waitcnt lgkmcnt(15)
 ds_read_b64_tr_b16 a[58:59], v13 offset:4096
 buffer_load_dwordx4 v15, s[20:23], s57 offen offset:1536 lds
 v_mfma_f32_16x16x32_bf16 v[16:19], a[96:99], a[0:3], v[16:19]
 ds_read_b64_tr_b16 a[60:61], v13 offset:16384
 v_mfma_f32_16x16x32_bf16 v[16:19], a[100:103], a[4:7], v[16:19]
 ds_read_b64_tr_b16 a[62:63], v13 offset:20480
 v_mfma_f32_16x16x32_bf16 v[20:23], a[108:111], a[4:7], v[20:23]
 v_mfma_f32_16x16x32_bf16 v[20:23], a[104:107], a[0:3], v[20:23]
 v_mfma_f32_16x16x32_bf16 v[24:27], a[112:115], a[0:3], v[24:27]
 v_mfma_f32_16x16x32_bf16 v[24:27], a[116:119], a[4:7], v[24:27]
 s_waitcnt lgkmcnt(15)
 v_mfma_f32_16x16x32_bf16 v[28:31], a[124:127], a[4:7], v[28:31]
 v_mfma_f32_16x16x32_bf16 v[28:31], a[120:123], a[0:3], v[28:31]
 s_waitcnt lgkmcnt(0)
 v_mfma_f32_16x16x32_bf16 a[228:231], a[120:123], a[8:11], a[228:231]
 s_barrier
 v_mfma_f32_16x16x32_bf16 a[228:231], a[124:127], a[12:15], a[228:231]
 s_add_u32 m0, s29, 0
 v_add_u32 v2, 0xff800000, v2
 v_mfma_f32_16x16x32_bf16 a[224:227], a[116:119], a[12:15], a[224:227]
 buffer_load_dwordx4 v2, s[16:19], 0 offen lds
 v_mfma_f32_16x16x32_bf16 a[224:227], a[112:115], a[8:11], a[224:227]
 v_mfma_f32_16x16x32_bf16 a[236:239], a[104:107], a[8:11], a[236:239]
 v_mfma_f32_16x16x32_bf16 a[236:239], a[108:111], a[12:15], a[236:239]
 v_mfma_f32_16x16x32_bf16 a[232:235], a[100:103], a[12:15], a[232:235]
 s_add_u32 m0, s29, 4096
 v_mfma_f32_16x16x32_bf16 a[232:235], a[96:99], a[8:11], a[232:235]
 buffer_load_dwordx4 v2, s[16:19], s48 offen lds
 v_mfma_f32_16x16x32_bf16 v[32:35], a[96:99], a[16:19], v[32:35]
 v_mfma_f32_16x16x32_bf16 v[32:35], a[100:103], a[20:23], v[32:35]
 v_mfma_f32_16x16x32_bf16 v[36:39], a[108:111], a[20:23], v[36:39]
 v_mfma_f32_16x16x32_bf16 v[36:39], a[104:107], a[16:19], v[36:39]
 s_add_u32 m0, s29, 8192
 v_mfma_f32_16x16x32_bf16 v[40:43], a[112:115], a[16:19], v[40:43]
 buffer_load_dwordx4 v2, s[16:19], s49 offen lds
 v_mfma_f32_16x16x32_bf16 v[40:43], a[116:119], a[20:23], v[40:43]
 v_mfma_f32_16x16x32_bf16 v[44:47], a[124:127], a[20:23], v[44:47]
 v_mfma_f32_16x16x32_bf16 v[44:47], a[120:123], a[16:19], v[44:47]
 v_mfma_f32_16x16x32_bf16 v[52:55], a[120:123], a[24:27], v[52:55]
 s_add_u32 m0, s29, 12288
 v_mfma_f32_16x16x32_bf16 v[52:55], a[124:127], a[28:31], v[52:55]
 buffer_load_dwordx4 v2, s[16:19], s50 offen lds
 v_mfma_f32_16x16x32_bf16 v[48:51], a[116:119], a[28:31], v[48:51]
 v_mfma_f32_16x16x32_bf16 v[48:51], a[112:115], a[24:27], v[48:51]
 v_mfma_f32_16x16x32_bf16 v[60:63], a[104:107], a[24:27], v[60:63]
 v_mfma_f32_16x16x32_bf16 v[60:63], a[108:111], a[28:31], v[60:63]
 s_add_u32 m0, s29, 16384
 v_mfma_f32_16x16x32_bf16 v[56:59], a[100:103], a[28:31], v[56:59]
 buffer_load_dwordx4 v2, s[16:19], s51 offen lds
 v_mfma_f32_16x16x32_bf16 v[56:59], a[96:99], a[24:27], v[56:59]
 v_mfma_f32_16x16x32_bf16 v[192:195], a[96:99], a[32:35], v[192:195]
 v_mfma_f32_16x16x32_bf16 v[192:195], a[100:103], a[36:39], v[192:195]
 v_mfma_f32_16x16x32_bf16 v[196:199], a[108:111], a[36:39], v[196:199]
 s_add_u32 m0, s29, 20480
 v_mfma_f32_16x16x32_bf16 v[196:199], a[104:107], a[32:35], v[196:199]
 buffer_load_dwordx4 v2, s[16:19], s52 offen lds
 v_mfma_f32_16x16x32_bf16 v[200:203], a[112:115], a[32:35], v[200:203]
 v_mfma_f32_16x16x32_bf16 v[200:203], a[116:119], a[36:39], v[200:203]
 v_mfma_f32_16x16x32_bf16 v[204:207], a[124:127], a[36:39], v[204:207]
 v_mfma_f32_16x16x32_bf16 v[204:207], a[120:123], a[32:35], v[204:207]
 s_add_u32 m0, s29, 24576
 v_mfma_f32_16x16x32_bf16 v[212:215], a[120:123], a[40:43], v[212:215]
 buffer_load_dwordx4 v2, s[16:19], s53 offen lds
 v_mfma_f32_16x16x32_bf16 v[212:215], a[124:127], a[44:47], v[212:215]
 v_mfma_f32_16x16x32_bf16 v[208:211], a[116:119], a[44:47], v[208:211]
 v_mfma_f32_16x16x32_bf16 v[208:211], a[112:115], a[40:43], v[208:211]
 v_mfma_f32_16x16x32_bf16 v[220:223], a[104:107], a[40:43], v[220:223]
 s_add_u32 m0, s29, 28672
 v_mfma_f32_16x16x32_bf16 v[220:223], a[108:111], a[44:47], v[220:223]
 buffer_load_dwordx4 v2, s[16:19], s54 offen lds
 v_mfma_f32_16x16x32_bf16 v[216:219], a[100:103], a[44:47], v[216:219]
 v_mfma_f32_16x16x32_bf16 v[216:219], a[96:99], a[40:43], v[216:219]
 v_mfma_f32_16x16x32_bf16 v[224:227], a[96:99], a[48:51], v[224:227]
 s_add_u32 m0, s29, 65536
 v_add_u32 v2, 0x80000, v2
 v_mfma_f32_16x16x32_bf16 v[224:227], a[100:103], a[52:55], v[224:227]
 buffer_load_dwordx4 v2, s[16:19], 0 offen lds
 v_mfma_f32_16x16x32_bf16 v[228:231], a[108:111], a[52:55], v[228:231]
 v_mfma_f32_16x16x32_bf16 v[228:231], a[104:107], a[48:51], v[228:231]
 v_mfma_f32_16x16x32_bf16 v[232:235], a[112:115], a[48:51], v[232:235]
 v_mfma_f32_16x16x32_bf16 v[232:235], a[116:119], a[52:55], v[232:235]
 s_add_u32 m0, s29, 69632
 v_mfma_f32_16x16x32_bf16 v[236:239], a[124:127], a[52:55], v[236:239]
 buffer_load_dwordx4 v2, s[16:19], s48 offen lds
 v_mfma_f32_16x16x32_bf16 v[236:239], a[120:123], a[48:51], v[236:239]
 v_mfma_f32_16x16x32_bf16 v[244:247], a[120:123], a[56:59], v[244:247]
 s_waitcnt vmcnt(10)
 v_mfma_f32_16x16x32_bf16 v[244:247], a[124:127], a[60:63], v[244:247]
 s_barrier
 v_mfma_f32_16x16x32_bf16 v[240:243], a[116:119], a[60:63], v[240:243]
 s_add_u32 m0, s29, 73728
 ds_read_b64_tr_b16 a[0:1], v6 offset:32768
 v_mfma_f32_16x16x32_bf16 v[240:243], a[112:115], a[56:59], v[240:243]
 ds_read_b64_tr_b16 a[2:3], v6 offset:36864
 buffer_load_dwordx4 v2, s[16:19], s49 offen lds
 v_mfma_f32_16x16x32_bf16 v[252:255], a[104:107], a[56:59], v[252:255]
 ds_read_b128 a[192:195], v14 offset:0
 v_mfma_f32_16x16x32_bf16 v[252:255], a[108:111], a[60:63], v[252:255]
 ds_read_b64_tr_b16 a[4:5], v6 offset:49152
 v_mfma_f32_16x16x32_bf16 v[248:251], a[100:103], a[60:63], v[248:251]
 ds_read_b64_tr_b16 a[6:7], v6 offset:53248
 v_mfma_f32_16x16x32_bf16 v[248:251], a[96:99], a[56:59], v[248:251]
 s_add_u32 m0, s29, 77824
 ds_read_b128 a[96:99], v4 offset:40960
 v_mfma_f32_16x16x32_bf16 v[128:131], a[64:67], a[32:35], v[128:131]
 ds_read_b128 a[200:203], v3 offset:0
 buffer_load_dwordx4 v2, s[16:19], s50 offen lds
 v_mfma_f32_16x16x32_bf16 v[128:131], a[68:71], a[36:39], v[128:131]
 ds_read_b128 a[196:199], v14 offset:2048
 v_mfma_f32_16x16x32_bf16 v[132:135], a[76:79], a[36:39], v[132:135]
 s_mov_b32 s56, s58
 ds_read_b128 a[100:103], v5 offset:40960
 v_mfma_f32_16x16x32_bf16 v[132:135], a[72:75], a[32:35], v[132:135]
 ds_read_b128 a[204:207], v3 offset:2048
 v_mfma_f32_16x16x32_bf16 v[136:139], a[80:83], a[32:35], v[136:139]
 s_add_u32 m0, s29, 81920
 ds_read_b128 a[108:111], v5 offset:43008
 v_mfma_f32_16x16x32_bf16 v[136:139], a[84:87], a[36:39], v[136:139]
 ds_read_b128 a[208:211], v14 offset:4096
 buffer_load_dwordx4 v2, s[16:19], s51 offen lds
 v_mfma_f32_16x16x32_bf16 v[140:143], a[92:95], a[36:39], v[140:143]
 ds_read_b128 a[216:219], v3 offset:4096
 v_mfma_f32_16x16x32_bf16 v[140:143], a[88:91], a[32:35], v[140:143]
 ds_read_b128 a[104:107], v4 offset:43008
 v_mfma_f32_16x16x32_bf16 v[148:151], a[88:91], a[40:43], v[148:151]
 ds_read_b128 a[212:215], v14 offset:6144
 v_mfma_f32_16x16x32_bf16 v[148:151], a[92:95], a[44:47], v[148:151]
 s_add_u32 m0, s29, 86016
 ds_read_b128 a[112:115], v4 offset:45056
 v_mfma_f32_16x16x32_bf16 v[144:147], a[84:87], a[44:47], v[144:147]
 ds_read_b128 a[220:223], v3 offset:6144
 buffer_load_dwordx4 v2, s[16:19], s52 offen lds
 v_mfma_f32_16x16x32_bf16 v[144:147], a[80:83], a[40:43], v[144:147]
 v_mfma_f32_16x16x32_bf16 v[156:159], a[72:75], a[40:43], v[156:159]
 s_cmp_lt_u32 s25, 4
 s_cselect_b32 s1, 2.0, s92
 ds_read_b128 a[116:119], v5 offset:45056
 v_mfma_f32_16x16x32_bf16 v[156:159], a[76:79], a[44:47], v[156:159]
 v_mfma_f32_16x16x32_bf16 v[152:155], a[68:71], a[44:47], v[152:155]
 s_add_u32 m0, s29, 90112
 ds_read_b128 a[124:127], v5 offset:47104
 v_mfma_f32_16x16x32_bf16 v[152:155], a[64:67], a[40:43], v[152:155]
 buffer_load_dwordx4 v2, s[16:19], s53 offen lds
 v_mfma_f32_16x16x32_bf16 v[160:163], a[64:67], a[48:51], v[160:163]
 v_mfma_f32_16x16x32_bf16 v[160:163], a[68:71], a[52:55], v[160:163]
 ds_read_b128 a[120:123], v4 offset:47104
 v_mfma_f32_16x16x32_bf16 v[164:167], a[76:79], a[52:55], v[164:167]
 v_mfma_f32_16x16x32_bf16 v[164:167], a[72:75], a[48:51], v[164:167]
 s_add_u32 m0, s29, 94208
 ds_read_b64_tr_b16 a[8:9], v7 offset:32768
 v_mfma_f32_16x16x32_bf16 v[168:171], a[80:83], a[48:51], v[168:171]
 ds_read_b64_tr_b16 a[10:11], v7 offset:36864
 buffer_load_dwordx4 v2, s[16:19], s54 offen lds
 v_mfma_f32_16x16x32_bf16 v[168:171], a[84:87], a[52:55], v[168:171]
 v_mfma_f32_16x16x32_bf16 v[172:175], a[92:95], a[52:55], v[172:175]
 v_mfma_f32_16x16x32_bf16 v[172:175], a[88:91], a[48:51], v[172:175]
 ds_read_b64_tr_b16 a[12:13], v7 offset:49152
 v_mfma_f32_16x16x32_bf16 v[180:183], a[88:91], a[56:59], v[180:183]
 v_mfma_f32_16x16x32_bf16 v[180:183], a[92:95], a[60:63], v[180:183]
 ds_read_b64_tr_b16 a[14:15], v7 offset:53248
 v_mfma_f32_16x16x32_bf16 v[176:179], a[84:87], a[60:63], v[176:179]
 ds_read_b64_tr_b16 a[16:17], v8 offset:32768
 v_mfma_f32_16x16x32_bf16 v[176:179], a[80:83], a[56:59], v[176:179]
 ds_read_b64_tr_b16 a[18:19], v8 offset:36864
 v_mfma_f32_16x16x32_bf16 v[188:191], a[72:75], a[56:59], v[188:191]
 ds_read_b64_tr_b16 a[20:21], v8 offset:49152
 v_mfma_f32_16x16x32_bf16 v[188:191], a[76:79], a[60:63], v[188:191]
 ds_read_b64_tr_b16 a[22:23], v8 offset:53248
 v_mfma_f32_16x16x32_bf16 v[184:187], a[68:71], a[60:63], v[184:187]
 ds_read_b64_tr_b16 a[24:25], v9 offset:32768
 v_mfma_f32_16x16x32_bf16 v[184:187], a[64:67], a[56:59], v[184:187]
 s_waitcnt lgkmcnt(15)
 ds_read_b64_tr_b16 a[26:27], v9 offset:36864
 s_cmp_ge_u32 s25, 4
 s_cbranch_scc1 L_late1
 v_mfma_f32_16x16x32_bf16 v[16:19], a[96:99], a[0:3], v[16:19]
 ds_read_b64_tr_b16 a[28:29], v9 offset:49152
 v_mfma_f32_16x16x32_bf16 v[16:19], a[100:103], a[4:7], v[16:19]
 s_add_u32 m0, s33, 0xfffffd00
 ds_read_b64_tr_b16 a[30:31], v9 offset:53248
 v_mfma_f32_16x16x32_bf16 v[20:23], a[108:111], a[4:7], v[20:23]
 s_waitcnt lgkmcnt(15)
 ds_read_b128 a[64:67], v4 offset:32768
 v_mfma_f32_16x16x32_bf16 v[20:23], a[104:107], a[0:3], v[20:23]
 buffer_load_dwordx4 v15, s[20:23], 0 offen offset:768 lds
 v_mfma_f32_16x16x32_bf16 v[24:27], a[112:115], a[0:3], v[24:27]
 s_waitcnt lgkmcnt(13)
 ds_read_b128 a[68:71], v5 offset:32768
 v_mfma_f32_16x16x32_bf16 v[24:27], a[116:119], a[4:7], v[24:27]
 v_mfma_f32_16x16x32_bf16 v[28:31], a[124:127], a[4:7], v[28:31]
 s_add_u32 m0, s33, 0xfffffd80
 ds_read_b128 a[76:79], v5 offset:34816
 v_mfma_f32_16x16x32_bf16 v[28:31], a[120:123], a[0:3], v[28:31]
 s_waitcnt lgkmcnt(11)
 buffer_load_dwordx4 v15, s[20:23], 0 offen offset:1664 lds
 v_mfma_f32_16x16x32_bf16 a[228:231], a[120:123], a[8:11], a[228:231]
 ds_read_b128 a[72:75], v4 offset:34816
 v_mfma_f32_16x16x32_bf16 a[228:231], a[124:127], a[12:15], a[228:231]
 v_mfma_f32_16x16x32_bf16 a[224:227], a[116:119], a[12:15], a[224:227]
 s_add_u32 m0, s33, 0x500
 ds_read_b128 a[80:83], v4 offset:36864
 v_mfma_f32_16x16x32_bf16 a[224:227], a[112:115], a[8:11], a[224:227]
 buffer_load_dwordx4 v15, s[20:23], s57 offen offset:768 lds
 v_mfma_f32_16x16x32_bf16 a[236:239], a[104:107], a[8:11], a[236:239]
 ds_read_b128 a[84:87], v5 offset:36864
 v_cvt_pk_bf16_f32 v16, v16, v17
 v_mfma_f32_16x16x32_bf16 a[236:239], a[108:111], a[12:15], a[236:239]
 v_cvt_pk_bf16_f32 v17, v18, v19
 v_cvt_pk_bf16_f32 v18, v20, v21
 v_mfma_f32_16x16x32_bf16 a[232:235], a[100:103], a[12:15], a[232:235]
 s_add_u32 m0, s33, 0x580
 ds_read_b128 a[92:95], v5 offset:38912
 v_cvt_pk_bf16_f32 v19, v22, v23
 v_mfma_f32_16x16x32_bf16 a[232:235], a[96:99], a[8:11], a[232:235]
 s_waitcnt lgkmcnt(11)
 buffer_load_dwordx4 v15, s[20:23], s57 offen offset:1664 lds
 v_mfma_f32_16x16x32_bf16 v[32:35], a[96:99], a[16:19], v[32:35]
 ds_read_b128 a[88:91], v4 offset:38912
 v_cvt_pk_bf16_f32 v24, v24, v25
 v_mfma_f32_16x16x32_bf16 v[32:35], a[100:103], a[20:23], v[32:35]
 v_cvt_pk_bf16_f32 v25, v26, v27
 v_cvt_pk_bf16_f32 v26, v28, v29
 v_mfma_f32_16x16x32_bf16 v[36:39], a[108:111], a[20:23], v[36:39]
 ds_read_b64_tr_b16 a[32:33], v10 offset:32768
 v_cvt_pk_bf16_f32 v27, v30, v31
 v_mfma_f32_16x16x32_bf16 v[36:39], a[104:107], a[16:19], v[36:39]
 ds_read_b64_tr_b16 a[34:35], v10 offset:36864
 v_accvgpr_read_b32 v20, a224
 v_mfma_f32_16x16x32_bf16 v[40:43], a[112:115], a[16:19], v[40:43]
 ds_read_b64_tr_b16 a[36:37], v10 offset:49152
 v_accvgpr_read_b32 v21, a225
 v_mfma_f32_16x16x32_bf16 v[40:43], a[116:119], a[20:23], v[40:43]
 ds_read_b64_tr_b16 a[38:39], v10 offset:53248
 v_accvgpr_read_b32 v22, a226
 v_mfma_f32_16x16x32_bf16 v[44:47], a[124:127], a[20:23], v[44:47]
 s_add_u32 s59, s56, 32768
 ds_read_b64_tr_b16 a[40:41], v11 offset:32768
 v_accvgpr_read_b32 v23, a227
 v_mfma_f32_16x16x32_bf16 v[44:47], a[120:123], a[16:19], v[44:47]
 s_waitcnt lgkmcnt(13)
 ds_read_b64_tr_b16 a[42:43], v11 offset:36864
 v_accvgpr_read_b32 v28, a228
 v_mfma_f32_16x16x32_bf16 v[52:55], a[120:123], a[24:27], v[52:55]
 ds_read_b64_tr_b16 a[44:45], v11 offset:49152
 buffer_store_dwordx4 v[16:19], v1, s[12:15], s59 offen offset:0 sc1
 v_mfma_f32_16x16x32_bf16 v[52:55], a[124:127], a[28:31], v[52:55]
 ds_read_b64_tr_b16 a[46:47], v11 offset:53248
 v_accvgpr_read_b32 v29, a229
 v_mfma_f32_16x16x32_bf16 v[48:51], a[116:119], a[28:31], v[48:51]
 ds_read_b64_tr_b16 a[48:49], v12 offset:32768
 v_accvgpr_read_b32 v30, a230
 v_mfma_f32_16x16x32_bf16 v[48:51], a[112:115], a[24:27], v[48:51]
 ds_read_b64_tr_b16 a[50:51], v12 offset:36864
 v_accvgpr_read_b32 v31, a231
 v_mfma_f32_16x16x32_bf16 v[60:63], a[104:107], a[24:27], v[60:63]
 ds_read_b64_tr_b16 a[52:53], v12 offset:49152
 v_cvt_pk_bf16_f32 v20, v20, v21
 v_mfma_f32_16x16x32_bf16 v[60:63], a[108:111], a[28:31], v[60:63]
 ds_read_b64_tr_b16 a[54:55], v12 offset:53248
 v_cvt_pk_bf16_f32 v21, v22, v23
 v_mfma_f32_16x16x32_bf16 v[56:59], a[100:103], a[28:31], v[56:59]
 s_add_u32 s59, s56, 49152
 ds_read_b64_tr_b16 a[56:57], v13 offset:32768
 v_cvt_pk_bf16_f32 v22, v28, v29
 v_mfma_f32_16x16x32_bf16 v[56:59], a[96:99], a[24:27], v[56:59]
 s_waitcnt lgkmcnt(15)
 ds_read_b64_tr_b16 a[58:59], v13 offset:36864
 buffer_store_dwordx4 v[24:27], v1, s[12:15], s59 offen offset:0 sc1
 v_mfma_f32_16x16x32_bf16 v[64:67], a[64:67], a[0:3], v[64:67]
 ds_read_b64_tr_b16 a[60:61], v13 offset:49152
 v_cvt_pk_bf16_f32 v23, v30, v31
 v_mfma_f32_16x16x32_bf16 v[64:67], a[68:71], a[4:7], v[64:67]
 ds_read_b64_tr_b16 a[62:63], v13 offset:53248
 v_cvt_pk_bf16_f32 v32, v32, v33
 v_mfma_f32_16x16x32_bf16 v[68:71], a[76:79], a[4:7], v[68:71]
 v_cvt_pk_bf16_f32 v33, v34, v35
 v_cvt_pk_bf16_f32 v34, v36, v37
 v_mfma_f32_16x16x32_bf16 v[68:71], a[72:75], a[0:3], v[68:71]
 v_cvt_pk_bf16_f32 v35, v38, v39
 v_cvt_pk_bf16_f32 v40, v40, v41
 v_mfma_f32_16x16x32_bf16 v[72:75], a[80:83], a[0:3], v[72:75]
 s_add_u32 s59, s56, 49152
 v_cvt_pk_bf16_f32 v41, v42, v43
 v_cvt_pk_bf16_f32 v42, v44, v45
 v_mfma_f32_16x16x32_bf16 v[72:75], a[84:87], a[4:7], v[72:75]
 s_waitcnt lgkmcnt(15)
 v_cvt_pk_bf16_f32 v43, v46, v47
 v_accvgpr_read_b32 v36, a232
 v_mfma_f32_16x16x32_bf16 v[76:79], a[92:95], a[4:7], v[76:79]
 buffer_store_dwordx4 v[20:23], v1, s[12:15], s59 offen offset:1024 sc1
 v_mfma_f32_16x16x32_bf16 v[76:79], a[88:91], a[0:3], v[76:79]
 s_waitcnt lgkmcnt(0)
 v_accvgpr_read_b32 v37, a233
 v_accvgpr_read_b32 v38, a234
 v_mfma_f32_16x16x32_bf16 v[84:87], a[88:91], a[8:11], v[84:87]
 s_barrier
 v_xor_b32 v6, s60, v6
 v_accvgpr_read_b32 v39, a235
 v_mfma_f32_16x16x32_bf16 v[84:87], a[92:95], a[12:15], v[84:87]
 s_add_u32 m0, s29, 32768
 v_add_u32 v2, 0x80000, v2
 v_accvgpr_read_b32 v44, a236
 v_mfma_f32_16x16x32_bf16 v[80:83], a[84:87], a[12:15], v[80:83]
 buffer_load_dwordx4 v2, s[16:19], 0 offen lds
 v_mfma_f32_16x16x32_bf16 v[80:83], a[80:83], a[8:11], v[80:83]
 v_accvgpr_read_b32 v45, a237
 v_accvgpr_read_b32 v46, a238
 v_mfma_f32_16x16x32_bf16 v[92:95], a[72:75], a[8:11], v[92:95]
 s_add_u32 s59, s56, 32768
 v_accvgpr_read_b32 v47, a239
 v_cvt_pk_bf16_f32 v36, v36, v37
 v_mfma_f32_16x16x32_bf16 v[92:95], a[76:79], a[12:15], v[92:95]
 buffer_store_dwordx4 v[32:35], v1, s[12:15], s59 offen offset:2048 sc1
 v_mfma_f32_16x16x32_bf16 v[88:91], a[68:71], a[12:15], v[88:91]
 s_add_u32 m0, s29, 36864
 v_cvt_pk_bf16_f32 v37, v38, v39
 v_cvt_pk_bf16_f32 v38, v44, v45
 v_mfma_f32_16x16x32_bf16 v[88:91], a[64:67], a[8:11], v[88:91]
 buffer_load_dwordx4 v2, s[16:19], s48 offen lds
 v_mfma_f32_16x16x32_bf16 v[96:99], a[64:67], a[16:19], v[96:99]
 v_cvt_pk_bf16_f32 v39, v46, v47
 v_cvt_pk_bf16_f32 v48, v48, v49
 v_mfma_f32_16x16x32_bf16 v[96:99], a[68:71], a[20:23], v[96:99]
 v_cvt_pk_bf16_f32 v49, v50, v51
 v_cvt_pk_bf16_f32 v50, v52, v53
 v_mfma_f32_16x16x32_bf16 v[100:103], a[76:79], a[20:23], v[100:103]
 v_cvt_pk_bf16_f32 v51, v54, v55
 v_cvt_pk_bf16_f32 v56, v56, v57
 v_mfma_f32_16x16x32_bf16 v[100:103], a[72:75], a[16:19], v[100:103]
 s_add_u32 m0, s29, 40960
 v_cvt_pk_bf16_f32 v57, v58, v59
 v_cvt_pk_bf16_f32 v58, v60, v61
 v_mfma_f32_16x16x32_bf16 v[104:107], a[80:83], a[16:19], v[104:107]
 buffer_load_dwordx4 v2, s[16:19], s49 offen lds
 v_mfma_f32_16x16x32_bf16 v[104:107], a[84:87], a[20:23], v[104:107]
 s_add_u32 s59, s56, 49152
 v_cvt_pk_bf16_f32 v59, v62, v63
 v_cvt_pk_bf16_f32 v64, v64, v65
 v_mfma_f32_16x16x32_bf16 v[108:111], a[92:95], a[20:23], v[108:111]
 buffer_store_dwordx4 v[40:43], v1, s[12:15], s59 offen offset:2048 sc1
 v_mfma_f32_16x16x32_bf16 v[108:111], a[88:91], a[16:19], v[108:111]
 v_cvt_pk_bf16_f32 v65, v66, v67
 v_cvt_pk_bf16_f32 v66, v68, v69
 v_mfma_f32_16x16x32_bf16 v[116:119], a[88:91], a[24:27], v[116:119]
 s_add_u32 m0, s29, 45056
 v_cvt_pk_bf16_f32 v67, v70, v71
 v_cvt_pk_bf16_f32 v72, v72, v73
 v_mfma_f32_16x16x32_bf16 v[116:119], a[92:95], a[28:31], v[116:119]
 buffer_load_dwordx4 v2, s[16:19], s50 offen lds
 v_mfma_f32_16x16x32_bf16 v[112:115], a[84:87], a[28:31], v[112:115]
 v_cvt_pk_bf16_f32 v73, v74, v75
 v_cvt_pk_bf16_f32 v74, v76, v77
 v_mfma_f32_16x16x32_bf16 v[112:115], a[80:83], a[24:27], v[112:115]
 v_cvt_pk_bf16_f32 v75, v78, v79
 v_cvt_pk_bf16_f32 v80, v80, v81
 v_mfma_f32_16x16x32_bf16 v[124:127], a[72:75], a[24:27], v[124:127]
 v_cvt_pk_bf16_f32 v81, v82, v83
 v_cvt_pk_bf16_f32 v82, v84, v85
 v_mfma_f32_16x16x32_bf16 v[124:127], a[76:79], a[28:31], v[124:127]
 s_add_u32 m0, s29, 49152
 v_cvt_pk_bf16_f32 v83, v86, v87
 v_cvt_pk_bf16_f32 v88, v88, v89
 v_mfma_f32_16x16x32_bf16 v[120:123], a[68:71], a[28:31], v[120:123]
 buffer_load_dwordx4 v2, s[16:19], s51 offen lds
 v_mfma_f32_16x16x32_bf16 v[120:123], a[64:67], a[24:27], v[120:123]
 s_add_u32 s59, s56, 32768
 v_cvt_pk_bf16_f32 v89, v90, v91
 v_cvt_pk_bf16_f32 v90, v92, v93
 v_mfma_f32_16x16x32_bf16 v[128:131], a[64:67], a[32:35], v[128:131]
 buffer_store_dwordx4 v[36:39], v1, s[12:15], s59 offen offset:1024 sc1
 v_mfma_f32_16x16x32_bf16 v[128:131], a[68:71], a[36:39], v[128:131]
 v_cvt_pk_bf16_f32 v91, v94, v95
 v_cvt_pk_bf16_f32 v96, v96, v97
 v_mfma_f32_16x16x32_bf16 v[132:135], a[76:79], a[36:39], v[132:135]
 s_add_u32 m0, s29, 53248
 v_cvt_pk_bf16_f32 v97, v98, v99
 v_cvt_pk_bf16_f32 v98, v100, v101
 v_mfma_f32_16x16x32_bf16 v[132:135], a[72:75], a[32:35], v[132:135]
 buffer_load_dwordx4 v2, s[16:19], s52 offen lds
 v_mfma_f32_16x16x32_bf16 v[136:139], a[80:83], a[32:35], v[136:139]
 v_cvt_pk_bf16_f32 v99, v102, v103
 v_cvt_pk_bf16_f32 v104, v104, v105
 v_mfma_f32_16x16x32_bf16 v[136:139], a[84:87], a[36:39], v[136:139]
 v_cvt_pk_bf16_f32 v105, v106, v107
 v_cvt_pk_bf16_f32 v106, v108, v109
 v_mfma_f32_16x16x32_bf16 v[140:143], a[92:95], a[36:39], v[140:143]
 v_cvt_pk_bf16_f32 v107, v110, v111
 v_cvt_pk_bf16_f32 v112, v112, v113
 v_mfma_f32_16x16x32_bf16 v[140:143], a[88:91], a[32:35], v[140:143]
 s_add_u32 m0, s29, 57344
 v_cvt_pk_bf16_f32 v113, v114, v115
 v_cvt_pk_bf16_f32 v114, v116, v117
 v_mfma_f32_16x16x32_bf16 v[148:151], a[88:91], a[40:43], v[148:151]
 buffer_load_dwordx4 v2, s[16:19], s53 offen lds
 v_mfma_f32_16x16x32_bf16 v[148:151], a[92:95], a[44:47], v[148:151]
 s_add_u32 s59, s56, 49152
 v_cvt_pk_bf16_f32 v115, v118, v119
 v_cvt_pk_bf16_f32 v120, v120, v121
 v_mfma_f32_16x16x32_bf16 v[144:147], a[84:87], a[44:47], v[144:147]
 buffer_store_dwordx4 v[48:51], v1, s[12:15], s59 offen offset:3072 sc1
 v_mfma_f32_16x16x32_bf16 v[144:147], a[80:83], a[40:43], v[144:147]
 v_cvt_pk_bf16_f32 v121, v122, v123
 v_cvt_pk_bf16_f32 v122, v124, v125
 v_mfma_f32_16x16x32_bf16 v[156:159], a[72:75], a[40:43], v[156:159]
 s_add_u32 m0, s29, 61440
 v_cvt_pk_bf16_f32 v123, v126, v127
 v_cvt_pk_bf16_f32 v128, v128, v129
 v_mfma_f32_16x16x32_bf16 v[156:159], a[76:79], a[44:47], v[156:159]
 buffer_load_dwordx4 v2, s[16:19], s54 offen lds
 v_mfma_f32_16x16x32_bf16 v[152:155], a[68:71], a[44:47], v[152:155]
 v_cvt_pk_bf16_f32 v129, v130, v131
 v_cvt_pk_bf16_f32 v130, v132, v133
 v_mfma_f32_16x16x32_bf16 v[152:155], a[64:67], a[40:43], v[152:155]
 v_cvt_pk_bf16_f32 v131, v134, v135
 v_cvt_pk_bf16_f32 v136, v136, v137
 v_mfma_f32_16x16x32_bf16 v[160:163], a[64:67], a[48:51], v[160:163]
 s_add_u32 m0, s29, 98304
 v_add_u32 v2, 0x80000, v2
 v_cvt_pk_bf16_f32 v137, v138, v139
 v_mfma_f32_16x16x32_bf16 v[160:163], a[68:71], a[52:55], v[160:163]
 buffer_load_dwordx4 v2, s[16:19], 0 offen lds
 v_mfma_f32_16x16x32_bf16 v[164:167], a[76:79], a[52:55], v[164:167]
 s_add_u32 s59, s56, 32768
 v_cvt_pk_bf16_f32 v138, v140, v141
 v_cvt_pk_bf16_f32 v139, v142, v143
 v_mfma_f32_16x16x32_bf16 v[164:167], a[72:75], a[48:51], v[164:167]
 buffer_store_dwordx4 v[56:59], v1, s[12:15], s59 offen offset:3072 sc1
 v_mfma_f32_16x16x32_bf16 v[168:171], a[80:83], a[48:51], v[168:171]
 v_cvt_pk_bf16_f32 v144, v144, v145
 v_cvt_pk_bf16_f32 v145, v146, v147
 v_mfma_f32_16x16x32_bf16 v[168:171], a[84:87], a[52:55], v[168:171]
 s_add_u32 m0, s29, 102400
 v_cvt_pk_bf16_f32 v146, v148, v149
 v_cvt_pk_bf16_f32 v147, v150, v151
 v_mfma_f32_16x16x32_bf16 v[172:175], a[92:95], a[52:55], v[172:175]
 buffer_load_dwordx4 v2, s[16:19], s48 offen lds
 v_mfma_f32_16x16x32_bf16 v[172:175], a[88:91], a[48:51], v[172:175]
 v_cvt_pk_bf16_f32 v152, v152, v153
 v_cvt_pk_bf16_f32 v153, v154, v155
 v_mfma_f32_16x16x32_bf16 v[180:183], a[88:91], a[56:59], v[180:183]
 v_cvt_pk_bf16_f32 v154, v156, v157
 v_cvt_pk_bf16_f32 v155, v158, v159
 v_mfma_f32_16x16x32_bf16 v[180:183], a[92:95], a[60:63], v[180:183]
 v_mfma_f32_16x16x32_bf16 v[176:179], a[84:87], a[60:63], v[176:179]
 s_add_u32 m0, s29, 106496
 v_mfma_f32_16x16x32_bf16 v[176:179], a[80:83], a[56:59], v[176:179]
 buffer_load_dwordx4 v2, s[16:19], s49 offen lds
 v_mfma_f32_16x16x32_bf16 v[188:191], a[72:75], a[56:59], v[188:191]
 s_add_u32 s59, s56, 0
 v_cvt_pk_bf16_f32 v160, v160, v161
 v_cvt_pk_bf16_f32 v161, v162, v163
 v_mfma_f32_16x16x32_bf16 v[188:191], a[76:79], a[60:63], v[188:191]
 buffer_store_dwordx4 v[64:67], v1, s[12:15], s59 offen offset:0 sc1
 v_mfma_f32_16x16x32_bf16 v[184:187], a[68:71], a[60:63], v[184:187]
 v_cvt_pk_bf16_f32 v162, v164, v165
 v_cvt_pk_bf16_f32 v163, v166, v167
 v_mfma_f32_16x16x32_bf16 v[184:187], a[64:67], a[56:59], v[184:187]
 s_add_u32 m0, s29, 110592
 v_cvt_pk_bf16_f32 v168, v168, v169
 v_cvt_pk_bf16_f32 v169, v170, v171
 v_mfma_f32_16x16x32_bf16 v[192:195], a[96:99], a[32:35], v[192:195]
 buffer_load_dwordx4 v2, s[16:19], s50 offen lds
 v_mfma_f32_16x16x32_bf16 v[192:195], a[100:103], a[36:39], v[192:195]
 v_cvt_pk_bf16_f32 v170, v172, v173
 v_cvt_pk_bf16_f32 v171, v174, v175
 v_mfma_f32_16x16x32_bf16 v[196:199], a[108:111], a[36:39], v[196:199]
 v_mfma_f32_16x16x32_bf16 v[196:199], a[104:107], a[32:35], v[196:199]
 v_cvt_pk_bf16_f32 v176, v176, v177
 v_cvt_pk_bf16_f32 v177, v178, v179
 v_mfma_f32_16x16x32_bf16 v[200:203], a[112:115], a[32:35], v[200:203]
 s_add_u32 m0, s29, 114688
 v_cvt_pk_bf16_f32 v178, v180, v181
 v_cvt_pk_bf16_f32 v179, v182, v183
 v_mfma_f32_16x16x32_bf16 v[200:203], a[116:119], a[36:39], v[200:203]
 buffer_load_dwordx4 v2, s[16:19], s51 offen lds
 v_mfma_f32_16x16x32_bf16 v[204:207], a[124:127], a[36:39], v[204:207]
 s_add_u32 s59, s56, 16384
 v_mfma_f32_16x16x32_bf16 v[204:207], a[120:123], a[32:35], v[204:207]
 buffer_store_dwordx4 v[72:75], v1, s[12:15], s59 offen offset:0 sc1
 v_mfma_f32_16x16x32_bf16 v[212:215], a[120:123], a[40:43], v[212:215]
 v_cvt_pk_bf16_f32 v184, v184, v185
 v_cvt_pk_bf16_f32 v185, v186, v187
 v_mfma_f32_16x16x32_bf16 v[212:215], a[124:127], a[44:47], v[212:215]
 s_add_u32 m0, s29, 118784
 v_cvt_pk_bf16_f32 v186, v188, v189
 v_cvt_pk_bf16_f32 v187, v190, v191
 v_mfma_f32_16x16x32_bf16 v[208:211], a[116:119], a[44:47], v[208:211]
 buffer_load_dwordx4 v2, s[16:19], s52 offen lds
 v_mfma_f32_16x16x32_bf16 v[208:211], a[112:115], a[40:43], v[208:211]
 v_cvt_pk_bf16_f32 v192, v192, v193
 v_cvt_pk_bf16_f32 v193, v194, v195
 v_mfma_f32_16x16x32_bf16 v[220:223], a[104:107], a[40:43], v[220:223]
 v_cvt_pk_bf16_f32 v194, v196, v197
 v_cvt_pk_bf16_f32 v195, v198, v199
 v_mfma_f32_16x16x32_bf16 v[220:223], a[108:111], a[44:47], v[220:223]
 v_mfma_f32_16x16x32_bf16 v[216:219], a[100:103], a[44:47], v[216:219]
 s_add_u32 m0, s29, 122880
 v_mfma_f32_16x16x32_bf16 v[216:219], a[96:99], a[40:43], v[216:219]
 buffer_load_dwordx4 v2, s[16:19], s53 offen lds
 v_mfma_f32_16x16x32_bf16 v[224:227], a[96:99], a[48:51], v[224:227]
 s_add_u32 s59, s56, 16384
 v_cvt_pk_bf16_f32 v200, v200, v201
 v_cvt_pk_bf16_f32 v201, v202, v203
 v_mfma_f32_16x16x32_bf16 v[224:227], a[100:103], a[52:55], v[224:227]
 s_waitcnt vmcnt(25)
 buffer_store_dwordx4 v[80:83], v1, s[12:15], s59 offen offset:1024 sc1
 v_mfma_f32_16x16x32_bf16 v[228:231], a[108:111], a[52:55], v[228:231]
 s_barrier
 v_xor_b32 v7, 0, v6
 v_cvt_pk_bf16_f32 v202, v204, v205
 v_mfma_f32_16x16x32_bf16 v[228:231], a[104:107], a[48:51], v[228:231]
 s_add_u32 m0, s29, 126976
 ds_read_b64_tr_b16 a[64:65], v7 offset:0
 v_cvt_pk_bf16_f32 v203, v206, v207
 v_mfma_f32_16x16x32_bf16 v[232:235], a[112:115], a[48:51], v[232:235]
 ds_read_b64_tr_b16 a[66:67], v7 offset:4096
 buffer_load_dwordx4 v2, s[16:19], s54 offen lds
 v_mfma_f32_16x16x32_bf16 v[232:235], a[116:119], a[52:55], v[232:235]
 ds_read_b64_tr_b16 a[68:69], v7 offset:16384
 v_cvt_pk_bf16_f32 v208, v208, v209
 v_mfma_f32_16x16x32_bf16 v[236:239], a[124:127], a[52:55], v[236:239]
 ds_read_b64_tr_b16 a[70:71], v7 offset:20480
 v_xor_b32 v8, 65536, v6
 v_mfma_f32_16x16x32_bf16 v[236:239], a[120:123], a[48:51], v[236:239]
 s_add_u32 s59, s56, 0
 ds_read_b64_tr_b16 a[72:73], v8 offset:0
 v_cvt_pk_bf16_f32 v209, v210, v211
 v_mfma_f32_16x16x32_bf16 v[244:247], a[120:123], a[56:59], v[244:247]
 ds_read_b64_tr_b16 a[74:75], v8 offset:4096
 buffer_store_dwordx4 v[88:91], v1, s[12:15], s59 offen offset:1024 sc1
 v_mfma_f32_16x16x32_bf16 v[244:247], a[124:127], a[60:63], v[244:247]
 ds_read_b64_tr_b16 a[76:77], v8 offset:16384
 v_cvt_pk_bf16_f32 v210, v212, v213
 v_mfma_f32_16x16x32_bf16 v[240:243], a[116:119], a[60:63], v[240:243]
 ds_read_b64_tr_b16 a[78:79], v8 offset:20480
 v_xor_b32 v9, 32, v6
 v_mfma_f32_16x16x32_bf16 v[240:243], a[112:115], a[56:59], v[240:243]
 ds_read_b64_tr_b16 a[80:81], v9 offset:0
 v_cvt_pk_bf16_f32 v211, v214, v215
 v_mfma_f32_16x16x32_bf16 v[252:255], a[104:107], a[56:59], v[252:255]
 ds_read_b64_tr_b16 a[82:83], v9 offset:4096
 v_cvt_pk_bf16_f32 v216, v216, v217
 v_mfma_f32_16x16x32_bf16 v[252:255], a[108:111], a[60:63], v[252:255]
 ds_read_b64_tr_b16 a[84:85], v9 offset:16384
 v_cvt_pk_bf16_f32 v217, v218, v219
 v_mfma_f32_16x16x32_bf16 v[248:251], a[100:103], a[60:63], v[248:251]
 s_add_u32 s59, s56, 0
 ds_read_b64_tr_b16 a[86:87], v9 offset:20480
 v_xor_b32 v10, 65568, v6
 v_mfma_f32_16x16x32_bf16 v[248:251], a[96:99], a[56:59], v[248:251]
 s_waitcnt lgkmcnt(6)
 ds_read_b64_tr_b16 a[88:89], v10 offset:0
 buffer_store_dwordx4 v[96:99], v1, s[12:15], s59 offen offset:2048 sc1
 v_mfma_f32_16x16x32_bf16 v[28:31], a[64:67], a[128:131], 0
 ds_read_b64_tr_b16 a[90:91], v10 offset:4096
 v_cvt_pk_bf16_f32 v218, v220, v221
 v_mfma_f32_16x16x32_bf16 v[28:31], a[68:71], a[136:139], v[28:31]
 ds_read_b64_tr_b16 a[92:93], v10 offset:16384
 v_xor_b32 v7, 64, v6
 v_mfma_f32_16x16x32_bf16 v[28:31], a[72:75], a[144:147], v[28:31]
 s_waitcnt lgkmcnt(7)
 ds_read_b128 a[112:115], v14 offset:0
 ds_read_b64_tr_b16 a[94:95], v10 offset:20480
 v_mfma_f32_16x16x32_bf16 v[28:31], a[76:79], a[152:155], v[28:31]
 ds_read_b64_tr_b16 a[96:97], v7 offset:0
 v_cvt_pk_bf16_f32 v219, v222, v223
 v_mfma_f32_16x16x32_bf16 v[44:47], a[64:67], a[132:135], 0
 ds_read_b128 a[120:123], v3 offset:0
 ds_read_b64_tr_b16 a[98:99], v7 offset:4096
 v_mfma_f32_16x16x32_bf16 v[44:47], a[68:71], a[140:143], v[44:47]
 s_add_u32 s59, s56, 16384
 ds_read_b64_tr_b16 a[100:101], v7 offset:16384
 v_xor_b32 v8, 65600, v6
 v_mfma_f32_16x16x32_bf16 v[44:47], a[72:75], a[148:151], v[44:47]
 ds_read_b128 a[116:119], v14 offset:2048
 ds_read_b64_tr_b16 a[102:103], v7 offset:20480
 buffer_store_dwordx4 v[104:107], v1, s[12:15], s59 offen offset:2048 sc1
 v_mfma_f32_16x16x32_bf16 v[44:47], a[76:79], a[156:159], v[44:47]
 s_waitcnt lgkmcnt(9)
 ds_read_b64_tr_b16 a[104:105], v8 offset:0
 v_cvt_pk_bf16_f32 v224, v224, v225
 v_mfma_f32_16x16x32_bf16 v[52:55], a[80:83], a[128:131], 0
 ds_read_b128 a[124:127], v3 offset:2048
 ds_read_b64_tr_b16 a[106:107], v8 offset:4096
 v_mfma_f32_16x16x32_bf16 v[52:55], a[84:87], a[136:139], v[52:55]
 ds_read_b64_tr_b16 a[108:109], v8 offset:16384
 v_cvt_pk_bf16_f32 v225, v226, v227
 v_mfma_f32_16x16x32_bf16 v[52:55], a[88:91], a[144:147], v[52:55]
 s_waitcnt lgkmcnt(10)
 ds_read_b64_tr_b16 a[110:111], v8 offset:20480
 v_xor_b32 v9, 96, v6
 v_mfma_f32_16x16x32_bf16 v[52:55], a[92:95], a[152:155], v[52:55]
 ds_read_b64_tr_b16 a[64:65], v9 offset:0
 v_cvt_pk_bf16_f32 v226, v228, v229
 v_mfma_f32_16x16x32_bf16 v[60:63], a[80:83], a[132:135], 0
 s_add_u32 s59, s56, 16384
 ds_read_b64_tr_b16 a[66:67], v9 offset:4096
 v_cvt_pk_bf16_f32 v227, v230, v231
 v_mfma_f32_16x16x32_bf16 v[60:63], a[84:87], a[140:143], v[60:63]
 ds_read_b64_tr_b16 a[68:69], v9 offset:16384
 buffer_store_dwordx4 v[112:115], v1, s[12:15], s59 offen offset:3072 sc1
 v_mfma_f32_16x16x32_bf16 v[60:63], a[88:91], a[148:151], v[60:63]
 ds_read_b64_tr_b16 a[70:71], v9 offset:20480
 v_xor_b32 v10, 65632, v6
 v_mfma_f32_16x16x32_bf16 v[60:63], a[92:95], a[156:159], v[60:63]
 s_waitcnt lgkmcnt(6)
 ds_read_b64_tr_b16 a[72:73], v10 offset:0
 v_cvt_pk_bf16_f32 v232, v232, v233
 v_mfma_f32_16x16x32_bf16 v[20:23], a[96:99], a[128:131], 0
 ds_read_b64_tr_b16 a[74:75], v10 offset:4096
 v_cvt_pk_bf16_f32 v233, v234, v235
 v_mfma_f32_16x16x32_bf16 v[20:23], a[100:103], a[136:139], v[20:23]
 s_waitcnt lgkmcnt(8)
 ds_read_b64_tr_b16 a[76:77], v10 offset:16384
 v_xor_b32 v7, 128, v6
 v_mfma_f32_16x16x32_bf16 v[20:23], a[104:107], a[144:147], v[20:23]
 s_waitcnt lgkmcnt(7)
 s_barrier
 ds_read_b64_tr_b16 a[78:79], v10 offset:20480
 v_mfma_f32_16x16x32_bf16 v[20:23], a[108:111], a[152:155], v[20:23]
 s_add_u32 m0, s29, 131072
 ds_read_b64_tr_b16 a[80:81], v7 offset:0
 v_add_u32 v2, 0x80000, v2
 v_mfma_f32_16x16x32_bf16 v[36:39], a[96:99], a[132:135], 0
 ds_read_b64_tr_b16 a[82:83], v7 offset:4096
 buffer_load_dwordx4 v2, s[16:19], 0 offen lds
 v_mfma_f32_16x16x32_bf16 v[36:39], a[100:103], a[140:143], v[36:39]
 ds_read_b64_tr_b16 a[84:85], v7 offset:16384
 v_cvt_pk_bf16_f32 v234, v236, v237
 v_mfma_f32_16x16x32_bf16 v[36:39], a[104:107], a[148:151], v[36:39]
 s_add_u32 s59, s56, 0
 ds_read_b64_tr_b16 a[86:87], v7 offset:20480
 v_xor_b32 v8, 65664, v6
 v_mfma_f32_16x16x32_bf16 v[36:39], a[108:111], a[156:159], v[36:39]
 s_waitcnt lgkmcnt(6)
 ds_read_b64_tr_b16 a[88:89], v8 offset:0
 buffer_store_dwordx4 v[120:123], v1, s[12:15], s59 offen offset:3072 sc1
 v_mfma_f32_16x16x32_bf16 v[68:71], a[64:67], a[128:131], 0
 ds_read_b64_tr_b16 a[90:91], v8 offset:4096
 v_cvt_pk_bf16_f32 v235, v238, v239
 v_mfma_f32_16x16x32_bf16 v[68:71], a[68:71], a[136:139], v[68:71]
 s_add_u32 m0, s29, 135168
 ds_read_b64_tr_b16 a[92:93], v8 offset:16384
 v_cvt_pk_bf16_f32 v240, v240, v241
 v_mfma_f32_16x16x32_bf16 v[68:71], a[72:75], a[144:147], v[68:71]
 s_waitcnt lgkmcnt(7)
 ds_read_b64_tr_b16 a[94:95], v8 offset:20480
 v_xor_b32 v9, 160, v6
 v_mfma_f32_16x16x32_bf16 v[68:71], a[76:79], a[152:155], v[68:71]
 ds_read_b64_tr_b16 a[96:97], v9 offset:0
 buffer_load_dwordx4 v2, s[16:19], s48 offen lds
 v_mfma_f32_16x16x32_bf16 v[76:79], a[64:67], a[132:135], 0
 ds_read_b64_tr_b16 a[98:99], v9 offset:4096
 v_cvt_pk_bf16_f32 v241, v242, v243
 v_mfma_f32_16x16x32_bf16 v[76:79], a[68:71], a[140:143], v[76:79]
 ds_read_b64_tr_b16 a[100:101], v9 offset:16384
 v_cvt_pk_bf16_f32 v242, v244, v245
 v_mfma_f32_16x16x32_bf16 v[76:79], a[72:75], a[148:151], v[76:79]
 s_add_u32 s59, s56, 4096
 ds_read_b64_tr_b16 a[102:103], v9 offset:20480
 v_xor_b32 v10, 65696, v6
 v_mfma_f32_16x16x32_bf16 v[76:79], a[76:79], a[156:159], v[76:79]
 s_waitcnt lgkmcnt(6)
 ds_read_b64_tr_b16 a[104:105], v10 offset:0
 buffer_store_dwordx4 v[128:131], v1, s[12:15], s59 offen offset:0 sc1
 v_mfma_f32_16x16x32_bf16 v[84:87], a[80:83], a[128:131], 0
 s_add_u32 m0, s29, 139264
 ds_read_b64_tr_b16 a[106:107], v10 offset:4096
 v_cvt_pk_bf16_f32 v243, v246, v247
 v_mfma_f32_16x16x32_bf16 v[84:87], a[84:87], a[136:139], v[84:87]
 ds_read_b64_tr_b16 a[108:109], v10 offset:16384
 buffer_load_dwordx4 v2, s[16:19], s49 offen lds
 v_mfma_f32_16x16x32_bf16 v[84:87], a[88:91], a[144:147], v[84:87]
 s_waitcnt lgkmcnt(7)
 ds_read_b64_tr_b16 a[110:111], v10 offset:20480
 v_xor_b32 v7, 192, v6
 v_mfma_f32_16x16x32_bf16 v[84:87], a[92:95], a[152:155], v[84:87]
 ds_read_b64_tr_b16 a[64:65], v7 offset:0
 v_cvt_pk_bf16_f32 v248, v248, v249
 v_mfma_f32_16x16x32_bf16 v[92:95], a[80:83], a[132:135], 0
 ds_read_b64_tr_b16 a[66:67], v7 offset:4096
 v_cvt_pk_bf16_f32 v249, v250, v251
 v_mfma_f32_16x16x32_bf16 v[92:95], a[84:87], a[140:143], v[92:95]
 ds_read_b64_tr_b16 a[68:69], v7 offset:16384
 v_cvt_pk_bf16_f32 v250, v252, v253
 v_mfma_f32_16x16x32_bf16 v[92:95], a[88:91], a[148:151], v[92:95]
 s_add_u32 m0, s29, 143360
 ds_read_b64_tr_b16 a[70:71], v7 offset:20480
 v_xor_b32 v8, 65728, v6
 v_mfma_f32_16x16x32_bf16 v[92:95], a[92:95], a[156:159], v[92:95]
 s_waitcnt lgkmcnt(6)
 ds_read_b64_tr_b16 a[72:73], v8 offset:0
 buffer_load_dwordx4 v2, s[16:19], s50 offen lds
 v_mfma_f32_16x16x32_bf16 v[100:103], a[96:99], a[128:131], 0
 s_add_u32 s59, s56, 20480
 ds_read_b64_tr_b16 a[74:75], v8 offset:4096
 v_cvt_pk_bf16_f32 v251, v254, v255
 v_mfma_f32_16x16x32_bf16 v[100:103], a[100:103], a[136:139], v[100:103]
 ds_read_b64_tr_b16 a[76:77], v8 offset:16384
 buffer_store_dwordx4 v[136:139], v1, s[12:15], s59 offen offset:0 sc1
 v_mfma_f32_16x16x32_bf16 v[100:103], a[104:107], a[144:147], v[100:103]
 s_waitcnt lgkmcnt(7)
 ds_read_b64_tr_b16 a[78:79], v8 offset:20480
 v_xor_b32 v9, 224, v6
 v_mfma_f32_16x16x32_bf16 v[100:103], a[108:111], a[152:155], v[100:103]
 s_and_b32 s36, s95, 31
 ds_read_b64_tr_b16 a[80:81], v9 offset:0
 v_accvgpr_read_b32 v11, a245
 v_mfma_f32_16x16x32_bf16 v[108:111], a[96:99], a[132:135], 0
 s_add_u32 m0, s29, 147456
 ds_read_b64_tr_b16 a[82:83], v9 offset:4096
 v_mov_b32 v12, 0
 v_mfma_f32_16x16x32_bf16 v[108:111], a[100:103], a[140:143], v[108:111]
 ds_read_b64_tr_b16 a[84:85], v9 offset:16384
 buffer_load_dwordx4 v2, s[16:19], s51 offen lds
 v_mfma_f32_16x16x32_bf16 v[108:111], a[104:107], a[148:151], v[108:111]
 s_add_u32 s59, s56, 20480
 ds_read_b64_tr_b16 a[86:87], v9 offset:20480
 v_xor_b32 v10, 65760, v6
 v_mfma_f32_16x16x32_bf16 v[108:111], a[108:111], a[156:159], v[108:111]
 s_waitcnt lgkmcnt(6)
 ds_read_b64_tr_b16 a[88:89], v10 offset:0
 v_and_b32 v14, 15, v0
 v_mfma_f32_16x16x32_bf16 v[116:119], a[64:67], a[128:131], 0
 ds_read_b64_tr_b16 a[90:91], v10 offset:4096
 buffer_store_dwordx4 v[144:147], v1, s[12:15], s59 offen offset:1024 sc1
 v_mfma_f32_16x16x32_bf16 v[116:119], a[68:71], a[136:139], v[116:119]
 s_add_u32 m0, s29, 151552
 ds_read_b64_tr_b16 a[92:93], v10 offset:16384
 v_lshrrev_b32 v3, 4, v0
 v_mfma_f32_16x16x32_bf16 v[116:119], a[72:75], a[144:147], v[116:119]
 s_waitcnt lgkmcnt(7)
 ds_read_b64_tr_b16 a[94:95], v10 offset:20480
 v_xor_b32 v7, 256, v6
 v_mfma_f32_16x16x32_bf16 v[116:119], a[76:79], a[152:155], v[116:119]
 ds_read_b64_tr_b16 a[96:97], v7 offset:0
 buffer_load_dwordx4 v2, s[16:19], s52 offen lds
 v_mfma_f32_16x16x32_bf16 v[124:127], a[64:67], a[132:135], 0
 s_lshr_b32 s37, s95, 5
 ds_read_b64_tr_b16 a[98:99], v7 offset:4096
 v_lshlrev_b32 v3, 2, v3
 v_mfma_f32_16x16x32_bf16 v[124:127], a[68:71], a[140:143], v[124:127]
 ds_read_b64_tr_b16 a[100:101], v7 offset:16384
 global_load_dword v5, v12, s[90:91] offset:128 sc1
 v_mfma_f32_16x16x32_bf16 v[124:127], a[72:75], a[148:151], v[124:127]
 s_add_u32 s59, s56, 4096
 ds_read_b64_tr_b16 a[102:103], v7 offset:20480
 v_xor_b32 v8, 65792, v6
 v_mfma_f32_16x16x32_bf16 v[124:127], a[76:79], a[156:159], v[124:127]
 s_waitcnt lgkmcnt(6)
 ds_read_b64_tr_b16 a[104:105], v8 offset:0
 buffer_store_dwordx4 v[152:155], v1, s[12:15], s59 offen offset:1024 sc1
 v_mfma_f32_16x16x32_bf16 v[132:135], a[80:83], a[128:131], 0
 s_add_u32 m0, s29, 155648
 ds_read_b64_tr_b16 a[106:107], v8 offset:4096
 v_and_b32 v12, 11, v0
 v_mfma_f32_16x16x32_bf16 v[132:135], a[84:87], a[136:139], v[132:135]
 ds_read_b64_tr_b16 a[108:109], v8 offset:16384
 buffer_load_dwordx4 v2, s[16:19], s53 offen lds
 v_mfma_f32_16x16x32_bf16 v[132:135], a[88:91], a[144:147], v[132:135]
 s_waitcnt lgkmcnt(7)
 ds_read_b64_tr_b16 a[110:111], v8 offset:20480
 v_xor_b32 v9, 288, v6
 v_mfma_f32_16x16x32_bf16 v[132:135], a[92:95], a[152:155], v[132:135]
 s_lshl_b32 s38, s3, 4
 ds_read_b64_tr_b16 a[64:65], v9 offset:0
 v_lshlrev_b32 v12, 2, v12
 v_mfma_f32_16x16x32_bf16 v[140:143], a[80:83], a[132:135], 0
 s_lshl_b32 s39, s36, 6
 ds_read_b64_tr_b16 a[66:67], v9 offset:4096
 v_sub_u32 v14, v14, v3
 v_mfma_f32_16x16x32_bf16 v[140:143], a[84:87], a[140:143], v[140:143]
 s_add_u32 s38, s38, s39
 ds_read_b64_tr_b16 a[68:69], v9 offset:16384
 v_lshrrev_b32_e64 v3, 6, s29
 v_mfma_f32_16x16x32_bf16 v[140:143], a[88:91], a[148:151], v[140:143]
 s_add_u32 m0, s29, 159744
 ds_read_b64_tr_b16 a[70:71], v9 offset:20480
 v_xor_b32 v10, 65824, v6
 v_mfma_f32_16x16x32_bf16 v[140:143], a[92:95], a[156:159], v[140:143]
 s_waitcnt lgkmcnt(6)
 ds_read_b64_tr_b16 a[72:73], v10 offset:0
 buffer_load_dwordx4 v2, s[16:19], s54 offen lds
 v_mfma_f32_16x16x32_bf16 v[148:151], a[96:99], a[128:131], 0
 s_add_u32 s59, s56, 4096
 ds_read_b64_tr_b16 a[74:75], v10 offset:4096
 v_add_u32 v14, v3, v14
 v_mfma_f32_16x16x32_bf16 v[148:151], a[100:103], a[136:139], v[148:151]
 ds_read_b64_tr_b16 a[76:77], v10 offset:16384
 buffer_store_dwordx4 v[160:163], v1, s[12:15], s59 offen offset:2048 sc1
 v_mfma_f32_16x16x32_bf16 v[148:151], a[104:107], a[144:147], v[148:151]
 s_waitcnt lgkmcnt(7)
 ds_read_b64_tr_b16 a[78:79], v10 offset:20480
 v_xor_b32 v7, 320, v6
 v_mfma_f32_16x16x32_bf16 v[148:151], a[108:111], a[152:155], v[148:151]
 s_mul_i32 s38, s38, 896
 ds_read_b64_tr_b16 a[80:81], v7 offset:0
 v_mov_b32 v15, 0xf149f2ca
 v_mfma_f32_16x16x32_bf16 v[156:159], a[96:99], a[132:135], 0
 s_lshl_b32 s39, s37, 7
 ds_read_b64_tr_b16 a[82:83], v7 offset:4096
 v_cmp_gt_i32 vcc, 0, v14
 v_mfma_f32_16x16x32_bf16 v[156:159], a[100:103], a[140:143], v[156:159]
 s_add_u32 s38, s38, s39
 ds_read_b64_tr_b16 a[84:85], v7 offset:16384
 v_cndmask_b32 v3, 0, v15, vcc
 v_mfma_f32_16x16x32_bf16 v[156:159], a[104:107], a[148:151], v[156:159]
 s_add_u32 s59, s56, 20480
 ds_read_b64_tr_b16 a[86:87], v7 offset:20480
 v_xor_b32 v8, 65856, v6
 v_mfma_f32_16x16x32_bf16 v[156:159], a[108:111], a[156:159], v[156:159]
 s_waitcnt lgkmcnt(6)
 ds_read_b64_tr_b16 a[88:89], v8 offset:0
 v_accvgpr_write_b32 a224, v3
 v_mfma_f32_16x16x32_bf16 v[164:167], a[64:67], a[128:131], 0
 ds_read_b64_tr_b16 a[90:91], v8 offset:4096
 buffer_store_dwordx4 v[168:171], v1, s[12:15], s59 offen offset:2048 sc1
 v_mfma_f32_16x16x32_bf16 v[164:167], a[68:71], a[136:139], v[164:167]
 s_lshl_b32 s39, s37, 9
 ds_read_b64_tr_b16 a[92:93], v8 offset:16384
 v_cmp_gt_i32 vcc, 1, v14
 v_mfma_f32_16x16x32_bf16 v[164:167], a[72:75], a[144:147], v[164:167]
 s_waitcnt lgkmcnt(7)
 ds_read_b64_tr_b16 a[94:95], v8 offset:20480
 v_xor_b32 v9, 352, v6
 v_mfma_f32_16x16x32_bf16 v[164:167], a[76:79], a[152:155], v[164:167]
 s_mov_b32 s4, s66
 ds_read_b64_tr_b16 a[96:97], v9 offset:0
 v_cndmask_b32 v3, 0, v15, vcc
 v_mfma_f32_16x16x32_bf16 v[172:175], a[64:67], a[132:135], 0
 s_mov_b32 s5, s67
 ds_read_b64_tr_b16 a[98:99], v9 offset:4096
 v_accvgpr_write_b32 a225, v3
 v_mfma_f32_16x16x32_bf16 v[172:175], a[68:71], a[140:143], v[172:175]
 s_mov_b32 s6, 1835008
 ds_read_b64_tr_b16 a[100:101], v9 offset:16384
 v_cmp_gt_i32 vcc, 2, v14
 v_mfma_f32_16x16x32_bf16 v[172:175], a[72:75], a[148:151], v[172:175]
 s_add_u32 s59, s56, 20480
 ds_read_b64_tr_b16 a[102:103], v9 offset:20480
 v_xor_b32 v10, 65888, v6
 v_mfma_f32_16x16x32_bf16 v[172:175], a[76:79], a[156:159], v[172:175]
 s_waitcnt lgkmcnt(6)
 ds_read_b64_tr_b16 a[104:105], v10 offset:0
 buffer_store_dwordx4 v[176:179], v1, s[12:15], s59 offen offset:3072 sc1
 v_mfma_f32_16x16x32_bf16 v[180:183], a[80:83], a[128:131], 0
 s_mov_b32 s7, 0x20000
 ds_read_b64_tr_b16 a[106:107], v10 offset:4096
 v_cndmask_b32 v3, 0, v15, vcc
 v_mfma_f32_16x16x32_bf16 v[180:183], a[84:87], a[136:139], v[180:183]
 s_mov_b32 s8, s68
 ds_read_b64_tr_b16 a[108:109], v10 offset:16384
 v_accvgpr_write_b32 a226, v3
 v_mfma_f32_16x16x32_bf16 v[180:183], a[88:91], a[144:147], v[180:183]
 s_waitcnt lgkmcnt(7)
 ds_read_b64_tr_b16 a[110:111], v10 offset:20480
 v_xor_b32 v7, 384, v6
 v_mfma_f32_16x16x32_bf16 v[180:183], a[92:95], a[152:155], v[180:183]
 s_mov_b32 s9, s69
 ds_read_b64_tr_b16 a[64:65], v7 offset:0
 v_cmp_gt_i32 vcc, 3, v14
 v_mfma_f32_16x16x32_bf16 v[188:191], a[80:83], a[132:135], 0
 s_mov_b32 s10, 1835008
 ds_read_b64_tr_b16 a[66:67], v7 offset:4096
 v_cndmask_b32 v3, 0, v15, vcc
 v_mfma_f32_16x16x32_bf16 v[188:191], a[84:87], a[140:143], v[188:191]
 s_mov_b32 s11, 0x20000
 ds_read_b64_tr_b16 a[68:69], v7 offset:16384
 v_accvgpr_write_b32 a227, v3
 v_mfma_f32_16x16x32_bf16 v[188:191], a[88:91], a[148:151], v[188:191]
 s_add_u32 s59, s56, 4096
 ds_read_b64_tr_b16 a[70:71], v7 offset:20480
 v_xor_b32 v8, 65920, v6
 v_mfma_f32_16x16x32_bf16 v[188:191], a[92:95], a[156:159], v[188:191]
 s_waitcnt lgkmcnt(6)
 ds_read_b64_tr_b16 a[72:73], v8 offset:0
 buffer_store_dwordx4 v[184:187], v1, s[12:15], s59 offen offset:3072 sc1
 v_mfma_f32_16x16x32_bf16 v[196:199], a[96:99], a[128:131], 0
 s_mov_b32 s20, s70
 ds_read_b64_tr_b16 a[74:75], v8 offset:4096
 v_cmp_gt_i32 vcc, 16, v14
 v_mfma_f32_16x16x32_bf16 v[196:199], a[100:103], a[136:139], v[196:199]
 s_mov_b32 s21, s71
 ds_read_b64_tr_b16 a[76:77], v8 offset:16384
 v_cndmask_b32 v3, 0, v15, vcc
 v_mfma_f32_16x16x32_bf16 v[196:199], a[104:107], a[144:147], v[196:199]
 s_waitcnt lgkmcnt(7)
 ds_read_b64_tr_b16 a[78:79], v8 offset:20480
 v_xor_b32 v9, 416, v6
 v_mfma_f32_16x16x32_bf16 v[196:199], a[108:111], a[152:155], v[196:199]
 s_mov_b32 s22, 3584
 ds_read_b64_tr_b16 a[80:81], v9 offset:0
 v_accvgpr_write_b32 a228, v3
 v_mfma_f32_16x16x32_bf16 v[204:207], a[96:99], a[132:135], 0
 s_mov_b32 s23, 0x20000
 ds_read_b64_tr_b16 a[82:83], v9 offset:4096
 v_cmp_gt_i32 vcc, 17, v14
 v_mfma_f32_16x16x32_bf16 v[204:207], a[100:103], a[140:143], v[204:207]
 ds_read_b64_tr_b16 a[84:85], v9 offset:16384
 v_lshrrev_b32 v120, 3, v0
 v_mfma_f32_16x16x32_bf16 v[204:207], a[104:107], a[148:151], v[204:207]
 s_add_u32 s59, s56, 36864
 ds_read_b64_tr_b16 a[86:87], v9 offset:20480
 v_xor_b32 v10, 65952, v6
 v_mfma_f32_16x16x32_bf16 v[204:207], a[108:111], a[156:159], v[204:207]
 s_waitcnt lgkmcnt(6)
 ds_read_b64_tr_b16 a[88:89], v10 offset:0
 buffer_store_dwordx4 v[192:195], v1, s[12:15], s59 offen offset:0 sc1
 v_mfma_f32_16x16x32_bf16 v[212:215], a[64:67], a[128:131], 0
 ds_read_b64_tr_b16 a[90:91], v10 offset:4096
 v_mul_u32_u24 v120, 1792, v120
 v_mfma_f32_16x16x32_bf16 v[212:215], a[68:71], a[136:139], v[212:215]
 ds_read_b64_tr_b16 a[92:93], v10 offset:16384
 v_and_b32 v121, 7, v0
 v_mfma_f32_16x16x32_bf16 v[212:215], a[72:75], a[144:147], v[212:215]
 s_waitcnt lgkmcnt(7)
 ds_read_b64_tr_b16 a[94:95], v10 offset:20480
 v_xor_b32 v7, 448, v6
 v_mfma_f32_16x16x32_bf16 v[212:215], a[76:79], a[152:155], v[212:215]
 ds_read_b64_tr_b16 a[96:97], v7 offset:0
 v_lshl_add_u32 v120, v121, 4, v120
 v_mfma_f32_16x16x32_bf16 v[220:223], a[64:67], a[132:135], 0
 ds_read_b64_tr_b16 a[98:99], v7 offset:4096
 v_add_u32 v120, s38, v120
 v_mfma_f32_16x16x32_bf16 v[220:223], a[68:71], a[140:143], v[220:223]
 ds_read_b64_tr_b16 a[100:101], v7 offset:16384
 v_lshlrev_b32 v121, 6, v121
 v_mfma_f32_16x16x32_bf16 v[220:223], a[72:75], a[148:151], v[220:223]
 s_add_u32 s59, s56, 53248
 ds_read_b64_tr_b16 a[102:103], v7 offset:20480
 v_xor_b32 v8, 65984, v6
 v_mfma_f32_16x16x32_bf16 v[220:223], a[76:79], a[156:159], v[220:223]
 s_waitcnt lgkmcnt(6)
 ds_read_b64_tr_b16 a[104:105], v8 offset:0
 buffer_store_dwordx4 v[200:203], v1, s[12:15], s59 offen offset:0 sc1
 v_mfma_f32_16x16x32_bf16 v[228:231], a[80:83], a[128:131], 0
 ds_read_b64_tr_b16 a[106:107], v8 offset:4096
 v_subrev_u32 v122, 2688, v120
 v_mfma_f32_16x16x32_bf16 v[228:231], a[84:87], a[136:139], v[228:231]
 ds_read_b64_tr_b16 a[108:109], v8 offset:16384
 v_subrev_u32 v123, 1792, v120
 v_mfma_f32_16x16x32_bf16 v[228:231], a[88:91], a[144:147], v[228:231]
 s_waitcnt lgkmcnt(7)
 ds_read_b64_tr_b16 a[110:111], v8 offset:20480
 v_xor_b32 v9, 480, v6
 v_mfma_f32_16x16x32_bf16 v[228:231], a[92:95], a[152:155], v[228:231]
 ds_read_b64_tr_b16 a[64:65], v9 offset:0
 v_subrev_u32 v128, 896, v120
 v_mfma_f32_16x16x32_bf16 v[236:239], a[80:83], a[132:135], 0
 ds_read_b64_tr_b16 a[66:67], v9 offset:4096
 v_cndmask_b32 v3, 0, v15, vcc
 v_mfma_f32_16x16x32_bf16 v[236:239], a[84:87], a[140:143], v[236:239]
 ds_read_b64_tr_b16 a[68:69], v9 offset:16384
 v_accvgpr_write_b32 a229, v3
 v_mfma_f32_16x16x32_bf16 v[236:239], a[88:91], a[148:151], v[236:239]
 s_add_u32 s59, s56, 53248
 ds_read_b64_tr_b16 a[70:71], v9 offset:20480
 v_xor_b32 v10, 66016, v6
 v_mfma_f32_16x16x32_bf16 v[236:239], a[92:95], a[156:159], v[236:239]
 s_waitcnt lgkmcnt(6)
 ds_read_b64_tr_b16 a[72:73], v10 offset:0
 buffer_store_dwordx4 v[208:211], v1, s[12:15], s59 offen offset:1024 sc1
 v_mfma_f32_16x16x32_bf16 v[244:247], a[96:99], a[128:131], 0
 ds_read_b64_tr_b16 a[74:75], v10 offset:4096
 v_cmp_gt_i32 vcc, 18, v14
 v_mfma_f32_16x16x32_bf16 v[244:247], a[100:103], a[136:139], v[244:247]
 s_waitcnt vmcnt(25)
 ds_read_b64_tr_b16 a[76:77], v10 offset:16384
 v_xor_b32 v7, 32768, v6
 v_mfma_f32_16x16x32_bf16 v[244:247], a[104:107], a[144:147], v[244:247]
 s_waitcnt lgkmcnt(7)
 s_barrier
 ds_read_b64_tr_b16 a[78:79], v10 offset:20480
 v_mfma_f32_16x16x32_bf16 v[244:247], a[108:111], a[152:155], v[244:247]
 ds_read_b64_tr_b16 a[80:81], v7 offset:0
 v_cndmask_b32 v3, 0, v15, vcc
 v_mfma_f32_16x16x32_bf16 v[252:255], a[96:99], a[132:135], 0
 ds_read_b64_tr_b16 a[82:83], v7 offset:4096
 v_accvgpr_write_b32 a230, v3
 v_mfma_f32_16x16x32_bf16 v[252:255], a[100:103], a[140:143], v[252:255]
 ds_read_b64_tr_b16 a[84:85], v7 offset:16384
 v_cmp_gt_i32 vcc, 19, v14
 v_mfma_f32_16x16x32_bf16 v[252:255], a[104:107], a[148:151], v[252:255]
 s_add_u32 s59, s56, 36864
 ds_read_b64_tr_b16 a[86:87], v7 offset:20480
 v_xor_b32 v8, 98304, v6
 v_mfma_f32_16x16x32_bf16 v[252:255], a[108:111], a[156:159], v[252:255]
 s_waitcnt lgkmcnt(6)
 ds_read_b64_tr_b16 a[88:89], v8 offset:0
 buffer_store_dwordx4 v[216:219], v1, s[12:15], s59 offen offset:1024 sc1
 v_mfma_f32_16x16x32_bf16 v[16:19], a[64:67], a[128:131], 0
 ds_read_b64_tr_b16 a[90:91], v8 offset:4096
 v_cndmask_b32 v3, 0, v15, vcc
 v_mfma_f32_16x16x32_bf16 v[16:19], a[68:71], a[136:139], v[16:19]
 ds_read_b64_tr_b16 a[92:93], v8 offset:16384
 v_accvgpr_write_b32 a231, v3
 v_mfma_f32_16x16x32_bf16 v[16:19], a[72:75], a[144:147], v[16:19]
 s_waitcnt lgkmcnt(7)
 ds_read_b64_tr_b16 a[94:95], v8 offset:20480
 v_xor_b32 v9, 32800, v6
 v_mfma_f32_16x16x32_bf16 v[16:19], a[76:79], a[152:155], v[16:19]
 ds_read_b64_tr_b16 a[96:97], v9 offset:0
 v_cmp_gt_i32 vcc, 32, v14
 v_mfma_f32_16x16x32_bf16 v[24:27], a[64:67], a[132:135], 0
 s_waitcnt lgkmcnt(9)
 ds_read_b64_tr_b16 a[98:99], v9 offset:4096
 v_cndmask_b32 v3, 0, v15, vcc
 v_mfma_f32_16x16x32_bf16 v[24:27], a[68:71], a[140:143], v[24:27]
 s_barrier
 ds_read_b64_tr_b16 a[100:101], v9 offset:16384
 v_accvgpr_write_b32 a232, v3
 v_mfma_f32_16x16x32_bf16 v[24:27], a[72:75], a[148:151], v[24:27]
 s_add_u32 m0, s29, 0
 ds_read_b64_tr_b16 a[102:103], v9 offset:20480
 v_xor_b32 v10, 98336, v6
 v_mfma_f32_16x16x32_bf16 v[24:27], a[76:79], a[156:159], v[24:27]
 s_waitcnt lgkmcnt(6)
 ds_read_b64_tr_b16 a[104:105], v10 offset:0
 v_add_u32 v2, 0x80000, v2
 v_mfma_f32_16x16x32_bf16 v[28:31], a[80:83], a[160:163], v[28:31]
 ds_read_b64_tr_b16 a[106:107], v10 offset:4096
 buffer_load_dwordx4 v2, s[16:19], 0 offen lds
 v_mfma_f32_16x16x32_bf16 v[28:31], a[84:87], a[168:171], v[28:31]
 s_add_u32 s59, s56, 36864
 ds_read_b64_tr_b16 a[108:109], v10 offset:16384
 v_cmp_gt_i32 vcc, 33, v14
 v_mfma_f32_16x16x32_bf16 v[28:31], a[88:91], a[176:179], v[28:31]
 s_waitcnt lgkmcnt(7)
 ds_read_b64_tr_b16 a[110:111], v10 offset:20480
 v_xor_b32 v7, 32832, v6
 v_mfma_f32_16x16x32_bf16 v[28:31], a[92:95], a[184:187], v[28:31]
 ds_read_b64_tr_b16 a[64:65], v7 offset:0
 buffer_store_dwordx4 v[224:227], v1, s[12:15], s59 offen offset:2048 sc1
 v_mfma_f32_16x16x32_bf16 v[44:47], a[80:83], a[164:167], v[44:47]
 s_add_u32 m0, s29, 4096
 ds_read_b64_tr_b16 a[66:67], v7 offset:4096
 v_add_u32 v4, 4096, v1
 v_mfma_f32_16x16x32_bf16 v[44:47], a[84:87], a[172:175], v[44:47]
 ds_read_b64_tr_b16 a[68:69], v7 offset:16384
 buffer_load_dwordx4 v2, s[16:19], s48 offen lds
 v_mfma_f32_16x16x32_bf16 v[44:47], a[88:91], a[180:183], v[44:47]
 ds_read_b64_tr_b16 a[70:71], v7 offset:20480
 v_xor_b32 v8, 98368, v6
 v_mfma_f32_16x16x32_bf16 v[44:47], a[92:95], a[188:191], v[44:47]
 s_waitcnt lgkmcnt(6)
 ds_read_b64_tr_b16 a[72:73], v8 offset:0
 v_cndmask_b32 v3, 0, v15, vcc
 v_mfma_f32_16x16x32_bf16 v[52:55], a[96:99], a[160:163], v[52:55]
 ds_read_b64_tr_b16 a[74:75], v8 offset:4096
 v_accvgpr_write_b32 a233, v3
 v_mfma_f32_16x16x32_bf16 v[52:55], a[100:103], a[168:171], v[52:55]
 s_add_u32 m0, s29, 8192
 ds_read_b64_tr_b16 a[76:77], v8 offset:16384
 v_cmp_gt_i32 vcc, 34, v14
 v_mfma_f32_16x16x32_bf16 v[52:55], a[104:107], a[176:179], v[52:55]
 s_waitcnt lgkmcnt(7)
 ds_read_b64_tr_b16 a[78:79], v8 offset:20480
 v_xor_b32 v9, 32864, v6
 v_mfma_f32_16x16x32_bf16 v[52:55], a[108:111], a[184:187], v[52:55]
 ds_read_b64_tr_b16 a[80:81], v9 offset:0
 buffer_load_dwordx4 v2, s[16:19], s49 offen lds
 v_mfma_f32_16x16x32_bf16 v[60:63], a[96:99], a[164:167], v[60:63]
 s_add_u32 s59, s56, 53248
 ds_read_b64_tr_b16 a[82:83], v9 offset:4096
 v_cndmask_b32 v3, 0, v15, vcc
 v_mfma_f32_16x16x32_bf16 v[60:63], a[100:103], a[172:175], v[60:63]
 ds_read_b64_tr_b16 a[84:85], v9 offset:16384
 buffer_store_dwordx4 v[232:235], v1, s[12:15], s59 offen offset:2048 sc1
 v_mfma_f32_16x16x32_bf16 v[60:63], a[104:107], a[180:183], v[60:63]
 s_add_u32 m0, s29, 12288
 ds_read_b64_tr_b16 a[86:87], v9 offset:20480
 v_xor_b32 v10, 98400, v6
 v_mfma_f32_16x16x32_bf16 v[60:63], a[108:111], a[188:191], v[60:63]
 s_waitcnt lgkmcnt(6)
 ds_read_b64_tr_b16 a[88:89], v10 offset:0
 v_accvgpr_write_b32 a234, v3
 v_mfma_f32_16x16x32_bf16 v[20:23], a[64:67], a[160:163], v[20:23]
 ds_read_b64_tr_b16 a[90:91], v10 offset:4096
 buffer_load_dwordx4 v2, s[16:19], s50 offen lds
 v_mfma_f32_16x16x32_bf16 v[20:23], a[68:71], a[168:171], v[20:23]
 ds_read_b64_tr_b16 a[92:93], v10 offset:16384
 v_cmp_gt_i32 vcc, 35, v14
 v_mfma_f32_16x16x32_bf16 v[20:23], a[72:75], a[176:179], v[20:23]
 s_waitcnt lgkmcnt(7)
 ds_read_b64_tr_b16 a[94:95], v10 offset:20480
 v_xor_b32 v7, 32896, v6
 v_mfma_f32_16x16x32_bf16 v[20:23], a[76:79], a[184:187], v[20:23]
 ds_read_b64_tr_b16 a[96:97], v7 offset:0
 v_cndmask_b32 v3, 0, v15, vcc
 v_mfma_f32_16x16x32_bf16 v[36:39], a[64:67], a[164:167], v[36:39]
 s_add_u32 m0, s29, 16384
 ds_read_b64_tr_b16 a[98:99], v7 offset:4096
 v_accvgpr_write_b32 a235, v3
 v_mfma_f32_16x16x32_bf16 v[36:39], a[68:71], a[172:175], v[36:39]
 ds_read_b64_tr_b16 a[100:101], v7 offset:16384
 buffer_load_dwordx4 v2, s[16:19], s51 offen lds
 v_mfma_f32_16x16x32_bf16 v[36:39], a[72:75], a[180:183], v[36:39]
 s_add_u32 s59, s56, 53248
 ds_read_b64_tr_b16 a[102:103], v7 offset:20480
 v_xor_b32 v8, 98432, v6
 v_mfma_f32_16x16x32_bf16 v[36:39], a[76:79], a[188:191], v[36:39]
 s_waitcnt lgkmcnt(6)
 ds_read_b64_tr_b16 a[104:105], v8 offset:0
 buffer_store_dwordx4 v[240:243], v1, s[12:15], s59 offen offset:3072 sc1
 v_mfma_f32_16x16x32_bf16 v[68:71], a[80:83], a[160:163], v[68:71]
 ds_read_b64_tr_b16 a[106:107], v8 offset:4096
 v_cmp_gt_i32 vcc, 48, v14
 v_mfma_f32_16x16x32_bf16 v[68:71], a[84:87], a[168:171], v[68:71]
 s_add_u32 m0, s29, 20480
 ds_read_b64_tr_b16 a[108:109], v8 offset:16384
 v_cndmask_b32 v3, 0, v15, vcc
 v_mfma_f32_16x16x32_bf16 v[68:71], a[88:91], a[176:179], v[68:71]
 s_waitcnt lgkmcnt(7)
 ds_read_b64_tr_b16 a[110:111], v8 offset:20480
 v_xor_b32 v9, 32928, v6
 v_mfma_f32_16x16x32_bf16 v[68:71], a[92:95], a[184:187], v[68:71]
 ds_read_b64_tr_b16 a[64:65], v9 offset:0
 buffer_load_dwordx4 v2, s[16:19], s52 offen lds
 v_mfma_f32_16x16x32_bf16 v[76:79], a[80:83], a[164:167], v[76:79]
 ds_read_b64_tr_b16 a[66:67], v9 offset:4096
 v_accvgpr_write_b32 a236, v3
 v_mfma_f32_16x16x32_bf16 v[76:79], a[84:87], a[172:175], v[76:79]
 ds_read_b64_tr_b16 a[68:69], v9 offset:16384
 v_cmp_gt_i32 vcc, 49, v14
 v_mfma_f32_16x16x32_bf16 v[76:79], a[88:91], a[180:183], v[76:79]
 s_add_u32 m0, s29, 24576
 ds_read_b64_tr_b16 a[70:71], v9 offset:20480
 v_xor_b32 v10, 98464, v6
 v_mfma_f32_16x16x32_bf16 v[76:79], a[92:95], a[188:191], v[76:79]
 s_waitcnt lgkmcnt(6)
 ds_read_b64_tr_b16 a[72:73], v10 offset:0
 v_cndmask_b32 v3, 0, v15, vcc
 v_mfma_f32_16x16x32_bf16 v[84:87], a[96:99], a[160:163], v[84:87]
 ds_read_b64_tr_b16 a[74:75], v10 offset:4096
 buffer_load_dwordx4 v2, s[16:19], s53 offen lds
 v_mfma_f32_16x16x32_bf16 v[84:87], a[100:103], a[168:171], v[84:87]
 s_add_u32 s59, s56, 36864
 ds_read_b64_tr_b16 a[76:77], v10 offset:16384
 v_accvgpr_write_b32 a237, v3
 v_mfma_f32_16x16x32_bf16 v[84:87], a[104:107], a[176:179], v[84:87]
 s_waitcnt lgkmcnt(7)
 ds_read_b64_tr_b16 a[78:79], v10 offset:20480
 v_xor_b32 v7, 32960, v6
 v_mfma_f32_16x16x32_bf16 v[84:87], a[108:111], a[184:187], v[84:87]
 ds_read_b64_tr_b16 a[80:81], v7 offset:0
 buffer_store_dwordx4 v[248:251], v1, s[12:15], s59 offen offset:3072 sc1
 v_mfma_f32_16x16x32_bf16 v[92:95], a[96:99], a[164:167], v[92:95]
 s_add_u32 m0, s29, 28672
 ds_read_b64_tr_b16 a[82:83], v7 offset:4096
 v_cmp_gt_i32 vcc, 50, v14
 v_mfma_f32_16x16x32_bf16 v[92:95], a[100:103], a[172:175], v[92:95]
 ds_read_b64_tr_b16 a[84:85], v7 offset:16384
 buffer_load_dwordx4 v2, s[16:19], s54 offen lds
 v_mfma_f32_16x16x32_bf16 v[92:95], a[104:107], a[180:183], v[92:95]
 ds_read_b64_tr_b16 a[86:87], v7 offset:20480
 v_xor_b32 v8, 98496, v6
 v_mfma_f32_16x16x32_bf16 v[92:95], a[108:111], a[188:191], v[92:95]
 s_waitcnt lgkmcnt(6)
 ds_read_b64_tr_b16 a[88:89], v8 offset:0
 v_cndmask_b32 v3, 0, v15, vcc
 v_mfma_f32_16x16x32_bf16 v[100:103], a[64:67], a[160:163], v[100:103]
 s_add_u32 m0, s29, 65536
 ds_read_b64_tr_b16 a[90:91], v8 offset:4096
 v_add_u32 v2, 0x80000, v2
 v_mfma_f32_16x16x32_bf16 v[100:103], a[68:71], a[168:171], v[100:103]
 ds_read_b64_tr_b16 a[92:93], v8 offset:16384
 buffer_load_dwordx4 v2, s[16:19], 0 offen lds
 v_mfma_f32_16x16x32_bf16 v[100:103], a[72:75], a[176:179], v[100:103]
 s_waitcnt lgkmcnt(7)
 ds_read_b64_tr_b16 a[94:95], v8 offset:20480
 v_xor_b32 v9, 32992, v6
 v_mfma_f32_16x16x32_bf16 v[100:103], a[76:79], a[184:187], v[100:103]
 ds_read_b64_tr_b16 a[96:97], v9 offset:0
 v_accvgpr_write_b32 a238, v3
 v_mfma_f32_16x16x32_bf16 v[108:111], a[64:67], a[164:167], v[108:111]
 ds_read_b64_tr_b16 a[98:99], v9 offset:4096
 v_cmp_gt_i32 vcc, 51, v14
 v_mfma_f32_16x16x32_bf16 v[108:111], a[68:71], a[172:175], v[108:111]
 ds_read_b64_tr_b16 a[100:101], v9 offset:16384
 v_cndmask_b32 v3, 0, v15, vcc
 v_mfma_f32_16x16x32_bf16 v[108:111], a[72:75], a[180:183], v[108:111]
 s_add_u32 m0, s29, 69632
 ds_read_b64_tr_b16 a[102:103], v9 offset:20480
 v_xor_b32 v10, 98528, v6
 v_mfma_f32_16x16x32_bf16 v[108:111], a[76:79], a[188:191], v[108:111]
 s_waitcnt lgkmcnt(6)
 ds_read_b64_tr_b16 a[104:105], v10 offset:0
 buffer_load_dwordx4 v2, s[16:19], s48 offen lds
 v_mfma_f32_16x16x32_bf16 v[116:119], a[80:83], a[160:163], v[116:119]
 ds_read_b64_tr_b16 a[106:107], v10 offset:4096
 v_accvgpr_write_b32 a239, v3
 v_mfma_f32_16x16x32_bf16 v[116:119], a[84:87], a[168:171], v[116:119]
 ds_read_b64_tr_b16 a[108:109], v10 offset:16384
 v_mfma_f32_16x16x32_bf16 v[116:119], a[88:91], a[176:179], v[116:119]
 s_waitcnt lgkmcnt(7)
 ds_read_b64_tr_b16 a[110:111], v10 offset:20480
 v_xor_b32 v7, 33024, v6
 v_mfma_f32_16x16x32_bf16 v[116:119], a[92:95], a[184:187], v[116:119]
 s_add_u32 m0, s29, 73728
 ds_read_b64_tr_b16 a[64:65], v7 offset:0
 v_mfma_f32_16x16x32_bf16 v[124:127], a[80:83], a[164:167], v[124:127]
 ds_read_b64_tr_b16 a[66:67], v7 offset:4096
 buffer_load_dwordx4 v2, s[16:19], s49 offen lds
 v_mfma_f32_16x16x32_bf16 v[124:127], a[84:87], a[172:175], v[124:127]
 ds_read_b64_tr_b16 a[68:69], v7 offset:16384
 v_mfma_f32_16x16x32_bf16 v[124:127], a[88:91], a[180:183], v[124:127]
 ds_read_b64_tr_b16 a[70:71], v7 offset:20480
 v_xor_b32 v8, 98560, v6
 v_mfma_f32_16x16x32_bf16 v[124:127], a[92:95], a[188:191], v[124:127]
 s_waitcnt lgkmcnt(6)
 ds_read_b64_tr_b16 a[72:73], v8 offset:0
 v_mfma_f32_16x16x32_bf16 v[132:135], a[96:99], a[160:163], v[132:135]
 s_add_u32 m0, s29, 77824
 ds_read_b64_tr_b16 a[74:75], v8 offset:4096
 v_mfma_f32_16x16x32_bf16 v[132:135], a[100:103], a[168:171], v[132:135]
 ds_read_b64_tr_b16 a[76:77], v8 offset:16384
 buffer_load_dwordx4 v2, s[16:19], s50 offen lds
 v_mfma_f32_16x16x32_bf16 v[132:135], a[104:107], a[176:179], v[132:135]
 s_waitcnt lgkmcnt(7)
 ds_read_b64_tr_b16 a[78:79], v8 offset:20480
 v_xor_b32 v9, 33056, v6
 v_mfma_f32_16x16x32_bf16 v[132:135], a[108:111], a[184:187], v[132:135]
 ds_read_b64_tr_b16 a[80:81], v9 offset:0
 v_mfma_f32_16x16x32_bf16 v[140:143], a[96:99], a[164:167], v[140:143]
 ds_read_b64_tr_b16 a[82:83], v9 offset:4096
 v_mfma_f32_16x16x32_bf16 v[140:143], a[100:103], a[172:175], v[140:143]
 ds_read_b64_tr_b16 a[84:85], v9 offset:16384
 v_mfma_f32_16x16x32_bf16 v[140:143], a[104:107], a[180:183], v[140:143]
 s_add_u32 m0, s29, 81920
 ds_read_b64_tr_b16 a[86:87], v9 offset:20480
 v_xor_b32 v10, 98592, v6
 v_mfma_f32_16x16x32_bf16 v[140:143], a[108:111], a[188:191], v[140:143]
 s_waitcnt lgkmcnt(6)
 ds_read_b64_tr_b16 a[88:89], v10 offset:0
 buffer_load_dwordx4 v2, s[16:19], s51 offen lds
 v_mfma_f32_16x16x32_bf16 v[148:151], a[64:67], a[160:163], v[148:151]
 ds_read_b64_tr_b16 a[90:91], v10 offset:4096
 v_mfma_f32_16x16x32_bf16 v[148:151], a[68:71], a[168:171], v[148:151]
 ds_read_b64_tr_b16 a[92:93], v10 offset:16384
 v_mfma_f32_16x16x32_bf16 v[148:151], a[72:75], a[176:179], v[148:151]
 s_waitcnt lgkmcnt(7)
 ds_read_b64_tr_b16 a[94:95], v10 offset:20480
 v_xor_b32 v7, 33088, v6
 v_mfma_f32_16x16x32_bf16 v[148:151], a[76:79], a[184:187], v[148:151]
 s_add_u32 m0, s29, 86016
 ds_read_b64_tr_b16 a[96:97], v7 offset:0
 v_mfma_f32_16x16x32_bf16 v[156:159], a[64:67], a[164:167], v[156:159]
 ds_read_b64_tr_b16 a[98:99], v7 offset:4096
 buffer_load_dwordx4 v2, s[16:19], s52 offen lds
 v_mfma_f32_16x16x32_bf16 v[156:159], a[68:71], a[172:175], v[156:159]
 ds_read_b64_tr_b16 a[100:101], v7 offset:16384
 v_mfma_f32_16x16x32_bf16 v[156:159], a[72:75], a[180:183], v[156:159]
 ds_read_b64_tr_b16 a[102:103], v7 offset:20480
 v_xor_b32 v8, 98624, v6
 v_mfma_f32_16x16x32_bf16 v[156:159], a[76:79], a[188:191], v[156:159]
 s_waitcnt lgkmcnt(6)
 ds_read_b64_tr_b16 a[104:105], v8 offset:0
 v_mfma_f32_16x16x32_bf16 v[164:167], a[80:83], a[160:163], v[164:167]
 s_add_u32 m0, s29, 90112
 ds_read_b64_tr_b16 a[106:107], v8 offset:4096
 v_mfma_f32_16x16x32_bf16 v[164:167], a[84:87], a[168:171], v[164:167]
 ds_read_b64_tr_b16 a[108:109], v8 offset:16384
 buffer_load_dwordx4 v2, s[16:19], s53 offen lds
 v_mfma_f32_16x16x32_bf16 v[164:167], a[88:91], a[176:179], v[164:167]
 s_waitcnt lgkmcnt(7)
 ds_read_b64_tr_b16 a[110:111], v8 offset:20480
 v_xor_b32 v9, 33120, v6
 v_mfma_f32_16x16x32_bf16 v[164:167], a[92:95], a[184:187], v[164:167]
 s_waitcnt vmcnt(8)
 ds_read_b64_tr_b16 a[64:65], v9 offset:0
 v_mfma_f32_16x16x32_bf16 v[172:175], a[80:83], a[164:167], v[172:175]
 s_barrier
 ds_read_b64_tr_b16 a[66:67], v9 offset:4096
 v_mfma_f32_16x16x32_bf16 v[172:175], a[84:87], a[172:175], v[172:175]
 ds_read_b64_tr_b16 a[68:69], v9 offset:16384
 buffer_store_dword v11, v11, s[12:15], s92 offen sc1
 v_mfma_f32_16x16x32_bf16 v[172:175], a[88:91], a[180:183], v[172:175]
 s_add_u32 m0, s29, 94208
 ds_read_b64_tr_b16 a[70:71], v9 offset:20480
 v_xor_b32 v10, 98656, v6
 v_mfma_f32_16x16x32_bf16 v[172:175], a[92:95], a[188:191], v[172:175]
 s_waitcnt lgkmcnt(6)
 ds_read_b64_tr_b16 a[72:73], v10 offset:0
 buffer_load_dwordx4 v2, s[16:19], s54 offen lds
 v_mfma_f32_16x16x32_bf16 v[180:183], a[96:99], a[160:163], v[180:183]
 ds_read_b64_tr_b16 a[74:75], v10 offset:4096
 v_mfma_f32_16x16x32_bf16 v[180:183], a[100:103], a[168:171], v[180:183]
 ds_read_b64_tr_b16 a[76:77], v10 offset:16384
 v_mfma_f32_16x16x32_bf16 v[180:183], a[104:107], a[176:179], v[180:183]
 s_waitcnt lgkmcnt(7)
 ds_read_b64_tr_b16 a[78:79], v10 offset:20480
 v_xor_b32 v7, 33152, v6
 v_mfma_f32_16x16x32_bf16 v[180:183], a[108:111], a[184:187], v[180:183]
 ds_read_b64_tr_b16 a[80:81], v7 offset:0
 v_mfma_f32_16x16x32_bf16 v[188:191], a[96:99], a[164:167], v[188:191]
 ds_read_b64_tr_b16 a[82:83], v7 offset:4096
 v_mfma_f32_16x16x32_bf16 v[188:191], a[100:103], a[172:175], v[188:191]
 ds_read_b64_tr_b16 a[84:85], v7 offset:16384
 v_mfma_f32_16x16x32_bf16 v[188:191], a[104:107], a[180:183], v[188:191]
 ds_read_b64_tr_b16 a[86:87], v7 offset:20480
 v_xor_b32 v8, 98688, v6
 v_mfma_f32_16x16x32_bf16 v[188:191], a[108:111], a[188:191], v[188:191]
 s_waitcnt lgkmcnt(6)
 ds_read_b64_tr_b16 a[88:89], v8 offset:0
 v_mfma_f32_16x16x32_bf16 v[196:199], a[64:67], a[160:163], v[196:199]
 s_and_b32 s58, s92, ~127
 ds_read_b64_tr_b16 a[90:91], v8 offset:4096
 v_mfma_f32_16x16x32_bf16 v[196:199], a[68:71], a[168:171], v[196:199]
 s_lshl_b32 s37, s25, 1
 ds_read_b64_tr_b16 a[92:93], v8 offset:16384
 v_mfma_f32_16x16x32_bf16 v[196:199], a[72:75], a[176:179], v[196:199]
 s_waitcnt lgkmcnt(7)
 ds_read_b64_tr_b16 a[94:95], v8 offset:20480
 v_xor_b32 v9, 33184, v6
 v_mfma_f32_16x16x32_bf16 v[196:199], a[76:79], a[184:187], v[196:199]
 s_sub_i32 s38, 12, s37
 ds_read_b64_tr_b16 a[96:97], v9 offset:0
 v_mfma_f32_16x16x32_bf16 v[204:207], a[64:67], a[164:167], v[204:207]
 s_max_i32 s38, s38, 0
 ds_read_b64_tr_b16 a[98:99], v9 offset:4096
 v_mfma_f32_16x16x32_bf16 v[204:207], a[68:71], a[172:175], v[204:207]
 s_mul_i32 s49, s26, 1048576
 ds_read_b64_tr_b16 a[100:101], v9 offset:16384
 v_mfma_f32_16x16x32_bf16 v[204:207], a[72:75], a[180:183], v[204:207]
 s_lshl_b32 s50, s3, 13
 ds_read_b64_tr_b16 a[102:103], v9 offset:20480
 v_xor_b32 v10, 98720, v6
 v_mfma_f32_16x16x32_bf16 v[204:207], a[76:79], a[188:191], v[204:207]
 s_waitcnt lgkmcnt(6)
 ds_read_b64_tr_b16 a[104:105], v10 offset:0
 v_mfma_f32_16x16x32_bf16 v[212:215], a[80:83], a[160:163], v[212:215]
 s_add_u32 s49, s49, s50
 ds_read_b64_tr_b16 a[106:107], v10 offset:4096
 v_mfma_f32_16x16x32_bf16 v[212:215], a[84:87], a[168:171], v[212:215]
 s_mov_b32 s54, 2
 ds_read_b64_tr_b16 a[108:109], v10 offset:16384
 v_mfma_f32_16x16x32_bf16 v[212:215], a[88:91], a[176:179], v[212:215]
 s_waitcnt lgkmcnt(7)
 ds_read_b64_tr_b16 a[110:111], v10 offset:20480
 v_xor_b32 v7, 33216, v6
 v_mfma_f32_16x16x32_bf16 v[212:215], a[92:95], a[184:187], v[212:215]
 s_sub_u32 s44, 31, s37
 ds_read_b64_tr_b16 a[64:65], v7 offset:0
 v_mfma_f32_16x16x32_bf16 v[220:223], a[80:83], a[164:167], v[220:223]
 s_sub_u32 s44, s44, s38
 ds_read_b64_tr_b16 a[66:67], v7 offset:4096
 v_mfma_f32_16x16x32_bf16 v[220:223], a[84:87], a[172:175], v[220:223]
 s_mul_i32 s55, s38, 32768
 ds_read_b64_tr_b16 a[68:69], v7 offset:16384
 v_mfma_f32_16x16x32_bf16 v[220:223], a[88:91], a[180:183], v[220:223]
 s_add_u32 s42, s55, s49
 ds_read_b64_tr_b16 a[70:71], v7 offset:20480
 v_xor_b32 v8, 98752, v6
 v_mfma_f32_16x16x32_bf16 v[220:223], a[92:95], a[188:191], v[220:223]
 s_waitcnt lgkmcnt(6)
 ds_read_b64_tr_b16 a[72:73], v8 offset:0
 buffer_load_dwordx4 v[32:35], v122, s[4:7], 0 offen
 v_mfma_f32_16x16x32_bf16 v[228:231], a[96:99], a[160:163], v[228:231]
 s_add_u32 s60, s58, 16
 ds_read_b64_tr_b16 a[74:75], v8 offset:4096
 v_mfma_f32_16x16x32_bf16 v[228:231], a[100:103], a[168:171], v[228:231]
 s_sub_u32 s45, 17, s37
 ds_read_b64_tr_b16 a[76:77], v8 offset:16384
 v_mfma_f32_16x16x32_bf16 v[228:231], a[104:107], a[176:179], v[228:231]
 s_waitcnt lgkmcnt(7)
 ds_read_b64_tr_b16 a[78:79], v8 offset:20480
 v_xor_b32 v9, 33248, v6
 v_mfma_f32_16x16x32_bf16 v[228:231], a[108:111], a[184:187], v[228:231]
 ds_read_b64_tr_b16 a[80:81], v9 offset:0
 buffer_load_dwordx4 v[40:43], v123, s[4:7], 0 offen
 v_mfma_f32_16x16x32_bf16 v[236:239], a[96:99], a[164:167], v[236:239]
 s_sub_u32 s66, s42, 32768
 ds_read_b64_tr_b16 a[82:83], v9 offset:4096
 v_mfma_f32_16x16x32_bf16 v[236:239], a[100:103], a[172:175], v[236:239]
 s_add_u32 s42, s49, 491520
 ds_read_b64_tr_b16 a[84:85], v9 offset:16384
 v_mfma_f32_16x16x32_bf16 v[236:239], a[104:107], a[180:183], v[236:239]
 s_add_u32 s67, s49, 524288
 ds_read_b64_tr_b16 a[86:87], v9 offset:20480
 v_xor_b32 v10, 98784, v6
 v_mfma_f32_16x16x32_bf16 v[236:239], a[108:111], a[188:191], v[236:239]
 s_waitcnt lgkmcnt(6)
 ds_read_b64_tr_b16 a[88:89], v10 offset:0
 buffer_load_dwordx4 v[48:51], v128, s[4:7], 0 offen
 v_mfma_f32_16x16x32_bf16 v[244:247], a[64:67], a[160:163], v[244:247]
 s_add_u32 s68, s66, 16777216
 ds_read_b64_tr_b16 a[90:91], v10 offset:4096
 v_mfma_f32_16x16x32_bf16 v[244:247], a[68:71], a[168:171], v[244:247]
 s_waitcnt vmcnt(3)
 ds_read_b64_tr_b16 a[92:93], v10 offset:16384
 v_xor_b32 v7, 131072, v6
 v_mfma_f32_16x16x32_bf16 v[244:247], a[72:75], a[176:179], v[244:247]
 s_waitcnt lgkmcnt(7)
 s_barrier
 ds_read_b64_tr_b16 a[94:95], v10 offset:20480
 v_mfma_f32_16x16x32_bf16 v[244:247], a[76:79], a[184:187], v[244:247]
 ds_read_b64_tr_b16 a[96:97], v7 offset:0
 buffer_load_dwordx4 v[56:59], v120, s[4:7], 0 offen offset:0
 v_mfma_f32_16x16x32_bf16 v[252:255], a[64:67], a[164:167], v[252:255]
 s_add_u32 s69, s67, 16777216
 ds_read_b64_tr_b16 a[98:99], v7 offset:4096
 v_mfma_f32_16x16x32_bf16 v[252:255], a[68:71], a[172:175], v[252:255]
 s_mov_b32 s70, 0xffff8000
 ds_read_b64_tr_b16 a[100:101], v7 offset:16384
 v_mfma_f32_16x16x32_bf16 v[252:255], a[72:75], a[180:183], v[252:255]
 s_mov_b32 s71, s70
 ds_read_b64_tr_b16 a[102:103], v7 offset:20480
 v_xor_b32 v8, 0, v6
 v_mfma_f32_16x16x32_bf16 v[252:255], a[76:79], a[188:191], v[252:255]
 s_waitcnt lgkmcnt(6)
 ds_read_b64_tr_b16 a[104:105], v8 offset:0
 buffer_load_dwordx4 v[64:67], v120, s[4:7], 0 offen offset:896
 v_mfma_f32_16x16x32_bf16 v[16:19], a[80:83], a[160:163], v[16:19]
 s_add_u32 s43, s42, 16777216
 ds_read_b64_tr_b16 a[106:107], v8 offset:4096
 v_mfma_f32_16x16x32_bf16 v[16:19], a[84:87], a[168:171], v[16:19]
 s_mov_b32 s40, s50
 ds_read_b64_tr_b16 a[108:109], v8 offset:16384
 v_mfma_f32_16x16x32_bf16 v[16:19], a[88:91], a[176:179], v[16:19]
 s_waitcnt lgkmcnt(7)
 ds_read_b64_tr_b16 a[110:111], v8 offset:20480
 v_xor_b32 v9, 65536, v6
 v_mfma_f32_16x16x32_bf16 v[16:19], a[92:95], a[184:187], v[16:19]
 ds_read_b64_tr_b16 a[64:65], v9 offset:0
 buffer_load_dwordx4 v[72:75], v120, s[8:11], 0 offen offset:0
 v_mfma_f32_16x16x32_bf16 v[24:27], a[80:83], a[164:167], v[24:27]
 s_add_u32 s41, s50, 0x10000
 ds_read_b64_tr_b16 a[66:67], v9 offset:4096
 v_mfma_f32_16x16x32_bf16 v[24:27], a[84:87], a[172:175], v[24:27]
 s_lshr_b32 s61, s95, 4
 ds_read_b64_tr_b16 a[68:69], v9 offset:16384
 v_mfma_f32_16x16x32_bf16 v[24:27], a[88:91], a[180:183], v[24:27]
 s_lshl_b32 s61, s61, 7
 ds_read_b64_tr_b16 a[70:71], v9 offset:20480
 v_xor_b32 v10, 131104, v6
 v_mfma_f32_16x16x32_bf16 v[24:27], a[92:95], a[188:191], v[24:27]
 s_waitcnt lgkmcnt(6)
 ds_read_b64_tr_b16 a[72:73], v10 offset:0
 buffer_load_dwordx4 v[80:83], v120, s[8:11], 0 offen offset:896
 v_mfma_f32_16x16x32_bf16 v[28:31], a[96:99], a[192:195], v[28:31]
 s_add_u32 s61, s61, 84959232
 ds_read_b64_tr_b16 a[74:75], v10 offset:4096
 v_mfma_f32_16x16x32_bf16 v[28:31], a[100:103], a[200:203], v[28:31]
 s_mov_b32 s47, 0x4b800000
 ds_read_b64_tr_b16 a[76:77], v10 offset:16384
 v_mfma_f32_16x16x32_bf16 v[28:31], a[104:107], a[208:211], v[28:31]
 s_waitcnt lgkmcnt(3)
 ds_read_b64_tr_b16 a[78:79], v10 offset:20480
 v_xor_b32 v7, 32, v6
 v_mfma_f32_16x16x32_bf16 v[28:31], a[108:111], a[216:219], v[28:31]
 ds_read_b64_tr_b16 a[80:81], v7 offset:0
 buffer_load_dwordx4 v[88:91], v121, s[20:23], s39 offen offset:0
 v_mfma_f32_16x16x32_bf16 v[28:31], a[64:67], a[112:115], v[28:31]
 s_lshl_b32 s30, s95, 1
 ds_read_b64_tr_b16 a[82:83], v7 offset:4096
 v_mfma_f32_16x16x32_bf16 v[28:31], a[68:71], a[120:123], v[28:31]
 s_lshr_b32 s31, s3, 1
 ds_read_b64_tr_b16 a[84:85], v7 offset:16384
 v_mfma_f32_16x16x32_bf16 v[44:47], a[96:99], a[196:199], v[44:47]
 s_add_u32 s30, s30, s31
 ds_read_b64_tr_b16 a[86:87], v7 offset:20480
 v_xor_b32 v8, 65568, v6
 v_mfma_f32_16x16x32_bf16 v[44:47], a[100:103], a[204:207], v[44:47]
 ds_read_b64_tr_b16 a[88:89], v8 offset:0
 buffer_load_dwordx4 v[96:99], v121, s[20:23], s39 offen offset:16
 v_mfma_f32_16x16x32_bf16 v[44:47], a[104:107], a[212:215], v[44:47]
 s_min_u32 s30, s30, 223
 ds_read_b64_tr_b16 a[90:91], v8 offset:4096
 v_mfma_f32_16x16x32_bf16 v[44:47], a[108:111], a[220:223], v[44:47]
 s_lshl_b32 s30, s30, 2
 ds_read_b64_tr_b16 a[92:93], v8 offset:16384
 v_mfma_f32_16x16x32_bf16 v[44:47], a[64:67], a[116:119], v[44:47]
 ds_read_b64_tr_b16 a[94:95], v8 offset:20480
 v_xor_b32 v9, 131136, v6
 v_mfma_f32_16x16x32_bf16 v[44:47], a[68:71], a[124:127], v[44:47]
 s_waitcnt lgkmcnt(6)
 ds_read_b64_tr_b16 a[96:97], v9 offset:0
 buffer_load_dwordx4 v[104:107], v121, s[20:23], s39 offen offset:32
 v_mfma_f32_16x16x32_bf16 v[52:55], a[72:75], a[192:195], v[52:55]
 ds_read_b64_tr_b16 a[98:99], v9 offset:4096
 v_mfma_f32_16x16x32_bf16 v[52:55], a[76:79], a[200:203], v[52:55]
 ds_read_b64_tr_b16 a[100:101], v9 offset:16384
 v_mfma_f32_16x16x32_bf16 v[52:55], a[80:83], a[208:211], v[52:55]
 s_waitcnt lgkmcnt(3)
 ds_read_b64_tr_b16 a[102:103], v9 offset:20480
 v_xor_b32 v10, 64, v6
 v_mfma_f32_16x16x32_bf16 v[52:55], a[84:87], a[216:219], v[52:55]
 ds_read_b64_tr_b16 a[104:105], v10 offset:0
 buffer_load_dwordx4 v[112:115], v121, s[20:23], s39 offen offset:48
 v_mfma_f32_16x16x32_bf16 v[52:55], a[88:91], a[112:115], v[52:55]
 ds_read_b64_tr_b16 a[106:107], v10 offset:4096
 v_mfma_f32_16x16x32_bf16 v[52:55], a[92:95], a[120:123], v[52:55]
 ds_read_b64_tr_b16 a[108:109], v10 offset:16384
 v_mfma_f32_16x16x32_bf16 v[60:63], a[72:75], a[196:199], v[60:63]
 ds_read_b64_tr_b16 a[110:111], v10 offset:20480
 v_xor_b32 v7, 65600, v6
 v_mfma_f32_16x16x32_bf16 v[60:63], a[76:79], a[204:207], v[60:63]
 ds_read_b64_tr_b16 a[64:65], v7 offset:0
 v_mfma_f32_16x16x32_bf16 v[60:63], a[80:83], a[212:215], v[60:63]
 s_and_b32 s4, s2, 127
 ds_read_b64_tr_b16 a[66:67], v7 offset:4096
 v_mfma_f32_16x16x32_bf16 v[60:63], a[84:87], a[220:223], v[60:63]
 s_lshl_b32 s4, s4, 2
 ds_read_b64_tr_b16 a[68:69], v7 offset:16384
 v_mfma_f32_16x16x32_bf16 v[60:63], a[88:91], a[116:119], v[60:63]
 s_add_u32 s4, s4, s3
 ds_read_b64_tr_b16 a[70:71], v7 offset:20480
 v_xor_b32 v8, 131168, v6
 v_mfma_f32_16x16x32_bf16 v[60:63], a[92:95], a[124:127], v[60:63]
 s_waitcnt lgkmcnt(6)
 ds_read_b64_tr_b16 a[72:73], v8 offset:0
 v_mfma_f32_16x16x32_bf16 v[20:23], a[96:99], a[192:195], v[20:23]
 s_lshl_b32 s6, s4, 10
 ds_read_b64_tr_b16 a[74:75], v8 offset:4096
 v_mfma_f32_16x16x32_bf16 v[20:23], a[100:103], a[200:203], v[20:23]
 s_add_u32 s6, s6, 83886080
 ds_read_b64_tr_b16 a[76:77], v8 offset:16384
 v_mul_f32 v28, s34, v28
 v_mfma_f32_16x16x32_bf16 v[20:23], a[104:107], a[208:211], v[20:23]
 s_waitcnt lgkmcnt(3)
 ds_read_b64_tr_b16 a[78:79], v8 offset:20480
 v_xor_b32 v9, 96, v6
 v_mfma_f32_16x16x32_bf16 v[20:23], a[108:111], a[216:219], v[20:23]
 s_mul_i32 s4, s4, 17408
 ds_read_b64_tr_b16 a[80:81], v9 offset:0
 v_mul_f32 v29, s34, v29
 v_mfma_f32_16x16x32_bf16 v[20:23], a[64:67], a[112:115], v[20:23]
 s_add_u32 s4, s4, 67108864
 ds_read_b64_tr_b16 a[82:83], v9 offset:4096
 v_mul_f32 v30, s34, v30
 v_mfma_f32_16x16x32_bf16 v[20:23], a[68:71], a[120:123], v[20:23]
 s_add_u32 s5, s4, 0x2000
 ds_read_b64_tr_b16 a[84:85], v9 offset:16384
 v_mul_f32 v31, s34, v31
 v_mfma_f32_16x16x32_bf16 v[36:39], a[96:99], a[196:199], v[36:39]
 s_mov_b32 s7, 0
 ds_read_b64_tr_b16 a[86:87], v9 offset:20480
 v_xor_b32 v10, 65632, v6
 v_mfma_f32_16x16x32_bf16 v[36:39], a[100:103], a[204:207], v[36:39]
 s_mov_b32 s53, 0
 ds_read_b64_tr_b16 a[88:89], v10 offset:0
 v_mul_f32 v52, s34, v52
 v_mfma_f32_16x16x32_bf16 v[36:39], a[104:107], a[212:215], v[36:39]
 s_cmp_eq_u32 s38, 0
 s_cmov_b32 s4, 2.0
 ds_read_b64_tr_b16 a[90:91], v10 offset:4096
 v_mfma_f32_16x16x32_bf16 v[36:39], a[108:111], a[220:223], v[36:39]
 s_cmp_eq_u32 s38, 0
 s_cmov_b32 s5, 2.0
 ds_read_b64_tr_b16 a[92:93], v10 offset:16384
 v_mfma_f32_16x16x32_bf16 v[36:39], a[64:67], a[116:119], v[36:39]
 s_cmp_eq_u32 s38, 0
 s_cmov_b32 s6, 2.0
 ds_read_b64_tr_b16 a[94:95], v10 offset:20480
 v_xor_b32 v7, 131200, v6
 v_mfma_f32_16x16x32_bf16 v[36:39], a[68:71], a[124:127], v[36:39]
 s_waitcnt lgkmcnt(6)
 ds_read_b64_tr_b16 a[96:97], v7 offset:0
 v_mul_f32 v53, s34, v53
 v_mfma_f32_16x16x32_bf16 v[68:71], a[72:75], a[192:195], v[68:71]
 s_mov_b64 s[8:9], s[12:13]
 ds_read_b64_tr_b16 a[98:99], v7 offset:4096
 v_mul_f32 v54, s34, v54
 v_mfma_f32_16x16x32_bf16 v[68:71], a[76:79], a[200:203], v[68:71]
 s_mov_b32 s10, s14
 ds_read_b64_tr_b16 a[100:101], v7 offset:16384
 v_mul_f32 v55, s34, v55
 v_mfma_f32_16x16x32_bf16 v[68:71], a[80:83], a[208:211], v[68:71]
 s_waitcnt lgkmcnt(3)
 ds_read_b64_tr_b16 a[102:103], v7 offset:20480
 v_xor_b32 v8, 128, v6
 v_mfma_f32_16x16x32_bf16 v[68:71], a[84:87], a[216:219], v[68:71]
 s_mov_b32 s76, 0
 ds_read_b64_tr_b16 a[104:105], v8 offset:0
 v_cvt_pk_bf16_f32 v28, v28, v29
 v_mfma_f32_16x16x32_bf16 v[68:71], a[88:91], a[112:115], v[68:71]
 s_movk_i32 s77, 0x1000
 ds_read_b64_tr_b16 a[106:107], v8 offset:4096
 v_cvt_pk_bf16_f32 v29, v30, v31
 v_mfma_f32_16x16x32_bf16 v[68:71], a[92:95], a[120:123], v[68:71]
 s_mov_b32 s51, 0
 ds_read_b64_tr_b16 a[108:109], v8 offset:16384
 v_cvt_pk_bf16_f32 v30, v52, v53
 v_mfma_f32_16x16x32_bf16 v[76:79], a[72:75], a[196:199], v[76:79]
 s_mul_i32 s78, s26, 229376
 ds_read_b64_tr_b16 a[110:111], v8 offset:20480
 v_xor_b32 v9, 65664, v6
 v_mfma_f32_16x16x32_bf16 v[76:79], a[76:79], a[204:207], v[76:79]
 s_add_u32 s79, s78, 28672
 ds_read_b64_tr_b16 a[64:65], v9 offset:0
 v_cvt_pk_bf16_f32 v31, v54, v55
 v_mfma_f32_16x16x32_bf16 v[76:79], a[80:83], a[212:215], v[76:79]
 s_add_u32 s80, s78, 57344
 ds_read_b64_tr_b16 a[66:67], v9 offset:4096
 v_accvgpr_write_b32 a0, v28
 v_mfma_f32_16x16x32_bf16 v[76:79], a[84:87], a[220:223], v[76:79]
 s_add_u32 s81, s78, 86016
 ds_read_b64_tr_b16 a[68:69], v9 offset:16384
 v_accvgpr_write_b32 a1, v29
 v_mfma_f32_16x16x32_bf16 v[76:79], a[88:91], a[116:119], v[76:79]
 s_add_u32 s82, s78, 114688
 ds_read_b64_tr_b16 a[70:71], v9 offset:20480
 v_xor_b32 v10, 131232, v6
 v_mfma_f32_16x16x32_bf16 v[76:79], a[92:95], a[124:127], v[76:79]
 s_waitcnt lgkmcnt(6)
 ds_read_b64_tr_b16 a[72:73], v10 offset:0
 v_accvgpr_write_b32 a2, v30
 v_mfma_f32_16x16x32_bf16 v[84:87], a[96:99], a[192:195], v[84:87]
 s_add_u32 s83, s78, 143360
 ds_read_b64_tr_b16 a[74:75], v10 offset:4096
 v_accvgpr_write_b32 a3, v31
 v_mfma_f32_16x16x32_bf16 v[84:87], a[100:103], a[200:203], v[84:87]
 s_add_u32 s84, s78, 172032
 ds_read_b64_tr_b16 a[76:77], v10 offset:16384
 v_mul_f32 v44, s34, v44
 v_mfma_f32_16x16x32_bf16 v[84:87], a[104:107], a[208:211], v[84:87]
 s_waitcnt lgkmcnt(3)
 ds_read_b64_tr_b16 a[78:79], v10 offset:20480
 v_xor_b32 v7, 160, v6
 v_mfma_f32_16x16x32_bf16 v[84:87], a[108:111], a[216:219], v[84:87]
 s_add_u32 s85, s78, 200704
 ds_read_b64_tr_b16 a[80:81], v7 offset:0
 v_mul_f32 v45, s34, v45
 v_mfma_f32_16x16x32_bf16 v[84:87], a[64:67], a[112:115], v[84:87]
 s_add_u32 s59, s62, 0
 ds_read_b64_tr_b16 a[82:83], v7 offset:4096
 v_mul_f32 v46, s34, v46
 v_mfma_f32_16x16x32_bf16 v[84:87], a[68:71], a[120:123], v[84:87]
 ds_read_b64_tr_b16 a[84:85], v7 offset:16384
 buffer_store_dwordx4 v[28:31], v1, s[12:15], s59 offen offset:0 sc1
 v_mfma_f32_16x16x32_bf16 v[92:95], a[96:99], a[196:199], v[92:95]
 ds_read_b64_tr_b16 a[86:87], v7 offset:20480
 v_xor_b32 v8, 65696, v6
 v_mfma_f32_16x16x32_bf16 v[92:95], a[100:103], a[204:207], v[92:95]
 ds_read_b64_tr_b16 a[88:89], v8 offset:0
 v_mul_f32 v47, s34, v47
 v_mfma_f32_16x16x32_bf16 v[92:95], a[104:107], a[212:215], v[92:95]
 ds_read_b64_tr_b16 a[90:91], v8 offset:4096
 v_mul_f32 v60, s34, v60
 v_mfma_f32_16x16x32_bf16 v[92:95], a[108:111], a[220:223], v[92:95]
 ds_read_b64_tr_b16 a[92:93], v8 offset:16384
 v_mul_f32 v61, s34, v61
 v_mfma_f32_16x16x32_bf16 v[92:95], a[64:67], a[116:119], v[92:95]
 ds_read_b64_tr_b16 a[94:95], v8 offset:20480
 v_xor_b32 v9, 131264, v6
 v_mfma_f32_16x16x32_bf16 v[92:95], a[68:71], a[124:127], v[92:95]
 s_waitcnt lgkmcnt(6)
 ds_read_b64_tr_b16 a[96:97], v9 offset:0
 v_mul_f32 v62, s34, v62
 v_mfma_f32_16x16x32_bf16 v[100:103], a[72:75], a[192:195], v[100:103]
 ds_read_b64_tr_b16 a[98:99], v9 offset:4096
 v_mul_f32 v63, s34, v63
 v_mfma_f32_16x16x32_bf16 v[100:103], a[76:79], a[200:203], v[100:103]
 ds_read_b64_tr_b16 a[100:101], v9 offset:16384
 v_cvt_pk_bf16_f32 v44, v44, v45
 v_mfma_f32_16x16x32_bf16 v[100:103], a[80:83], a[208:211], v[100:103]
 s_waitcnt lgkmcnt(3)
 ds_read_b64_tr_b16 a[102:103], v9 offset:20480
 v_xor_b32 v10, 192, v6
 v_mfma_f32_16x16x32_bf16 v[100:103], a[84:87], a[216:219], v[100:103]
 ds_read_b64_tr_b16 a[104:105], v10 offset:0
 v_cvt_pk_bf16_f32 v45, v46, v47
 v_mfma_f32_16x16x32_bf16 v[100:103], a[88:91], a[112:115], v[100:103]
 ds_read_b64_tr_b16 a[106:107], v10 offset:4096
 v_cvt_pk_bf16_f32 v46, v60, v61
 v_mfma_f32_16x16x32_bf16 v[100:103], a[92:95], a[120:123], v[100:103]
 ds_read_b64_tr_b16 a[108:109], v10 offset:16384
 v_cvt_pk_bf16_f32 v47, v62, v63
 v_mfma_f32_16x16x32_bf16 v[108:111], a[72:75], a[196:199], v[108:111]
 s_add_u32 s59, s62, 8192
 ds_read_b64_tr_b16 a[110:111], v10 offset:20480
 v_xor_b32 v7, 65728, v6
 v_mfma_f32_16x16x32_bf16 v[108:111], a[76:79], a[204:207], v[108:111]
 ds_read_b64_tr_b16 a[64:65], v7 offset:0
 buffer_store_dwordx4 v[44:47], v1, s[12:15], s59 offen offset:0 sc1
 v_mfma_f32_16x16x32_bf16 v[108:111], a[80:83], a[212:215], v[108:111]
 ds_read_b64_tr_b16 a[66:67], v7 offset:4096
 v_accvgpr_write_b32 a32, v44
 v_mfma_f32_16x16x32_bf16 v[108:111], a[84:87], a[220:223], v[108:111]
 ds_read_b64_tr_b16 a[68:69], v7 offset:16384
 v_accvgpr_write_b32 a33, v45
 v_mfma_f32_16x16x32_bf16 v[108:111], a[88:91], a[116:119], v[108:111]
 ds_read_b64_tr_b16 a[70:71], v7 offset:20480
 v_xor_b32 v8, 131296, v6
 v_mfma_f32_16x16x32_bf16 v[108:111], a[92:95], a[124:127], v[108:111]
 s_waitcnt lgkmcnt(6)
 ds_read_b64_tr_b16 a[72:73], v8 offset:0
 v_accvgpr_write_b32 a34, v46
 v_mfma_f32_16x16x32_bf16 v[116:119], a[96:99], a[192:195], v[116:119]
 ds_read_b64_tr_b16 a[74:75], v8 offset:4096
 v_accvgpr_write_b32 a35, v47
 v_mfma_f32_16x16x32_bf16 v[116:119], a[100:103], a[200:203], v[116:119]
 ds_read_b64_tr_b16 a[76:77], v8 offset:16384
 v_mul_f32 v20, s34, v20
 v_mfma_f32_16x16x32_bf16 v[116:119], a[104:107], a[208:211], v[116:119]
 s_waitcnt lgkmcnt(3)
 ds_read_b64_tr_b16 a[78:79], v8 offset:20480
 v_xor_b32 v9, 224, v6
 v_mfma_f32_16x16x32_bf16 v[116:119], a[108:111], a[216:219], v[116:119]
 ds_read_b64_tr_b16 a[80:81], v9 offset:0
 v_mul_f32 v21, s34, v21
 v_mfma_f32_16x16x32_bf16 v[116:119], a[64:67], a[112:115], v[116:119]
 ds_read_b64_tr_b16 a[82:83], v9 offset:4096
 v_mul_f32 v22, s34, v22
 v_mfma_f32_16x16x32_bf16 v[116:119], a[68:71], a[120:123], v[116:119]
 ds_read_b64_tr_b16 a[84:85], v9 offset:16384
 v_mul_f32 v23, s34, v23
 v_mfma_f32_16x16x32_bf16 v[124:127], a[96:99], a[196:199], v[124:127]
 ds_read_b64_tr_b16 a[86:87], v9 offset:20480
 v_xor_b32 v10, 65760, v6
 v_mfma_f32_16x16x32_bf16 v[124:127], a[100:103], a[204:207], v[124:127]
 ds_read_b64_tr_b16 a[88:89], v10 offset:0
 v_mul_f32 v68, s34, v68
 v_mfma_f32_16x16x32_bf16 v[124:127], a[104:107], a[212:215], v[124:127]
 ds_read_b64_tr_b16 a[90:91], v10 offset:4096
 v_mul_f32 v69, s34, v69
 v_mfma_f32_16x16x32_bf16 v[124:127], a[108:111], a[220:223], v[124:127]
 ds_read_b64_tr_b16 a[92:93], v10 offset:16384
 v_mul_f32 v70, s34, v70
 v_mfma_f32_16x16x32_bf16 v[124:127], a[64:67], a[116:119], v[124:127]
 ds_read_b64_tr_b16 a[94:95], v10 offset:20480
 v_xor_b32 v7, 131328, v6
 v_mfma_f32_16x16x32_bf16 v[124:127], a[68:71], a[124:127], v[124:127]
 s_waitcnt lgkmcnt(6)
 ds_read_b64_tr_b16 a[96:97], v7 offset:0
 v_mul_f32 v71, s34, v71
 v_mfma_f32_16x16x32_bf16 v[132:135], a[72:75], a[192:195], v[132:135]
 ds_read_b64_tr_b16 a[98:99], v7 offset:4096
 v_cvt_pk_bf16_f32 v20, v20, v21
 v_mfma_f32_16x16x32_bf16 v[132:135], a[76:79], a[200:203], v[132:135]
 ds_read_b64_tr_b16 a[100:101], v7 offset:16384
 v_cvt_pk_bf16_f32 v21, v22, v23
 v_mfma_f32_16x16x32_bf16 v[132:135], a[80:83], a[208:211], v[132:135]
 s_waitcnt lgkmcnt(3)
 ds_read_b64_tr_b16 a[102:103], v7 offset:20480
 v_xor_b32 v8, 256, v6
 v_mfma_f32_16x16x32_bf16 v[132:135], a[84:87], a[216:219], v[132:135]
 ds_read_b64_tr_b16 a[104:105], v8 offset:0
 v_cvt_pk_bf16_f32 v22, v68, v69
 v_mfma_f32_16x16x32_bf16 v[132:135], a[88:91], a[112:115], v[132:135]
 s_add_u32 s59, s62, 0
 ds_read_b64_tr_b16 a[106:107], v8 offset:4096
 v_cvt_pk_bf16_f32 v23, v70, v71
 v_mfma_f32_16x16x32_bf16 v[132:135], a[92:95], a[120:123], v[132:135]
 ds_read_b64_tr_b16 a[108:109], v8 offset:16384
 buffer_store_dwordx4 v[20:23], v1, s[12:15], s59 offen offset:1024 sc1
 v_mfma_f32_16x16x32_bf16 v[140:143], a[72:75], a[196:199], v[140:143]
 ds_read_b64_tr_b16 a[110:111], v8 offset:20480
 v_xor_b32 v9, 65792, v6
 v_mfma_f32_16x16x32_bf16 v[140:143], a[76:79], a[204:207], v[140:143]
 ds_read_b64_tr_b16 a[64:65], v9 offset:0
 v_accvgpr_write_b32 a4, v20
 v_mfma_f32_16x16x32_bf16 v[140:143], a[80:83], a[212:215], v[140:143]
 ds_read_b64_tr_b16 a[66:67], v9 offset:4096
 v_accvgpr_write_b32 a5, v21
 v_mfma_f32_16x16x32_bf16 v[140:143], a[84:87], a[220:223], v[140:143]
 ds_read_b64_tr_b16 a[68:69], v9 offset:16384
 v_accvgpr_write_b32 a6, v22
 v_mfma_f32_16x16x32_bf16 v[140:143], a[88:91], a[116:119], v[140:143]
 ds_read_b64_tr_b16 a[70:71], v9 offset:20480
 v_xor_b32 v10, 131360, v6
 v_mfma_f32_16x16x32_bf16 v[140:143], a[92:95], a[124:127], v[140:143]
 s_waitcnt lgkmcnt(6)
 ds_read_b64_tr_b16 a[72:73], v10 offset:0
 v_accvgpr_write_b32 a7, v23
 v_mfma_f32_16x16x32_bf16 v[148:151], a[96:99], a[192:195], v[148:151]
 ds_read_b64_tr_b16 a[74:75], v10 offset:4096
 v_mul_f32 v36, s34, v36
 v_mfma_f32_16x16x32_bf16 v[148:151], a[100:103], a[200:203], v[148:151]
 ds_read_b64_tr_b16 a[76:77], v10 offset:16384
 v_mul_f32 v37, s34, v37
 v_mfma_f32_16x16x32_bf16 v[148:151], a[104:107], a[208:211], v[148:151]
 s_waitcnt lgkmcnt(3)
 ds_read_b64_tr_b16 a[78:79], v10 offset:20480
 v_xor_b32 v7, 288, v6
 v_mfma_f32_16x16x32_bf16 v[148:151], a[108:111], a[216:219], v[148:151]
 ds_read_b64_tr_b16 a[80:81], v7 offset:0
 v_mul_f32 v38, s34, v38
 v_mfma_f32_16x16x32_bf16 v[148:151], a[64:67], a[112:115], v[148:151]
 ds_read_b64_tr_b16 a[82:83], v7 offset:4096
 v_mul_f32 v39, s34, v39
 v_mfma_f32_16x16x32_bf16 v[148:151], a[68:71], a[120:123], v[148:151]
 ds_read_b64_tr_b16 a[84:85], v7 offset:16384
 v_mul_f32 v76, s34, v76
 v_mfma_f32_16x16x32_bf16 v[156:159], a[96:99], a[196:199], v[156:159]
 ds_read_b64_tr_b16 a[86:87], v7 offset:20480
 v_xor_b32 v8, 65824, v6
 v_mfma_f32_16x16x32_bf16 v[156:159], a[100:103], a[204:207], v[156:159]
 ds_read_b64_tr_b16 a[88:89], v8 offset:0
 v_mul_f32 v77, s34, v77
 v_mfma_f32_16x16x32_bf16 v[156:159], a[104:107], a[212:215], v[156:159]
 ds_read_b64_tr_b16 a[90:91], v8 offset:4096
 v_mul_f32 v78, s34, v78
 v_mfma_f32_16x16x32_bf16 v[156:159], a[108:111], a[220:223], v[156:159]
 ds_read_b64_tr_b16 a[92:93], v8 offset:16384
 v_mul_f32 v79, s34, v79
 v_mfma_f32_16x16x32_bf16 v[156:159], a[64:67], a[116:119], v[156:159]
 ds_read_b64_tr_b16 a[94:95], v8 offset:20480
 v_xor_b32 v9, 131392, v6
 v_mfma_f32_16x16x32_bf16 v[156:159], a[68:71], a[124:127], v[156:159]
 s_waitcnt lgkmcnt(6)
 ds_read_b64_tr_b16 a[96:97], v9 offset:0
 v_cvt_pk_bf16_f32 v36, v36, v37
 v_mfma_f32_16x16x32_bf16 v[164:167], a[72:75], a[192:195], v[164:167]
 ds_read_b64_tr_b16 a[98:99], v9 offset:4096
 v_cvt_pk_bf16_f32 v37, v38, v39
 v_mfma_f32_16x16x32_bf16 v[164:167], a[76:79], a[200:203], v[164:167]
 ds_read_b64_tr_b16 a[100:101], v9 offset:16384
 v_cvt_pk_bf16_f32 v38, v76, v77
 v_mfma_f32_16x16x32_bf16 v[164:167], a[80:83], a[208:211], v[164:167]
 s_waitcnt lgkmcnt(3)
 ds_read_b64_tr_b16 a[102:103], v9 offset:20480
 v_xor_b32 v10, 320, v6
 v_mfma_f32_16x16x32_bf16 v[164:167], a[84:87], a[216:219], v[164:167]
 s_add_u32 s59, s62, 8192
 ds_read_b64_tr_b16 a[104:105], v10 offset:0
 v_cvt_pk_bf16_f32 v39, v78, v79
 v_mfma_f32_16x16x32_bf16 v[164:167], a[88:91], a[112:115], v[164:167]
 ds_read_b64_tr_b16 a[106:107], v10 offset:4096
 buffer_store_dwordx4 v[36:39], v1, s[12:15], s59 offen offset:1024 sc1
 v_mfma_f32_16x16x32_bf16 v[164:167], a[92:95], a[120:123], v[164:167]
 ds_read_b64_tr_b16 a[108:109], v10 offset:16384
 v_accvgpr_write_b32 a36, v36
 v_mfma_f32_16x16x32_bf16 v[172:175], a[72:75], a[196:199], v[172:175]
 ds_read_b64_tr_b16 a[110:111], v10 offset:20480
 v_xor_b32 v7, 65856, v6
 v_mfma_f32_16x16x32_bf16 v[172:175], a[76:79], a[204:207], v[172:175]
 ds_read_b64_tr_b16 a[64:65], v7 offset:0
 v_accvgpr_write_b32 a37, v37
 v_mfma_f32_16x16x32_bf16 v[172:175], a[80:83], a[212:215], v[172:175]
 ds_read_b64_tr_b16 a[66:67], v7 offset:4096
 v_accvgpr_write_b32 a38, v38
 v_mfma_f32_16x16x32_bf16 v[172:175], a[84:87], a[220:223], v[172:175]
 ds_read_b64_tr_b16 a[68:69], v7 offset:16384
 v_accvgpr_write_b32 a39, v39
 v_mfma_f32_16x16x32_bf16 v[172:175], a[88:91], a[116:119], v[172:175]
 ds_read_b64_tr_b16 a[70:71], v7 offset:20480
 v_xor_b32 v8, 131424, v6
 v_mfma_f32_16x16x32_bf16 v[172:175], a[92:95], a[124:127], v[172:175]
 s_waitcnt lgkmcnt(6)
 ds_read_b64_tr_b16 a[72:73], v8 offset:0
 v_mul_f32 v84, s34, v84
 v_mfma_f32_16x16x32_bf16 v[180:183], a[96:99], a[192:195], v[180:183]
 ds_read_b64_tr_b16 a[74:75], v8 offset:4096
 v_mul_f32 v85, s34, v85
 v_mfma_f32_16x16x32_bf16 v[180:183], a[100:103], a[200:203], v[180:183]
 ds_read_b64_tr_b16 a[76:77], v8 offset:16384
 v_mul_f32 v86, s34, v86
 v_mfma_f32_16x16x32_bf16 v[180:183], a[104:107], a[208:211], v[180:183]
 s_waitcnt lgkmcnt(3)
 ds_read_b64_tr_b16 a[78:79], v8 offset:20480
 v_xor_b32 v9, 352, v6
 v_mfma_f32_16x16x32_bf16 v[180:183], a[108:111], a[216:219], v[180:183]
 ds_read_b64_tr_b16 a[80:81], v9 offset:0
 v_mul_f32 v87, s34, v87
 v_mfma_f32_16x16x32_bf16 v[180:183], a[64:67], a[112:115], v[180:183]
 ds_read_b64_tr_b16 a[82:83], v9 offset:4096
 v_mul_f32 v100, s34, v100
 v_mfma_f32_16x16x32_bf16 v[180:183], a[68:71], a[120:123], v[180:183]
 ds_read_b64_tr_b16 a[84:85], v9 offset:16384
 v_mul_f32 v101, s34, v101
 v_mfma_f32_16x16x32_bf16 v[188:191], a[96:99], a[196:199], v[188:191]
 ds_read_b64_tr_b16 a[86:87], v9 offset:20480
 v_xor_b32 v10, 65888, v6
 v_mfma_f32_16x16x32_bf16 v[188:191], a[100:103], a[204:207], v[188:191]
 ds_read_b64_tr_b16 a[88:89], v10 offset:0
 v_mul_f32 v102, s34, v102
 v_mfma_f32_16x16x32_bf16 v[188:191], a[104:107], a[212:215], v[188:191]
 ds_read_b64_tr_b16 a[90:91], v10 offset:4096
 v_mul_f32 v103, s34, v103
 v_mfma_f32_16x16x32_bf16 v[188:191], a[108:111], a[220:223], v[188:191]
 ds_read_b64_tr_b16 a[92:93], v10 offset:16384
 v_cvt_pk_bf16_f32 v84, v84, v85
 v_mfma_f32_16x16x32_bf16 v[188:191], a[64:67], a[116:119], v[188:191]
 ds_read_b64_tr_b16 a[94:95], v10 offset:20480
 v_xor_b32 v7, 131456, v6
 v_mfma_f32_16x16x32_bf16 v[188:191], a[68:71], a[124:127], v[188:191]
 s_waitcnt lgkmcnt(6)
 ds_read_b64_tr_b16 a[96:97], v7 offset:0
 v_cvt_pk_bf16_f32 v85, v86, v87
 v_mfma_f32_16x16x32_bf16 v[196:199], a[72:75], a[192:195], v[196:199]
 ds_read_b64_tr_b16 a[98:99], v7 offset:4096
 v_cvt_pk_bf16_f32 v86, v100, v101
 v_mfma_f32_16x16x32_bf16 v[196:199], a[76:79], a[200:203], v[196:199]
 s_add_u32 s59, s62, 0
 ds_read_b64_tr_b16 a[100:101], v7 offset:16384
 v_cvt_pk_bf16_f32 v87, v102, v103
 v_mfma_f32_16x16x32_bf16 v[196:199], a[80:83], a[208:211], v[196:199]
 s_waitcnt lgkmcnt(3)
 ds_read_b64_tr_b16 a[102:103], v7 offset:20480
 v_xor_b32 v8, 384, v6
 v_mfma_f32_16x16x32_bf16 v[196:199], a[84:87], a[216:219], v[196:199]
 ds_read_b64_tr_b16 a[104:105], v8 offset:0
 buffer_store_dwordx4 v[84:87], v1, s[12:15], s59 offen offset:2048 sc1
 v_mfma_f32_16x16x32_bf16 v[196:199], a[88:91], a[112:115], v[196:199]
 ds_read_b64_tr_b16 a[106:107], v8 offset:4096
 v_accvgpr_write_b32 a8, v84
 v_mfma_f32_16x16x32_bf16 v[196:199], a[92:95], a[120:123], v[196:199]
 ds_read_b64_tr_b16 a[108:109], v8 offset:16384
 v_accvgpr_write_b32 a9, v85
 v_mfma_f32_16x16x32_bf16 v[204:207], a[72:75], a[196:199], v[204:207]
 ds_read_b64_tr_b16 a[110:111], v8 offset:20480
 v_xor_b32 v9, 65920, v6
 v_mfma_f32_16x16x32_bf16 v[204:207], a[76:79], a[204:207], v[204:207]
 ds_read_b64_tr_b16 a[64:65], v9 offset:0
 v_accvgpr_write_b32 a10, v86
 v_mfma_f32_16x16x32_bf16 v[204:207], a[80:83], a[212:215], v[204:207]
 ds_read_b64_tr_b16 a[66:67], v9 offset:4096
 v_accvgpr_write_b32 a11, v87
 v_mfma_f32_16x16x32_bf16 v[204:207], a[84:87], a[220:223], v[204:207]
 ds_read_b64_tr_b16 a[68:69], v9 offset:16384
 v_mul_f32 v92, s34, v92
 v_mfma_f32_16x16x32_bf16 v[204:207], a[88:91], a[116:119], v[204:207]
 ds_read_b64_tr_b16 a[70:71], v9 offset:20480
 v_xor_b32 v10, 131488, v6
 v_mfma_f32_16x16x32_bf16 v[204:207], a[92:95], a[124:127], v[204:207]
 s_waitcnt lgkmcnt(6)
 ds_read_b64_tr_b16 a[72:73], v10 offset:0
 v_mul_f32 v93, s34, v93
 v_mfma_f32_16x16x32_bf16 v[212:215], a[96:99], a[192:195], v[212:215]
 ds_read_b64_tr_b16 a[74:75], v10 offset:4096
 v_mul_f32 v94, s34, v94
 v_mfma_f32_16x16x32_bf16 v[212:215], a[100:103], a[200:203], v[212:215]
 ds_read_b64_tr_b16 a[76:77], v10 offset:16384
 v_mul_f32 v95, s34, v95
 v_mfma_f32_16x16x32_bf16 v[212:215], a[104:107], a[208:211], v[212:215]
 s_waitcnt lgkmcnt(3)
 ds_read_b64_tr_b16 a[78:79], v10 offset:20480
 v_xor_b32 v7, 416, v6
 v_mfma_f32_16x16x32_bf16 v[212:215], a[108:111], a[216:219], v[212:215]
 ds_read_b64_tr_b16 a[80:81], v7 offset:0
 v_mul_f32 v108, s34, v108
 v_mfma_f32_16x16x32_bf16 v[212:215], a[64:67], a[112:115], v[212:215]
 ds_read_b64_tr_b16 a[82:83], v7 offset:4096
 v_mul_f32 v109, s34, v109
 v_mfma_f32_16x16x32_bf16 v[212:215], a[68:71], a[120:123], v[212:215]
 ds_read_b64_tr_b16 a[84:85], v7 offset:16384
 v_mul_f32 v110, s34, v110
 v_mfma_f32_16x16x32_bf16 v[220:223], a[96:99], a[196:199], v[220:223]
 ds_read_b64_tr_b16 a[86:87], v7 offset:20480
 v_xor_b32 v8, 65952, v6
 v_mfma_f32_16x16x32_bf16 v[220:223], a[100:103], a[204:207], v[220:223]
 ds_read_b64_tr_b16 a[88:89], v8 offset:0
 v_mul_f32 v111, s34, v111
 v_mfma_f32_16x16x32_bf16 v[220:223], a[104:107], a[212:215], v[220:223]
 ds_read_b64_tr_b16 a[90:91], v8 offset:4096
 v_cvt_pk_bf16_f32 v92, v92, v93
 v_mfma_f32_16x16x32_bf16 v[220:223], a[108:111], a[220:223], v[220:223]
 ds_read_b64_tr_b16 a[92:93], v8 offset:16384
 v_cvt_pk_bf16_f32 v93, v94, v95
 v_mfma_f32_16x16x32_bf16 v[220:223], a[64:67], a[116:119], v[220:223]
 ds_read_b64_tr_b16 a[94:95], v8 offset:20480
 v_xor_b32 v9, 131520, v6
 v_mfma_f32_16x16x32_bf16 v[220:223], a[68:71], a[124:127], v[220:223]
 s_waitcnt lgkmcnt(6)
 ds_read_b64_tr_b16 a[96:97], v9 offset:0
 v_cvt_pk_bf16_f32 v94, v108, v109
 v_mfma_f32_16x16x32_bf16 v[228:231], a[72:75], a[192:195], v[228:231]
 s_add_u32 s59, s62, 8192
 ds_read_b64_tr_b16 a[98:99], v9 offset:4096
 v_cvt_pk_bf16_f32 v95, v110, v111
 v_mfma_f32_16x16x32_bf16 v[228:231], a[76:79], a[200:203], v[228:231]
 ds_read_b64_tr_b16 a[100:101], v9 offset:16384
 buffer_store_dwordx4 v[92:95], v1, s[12:15], s59 offen offset:2048 sc1
 v_mfma_f32_16x16x32_bf16 v[228:231], a[80:83], a[208:211], v[228:231]
 s_waitcnt lgkmcnt(3)
 ds_read_b64_tr_b16 a[102:103], v9 offset:20480
 v_xor_b32 v10, 448, v6
 v_mfma_f32_16x16x32_bf16 v[228:231], a[84:87], a[216:219], v[228:231]
 ds_read_b64_tr_b16 a[104:105], v10 offset:0
 v_accvgpr_write_b32 a40, v92
 v_mfma_f32_16x16x32_bf16 v[228:231], a[88:91], a[112:115], v[228:231]
 ds_read_b64_tr_b16 a[106:107], v10 offset:4096
 v_accvgpr_write_b32 a41, v93
 v_mfma_f32_16x16x32_bf16 v[228:231], a[92:95], a[120:123], v[228:231]
 ds_read_b64_tr_b16 a[108:109], v10 offset:16384
 v_accvgpr_write_b32 a42, v94
 v_mfma_f32_16x16x32_bf16 v[236:239], a[72:75], a[196:199], v[236:239]
 ds_read_b64_tr_b16 a[110:111], v10 offset:20480
 v_xor_b32 v7, 65984, v6
 v_mfma_f32_16x16x32_bf16 v[236:239], a[76:79], a[204:207], v[236:239]
 ds_read_b64_tr_b16 a[64:65], v7 offset:0
 buffer_load_dword v13, v12, s[12:15], s58 offen sc1
 v_mfma_f32_16x16x32_bf16 v[236:239], a[80:83], a[212:215], v[236:239]
 ds_read_b64_tr_b16 a[66:67], v7 offset:4096
 v_accvgpr_write_b32 a43, v95
 v_mfma_f32_16x16x32_bf16 v[236:239], a[84:87], a[220:223], v[236:239]
 ds_read_b64_tr_b16 a[68:69], v7 offset:16384
 v_mul_f32 v116, s34, v116
 v_mfma_f32_16x16x32_bf16 v[236:239], a[88:91], a[116:119], v[236:239]
 ds_read_b64_tr_b16 a[70:71], v7 offset:20480
 v_xor_b32 v8, 131552, v6
 v_mfma_f32_16x16x32_bf16 v[236:239], a[92:95], a[124:127], v[236:239]
 s_waitcnt lgkmcnt(6)
 ds_read_b64_tr_b16 a[72:73], v8 offset:0
 v_mul_f32 v117, s34, v117
 v_mfma_f32_16x16x32_bf16 v[244:247], a[96:99], a[192:195], v[244:247]
 ds_read_b64_tr_b16 a[74:75], v8 offset:4096
 v_mul_f32 v118, s34, v118
 v_mfma_f32_16x16x32_bf16 v[244:247], a[100:103], a[200:203], v[244:247]
 ds_read_b64_tr_b16 a[76:77], v8 offset:16384
 v_mul_f32 v119, s34, v119
 v_mfma_f32_16x16x32_bf16 v[244:247], a[104:107], a[208:211], v[244:247]
 s_waitcnt lgkmcnt(3)
 ds_read_b64_tr_b16 a[78:79], v8 offset:20480
 v_xor_b32 v9, 480, v6
 v_mfma_f32_16x16x32_bf16 v[244:247], a[108:111], a[216:219], v[244:247]
 ds_read_b64_tr_b16 a[80:81], v9 offset:0
 v_mul_f32 v132, s34, v132
 v_mfma_f32_16x16x32_bf16 v[244:247], a[64:67], a[112:115], v[244:247]
 ds_read_b64_tr_b16 a[82:83], v9 offset:4096
 v_mul_f32 v133, s34, v133
 v_mfma_f32_16x16x32_bf16 v[244:247], a[68:71], a[120:123], v[244:247]
 ds_read_b64_tr_b16 a[84:85], v9 offset:16384
 v_mul_f32 v134, s34, v134
 v_mfma_f32_16x16x32_bf16 v[252:255], a[96:99], a[196:199], v[252:255]
 ds_read_b64_tr_b16 a[86:87], v9 offset:20480
 v_xor_b32 v10, 66016, v6
 v_mfma_f32_16x16x32_bf16 v[252:255], a[100:103], a[204:207], v[252:255]
 ds_read_b64_tr_b16 a[88:89], v10 offset:0
 v_mul_f32 v135, s34, v135
 v_mfma_f32_16x16x32_bf16 v[252:255], a[104:107], a[212:215], v[252:255]
 ds_read_b64_tr_b16 a[90:91], v10 offset:4096
 v_cvt_pk_bf16_f32 v116, v116, v117
 v_mfma_f32_16x16x32_bf16 v[252:255], a[108:111], a[220:223], v[252:255]
 ds_read_b64_tr_b16 a[92:93], v10 offset:16384
 v_cvt_pk_bf16_f32 v117, v118, v119
 v_mfma_f32_16x16x32_bf16 v[252:255], a[64:67], a[116:119], v[252:255]
 s_add_u32 s59, s62, 0
 ds_read_b64_tr_b16 a[94:95], v10 offset:20480
 v_cvt_pk_bf16_f32 v118, v132, v133
 v_mfma_f32_16x16x32_bf16 v[252:255], a[68:71], a[124:127], v[252:255]
 s_waitcnt lgkmcnt(6)
 v_cvt_pk_bf16_f32 v119, v134, v135
 v_accvgpr_write_b32 a12, v116
 v_mfma_f32_16x16x32_bf16 v[16:19], a[72:75], a[192:195], v[16:19]
 buffer_store_dwordx4 v[116:119], v1, s[12:15], s59 offen offset:3072 sc1
 v_mfma_f32_16x16x32_bf16 v[16:19], a[76:79], a[200:203], v[16:19]
 v_accvgpr_write_b32 a13, v117
 v_accvgpr_write_b32 a14, v118
 v_mfma_f32_16x16x32_bf16 v[16:19], a[80:83], a[208:211], v[16:19]
 s_waitcnt lgkmcnt(0)
 v_accvgpr_write_b32 a15, v119
 v_mfma_f32_16x16x32_bf16 v[16:19], a[84:87], a[216:219], v[16:19]
 v_mfma_f32_16x16x32_bf16 v[16:19], a[88:91], a[112:115], v[16:19]
 v_mfma_f32_16x16x32_bf16 v[16:19], a[92:95], a[120:123], v[16:19]
 v_mfma_f32_16x16x32_bf16 v[24:27], a[72:75], a[196:199], v[24:27]
 v_mfma_f32_16x16x32_bf16 v[24:27], a[76:79], a[204:207], v[24:27]
 v_mfma_f32_16x16x32_bf16 v[24:27], a[80:83], a[212:215], v[24:27]
 v_mfma_f32_16x16x32_bf16 v[24:27], a[84:87], a[220:223], v[24:27]
 s_waitcnt lgkmcnt(0)
 v_mfma_f32_16x16x32_bf16 v[24:27], a[88:91], a[116:119], v[24:27]
 s_barrier
 v_mfma_f32_16x16x32_bf16 v[24:27], a[92:95], a[124:127], v[24:27]
 s_waitcnt vmcnt(1)
 v_cmp_ne_u32 s[16:17], 0, v13
 v_cmp_gt_u32 vcc, 256, v5
 s_or_b64 vcc, vcc, s[16:17]
 s_mov_b32 m0, s40
 s_cselect_b32 s48, 0, 1
 s_cselect_b32 s52, 2.0, s42
 buffer_load_dwordx4 v1, s[12:15], s52 offen offset:0 sc1 lds
 v_pk_mul_f32 v[124:125], v[124:125], s[34:35]
 v_pk_mul_f32 v[126:127], v[126:127], s[34:35]
 v_pk_mul_f32 v[140:141], v[140:141], s[34:35]
 v_pk_mul_f32 v[142:143], v[142:143], s[34:35]
 v_cvt_pk_bf16_f32 v124, v124, v125
 v_cvt_pk_bf16_f32 v125, v126, v127
 v_cvt_pk_bf16_f32 v126, v140, v141
 v_cvt_pk_bf16_f32 v127, v142, v143
 s_add_u32 s59, s62, 8192
 buffer_store_dwordx4 v[124:127], v1, s[12:15], s59 offen offset:3072 sc1
 v_accvgpr_write_b32 a44, v124
 v_accvgpr_write_b32 a45, v125
 v_accvgpr_write_b32 a46, v126
 v_accvgpr_write_b32 a47, v127
 v_pk_mul_f32 v[148:149], v[148:149], s[34:35]
 v_pk_mul_f32 v[150:151], v[150:151], s[34:35]
 buffer_load_dwordx4 v1, s[12:15], s52 offen offset:1024 sc1 lds
 v_pk_mul_f32 v[164:165], v[164:165], s[34:35]
 v_pk_mul_f32 v[166:167], v[166:167], s[34:35]
 v_cvt_pk_bf16_f32 v148, v148, v149
 v_cvt_pk_bf16_f32 v149, v150, v151
 v_cvt_pk_bf16_f32 v150, v164, v165
 v_cvt_pk_bf16_f32 v151, v166, v167
 s_add_u32 s59, s62, 4096
 buffer_store_dwordx4 v[148:151], v1, s[12:15], s59 offen offset:0 sc1
 v_accvgpr_write_b32 a16, v148
 v_accvgpr_write_b32 a17, v149
 v_accvgpr_write_b32 a18, v150
 v_accvgpr_write_b32 a19, v151
 v_pk_mul_f32 v[156:157], v[156:157], s[34:35]
 v_pk_mul_f32 v[158:159], v[158:159], s[34:35]
 v_pk_mul_f32 v[172:173], v[172:173], s[34:35]
 v_pk_mul_f32 v[174:175], v[174:175], s[34:35]
 buffer_load_dwordx4 v1, s[12:15], s52 offen offset:2048 sc1 lds
 v_cvt_pk_bf16_f32 v156, v156, v157
 v_cvt_pk_bf16_f32 v157, v158, v159
 v_cvt_pk_bf16_f32 v158, v172, v173
 v_cvt_pk_bf16_f32 v159, v174, v175
 s_add_u32 s59, s62, 12288
 buffer_store_dwordx4 v[156:159], v1, s[12:15], s59 offen offset:0 sc1
 v_accvgpr_write_b32 a48, v156
 v_accvgpr_write_b32 a49, v157
 v_accvgpr_write_b32 a50, v158
 v_accvgpr_write_b32 a51, v159
 v_pk_mul_f32 v[180:181], v[180:181], s[34:35]
 v_pk_mul_f32 v[182:183], v[182:183], s[34:35]
 v_pk_mul_f32 v[196:197], v[196:197], s[34:35]
 v_pk_mul_f32 v[198:199], v[198:199], s[34:35]
 v_cvt_pk_bf16_f32 v180, v180, v181
 v_cvt_pk_bf16_f32 v181, v182, v183
 buffer_load_dwordx4 v1, s[12:15], s52 offen offset:3072 sc1 lds
 v_cvt_pk_bf16_f32 v182, v196, v197
 v_cvt_pk_bf16_f32 v183, v198, v199
 s_add_u32 s59, s62, 4096
 buffer_store_dwordx4 v[180:183], v1, s[12:15], s59 offen offset:1024 sc1
 v_accvgpr_write_b32 a20, v180
 v_accvgpr_write_b32 a21, v181
 v_accvgpr_write_b32 a22, v182
 v_accvgpr_write_b32 a23, v183
 v_pk_mul_f32 v[188:189], v[188:189], s[34:35]
 v_pk_mul_f32 v[190:191], v[190:191], s[34:35]
 v_pk_mul_f32 v[204:205], v[204:205], s[34:35]
 v_pk_mul_f32 v[206:207], v[206:207], s[34:35]
 v_cvt_pk_bf16_f32 v188, v188, v189
 v_cvt_pk_bf16_f32 v189, v190, v191
 v_cvt_pk_bf16_f32 v190, v204, v205
 s_bitset1_b32 m0, 12
 s_nop 0
 buffer_load_dwordx4 v4, s[12:15], s52 offen offset:0 sc1 lds
 v_cvt_pk_bf16_f32 v191, v206, v207
 s_add_u32 s59, s62, 12288
 buffer_store_dwordx4 v[188:191], v1, s[12:15], s59 offen offset:1024 sc1
 v_accvgpr_write_b32 a52, v188
 v_accvgpr_write_b32 a53, v189
 v_accvgpr_write_b32 a54, v190
 v_accvgpr_write_b32 a55, v191
 v_pk_mul_f32 v[212:213], v[212:213], s[34:35]
 v_pk_mul_f32 v[214:215], v[214:215], s[34:35]
 v_pk_mul_f32 v[228:229], v[228:229], s[34:35]
 v_pk_mul_f32 v[230:231], v[230:231], s[34:35]
 v_cvt_pk_bf16_f32 v212, v212, v213
 v_cvt_pk_bf16_f32 v213, v214, v215
 v_cvt_pk_bf16_f32 v214, v228, v229
 v_cvt_pk_bf16_f32 v215, v230, v231
 s_add_u32 s59, s62, 4096
 buffer_load_dwordx4 v4, s[12:15], s52 offen offset:1024 sc1 lds
 buffer_store_dwordx4 v[212:215], v1, s[12:15], s59 offen offset:2048 sc1
 v_accvgpr_write_b32 a24, v212
 v_accvgpr_write_b32 a25, v213
 v_accvgpr_write_b32 a26, v214
 v_accvgpr_write_b32 a27, v215
 v_pk_mul_f32 v[220:221], v[220:221], s[34:35]
 v_pk_mul_f32 v[222:223], v[222:223], s[34:35]
 v_pk_mul_f32 v[236:237], v[236:237], s[34:35]
 v_pk_mul_f32 v[238:239], v[238:239], s[34:35]
 v_cvt_pk_bf16_f32 v220, v220, v221
 v_cvt_pk_bf16_f32 v221, v222, v223
 v_cvt_pk_bf16_f32 v222, v236, v237
 v_cvt_pk_bf16_f32 v223, v238, v239
 s_add_u32 s59, s62, 12288
 buffer_store_dwordx4 v[220:223], v1, s[12:15], s59 offen offset:2048 sc1
 v_accvgpr_write_b32 a56, v220
 buffer_load_dwordx4 v4, s[12:15], s52 offen offset:2048 sc1 lds
 v_accvgpr_write_b32 a57, v221
 v_accvgpr_write_b32 a58, v222
 v_accvgpr_write_b32 a59, v223
 v_pk_mul_f32 v[244:245], v[244:245], s[34:35]
 v_pk_mul_f32 v[246:247], v[246:247], s[34:35]
 v_pk_mul_f32 v[16:17], v[16:17], s[34:35]
 v_pk_mul_f32 v[18:19], v[18:19], s[34:35]
 v_cvt_pk_bf16_f32 v244, v244, v245
 v_cvt_pk_bf16_f32 v245, v246, v247
 v_cvt_pk_bf16_f32 v246, v16, v17
 v_cvt_pk_bf16_f32 v247, v18, v19
 s_add_u32 s59, s62, 4096
 buffer_store_dwordx4 v[244:247], v1, s[12:15], s59 offen offset:3072 sc1
 v_accvgpr_write_b32 a28, v244
 v_accvgpr_write_b32 a29, v245
 v_accvgpr_write_b32 a30, v246
 buffer_load_dwordx4 v4, s[12:15], s52 offen offset:3072 sc1 lds
 v_accvgpr_write_b32 a31, v247
 v_pk_mul_f32 v[252:253], v[252:253], s[34:35]
 v_pk_mul_f32 v[254:255], v[254:255], s[34:35]
 v_pk_mul_f32 v[24:25], v[24:25], s[34:35]
 v_pk_mul_f32 v[26:27], v[26:27], s[34:35]
 v_cvt_pk_bf16_f32 v252, v252, v253
 v_cvt_pk_bf16_f32 v253, v254, v255
 v_cvt_pk_bf16_f32 v254, v24, v25
 v_cvt_pk_bf16_f32 v255, v26, v27
 s_add_u32 s59, s62, 12288
 buffer_store_dwordx4 v[252:255], v1, s[12:15], s59 offen offset:3072 sc1
 v_accvgpr_write_b32 a60, v252
 v_accvgpr_write_b32 a61, v253
 v_accvgpr_write_b32 a62, v254
 v_accvgpr_write_b32 a63, v255
 s_branch L_kvdone
L_late1:
 v_mfma_f32_16x16x32_bf16 v[16:19], a[96:99], a[0:3], v[16:19]
 ds_read_b64_tr_b16 a[28:29], v9 offset:49152
 v_mfma_f32_16x16x32_bf16 v[16:19], a[100:103], a[4:7], v[16:19]
 s_add_u32 m0, s33, 0xfffffd00
 ds_read_b64_tr_b16 a[30:31], v9 offset:53248
 v_mfma_f32_16x16x32_bf16 v[20:23], a[108:111], a[4:7], v[20:23]
 s_waitcnt lgkmcnt(15)
 ds_read_b128 a[64:67], v4 offset:32768
 v_mfma_f32_16x16x32_bf16 v[20:23], a[104:107], a[0:3], v[20:23]
 buffer_load_dwordx4 v15, s[20:23], 0 offen offset:768 lds
 v_mfma_f32_16x16x32_bf16 v[24:27], a[112:115], a[0:3], v[24:27]
 s_waitcnt lgkmcnt(13)
 ds_read_b128 a[68:71], v5 offset:32768
 v_mfma_f32_16x16x32_bf16 v[24:27], a[116:119], a[4:7], v[24:27]
 v_mfma_f32_16x16x32_bf16 v[28:31], a[124:127], a[4:7], v[28:31]
 s_add_u32 m0, s33, 0xfffffd80
 ds_read_b128 a[76:79], v5 offset:34816
 v_mfma_f32_16x16x32_bf16 v[28:31], a[120:123], a[0:3], v[28:31]
 s_waitcnt lgkmcnt(11)
 buffer_load_dwordx4 v15, s[20:23], 0 offen offset:1664 lds
 v_mfma_f32_16x16x32_bf16 a[228:231], a[120:123], a[8:11], a[228:231]
 ds_read_b128 a[72:75], v4 offset:34816
 v_mfma_f32_16x16x32_bf16 a[228:231], a[124:127], a[12:15], a[228:231]
 v_mfma_f32_16x16x32_bf16 a[224:227], a[116:119], a[12:15], a[224:227]
 s_add_u32 m0, s33, 0x500
 ds_read_b128 a[80:83], v4 offset:36864
 v_mfma_f32_16x16x32_bf16 a[224:227], a[112:115], a[8:11], a[224:227]
 buffer_load_dwordx4 v15, s[20:23], s57 offen offset:768 lds
 v_mfma_f32_16x16x32_bf16 a[236:239], a[104:107], a[8:11], a[236:239]
 ds_read_b128 a[84:87], v5 offset:36864
 v_cvt_pk_bf16_f32 v16, v16, v17
 v_mfma_f32_16x16x32_bf16 a[236:239], a[108:111], a[12:15], a[236:239]
 v_cvt_pk_bf16_f32 v17, v18, v19
 v_cvt_pk_bf16_f32 v18, v20, v21
 v_mfma_f32_16x16x32_bf16 a[232:235], a[100:103], a[12:15], a[232:235]
 s_add_u32 m0, s33, 0x580
 ds_read_b128 a[92:95], v5 offset:38912
 v_cvt_pk_bf16_f32 v19, v22, v23
 v_mfma_f32_16x16x32_bf16 a[232:235], a[96:99], a[8:11], a[232:235]
 s_waitcnt lgkmcnt(11)
 buffer_load_dwordx4 v15, s[20:23], s57 offen offset:1664 lds
 v_mfma_f32_16x16x32_bf16 v[32:35], a[96:99], a[16:19], v[32:35]
 ds_read_b128 a[88:91], v4 offset:38912
 v_cvt_pk_bf16_f32 v24, v24, v25
 v_mfma_f32_16x16x32_bf16 v[32:35], a[100:103], a[20:23], v[32:35]
 v_cvt_pk_bf16_f32 v25, v26, v27
 v_cvt_pk_bf16_f32 v26, v28, v29
 v_mfma_f32_16x16x32_bf16 v[36:39], a[108:111], a[20:23], v[36:39]
 ds_read_b64_tr_b16 a[32:33], v10 offset:32768
 v_cvt_pk_bf16_f32 v27, v30, v31
 v_mfma_f32_16x16x32_bf16 v[36:39], a[104:107], a[16:19], v[36:39]
 ds_read_b64_tr_b16 a[34:35], v10 offset:36864
 v_accvgpr_read_b32 v20, a224
 v_mfma_f32_16x16x32_bf16 v[40:43], a[112:115], a[16:19], v[40:43]
 ds_read_b64_tr_b16 a[36:37], v10 offset:49152
 v_accvgpr_read_b32 v21, a225
 v_mfma_f32_16x16x32_bf16 v[40:43], a[116:119], a[20:23], v[40:43]
 ds_read_b64_tr_b16 a[38:39], v10 offset:53248
 v_accvgpr_read_b32 v22, a226
 v_mfma_f32_16x16x32_bf16 v[44:47], a[124:127], a[20:23], v[44:47]
 s_add_u32 s59, s56, 32768
 ds_read_b64_tr_b16 a[40:41], v11 offset:32768
 v_accvgpr_read_b32 v23, a227
 v_mfma_f32_16x16x32_bf16 v[44:47], a[120:123], a[16:19], v[44:47]
 s_waitcnt lgkmcnt(13)
 ds_read_b64_tr_b16 a[42:43], v11 offset:36864
 v_accvgpr_read_b32 v28, a228
 v_mfma_f32_16x16x32_bf16 v[52:55], a[120:123], a[24:27], v[52:55]
 ds_read_b64_tr_b16 a[44:45], v11 offset:49152
 buffer_store_dwordx4 v[16:19], v1, s[12:15], s59 offen offset:0 sc1
 v_mfma_f32_16x16x32_bf16 v[52:55], a[124:127], a[28:31], v[52:55]
 ds_read_b64_tr_b16 a[46:47], v11 offset:53248
 v_accvgpr_read_b32 v29, a229
 v_mfma_f32_16x16x32_bf16 v[48:51], a[116:119], a[28:31], v[48:51]
 ds_read_b64_tr_b16 a[48:49], v12 offset:32768
 v_accvgpr_read_b32 v30, a230
 v_mfma_f32_16x16x32_bf16 v[48:51], a[112:115], a[24:27], v[48:51]
 ds_read_b64_tr_b16 a[50:51], v12 offset:36864
 v_accvgpr_read_b32 v31, a231
 v_mfma_f32_16x16x32_bf16 v[60:63], a[104:107], a[24:27], v[60:63]
 ds_read_b64_tr_b16 a[52:53], v12 offset:49152
 v_cvt_pk_bf16_f32 v20, v20, v21
 v_mfma_f32_16x16x32_bf16 v[60:63], a[108:111], a[28:31], v[60:63]
 ds_read_b64_tr_b16 a[54:55], v12 offset:53248
 v_cvt_pk_bf16_f32 v21, v22, v23
 v_mfma_f32_16x16x32_bf16 v[56:59], a[100:103], a[28:31], v[56:59]
 s_add_u32 s59, s56, 49152
 ds_read_b64_tr_b16 a[56:57], v13 offset:32768
 v_cvt_pk_bf16_f32 v22, v28, v29
 v_mfma_f32_16x16x32_bf16 v[56:59], a[96:99], a[24:27], v[56:59]
 s_waitcnt lgkmcnt(15)
 ds_read_b64_tr_b16 a[58:59], v13 offset:36864
 buffer_store_dwordx4 v[24:27], v1, s[12:15], s59 offen offset:0 sc1
 v_mfma_f32_16x16x32_bf16 v[64:67], a[64:67], a[0:3], v[64:67]
 ds_read_b64_tr_b16 a[60:61], v13 offset:49152
 v_cvt_pk_bf16_f32 v23, v30, v31
 v_mfma_f32_16x16x32_bf16 v[64:67], a[68:71], a[4:7], v[64:67]
 ds_read_b64_tr_b16 a[62:63], v13 offset:53248
 v_cvt_pk_bf16_f32 v32, v32, v33
 v_mfma_f32_16x16x32_bf16 v[68:71], a[76:79], a[4:7], v[68:71]
 v_cvt_pk_bf16_f32 v33, v34, v35
 v_cvt_pk_bf16_f32 v34, v36, v37
 v_mfma_f32_16x16x32_bf16 v[68:71], a[72:75], a[0:3], v[68:71]
 v_cvt_pk_bf16_f32 v35, v38, v39
 v_cvt_pk_bf16_f32 v40, v40, v41
 v_mfma_f32_16x16x32_bf16 v[72:75], a[80:83], a[0:3], v[72:75]
 s_add_u32 s59, s56, 49152
 v_cvt_pk_bf16_f32 v41, v42, v43
 v_cvt_pk_bf16_f32 v42, v44, v45
 v_mfma_f32_16x16x32_bf16 v[72:75], a[84:87], a[4:7], v[72:75]
 s_waitcnt lgkmcnt(15)
 v_cvt_pk_bf16_f32 v43, v46, v47
 v_accvgpr_read_b32 v36, a232
 v_mfma_f32_16x16x32_bf16 v[76:79], a[92:95], a[4:7], v[76:79]
 buffer_store_dwordx4 v[20:23], v1, s[12:15], s59 offen offset:1024 sc1
 v_mfma_f32_16x16x32_bf16 v[76:79], a[88:91], a[0:3], v[76:79]
 s_waitcnt lgkmcnt(0)
 v_accvgpr_read_b32 v37, a233
 v_accvgpr_read_b32 v38, a234
 v_mfma_f32_16x16x32_bf16 v[84:87], a[88:91], a[8:11], v[84:87]
 s_barrier
 v_xor_b32 v6, s60, v6
 v_accvgpr_read_b32 v39, a235
 v_mfma_f32_16x16x32_bf16 v[84:87], a[92:95], a[12:15], v[84:87]
 s_add_u32 m0, s29, 32768
 v_add_u32 v2, 0x80000, v2
 v_accvgpr_read_b32 v44, a236
 v_mfma_f32_16x16x32_bf16 v[80:83], a[84:87], a[12:15], v[80:83]
 buffer_load_dwordx4 v2, s[16:19], 0 offen lds
 v_mfma_f32_16x16x32_bf16 v[80:83], a[80:83], a[8:11], v[80:83]
 v_accvgpr_read_b32 v45, a237
 v_accvgpr_read_b32 v46, a238
 v_mfma_f32_16x16x32_bf16 v[92:95], a[72:75], a[8:11], v[92:95]
 v_accvgpr_read_b32 v47, a239
 v_cvt_pk_bf16_f32 v36, v36, v37
 v_mfma_f32_16x16x32_bf16 v[92:95], a[76:79], a[12:15], v[92:95]
 v_cvt_pk_bf16_f32 v37, v38, v39
 v_cvt_pk_bf16_f32 v38, v44, v45
 v_mfma_f32_16x16x32_bf16 v[88:91], a[68:71], a[12:15], v[88:91]
 s_add_u32 m0, s29, 36864
 v_cvt_pk_bf16_f32 v39, v46, v47
 v_cvt_pk_bf16_f32 v48, v48, v49
 v_mfma_f32_16x16x32_bf16 v[88:91], a[64:67], a[8:11], v[88:91]
 buffer_load_dwordx4 v2, s[16:19], s48 offen lds
 v_mfma_f32_16x16x32_bf16 v[96:99], a[64:67], a[16:19], v[96:99]
 v_cvt_pk_bf16_f32 v49, v50, v51
 v_cvt_pk_bf16_f32 v50, v52, v53
 v_mfma_f32_16x16x32_bf16 v[96:99], a[68:71], a[20:23], v[96:99]
 v_cvt_pk_bf16_f32 v51, v54, v55
 v_cvt_pk_bf16_f32 v56, v56, v57
 v_mfma_f32_16x16x32_bf16 v[100:103], a[76:79], a[20:23], v[100:103]
 v_cvt_pk_bf16_f32 v57, v58, v59
 v_cvt_pk_bf16_f32 v58, v60, v61
 v_mfma_f32_16x16x32_bf16 v[100:103], a[72:75], a[16:19], v[100:103]
 s_add_u32 m0, s29, 40960
 v_cvt_pk_bf16_f32 v59, v62, v63
 v_cvt_pk_bf16_f32 v64, v64, v65
 v_mfma_f32_16x16x32_bf16 v[104:107], a[80:83], a[16:19], v[104:107]
 buffer_load_dwordx4 v2, s[16:19], s49 offen lds
 v_mfma_f32_16x16x32_bf16 v[104:107], a[84:87], a[20:23], v[104:107]
 v_cvt_pk_bf16_f32 v65, v66, v67
 v_cvt_pk_bf16_f32 v66, v68, v69
 v_mfma_f32_16x16x32_bf16 v[108:111], a[92:95], a[20:23], v[108:111]
 v_cvt_pk_bf16_f32 v67, v70, v71
 v_cvt_pk_bf16_f32 v72, v72, v73
 v_mfma_f32_16x16x32_bf16 v[108:111], a[88:91], a[16:19], v[108:111]
 v_cvt_pk_bf16_f32 v73, v74, v75
 v_cvt_pk_bf16_f32 v74, v76, v77
 v_mfma_f32_16x16x32_bf16 v[116:119], a[88:91], a[24:27], v[116:119]
 s_add_u32 m0, s29, 45056
 v_cvt_pk_bf16_f32 v75, v78, v79
 v_cvt_pk_bf16_f32 v80, v80, v81
 v_mfma_f32_16x16x32_bf16 v[116:119], a[92:95], a[28:31], v[116:119]
 buffer_load_dwordx4 v2, s[16:19], s50 offen lds
 v_mfma_f32_16x16x32_bf16 v[112:115], a[84:87], a[28:31], v[112:115]
 s_add_u32 s59, s56, 32768
 v_cvt_pk_bf16_f32 v81, v82, v83
 v_cvt_pk_bf16_f32 v82, v84, v85
 v_mfma_f32_16x16x32_bf16 v[112:115], a[80:83], a[24:27], v[112:115]
 buffer_store_dwordx4 v[36:39], v1, s[12:15], s59 offen offset:1024 sc1
 v_mfma_f32_16x16x32_bf16 v[124:127], a[72:75], a[24:27], v[124:127]
 v_cvt_pk_bf16_f32 v83, v86, v87
 v_cvt_pk_bf16_f32 v88, v88, v89
 v_mfma_f32_16x16x32_bf16 v[124:127], a[76:79], a[28:31], v[124:127]
 s_add_u32 m0, s29, 49152
 v_cvt_pk_bf16_f32 v89, v90, v91
 v_cvt_pk_bf16_f32 v90, v92, v93
 v_mfma_f32_16x16x32_bf16 v[120:123], a[68:71], a[28:31], v[120:123]
 buffer_load_dwordx4 v2, s[16:19], s51 offen lds
 v_mfma_f32_16x16x32_bf16 v[120:123], a[64:67], a[24:27], v[120:123]
 v_cvt_pk_bf16_f32 v91, v94, v95
 v_cvt_pk_bf16_f32 v96, v96, v97
 v_mfma_f32_16x16x32_bf16 v[128:131], a[64:67], a[32:35], v[128:131]
 v_cvt_pk_bf16_f32 v97, v98, v99
 v_cvt_pk_bf16_f32 v98, v100, v101
 v_mfma_f32_16x16x32_bf16 v[128:131], a[68:71], a[36:39], v[128:131]
 v_cvt_pk_bf16_f32 v99, v102, v103
 v_cvt_pk_bf16_f32 v104, v104, v105
 v_mfma_f32_16x16x32_bf16 v[132:135], a[76:79], a[36:39], v[132:135]
 s_add_u32 m0, s29, 53248
 v_cvt_pk_bf16_f32 v105, v106, v107
 v_cvt_pk_bf16_f32 v106, v108, v109
 v_mfma_f32_16x16x32_bf16 v[132:135], a[72:75], a[32:35], v[132:135]
 buffer_load_dwordx4 v2, s[16:19], s52 offen lds
 v_mfma_f32_16x16x32_bf16 v[136:139], a[80:83], a[32:35], v[136:139]
 v_cvt_pk_bf16_f32 v107, v110, v111
 v_cvt_pk_bf16_f32 v112, v112, v113
 v_mfma_f32_16x16x32_bf16 v[136:139], a[84:87], a[36:39], v[136:139]
 v_cvt_pk_bf16_f32 v113, v114, v115
 v_cvt_pk_bf16_f32 v114, v116, v117
 v_mfma_f32_16x16x32_bf16 v[140:143], a[92:95], a[36:39], v[140:143]
 v_cvt_pk_bf16_f32 v115, v118, v119
 v_mfma_f32_16x16x32_bf16 v[140:143], a[88:91], a[32:35], v[140:143]
 s_add_u32 m0, s29, 57344
 v_cvt_pk_bf16_f32 v120, v120, v121
 v_cvt_pk_bf16_f32 v121, v122, v123
 v_mfma_f32_16x16x32_bf16 v[148:151], a[88:91], a[40:43], v[148:151]
 buffer_load_dwordx4 v2, s[16:19], s53 offen lds
 v_mfma_f32_16x16x32_bf16 v[148:151], a[92:95], a[44:47], v[148:151]
 v_cvt_pk_bf16_f32 v122, v124, v125
 v_cvt_pk_bf16_f32 v123, v126, v127
 v_mfma_f32_16x16x32_bf16 v[144:147], a[84:87], a[44:47], v[144:147]
 v_mfma_f32_16x16x32_bf16 v[144:147], a[80:83], a[40:43], v[144:147]
 v_cvt_pk_bf16_f32 v128, v128, v129
 v_cvt_pk_bf16_f32 v129, v130, v131
 v_mfma_f32_16x16x32_bf16 v[156:159], a[72:75], a[40:43], v[156:159]
 s_add_u32 m0, s29, 61440
 v_cvt_pk_bf16_f32 v130, v132, v133
 v_cvt_pk_bf16_f32 v131, v134, v135
 v_mfma_f32_16x16x32_bf16 v[156:159], a[76:79], a[44:47], v[156:159]
 buffer_load_dwordx4 v2, s[16:19], s54 offen lds
 v_mfma_f32_16x16x32_bf16 v[152:155], a[68:71], a[44:47], v[152:155]
 v_mfma_f32_16x16x32_bf16 v[152:155], a[64:67], a[40:43], v[152:155]
 v_cvt_pk_bf16_f32 v136, v136, v137
 v_cvt_pk_bf16_f32 v137, v138, v139
 v_mfma_f32_16x16x32_bf16 v[160:163], a[64:67], a[48:51], v[160:163]
 s_add_u32 m0, s29, 98304
 v_add_u32 v2, 0x80000, v2
 v_cvt_pk_bf16_f32 v138, v140, v141
 v_mfma_f32_16x16x32_bf16 v[160:163], a[68:71], a[52:55], v[160:163]
 buffer_load_dwordx4 v2, s[16:19], 0 offen lds
 v_mfma_f32_16x16x32_bf16 v[164:167], a[76:79], a[52:55], v[164:167]
 v_cvt_pk_bf16_f32 v139, v142, v143
 v_mfma_f32_16x16x32_bf16 v[164:167], a[72:75], a[48:51], v[164:167]
 v_cvt_pk_bf16_f32 v144, v144, v145
 v_cvt_pk_bf16_f32 v145, v146, v147
 v_mfma_f32_16x16x32_bf16 v[168:171], a[80:83], a[48:51], v[168:171]
 v_cvt_pk_bf16_f32 v146, v148, v149
 v_cvt_pk_bf16_f32 v147, v150, v151
 v_mfma_f32_16x16x32_bf16 v[168:171], a[84:87], a[52:55], v[168:171]
 s_add_u32 m0, s29, 102400
 v_mfma_f32_16x16x32_bf16 v[172:175], a[92:95], a[52:55], v[172:175]
 buffer_load_dwordx4 v2, s[16:19], s48 offen lds
 v_mfma_f32_16x16x32_bf16 v[172:175], a[88:91], a[48:51], v[172:175]
 v_cvt_pk_bf16_f32 v152, v152, v153
 v_cvt_pk_bf16_f32 v153, v154, v155
 v_mfma_f32_16x16x32_bf16 v[180:183], a[88:91], a[56:59], v[180:183]
 v_cvt_pk_bf16_f32 v154, v156, v157
 v_cvt_pk_bf16_f32 v155, v158, v159
 v_mfma_f32_16x16x32_bf16 v[180:183], a[92:95], a[60:63], v[180:183]
 v_mfma_f32_16x16x32_bf16 v[176:179], a[84:87], a[60:63], v[176:179]
 s_add_u32 m0, s29, 106496
 v_mfma_f32_16x16x32_bf16 v[176:179], a[80:83], a[56:59], v[176:179]
 buffer_load_dwordx4 v2, s[16:19], s49 offen lds
 v_mfma_f32_16x16x32_bf16 v[188:191], a[72:75], a[56:59], v[188:191]
 v_cvt_pk_bf16_f32 v160, v160, v161
 v_cvt_pk_bf16_f32 v161, v162, v163
 v_mfma_f32_16x16x32_bf16 v[188:191], a[76:79], a[60:63], v[188:191]
 v_cvt_pk_bf16_f32 v162, v164, v165
 v_cvt_pk_bf16_f32 v163, v166, v167
 v_mfma_f32_16x16x32_bf16 v[184:187], a[68:71], a[60:63], v[184:187]
 v_mfma_f32_16x16x32_bf16 v[184:187], a[64:67], a[56:59], v[184:187]
 s_add_u32 m0, s29, 110592
 v_cvt_pk_bf16_f32 v168, v168, v169
 v_cvt_pk_bf16_f32 v169, v170, v171
 v_mfma_f32_16x16x32_bf16 v[192:195], a[96:99], a[32:35], v[192:195]
 buffer_load_dwordx4 v2, s[16:19], s50 offen lds
 v_mfma_f32_16x16x32_bf16 v[192:195], a[100:103], a[36:39], v[192:195]
 v_cvt_pk_bf16_f32 v170, v172, v173
 v_cvt_pk_bf16_f32 v171, v174, v175
 v_mfma_f32_16x16x32_bf16 v[196:199], a[108:111], a[36:39], v[196:199]
 v_mfma_f32_16x16x32_bf16 v[196:199], a[104:107], a[32:35], v[196:199]
 v_cvt_pk_bf16_f32 v176, v176, v177
 v_cvt_pk_bf16_f32 v177, v178, v179
 v_mfma_f32_16x16x32_bf16 v[200:203], a[112:115], a[32:35], v[200:203]
 s_add_u32 m0, s29, 114688
 v_cvt_pk_bf16_f32 v178, v180, v181
 v_cvt_pk_bf16_f32 v179, v182, v183
 v_mfma_f32_16x16x32_bf16 v[200:203], a[116:119], a[36:39], v[200:203]
 buffer_load_dwordx4 v2, s[16:19], s51 offen lds
 v_mfma_f32_16x16x32_bf16 v[204:207], a[124:127], a[36:39], v[204:207]
 v_mfma_f32_16x16x32_bf16 v[204:207], a[120:123], a[32:35], v[204:207]
 v_cvt_pk_bf16_f32 v184, v184, v185
 v_cvt_pk_bf16_f32 v185, v186, v187
 v_mfma_f32_16x16x32_bf16 v[212:215], a[120:123], a[40:43], v[212:215]
 v_cvt_pk_bf16_f32 v186, v188, v189
 v_cvt_pk_bf16_f32 v187, v190, v191
 v_mfma_f32_16x16x32_bf16 v[212:215], a[124:127], a[44:47], v[212:215]
 s_add_u32 m0, s29, 118784
 v_mfma_f32_16x16x32_bf16 v[208:211], a[116:119], a[44:47], v[208:211]
 buffer_load_dwordx4 v2, s[16:19], s52 offen lds
 v_mfma_f32_16x16x32_bf16 v[208:211], a[112:115], a[40:43], v[208:211]
 v_cvt_pk_bf16_f32 v192, v192, v193
 v_cvt_pk_bf16_f32 v193, v194, v195
 v_mfma_f32_16x16x32_bf16 v[220:223], a[104:107], a[40:43], v[220:223]
 v_cvt_pk_bf16_f32 v194, v196, v197
 v_cvt_pk_bf16_f32 v195, v198, v199
 v_mfma_f32_16x16x32_bf16 v[220:223], a[108:111], a[44:47], v[220:223]
 v_mfma_f32_16x16x32_bf16 v[216:219], a[100:103], a[44:47], v[216:219]
 s_add_u32 m0, s29, 122880
 v_mfma_f32_16x16x32_bf16 v[216:219], a[96:99], a[40:43], v[216:219]
 buffer_load_dwordx4 v2, s[16:19], s53 offen lds
 v_mfma_f32_16x16x32_bf16 v[224:227], a[96:99], a[48:51], v[224:227]
 v_cvt_pk_bf16_f32 v200, v200, v201
 v_cvt_pk_bf16_f32 v201, v202, v203
 v_mfma_f32_16x16x32_bf16 v[224:227], a[100:103], a[52:55], v[224:227]
 s_waitcnt vmcnt(19)
 v_cvt_pk_bf16_f32 v202, v204, v205
 v_cvt_pk_bf16_f32 v203, v206, v207
 v_mfma_f32_16x16x32_bf16 v[228:231], a[108:111], a[52:55], v[228:231]
 s_barrier
 v_xor_b32 v7, 0, v6
 v_mfma_f32_16x16x32_bf16 v[228:231], a[104:107], a[48:51], v[228:231]
 s_add_u32 m0, s29, 126976
 ds_read_b64_tr_b16 a[64:65], v7 offset:0
 v_cvt_pk_bf16_f32 v208, v208, v209
 v_mfma_f32_16x16x32_bf16 v[232:235], a[112:115], a[48:51], v[232:235]
 ds_read_b64_tr_b16 a[66:67], v7 offset:4096
 buffer_load_dwordx4 v2, s[16:19], s54 offen lds
 v_mfma_f32_16x16x32_bf16 v[232:235], a[116:119], a[52:55], v[232:235]
 ds_read_b64_tr_b16 a[68:69], v7 offset:16384
 v_cvt_pk_bf16_f32 v209, v210, v211
 v_mfma_f32_16x16x32_bf16 v[236:239], a[124:127], a[52:55], v[236:239]
 ds_read_b64_tr_b16 a[70:71], v7 offset:20480
 v_xor_b32 v8, 65536, v6
 v_mfma_f32_16x16x32_bf16 v[236:239], a[120:123], a[48:51], v[236:239]
 ds_read_b64_tr_b16 a[72:73], v8 offset:0
 v_cvt_pk_bf16_f32 v210, v212, v213
 v_mfma_f32_16x16x32_bf16 v[244:247], a[120:123], a[56:59], v[244:247]
 ds_read_b64_tr_b16 a[74:75], v8 offset:4096
 v_cvt_pk_bf16_f32 v211, v214, v215
 v_mfma_f32_16x16x32_bf16 v[244:247], a[124:127], a[60:63], v[244:247]
 ds_read_b64_tr_b16 a[76:77], v8 offset:16384
 v_cvt_pk_bf16_f32 v216, v216, v217
 v_mfma_f32_16x16x32_bf16 v[240:243], a[116:119], a[60:63], v[240:243]
 ds_read_b64_tr_b16 a[78:79], v8 offset:20480
 v_xor_b32 v9, 32, v6
 v_mfma_f32_16x16x32_bf16 v[240:243], a[112:115], a[56:59], v[240:243]
 ds_read_b64_tr_b16 a[80:81], v9 offset:0
 v_cvt_pk_bf16_f32 v217, v218, v219
 v_mfma_f32_16x16x32_bf16 v[252:255], a[104:107], a[56:59], v[252:255]
 ds_read_b64_tr_b16 a[82:83], v9 offset:4096
 v_cvt_pk_bf16_f32 v218, v220, v221
 v_mfma_f32_16x16x32_bf16 v[252:255], a[108:111], a[60:63], v[252:255]
 ds_read_b64_tr_b16 a[84:85], v9 offset:16384
 v_cvt_pk_bf16_f32 v219, v222, v223
 v_mfma_f32_16x16x32_bf16 v[248:251], a[100:103], a[60:63], v[248:251]
 ds_read_b64_tr_b16 a[86:87], v9 offset:20480
 v_xor_b32 v10, 65568, v6
 v_mfma_f32_16x16x32_bf16 v[248:251], a[96:99], a[56:59], v[248:251]
 s_waitcnt lgkmcnt(6)
 ds_read_b64_tr_b16 a[88:89], v10 offset:0
 v_cvt_pk_bf16_f32 v224, v224, v225
 v_mfma_f32_16x16x32_bf16 v[28:31], a[64:67], a[128:131], 0
 ds_read_b64_tr_b16 a[90:91], v10 offset:4096
 v_cvt_pk_bf16_f32 v225, v226, v227
 v_mfma_f32_16x16x32_bf16 v[28:31], a[68:71], a[136:139], v[28:31]
 ds_read_b64_tr_b16 a[92:93], v10 offset:16384
 v_xor_b32 v7, 64, v6
 v_mfma_f32_16x16x32_bf16 v[28:31], a[72:75], a[144:147], v[28:31]
 s_waitcnt lgkmcnt(7)
 ds_read_b128 a[112:115], v14 offset:0
 ds_read_b64_tr_b16 a[94:95], v10 offset:20480
 v_mfma_f32_16x16x32_bf16 v[28:31], a[76:79], a[152:155], v[28:31]
 ds_read_b64_tr_b16 a[96:97], v7 offset:0
 v_cvt_pk_bf16_f32 v226, v228, v229
 v_mfma_f32_16x16x32_bf16 v[44:47], a[64:67], a[132:135], 0
 ds_read_b128 a[120:123], v3 offset:0
 ds_read_b64_tr_b16 a[98:99], v7 offset:4096
 v_mfma_f32_16x16x32_bf16 v[44:47], a[68:71], a[140:143], v[44:47]
 ds_read_b64_tr_b16 a[100:101], v7 offset:16384
 v_xor_b32 v8, 65600, v6
 v_mfma_f32_16x16x32_bf16 v[44:47], a[72:75], a[148:151], v[44:47]
 ds_read_b128 a[116:119], v14 offset:2048
 ds_read_b64_tr_b16 a[102:103], v7 offset:20480
 v_mfma_f32_16x16x32_bf16 v[44:47], a[76:79], a[156:159], v[44:47]
 s_waitcnt lgkmcnt(9)
 ds_read_b64_tr_b16 a[104:105], v8 offset:0
 v_cvt_pk_bf16_f32 v227, v230, v231
 v_mfma_f32_16x16x32_bf16 v[52:55], a[80:83], a[128:131], 0
 ds_read_b128 a[124:127], v3 offset:2048
 ds_read_b64_tr_b16 a[106:107], v8 offset:4096
 v_mfma_f32_16x16x32_bf16 v[52:55], a[84:87], a[136:139], v[52:55]
 ds_read_b64_tr_b16 a[108:109], v8 offset:16384
 v_cvt_pk_bf16_f32 v232, v232, v233
 v_mfma_f32_16x16x32_bf16 v[52:55], a[88:91], a[144:147], v[52:55]
 s_waitcnt lgkmcnt(10)
 ds_read_b64_tr_b16 a[110:111], v8 offset:20480
 v_xor_b32 v9, 96, v6
 v_mfma_f32_16x16x32_bf16 v[52:55], a[92:95], a[152:155], v[52:55]
 ds_read_b64_tr_b16 a[64:65], v9 offset:0
 v_cvt_pk_bf16_f32 v233, v234, v235
 v_mfma_f32_16x16x32_bf16 v[60:63], a[80:83], a[132:135], 0
 ds_read_b64_tr_b16 a[66:67], v9 offset:4096
 v_cvt_pk_bf16_f32 v234, v236, v237
 v_mfma_f32_16x16x32_bf16 v[60:63], a[84:87], a[140:143], v[60:63]
 ds_read_b64_tr_b16 a[68:69], v9 offset:16384
 v_cvt_pk_bf16_f32 v235, v238, v239
 v_mfma_f32_16x16x32_bf16 v[60:63], a[88:91], a[148:151], v[60:63]
 ds_read_b64_tr_b16 a[70:71], v9 offset:20480
 v_xor_b32 v10, 65632, v6
 v_mfma_f32_16x16x32_bf16 v[60:63], a[92:95], a[156:159], v[60:63]
 s_waitcnt lgkmcnt(6)
 ds_read_b64_tr_b16 a[72:73], v10 offset:0
 v_cvt_pk_bf16_f32 v240, v240, v241
 v_mfma_f32_16x16x32_bf16 v[20:23], a[96:99], a[128:131], 0
 ds_read_b64_tr_b16 a[74:75], v10 offset:4096
 v_cvt_pk_bf16_f32 v241, v242, v243
 v_mfma_f32_16x16x32_bf16 v[20:23], a[100:103], a[136:139], v[20:23]
 s_waitcnt lgkmcnt(8)
 ds_read_b64_tr_b16 a[76:77], v10 offset:16384
 v_xor_b32 v7, 128, v6
 v_mfma_f32_16x16x32_bf16 v[20:23], a[104:107], a[144:147], v[20:23]
 s_waitcnt lgkmcnt(7)
 s_barrier
 ds_read_b64_tr_b16 a[78:79], v10 offset:20480
 v_mfma_f32_16x16x32_bf16 v[20:23], a[108:111], a[152:155], v[20:23]
 s_add_u32 m0, s29, 131072
 ds_read_b64_tr_b16 a[80:81], v7 offset:0
 v_add_u32 v2, 0x80000, v2
 v_mfma_f32_16x16x32_bf16 v[36:39], a[96:99], a[132:135], 0
 ds_read_b64_tr_b16 a[82:83], v7 offset:4096
 buffer_load_dwordx4 v2, s[16:19], 0 offen lds
 v_mfma_f32_16x16x32_bf16 v[36:39], a[100:103], a[140:143], v[36:39]
 ds_read_b64_tr_b16 a[84:85], v7 offset:16384
 v_cvt_pk_bf16_f32 v242, v244, v245
 v_mfma_f32_16x16x32_bf16 v[36:39], a[104:107], a[148:151], v[36:39]
 ds_read_b64_tr_b16 a[86:87], v7 offset:20480
 v_xor_b32 v8, 65664, v6
 v_mfma_f32_16x16x32_bf16 v[36:39], a[108:111], a[156:159], v[36:39]
 s_waitcnt lgkmcnt(6)
 ds_read_b64_tr_b16 a[88:89], v8 offset:0
 v_cvt_pk_bf16_f32 v243, v246, v247
 v_mfma_f32_16x16x32_bf16 v[68:71], a[64:67], a[128:131], 0
 ds_read_b64_tr_b16 a[90:91], v8 offset:4096
 v_cvt_pk_bf16_f32 v248, v248, v249
 v_mfma_f32_16x16x32_bf16 v[68:71], a[68:71], a[136:139], v[68:71]
 s_add_u32 m0, s29, 135168
 ds_read_b64_tr_b16 a[92:93], v8 offset:16384
 v_cvt_pk_bf16_f32 v249, v250, v251
 v_mfma_f32_16x16x32_bf16 v[68:71], a[72:75], a[144:147], v[68:71]
 s_waitcnt lgkmcnt(7)
 ds_read_b64_tr_b16 a[94:95], v8 offset:20480
 v_xor_b32 v9, 160, v6
 v_mfma_f32_16x16x32_bf16 v[68:71], a[76:79], a[152:155], v[68:71]
 ds_read_b64_tr_b16 a[96:97], v9 offset:0
 buffer_load_dwordx4 v2, s[16:19], s48 offen lds
 v_mfma_f32_16x16x32_bf16 v[76:79], a[64:67], a[132:135], 0
 ds_read_b64_tr_b16 a[98:99], v9 offset:4096
 v_cvt_pk_bf16_f32 v250, v252, v253
 v_mfma_f32_16x16x32_bf16 v[76:79], a[68:71], a[140:143], v[76:79]
 ds_read_b64_tr_b16 a[100:101], v9 offset:16384
 v_cvt_pk_bf16_f32 v251, v254, v255
 v_mfma_f32_16x16x32_bf16 v[76:79], a[72:75], a[148:151], v[76:79]
 ds_read_b64_tr_b16 a[102:103], v9 offset:20480
 v_xor_b32 v10, 65696, v6
 v_mfma_f32_16x16x32_bf16 v[76:79], a[76:79], a[156:159], v[76:79]
 s_waitcnt lgkmcnt(6)
 ds_read_b64_tr_b16 a[104:105], v10 offset:0
 v_mov_b32 v12, 0
 v_mfma_f32_16x16x32_bf16 v[84:87], a[80:83], a[128:131], 0
 s_add_u32 m0, s29, 139264
 ds_read_b64_tr_b16 a[106:107], v10 offset:4096
 v_mfma_f32_16x16x32_bf16 v[84:87], a[84:87], a[136:139], v[84:87]
 ds_read_b64_tr_b16 a[108:109], v10 offset:16384
 buffer_load_dwordx4 v2, s[16:19], s49 offen lds
 v_mfma_f32_16x16x32_bf16 v[84:87], a[88:91], a[144:147], v[84:87]
 s_waitcnt lgkmcnt(7)
 ds_read_b64_tr_b16 a[110:111], v10 offset:20480
 v_xor_b32 v7, 192, v6
 v_mfma_f32_16x16x32_bf16 v[84:87], a[92:95], a[152:155], v[84:87]
 ds_read_b64_tr_b16 a[64:65], v7 offset:0
 global_load_dword v5, v12, s[90:91] offset:128 sc1
 v_mfma_f32_16x16x32_bf16 v[92:95], a[80:83], a[132:135], 0
 ds_read_b64_tr_b16 a[66:67], v7 offset:4096
 v_and_b32 v12, 11, v0
 v_mfma_f32_16x16x32_bf16 v[92:95], a[84:87], a[140:143], v[92:95]
 ds_read_b64_tr_b16 a[68:69], v7 offset:16384
 v_lshlrev_b32 v12, 2, v12
 v_mfma_f32_16x16x32_bf16 v[92:95], a[88:91], a[148:151], v[92:95]
 s_add_u32 m0, s29, 143360
 ds_read_b64_tr_b16 a[70:71], v7 offset:20480
 v_xor_b32 v8, 65728, v6
 v_mfma_f32_16x16x32_bf16 v[92:95], a[92:95], a[156:159], v[92:95]
 s_waitcnt lgkmcnt(6)
 ds_read_b64_tr_b16 a[72:73], v8 offset:0
 buffer_load_dwordx4 v2, s[16:19], s50 offen lds
 v_mfma_f32_16x16x32_bf16 v[100:103], a[96:99], a[128:131], 0
 ds_read_b64_tr_b16 a[74:75], v8 offset:4096
 v_mfma_f32_16x16x32_bf16 v[100:103], a[100:103], a[136:139], v[100:103]
 s_and_b32 s36, s95, 31
 ds_read_b64_tr_b16 a[76:77], v8 offset:16384
 v_and_b32 v14, 15, v0
 v_mfma_f32_16x16x32_bf16 v[100:103], a[104:107], a[144:147], v[100:103]
 s_waitcnt lgkmcnt(7)
 ds_read_b64_tr_b16 a[78:79], v8 offset:20480
 v_xor_b32 v9, 224, v6
 v_mfma_f32_16x16x32_bf16 v[100:103], a[108:111], a[152:155], v[100:103]
 s_lshr_b32 s37, s95, 5
 ds_read_b64_tr_b16 a[80:81], v9 offset:0
 v_lshrrev_b32 v3, 4, v0
 v_mfma_f32_16x16x32_bf16 v[108:111], a[96:99], a[132:135], 0
 s_add_u32 m0, s29, 147456
 ds_read_b64_tr_b16 a[82:83], v9 offset:4096
 v_lshlrev_b32 v3, 2, v3
 v_mfma_f32_16x16x32_bf16 v[108:111], a[100:103], a[140:143], v[108:111]
 ds_read_b64_tr_b16 a[84:85], v9 offset:16384
 buffer_load_dwordx4 v2, s[16:19], s51 offen lds
 v_mfma_f32_16x16x32_bf16 v[108:111], a[104:107], a[148:151], v[108:111]
 s_lshl_b32 s38, s3, 4
 ds_read_b64_tr_b16 a[86:87], v9 offset:20480
 v_xor_b32 v10, 65760, v6
 v_mfma_f32_16x16x32_bf16 v[108:111], a[108:111], a[156:159], v[108:111]
 s_waitcnt lgkmcnt(6)
 ds_read_b64_tr_b16 a[88:89], v10 offset:0
 v_sub_u32 v14, v14, v3
 v_mfma_f32_16x16x32_bf16 v[116:119], a[64:67], a[128:131], 0
 s_lshl_b32 s39, s36, 6
 ds_read_b64_tr_b16 a[90:91], v10 offset:4096
 v_lshrrev_b32_e64 v3, 6, s29
 v_mfma_f32_16x16x32_bf16 v[116:119], a[68:71], a[136:139], v[116:119]
 s_add_u32 m0, s29, 151552
 ds_read_b64_tr_b16 a[92:93], v10 offset:16384
 v_add_u32 v14, v3, v14
 v_mfma_f32_16x16x32_bf16 v[116:119], a[72:75], a[144:147], v[116:119]
 s_waitcnt lgkmcnt(7)
 ds_read_b64_tr_b16 a[94:95], v10 offset:20480
 v_xor_b32 v7, 256, v6
 v_mfma_f32_16x16x32_bf16 v[116:119], a[76:79], a[152:155], v[116:119]
 ds_read_b64_tr_b16 a[96:97], v7 offset:0
 buffer_load_dwordx4 v2, s[16:19], s52 offen lds
 v_mfma_f32_16x16x32_bf16 v[124:127], a[64:67], a[132:135], 0
 s_add_u32 s38, s38, s39
 ds_read_b64_tr_b16 a[98:99], v7 offset:4096
 v_mov_b32 v15, 0xf149f2ca
 v_mfma_f32_16x16x32_bf16 v[124:127], a[68:71], a[140:143], v[124:127]
 s_mul_i32 s38, s38, 896
 ds_read_b64_tr_b16 a[100:101], v7 offset:16384
 v_cmp_gt_i32 vcc, 0, v14
 v_mfma_f32_16x16x32_bf16 v[124:127], a[72:75], a[148:151], v[124:127]
 s_lshl_b32 s39, s37, 7
 ds_read_b64_tr_b16 a[102:103], v7 offset:20480
 v_xor_b32 v8, 65792, v6
 v_mfma_f32_16x16x32_bf16 v[124:127], a[76:79], a[156:159], v[124:127]
 s_waitcnt lgkmcnt(6)
 ds_read_b64_tr_b16 a[104:105], v8 offset:0
 v_cndmask_b32 v3, 0, v15, vcc
 v_mfma_f32_16x16x32_bf16 v[132:135], a[80:83], a[128:131], 0
 s_add_u32 m0, s29, 155648
 ds_read_b64_tr_b16 a[106:107], v8 offset:4096
 v_accvgpr_write_b32 a224, v3
 v_mfma_f32_16x16x32_bf16 v[132:135], a[84:87], a[136:139], v[132:135]
 ds_read_b64_tr_b16 a[108:109], v8 offset:16384
 buffer_load_dwordx4 v2, s[16:19], s53 offen lds
 v_mfma_f32_16x16x32_bf16 v[132:135], a[88:91], a[144:147], v[132:135]
 s_waitcnt lgkmcnt(7)
 ds_read_b64_tr_b16 a[110:111], v8 offset:20480
 v_xor_b32 v9, 288, v6
 v_mfma_f32_16x16x32_bf16 v[132:135], a[92:95], a[152:155], v[132:135]
 s_add_u32 s38, s38, s39
 ds_read_b64_tr_b16 a[64:65], v9 offset:0
 v_cmp_gt_i32 vcc, 1, v14
 v_mfma_f32_16x16x32_bf16 v[140:143], a[80:83], a[132:135], 0
 s_lshl_b32 s39, s37, 9
 ds_read_b64_tr_b16 a[66:67], v9 offset:4096
 v_cndmask_b32 v3, 0, v15, vcc
 v_mfma_f32_16x16x32_bf16 v[140:143], a[84:87], a[140:143], v[140:143]
 s_mov_b32 s4, s66
 ds_read_b64_tr_b16 a[68:69], v9 offset:16384
 v_accvgpr_write_b32 a225, v3
 v_mfma_f32_16x16x32_bf16 v[140:143], a[88:91], a[148:151], v[140:143]
 s_add_u32 m0, s29, 159744
 ds_read_b64_tr_b16 a[70:71], v9 offset:20480
 v_xor_b32 v10, 65824, v6
 v_mfma_f32_16x16x32_bf16 v[140:143], a[92:95], a[156:159], v[140:143]
 s_waitcnt lgkmcnt(6)
 ds_read_b64_tr_b16 a[72:73], v10 offset:0
 buffer_load_dwordx4 v2, s[16:19], s54 offen lds
 v_mfma_f32_16x16x32_bf16 v[148:151], a[96:99], a[128:131], 0
 s_mov_b32 s5, s67
 ds_read_b64_tr_b16 a[74:75], v10 offset:4096
 v_cmp_gt_i32 vcc, 2, v14
 v_mfma_f32_16x16x32_bf16 v[148:151], a[100:103], a[136:139], v[148:151]
 s_mov_b32 s6, 1835008
 ds_read_b64_tr_b16 a[76:77], v10 offset:16384
 v_cndmask_b32 v3, 0, v15, vcc
 v_mfma_f32_16x16x32_bf16 v[148:151], a[104:107], a[144:147], v[148:151]
 s_waitcnt lgkmcnt(7)
 ds_read_b64_tr_b16 a[78:79], v10 offset:20480
 v_xor_b32 v7, 320, v6
 v_mfma_f32_16x16x32_bf16 v[148:151], a[108:111], a[152:155], v[148:151]
 s_mov_b32 s7, 0x20000
 ds_read_b64_tr_b16 a[80:81], v7 offset:0
 v_accvgpr_write_b32 a226, v3
 v_mfma_f32_16x16x32_bf16 v[156:159], a[96:99], a[132:135], 0
 s_mov_b32 s8, s68
 ds_read_b64_tr_b16 a[82:83], v7 offset:4096
 v_cmp_gt_i32 vcc, 3, v14
 v_mfma_f32_16x16x32_bf16 v[156:159], a[100:103], a[140:143], v[156:159]
 s_mov_b32 s9, s69
 ds_read_b64_tr_b16 a[84:85], v7 offset:16384
 v_cndmask_b32 v3, 0, v15, vcc
 v_mfma_f32_16x16x32_bf16 v[156:159], a[104:107], a[148:151], v[156:159]
 s_mov_b32 s10, 1835008
 ds_read_b64_tr_b16 a[86:87], v7 offset:20480
 v_xor_b32 v8, 65856, v6
 v_mfma_f32_16x16x32_bf16 v[156:159], a[108:111], a[156:159], v[156:159]
 s_waitcnt lgkmcnt(6)
 ds_read_b64_tr_b16 a[88:89], v8 offset:0
 v_accvgpr_write_b32 a227, v3
 v_mfma_f32_16x16x32_bf16 v[164:167], a[64:67], a[128:131], 0
 s_mov_b32 s11, 0x20000
 ds_read_b64_tr_b16 a[90:91], v8 offset:4096
 v_cmp_gt_i32 vcc, 16, v14
 v_mfma_f32_16x16x32_bf16 v[164:167], a[68:71], a[136:139], v[164:167]
 s_mov_b32 s20, s70
 ds_read_b64_tr_b16 a[92:93], v8 offset:16384
 v_cndmask_b32 v3, 0, v15, vcc
 v_mfma_f32_16x16x32_bf16 v[164:167], a[72:75], a[144:147], v[164:167]
 s_waitcnt lgkmcnt(7)
 ds_read_b64_tr_b16 a[94:95], v8 offset:20480
 v_xor_b32 v9, 352, v6
 v_mfma_f32_16x16x32_bf16 v[164:167], a[76:79], a[152:155], v[164:167]
 s_mov_b32 s21, s71
 ds_read_b64_tr_b16 a[96:97], v9 offset:0
 v_accvgpr_write_b32 a228, v3
 v_mfma_f32_16x16x32_bf16 v[172:175], a[64:67], a[132:135], 0
 s_mov_b32 s22, 3584
 ds_read_b64_tr_b16 a[98:99], v9 offset:4096
 v_cmp_gt_i32 vcc, 17, v14
 v_mfma_f32_16x16x32_bf16 v[172:175], a[68:71], a[140:143], v[172:175]
 s_mov_b32 s23, 0x20000
 ds_read_b64_tr_b16 a[100:101], v9 offset:16384
 v_cndmask_b32 v3, 0, v15, vcc
 v_mfma_f32_16x16x32_bf16 v[172:175], a[72:75], a[148:151], v[172:175]
 ds_read_b64_tr_b16 a[102:103], v9 offset:20480
 v_xor_b32 v10, 65888, v6
 v_mfma_f32_16x16x32_bf16 v[172:175], a[76:79], a[156:159], v[172:175]
 s_waitcnt lgkmcnt(6)
 ds_read_b64_tr_b16 a[104:105], v10 offset:0
 v_accvgpr_write_b32 a229, v3
 v_mfma_f32_16x16x32_bf16 v[180:183], a[80:83], a[128:131], 0
 ds_read_b64_tr_b16 a[106:107], v10 offset:4096
 v_cmp_gt_i32 vcc, 18, v14
 v_mfma_f32_16x16x32_bf16 v[180:183], a[84:87], a[136:139], v[180:183]
 ds_read_b64_tr_b16 a[108:109], v10 offset:16384
 v_cndmask_b32 v3, 0, v15, vcc
 v_mfma_f32_16x16x32_bf16 v[180:183], a[88:91], a[144:147], v[180:183]
 s_waitcnt lgkmcnt(7)
 ds_read_b64_tr_b16 a[110:111], v10 offset:20480
 v_xor_b32 v7, 384, v6
 v_mfma_f32_16x16x32_bf16 v[180:183], a[92:95], a[152:155], v[180:183]
 ds_read_b64_tr_b16 a[64:65], v7 offset:0
 v_accvgpr_write_b32 a230, v3
 v_mfma_f32_16x16x32_bf16 v[188:191], a[80:83], a[132:135], 0
 ds_read_b64_tr_b16 a[66:67], v7 offset:4096
 v_cmp_gt_i32 vcc, 19, v14
 v_mfma_f32_16x16x32_bf16 v[188:191], a[84:87], a[140:143], v[188:191]
 ds_read_b64_tr_b16 a[68:69], v7 offset:16384
 v_cndmask_b32 v3, 0, v15, vcc
 v_mfma_f32_16x16x32_bf16 v[188:191], a[88:91], a[148:151], v[188:191]
 ds_read_b64_tr_b16 a[70:71], v7 offset:20480
 v_xor_b32 v8, 65920, v6
 v_mfma_f32_16x16x32_bf16 v[188:191], a[92:95], a[156:159], v[188:191]
 s_waitcnt lgkmcnt(6)
 ds_read_b64_tr_b16 a[72:73], v8 offset:0
 v_accvgpr_write_b32 a231, v3
 v_mfma_f32_16x16x32_bf16 v[196:199], a[96:99], a[128:131], 0
 ds_read_b64_tr_b16 a[74:75], v8 offset:4096
 v_cmp_gt_i32 vcc, 32, v14
 v_mfma_f32_16x16x32_bf16 v[196:199], a[100:103], a[136:139], v[196:199]
 ds_read_b64_tr_b16 a[76:77], v8 offset:16384
 v_cndmask_b32 v3, 0, v15, vcc
 v_mfma_f32_16x16x32_bf16 v[196:199], a[104:107], a[144:147], v[196:199]
 s_waitcnt lgkmcnt(7)
 ds_read_b64_tr_b16 a[78:79], v8 offset:20480
 v_xor_b32 v9, 416, v6
 v_mfma_f32_16x16x32_bf16 v[196:199], a[108:111], a[152:155], v[196:199]
 ds_read_b64_tr_b16 a[80:81], v9 offset:0
 v_accvgpr_write_b32 a232, v3
 v_mfma_f32_16x16x32_bf16 v[204:207], a[96:99], a[132:135], 0
 ds_read_b64_tr_b16 a[82:83], v9 offset:4096
 v_cmp_gt_i32 vcc, 33, v14
 v_mfma_f32_16x16x32_bf16 v[204:207], a[100:103], a[140:143], v[204:207]
 ds_read_b64_tr_b16 a[84:85], v9 offset:16384
 v_cndmask_b32 v3, 0, v15, vcc
 v_mfma_f32_16x16x32_bf16 v[204:207], a[104:107], a[148:151], v[204:207]
 ds_read_b64_tr_b16 a[86:87], v9 offset:20480
 v_xor_b32 v10, 65952, v6
 v_mfma_f32_16x16x32_bf16 v[204:207], a[108:111], a[156:159], v[204:207]
 s_waitcnt lgkmcnt(6)
 ds_read_b64_tr_b16 a[88:89], v10 offset:0
 v_accvgpr_write_b32 a233, v3
 v_mfma_f32_16x16x32_bf16 v[212:215], a[64:67], a[128:131], 0
 ds_read_b64_tr_b16 a[90:91], v10 offset:4096
 v_cmp_gt_i32 vcc, 34, v14
 v_mfma_f32_16x16x32_bf16 v[212:215], a[68:71], a[136:139], v[212:215]
 ds_read_b64_tr_b16 a[92:93], v10 offset:16384
 v_cndmask_b32 v3, 0, v15, vcc
 v_mfma_f32_16x16x32_bf16 v[212:215], a[72:75], a[144:147], v[212:215]
 s_waitcnt lgkmcnt(7)
 ds_read_b64_tr_b16 a[94:95], v10 offset:20480
 v_xor_b32 v7, 448, v6
 v_mfma_f32_16x16x32_bf16 v[212:215], a[76:79], a[152:155], v[212:215]
 s_add_u32 s59, s56, 32768
 ds_read_b64_tr_b16 a[96:97], v7 offset:0
 v_accvgpr_write_b32 a234, v3
 v_mfma_f32_16x16x32_bf16 v[220:223], a[64:67], a[132:135], 0
 ds_read_b64_tr_b16 a[98:99], v7 offset:4096
 buffer_store_dwordx4 v[32:35], v1, s[12:15], s59 offen offset:2048 sc1
 v_mfma_f32_16x16x32_bf16 v[220:223], a[68:71], a[140:143], v[220:223]
 ds_read_b64_tr_b16 a[100:101], v7 offset:16384
 v_cmp_gt_i32 vcc, 35, v14
 v_mfma_f32_16x16x32_bf16 v[220:223], a[72:75], a[148:151], v[220:223]
 ds_read_b64_tr_b16 a[102:103], v7 offset:20480
 v_xor_b32 v8, 65984, v6
 v_mfma_f32_16x16x32_bf16 v[220:223], a[76:79], a[156:159], v[220:223]
 s_waitcnt lgkmcnt(6)
 ds_read_b64_tr_b16 a[104:105], v8 offset:0
 v_cndmask_b32 v3, 0, v15, vcc
 v_mfma_f32_16x16x32_bf16 v[228:231], a[80:83], a[128:131], 0
 ds_read_b64_tr_b16 a[106:107], v8 offset:4096
 v_accvgpr_write_b32 a235, v3
 v_mfma_f32_16x16x32_bf16 v[228:231], a[84:87], a[136:139], v[228:231]
 ds_read_b64_tr_b16 a[108:109], v8 offset:16384
 v_cmp_gt_i32 vcc, 48, v14
 v_mfma_f32_16x16x32_bf16 v[228:231], a[88:91], a[144:147], v[228:231]
 s_waitcnt lgkmcnt(7)
 ds_read_b64_tr_b16 a[110:111], v8 offset:20480
 v_xor_b32 v9, 480, v6
 v_mfma_f32_16x16x32_bf16 v[228:231], a[92:95], a[152:155], v[228:231]
 ds_read_b64_tr_b16 a[64:65], v9 offset:0
 v_cndmask_b32 v3, 0, v15, vcc
 v_mfma_f32_16x16x32_bf16 v[236:239], a[80:83], a[132:135], 0
 ds_read_b64_tr_b16 a[66:67], v9 offset:4096
 v_accvgpr_write_b32 a236, v3
 v_mfma_f32_16x16x32_bf16 v[236:239], a[84:87], a[140:143], v[236:239]
 ds_read_b64_tr_b16 a[68:69], v9 offset:16384
 v_cmp_gt_i32 vcc, 49, v14
 v_mfma_f32_16x16x32_bf16 v[236:239], a[88:91], a[148:151], v[236:239]
 s_add_u32 s59, s56, 49152
 ds_read_b64_tr_b16 a[70:71], v9 offset:20480
 v_xor_b32 v10, 66016, v6
 v_mfma_f32_16x16x32_bf16 v[236:239], a[92:95], a[156:159], v[236:239]
 s_waitcnt lgkmcnt(6)
 ds_read_b64_tr_b16 a[72:73], v10 offset:0
 buffer_store_dwordx4 v[40:43], v1, s[12:15], s59 offen offset:2048 sc1
 v_mfma_f32_16x16x32_bf16 v[244:247], a[96:99], a[128:131], 0
 ds_read_b64_tr_b16 a[74:75], v10 offset:4096
 v_cndmask_b32 v3, 0, v15, vcc
 v_mfma_f32_16x16x32_bf16 v[244:247], a[100:103], a[136:139], v[244:247]
 s_waitcnt vmcnt(11)
 ds_read_b64_tr_b16 a[76:77], v10 offset:16384
 v_xor_b32 v7, 32768, v6
 v_mfma_f32_16x16x32_bf16 v[244:247], a[104:107], a[144:147], v[244:247]
 s_waitcnt lgkmcnt(7)
 s_barrier
 ds_read_b64_tr_b16 a[78:79], v10 offset:20480
 v_mfma_f32_16x16x32_bf16 v[244:247], a[108:111], a[152:155], v[244:247]
 ds_read_b64_tr_b16 a[80:81], v7 offset:0
 v_accvgpr_write_b32 a237, v3
 v_mfma_f32_16x16x32_bf16 v[252:255], a[96:99], a[132:135], 0
 ds_read_b64_tr_b16 a[82:83], v7 offset:4096
 v_cmp_gt_i32 vcc, 50, v14
 v_mfma_f32_16x16x32_bf16 v[252:255], a[100:103], a[140:143], v[252:255]
 ds_read_b64_tr_b16 a[84:85], v7 offset:16384
 v_cndmask_b32 v3, 0, v15, vcc
 v_mfma_f32_16x16x32_bf16 v[252:255], a[104:107], a[148:151], v[252:255]
 ds_read_b64_tr_b16 a[86:87], v7 offset:20480
 v_xor_b32 v8, 98304, v6
 v_mfma_f32_16x16x32_bf16 v[252:255], a[108:111], a[156:159], v[252:255]
 s_waitcnt lgkmcnt(6)
 ds_read_b64_tr_b16 a[88:89], v8 offset:0
 v_accvgpr_write_b32 a238, v3
 v_mfma_f32_16x16x32_bf16 v[16:19], a[64:67], a[128:131], 0
 s_add_u32 s59, s56, 49152
 ds_read_b64_tr_b16 a[90:91], v8 offset:4096
 v_cmp_gt_i32 vcc, 51, v14
 v_mfma_f32_16x16x32_bf16 v[16:19], a[68:71], a[136:139], v[16:19]
 ds_read_b64_tr_b16 a[92:93], v8 offset:16384
 buffer_store_dwordx4 v[48:51], v1, s[12:15], s59 offen offset:3072 sc1
 v_mfma_f32_16x16x32_bf16 v[16:19], a[72:75], a[144:147], v[16:19]
 s_waitcnt lgkmcnt(7)
 ds_read_b64_tr_b16 a[94:95], v8 offset:20480
 v_xor_b32 v9, 32800, v6
 v_mfma_f32_16x16x32_bf16 v[16:19], a[76:79], a[152:155], v[16:19]
 ds_read_b64_tr_b16 a[96:97], v9 offset:0
 v_cndmask_b32 v3, 0, v15, vcc
 v_mfma_f32_16x16x32_bf16 v[24:27], a[64:67], a[132:135], 0
 s_waitcnt lgkmcnt(9)
 ds_read_b64_tr_b16 a[98:99], v9 offset:4096
 v_accvgpr_write_b32 a239, v3
 v_mfma_f32_16x16x32_bf16 v[24:27], a[68:71], a[140:143], v[24:27]
 s_barrier
 ds_read_b64_tr_b16 a[100:101], v9 offset:16384
 v_mfma_f32_16x16x32_bf16 v[24:27], a[72:75], a[148:151], v[24:27]
 s_add_u32 m0, s29, 0
 ds_read_b64_tr_b16 a[102:103], v9 offset:20480
 v_xor_b32 v10, 98336, v6
 v_mfma_f32_16x16x32_bf16 v[24:27], a[76:79], a[156:159], v[24:27]
 s_waitcnt lgkmcnt(6)
 ds_read_b64_tr_b16 a[104:105], v10 offset:0
 v_add_u32 v2, 0x80000, v2
 v_mfma_f32_16x16x32_bf16 v[28:31], a[80:83], a[160:163], v[28:31]
 ds_read_b64_tr_b16 a[106:107], v10 offset:4096
 buffer_load_dwordx4 v2, s[16:19], 0 offen lds
 v_mfma_f32_16x16x32_bf16 v[28:31], a[84:87], a[168:171], v[28:31]
 s_add_u32 s59, s56, 32768
 ds_read_b64_tr_b16 a[108:109], v10 offset:16384
 v_mfma_f32_16x16x32_bf16 v[28:31], a[88:91], a[176:179], v[28:31]
 s_waitcnt lgkmcnt(7)
 ds_read_b64_tr_b16 a[110:111], v10 offset:20480
 v_xor_b32 v7, 32832, v6
 v_mfma_f32_16x16x32_bf16 v[28:31], a[92:95], a[184:187], v[28:31]
 ds_read_b64_tr_b16 a[64:65], v7 offset:0
 buffer_store_dwordx4 v[56:59], v1, s[12:15], s59 offen offset:3072 sc1
 v_mfma_f32_16x16x32_bf16 v[44:47], a[80:83], a[164:167], v[44:47]
 s_add_u32 m0, s29, 4096
 ds_read_b64_tr_b16 a[66:67], v7 offset:4096
 v_add_u32 v4, 4096, v1
 v_mfma_f32_16x16x32_bf16 v[44:47], a[84:87], a[172:175], v[44:47]
 ds_read_b64_tr_b16 a[68:69], v7 offset:16384
 buffer_load_dwordx4 v2, s[16:19], s48 offen lds
 v_mfma_f32_16x16x32_bf16 v[44:47], a[88:91], a[180:183], v[44:47]
 ds_read_b64_tr_b16 a[70:71], v7 offset:20480
 v_xor_b32 v8, 98368, v6
 v_mfma_f32_16x16x32_bf16 v[44:47], a[92:95], a[188:191], v[44:47]
 s_waitcnt lgkmcnt(6)
 ds_read_b64_tr_b16 a[72:73], v8 offset:0
 v_mfma_f32_16x16x32_bf16 v[52:55], a[96:99], a[160:163], v[52:55]
 ds_read_b64_tr_b16 a[74:75], v8 offset:4096
 v_mfma_f32_16x16x32_bf16 v[52:55], a[100:103], a[168:171], v[52:55]
 s_add_u32 m0, s29, 8192
 ds_read_b64_tr_b16 a[76:77], v8 offset:16384
 v_mfma_f32_16x16x32_bf16 v[52:55], a[104:107], a[176:179], v[52:55]
 s_waitcnt lgkmcnt(7)
 ds_read_b64_tr_b16 a[78:79], v8 offset:20480
 v_xor_b32 v9, 32864, v6
 v_mfma_f32_16x16x32_bf16 v[52:55], a[108:111], a[184:187], v[52:55]
 ds_read_b64_tr_b16 a[80:81], v9 offset:0
 buffer_load_dwordx4 v2, s[16:19], s49 offen lds
 v_mfma_f32_16x16x32_bf16 v[60:63], a[96:99], a[164:167], v[60:63]
 s_add_u32 s59, s56, 0
 ds_read_b64_tr_b16 a[82:83], v9 offset:4096
 v_mfma_f32_16x16x32_bf16 v[60:63], a[100:103], a[172:175], v[60:63]
 ds_read_b64_tr_b16 a[84:85], v9 offset:16384
 buffer_store_dwordx4 v[64:67], v1, s[12:15], s59 offen offset:0 sc1
 v_mfma_f32_16x16x32_bf16 v[60:63], a[104:107], a[180:183], v[60:63]
 s_add_u32 m0, s29, 12288
 ds_read_b64_tr_b16 a[86:87], v9 offset:20480
 v_xor_b32 v10, 98400, v6
 v_mfma_f32_16x16x32_bf16 v[60:63], a[108:111], a[188:191], v[60:63]
 s_waitcnt lgkmcnt(6)
 ds_read_b64_tr_b16 a[88:89], v10 offset:0
 v_mfma_f32_16x16x32_bf16 v[20:23], a[64:67], a[160:163], v[20:23]
 ds_read_b64_tr_b16 a[90:91], v10 offset:4096
 buffer_load_dwordx4 v2, s[16:19], s50 offen lds
 v_mfma_f32_16x16x32_bf16 v[20:23], a[68:71], a[168:171], v[20:23]
 ds_read_b64_tr_b16 a[92:93], v10 offset:16384
 v_mfma_f32_16x16x32_bf16 v[20:23], a[72:75], a[176:179], v[20:23]
 s_waitcnt lgkmcnt(7)
 ds_read_b64_tr_b16 a[94:95], v10 offset:20480
 v_xor_b32 v7, 32896, v6
 v_mfma_f32_16x16x32_bf16 v[20:23], a[76:79], a[184:187], v[20:23]
 ds_read_b64_tr_b16 a[96:97], v7 offset:0
 v_mfma_f32_16x16x32_bf16 v[36:39], a[64:67], a[164:167], v[36:39]
 s_add_u32 m0, s29, 16384
 ds_read_b64_tr_b16 a[98:99], v7 offset:4096
 v_mfma_f32_16x16x32_bf16 v[36:39], a[68:71], a[172:175], v[36:39]
 ds_read_b64_tr_b16 a[100:101], v7 offset:16384
 buffer_load_dwordx4 v2, s[16:19], s51 offen lds
 v_mfma_f32_16x16x32_bf16 v[36:39], a[72:75], a[180:183], v[36:39]
 s_add_u32 s59, s56, 16384
 ds_read_b64_tr_b16 a[102:103], v7 offset:20480
 v_xor_b32 v8, 98432, v6
 v_mfma_f32_16x16x32_bf16 v[36:39], a[76:79], a[188:191], v[36:39]
 s_waitcnt lgkmcnt(6)
 ds_read_b64_tr_b16 a[104:105], v8 offset:0
 buffer_store_dwordx4 v[72:75], v1, s[12:15], s59 offen offset:0 sc1
 v_mfma_f32_16x16x32_bf16 v[68:71], a[80:83], a[160:163], v[68:71]
 ds_read_b64_tr_b16 a[106:107], v8 offset:4096
 v_mfma_f32_16x16x32_bf16 v[68:71], a[84:87], a[168:171], v[68:71]
 s_add_u32 m0, s29, 20480
 ds_read_b64_tr_b16 a[108:109], v8 offset:16384
 v_mfma_f32_16x16x32_bf16 v[68:71], a[88:91], a[176:179], v[68:71]
 s_waitcnt lgkmcnt(7)
 ds_read_b64_tr_b16 a[110:111], v8 offset:20480
 v_xor_b32 v9, 32928, v6
 v_mfma_f32_16x16x32_bf16 v[68:71], a[92:95], a[184:187], v[68:71]
 ds_read_b64_tr_b16 a[64:65], v9 offset:0
 buffer_load_dwordx4 v2, s[16:19], s52 offen lds
 v_mfma_f32_16x16x32_bf16 v[76:79], a[80:83], a[164:167], v[76:79]
 ds_read_b64_tr_b16 a[66:67], v9 offset:4096
 v_mfma_f32_16x16x32_bf16 v[76:79], a[84:87], a[172:175], v[76:79]
 ds_read_b64_tr_b16 a[68:69], v9 offset:16384
 v_mfma_f32_16x16x32_bf16 v[76:79], a[88:91], a[180:183], v[76:79]
 s_add_u32 m0, s29, 24576
 ds_read_b64_tr_b16 a[70:71], v9 offset:20480
 v_xor_b32 v10, 98464, v6
 v_mfma_f32_16x16x32_bf16 v[76:79], a[92:95], a[188:191], v[76:79]
 s_waitcnt lgkmcnt(6)
 ds_read_b64_tr_b16 a[72:73], v10 offset:0
 v_mfma_f32_16x16x32_bf16 v[84:87], a[96:99], a[160:163], v[84:87]
 ds_read_b64_tr_b16 a[74:75], v10 offset:4096
 buffer_load_dwordx4 v2, s[16:19], s53 offen lds
 v_mfma_f32_16x16x32_bf16 v[84:87], a[100:103], a[168:171], v[84:87]
 s_add_u32 s59, s56, 16384
 ds_read_b64_tr_b16 a[76:77], v10 offset:16384
 v_mfma_f32_16x16x32_bf16 v[84:87], a[104:107], a[176:179], v[84:87]
 s_waitcnt lgkmcnt(7)
 ds_read_b64_tr_b16 a[78:79], v10 offset:20480
 v_xor_b32 v7, 32960, v6
 v_mfma_f32_16x16x32_bf16 v[84:87], a[108:111], a[184:187], v[84:87]
 ds_read_b64_tr_b16 a[80:81], v7 offset:0
 buffer_store_dwordx4 v[80:83], v1, s[12:15], s59 offen offset:1024 sc1
 v_mfma_f32_16x16x32_bf16 v[92:95], a[96:99], a[164:167], v[92:95]
 s_add_u32 m0, s29, 28672
 ds_read_b64_tr_b16 a[82:83], v7 offset:4096
 v_mfma_f32_16x16x32_bf16 v[92:95], a[100:103], a[172:175], v[92:95]
 ds_read_b64_tr_b16 a[84:85], v7 offset:16384
 buffer_load_dwordx4 v2, s[16:19], s54 offen lds
 v_mfma_f32_16x16x32_bf16 v[92:95], a[104:107], a[180:183], v[92:95]
 ds_read_b64_tr_b16 a[86:87], v7 offset:20480
 v_xor_b32 v8, 98496, v6
 v_mfma_f32_16x16x32_bf16 v[92:95], a[108:111], a[188:191], v[92:95]
 s_waitcnt lgkmcnt(6)
 ds_read_b64_tr_b16 a[88:89], v8 offset:0
 v_mfma_f32_16x16x32_bf16 v[100:103], a[64:67], a[160:163], v[100:103]
 s_add_u32 m0, s29, 65536
 ds_read_b64_tr_b16 a[90:91], v8 offset:4096
 v_add_u32 v2, 0x80000, v2
 v_mfma_f32_16x16x32_bf16 v[100:103], a[68:71], a[168:171], v[100:103]
 ds_read_b64_tr_b16 a[92:93], v8 offset:16384
 buffer_load_dwordx4 v2, s[16:19], 0 offen lds
 v_mfma_f32_16x16x32_bf16 v[100:103], a[72:75], a[176:179], v[100:103]
 s_waitcnt lgkmcnt(7)
 ds_read_b64_tr_b16 a[94:95], v8 offset:20480
 v_xor_b32 v9, 32992, v6
 v_mfma_f32_16x16x32_bf16 v[100:103], a[76:79], a[184:187], v[100:103]
 ds_read_b64_tr_b16 a[96:97], v9 offset:0
 v_mfma_f32_16x16x32_bf16 v[108:111], a[64:67], a[164:167], v[108:111]
 s_add_u32 s59, s56, 0
 ds_read_b64_tr_b16 a[98:99], v9 offset:4096
 v_mfma_f32_16x16x32_bf16 v[108:111], a[68:71], a[172:175], v[108:111]
 ds_read_b64_tr_b16 a[100:101], v9 offset:16384
 buffer_store_dwordx4 v[88:91], v1, s[12:15], s59 offen offset:1024 sc1
 v_mfma_f32_16x16x32_bf16 v[108:111], a[72:75], a[180:183], v[108:111]
 s_add_u32 m0, s29, 69632
 ds_read_b64_tr_b16 a[102:103], v9 offset:20480
 v_xor_b32 v10, 98528, v6
 v_mfma_f32_16x16x32_bf16 v[108:111], a[76:79], a[188:191], v[108:111]
 s_waitcnt lgkmcnt(6)
 ds_read_b64_tr_b16 a[104:105], v10 offset:0
 buffer_load_dwordx4 v2, s[16:19], s48 offen lds
 v_mfma_f32_16x16x32_bf16 v[116:119], a[80:83], a[160:163], v[116:119]
 ds_read_b64_tr_b16 a[106:107], v10 offset:4096
 v_mfma_f32_16x16x32_bf16 v[116:119], a[84:87], a[168:171], v[116:119]
 ds_read_b64_tr_b16 a[108:109], v10 offset:16384
 v_mfma_f32_16x16x32_bf16 v[116:119], a[88:91], a[176:179], v[116:119]
 s_waitcnt lgkmcnt(7)
 ds_read_b64_tr_b16 a[110:111], v10 offset:20480
 v_xor_b32 v7, 33024, v6
 v_mfma_f32_16x16x32_bf16 v[116:119], a[92:95], a[184:187], v[116:119]
 s_add_u32 m0, s29, 73728
 ds_read_b64_tr_b16 a[64:65], v7 offset:0
 v_mfma_f32_16x16x32_bf16 v[124:127], a[80:83], a[164:167], v[124:127]
 ds_read_b64_tr_b16 a[66:67], v7 offset:4096
 buffer_load_dwordx4 v2, s[16:19], s49 offen lds
 v_mfma_f32_16x16x32_bf16 v[124:127], a[84:87], a[172:175], v[124:127]
 ds_read_b64_tr_b16 a[68:69], v7 offset:16384
 v_mfma_f32_16x16x32_bf16 v[124:127], a[88:91], a[180:183], v[124:127]
 s_add_u32 s59, s56, 0
 ds_read_b64_tr_b16 a[70:71], v7 offset:20480
 v_xor_b32 v8, 98560, v6
 v_mfma_f32_16x16x32_bf16 v[124:127], a[92:95], a[188:191], v[124:127]
 s_waitcnt lgkmcnt(6)
 ds_read_b64_tr_b16 a[72:73], v8 offset:0
 buffer_store_dwordx4 v[96:99], v1, s[12:15], s59 offen offset:2048 sc1
 v_mfma_f32_16x16x32_bf16 v[132:135], a[96:99], a[160:163], v[132:135]
 s_add_u32 m0, s29, 77824
 ds_read_b64_tr_b16 a[74:75], v8 offset:4096
 v_mfma_f32_16x16x32_bf16 v[132:135], a[100:103], a[168:171], v[132:135]
 ds_read_b64_tr_b16 a[76:77], v8 offset:16384
 buffer_load_dwordx4 v2, s[16:19], s50 offen lds
 v_mfma_f32_16x16x32_bf16 v[132:135], a[104:107], a[176:179], v[132:135]
 s_waitcnt lgkmcnt(7)
 ds_read_b64_tr_b16 a[78:79], v8 offset:20480
 v_xor_b32 v9, 33056, v6
 v_mfma_f32_16x16x32_bf16 v[132:135], a[108:111], a[184:187], v[132:135]
 ds_read_b64_tr_b16 a[80:81], v9 offset:0
 v_mfma_f32_16x16x32_bf16 v[140:143], a[96:99], a[164:167], v[140:143]
 ds_read_b64_tr_b16 a[82:83], v9 offset:4096
 v_mfma_f32_16x16x32_bf16 v[140:143], a[100:103], a[172:175], v[140:143]
 ds_read_b64_tr_b16 a[84:85], v9 offset:16384
 v_mfma_f32_16x16x32_bf16 v[140:143], a[104:107], a[180:183], v[140:143]
 s_add_u32 m0, s29, 81920
 ds_read_b64_tr_b16 a[86:87], v9 offset:20480
 v_xor_b32 v10, 98592, v6
 v_mfma_f32_16x16x32_bf16 v[140:143], a[108:111], a[188:191], v[140:143]
 s_waitcnt lgkmcnt(6)
 ds_read_b64_tr_b16 a[88:89], v10 offset:0
 buffer_load_dwordx4 v2, s[16:19], s51 offen lds
 v_mfma_f32_16x16x32_bf16 v[148:151], a[64:67], a[160:163], v[148:151]
 s_add_u32 s59, s56, 16384
 ds_read_b64_tr_b16 a[90:91], v10 offset:4096
 v_mfma_f32_16x16x32_bf16 v[148:151], a[68:71], a[168:171], v[148:151]
 ds_read_b64_tr_b16 a[92:93], v10 offset:16384
 buffer_store_dwordx4 v[104:107], v1, s[12:15], s59 offen offset:2048 sc1
 v_mfma_f32_16x16x32_bf16 v[148:151], a[72:75], a[176:179], v[148:151]
 s_waitcnt lgkmcnt(7)
 ds_read_b64_tr_b16 a[94:95], v10 offset:20480
 v_xor_b32 v7, 33088, v6
 v_mfma_f32_16x16x32_bf16 v[148:151], a[76:79], a[184:187], v[148:151]
 s_add_u32 m0, s29, 86016
 ds_read_b64_tr_b16 a[96:97], v7 offset:0
 v_mfma_f32_16x16x32_bf16 v[156:159], a[64:67], a[164:167], v[156:159]
 ds_read_b64_tr_b16 a[98:99], v7 offset:4096
 buffer_load_dwordx4 v2, s[16:19], s52 offen lds
 v_mfma_f32_16x16x32_bf16 v[156:159], a[68:71], a[172:175], v[156:159]
 ds_read_b64_tr_b16 a[100:101], v7 offset:16384
 v_mfma_f32_16x16x32_bf16 v[156:159], a[72:75], a[180:183], v[156:159]
 ds_read_b64_tr_b16 a[102:103], v7 offset:20480
 v_xor_b32 v8, 98624, v6
 v_mfma_f32_16x16x32_bf16 v[156:159], a[76:79], a[188:191], v[156:159]
 s_waitcnt lgkmcnt(6)
 ds_read_b64_tr_b16 a[104:105], v8 offset:0
 v_mfma_f32_16x16x32_bf16 v[164:167], a[80:83], a[160:163], v[164:167]
 s_add_u32 m0, s29, 90112
 ds_read_b64_tr_b16 a[106:107], v8 offset:4096
 v_mfma_f32_16x16x32_bf16 v[164:167], a[84:87], a[168:171], v[164:167]
 ds_read_b64_tr_b16 a[108:109], v8 offset:16384
 buffer_load_dwordx4 v2, s[16:19], s53 offen lds
 v_mfma_f32_16x16x32_bf16 v[164:167], a[88:91], a[176:179], v[164:167]
 s_waitcnt lgkmcnt(7)
 ds_read_b64_tr_b16 a[110:111], v8 offset:20480
 v_xor_b32 v9, 33120, v6
 v_mfma_f32_16x16x32_bf16 v[164:167], a[92:95], a[184:187], v[164:167]
 s_add_u32 s59, s56, 16384
 ds_read_b64_tr_b16 a[64:65], v9 offset:0
 v_mfma_f32_16x16x32_bf16 v[172:175], a[80:83], a[164:167], v[172:175]
 ds_read_b64_tr_b16 a[66:67], v9 offset:4096
 buffer_store_dwordx4 v[112:115], v1, s[12:15], s59 offen offset:3072 sc1
 v_mfma_f32_16x16x32_bf16 v[172:175], a[84:87], a[172:175], v[172:175]
 ds_read_b64_tr_b16 a[68:69], v9 offset:16384
 v_mfma_f32_16x16x32_bf16 v[172:175], a[88:91], a[180:183], v[172:175]
 s_add_u32 m0, s29, 94208
 ds_read_b64_tr_b16 a[70:71], v9 offset:20480
 v_xor_b32 v10, 98656, v6
 v_mfma_f32_16x16x32_bf16 v[172:175], a[92:95], a[188:191], v[172:175]
 s_waitcnt lgkmcnt(6)
 ds_read_b64_tr_b16 a[72:73], v10 offset:0
 buffer_load_dwordx4 v2, s[16:19], s54 offen lds
 v_mfma_f32_16x16x32_bf16 v[180:183], a[96:99], a[160:163], v[180:183]
 ds_read_b64_tr_b16 a[74:75], v10 offset:4096
 v_mfma_f32_16x16x32_bf16 v[180:183], a[100:103], a[168:171], v[180:183]
 ds_read_b64_tr_b16 a[76:77], v10 offset:16384
 v_mfma_f32_16x16x32_bf16 v[180:183], a[104:107], a[176:179], v[180:183]
 s_waitcnt lgkmcnt(7)
 ds_read_b64_tr_b16 a[78:79], v10 offset:20480
 v_xor_b32 v7, 33152, v6
 v_mfma_f32_16x16x32_bf16 v[180:183], a[108:111], a[184:187], v[180:183]
 ds_read_b64_tr_b16 a[80:81], v7 offset:0
 v_mfma_f32_16x16x32_bf16 v[188:191], a[96:99], a[164:167], v[188:191]
 ds_read_b64_tr_b16 a[82:83], v7 offset:4096
 v_mfma_f32_16x16x32_bf16 v[188:191], a[100:103], a[172:175], v[188:191]
 ds_read_b64_tr_b16 a[84:85], v7 offset:16384
 v_mfma_f32_16x16x32_bf16 v[188:191], a[104:107], a[180:183], v[188:191]
 s_add_u32 s59, s56, 0
 ds_read_b64_tr_b16 a[86:87], v7 offset:20480
 v_xor_b32 v8, 98688, v6
 v_mfma_f32_16x16x32_bf16 v[188:191], a[108:111], a[188:191], v[188:191]
 s_waitcnt lgkmcnt(6)
 ds_read_b64_tr_b16 a[88:89], v8 offset:0
 buffer_store_dwordx4 v[120:123], v1, s[12:15], s59 offen offset:3072 sc1
 v_mfma_f32_16x16x32_bf16 v[196:199], a[64:67], a[160:163], v[196:199]
 ds_read_b64_tr_b16 a[90:91], v8 offset:4096
 v_mfma_f32_16x16x32_bf16 v[196:199], a[68:71], a[168:171], v[196:199]
 ds_read_b64_tr_b16 a[92:93], v8 offset:16384
 v_mfma_f32_16x16x32_bf16 v[196:199], a[72:75], a[176:179], v[196:199]
 s_waitcnt lgkmcnt(7)
 ds_read_b64_tr_b16 a[94:95], v8 offset:20480
 v_xor_b32 v9, 33184, v6
 v_mfma_f32_16x16x32_bf16 v[196:199], a[76:79], a[184:187], v[196:199]
 ds_read_b64_tr_b16 a[96:97], v9 offset:0
 v_mfma_f32_16x16x32_bf16 v[204:207], a[64:67], a[164:167], v[204:207]
 ds_read_b64_tr_b16 a[98:99], v9 offset:4096
 v_mfma_f32_16x16x32_bf16 v[204:207], a[68:71], a[172:175], v[204:207]
 ds_read_b64_tr_b16 a[100:101], v9 offset:16384
 v_mfma_f32_16x16x32_bf16 v[204:207], a[72:75], a[180:183], v[204:207]
 ds_read_b64_tr_b16 a[102:103], v9 offset:20480
 v_xor_b32 v10, 98720, v6
 v_mfma_f32_16x16x32_bf16 v[204:207], a[76:79], a[188:191], v[204:207]
 s_waitcnt lgkmcnt(6)
 ds_read_b64_tr_b16 a[104:105], v10 offset:0
 v_mfma_f32_16x16x32_bf16 v[212:215], a[80:83], a[160:163], v[212:215]
 s_add_u32 s59, s56, 4096
 ds_read_b64_tr_b16 a[106:107], v10 offset:4096
 v_mfma_f32_16x16x32_bf16 v[212:215], a[84:87], a[168:171], v[212:215]
 ds_read_b64_tr_b16 a[108:109], v10 offset:16384
 buffer_store_dwordx4 v[128:131], v1, s[12:15], s59 offen offset:0 sc1
 v_mfma_f32_16x16x32_bf16 v[212:215], a[88:91], a[176:179], v[212:215]
 s_waitcnt lgkmcnt(7)
 ds_read_b64_tr_b16 a[110:111], v10 offset:20480
 v_xor_b32 v7, 33216, v6
 v_mfma_f32_16x16x32_bf16 v[212:215], a[92:95], a[184:187], v[212:215]
 ds_read_b64_tr_b16 a[64:65], v7 offset:0
 v_lshrrev_b32 v120, 3, v0
 v_mfma_f32_16x16x32_bf16 v[220:223], a[80:83], a[164:167], v[220:223]
 ds_read_b64_tr_b16 a[66:67], v7 offset:4096
 v_mul_u32_u24 v120, 1792, v120
 v_mfma_f32_16x16x32_bf16 v[220:223], a[84:87], a[172:175], v[220:223]
 ds_read_b64_tr_b16 a[68:69], v7 offset:16384
 v_and_b32 v121, 7, v0
 v_mfma_f32_16x16x32_bf16 v[220:223], a[88:91], a[180:183], v[220:223]
 ds_read_b64_tr_b16 a[70:71], v7 offset:20480
 v_xor_b32 v8, 98752, v6
 v_mfma_f32_16x16x32_bf16 v[220:223], a[92:95], a[188:191], v[220:223]
 s_waitcnt lgkmcnt(6)
 ds_read_b64_tr_b16 a[72:73], v8 offset:0
 v_lshl_add_u32 v120, v121, 4, v120
 v_mfma_f32_16x16x32_bf16 v[228:231], a[96:99], a[160:163], v[228:231]
 ds_read_b64_tr_b16 a[74:75], v8 offset:4096
 v_add_u32 v120, s38, v120
 v_mfma_f32_16x16x32_bf16 v[228:231], a[100:103], a[168:171], v[228:231]
 s_add_u32 s59, s56, 20480
 ds_read_b64_tr_b16 a[76:77], v8 offset:16384
 v_lshlrev_b32 v121, 6, v121
 v_mfma_f32_16x16x32_bf16 v[228:231], a[104:107], a[176:179], v[228:231]
 s_waitcnt lgkmcnt(7)
 ds_read_b64_tr_b16 a[78:79], v8 offset:20480
 v_xor_b32 v9, 33248, v6
 v_mfma_f32_16x16x32_bf16 v[228:231], a[108:111], a[184:187], v[228:231]
 ds_read_b64_tr_b16 a[80:81], v9 offset:0
 buffer_store_dwordx4 v[136:139], v1, s[12:15], s59 offen offset:0 sc1
 v_mfma_f32_16x16x32_bf16 v[236:239], a[96:99], a[164:167], v[236:239]
 ds_read_b64_tr_b16 a[82:83], v9 offset:4096
 v_subrev_u32 v122, 2688, v120
 v_mfma_f32_16x16x32_bf16 v[236:239], a[100:103], a[172:175], v[236:239]
 ds_read_b64_tr_b16 a[84:85], v9 offset:16384
 v_subrev_u32 v123, 1792, v120
 v_mfma_f32_16x16x32_bf16 v[236:239], a[104:107], a[180:183], v[236:239]
 ds_read_b64_tr_b16 a[86:87], v9 offset:20480
 v_xor_b32 v10, 98784, v6
 v_mfma_f32_16x16x32_bf16 v[236:239], a[108:111], a[188:191], v[236:239]
 s_waitcnt lgkmcnt(6)
 ds_read_b64_tr_b16 a[88:89], v10 offset:0
 v_subrev_u32 v128, 896, v120
 v_mfma_f32_16x16x32_bf16 v[244:247], a[64:67], a[160:163], v[244:247]
 ds_read_b64_tr_b16 a[90:91], v10 offset:4096
 buffer_load_dwordx4 v[32:35], v122, s[4:7], 0 offen
 v_mfma_f32_16x16x32_bf16 v[244:247], a[68:71], a[168:171], v[244:247]
 s_waitcnt vmcnt(4)
 ds_read_b64_tr_b16 a[92:93], v10 offset:16384
 v_xor_b32 v7, 131072, v6
 v_mfma_f32_16x16x32_bf16 v[244:247], a[72:75], a[176:179], v[244:247]
 s_waitcnt lgkmcnt(7)
 s_barrier
 ds_read_b64_tr_b16 a[94:95], v10 offset:20480
 v_mfma_f32_16x16x32_bf16 v[244:247], a[76:79], a[184:187], v[244:247]
 s_and_b32 s58, s92, ~127
 ds_read_b64_tr_b16 a[96:97], v7 offset:0
 v_mfma_f32_16x16x32_bf16 v[252:255], a[64:67], a[164:167], v[252:255]
 s_add_u32 s59, s56, 20480
 ds_read_b64_tr_b16 a[98:99], v7 offset:4096
 v_mfma_f32_16x16x32_bf16 v[252:255], a[68:71], a[172:175], v[252:255]
 ds_read_b64_tr_b16 a[100:101], v7 offset:16384
 buffer_store_dwordx4 v[144:147], v1, s[12:15], s59 offen offset:1024 sc1
 v_mfma_f32_16x16x32_bf16 v[252:255], a[72:75], a[180:183], v[252:255]
 s_lshl_b32 s37, s25, 1
 ds_read_b64_tr_b16 a[102:103], v7 offset:20480
 v_xor_b32 v8, 0, v6
 v_mfma_f32_16x16x32_bf16 v[252:255], a[76:79], a[188:191], v[252:255]
 s_waitcnt lgkmcnt(6)
 ds_read_b64_tr_b16 a[104:105], v8 offset:0
 buffer_load_dwordx4 v[40:43], v123, s[4:7], 0 offen
 v_mfma_f32_16x16x32_bf16 v[16:19], a[80:83], a[160:163], v[16:19]
 s_sub_i32 s38, 12, s37
 ds_read_b64_tr_b16 a[106:107], v8 offset:4096
 v_mfma_f32_16x16x32_bf16 v[16:19], a[84:87], a[168:171], v[16:19]
 s_max_i32 s38, s38, 0
 ds_read_b64_tr_b16 a[108:109], v8 offset:16384
 v_mfma_f32_16x16x32_bf16 v[16:19], a[88:91], a[176:179], v[16:19]
 s_waitcnt lgkmcnt(7)
 ds_read_b64_tr_b16 a[110:111], v8 offset:20480
 v_xor_b32 v9, 65536, v6
 v_mfma_f32_16x16x32_bf16 v[16:19], a[92:95], a[184:187], v[16:19]
 ds_read_b64_tr_b16 a[64:65], v9 offset:0
 buffer_load_dwordx4 v[48:51], v128, s[4:7], 0 offen
 v_mfma_f32_16x16x32_bf16 v[24:27], a[80:83], a[164:167], v[24:27]
 s_mul_i32 s49, s26, 1048576
 ds_read_b64_tr_b16 a[66:67], v9 offset:4096
 v_mfma_f32_16x16x32_bf16 v[24:27], a[84:87], a[172:175], v[24:27]
 s_lshl_b32 s50, s3, 13
 ds_read_b64_tr_b16 a[68:69], v9 offset:16384
 v_mfma_f32_16x16x32_bf16 v[24:27], a[88:91], a[180:183], v[24:27]
 s_add_u32 s59, s56, 4096
 ds_read_b64_tr_b16 a[70:71], v9 offset:20480
 v_xor_b32 v10, 131104, v6
 v_mfma_f32_16x16x32_bf16 v[24:27], a[92:95], a[188:191], v[24:27]
 s_waitcnt lgkmcnt(6)
 ds_read_b64_tr_b16 a[72:73], v10 offset:0
 buffer_store_dwordx4 v[152:155], v1, s[12:15], s59 offen offset:1024 sc1
 v_mfma_f32_16x16x32_bf16 v[28:31], a[96:99], a[192:195], v[28:31]
 s_add_u32 s49, s49, s50
 ds_read_b64_tr_b16 a[74:75], v10 offset:4096
 v_mfma_f32_16x16x32_bf16 v[28:31], a[100:103], a[200:203], v[28:31]
 ds_read_b64_tr_b16 a[76:77], v10 offset:16384
 buffer_load_dwordx4 v[56:59], v120, s[4:7], 0 offen offset:0
 v_mfma_f32_16x16x32_bf16 v[28:31], a[104:107], a[208:211], v[28:31]
 s_waitcnt lgkmcnt(3)
 ds_read_b64_tr_b16 a[78:79], v10 offset:20480
 v_xor_b32 v7, 32, v6
 v_mfma_f32_16x16x32_bf16 v[28:31], a[108:111], a[216:219], v[28:31]
 s_mov_b32 s54, 2
 ds_read_b64_tr_b16 a[80:81], v7 offset:0
 v_mfma_f32_16x16x32_bf16 v[28:31], a[64:67], a[112:115], v[28:31]
 s_sub_u32 s44, 31, s37
 ds_read_b64_tr_b16 a[82:83], v7 offset:4096
 v_mfma_f32_16x16x32_bf16 v[28:31], a[68:71], a[120:123], v[28:31]
 ds_read_b64_tr_b16 a[84:85], v7 offset:16384
 buffer_load_dwordx4 v[64:67], v120, s[4:7], 0 offen offset:896
 v_mfma_f32_16x16x32_bf16 v[44:47], a[96:99], a[196:199], v[44:47]
 s_sub_u32 s44, s44, s38
 ds_read_b64_tr_b16 a[86:87], v7 offset:20480
 v_xor_b32 v8, 65568, v6
 v_mfma_f32_16x16x32_bf16 v[44:47], a[100:103], a[204:207], v[44:47]
 s_mul_i32 s55, s38, 32768
 ds_read_b64_tr_b16 a[88:89], v8 offset:0
 v_mfma_f32_16x16x32_bf16 v[44:47], a[104:107], a[212:215], v[44:47]
 s_add_u32 s59, s56, 4096
 ds_read_b64_tr_b16 a[90:91], v8 offset:4096
 v_mfma_f32_16x16x32_bf16 v[44:47], a[108:111], a[220:223], v[44:47]
 ds_read_b64_tr_b16 a[92:93], v8 offset:16384
 buffer_store_dwordx4 v[160:163], v1, s[12:15], s59 offen offset:2048 sc1
 v_mfma_f32_16x16x32_bf16 v[44:47], a[64:67], a[116:119], v[44:47]
 s_add_u32 s42, s55, s49
 ds_read_b64_tr_b16 a[94:95], v8 offset:20480
 v_xor_b32 v9, 131136, v6
 v_mfma_f32_16x16x32_bf16 v[44:47], a[68:71], a[124:127], v[44:47]
 s_waitcnt lgkmcnt(6)
 ds_read_b64_tr_b16 a[96:97], v9 offset:0
 buffer_load_dwordx4 v[72:75], v120, s[8:11], 0 offen offset:0
 v_mfma_f32_16x16x32_bf16 v[52:55], a[72:75], a[192:195], v[52:55]
 s_add_u32 s60, s58, 16
 ds_read_b64_tr_b16 a[98:99], v9 offset:4096
 v_mfma_f32_16x16x32_bf16 v[52:55], a[76:79], a[200:203], v[52:55]
 s_sub_u32 s45, 17, s37
 ds_read_b64_tr_b16 a[100:101], v9 offset:16384
 v_mfma_f32_16x16x32_bf16 v[52:55], a[80:83], a[208:211], v[52:55]
 s_waitcnt lgkmcnt(3)
 ds_read_b64_tr_b16 a[102:103], v9 offset:20480
 v_xor_b32 v10, 64, v6
 v_mfma_f32_16x16x32_bf16 v[52:55], a[84:87], a[216:219], v[52:55]
 ds_read_b64_tr_b16 a[104:105], v10 offset:0
 buffer_load_dwordx4 v[80:83], v120, s[8:11], 0 offen offset:896
 v_mfma_f32_16x16x32_bf16 v[52:55], a[88:91], a[112:115], v[52:55]
 s_sub_u32 s66, s42, 32768
 ds_read_b64_tr_b16 a[106:107], v10 offset:4096
 v_mfma_f32_16x16x32_bf16 v[52:55], a[92:95], a[120:123], v[52:55]
 s_add_u32 s42, s49, 491520
 ds_read_b64_tr_b16 a[108:109], v10 offset:16384
 v_mfma_f32_16x16x32_bf16 v[60:63], a[72:75], a[196:199], v[60:63]
 s_add_u32 s59, s56, 20480
 ds_read_b64_tr_b16 a[110:111], v10 offset:20480
 v_xor_b32 v7, 65600, v6
 v_mfma_f32_16x16x32_bf16 v[60:63], a[76:79], a[204:207], v[60:63]
 ds_read_b64_tr_b16 a[64:65], v7 offset:0
 buffer_store_dwordx4 v[168:171], v1, s[12:15], s59 offen offset:2048 sc1
 v_mfma_f32_16x16x32_bf16 v[60:63], a[80:83], a[212:215], v[60:63]
 s_add_u32 s67, s49, 524288
 ds_read_b64_tr_b16 a[66:67], v7 offset:4096
 v_mfma_f32_16x16x32_bf16 v[60:63], a[84:87], a[220:223], v[60:63]
 ds_read_b64_tr_b16 a[68:69], v7 offset:16384
 buffer_load_dwordx4 v[88:91], v121, s[20:23], s39 offen offset:0
 v_mfma_f32_16x16x32_bf16 v[60:63], a[88:91], a[116:119], v[60:63]
 s_add_u32 s68, s66, 16777216
 ds_read_b64_tr_b16 a[70:71], v7 offset:20480
 v_xor_b32 v8, 131168, v6
 v_mfma_f32_16x16x32_bf16 v[60:63], a[92:95], a[124:127], v[60:63]
 s_waitcnt lgkmcnt(6)
 ds_read_b64_tr_b16 a[72:73], v8 offset:0
 v_mfma_f32_16x16x32_bf16 v[20:23], a[96:99], a[192:195], v[20:23]
 s_add_u32 s69, s67, 16777216
 ds_read_b64_tr_b16 a[74:75], v8 offset:4096
 v_mfma_f32_16x16x32_bf16 v[20:23], a[100:103], a[200:203], v[20:23]
 ds_read_b64_tr_b16 a[76:77], v8 offset:16384
 buffer_load_dwordx4 v[96:99], v121, s[20:23], s39 offen offset:16
 v_mfma_f32_16x16x32_bf16 v[20:23], a[104:107], a[208:211], v[20:23]
 s_waitcnt lgkmcnt(3)
 ds_read_b64_tr_b16 a[78:79], v8 offset:20480
 v_xor_b32 v9, 96, v6
 v_mfma_f32_16x16x32_bf16 v[20:23], a[108:111], a[216:219], v[20:23]
 s_mov_b32 s70, 0xffff8000
 ds_read_b64_tr_b16 a[80:81], v9 offset:0
 v_mul_f32 v28, s34, v28
 v_mfma_f32_16x16x32_bf16 v[20:23], a[64:67], a[112:115], v[20:23]
 s_add_u32 s59, s56, 20480
 ds_read_b64_tr_b16 a[82:83], v9 offset:4096
 v_mul_f32 v29, s34, v29
 v_mfma_f32_16x16x32_bf16 v[20:23], a[68:71], a[120:123], v[20:23]
 ds_read_b64_tr_b16 a[84:85], v9 offset:16384
 buffer_store_dwordx4 v[176:179], v1, s[12:15], s59 offen offset:3072 sc1
 v_mfma_f32_16x16x32_bf16 v[36:39], a[96:99], a[196:199], v[36:39]
 s_mov_b32 s71, s70
 ds_read_b64_tr_b16 a[86:87], v9 offset:20480
 v_xor_b32 v10, 65632, v6
 v_mfma_f32_16x16x32_bf16 v[36:39], a[100:103], a[204:207], v[36:39]
 ds_read_b64_tr_b16 a[88:89], v10 offset:0
 buffer_load_dwordx4 v[104:107], v121, s[20:23], s39 offen offset:32
 v_mfma_f32_16x16x32_bf16 v[36:39], a[104:107], a[212:215], v[36:39]
 s_add_u32 s43, s42, 16777216
 ds_read_b64_tr_b16 a[90:91], v10 offset:4096
 v_mul_f32 v30, s34, v30
 v_mfma_f32_16x16x32_bf16 v[36:39], a[108:111], a[220:223], v[36:39]
 s_mov_b32 s40, s50
 ds_read_b64_tr_b16 a[92:93], v10 offset:16384
 v_mul_f32 v31, s34, v31
 v_mfma_f32_16x16x32_bf16 v[36:39], a[64:67], a[116:119], v[36:39]
 s_add_u32 s41, s50, 0x10000
 ds_read_b64_tr_b16 a[94:95], v10 offset:20480
 v_xor_b32 v7, 131200, v6
 v_mfma_f32_16x16x32_bf16 v[36:39], a[68:71], a[124:127], v[36:39]
 s_waitcnt lgkmcnt(6)
 ds_read_b64_tr_b16 a[96:97], v7 offset:0
 buffer_load_dwordx4 v[112:115], v121, s[20:23], s39 offen offset:48
 v_mfma_f32_16x16x32_bf16 v[68:71], a[72:75], a[192:195], v[68:71]
 s_lshr_b32 s61, s95, 4
 ds_read_b64_tr_b16 a[98:99], v7 offset:4096
 v_mul_f32 v52, s34, v52
 v_mfma_f32_16x16x32_bf16 v[68:71], a[76:79], a[200:203], v[68:71]
 s_add_u32 s59, s56, 4096
 ds_read_b64_tr_b16 a[100:101], v7 offset:16384
 v_mul_f32 v53, s34, v53
 v_mfma_f32_16x16x32_bf16 v[68:71], a[80:83], a[208:211], v[68:71]
 s_waitcnt lgkmcnt(3)
 ds_read_b64_tr_b16 a[102:103], v7 offset:20480
 v_xor_b32 v8, 128, v6
 v_mfma_f32_16x16x32_bf16 v[68:71], a[84:87], a[216:219], v[68:71]
 ds_read_b64_tr_b16 a[104:105], v8 offset:0
 buffer_store_dwordx4 v[184:187], v1, s[12:15], s59 offen offset:3072 sc1
 v_mfma_f32_16x16x32_bf16 v[68:71], a[88:91], a[112:115], v[68:71]
 s_lshl_b32 s61, s61, 7
 ds_read_b64_tr_b16 a[106:107], v8 offset:4096
 v_mul_f32 v54, s34, v54
 v_mfma_f32_16x16x32_bf16 v[68:71], a[92:95], a[120:123], v[68:71]
 s_add_u32 s61, s61, 84959232
 ds_read_b64_tr_b16 a[108:109], v8 offset:16384
 v_mul_f32 v55, s34, v55
 v_mfma_f32_16x16x32_bf16 v[76:79], a[72:75], a[196:199], v[76:79]
 s_mov_b32 s47, 0x4b800000
 ds_read_b64_tr_b16 a[110:111], v8 offset:20480
 v_xor_b32 v9, 65664, v6
 v_mfma_f32_16x16x32_bf16 v[76:79], a[76:79], a[204:207], v[76:79]
 s_lshl_b32 s30, s95, 1
 ds_read_b64_tr_b16 a[64:65], v9 offset:0
 v_cvt_pk_bf16_f32 v28, v28, v29
 v_mfma_f32_16x16x32_bf16 v[76:79], a[80:83], a[212:215], v[76:79]
 s_lshr_b32 s31, s3, 1
 ds_read_b64_tr_b16 a[66:67], v9 offset:4096
 v_cvt_pk_bf16_f32 v29, v30, v31
 v_mfma_f32_16x16x32_bf16 v[76:79], a[84:87], a[220:223], v[76:79]
 s_add_u32 s30, s30, s31
 ds_read_b64_tr_b16 a[68:69], v9 offset:16384
 v_cvt_pk_bf16_f32 v30, v52, v53
 v_mfma_f32_16x16x32_bf16 v[76:79], a[88:91], a[116:119], v[76:79]
 s_min_u32 s30, s30, 223
 ds_read_b64_tr_b16 a[70:71], v9 offset:20480
 v_xor_b32 v10, 131232, v6
 v_mfma_f32_16x16x32_bf16 v[76:79], a[92:95], a[124:127], v[76:79]
 s_waitcnt lgkmcnt(6)
 ds_read_b64_tr_b16 a[72:73], v10 offset:0
 v_cvt_pk_bf16_f32 v31, v54, v55
 v_mfma_f32_16x16x32_bf16 v[84:87], a[96:99], a[192:195], v[84:87]
 s_add_u32 s59, s56, 36864
 ds_read_b64_tr_b16 a[74:75], v10 offset:4096
 v_accvgpr_write_b32 a0, v28
 v_mfma_f32_16x16x32_bf16 v[84:87], a[100:103], a[200:203], v[84:87]
 ds_read_b64_tr_b16 a[76:77], v10 offset:16384
 buffer_store_dwordx4 v[192:195], v1, s[12:15], s59 offen offset:0 sc1
 v_mfma_f32_16x16x32_bf16 v[84:87], a[104:107], a[208:211], v[84:87]
 s_waitcnt lgkmcnt(3)
 ds_read_b64_tr_b16 a[78:79], v10 offset:20480
 v_xor_b32 v7, 160, v6
 v_mfma_f32_16x16x32_bf16 v[84:87], a[108:111], a[216:219], v[84:87]
 s_lshl_b32 s30, s30, 2
 ds_read_b64_tr_b16 a[80:81], v7 offset:0
 v_accvgpr_write_b32 a1, v29
 v_mfma_f32_16x16x32_bf16 v[84:87], a[64:67], a[112:115], v[84:87]
 s_and_b32 s4, s2, 127
 ds_read_b64_tr_b16 a[82:83], v7 offset:4096
 v_accvgpr_write_b32 a2, v30
 v_mfma_f32_16x16x32_bf16 v[84:87], a[68:71], a[120:123], v[84:87]
 s_lshl_b32 s4, s4, 2
 ds_read_b64_tr_b16 a[84:85], v7 offset:16384
 v_accvgpr_write_b32 a3, v31
 v_mfma_f32_16x16x32_bf16 v[92:95], a[96:99], a[196:199], v[92:95]
 s_add_u32 s4, s4, s3
 ds_read_b64_tr_b16 a[86:87], v7 offset:20480
 v_xor_b32 v8, 65696, v6
 v_mfma_f32_16x16x32_bf16 v[92:95], a[100:103], a[204:207], v[92:95]
 s_lshl_b32 s6, s4, 10
 ds_read_b64_tr_b16 a[88:89], v8 offset:0
 v_mul_f32 v44, s34, v44
 v_mfma_f32_16x16x32_bf16 v[92:95], a[104:107], a[212:215], v[92:95]
 s_add_u32 s6, s6, 83886080
 ds_read_b64_tr_b16 a[90:91], v8 offset:4096
 v_mul_f32 v45, s34, v45
 v_mfma_f32_16x16x32_bf16 v[92:95], a[108:111], a[220:223], v[92:95]
 s_mul_i32 s4, s4, 17408
 ds_read_b64_tr_b16 a[92:93], v8 offset:16384
 v_mul_f32 v46, s34, v46
 v_mfma_f32_16x16x32_bf16 v[92:95], a[64:67], a[116:119], v[92:95]
 s_add_u32 s59, s56, 53248
 ds_read_b64_tr_b16 a[94:95], v8 offset:20480
 v_xor_b32 v9, 131264, v6
 v_mfma_f32_16x16x32_bf16 v[92:95], a[68:71], a[124:127], v[92:95]
 s_waitcnt lgkmcnt(6)
 ds_read_b64_tr_b16 a[96:97], v9 offset:0
 buffer_store_dwordx4 v[200:203], v1, s[12:15], s59 offen offset:0 sc1
 v_mfma_f32_16x16x32_bf16 v[100:103], a[72:75], a[192:195], v[100:103]
 s_add_u32 s4, s4, 67108864
 ds_read_b64_tr_b16 a[98:99], v9 offset:4096
 v_mul_f32 v47, s34, v47
 v_mfma_f32_16x16x32_bf16 v[100:103], a[76:79], a[200:203], v[100:103]
 s_add_u32 s5, s4, 0x2000
 ds_read_b64_tr_b16 a[100:101], v9 offset:16384
 v_mul_f32 v60, s34, v60
 v_mfma_f32_16x16x32_bf16 v[100:103], a[80:83], a[208:211], v[100:103]
 s_waitcnt lgkmcnt(3)
 ds_read_b64_tr_b16 a[102:103], v9 offset:20480
 v_xor_b32 v10, 192, v6
 v_mfma_f32_16x16x32_bf16 v[100:103], a[84:87], a[216:219], v[100:103]
 s_mov_b32 s7, 0
 ds_read_b64_tr_b16 a[104:105], v10 offset:0
 v_mul_f32 v61, s34, v61
 v_mfma_f32_16x16x32_bf16 v[100:103], a[88:91], a[112:115], v[100:103]
 s_mov_b32 s53, 0
 ds_read_b64_tr_b16 a[106:107], v10 offset:4096
 v_mul_f32 v62, s34, v62
 v_mfma_f32_16x16x32_bf16 v[100:103], a[92:95], a[120:123], v[100:103]
 s_cmp_eq_u32 s38, 0
 s_cmov_b32 s4, 2.0
 ds_read_b64_tr_b16 a[108:109], v10 offset:16384
 v_mfma_f32_16x16x32_bf16 v[108:111], a[72:75], a[196:199], v[108:111]
 s_cmp_eq_u32 s38, 0
 s_cmov_b32 s5, 2.0
 ds_read_b64_tr_b16 a[110:111], v10 offset:20480
 v_xor_b32 v7, 65728, v6
 v_mfma_f32_16x16x32_bf16 v[108:111], a[76:79], a[204:207], v[108:111]
 s_cmp_eq_u32 s38, 0
 s_cmov_b32 s6, 2.0
 ds_read_b64_tr_b16 a[64:65], v7 offset:0
 v_mfma_f32_16x16x32_bf16 v[108:111], a[80:83], a[212:215], v[108:111]
 s_add_u32 s59, s56, 53248
 ds_read_b64_tr_b16 a[66:67], v7 offset:4096
 v_mul_f32 v63, s34, v63
 v_mfma_f32_16x16x32_bf16 v[108:111], a[84:87], a[220:223], v[108:111]
 ds_read_b64_tr_b16 a[68:69], v7 offset:16384
 buffer_store_dwordx4 v[208:211], v1, s[12:15], s59 offen offset:1024 sc1
 v_mfma_f32_16x16x32_bf16 v[108:111], a[88:91], a[116:119], v[108:111]
 s_mov_b64 s[8:9], s[12:13]
 ds_read_b64_tr_b16 a[70:71], v7 offset:20480
 v_xor_b32 v8, 131296, v6
 v_mfma_f32_16x16x32_bf16 v[108:111], a[92:95], a[124:127], v[108:111]
 s_waitcnt lgkmcnt(6)
 ds_read_b64_tr_b16 a[72:73], v8 offset:0
 v_cvt_pk_bf16_f32 v44, v44, v45
 v_mfma_f32_16x16x32_bf16 v[116:119], a[96:99], a[192:195], v[116:119]
 s_mov_b32 s10, s14
 ds_read_b64_tr_b16 a[74:75], v8 offset:4096
 v_cvt_pk_bf16_f32 v45, v46, v47
 v_mfma_f32_16x16x32_bf16 v[116:119], a[100:103], a[200:203], v[116:119]
 s_mov_b32 s76, 0
 ds_read_b64_tr_b16 a[76:77], v8 offset:16384
 v_cvt_pk_bf16_f32 v46, v60, v61
 v_mfma_f32_16x16x32_bf16 v[116:119], a[104:107], a[208:211], v[116:119]
 s_waitcnt lgkmcnt(3)
 ds_read_b64_tr_b16 a[78:79], v8 offset:20480
 v_xor_b32 v9, 224, v6
 v_mfma_f32_16x16x32_bf16 v[116:119], a[108:111], a[216:219], v[116:119]
 s_movk_i32 s77, 0x1000
 ds_read_b64_tr_b16 a[80:81], v9 offset:0
 v_cvt_pk_bf16_f32 v47, v62, v63
 v_mfma_f32_16x16x32_bf16 v[116:119], a[64:67], a[112:115], v[116:119]
 s_mov_b32 s51, 0
 ds_read_b64_tr_b16 a[82:83], v9 offset:4096
 v_accvgpr_write_b32 a32, v44
 v_mfma_f32_16x16x32_bf16 v[116:119], a[68:71], a[120:123], v[116:119]
 s_mul_i32 s78, s26, 229376
 ds_read_b64_tr_b16 a[84:85], v9 offset:16384
 v_accvgpr_write_b32 a33, v45
 v_mfma_f32_16x16x32_bf16 v[124:127], a[96:99], a[196:199], v[124:127]
 s_add_u32 s59, s56, 36864
 ds_read_b64_tr_b16 a[86:87], v9 offset:20480
 v_xor_b32 v10, 65760, v6
 v_mfma_f32_16x16x32_bf16 v[124:127], a[100:103], a[204:207], v[124:127]
 ds_read_b64_tr_b16 a[88:89], v10 offset:0
 buffer_store_dwordx4 v[216:219], v1, s[12:15], s59 offen offset:1024 sc1
 v_mfma_f32_16x16x32_bf16 v[124:127], a[104:107], a[212:215], v[124:127]
 s_add_u32 s79, s78, 28672
 ds_read_b64_tr_b16 a[90:91], v10 offset:4096
 v_accvgpr_write_b32 a34, v46
 v_mfma_f32_16x16x32_bf16 v[124:127], a[108:111], a[220:223], v[124:127]
 s_add_u32 s80, s78, 57344
 ds_read_b64_tr_b16 a[92:93], v10 offset:16384
 v_accvgpr_write_b32 a35, v47
 v_mfma_f32_16x16x32_bf16 v[124:127], a[64:67], a[116:119], v[124:127]
 s_add_u32 s81, s78, 86016
 ds_read_b64_tr_b16 a[94:95], v10 offset:20480
 v_xor_b32 v7, 131328, v6
 v_mfma_f32_16x16x32_bf16 v[124:127], a[68:71], a[124:127], v[124:127]
 s_waitcnt lgkmcnt(6)
 ds_read_b64_tr_b16 a[96:97], v7 offset:0
 v_mul_f32 v20, s34, v20
 v_mfma_f32_16x16x32_bf16 v[132:135], a[72:75], a[192:195], v[132:135]
 s_add_u32 s82, s78, 114688
 ds_read_b64_tr_b16 a[98:99], v7 offset:4096
 v_mul_f32 v21, s34, v21
 v_mfma_f32_16x16x32_bf16 v[132:135], a[76:79], a[200:203], v[132:135]
 s_add_u32 s83, s78, 143360
 ds_read_b64_tr_b16 a[100:101], v7 offset:16384
 v_mul_f32 v22, s34, v22
 v_mfma_f32_16x16x32_bf16 v[132:135], a[80:83], a[208:211], v[132:135]
 s_waitcnt lgkmcnt(3)
 ds_read_b64_tr_b16 a[102:103], v7 offset:20480
 v_xor_b32 v8, 256, v6
 v_mfma_f32_16x16x32_bf16 v[132:135], a[84:87], a[216:219], v[132:135]
 s_add_u32 s84, s78, 172032
 ds_read_b64_tr_b16 a[104:105], v8 offset:0
 v_mul_f32 v23, s34, v23
 v_mfma_f32_16x16x32_bf16 v[132:135], a[88:91], a[112:115], v[132:135]
 s_add_u32 s59, s56, 36864
 ds_read_b64_tr_b16 a[106:107], v8 offset:4096
 v_mul_f32 v68, s34, v68
 v_mfma_f32_16x16x32_bf16 v[132:135], a[92:95], a[120:123], v[132:135]
 ds_read_b64_tr_b16 a[108:109], v8 offset:16384
 buffer_store_dwordx4 v[224:227], v1, s[12:15], s59 offen offset:2048 sc1
 v_mfma_f32_16x16x32_bf16 v[140:143], a[72:75], a[196:199], v[140:143]
 s_add_u32 s85, s78, 200704
 ds_read_b64_tr_b16 a[110:111], v8 offset:20480
 v_xor_b32 v9, 65792, v6
 v_mfma_f32_16x16x32_bf16 v[140:143], a[76:79], a[204:207], v[140:143]
 s_add_u32 s59, s62, 0
 ds_read_b64_tr_b16 a[64:65], v9 offset:0
 v_mul_f32 v69, s34, v69
 v_mfma_f32_16x16x32_bf16 v[140:143], a[80:83], a[212:215], v[140:143]
 ds_read_b64_tr_b16 a[66:67], v9 offset:4096
 buffer_store_dwordx4 v[28:31], v1, s[12:15], s59 offen offset:0 sc1
 v_mfma_f32_16x16x32_bf16 v[140:143], a[84:87], a[220:223], v[140:143]
 ds_read_b64_tr_b16 a[68:69], v9 offset:16384
 v_mul_f32 v70, s34, v70
 v_mfma_f32_16x16x32_bf16 v[140:143], a[88:91], a[116:119], v[140:143]
 s_add_u32 s59, s62, 8192
 ds_read_b64_tr_b16 a[70:71], v9 offset:20480
 v_xor_b32 v10, 131360, v6
 v_mfma_f32_16x16x32_bf16 v[140:143], a[92:95], a[124:127], v[140:143]
 s_waitcnt lgkmcnt(6)
 ds_read_b64_tr_b16 a[72:73], v10 offset:0
 buffer_store_dwordx4 v[44:47], v1, s[12:15], s59 offen offset:0 sc1
 v_mfma_f32_16x16x32_bf16 v[148:151], a[96:99], a[192:195], v[148:151]
 ds_read_b64_tr_b16 a[74:75], v10 offset:4096
 v_mul_f32 v71, s34, v71
 v_mfma_f32_16x16x32_bf16 v[148:151], a[100:103], a[200:203], v[148:151]
 s_add_u32 s59, s56, 53248
 ds_read_b64_tr_b16 a[76:77], v10 offset:16384
 v_cvt_pk_bf16_f32 v20, v20, v21
 v_mfma_f32_16x16x32_bf16 v[148:151], a[104:107], a[208:211], v[148:151]
 s_waitcnt lgkmcnt(3)
 ds_read_b64_tr_b16 a[78:79], v10 offset:20480
 v_xor_b32 v7, 288, v6
 v_mfma_f32_16x16x32_bf16 v[148:151], a[108:111], a[216:219], v[148:151]
 ds_read_b64_tr_b16 a[80:81], v7 offset:0
 buffer_store_dwordx4 v[232:235], v1, s[12:15], s59 offen offset:2048 sc1
 v_mfma_f32_16x16x32_bf16 v[148:151], a[64:67], a[112:115], v[148:151]
 ds_read_b64_tr_b16 a[82:83], v7 offset:4096
 v_cvt_pk_bf16_f32 v21, v22, v23
 v_mfma_f32_16x16x32_bf16 v[148:151], a[68:71], a[120:123], v[148:151]
 ds_read_b64_tr_b16 a[84:85], v7 offset:16384
 v_cvt_pk_bf16_f32 v22, v68, v69
 v_mfma_f32_16x16x32_bf16 v[156:159], a[96:99], a[196:199], v[156:159]
 ds_read_b64_tr_b16 a[86:87], v7 offset:20480
 v_xor_b32 v8, 65824, v6
 v_mfma_f32_16x16x32_bf16 v[156:159], a[100:103], a[204:207], v[156:159]
 s_add_u32 s59, s62, 0
 ds_read_b64_tr_b16 a[88:89], v8 offset:0
 v_cvt_pk_bf16_f32 v23, v70, v71
 v_mfma_f32_16x16x32_bf16 v[156:159], a[104:107], a[212:215], v[156:159]
 ds_read_b64_tr_b16 a[90:91], v8 offset:4096
 buffer_store_dwordx4 v[20:23], v1, s[12:15], s59 offen offset:1024 sc1
 v_mfma_f32_16x16x32_bf16 v[156:159], a[108:111], a[220:223], v[156:159]
 ds_read_b64_tr_b16 a[92:93], v8 offset:16384
 v_accvgpr_write_b32 a4, v20
 v_mfma_f32_16x16x32_bf16 v[156:159], a[64:67], a[116:119], v[156:159]
 ds_read_b64_tr_b16 a[94:95], v8 offset:20480
 v_xor_b32 v9, 131392, v6
 v_mfma_f32_16x16x32_bf16 v[156:159], a[68:71], a[124:127], v[156:159]
 s_waitcnt lgkmcnt(6)
 ds_read_b64_tr_b16 a[96:97], v9 offset:0
 v_accvgpr_write_b32 a5, v21
 v_mfma_f32_16x16x32_bf16 v[164:167], a[72:75], a[192:195], v[164:167]
 s_add_u32 s59, s56, 53248
 ds_read_b64_tr_b16 a[98:99], v9 offset:4096
 v_accvgpr_write_b32 a6, v22
 v_mfma_f32_16x16x32_bf16 v[164:167], a[76:79], a[200:203], v[164:167]
 ds_read_b64_tr_b16 a[100:101], v9 offset:16384
 buffer_store_dwordx4 v[240:243], v1, s[12:15], s59 offen offset:3072 sc1
 v_mfma_f32_16x16x32_bf16 v[164:167], a[80:83], a[208:211], v[164:167]
 s_waitcnt lgkmcnt(3)
 ds_read_b64_tr_b16 a[102:103], v9 offset:20480
 v_xor_b32 v10, 320, v6
 v_mfma_f32_16x16x32_bf16 v[164:167], a[84:87], a[216:219], v[164:167]
 ds_read_b64_tr_b16 a[104:105], v10 offset:0
 v_accvgpr_write_b32 a7, v23
 v_mfma_f32_16x16x32_bf16 v[164:167], a[88:91], a[112:115], v[164:167]
 ds_read_b64_tr_b16 a[106:107], v10 offset:4096
 v_mul_f32 v36, s34, v36
 v_mfma_f32_16x16x32_bf16 v[164:167], a[92:95], a[120:123], v[164:167]
 ds_read_b64_tr_b16 a[108:109], v10 offset:16384
 v_mul_f32 v37, s34, v37
 v_mfma_f32_16x16x32_bf16 v[172:175], a[72:75], a[196:199], v[172:175]
 ds_read_b64_tr_b16 a[110:111], v10 offset:20480
 v_xor_b32 v7, 65856, v6
 v_mfma_f32_16x16x32_bf16 v[172:175], a[76:79], a[204:207], v[172:175]
 ds_read_b64_tr_b16 a[64:65], v7 offset:0
 v_mul_f32 v38, s34, v38
 v_mfma_f32_16x16x32_bf16 v[172:175], a[80:83], a[212:215], v[172:175]
 ds_read_b64_tr_b16 a[66:67], v7 offset:4096
 v_mul_f32 v39, s34, v39
 v_mfma_f32_16x16x32_bf16 v[172:175], a[84:87], a[220:223], v[172:175]
 ds_read_b64_tr_b16 a[68:69], v7 offset:16384
 v_mul_f32 v76, s34, v76
 v_mfma_f32_16x16x32_bf16 v[172:175], a[88:91], a[116:119], v[172:175]
 s_add_u32 s59, s56, 36864
 ds_read_b64_tr_b16 a[70:71], v7 offset:20480
 v_xor_b32 v8, 131424, v6
 v_mfma_f32_16x16x32_bf16 v[172:175], a[92:95], a[124:127], v[172:175]
 s_waitcnt lgkmcnt(6)
 ds_read_b64_tr_b16 a[72:73], v8 offset:0
 buffer_store_dwordx4 v[248:251], v1, s[12:15], s59 offen offset:3072 sc1
 v_mfma_f32_16x16x32_bf16 v[180:183], a[96:99], a[192:195], v[180:183]
 ds_read_b64_tr_b16 a[74:75], v8 offset:4096
 v_mul_f32 v77, s34, v77
 v_mfma_f32_16x16x32_bf16 v[180:183], a[100:103], a[200:203], v[180:183]
 ds_read_b64_tr_b16 a[76:77], v8 offset:16384
 v_mul_f32 v78, s34, v78
 v_mfma_f32_16x16x32_bf16 v[180:183], a[104:107], a[208:211], v[180:183]
 s_waitcnt lgkmcnt(3)
 ds_read_b64_tr_b16 a[78:79], v8 offset:20480
 v_xor_b32 v9, 352, v6
 v_mfma_f32_16x16x32_bf16 v[180:183], a[108:111], a[216:219], v[180:183]
 ds_read_b64_tr_b16 a[80:81], v9 offset:0
 v_mul_f32 v79, s34, v79
 v_mfma_f32_16x16x32_bf16 v[180:183], a[64:67], a[112:115], v[180:183]
 ds_read_b64_tr_b16 a[82:83], v9 offset:4096
 v_cvt_pk_bf16_f32 v36, v36, v37
 v_mfma_f32_16x16x32_bf16 v[180:183], a[68:71], a[120:123], v[180:183]
 ds_read_b64_tr_b16 a[84:85], v9 offset:16384
 v_cvt_pk_bf16_f32 v37, v38, v39
 v_mfma_f32_16x16x32_bf16 v[188:191], a[96:99], a[196:199], v[188:191]
 ds_read_b64_tr_b16 a[86:87], v9 offset:20480
 v_xor_b32 v10, 65888, v6
 v_mfma_f32_16x16x32_bf16 v[188:191], a[100:103], a[204:207], v[188:191]
 ds_read_b64_tr_b16 a[88:89], v10 offset:0
 v_cvt_pk_bf16_f32 v38, v76, v77
 v_mfma_f32_16x16x32_bf16 v[188:191], a[104:107], a[212:215], v[188:191]
 s_add_u32 s59, s62, 8192
 ds_read_b64_tr_b16 a[90:91], v10 offset:4096
 v_cvt_pk_bf16_f32 v39, v78, v79
 v_mfma_f32_16x16x32_bf16 v[188:191], a[108:111], a[220:223], v[188:191]
 ds_read_b64_tr_b16 a[92:93], v10 offset:16384
 buffer_store_dwordx4 v[36:39], v1, s[12:15], s59 offen offset:1024 sc1
 v_mfma_f32_16x16x32_bf16 v[188:191], a[64:67], a[116:119], v[188:191]
 ds_read_b64_tr_b16 a[94:95], v10 offset:20480
 v_xor_b32 v7, 131456, v6
 v_mfma_f32_16x16x32_bf16 v[188:191], a[68:71], a[124:127], v[188:191]
 s_waitcnt lgkmcnt(6)
 ds_read_b64_tr_b16 a[96:97], v7 offset:0
 v_accvgpr_write_b32 a36, v36
 v_mfma_f32_16x16x32_bf16 v[196:199], a[72:75], a[192:195], v[196:199]
 ds_read_b64_tr_b16 a[98:99], v7 offset:4096
 v_accvgpr_write_b32 a37, v37
 v_mfma_f32_16x16x32_bf16 v[196:199], a[76:79], a[200:203], v[196:199]
 ds_read_b64_tr_b16 a[100:101], v7 offset:16384
 v_accvgpr_write_b32 a38, v38
 v_mfma_f32_16x16x32_bf16 v[196:199], a[80:83], a[208:211], v[196:199]
 s_waitcnt lgkmcnt(3)
 ds_read_b64_tr_b16 a[102:103], v7 offset:20480
 v_xor_b32 v8, 384, v6
 v_mfma_f32_16x16x32_bf16 v[196:199], a[84:87], a[216:219], v[196:199]
 ds_read_b64_tr_b16 a[104:105], v8 offset:0
 v_accvgpr_write_b32 a39, v39
 v_mfma_f32_16x16x32_bf16 v[196:199], a[88:91], a[112:115], v[196:199]
 ds_read_b64_tr_b16 a[106:107], v8 offset:4096
 v_mul_f32 v84, s34, v84
 v_mfma_f32_16x16x32_bf16 v[196:199], a[92:95], a[120:123], v[196:199]
 ds_read_b64_tr_b16 a[108:109], v8 offset:16384
 v_mul_f32 v85, s34, v85
 v_mfma_f32_16x16x32_bf16 v[204:207], a[72:75], a[196:199], v[204:207]
 ds_read_b64_tr_b16 a[110:111], v8 offset:20480
 v_xor_b32 v9, 65920, v6
 v_mfma_f32_16x16x32_bf16 v[204:207], a[76:79], a[204:207], v[204:207]
 ds_read_b64_tr_b16 a[64:65], v9 offset:0
 v_mul_f32 v86, s34, v86
 v_mfma_f32_16x16x32_bf16 v[204:207], a[80:83], a[212:215], v[204:207]
 ds_read_b64_tr_b16 a[66:67], v9 offset:4096
 v_mul_f32 v87, s34, v87
 v_mfma_f32_16x16x32_bf16 v[204:207], a[84:87], a[220:223], v[204:207]
 ds_read_b64_tr_b16 a[68:69], v9 offset:16384
 v_mul_f32 v100, s34, v100
 v_mfma_f32_16x16x32_bf16 v[204:207], a[88:91], a[116:119], v[204:207]
 ds_read_b64_tr_b16 a[70:71], v9 offset:20480
 v_xor_b32 v10, 131488, v6
 v_mfma_f32_16x16x32_bf16 v[204:207], a[92:95], a[124:127], v[204:207]
 s_waitcnt lgkmcnt(6)
 ds_read_b64_tr_b16 a[72:73], v10 offset:0
 v_mul_f32 v101, s34, v101
 v_mfma_f32_16x16x32_bf16 v[212:215], a[96:99], a[192:195], v[212:215]
 ds_read_b64_tr_b16 a[74:75], v10 offset:4096
 v_mul_f32 v102, s34, v102
 v_mfma_f32_16x16x32_bf16 v[212:215], a[100:103], a[200:203], v[212:215]
 ds_read_b64_tr_b16 a[76:77], v10 offset:16384
 v_mul_f32 v103, s34, v103
 v_mfma_f32_16x16x32_bf16 v[212:215], a[104:107], a[208:211], v[212:215]
 s_waitcnt lgkmcnt(3)
 ds_read_b64_tr_b16 a[78:79], v10 offset:20480
 v_xor_b32 v7, 416, v6
 v_mfma_f32_16x16x32_bf16 v[212:215], a[108:111], a[216:219], v[212:215]
 ds_read_b64_tr_b16 a[80:81], v7 offset:0
 v_cvt_pk_bf16_f32 v84, v84, v85
 v_mfma_f32_16x16x32_bf16 v[212:215], a[64:67], a[112:115], v[212:215]
 ds_read_b64_tr_b16 a[82:83], v7 offset:4096
 v_cvt_pk_bf16_f32 v85, v86, v87
 v_mfma_f32_16x16x32_bf16 v[212:215], a[68:71], a[120:123], v[212:215]
 ds_read_b64_tr_b16 a[84:85], v7 offset:16384
 v_cvt_pk_bf16_f32 v86, v100, v101
 v_mfma_f32_16x16x32_bf16 v[220:223], a[96:99], a[196:199], v[220:223]
 ds_read_b64_tr_b16 a[86:87], v7 offset:20480
 v_xor_b32 v8, 65952, v6
 v_mfma_f32_16x16x32_bf16 v[220:223], a[100:103], a[204:207], v[220:223]
 s_add_u32 s59, s62, 0
 ds_read_b64_tr_b16 a[88:89], v8 offset:0
 v_cvt_pk_bf16_f32 v87, v102, v103
 v_mfma_f32_16x16x32_bf16 v[220:223], a[104:107], a[212:215], v[220:223]
 ds_read_b64_tr_b16 a[90:91], v8 offset:4096
 buffer_store_dwordx4 v[84:87], v1, s[12:15], s59 offen offset:2048 sc1
 v_mfma_f32_16x16x32_bf16 v[220:223], a[108:111], a[220:223], v[220:223]
 ds_read_b64_tr_b16 a[92:93], v8 offset:16384
 v_accvgpr_write_b32 a8, v84
 v_mfma_f32_16x16x32_bf16 v[220:223], a[64:67], a[116:119], v[220:223]
 ds_read_b64_tr_b16 a[94:95], v8 offset:20480
 v_xor_b32 v9, 131520, v6
 v_mfma_f32_16x16x32_bf16 v[220:223], a[68:71], a[124:127], v[220:223]
 s_waitcnt lgkmcnt(6)
 ds_read_b64_tr_b16 a[96:97], v9 offset:0
 v_accvgpr_write_b32 a9, v85
 v_mfma_f32_16x16x32_bf16 v[228:231], a[72:75], a[192:195], v[228:231]
 ds_read_b64_tr_b16 a[98:99], v9 offset:4096
 v_accvgpr_write_b32 a10, v86
 v_mfma_f32_16x16x32_bf16 v[228:231], a[76:79], a[200:203], v[228:231]
 ds_read_b64_tr_b16 a[100:101], v9 offset:16384
 v_accvgpr_write_b32 a11, v87
 v_mfma_f32_16x16x32_bf16 v[228:231], a[80:83], a[208:211], v[228:231]
 s_waitcnt lgkmcnt(3)
 ds_read_b64_tr_b16 a[102:103], v9 offset:20480
 v_xor_b32 v10, 448, v6
 v_mfma_f32_16x16x32_bf16 v[228:231], a[84:87], a[216:219], v[228:231]
 ds_read_b64_tr_b16 a[104:105], v10 offset:0
 v_mul_f32 v92, s34, v92
 v_mfma_f32_16x16x32_bf16 v[228:231], a[88:91], a[112:115], v[228:231]
 ds_read_b64_tr_b16 a[106:107], v10 offset:4096
 v_mul_f32 v93, s34, v93
 v_mfma_f32_16x16x32_bf16 v[228:231], a[92:95], a[120:123], v[228:231]
 ds_read_b64_tr_b16 a[108:109], v10 offset:16384
 v_mul_f32 v94, s34, v94
 v_mfma_f32_16x16x32_bf16 v[236:239], a[72:75], a[196:199], v[236:239]
 ds_read_b64_tr_b16 a[110:111], v10 offset:20480
 v_xor_b32 v7, 65984, v6
 v_mfma_f32_16x16x32_bf16 v[236:239], a[76:79], a[204:207], v[236:239]
 ds_read_b64_tr_b16 a[64:65], v7 offset:0
 buffer_load_dword v13, v12, s[12:15], s58 offen sc1
 v_mfma_f32_16x16x32_bf16 v[236:239], a[80:83], a[212:215], v[236:239]
 ds_read_b64_tr_b16 a[66:67], v7 offset:4096
 v_mul_f32 v95, s34, v95
 v_mfma_f32_16x16x32_bf16 v[236:239], a[84:87], a[220:223], v[236:239]
 ds_read_b64_tr_b16 a[68:69], v7 offset:16384
 v_mul_f32 v108, s34, v108
 v_mfma_f32_16x16x32_bf16 v[236:239], a[88:91], a[116:119], v[236:239]
 ds_read_b64_tr_b16 a[70:71], v7 offset:20480
 v_xor_b32 v8, 131552, v6
 v_mfma_f32_16x16x32_bf16 v[236:239], a[92:95], a[124:127], v[236:239]
 s_waitcnt lgkmcnt(6)
 ds_read_b64_tr_b16 a[72:73], v8 offset:0
 v_mul_f32 v109, s34, v109
 v_mfma_f32_16x16x32_bf16 v[244:247], a[96:99], a[192:195], v[244:247]
 ds_read_b64_tr_b16 a[74:75], v8 offset:4096
 v_mul_f32 v110, s34, v110
 v_mfma_f32_16x16x32_bf16 v[244:247], a[100:103], a[200:203], v[244:247]
 ds_read_b64_tr_b16 a[76:77], v8 offset:16384
 v_mul_f32 v111, s34, v111
 v_mfma_f32_16x16x32_bf16 v[244:247], a[104:107], a[208:211], v[244:247]
 s_waitcnt lgkmcnt(3)
 ds_read_b64_tr_b16 a[78:79], v8 offset:20480
 v_xor_b32 v9, 480, v6
 v_mfma_f32_16x16x32_bf16 v[244:247], a[108:111], a[216:219], v[244:247]
 ds_read_b64_tr_b16 a[80:81], v9 offset:0
 v_cvt_pk_bf16_f32 v92, v92, v93
 v_mfma_f32_16x16x32_bf16 v[244:247], a[64:67], a[112:115], v[244:247]
 ds_read_b64_tr_b16 a[82:83], v9 offset:4096
 v_cvt_pk_bf16_f32 v93, v94, v95
 v_mfma_f32_16x16x32_bf16 v[244:247], a[68:71], a[120:123], v[244:247]
 ds_read_b64_tr_b16 a[84:85], v9 offset:16384
 v_cvt_pk_bf16_f32 v94, v108, v109
 v_mfma_f32_16x16x32_bf16 v[252:255], a[96:99], a[196:199], v[252:255]
 ds_read_b64_tr_b16 a[86:87], v9 offset:20480
 v_xor_b32 v10, 66016, v6
 v_mfma_f32_16x16x32_bf16 v[252:255], a[100:103], a[204:207], v[252:255]
 s_add_u32 s59, s62, 8192
 ds_read_b64_tr_b16 a[88:89], v10 offset:0
 v_cvt_pk_bf16_f32 v95, v110, v111
 v_mfma_f32_16x16x32_bf16 v[252:255], a[104:107], a[212:215], v[252:255]
 ds_read_b64_tr_b16 a[90:91], v10 offset:4096
 buffer_store_dwordx4 v[92:95], v1, s[12:15], s59 offen offset:2048 sc1
 v_mfma_f32_16x16x32_bf16 v[252:255], a[108:111], a[220:223], v[252:255]
 ds_read_b64_tr_b16 a[92:93], v10 offset:16384
 v_accvgpr_write_b32 a40, v92
 v_mfma_f32_16x16x32_bf16 v[252:255], a[64:67], a[116:119], v[252:255]
 ds_read_b64_tr_b16 a[94:95], v10 offset:20480
 v_accvgpr_write_b32 a41, v93
 v_mfma_f32_16x16x32_bf16 v[252:255], a[68:71], a[124:127], v[252:255]
 s_waitcnt lgkmcnt(6)
 v_accvgpr_write_b32 a42, v94
 v_accvgpr_write_b32 a43, v95
 v_mfma_f32_16x16x32_bf16 v[16:19], a[72:75], a[192:195], v[16:19]
 v_mfma_f32_16x16x32_bf16 v[16:19], a[76:79], a[200:203], v[16:19]
 v_mfma_f32_16x16x32_bf16 v[16:19], a[80:83], a[208:211], v[16:19]
 s_waitcnt lgkmcnt(0)
 v_mfma_f32_16x16x32_bf16 v[16:19], a[84:87], a[216:219], v[16:19]
 v_mfma_f32_16x16x32_bf16 v[16:19], a[88:91], a[112:115], v[16:19]
 v_mfma_f32_16x16x32_bf16 v[16:19], a[92:95], a[120:123], v[16:19]
 v_mfma_f32_16x16x32_bf16 v[24:27], a[72:75], a[196:199], v[24:27]
 v_mfma_f32_16x16x32_bf16 v[24:27], a[76:79], a[204:207], v[24:27]
 v_mfma_f32_16x16x32_bf16 v[24:27], a[80:83], a[212:215], v[24:27]
 v_mfma_f32_16x16x32_bf16 v[24:27], a[84:87], a[220:223], v[24:27]
 s_waitcnt lgkmcnt(0)
 v_mfma_f32_16x16x32_bf16 v[24:27], a[88:91], a[116:119], v[24:27]
 s_barrier
 v_mfma_f32_16x16x32_bf16 v[24:27], a[92:95], a[124:127], v[24:27]
 s_waitcnt vmcnt(1)
 v_cmp_ne_u32 s[16:17], 0, v13
 v_cmp_gt_u32 vcc, 256, v5
 s_or_b64 vcc, vcc, s[16:17]
 s_mov_b32 m0, s40
 s_cselect_b32 s48, 0, 1
 s_cselect_b32 s52, 2.0, s42
 buffer_load_dwordx4 v1, s[12:15], s52 offen offset:0 sc1 lds
 v_pk_mul_f32 v[116:117], v[116:117], s[34:35]
 v_pk_mul_f32 v[118:119], v[118:119], s[34:35]
 v_pk_mul_f32 v[132:133], v[132:133], s[34:35]
 v_pk_mul_f32 v[134:135], v[134:135], s[34:35]
 v_cvt_pk_bf16_f32 v116, v116, v117
 v_cvt_pk_bf16_f32 v117, v118, v119
 v_cvt_pk_bf16_f32 v118, v132, v133
 v_cvt_pk_bf16_f32 v119, v134, v135
 s_add_u32 s59, s62, 0
 buffer_store_dwordx4 v[116:119], v1, s[12:15], s59 offen offset:3072 sc1
 v_accvgpr_write_b32 a12, v116
 v_accvgpr_write_b32 a13, v117
 v_accvgpr_write_b32 a14, v118
 v_accvgpr_write_b32 a15, v119
 v_pk_mul_f32 v[124:125], v[124:125], s[34:35]
 v_pk_mul_f32 v[126:127], v[126:127], s[34:35]
 v_pk_mul_f32 v[140:141], v[140:141], s[34:35]
 v_pk_mul_f32 v[142:143], v[142:143], s[34:35]
 buffer_load_dwordx4 v1, s[12:15], s52 offen offset:1024 sc1 lds
 v_cvt_pk_bf16_f32 v124, v124, v125
 v_cvt_pk_bf16_f32 v125, v126, v127
 v_cvt_pk_bf16_f32 v126, v140, v141
 v_cvt_pk_bf16_f32 v127, v142, v143
 s_add_u32 s59, s62, 8192
 buffer_store_dwordx4 v[124:127], v1, s[12:15], s59 offen offset:3072 sc1
 v_accvgpr_write_b32 a44, v124
 v_accvgpr_write_b32 a45, v125
 v_accvgpr_write_b32 a46, v126
 v_accvgpr_write_b32 a47, v127
 v_pk_mul_f32 v[148:149], v[148:149], s[34:35]
 v_pk_mul_f32 v[150:151], v[150:151], s[34:35]
 v_pk_mul_f32 v[164:165], v[164:165], s[34:35]
 v_pk_mul_f32 v[166:167], v[166:167], s[34:35]
 v_cvt_pk_bf16_f32 v148, v148, v149
 v_cvt_pk_bf16_f32 v149, v150, v151
 v_cvt_pk_bf16_f32 v150, v164, v165
 buffer_load_dwordx4 v1, s[12:15], s52 offen offset:2048 sc1 lds
 v_cvt_pk_bf16_f32 v151, v166, v167
 s_add_u32 s59, s62, 4096
 buffer_store_dwordx4 v[148:151], v1, s[12:15], s59 offen offset:0 sc1
 v_accvgpr_write_b32 a16, v148
 v_accvgpr_write_b32 a17, v149
 v_accvgpr_write_b32 a18, v150
 v_accvgpr_write_b32 a19, v151
 v_pk_mul_f32 v[156:157], v[156:157], s[34:35]
 v_pk_mul_f32 v[158:159], v[158:159], s[34:35]
 v_pk_mul_f32 v[172:173], v[172:173], s[34:35]
 v_pk_mul_f32 v[174:175], v[174:175], s[34:35]
 v_cvt_pk_bf16_f32 v156, v156, v157
 v_cvt_pk_bf16_f32 v157, v158, v159
 v_cvt_pk_bf16_f32 v158, v172, v173
 v_cvt_pk_bf16_f32 v159, v174, v175
 s_add_u32 s59, s62, 12288
 buffer_store_dwordx4 v[156:159], v1, s[12:15], s59 offen offset:0 sc1
 v_accvgpr_write_b32 a48, v156
 buffer_load_dwordx4 v1, s[12:15], s52 offen offset:3072 sc1 lds
 v_accvgpr_write_b32 a49, v157
 v_accvgpr_write_b32 a50, v158
 v_accvgpr_write_b32 a51, v159
 v_pk_mul_f32 v[180:181], v[180:181], s[34:35]
 v_pk_mul_f32 v[182:183], v[182:183], s[34:35]
 v_pk_mul_f32 v[196:197], v[196:197], s[34:35]
 v_pk_mul_f32 v[198:199], v[198:199], s[34:35]
 v_cvt_pk_bf16_f32 v180, v180, v181
 v_cvt_pk_bf16_f32 v181, v182, v183
 v_cvt_pk_bf16_f32 v182, v196, v197
 v_cvt_pk_bf16_f32 v183, v198, v199
 s_add_u32 s59, s62, 4096
 buffer_store_dwordx4 v[180:183], v1, s[12:15], s59 offen offset:1024 sc1
 v_accvgpr_write_b32 a20, v180
 v_accvgpr_write_b32 a21, v181
 v_accvgpr_write_b32 a22, v182
 v_accvgpr_write_b32 a23, v183
 s_bitset1_b32 m0, 12
 s_nop 0
 buffer_load_dwordx4 v4, s[12:15], s52 offen offset:0 sc1 lds
 v_pk_mul_f32 v[188:189], v[188:189], s[34:35]
 v_pk_mul_f32 v[190:191], v[190:191], s[34:35]
 v_pk_mul_f32 v[204:205], v[204:205], s[34:35]
 v_pk_mul_f32 v[206:207], v[206:207], s[34:35]
 v_cvt_pk_bf16_f32 v188, v188, v189
 v_cvt_pk_bf16_f32 v189, v190, v191
 v_cvt_pk_bf16_f32 v190, v204, v205
 v_cvt_pk_bf16_f32 v191, v206, v207
 s_add_u32 s59, s62, 12288
 buffer_store_dwordx4 v[188:191], v1, s[12:15], s59 offen offset:1024 sc1
 v_accvgpr_write_b32 a52, v188
 v_accvgpr_write_b32 a53, v189
 v_accvgpr_write_b32 a54, v190
 v_accvgpr_write_b32 a55, v191
 v_pk_mul_f32 v[212:213], v[212:213], s[34:35]
 v_pk_mul_f32 v[214:215], v[214:215], s[34:35]
 v_pk_mul_f32 v[228:229], v[228:229], s[34:35]
 v_pk_mul_f32 v[230:231], v[230:231], s[34:35]
 buffer_load_dwordx4 v4, s[12:15], s52 offen offset:1024 sc1 lds
 v_cvt_pk_bf16_f32 v212, v212, v213
 v_cvt_pk_bf16_f32 v213, v214, v215
 v_cvt_pk_bf16_f32 v214, v228, v229
 v_cvt_pk_bf16_f32 v215, v230, v231
 s_add_u32 s59, s62, 4096
 buffer_store_dwordx4 v[212:215], v1, s[12:15], s59 offen offset:2048 sc1
 v_accvgpr_write_b32 a24, v212
 v_accvgpr_write_b32 a25, v213
 v_accvgpr_write_b32 a26, v214
 v_accvgpr_write_b32 a27, v215
 v_pk_mul_f32 v[220:221], v[220:221], s[34:35]
 v_pk_mul_f32 v[222:223], v[222:223], s[34:35]
 v_pk_mul_f32 v[236:237], v[236:237], s[34:35]
 v_pk_mul_f32 v[238:239], v[238:239], s[34:35]
 v_cvt_pk_bf16_f32 v220, v220, v221
 v_cvt_pk_bf16_f32 v221, v222, v223
 v_cvt_pk_bf16_f32 v222, v236, v237
 buffer_load_dwordx4 v4, s[12:15], s52 offen offset:2048 sc1 lds
 v_cvt_pk_bf16_f32 v223, v238, v239
 s_add_u32 s59, s62, 12288
 buffer_store_dwordx4 v[220:223], v1, s[12:15], s59 offen offset:2048 sc1
 v_accvgpr_write_b32 a56, v220
 v_accvgpr_write_b32 a57, v221
 v_accvgpr_write_b32 a58, v222
 v_accvgpr_write_b32 a59, v223
 v_pk_mul_f32 v[244:245], v[244:245], s[34:35]
 v_pk_mul_f32 v[246:247], v[246:247], s[34:35]
 v_pk_mul_f32 v[16:17], v[16:17], s[34:35]
 v_pk_mul_f32 v[18:19], v[18:19], s[34:35]
 v_cvt_pk_bf16_f32 v244, v244, v245
 v_cvt_pk_bf16_f32 v245, v246, v247
 v_cvt_pk_bf16_f32 v246, v16, v17
 v_cvt_pk_bf16_f32 v247, v18, v19
 s_add_u32 s59, s62, 4096
 buffer_store_dwordx4 v[244:247], v1, s[12:15], s59 offen offset:3072 sc1
 v_accvgpr_write_b32 a28, v244
 buffer_load_dwordx4 v4, s[12:15], s52 offen offset:3072 sc1 lds
 v_accvgpr_write_b32 a29, v245
 v_accvgpr_write_b32 a30, v246
 v_accvgpr_write_b32 a31, v247
 v_pk_mul_f32 v[252:253], v[252:253], s[34:35]
 v_pk_mul_f32 v[254:255], v[254:255], s[34:35]
 v_pk_mul_f32 v[24:25], v[24:25], s[34:35]
 v_pk_mul_f32 v[26:27], v[26:27], s[34:35]
 v_cvt_pk_bf16_f32 v252, v252, v253
 v_cvt_pk_bf16_f32 v253, v254, v255
 v_cvt_pk_bf16_f32 v254, v24, v25
 v_cvt_pk_bf16_f32 v255, v26, v27
 s_add_u32 s59, s62, 12288
 buffer_store_dwordx4 v[252:255], v1, s[12:15], s59 offen offset:3072 sc1
 v_accvgpr_write_b32 a60, v252
 v_accvgpr_write_b32 a61, v253
 v_accvgpr_write_b32 a62, v254
 v_accvgpr_write_b32 a63, v255
L_kvdone:
 s_load_dword s31, s[74:75], s30
 s_cmp_ge_u32 s28, 14
 s_cbranch_scc1 L_s1b
 s_mov_b32 s36, 0xffff0000
 s_and_b32 s33, s95, 31
 s_lshr_b32 s34, s95, 5
 v_lshlrev_b32 v128, 16, v32
 v_and_b32 v129, s36, v32
 v_lshlrev_b32 v130, 16, v40
 v_and_b32 v131, s36, v40
 v_lshlrev_b32 v132, 16, v48
 v_and_b32 v133, s36, v48
 v_lshlrev_b32 v134, 16, v56
 v_and_b32 v135, s36, v56
 v_lshlrev_b32 v136, 16, v64
 v_and_b32 v137, s36, v64
 v_lshlrev_b32 v138, 16, v72
 v_and_b32 v139, s36, v72
 v_lshlrev_b32 v140, 16, v80
 v_and_b32 v141, s36, v80
 v_lshlrev_b32 v142, 16, v88
 v_lshlrev_b32 v143, 16, v90
 v_and_b32 v144, s36, v88
 v_and_b32 v145, s36, v90
 v_lshlrev_b32 v146, 16, v89
 v_lshlrev_b32 v147, 16, v91
 v_and_b32 v148, s36, v89
 v_and_b32 v149, s36, v91
 v_pk_mul_f32 v[150:151], v[128:129], v[148:149]
 v_pk_fma_f32 v[150:151], v[130:131], v[146:147], v[150:151]
 v_pk_fma_f32 v[150:151], v[132:133], v[144:145], v[150:151]
 v_pk_fma_f32 v[150:151], v[134:135], v[142:143], v[150:151]
 v_pk_mul_f32 v[150:151], v[150:151], v[138:139]
 v_cvt_pk_bf16_f32 v16, v150, v151
 v_pk_mul_f32 v[152:153], v[130:131], v[148:149]
 v_pk_fma_f32 v[152:153], v[132:133], v[146:147], v[152:153]
 v_pk_fma_f32 v[152:153], v[134:135], v[144:145], v[152:153]
 v_pk_fma_f32 v[152:153], v[136:137], v[142:143], v[152:153]
 v_pk_mul_f32 v[152:153], v[152:153], v[140:141]
 v_cvt_pk_bf16_f32 v20, v152, v153
 v_lshlrev_b32 v128, 16, v33
 v_and_b32 v129, s36, v33
 v_lshlrev_b32 v130, 16, v41
 v_and_b32 v131, s36, v41
 v_lshlrev_b32 v132, 16, v49
 v_and_b32 v133, s36, v49
 v_lshlrev_b32 v134, 16, v57
 v_and_b32 v135, s36, v57
 v_lshlrev_b32 v136, 16, v65
 v_and_b32 v137, s36, v65
 v_lshlrev_b32 v138, 16, v73
 v_and_b32 v139, s36, v73
 v_lshlrev_b32 v140, 16, v81
 v_and_b32 v141, s36, v81
 v_lshlrev_b32 v142, 16, v96
 v_lshlrev_b32 v143, 16, v98
 v_and_b32 v144, s36, v96
 v_and_b32 v145, s36, v98
 v_lshlrev_b32 v146, 16, v97
 v_lshlrev_b32 v147, 16, v99
 v_and_b32 v148, s36, v97
 v_and_b32 v149, s36, v99
 v_pk_mul_f32 v[150:151], v[128:129], v[148:149]
 v_pk_fma_f32 v[150:151], v[130:131], v[146:147], v[150:151]
 v_pk_fma_f32 v[150:151], v[132:133], v[144:145], v[150:151]
 v_pk_fma_f32 v[150:151], v[134:135], v[142:143], v[150:151]
 v_pk_mul_f32 v[150:151], v[150:151], v[138:139]
 v_cvt_pk_bf16_f32 v17, v150, v151
 v_pk_mul_f32 v[152:153], v[130:131], v[148:149]
 v_pk_fma_f32 v[152:153], v[132:133], v[146:147], v[152:153]
 v_pk_fma_f32 v[152:153], v[134:135], v[144:145], v[152:153]
 v_pk_fma_f32 v[152:153], v[136:137], v[142:143], v[152:153]
 v_pk_mul_f32 v[152:153], v[152:153], v[140:141]
 v_cvt_pk_bf16_f32 v21, v152, v153
 v_lshlrev_b32 v128, 16, v34
 v_and_b32 v129, s36, v34
 v_lshlrev_b32 v130, 16, v42
 v_and_b32 v131, s36, v42
 v_lshlrev_b32 v132, 16, v50
 v_and_b32 v133, s36, v50
 v_lshlrev_b32 v134, 16, v58
 v_and_b32 v135, s36, v58
 v_lshlrev_b32 v136, 16, v66
 v_and_b32 v137, s36, v66
 v_lshlrev_b32 v138, 16, v74
 v_and_b32 v139, s36, v74
 v_lshlrev_b32 v140, 16, v82
 v_and_b32 v141, s36, v82
 v_lshlrev_b32 v142, 16, v104
 v_lshlrev_b32 v143, 16, v106
 v_and_b32 v144, s36, v104
 v_and_b32 v145, s36, v106
 v_lshlrev_b32 v146, 16, v105
 v_lshlrev_b32 v147, 16, v107
 v_and_b32 v148, s36, v105
 v_and_b32 v149, s36, v107
 v_pk_mul_f32 v[150:151], v[128:129], v[148:149]
 v_pk_fma_f32 v[150:151], v[130:131], v[146:147], v[150:151]
 v_pk_fma_f32 v[150:151], v[132:133], v[144:145], v[150:151]
 v_pk_fma_f32 v[150:151], v[134:135], v[142:143], v[150:151]
 v_pk_mul_f32 v[150:151], v[150:151], v[138:139]
 v_cvt_pk_bf16_f32 v18, v150, v151
 v_pk_mul_f32 v[152:153], v[130:131], v[148:149]
 v_pk_fma_f32 v[152:153], v[132:133], v[146:147], v[152:153]
 v_pk_fma_f32 v[152:153], v[134:135], v[144:145], v[152:153]
 v_pk_fma_f32 v[152:153], v[136:137], v[142:143], v[152:153]
 v_pk_mul_f32 v[152:153], v[152:153], v[140:141]
 v_cvt_pk_bf16_f32 v22, v152, v153
 v_lshlrev_b32 v128, 16, v35
 v_and_b32 v129, s36, v35
 v_lshlrev_b32 v130, 16, v43
 v_and_b32 v131, s36, v43
 v_lshlrev_b32 v132, 16, v51
 v_and_b32 v133, s36, v51
 v_lshlrev_b32 v134, 16, v59
 v_and_b32 v135, s36, v59
 v_lshlrev_b32 v136, 16, v67
 v_and_b32 v137, s36, v67
 v_lshlrev_b32 v138, 16, v75
 v_and_b32 v139, s36, v75
 v_lshlrev_b32 v140, 16, v83
 v_and_b32 v141, s36, v83
 v_lshlrev_b32 v142, 16, v112
 v_lshlrev_b32 v143, 16, v114
 v_and_b32 v144, s36, v112
 v_and_b32 v145, s36, v114
 v_lshlrev_b32 v146, 16, v113
 v_lshlrev_b32 v147, 16, v115
 v_and_b32 v148, s36, v113
 v_and_b32 v149, s36, v115
 v_pk_mul_f32 v[150:151], v[128:129], v[148:149]
 v_pk_fma_f32 v[150:151], v[130:131], v[146:147], v[150:151]
 v_pk_fma_f32 v[150:151], v[132:133], v[144:145], v[150:151]
 v_pk_fma_f32 v[150:151], v[134:135], v[142:143], v[150:151]
 v_pk_mul_f32 v[150:151], v[150:151], v[138:139]
 v_cvt_pk_bf16_f32 v19, v150, v151
 v_pk_mul_f32 v[152:153], v[130:131], v[148:149]
 v_pk_fma_f32 v[152:153], v[132:133], v[146:147], v[152:153]
 v_pk_fma_f32 v[152:153], v[134:135], v[144:145], v[152:153]
 v_pk_fma_f32 v[152:153], v[136:137], v[142:143], v[152:153]
 v_pk_mul_f32 v[152:153], v[152:153], v[140:141]
 v_cvt_pk_bf16_f32 v23, v152, v153
 v_lshrrev_b32 v26, 3, v0
 v_lshlrev_b32 v26, 8, v26
 v_and_b32 v25, 7, v0
 v_lshl_add_u32 v26, v25, 4, v26
 s_lshl_b32 s35, s3, 11
 s_add_u32 s35, s35, 0x20000
 v_add_u32 v26, s35, v26
 ds_write_b128 v26, v[16:19] offset:0
 ds_write_b128 v26, v[20:23] offset:128
 v_bfe_u32 v24, v0, 2, 2
 v_bfe_u32 v28, v0, 4, 1
 v_lshl_add_u32 v24, v28, 3, v24
 v_lshlrev_b32 v24, 2, v24
 v_lshrrev_b32 v28, 5, v0
 v_add_u32 v24, v24, v28
 v_lshlrev_b32 v24, 7, v24
 v_and_b32 v28, 3, v0
 v_lshl_add_u32 v24, v28, 3, v24
 s_lshl_b32 s35, s3, 5
 s_add_u32 s35, s35, 0x20000
 v_add_u32 v24, s35, v24
 v_and_b32 v25, 15, v0
 v_mul_u32_u24 v25, 4096, v25
 v_lshrrev_b32 v28, 4, v0
 v_lshl_add_u32 v25, v28, 4, v25
 s_lshl_b32 s35, s34, 2
 s_add_u32 s35, s35, s3
 s_mul_i32 s35, s35, 65536
 s_lshl_b32 s36, s33, 7
 s_add_u32 s35, s35, s36
 s_add_u32 s35, s35, 85983232
L_s1b:
 s_add_u32 s52, s52, s70
 s_or_b32 m0, s40, 0x8000
 s_nop 0
 buffer_load_dwordx4 v1, s[12:15], s52 offen offset:0 sc1 lds
 v_mov_b32 v2, v1
 v_add_u32 v3, 0x10000, v1
 v_mov_b64 v[96:97], 0
 v_mov_b64 v[98:99], 0
 v_mov_b64 v[100:101], 0
 v_mov_b64 v[102:103], 0
 v_mov_b64 v[104:105], 0
 v_mov_b64 v[106:107], 0
 v_mov_b64 v[108:109], 0
 v_mov_b64 v[110:111], 0
 v_mov_b64 v[112:113], 0
 v_mov_b64 v[114:115], 0
 buffer_load_dwordx4 v1, s[12:15], s52 offen offset:1024 sc1 lds
 v_mov_b64 v[116:117], 0
 v_mov_b64 v[118:119], 0
 v_mov_b64 v[120:121], 0
 v_mov_b64 v[122:123], 0
 v_mov_b64 v[124:125], 0
 v_mov_b64 v[126:127], 0
 v_mov_b64 v[128:129], 0
 v_mov_b64 v[130:131], 0
 v_mov_b64 v[132:133], 0
 v_mov_b64 v[134:135], 0
 v_mov_b64 v[136:137], 0
 v_mov_b64 v[138:139], 0
 buffer_load_dwordx4 v1, s[12:15], s52 offen offset:2048 sc1 lds
 v_mov_b64 v[140:141], 0
 v_mov_b64 v[142:143], 0
 v_mov_b64 v[144:145], 0
 v_mov_b64 v[146:147], 0
 v_mov_b64 v[148:149], 0
 v_mov_b64 v[150:151], 0
 v_mov_b64 v[152:153], 0
 v_mov_b64 v[154:155], 0
 v_mov_b64 v[156:157], 0
 v_mov_b64 v[158:159], 0
 v_mov_b64 v[160:161], 0
 buffer_load_dwordx4 v1, s[12:15], s52 offen offset:3072 sc1 lds
 v_mov_b64 v[162:163], 0
 v_mov_b64 v[164:165], 0
 v_mov_b64 v[166:167], 0
 v_mov_b64 v[168:169], 0
 v_mov_b64 v[170:171], 0
 v_mov_b64 v[172:173], 0
 v_mov_b64 v[174:175], 0
 v_mov_b64 v[176:177], 0
 v_mov_b64 v[178:179], 0
 v_mov_b64 v[180:181], 0
 v_mov_b64 v[182:183], 0
 v_mov_b64 v[184:185], 0
 s_bitset1_b32 m0, 12
 s_nop 0
 buffer_load_dwordx4 v4, s[12:15], s52 offen offset:0 sc1 lds
 v_mov_b64 v[186:187], 0
 v_mov_b64 v[188:189], 0
 v_mov_b64 v[190:191], 0
 v_mov_b64 v[192:193], 0
 v_mov_b64 v[194:195], 0
 v_mov_b64 v[196:197], 0
 v_mov_b64 v[198:199], 0
 v_mov_b64 v[200:201], 0
 v_mov_b64 v[202:203], 0
 v_mov_b64 v[204:205], 0
 v_mov_b64 v[206:207], 0
 v_mov_b64 v[208:209], 0
 buffer_load_dwordx4 v4, s[12:15], s52 offen offset:1024 sc1 lds
 v_mov_b64 v[210:211], 0
 v_mov_b64 v[212:213], 0
 v_mov_b64 v[214:215], 0
 v_mov_b64 v[216:217], 0
 v_mov_b64 v[218:219], 0
 v_mov_b64 v[220:221], 0
 v_mov_b64 v[222:223], 0
 v_mov_b64 v[224:225], 0
 v_mov_b64 v[226:227], 0
 v_mov_b64 v[228:229], 0
 v_mov_b64 v[230:231], 0
 buffer_load_dwordx4 v4, s[12:15], s52 offen offset:2048 sc1 lds
 v_mov_b64 v[232:233], 0
 v_mov_b64 v[234:235], 0
 v_mov_b64 v[236:237], 0
 v_mov_b64 v[238:239], 0
 v_mov_b64 v[240:241], 0
 v_mov_b64 v[242:243], 0
 v_mov_b64 v[244:245], 0
 v_mov_b64 v[246:247], 0
 v_mov_b64 v[248:249], 0
 v_mov_b64 v[250:251], 0
 v_mov_b64 v[252:253], 0
 v_mov_b64 v[254:255], 0
 buffer_load_dwordx4 v4, s[12:15], s52 offen offset:3072 sc1 lds
 v_mov_b32 v7, 0
 v_mov_b32 v8, 0
 v_mov_b32 v9, 0
 v_mov_b32 v10, 0
 v_mov_b32 v13, v1
 v_mul_u32_u24 v15, s27, v12
 v_accvgpr_write_b32 a246, 1
 v_accvgpr_write_b32 a247, 1
 s_cmp_lt_u32 s28, 14
 s_cselect_b32 s62, 1, 0
 s_andn2_b32 s62, s62, s27
 s_cmp_ge_u32 s44, 2
 s_cbranch_scc1 L_nomask0
 v_accvgpr_read_b32 v96, a224
 v_accvgpr_read_b32 v97, a225
 v_accvgpr_read_b32 v98, a226
 v_accvgpr_read_b32 v99, a227
 v_accvgpr_read_b32 v104, a228
 v_accvgpr_read_b32 v105, a229
 v_accvgpr_read_b32 v106, a230
 v_accvgpr_read_b32 v107, a231
 v_accvgpr_read_b32 v112, a232
 v_accvgpr_read_b32 v113, a233
 v_accvgpr_read_b32 v114, a234
 v_accvgpr_read_b32 v115, a235
 v_accvgpr_read_b32 v120, a236
 v_accvgpr_read_b32 v121, a237
 v_accvgpr_read_b32 v122, a238
 v_accvgpr_read_b32 v123, a239
L_nomask0:
 v_accvgpr_read_b32 v27, a245
 s_lshl_b32 s36, s95, 2
 s_add_u32 s36, s36, 84959232
 s_cmp_lt_u32 s28, 14
 s_cselect_b32 s36, s36, 2.0
 s_add_u32 s33, s94, 4
 s_cmp_eq_u32 s27, 1
 s_cselect_b32 s33, s33, 2.0
 s_cmp_eq_u32 s48, 0
 s_cbranch_scc1 L_kvlate
 s_add_u32 s42, s52, s70
L_kvok:
 s_waitcnt vmcnt(8) lgkmcnt(0)
 s_barrier
 ds_read_b128 a[64:67], v2 offset:0
 ds_read_b128 a[68:71], v2 offset:1024
 ds_read_b128 a[72:75], v2 offset:2048
 ds_read_b128 a[76:79], v2 offset:3072
 ds_read_b128 a[80:83], v2 offset:4096
 ds_read_b128 a[84:87], v2 offset:5120
 ds_read_b128 a[88:91], v2 offset:6144
 ds_read_b128 a[92:95], v2 offset:7168
 buffer_store_dword v27, v27, s[12:15], s1 offen sc1
 buffer_store_dword v27, v27, s[12:15], s33 offen sc1
 s_cmp_ge_u32 s28, 14
 s_cbranch_scc1 L_s1c
 ds_read_b64_tr_b16 v[16:17], v24 offset:0
 ds_read_b64_tr_b16 v[18:19], v24 offset:2048
 ds_read_b64_tr_b16 v[20:21], v24 offset:256
 ds_read_b64_tr_b16 v[22:23], v24 offset:2304
 s_waitcnt lgkmcnt(0)
 buffer_store_dwordx4 v[16:19], v25, s[12:15], s35 offen offset:0 sc1
 buffer_store_dwordx4 v[20:23], v25, s[12:15], s35 offen offset:64 sc1
L_s1c:
 s_mov_b32 m0, s41
 s_waitcnt lgkmcnt(0)
 v_mfma_f32_16x16x32_bf16 v[32:35], a[64:67], a[0:3], v[96:99]
 ds_read_b128 a[96:99], v2 offset:8192
 v_mfma_f32_16x16x32_bf16 v[32:35], a[68:71], a[4:7], v[32:35]
 buffer_load_dwordx4 v1, s[12:15], s43 offen offset:0 sc1 lds
 v_mfma_f32_16x16x32_bf16 v[32:35], a[72:75], a[8:11], v[32:35]
 ds_read_b128 a[100:103], v2 offset:9216
 v_mfma_f32_16x16x32_bf16 v[32:35], a[76:79], a[12:15], v[32:35]
 v_mfma_f32_16x16x32_bf16 v[32:35], a[80:83], a[16:19], v[32:35]
 ds_read_b128 a[104:107], v2 offset:10240
 v_mfma_f32_16x16x32_bf16 v[32:35], a[84:87], a[20:23], v[32:35]
 buffer_load_dwordx4 v1, s[12:15], s43 offen offset:1024 sc1 lds
 v_mfma_f32_16x16x32_bf16 v[32:35], a[88:91], a[24:27], v[32:35]
 ds_read_b128 a[108:111], v2 offset:11264
 v_mfma_f32_16x16x32_bf16 v[32:35], a[92:95], a[28:31], v[32:35]
 v_mfma_f32_16x16x32_bf16 v[36:39], a[64:67], a[32:35], v[100:103]
 ds_read_b128 a[112:115], v2 offset:12288
 v_mfma_f32_16x16x32_bf16 v[36:39], a[68:71], a[36:39], v[36:39]
 buffer_load_dwordx4 v1, s[12:15], s43 offen offset:2048 sc1 lds
 v_mfma_f32_16x16x32_bf16 v[36:39], a[72:75], a[40:43], v[36:39]
 ds_read_b128 a[116:119], v2 offset:13312
 v_mfma_f32_16x16x32_bf16 v[36:39], a[76:79], a[44:47], v[36:39]
 v_mfma_f32_16x16x32_bf16 v[36:39], a[80:83], a[48:51], v[36:39]
 ds_read_b128 a[120:123], v2 offset:14336
 v_mfma_f32_16x16x32_bf16 v[36:39], a[84:87], a[52:55], v[36:39]
 buffer_load_dwordx4 v1, s[12:15], s43 offen offset:3072 sc1 lds
 v_mfma_f32_16x16x32_bf16 v[36:39], a[88:91], a[56:59], v[36:39]
 ds_read_b128 a[124:127], v2 offset:15360
 v_mfma_f32_16x16x32_bf16 v[36:39], a[92:95], a[60:63], v[36:39]
 s_waitcnt lgkmcnt(6)
 v_exp_f32 v64, v32
 v_mfma_f32_16x16x32_bf16 v[40:43], a[96:99], a[0:3], v[104:107]
 s_bitset1_b32 m0, 12
 ds_read_b128 a[64:67], v2 offset:16384
 v_mfma_f32_16x16x32_bf16 v[40:43], a[100:103], a[4:7], v[40:43]
 s_waitcnt lgkmcnt(5)
 buffer_load_dwordx4 v4, s[12:15], s43 offen offset:0 sc1 lds
 v_mfma_f32_16x16x32_bf16 v[40:43], a[104:107], a[8:11], v[40:43]
 ds_read_b128 a[68:71], v2 offset:17408
 v_mfma_f32_16x16x32_bf16 v[40:43], a[108:111], a[12:15], v[40:43]
 s_waitcnt lgkmcnt(4)
 v_exp_f32 v65, v33
 v_mfma_f32_16x16x32_bf16 v[40:43], a[112:115], a[16:19], v[40:43]
 ds_read_b128 a[72:75], v2 offset:18432
 v_add_f32 v5, v64, v65
 v_mfma_f32_16x16x32_bf16 v[40:43], a[116:119], a[20:23], v[40:43]
 s_waitcnt lgkmcnt(3)
 buffer_load_dwordx4 v4, s[12:15], s43 offen offset:1024 sc1 lds
 v_mfma_f32_16x16x32_bf16 v[40:43], a[120:123], a[24:27], v[40:43]
 ds_read_b128 a[76:79], v2 offset:19456
 v_mfma_f32_16x16x32_bf16 v[40:43], a[124:127], a[28:31], v[40:43]
 v_exp_f32 v66, v34
 v_mfma_f32_16x16x32_bf16 v[44:47], a[96:99], a[32:35], v[108:111]
 ds_read_b128 a[80:83], v2 offset:20480
 v_add_f32 v5, v5, v66
 v_mfma_f32_16x16x32_bf16 v[44:47], a[100:103], a[36:39], v[44:47]
 buffer_load_dwordx4 v4, s[12:15], s43 offen offset:2048 sc1 lds
 v_mfma_f32_16x16x32_bf16 v[44:47], a[104:107], a[40:43], v[44:47]
 ds_read_b128 a[84:87], v2 offset:21504
 v_mfma_f32_16x16x32_bf16 v[44:47], a[108:111], a[44:47], v[44:47]
 v_exp_f32 v67, v35
 v_mfma_f32_16x16x32_bf16 v[44:47], a[112:115], a[48:51], v[44:47]
 ds_read_b128 a[88:91], v2 offset:22528
 v_add_f32 v5, v5, v67
 v_mfma_f32_16x16x32_bf16 v[44:47], a[116:119], a[52:55], v[44:47]
 buffer_load_dwordx4 v4, s[12:15], s43 offen offset:3072 sc1 lds
 v_mfma_f32_16x16x32_bf16 v[44:47], a[120:123], a[56:59], v[44:47]
 ds_read_b128 a[92:95], v2 offset:23552
 v_mfma_f32_16x16x32_bf16 v[44:47], a[124:127], a[60:63], v[44:47]
 s_waitcnt lgkmcnt(6)
 v_exp_f32 v68, v36
 v_mfma_f32_16x16x32_bf16 v[48:51], a[64:67], a[0:3], v[112:115]
 s_add_u32 s43, s43, s71
 ds_read_b128 a[96:99], v2 offset:24576
 v_mfma_f32_16x16x32_bf16 v[48:51], a[68:71], a[4:7], v[48:51]
 s_waitcnt lgkmcnt(5)
 v_exp_f32 v69, v37
 v_mfma_f32_16x16x32_bf16 v[48:51], a[72:75], a[8:11], v[48:51]
 s_xor_b32 s41, s41, 0x8000
 ds_read_b128 a[100:103], v2 offset:25600
 v_add_f32 v6, v68, v69
 v_mfma_f32_16x16x32_bf16 v[48:51], a[76:79], a[12:15], v[48:51]
 s_waitcnt lgkmcnt(4)
 v_exp_f32 v70, v38
 v_mfma_f32_16x16x32_bf16 v[48:51], a[80:83], a[16:19], v[48:51]
 ds_read_b128 a[104:107], v2 offset:26624
 v_add_f32 v6, v6, v70
 v_mfma_f32_16x16x32_bf16 v[48:51], a[84:87], a[20:23], v[48:51]
 s_waitcnt lgkmcnt(3)
 v_exp_f32 v71, v39
 v_mfma_f32_16x16x32_bf16 v[48:51], a[88:91], a[24:27], v[48:51]
 ds_read_b128 a[108:111], v2 offset:27648
 v_add_f32 v6, v6, v71
 v_mfma_f32_16x16x32_bf16 v[48:51], a[92:95], a[28:31], v[48:51]
 v_exp_f32 v72, v40
 v_mfma_f32_16x16x32_bf16 v[52:55], a[64:67], a[32:35], v[116:119]
 ds_read_b128 a[112:115], v2 offset:28672
 v_add_f32 v5, v5, v72
 v_mfma_f32_16x16x32_bf16 v[52:55], a[68:71], a[36:39], v[52:55]
 v_exp_f32 v73, v41
 v_mfma_f32_16x16x32_bf16 v[52:55], a[72:75], a[40:43], v[52:55]
 ds_read_b128 a[116:119], v2 offset:29696
 v_add_f32 v5, v5, v73
 v_mfma_f32_16x16x32_bf16 v[52:55], a[76:79], a[44:47], v[52:55]
 v_exp_f32 v74, v42
 v_mfma_f32_16x16x32_bf16 v[52:55], a[80:83], a[48:51], v[52:55]
 ds_read_b128 a[120:123], v2 offset:30720
 v_add_f32 v5, v5, v74
 v_mfma_f32_16x16x32_bf16 v[52:55], a[84:87], a[52:55], v[52:55]
 v_exp_f32 v75, v43
 v_mfma_f32_16x16x32_bf16 v[52:55], a[88:91], a[56:59], v[52:55]
 ds_read_b128 a[124:127], v2 offset:31744
 v_add_f32 v5, v5, v75
 v_mfma_f32_16x16x32_bf16 v[52:55], a[92:95], a[60:63], v[52:55]
 s_waitcnt lgkmcnt(6)
 v_exp_f32 v76, v44
 v_mfma_f32_16x16x32_bf16 v[56:59], a[96:99], a[0:3], v[120:123]
 v_exp_f32 v77, v45
 v_mfma_f32_16x16x32_bf16 v[56:59], a[100:103], a[4:7], v[56:59]
 s_waitcnt lgkmcnt(4)
 v_exp_f32 v78, v46
 v_mfma_f32_16x16x32_bf16 v[56:59], a[104:107], a[8:11], v[56:59]
 v_exp_f32 v79, v47
 v_mfma_f32_16x16x32_bf16 v[56:59], a[108:111], a[12:15], v[56:59]
 s_waitcnt lgkmcnt(2)
 v_exp_f32 v80, v48
 v_mfma_f32_16x16x32_bf16 v[56:59], a[112:115], a[16:19], v[56:59]
 v_exp_f32 v81, v49
 v_mfma_f32_16x16x32_bf16 v[56:59], a[116:119], a[20:23], v[56:59]
 s_waitcnt lgkmcnt(0)
 v_exp_f32 v82, v50
 v_mfma_f32_16x16x32_bf16 v[56:59], a[120:123], a[24:27], v[56:59]
 v_exp_f32 v83, v51
 v_mfma_f32_16x16x32_bf16 v[56:59], a[124:127], a[28:31], v[56:59]
 v_exp_f32 v84, v52
 v_mfma_f32_16x16x32_bf16 v[60:63], a[96:99], a[32:35], v[124:127]
 v_exp_f32 v85, v53
 v_mfma_f32_16x16x32_bf16 v[60:63], a[100:103], a[36:39], v[60:63]
 v_exp_f32 v86, v54
 v_mfma_f32_16x16x32_bf16 v[60:63], a[104:107], a[40:43], v[60:63]
 v_exp_f32 v87, v55
 v_mfma_f32_16x16x32_bf16 v[60:63], a[108:111], a[44:47], v[60:63]
 v_add_f32 v6, v6, v76
 v_mfma_f32_16x16x32_bf16 v[60:63], a[112:115], a[48:51], v[60:63]
 v_add_f32 v6, v6, v77
 v_mfma_f32_16x16x32_bf16 v[60:63], a[116:119], a[52:55], v[60:63]
 v_exp_f32 v88, v56
 v_mfma_f32_16x16x32_bf16 v[60:63], a[120:123], a[56:59], v[60:63]
 v_exp_f32 v89, v57
 v_mfma_f32_16x16x32_bf16 v[60:63], a[124:127], a[60:63], v[60:63]
 v_exp_f32 v90, v58
 v_xor_b32 v2, 0x8000, v2
 s_waitcnt vmcnt(8)
 s_barrier
 ds_read_b128 a[64:67], v2 offset:0
 ds_read_b128 a[68:71], v2 offset:1024
 ds_read_b128 a[72:75], v2 offset:2048
 ds_read_b128 a[76:79], v2 offset:3072
 ds_read_b128 a[80:83], v2 offset:4096
 ds_read_b128 a[84:87], v2 offset:5120
 ds_read_b128 a[88:91], v2 offset:6144
 ds_read_b128 a[92:95], v2 offset:7168
 buffer_store_dword v27, v27, s[12:15], s36 offen sc1
 v_exp_f32 v91, v59
 v_exp_f32 v92, v60
 v_exp_f32 v93, v61
 v_exp_f32 v94, v62
 v_exp_f32 v95, v63
 v_add_f32 v6, v6, v78
 v_add_f32 v6, v6, v79
 v_add_f32 v5, v5, v80
 v_add_f32 v5, v5, v81
 v_add_f32 v5, v5, v82
 v_add_f32 v5, v5, v83
 v_add_f32 v6, v6, v84
 v_add_f32 v6, v6, v85
 v_add_f32 v6, v6, v86
 v_add_f32 v6, v6, v87
 v_add_f32 v5, v5, v88
 v_add_f32 v5, v5, v89
 v_add_f32 v5, v5, v90
 v_add_f32 v5, v5, v91
 v_add_f32 v6, v6, v92
 v_add_f32 v6, v6, v93
 v_add_f32 v6, v6, v94
 v_add_f32 v6, v6, v95
L_first:
 v_add_f32 v11, v5, v6
 v_min_f32 v12, v5, v6
 v_cmp_nge_f32 vcc, s47, v11
 s_mov_b32 s46, 0xff800000
 s_cbranch_vccnz L_slow2
 v_cmp_gt_f32 vcc, 0x33800000, v12
 s_cbranch_vccnz L_rowchk
L_firstok:
 s_mov_b32 s46, 0
 s_waitcnt lgkmcnt(0)
 s_cmp_gt_u32 s44, s45
 s_cbranch_scc0 L_ret2
.p2align 6
L_loop:
 v_mfma_f32_16x16x32_bf16 v[32:35], a[64:67], a[0:3], v[96:99]
 s_mov_b32 m0, s40
 ds_read_b128 a[96:99], v2 offset:8192
 v_cvt_pk_bf16_f32 v16, v64, v65
 v_mfma_f32_16x16x32_bf16 v[32:35], a[68:71], a[4:7], v[32:35]
 s_waitcnt lgkmcnt(5)
 buffer_load_dwordx4 v13, s[8:11], s42 offen offset:0 sc1 lds
 v_mfma_f32_16x16x32_bf16 v[32:35], a[72:75], a[8:11], v[32:35]
 ds_read_b128 a[100:103], v2 offset:9216
 v_cvt_pk_bf16_f32 v17, v66, v67
 v_mfma_f32_16x16x32_bf16 v[32:35], a[76:79], a[12:15], v[32:35]
 s_waitcnt lgkmcnt(4)
 v_cvt_pk_bf16_f32 v20, v68, v69
 v_cvt_pk_bf16_f32 v21, v70, v71
 v_mfma_f32_16x16x32_bf16 v[32:35], a[80:83], a[16:19], v[32:35]
 s_add_u32 s39, s42, s76
 ds_read_b128 a[104:107], v2 offset:10240
 v_add_f32 v7, v7, v5
 v_mfma_f32_16x16x32_bf16 v[32:35], a[84:87], a[20:23], v[32:35]
 s_waitcnt lgkmcnt(3)
 v_add_f32 v8, v8, v6
 v_cvt_pk_bf16_f32 v18, v72, v73
 v_mfma_f32_16x16x32_bf16 v[32:35], a[88:91], a[24:27], v[32:35]
 ds_read_b128 a[108:111], v2 offset:11264
 v_cvt_pk_bf16_f32 v19, v74, v75
 v_mfma_f32_16x16x32_bf16 v[32:35], a[92:95], a[28:31], v[32:35]
 buffer_load_dwordx4 v13, s[8:11], s39 offen offset:1024 sc1 lds
 v_mfma_f32_16x16x32_bf16 v[36:39], a[64:67], a[32:35], v[100:103]
 ds_read_b128 a[112:115], v2 offset:12288
 v_cvt_pk_bf16_f32 v22, v76, v77
 v_mfma_f32_16x16x32_bf16 v[36:39], a[68:71], a[36:39], v[36:39]
 v_cvt_pk_bf16_f32 v23, v78, v79
 v_cvt_pk_bf16_f32 v24, v80, v81
 v_mfma_f32_16x16x32_bf16 v[36:39], a[72:75], a[40:43], v[36:39]
 s_add_u32 s39, s39, s76
 ds_read_b128 a[116:119], v2 offset:13312
 v_cvt_pk_bf16_f32 v25, v82, v83
 v_mfma_f32_16x16x32_bf16 v[36:39], a[76:79], a[44:47], v[36:39]
 v_cvt_pk_bf16_f32 v28, v84, v85
 v_cvt_pk_bf16_f32 v29, v86, v87
 v_mfma_f32_16x16x32_bf16 v[36:39], a[80:83], a[48:51], v[36:39]
 ds_read_b128 a[120:123], v2 offset:14336
 v_cvt_pk_bf16_f32 v26, v88, v89
 v_mfma_f32_16x16x32_bf16 v[36:39], a[84:87], a[52:55], v[36:39]
 buffer_load_dwordx4 v13, s[8:11], s39 offen offset:2048 sc1 lds
 v_mfma_f32_16x16x32_bf16 v[36:39], a[88:91], a[56:59], v[36:39]
 ds_read_b128 a[124:127], v2 offset:15360
 v_cvt_pk_bf16_f32 v27, v90, v91
 v_mfma_f32_16x16x32_bf16 v[36:39], a[92:95], a[60:63], v[36:39]
 s_waitcnt lgkmcnt(6)
 v_exp_f32 v64, v32
 v_mfma_f32_16x16x32_bf16 v[40:43], a[96:99], a[0:3], v[104:107]
 s_add_u32 s39, s39, s76
 ds_read_b128 a[64:67], v2 offset:16384
 v_cvt_pk_bf16_f32 v30, v92, v93
 v_mfma_f32_16x16x32_bf16 v[40:43], a[100:103], a[4:7], v[40:43]
 s_waitcnt lgkmcnt(5)
 v_exp_f32 v65, v33
 v_mfma_f32_16x16x32_bf16 v[40:43], a[104:107], a[8:11], v[40:43]
 ds_read_b128 a[68:71], v2 offset:17408
 v_cvt_pk_bf16_f32 v31, v94, v95
 v_mfma_f32_16x16x32_bf16 v[40:43], a[108:111], a[12:15], v[40:43]
 s_waitcnt lgkmcnt(4)
 buffer_load_dwordx4 v13, s[8:11], s39 offen offset:3072 sc1 lds
 v_mfma_f32_16x16x32_bf16 v[40:43], a[112:115], a[16:19], v[40:43]
 ds_read_b128 a[72:75], v2 offset:18432
 v_add_f32 v5, v64, v65
 v_mfma_f32_16x16x32_bf16 v[40:43], a[116:119], a[20:23], v[40:43]
 s_waitcnt lgkmcnt(3)
 v_exp_f32 v66, v34
 v_mfma_f32_16x16x32_bf16 v[40:43], a[120:123], a[24:27], v[40:43]
 s_add_u32 s39, s39, s77
 ds_read_b128 a[76:79], v2 offset:19456
 v_add_f32 v5, v5, v66
 v_mfma_f32_16x16x32_bf16 v[40:43], a[124:127], a[28:31], v[40:43]
 v_exp_f32 v67, v35
 v_mfma_f32_16x16x32_bf16 v[44:47], a[96:99], a[32:35], v[108:111]
 s_bitset1_b32 m0, 12
 ds_read_b128 a[80:83], v2 offset:20480
 v_add_f32 v5, v5, v67
 v_mfma_f32_16x16x32_bf16 v[44:47], a[100:103], a[36:39], v[44:47]
 buffer_load_dwordx4 v13, s[8:11], s39 offen offset:0 sc1 lds
 v_mfma_f32_16x16x32_bf16 v[44:47], a[104:107], a[40:43], v[44:47]
 ds_read_b128 a[84:87], v2 offset:21504
 v_mfma_f32_16x16x32_bf16 v[44:47], a[108:111], a[44:47], v[44:47]
 v_exp_f32 v68, v36
 v_mfma_f32_16x16x32_bf16 v[44:47], a[112:115], a[48:51], v[44:47]
 s_add_u32 s39, s39, s76
 ds_read_b128 a[88:91], v2 offset:22528
 v_mfma_f32_16x16x32_bf16 v[44:47], a[116:119], a[52:55], v[44:47]
 v_exp_f32 v69, v37
 v_mfma_f32_16x16x32_bf16 v[44:47], a[120:123], a[56:59], v[44:47]
 ds_read_b128 a[92:95], v2 offset:23552
 v_add_f32 v6, v68, v69
 v_mfma_f32_16x16x32_bf16 v[44:47], a[124:127], a[60:63], v[44:47]
 s_waitcnt lgkmcnt(6)
 buffer_load_dwordx4 v13, s[8:11], s39 offen offset:1024 sc1 lds
 v_mfma_f32_16x16x32_bf16 v[48:51], a[64:67], a[0:3], v[112:115]
 ds_read_b128 a[96:99], v2 offset:24576
 v_mfma_f32_16x16x32_bf16 v[48:51], a[68:71], a[4:7], v[48:51]
 s_waitcnt lgkmcnt(5)
 v_exp_f32 v70, v38
 v_mfma_f32_16x16x32_bf16 v[48:51], a[72:75], a[8:11], v[48:51]
 s_add_u32 s39, s39, s76
 ds_read_b128 a[100:103], v2 offset:25600
 v_add_f32 v6, v6, v70
 v_mfma_f32_16x16x32_bf16 v[48:51], a[76:79], a[12:15], v[48:51]
 s_waitcnt lgkmcnt(4)
 v_exp_f32 v71, v39
 v_mfma_f32_16x16x32_bf16 v[48:51], a[80:83], a[16:19], v[48:51]
 ds_read_b128 a[104:107], v2 offset:26624
 v_add_f32 v6, v6, v71
 v_mfma_f32_16x16x32_bf16 v[48:51], a[84:87], a[20:23], v[48:51]
 s_waitcnt lgkmcnt(3)
 buffer_load_dwordx4 v13, s[8:11], s39 offen offset:2048 sc1 lds
 v_mfma_f32_16x16x32_bf16 v[48:51], a[88:91], a[24:27], v[48:51]
 ds_read_b128 a[108:111], v2 offset:27648
 v_mfma_f32_16x16x32_bf16 v[48:51], a[92:95], a[28:31], v[48:51]
 v_exp_f32 v72, v40
 v_mfma_f32_16x16x32_bf16 v[52:55], a[64:67], a[32:35], v[116:119]
 s_add_u32 s39, s39, s76
 ds_read_b128 a[112:115], v2 offset:28672
 v_add_f32 v5, v5, v72
 v_mfma_f32_16x16x32_bf16 v[52:55], a[68:71], a[36:39], v[52:55]
 v_exp_f32 v73, v41
 v_mfma_f32_16x16x32_bf16 v[52:55], a[72:75], a[40:43], v[52:55]
 s_xor_b32 s40, s40, 0x8000
 ds_read_b128 a[116:119], v2 offset:29696
 v_add_f32 v5, v5, v73
 v_mfma_f32_16x16x32_bf16 v[52:55], a[76:79], a[44:47], v[52:55]
 buffer_load_dwordx4 v13, s[8:11], s39 offen offset:3072 sc1 lds
 v_mfma_f32_16x16x32_bf16 v[52:55], a[80:83], a[48:51], v[52:55]
 s_add_u32 s42, s42, s70
 ds_read_b128 a[120:123], v2 offset:30720
 v_mfma_f32_16x16x32_bf16 v[52:55], a[84:87], a[52:55], v[52:55]
 v_exp_f32 v74, v42
 v_mfma_f32_16x16x32_bf16 v[52:55], a[88:91], a[56:59], v[52:55]
 s_waitcnt vmcnt(8) lgkmcnt(5)
 ds_read_b128 a[124:127], v2 offset:31744
 v_add_f32 v5, v5, v74
 v_mfma_f32_16x16x32_bf16 v[52:55], a[92:95], a[60:63], v[52:55]
 s_barrier
 v_mfma_f32_16x16x32_bf16 v[56:59], a[96:99], a[0:3], v[120:123]
 s_mov_b32 m0, s41
 ds_read_b128 a[64:67], v3 offset:0
 v_xor_b32 v2, 0x8000, v2
 v_mfma_f32_16x16x32_bf16 v[56:59], a[100:103], a[4:7], v[56:59]
 s_waitcnt lgkmcnt(5)
 buffer_load_dwordx4 v1, s[12:15], s43 offen offset:0 sc1 lds
 v_mfma_f32_16x16x32_bf16 v[56:59], a[104:107], a[8:11], v[56:59]
 s_cmp_eq_u32 s42, s66
 ds_read_b128 a[68:71], v3 offset:16384
 v_mfma_f32_16x16x32_bf16 v[56:59], a[108:111], a[12:15], v[56:59]
 s_waitcnt lgkmcnt(4)
 v_exp_f32 v75, v43
 v_mfma_f32_16x16x32_bf16 v[56:59], a[112:115], a[16:19], v[56:59]
 s_cmov_b32 s42, s67
 ds_read_b128 a[72:75], v3 offset:1024
 v_add_f32 v5, v5, v75
 v_mfma_f32_16x16x32_bf16 v[56:59], a[116:119], a[20:23], v[56:59]
 s_waitcnt lgkmcnt(3)
 v_exp_f32 v76, v44
 v_mfma_f32_16x16x32_bf16 v[56:59], a[120:123], a[24:27], v[56:59]
 s_cmov_b32 s70, 32768
 ds_read_b128 a[76:79], v3 offset:17408
 v_add_f32 v6, v6, v76
 v_mfma_f32_16x16x32_bf16 v[56:59], a[124:127], a[28:31], v[56:59]
 buffer_load_dwordx4 v1, s[12:15], s43 offen offset:1024 sc1 lds
 v_mfma_f32_16x16x32_bf16 v[60:63], a[96:99], a[32:35], v[124:127]
 ds_read_b128 a[80:83], v3 offset:2048
 v_mfma_f32_16x16x32_bf16 v[60:63], a[100:103], a[36:39], v[60:63]
 v_exp_f32 v77, v45
 v_mfma_f32_16x16x32_bf16 v[60:63], a[104:107], a[40:43], v[60:63]
 ds_read_b128 a[84:87], v3 offset:18432
 v_add_f32 v6, v6, v77
 v_mfma_f32_16x16x32_bf16 v[60:63], a[108:111], a[44:47], v[60:63]
 v_exp_f32 v78, v46
 v_mfma_f32_16x16x32_bf16 v[60:63], a[112:115], a[48:51], v[60:63]
 ds_read_b128 a[88:91], v3 offset:3072
 v_add_f32 v6, v6, v78
 v_mfma_f32_16x16x32_bf16 v[60:63], a[116:119], a[52:55], v[60:63]
 buffer_load_dwordx4 v1, s[12:15], s43 offen offset:2048 sc1 lds
 v_mfma_f32_16x16x32_bf16 v[60:63], a[120:123], a[56:59], v[60:63]
 ds_read_b128 a[92:95], v3 offset:19456
 v_mfma_f32_16x16x32_bf16 v[60:63], a[124:127], a[60:63], v[60:63]
 s_waitcnt lgkmcnt(6)
 v_exp_f32 v79, v47
 v_mfma_f32_16x16x32_bf16 v[128:131], a[64:67], v[16:19], v[128:131]
 ds_read_b128 a[96:99], v3 offset:4096
 v_add_f32 v6, v6, v79
 v_mfma_f32_16x16x32_bf16 v[128:131], a[68:71], v[24:27], v[128:131]
 v_exp_f32 v80, v48
 v_mfma_f32_16x16x32_bf16 v[192:195], a[68:71], v[28:31], v[192:195]
 ds_read_b128 a[100:103], v3 offset:20480
 v_add_f32 v5, v5, v80
 v_mfma_f32_16x16x32_bf16 v[192:195], a[64:67], v[20:23], v[192:195]
 s_waitcnt lgkmcnt(6)
 buffer_load_dwordx4 v1, s[12:15], s43 offen offset:3072 sc1 lds
 v_mfma_f32_16x16x32_bf16 v[132:135], a[72:75], v[16:19], v[132:135]
 ds_read_b128 a[104:107], v3 offset:5120
 v_mfma_f32_16x16x32_bf16 v[132:135], a[76:79], v[24:27], v[132:135]
 v_exp_f32 v81, v49
 v_mfma_f32_16x16x32_bf16 v[196:199], a[76:79], v[28:31], v[196:199]
 ds_read_b128 a[108:111], v3 offset:21504
 v_add_f32 v5, v5, v81
 v_mfma_f32_16x16x32_bf16 v[196:199], a[72:75], v[20:23], v[196:199]
 s_waitcnt lgkmcnt(6)
 v_exp_f32 v82, v50
 v_mfma_f32_16x16x32_bf16 v[136:139], a[80:83], v[16:19], v[136:139]
 s_bitset1_b32 m0, 12
 ds_read_b128 a[112:115], v3 offset:6144
 v_add_f32 v5, v5, v82
 v_mfma_f32_16x16x32_bf16 v[136:139], a[84:87], v[24:27], v[136:139]
 buffer_load_dwordx4 v4, s[12:15], s43 offen offset:0 sc1 lds
 v_mfma_f32_16x16x32_bf16 v[200:203], a[84:87], v[28:31], v[200:203]
 ds_read_b128 a[116:119], v3 offset:22528
 v_mfma_f32_16x16x32_bf16 v[200:203], a[80:83], v[20:23], v[200:203]
 s_waitcnt lgkmcnt(6)
 v_exp_f32 v83, v51
 v_mfma_f32_16x16x32_bf16 v[140:143], a[88:91], v[16:19], v[140:143]
 ds_read_b128 a[120:123], v3 offset:7168
 v_add_f32 v5, v5, v83
 v_mfma_f32_16x16x32_bf16 v[140:143], a[92:95], v[24:27], v[140:143]
 v_exp_f32 v84, v52
 v_mfma_f32_16x16x32_bf16 v[204:207], a[92:95], v[28:31], v[204:207]
 ds_read_b128 a[124:127], v3 offset:23552
 v_add_f32 v6, v6, v84
 v_mfma_f32_16x16x32_bf16 v[204:207], a[88:91], v[20:23], v[204:207]
 s_waitcnt lgkmcnt(6)
 buffer_load_dwordx4 v4, s[12:15], s43 offen offset:1024 sc1 lds
 v_mfma_f32_16x16x32_bf16 v[144:147], a[96:99], v[16:19], v[144:147]
 ds_read_b128 a[64:67], v3 offset:8192
 v_mfma_f32_16x16x32_bf16 v[144:147], a[100:103], v[24:27], v[144:147]
 v_exp_f32 v85, v53
 v_mfma_f32_16x16x32_bf16 v[208:211], a[100:103], v[28:31], v[208:211]
 ds_read_b128 a[68:71], v3 offset:24576
 v_add_f32 v6, v6, v85
 v_mfma_f32_16x16x32_bf16 v[208:211], a[96:99], v[20:23], v[208:211]
 s_waitcnt lgkmcnt(6)
 v_exp_f32 v86, v54
 v_mfma_f32_16x16x32_bf16 v[148:151], a[104:107], v[16:19], v[148:151]
 ds_read_b128 a[72:75], v3 offset:9216
 v_add_f32 v6, v6, v86
 v_mfma_f32_16x16x32_bf16 v[148:151], a[108:111], v[24:27], v[148:151]
 buffer_load_dwordx4 v4, s[12:15], s43 offen offset:2048 sc1 lds
 v_mfma_f32_16x16x32_bf16 v[212:215], a[108:111], v[28:31], v[212:215]
 ds_read_b128 a[76:79], v3 offset:25600
 v_mfma_f32_16x16x32_bf16 v[212:215], a[104:107], v[20:23], v[212:215]
 s_waitcnt lgkmcnt(6)
 v_exp_f32 v87, v55
 v_mfma_f32_16x16x32_bf16 v[152:155], a[112:115], v[16:19], v[152:155]
 ds_read_b128 a[80:83], v3 offset:10240
 v_add_f32 v6, v6, v87
 v_mfma_f32_16x16x32_bf16 v[152:155], a[116:119], v[24:27], v[152:155]
 v_exp_f32 v88, v56
 v_mfma_f32_16x16x32_bf16 v[216:219], a[116:119], v[28:31], v[216:219]
 s_xor_b32 s41, s41, 0x8000
 ds_read_b128 a[84:87], v3 offset:26624
 v_add_f32 v5, v5, v88
 v_mfma_f32_16x16x32_bf16 v[216:219], a[112:115], v[20:23], v[216:219]
 s_waitcnt lgkmcnt(6)
 buffer_load_dwordx4 v4, s[12:15], s43 offen offset:3072 sc1 lds
 v_mfma_f32_16x16x32_bf16 v[156:159], a[120:123], v[16:19], v[156:159]
 s_add_u32 s43, s43, s71
 ds_read_b128 a[88:91], v3 offset:11264
 v_mfma_f32_16x16x32_bf16 v[156:159], a[124:127], v[24:27], v[156:159]
 v_exp_f32 v89, v57
 v_mfma_f32_16x16x32_bf16 v[220:223], a[124:127], v[28:31], v[220:223]
 s_cmp_eq_u32 s43, s68
 ds_read_b128 a[92:95], v3 offset:27648
 v_add_f32 v5, v5, v89
 v_mfma_f32_16x16x32_bf16 v[220:223], a[120:123], v[20:23], v[220:223]
 s_waitcnt lgkmcnt(6)
 v_exp_f32 v90, v58
 v_mfma_f32_16x16x32_bf16 v[160:163], a[64:67], v[16:19], v[160:163]
 s_cmov_b32 s43, s69
 ds_read_b128 a[96:99], v3 offset:12288
 v_add_f32 v5, v5, v90
 v_mfma_f32_16x16x32_bf16 v[160:163], a[68:71], v[24:27], v[160:163]
 s_cmov_b32 s71, 32768
 v_exp_f32 v91, v59
 v_mfma_f32_16x16x32_bf16 v[224:227], a[68:71], v[28:31], v[224:227]
 ds_read_b128 a[100:103], v3 offset:28672
 v_add_f32 v5, v5, v91
 v_mfma_f32_16x16x32_bf16 v[224:227], a[64:67], v[20:23], v[224:227]
 s_waitcnt lgkmcnt(6)
 v_exp_f32 v92, v60
 v_mfma_f32_16x16x32_bf16 v[164:167], a[72:75], v[16:19], v[164:167]
 ds_read_b128 a[104:107], v3 offset:13312
 v_add_f32 v6, v6, v92
 v_mfma_f32_16x16x32_bf16 v[164:167], a[76:79], v[24:27], v[164:167]
 v_exp_f32 v93, v61
 v_mfma_f32_16x16x32_bf16 v[228:231], a[76:79], v[28:31], v[228:231]
 ds_read_b128 a[108:111], v3 offset:29696
 v_add_f32 v6, v6, v93
 v_mfma_f32_16x16x32_bf16 v[228:231], a[72:75], v[20:23], v[228:231]
 s_waitcnt lgkmcnt(6)
 v_exp_f32 v94, v62
 v_mfma_f32_16x16x32_bf16 v[168:171], a[80:83], v[16:19], v[168:171]
 ds_read_b128 a[112:115], v3 offset:14336
 v_add_f32 v6, v6, v94
 v_mfma_f32_16x16x32_bf16 v[168:171], a[84:87], v[24:27], v[168:171]
 v_exp_f32 v95, v63
 v_mfma_f32_16x16x32_bf16 v[232:235], a[84:87], v[28:31], v[232:235]
 ds_read_b128 a[116:119], v3 offset:30720
 v_add_f32 v6, v6, v95
 v_mfma_f32_16x16x32_bf16 v[232:235], a[80:83], v[20:23], v[232:235]
 s_waitcnt lgkmcnt(6)
 v_add_f32 v11, v5, v6
 v_mfma_f32_16x16x32_bf16 v[172:175], a[88:91], v[16:19], v[172:175]
 ds_read_b128 a[120:123], v3 offset:15360
 v_cmp_nge_f32 vcc, s47, v11
 v_mfma_f32_16x16x32_bf16 v[172:175], a[92:95], v[24:27], v[172:175]
 buffer_load_dword a246, v15, s[12:15], s60 offen sc1
 v_mfma_f32_16x16x32_bf16 v[236:239], a[92:95], v[28:31], v[236:239]
 s_waitcnt vmcnt(9) lgkmcnt(5)
 ds_read_b128 a[124:127], v3 offset:31744
 v_mfma_f32_16x16x32_bf16 v[236:239], a[88:91], v[20:23], v[236:239]
 s_barrier
 v_mfma_f32_16x16x32_bf16 v[176:179], a[96:99], v[16:19], v[176:179]
 ds_read_b128 a[64:67], v2 offset:0
 v_xor_b32 v3, 0x8000, v3
 v_mfma_f32_16x16x32_bf16 v[176:179], a[100:103], v[24:27], v[176:179]
 v_mfma_f32_16x16x32_bf16 v[240:243], a[100:103], v[28:31], v[240:243]
 ds_read_b128 a[68:71], v2 offset:1024
 v_mfma_f32_16x16x32_bf16 v[240:243], a[96:99], v[20:23], v[240:243]
 s_waitcnt lgkmcnt(6)
 v_mfma_f32_16x16x32_bf16 v[180:183], a[104:107], v[16:19], v[180:183]
 ds_read_b128 a[72:75], v2 offset:2048
 v_mfma_f32_16x16x32_bf16 v[180:183], a[108:111], v[24:27], v[180:183]
 v_mfma_f32_16x16x32_bf16 v[244:247], a[108:111], v[28:31], v[244:247]
 ds_read_b128 a[76:79], v2 offset:3072
 v_mfma_f32_16x16x32_bf16 v[244:247], a[104:107], v[20:23], v[244:247]
 s_waitcnt lgkmcnt(6)
 v_mfma_f32_16x16x32_bf16 v[184:187], a[112:115], v[16:19], v[184:187]
 s_sub_u32 s44, s44, 1
 ds_read_b128 a[80:83], v2 offset:4096
 v_mfma_f32_16x16x32_bf16 v[184:187], a[116:119], v[24:27], v[184:187]
 v_mfma_f32_16x16x32_bf16 v[248:251], a[116:119], v[28:31], v[248:251]
 ds_read_b128 a[84:87], v2 offset:5120
 v_mfma_f32_16x16x32_bf16 v[248:251], a[112:115], v[20:23], v[248:251]
 s_waitcnt lgkmcnt(6)
 v_mfma_f32_16x16x32_bf16 v[188:191], a[120:123], v[16:19], v[188:191]
 s_cmp_gt_u32 s44, s45
 ds_read_b128 a[88:91], v2 offset:6144
 v_mfma_f32_16x16x32_bf16 v[188:191], a[124:127], v[24:27], v[188:191]
 s_cselect_b64 vcc, vcc, -1
 v_mfma_f32_16x16x32_bf16 v[252:255], a[124:127], v[28:31], v[252:255]
 s_waitcnt lgkmcnt(5)
 ds_read_b128 a[92:95], v2 offset:7168
 v_mfma_f32_16x16x32_bf16 v[252:255], a[120:123], v[20:23], v[252:255]
 s_cbranch_vccz L_loop
 v_cmp_nge_f32 vcc, s47, v11
 s_cbranch_vccnz L_slow
L_ret2:
 s_cmp_lg_u32 s44, 2
 s_cbranch_scc1 L_disp
 v_mfma_f32_16x16x32_bf16 v[36:39], a[64:67], a[32:35], v[100:103]
 s_mov_b32 m0, s40
 ds_read_b128 a[96:99], v2 offset:8192
 v_accvgpr_read_b32 v96, a224
 v_mfma_f32_16x16x32_bf16 v[36:39], a[68:71], a[36:39], v[36:39]
 s_waitcnt lgkmcnt(5)
 buffer_load_dwordx4 v1, s[12:15], s42 offen offset:0 sc1 lds
 v_mfma_f32_16x16x32_bf16 v[36:39], a[72:75], a[40:43], v[36:39]
 ds_read_b128 a[100:103], v2 offset:9216
 v_accvgpr_read_b32 v97, a225
 v_mfma_f32_16x16x32_bf16 v[36:39], a[76:79], a[44:47], v[36:39]
 s_waitcnt lgkmcnt(4)
 v_accvgpr_read_b32 v98, a226
 v_accvgpr_read_b32 v99, a227
 v_mfma_f32_16x16x32_bf16 v[36:39], a[80:83], a[48:51], v[36:39]
 ds_read_b128 a[104:107], v2 offset:10240
 v_cvt_pk_bf16_f32 v20, v68, v69
 v_mfma_f32_16x16x32_bf16 v[36:39], a[84:87], a[52:55], v[36:39]
 s_waitcnt lgkmcnt(3)
 v_cvt_pk_bf16_f32 v21, v70, v71
 v_cvt_pk_bf16_f32 v16, v64, v65
 v_mfma_f32_16x16x32_bf16 v[36:39], a[88:91], a[56:59], v[36:39]
 ds_read_b128 a[108:111], v2 offset:11264
 v_cvt_pk_bf16_f32 v17, v66, v67
 v_mfma_f32_16x16x32_bf16 v[36:39], a[92:95], a[60:63], v[36:39]
 buffer_load_dwordx4 v1, s[12:15], s42 offen offset:1024 sc1 lds
 v_mfma_f32_16x16x32_bf16 v[32:35], a[64:67], a[0:3], v[96:99]
 ds_read_b128 a[112:115], v2 offset:12288
 v_add_f32 v7, v7, v5
 v_mfma_f32_16x16x32_bf16 v[32:35], a[68:71], a[4:7], v[32:35]
 v_add_f32 v8, v8, v6
 v_accvgpr_read_b32 v104, a228
 v_mfma_f32_16x16x32_bf16 v[32:35], a[72:75], a[8:11], v[32:35]
 ds_read_b128 a[116:119], v2 offset:13312
 v_accvgpr_read_b32 v105, a229
 v_mfma_f32_16x16x32_bf16 v[32:35], a[76:79], a[12:15], v[32:35]
 v_accvgpr_read_b32 v106, a230
 v_accvgpr_read_b32 v107, a231
 v_mfma_f32_16x16x32_bf16 v[32:35], a[80:83], a[16:19], v[32:35]
 ds_read_b128 a[120:123], v2 offset:14336
 v_cvt_pk_bf16_f32 v22, v76, v77
 v_mfma_f32_16x16x32_bf16 v[32:35], a[84:87], a[20:23], v[32:35]
 buffer_load_dwordx4 v1, s[12:15], s42 offen offset:2048 sc1 lds
 v_mfma_f32_16x16x32_bf16 v[32:35], a[88:91], a[24:27], v[32:35]
 ds_read_b128 a[124:127], v2 offset:15360
 v_cvt_pk_bf16_f32 v23, v78, v79
 v_mfma_f32_16x16x32_bf16 v[32:35], a[92:95], a[28:31], v[32:35]
 s_waitcnt lgkmcnt(6)
 v_exp_f32 v68, v36
 v_mfma_f32_16x16x32_bf16 v[44:47], a[96:99], a[32:35], v[108:111]
 ds_read_b128 a[64:67], v2 offset:16384
 v_cvt_pk_bf16_f32 v18, v72, v73
 v_mfma_f32_16x16x32_bf16 v[44:47], a[100:103], a[36:39], v[44:47]
 s_waitcnt lgkmcnt(5)
 v_exp_f32 v69, v37
 v_mfma_f32_16x16x32_bf16 v[44:47], a[104:107], a[40:43], v[44:47]
 ds_read_b128 a[68:71], v2 offset:17408
 v_cvt_pk_bf16_f32 v19, v74, v75
 v_add_f32 v6, v68, v69
 v_mfma_f32_16x16x32_bf16 v[44:47], a[108:111], a[44:47], v[44:47]
 s_waitcnt lgkmcnt(4)
 buffer_load_dwordx4 v1, s[12:15], s42 offen offset:3072 sc1 lds
 v_mfma_f32_16x16x32_bf16 v[44:47], a[112:115], a[48:51], v[44:47]
 ds_read_b128 a[72:75], v2 offset:18432
 v_accvgpr_read_b32 v112, a232
 v_mfma_f32_16x16x32_bf16 v[44:47], a[116:119], a[52:55], v[44:47]
 s_waitcnt lgkmcnt(3)
 v_exp_f32 v70, v38
 v_mfma_f32_16x16x32_bf16 v[44:47], a[120:123], a[56:59], v[44:47]
 ds_read_b128 a[76:79], v2 offset:19456
 v_accvgpr_read_b32 v113, a233
 v_add_f32 v6, v6, v70
 v_mfma_f32_16x16x32_bf16 v[44:47], a[124:127], a[60:63], v[44:47]
 v_exp_f32 v71, v39
 v_mfma_f32_16x16x32_bf16 v[40:43], a[96:99], a[0:3], v[104:107]
 s_bitset1_b32 m0, 12
 ds_read_b128 a[80:83], v2 offset:20480
 v_accvgpr_read_b32 v114, a234
 v_add_f32 v6, v6, v71
 v_mfma_f32_16x16x32_bf16 v[40:43], a[100:103], a[4:7], v[40:43]
 buffer_load_dwordx4 v4, s[12:15], s42 offen offset:0 sc1 lds
 v_mfma_f32_16x16x32_bf16 v[40:43], a[104:107], a[8:11], v[40:43]
 ds_read_b128 a[84:87], v2 offset:21504
 v_accvgpr_read_b32 v115, a235
 v_mfma_f32_16x16x32_bf16 v[40:43], a[108:111], a[12:15], v[40:43]
 v_exp_f32 v64, v32
 v_mfma_f32_16x16x32_bf16 v[40:43], a[112:115], a[16:19], v[40:43]
 ds_read_b128 a[88:91], v2 offset:22528
 v_cvt_pk_bf16_f32 v28, v84, v85
 v_mfma_f32_16x16x32_bf16 v[40:43], a[116:119], a[20:23], v[40:43]
 v_exp_f32 v65, v33
 v_mfma_f32_16x16x32_bf16 v[40:43], a[120:123], a[24:27], v[40:43]
 ds_read_b128 a[92:95], v2 offset:23552
 v_cvt_pk_bf16_f32 v29, v86, v87
 v_add_f32 v5, v64, v65
 v_mfma_f32_16x16x32_bf16 v[40:43], a[124:127], a[28:31], v[40:43]
 s_waitcnt lgkmcnt(6)
 buffer_load_dwordx4 v4, s[12:15], s42 offen offset:1024 sc1 lds
 v_mfma_f32_16x16x32_bf16 v[52:55], a[64:67], a[32:35], v[116:119]
 ds_read_b128 a[96:99], v2 offset:24576
 v_cvt_pk_bf16_f32 v24, v80, v81
 v_mfma_f32_16x16x32_bf16 v[52:55], a[68:71], a[36:39], v[52:55]
 s_waitcnt lgkmcnt(5)
 v_exp_f32 v66, v34
 v_mfma_f32_16x16x32_bf16 v[52:55], a[72:75], a[40:43], v[52:55]
 ds_read_b128 a[100:103], v2 offset:25600
 v_cvt_pk_bf16_f32 v25, v82, v83
 v_add_f32 v5, v5, v66
 v_mfma_f32_16x16x32_bf16 v[52:55], a[76:79], a[44:47], v[52:55]
 s_waitcnt lgkmcnt(4)
 v_exp_f32 v67, v35
 v_mfma_f32_16x16x32_bf16 v[52:55], a[80:83], a[48:51], v[52:55]
 ds_read_b128 a[104:107], v2 offset:26624
 v_accvgpr_read_b32 v120, a236
 v_add_f32 v5, v5, v67
 v_mfma_f32_16x16x32_bf16 v[52:55], a[84:87], a[52:55], v[52:55]
 s_waitcnt lgkmcnt(3)
 buffer_load_dwordx4 v4, s[12:15], s42 offen offset:2048 sc1 lds
 v_mfma_f32_16x16x32_bf16 v[52:55], a[88:91], a[56:59], v[52:55]
 ds_read_b128 a[108:111], v2 offset:27648
 v_accvgpr_read_b32 v121, a237
 v_mfma_f32_16x16x32_bf16 v[52:55], a[92:95], a[60:63], v[52:55]
 v_exp_f32 v76, v44
 v_mfma_f32_16x16x32_bf16 v[48:51], a[64:67], a[0:3], v[112:115]
 ds_read_b128 a[112:115], v2 offset:28672
 v_accvgpr_read_b32 v122, a238
 v_add_f32 v6, v6, v76
 v_mfma_f32_16x16x32_bf16 v[48:51], a[68:71], a[4:7], v[48:51]
 v_exp_f32 v77, v45
 v_mfma_f32_16x16x32_bf16 v[48:51], a[72:75], a[8:11], v[48:51]
 ds_read_b128 a[116:119], v2 offset:29696
 v_accvgpr_read_b32 v123, a239
 v_add_f32 v6, v6, v77
 v_mfma_f32_16x16x32_bf16 v[48:51], a[76:79], a[12:15], v[48:51]
 buffer_load_dwordx4 v4, s[12:15], s42 offen offset:3072 sc1 lds
 v_mfma_f32_16x16x32_bf16 v[48:51], a[80:83], a[16:19], v[48:51]
 ds_read_b128 a[120:123], v2 offset:30720
 v_cvt_pk_bf16_f32 v30, v92, v93
 v_mfma_f32_16x16x32_bf16 v[48:51], a[84:87], a[20:23], v[48:51]
 v_exp_f32 v78, v46
 v_mfma_f32_16x16x32_bf16 v[48:51], a[88:91], a[24:27], v[48:51]
 s_waitcnt vmcnt(8)
 ds_read_b128 a[124:127], v2 offset:31744
 v_xor_b32 v2, 0x8000, v2
 v_add_f32 v6, v6, v78
 v_mfma_f32_16x16x32_bf16 v[48:51], a[92:95], a[28:31], v[48:51]
 s_waitcnt lgkmcnt(6)
 s_barrier
 v_exp_f32 v79, v47
 v_mfma_f32_16x16x32_bf16 v[60:63], a[96:99], a[32:35], v[124:127]
 s_mov_b32 m0, s41
 ds_read_b128 a[64:67], v3 offset:0
 v_accvgpr_read_b32 v12, a246
 v_add_f32 v6, v6, v79
 v_mfma_f32_16x16x32_bf16 v[60:63], a[100:103], a[36:39], v[60:63]
 s_waitcnt lgkmcnt(5)
 buffer_load_dwordx4 v1, s[12:15], s43 offen offset:0 sc1 lds
 v_mfma_f32_16x16x32_bf16 v[60:63], a[104:107], a[40:43], v[60:63]
 ds_read_b128 a[68:71], v3 offset:16384
 v_cmp_ne_u32 s[20:21], 0, v12
 v_mfma_f32_16x16x32_bf16 v[60:63], a[108:111], a[44:47], v[60:63]
 s_waitcnt lgkmcnt(4)
 v_exp_f32 v72, v40
 v_mfma_f32_16x16x32_bf16 v[60:63], a[112:115], a[48:51], v[60:63]
 s_cmp_eq_u64 s[20:21], 0
 ds_read_b128 a[72:75], v3 offset:1024
 v_cvt_pk_bf16_f32 v31, v94, v95
 v_add_f32 v5, v5, v72
 v_mfma_f32_16x16x32_bf16 v[60:63], a[116:119], a[52:55], v[60:63]
 s_waitcnt lgkmcnt(3)
 buffer_load_dwordx4 v1, s[12:15], s43 offen offset:1024 sc1 lds
 v_mfma_f32_16x16x32_bf16 v[60:63], a[120:123], a[56:59], v[60:63]
 s_cselect_b32 s51, 1, 0
 ds_read_b128 a[76:79], v3 offset:17408
 v_cvt_pk_bf16_f32 v26, v88, v89
 v_mfma_f32_16x16x32_bf16 v[60:63], a[124:127], a[60:63], v[60:63]
 s_cselect_b32 s55, s4, 2.0
 v_exp_f32 v73, v41
 v_mfma_f32_16x16x32_bf16 v[56:59], a[96:99], a[0:3], v[120:123]
 s_cselect_b32 s56, s5, 2.0
 ds_read_b128 a[80:83], v3 offset:2048
 v_cvt_pk_bf16_f32 v27, v90, v91
 v_mfma_f32_16x16x32_bf16 v[56:59], a[100:103], a[4:7], v[56:59]
 buffer_load_dwordx4 v1, s[12:15], s43 offen offset:2048 sc1 lds
 v_mfma_f32_16x16x32_bf16 v[56:59], a[104:107], a[8:11], v[56:59]
 s_cselect_b32 s57, s6, 2.0
 ds_read_b128 a[84:87], v3 offset:18432
 v_add_f32 v5, v5, v73
 v_mfma_f32_16x16x32_bf16 v[56:59], a[108:111], a[12:15], v[56:59]
 v_exp_f32 v74, v42
 v_mfma_f32_16x16x32_bf16 v[56:59], a[112:115], a[16:19], v[56:59]
 ds_read_b128 a[88:91], v3 offset:3072
 v_accvgpr_read_b32 v13, a244
 v_mfma_f32_16x16x32_bf16 v[56:59], a[116:119], a[20:23], v[56:59]
 buffer_load_dwordx4 v1, s[12:15], s43 offen offset:3072 sc1 lds
 v_mfma_f32_16x16x32_bf16 v[56:59], a[120:123], a[24:27], v[56:59]
 ds_read_b128 a[92:95], v3 offset:19456
 v_add_f32 v5, v5, v74
 v_mfma_f32_16x16x32_bf16 v[56:59], a[124:127], a[28:31], v[56:59]
 s_waitcnt lgkmcnt(6)
 v_exp_f32 v75, v43
 v_mfma_f32_16x16x32_bf16 v[128:131], a[64:67], v[16:19], v[128:131]
 s_bitset1_b32 m0, 12
 ds_read_b128 a[96:99], v3 offset:4096
 v_add_f32 v5, v5, v75
 v_mfma_f32_16x16x32_bf16 v[128:131], a[68:71], v[24:27], v[128:131]
 buffer_load_dwordx4 v4, s[12:15], s43 offen offset:0 sc1 lds
 v_mfma_f32_16x16x32_bf16 v[192:195], a[68:71], v[28:31], v[192:195]
 ds_read_b128 a[100:103], v3 offset:20480
 v_sub_f32 v12, v10, v9
 v_mfma_f32_16x16x32_bf16 v[192:195], a[64:67], v[20:23], v[192:195]
 s_waitcnt lgkmcnt(6)
 v_exp_f32 v84, v52
 v_add_f32 v127, v123, v12
 v_mfma_f32_16x16x32_bf16 v[132:135], a[72:75], v[16:19], v[132:135]
 ds_read_b128 a[104:107], v3 offset:5120
 v_add_f32 v6, v6, v84
 v_mfma_f32_16x16x32_bf16 v[132:135], a[76:79], v[24:27], v[132:135]
 buffer_load_dwordx4 v4, s[12:15], s43 offen offset:1024 sc1 lds
 v_mfma_f32_16x16x32_bf16 v[196:199], a[76:79], v[28:31], v[196:199]
 ds_read_b128 a[108:111], v3 offset:21504
 v_add_f32 v100, v96, v12
 v_mfma_f32_16x16x32_bf16 v[196:199], a[72:75], v[20:23], v[196:199]
 s_waitcnt lgkmcnt(6)
 v_exp_f32 v85, v53
 v_mfma_f32_16x16x32_bf16 v[136:139], a[80:83], v[16:19], v[136:139]
 ds_read_b128 a[112:115], v3 offset:6144
 v_add_f32 v6, v6, v85
 v_mfma_f32_16x16x32_bf16 v[136:139], a[84:87], v[24:27], v[136:139]
 buffer_load_dwordx4 v4, s[12:15], s43 offen offset:2048 sc1 lds
 v_mfma_f32_16x16x32_bf16 v[200:203], a[84:87], v[28:31], v[200:203]
 ds_read_b128 a[116:119], v3 offset:22528
 v_add_f32 v101, v97, v12
 v_mfma_f32_16x16x32_bf16 v[200:203], a[80:83], v[20:23], v[200:203]
 s_waitcnt lgkmcnt(6)
 v_exp_f32 v86, v54
 v_mfma_f32_16x16x32_bf16 v[140:143], a[88:91], v[16:19], v[140:143]
 ds_read_b128 a[120:123], v3 offset:7168
 v_add_f32 v6, v6, v86
 v_mfma_f32_16x16x32_bf16 v[140:143], a[92:95], v[24:27], v[140:143]
 buffer_load_dwordx4 v4, s[12:15], s43 offen offset:3072 sc1 lds
 v_mfma_f32_16x16x32_bf16 v[204:207], a[92:95], v[28:31], v[204:207]
 s_add_u32 s43, s43, 32768
 ds_read_b128 a[124:127], v3 offset:23552
 v_add_f32 v102, v98, v12
 v_mfma_f32_16x16x32_bf16 v[204:207], a[88:91], v[20:23], v[204:207]
 s_waitcnt lgkmcnt(6)
 v_exp_f32 v87, v55
 v_mfma_f32_16x16x32_bf16 v[144:147], a[96:99], v[16:19], v[144:147]
 s_xor_b32 s41, s41, 0x8000
 ds_read_b128 a[64:67], v3 offset:8192
 v_add_f32 v6, v6, v87
 v_mfma_f32_16x16x32_bf16 v[144:147], a[100:103], v[24:27], v[144:147]
 buffer_load_dwordx4 a[192:195], v1, s[12:15], s57 offen sc1
 v_mfma_f32_16x16x32_bf16 v[208:211], a[100:103], v[28:31], v[208:211]
 s_xor_b32 s40, s40, 0x8000
 ds_read_b128 a[68:71], v3 offset:24576
 v_add_f32 v103, v99, v12
 v_mfma_f32_16x16x32_bf16 v[208:211], a[96:99], v[20:23], v[208:211]
 s_waitcnt lgkmcnt(6)
 v_exp_f32 v80, v48
 v_mfma_f32_16x16x32_bf16 v[148:151], a[104:107], v[16:19], v[148:151]
 s_add_u32 s52, s50, 131072
 ds_read_b128 a[72:75], v3 offset:9216
 v_add_f32 v5, v5, v80
 v_mfma_f32_16x16x32_bf16 v[148:151], a[108:111], v[24:27], v[148:151]
 buffer_load_dwordx4 a[128:131], v1, s[12:15], s55 offen offset:0 sc1
 v_mfma_f32_16x16x32_bf16 v[212:215], a[108:111], v[28:31], v[212:215]
 s_mul_i32 s58, s3, 50176
 ds_read_b128 a[76:79], v3 offset:25600
 v_add_f32 v108, v104, v12
 v_mfma_f32_16x16x32_bf16 v[212:215], a[104:107], v[20:23], v[212:215]
 s_waitcnt lgkmcnt(6)
 v_exp_f32 v81, v49
 v_mfma_f32_16x16x32_bf16 v[152:155], a[112:115], v[16:19], v[152:155]
 s_sub_u32 s58, 128, s58
 ds_read_b128 a[80:83], v3 offset:10240
 v_add_f32 v5, v5, v81
 v_mfma_f32_16x16x32_bf16 v[152:155], a[116:119], v[24:27], v[152:155]
 buffer_load_dwordx4 a[132:135], v1, s[12:15], s55 offen offset:1024 sc1
 v_mfma_f32_16x16x32_bf16 v[216:219], a[116:119], v[28:31], v[216:219]
 s_cmp_eq_u32 s7, 0
 ds_read_b128 a[84:87], v3 offset:26624
 v_add_f32 v109, v105, v12
 v_mfma_f32_16x16x32_bf16 v[216:219], a[112:115], v[20:23], v[216:219]
 s_waitcnt lgkmcnt(6)
 v_exp_f32 v82, v50
 v_mfma_f32_16x16x32_bf16 v[156:159], a[120:123], v[16:19], v[156:159]
 s_cselect_b32 s42, s78, s49
 ds_read_b128 a[88:91], v3 offset:11264
 v_add_f32 v5, v5, v82
 v_mfma_f32_16x16x32_bf16 v[156:159], a[124:127], v[24:27], v[156:159]
 buffer_load_dwordx4 a[136:139], v1, s[12:15], s55 offen offset:2048 sc1
 v_mfma_f32_16x16x32_bf16 v[220:223], a[124:127], v[28:31], v[220:223]
 s_cmov_b32 s40, s52
 ds_read_b128 a[92:95], v3 offset:27648
 v_add_f32 v110, v106, v12
 v_mfma_f32_16x16x32_bf16 v[220:223], a[120:123], v[20:23], v[220:223]
 s_waitcnt lgkmcnt(6)
 v_exp_f32 v83, v51
 v_mfma_f32_16x16x32_bf16 v[160:163], a[64:67], v[16:19], v[160:163]
 s_cmov_b64 s[8:9], s[86:87]
 ds_read_b128 a[96:99], v3 offset:12288
 v_add_f32 v5, v5, v83
 v_mfma_f32_16x16x32_bf16 v[160:163], a[68:71], v[24:27], v[160:163]
 buffer_load_dwordx4 a[140:143], v1, s[12:15], s55 offen offset:3072 sc1
 v_mfma_f32_16x16x32_bf16 v[224:227], a[68:71], v[28:31], v[224:227]
 s_cmov_b32 s10, 3670016
 ds_read_b128 a[100:103], v3 offset:28672
 v_add_f32 v111, v107, v12
 v_mfma_f32_16x16x32_bf16 v[224:227], a[64:67], v[20:23], v[224:227]
 s_waitcnt lgkmcnt(6)
 v_exp_f32 v92, v60
 v_mfma_f32_16x16x32_bf16 v[164:167], a[72:75], v[16:19], v[164:167]
 s_cmov_b32 s76, 6144
 ds_read_b128 a[104:107], v3 offset:13312
 v_add_f32 v6, v6, v92
 v_mfma_f32_16x16x32_bf16 v[164:167], a[76:79], v[24:27], v[164:167]
 buffer_load_dwordx4 a[144:147], v4, s[12:15], s55 offen offset:0 sc1
 v_mfma_f32_16x16x32_bf16 v[228:231], a[76:79], v[28:31], v[228:231]
 s_cmov_b32 s77, 10240
 ds_read_b128 a[108:111], v3 offset:29696
 v_add_f32 v116, v112, v12
 v_mfma_f32_16x16x32_bf16 v[228:231], a[72:75], v[20:23], v[228:231]
 s_waitcnt lgkmcnt(6)
 v_exp_f32 v93, v61
 v_mfma_f32_16x16x32_bf16 v[168:171], a[80:83], v[16:19], v[168:171]
 s_mov_b32 s44, 1
 ds_read_b128 a[112:115], v3 offset:14336
 v_add_f32 v6, v6, v93
 v_mfma_f32_16x16x32_bf16 v[168:171], a[84:87], v[24:27], v[168:171]
 buffer_load_dwordx4 a[148:151], v4, s[12:15], s55 offen offset:1024 sc1
 v_mfma_f32_16x16x32_bf16 v[232:235], a[84:87], v[28:31], v[232:235]
 s_cmp_eq_u32 s51, 1
 ds_read_b128 a[116:119], v3 offset:30720
 v_add_f32 v117, v113, v12
 v_mfma_f32_16x16x32_bf16 v[232:235], a[80:83], v[20:23], v[232:235]
 s_waitcnt lgkmcnt(6)
 v_exp_f32 v94, v62
 v_mfma_f32_16x16x32_bf16 v[172:175], a[88:91], v[16:19], v[172:175]
 ds_read_b128 a[120:123], v3 offset:15360
 v_add_f32 v6, v6, v94
 v_mfma_f32_16x16x32_bf16 v[172:175], a[92:95], v[24:27], v[172:175]
 buffer_load_dwordx4 a[152:155], v4, s[12:15], s55 offen offset:2048 sc1
 v_mfma_f32_16x16x32_bf16 v[236:239], a[92:95], v[28:31], v[236:239]
 s_waitcnt vmcnt(16)
 ds_read_b128 a[124:127], v3 offset:31744
 v_xor_b32 v3, 0x8000, v3
 v_mfma_f32_16x16x32_bf16 v[236:239], a[88:91], v[20:23], v[236:239]
 s_waitcnt lgkmcnt(6)
 s_barrier
 v_exp_f32 v95, v63
 v_mfma_f32_16x16x32_bf16 v[176:179], a[96:99], v[16:19], v[176:179]
 ds_read_b128 a[64:67], v2 offset:0
 v_add_f32 v6, v6, v95
 v_mfma_f32_16x16x32_bf16 v[176:179], a[100:103], v[24:27], v[176:179]
 buffer_load_dwordx4 a[156:159], v4, s[12:15], s55 offen offset:3072 sc1
 v_mfma_f32_16x16x32_bf16 v[240:243], a[100:103], v[28:31], v[240:243]
 s_waitcnt vmcnt(9)
 ds_read_b128 a[68:71], v2 offset:1024
 v_add_f32 v118, v114, v12
 v_mfma_f32_16x16x32_bf16 v[240:243], a[96:99], v[20:23], v[240:243]
 s_waitcnt lgkmcnt(6)
 s_barrier
 v_exp_f32 v88, v56
 v_mfma_f32_16x16x32_bf16 v[180:183], a[104:107], v[16:19], v[180:183]
 ds_read_b128 a[72:75], v2 offset:2048
 v_exp_f32 v89, v57
 v_add_f32 v5, v5, v88
 v_mfma_f32_16x16x32_bf16 v[180:183], a[108:111], v[24:27], v[180:183]
 ds_read_b128 a[96:99], v3 offset:0
 v_exp_f32 v90, v58
 v_add_f32 v5, v5, v89
 v_mfma_f32_16x16x32_bf16 v[244:247], a[108:111], v[28:31], v[244:247]
 ds_read_b128 a[76:79], v2 offset:3072
 v_exp_f32 v91, v59
 v_mfma_f32_16x16x32_bf16 v[244:247], a[104:107], v[20:23], v[244:247]
 s_waitcnt lgkmcnt(7)
 ds_read_b128 a[100:103], v3 offset:16384
 v_add_f32 v5, v5, v90
 v_mfma_f32_16x16x32_bf16 v[184:187], a[112:115], v[16:19], v[184:187]
 ds_read_b128 a[80:83], v2 offset:4096
 v_add_f32 v5, v5, v91
 v_mfma_f32_16x16x32_bf16 v[184:187], a[116:119], v[24:27], v[184:187]
 ds_read_b128 a[104:107], v3 offset:1024
 v_add_f32 v11, v5, v6
 v_mfma_f32_16x16x32_bf16 v[248:251], a[116:119], v[28:31], v[248:251]
 ds_read_b128 a[84:87], v2 offset:5120
 v_cmp_nge_f32 vcc, s47, v11
 v_mfma_f32_16x16x32_bf16 v[248:251], a[112:115], v[20:23], v[248:251]
 s_waitcnt lgkmcnt(9)
 ds_read_b128 a[108:111], v3 offset:17408
 v_add_f32 v119, v115, v12
 v_mfma_f32_16x16x32_bf16 v[188:191], a[120:123], v[16:19], v[188:191]
 s_cselect_b64 vcc, vcc, -1
 ds_read_b128 a[88:91], v2 offset:6144
 v_add_f32 v124, v120, v12
 v_mfma_f32_16x16x32_bf16 v[188:191], a[124:127], v[24:27], v[188:191]
 ds_read_b128 a[112:115], v3 offset:2048
 v_add_f32 v125, v121, v12
 v_mfma_f32_16x16x32_bf16 v[252:255], a[124:127], v[28:31], v[252:255]
 ds_read_b128 a[92:95], v2 offset:7168
 v_add_f32 v126, v122, v12
 v_mfma_f32_16x16x32_bf16 v[252:255], a[120:123], v[20:23], v[252:255]
 s_waitcnt lgkmcnt(11)
 ds_read_b128 a[116:119], v3 offset:18432
 s_cbranch_vccnz L_g0x
L_p1:
 v_mfma_f32_16x16x32_bf16 v[36:39], a[64:67], a[32:35], v[100:103]
 s_mov_b32 m0, s40
 ds_read_b128 a[120:123], v3 offset:3072
 v_cvt_pk_bf16_f32 v16, v64, v65
 v_cvt_pk_bf16_f32 v24, v80, v81
 v_mfma_f32_16x16x32_bf16 v[36:39], a[68:71], a[36:39], v[36:39]
 s_waitcnt lgkmcnt(10)
 ds_read_b128 a[124:127], v3 offset:19456
 buffer_load_dwordx4 v13, s[8:11], s42 offen offset:0 sc1 lds
 v_mfma_f32_16x16x32_bf16 v[36:39], a[72:75], a[40:43], v[36:39]
 s_add_u32 s39, s42, s76
 ds_read_b128 a[64:67], v2 offset:8192
 v_cvt_pk_bf16_f32 v17, v66, v67
 v_cvt_pk_bf16_f32 v25, v82, v83
 v_mfma_f32_16x16x32_bf16 v[36:39], a[76:79], a[44:47], v[36:39]
 s_waitcnt lgkmcnt(8)
 ds_read_b128 a[68:71], v2 offset:9216
 v_cvt_pk_bf16_f32 v18, v72, v73
 v_cvt_pk_bf16_f32 v26, v88, v89
 v_mfma_f32_16x16x32_bf16 v[36:39], a[80:83], a[48:51], v[36:39]
 buffer_load_dwordx4 v13, s[8:11], s39 offen offset:1024 sc1 lds
 v_mfma_f32_16x16x32_bf16 v[36:39], a[84:87], a[52:55], v[36:39]
 s_waitcnt lgkmcnt(5)
 ds_read_b128 a[72:75], v2 offset:10240
 v_cvt_pk_bf16_f32 v19, v74, v75
 v_cvt_pk_bf16_f32 v27, v90, v91
 v_mfma_f32_16x16x32_bf16 v[36:39], a[88:91], a[56:59], v[36:39]
 ds_read_b128 a[76:79], v2 offset:11264
 v_cvt_pk_bf16_f32 v20, v68, v69
 v_mfma_f32_16x16x32_bf16 v[36:39], a[92:95], a[60:63], v[36:39]
 s_add_u32 s39, s39, s76
 v_cvt_pk_bf16_f32 v21, v70, v71
 v_cvt_pk_bf16_f32 v22, v76, v77
 v_mfma_f32_16x16x32_bf16 v[128:131], a[96:99], v[16:19], v[128:131]
 ds_read_b128 a[80:83], v2 offset:12288
 buffer_load_dwordx4 v13, s[8:11], s39 offen offset:2048 sc1 lds
 v_mfma_f32_16x16x32_bf16 v[128:131], a[100:103], v[24:27], v[128:131]
 ds_read_b128 a[84:87], v2 offset:13312
 v_cvt_pk_bf16_f32 v23, v78, v79
 v_mfma_f32_16x16x32_bf16 v[132:135], a[104:107], v[16:19], v[132:135]
 v_cvt_pk_bf16_f32 v28, v84, v85
 v_cvt_pk_bf16_f32 v29, v86, v87
 v_mfma_f32_16x16x32_bf16 v[132:135], a[108:111], v[24:27], v[132:135]
 s_add_u32 s39, s39, s76
 ds_read_b128 a[88:91], v2 offset:14336
 v_cvt_pk_bf16_f32 v30, v92, v93
 v_mfma_f32_16x16x32_bf16 v[136:139], a[112:115], v[16:19], v[136:139]
 s_waitcnt lgkmcnt(8)
 ds_read_b128 a[92:95], v2 offset:15360
 v_cvt_pk_bf16_f32 v31, v94, v95
 v_mfma_f32_16x16x32_bf16 v[136:139], a[116:119], v[24:27], v[136:139]
 buffer_load_dwordx4 v13, s[8:11], s39 offen offset:3072 sc1 lds
 v_mfma_f32_16x16x32_bf16 v[140:143], a[120:123], v[16:19], v[140:143]
 s_waitcnt lgkmcnt(8)
 v_add_f32 v7, v7, v5
 v_add_f32 v8, v8, v6
 v_mfma_f32_16x16x32_bf16 v[140:143], a[124:127], v[24:27], v[140:143]
 s_bitset1_b32 m0, 12
 v_exp_f32 v68, v36
 v_mfma_f32_16x16x32_bf16 v[192:195], a[96:99], v[20:23], v[192:195]
 s_add_u32 s39, s39, s77
 ds_read_b128 a[96:99], v3 offset:4096
 v_mfma_f32_16x16x32_bf16 v[192:195], a[100:103], v[28:31], v[192:195]
 ds_read_b128 a[100:103], v3 offset:20480
 buffer_load_dwordx4 v13, s[8:11], s39 offen offset:0 sc1 lds
 v_mfma_f32_16x16x32_bf16 v[196:199], a[104:107], v[20:23], v[196:199]
 s_add_u32 s39, s39, s76
 v_exp_f32 v69, v37
 v_mfma_f32_16x16x32_bf16 v[196:199], a[108:111], v[28:31], v[196:199]
 ds_read_b128 a[104:107], v3 offset:5120
 buffer_load_dwordx4 v13, s[8:11], s39 offen offset:1024 sc1 lds
 v_mfma_f32_16x16x32_bf16 v[200:203], a[112:115], v[20:23], v[200:203]
 ds_read_b128 a[108:111], v3 offset:21504
 v_add_f32 v6, v68, v69
 v_mfma_f32_16x16x32_bf16 v[200:203], a[116:119], v[28:31], v[200:203]
 v_exp_f32 v70, v38
 v_mfma_f32_16x16x32_bf16 v[204:207], a[120:123], v[20:23], v[204:207]
 s_add_u32 s39, s39, s76
 ds_read_b128 a[112:115], v3 offset:6144
 v_add_f32 v6, v6, v70
 v_mfma_f32_16x16x32_bf16 v[204:207], a[124:127], v[28:31], v[204:207]
 s_waitcnt lgkmcnt(11)
 ds_read_b128 a[116:119], v3 offset:22528
 v_exp_f32 v71, v39
 v_mfma_f32_16x16x32_bf16 v[44:47], a[64:67], a[32:35], v[108:111]
 buffer_load_dwordx4 v13, s[8:11], s39 offen offset:2048 sc1 lds
 v_mfma_f32_16x16x32_bf16 v[44:47], a[68:71], a[36:39], v[44:47]
 s_waitcnt lgkmcnt(10)
 ds_read_b128 a[120:123], v3 offset:7168
 v_add_f32 v6, v6, v71
 v_mfma_f32_16x16x32_bf16 v[44:47], a[72:75], a[40:43], v[44:47]
 s_barrier
 ds_read_b128 a[124:127], v3 offset:23552
 v_mfma_f32_16x16x32_bf16 v[44:47], a[76:79], a[44:47], v[44:47]
 s_waitcnt lgkmcnt(10)
 v_mfma_f32_16x16x32_bf16 v[44:47], a[80:83], a[48:51], v[44:47]
 s_add_u32 s39, s39, s76
 ds_read_b128 a[64:67], v2 offset:16384
 v_mfma_f32_16x16x32_bf16 v[44:47], a[84:87], a[52:55], v[44:47]
 s_waitcnt lgkmcnt(9)
 ds_read_b128 a[68:71], v2 offset:17408
 buffer_load_dwordx4 v13, s[8:11], s39 offen offset:3072 sc1 lds
 v_mfma_f32_16x16x32_bf16 v[44:47], a[88:91], a[56:59], v[44:47]
 v_mfma_f32_16x16x32_bf16 v[44:47], a[92:95], a[60:63], v[44:47]
 s_waitcnt lgkmcnt(8)
 ds_read_b128 a[72:75], v2 offset:18432
 buffer_load_dwordx4 a[0:3], v1, s[12:15], s56 offen offset:0 sc1
 v_mfma_f32_16x16x32_bf16 v[144:147], a[96:99], v[16:19], v[144:147]
 ds_read_b128 a[76:79], v2 offset:19456
 v_mfma_f32_16x16x32_bf16 v[144:147], a[100:103], v[24:27], v[144:147]
 v_mfma_f32_16x16x32_bf16 v[208:211], a[100:103], v[28:31], v[208:211]
 ds_read_b128 a[80:83], v2 offset:20480
 buffer_load_dwordx4 a[4:7], v1, s[12:15], s56 offen offset:1024 sc1
 v_mfma_f32_16x16x32_bf16 v[208:211], a[96:99], v[20:23], v[208:211]
 s_waitcnt lgkmcnt(9)
 ds_read_b128 a[84:87], v2 offset:21504
 v_mfma_f32_16x16x32_bf16 v[148:151], a[104:107], v[16:19], v[148:151]
 v_exp_f32 v76, v44
 v_mfma_f32_16x16x32_bf16 v[148:151], a[108:111], v[24:27], v[148:151]
 ds_read_b128 a[88:91], v2 offset:22528
 v_add_f32 v6, v6, v76
 v_mfma_f32_16x16x32_bf16 v[212:215], a[108:111], v[28:31], v[212:215]
 ds_read_b128 a[92:95], v2 offset:23552
 v_exp_f32 v77, v45
 v_mfma_f32_16x16x32_bf16 v[212:215], a[104:107], v[20:23], v[212:215]
 s_waitcnt lgkmcnt(10)
 buffer_load_dwordx4 a[8:11], v1, s[12:15], s56 offen offset:2048 sc1
 v_mfma_f32_16x16x32_bf16 v[152:155], a[112:115], v[16:19], v[152:155]
 ds_read_b128 a[96:99], v3 offset:8192
 v_add_f32 v6, v6, v77
 v_mfma_f32_16x16x32_bf16 v[152:155], a[116:119], v[24:27], v[152:155]
 ds_read_b128 a[100:103], v3 offset:24576
 v_exp_f32 v78, v46
 v_mfma_f32_16x16x32_bf16 v[216:219], a[116:119], v[28:31], v[216:219]
 buffer_load_dwordx4 a[12:15], v1, s[12:15], s56 offen offset:3072 sc1
 v_mfma_f32_16x16x32_bf16 v[216:219], a[112:115], v[20:23], v[216:219]
 s_waitcnt lgkmcnt(10)
 ds_read_b128 a[104:107], v3 offset:9216
 v_add_f32 v6, v6, v78
 v_mfma_f32_16x16x32_bf16 v[156:159], a[120:123], v[16:19], v[156:159]
 ds_read_b128 a[108:111], v3 offset:25600
 v_exp_f32 v79, v47
 v_mfma_f32_16x16x32_bf16 v[156:159], a[124:127], v[24:27], v[156:159]
 buffer_load_dwordx4 a[16:19], v4, s[12:15], s56 offen offset:0 sc1
 v_mfma_f32_16x16x32_bf16 v[220:223], a[124:127], v[28:31], v[220:223]
 ds_read_b128 a[112:115], v3 offset:10240
 v_add_f32 v6, v6, v79
 v_mfma_f32_16x16x32_bf16 v[220:223], a[120:123], v[20:23], v[220:223]
 s_waitcnt lgkmcnt(11)
 ds_read_b128 a[116:119], v3 offset:26624
 v_mfma_f32_16x16x32_bf16 v[52:55], a[64:67], a[32:35], v[116:119]
 v_mfma_f32_16x16x32_bf16 v[52:55], a[68:71], a[36:39], v[52:55]
 s_waitcnt lgkmcnt(10)
 ds_read_b128 a[120:123], v3 offset:11264
 buffer_load_dwordx4 a[20:23], v4, s[12:15], s56 offen offset:1024 sc1
 v_mfma_f32_16x16x32_bf16 v[52:55], a[72:75], a[40:43], v[52:55]
 ds_read_b128 a[124:127], v3 offset:27648
 v_mfma_f32_16x16x32_bf16 v[52:55], a[76:79], a[44:47], v[52:55]
 s_waitcnt lgkmcnt(10)
 v_mfma_f32_16x16x32_bf16 v[52:55], a[80:83], a[48:51], v[52:55]
 ds_read_b128 a[64:67], v2 offset:24576
 buffer_load_dwordx4 a[24:27], v4, s[12:15], s56 offen offset:2048 sc1
 v_mfma_f32_16x16x32_bf16 v[52:55], a[84:87], a[52:55], v[52:55]
 s_waitcnt lgkmcnt(9)
 ds_read_b128 a[68:71], v2 offset:25600
 v_mfma_f32_16x16x32_bf16 v[52:55], a[88:91], a[56:59], v[52:55]
 v_mfma_f32_16x16x32_bf16 v[52:55], a[92:95], a[60:63], v[52:55]
 s_waitcnt lgkmcnt(8)
 ds_read_b128 a[72:75], v2 offset:26624
 v_mfma_f32_16x16x32_bf16 v[160:163], a[96:99], v[16:19], v[160:163]
 ds_read_b128 a[76:79], v2 offset:27648
 v_mfma_f32_16x16x32_bf16 v[160:163], a[100:103], v[24:27], v[160:163]
 buffer_load_dwordx4 a[28:31], v4, s[12:15], s56 offen offset:3072 sc1
 v_mfma_f32_16x16x32_bf16 v[224:227], a[100:103], v[28:31], v[224:227]
 s_mov_b32 m0, s41
 ds_read_b128 a[80:83], v2 offset:28672
 v_mfma_f32_16x16x32_bf16 v[224:227], a[96:99], v[20:23], v[224:227]
 s_waitcnt lgkmcnt(9)
 ds_read_b128 a[84:87], v2 offset:29696
 v_mfma_f32_16x16x32_bf16 v[164:167], a[104:107], v[16:19], v[164:167]
 buffer_load_dwordx4 v1, s[12:15], s43 offen offset:0 sc1 lds
 v_mfma_f32_16x16x32_bf16 v[164:167], a[108:111], v[24:27], v[164:167]
 ds_read_b128 a[88:91], v2 offset:30720
 v_exp_f32 v84, v52
 v_mfma_f32_16x16x32_bf16 v[228:231], a[108:111], v[28:31], v[228:231]
 ds_read_b128 a[92:95], v2 offset:31744
 v_xor_b32 v2, 0x8000, v2
 v_add_f32 v6, v6, v84
 v_mfma_f32_16x16x32_bf16 v[228:231], a[104:107], v[20:23], v[228:231]
 s_waitcnt lgkmcnt(10)
 buffer_load_dwordx4 v1, s[12:15], s43 offen offset:1024 sc1 lds
 v_mfma_f32_16x16x32_bf16 v[168:171], a[112:115], v[16:19], v[168:171]
 ds_read_b128 a[96:99], v3 offset:12288
 v_exp_f32 v85, v53
 v_mfma_f32_16x16x32_bf16 v[168:171], a[116:119], v[24:27], v[168:171]
 ds_read_b128 a[100:103], v3 offset:28672
 v_add_f32 v6, v6, v85
 v_mfma_f32_16x16x32_bf16 v[232:235], a[116:119], v[28:31], v[232:235]
 v_exp_f32 v86, v54
 v_mfma_f32_16x16x32_bf16 v[232:235], a[112:115], v[20:23], v[232:235]
 s_waitcnt lgkmcnt(10)
 ds_read_b128 a[104:107], v3 offset:13312
 buffer_load_dwordx4 v1, s[12:15], s43 offen offset:2048 sc1 lds
 v_mfma_f32_16x16x32_bf16 v[172:175], a[120:123], v[16:19], v[172:175]
 ds_read_b128 a[108:111], v3 offset:29696
 v_add_f32 v6, v6, v86
 v_mfma_f32_16x16x32_bf16 v[172:175], a[124:127], v[24:27], v[172:175]
 v_exp_f32 v87, v55
 v_mfma_f32_16x16x32_bf16 v[236:239], a[124:127], v[28:31], v[236:239]
 s_mov_b32 s44, 0
 ds_read_b128 a[112:115], v3 offset:14336
 v_add_f32 v6, v6, v87
 v_mfma_f32_16x16x32_bf16 v[236:239], a[120:123], v[20:23], v[236:239]
 s_waitcnt lgkmcnt(11)
 ds_read_b128 a[116:119], v3 offset:30720
 v_mfma_f32_16x16x32_bf16 v[60:63], a[64:67], a[32:35], v[124:127]
 buffer_load_dwordx4 v1, s[12:15], s43 offen offset:3072 sc1 lds
 v_mfma_f32_16x16x32_bf16 v[60:63], a[68:71], a[36:39], v[60:63]
 s_waitcnt lgkmcnt(10)
 ds_read_b128 a[120:123], v3 offset:15360
 v_mfma_f32_16x16x32_bf16 v[60:63], a[72:75], a[40:43], v[60:63]
 s_bitset1_b32 m0, 12
 ds_read_b128 a[124:127], v3 offset:31744
 v_xor_b32 v3, 0x8000, v3
 v_mfma_f32_16x16x32_bf16 v[60:63], a[76:79], a[44:47], v[60:63]
 s_waitcnt lgkmcnt(10)
 buffer_load_dwordx4 v4, s[12:15], s43 offen offset:0 sc1 lds
 v_mfma_f32_16x16x32_bf16 v[60:63], a[80:83], a[48:51], v[60:63]
 v_mfma_f32_16x16x32_bf16 v[60:63], a[84:87], a[52:55], v[60:63]
 s_waitcnt lgkmcnt(8)
 v_mfma_f32_16x16x32_bf16 v[60:63], a[88:91], a[56:59], v[60:63]
 buffer_load_dwordx4 v4, s[12:15], s43 offen offset:1024 sc1 lds
 v_mfma_f32_16x16x32_bf16 v[60:63], a[92:95], a[60:63], v[60:63]
 s_waitcnt lgkmcnt(6)
 v_mfma_f32_16x16x32_bf16 v[176:179], a[96:99], v[16:19], v[176:179]
 s_waitcnt vmcnt(14)
 v_mfma_f32_16x16x32_bf16 v[176:179], a[100:103], v[24:27], v[176:179]
 s_barrier
 v_mfma_f32_16x16x32_bf16 v[240:243], a[100:103], v[28:31], v[240:243]
 ds_read_b128 a[64:67], v2 offset:0
 buffer_load_dwordx4 v4, s[12:15], s43 offen offset:2048 sc1 lds
 v_mfma_f32_16x16x32_bf16 v[240:243], a[96:99], v[20:23], v[240:243]
 s_waitcnt lgkmcnt(5)
 ds_read_b128 a[68:71], v2 offset:1024
 v_mfma_f32_16x16x32_bf16 v[180:183], a[104:107], v[16:19], v[180:183]
 v_exp_f32 v92, v60
 v_mfma_f32_16x16x32_bf16 v[180:183], a[108:111], v[24:27], v[180:183]
 ds_read_b128 a[72:75], v2 offset:2048
 v_add_f32 v6, v6, v92
 v_mfma_f32_16x16x32_bf16 v[244:247], a[108:111], v[28:31], v[244:247]
 ds_read_b128 a[76:79], v2 offset:3072
 v_exp_f32 v93, v61
 v_mfma_f32_16x16x32_bf16 v[244:247], a[104:107], v[20:23], v[244:247]
 s_waitcnt lgkmcnt(6)
 buffer_load_dwordx4 v4, s[12:15], s43 offen offset:3072 sc1 lds
 v_mfma_f32_16x16x32_bf16 v[184:187], a[112:115], v[16:19], v[184:187]
 ds_read_b128 a[80:83], v2 offset:4096
 v_add_f32 v6, v6, v93
 v_exp_f32 v94, v62
 v_mfma_f32_16x16x32_bf16 v[184:187], a[116:119], v[24:27], v[184:187]
 v_add_f32 v6, v6, v94
 v_exp_f32 v95, v63
 v_mfma_f32_16x16x32_bf16 v[248:251], a[116:119], v[28:31], v[248:251]
 ds_read_b128 a[84:87], v2 offset:5120
 v_add_f32 v6, v6, v95
 v_mfma_f32_16x16x32_bf16 v[248:251], a[112:115], v[20:23], v[248:251]
 s_waitcnt lgkmcnt(6)
 ds_read_b128 a[88:91], v2 offset:6144
 v_cmp_nge_f32 vcc, s47, v6
 v_mfma_f32_16x16x32_bf16 v[188:191], a[120:123], v[16:19], v[188:191]
 v_mfma_f32_16x16x32_bf16 v[188:191], a[124:127], v[24:27], v[188:191]
 ds_read_b128 a[92:95], v2 offset:7168
 v_mfma_f32_16x16x32_bf16 v[252:255], a[124:127], v[28:31], v[252:255]
 v_mfma_f32_16x16x32_bf16 v[252:255], a[120:123], v[20:23], v[252:255]
 s_cbranch_vccnz L_slow
L_p2:
 s_cmp_lg_u32 s7, 0
 s_cbranch_scc1 L_switch
 v_and_b32 v11, 31, v0
 v_lshlrev_b32 v11, 2, v11
 buffer_load_dword a247, v11, s[12:15], s61 offen sc1
 v_accvgpr_read_b32 v32, a192
 v_accvgpr_read_b32 v33, a193
 v_accvgpr_read_b32 v34, a194
 v_accvgpr_read_b32 v35, a195
 v_add_u32 v2, s58, v13
 v_cmp_neq_f32 vcc, v34, v9
 v_cmp_neq_f32 s[20:21], v35, v10
 s_or_b64 vcc, vcc, s[20:21]
 s_cmp_eq_u32 s51, 1
 s_cselect_b64 vcc, vcc, -1
 s_cmp_eq_u32 s38, 0
 s_cselect_b64 vcc, 0, vcc
 s_cbranch_vccnz L_fagen
 v_mfma_f32_16x16x32_bf16 v[128:131], a[250:253], a[128:131], v[128:131]
 v_cvt_pk_bf16_f32 v20, v68, v69
 v_cvt_pk_bf16_f32 v21, v70, v71
 v_mfma_f32_16x16x32_bf16 v[132:135], a[248:251], a[128:131], v[132:135]
 v_cvt_pk_bf16_f32 v22, v76, v77
 v_cvt_pk_bf16_f32 v23, v78, v79
 v_mfma_f32_16x16x32_bf16 v[136:139], a[250:253], a[132:135], v[136:139]
 v_cvt_pk_bf16_f32 v28, v84, v85
 v_cvt_pk_bf16_f32 v29, v86, v87
 v_mfma_f32_16x16x32_bf16 v[140:143], a[248:251], a[132:135], v[140:143]
 v_cvt_pk_bf16_f32 v30, v92, v93
 v_cvt_pk_bf16_f32 v31, v94, v95
 v_mfma_f32_16x16x32_bf16 v[144:147], a[250:253], a[136:139], v[144:147]
 s_waitcnt vmcnt(0)
 v_add_f32 v8, v8, v6
 v_accvgpr_read_b32 v44, a254
 v_mfma_f32_16x16x32_bf16 v[148:151], a[248:251], a[136:139], v[148:151]
 s_barrier
 ds_read_b128 a[64:67], v3 offset:0
 v_mfma_f32_16x16x32_bf16 v[152:155], a[250:253], a[140:143], v[152:155]
 s_add_u32 m0, s29, 0
 ds_read_b128 a[68:71], v3 offset:16384
 v_mov_b32 v40, v7
 v_mfma_f32_16x16x32_bf16 v[156:159], a[248:251], a[140:143], v[156:159]
 buffer_load_dwordx4 v2, s[8:11], s78 offen lds
 v_mfma_f32_16x16x32_bf16 v[160:163], a[250:253], a[144:147], v[160:163]
 ds_read_b128 a[72:75], v3 offset:1024
 v_mov_b32 v41, v8
 v_mfma_f32_16x16x32_bf16 v[164:167], a[248:251], a[144:147], v[164:167]
 ds_read_b128 a[76:79], v3 offset:17408
 v_cvt_pk_bf16_f32 v128, v128, v129
 v_mfma_f32_16x16x32_bf16 v[168:171], a[250:253], a[148:151], v[168:171]
 s_add_u32 m0, s29, 4096
 v_permlane32_swap_b32 v7, v40
 v_permlane32_swap_b32 v8, v41
 v_mfma_f32_16x16x32_bf16 v[172:175], a[248:251], a[148:151], v[172:175]
 ds_read_b128 a[80:83], v3 offset:2048
 buffer_load_dwordx4 v2, s[8:11], s79 offen lds
 v_mfma_f32_16x16x32_bf16 v[176:179], a[250:253], a[152:155], v[176:179]
 ds_read_b128 a[84:87], v3 offset:18432
 v_add_f32 v7, v7, v40
 v_mfma_f32_16x16x32_bf16 v[180:183], a[248:251], a[152:155], v[180:183]
 v_add_f32 v8, v8, v41
 v_cvt_pk_bf16_f32 v129, v130, v131
 v_mfma_f32_16x16x32_bf16 v[184:187], a[250:253], a[156:159], v[184:187]
 s_add_u32 m0, s29, 8192
 ds_read_b128 a[88:91], v3 offset:3072
 v_cvt_pk_bf16_f32 v130, v132, v133
 v_mfma_f32_16x16x32_bf16 v[188:191], a[248:251], a[156:159], v[188:191]
 s_waitcnt lgkmcnt(5)
 ds_read_b128 a[92:95], v3 offset:19456
 v_mov_b32 v40, v7
 v_mfma_f32_16x16x32_bf16 v[192:195], a[64:67], v[20:23], v[192:195]
 s_waitcnt vmcnt(10)
 buffer_load_dwordx4 v2, s[8:11], s80 offen lds
 v_mfma_f32_16x16x32_bf16 v[192:195], a[68:71], v[28:31], v[192:195]
 ds_read_b128 a[96:99], v3 offset:4096
 v_mov_b32 v41, v8
 v_mfma_f32_16x16x32_bf16 v[192:195], a[250:253], a[0:3], v[192:195]
 s_waitcnt lgkmcnt(5)
 ds_read_b128 a[100:103], v3 offset:20480
 v_cvt_pk_bf16_f32 v131, v134, v135
 v_mfma_f32_16x16x32_bf16 v[196:199], a[72:75], v[20:23], v[196:199]
 s_add_u32 m0, s29, 12288
 v_permlane16_swap_b32 v7, v40
 v_permlane16_swap_b32 v8, v41
 v_mfma_f32_16x16x32_bf16 v[196:199], a[76:79], v[28:31], v[196:199]
 ds_read_b128 a[104:107], v3 offset:5120
 buffer_load_dwordx4 v2, s[8:11], s81 offen lds
 v_mfma_f32_16x16x32_bf16 v[196:199], a[248:251], a[0:3], v[196:199]
 s_waitcnt lgkmcnt(5)
 ds_read_b128 a[108:111], v3 offset:21504
 v_add_f32 v7, v7, v40
 v_mfma_f32_16x16x32_bf16 v[200:203], a[80:83], v[20:23], v[200:203]
 v_add_f32 v8, v8, v41
 v_cvt_pk_bf16_f32 v136, v136, v137
 v_mfma_f32_16x16x32_bf16 v[200:203], a[84:87], v[28:31], v[200:203]
 s_add_u32 m0, s29, 16384
 ds_read_b128 a[112:115], v3 offset:6144
 v_cvt_pk_bf16_f32 v137, v138, v139
 v_mfma_f32_16x16x32_bf16 v[200:203], a[250:253], a[4:7], v[200:203]
 s_waitcnt lgkmcnt(5)
 ds_read_b128 a[116:119], v3 offset:22528
 v_add_f32 v7, v7, v32
 v_mfma_f32_16x16x32_bf16 v[204:207], a[88:91], v[20:23], v[204:207]
 buffer_load_dwordx4 v2, s[8:11], s82 offen lds
 v_mfma_f32_16x16x32_bf16 v[204:207], a[92:95], v[28:31], v[204:207]
 ds_read_b128 a[120:123], v3 offset:7168
 v_add_f32 v8, v8, v33
 v_mfma_f32_16x16x32_bf16 v[204:207], a[248:251], a[4:7], v[204:207]
 s_waitcnt lgkmcnt(5)
 ds_read_b128 a[124:127], v3 offset:23552
 v_cvt_pk_bf16_f32 v138, v140, v141
 v_mfma_f32_16x16x32_bf16 v[208:211], a[96:99], v[20:23], v[208:211]
 s_add_u32 m0, s29, 20480
 v_cvt_pk_bf16_f32 v139, v142, v143
 v_cvt_pk_bf16_f32 v144, v144, v145
 v_mfma_f32_16x16x32_bf16 v[208:211], a[100:103], v[28:31], v[208:211]
 ds_read_b128 a[64:67], v3 offset:8192
 buffer_load_dwordx4 v2, s[8:11], s83 offen lds
 v_mfma_f32_16x16x32_bf16 v[208:211], a[250:253], a[8:11], v[208:211]
 s_waitcnt lgkmcnt(5)
 ds_read_b128 a[68:71], v3 offset:24576
 v_cvt_pk_bf16_f32 v145, v146, v147
 v_mfma_f32_16x16x32_bf16 v[212:215], a[104:107], v[20:23], v[212:215]
 v_cvt_pk_bf16_f32 v146, v148, v149
 v_cvt_pk_bf16_f32 v147, v150, v151
 v_mfma_f32_16x16x32_bf16 v[212:215], a[108:111], v[28:31], v[212:215]
 s_add_u32 m0, s29, 24576
 ds_read_b128 a[72:75], v3 offset:9216
 v_cvt_pk_bf16_f32 v152, v152, v153
 v_mfma_f32_16x16x32_bf16 v[212:215], a[248:251], a[8:11], v[212:215]
 s_waitcnt lgkmcnt(5)
 ds_read_b128 a[76:79], v3 offset:25600
 v_cvt_pk_bf16_f32 v153, v154, v155
 v_mfma_f32_16x16x32_bf16 v[216:219], a[112:115], v[20:23], v[216:219]
 buffer_load_dwordx4 v2, s[8:11], s84 offen lds
 v_mfma_f32_16x16x32_bf16 v[216:219], a[116:119], v[28:31], v[216:219]
 ds_read_b128 a[80:83], v3 offset:10240
 v_cvt_pk_bf16_f32 v154, v156, v157
 v_mfma_f32_16x16x32_bf16 v[216:219], a[250:253], a[12:15], v[216:219]
 s_waitcnt lgkmcnt(5)
 ds_read_b128 a[84:87], v3 offset:26624
 v_cvt_pk_bf16_f32 v155, v158, v159
 v_mfma_f32_16x16x32_bf16 v[220:223], a[120:123], v[20:23], v[220:223]
 s_add_u32 m0, s29, 28672
 v_cvt_pk_bf16_f32 v160, v160, v161
 v_cvt_pk_bf16_f32 v161, v162, v163
 v_mfma_f32_16x16x32_bf16 v[220:223], a[124:127], v[28:31], v[220:223]
 ds_read_b128 a[88:91], v3 offset:11264
 buffer_load_dwordx4 v2, s[8:11], s85 offen lds
 v_mfma_f32_16x16x32_bf16 v[220:223], a[248:251], a[12:15], v[220:223]
 s_waitcnt lgkmcnt(5)
 ds_read_b128 a[92:95], v3 offset:27648
 v_add_u32 v2, 128, v2
 v_mfma_f32_16x16x32_bf16 v[224:227], a[64:67], v[20:23], v[224:227]
 v_cvt_pk_bf16_f32 v162, v164, v165
 v_cvt_pk_bf16_f32 v163, v166, v167
 v_mfma_f32_16x16x32_bf16 v[224:227], a[68:71], v[28:31], v[224:227]
 ds_read_b128 a[96:99], v3 offset:12288
 v_cvt_pk_bf16_f32 v168, v168, v169
 v_mfma_f32_16x16x32_bf16 v[224:227], a[250:253], a[16:19], v[224:227]
 s_waitcnt lgkmcnt(5)
 ds_read_b128 a[100:103], v3 offset:28672
 v_cvt_pk_bf16_f32 v169, v170, v171
 v_mfma_f32_16x16x32_bf16 v[228:231], a[72:75], v[20:23], v[228:231]
 v_cvt_pk_bf16_f32 v170, v172, v173
 v_cvt_pk_bf16_f32 v171, v174, v175
 v_mfma_f32_16x16x32_bf16 v[228:231], a[76:79], v[28:31], v[228:231]
 ds_read_b128 a[104:107], v3 offset:13312
 v_cvt_pk_bf16_f32 v176, v176, v177
 v_mfma_f32_16x16x32_bf16 v[228:231], a[248:251], a[16:19], v[228:231]
 s_waitcnt lgkmcnt(5)
 ds_read_b128 a[108:111], v3 offset:29696
 v_cvt_pk_bf16_f32 v177, v178, v179
 v_mfma_f32_16x16x32_bf16 v[232:235], a[80:83], v[20:23], v[232:235]
 v_cvt_pk_bf16_f32 v178, v180, v181
 v_cvt_pk_bf16_f32 v179, v182, v183
 v_mfma_f32_16x16x32_bf16 v[232:235], a[84:87], v[28:31], v[232:235]
 ds_read_b128 a[112:115], v3 offset:14336
 v_cvt_pk_bf16_f32 v184, v184, v185
 v_mfma_f32_16x16x32_bf16 v[232:235], a[250:253], a[20:23], v[232:235]
 s_waitcnt lgkmcnt(5)
 ds_read_b128 a[116:119], v3 offset:30720
 v_cvt_pk_bf16_f32 v185, v186, v187
 v_mfma_f32_16x16x32_bf16 v[236:239], a[88:91], v[20:23], v[236:239]
 v_cvt_pk_bf16_f32 v186, v188, v189
 v_cvt_pk_bf16_f32 v187, v190, v191
 v_mfma_f32_16x16x32_bf16 v[236:239], a[92:95], v[28:31], v[236:239]
 ds_read_b128 a[120:123], v3 offset:15360
 v_cvt_pk_bf16_f32 v192, v192, v193
 v_mfma_f32_16x16x32_bf16 v[236:239], a[248:251], a[20:23], v[236:239]
 s_waitcnt lgkmcnt(5)
 ds_read_b128 a[124:127], v3 offset:31744
 v_cvt_pk_bf16_f32 v193, v194, v195
 v_mfma_f32_16x16x32_bf16 v[240:243], a[96:99], v[20:23], v[240:243]
 v_cvt_pk_bf16_f32 v194, v196, v197
 v_cvt_pk_bf16_f32 v195, v198, v199
 v_mfma_f32_16x16x32_bf16 v[240:243], a[100:103], v[28:31], v[240:243]
 v_cvt_pk_bf16_f32 v200, v200, v201
 v_cvt_pk_bf16_f32 v201, v202, v203
 v_mfma_f32_16x16x32_bf16 v[240:243], a[250:253], a[24:27], v[240:243]
 s_waitcnt lgkmcnt(4)
 v_cvt_pk_bf16_f32 v202, v204, v205
 v_cvt_pk_bf16_f32 v203, v206, v207
 v_mfma_f32_16x16x32_bf16 v[244:247], a[104:107], v[20:23], v[244:247]
 v_cvt_pk_bf16_f32 v208, v208, v209
 v_cvt_pk_bf16_f32 v209, v210, v211
 v_mfma_f32_16x16x32_bf16 v[244:247], a[108:111], v[28:31], v[244:247]
 v_cvt_pk_bf16_f32 v210, v212, v213
 v_cvt_pk_bf16_f32 v211, v214, v215
 v_mfma_f32_16x16x32_bf16 v[244:247], a[248:251], a[24:27], v[244:247]
 s_waitcnt lgkmcnt(2)
 v_cvt_pk_bf16_f32 v216, v216, v217
 v_cvt_pk_bf16_f32 v217, v218, v219
 v_mfma_f32_16x16x32_bf16 v[248:251], a[112:115], v[20:23], v[248:251]
 v_cvt_pk_bf16_f32 v218, v220, v221
 v_cvt_pk_bf16_f32 v219, v222, v223
 v_mfma_f32_16x16x32_bf16 v[248:251], a[116:119], v[28:31], v[248:251]
 v_cvt_pk_bf16_f32 v224, v224, v225
 v_cvt_pk_bf16_f32 v225, v226, v227
 v_mfma_f32_16x16x32_bf16 v[248:251], a[250:253], a[28:31], v[248:251]
 s_waitcnt lgkmcnt(0)
 v_cvt_pk_bf16_f32 v226, v228, v229
 v_cvt_pk_bf16_f32 v227, v230, v231
 v_mfma_f32_16x16x32_bf16 v[252:255], a[120:123], v[20:23], v[252:255]
 v_cvt_pk_bf16_f32 v232, v232, v233
 v_cvt_pk_bf16_f32 v233, v234, v235
 v_mfma_f32_16x16x32_bf16 v[252:255], a[124:127], v[28:31], v[252:255]
 v_cvt_pk_bf16_f32 v234, v236, v237
 v_cvt_pk_bf16_f32 v235, v238, v239
 v_mfma_f32_16x16x32_bf16 v[252:255], a[248:251], a[28:31], v[252:255]
 v_cvt_pk_bf16_f32 v240, v240, v241
 v_cvt_pk_bf16_f32 v241, v242, v243
 ds_read_b64_tr_b16 a[160:161], v44 offset:0
 ds_read_b64_tr_b16 a[162:163], v44 offset:2048
 ds_read_b64_tr_b16 a[164:165], v44 offset:4096
 ds_read_b64_tr_b16 a[166:167], v44 offset:6144
 ds_read_b64_tr_b16 a[168:169], v44 offset:8192
 ds_read_b64_tr_b16 a[170:171], v44 offset:10240
 ds_read_b64_tr_b16 a[172:173], v44 offset:12288
 ds_read_b64_tr_b16 a[174:175], v44 offset:14336
 ds_read_b64_tr_b16 a[176:177], v44 offset:16384
 ds_read_b64_tr_b16 a[178:179], v44 offset:18432
 ds_read_b64_tr_b16 a[180:181], v44 offset:20480
 ds_read_b64_tr_b16 a[182:183], v44 offset:22528
 ds_read_b64_tr_b16 a[184:185], v44 offset:24576
 ds_read_b64_tr_b16 a[186:187], v44 offset:26624
 s_nop 1
 v_rcp_f32 v64, v7
 v_rcp_f32 v65, v8
 v_cvt_pk_bf16_f32 v242, v244, v245
 v_cvt_pk_bf16_f32 v243, v246, v247
 v_cvt_pk_bf16_f32 v248, v248, v249
 v_cvt_pk_bf16_f32 v249, v250, v251
 v_cvt_pk_bf16_f32 v250, v252, v253
 v_cvt_pk_bf16_f32 v251, v254, v255
 s_cmp_eq_u32 s27, 0
 s_cbranch_scc1 L_bpark
L_op1in:
 s_waitcnt lgkmcnt(7)
 v_mfma_f32_16x16x32_bf16 v[72:75], a[160:163], v[128:131], 0
 s_lshl_b32 s48, s63, 3
 ds_read_b64_tr_b16 a[188:189], v44 offset:28672
 v_xor_b32 v45, 32, v44
 v_mfma_f32_16x16x32_bf16 v[72:75], a[164:167], v[136:139], v[72:75]
 s_add_u32 s48, s48, s3
 ds_read_b64_tr_b16 a[190:191], v44 offset:30720
 v_xor_b32 v46, 64, v44
 v_mfma_f32_16x16x32_bf16 v[72:75], a[168:171], v[144:147], v[72:75]
 s_waitcnt lgkmcnt(4)
 ds_read_b64_tr_b16 a[192:193], v45 offset:0
 v_xor_b32 v47, 96, v44
 v_mfma_f32_16x16x32_bf16 v[72:75], a[172:175], v[152:155], v[72:75]
 s_add_u32 m0, s29, 32768
 ds_read_b64_tr_b16 a[194:195], v45 offset:2048
 v_accvgpr_read_b32 v9, a245
 v_mfma_f32_16x16x32_bf16 v[72:75], a[176:179], v[160:163], v[72:75]
 ds_read_b64_tr_b16 a[196:197], v45 offset:4096
 buffer_load_dwordx4 v2, s[8:11], s78 offen lds
 v_mfma_f32_16x16x32_bf16 v[72:75], a[180:183], v[168:171], v[72:75]
 s_waitcnt lgkmcnt(3)
 ds_read_b64_tr_b16 a[198:199], v45 offset:6144
 v_mfma_f32_16x16x32_bf16 v[72:75], a[184:187], v[176:179], v[72:75]
 s_mul_i32 s48, s48, 243712
 ds_read_b64_tr_b16 a[200:201], v45 offset:8192
 v_mfma_f32_16x16x32_bf16 v[72:75], a[188:191], v[184:187], v[72:75]
 s_lshl_b32 s58, s26, 10
 ds_read_b64_tr_b16 a[202:203], v45 offset:10240
 v_mfma_f32_16x16x32_bf16 v[80:83], a[160:163], v[192:195], 0
 s_add_u32 s48, s48, s58
 ds_read_b64_tr_b16 a[204:205], v45 offset:12288
 v_mfma_f32_16x16x32_bf16 v[80:83], a[164:167], v[200:203], v[80:83]
 s_add_u32 s48, s48, 117440512
 ds_read_b64_tr_b16 a[206:207], v45 offset:14336
 v_mfma_f32_16x16x32_bf16 v[80:83], a[168:171], v[208:211], v[80:83]
 s_add_u32 m0, s29, 36864
 ds_read_b64_tr_b16 a[208:209], v45 offset:16384
 v_mfma_f32_16x16x32_bf16 v[80:83], a[172:175], v[216:219], v[80:83]
 ds_read_b64_tr_b16 a[210:211], v45 offset:18432
 buffer_load_dwordx4 v2, s[8:11], s79 offen lds
 v_mfma_f32_16x16x32_bf16 v[80:83], a[176:179], v[224:227], v[80:83]
 ds_read_b64_tr_b16 a[212:213], v45 offset:20480
 v_mul_f32 v72, v72, v64
 v_mfma_f32_16x16x32_bf16 v[80:83], a[180:183], v[232:235], v[80:83]
 ds_read_b64_tr_b16 a[214:215], v45 offset:22528
 v_mul_f32 v73, v73, v64
 v_mfma_f32_16x16x32_bf16 v[80:83], a[184:187], v[240:243], v[80:83]
 ds_read_b64_tr_b16 a[216:217], v45 offset:24576
 v_mul_f32 v74, v74, v64
 v_mfma_f32_16x16x32_bf16 v[80:83], a[188:191], v[248:251], v[80:83]
 s_waitcnt lgkmcnt(7)
 ds_read_b64_tr_b16 a[218:219], v45 offset:26624
 v_mul_f32 v75, v75, v64
 v_mfma_f32_16x16x32_bf16 v[76:79], a[192:195], v[128:131], 0
 ds_read_b64_tr_b16 a[220:221], v45 offset:28672
 v_mfma_f32_16x16x32_bf16 v[76:79], a[196:199], v[136:139], v[76:79]
 s_add_u32 m0, s29, 40960
 ds_read_b64_tr_b16 a[222:223], v45 offset:30720
 v_mfma_f32_16x16x32_bf16 v[76:79], a[200:203], v[144:147], v[76:79]
 s_waitcnt lgkmcnt(4)
 ds_read_b64_tr_b16 a[160:161], v46 offset:0
 buffer_load_dwordx4 v2, s[8:11], s80 offen lds
 v_mfma_f32_16x16x32_bf16 v[76:79], a[204:207], v[152:155], v[76:79]
 ds_read_b64_tr_b16 a[162:163], v46 offset:2048
 v_mfma_f32_16x16x32_bf16 v[76:79], a[208:211], v[160:163], v[76:79]
 ds_read_b64_tr_b16 a[164:165], v46 offset:4096
 v_mul_f32 v80, v80, v65
 v_mfma_f32_16x16x32_bf16 v[76:79], a[212:215], v[168:171], v[76:79]
 s_waitcnt lgkmcnt(3)
 ds_read_b64_tr_b16 a[166:167], v46 offset:6144
 v_mul_f32 v81, v81, v65
 v_mfma_f32_16x16x32_bf16 v[76:79], a[216:219], v[176:179], v[76:79]
 ds_read_b64_tr_b16 a[168:169], v46 offset:8192
 v_mul_f32 v82, v82, v65
 v_mfma_f32_16x16x32_bf16 v[76:79], a[220:223], v[184:187], v[76:79]
 ds_read_b64_tr_b16 a[170:171], v46 offset:10240
 v_mul_f32 v83, v83, v65
 v_mfma_f32_16x16x32_bf16 v[84:87], a[192:195], v[192:195], 0
 s_add_u32 m0, s29, 45056
 ds_read_b64_tr_b16 a[172:173], v46 offset:12288
 v_mfma_f32_16x16x32_bf16 v[84:87], a[196:199], v[200:203], v[84:87]
 ds_read_b64_tr_b16 a[174:175], v46 offset:14336
 buffer_load_dwordx4 v2, s[8:11], s81 offen lds
 v_mfma_f32_16x16x32_bf16 v[84:87], a[200:203], v[208:211], v[84:87]
 ds_read_b64_tr_b16 a[176:177], v46 offset:16384
 v_mfma_f32_16x16x32_bf16 v[84:87], a[204:207], v[216:219], v[84:87]
 ds_read_b64_tr_b16 a[178:179], v46 offset:18432
 v_mfma_f32_16x16x32_bf16 v[84:87], a[208:211], v[224:227], v[84:87]
 ds_read_b64_tr_b16 a[180:181], v46 offset:20480
 v_mul_f32 v76, v76, v64
 v_mfma_f32_16x16x32_bf16 v[84:87], a[212:215], v[232:235], v[84:87]
 ds_read_b64_tr_b16 a[182:183], v46 offset:22528
 v_mul_f32 v77, v77, v64
 v_mfma_f32_16x16x32_bf16 v[84:87], a[216:219], v[240:243], v[84:87]
 s_add_u32 m0, s29, 49152
 ds_read_b64_tr_b16 a[184:185], v46 offset:24576
 v_mul_f32 v78, v78, v64
 v_mfma_f32_16x16x32_bf16 v[84:87], a[220:223], v[248:251], v[84:87]
 s_waitcnt lgkmcnt(7)
 ds_read_b64_tr_b16 a[186:187], v46 offset:26624
 v_mul_f32 v79, v79, v64
 v_mfma_f32_16x16x32_bf16 v[88:91], a[160:163], v[128:131], 0
 ds_read_b64_tr_b16 a[188:189], v46 offset:28672
 buffer_load_dwordx4 v2, s[8:11], s82 offen lds
 v_mfma_f32_16x16x32_bf16 v[88:91], a[164:167], v[136:139], v[88:91]
 ds_read_b64_tr_b16 a[190:191], v46 offset:30720
 v_cvt_pk_bf16_f32 v72, v72, v73
 v_mfma_f32_16x16x32_bf16 v[88:91], a[168:171], v[144:147], v[88:91]
 s_waitcnt lgkmcnt(4)
 ds_read_b64_tr_b16 a[192:193], v47 offset:0
 v_cvt_pk_bf16_f32 v73, v74, v75
 v_mfma_f32_16x16x32_bf16 v[88:91], a[172:175], v[152:155], v[88:91]
 ds_read_b64_tr_b16 a[194:195], v47 offset:2048
 v_cvt_pk_bf16_f32 v74, v76, v77
 v_mfma_f32_16x16x32_bf16 v[88:91], a[176:179], v[160:163], v[88:91]
 s_add_u32 s58, s48, 0
 ds_read_b64_tr_b16 a[196:197], v47 offset:4096
 v_cvt_pk_bf16_f32 v75, v78, v79
 v_mfma_f32_16x16x32_bf16 v[88:91], a[180:183], v[168:171], v[88:91]
 s_waitcnt lgkmcnt(3)
 ds_read_b64_tr_b16 a[198:199], v47 offset:6144
 buffer_store_dwordx4 v[72:75], v1, s[12:15], s58 offen sc1
 v_mfma_f32_16x16x32_bf16 v[88:91], a[184:187], v[176:179], v[88:91]
 s_add_u32 m0, s29, 53248
 ds_read_b64_tr_b16 a[200:201], v47 offset:8192
 v_mul_f32 v84, v84, v65
 v_mfma_f32_16x16x32_bf16 v[88:91], a[188:191], v[184:187], v[88:91]
 ds_read_b64_tr_b16 a[202:203], v47 offset:10240
 buffer_load_dwordx4 v2, s[8:11], s83 offen lds
 v_mfma_f32_16x16x32_bf16 v[96:99], a[160:163], v[192:195], 0
 ds_read_b64_tr_b16 a[204:205], v47 offset:12288
 v_mul_f32 v85, v85, v65
 v_mfma_f32_16x16x32_bf16 v[96:99], a[164:167], v[200:203], v[96:99]
 ds_read_b64_tr_b16 a[206:207], v47 offset:14336
 v_mul_f32 v86, v86, v65
 v_mfma_f32_16x16x32_bf16 v[96:99], a[168:171], v[208:211], v[96:99]
 ds_read_b64_tr_b16 a[208:209], v47 offset:16384
 v_mul_f32 v87, v87, v65
 v_mfma_f32_16x16x32_bf16 v[96:99], a[172:175], v[216:219], v[96:99]
 ds_read_b64_tr_b16 a[210:211], v47 offset:18432
 v_cvt_pk_bf16_f32 v80, v80, v81
 v_mfma_f32_16x16x32_bf16 v[96:99], a[176:179], v[224:227], v[96:99]
 ds_read_b64_tr_b16 a[212:213], v47 offset:20480
 v_cvt_pk_bf16_f32 v81, v82, v83
 v_mfma_f32_16x16x32_bf16 v[96:99], a[180:183], v[232:235], v[96:99]
 s_add_u32 m0, s29, 57344
 ds_read_b64_tr_b16 a[214:215], v47 offset:22528
 v_cvt_pk_bf16_f32 v82, v84, v85
 v_mfma_f32_16x16x32_bf16 v[96:99], a[184:187], v[240:243], v[96:99]
 ds_read_b64_tr_b16 a[216:217], v47 offset:24576
 buffer_load_dwordx4 v2, s[8:11], s84 offen lds
 v_mfma_f32_16x16x32_bf16 v[96:99], a[188:191], v[248:251], v[96:99]
 s_waitcnt lgkmcnt(7)
 ds_read_b64_tr_b16 a[218:219], v47 offset:26624
 v_cvt_pk_bf16_f32 v83, v86, v87
 v_mfma_f32_16x16x32_bf16 v[92:95], a[192:195], v[128:131], 0
 s_waitcnt vmcnt(8)
 ds_read_b64_tr_b16 a[220:221], v47 offset:28672
 v_mul_f32 v88, v88, v64
 v_mfma_f32_16x16x32_bf16 v[92:95], a[196:199], v[136:139], v[92:95]
 s_barrier
 ds_read_b64_tr_b16 a[222:223], v47 offset:30720
 v_xor_b32 v44, 0x20000, v44
 v_mfma_f32_16x16x32_bf16 v[92:95], a[200:203], v[144:147], v[92:95]
 s_waitcnt lgkmcnt(4)
 ds_read_b64_tr_b16 a[160:161], v44 offset:0
 v_mul_f32 v89, v89, v64
 v_mfma_f32_16x16x32_bf16 v[92:95], a[204:207], v[152:155], v[92:95]
 ds_read_b64_tr_b16 a[162:163], v44 offset:2048
 v_mul_f32 v90, v90, v64
 v_mfma_f32_16x16x32_bf16 v[92:95], a[208:211], v[160:163], v[92:95]
 s_add_u32 m0, s29, 61440
 ds_read_b64_tr_b16 a[164:165], v44 offset:4096
 v_mul_f32 v91, v91, v64
 v_mfma_f32_16x16x32_bf16 v[92:95], a[212:215], v[168:171], v[92:95]
 s_waitcnt lgkmcnt(3)
 ds_read_b64_tr_b16 a[166:167], v44 offset:6144
 buffer_load_dwordx4 v2, s[8:11], s85 offen lds
 v_mfma_f32_16x16x32_bf16 v[92:95], a[216:219], v[176:179], v[92:95]
 s_add_u32 s58, s48, 974848
 ds_read_b64_tr_b16 a[168:169], v44 offset:8192
 v_add_u32 v2, 128, v2
 v_mfma_f32_16x16x32_bf16 v[92:95], a[220:223], v[184:187], v[92:95]
 ds_read_b64_tr_b16 a[170:171], v44 offset:10240
 buffer_store_dwordx4 v[80:83], v1, s[12:15], s58 offen sc1
 v_mfma_f32_16x16x32_bf16 v[100:103], a[192:195], v[192:195], 0
 ds_read_b64_tr_b16 a[172:173], v44 offset:12288
 v_mul_f32 v96, v96, v65
 v_mfma_f32_16x16x32_bf16 v[100:103], a[196:199], v[200:203], v[100:103]
 ds_read_b64_tr_b16 a[174:175], v44 offset:14336
 v_mul_f32 v97, v97, v65
 v_mfma_f32_16x16x32_bf16 v[100:103], a[200:203], v[208:211], v[100:103]
 ds_read_b64_tr_b16 a[176:177], v44 offset:16384
 v_mul_f32 v98, v98, v65
 v_mfma_f32_16x16x32_bf16 v[100:103], a[204:207], v[216:219], v[100:103]
 ds_read_b64_tr_b16 a[178:179], v44 offset:18432
 v_mul_f32 v99, v99, v65
 v_mfma_f32_16x16x32_bf16 v[100:103], a[208:211], v[224:227], v[100:103]
 ds_read_b64_tr_b16 a[180:181], v44 offset:20480
 v_mul_f32 v92, v92, v64
 v_mfma_f32_16x16x32_bf16 v[100:103], a[212:215], v[232:235], v[100:103]
 ds_read_b64_tr_b16 a[182:183], v44 offset:22528
 v_mul_f32 v93, v93, v64
 v_mfma_f32_16x16x32_bf16 v[100:103], a[216:219], v[240:243], v[100:103]
 ds_read_b64_tr_b16 a[184:185], v44 offset:24576
 v_mul_f32 v94, v94, v64
 v_mfma_f32_16x16x32_bf16 v[100:103], a[220:223], v[248:251], v[100:103]
 s_waitcnt lgkmcnt(7)
 ds_read_b64_tr_b16 a[186:187], v44 offset:26624
 v_mul_f32 v95, v95, v64
 v_mfma_f32_16x16x32_bf16 v[104:107], a[160:163], v[128:131], 0
 ds_read_b64_tr_b16 a[188:189], v44 offset:28672
 v_cvt_pk_bf16_f32 v88, v88, v89
 v_mfma_f32_16x16x32_bf16 v[104:107], a[164:167], v[136:139], v[104:107]
 ds_read_b64_tr_b16 a[190:191], v44 offset:30720
 v_xor_b32 v45, 0x20000, v45
 v_mfma_f32_16x16x32_bf16 v[104:107], a[168:171], v[144:147], v[104:107]
 s_waitcnt lgkmcnt(4)
 ds_read_b64_tr_b16 a[192:193], v45 offset:0
 v_cvt_pk_bf16_f32 v89, v90, v91
 v_mfma_f32_16x16x32_bf16 v[104:107], a[172:175], v[152:155], v[104:107]
 s_add_u32 m0, s29, 65536
 ds_read_b64_tr_b16 a[194:195], v45 offset:2048
 v_cvt_pk_bf16_f32 v90, v92, v93
 v_mfma_f32_16x16x32_bf16 v[104:107], a[176:179], v[160:163], v[104:107]
 ds_read_b64_tr_b16 a[196:197], v45 offset:4096
 buffer_load_dwordx4 v2, s[8:11], s78 offen lds
 v_mfma_f32_16x16x32_bf16 v[104:107], a[180:183], v[168:171], v[104:107]
 s_waitcnt lgkmcnt(3)
 ds_read_b64_tr_b16 a[198:199], v45 offset:6144
 v_cvt_pk_bf16_f32 v91, v94, v95
 v_mfma_f32_16x16x32_bf16 v[104:107], a[184:187], v[176:179], v[104:107]
 s_add_u32 s58, s48, 17408
 ds_read_b64_tr_b16 a[200:201], v45 offset:8192
 v_mul_f32 v100, v100, v65
 v_mfma_f32_16x16x32_bf16 v[104:107], a[188:191], v[184:187], v[104:107]
 ds_read_b64_tr_b16 a[202:203], v45 offset:10240
 buffer_store_dwordx4 v[88:91], v1, s[12:15], s58 offen sc1
 v_mfma_f32_16x16x32_bf16 v[112:115], a[160:163], v[192:195], 0
 ds_read_b64_tr_b16 a[204:205], v45 offset:12288
 v_mul_f32 v101, v101, v65
 v_mfma_f32_16x16x32_bf16 v[112:115], a[164:167], v[200:203], v[112:115]
 ds_read_b64_tr_b16 a[206:207], v45 offset:14336
 v_mul_f32 v102, v102, v65
 v_mfma_f32_16x16x32_bf16 v[112:115], a[168:171], v[208:211], v[112:115]
 s_add_u32 m0, s29, 69632
 ds_read_b64_tr_b16 a[208:209], v45 offset:16384
 v_mul_f32 v103, v103, v65
 v_mfma_f32_16x16x32_bf16 v[112:115], a[172:175], v[216:219], v[112:115]
 ds_read_b64_tr_b16 a[210:211], v45 offset:18432
 buffer_load_dwordx4 v2, s[8:11], s79 offen lds
 v_mfma_f32_16x16x32_bf16 v[112:115], a[176:179], v[224:227], v[112:115]
 ds_read_b64_tr_b16 a[212:213], v45 offset:20480
 v_cvt_pk_bf16_f32 v96, v96, v97
 v_mfma_f32_16x16x32_bf16 v[112:115], a[180:183], v[232:235], v[112:115]
 ds_read_b64_tr_b16 a[214:215], v45 offset:22528
 v_cvt_pk_bf16_f32 v97, v98, v99
 v_mfma_f32_16x16x32_bf16 v[112:115], a[184:187], v[240:243], v[112:115]
 s_add_u32 s58, s48, 992256
 ds_read_b64_tr_b16 a[216:217], v45 offset:24576
 v_cvt_pk_bf16_f32 v98, v100, v101
 v_mfma_f32_16x16x32_bf16 v[112:115], a[188:191], v[248:251], v[112:115]
 s_waitcnt lgkmcnt(7)
 ds_read_b64_tr_b16 a[218:219], v45 offset:26624
 v_cvt_pk_bf16_f32 v99, v102, v103
 v_mfma_f32_16x16x32_bf16 v[108:111], a[192:195], v[128:131], 0
 ds_read_b64_tr_b16 a[220:221], v45 offset:28672
 buffer_store_dwordx4 v[96:99], v1, s[12:15], s58 offen sc1
 v_mfma_f32_16x16x32_bf16 v[108:111], a[196:199], v[136:139], v[108:111]
 s_add_u32 m0, s29, 73728
 ds_read_b64_tr_b16 a[222:223], v45 offset:30720
 v_xor_b32 v46, 0x20000, v46
 v_mfma_f32_16x16x32_bf16 v[108:111], a[200:203], v[144:147], v[108:111]
 s_waitcnt lgkmcnt(4)
 ds_read_b64_tr_b16 a[160:161], v46 offset:0
 buffer_load_dwordx4 v2, s[8:11], s80 offen lds
 v_mfma_f32_16x16x32_bf16 v[108:111], a[204:207], v[152:155], v[108:111]
 ds_read_b64_tr_b16 a[162:163], v46 offset:2048
 v_mul_f32 v104, v104, v64
 v_mfma_f32_16x16x32_bf16 v[108:111], a[208:211], v[160:163], v[108:111]
 ds_read_b64_tr_b16 a[164:165], v46 offset:4096
 v_mul_f32 v105, v105, v64
 v_mfma_f32_16x16x32_bf16 v[108:111], a[212:215], v[168:171], v[108:111]
 s_waitcnt lgkmcnt(3)
 ds_read_b64_tr_b16 a[166:167], v46 offset:6144
 v_mul_f32 v106, v106, v64
 v_mfma_f32_16x16x32_bf16 v[108:111], a[216:219], v[176:179], v[108:111]
 ds_read_b64_tr_b16 a[168:169], v46 offset:8192
 v_mul_f32 v107, v107, v64
 v_mfma_f32_16x16x32_bf16 v[108:111], a[220:223], v[184:187], v[108:111]
 ds_read_b64_tr_b16 a[170:171], v46 offset:10240
 v_mul_f32 v112, v112, v65
 v_mfma_f32_16x16x32_bf16 v[116:119], a[192:195], v[192:195], 0
 s_add_u32 m0, s29, 77824
 ds_read_b64_tr_b16 a[172:173], v46 offset:12288
 v_mul_f32 v113, v113, v65
 v_mfma_f32_16x16x32_bf16 v[116:119], a[196:199], v[200:203], v[116:119]
 ds_read_b64_tr_b16 a[174:175], v46 offset:14336
 buffer_load_dwordx4 v2, s[8:11], s81 offen lds
 v_mfma_f32_16x16x32_bf16 v[116:119], a[200:203], v[208:211], v[116:119]
 ds_read_b64_tr_b16 a[176:177], v46 offset:16384
 v_mul_f32 v114, v114, v65
 v_mfma_f32_16x16x32_bf16 v[116:119], a[204:207], v[216:219], v[116:119]
 ds_read_b64_tr_b16 a[178:179], v46 offset:18432
 v_mul_f32 v115, v115, v65
 v_mfma_f32_16x16x32_bf16 v[116:119], a[208:211], v[224:227], v[116:119]
 ds_read_b64_tr_b16 a[180:181], v46 offset:20480
 v_mul_f32 v108, v108, v64
 v_mfma_f32_16x16x32_bf16 v[116:119], a[212:215], v[232:235], v[116:119]
 ds_read_b64_tr_b16 a[182:183], v46 offset:22528
 v_mul_f32 v109, v109, v64
 v_mfma_f32_16x16x32_bf16 v[116:119], a[216:219], v[240:243], v[116:119]
 s_add_u32 m0, s29, 81920
 ds_read_b64_tr_b16 a[184:185], v46 offset:24576
 v_mul_f32 v110, v110, v64
 v_mfma_f32_16x16x32_bf16 v[116:119], a[220:223], v[248:251], v[116:119]
 s_waitcnt lgkmcnt(7)
 ds_read_b64_tr_b16 a[186:187], v46 offset:26624
 v_mul_f32 v111, v111, v64
 v_mfma_f32_16x16x32_bf16 v[72:75], a[160:163], v[128:131], 0
 ds_read_b64_tr_b16 a[188:189], v46 offset:28672
 buffer_load_dwordx4 v2, s[8:11], s82 offen lds
 v_mfma_f32_16x16x32_bf16 v[72:75], a[164:167], v[136:139], v[72:75]
 ds_read_b64_tr_b16 a[190:191], v46 offset:30720
 v_xor_b32 v47, 0x20000, v47
 v_mfma_f32_16x16x32_bf16 v[72:75], a[168:171], v[144:147], v[72:75]
 s_waitcnt lgkmcnt(4)
 ds_read_b64_tr_b16 a[192:193], v47 offset:0
 v_cvt_pk_bf16_f32 v104, v104, v105
 v_mfma_f32_16x16x32_bf16 v[72:75], a[172:175], v[152:155], v[72:75]
 ds_read_b64_tr_b16 a[194:195], v47 offset:2048
 v_cvt_pk_bf16_f32 v105, v106, v107
 v_mfma_f32_16x16x32_bf16 v[72:75], a[176:179], v[160:163], v[72:75]
 ds_read_b64_tr_b16 a[196:197], v47 offset:4096
 v_cvt_pk_bf16_f32 v106, v108, v109
 v_mfma_f32_16x16x32_bf16 v[72:75], a[180:183], v[168:171], v[72:75]
 s_waitcnt lgkmcnt(3)
 ds_read_b64_tr_b16 a[198:199], v47 offset:6144
 v_cvt_pk_bf16_f32 v107, v110, v111
 v_mfma_f32_16x16x32_bf16 v[72:75], a[184:187], v[176:179], v[72:75]
 s_add_u32 m0, s29, 86016
 ds_read_b64_tr_b16 a[200:201], v47 offset:8192
 v_mul_f32 v116, v116, v65
 v_mfma_f32_16x16x32_bf16 v[72:75], a[188:191], v[184:187], v[72:75]
 ds_read_b64_tr_b16 a[202:203], v47 offset:10240
 buffer_load_dwordx4 v2, s[8:11], s83 offen lds
 v_mfma_f32_16x16x32_bf16 v[80:83], a[160:163], v[192:195], 0
 s_add_u32 s58, s48, 34816
 ds_read_b64_tr_b16 a[204:205], v47 offset:12288
 v_mul_f32 v117, v117, v65
 v_mfma_f32_16x16x32_bf16 v[80:83], a[164:167], v[200:203], v[80:83]
 ds_read_b64_tr_b16 a[206:207], v47 offset:14336
 buffer_store_dwordx4 v[104:107], v1, s[12:15], s58 offen sc1
 v_mfma_f32_16x16x32_bf16 v[80:83], a[168:171], v[208:211], v[80:83]
 ds_read_b64_tr_b16 a[208:209], v47 offset:16384
 v_mul_f32 v118, v118, v65
 v_mfma_f32_16x16x32_bf16 v[80:83], a[172:175], v[216:219], v[80:83]
 ds_read_b64_tr_b16 a[210:211], v47 offset:18432
 v_mul_f32 v119, v119, v65
 v_mfma_f32_16x16x32_bf16 v[80:83], a[176:179], v[224:227], v[80:83]
 ds_read_b64_tr_b16 a[212:213], v47 offset:20480
 v_cvt_pk_bf16_f32 v112, v112, v113
 v_mfma_f32_16x16x32_bf16 v[80:83], a[180:183], v[232:235], v[80:83]
 s_add_u32 m0, s29, 90112
 ds_read_b64_tr_b16 a[214:215], v47 offset:22528
 v_cvt_pk_bf16_f32 v113, v114, v115
 v_mfma_f32_16x16x32_bf16 v[80:83], a[184:187], v[240:243], v[80:83]
 ds_read_b64_tr_b16 a[216:217], v47 offset:24576
 buffer_load_dwordx4 v2, s[8:11], s84 offen lds
 v_mfma_f32_16x16x32_bf16 v[80:83], a[188:191], v[248:251], v[80:83]
 s_waitcnt lgkmcnt(7)
 ds_read_b64_tr_b16 a[218:219], v47 offset:26624
 v_cvt_pk_bf16_f32 v114, v116, v117
 v_mfma_f32_16x16x32_bf16 v[76:79], a[192:195], v[128:131], 0
 s_waitcnt vmcnt(11)
 ds_read_b64_tr_b16 a[220:221], v47 offset:28672
 v_cvt_pk_bf16_f32 v115, v118, v119
 v_mfma_f32_16x16x32_bf16 v[76:79], a[196:199], v[136:139], v[76:79]
 s_barrier
 ds_read_b64_tr_b16 a[222:223], v47 offset:30720
 v_mul_f32 v72, v72, v64
 v_mfma_f32_16x16x32_bf16 v[76:79], a[200:203], v[144:147], v[76:79]
 s_waitcnt lgkmcnt(4)
 ds_read_b64_tr_b16 a[160:161], v44 offset:32768
 v_mul_f32 v73, v73, v64
 v_mfma_f32_16x16x32_bf16 v[76:79], a[204:207], v[152:155], v[76:79]
 ds_read_b64_tr_b16 a[162:163], v44 offset:34816
 v_mul_f32 v74, v74, v64
 v_mfma_f32_16x16x32_bf16 v[76:79], a[208:211], v[160:163], v[76:79]
 s_add_u32 m0, s29, 94208
 ds_read_b64_tr_b16 a[164:165], v44 offset:36864
 v_mul_f32 v75, v75, v64
 v_mfma_f32_16x16x32_bf16 v[76:79], a[212:215], v[168:171], v[76:79]
 s_waitcnt lgkmcnt(3)
 ds_read_b64_tr_b16 a[166:167], v44 offset:38912
 buffer_load_dwordx4 v2, s[8:11], s85 offen lds
 v_mfma_f32_16x16x32_bf16 v[76:79], a[216:219], v[176:179], v[76:79]
 s_add_u32 s58, s48, 1009664
 ds_read_b64_tr_b16 a[168:169], v44 offset:40960
 v_add_u32 v2, 128, v2
 v_mfma_f32_16x16x32_bf16 v[76:79], a[220:223], v[184:187], v[76:79]
 ds_read_b64_tr_b16 a[170:171], v44 offset:43008
 buffer_store_dwordx4 v[112:115], v1, s[12:15], s58 offen sc1
 v_mfma_f32_16x16x32_bf16 v[84:87], a[192:195], v[192:195], 0
 ds_read_b64_tr_b16 a[172:173], v44 offset:45056
 v_mul_f32 v80, v80, v65
 v_mfma_f32_16x16x32_bf16 v[84:87], a[196:199], v[200:203], v[84:87]
 ds_read_b64_tr_b16 a[174:175], v44 offset:47104
 v_mul_f32 v81, v81, v65
 v_mfma_f32_16x16x32_bf16 v[84:87], a[200:203], v[208:211], v[84:87]
 ds_read_b64_tr_b16 a[176:177], v44 offset:49152
 v_mul_f32 v82, v82, v65
 v_mfma_f32_16x16x32_bf16 v[84:87], a[204:207], v[216:219], v[84:87]
 ds_read_b64_tr_b16 a[178:179], v44 offset:51200
 v_mul_f32 v83, v83, v65
 v_mfma_f32_16x16x32_bf16 v[84:87], a[208:211], v[224:227], v[84:87]
 ds_read_b64_tr_b16 a[180:181], v44 offset:53248
 v_mul_f32 v76, v76, v64
 v_mfma_f32_16x16x32_bf16 v[84:87], a[212:215], v[232:235], v[84:87]
 ds_read_b64_tr_b16 a[182:183], v44 offset:55296
 v_mul_f32 v77, v77, v64
 v_mfma_f32_16x16x32_bf16 v[84:87], a[216:219], v[240:243], v[84:87]
 ds_read_b64_tr_b16 a[184:185], v44 offset:57344
 v_mul_f32 v78, v78, v64
 v_mfma_f32_16x16x32_bf16 v[84:87], a[220:223], v[248:251], v[84:87]
 s_waitcnt lgkmcnt(7)
 ds_read_b64_tr_b16 a[186:187], v44 offset:59392
 v_mul_f32 v79, v79, v64
 v_mfma_f32_16x16x32_bf16 v[88:91], a[160:163], v[128:131], 0
 ds_read_b64_tr_b16 a[188:189], v44 offset:61440
 v_cvt_pk_bf16_f32 v72, v72, v73
 v_mfma_f32_16x16x32_bf16 v[88:91], a[164:167], v[136:139], v[88:91]
 ds_read_b64_tr_b16 a[190:191], v44 offset:63488
 v_cvt_pk_bf16_f32 v73, v74, v75
 v_mfma_f32_16x16x32_bf16 v[88:91], a[168:171], v[144:147], v[88:91]
 s_waitcnt lgkmcnt(4)
 ds_read_b64_tr_b16 a[192:193], v45 offset:32768
 v_cvt_pk_bf16_f32 v74, v76, v77
 v_mfma_f32_16x16x32_bf16 v[88:91], a[172:175], v[152:155], v[88:91]
 s_add_u32 m0, s29, 98304
 ds_read_b64_tr_b16 a[194:195], v45 offset:34816
 v_cvt_pk_bf16_f32 v75, v78, v79
 v_mfma_f32_16x16x32_bf16 v[88:91], a[176:179], v[160:163], v[88:91]
 ds_read_b64_tr_b16 a[196:197], v45 offset:36864
 buffer_load_dwordx4 v2, s[8:11], s78 offen lds
 v_mfma_f32_16x16x32_bf16 v[88:91], a[180:183], v[168:171], v[88:91]
 s_waitcnt lgkmcnt(3)
 ds_read_b64_tr_b16 a[198:199], v45 offset:38912
 v_mul_f32 v84, v84, v65
 v_mfma_f32_16x16x32_bf16 v[88:91], a[184:187], v[176:179], v[88:91]
 s_add_u32 s58, s48, 52224
 ds_read_b64_tr_b16 a[200:201], v45 offset:40960
 v_mul_f32 v85, v85, v65
 v_mfma_f32_16x16x32_bf16 v[88:91], a[188:191], v[184:187], v[88:91]
 ds_read_b64_tr_b16 a[202:203], v45 offset:43008
 buffer_store_dwordx4 v[72:75], v1, s[12:15], s58 offen sc1
 v_mfma_f32_16x16x32_bf16 v[96:99], a[160:163], v[192:195], 0
 ds_read_b64_tr_b16 a[204:205], v45 offset:45056
 v_mul_f32 v86, v86, v65
 v_mfma_f32_16x16x32_bf16 v[96:99], a[164:167], v[200:203], v[96:99]
 ds_read_b64_tr_b16 a[206:207], v45 offset:47104
 v_mul_f32 v87, v87, v65
 v_mfma_f32_16x16x32_bf16 v[96:99], a[168:171], v[208:211], v[96:99]
 s_add_u32 m0, s29, 102400
 ds_read_b64_tr_b16 a[208:209], v45 offset:49152
 v_cvt_pk_bf16_f32 v80, v80, v81
 v_mfma_f32_16x16x32_bf16 v[96:99], a[172:175], v[216:219], v[96:99]
 ds_read_b64_tr_b16 a[210:211], v45 offset:51200
 buffer_load_dwordx4 v2, s[8:11], s79 offen lds
 v_mfma_f32_16x16x32_bf16 v[96:99], a[176:179], v[224:227], v[96:99]
 ds_read_b64_tr_b16 a[212:213], v45 offset:53248
 v_cvt_pk_bf16_f32 v81, v82, v83
 v_mfma_f32_16x16x32_bf16 v[96:99], a[180:183], v[232:235], v[96:99]
 ds_read_b64_tr_b16 a[214:215], v45 offset:55296
 v_cvt_pk_bf16_f32 v82, v84, v85
 v_mfma_f32_16x16x32_bf16 v[96:99], a[184:187], v[240:243], v[96:99]
 s_add_u32 s58, s48, 1027072
 ds_read_b64_tr_b16 a[216:217], v45 offset:57344
 v_cvt_pk_bf16_f32 v83, v86, v87
 v_mfma_f32_16x16x32_bf16 v[96:99], a[188:191], v[248:251], v[96:99]
 s_waitcnt lgkmcnt(7)
 ds_read_b64_tr_b16 a[218:219], v45 offset:59392
 buffer_store_dwordx4 v[80:83], v1, s[12:15], s58 offen sc1
 v_mfma_f32_16x16x32_bf16 v[92:95], a[192:195], v[128:131], 0
 ds_read_b64_tr_b16 a[220:221], v45 offset:61440
 v_mul_f32 v88, v88, v64
 v_mfma_f32_16x16x32_bf16 v[92:95], a[196:199], v[136:139], v[92:95]
 s_add_u32 m0, s29, 106496
 ds_read_b64_tr_b16 a[222:223], v45 offset:63488
 v_mul_f32 v89, v89, v64
 v_mfma_f32_16x16x32_bf16 v[92:95], a[200:203], v[144:147], v[92:95]
 s_waitcnt lgkmcnt(4)
 ds_read_b64_tr_b16 a[160:161], v46 offset:32768
 buffer_load_dwordx4 v2, s[8:11], s80 offen lds
 v_mfma_f32_16x16x32_bf16 v[92:95], a[204:207], v[152:155], v[92:95]
 ds_read_b64_tr_b16 a[162:163], v46 offset:34816
 v_mul_f32 v90, v90, v64
 v_mfma_f32_16x16x32_bf16 v[92:95], a[208:211], v[160:163], v[92:95]
 ds_read_b64_tr_b16 a[164:165], v46 offset:36864
 v_mul_f32 v91, v91, v64
 v_mfma_f32_16x16x32_bf16 v[92:95], a[212:215], v[168:171], v[92:95]
 s_waitcnt lgkmcnt(3)
 ds_read_b64_tr_b16 a[166:167], v46 offset:38912
 v_mul_f32 v96, v96, v65
 v_mfma_f32_16x16x32_bf16 v[92:95], a[216:219], v[176:179], v[92:95]
 ds_read_b64_tr_b16 a[168:169], v46 offset:40960
 v_mul_f32 v97, v97, v65
 v_mfma_f32_16x16x32_bf16 v[92:95], a[220:223], v[184:187], v[92:95]
 ds_read_b64_tr_b16 a[170:171], v46 offset:43008
 v_mul_f32 v98, v98, v65
 v_mfma_f32_16x16x32_bf16 v[100:103], a[192:195], v[192:195], 0
 s_add_u32 m0, s29, 110592
 ds_read_b64_tr_b16 a[172:173], v46 offset:45056
 v_mul_f32 v99, v99, v65
 v_mfma_f32_16x16x32_bf16 v[100:103], a[196:199], v[200:203], v[100:103]
 ds_read_b64_tr_b16 a[174:175], v46 offset:47104
 buffer_load_dwordx4 v2, s[8:11], s81 offen lds
 v_mfma_f32_16x16x32_bf16 v[100:103], a[200:203], v[208:211], v[100:103]
 ds_read_b64_tr_b16 a[176:177], v46 offset:49152
 v_mfma_f32_16x16x32_bf16 v[100:103], a[204:207], v[216:219], v[100:103]
 ds_read_b64_tr_b16 a[178:179], v46 offset:51200
 v_mfma_f32_16x16x32_bf16 v[100:103], a[208:211], v[224:227], v[100:103]
 ds_read_b64_tr_b16 a[180:181], v46 offset:53248
 v_mul_f32 v92, v92, v64
 v_mfma_f32_16x16x32_bf16 v[100:103], a[212:215], v[232:235], v[100:103]
 ds_read_b64_tr_b16 a[182:183], v46 offset:55296
 v_mul_f32 v93, v93, v64
 v_mfma_f32_16x16x32_bf16 v[100:103], a[216:219], v[240:243], v[100:103]
 s_add_u32 m0, s29, 114688
 ds_read_b64_tr_b16 a[184:185], v46 offset:57344
 v_mul_f32 v94, v94, v64
 v_mfma_f32_16x16x32_bf16 v[100:103], a[220:223], v[248:251], v[100:103]
 s_waitcnt lgkmcnt(7)
 ds_read_b64_tr_b16 a[186:187], v46 offset:59392
 v_mul_f32 v95, v95, v64
 v_mfma_f32_16x16x32_bf16 v[104:107], a[160:163], v[128:131], 0
 ds_read_b64_tr_b16 a[188:189], v46 offset:61440
 buffer_load_dwordx4 v2, s[8:11], s82 offen lds
 v_mfma_f32_16x16x32_bf16 v[104:107], a[164:167], v[136:139], v[104:107]
 ds_read_b64_tr_b16 a[190:191], v46 offset:63488
 v_cvt_pk_bf16_f32 v88, v88, v89
 v_mfma_f32_16x16x32_bf16 v[104:107], a[168:171], v[144:147], v[104:107]
 s_waitcnt lgkmcnt(4)
 ds_read_b64_tr_b16 a[192:193], v47 offset:32768
 v_cvt_pk_bf16_f32 v89, v90, v91
 v_mfma_f32_16x16x32_bf16 v[104:107], a[172:175], v[152:155], v[104:107]
 ds_read_b64_tr_b16 a[194:195], v47 offset:34816
 v_cvt_pk_bf16_f32 v90, v92, v93
 v_mfma_f32_16x16x32_bf16 v[104:107], a[176:179], v[160:163], v[104:107]
 s_add_u32 s58, s48, 69632
 ds_read_b64_tr_b16 a[196:197], v47 offset:36864
 v_cvt_pk_bf16_f32 v91, v94, v95
 v_mfma_f32_16x16x32_bf16 v[104:107], a[180:183], v[168:171], v[104:107]
 s_waitcnt lgkmcnt(3)
 ds_read_b64_tr_b16 a[198:199], v47 offset:38912
 buffer_store_dwordx4 v[88:91], v1, s[12:15], s58 offen sc1
 v_mfma_f32_16x16x32_bf16 v[104:107], a[184:187], v[176:179], v[104:107]
 s_add_u32 m0, s29, 118784
 ds_read_b64_tr_b16 a[200:201], v47 offset:40960
 v_mul_f32 v100, v100, v65
 v_mfma_f32_16x16x32_bf16 v[104:107], a[188:191], v[184:187], v[104:107]
 ds_read_b64_tr_b16 a[202:203], v47 offset:43008
 buffer_load_dwordx4 v2, s[8:11], s83 offen lds
 v_mfma_f32_16x16x32_bf16 v[112:115], a[160:163], v[192:195], 0
 ds_read_b64_tr_b16 a[204:205], v47 offset:45056
 v_mul_f32 v101, v101, v65
 v_mfma_f32_16x16x32_bf16 v[112:115], a[164:167], v[200:203], v[112:115]
 ds_read_b64_tr_b16 a[206:207], v47 offset:47104
 v_mul_f32 v102, v102, v65
 v_mfma_f32_16x16x32_bf16 v[112:115], a[168:171], v[208:211], v[112:115]
 ds_read_b64_tr_b16 a[208:209], v47 offset:49152
 v_mul_f32 v103, v103, v65
 v_mfma_f32_16x16x32_bf16 v[112:115], a[172:175], v[216:219], v[112:115]
 ds_read_b64_tr_b16 a[210:211], v47 offset:51200
 v_cvt_pk_bf16_f32 v96, v96, v97
 v_mfma_f32_16x16x32_bf16 v[112:115], a[176:179], v[224:227], v[112:115]
 ds_read_b64_tr_b16 a[212:213], v47 offset:53248
 v_cvt_pk_bf16_f32 v97, v98, v99
 v_mfma_f32_16x16x32_bf16 v[112:115], a[180:183], v[232:235], v[112:115]
 s_add_u32 m0, s29, 122880
 ds_read_b64_tr_b16 a[214:215], v47 offset:55296
 v_cvt_pk_bf16_f32 v98, v100, v101
 v_mfma_f32_16x16x32_bf16 v[112:115], a[184:187], v[240:243], v[112:115]
 ds_read_b64_tr_b16 a[216:217], v47 offset:57344
 buffer_load_dwordx4 v2, s[8:11], s84 offen lds
 v_mfma_f32_16x16x32_bf16 v[112:115], a[188:191], v[248:251], v[112:115]
 s_waitcnt lgkmcnt(7)
 ds_read_b64_tr_b16 a[218:219], v47 offset:59392
 v_cvt_pk_bf16_f32 v99, v102, v103
 v_mfma_f32_16x16x32_bf16 v[108:111], a[192:195], v[128:131], 0
 s_waitcnt vmcnt(11)
 ds_read_b64_tr_b16 a[220:221], v47 offset:61440
 v_mul_f32 v104, v104, v64
 v_mfma_f32_16x16x32_bf16 v[108:111], a[196:199], v[136:139], v[108:111]
 s_barrier
 ds_read_b64_tr_b16 a[222:223], v47 offset:63488
 v_xor_b32 v44, 0x10000, v44
 v_mfma_f32_16x16x32_bf16 v[108:111], a[200:203], v[144:147], v[108:111]
 s_waitcnt lgkmcnt(4)
 ds_read_b64_tr_b16 a[160:161], v44 offset:0
 v_mul_f32 v105, v105, v64
 v_mfma_f32_16x16x32_bf16 v[108:111], a[204:207], v[152:155], v[108:111]
 ds_read_b64_tr_b16 a[162:163], v44 offset:2048
 v_mul_f32 v106, v106, v64
 v_mfma_f32_16x16x32_bf16 v[108:111], a[208:211], v[160:163], v[108:111]
 s_add_u32 m0, s29, 126976
 ds_read_b64_tr_b16 a[164:165], v44 offset:4096
 v_mul_f32 v107, v107, v64
 v_mfma_f32_16x16x32_bf16 v[108:111], a[212:215], v[168:171], v[108:111]
 s_waitcnt lgkmcnt(3)
 ds_read_b64_tr_b16 a[166:167], v44 offset:6144
 buffer_load_dwordx4 v2, s[8:11], s85 offen lds
 v_mfma_f32_16x16x32_bf16 v[108:111], a[216:219], v[176:179], v[108:111]
 s_add_u32 s58, s48, 1044480
 ds_read_b64_tr_b16 a[168:169], v44 offset:8192
 v_add_u32 v2, 128, v2
 v_mfma_f32_16x16x32_bf16 v[108:111], a[220:223], v[184:187], v[108:111]
 ds_read_b64_tr_b16 a[170:171], v44 offset:10240
 buffer_store_dwordx4 v[96:99], v1, s[12:15], s58 offen sc1
 v_mfma_f32_16x16x32_bf16 v[116:119], a[192:195], v[192:195], 0
 ds_read_b64_tr_b16 a[172:173], v44 offset:12288
 v_mul_f32 v112, v112, v65
 v_mfma_f32_16x16x32_bf16 v[116:119], a[196:199], v[200:203], v[116:119]
 ds_read_b64_tr_b16 a[174:175], v44 offset:14336
 v_mul_f32 v113, v113, v65
 v_mfma_f32_16x16x32_bf16 v[116:119], a[200:203], v[208:211], v[116:119]
 ds_read_b64_tr_b16 a[176:177], v44 offset:16384
 v_mul_f32 v114, v114, v65
 v_mfma_f32_16x16x32_bf16 v[116:119], a[204:207], v[216:219], v[116:119]
 ds_read_b64_tr_b16 a[178:179], v44 offset:18432
 v_mul_f32 v115, v115, v65
 v_mfma_f32_16x16x32_bf16 v[116:119], a[208:211], v[224:227], v[116:119]
 ds_read_b64_tr_b16 a[180:181], v44 offset:20480
 v_mul_f32 v108, v108, v64
 v_mfma_f32_16x16x32_bf16 v[116:119], a[212:215], v[232:235], v[116:119]
 ds_read_b64_tr_b16 a[182:183], v44 offset:22528
 v_mul_f32 v109, v109, v64
 v_mfma_f32_16x16x32_bf16 v[116:119], a[216:219], v[240:243], v[116:119]
 ds_read_b64_tr_b16 a[184:185], v44 offset:24576
 v_mul_f32 v110, v110, v64
 v_mfma_f32_16x16x32_bf16 v[116:119], a[220:223], v[248:251], v[116:119]
 s_waitcnt lgkmcnt(7)
 ds_read_b64_tr_b16 a[186:187], v44 offset:26624
 v_mul_f32 v111, v111, v64
 v_mfma_f32_16x16x32_bf16 v[72:75], a[160:163], v[128:131], 0
 ds_read_b64_tr_b16 a[188:189], v44 offset:28672
 v_cvt_pk_bf16_f32 v104, v104, v105
 v_mfma_f32_16x16x32_bf16 v[72:75], a[164:167], v[136:139], v[72:75]
 ds_read_b64_tr_b16 a[190:191], v44 offset:30720
 v_xor_b32 v45, 0x10000, v45
 v_mfma_f32_16x16x32_bf16 v[72:75], a[168:171], v[144:147], v[72:75]
 s_waitcnt lgkmcnt(4)
 ds_read_b64_tr_b16 a[192:193], v45 offset:0
 v_cvt_pk_bf16_f32 v105, v106, v107
 v_mfma_f32_16x16x32_bf16 v[72:75], a[172:175], v[152:155], v[72:75]
 s_add_u32 m0, s29, 131072
 ds_read_b64_tr_b16 a[194:195], v45 offset:2048
 v_cvt_pk_bf16_f32 v106, v108, v109
 v_mfma_f32_16x16x32_bf16 v[72:75], a[176:179], v[160:163], v[72:75]
 ds_read_b64_tr_b16 a[196:197], v45 offset:4096
 buffer_load_dwordx4 v2, s[8:11], s78 offen lds
 v_mfma_f32_16x16x32_bf16 v[72:75], a[180:183], v[168:171], v[72:75]
 s_waitcnt lgkmcnt(3)
 ds_read_b64_tr_b16 a[198:199], v45 offset:6144
 v_cvt_pk_bf16_f32 v107, v110, v111
 v_mfma_f32_16x16x32_bf16 v[72:75], a[184:187], v[176:179], v[72:75]
 s_add_u32 s58, s48, 87040
 ds_read_b64_tr_b16 a[200:201], v45 offset:8192
 v_mul_f32 v116, v116, v65
 v_mfma_f32_16x16x32_bf16 v[72:75], a[188:191], v[184:187], v[72:75]
 ds_read_b64_tr_b16 a[202:203], v45 offset:10240
 buffer_store_dwordx4 v[104:107], v1, s[12:15], s58 offen sc1
 v_mfma_f32_16x16x32_bf16 v[80:83], a[160:163], v[192:195], 0
 ds_read_b64_tr_b16 a[204:205], v45 offset:12288
 v_mul_f32 v117, v117, v65
 v_mfma_f32_16x16x32_bf16 v[80:83], a[164:167], v[200:203], v[80:83]
 ds_read_b64_tr_b16 a[206:207], v45 offset:14336
 v_mul_f32 v118, v118, v65
 v_mfma_f32_16x16x32_bf16 v[80:83], a[168:171], v[208:211], v[80:83]
 s_add_u32 m0, s29, 135168
 ds_read_b64_tr_b16 a[208:209], v45 offset:16384
 v_mul_f32 v119, v119, v65
 v_mfma_f32_16x16x32_bf16 v[80:83], a[172:175], v[216:219], v[80:83]
 ds_read_b64_tr_b16 a[210:211], v45 offset:18432
 buffer_load_dwordx4 v2, s[8:11], s79 offen lds
 v_mfma_f32_16x16x32_bf16 v[80:83], a[176:179], v[224:227], v[80:83]
 ds_read_b64_tr_b16 a[212:213], v45 offset:20480
 v_cvt_pk_bf16_f32 v112, v112, v113
 v_mfma_f32_16x16x32_bf16 v[80:83], a[180:183], v[232:235], v[80:83]
 ds_read_b64_tr_b16 a[214:215], v45 offset:22528
 v_cvt_pk_bf16_f32 v113, v114, v115
 v_mfma_f32_16x16x32_bf16 v[80:83], a[184:187], v[240:243], v[80:83]
 s_add_u32 s58, s48, 1061888
 ds_read_b64_tr_b16 a[216:217], v45 offset:24576
 v_cvt_pk_bf16_f32 v114, v116, v117
 v_mfma_f32_16x16x32_bf16 v[80:83], a[188:191], v[248:251], v[80:83]
 s_waitcnt lgkmcnt(7)
 ds_read_b64_tr_b16 a[218:219], v45 offset:26624
 v_cvt_pk_bf16_f32 v115, v118, v119
 v_mfma_f32_16x16x32_bf16 v[76:79], a[192:195], v[128:131], 0
 ds_read_b64_tr_b16 a[220:221], v45 offset:28672
 buffer_store_dwordx4 v[112:115], v1, s[12:15], s58 offen sc1
 v_mfma_f32_16x16x32_bf16 v[76:79], a[196:199], v[136:139], v[76:79]
 s_add_u32 m0, s29, 139264
 ds_read_b64_tr_b16 a[222:223], v45 offset:30720
 v_xor_b32 v46, 0x10000, v46
 v_mfma_f32_16x16x32_bf16 v[76:79], a[200:203], v[144:147], v[76:79]
 s_waitcnt lgkmcnt(4)
 ds_read_b64_tr_b16 a[160:161], v46 offset:0
 buffer_load_dwordx4 v2, s[8:11], s80 offen lds
 v_mfma_f32_16x16x32_bf16 v[76:79], a[204:207], v[152:155], v[76:79]
 ds_read_b64_tr_b16 a[162:163], v46 offset:2048
 v_mul_f32 v72, v72, v64
 v_mfma_f32_16x16x32_bf16 v[76:79], a[208:211], v[160:163], v[76:79]
 ds_read_b64_tr_b16 a[164:165], v46 offset:4096
 v_mul_f32 v73, v73, v64
 v_mfma_f32_16x16x32_bf16 v[76:79], a[212:215], v[168:171], v[76:79]
 s_waitcnt lgkmcnt(3)
 ds_read_b64_tr_b16 a[166:167], v46 offset:6144
 v_mul_f32 v74, v74, v64
 v_mfma_f32_16x16x32_bf16 v[76:79], a[216:219], v[176:179], v[76:79]
 ds_read_b64_tr_b16 a[168:169], v46 offset:8192
 v_mul_f32 v75, v75, v64
 v_mfma_f32_16x16x32_bf16 v[76:79], a[220:223], v[184:187], v[76:79]
 ds_read_b64_tr_b16 a[170:171], v46 offset:10240
 v_mul_f32 v80, v80, v65
 v_mfma_f32_16x16x32_bf16 v[84:87], a[192:195], v[192:195], 0
 s_add_u32 m0, s29, 143360
 ds_read_b64_tr_b16 a[172:173], v46 offset:12288
 v_mul_f32 v81, v81, v65
 v_mfma_f32_16x16x32_bf16 v[84:87], a[196:199], v[200:203], v[84:87]
 ds_read_b64_tr_b16 a[174:175], v46 offset:14336
 buffer_load_dwordx4 v2, s[8:11], s81 offen lds
 v_mfma_f32_16x16x32_bf16 v[84:87], a[200:203], v[208:211], v[84:87]
 ds_read_b64_tr_b16 a[176:177], v46 offset:16384
 v_mul_f32 v82, v82, v65
 v_mfma_f32_16x16x32_bf16 v[84:87], a[204:207], v[216:219], v[84:87]
 ds_read_b64_tr_b16 a[178:179], v46 offset:18432
 v_mul_f32 v83, v83, v65
 v_mfma_f32_16x16x32_bf16 v[84:87], a[208:211], v[224:227], v[84:87]
 ds_read_b64_tr_b16 a[180:181], v46 offset:20480
 v_mul_f32 v76, v76, v64
 v_mfma_f32_16x16x32_bf16 v[84:87], a[212:215], v[232:235], v[84:87]
 ds_read_b64_tr_b16 a[182:183], v46 offset:22528
 v_mul_f32 v77, v77, v64
 v_mfma_f32_16x16x32_bf16 v[84:87], a[216:219], v[240:243], v[84:87]
 s_add_u32 m0, s29, 147456
 ds_read_b64_tr_b16 a[184:185], v46 offset:24576
 v_mul_f32 v78, v78, v64
 v_mfma_f32_16x16x32_bf16 v[84:87], a[220:223], v[248:251], v[84:87]
 s_waitcnt lgkmcnt(7)
 ds_read_b64_tr_b16 a[186:187], v46 offset:26624
 v_mul_f32 v79, v79, v64
 v_mfma_f32_16x16x32_bf16 v[88:91], a[160:163], v[128:131], 0
 ds_read_b64_tr_b16 a[188:189], v46 offset:28672
 buffer_load_dwordx4 v2, s[8:11], s82 offen lds
 v_mfma_f32_16x16x32_bf16 v[88:91], a[164:167], v[136:139], v[88:91]
 ds_read_b64_tr_b16 a[190:191], v46 offset:30720
 v_xor_b32 v47, 0x10000, v47
 v_mfma_f32_16x16x32_bf16 v[88:91], a[168:171], v[144:147], v[88:91]
 s_waitcnt lgkmcnt(4)
 ds_read_b64_tr_b16 a[192:193], v47 offset:0
 v_cvt_pk_bf16_f32 v72, v72, v73
 v_mfma_f32_16x16x32_bf16 v[88:91], a[172:175], v[152:155], v[88:91]
 ds_read_b64_tr_b16 a[194:195], v47 offset:2048
 v_cvt_pk_bf16_f32 v73, v74, v75
 v_mfma_f32_16x16x32_bf16 v[88:91], a[176:179], v[160:163], v[88:91]
 ds_read_b64_tr_b16 a[196:197], v47 offset:4096
 v_cvt_pk_bf16_f32 v74, v76, v77
 v_mfma_f32_16x16x32_bf16 v[88:91], a[180:183], v[168:171], v[88:91]
 s_waitcnt lgkmcnt(3)
 ds_read_b64_tr_b16 a[198:199], v47 offset:6144
 v_cvt_pk_bf16_f32 v75, v78, v79
 v_mfma_f32_16x16x32_bf16 v[88:91], a[184:187], v[176:179], v[88:91]
 s_add_u32 m0, s29, 151552
 ds_read_b64_tr_b16 a[200:201], v47 offset:8192
 v_mul_f32 v84, v84, v65
 v_mfma_f32_16x16x32_bf16 v[88:91], a[188:191], v[184:187], v[88:91]
 ds_read_b64_tr_b16 a[202:203], v47 offset:10240
 buffer_load_dwordx4 v2, s[8:11], s83 offen lds
 v_mfma_f32_16x16x32_bf16 v[96:99], a[160:163], v[192:195], 0
 s_add_u32 s58, s48, 104448
 ds_read_b64_tr_b16 a[204:205], v47 offset:12288
 v_mul_f32 v85, v85, v65
 v_mfma_f32_16x16x32_bf16 v[96:99], a[164:167], v[200:203], v[96:99]
 ds_read_b64_tr_b16 a[206:207], v47 offset:14336
 buffer_store_dwordx4 v[72:75], v1, s[12:15], s58 offen sc1
 v_mfma_f32_16x16x32_bf16 v[96:99], a[168:171], v[208:211], v[96:99]
 ds_read_b64_tr_b16 a[208:209], v47 offset:16384
 v_mul_f32 v86, v86, v65
 v_mfma_f32_16x16x32_bf16 v[96:99], a[172:175], v[216:219], v[96:99]
 ds_read_b64_tr_b16 a[210:211], v47 offset:18432
 v_mul_f32 v87, v87, v65
 v_mfma_f32_16x16x32_bf16 v[96:99], a[176:179], v[224:227], v[96:99]
 ds_read_b64_tr_b16 a[212:213], v47 offset:20480
 v_cvt_pk_bf16_f32 v80, v80, v81
 v_mfma_f32_16x16x32_bf16 v[96:99], a[180:183], v[232:235], v[96:99]
 s_add_u32 m0, s29, 155648
 ds_read_b64_tr_b16 a[214:215], v47 offset:22528
 v_cvt_pk_bf16_f32 v81, v82, v83
 v_mfma_f32_16x16x32_bf16 v[96:99], a[184:187], v[240:243], v[96:99]
 ds_read_b64_tr_b16 a[216:217], v47 offset:24576
 buffer_load_dwordx4 v2, s[8:11], s84 offen lds
 v_mfma_f32_16x16x32_bf16 v[96:99], a[188:191], v[248:251], v[96:99]
 s_waitcnt lgkmcnt(7)
 ds_read_b64_tr_b16 a[218:219], v47 offset:26624
 v_cvt_pk_bf16_f32 v82, v84, v85
 v_mfma_f32_16x16x32_bf16 v[92:95], a[192:195], v[128:131], 0
 s_waitcnt vmcnt(11)
 ds_read_b64_tr_b16 a[220:221], v47 offset:28672
 v_cvt_pk_bf16_f32 v83, v86, v87
 v_mfma_f32_16x16x32_bf16 v[92:95], a[196:199], v[136:139], v[92:95]
 s_barrier
 ds_read_b64_tr_b16 a[222:223], v47 offset:30720
 v_mul_f32 v88, v88, v64
 v_mfma_f32_16x16x32_bf16 v[92:95], a[200:203], v[144:147], v[92:95]
 s_waitcnt lgkmcnt(4)
 ds_read_b64_tr_b16 a[160:161], v44 offset:32768
 v_mul_f32 v89, v89, v64
 v_mfma_f32_16x16x32_bf16 v[92:95], a[204:207], v[152:155], v[92:95]
 ds_read_b64_tr_b16 a[162:163], v44 offset:34816
 v_mul_f32 v90, v90, v64
 v_mfma_f32_16x16x32_bf16 v[92:95], a[208:211], v[160:163], v[92:95]
 s_add_u32 m0, s29, 159744
 ds_read_b64_tr_b16 a[164:165], v44 offset:36864
 v_mul_f32 v91, v91, v64
 v_mfma_f32_16x16x32_bf16 v[92:95], a[212:215], v[168:171], v[92:95]
 s_waitcnt lgkmcnt(3)
 ds_read_b64_tr_b16 a[166:167], v44 offset:38912
 buffer_load_dwordx4 v2, s[8:11], s85 offen lds
 v_mfma_f32_16x16x32_bf16 v[92:95], a[216:219], v[176:179], v[92:95]
 s_add_u32 s58, s48, 1079296
 ds_read_b64_tr_b16 a[168:169], v44 offset:40960
 v_add_u32 v2, 128, v2
 v_mfma_f32_16x16x32_bf16 v[92:95], a[220:223], v[184:187], v[92:95]
 ds_read_b64_tr_b16 a[170:171], v44 offset:43008
 buffer_store_dwordx4 v[80:83], v1, s[12:15], s58 offen sc1
 v_mfma_f32_16x16x32_bf16 v[100:103], a[192:195], v[192:195], 0
 ds_read_b64_tr_b16 a[172:173], v44 offset:45056
 v_mul_f32 v96, v96, v65
 v_mfma_f32_16x16x32_bf16 v[100:103], a[196:199], v[200:203], v[100:103]
 ds_read_b64_tr_b16 a[174:175], v44 offset:47104
 v_mul_f32 v97, v97, v65
 v_mfma_f32_16x16x32_bf16 v[100:103], a[200:203], v[208:211], v[100:103]
 ds_read_b64_tr_b16 a[176:177], v44 offset:49152
 v_mul_f32 v98, v98, v65
 v_mfma_f32_16x16x32_bf16 v[100:103], a[204:207], v[216:219], v[100:103]
 ds_read_b64_tr_b16 a[178:179], v44 offset:51200
 v_mul_f32 v99, v99, v65
 v_mfma_f32_16x16x32_bf16 v[100:103], a[208:211], v[224:227], v[100:103]
 ds_read_b64_tr_b16 a[180:181], v44 offset:53248
 v_mul_f32 v92, v92, v64
 v_mfma_f32_16x16x32_bf16 v[100:103], a[212:215], v[232:235], v[100:103]
 ds_read_b64_tr_b16 a[182:183], v44 offset:55296
 v_mul_f32 v93, v93, v64
 v_mfma_f32_16x16x32_bf16 v[100:103], a[216:219], v[240:243], v[100:103]
 ds_read_b64_tr_b16 a[184:185], v44 offset:57344
 v_mul_f32 v94, v94, v64
 v_mfma_f32_16x16x32_bf16 v[100:103], a[220:223], v[248:251], v[100:103]
 s_waitcnt lgkmcnt(7)
 ds_read_b64_tr_b16 a[186:187], v44 offset:59392
 v_mul_f32 v95, v95, v64
 v_mfma_f32_16x16x32_bf16 v[104:107], a[160:163], v[128:131], 0
 ds_read_b64_tr_b16 a[188:189], v44 offset:61440
 v_cvt_pk_bf16_f32 v88, v88, v89
 v_mfma_f32_16x16x32_bf16 v[104:107], a[164:167], v[136:139], v[104:107]
 ds_read_b64_tr_b16 a[190:191], v44 offset:63488
 v_cvt_pk_bf16_f32 v89, v90, v91
 v_mfma_f32_16x16x32_bf16 v[104:107], a[168:171], v[144:147], v[104:107]
 s_waitcnt lgkmcnt(4)
 ds_read_b64_tr_b16 a[192:193], v45 offset:32768
 v_cvt_pk_bf16_f32 v90, v92, v93
 v_mfma_f32_16x16x32_bf16 v[104:107], a[172:175], v[152:155], v[104:107]
 s_add_u32 m0, s29, 0
 ds_read_b64_tr_b16 a[194:195], v45 offset:34816
 v_cvt_pk_bf16_f32 v91, v94, v95
 v_mfma_f32_16x16x32_bf16 v[104:107], a[176:179], v[160:163], v[104:107]
 ds_read_b64_tr_b16 a[196:197], v45 offset:36864
 buffer_load_dwordx4 v2, s[8:11], s78 offen lds
 v_mfma_f32_16x16x32_bf16 v[104:107], a[180:183], v[168:171], v[104:107]
 s_waitcnt lgkmcnt(3)
 ds_read_b64_tr_b16 a[198:199], v45 offset:38912
 v_mul_f32 v100, v100, v65
 v_mfma_f32_16x16x32_bf16 v[104:107], a[184:187], v[176:179], v[104:107]
 s_add_u32 s58, s48, 121856
 ds_read_b64_tr_b16 a[200:201], v45 offset:40960
 v_mul_f32 v101, v101, v65
 v_mfma_f32_16x16x32_bf16 v[104:107], a[188:191], v[184:187], v[104:107]
 ds_read_b64_tr_b16 a[202:203], v45 offset:43008
 buffer_store_dwordx4 v[88:91], v1, s[12:15], s58 offen sc1
 v_mfma_f32_16x16x32_bf16 v[112:115], a[160:163], v[192:195], 0
 ds_read_b64_tr_b16 a[204:205], v45 offset:45056
 v_mul_f32 v102, v102, v65
 v_mfma_f32_16x16x32_bf16 v[112:115], a[164:167], v[200:203], v[112:115]
 ds_read_b64_tr_b16 a[206:207], v45 offset:47104
 v_mul_f32 v103, v103, v65
 v_mfma_f32_16x16x32_bf16 v[112:115], a[168:171], v[208:211], v[112:115]
 s_add_u32 m0, s29, 4096
 ds_read_b64_tr_b16 a[208:209], v45 offset:49152
 v_cvt_pk_bf16_f32 v96, v96, v97
 v_mfma_f32_16x16x32_bf16 v[112:115], a[172:175], v[216:219], v[112:115]
 ds_read_b64_tr_b16 a[210:211], v45 offset:51200
 buffer_load_dwordx4 v2, s[8:11], s79 offen lds
 v_mfma_f32_16x16x32_bf16 v[112:115], a[176:179], v[224:227], v[112:115]
 ds_read_b64_tr_b16 a[212:213], v45 offset:53248
 v_cvt_pk_bf16_f32 v97, v98, v99
 v_mfma_f32_16x16x32_bf16 v[112:115], a[180:183], v[232:235], v[112:115]
 ds_read_b64_tr_b16 a[214:215], v45 offset:55296
 v_cvt_pk_bf16_f32 v98, v100, v101
 v_mfma_f32_16x16x32_bf16 v[112:115], a[184:187], v[240:243], v[112:115]
 s_add_u32 s58, s48, 1096704
 ds_read_b64_tr_b16 a[216:217], v45 offset:57344
 v_cvt_pk_bf16_f32 v99, v102, v103
 v_mfma_f32_16x16x32_bf16 v[112:115], a[188:191], v[248:251], v[112:115]
 s_waitcnt lgkmcnt(7)
 ds_read_b64_tr_b16 a[218:219], v45 offset:59392
 buffer_store_dwordx4 v[96:99], v1, s[12:15], s58 offen sc1
 v_mfma_f32_16x16x32_bf16 v[108:111], a[192:195], v[128:131], 0
 ds_read_b64_tr_b16 a[220:221], v45 offset:61440
 v_mul_f32 v104, v104, v64
 v_mfma_f32_16x16x32_bf16 v[108:111], a[196:199], v[136:139], v[108:111]
 s_add_u32 m0, s29, 8192
 ds_read_b64_tr_b16 a[222:223], v45 offset:63488
 v_mul_f32 v105, v105, v64
 v_mfma_f32_16x16x32_bf16 v[108:111], a[200:203], v[144:147], v[108:111]
 s_waitcnt lgkmcnt(4)
 ds_read_b64_tr_b16 a[160:161], v46 offset:32768
 buffer_load_dwordx4 v2, s[8:11], s80 offen lds
 v_mfma_f32_16x16x32_bf16 v[108:111], a[204:207], v[152:155], v[108:111]
 ds_read_b64_tr_b16 a[162:163], v46 offset:34816
 v_mul_f32 v106, v106, v64
 v_mfma_f32_16x16x32_bf16 v[108:111], a[208:211], v[160:163], v[108:111]
 ds_read_b64_tr_b16 a[164:165], v46 offset:36864
 v_mul_f32 v107, v107, v64
 v_mfma_f32_16x16x32_bf16 v[108:111], a[212:215], v[168:171], v[108:111]
 s_waitcnt lgkmcnt(3)
 ds_read_b64_tr_b16 a[166:167], v46 offset:38912
 v_mul_f32 v112, v112, v65
 v_mfma_f32_16x16x32_bf16 v[108:111], a[216:219], v[176:179], v[108:111]
 ds_read_b64_tr_b16 a[168:169], v46 offset:40960
 v_mul_f32 v113, v113, v65
 v_mfma_f32_16x16x32_bf16 v[108:111], a[220:223], v[184:187], v[108:111]
 ds_read_b64_tr_b16 a[170:171], v46 offset:43008
 v_mul_f32 v114, v114, v65
 v_mfma_f32_16x16x32_bf16 v[116:119], a[192:195], v[192:195], 0
 s_add_u32 m0, s29, 12288
 ds_read_b64_tr_b16 a[172:173], v46 offset:45056
 v_mul_f32 v115, v115, v65
 v_mfma_f32_16x16x32_bf16 v[116:119], a[196:199], v[200:203], v[116:119]
 ds_read_b64_tr_b16 a[174:175], v46 offset:47104
 buffer_load_dwordx4 v2, s[8:11], s81 offen lds
 v_mfma_f32_16x16x32_bf16 v[116:119], a[200:203], v[208:211], v[116:119]
 ds_read_b64_tr_b16 a[176:177], v46 offset:49152
 v_mfma_f32_16x16x32_bf16 v[116:119], a[204:207], v[216:219], v[116:119]
 ds_read_b64_tr_b16 a[178:179], v46 offset:51200
 v_mfma_f32_16x16x32_bf16 v[116:119], a[208:211], v[224:227], v[116:119]
 ds_read_b64_tr_b16 a[180:181], v46 offset:53248
 v_mul_f32 v108, v108, v64
 v_mfma_f32_16x16x32_bf16 v[116:119], a[212:215], v[232:235], v[116:119]
 ds_read_b64_tr_b16 a[182:183], v46 offset:55296
 v_mul_f32 v109, v109, v64
 v_mfma_f32_16x16x32_bf16 v[116:119], a[216:219], v[240:243], v[116:119]
 s_add_u32 m0, s29, 16384
 ds_read_b64_tr_b16 a[184:185], v46 offset:57344
 v_mul_f32 v110, v110, v64
 v_mfma_f32_16x16x32_bf16 v[116:119], a[220:223], v[248:251], v[116:119]
 s_waitcnt lgkmcnt(7)
 ds_read_b64_tr_b16 a[186:187], v46 offset:59392
 v_mul_f32 v111, v111, v64
 v_mfma_f32_16x16x32_bf16 v[72:75], a[160:163], v[128:131], 0
 ds_read_b64_tr_b16 a[188:189], v46 offset:61440
 buffer_load_dwordx4 v2, s[8:11], s82 offen lds
 v_mfma_f32_16x16x32_bf16 v[72:75], a[164:167], v[136:139], v[72:75]
 ds_read_b64_tr_b16 a[190:191], v46 offset:63488
 v_cvt_pk_bf16_f32 v104, v104, v105
 v_mfma_f32_16x16x32_bf16 v[72:75], a[168:171], v[144:147], v[72:75]
 s_waitcnt lgkmcnt(4)
 ds_read_b64_tr_b16 a[192:193], v47 offset:32768
 v_cvt_pk_bf16_f32 v105, v106, v107
 v_mfma_f32_16x16x32_bf16 v[72:75], a[172:175], v[152:155], v[72:75]
 ds_read_b64_tr_b16 a[194:195], v47 offset:34816
 v_cvt_pk_bf16_f32 v106, v108, v109
 v_mfma_f32_16x16x32_bf16 v[72:75], a[176:179], v[160:163], v[72:75]
 s_add_u32 s58, s48, 139264
 ds_read_b64_tr_b16 a[196:197], v47 offset:36864
 v_cvt_pk_bf16_f32 v107, v110, v111
 v_mfma_f32_16x16x32_bf16 v[72:75], a[180:183], v[168:171], v[72:75]
 s_waitcnt lgkmcnt(3)
 ds_read_b64_tr_b16 a[198:199], v47 offset:38912
 buffer_store_dwordx4 v[104:107], v1, s[12:15], s58 offen sc1
 v_mfma_f32_16x16x32_bf16 v[72:75], a[184:187], v[176:179], v[72:75]
 s_add_u32 m0, s29, 20480
 ds_read_b64_tr_b16 a[200:201], v47 offset:40960
 v_mul_f32 v116, v116, v65
 v_mfma_f32_16x16x32_bf16 v[72:75], a[188:191], v[184:187], v[72:75]
 ds_read_b64_tr_b16 a[202:203], v47 offset:43008
 buffer_load_dwordx4 v2, s[8:11], s83 offen lds
 v_mfma_f32_16x16x32_bf16 v[80:83], a[160:163], v[192:195], 0
 ds_read_b64_tr_b16 a[204:205], v47 offset:45056
 v_mul_f32 v117, v117, v65
 v_mfma_f32_16x16x32_bf16 v[80:83], a[164:167], v[200:203], v[80:83]
 ds_read_b64_tr_b16 a[206:207], v47 offset:47104
 v_mul_f32 v118, v118, v65
 v_mfma_f32_16x16x32_bf16 v[80:83], a[168:171], v[208:211], v[80:83]
 ds_read_b64_tr_b16 a[208:209], v47 offset:49152
 v_mul_f32 v119, v119, v65
 v_mfma_f32_16x16x32_bf16 v[80:83], a[172:175], v[216:219], v[80:83]
 ds_read_b64_tr_b16 a[210:211], v47 offset:51200
 v_cvt_pk_bf16_f32 v112, v112, v113
 v_mfma_f32_16x16x32_bf16 v[80:83], a[176:179], v[224:227], v[80:83]
 ds_read_b64_tr_b16 a[212:213], v47 offset:53248
 v_cvt_pk_bf16_f32 v113, v114, v115
 v_mfma_f32_16x16x32_bf16 v[80:83], a[180:183], v[232:235], v[80:83]
 s_add_u32 m0, s29, 24576
 ds_read_b64_tr_b16 a[214:215], v47 offset:55296
 v_cvt_pk_bf16_f32 v114, v116, v117
 v_mfma_f32_16x16x32_bf16 v[80:83], a[184:187], v[240:243], v[80:83]
 ds_read_b64_tr_b16 a[216:217], v47 offset:57344
 buffer_load_dwordx4 v2, s[8:11], s84 offen lds
 v_mfma_f32_16x16x32_bf16 v[80:83], a[188:191], v[248:251], v[80:83]
 s_waitcnt lgkmcnt(7)
 ds_read_b64_tr_b16 a[218:219], v47 offset:59392
 v_cvt_pk_bf16_f32 v115, v118, v119
 v_mfma_f32_16x16x32_bf16 v[76:79], a[192:195], v[128:131], 0
 s_waitcnt vmcnt(10)
 ds_read_b64_tr_b16 a[220:221], v47 offset:61440
 v_mul_f32 v72, v72, v64
 v_mfma_f32_16x16x32_bf16 v[76:79], a[196:199], v[136:139], v[76:79]
 s_barrier
 ds_read_b64_tr_b16 a[222:223], v47 offset:63488
 v_xor_b32 v44, 0x30000, v44
 v_mfma_f32_16x16x32_bf16 v[76:79], a[200:203], v[144:147], v[76:79]
 s_waitcnt lgkmcnt(4)
 ds_read_b64_tr_b16 a[160:161], v44 offset:0
 buffer_store_dword v9, v9, s[12:15], s93 offen offset:64 sc1
 v_mfma_f32_16x16x32_bf16 v[76:79], a[204:207], v[152:155], v[76:79]
 ds_read_b64_tr_b16 a[162:163], v44 offset:2048
 v_mul_f32 v73, v73, v64
 v_mfma_f32_16x16x32_bf16 v[76:79], a[208:211], v[160:163], v[76:79]
 s_add_u32 m0, s29, 28672
 ds_read_b64_tr_b16 a[164:165], v44 offset:4096
 v_mul_f32 v74, v74, v64
 v_mfma_f32_16x16x32_bf16 v[76:79], a[212:215], v[168:171], v[76:79]
 s_waitcnt lgkmcnt(3)
 ds_read_b64_tr_b16 a[166:167], v44 offset:6144
 buffer_load_dwordx4 v2, s[8:11], s85 offen lds
 v_mfma_f32_16x16x32_bf16 v[76:79], a[216:219], v[176:179], v[76:79]
 s_add_u32 s58, s48, 1114112
 ds_read_b64_tr_b16 a[168:169], v44 offset:8192
 v_add_u32 v2, 128, v2
 v_mfma_f32_16x16x32_bf16 v[76:79], a[220:223], v[184:187], v[76:79]
 ds_read_b64_tr_b16 a[170:171], v44 offset:10240
 buffer_store_dwordx4 v[112:115], v1, s[12:15], s58 offen sc1
 v_mfma_f32_16x16x32_bf16 v[84:87], a[192:195], v[192:195], 0
 ds_read_b64_tr_b16 a[172:173], v44 offset:12288
 v_mul_f32 v75, v75, v64
 v_mfma_f32_16x16x32_bf16 v[84:87], a[196:199], v[200:203], v[84:87]
 ds_read_b64_tr_b16 a[174:175], v44 offset:14336
 v_mul_f32 v80, v80, v65
 v_mfma_f32_16x16x32_bf16 v[84:87], a[200:203], v[208:211], v[84:87]
 ds_read_b64_tr_b16 a[176:177], v44 offset:16384
 v_mul_f32 v81, v81, v65
 v_mfma_f32_16x16x32_bf16 v[84:87], a[204:207], v[216:219], v[84:87]
 ds_read_b64_tr_b16 a[178:179], v44 offset:18432
 v_mul_f32 v82, v82, v65
 v_mfma_f32_16x16x32_bf16 v[84:87], a[208:211], v[224:227], v[84:87]
 ds_read_b64_tr_b16 a[180:181], v44 offset:20480
 v_mul_f32 v76, v76, v64
 v_mfma_f32_16x16x32_bf16 v[84:87], a[212:215], v[232:235], v[84:87]
 ds_read_b64_tr_b16 a[182:183], v44 offset:22528
 v_mul_f32 v77, v77, v64
 v_mfma_f32_16x16x32_bf16 v[84:87], a[216:219], v[240:243], v[84:87]
 ds_read_b64_tr_b16 a[184:185], v44 offset:24576
 v_mul_f32 v78, v78, v64
 v_mfma_f32_16x16x32_bf16 v[84:87], a[220:223], v[248:251], v[84:87]
 s_waitcnt lgkmcnt(7)
 ds_read_b64_tr_b16 a[186:187], v44 offset:26624
 v_mul_f32 v79, v79, v64
 v_mfma_f32_16x16x32_bf16 v[88:91], a[160:163], v[128:131], 0
 ds_read_b64_tr_b16 a[188:189], v44 offset:28672
 v_cvt_pk_bf16_f32 v72, v72, v73
 v_mfma_f32_16x16x32_bf16 v[88:91], a[164:167], v[136:139], v[88:91]
 ds_read_b64_tr_b16 a[190:191], v44 offset:30720
 v_xor_b32 v45, 0x30000, v45
 v_mfma_f32_16x16x32_bf16 v[88:91], a[168:171], v[144:147], v[88:91]
 s_waitcnt lgkmcnt(4)
 ds_read_b64_tr_b16 a[192:193], v45 offset:0
 v_cvt_pk_bf16_f32 v73, v74, v75
 v_mfma_f32_16x16x32_bf16 v[88:91], a[172:175], v[152:155], v[88:91]
 ds_read_b64_tr_b16 a[194:195], v45 offset:2048
 v_cvt_pk_bf16_f32 v74, v76, v77
 v_mfma_f32_16x16x32_bf16 v[88:91], a[176:179], v[160:163], v[88:91]
 s_add_u32 s58, s48, 156672
 ds_read_b64_tr_b16 a[196:197], v45 offset:4096
 v_cvt_pk_bf16_f32 v75, v78, v79
 v_mfma_f32_16x16x32_bf16 v[88:91], a[180:183], v[168:171], v[88:91]
 s_waitcnt lgkmcnt(3)
 ds_read_b64_tr_b16 a[198:199], v45 offset:6144
 buffer_store_dwordx4 v[72:75], v1, s[12:15], s58 offen sc1
 v_mfma_f32_16x16x32_bf16 v[88:91], a[184:187], v[176:179], v[88:91]
 ds_read_b64_tr_b16 a[200:201], v45 offset:8192
 v_mul_f32 v83, v83, v65
 v_mfma_f32_16x16x32_bf16 v[88:91], a[188:191], v[184:187], v[88:91]
 ds_read_b64_tr_b16 a[202:203], v45 offset:10240
 v_mul_f32 v84, v84, v65
 v_mfma_f32_16x16x32_bf16 v[96:99], a[160:163], v[192:195], 0
 ds_read_b64_tr_b16 a[204:205], v45 offset:12288
 v_mul_f32 v85, v85, v65
 v_mfma_f32_16x16x32_bf16 v[96:99], a[164:167], v[200:203], v[96:99]
 ds_read_b64_tr_b16 a[206:207], v45 offset:14336
 v_mul_f32 v86, v86, v65
 v_mfma_f32_16x16x32_bf16 v[96:99], a[168:171], v[208:211], v[96:99]
 ds_read_b64_tr_b16 a[208:209], v45 offset:16384
 v_mul_f32 v87, v87, v65
 v_mfma_f32_16x16x32_bf16 v[96:99], a[172:175], v[216:219], v[96:99]
 ds_read_b64_tr_b16 a[210:211], v45 offset:18432
 v_cvt_pk_bf16_f32 v80, v80, v81
 v_mfma_f32_16x16x32_bf16 v[96:99], a[176:179], v[224:227], v[96:99]
 ds_read_b64_tr_b16 a[212:213], v45 offset:20480
 v_cvt_pk_bf16_f32 v81, v82, v83
 v_mfma_f32_16x16x32_bf16 v[96:99], a[180:183], v[232:235], v[96:99]
 ds_read_b64_tr_b16 a[214:215], v45 offset:22528
 v_cvt_pk_bf16_f32 v82, v84, v85
 v_mfma_f32_16x16x32_bf16 v[96:99], a[184:187], v[240:243], v[96:99]
 s_add_u32 s58, s48, 1131520
 ds_read_b64_tr_b16 a[216:217], v45 offset:24576
 v_cvt_pk_bf16_f32 v83, v86, v87
 v_mfma_f32_16x16x32_bf16 v[96:99], a[188:191], v[248:251], v[96:99]
 s_waitcnt lgkmcnt(7)
 ds_read_b64_tr_b16 a[218:219], v45 offset:26624
 buffer_store_dwordx4 v[80:83], v1, s[12:15], s58 offen sc1
 v_mfma_f32_16x16x32_bf16 v[92:95], a[192:195], v[128:131], 0
 ds_read_b64_tr_b16 a[220:221], v45 offset:28672
 v_mul_f32 v88, v88, v64
 v_mfma_f32_16x16x32_bf16 v[92:95], a[196:199], v[136:139], v[92:95]
 ds_read_b64_tr_b16 a[222:223], v45 offset:30720
 v_xor_b32 v46, 0x30000, v46
 v_mfma_f32_16x16x32_bf16 v[92:95], a[200:203], v[144:147], v[92:95]
 s_waitcnt lgkmcnt(4)
 ds_read_b64_tr_b16 a[160:161], v46 offset:0
 v_mul_f32 v89, v89, v64
 v_mfma_f32_16x16x32_bf16 v[92:95], a[204:207], v[152:155], v[92:95]
 ds_read_b64_tr_b16 a[162:163], v46 offset:2048
 v_mul_f32 v90, v90, v64
 v_mfma_f32_16x16x32_bf16 v[92:95], a[208:211], v[160:163], v[92:95]
 ds_read_b64_tr_b16 a[164:165], v46 offset:4096
 v_mul_f32 v91, v91, v64
 v_mfma_f32_16x16x32_bf16 v[92:95], a[212:215], v[168:171], v[92:95]
 s_waitcnt lgkmcnt(3)
 ds_read_b64_tr_b16 a[166:167], v46 offset:6144
 v_mul_f32 v96, v96, v65
 v_mfma_f32_16x16x32_bf16 v[92:95], a[216:219], v[176:179], v[92:95]
 ds_read_b64_tr_b16 a[168:169], v46 offset:8192
 v_mul_f32 v97, v97, v65
 v_mfma_f32_16x16x32_bf16 v[92:95], a[220:223], v[184:187], v[92:95]
 ds_read_b64_tr_b16 a[170:171], v46 offset:10240
 v_mul_f32 v98, v98, v65
 v_mfma_f32_16x16x32_bf16 v[100:103], a[192:195], v[192:195], 0
 ds_read_b64_tr_b16 a[172:173], v46 offset:12288
 v_mul_f32 v99, v99, v65
 v_mfma_f32_16x16x32_bf16 v[100:103], a[196:199], v[200:203], v[100:103]
 ds_read_b64_tr_b16 a[174:175], v46 offset:14336
 v_mfma_f32_16x16x32_bf16 v[100:103], a[200:203], v[208:211], v[100:103]
 ds_read_b64_tr_b16 a[176:177], v46 offset:16384
 v_mfma_f32_16x16x32_bf16 v[100:103], a[204:207], v[216:219], v[100:103]
 ds_read_b64_tr_b16 a[178:179], v46 offset:18432
 v_mfma_f32_16x16x32_bf16 v[100:103], a[208:211], v[224:227], v[100:103]
 ds_read_b64_tr_b16 a[180:181], v46 offset:20480
 v_mul_f32 v92, v92, v64
 v_mfma_f32_16x16x32_bf16 v[100:103], a[212:215], v[232:235], v[100:103]
 ds_read_b64_tr_b16 a[182:183], v46 offset:22528
 v_mul_f32 v93, v93, v64
 v_mfma_f32_16x16x32_bf16 v[100:103], a[216:219], v[240:243], v[100:103]
 ds_read_b64_tr_b16 a[184:185], v46 offset:24576
 v_mul_f32 v94, v94, v64
 v_mfma_f32_16x16x32_bf16 v[100:103], a[220:223], v[248:251], v[100:103]
 s_waitcnt lgkmcnt(7)
 ds_read_b64_tr_b16 a[186:187], v46 offset:26624
 v_mul_f32 v95, v95, v64
 v_mfma_f32_16x16x32_bf16 v[104:107], a[160:163], v[128:131], 0
 ds_read_b64_tr_b16 a[188:189], v46 offset:28672
 v_cvt_pk_bf16_f32 v88, v88, v89
 v_mfma_f32_16x16x32_bf16 v[104:107], a[164:167], v[136:139], v[104:107]
 ds_read_b64_tr_b16 a[190:191], v46 offset:30720
 v_xor_b32 v47, 0x30000, v47
 v_mfma_f32_16x16x32_bf16 v[104:107], a[168:171], v[144:147], v[104:107]
 s_waitcnt lgkmcnt(4)
 ds_read_b64_tr_b16 a[192:193], v47 offset:0
 v_cvt_pk_bf16_f32 v89, v90, v91
 v_mfma_f32_16x16x32_bf16 v[104:107], a[172:175], v[152:155], v[104:107]
 ds_read_b64_tr_b16 a[194:195], v47 offset:2048
 v_cvt_pk_bf16_f32 v90, v92, v93
 v_mfma_f32_16x16x32_bf16 v[104:107], a[176:179], v[160:163], v[104:107]
 s_add_u32 s58, s48, 174080
 ds_read_b64_tr_b16 a[196:197], v47 offset:4096
 v_cvt_pk_bf16_f32 v91, v94, v95
 v_mfma_f32_16x16x32_bf16 v[104:107], a[180:183], v[168:171], v[104:107]
 s_waitcnt lgkmcnt(3)
 ds_read_b64_tr_b16 a[198:199], v47 offset:6144
 buffer_store_dwordx4 v[88:91], v1, s[12:15], s58 offen sc1
 v_mfma_f32_16x16x32_bf16 v[104:107], a[184:187], v[176:179], v[104:107]
 ds_read_b64_tr_b16 a[200:201], v47 offset:8192
 v_mul_f32 v100, v100, v65
 v_mfma_f32_16x16x32_bf16 v[104:107], a[188:191], v[184:187], v[104:107]
 ds_read_b64_tr_b16 a[202:203], v47 offset:10240
 v_mul_f32 v101, v101, v65
 v_mfma_f32_16x16x32_bf16 v[112:115], a[160:163], v[192:195], 0
 ds_read_b64_tr_b16 a[204:205], v47 offset:12288
 v_mul_f32 v102, v102, v65
 v_mfma_f32_16x16x32_bf16 v[112:115], a[164:167], v[200:203], v[112:115]
 ds_read_b64_tr_b16 a[206:207], v47 offset:14336
 v_mul_f32 v103, v103, v65
 v_mfma_f32_16x16x32_bf16 v[112:115], a[168:171], v[208:211], v[112:115]
 ds_read_b64_tr_b16 a[208:209], v47 offset:16384
 v_cvt_pk_bf16_f32 v96, v96, v97
 v_mfma_f32_16x16x32_bf16 v[112:115], a[172:175], v[216:219], v[112:115]
 ds_read_b64_tr_b16 a[210:211], v47 offset:18432
 v_cvt_pk_bf16_f32 v97, v98, v99
 v_mfma_f32_16x16x32_bf16 v[112:115], a[176:179], v[224:227], v[112:115]
 ds_read_b64_tr_b16 a[212:213], v47 offset:20480
 v_cvt_pk_bf16_f32 v98, v100, v101
 v_mfma_f32_16x16x32_bf16 v[112:115], a[180:183], v[232:235], v[112:115]
 s_add_u32 s58, s48, 1148928
 ds_read_b64_tr_b16 a[214:215], v47 offset:22528
 v_cvt_pk_bf16_f32 v99, v102, v103
 v_mfma_f32_16x16x32_bf16 v[112:115], a[184:187], v[240:243], v[112:115]
 ds_read_b64_tr_b16 a[216:217], v47 offset:24576
 buffer_store_dwordx4 v[96:99], v1, s[12:15], s58 offen sc1
 v_mfma_f32_16x16x32_bf16 v[112:115], a[188:191], v[248:251], v[112:115]
 s_waitcnt lgkmcnt(7)
 ds_read_b64_tr_b16 a[218:219], v47 offset:26624
 v_mul_f32 v104, v104, v64
 v_mfma_f32_16x16x32_bf16 v[108:111], a[192:195], v[128:131], 0
 s_waitcnt vmcnt(5)
 ds_read_b64_tr_b16 a[220:221], v47 offset:28672
 v_mul_f32 v105, v105, v64
 v_mfma_f32_16x16x32_bf16 v[108:111], a[196:199], v[136:139], v[108:111]
 s_barrier
 ds_read_b64_tr_b16 a[222:223], v47 offset:30720
 v_xor_b32 v44, 0x20000, v44
 v_mfma_f32_16x16x32_bf16 v[108:111], a[200:203], v[144:147], v[108:111]
 s_waitcnt lgkmcnt(4)
 ds_read_b64_tr_b16 a[160:161], v44 offset:0
 v_mul_f32 v106, v106, v64
 v_mfma_f32_16x16x32_bf16 v[108:111], a[204:207], v[152:155], v[108:111]
 ds_read_b64_tr_b16 a[162:163], v44 offset:2048
 v_mul_f32 v107, v107, v64
 v_mfma_f32_16x16x32_bf16 v[108:111], a[208:211], v[160:163], v[108:111]
 ds_read_b64_tr_b16 a[164:165], v44 offset:4096
 v_mul_f32 v112, v112, v65
 v_mfma_f32_16x16x32_bf16 v[108:111], a[212:215], v[168:171], v[108:111]
 s_waitcnt lgkmcnt(3)
 ds_read_b64_tr_b16 a[166:167], v44 offset:6144
 v_mul_f32 v113, v113, v65
 v_mfma_f32_16x16x32_bf16 v[108:111], a[216:219], v[176:179], v[108:111]
 ds_read_b64_tr_b16 a[168:169], v44 offset:8192
 v_mul_f32 v114, v114, v65
 v_mfma_f32_16x16x32_bf16 v[108:111], a[220:223], v[184:187], v[108:111]
 ds_read_b64_tr_b16 a[170:171], v44 offset:10240
 v_mul_f32 v115, v115, v65
 v_mfma_f32_16x16x32_bf16 v[116:119], a[192:195], v[192:195], 0
 ds_read_b64_tr_b16 a[172:173], v44 offset:12288
 v_mfma_f32_16x16x32_bf16 v[116:119], a[196:199], v[200:203], v[116:119]
 ds_read_b64_tr_b16 a[174:175], v44 offset:14336
 v_mfma_f32_16x16x32_bf16 v[116:119], a[200:203], v[208:211], v[116:119]
 ds_read_b64_tr_b16 a[176:177], v44 offset:16384
 v_mfma_f32_16x16x32_bf16 v[116:119], a[204:207], v[216:219], v[116:119]
 ds_read_b64_tr_b16 a[178:179], v44 offset:18432
 v_mfma_f32_16x16x32_bf16 v[116:119], a[208:211], v[224:227], v[116:119]
 ds_read_b64_tr_b16 a[180:181], v44 offset:20480
 v_mul_f32 v108, v108, v64
 v_mfma_f32_16x16x32_bf16 v[116:119], a[212:215], v[232:235], v[116:119]
 ds_read_b64_tr_b16 a[182:183], v44 offset:22528
 v_mul_f32 v109, v109, v64
 v_mfma_f32_16x16x32_bf16 v[116:119], a[216:219], v[240:243], v[116:119]
 ds_read_b64_tr_b16 a[184:185], v44 offset:24576
 v_mul_f32 v110, v110, v64
 v_mfma_f32_16x16x32_bf16 v[116:119], a[220:223], v[248:251], v[116:119]
 s_waitcnt lgkmcnt(7)
 ds_read_b64_tr_b16 a[186:187], v44 offset:26624
 v_mul_f32 v111, v111, v64
 v_mfma_f32_16x16x32_bf16 v[72:75], a[160:163], v[128:131], 0
 ds_read_b64_tr_b16 a[188:189], v44 offset:28672
 v_cvt_pk_bf16_f32 v104, v104, v105
 v_mfma_f32_16x16x32_bf16 v[72:75], a[164:167], v[136:139], v[72:75]
 ds_read_b64_tr_b16 a[190:191], v44 offset:30720
 v_xor_b32 v45, 0x20000, v45
 v_mfma_f32_16x16x32_bf16 v[72:75], a[168:171], v[144:147], v[72:75]
 s_waitcnt lgkmcnt(4)
 ds_read_b64_tr_b16 a[192:193], v45 offset:0
 v_cvt_pk_bf16_f32 v105, v106, v107
 v_mfma_f32_16x16x32_bf16 v[72:75], a[172:175], v[152:155], v[72:75]
 ds_read_b64_tr_b16 a[194:195], v45 offset:2048
 v_cvt_pk_bf16_f32 v106, v108, v109
 v_mfma_f32_16x16x32_bf16 v[72:75], a[176:179], v[160:163], v[72:75]
 s_add_u32 s58, s48, 191488
 ds_read_b64_tr_b16 a[196:197], v45 offset:4096
 v_cvt_pk_bf16_f32 v107, v110, v111
 v_mfma_f32_16x16x32_bf16 v[72:75], a[180:183], v[168:171], v[72:75]
 s_waitcnt lgkmcnt(3)
 ds_read_b64_tr_b16 a[198:199], v45 offset:6144
 buffer_store_dwordx4 v[104:107], v1, s[12:15], s58 offen sc1
 v_mfma_f32_16x16x32_bf16 v[72:75], a[184:187], v[176:179], v[72:75]
 ds_read_b64_tr_b16 a[200:201], v45 offset:8192
 v_mul_f32 v116, v116, v65
 v_mfma_f32_16x16x32_bf16 v[72:75], a[188:191], v[184:187], v[72:75]
 ds_read_b64_tr_b16 a[202:203], v45 offset:10240
 v_mul_f32 v117, v117, v65
 v_mfma_f32_16x16x32_bf16 v[80:83], a[160:163], v[192:195], 0
 ds_read_b64_tr_b16 a[204:205], v45 offset:12288
 v_mul_f32 v118, v118, v65
 v_mfma_f32_16x16x32_bf16 v[80:83], a[164:167], v[200:203], v[80:83]
 ds_read_b64_tr_b16 a[206:207], v45 offset:14336
 v_mul_f32 v119, v119, v65
 v_mfma_f32_16x16x32_bf16 v[80:83], a[168:171], v[208:211], v[80:83]
 ds_read_b64_tr_b16 a[208:209], v45 offset:16384
 v_cvt_pk_bf16_f32 v112, v112, v113
 v_mfma_f32_16x16x32_bf16 v[80:83], a[172:175], v[216:219], v[80:83]
 ds_read_b64_tr_b16 a[210:211], v45 offset:18432
 v_cvt_pk_bf16_f32 v113, v114, v115
 v_mfma_f32_16x16x32_bf16 v[80:83], a[176:179], v[224:227], v[80:83]
 ds_read_b64_tr_b16 a[212:213], v45 offset:20480
 v_cvt_pk_bf16_f32 v114, v116, v117
 v_mfma_f32_16x16x32_bf16 v[80:83], a[180:183], v[232:235], v[80:83]
 s_add_u32 s58, s48, 1166336
 ds_read_b64_tr_b16 a[214:215], v45 offset:22528
 v_cvt_pk_bf16_f32 v115, v118, v119
 v_mfma_f32_16x16x32_bf16 v[80:83], a[184:187], v[240:243], v[80:83]
 ds_read_b64_tr_b16 a[216:217], v45 offset:24576
 buffer_store_dwordx4 v[112:115], v1, s[12:15], s58 offen sc1
 v_mfma_f32_16x16x32_bf16 v[80:83], a[188:191], v[248:251], v[80:83]
 s_waitcnt lgkmcnt(7)
 ds_read_b64_tr_b16 a[218:219], v45 offset:26624
 v_mul_f32 v72, v72, v64
 v_mfma_f32_16x16x32_bf16 v[76:79], a[192:195], v[128:131], 0
 ds_read_b64_tr_b16 a[220:221], v45 offset:28672
 v_mul_f32 v73, v73, v64
 v_mfma_f32_16x16x32_bf16 v[76:79], a[196:199], v[136:139], v[76:79]
 ds_read_b64_tr_b16 a[222:223], v45 offset:30720
 v_xor_b32 v46, 0x20000, v46
 v_mfma_f32_16x16x32_bf16 v[76:79], a[200:203], v[144:147], v[76:79]
 s_waitcnt lgkmcnt(4)
 ds_read_b64_tr_b16 a[160:161], v46 offset:0
 v_mul_f32 v74, v74, v64
 v_mfma_f32_16x16x32_bf16 v[76:79], a[204:207], v[152:155], v[76:79]
 ds_read_b64_tr_b16 a[162:163], v46 offset:2048
 v_mul_f32 v75, v75, v64
 v_mfma_f32_16x16x32_bf16 v[76:79], a[208:211], v[160:163], v[76:79]
 ds_read_b64_tr_b16 a[164:165], v46 offset:4096
 v_mul_f32 v80, v80, v65
 v_mfma_f32_16x16x32_bf16 v[76:79], a[212:215], v[168:171], v[76:79]
 s_waitcnt lgkmcnt(3)
 ds_read_b64_tr_b16 a[166:167], v46 offset:6144
 v_mul_f32 v81, v81, v65
 v_mfma_f32_16x16x32_bf16 v[76:79], a[216:219], v[176:179], v[76:79]
 ds_read_b64_tr_b16 a[168:169], v46 offset:8192
 v_mul_f32 v82, v82, v65
 v_mfma_f32_16x16x32_bf16 v[76:79], a[220:223], v[184:187], v[76:79]
 ds_read_b64_tr_b16 a[170:171], v46 offset:10240
 v_mul_f32 v83, v83, v65
 v_mfma_f32_16x16x32_bf16 v[84:87], a[192:195], v[192:195], 0
 ds_read_b64_tr_b16 a[172:173], v46 offset:12288
 v_mfma_f32_16x16x32_bf16 v[84:87], a[196:199], v[200:203], v[84:87]
 ds_read_b64_tr_b16 a[174:175], v46 offset:14336
 v_mfma_f32_16x16x32_bf16 v[84:87], a[200:203], v[208:211], v[84:87]
 ds_read_b64_tr_b16 a[176:177], v46 offset:16384
 v_mfma_f32_16x16x32_bf16 v[84:87], a[204:207], v[216:219], v[84:87]
 ds_read_b64_tr_b16 a[178:179], v46 offset:18432
 v_mfma_f32_16x16x32_bf16 v[84:87], a[208:211], v[224:227], v[84:87]
 ds_read_b64_tr_b16 a[180:181], v46 offset:20480
 v_mul_f32 v76, v76, v64
 v_mfma_f32_16x16x32_bf16 v[84:87], a[212:215], v[232:235], v[84:87]
 ds_read_b64_tr_b16 a[182:183], v46 offset:22528
 v_mul_f32 v77, v77, v64
 v_mfma_f32_16x16x32_bf16 v[84:87], a[216:219], v[240:243], v[84:87]
 ds_read_b64_tr_b16 a[184:185], v46 offset:24576
 v_mul_f32 v78, v78, v64
 v_mfma_f32_16x16x32_bf16 v[84:87], a[220:223], v[248:251], v[84:87]
 s_waitcnt lgkmcnt(7)
 ds_read_b64_tr_b16 a[186:187], v46 offset:26624
 v_mul_f32 v79, v79, v64
 v_mfma_f32_16x16x32_bf16 v[88:91], a[160:163], v[128:131], 0
 ds_read_b64_tr_b16 a[188:189], v46 offset:28672
 v_cvt_pk_bf16_f32 v72, v72, v73
 v_mfma_f32_16x16x32_bf16 v[88:91], a[164:167], v[136:139], v[88:91]
 ds_read_b64_tr_b16 a[190:191], v46 offset:30720
 v_xor_b32 v47, 0x20000, v47
 v_mfma_f32_16x16x32_bf16 v[88:91], a[168:171], v[144:147], v[88:91]
 s_waitcnt lgkmcnt(4)
 ds_read_b64_tr_b16 a[192:193], v47 offset:0
 v_cvt_pk_bf16_f32 v73, v74, v75
 v_mfma_f32_16x16x32_bf16 v[88:91], a[172:175], v[152:155], v[88:91]
 ds_read_b64_tr_b16 a[194:195], v47 offset:2048
 v_cvt_pk_bf16_f32 v74, v76, v77
 v_mfma_f32_16x16x32_bf16 v[88:91], a[176:179], v[160:163], v[88:91]
 s_add_u32 s58, s48, 208896
 ds_read_b64_tr_b16 a[196:197], v47 offset:4096
 v_cvt_pk_bf16_f32 v75, v78, v79
 v_mfma_f32_16x16x32_bf16 v[88:91], a[180:183], v[168:171], v[88:91]
 s_waitcnt lgkmcnt(3)
 ds_read_b64_tr_b16 a[198:199], v47 offset:6144
 buffer_store_dwordx4 v[72:75], v1, s[12:15], s58 offen sc1
 v_mfma_f32_16x16x32_bf16 v[88:91], a[184:187], v[176:179], v[88:91]
 ds_read_b64_tr_b16 a[200:201], v47 offset:8192
 v_mul_f32 v84, v84, v65
 v_mfma_f32_16x16x32_bf16 v[88:91], a[188:191], v[184:187], v[88:91]
 ds_read_b64_tr_b16 a[202:203], v47 offset:10240
 v_mul_f32 v85, v85, v65
 v_mfma_f32_16x16x32_bf16 v[96:99], a[160:163], v[192:195], 0
 ds_read_b64_tr_b16 a[204:205], v47 offset:12288
 v_mul_f32 v86, v86, v65
 v_mfma_f32_16x16x32_bf16 v[96:99], a[164:167], v[200:203], v[96:99]
 ds_read_b64_tr_b16 a[206:207], v47 offset:14336
 v_mul_f32 v87, v87, v65
 v_mfma_f32_16x16x32_bf16 v[96:99], a[168:171], v[208:211], v[96:99]
 ds_read_b64_tr_b16 a[208:209], v47 offset:16384
 v_cvt_pk_bf16_f32 v80, v80, v81
 v_mfma_f32_16x16x32_bf16 v[96:99], a[172:175], v[216:219], v[96:99]
 ds_read_b64_tr_b16 a[210:211], v47 offset:18432
 v_cvt_pk_bf16_f32 v81, v82, v83
 v_mfma_f32_16x16x32_bf16 v[96:99], a[176:179], v[224:227], v[96:99]
 ds_read_b64_tr_b16 a[212:213], v47 offset:20480
 v_cvt_pk_bf16_f32 v82, v84, v85
 v_mfma_f32_16x16x32_bf16 v[96:99], a[180:183], v[232:235], v[96:99]
 s_add_u32 s58, s48, 1183744
 ds_read_b64_tr_b16 a[214:215], v47 offset:22528
 v_cvt_pk_bf16_f32 v83, v86, v87
 v_mfma_f32_16x16x32_bf16 v[96:99], a[184:187], v[240:243], v[96:99]
 ds_read_b64_tr_b16 a[216:217], v47 offset:24576
 buffer_store_dwordx4 v[80:83], v1, s[12:15], s58 offen sc1
 v_mfma_f32_16x16x32_bf16 v[96:99], a[188:191], v[248:251], v[96:99]
 s_waitcnt lgkmcnt(7)
 ds_read_b64_tr_b16 a[218:219], v47 offset:26624
 v_mul_f32 v88, v88, v64
 v_mfma_f32_16x16x32_bf16 v[92:95], a[192:195], v[128:131], 0
 ds_read_b64_tr_b16 a[220:221], v47 offset:28672
 v_mul_f32 v89, v89, v64
 v_mfma_f32_16x16x32_bf16 v[92:95], a[196:199], v[136:139], v[92:95]
 ds_read_b64_tr_b16 a[222:223], v47 offset:30720
 v_mul_f32 v90, v90, v64
 v_mfma_f32_16x16x32_bf16 v[92:95], a[200:203], v[144:147], v[92:95]
 s_waitcnt lgkmcnt(4)
 v_mul_f32 v91, v91, v64
 v_mfma_f32_16x16x32_bf16 v[92:95], a[204:207], v[152:155], v[92:95]
 v_mfma_f32_16x16x32_bf16 v[92:95], a[208:211], v[160:163], v[92:95]
 v_mul_f32 v96, v96, v65
 v_mul_f32 v97, v97, v65
 v_mfma_f32_16x16x32_bf16 v[92:95], a[212:215], v[168:171], v[92:95]
 s_waitcnt lgkmcnt(0)
 v_mul_f32 v98, v98, v65
 v_mul_f32 v99, v99, v65
 v_mfma_f32_16x16x32_bf16 v[92:95], a[216:219], v[176:179], v[92:95]
 v_mfma_f32_16x16x32_bf16 v[92:95], a[220:223], v[184:187], v[92:95]
 v_mfma_f32_16x16x32_bf16 v[100:103], a[192:195], v[192:195], 0
 v_mfma_f32_16x16x32_bf16 v[100:103], a[196:199], v[200:203], v[100:103]
 v_mfma_f32_16x16x32_bf16 v[100:103], a[200:203], v[208:211], v[100:103]
 v_mfma_f32_16x16x32_bf16 v[100:103], a[204:207], v[216:219], v[100:103]
 v_mfma_f32_16x16x32_bf16 v[100:103], a[208:211], v[224:227], v[100:103]
 v_mfma_f32_16x16x32_bf16 v[100:103], a[212:215], v[232:235], v[100:103]
 v_mfma_f32_16x16x32_bf16 v[100:103], a[216:219], v[240:243], v[100:103]
 v_mfma_f32_16x16x32_bf16 v[100:103], a[220:223], v[248:251], v[100:103]
 s_nop 4
 v_mul_f32 v92, v92, v64
 v_mul_f32 v93, v93, v64
 v_mul_f32 v94, v94, v64
 v_mul_f32 v95, v95, v64
 v_cvt_pk_bf16_f32 v88, v88, v89
 v_cvt_pk_bf16_f32 v89, v90, v91
 v_cvt_pk_bf16_f32 v90, v92, v93
 v_cvt_pk_bf16_f32 v91, v94, v95
 s_add_u32 s58, s48, 226304
 buffer_store_dwordx4 v[88:91], v1, s[12:15], s58 offen sc1
 v_mul_f32 v100, v100, v65
 v_mul_f32 v101, v101, v65
 v_mul_f32 v102, v102, v65
 v_mul_f32 v103, v103, v65
 v_cvt_pk_bf16_f32 v96, v96, v97
 v_cvt_pk_bf16_f32 v97, v98, v99
 v_cvt_pk_bf16_f32 v98, v100, v101
 v_cvt_pk_bf16_f32 v99, v102, v103
 s_add_u32 s58, s48, 1201152
 buffer_store_dwordx4 v[96:99], v1, s[12:15], s58 offen sc1
L_nossm:
 s_bfe_u32 s40, s2, 0x20003
 s_lshl_b32 s38, s40, 12
 s_add_u32 s38, s38, 84967424
 v_mov_b32 v12, 1
 buffer_atomic_add v12, v9, s[12:15], s38 offen sc0 sc1
 v_and_b32 v2, 15, v0
 v_lshlrev_b32 v11, 2, v2
 v_mul_u32_u24 v7, 896, v2
 v_lshrrev_b32 v3, 4, v0
 v_lshlrev_b32 v8, 4, v3
 v_lshl_add_u32 v2, v7, 1, v8
 v_add_u32 v7, v7, v8
 v_and_b32 v4, 1, v0
 v_lshlrev_b32 v4, 4, v4
 v_mov_b32 v5, 0x3f80
 v_lshlrev_b32 v4, v4, v5
 v_bfe_u32 v5, v0, 3, 1
 v_bfe_u32 v6, v0, 1, 1
 v_lshl_add_u32 v5, v5, 1, v6
 v_bfe_u32 v6, v0, 2, 1
 v_lshlrev_b32 v6, 1, v6
 v_sub_u32 v6, v3, v6
 v_lshl_add_u32 v5, v6, 2, v5
 v_cmp_eq_u32 s[16:17], 0, v5
 v_cmp_eq_u32 s[18:19], 1, v5
 v_cmp_eq_u32 s[20:21], 2, v5
 v_cmp_eq_u32 s[22:23], 3, v5
 v_cndmask_b32 v24, 0, v4, s[16:17]
 v_cndmask_b32 v25, 0, v4, s[18:19]
 v_cndmask_b32 v26, 0, v4, s[20:21]
 v_cndmask_b32 v27, 0, v4, s[22:23]
 v_cmp_eq_u32 s[16:17], 4, v5
 v_cmp_eq_u32 s[18:19], 5, v5
 v_cmp_eq_u32 s[20:21], 6, v5
 v_cmp_eq_u32 s[22:23], 7, v5
 v_cndmask_b32 v28, 0, v4, s[16:17]
 v_cndmask_b32 v29, 0, v4, s[18:19]
 v_cndmask_b32 v30, 0, v4, s[20:21]
 v_cndmask_b32 v31, 0, v4, s[22:23]
 s_mov_b32 s8, s88
 s_mov_b32 s9, s89
 s_mov_b32 s10, 3670016
 s_mov_b32 s11, 0x20000
 s_mov_b32 s16, s64
 s_mov_b32 s17, s65
 s_mov_b32 s18, 1835008
 s_mov_b32 s19, 0x20000
 s_lshl_b32 s58, s3, 12
 s_add_u32 s58, s58, 0x20000
 s_mov_b32 s59, 0xffff0000
 v_lshrrev_b32 v8, 1, v0
 v_mul_u32_u24 v8, 4096, v8
 v_and_b32 v6, 1, v0
 v_lshl_add_u32 v8, v6, 4, v8
 v_lshlrev_b32 v10, 3, v3
 v_bfe_u32 v6, v0, 2, 2
 v_add_u32 v10, v10, v6
 v_lshlrev_b32 v10, 5, v10
 v_and_b32 v6, 3, v0
 v_lshl_add_u32 v10, v6, 3, v10
 v_add_u32 v10, s58, v10
 v_mov_b32 v5, 0x24000
 v_lshrrev_b32 v4, 2, v0
 v_lshl_add_u32 v11, v6, 4, v4
 v_lshlrev_b32 v11, 2, v11
 v_mul_u32_u24 v7, 896, v4
 v_lshlrev_b32 v6, 4, v6
 v_lshl_add_u32 v3, v7, 1, v6
 v_add_u32 v7, v7, v6
 s_branch L_pub
L_bpark:
 s_waitcnt vmcnt(0) lgkmcnt(0)
 s_mov_b32 s59, 2.0
 s_cmp_eq_u32 s62, 0
 s_cbranch_scc1 L_t1park
 v_accvgpr_read_b32 v12, a247
 v_cmp_ne_u32 vcc, 0, v12
 s_cbranch_vccz L_poll1_ok
 v_and_b32 v11, 31, v0
 v_lshlrev_b32 v11, 2, v11
 s_mov_b32 s32, 0
L_poll1:
 buffer_load_dword v12, v11, s[12:15], s61 offen sc1
 s_waitcnt vmcnt(0)
 v_cmp_ne_u32 vcc, 0, v12
 s_cbranch_vccz L_poll1_ok
 s_sleep 6
 s_add_u32 s32, s32, 1
 s_cmp_lt_u32 s32, 0x80000
 s_cbranch_scc1 L_poll1
L_poll1_ok:
 s_branch L_t1park
L_kvlate:
 v_cmp_gt_u32 vcc, 256, v5
 v_mov_b32 v29, 0
 s_mov_b32 s32, 0
 s_cbranch_vccz L_armed
L_pollA:
 global_load_dword v28, v29, s[90:91] offset:128 sc1
 s_add_u32 s32, s32, 1
 s_waitcnt vmcnt(0)
 v_cmp_gt_u32 vcc, 256, v28
 s_cmp_lt_u32 s32, 0x80000
 s_cselect_b64 vcc, vcc, 0
 s_cbranch_vccnz L_pollA
L_armed:
 v_and_b32 v28, 11, v0
 v_lshlrev_b32 v28, 2, v28
 s_mov_b32 s32, 0
L_poll0:
 buffer_load_dword v29, v28, s[12:15], s58 offen sc1
 s_waitcnt vmcnt(0)
 v_cmp_ne_u32 vcc, 0, v29
 s_cbranch_vccz L_poll0_ok
 s_sleep 6
 s_add_u32 s32, s32, 1
 s_cmp_lt_u32 s32, 0x80000
 s_cbranch_scc1 L_poll0
L_poll0_ok:
 s_mov_b32 m0, s40
 s_nop 0
 buffer_load_dwordx4 v1, s[12:15], s42 offen offset:0 sc1 lds
 buffer_load_dwordx4 v1, s[12:15], s42 offen offset:1024 sc1 lds
 buffer_load_dwordx4 v1, s[12:15], s42 offen offset:2048 sc1 lds
 buffer_load_dwordx4 v1, s[12:15], s42 offen offset:3072 sc1 lds
 s_bitset1_b32 m0, 12
 s_nop 0
 buffer_load_dwordx4 v4, s[12:15], s42 offen offset:0 sc1 lds
 buffer_load_dwordx4 v4, s[12:15], s42 offen offset:1024 sc1 lds
 buffer_load_dwordx4 v4, s[12:15], s42 offen offset:2048 sc1 lds
 buffer_load_dwordx4 v4, s[12:15], s42 offen offset:3072 sc1 lds
 s_add_u32 s42, s42, s70
 s_xor_b32 s40, s40, 0x8000
 s_mov_b32 m0, s40
 s_nop 0
 buffer_load_dwordx4 v1, s[12:15], s42 offen offset:0 sc1 lds
 buffer_load_dwordx4 v1, s[12:15], s42 offen offset:1024 sc1 lds
 buffer_load_dwordx4 v1, s[12:15], s42 offen offset:2048 sc1 lds
 buffer_load_dwordx4 v1, s[12:15], s42 offen offset:3072 sc1 lds
 s_bitset1_b32 m0, 12
 s_nop 0
 buffer_load_dwordx4 v4, s[12:15], s42 offen offset:0 sc1 lds
 buffer_load_dwordx4 v4, s[12:15], s42 offen offset:1024 sc1 lds
 buffer_load_dwordx4 v4, s[12:15], s42 offen offset:2048 sc1 lds
 buffer_load_dwordx4 v4, s[12:15], s42 offen offset:3072 sc1 lds
 s_add_u32 s42, s42, s70
 s_xor_b32 s40, s40, 0x8000
 s_branch L_kvok
L_rowchk:
 v_mov_b32 v16, v5
 v_mov_b32 v17, v6
 v_mov_b32 v18, v16
 v_mov_b32 v19, v17
 s_nop 0
 v_permlane32_swap_b32 v16, v18
 v_permlane32_swap_b32 v17, v19
 s_nop 0
 v_add_f32 v16, v16, v18
 v_add_f32 v17, v17, v19
 v_mov_b32 v18, v16
 v_mov_b32 v19, v17
 s_nop 0
 v_permlane16_swap_b32 v16, v18
 v_permlane16_swap_b32 v17, v19
 s_nop 0
 v_add_f32 v16, v16, v18
 v_add_f32 v17, v17, v19
 v_min_f32 v16, v16, v17
 v_cmp_gt_f32 vcc, 0x33800000, v16
 s_cbranch_vccz L_firstok
 s_branch L_slow2
L_slow:
 s_cmp_lg_u32 s47, 0x4b800000
 s_cbranch_scc1 L_switched
 s_nop 5
L_slow2:
 v_max3_f32 v11, v32, v33, v34
 v_max3_f32 v11, v11, v35, v40
 v_max3_f32 v11, v11, v41, v42
 v_max3_f32 v11, v11, v43, v48
 v_max3_f32 v11, v11, v49, v50
 v_max3_f32 v11, v11, v51, v56
 v_max3_f32 v11, v11, v57, v58
 v_max_f32 v11, v11, v59
 v_mov_b32 v16, v11
 s_nop 1
 v_permlane32_swap_b32 v11, v16
 s_nop 1
 v_max_f32 v11, v11, v16
 v_mov_b32 v16, v11
 s_nop 1
 v_permlane16_swap_b32 v11, v16
 s_nop 1
 v_max_f32 v11, v11, v16
 v_max_f32 v11, s46, v11
 v_sub_f32 v9, v9, v11
 v_sub_f32 v32, v32, v11
 v_sub_f32 v33, v33, v11
 v_sub_f32 v34, v34, v11
 v_sub_f32 v35, v35, v11
 v_sub_f32 v40, v40, v11
 v_sub_f32 v41, v41, v11
 v_sub_f32 v42, v42, v11
 v_sub_f32 v43, v43, v11
 v_sub_f32 v48, v48, v11
 v_sub_f32 v49, v49, v11
 v_sub_f32 v50, v50, v11
 v_sub_f32 v51, v51, v11
 v_sub_f32 v56, v56, v11
 v_sub_f32 v57, v57, v11
 v_sub_f32 v58, v58, v11
 v_sub_f32 v59, v59, v11
 v_exp_f32 v64, v32
 v_mov_b32 v96, v9
 v_exp_f32 v65, v33
 v_mov_b32 v97, v9
 v_exp_f32 v66, v34
 v_mov_b32 v98, v9
 v_exp_f32 v67, v35
 v_mov_b32 v99, v9
 v_exp_f32 v72, v40
 v_mov_b32 v104, v9
 v_exp_f32 v73, v41
 v_mov_b32 v105, v9
 v_exp_f32 v74, v42
 v_mov_b32 v106, v9
 v_exp_f32 v75, v43
 v_mov_b32 v107, v9
 v_exp_f32 v80, v48
 v_mov_b32 v112, v9
 v_exp_f32 v81, v49
 v_mov_b32 v113, v9
 v_exp_f32 v82, v50
 v_mov_b32 v114, v9
 v_exp_f32 v83, v51
 v_mov_b32 v115, v9
 v_exp_f32 v88, v56
 v_mov_b32 v120, v9
 v_exp_f32 v89, v57
 v_mov_b32 v121, v9
 v_exp_f32 v90, v58
 v_mov_b32 v122, v9
 v_exp_f32 v91, v59
 v_mov_b32 v123, v9
 v_add_f32 v5, v64, v65
 v_add_f32 v5, v5, v66
 v_add_f32 v5, v5, v67
 v_add_f32 v5, v5, v72
 v_add_f32 v5, v5, v73
 v_add_f32 v5, v5, v74
 v_add_f32 v5, v5, v75
 v_add_f32 v5, v5, v80
 v_add_f32 v5, v5, v81
 v_add_f32 v5, v5, v82
 v_add_f32 v5, v5, v83
 v_add_f32 v5, v5, v88
 v_add_f32 v5, v5, v89
 v_add_f32 v5, v5, v90
 v_add_f32 v5, v5, v91
 v_max3_f32 v12, v36, v37, v38
 v_max3_f32 v12, v12, v39, v44
 v_max3_f32 v12, v12, v45, v46
 v_max3_f32 v12, v12, v47, v52
 v_max3_f32 v12, v12, v53, v54
 v_max3_f32 v12, v12, v55, v60
 v_max3_f32 v12, v12, v61, v62
 v_max_f32 v12, v12, v63
 v_mov_b32 v16, v12
 s_nop 1
 v_permlane32_swap_b32 v12, v16
 s_nop 1
 v_max_f32 v12, v12, v16
 v_mov_b32 v16, v12
 s_nop 1
 v_permlane16_swap_b32 v12, v16
 s_nop 1
 v_max_f32 v12, v12, v16
 v_max_f32 v12, s46, v12
 v_sub_f32 v10, v10, v12
 v_sub_f32 v36, v36, v12
 v_sub_f32 v37, v37, v12
 v_sub_f32 v38, v38, v12
 v_sub_f32 v39, v39, v12
 v_sub_f32 v44, v44, v12
 v_sub_f32 v45, v45, v12
 v_sub_f32 v46, v46, v12
 v_sub_f32 v47, v47, v12
 v_sub_f32 v52, v52, v12
 v_sub_f32 v53, v53, v12
 v_sub_f32 v54, v54, v12
 v_sub_f32 v55, v55, v12
 v_sub_f32 v60, v60, v12
 v_sub_f32 v61, v61, v12
 v_sub_f32 v62, v62, v12
 v_sub_f32 v63, v63, v12
 v_exp_f32 v68, v36
 v_mov_b32 v100, v10
 v_exp_f32 v69, v37
 v_mov_b32 v101, v10
 v_exp_f32 v70, v38
 v_mov_b32 v102, v10
 v_exp_f32 v71, v39
 v_mov_b32 v103, v10
 v_exp_f32 v76, v44
 v_mov_b32 v108, v10
 v_exp_f32 v77, v45
 v_mov_b32 v109, v10
 v_exp_f32 v78, v46
 v_mov_b32 v110, v10
 v_exp_f32 v79, v47
 v_mov_b32 v111, v10
 v_exp_f32 v84, v52
 v_mov_b32 v116, v10
 v_exp_f32 v85, v53
 v_mov_b32 v117, v10
 v_exp_f32 v86, v54
 v_mov_b32 v118, v10
 v_exp_f32 v87, v55
 v_mov_b32 v119, v10
 v_exp_f32 v92, v60
 v_mov_b32 v124, v10
 v_exp_f32 v93, v61
 v_mov_b32 v125, v10
 v_exp_f32 v94, v62
 v_mov_b32 v126, v10
 v_exp_f32 v95, v63
 v_mov_b32 v127, v10
 v_add_f32 v6, v68, v69
 v_add_f32 v6, v6, v70
 v_add_f32 v6, v6, v71
 v_add_f32 v6, v6, v76
 v_add_f32 v6, v6, v77
 v_add_f32 v6, v6, v78
 v_add_f32 v6, v6, v79
 v_add_f32 v6, v6, v84
 v_add_f32 v6, v6, v85
 v_add_f32 v6, v6, v86
 v_add_f32 v6, v6, v87
 v_add_f32 v6, v6, v92
 v_add_f32 v6, v6, v93
 v_add_f32 v6, v6, v94
 v_add_f32 v6, v6, v95
 v_mov_b32 v16, 0xf149f2ca
 v_cmp_gt_i32 s[16:17], 0, v14
 v_cmp_gt_i32 s[18:19], 1, v14
 v_cmp_gt_i32 s[20:21], 2, v14
 v_cmp_gt_i32 s[22:23], 3, v14
 v_cndmask_b32 v20, v9, v16, s[16:17]
 v_cndmask_b32 v21, v9, v16, s[18:19]
 v_cndmask_b32 v22, v9, v16, s[20:21]
 v_cndmask_b32 v23, v9, v16, s[22:23]
 v_accvgpr_write_b32 a224, v20
 v_accvgpr_write_b32 a225, v21
 v_accvgpr_write_b32 a226, v22
 v_accvgpr_write_b32 a227, v23
 v_cmp_gt_i32 s[16:17], 16, v14
 v_cmp_gt_i32 s[18:19], 17, v14
 v_cmp_gt_i32 s[20:21], 18, v14
 v_cmp_gt_i32 s[22:23], 19, v14
 v_cndmask_b32 v20, v9, v16, s[16:17]
 v_cndmask_b32 v21, v9, v16, s[18:19]
 v_cndmask_b32 v22, v9, v16, s[20:21]
 v_cndmask_b32 v23, v9, v16, s[22:23]
 v_accvgpr_write_b32 a228, v20
 v_accvgpr_write_b32 a229, v21
 v_accvgpr_write_b32 a230, v22
 v_accvgpr_write_b32 a231, v23
 v_cmp_gt_i32 s[16:17], 32, v14
 v_cmp_gt_i32 s[18:19], 33, v14
 v_cmp_gt_i32 s[20:21], 34, v14
 v_cmp_gt_i32 s[22:23], 35, v14
 v_cndmask_b32 v20, v9, v16, s[16:17]
 v_cndmask_b32 v21, v9, v16, s[18:19]
 v_cndmask_b32 v22, v9, v16, s[20:21]
 v_cndmask_b32 v23, v9, v16, s[22:23]
 v_accvgpr_write_b32 a232, v20
 v_accvgpr_write_b32 a233, v21
 v_accvgpr_write_b32 a234, v22
 v_accvgpr_write_b32 a235, v23
 v_cmp_gt_i32 s[16:17], 48, v14
 v_cmp_gt_i32 s[18:19], 49, v14
 v_cmp_gt_i32 s[20:21], 50, v14
 v_cmp_gt_i32 s[22:23], 51, v14
 v_cndmask_b32 v20, v9, v16, s[16:17]
 v_cndmask_b32 v21, v9, v16, s[18:19]
 v_cndmask_b32 v22, v9, v16, s[20:21]
 v_cndmask_b32 v23, v9, v16, s[22:23]
 v_accvgpr_write_b32 a236, v20
 v_accvgpr_write_b32 a237, v21
 v_accvgpr_write_b32 a238, v22
 v_accvgpr_write_b32 a239, v23
 s_waitcnt lgkmcnt(0)
 s_cmp_lg_u32 s46, 0
 s_mov_b32 s46, 0
 s_cbranch_scc1 L_ret
 v_exp_f32 v11, -v11
 s_nop 0
 v_mul_f32 v7, v7, v11
 v_mul_f32 v128, v128, v11
 v_mul_f32 v129, v129, v11
 v_mul_f32 v130, v130, v11
 v_mul_f32 v131, v131, v11
 v_mul_f32 v132, v132, v11
 v_mul_f32 v133, v133, v11
 v_mul_f32 v134, v134, v11
 v_mul_f32 v135, v135, v11
 v_mul_f32 v136, v136, v11
 v_mul_f32 v137, v137, v11
 v_mul_f32 v138, v138, v11
 v_mul_f32 v139, v139, v11
 v_mul_f32 v140, v140, v11
 v_mul_f32 v141, v141, v11
 v_mul_f32 v142, v142, v11
 v_mul_f32 v143, v143, v11
 v_mul_f32 v144, v144, v11
 v_mul_f32 v145, v145, v11
 v_mul_f32 v146, v146, v11
 v_mul_f32 v147, v147, v11
 v_mul_f32 v148, v148, v11
 v_mul_f32 v149, v149, v11
 v_mul_f32 v150, v150, v11
 v_mul_f32 v151, v151, v11
 v_mul_f32 v152, v152, v11
 v_mul_f32 v153, v153, v11
 v_mul_f32 v154, v154, v11
 v_mul_f32 v155, v155, v11
 v_mul_f32 v156, v156, v11
 v_mul_f32 v157, v157, v11
 v_mul_f32 v158, v158, v11
 v_mul_f32 v159, v159, v11
 v_mul_f32 v160, v160, v11
 v_mul_f32 v161, v161, v11
 v_mul_f32 v162, v162, v11
 v_mul_f32 v163, v163, v11
 v_mul_f32 v164, v164, v11
 v_mul_f32 v165, v165, v11
 v_mul_f32 v166, v166, v11
 v_mul_f32 v167, v167, v11
 v_mul_f32 v168, v168, v11
 v_mul_f32 v169, v169, v11
 v_mul_f32 v170, v170, v11
 v_mul_f32 v171, v171, v11
 v_mul_f32 v172, v172, v11
 v_mul_f32 v173, v173, v11
 v_mul_f32 v174, v174, v11
 v_mul_f32 v175, v175, v11
 v_mul_f32 v176, v176, v11
 v_mul_f32 v177, v177, v11
 v_mul_f32 v178, v178, v11
 v_mul_f32 v179, v179, v11
 v_mul_f32 v180, v180, v11
 v_mul_f32 v181, v181, v11
 v_mul_f32 v182, v182, v11
 v_mul_f32 v183, v183, v11
 v_mul_f32 v184, v184, v11
 v_mul_f32 v185, v185, v11
 v_mul_f32 v186, v186, v11
 v_mul_f32 v187, v187, v11
 v_mul_f32 v188, v188, v11
 v_mul_f32 v189, v189, v11
 v_mul_f32 v190, v190, v11
 v_mul_f32 v191, v191, v11
 v_exp_f32 v12, -v12
 s_nop 0
 v_mul_f32 v8, v8, v12
 v_mul_f32 v192, v192, v12
 v_mul_f32 v193, v193, v12
 v_mul_f32 v194, v194, v12
 v_mul_f32 v195, v195, v12
 v_mul_f32 v196, v196, v12
 v_mul_f32 v197, v197, v12
 v_mul_f32 v198, v198, v12
 v_mul_f32 v199, v199, v12
 v_mul_f32 v200, v200, v12
 v_mul_f32 v201, v201, v12
 v_mul_f32 v202, v202, v12
 v_mul_f32 v203, v203, v12
 v_mul_f32 v204, v204, v12
 v_mul_f32 v205, v205, v12
 v_mul_f32 v206, v206, v12
 v_mul_f32 v207, v207, v12
 v_mul_f32 v208, v208, v12
 v_mul_f32 v209, v209, v12
 v_mul_f32 v210, v210, v12
 v_mul_f32 v211, v211, v12
 v_mul_f32 v212, v212, v12
 v_mul_f32 v213, v213, v12
 v_mul_f32 v214, v214, v12
 v_mul_f32 v215, v215, v12
 v_mul_f32 v216, v216, v12
 v_mul_f32 v217, v217, v12
 v_mul_f32 v218, v218, v12
 v_mul_f32 v219, v219, v12
 v_mul_f32 v220, v220, v12
 v_mul_f32 v221, v221, v12
 v_mul_f32 v222, v222, v12
 v_mul_f32 v223, v223, v12
 v_mul_f32 v224, v224, v12
 v_mul_f32 v225, v225, v12
 v_mul_f32 v226, v226, v12
 v_mul_f32 v227, v227, v12
 v_mul_f32 v228, v228, v12
 v_mul_f32 v229, v229, v12
 v_mul_f32 v230, v230, v12
 v_mul_f32 v231, v231, v12
 v_mul_f32 v232, v232, v12
 v_mul_f32 v233, v233, v12
 v_mul_f32 v234, v234, v12
 v_mul_f32 v235, v235, v12
 v_mul_f32 v236, v236, v12
 v_mul_f32 v237, v237, v12
 v_mul_f32 v238, v238, v12
 v_mul_f32 v239, v239, v12
 v_mul_f32 v240, v240, v12
 v_mul_f32 v241, v241, v12
 v_mul_f32 v242, v242, v12
 v_mul_f32 v243, v243, v12
 v_mul_f32 v244, v244, v12
 v_mul_f32 v245, v245, v12
 v_mul_f32 v246, v246, v12
 v_mul_f32 v247, v247, v12
 v_mul_f32 v248, v248, v12
 v_mul_f32 v249, v249, v12
 v_mul_f32 v250, v250, v12
 v_mul_f32 v251, v251, v12
 v_mul_f32 v252, v252, v12
 v_mul_f32 v253, v253, v12
 v_mul_f32 v254, v254, v12
 v_mul_f32 v255, v255, v12
 s_branch L_ret
L_ret:
 s_cmp_gt_u32 s44, s45
 s_cbranch_scc1 L_loop
 s_branch L_ret2
L_disp:
 s_cmp_lt_u32 s44, 2
 s_cbranch_scc1 L_d1
 s_waitcnt vmcnt(0)
 v_accvgpr_read_b32 v12, a246
 v_cmp_ne_u32 vcc, 0, v12
 s_cbranch_vccz L_poll2_ok
 v_and_b32 v11, 11, v0
 v_lshlrev_b32 v11, 2, v11
 s_mov_b32 s32, 0
L_poll2:
 buffer_load_dword v12, v11, s[12:15], s60 offen sc1
 s_waitcnt vmcnt(0)
 v_cmp_ne_u32 vcc, 0, v12
 s_cbranch_vccz L_poll2_ok
 s_sleep 6
 s_add_u32 s32, s32, 1
 s_cmp_lt_u32 s32, 0x80000
 s_cbranch_scc1 L_poll2
L_poll2_ok:
 s_cmp_eq_u32 s38, 0
 s_cselect_b32 s60, s60, s94
 v_mov_b32 v15, 0
 s_mov_b32 s45, 2
 s_branch L_loop
L_d1:
 s_cmp_eq_u32 s54, 1
 s_cbranch_scc1 L_seg2
 s_cmp_eq_u32 s44, 0
 s_cbranch_scc1 L_p2
 s_cmp_eq_u32 s53, 0
 s_cbranch_scc1 L_g0y
 s_mov_b32 s53, 0
 s_add_u32 s52, s50, 131072
 s_mul_i32 s58, s3, 50176
 s_sub_u32 s58, 128, s58
 s_cmp_eq_u32 s7, 0
 s_cselect_b32 s42, s78, s49
 s_cmov_b32 s40, s52
 s_cmov_b64 s[8:9], s[86:87]
 s_cmov_b32 s10, 3670016
 s_cmov_b32 s76, 6144
 s_cmov_b32 s77, 10240
 s_mov_b32 s44, 1
 s_waitcnt vmcnt(0)
 s_barrier
 ds_read_b128 a[96:99], v3 offset:0
 ds_read_b128 a[100:103], v3 offset:16384
 ds_read_b128 a[104:107], v3 offset:1024
 ds_read_b128 a[108:111], v3 offset:17408
 ds_read_b128 a[112:115], v3 offset:2048
 ds_read_b128 a[116:119], v3 offset:18432
 s_branch L_g0y
L_g0x:
 v_cmp_nge_f32 vcc, s47, v11
 s_cbranch_vccnz L_slow
L_g0y:
 v_mov_b32 v16, 0xf149f2ca
 v_cmp_gt_i32 s[16:17], 0, v14
 v_cmp_gt_i32 s[18:19], 1, v14
 v_cmp_gt_i32 s[20:21], 2, v14
 v_cmp_gt_i32 s[22:23], 3, v14
 v_cndmask_b32 v100, v10, v16, s[16:17]
 v_cndmask_b32 v101, v10, v16, s[18:19]
 v_cndmask_b32 v102, v10, v16, s[20:21]
 v_cndmask_b32 v103, v10, v16, s[22:23]
 v_cmp_gt_i32 s[16:17], 16, v14
 v_cmp_gt_i32 s[18:19], 17, v14
 v_cmp_gt_i32 s[20:21], 18, v14
 v_cmp_gt_i32 s[22:23], 19, v14
 v_cndmask_b32 v108, v10, v16, s[16:17]
 v_cndmask_b32 v109, v10, v16, s[18:19]
 v_cndmask_b32 v110, v10, v16, s[20:21]
 v_cndmask_b32 v111, v10, v16, s[22:23]
 v_cmp_gt_i32 s[16:17], 32, v14
 v_cmp_gt_i32 s[18:19], 33, v14
 v_cmp_gt_i32 s[20:21], 34, v14
 v_cmp_gt_i32 s[22:23], 35, v14
 v_cndmask_b32 v116, v10, v16, s[16:17]
 v_cndmask_b32 v117, v10, v16, s[18:19]
 v_cndmask_b32 v118, v10, v16, s[20:21]
 v_cndmask_b32 v119, v10, v16, s[22:23]
 v_cmp_gt_i32 s[16:17], 48, v14
 v_cmp_gt_i32 s[18:19], 49, v14
 v_cmp_gt_i32 s[20:21], 50, v14
 v_cmp_gt_i32 s[22:23], 51, v14
 v_cndmask_b32 v124, v10, v16, s[16:17]
 v_cndmask_b32 v125, v10, v16, s[18:19]
 v_cndmask_b32 v126, v10, v16, s[20:21]
 v_cndmask_b32 v127, v10, v16, s[22:23]
 s_waitcnt lgkmcnt(0)
 s_cmp_eq_u32 s51, 1
 s_cbranch_scc1 L_p1
 s_cmp_eq_u32 s7, 0
 s_cbranch_scc1 L_g0z
 v_and_b32 v11, 0, v0
 v_lshlrev_b32 v11, 2, v11
 s_mov_b32 s32, 0
L_poll3:
 buffer_load_dword v12, v11, s[12:15], s60 offen sc1
 s_waitcnt vmcnt(0)
 v_cmp_ne_u32 vcc, 0, v12
 s_cbranch_vccz L_poll3_ok
 s_sleep 1
 s_add_u32 s32, s32, 1
 s_cmp_lt_u32 s32, 0x80000
 s_cbranch_scc1 L_poll3
L_poll3_ok:
 s_branch L_g0w
L_g0z:
 buffer_load_dword v12, v15, s[12:15], s60 offen sc1
 s_waitcnt vmcnt(0)
 v_cmp_ne_u32 vcc, 0, v12
L_g0w:
 s_cmp_eq_u64 vcc, 0
 s_cselect_b32 s51, 1, 0
 s_cselect_b32 s55, s4, 2.0
 s_cselect_b32 s56, s5, 2.0
 s_cselect_b32 s57, s6, 2.0
 buffer_load_dwordx4 a[192:195], v1, s[12:15], s57 offen sc1
 buffer_load_dwordx4 a[128:131], v1, s[12:15], s55 offen offset:0 sc1
 buffer_load_dwordx4 a[132:135], v1, s[12:15], s55 offen offset:1024 sc1
 buffer_load_dwordx4 a[136:139], v1, s[12:15], s55 offen offset:2048 sc1
 buffer_load_dwordx4 a[140:143], v1, s[12:15], s55 offen offset:3072 sc1
 buffer_load_dwordx4 a[144:147], v4, s[12:15], s55 offen offset:0 sc1
 buffer_load_dwordx4 a[148:151], v4, s[12:15], s55 offen offset:1024 sc1
 buffer_load_dwordx4 a[152:155], v4, s[12:15], s55 offen offset:2048 sc1
 buffer_load_dwordx4 a[156:159], v4, s[12:15], s55 offen offset:3072 sc1
 s_branch L_p1
L_seg2:
 s_cmp_eq_u32 s44, 0
 s_cbranch_scc1 L_tail
L_last:
 v_and_b32 v11, 31, v0
 v_lshlrev_b32 v11, 2, v11
 buffer_load_dword a247, v11, s[12:15], s61 offen sc1
 v_accvgpr_read_b32 v13, a241
 s_mov_b64 s[8:9], s[86:87]
 s_mov_b32 s10, 3670016
 s_mov_b32 s42, s78
 s_add_u32 s40, s50, 131072
 s_movk_i32 s76, 6144
 s_movk_i32 s77, 10240
 s_branch L_loop
L_switch:
 v_accvgpr_mov_b32 a32, a128
 v_accvgpr_mov_b32 a33, a129
 v_accvgpr_mov_b32 a34, a130
 v_accvgpr_mov_b32 a35, a131
 v_accvgpr_mov_b32 a36, a132
 v_accvgpr_mov_b32 a37, a133
 v_accvgpr_mov_b32 a38, a134
 v_accvgpr_mov_b32 a39, a135
 v_accvgpr_mov_b32 a40, a136
 v_accvgpr_mov_b32 a41, a137
 v_accvgpr_mov_b32 a42, a138
 v_accvgpr_mov_b32 a43, a139
 v_accvgpr_mov_b32 a44, a140
 v_accvgpr_mov_b32 a45, a141
 v_accvgpr_mov_b32 a46, a142
 v_accvgpr_mov_b32 a47, a143
 v_accvgpr_mov_b32 a48, a144
 v_accvgpr_mov_b32 a49, a145
 v_accvgpr_mov_b32 a50, a146
 v_accvgpr_mov_b32 a51, a147
 v_accvgpr_mov_b32 a52, a148
 v_accvgpr_mov_b32 a53, a149
 v_accvgpr_mov_b32 a54, a150
 v_accvgpr_mov_b32 a55, a151
 v_accvgpr_mov_b32 a56, a152
 v_accvgpr_mov_b32 a57, a153
 v_accvgpr_mov_b32 a58, a154
 v_accvgpr_mov_b32 a59, a155
 v_accvgpr_mov_b32 a60, a156
 v_accvgpr_mov_b32 a61, a157
 v_accvgpr_mov_b32 a62, a158
 v_accvgpr_mov_b32 a63, a159
 v_mov_b64 v[96:97], 0
 v_mov_b64 v[98:99], 0
 v_mov_b64 v[100:101], 0
 v_mov_b64 v[102:103], 0
 v_mov_b64 v[104:105], 0
 v_mov_b64 v[106:107], 0
 v_mov_b64 v[108:109], 0
 v_mov_b64 v[110:111], 0
 v_mov_b64 v[112:113], 0
 v_mov_b64 v[114:115], 0
 v_mov_b64 v[116:117], 0
 v_mov_b64 v[118:119], 0
 v_mov_b64 v[120:121], 0
 v_mov_b64 v[122:123], 0
 v_mov_b64 v[124:125], 0
 v_mov_b64 v[126:127], 0
 v_mov_b64 v[64:65], 0
 v_mov_b64 v[66:67], 0
 v_mov_b64 v[72:73], 0
 v_mov_b64 v[74:75], 0
 v_mov_b64 v[80:81], 0
 v_mov_b64 v[82:83], 0
 v_mov_b64 v[88:89], 0
 v_mov_b64 v[90:91], 0
 v_mov_b32 v5, 0
 s_add_u32 s42, s49, 32768
 s_xor_b32 s40, s40, 0x8000
 s_xor_b32 s41, s41, 0x8000
 s_add_u32 s43, s49, 16777216
 s_mov_b32 s44, s38
 s_mov_b32 s45, 1
 s_mov_b32 s47, -1.0
 s_waitcnt vmcnt(8) lgkmcnt(0)
 s_cmp_eq_u32 s38, 1
 s_cbranch_scc1 L_last
 s_branch L_loop
L_switched:
 v_mov_b32 v18, v7
 v_mov_b32 v19, v8
 s_nop 0
 v_permlane32_swap_b32 v7, v18
 v_permlane32_swap_b32 v8, v19
 s_nop 0
 v_add_f32 v7, v7, v18
 v_add_f32 v8, v8, v19
 s_nop 0
 v_mov_b32 v18, v7
 v_mov_b32 v19, v8
 s_nop 0
 v_permlane16_swap_b32 v7, v18
 v_permlane16_swap_b32 v8, v19
 s_nop 0
 v_add_f32 v7, v7, v18
 v_add_f32 v8, v8, v19
 s_nop 0
 v_rcp_f32 v16, v7
 v_rcp_f32 v17, v8
 s_mov_b32 s47, 0x4b800000
 s_mov_b32 s54, 1
 v_accvgpr_write_b32 a200, v16
 v_cvt_pk_bf16_f32 v128, v128, v129
 v_cvt_pk_bf16_f32 v129, v130, v131
 v_cvt_pk_bf16_f32 v130, v132, v133
 v_cvt_pk_bf16_f32 v131, v134, v135
 v_accvgpr_write_b32 a128, v128
 v_accvgpr_write_b32 a129, v129
 v_accvgpr_write_b32 a130, v130
 v_accvgpr_write_b32 a131, v131
 v_cvt_pk_bf16_f32 v136, v136, v137
 v_cvt_pk_bf16_f32 v137, v138, v139
 v_cvt_pk_bf16_f32 v138, v140, v141
 v_cvt_pk_bf16_f32 v139, v142, v143
 v_accvgpr_write_b32 a132, v136
 v_accvgpr_write_b32 a133, v137
 v_accvgpr_write_b32 a134, v138
 v_accvgpr_write_b32 a135, v139
 v_cvt_pk_bf16_f32 v144, v144, v145
 v_cvt_pk_bf16_f32 v145, v146, v147
 v_cvt_pk_bf16_f32 v146, v148, v149
 v_cvt_pk_bf16_f32 v147, v150, v151
 v_accvgpr_write_b32 a136, v144
 v_accvgpr_write_b32 a137, v145
 v_accvgpr_write_b32 a138, v146
 v_accvgpr_write_b32 a139, v147
 v_cvt_pk_bf16_f32 v152, v152, v153
 v_cvt_pk_bf16_f32 v153, v154, v155
 v_cvt_pk_bf16_f32 v154, v156, v157
 v_cvt_pk_bf16_f32 v155, v158, v159
 v_accvgpr_write_b32 a140, v152
 v_accvgpr_write_b32 a141, v153
 v_accvgpr_write_b32 a142, v154
 v_accvgpr_write_b32 a143, v155
 v_cvt_pk_bf16_f32 v160, v160, v161
 v_cvt_pk_bf16_f32 v161, v162, v163
 v_cvt_pk_bf16_f32 v162, v164, v165
 v_cvt_pk_bf16_f32 v163, v166, v167
 v_accvgpr_write_b32 a144, v160
 v_accvgpr_write_b32 a145, v161
 v_accvgpr_write_b32 a146, v162
 v_accvgpr_write_b32 a147, v163
 v_cvt_pk_bf16_f32 v168, v168, v169
 v_cvt_pk_bf16_f32 v169, v170, v171
 v_cvt_pk_bf16_f32 v170, v172, v173
 v_cvt_pk_bf16_f32 v171, v174, v175
 v_accvgpr_write_b32 a148, v168
 v_accvgpr_write_b32 a149, v169
 v_accvgpr_write_b32 a150, v170
 v_accvgpr_write_b32 a151, v171
 v_cvt_pk_bf16_f32 v176, v176, v177
 v_cvt_pk_bf16_f32 v177, v178, v179
 v_cvt_pk_bf16_f32 v178, v180, v181
 v_cvt_pk_bf16_f32 v179, v182, v183
 v_accvgpr_write_b32 a152, v176
 v_accvgpr_write_b32 a153, v177
 v_accvgpr_write_b32 a154, v178
 v_accvgpr_write_b32 a155, v179
 v_cvt_pk_bf16_f32 v184, v184, v185
 v_cvt_pk_bf16_f32 v185, v186, v187
 v_cvt_pk_bf16_f32 v186, v188, v189
 v_cvt_pk_bf16_f32 v187, v190, v191
 v_accvgpr_write_b32 a156, v184
 v_accvgpr_write_b32 a157, v185
 v_accvgpr_write_b32 a158, v186
 v_accvgpr_write_b32 a159, v187
 v_accvgpr_write_b32 a201, v17
 v_cvt_pk_bf16_f32 v192, v192, v193
 v_cvt_pk_bf16_f32 v193, v194, v195
 v_cvt_pk_bf16_f32 v194, v196, v197
 v_cvt_pk_bf16_f32 v195, v198, v199
 v_accvgpr_write_b32 a160, v192
 v_accvgpr_write_b32 a161, v193
 v_accvgpr_write_b32 a162, v194
 v_accvgpr_write_b32 a163, v195
 v_cvt_pk_bf16_f32 v200, v200, v201
 v_cvt_pk_bf16_f32 v201, v202, v203
 v_cvt_pk_bf16_f32 v202, v204, v205
 v_cvt_pk_bf16_f32 v203, v206, v207
 v_accvgpr_write_b32 a164, v200
 v_accvgpr_write_b32 a165, v201
 v_accvgpr_write_b32 a166, v202
 v_accvgpr_write_b32 a167, v203
 v_cvt_pk_bf16_f32 v208, v208, v209
 v_cvt_pk_bf16_f32 v209, v210, v211
 v_cvt_pk_bf16_f32 v210, v212, v213
 v_cvt_pk_bf16_f32 v211, v214, v215
 v_accvgpr_write_b32 a168, v208
 v_accvgpr_write_b32 a169, v209
 v_accvgpr_write_b32 a170, v210
 v_accvgpr_write_b32 a171, v211
 v_cvt_pk_bf16_f32 v216, v216, v217
 v_cvt_pk_bf16_f32 v217, v218, v219
 v_cvt_pk_bf16_f32 v218, v220, v221
 v_cvt_pk_bf16_f32 v219, v222, v223
 v_accvgpr_write_b32 a172, v216
 v_accvgpr_write_b32 a173, v217
 v_accvgpr_write_b32 a174, v218
 v_accvgpr_write_b32 a175, v219
 v_cvt_pk_bf16_f32 v224, v224, v225
 v_cvt_pk_bf16_f32 v225, v226, v227
 v_cvt_pk_bf16_f32 v226, v228, v229
 v_cvt_pk_bf16_f32 v227, v230, v231
 v_accvgpr_write_b32 a176, v224
 v_accvgpr_write_b32 a177, v225
 v_accvgpr_write_b32 a178, v226
 v_accvgpr_write_b32 a179, v227
 v_cvt_pk_bf16_f32 v232, v232, v233
 v_cvt_pk_bf16_f32 v233, v234, v235
 v_cvt_pk_bf16_f32 v234, v236, v237
 v_cvt_pk_bf16_f32 v235, v238, v239
 v_accvgpr_write_b32 a180, v232
 v_accvgpr_write_b32 a181, v233
 v_accvgpr_write_b32 a182, v234
 v_accvgpr_write_b32 a183, v235
 v_cvt_pk_bf16_f32 v240, v240, v241
 v_cvt_pk_bf16_f32 v241, v242, v243
 v_cvt_pk_bf16_f32 v242, v244, v245
 v_cvt_pk_bf16_f32 v243, v246, v247
 v_accvgpr_write_b32 a184, v240
 v_accvgpr_write_b32 a185, v241
 v_accvgpr_write_b32 a186, v242
 v_accvgpr_write_b32 a187, v243
 v_cvt_pk_bf16_f32 v248, v248, v249
 v_cvt_pk_bf16_f32 v249, v250, v251
 v_cvt_pk_bf16_f32 v250, v252, v253
 v_cvt_pk_bf16_f32 v251, v254, v255
 v_accvgpr_write_b32 a188, v248
 v_accvgpr_write_b32 a189, v249
 v_accvgpr_write_b32 a190, v250
 v_accvgpr_write_b32 a191, v251
 v_mov_b64 v[128:129], 0
 v_mov_b64 v[130:131], 0
 v_mov_b64 v[132:133], 0
 v_mov_b64 v[134:135], 0
 v_mov_b64 v[136:137], 0
 v_mov_b64 v[138:139], 0
 v_mov_b64 v[140:141], 0
 v_mov_b64 v[142:143], 0
 v_mov_b64 v[144:145], 0
 v_mov_b64 v[146:147], 0
 v_mov_b64 v[148:149], 0
 v_mov_b64 v[150:151], 0
 v_mov_b64 v[152:153], 0
 v_mov_b64 v[154:155], 0
 v_mov_b64 v[156:157], 0
 v_mov_b64 v[158:159], 0
 v_mov_b64 v[160:161], 0
 v_mov_b64 v[162:163], 0
 v_mov_b64 v[164:165], 0
 v_mov_b64 v[166:167], 0
 v_mov_b64 v[168:169], 0
 v_mov_b64 v[170:171], 0
 v_mov_b64 v[172:173], 0
 v_mov_b64 v[174:175], 0
 v_mov_b64 v[176:177], 0
 v_mov_b64 v[178:179], 0
 v_mov_b64 v[180:181], 0
 v_mov_b64 v[182:183], 0
 v_mov_b64 v[184:185], 0
 v_mov_b64 v[186:187], 0
 v_mov_b64 v[188:189], 0
 v_mov_b64 v[190:191], 0
 v_mov_b64 v[192:193], 0
 v_mov_b64 v[194:195], 0
 v_mov_b64 v[196:197], 0
 v_mov_b64 v[198:199], 0
 v_mov_b64 v[200:201], 0
 v_mov_b64 v[202:203], 0
 v_mov_b64 v[204:205], 0
 v_mov_b64 v[206:207], 0
 v_mov_b64 v[208:209], 0
 v_mov_b64 v[210:211], 0
 v_mov_b64 v[212:213], 0
 v_mov_b64 v[214:215], 0
 v_mov_b64 v[216:217], 0
 v_mov_b64 v[218:219], 0
 v_mov_b64 v[220:221], 0
 v_mov_b64 v[222:223], 0
 v_mov_b64 v[224:225], 0
 v_mov_b64 v[226:227], 0
 v_mov_b64 v[228:229], 0
 v_mov_b64 v[230:231], 0
 v_mov_b64 v[232:233], 0
 v_mov_b64 v[234:235], 0
 v_mov_b64 v[236:237], 0
 v_mov_b64 v[238:239], 0
 v_mov_b64 v[240:241], 0
 v_mov_b64 v[242:243], 0
 v_mov_b64 v[244:245], 0
 v_mov_b64 v[246:247], 0
 v_mov_b64 v[248:249], 0
 v_mov_b64 v[250:251], 0
 v_mov_b64 v[252:253], 0
 v_mov_b64 v[254:255], 0
 v_mov_b32 v7, 0
 v_mov_b32 v8, 0
 v_mov_b32 v9, 0
 v_mov_b32 v10, 0
 s_branch L_first
L_fagen:
 v_mov_b32 v5, 0
 buffer_load_dword a246, v15, s[12:15], s60 offen sc1
 v_mov_b32 v64, 0
 v_mov_b32 v65, 0
 v_mov_b32 v66, 0
 v_mov_b32 v67, 0
 v_mov_b32 v72, 0
 v_mov_b32 v73, 0
 v_mov_b32 v74, 0
 v_mov_b32 v75, 0
 v_mov_b32 v80, 0
 v_mov_b32 v81, 0
 v_mov_b32 v82, 0
 v_mov_b32 v83, 0
 v_mov_b32 v88, 0
 v_mov_b32 v89, 0
 v_mov_b32 v90, 0
 v_mov_b32 v91, 0
L_tail:
 s_and_b32 s55, s2, 127
 s_lshl_b32 s57, s55, 2
 s_add_u32 s57, s57, s3
 s_mul_i32 s55, s57, 17408
 s_add_u32 s55, s55, 67108864
 s_lshl_b32 s57, s57, 10
 s_add_u32 s57, s57, 83886080
 s_mul_i32 s58, s3, 50176
 s_sub_u32 s58, 128, s58
 v_add_u32 v2, s58, v13
 v_cvt_pk_bf16_f32 v16, v64, v65
 v_cvt_pk_bf16_f32 v17, v66, v67
 v_cvt_pk_bf16_f32 v20, v68, v69
 v_cvt_pk_bf16_f32 v21, v70, v71
 v_cvt_pk_bf16_f32 v18, v72, v73
 v_cvt_pk_bf16_f32 v19, v74, v75
 v_cvt_pk_bf16_f32 v22, v76, v77
 v_cvt_pk_bf16_f32 v23, v78, v79
 v_cvt_pk_bf16_f32 v24, v80, v81
 v_cvt_pk_bf16_f32 v25, v82, v83
 v_cvt_pk_bf16_f32 v28, v84, v85
 v_cvt_pk_bf16_f32 v29, v86, v87
 v_cvt_pk_bf16_f32 v26, v88, v89
 v_cvt_pk_bf16_f32 v27, v90, v91
 v_cvt_pk_bf16_f32 v30, v92, v93
 v_cvt_pk_bf16_f32 v31, v94, v95
 v_add_f32 v7, v7, v5
 v_add_f32 v8, v8, v6
 s_waitcnt vmcnt(0) lgkmcnt(0)
 s_barrier
 ds_read_b128 a[64:67], v3 offset:0
 ds_read_b128 a[68:71], v3 offset:16384
 ds_read_b128 a[72:75], v3 offset:1024
 ds_read_b128 a[76:79], v3 offset:17408
 ds_read_b128 a[80:83], v3 offset:2048
 ds_read_b128 a[84:87], v3 offset:18432
 ds_read_b128 a[88:91], v3 offset:3072
 ds_read_b128 a[92:95], v3 offset:19456
 s_cmp_lg_u32 s38, 0
 s_cselect_b32 s58, s54, 0
 s_cmp_eq_u32 s58, 2
 s_cbranch_scc1 L_tail2
 s_cmp_eq_u32 s62, 0
 s_cbranch_scc1 L_nou
 v_accvgpr_read_b32 v12, a247
 v_cmp_ne_u32 vcc, 0, v12
 s_cbranch_vccz L_poll4_ok
 v_and_b32 v11, 31, v0
 v_lshlrev_b32 v11, 2, v11
 s_mov_b32 s32, 0
L_poll4:
 buffer_load_dword v12, v11, s[12:15], s61 offen sc1
 s_waitcnt vmcnt(0)
 v_cmp_ne_u32 vcc, 0, v12
 s_cbranch_vccz L_poll4_ok
 s_sleep 6
 s_add_u32 s32, s32, 1
 s_cmp_lt_u32 s32, 0x80000
 s_cbranch_scc1 L_poll4
L_poll4_ok:
L_nou:
 s_cmp_eq_u32 s54, 1
 s_cselect_b32 s55, s55, 2.0
 s_cselect_b32 s57, s57, 2.0
 s_cselect_b32 s59, s94, 2.0
 s_add_u32 s56, s55, 0x2000
 s_waitcnt lgkmcnt(0)
 v_mfma_f32_16x16x32_bf16 v[128:131], a[64:67], v[16:19], v[128:131]
 s_add_u32 m0, s29, 0
 ds_read_b128 a[96:99], v3 offset:4096
 v_mov_b32 v72, v7
 v_mfma_f32_16x16x32_bf16 v[128:131], a[68:71], v[24:27], v[128:131]
 buffer_load_dwordx4 v2, s[8:11], s78 offen lds
 v_mfma_f32_16x16x32_bf16 v[192:195], a[68:71], v[28:31], v[192:195]
 ds_read_b128 a[100:103], v3 offset:20480
 v_mov_b32 v73, v8
 v_mfma_f32_16x16x32_bf16 v[192:195], a[64:67], v[20:23], v[192:195]
 v_permlane32_swap_b32 v7, v72
 v_permlane32_swap_b32 v8, v73
 v_mfma_f32_16x16x32_bf16 v[132:135], a[72:75], v[16:19], v[132:135]
 s_add_u32 m0, s29, 4096
 ds_read_b128 a[104:107], v3 offset:5120
 v_accvgpr_read_b32 v44, a254
 v_mfma_f32_16x16x32_bf16 v[132:135], a[76:79], v[24:27], v[132:135]
 buffer_load_dwordx4 v2, s[8:11], s79 offen lds
 v_mfma_f32_16x16x32_bf16 v[196:199], a[76:79], v[28:31], v[196:199]
 ds_read_b128 a[108:111], v3 offset:21504
 v_add_f32 v7, v7, v72
 v_mfma_f32_16x16x32_bf16 v[196:199], a[72:75], v[20:23], v[196:199]
 v_add_f32 v8, v8, v73
 v_mfma_f32_16x16x32_bf16 v[136:139], a[80:83], v[16:19], v[136:139]
 s_add_u32 m0, s29, 8192
 ds_read_b128 a[112:115], v3 offset:6144
 v_mov_b32 v72, v7
 v_mfma_f32_16x16x32_bf16 v[136:139], a[84:87], v[24:27], v[136:139]
 buffer_load_dwordx4 v2, s[8:11], s80 offen lds
 v_mfma_f32_16x16x32_bf16 v[200:203], a[84:87], v[28:31], v[200:203]
 s_add_u32 m0, s29, 12288
 ds_read_b128 a[116:119], v3 offset:22528
 v_mov_b32 v73, v8
 v_mfma_f32_16x16x32_bf16 v[200:203], a[80:83], v[20:23], v[200:203]
 buffer_load_dwordx4 v2, s[8:11], s81 offen lds
 v_mfma_f32_16x16x32_bf16 v[140:143], a[88:91], v[16:19], v[140:143]
 s_add_u32 m0, s29, 16384
 ds_read_b128 a[120:123], v3 offset:7168
 v_mfma_f32_16x16x32_bf16 v[140:143], a[92:95], v[24:27], v[140:143]
 buffer_load_dwordx4 v2, s[8:11], s82 offen lds
 v_mfma_f32_16x16x32_bf16 v[204:207], a[92:95], v[28:31], v[204:207]
 ds_read_b128 a[124:127], v3 offset:23552
 v_permlane16_swap_b32 v7, v72
 v_mfma_f32_16x16x32_bf16 v[204:207], a[88:91], v[20:23], v[204:207]
 s_waitcnt lgkmcnt(6)
 v_permlane16_swap_b32 v8, v73
 v_cvt_pk_bf16_f32 v128, v128, v129
 v_mfma_f32_16x16x32_bf16 v[144:147], a[96:99], v[16:19], v[144:147]
 s_add_u32 m0, s29, 20480
 ds_read_b128 a[64:67], v3 offset:8192
 v_cvt_pk_bf16_f32 v129, v130, v131
 v_mfma_f32_16x16x32_bf16 v[144:147], a[100:103], v[24:27], v[144:147]
 buffer_load_dwordx4 v2, s[8:11], s83 offen lds
 v_mfma_f32_16x16x32_bf16 v[208:211], a[100:103], v[28:31], v[208:211]
 s_add_u32 m0, s29, 24576
 ds_read_b128 a[68:71], v3 offset:24576
 v_add_f32 v7, v7, v72
 v_mfma_f32_16x16x32_bf16 v[208:211], a[96:99], v[20:23], v[208:211]
 s_waitcnt lgkmcnt(6)
 buffer_load_dwordx4 v2, s[8:11], s84 offen lds
 v_mfma_f32_16x16x32_bf16 v[148:151], a[104:107], v[16:19], v[148:151]
 s_add_u32 m0, s29, 28672
 ds_read_b128 a[72:75], v3 offset:9216
 v_add_f32 v8, v8, v73
 v_mfma_f32_16x16x32_bf16 v[148:151], a[108:111], v[24:27], v[148:151]
 buffer_load_dwordx4 v2, s[8:11], s85 offen lds
 v_mfma_f32_16x16x32_bf16 v[212:215], a[108:111], v[28:31], v[212:215]
 ds_read_b128 a[76:79], v3 offset:25600
 v_add_u32 v2, 128, v2
 v_mfma_f32_16x16x32_bf16 v[212:215], a[104:107], v[20:23], v[212:215]
 s_waitcnt lgkmcnt(6)
 v_cvt_pk_bf16_f32 v130, v132, v133
 v_cvt_pk_bf16_f32 v131, v134, v135
 v_mfma_f32_16x16x32_bf16 v[152:155], a[112:115], v[16:19], v[152:155]
 ds_read_b128 a[80:83], v3 offset:10240
 v_cvt_pk_bf16_f32 v192, v192, v193
 v_mfma_f32_16x16x32_bf16 v[152:155], a[116:119], v[24:27], v[152:155]
 buffer_store_dwordx4 v[128:131], v1, s[12:15], s55 offen offset:0 sc1
 v_mfma_f32_16x16x32_bf16 v[216:219], a[116:119], v[28:31], v[216:219]
 ds_read_b128 a[84:87], v3 offset:26624
 v_cvt_pk_bf16_f32 v193, v194, v195
 v_mfma_f32_16x16x32_bf16 v[216:219], a[112:115], v[20:23], v[216:219]
 s_waitcnt lgkmcnt(6)
 v_cvt_pk_bf16_f32 v194, v196, v197
 v_cvt_pk_bf16_f32 v195, v198, v199
 v_mfma_f32_16x16x32_bf16 v[156:159], a[120:123], v[16:19], v[156:159]
 ds_read_b128 a[88:91], v3 offset:11264
 v_cvt_pk_bf16_f32 v136, v136, v137
 v_mfma_f32_16x16x32_bf16 v[156:159], a[124:127], v[24:27], v[156:159]
 buffer_store_dwordx4 v[192:195], v1, s[12:15], s56 offen offset:0 sc1
 v_mfma_f32_16x16x32_bf16 v[220:223], a[124:127], v[28:31], v[220:223]
 ds_read_b128 a[92:95], v3 offset:27648
 v_cvt_pk_bf16_f32 v137, v138, v139
 v_mfma_f32_16x16x32_bf16 v[220:223], a[120:123], v[20:23], v[220:223]
 s_waitcnt lgkmcnt(6)
 v_cvt_pk_bf16_f32 v138, v140, v141
 v_cvt_pk_bf16_f32 v139, v142, v143
 v_mfma_f32_16x16x32_bf16 v[160:163], a[64:67], v[16:19], v[160:163]
 ds_read_b128 a[96:99], v3 offset:12288
 v_cvt_pk_bf16_f32 v200, v200, v201
 v_mfma_f32_16x16x32_bf16 v[160:163], a[68:71], v[24:27], v[160:163]
 buffer_store_dwordx4 v[136:139], v1, s[12:15], s55 offen offset:1024 sc1
 v_mfma_f32_16x16x32_bf16 v[224:227], a[68:71], v[28:31], v[224:227]
 ds_read_b128 a[100:103], v3 offset:28672
 v_cvt_pk_bf16_f32 v201, v202, v203
 v_mfma_f32_16x16x32_bf16 v[224:227], a[64:67], v[20:23], v[224:227]
 s_waitcnt lgkmcnt(6)
 v_cvt_pk_bf16_f32 v202, v204, v205
 v_cvt_pk_bf16_f32 v203, v206, v207
 v_mfma_f32_16x16x32_bf16 v[164:167], a[72:75], v[16:19], v[164:167]
 ds_read_b128 a[104:107], v3 offset:13312
 v_cvt_pk_bf16_f32 v144, v144, v145
 v_mfma_f32_16x16x32_bf16 v[164:167], a[76:79], v[24:27], v[164:167]
 buffer_store_dwordx4 v[200:203], v1, s[12:15], s56 offen offset:1024 sc1
 v_mfma_f32_16x16x32_bf16 v[228:231], a[76:79], v[28:31], v[228:231]
 ds_read_b128 a[108:111], v3 offset:29696
 v_cvt_pk_bf16_f32 v145, v146, v147
 v_mfma_f32_16x16x32_bf16 v[228:231], a[72:75], v[20:23], v[228:231]
 s_waitcnt lgkmcnt(6)
 v_cvt_pk_bf16_f32 v146, v148, v149
 v_cvt_pk_bf16_f32 v147, v150, v151
 v_mfma_f32_16x16x32_bf16 v[168:171], a[80:83], v[16:19], v[168:171]
 ds_read_b128 a[112:115], v3 offset:14336
 v_cvt_pk_bf16_f32 v208, v208, v209
 v_mfma_f32_16x16x32_bf16 v[168:171], a[84:87], v[24:27], v[168:171]
 buffer_store_dwordx4 v[144:147], v1, s[12:15], s55 offen offset:2048 sc1
 v_mfma_f32_16x16x32_bf16 v[232:235], a[84:87], v[28:31], v[232:235]
 ds_read_b128 a[116:119], v3 offset:30720
 v_cvt_pk_bf16_f32 v209, v210, v211
 v_mfma_f32_16x16x32_bf16 v[232:235], a[80:83], v[20:23], v[232:235]
 s_waitcnt lgkmcnt(6)
 v_cvt_pk_bf16_f32 v210, v212, v213
 v_cvt_pk_bf16_f32 v211, v214, v215
 v_mfma_f32_16x16x32_bf16 v[172:175], a[88:91], v[16:19], v[172:175]
 ds_read_b128 a[120:123], v3 offset:15360
 v_cvt_pk_bf16_f32 v152, v152, v153
 v_mfma_f32_16x16x32_bf16 v[172:175], a[92:95], v[24:27], v[172:175]
 buffer_store_dwordx4 v[208:211], v1, s[12:15], s56 offen offset:2048 sc1
 v_mfma_f32_16x16x32_bf16 v[236:239], a[92:95], v[28:31], v[236:239]
 ds_read_b128 a[124:127], v3 offset:31744
 v_cvt_pk_bf16_f32 v153, v154, v155
 v_mfma_f32_16x16x32_bf16 v[236:239], a[88:91], v[20:23], v[236:239]
 s_waitcnt lgkmcnt(6)
 v_cvt_pk_bf16_f32 v154, v156, v157
 v_cvt_pk_bf16_f32 v155, v158, v159
 v_mfma_f32_16x16x32_bf16 v[176:179], a[96:99], v[16:19], v[176:179]
 v_cvt_pk_bf16_f32 v216, v216, v217
 v_cvt_pk_bf16_f32 v217, v218, v219
 v_mfma_f32_16x16x32_bf16 v[176:179], a[100:103], v[24:27], v[176:179]
 buffer_store_dwordx4 v[152:155], v1, s[12:15], s55 offen offset:3072 sc1
 v_mfma_f32_16x16x32_bf16 v[240:243], a[100:103], v[28:31], v[240:243]
 v_cvt_pk_bf16_f32 v218, v220, v221
 v_cvt_pk_bf16_f32 v219, v222, v223
 v_mfma_f32_16x16x32_bf16 v[240:243], a[96:99], v[20:23], v[240:243]
 s_waitcnt lgkmcnt(4)
 v_cvt_pk_bf16_f32 v160, v160, v161
 v_cvt_pk_bf16_f32 v161, v162, v163
 v_mfma_f32_16x16x32_bf16 v[180:183], a[104:107], v[16:19], v[180:183]
 v_cvt_pk_bf16_f32 v162, v164, v165
 v_cvt_pk_bf16_f32 v163, v166, v167
 v_mfma_f32_16x16x32_bf16 v[180:183], a[108:111], v[24:27], v[180:183]
 buffer_store_dwordx4 v[216:219], v1, s[12:15], s56 offen offset:3072 sc1
 v_mfma_f32_16x16x32_bf16 v[244:247], a[108:111], v[28:31], v[244:247]
 v_cvt_pk_bf16_f32 v224, v224, v225
 v_cvt_pk_bf16_f32 v225, v226, v227
 v_mfma_f32_16x16x32_bf16 v[244:247], a[104:107], v[20:23], v[244:247]
 s_waitcnt lgkmcnt(2)
 v_cvt_pk_bf16_f32 v226, v228, v229
 v_cvt_pk_bf16_f32 v227, v230, v231
 v_mfma_f32_16x16x32_bf16 v[184:187], a[112:115], v[16:19], v[184:187]
 v_cvt_pk_bf16_f32 v168, v168, v169
 v_cvt_pk_bf16_f32 v169, v170, v171
 v_mfma_f32_16x16x32_bf16 v[184:187], a[116:119], v[24:27], v[184:187]
 buffer_store_dwordx4 v[160:163], v4, s[12:15], s55 offen offset:0 sc1
 v_mfma_f32_16x16x32_bf16 v[248:251], a[116:119], v[28:31], v[248:251]
 v_cvt_pk_bf16_f32 v170, v172, v173
 v_cvt_pk_bf16_f32 v171, v174, v175
 v_mfma_f32_16x16x32_bf16 v[248:251], a[112:115], v[20:23], v[248:251]
 s_waitcnt lgkmcnt(0)
 v_cvt_pk_bf16_f32 v232, v232, v233
 v_cvt_pk_bf16_f32 v233, v234, v235
 v_mfma_f32_16x16x32_bf16 v[188:191], a[120:123], v[16:19], v[188:191]
 v_cvt_pk_bf16_f32 v234, v236, v237
 v_cvt_pk_bf16_f32 v235, v238, v239
 v_mfma_f32_16x16x32_bf16 v[188:191], a[124:127], v[24:27], v[188:191]
 buffer_store_dwordx4 v[224:227], v4, s[12:15], s56 offen offset:0 sc1
 v_mfma_f32_16x16x32_bf16 v[252:255], a[124:127], v[28:31], v[252:255]
 v_mfma_f32_16x16x32_bf16 v[252:255], a[120:123], v[20:23], v[252:255]
 ds_read_b64_tr_b16 a[0:1], v44 offset:0
 ds_read_b64_tr_b16 a[2:3], v44 offset:2048
 ds_read_b64_tr_b16 a[4:5], v44 offset:4096
 ds_read_b64_tr_b16 a[6:7], v44 offset:6144
 ds_read_b64_tr_b16 a[8:9], v44 offset:8192
 ds_read_b64_tr_b16 a[10:11], v44 offset:10240
 ds_read_b64_tr_b16 a[12:13], v44 offset:12288
 ds_read_b64_tr_b16 a[14:15], v44 offset:14336
 ds_read_b64_tr_b16 a[16:17], v44 offset:16384
 ds_read_b64_tr_b16 a[18:19], v44 offset:18432
 ds_read_b64_tr_b16 a[20:21], v44 offset:20480
 ds_read_b64_tr_b16 a[22:23], v44 offset:22528
 ds_read_b64_tr_b16 a[24:25], v44 offset:24576
 ds_read_b64_tr_b16 a[26:27], v44 offset:26624
 v_mov_b32 v68, v7
 v_mov_b32 v69, v8
 v_mov_b32 v70, v9
 v_mov_b32 v71, v10
 v_accvgpr_read_b32 v64, a200
 v_accvgpr_read_b32 v65, a201
 v_cvt_pk_bf16_f32 v176, v176, v177
 v_cvt_pk_bf16_f32 v177, v178, v179
 v_cvt_pk_bf16_f32 v178, v180, v181
 v_cvt_pk_bf16_f32 v179, v182, v183
 v_cvt_pk_bf16_f32 v240, v240, v241
 v_cvt_pk_bf16_f32 v241, v242, v243
 v_cvt_pk_bf16_f32 v242, v244, v245
 v_cvt_pk_bf16_f32 v243, v246, v247
 v_cvt_pk_bf16_f32 v184, v184, v185
 v_cvt_pk_bf16_f32 v185, v186, v187
 v_cvt_pk_bf16_f32 v186, v188, v189
 v_cvt_pk_bf16_f32 v187, v190, v191
 v_cvt_pk_bf16_f32 v248, v248, v249
 v_cvt_pk_bf16_f32 v249, v250, v251
 v_cvt_pk_bf16_f32 v250, v252, v253
 v_cvt_pk_bf16_f32 v251, v254, v255
L_op0in:
 s_waitcnt lgkmcnt(7)
 v_mfma_f32_16x16x32_bf16 v[72:75], a[0:3], a[128:131], 0
 ds_read_b64_tr_b16 a[28:29], v44 offset:28672
 buffer_store_dwordx4 v[68:71], v1, s[12:15], s57 offen sc1
 v_mfma_f32_16x16x32_bf16 v[72:75], a[4:7], a[132:135], v[72:75]
 s_lshl_b32 s48, s63, 3
 ds_read_b64_tr_b16 a[30:31], v44 offset:30720
 v_xor_b32 v45, 32, v44
 v_mfma_f32_16x16x32_bf16 v[72:75], a[8:11], a[136:139], v[72:75]
 s_waitcnt lgkmcnt(4)
 ds_read_b64_tr_b16 a[32:33], v45 offset:0
 v_xor_b32 v46, 64, v44
 v_mfma_f32_16x16x32_bf16 v[72:75], a[12:15], a[140:143], v[72:75]
 ds_read_b64_tr_b16 a[34:35], v45 offset:2048
 buffer_store_dwordx4 v[168:171], v4, s[12:15], s55 offen offset:1024 sc1
 v_mfma_f32_16x16x32_bf16 v[72:75], a[16:19], a[144:147], v[72:75]
 s_add_u32 s48, s48, s3
 ds_read_b64_tr_b16 a[36:37], v45 offset:4096
 v_xor_b32 v47, 96, v44
 v_mfma_f32_16x16x32_bf16 v[72:75], a[20:23], a[148:151], v[72:75]
 s_waitcnt lgkmcnt(3)
 ds_read_b64_tr_b16 a[38:39], v45 offset:6144
 v_accvgpr_read_b32 v9, a245
 v_mfma_f32_16x16x32_bf16 v[72:75], a[24:27], a[152:155], v[72:75]
 ds_read_b64_tr_b16 a[40:41], v45 offset:8192
 buffer_store_dwordx4 v[232:235], v4, s[12:15], s56 offen offset:1024 sc1
 v_mfma_f32_16x16x32_bf16 v[72:75], a[28:31], a[156:159], v[72:75]
 s_mul_i32 s48, s48, 243712
 ds_read_b64_tr_b16 a[42:43], v45 offset:10240
 v_mfma_f32_16x16x32_bf16 v[80:83], a[0:3], a[160:163], 0
 s_lshl_b32 s58, s26, 10
 ds_read_b64_tr_b16 a[44:45], v45 offset:12288
 v_mfma_f32_16x16x32_bf16 v[80:83], a[4:7], a[164:167], v[80:83]
 ds_read_b64_tr_b16 a[46:47], v45 offset:14336
 buffer_store_dwordx4 v[176:179], v4, s[12:15], s55 offen offset:2048 sc1
 v_mfma_f32_16x16x32_bf16 v[80:83], a[8:11], a[168:171], v[80:83]
 s_add_u32 s48, s48, s58
 ds_read_b64_tr_b16 a[48:49], v45 offset:16384
 v_mfma_f32_16x16x32_bf16 v[80:83], a[12:15], a[172:175], v[80:83]
 s_add_u32 s48, s48, 117440512
 ds_read_b64_tr_b16 a[50:51], v45 offset:18432
 v_mfma_f32_16x16x32_bf16 v[80:83], a[16:19], a[176:179], v[80:83]
 ds_read_b64_tr_b16 a[52:53], v45 offset:20480
 buffer_store_dwordx4 v[240:243], v4, s[12:15], s56 offen offset:2048 sc1
 v_mfma_f32_16x16x32_bf16 v[80:83], a[20:23], a[180:183], v[80:83]
 ds_read_b64_tr_b16 a[54:55], v45 offset:22528
 v_mul_f32 v72, v72, v64
 v_mfma_f32_16x16x32_bf16 v[80:83], a[24:27], a[184:187], v[80:83]
 ds_read_b64_tr_b16 a[56:57], v45 offset:24576
 v_mul_f32 v73, v73, v64
 v_mfma_f32_16x16x32_bf16 v[80:83], a[28:31], a[188:191], v[80:83]
 s_waitcnt lgkmcnt(7)
 ds_read_b64_tr_b16 a[58:59], v45 offset:26624
 buffer_store_dwordx4 v[184:187], v4, s[12:15], s55 offen offset:3072 sc1
 v_mfma_f32_16x16x32_bf16 v[76:79], a[32:35], a[128:131], 0
 ds_read_b64_tr_b16 a[60:61], v45 offset:28672
 v_mul_f32 v74, v74, v64
 v_mfma_f32_16x16x32_bf16 v[76:79], a[36:39], a[132:135], v[76:79]
 ds_read_b64_tr_b16 a[62:63], v45 offset:30720
 v_mul_f32 v75, v75, v64
 v_mfma_f32_16x16x32_bf16 v[76:79], a[40:43], a[136:139], v[76:79]
 s_waitcnt lgkmcnt(4)
 ds_read_b64_tr_b16 a[0:1], v46 offset:0
 buffer_store_dwordx4 v[248:251], v4, s[12:15], s56 offen offset:3072 sc1
 v_mfma_f32_16x16x32_bf16 v[76:79], a[44:47], a[140:143], v[76:79]
 ds_read_b64_tr_b16 a[2:3], v46 offset:2048
 v_mfma_f32_16x16x32_bf16 v[76:79], a[48:51], a[144:147], v[76:79]
 s_add_u32 m0, s29, 32768
 ds_read_b64_tr_b16 a[4:5], v46 offset:4096
 v_mul_f32 v80, v80, v65
 v_mfma_f32_16x16x32_bf16 v[76:79], a[52:55], a[148:151], v[76:79]
 s_waitcnt lgkmcnt(3)
 ds_read_b64_tr_b16 a[6:7], v46 offset:6144
 buffer_load_dwordx4 v2, s[8:11], s78 offen lds
 v_mfma_f32_16x16x32_bf16 v[76:79], a[56:59], a[152:155], v[76:79]
 ds_read_b64_tr_b16 a[8:9], v46 offset:8192
 v_mul_f32 v81, v81, v65
 v_mfma_f32_16x16x32_bf16 v[76:79], a[60:63], a[156:159], v[76:79]
 ds_read_b64_tr_b16 a[10:11], v46 offset:10240
 v_mul_f32 v82, v82, v65
 v_mfma_f32_16x16x32_bf16 v[84:87], a[32:35], a[160:163], 0
 ds_read_b64_tr_b16 a[12:13], v46 offset:12288
 v_mul_f32 v83, v83, v65
 v_mfma_f32_16x16x32_bf16 v[84:87], a[36:39], a[164:167], v[84:87]
 ds_read_b64_tr_b16 a[14:15], v46 offset:14336
 v_mfma_f32_16x16x32_bf16 v[84:87], a[40:43], a[168:171], v[84:87]
 ds_read_b64_tr_b16 a[16:17], v46 offset:16384
 v_mfma_f32_16x16x32_bf16 v[84:87], a[44:47], a[172:175], v[84:87]
 s_add_u32 m0, s29, 36864
 ds_read_b64_tr_b16 a[18:19], v46 offset:18432
 v_mfma_f32_16x16x32_bf16 v[84:87], a[48:51], a[176:179], v[84:87]
 ds_read_b64_tr_b16 a[20:21], v46 offset:20480
 buffer_load_dwordx4 v2, s[8:11], s79 offen lds
 v_mfma_f32_16x16x32_bf16 v[84:87], a[52:55], a[180:183], v[84:87]
 ds_read_b64_tr_b16 a[22:23], v46 offset:22528
 v_mul_f32 v76, v76, v64
 v_mfma_f32_16x16x32_bf16 v[84:87], a[56:59], a[184:187], v[84:87]
 ds_read_b64_tr_b16 a[24:25], v46 offset:24576
 v_mul_f32 v77, v77, v64
 v_mfma_f32_16x16x32_bf16 v[84:87], a[60:63], a[188:191], v[84:87]
 s_waitcnt lgkmcnt(7)
 ds_read_b64_tr_b16 a[26:27], v46 offset:26624
 v_mul_f32 v78, v78, v64
 v_mfma_f32_16x16x32_bf16 v[88:91], a[0:3], a[128:131], 0
 ds_read_b64_tr_b16 a[28:29], v46 offset:28672
 v_mul_f32 v79, v79, v64
 v_mfma_f32_16x16x32_bf16 v[88:91], a[4:7], a[132:135], v[88:91]
 s_add_u32 m0, s29, 40960
 ds_read_b64_tr_b16 a[30:31], v46 offset:30720
 v_cvt_pk_bf16_f32 v72, v72, v73
 v_mfma_f32_16x16x32_bf16 v[88:91], a[8:11], a[136:139], v[88:91]
 s_waitcnt lgkmcnt(4)
 ds_read_b64_tr_b16 a[32:33], v47 offset:0
 v_cvt_pk_bf16_f32 v73, v74, v75
 v_mfma_f32_16x16x32_bf16 v[88:91], a[12:15], a[140:143], v[88:91]
 ds_read_b64_tr_b16 a[34:35], v47 offset:2048
 buffer_load_dwordx4 v2, s[8:11], s80 offen lds
 v_mfma_f32_16x16x32_bf16 v[88:91], a[16:19], a[144:147], v[88:91]
 s_add_u32 s58, s48, 0
 ds_read_b64_tr_b16 a[36:37], v47 offset:4096
 v_cvt_pk_bf16_f32 v74, v76, v77
 v_mfma_f32_16x16x32_bf16 v[88:91], a[20:23], a[148:151], v[88:91]
 s_waitcnt lgkmcnt(3)
 ds_read_b64_tr_b16 a[38:39], v47 offset:6144
 v_cvt_pk_bf16_f32 v75, v78, v79
 v_mfma_f32_16x16x32_bf16 v[88:91], a[24:27], a[152:155], v[88:91]
 ds_read_b64_tr_b16 a[40:41], v47 offset:8192
 buffer_store_dwordx4 v[72:75], v1, s[12:15], s58 offen sc1
 v_mfma_f32_16x16x32_bf16 v[88:91], a[28:31], a[156:159], v[88:91]
 s_waitcnt vmcnt(4)
 ds_read_b64_tr_b16 a[42:43], v47 offset:10240
 v_mul_f32 v84, v84, v65
 v_mfma_f32_16x16x32_bf16 v[96:99], a[0:3], a[160:163], 0
 s_barrier
 ds_read_b64_tr_b16 a[44:45], v47 offset:12288
 v_mul_f32 v85, v85, v65
 v_mfma_f32_16x16x32_bf16 v[96:99], a[4:7], a[164:167], v[96:99]
 ds_read_b64_tr_b16 a[46:47], v47 offset:14336
 buffer_store_dword v9, v9, s[12:15], s59 offen sc1
 v_mfma_f32_16x16x32_bf16 v[96:99], a[8:11], a[168:171], v[96:99]
 s_add_u32 m0, s29, 45056
 ds_read_b64_tr_b16 a[48:49], v47 offset:16384
 v_mul_f32 v86, v86, v65
 v_mfma_f32_16x16x32_bf16 v[96:99], a[12:15], a[172:175], v[96:99]
 ds_read_b64_tr_b16 a[50:51], v47 offset:18432
 buffer_load_dwordx4 v2, s[8:11], s81 offen lds
 v_mfma_f32_16x16x32_bf16 v[96:99], a[16:19], a[176:179], v[96:99]
 ds_read_b64_tr_b16 a[52:53], v47 offset:20480
 v_mul_f32 v87, v87, v65
 v_mfma_f32_16x16x32_bf16 v[96:99], a[20:23], a[180:183], v[96:99]
 ds_read_b64_tr_b16 a[54:55], v47 offset:22528
 v_cvt_pk_bf16_f32 v80, v80, v81
 v_mfma_f32_16x16x32_bf16 v[96:99], a[24:27], a[184:187], v[96:99]
 ds_read_b64_tr_b16 a[56:57], v47 offset:24576
 v_cvt_pk_bf16_f32 v81, v82, v83
 v_mfma_f32_16x16x32_bf16 v[96:99], a[28:31], a[188:191], v[96:99]
 s_waitcnt lgkmcnt(7)
 ds_read_b64_tr_b16 a[58:59], v47 offset:26624
 v_cvt_pk_bf16_f32 v82, v84, v85
 v_mfma_f32_16x16x32_bf16 v[92:95], a[32:35], a[128:131], 0
 ds_read_b64_tr_b16 a[60:61], v47 offset:28672
 v_cvt_pk_bf16_f32 v83, v86, v87
 v_mfma_f32_16x16x32_bf16 v[92:95], a[36:39], a[132:135], v[92:95]
 s_add_u32 m0, s29, 49152
 ds_read_b64_tr_b16 a[62:63], v47 offset:30720
 v_xor_b32 v44, 0x20000, v44
 v_mfma_f32_16x16x32_bf16 v[92:95], a[40:43], a[136:139], v[92:95]
 s_waitcnt lgkmcnt(4)
 ds_read_b64_tr_b16 a[0:1], v44 offset:0
 buffer_load_dwordx4 v2, s[8:11], s82 offen lds
 v_mfma_f32_16x16x32_bf16 v[92:95], a[44:47], a[140:143], v[92:95]
 s_add_u32 s58, s48, 974848
 ds_read_b64_tr_b16 a[2:3], v44 offset:2048
 v_mul_f32 v88, v88, v64
 v_mfma_f32_16x16x32_bf16 v[92:95], a[48:51], a[144:147], v[92:95]
 ds_read_b64_tr_b16 a[4:5], v44 offset:4096
 buffer_store_dwordx4 v[80:83], v1, s[12:15], s58 offen sc1
 v_mfma_f32_16x16x32_bf16 v[92:95], a[52:55], a[148:151], v[92:95]
 s_waitcnt lgkmcnt(3)
 ds_read_b64_tr_b16 a[6:7], v44 offset:6144
 v_mul_f32 v89, v89, v64
 v_mfma_f32_16x16x32_bf16 v[92:95], a[56:59], a[152:155], v[92:95]
 ds_read_b64_tr_b16 a[8:9], v44 offset:8192
 v_mul_f32 v90, v90, v64
 v_mfma_f32_16x16x32_bf16 v[92:95], a[60:63], a[156:159], v[92:95]
 ds_read_b64_tr_b16 a[10:11], v44 offset:10240
 v_mul_f32 v91, v91, v64
 v_mfma_f32_16x16x32_bf16 v[100:103], a[32:35], a[160:163], 0
 s_add_u32 m0, s29, 53248
 ds_read_b64_tr_b16 a[12:13], v44 offset:12288
 v_mul_f32 v96, v96, v65
 v_mfma_f32_16x16x32_bf16 v[100:103], a[36:39], a[164:167], v[100:103]
 ds_read_b64_tr_b16 a[14:15], v44 offset:14336
 buffer_load_dwordx4 v2, s[8:11], s83 offen lds
 v_mfma_f32_16x16x32_bf16 v[100:103], a[40:43], a[168:171], v[100:103]
 ds_read_b64_tr_b16 a[16:17], v44 offset:16384
 v_mul_f32 v97, v97, v65
 v_mfma_f32_16x16x32_bf16 v[100:103], a[44:47], a[172:175], v[100:103]
 ds_read_b64_tr_b16 a[18:19], v44 offset:18432
 v_mul_f32 v98, v98, v65
 v_mfma_f32_16x16x32_bf16 v[100:103], a[48:51], a[176:179], v[100:103]
 ds_read_b64_tr_b16 a[20:21], v44 offset:20480
 v_mul_f32 v92, v92, v64
 v_mfma_f32_16x16x32_bf16 v[100:103], a[52:55], a[180:183], v[100:103]
 ds_read_b64_tr_b16 a[22:23], v44 offset:22528
 v_mul_f32 v93, v93, v64
 v_mfma_f32_16x16x32_bf16 v[100:103], a[56:59], a[184:187], v[100:103]
 s_add_u32 m0, s29, 57344
 ds_read_b64_tr_b16 a[24:25], v44 offset:24576
 v_mul_f32 v94, v94, v64
 v_mfma_f32_16x16x32_bf16 v[100:103], a[60:63], a[188:191], v[100:103]
 s_waitcnt lgkmcnt(7)
 ds_read_b64_tr_b16 a[26:27], v44 offset:26624
 v_mul_f32 v95, v95, v64
 v_mfma_f32_16x16x32_bf16 v[104:107], a[0:3], a[128:131], 0
 ds_read_b64_tr_b16 a[28:29], v44 offset:28672
 buffer_load_dwordx4 v2, s[8:11], s84 offen lds
 v_mfma_f32_16x16x32_bf16 v[104:107], a[4:7], a[132:135], v[104:107]
 ds_read_b64_tr_b16 a[30:31], v44 offset:30720
 v_xor_b32 v45, 0x20000, v45
 v_mfma_f32_16x16x32_bf16 v[104:107], a[8:11], a[136:139], v[104:107]
 s_waitcnt lgkmcnt(4)
 ds_read_b64_tr_b16 a[32:33], v45 offset:0
 v_cvt_pk_bf16_f32 v88, v88, v89
 v_mfma_f32_16x16x32_bf16 v[104:107], a[12:15], a[140:143], v[104:107]
 ds_read_b64_tr_b16 a[34:35], v45 offset:2048
 v_cvt_pk_bf16_f32 v89, v90, v91
 v_mfma_f32_16x16x32_bf16 v[104:107], a[16:19], a[144:147], v[104:107]
 ds_read_b64_tr_b16 a[36:37], v45 offset:4096
 v_cvt_pk_bf16_f32 v90, v92, v93
 v_mfma_f32_16x16x32_bf16 v[104:107], a[20:23], a[148:151], v[104:107]
 s_waitcnt lgkmcnt(3)
 ds_read_b64_tr_b16 a[38:39], v45 offset:6144
 v_cvt_pk_bf16_f32 v91, v94, v95
 v_mfma_f32_16x16x32_bf16 v[104:107], a[24:27], a[152:155], v[104:107]
 s_add_u32 m0, s29, 61440
 ds_read_b64_tr_b16 a[40:41], v45 offset:8192
 v_mul_f32 v99, v99, v65
 v_mfma_f32_16x16x32_bf16 v[104:107], a[28:31], a[156:159], v[104:107]
 ds_read_b64_tr_b16 a[42:43], v45 offset:10240
 buffer_load_dwordx4 v2, s[8:11], s85 offen lds
 v_mfma_f32_16x16x32_bf16 v[112:115], a[0:3], a[160:163], 0
 s_add_u32 s58, s48, 17408
 ds_read_b64_tr_b16 a[44:45], v45 offset:12288
 v_add_u32 v2, 128, v2
 v_mfma_f32_16x16x32_bf16 v[112:115], a[4:7], a[164:167], v[112:115]
 ds_read_b64_tr_b16 a[46:47], v45 offset:14336
 buffer_store_dwordx4 v[88:91], v1, s[12:15], s58 offen sc1
 v_mfma_f32_16x16x32_bf16 v[112:115], a[8:11], a[168:171], v[112:115]
 ds_read_b64_tr_b16 a[48:49], v45 offset:16384
 v_mul_f32 v100, v100, v65
 v_mfma_f32_16x16x32_bf16 v[112:115], a[12:15], a[172:175], v[112:115]
 ds_read_b64_tr_b16 a[50:51], v45 offset:18432
 v_mul_f32 v101, v101, v65
 v_mfma_f32_16x16x32_bf16 v[112:115], a[16:19], a[176:179], v[112:115]
 ds_read_b64_tr_b16 a[52:53], v45 offset:20480
 v_mul_f32 v102, v102, v65
 v_mfma_f32_16x16x32_bf16 v[112:115], a[20:23], a[180:183], v[112:115]
 s_add_u32 m0, s29, 65536
 ds_read_b64_tr_b16 a[54:55], v45 offset:22528
 v_mul_f32 v103, v103, v65
 v_mfma_f32_16x16x32_bf16 v[112:115], a[24:27], a[184:187], v[112:115]
 ds_read_b64_tr_b16 a[56:57], v45 offset:24576
 buffer_load_dwordx4 v2, s[8:11], s78 offen lds
 v_mfma_f32_16x16x32_bf16 v[112:115], a[28:31], a[188:191], v[112:115]
 s_waitcnt lgkmcnt(7)
 ds_read_b64_tr_b16 a[58:59], v45 offset:26624
 v_cvt_pk_bf16_f32 v96, v96, v97
 v_mfma_f32_16x16x32_bf16 v[108:111], a[32:35], a[128:131], 0
 ds_read_b64_tr_b16 a[60:61], v45 offset:28672
 v_cvt_pk_bf16_f32 v97, v98, v99
 v_mfma_f32_16x16x32_bf16 v[108:111], a[36:39], a[132:135], v[108:111]
 ds_read_b64_tr_b16 a[62:63], v45 offset:30720
 v_xor_b32 v46, 0x20000, v46
 v_mfma_f32_16x16x32_bf16 v[108:111], a[40:43], a[136:139], v[108:111]
 s_waitcnt lgkmcnt(4)
 ds_read_b64_tr_b16 a[0:1], v46 offset:0
 v_cvt_pk_bf16_f32 v98, v100, v101
 v_mfma_f32_16x16x32_bf16 v[108:111], a[44:47], a[140:143], v[108:111]
 ds_read_b64_tr_b16 a[2:3], v46 offset:2048
 v_cvt_pk_bf16_f32 v99, v102, v103
 v_mfma_f32_16x16x32_bf16 v[108:111], a[48:51], a[144:147], v[108:111]
 s_add_u32 m0, s29, 69632
 ds_read_b64_tr_b16 a[4:5], v46 offset:4096
 v_mul_f32 v104, v104, v64
 v_mfma_f32_16x16x32_bf16 v[108:111], a[52:55], a[148:151], v[108:111]
 s_waitcnt lgkmcnt(3)
 ds_read_b64_tr_b16 a[6:7], v46 offset:6144
 buffer_load_dwordx4 v2, s[8:11], s79 offen lds
 v_mfma_f32_16x16x32_bf16 v[108:111], a[56:59], a[152:155], v[108:111]
 s_add_u32 s58, s48, 992256
 ds_read_b64_tr_b16 a[8:9], v46 offset:8192
 v_mul_f32 v105, v105, v64
 v_mfma_f32_16x16x32_bf16 v[108:111], a[60:63], a[156:159], v[108:111]
 ds_read_b64_tr_b16 a[10:11], v46 offset:10240
 buffer_store_dwordx4 v[96:99], v1, s[12:15], s58 offen sc1
 v_mfma_f32_16x16x32_bf16 v[116:119], a[32:35], a[160:163], 0
 ds_read_b64_tr_b16 a[12:13], v46 offset:12288
 v_mul_f32 v106, v106, v64
 v_mfma_f32_16x16x32_bf16 v[116:119], a[36:39], a[164:167], v[116:119]
 ds_read_b64_tr_b16 a[14:15], v46 offset:14336
 v_mul_f32 v107, v107, v64
 v_mfma_f32_16x16x32_bf16 v[116:119], a[40:43], a[168:171], v[116:119]
 ds_read_b64_tr_b16 a[16:17], v46 offset:16384
 v_mul_f32 v112, v112, v65
 v_mfma_f32_16x16x32_bf16 v[116:119], a[44:47], a[172:175], v[116:119]
 s_add_u32 m0, s29, 73728
 ds_read_b64_tr_b16 a[18:19], v46 offset:18432
 v_mul_f32 v113, v113, v65
 v_mfma_f32_16x16x32_bf16 v[116:119], a[48:51], a[176:179], v[116:119]
 ds_read_b64_tr_b16 a[20:21], v46 offset:20480
 buffer_load_dwordx4 v2, s[8:11], s80 offen lds
 v_mfma_f32_16x16x32_bf16 v[116:119], a[52:55], a[180:183], v[116:119]
 ds_read_b64_tr_b16 a[22:23], v46 offset:22528
 v_mul_f32 v108, v108, v64
 v_mfma_f32_16x16x32_bf16 v[116:119], a[56:59], a[184:187], v[116:119]
 ds_read_b64_tr_b16 a[24:25], v46 offset:24576
 v_mul_f32 v109, v109, v64
 v_mfma_f32_16x16x32_bf16 v[116:119], a[60:63], a[188:191], v[116:119]
 s_waitcnt lgkmcnt(7)
 ds_read_b64_tr_b16 a[26:27], v46 offset:26624
 v_mul_f32 v110, v110, v64
 v_mfma_f32_16x16x32_bf16 v[72:75], a[0:3], a[128:131], 0
 ds_read_b64_tr_b16 a[28:29], v46 offset:28672
 v_mul_f32 v111, v111, v64
 v_mfma_f32_16x16x32_bf16 v[72:75], a[4:7], a[132:135], v[72:75]
 s_add_u32 m0, s29, 77824
 ds_read_b64_tr_b16 a[30:31], v46 offset:30720
 v_xor_b32 v47, 0x20000, v47
 v_mfma_f32_16x16x32_bf16 v[72:75], a[8:11], a[136:139], v[72:75]
 s_waitcnt lgkmcnt(4)
 ds_read_b64_tr_b16 a[32:33], v47 offset:0
 v_cvt_pk_bf16_f32 v104, v104, v105
 v_mfma_f32_16x16x32_bf16 v[72:75], a[12:15], a[140:143], v[72:75]
 ds_read_b64_tr_b16 a[34:35], v47 offset:2048
 buffer_load_dwordx4 v2, s[8:11], s81 offen lds
 v_mfma_f32_16x16x32_bf16 v[72:75], a[16:19], a[144:147], v[72:75]
 ds_read_b64_tr_b16 a[36:37], v47 offset:4096
 v_cvt_pk_bf16_f32 v105, v106, v107
 v_mfma_f32_16x16x32_bf16 v[72:75], a[20:23], a[148:151], v[72:75]
 s_waitcnt lgkmcnt(3)
 ds_read_b64_tr_b16 a[38:39], v47 offset:6144
 v_cvt_pk_bf16_f32 v106, v108, v109
 v_mfma_f32_16x16x32_bf16 v[72:75], a[24:27], a[152:155], v[72:75]
 s_add_u32 s58, s48, 34816
 ds_read_b64_tr_b16 a[40:41], v47 offset:8192
 v_cvt_pk_bf16_f32 v107, v110, v111
 v_mfma_f32_16x16x32_bf16 v[72:75], a[28:31], a[156:159], v[72:75]
 ds_read_b64_tr_b16 a[42:43], v47 offset:10240
 buffer_store_dwordx4 v[104:107], v1, s[12:15], s58 offen sc1
 v_mfma_f32_16x16x32_bf16 v[80:83], a[0:3], a[160:163], 0
 ds_read_b64_tr_b16 a[44:45], v47 offset:12288
 v_mul_f32 v114, v114, v65
 v_mfma_f32_16x16x32_bf16 v[80:83], a[4:7], a[164:167], v[80:83]
 s_add_u32 m0, s29, 81920
 ds_read_b64_tr_b16 a[46:47], v47 offset:14336
 v_mul_f32 v115, v115, v65
 v_mfma_f32_16x16x32_bf16 v[80:83], a[8:11], a[168:171], v[80:83]
 ds_read_b64_tr_b16 a[48:49], v47 offset:16384
 buffer_load_dwordx4 v2, s[8:11], s82 offen lds
 v_mfma_f32_16x16x32_bf16 v[80:83], a[12:15], a[172:175], v[80:83]
 ds_read_b64_tr_b16 a[50:51], v47 offset:18432
 v_mul_f32 v116, v116, v65
 v_mfma_f32_16x16x32_bf16 v[80:83], a[16:19], a[176:179], v[80:83]
 ds_read_b64_tr_b16 a[52:53], v47 offset:20480
 v_mul_f32 v117, v117, v65
 v_mfma_f32_16x16x32_bf16 v[80:83], a[20:23], a[180:183], v[80:83]
 ds_read_b64_tr_b16 a[54:55], v47 offset:22528
 v_mul_f32 v118, v118, v65
 v_mfma_f32_16x16x32_bf16 v[80:83], a[24:27], a[184:187], v[80:83]
 ds_read_b64_tr_b16 a[56:57], v47 offset:24576
 v_mul_f32 v119, v119, v65
 v_mfma_f32_16x16x32_bf16 v[80:83], a[28:31], a[188:191], v[80:83]
 s_waitcnt lgkmcnt(7)
 ds_read_b64_tr_b16 a[58:59], v47 offset:26624
 v_cvt_pk_bf16_f32 v112, v112, v113
 v_mfma_f32_16x16x32_bf16 v[76:79], a[32:35], a[128:131], 0
 s_waitcnt vmcnt(8)
 ds_read_b64_tr_b16 a[60:61], v47 offset:28672
 v_cvt_pk_bf16_f32 v113, v114, v115
 v_mfma_f32_16x16x32_bf16 v[76:79], a[36:39], a[132:135], v[76:79]
 s_barrier
 ds_read_b64_tr_b16 a[62:63], v47 offset:30720
 v_cvt_pk_bf16_f32 v114, v116, v117
 v_mfma_f32_16x16x32_bf16 v[76:79], a[40:43], a[136:139], v[76:79]
 s_waitcnt lgkmcnt(4)
 ds_read_b64_tr_b16 a[0:1], v44 offset:32768
 v_cvt_pk_bf16_f32 v115, v118, v119
 v_mfma_f32_16x16x32_bf16 v[76:79], a[44:47], a[140:143], v[76:79]
 s_add_u32 m0, s29, 86016
 ds_read_b64_tr_b16 a[2:3], v44 offset:34816
 v_mul_f32 v72, v72, v64
 v_mfma_f32_16x16x32_bf16 v[76:79], a[48:51], a[144:147], v[76:79]
 ds_read_b64_tr_b16 a[4:5], v44 offset:36864
 buffer_load_dwordx4 v2, s[8:11], s83 offen lds
 v_mfma_f32_16x16x32_bf16 v[76:79], a[52:55], a[148:151], v[76:79]
 s_waitcnt lgkmcnt(3)
 ds_read_b64_tr_b16 a[6:7], v44 offset:38912
 v_mul_f32 v73, v73, v64
 v_mfma_f32_16x16x32_bf16 v[76:79], a[56:59], a[152:155], v[76:79]
 s_add_u32 s58, s48, 1009664
 ds_read_b64_tr_b16 a[8:9], v44 offset:40960
 v_mul_f32 v74, v74, v64
 v_mfma_f32_16x16x32_bf16 v[76:79], a[60:63], a[156:159], v[76:79]
 ds_read_b64_tr_b16 a[10:11], v44 offset:43008
 buffer_store_dwordx4 v[112:115], v1, s[12:15], s58 offen sc1
 v_mfma_f32_16x16x32_bf16 v[84:87], a[32:35], a[160:163], 0
 ds_read_b64_tr_b16 a[12:13], v44 offset:45056
 v_mul_f32 v75, v75, v64
 v_mfma_f32_16x16x32_bf16 v[84:87], a[36:39], a[164:167], v[84:87]
 ds_read_b64_tr_b16 a[14:15], v44 offset:47104
 v_mul_f32 v80, v80, v65
 v_mfma_f32_16x16x32_bf16 v[84:87], a[40:43], a[168:171], v[84:87]
 s_add_u32 m0, s29, 90112
 ds_read_b64_tr_b16 a[16:17], v44 offset:49152
 v_mul_f32 v81, v81, v65
 v_mfma_f32_16x16x32_bf16 v[84:87], a[44:47], a[172:175], v[84:87]
 ds_read_b64_tr_b16 a[18:19], v44 offset:51200
 buffer_load_dwordx4 v2, s[8:11], s84 offen lds
 v_mfma_f32_16x16x32_bf16 v[84:87], a[48:51], a[176:179], v[84:87]
 ds_read_b64_tr_b16 a[20:21], v44 offset:53248
 v_mul_f32 v76, v76, v64
 v_mfma_f32_16x16x32_bf16 v[84:87], a[52:55], a[180:183], v[84:87]
 ds_read_b64_tr_b16 a[22:23], v44 offset:55296
 v_mul_f32 v77, v77, v64
 v_mfma_f32_16x16x32_bf16 v[84:87], a[56:59], a[184:187], v[84:87]
 ds_read_b64_tr_b16 a[24:25], v44 offset:57344
 v_mul_f32 v78, v78, v64
 v_mfma_f32_16x16x32_bf16 v[84:87], a[60:63], a[188:191], v[84:87]
 s_waitcnt lgkmcnt(7)
 ds_read_b64_tr_b16 a[26:27], v44 offset:59392
 v_mul_f32 v79, v79, v64
 v_mfma_f32_16x16x32_bf16 v[88:91], a[0:3], a[128:131], 0
 ds_read_b64_tr_b16 a[28:29], v44 offset:61440
 v_cvt_pk_bf16_f32 v72, v72, v73
 v_mfma_f32_16x16x32_bf16 v[88:91], a[4:7], a[132:135], v[88:91]
 s_add_u32 m0, s29, 94208
 ds_read_b64_tr_b16 a[30:31], v44 offset:63488
 v_cvt_pk_bf16_f32 v73, v74, v75
 v_mfma_f32_16x16x32_bf16 v[88:91], a[8:11], a[136:139], v[88:91]
 s_waitcnt lgkmcnt(4)
 ds_read_b64_tr_b16 a[32:33], v45 offset:32768
 buffer_load_dwordx4 v2, s[8:11], s85 offen lds
 v_mfma_f32_16x16x32_bf16 v[88:91], a[12:15], a[140:143], v[88:91]
 ds_read_b64_tr_b16 a[34:35], v45 offset:34816
 v_add_u32 v2, 128, v2
 v_mfma_f32_16x16x32_bf16 v[88:91], a[16:19], a[144:147], v[88:91]
 s_add_u32 s58, s48, 52224
 ds_read_b64_tr_b16 a[36:37], v45 offset:36864
 v_cvt_pk_bf16_f32 v74, v76, v77
 v_mfma_f32_16x16x32_bf16 v[88:91], a[20:23], a[148:151], v[88:91]
 s_waitcnt lgkmcnt(3)
 ds_read_b64_tr_b16 a[38:39], v45 offset:38912
 v_cvt_pk_bf16_f32 v75, v78, v79
 v_mfma_f32_16x16x32_bf16 v[88:91], a[24:27], a[152:155], v[88:91]
 ds_read_b64_tr_b16 a[40:41], v45 offset:40960
 buffer_store_dwordx4 v[72:75], v1, s[12:15], s58 offen sc1
 v_mfma_f32_16x16x32_bf16 v[88:91], a[28:31], a[156:159], v[88:91]
 ds_read_b64_tr_b16 a[42:43], v45 offset:43008
 v_mul_f32 v82, v82, v65
 v_mfma_f32_16x16x32_bf16 v[96:99], a[0:3], a[160:163], 0
 s_add_u32 m0, s29, 98304
 ds_read_b64_tr_b16 a[44:45], v45 offset:45056
 v_mul_f32 v83, v83, v65
 v_mfma_f32_16x16x32_bf16 v[96:99], a[4:7], a[164:167], v[96:99]
 ds_read_b64_tr_b16 a[46:47], v45 offset:47104
 buffer_load_dwordx4 v2, s[8:11], s78 offen lds
 v_mfma_f32_16x16x32_bf16 v[96:99], a[8:11], a[168:171], v[96:99]
 ds_read_b64_tr_b16 a[48:49], v45 offset:49152
 v_mul_f32 v84, v84, v65
 v_mfma_f32_16x16x32_bf16 v[96:99], a[12:15], a[172:175], v[96:99]
 ds_read_b64_tr_b16 a[50:51], v45 offset:51200
 v_mul_f32 v85, v85, v65
 v_mfma_f32_16x16x32_bf16 v[96:99], a[16:19], a[176:179], v[96:99]
 ds_read_b64_tr_b16 a[52:53], v45 offset:53248
 v_mul_f32 v86, v86, v65
 v_mfma_f32_16x16x32_bf16 v[96:99], a[20:23], a[180:183], v[96:99]
 ds_read_b64_tr_b16 a[54:55], v45 offset:55296
 v_mul_f32 v87, v87, v65
 v_mfma_f32_16x16x32_bf16 v[96:99], a[24:27], a[184:187], v[96:99]
 s_add_u32 m0, s29, 102400
 ds_read_b64_tr_b16 a[56:57], v45 offset:57344
 v_cvt_pk_bf16_f32 v80, v80, v81
 v_mfma_f32_16x16x32_bf16 v[96:99], a[28:31], a[188:191], v[96:99]
 s_waitcnt lgkmcnt(7)
 ds_read_b64_tr_b16 a[58:59], v45 offset:59392
 v_cvt_pk_bf16_f32 v81, v82, v83
 v_mfma_f32_16x16x32_bf16 v[92:95], a[32:35], a[128:131], 0
 ds_read_b64_tr_b16 a[60:61], v45 offset:61440
 buffer_load_dwordx4 v2, s[8:11], s79 offen lds
 v_mfma_f32_16x16x32_bf16 v[92:95], a[36:39], a[132:135], v[92:95]
 s_add_u32 s58, s48, 1027072
 ds_read_b64_tr_b16 a[62:63], v45 offset:63488
 v_cvt_pk_bf16_f32 v82, v84, v85
 v_mfma_f32_16x16x32_bf16 v[92:95], a[40:43], a[136:139], v[92:95]
 s_waitcnt lgkmcnt(4)
 ds_read_b64_tr_b16 a[0:1], v46 offset:32768
 v_cvt_pk_bf16_f32 v83, v86, v87
 v_mfma_f32_16x16x32_bf16 v[92:95], a[44:47], a[140:143], v[92:95]
 ds_read_b64_tr_b16 a[2:3], v46 offset:34816
 buffer_store_dwordx4 v[80:83], v1, s[12:15], s58 offen sc1
 v_mfma_f32_16x16x32_bf16 v[92:95], a[48:51], a[144:147], v[92:95]
 ds_read_b64_tr_b16 a[4:5], v46 offset:36864
 v_mul_f32 v88, v88, v64
 v_mfma_f32_16x16x32_bf16 v[92:95], a[52:55], a[148:151], v[92:95]
 s_waitcnt lgkmcnt(3)
 ds_read_b64_tr_b16 a[6:7], v46 offset:38912
 v_mul_f32 v89, v89, v64
 v_mfma_f32_16x16x32_bf16 v[92:95], a[56:59], a[152:155], v[92:95]
 s_add_u32 m0, s29, 106496
 ds_read_b64_tr_b16 a[8:9], v46 offset:40960
 v_mul_f32 v90, v90, v64
 v_mfma_f32_16x16x32_bf16 v[92:95], a[60:63], a[156:159], v[92:95]
 ds_read_b64_tr_b16 a[10:11], v46 offset:43008
 buffer_load_dwordx4 v2, s[8:11], s80 offen lds
 v_mfma_f32_16x16x32_bf16 v[100:103], a[32:35], a[160:163], 0
 ds_read_b64_tr_b16 a[12:13], v46 offset:45056
 v_mul_f32 v91, v91, v64
 v_mfma_f32_16x16x32_bf16 v[100:103], a[36:39], a[164:167], v[100:103]
 ds_read_b64_tr_b16 a[14:15], v46 offset:47104
 v_mul_f32 v96, v96, v65
 v_mfma_f32_16x16x32_bf16 v[100:103], a[40:43], a[168:171], v[100:103]
 ds_read_b64_tr_b16 a[16:17], v46 offset:49152
 v_mul_f32 v97, v97, v65
 v_mfma_f32_16x16x32_bf16 v[100:103], a[44:47], a[172:175], v[100:103]
 ds_read_b64_tr_b16 a[18:19], v46 offset:51200
 v_mul_f32 v98, v98, v65
 v_mfma_f32_16x16x32_bf16 v[100:103], a[48:51], a[176:179], v[100:103]
 ds_read_b64_tr_b16 a[20:21], v46 offset:53248
 v_mul_f32 v92, v92, v64
 v_mfma_f32_16x16x32_bf16 v[100:103], a[52:55], a[180:183], v[100:103]
 s_add_u32 m0, s29, 110592
 ds_read_b64_tr_b16 a[22:23], v46 offset:55296
 v_mul_f32 v93, v93, v64
 v_mfma_f32_16x16x32_bf16 v[100:103], a[56:59], a[184:187], v[100:103]
 ds_read_b64_tr_b16 a[24:25], v46 offset:57344
 buffer_load_dwordx4 v2, s[8:11], s81 offen lds
 v_mfma_f32_16x16x32_bf16 v[100:103], a[60:63], a[188:191], v[100:103]
 s_waitcnt lgkmcnt(7)
 ds_read_b64_tr_b16 a[26:27], v46 offset:59392
 v_mul_f32 v94, v94, v64
 v_mfma_f32_16x16x32_bf16 v[104:107], a[0:3], a[128:131], 0
 ds_read_b64_tr_b16 a[28:29], v46 offset:61440
 v_mul_f32 v95, v95, v64
 v_mfma_f32_16x16x32_bf16 v[104:107], a[4:7], a[132:135], v[104:107]
 ds_read_b64_tr_b16 a[30:31], v46 offset:63488
 v_cvt_pk_bf16_f32 v88, v88, v89
 v_mfma_f32_16x16x32_bf16 v[104:107], a[8:11], a[136:139], v[104:107]
 s_waitcnt lgkmcnt(4)
 ds_read_b64_tr_b16 a[32:33], v47 offset:32768
 v_cvt_pk_bf16_f32 v89, v90, v91
 v_mfma_f32_16x16x32_bf16 v[104:107], a[12:15], a[140:143], v[104:107]
 ds_read_b64_tr_b16 a[34:35], v47 offset:34816
 v_cvt_pk_bf16_f32 v90, v92, v93
 v_mfma_f32_16x16x32_bf16 v[104:107], a[16:19], a[144:147], v[104:107]
 s_add_u32 m0, s29, 114688
 ds_read_b64_tr_b16 a[36:37], v47 offset:36864
 v_cvt_pk_bf16_f32 v91, v94, v95
 v_mfma_f32_16x16x32_bf16 v[104:107], a[20:23], a[148:151], v[104:107]
 s_waitcnt lgkmcnt(3)
 ds_read_b64_tr_b16 a[38:39], v47 offset:38912
 buffer_load_dwordx4 v2, s[8:11], s82 offen lds
 v_mfma_f32_16x16x32_bf16 v[104:107], a[24:27], a[152:155], v[104:107]
 s_add_u32 s58, s48, 69632
 ds_read_b64_tr_b16 a[40:41], v47 offset:40960
 v_mul_f32 v99, v99, v65
 v_mfma_f32_16x16x32_bf16 v[104:107], a[28:31], a[156:159], v[104:107]
 ds_read_b64_tr_b16 a[42:43], v47 offset:43008
 buffer_store_dwordx4 v[88:91], v1, s[12:15], s58 offen sc1
 v_mfma_f32_16x16x32_bf16 v[112:115], a[0:3], a[160:163], 0
 ds_read_b64_tr_b16 a[44:45], v47 offset:45056
 v_mul_f32 v100, v100, v65
 v_mfma_f32_16x16x32_bf16 v[112:115], a[4:7], a[164:167], v[112:115]
 ds_read_b64_tr_b16 a[46:47], v47 offset:47104
 v_mul_f32 v101, v101, v65
 v_mfma_f32_16x16x32_bf16 v[112:115], a[8:11], a[168:171], v[112:115]
 ds_read_b64_tr_b16 a[48:49], v47 offset:49152
 v_mul_f32 v102, v102, v65
 v_mfma_f32_16x16x32_bf16 v[112:115], a[12:15], a[172:175], v[112:115]
 s_add_u32 m0, s29, 118784
 ds_read_b64_tr_b16 a[50:51], v47 offset:51200
 v_mul_f32 v103, v103, v65
 v_mfma_f32_16x16x32_bf16 v[112:115], a[16:19], a[176:179], v[112:115]
 ds_read_b64_tr_b16 a[52:53], v47 offset:53248
 buffer_load_dwordx4 v2, s[8:11], s83 offen lds
 v_mfma_f32_16x16x32_bf16 v[112:115], a[20:23], a[180:183], v[112:115]
 ds_read_b64_tr_b16 a[54:55], v47 offset:55296
 v_cvt_pk_bf16_f32 v96, v96, v97
 v_mfma_f32_16x16x32_bf16 v[112:115], a[24:27], a[184:187], v[112:115]
 ds_read_b64_tr_b16 a[56:57], v47 offset:57344
 v_cvt_pk_bf16_f32 v97, v98, v99
 v_mfma_f32_16x16x32_bf16 v[112:115], a[28:31], a[188:191], v[112:115]
 s_waitcnt lgkmcnt(7)
 ds_read_b64_tr_b16 a[58:59], v47 offset:59392
 v_cvt_pk_bf16_f32 v98, v100, v101
 v_mfma_f32_16x16x32_bf16 v[108:111], a[32:35], a[128:131], 0
 s_waitcnt vmcnt(9)
 ds_read_b64_tr_b16 a[60:61], v47 offset:61440
 v_cvt_pk_bf16_f32 v99, v102, v103
 v_mfma_f32_16x16x32_bf16 v[108:111], a[36:39], a[132:135], v[108:111]
 s_barrier
 ds_read_b64_tr_b16 a[62:63], v47 offset:63488
 v_xor_b32 v44, 0x10000, v44
 v_mfma_f32_16x16x32_bf16 v[108:111], a[40:43], a[136:139], v[108:111]
 s_waitcnt lgkmcnt(4)
 ds_read_b64_tr_b16 a[0:1], v44 offset:0
 v_mul_f32 v104, v104, v64
 v_mfma_f32_16x16x32_bf16 v[108:111], a[44:47], a[140:143], v[108:111]
 s_add_u32 m0, s29, 122880
 ds_read_b64_tr_b16 a[2:3], v44 offset:2048
 v_mul_f32 v105, v105, v64
 v_mfma_f32_16x16x32_bf16 v[108:111], a[48:51], a[144:147], v[108:111]
 ds_read_b64_tr_b16 a[4:5], v44 offset:4096
 buffer_load_dwordx4 v2, s[8:11], s84 offen lds
 v_mfma_f32_16x16x32_bf16 v[108:111], a[52:55], a[148:151], v[108:111]
 s_waitcnt lgkmcnt(3)
 ds_read_b64_tr_b16 a[6:7], v44 offset:6144
 v_mul_f32 v106, v106, v64
 v_mfma_f32_16x16x32_bf16 v[108:111], a[56:59], a[152:155], v[108:111]
 s_add_u32 s58, s48, 1044480
 ds_read_b64_tr_b16 a[8:9], v44 offset:8192
 v_mul_f32 v107, v107, v64
 v_mfma_f32_16x16x32_bf16 v[108:111], a[60:63], a[156:159], v[108:111]
 ds_read_b64_tr_b16 a[10:11], v44 offset:10240
 buffer_store_dwordx4 v[96:99], v1, s[12:15], s58 offen sc1
 v_mfma_f32_16x16x32_bf16 v[116:119], a[32:35], a[160:163], 0
 ds_read_b64_tr_b16 a[12:13], v44 offset:12288
 v_mul_f32 v112, v112, v65
 v_mfma_f32_16x16x32_bf16 v[116:119], a[36:39], a[164:167], v[116:119]
 ds_read_b64_tr_b16 a[14:15], v44 offset:14336
 v_mul_f32 v113, v113, v65
 v_mfma_f32_16x16x32_bf16 v[116:119], a[40:43], a[168:171], v[116:119]
 s_add_u32 m0, s29, 126976
 ds_read_b64_tr_b16 a[16:17], v44 offset:16384
 v_mul_f32 v114, v114, v65
 v_mfma_f32_16x16x32_bf16 v[116:119], a[44:47], a[172:175], v[116:119]
 ds_read_b64_tr_b16 a[18:19], v44 offset:18432
 buffer_load_dwordx4 v2, s[8:11], s85 offen lds
 v_mfma_f32_16x16x32_bf16 v[116:119], a[48:51], a[176:179], v[116:119]
 ds_read_b64_tr_b16 a[20:21], v44 offset:20480
 v_add_u32 v2, 128, v2
 v_mfma_f32_16x16x32_bf16 v[116:119], a[52:55], a[180:183], v[116:119]
 ds_read_b64_tr_b16 a[22:23], v44 offset:22528
 v_mul_f32 v108, v108, v64
 v_mfma_f32_16x16x32_bf16 v[116:119], a[56:59], a[184:187], v[116:119]
 ds_read_b64_tr_b16 a[24:25], v44 offset:24576
 v_mul_f32 v109, v109, v64
 v_mfma_f32_16x16x32_bf16 v[116:119], a[60:63], a[188:191], v[116:119]
 s_waitcnt lgkmcnt(7)
 ds_read_b64_tr_b16 a[26:27], v44 offset:26624
 v_mul_f32 v110, v110, v64
 v_mfma_f32_16x16x32_bf16 v[72:75], a[0:3], a[128:131], 0
 ds_read_b64_tr_b16 a[28:29], v44 offset:28672
 v_mul_f32 v111, v111, v64
 v_mfma_f32_16x16x32_bf16 v[72:75], a[4:7], a[132:135], v[72:75]
 ds_read_b64_tr_b16 a[30:31], v44 offset:30720
 v_xor_b32 v45, 0x10000, v45
 v_mfma_f32_16x16x32_bf16 v[72:75], a[8:11], a[136:139], v[72:75]
 s_waitcnt lgkmcnt(4)
 ds_read_b64_tr_b16 a[32:33], v45 offset:0
 v_cvt_pk_bf16_f32 v104, v104, v105
 v_mfma_f32_16x16x32_bf16 v[72:75], a[12:15], a[140:143], v[72:75]
 s_add_u32 m0, s29, 131072
 ds_read_b64_tr_b16 a[34:35], v45 offset:2048
 v_cvt_pk_bf16_f32 v105, v106, v107
 v_mfma_f32_16x16x32_bf16 v[72:75], a[16:19], a[144:147], v[72:75]
 ds_read_b64_tr_b16 a[36:37], v45 offset:4096
 buffer_load_dwordx4 v2, s[8:11], s78 offen lds
 v_mfma_f32_16x16x32_bf16 v[72:75], a[20:23], a[148:151], v[72:75]
 s_waitcnt lgkmcnt(3)
 ds_read_b64_tr_b16 a[38:39], v45 offset:6144
 v_cvt_pk_bf16_f32 v106, v108, v109
 v_mfma_f32_16x16x32_bf16 v[72:75], a[24:27], a[152:155], v[72:75]
 s_add_u32 s58, s48, 87040
 ds_read_b64_tr_b16 a[40:41], v45 offset:8192
 v_cvt_pk_bf16_f32 v107, v110, v111
 v_mfma_f32_16x16x32_bf16 v[72:75], a[28:31], a[156:159], v[72:75]
 ds_read_b64_tr_b16 a[42:43], v45 offset:10240
 buffer_store_dwordx4 v[104:107], v1, s[12:15], s58 offen sc1
 v_mfma_f32_16x16x32_bf16 v[80:83], a[0:3], a[160:163], 0
 ds_read_b64_tr_b16 a[44:45], v45 offset:12288
 v_mul_f32 v115, v115, v65
 v_mfma_f32_16x16x32_bf16 v[80:83], a[4:7], a[164:167], v[80:83]
 ds_read_b64_tr_b16 a[46:47], v45 offset:14336
 v_mul_f32 v116, v116, v65
 v_mfma_f32_16x16x32_bf16 v[80:83], a[8:11], a[168:171], v[80:83]
 s_add_u32 m0, s29, 135168
 ds_read_b64_tr_b16 a[48:49], v45 offset:16384
 v_mul_f32 v117, v117, v65
 v_mfma_f32_16x16x32_bf16 v[80:83], a[12:15], a[172:175], v[80:83]
 ds_read_b64_tr_b16 a[50:51], v45 offset:18432
 buffer_load_dwordx4 v2, s[8:11], s79 offen lds
 v_mfma_f32_16x16x32_bf16 v[80:83], a[16:19], a[176:179], v[80:83]
 ds_read_b64_tr_b16 a[52:53], v45 offset:20480
 v_mul_f32 v118, v118, v65
 v_mfma_f32_16x16x32_bf16 v[80:83], a[20:23], a[180:183], v[80:83]
 ds_read_b64_tr_b16 a[54:55], v45 offset:22528
 v_mul_f32 v119, v119, v65
 v_mfma_f32_16x16x32_bf16 v[80:83], a[24:27], a[184:187], v[80:83]
 ds_read_b64_tr_b16 a[56:57], v45 offset:24576
 v_cvt_pk_bf16_f32 v112, v112, v113
 v_mfma_f32_16x16x32_bf16 v[80:83], a[28:31], a[188:191], v[80:83]
 s_waitcnt lgkmcnt(7)
 ds_read_b64_tr_b16 a[58:59], v45 offset:26624
 v_cvt_pk_bf16_f32 v113, v114, v115
 v_mfma_f32_16x16x32_bf16 v[76:79], a[32:35], a[128:131], 0
 ds_read_b64_tr_b16 a[60:61], v45 offset:28672
 v_cvt_pk_bf16_f32 v114, v116, v117
 v_mfma_f32_16x16x32_bf16 v[76:79], a[36:39], a[132:135], v[76:79]
 s_add_u32 m0, s29, 139264
 ds_read_b64_tr_b16 a[62:63], v45 offset:30720
 v_xor_b32 v46, 0x10000, v46
 v_mfma_f32_16x16x32_bf16 v[76:79], a[40:43], a[136:139], v[76:79]
 s_waitcnt lgkmcnt(4)
 ds_read_b64_tr_b16 a[0:1], v46 offset:0
 buffer_load_dwordx4 v2, s[8:11], s80 offen lds
 v_mfma_f32_16x16x32_bf16 v[76:79], a[44:47], a[140:143], v[76:79]
 s_add_u32 s58, s48, 1061888
 ds_read_b64_tr_b16 a[2:3], v46 offset:2048
 v_cvt_pk_bf16_f32 v115, v118, v119
 v_mfma_f32_16x16x32_bf16 v[76:79], a[48:51], a[144:147], v[76:79]
 ds_read_b64_tr_b16 a[4:5], v46 offset:4096
 buffer_store_dwordx4 v[112:115], v1, s[12:15], s58 offen sc1
 v_mfma_f32_16x16x32_bf16 v[76:79], a[52:55], a[148:151], v[76:79]
 s_waitcnt lgkmcnt(3)
 ds_read_b64_tr_b16 a[6:7], v46 offset:6144
 v_mul_f32 v72, v72, v64
 v_mfma_f32_16x16x32_bf16 v[76:79], a[56:59], a[152:155], v[76:79]
 ds_read_b64_tr_b16 a[8:9], v46 offset:8192
 v_mul_f32 v73, v73, v64
 v_mfma_f32_16x16x32_bf16 v[76:79], a[60:63], a[156:159], v[76:79]
 ds_read_b64_tr_b16 a[10:11], v46 offset:10240
 v_mul_f32 v74, v74, v64
 v_mfma_f32_16x16x32_bf16 v[84:87], a[32:35], a[160:163], 0
 s_add_u32 m0, s29, 143360
 ds_read_b64_tr_b16 a[12:13], v46 offset:12288
 v_mul_f32 v75, v75, v64
 v_mfma_f32_16x16x32_bf16 v[84:87], a[36:39], a[164:167], v[84:87]
 ds_read_b64_tr_b16 a[14:15], v46 offset:14336
 buffer_load_dwordx4 v2, s[8:11], s81 offen lds
 v_mfma_f32_16x16x32_bf16 v[84:87], a[40:43], a[168:171], v[84:87]
 ds_read_b64_tr_b16 a[16:17], v46 offset:16384
 v_mul_f32 v80, v80, v65
 v_mfma_f32_16x16x32_bf16 v[84:87], a[44:47], a[172:175], v[84:87]
 ds_read_b64_tr_b16 a[18:19], v46 offset:18432
 v_mul_f32 v81, v81, v65
 v_mfma_f32_16x16x32_bf16 v[84:87], a[48:51], a[176:179], v[84:87]
 ds_read_b64_tr_b16 a[20:21], v46 offset:20480
 v_mul_f32 v76, v76, v64
 v_mfma_f32_16x16x32_bf16 v[84:87], a[52:55], a[180:183], v[84:87]
 ds_read_b64_tr_b16 a[22:23], v46 offset:22528
 v_mul_f32 v77, v77, v64
 v_mfma_f32_16x16x32_bf16 v[84:87], a[56:59], a[184:187], v[84:87]
 s_add_u32 m0, s29, 147456
 ds_read_b64_tr_b16 a[24:25], v46 offset:24576
 v_mul_f32 v78, v78, v64
 v_mfma_f32_16x16x32_bf16 v[84:87], a[60:63], a[188:191], v[84:87]
 s_waitcnt lgkmcnt(7)
 ds_read_b64_tr_b16 a[26:27], v46 offset:26624
 v_mul_f32 v79, v79, v64
 v_mfma_f32_16x16x32_bf16 v[88:91], a[0:3], a[128:131], 0
 ds_read_b64_tr_b16 a[28:29], v46 offset:28672
 buffer_load_dwordx4 v2, s[8:11], s82 offen lds
 v_mfma_f32_16x16x32_bf16 v[88:91], a[4:7], a[132:135], v[88:91]
 ds_read_b64_tr_b16 a[30:31], v46 offset:30720
 v_xor_b32 v47, 0x10000, v47
 v_mfma_f32_16x16x32_bf16 v[88:91], a[8:11], a[136:139], v[88:91]
 s_waitcnt lgkmcnt(4)
 ds_read_b64_tr_b16 a[32:33], v47 offset:0
 v_cvt_pk_bf16_f32 v72, v72, v73
 v_mfma_f32_16x16x32_bf16 v[88:91], a[12:15], a[140:143], v[88:91]
 ds_read_b64_tr_b16 a[34:35], v47 offset:2048
 v_cvt_pk_bf16_f32 v73, v74, v75
 v_mfma_f32_16x16x32_bf16 v[88:91], a[16:19], a[144:147], v[88:91]
 ds_read_b64_tr_b16 a[36:37], v47 offset:4096
 v_cvt_pk_bf16_f32 v74, v76, v77
 v_mfma_f32_16x16x32_bf16 v[88:91], a[20:23], a[148:151], v[88:91]
 s_waitcnt lgkmcnt(3)
 ds_read_b64_tr_b16 a[38:39], v47 offset:6144
 v_cvt_pk_bf16_f32 v75, v78, v79
 v_mfma_f32_16x16x32_bf16 v[88:91], a[24:27], a[152:155], v[88:91]
 s_add_u32 m0, s29, 151552
 ds_read_b64_tr_b16 a[40:41], v47 offset:8192
 v_mul_f32 v82, v82, v65
 v_mfma_f32_16x16x32_bf16 v[88:91], a[28:31], a[156:159], v[88:91]
 ds_read_b64_tr_b16 a[42:43], v47 offset:10240
 buffer_load_dwordx4 v2, s[8:11], s83 offen lds
 v_mfma_f32_16x16x32_bf16 v[96:99], a[0:3], a[160:163], 0
 s_add_u32 s58, s48, 104448
 ds_read_b64_tr_b16 a[44:45], v47 offset:12288
 v_mul_f32 v83, v83, v65
 v_mfma_f32_16x16x32_bf16 v[96:99], a[4:7], a[164:167], v[96:99]
 ds_read_b64_tr_b16 a[46:47], v47 offset:14336
 buffer_store_dwordx4 v[72:75], v1, s[12:15], s58 offen sc1
 v_mfma_f32_16x16x32_bf16 v[96:99], a[8:11], a[168:171], v[96:99]
 ds_read_b64_tr_b16 a[48:49], v47 offset:16384
 v_mul_f32 v84, v84, v65
 v_mfma_f32_16x16x32_bf16 v[96:99], a[12:15], a[172:175], v[96:99]
 ds_read_b64_tr_b16 a[50:51], v47 offset:18432
 v_mul_f32 v85, v85, v65
 v_mfma_f32_16x16x32_bf16 v[96:99], a[16:19], a[176:179], v[96:99]
 ds_read_b64_tr_b16 a[52:53], v47 offset:20480
 v_mul_f32 v86, v86, v65
 v_mfma_f32_16x16x32_bf16 v[96:99], a[20:23], a[180:183], v[96:99]
 s_add_u32 m0, s29, 155648
 ds_read_b64_tr_b16 a[54:55], v47 offset:22528
 v_mul_f32 v87, v87, v65
 v_mfma_f32_16x16x32_bf16 v[96:99], a[24:27], a[184:187], v[96:99]
 ds_read_b64_tr_b16 a[56:57], v47 offset:24576
 buffer_load_dwordx4 v2, s[8:11], s84 offen lds
 v_mfma_f32_16x16x32_bf16 v[96:99], a[28:31], a[188:191], v[96:99]
 s_waitcnt lgkmcnt(7)
 ds_read_b64_tr_b16 a[58:59], v47 offset:26624
 v_cvt_pk_bf16_f32 v80, v80, v81
 v_mfma_f32_16x16x32_bf16 v[92:95], a[32:35], a[128:131], 0
 s_waitcnt vmcnt(10)
 ds_read_b64_tr_b16 a[60:61], v47 offset:28672
 v_cvt_pk_bf16_f32 v81, v82, v83
 v_mfma_f32_16x16x32_bf16 v[92:95], a[36:39], a[132:135], v[92:95]
 s_barrier
 ds_read_b64_tr_b16 a[62:63], v47 offset:30720
 v_cvt_pk_bf16_f32 v82, v84, v85
 v_mfma_f32_16x16x32_bf16 v[92:95], a[40:43], a[136:139], v[92:95]
 s_waitcnt lgkmcnt(4)
 ds_read_b64_tr_b16 a[0:1], v44 offset:32768
 v_cvt_pk_bf16_f32 v83, v86, v87
 v_mfma_f32_16x16x32_bf16 v[92:95], a[44:47], a[140:143], v[92:95]
 s_lshl_b32 s34, s95, 2
 ds_read_b64_tr_b16 a[2:3], v44 offset:34816
 v_mul_f32 v88, v88, v64
 v_mfma_f32_16x16x32_bf16 v[92:95], a[48:51], a[144:147], v[92:95]
 s_add_u32 m0, s29, 159744
 ds_read_b64_tr_b16 a[4:5], v44 offset:36864
 v_mul_f32 v89, v89, v64
 v_mfma_f32_16x16x32_bf16 v[92:95], a[52:55], a[148:151], v[92:95]
 s_waitcnt lgkmcnt(3)
 ds_read_b64_tr_b16 a[6:7], v44 offset:38912
 buffer_load_dwordx4 v2, s[8:11], s85 offen lds
 v_mfma_f32_16x16x32_bf16 v[92:95], a[56:59], a[152:155], v[92:95]
 s_add_u32 s34, s34, s3
 ds_read_b64_tr_b16 a[8:9], v44 offset:40960
 v_add_u32 v2, 128, v2
 v_mfma_f32_16x16x32_bf16 v[92:95], a[60:63], a[156:159], v[92:95]
 s_mul_i32 s35, s34, 4096
 ds_read_b64_tr_b16 a[10:11], v44 offset:43008
 v_mul_f32 v90, v90, v64
 v_mfma_f32_16x16x32_bf16 v[100:103], a[32:35], a[160:163], 0
 s_lshl_b32 s34, s34, 12
 ds_read_b64_tr_b16 a[12:13], v44 offset:45056
 v_mul_f32 v91, v91, v64
 v_mfma_f32_16x16x32_bf16 v[100:103], a[36:39], a[164:167], v[100:103]
 s_cmp_eq_u32 s62, 0
 s_cmov_b32 s34, 2.0
 s_cmov_b32 s35, 2.0
 ds_read_b64_tr_b16 a[14:15], v44 offset:47104
 v_mfma_f32_16x16x32_bf16 v[100:103], a[40:43], a[168:171], v[100:103]
 s_add_u32 s35, s35, 85983232
 ds_read_b64_tr_b16 a[16:17], v44 offset:49152
 v_mul_f32 v96, v96, v65
 v_mfma_f32_16x16x32_bf16 v[100:103], a[44:47], a[172:175], v[100:103]
 s_mul_i32 s33, s3, 8736
 ds_read_b64_tr_b16 a[18:19], v44 offset:51200
 v_mul_f32 v97, v97, v65
 v_mfma_f32_16x16x32_bf16 v[100:103], a[48:51], a[176:179], v[100:103]
 s_add_u32 s33, s33, 0x10000
 ds_read_b64_tr_b16 a[20:21], v44 offset:53248
 v_mul_f32 v92, v92, v64
 v_mfma_f32_16x16x32_bf16 v[100:103], a[52:55], a[180:183], v[100:103]
 s_mov_b32 s4, s72
 ds_read_b64_tr_b16 a[22:23], v44 offset:55296
 v_mul_f32 v93, v93, v64
 v_mfma_f32_16x16x32_bf16 v[100:103], a[56:59], a[184:187], v[100:103]
 s_mov_b32 s5, s73
 ds_read_b64_tr_b16 a[24:25], v44 offset:57344
 v_mul_f32 v94, v94, v64
 v_mfma_f32_16x16x32_bf16 v[100:103], a[60:63], a[188:191], v[100:103]
 s_waitcnt lgkmcnt(7)
 ds_read_b64_tr_b16 a[26:27], v44 offset:59392
 v_mul_f32 v95, v95, v64
 v_mfma_f32_16x16x32_bf16 v[104:107], a[0:3], a[128:131], 0
 s_mov_b32 s6, 1835008
 ds_read_b64_tr_b16 a[28:29], v44 offset:61440
 v_cvt_pk_bf16_f32 v88, v88, v89
 v_mfma_f32_16x16x32_bf16 v[104:107], a[4:7], a[132:135], v[104:107]
 s_mov_b32 s7, 0x20000
 ds_read_b64_tr_b16 a[30:31], v44 offset:63488
 v_cvt_pk_bf16_f32 v89, v90, v91
 v_mfma_f32_16x16x32_bf16 v[104:107], a[8:11], a[136:139], v[104:107]
 s_waitcnt lgkmcnt(4)
 ds_read_b64_tr_b16 a[32:33], v45 offset:32768
 v_cvt_pk_bf16_f32 v90, v92, v93
 v_mfma_f32_16x16x32_bf16 v[104:107], a[12:15], a[140:143], v[104:107]
 s_add_u32 m0, s29, 0
 ds_read_b64_tr_b16 a[34:35], v45 offset:34816
 v_lshrrev_b32 v10, 1, v0
 v_mfma_f32_16x16x32_bf16 v[104:107], a[16:19], a[144:147], v[104:107]
 ds_read_b64_tr_b16 a[36:37], v45 offset:36864
 buffer_load_dwordx4 v2, s[8:11], s78 offen lds
 v_mfma_f32_16x16x32_bf16 v[104:107], a[20:23], a[148:151], v[104:107]
 s_waitcnt lgkmcnt(3)
 ds_read_b64_tr_b16 a[38:39], v45 offset:38912
 v_lshlrev_b32 v10, 7, v10
 v_mfma_f32_16x16x32_bf16 v[104:107], a[24:27], a[152:155], v[104:107]
 ds_read_b64_tr_b16 a[40:41], v45 offset:40960
 v_cvt_pk_bf16_f32 v91, v94, v95
 v_mfma_f32_16x16x32_bf16 v[104:107], a[28:31], a[156:159], v[104:107]
 s_add_u32 s58, s48, 1079296
 ds_read_b64_tr_b16 a[42:43], v45 offset:43008
 v_and_b32 v11, 1, v0
 v_mfma_f32_16x16x32_bf16 v[112:115], a[0:3], a[160:163], 0
 ds_read_b64_tr_b16 a[44:45], v45 offset:45056
 buffer_store_dwordx4 v[80:83], v1, s[12:15], s58 offen sc1
 v_mfma_f32_16x16x32_bf16 v[112:115], a[4:7], a[164:167], v[112:115]
 ds_read_b64_tr_b16 a[46:47], v45 offset:47104
 v_lshl_add_u32 v10, v11, 4, v10
 v_mfma_f32_16x16x32_bf16 v[112:115], a[8:11], a[168:171], v[112:115]
 s_add_u32 m0, s29, 4096
 ds_read_b64_tr_b16 a[48:49], v45 offset:49152
 v_mul_f32 v98, v98, v65
 v_mfma_f32_16x16x32_bf16 v[112:115], a[12:15], a[172:175], v[112:115]
 ds_read_b64_tr_b16 a[50:51], v45 offset:51200
 buffer_load_dwordx4 v2, s[8:11], s79 offen lds
 v_mfma_f32_16x16x32_bf16 v[112:115], a[16:19], a[176:179], v[112:115]
 s_add_u32 s58, s48, 121856
 ds_read_b64_tr_b16 a[52:53], v45 offset:53248
 v_and_b32 v11, 31, v0
 v_mfma_f32_16x16x32_bf16 v[112:115], a[20:23], a[180:183], v[112:115]
 ds_read_b64_tr_b16 a[54:55], v45 offset:55296
 buffer_store_dwordx4 v[88:91], v1, s[12:15], s58 offen sc1
 v_mfma_f32_16x16x32_bf16 v[112:115], a[24:27], a[184:187], v[112:115]
 ds_read_b64_tr_b16 a[56:57], v45 offset:57344
 v_lshl_add_u32 v11, v11, 2, s33
 v_mfma_f32_16x16x32_bf16 v[112:115], a[28:31], a[188:191], v[112:115]
 s_waitcnt lgkmcnt(7)
 ds_read_b64_tr_b16 a[58:59], v45 offset:59392
 v_mul_f32 v99, v99, v65
 v_mfma_f32_16x16x32_bf16 v[108:111], a[32:35], a[128:131], 0
 ds_read_b64_tr_b16 a[60:61], v45 offset:61440
 v_and_b32 v12, 7, v0
 v_mfma_f32_16x16x32_bf16 v[108:111], a[36:39], a[132:135], v[108:111]
 s_add_u32 m0, s29, 8192
 ds_read_b64_tr_b16 a[62:63], v45 offset:63488
 v_mul_f32 v100, v100, v65
 v_mfma_f32_16x16x32_bf16 v[108:111], a[40:43], a[136:139], v[108:111]
 s_waitcnt lgkmcnt(4)
 ds_read_b64_tr_b16 a[0:1], v46 offset:32768
 buffer_load_dwordx4 v2, s[8:11], s80 offen lds
 v_mfma_f32_16x16x32_bf16 v[108:111], a[44:47], a[140:143], v[108:111]
 ds_read_b64_tr_b16 a[2:3], v46 offset:34816
 v_lshl_add_u32 v12, v12, 2, s33
 v_mfma_f32_16x16x32_bf16 v[108:111], a[48:51], a[144:147], v[108:111]
 ds_read_b64_tr_b16 a[4:5], v46 offset:36864
 v_mul_f32 v101, v101, v65
 v_mfma_f32_16x16x32_bf16 v[108:111], a[52:55], a[148:151], v[108:111]
 s_waitcnt lgkmcnt(3)
 ds_read_b64_tr_b16 a[6:7], v46 offset:38912
 v_mov_b32 v13, 0
 v_mfma_f32_16x16x32_bf16 v[108:111], a[56:59], a[152:155], v[108:111]
 ds_read_b64_tr_b16 a[8:9], v46 offset:40960
 v_mul_f32 v102, v102, v65
 v_mfma_f32_16x16x32_bf16 v[108:111], a[60:63], a[156:159], v[108:111]
 ds_read_b64_tr_b16 a[10:11], v46 offset:43008
 v_mul_f32 v103, v103, v65
 v_mfma_f32_16x16x32_bf16 v[116:119], a[32:35], a[160:163], 0
 s_add_u32 m0, s29, 12288
 ds_read_b64_tr_b16 a[12:13], v46 offset:45056
 v_cvt_pk_bf16_f32 v96, v96, v97
 v_mfma_f32_16x16x32_bf16 v[116:119], a[36:39], a[164:167], v[116:119]
 ds_read_b64_tr_b16 a[14:15], v46 offset:47104
 buffer_load_dwordx4 v2, s[8:11], s81 offen lds
 v_mfma_f32_16x16x32_bf16 v[116:119], a[40:43], a[168:171], v[116:119]
 ds_read_b64_tr_b16 a[16:17], v46 offset:49152
 v_cvt_pk_bf16_f32 v97, v98, v99
 v_mfma_f32_16x16x32_bf16 v[116:119], a[44:47], a[172:175], v[116:119]
 ds_read_b64_tr_b16 a[18:19], v46 offset:51200
 v_cvt_pk_bf16_f32 v98, v100, v101
 v_mfma_f32_16x16x32_bf16 v[116:119], a[48:51], a[176:179], v[116:119]
 s_add_u32 s58, s48, 1096704
 ds_read_b64_tr_b16 a[20:21], v46 offset:53248
 v_cvt_pk_bf16_f32 v99, v102, v103
 v_mfma_f32_16x16x32_bf16 v[116:119], a[52:55], a[180:183], v[116:119]
 ds_read_b64_tr_b16 a[22:23], v46 offset:55296
 buffer_store_dwordx4 v[96:99], v1, s[12:15], s58 offen sc1
 v_mfma_f32_16x16x32_bf16 v[116:119], a[56:59], a[184:187], v[116:119]
 s_add_u32 m0, s29, 16384
 ds_read_b64_tr_b16 a[24:25], v46 offset:57344
 v_mul_f32 v104, v104, v64
 v_mfma_f32_16x16x32_bf16 v[116:119], a[60:63], a[188:191], v[116:119]
 s_waitcnt lgkmcnt(7)
 ds_read_b64_tr_b16 a[26:27], v46 offset:59392
 v_mul_f32 v105, v105, v64
 v_mfma_f32_16x16x32_bf16 v[72:75], a[0:3], a[128:131], 0
 ds_read_b64_tr_b16 a[28:29], v46 offset:61440
 buffer_load_dwordx4 v2, s[8:11], s82 offen lds
 v_mfma_f32_16x16x32_bf16 v[72:75], a[4:7], a[132:135], v[72:75]
 ds_read_b64_tr_b16 a[30:31], v46 offset:63488
 v_mul_f32 v106, v106, v64
 v_mfma_f32_16x16x32_bf16 v[72:75], a[8:11], a[136:139], v[72:75]
 s_waitcnt lgkmcnt(4)
 ds_read_b64_tr_b16 a[32:33], v47 offset:32768
 v_mul_f32 v107, v107, v64
 v_mfma_f32_16x16x32_bf16 v[72:75], a[12:15], a[140:143], v[72:75]
 ds_read_b64_tr_b16 a[34:35], v47 offset:34816
 v_mul_f32 v108, v108, v64
 v_mfma_f32_16x16x32_bf16 v[72:75], a[16:19], a[144:147], v[72:75]
 ds_read_b64_tr_b16 a[36:37], v47 offset:36864
 v_mul_f32 v109, v109, v64
 v_mfma_f32_16x16x32_bf16 v[72:75], a[20:23], a[148:151], v[72:75]
 s_waitcnt lgkmcnt(3)
 ds_read_b64_tr_b16 a[38:39], v47 offset:38912
 v_mul_f32 v110, v110, v64
 v_mfma_f32_16x16x32_bf16 v[72:75], a[24:27], a[152:155], v[72:75]
 s_add_u32 m0, s29, 20480
 ds_read_b64_tr_b16 a[40:41], v47 offset:40960
 v_mul_f32 v111, v111, v64
 v_mfma_f32_16x16x32_bf16 v[72:75], a[28:31], a[156:159], v[72:75]
 ds_read_b64_tr_b16 a[42:43], v47 offset:43008
 buffer_load_dwordx4 v2, s[8:11], s83 offen lds
 v_mfma_f32_16x16x32_bf16 v[80:83], a[0:3], a[160:163], 0
 ds_read_b64_tr_b16 a[44:45], v47 offset:45056
 v_cvt_pk_bf16_f32 v104, v104, v105
 v_mfma_f32_16x16x32_bf16 v[80:83], a[4:7], a[164:167], v[80:83]
 ds_read_b64_tr_b16 a[46:47], v47 offset:47104
 v_cvt_pk_bf16_f32 v105, v106, v107
 v_mfma_f32_16x16x32_bf16 v[80:83], a[8:11], a[168:171], v[80:83]
 ds_read_b64_tr_b16 a[48:49], v47 offset:49152
 v_cvt_pk_bf16_f32 v106, v108, v109
 v_mfma_f32_16x16x32_bf16 v[80:83], a[12:15], a[172:175], v[80:83]
 s_add_u32 s58, s48, 139264
 ds_read_b64_tr_b16 a[50:51], v47 offset:51200
 v_cvt_pk_bf16_f32 v107, v110, v111
 v_mfma_f32_16x16x32_bf16 v[80:83], a[16:19], a[176:179], v[80:83]
 ds_read_b64_tr_b16 a[52:53], v47 offset:53248
 buffer_store_dwordx4 v[104:107], v1, s[12:15], s58 offen sc1
 v_mfma_f32_16x16x32_bf16 v[80:83], a[20:23], a[180:183], v[80:83]
 s_add_u32 m0, s29, 24576
 ds_read_b64_tr_b16 a[54:55], v47 offset:55296
 v_mul_f32 v112, v112, v65
 v_mfma_f32_16x16x32_bf16 v[80:83], a[24:27], a[184:187], v[80:83]
 ds_read_b64_tr_b16 a[56:57], v47 offset:57344
 buffer_load_dwordx4 v2, s[8:11], s84 offen lds
 v_mfma_f32_16x16x32_bf16 v[80:83], a[28:31], a[188:191], v[80:83]
 s_waitcnt lgkmcnt(7)
 ds_read_b64_tr_b16 a[58:59], v47 offset:59392
 v_mul_f32 v113, v113, v65
 v_mfma_f32_16x16x32_bf16 v[76:79], a[32:35], a[128:131], 0
 s_waitcnt vmcnt(9)
 ds_read_b64_tr_b16 a[60:61], v47 offset:61440
 v_mul_f32 v114, v114, v65
 v_mfma_f32_16x16x32_bf16 v[76:79], a[36:39], a[132:135], v[76:79]
 s_barrier
 ds_read_b64_tr_b16 a[62:63], v47 offset:63488
 v_xor_b32 v44, 0x30000, v44
 v_mfma_f32_16x16x32_bf16 v[76:79], a[40:43], a[136:139], v[76:79]
 s_waitcnt lgkmcnt(4)
 ds_read_b64_tr_b16 a[0:1], v44 offset:0
 buffer_store_dword v9, v9, s[12:15], s93 offen offset:64 sc1
 v_mfma_f32_16x16x32_bf16 v[76:79], a[44:47], a[140:143], v[76:79]
 ds_read_b64_tr_b16 a[2:3], v44 offset:2048
 v_mul_f32 v115, v115, v65
 v_mfma_f32_16x16x32_bf16 v[76:79], a[48:51], a[144:147], v[76:79]
 s_add_u32 m0, s29, 28672
 ds_read_b64_tr_b16 a[4:5], v44 offset:4096
 v_mul_f32 v116, v116, v65
 v_mfma_f32_16x16x32_bf16 v[76:79], a[52:55], a[148:151], v[76:79]
 s_waitcnt lgkmcnt(3)
 ds_read_b64_tr_b16 a[6:7], v44 offset:6144
 buffer_load_dwordx4 v2, s[8:11], s85 offen lds
 v_mfma_f32_16x16x32_bf16 v[76:79], a[56:59], a[152:155], v[76:79]
 ds_read_b64_tr_b16 a[8:9], v44 offset:8192
 v_add_u32 v2, 128, v2
 v_mfma_f32_16x16x32_bf16 v[76:79], a[60:63], a[156:159], v[76:79]
 ds_read_b64_tr_b16 a[10:11], v44 offset:10240
 v_mul_f32 v117, v117, v65
 v_mfma_f32_16x16x32_bf16 v[84:87], a[32:35], a[160:163], 0
 ds_read_b64_tr_b16 a[12:13], v44 offset:12288
 v_mul_f32 v118, v118, v65
 v_mfma_f32_16x16x32_bf16 v[84:87], a[36:39], a[164:167], v[84:87]
 ds_read_b64_tr_b16 a[14:15], v44 offset:14336
 v_mul_f32 v119, v119, v65
 v_mfma_f32_16x16x32_bf16 v[84:87], a[40:43], a[168:171], v[84:87]
 ds_read_b64_tr_b16 a[16:17], v44 offset:16384
 v_cvt_pk_bf16_f32 v112, v112, v113
 v_mfma_f32_16x16x32_bf16 v[84:87], a[44:47], a[172:175], v[84:87]
 s_waitcnt lgkmcnt(9)
 ds_read_b64_tr_b16 a[18:19], v44 offset:18432
 v_cvt_pk_bf16_f32 v113, v114, v115
 v_mfma_f32_16x16x32_bf16 v[84:87], a[48:51], a[176:179], v[84:87]
 s_barrier
 ds_read_b64_tr_b16 a[20:21], v44 offset:20480
 v_cvt_pk_bf16_f32 v114, v116, v117
 v_mfma_f32_16x16x32_bf16 v[84:87], a[52:55], a[180:183], v[84:87]
 s_add_u32 m0, s33, 4640
 ds_read_b64_tr_b16 a[22:23], v44 offset:22528
 v_cvt_pk_bf16_f32 v115, v118, v119
 v_mfma_f32_16x16x32_bf16 v[84:87], a[56:59], a[184:187], v[84:87]
 ds_read_b64_tr_b16 a[24:25], v44 offset:24576
 buffer_load_dwordx4 v1, s[4:7], s34 offen offset:0 lds
 v_mfma_f32_16x16x32_bf16 v[84:87], a[60:63], a[188:191], v[84:87]
 s_waitcnt lgkmcnt(7)
 ds_read_b64_tr_b16 a[26:27], v44 offset:26624
 v_mul_f32 v72, v72, v64
 v_mfma_f32_16x16x32_bf16 v[88:91], a[0:3], a[128:131], 0
 ds_read_b64_tr_b16 a[28:29], v44 offset:28672
 v_mul_f32 v73, v73, v64
 v_mfma_f32_16x16x32_bf16 v[88:91], a[4:7], a[132:135], v[88:91]
 s_add_u32 s58, s48, 1114112
 ds_read_b64_tr_b16 a[30:31], v44 offset:30720
 v_xor_b32 v45, 0x30000, v45
 v_mfma_f32_16x16x32_bf16 v[88:91], a[8:11], a[136:139], v[88:91]
 s_waitcnt lgkmcnt(4)
 ds_read_b64_tr_b16 a[32:33], v45 offset:0
 buffer_store_dwordx4 v[112:115], v1, s[12:15], s58 offen sc1
 v_mfma_f32_16x16x32_bf16 v[88:91], a[12:15], a[140:143], v[88:91]
 ds_read_b64_tr_b16 a[34:35], v45 offset:2048
 v_mul_f32 v74, v74, v64
 v_mfma_f32_16x16x32_bf16 v[88:91], a[16:19], a[144:147], v[88:91]
 ds_read_b64_tr_b16 a[36:37], v45 offset:4096
 v_mul_f32 v75, v75, v64
 v_mfma_f32_16x16x32_bf16 v[88:91], a[20:23], a[148:151], v[88:91]
 s_waitcnt lgkmcnt(3)
 ds_read_b64_tr_b16 a[38:39], v45 offset:6144
 buffer_load_dwordx4 v1, s[4:7], s34 offen offset:1024 lds
 v_mfma_f32_16x16x32_bf16 v[88:91], a[24:27], a[152:155], v[88:91]
 ds_read_b64_tr_b16 a[40:41], v45 offset:8192
 v_mul_f32 v76, v76, v64
 v_mfma_f32_16x16x32_bf16 v[88:91], a[28:31], a[156:159], v[88:91]
 ds_read_b64_tr_b16 a[42:43], v45 offset:10240
 v_mul_f32 v77, v77, v64
 v_mfma_f32_16x16x32_bf16 v[96:99], a[0:3], a[160:163], 0
 ds_read_b64_tr_b16 a[44:45], v45 offset:12288
 v_mul_f32 v78, v78, v64
 v_mfma_f32_16x16x32_bf16 v[96:99], a[4:7], a[164:167], v[96:99]
 ds_read_b64_tr_b16 a[46:47], v45 offset:14336
 v_mul_f32 v79, v79, v64
 v_mfma_f32_16x16x32_bf16 v[96:99], a[8:11], a[168:171], v[96:99]
 ds_read_b64_tr_b16 a[48:49], v45 offset:16384
 v_cvt_pk_bf16_f32 v72, v72, v73
 v_mfma_f32_16x16x32_bf16 v[96:99], a[12:15], a[172:175], v[96:99]
 ds_read_b64_tr_b16 a[50:51], v45 offset:18432
 v_cvt_pk_bf16_f32 v73, v74, v75
 v_mfma_f32_16x16x32_bf16 v[96:99], a[16:19], a[176:179], v[96:99]
 ds_read_b64_tr_b16 a[52:53], v45 offset:20480
 buffer_load_dwordx4 v1, s[4:7], s34 offen offset:2048 lds
 v_mfma_f32_16x16x32_bf16 v[96:99], a[20:23], a[180:183], v[96:99]
 ds_read_b64_tr_b16 a[54:55], v45 offset:22528
 v_cvt_pk_bf16_f32 v74, v76, v77
 v_mfma_f32_16x16x32_bf16 v[96:99], a[24:27], a[184:187], v[96:99]
 s_add_u32 s58, s48, 156672
 ds_read_b64_tr_b16 a[56:57], v45 offset:24576
 v_cvt_pk_bf16_f32 v75, v78, v79
 v_mfma_f32_16x16x32_bf16 v[96:99], a[28:31], a[188:191], v[96:99]
 s_waitcnt lgkmcnt(7)
 ds_read_b64_tr_b16 a[58:59], v45 offset:26624
 buffer_store_dwordx4 v[72:75], v1, s[12:15], s58 offen sc1
 v_mfma_f32_16x16x32_bf16 v[92:95], a[32:35], a[128:131], 0
 ds_read_b64_tr_b16 a[60:61], v45 offset:28672
 v_mul_f32 v80, v80, v65
 v_mfma_f32_16x16x32_bf16 v[92:95], a[36:39], a[132:135], v[92:95]
 ds_read_b64_tr_b16 a[62:63], v45 offset:30720
 v_xor_b32 v46, 0x30000, v46
 v_mfma_f32_16x16x32_bf16 v[92:95], a[40:43], a[136:139], v[92:95]
 s_waitcnt lgkmcnt(4)
 ds_read_b64_tr_b16 a[0:1], v46 offset:0
 v_mul_f32 v81, v81, v65
 v_mfma_f32_16x16x32_bf16 v[92:95], a[44:47], a[140:143], v[92:95]
 ds_read_b64_tr_b16 a[2:3], v46 offset:2048
 buffer_load_dwordx4 v1, s[4:7], s34 offen offset:3072 lds
 v_mfma_f32_16x16x32_bf16 v[92:95], a[48:51], a[144:147], v[92:95]
 ds_read_b64_tr_b16 a[4:5], v46 offset:4096
 v_mul_f32 v82, v82, v65
 v_mfma_f32_16x16x32_bf16 v[92:95], a[52:55], a[148:151], v[92:95]
 s_waitcnt lgkmcnt(3)
 ds_read_b64_tr_b16 a[6:7], v46 offset:6144
 v_mul_f32 v83, v83, v65
 v_mfma_f32_16x16x32_bf16 v[92:95], a[56:59], a[152:155], v[92:95]
 ds_read_b64_tr_b16 a[8:9], v46 offset:8192
 v_mul_f32 v84, v84, v65
 v_mfma_f32_16x16x32_bf16 v[92:95], a[60:63], a[156:159], v[92:95]
 ds_read_b64_tr_b16 a[10:11], v46 offset:10240
 v_mul_f32 v85, v85, v65
 v_mfma_f32_16x16x32_bf16 v[100:103], a[32:35], a[160:163], 0
 ds_read_b64_tr_b16 a[12:13], v46 offset:12288
 v_mul_f32 v86, v86, v65
 v_mfma_f32_16x16x32_bf16 v[100:103], a[36:39], a[164:167], v[100:103]
 s_add_u32 m0, s33, 128
 ds_read_b64_tr_b16 a[14:15], v46 offset:14336
 v_mul_f32 v87, v87, v65
 v_mfma_f32_16x16x32_bf16 v[100:103], a[40:43], a[168:171], v[100:103]
 ds_read_b64_tr_b16 a[16:17], v46 offset:16384
 buffer_load_dwordx4 v10, s[12:15], s35 offen offset:0 sc1 lds
 v_mfma_f32_16x16x32_bf16 v[100:103], a[44:47], a[172:175], v[100:103]
 ds_read_b64_tr_b16 a[18:19], v46 offset:18432
 v_cvt_pk_bf16_f32 v80, v80, v81
 v_mfma_f32_16x16x32_bf16 v[100:103], a[48:51], a[176:179], v[100:103]
 ds_read_b64_tr_b16 a[20:21], v46 offset:20480
 v_cvt_pk_bf16_f32 v81, v82, v83
 v_mfma_f32_16x16x32_bf16 v[100:103], a[52:55], a[180:183], v[100:103]
 ds_read_b64_tr_b16 a[22:23], v46 offset:22528
 v_cvt_pk_bf16_f32 v82, v84, v85
 v_mfma_f32_16x16x32_bf16 v[100:103], a[56:59], a[184:187], v[100:103]
 s_add_u32 s58, s48, 1131520
 ds_read_b64_tr_b16 a[24:25], v46 offset:24576
 v_cvt_pk_bf16_f32 v83, v86, v87
 v_mfma_f32_16x16x32_bf16 v[100:103], a[60:63], a[188:191], v[100:103]
 s_waitcnt lgkmcnt(7)
 ds_read_b64_tr_b16 a[26:27], v46 offset:26624
 buffer_store_dwordx4 v[80:83], v1, s[12:15], s58 offen sc1
 v_mfma_f32_16x16x32_bf16 v[104:107], a[0:3], a[128:131], 0
 ds_read_b64_tr_b16 a[28:29], v46 offset:28672
 v_mul_f32 v88, v88, v64
 v_mfma_f32_16x16x32_bf16 v[104:107], a[4:7], a[132:135], v[104:107]
 s_add_u32 m0, s33, 1248
 ds_read_b64_tr_b16 a[30:31], v46 offset:30720
 v_xor_b32 v47, 0x30000, v47
 v_mfma_f32_16x16x32_bf16 v[104:107], a[8:11], a[136:139], v[104:107]
 s_waitcnt lgkmcnt(4)
 ds_read_b64_tr_b16 a[32:33], v47 offset:0
 buffer_load_dwordx4 v10, s[12:15], s35 offen offset:32 sc1 lds
 v_mfma_f32_16x16x32_bf16 v[104:107], a[12:15], a[140:143], v[104:107]
 ds_read_b64_tr_b16 a[34:35], v47 offset:2048
 v_mul_f32 v89, v89, v64
 v_mfma_f32_16x16x32_bf16 v[104:107], a[16:19], a[144:147], v[104:107]
 ds_read_b64_tr_b16 a[36:37], v47 offset:4096
 v_mul_f32 v90, v90, v64
 v_mfma_f32_16x16x32_bf16 v[104:107], a[20:23], a[148:151], v[104:107]
 s_waitcnt lgkmcnt(3)
 ds_read_b64_tr_b16 a[38:39], v47 offset:6144
 v_mul_f32 v91, v91, v64
 v_mfma_f32_16x16x32_bf16 v[104:107], a[24:27], a[152:155], v[104:107]
 ds_read_b64_tr_b16 a[40:41], v47 offset:8192
 v_mul_f32 v92, v92, v64
 v_mfma_f32_16x16x32_bf16 v[104:107], a[28:31], a[156:159], v[104:107]
 ds_read_b64_tr_b16 a[42:43], v47 offset:10240
 v_mul_f32 v93, v93, v64
 v_mfma_f32_16x16x32_bf16 v[112:115], a[0:3], a[160:163], 0
 s_add_u32 m0, s33, 2368
 ds_read_b64_tr_b16 a[44:45], v47 offset:12288
 v_mul_f32 v94, v94, v64
 v_mfma_f32_16x16x32_bf16 v[112:115], a[4:7], a[164:167], v[112:115]
 ds_read_b64_tr_b16 a[46:47], v47 offset:14336
 buffer_load_dwordx4 v10, s[12:15], s35 offen offset:64 sc1 lds
 v_mfma_f32_16x16x32_bf16 v[112:115], a[8:11], a[168:171], v[112:115]
 ds_read_b64_tr_b16 a[48:49], v47 offset:16384
 v_mul_f32 v95, v95, v64
 v_mfma_f32_16x16x32_bf16 v[112:115], a[12:15], a[172:175], v[112:115]
 ds_read_b64_tr_b16 a[50:51], v47 offset:18432
 v_cvt_pk_bf16_f32 v88, v88, v89
 v_mfma_f32_16x16x32_bf16 v[112:115], a[16:19], a[176:179], v[112:115]
 ds_read_b64_tr_b16 a[52:53], v47 offset:20480
 v_cvt_pk_bf16_f32 v89, v90, v91
 v_mfma_f32_16x16x32_bf16 v[112:115], a[20:23], a[180:183], v[112:115]
 ds_read_b64_tr_b16 a[54:55], v47 offset:22528
 v_cvt_pk_bf16_f32 v90, v92, v93
 v_mfma_f32_16x16x32_bf16 v[112:115], a[24:27], a[184:187], v[112:115]
 s_add_u32 m0, s33, 3488
 ds_read_b64_tr_b16 a[56:57], v47 offset:24576
 v_cvt_pk_bf16_f32 v91, v94, v95
 v_mfma_f32_16x16x32_bf16 v[112:115], a[28:31], a[188:191], v[112:115]
 s_waitcnt lgkmcnt(7)
 ds_read_b64_tr_b16 a[58:59], v47 offset:26624
 v_mul_f32 v96, v96, v65
 v_mfma_f32_16x16x32_bf16 v[108:111], a[32:35], a[128:131], 0
 s_waitcnt vmcnt(10)
 ds_read_b64_tr_b16 a[60:61], v47 offset:28672
 buffer_load_dwordx4 v10, s[12:15], s35 offen offset:96 sc1 lds
 v_mfma_f32_16x16x32_bf16 v[108:111], a[36:39], a[132:135], v[108:111]
 s_barrier
 ds_read_b64_tr_b16 a[62:63], v47 offset:30720
 v_xor_b32 v44, 0x20000, v44
 v_mfma_f32_16x16x32_bf16 v[108:111], a[40:43], a[136:139], v[108:111]
 s_waitcnt lgkmcnt(4)
 ds_read_b64_tr_b16 a[0:1], v44 offset:0
 v_mul_f32 v97, v97, v65
 v_mfma_f32_16x16x32_bf16 v[108:111], a[44:47], a[140:143], v[108:111]
 s_add_u32 s58, s48, 174080
 ds_read_b64_tr_b16 a[2:3], v44 offset:2048
 v_mul_f32 v98, v98, v65
 v_mfma_f32_16x16x32_bf16 v[108:111], a[48:51], a[144:147], v[108:111]
 ds_read_b64_tr_b16 a[4:5], v44 offset:4096
 buffer_store_dwordx4 v[88:91], v1, s[12:15], s58 offen sc1
 v_mfma_f32_16x16x32_bf16 v[108:111], a[52:55], a[148:151], v[108:111]
 s_waitcnt lgkmcnt(3)
 ds_read_b64_tr_b16 a[6:7], v44 offset:6144
 v_mul_f32 v99, v99, v65
 v_mfma_f32_16x16x32_bf16 v[108:111], a[56:59], a[152:155], v[108:111]
 ds_read_b64_tr_b16 a[8:9], v44 offset:8192
 v_mul_f32 v100, v100, v65
 v_mfma_f32_16x16x32_bf16 v[108:111], a[60:63], a[156:159], v[108:111]
 ds_read_b64_tr_b16 a[10:11], v44 offset:10240
 v_mul_f32 v101, v101, v65
 v_mfma_f32_16x16x32_bf16 v[116:119], a[32:35], a[160:163], 0
 ds_read_b64_tr_b16 a[12:13], v44 offset:12288
 v_mul_f32 v102, v102, v65
 v_mfma_f32_16x16x32_bf16 v[116:119], a[36:39], a[164:167], v[116:119]
 ds_read_b64_tr_b16 a[14:15], v44 offset:14336
 v_mul_f32 v103, v103, v65
 v_mfma_f32_16x16x32_bf16 v[116:119], a[40:43], a[168:171], v[116:119]
 ds_read_b64_tr_b16 a[16:17], v44 offset:16384
 v_cvt_pk_bf16_f32 v96, v96, v97
 v_mfma_f32_16x16x32_bf16 v[116:119], a[44:47], a[172:175], v[116:119]
 ds_read_b64_tr_b16 a[18:19], v44 offset:18432
 v_cvt_pk_bf16_f32 v97, v98, v99
 v_mfma_f32_16x16x32_bf16 v[116:119], a[48:51], a[176:179], v[116:119]
 ds_read_b64_tr_b16 a[20:21], v44 offset:20480
 v_cvt_pk_bf16_f32 v98, v100, v101
 v_mfma_f32_16x16x32_bf16 v[116:119], a[52:55], a[180:183], v[116:119]
 s_add_u32 s58, s48, 1148928
 ds_read_b64_tr_b16 a[22:23], v44 offset:22528
 v_cvt_pk_bf16_f32 v99, v102, v103
 v_mfma_f32_16x16x32_bf16 v[116:119], a[56:59], a[184:187], v[116:119]
 ds_read_b64_tr_b16 a[24:25], v44 offset:24576
 buffer_store_dwordx4 v[96:99], v1, s[12:15], s58 offen sc1
 v_mfma_f32_16x16x32_bf16 v[116:119], a[60:63], a[188:191], v[116:119]
 s_waitcnt lgkmcnt(7)
 ds_read_b64_tr_b16 a[26:27], v44 offset:26624
 v_mul_f32 v104, v104, v64
 v_mfma_f32_16x16x32_bf16 v[72:75], a[0:3], a[128:131], 0
 ds_read_b64_tr_b16 a[28:29], v44 offset:28672
 v_mul_f32 v105, v105, v64
 v_mfma_f32_16x16x32_bf16 v[72:75], a[4:7], a[132:135], v[72:75]
 ds_read_b64_tr_b16 a[30:31], v44 offset:30720
 v_xor_b32 v45, 0x20000, v45
 v_mfma_f32_16x16x32_bf16 v[72:75], a[8:11], a[136:139], v[72:75]
 s_waitcnt lgkmcnt(4)
 ds_read_b64_tr_b16 a[32:33], v45 offset:0
 v_mul_f32 v106, v106, v64
 v_mfma_f32_16x16x32_bf16 v[72:75], a[12:15], a[140:143], v[72:75]
 ds_read_b64_tr_b16 a[34:35], v45 offset:2048
 v_mul_f32 v107, v107, v64
 v_mfma_f32_16x16x32_bf16 v[72:75], a[16:19], a[144:147], v[72:75]
 ds_read_b64_tr_b16 a[36:37], v45 offset:4096
 v_mul_f32 v108, v108, v64
 v_mfma_f32_16x16x32_bf16 v[72:75], a[20:23], a[148:151], v[72:75]
 s_waitcnt lgkmcnt(3)
 ds_read_b64_tr_b16 a[38:39], v45 offset:6144
 v_mul_f32 v109, v109, v64
 v_mfma_f32_16x16x32_bf16 v[72:75], a[24:27], a[152:155], v[72:75]
 ds_read_b64_tr_b16 a[40:41], v45 offset:8192
 v_mul_f32 v110, v110, v64
 v_mfma_f32_16x16x32_bf16 v[72:75], a[28:31], a[156:159], v[72:75]
 ds_read_b64_tr_b16 a[42:43], v45 offset:10240
 v_mul_f32 v111, v111, v64
 v_mfma_f32_16x16x32_bf16 v[80:83], a[0:3], a[160:163], 0
 ds_read_b64_tr_b16 a[44:45], v45 offset:12288
 v_cvt_pk_bf16_f32 v104, v104, v105
 v_mfma_f32_16x16x32_bf16 v[80:83], a[4:7], a[164:167], v[80:83]
 ds_read_b64_tr_b16 a[46:47], v45 offset:14336
 v_cvt_pk_bf16_f32 v105, v106, v107
 v_mfma_f32_16x16x32_bf16 v[80:83], a[8:11], a[168:171], v[80:83]
 ds_read_b64_tr_b16 a[48:49], v45 offset:16384
 v_cvt_pk_bf16_f32 v106, v108, v109
 v_mfma_f32_16x16x32_bf16 v[80:83], a[12:15], a[172:175], v[80:83]
 s_add_u32 s58, s48, 191488
 ds_read_b64_tr_b16 a[50:51], v45 offset:18432
 v_cvt_pk_bf16_f32 v107, v110, v111
 v_mfma_f32_16x16x32_bf16 v[80:83], a[16:19], a[176:179], v[80:83]
 ds_read_b64_tr_b16 a[52:53], v45 offset:20480
 buffer_store_dwordx4 v[104:107], v1, s[12:15], s58 offen sc1
 v_mfma_f32_16x16x32_bf16 v[80:83], a[20:23], a[180:183], v[80:83]
 ds_read_b64_tr_b16 a[54:55], v45 offset:22528
 v_mul_f32 v112, v112, v65
 v_mfma_f32_16x16x32_bf16 v[80:83], a[24:27], a[184:187], v[80:83]
 ds_read_b64_tr_b16 a[56:57], v45 offset:24576
 v_mul_f32 v113, v113, v65
 v_mfma_f32_16x16x32_bf16 v[80:83], a[28:31], a[188:191], v[80:83]
 s_waitcnt lgkmcnt(7)
 ds_read_b64_tr_b16 a[58:59], v45 offset:26624
 v_mul_f32 v114, v114, v65
 v_mfma_f32_16x16x32_bf16 v[76:79], a[32:35], a[128:131], 0
 ds_read_b64_tr_b16 a[60:61], v45 offset:28672
 v_mul_f32 v115, v115, v65
 v_mfma_f32_16x16x32_bf16 v[76:79], a[36:39], a[132:135], v[76:79]
 ds_read_b64_tr_b16 a[62:63], v45 offset:30720
 v_xor_b32 v46, 0x20000, v46
 v_mfma_f32_16x16x32_bf16 v[76:79], a[40:43], a[136:139], v[76:79]
 s_waitcnt lgkmcnt(4)
 ds_read_b64_tr_b16 a[0:1], v46 offset:0
 v_mul_f32 v116, v116, v65
 v_mfma_f32_16x16x32_bf16 v[76:79], a[44:47], a[140:143], v[76:79]
 ds_read_b64_tr_b16 a[2:3], v46 offset:2048
 v_mul_f32 v117, v117, v65
 v_mfma_f32_16x16x32_bf16 v[76:79], a[48:51], a[144:147], v[76:79]
 ds_read_b64_tr_b16 a[4:5], v46 offset:4096
 v_mul_f32 v118, v118, v65
 v_mfma_f32_16x16x32_bf16 v[76:79], a[52:55], a[148:151], v[76:79]
 s_waitcnt lgkmcnt(3)
 ds_read_b64_tr_b16 a[6:7], v46 offset:6144
 v_mul_f32 v119, v119, v65
 v_mfma_f32_16x16x32_bf16 v[76:79], a[56:59], a[152:155], v[76:79]
 ds_read_b64_tr_b16 a[8:9], v46 offset:8192
 v_cvt_pk_bf16_f32 v112, v112, v113
 v_mfma_f32_16x16x32_bf16 v[76:79], a[60:63], a[156:159], v[76:79]
 ds_read_b64_tr_b16 a[10:11], v46 offset:10240
 v_cvt_pk_bf16_f32 v113, v114, v115
 v_mfma_f32_16x16x32_bf16 v[84:87], a[32:35], a[160:163], 0
 ds_read_b64_tr_b16 a[12:13], v46 offset:12288
 v_cvt_pk_bf16_f32 v114, v116, v117
 v_mfma_f32_16x16x32_bf16 v[84:87], a[36:39], a[164:167], v[84:87]
 s_add_u32 s58, s48, 1166336
 ds_read_b64_tr_b16 a[14:15], v46 offset:14336
 v_cvt_pk_bf16_f32 v115, v118, v119
 v_mfma_f32_16x16x32_bf16 v[84:87], a[40:43], a[168:171], v[84:87]
 ds_read_b64_tr_b16 a[16:17], v46 offset:16384
 buffer_store_dwordx4 v[112:115], v1, s[12:15], s58 offen sc1
 v_mfma_f32_16x16x32_bf16 v[84:87], a[44:47], a[172:175], v[84:87]
 ds_read_b64_tr_b16 a[18:19], v46 offset:18432
 v_mul_f32 v72, v72, v64
 v_mfma_f32_16x16x32_bf16 v[84:87], a[48:51], a[176:179], v[84:87]
 ds_read_b64_tr_b16 a[20:21], v46 offset:20480
 v_mul_f32 v73, v73, v64
 v_mfma_f32_16x16x32_bf16 v[84:87], a[52:55], a[180:183], v[84:87]
 ds_read_b64_tr_b16 a[22:23], v46 offset:22528
 v_mul_f32 v74, v74, v64
 v_mfma_f32_16x16x32_bf16 v[84:87], a[56:59], a[184:187], v[84:87]
 ds_read_b64_tr_b16 a[24:25], v46 offset:24576
 v_mul_f32 v75, v75, v64
 v_mfma_f32_16x16x32_bf16 v[84:87], a[60:63], a[188:191], v[84:87]
 s_waitcnt lgkmcnt(7)
 ds_read_b64_tr_b16 a[26:27], v46 offset:26624
 v_mul_f32 v76, v76, v64
 v_mfma_f32_16x16x32_bf16 v[88:91], a[0:3], a[128:131], 0
 ds_read_b64_tr_b16 a[28:29], v46 offset:28672
 v_mul_f32 v77, v77, v64
 v_mfma_f32_16x16x32_bf16 v[88:91], a[4:7], a[132:135], v[88:91]
 ds_read_b64_tr_b16 a[30:31], v46 offset:30720
 v_xor_b32 v47, 0x20000, v47
 v_mfma_f32_16x16x32_bf16 v[88:91], a[8:11], a[136:139], v[88:91]
 s_waitcnt lgkmcnt(4)
 ds_read_b64_tr_b16 a[32:33], v47 offset:0
 v_mul_f32 v78, v78, v64
 v_mfma_f32_16x16x32_bf16 v[88:91], a[12:15], a[140:143], v[88:91]
 ds_read_b64_tr_b16 a[34:35], v47 offset:2048
 v_mul_f32 v79, v79, v64
 v_mfma_f32_16x16x32_bf16 v[88:91], a[16:19], a[144:147], v[88:91]
 ds_read_b64_tr_b16 a[36:37], v47 offset:4096
 v_cvt_pk_bf16_f32 v72, v72, v73
 v_mfma_f32_16x16x32_bf16 v[88:91], a[20:23], a[148:151], v[88:91]
 s_waitcnt lgkmcnt(3)
 ds_read_b64_tr_b16 a[38:39], v47 offset:6144
 v_cvt_pk_bf16_f32 v73, v74, v75
 v_mfma_f32_16x16x32_bf16 v[88:91], a[24:27], a[152:155], v[88:91]
 ds_read_b64_tr_b16 a[40:41], v47 offset:8192
 v_cvt_pk_bf16_f32 v74, v76, v77
 v_mfma_f32_16x16x32_bf16 v[88:91], a[28:31], a[156:159], v[88:91]
 s_add_u32 s58, s48, 208896
 ds_read_b64_tr_b16 a[42:43], v47 offset:10240
 v_cvt_pk_bf16_f32 v75, v78, v79
 v_mfma_f32_16x16x32_bf16 v[96:99], a[0:3], a[160:163], 0
 ds_read_b64_tr_b16 a[44:45], v47 offset:12288
 buffer_store_dwordx4 v[72:75], v1, s[12:15], s58 offen sc1
 v_mfma_f32_16x16x32_bf16 v[96:99], a[4:7], a[164:167], v[96:99]
 ds_read_b64_tr_b16 a[46:47], v47 offset:14336
 v_mul_f32 v80, v80, v65
 v_mfma_f32_16x16x32_bf16 v[96:99], a[8:11], a[168:171], v[96:99]
 ds_read_b64_tr_b16 a[48:49], v47 offset:16384
 v_mul_f32 v81, v81, v65
 v_mfma_f32_16x16x32_bf16 v[96:99], a[12:15], a[172:175], v[96:99]
 ds_read_b64_tr_b16 a[50:51], v47 offset:18432
 v_mul_f32 v82, v82, v65
 v_mfma_f32_16x16x32_bf16 v[96:99], a[16:19], a[176:179], v[96:99]
 ds_read_b64_tr_b16 a[52:53], v47 offset:20480
 v_mul_f32 v83, v83, v65
 v_mfma_f32_16x16x32_bf16 v[96:99], a[20:23], a[180:183], v[96:99]
 ds_read_b64_tr_b16 a[54:55], v47 offset:22528
 v_mul_f32 v84, v84, v65
 v_mfma_f32_16x16x32_bf16 v[96:99], a[24:27], a[184:187], v[96:99]
 ds_read_b64_tr_b16 a[56:57], v47 offset:24576
 v_mul_f32 v85, v85, v65
 v_mfma_f32_16x16x32_bf16 v[96:99], a[28:31], a[188:191], v[96:99]
 s_waitcnt lgkmcnt(7)
 ds_read_b64_tr_b16 a[58:59], v47 offset:26624
 v_mul_f32 v86, v86, v65
 v_mfma_f32_16x16x32_bf16 v[92:95], a[32:35], a[128:131], 0
 ds_read_b64_tr_b16 a[60:61], v47 offset:28672
 v_mul_f32 v87, v87, v65
 v_mfma_f32_16x16x32_bf16 v[92:95], a[36:39], a[132:135], v[92:95]
 ds_read_b64_tr_b16 a[62:63], v47 offset:30720
 v_cvt_pk_bf16_f32 v80, v80, v81
 v_mfma_f32_16x16x32_bf16 v[92:95], a[40:43], a[136:139], v[92:95]
 s_waitcnt lgkmcnt(4)
 v_cvt_pk_bf16_f32 v81, v82, v83
 v_cvt_pk_bf16_f32 v82, v84, v85
 v_mfma_f32_16x16x32_bf16 v[92:95], a[44:47], a[140:143], v[92:95]
 s_add_u32 s58, s48, 1183744
 ds_write_b32 v11, v13 offset:0
 v_cvt_pk_bf16_f32 v83, v86, v87
 v_mul_f32 v88, v88, v64
 v_mfma_f32_16x16x32_bf16 v[92:95], a[48:51], a[144:147], v[92:95]
 ds_write_b32 v11, v13 offset:1152
 buffer_store_dwordx4 v[80:83], v1, s[12:15], s58 offen sc1
 v_mfma_f32_16x16x32_bf16 v[92:95], a[52:55], a[148:151], v[92:95]
 s_waitcnt lgkmcnt(0)
 ds_write_b32 v11, v13 offset:2304
 v_mul_f32 v89, v89, v64
 v_mul_f32 v90, v90, v64
 v_mfma_f32_16x16x32_bf16 v[92:95], a[56:59], a[152:155], v[92:95]
 ds_write_b32 v11, v13 offset:3456
 v_mul_f32 v91, v91, v64
 v_mul_f32 v96, v96, v65
 v_mfma_f32_16x16x32_bf16 v[92:95], a[60:63], a[156:159], v[92:95]
 ds_write_b32 v12, v13 offset:4608
 v_mul_f32 v97, v97, v65
 v_mul_f32 v98, v98, v65
 v_mfma_f32_16x16x32_bf16 v[100:103], a[32:35], a[160:163], 0
 v_mul_f32 v99, v99, v65
 v_mfma_f32_16x16x32_bf16 v[100:103], a[36:39], a[164:167], v[100:103]
 v_mfma_f32_16x16x32_bf16 v[100:103], a[40:43], a[168:171], v[100:103]
 v_mfma_f32_16x16x32_bf16 v[100:103], a[44:47], a[172:175], v[100:103]
 v_mfma_f32_16x16x32_bf16 v[100:103], a[48:51], a[176:179], v[100:103]
 v_mfma_f32_16x16x32_bf16 v[100:103], a[52:55], a[180:183], v[100:103]
 v_mfma_f32_16x16x32_bf16 v[100:103], a[56:59], a[184:187], v[100:103]
 v_mfma_f32_16x16x32_bf16 v[100:103], a[60:63], a[188:191], v[100:103]
 s_nop 4
 v_mul_f32 v92, v92, v64
 v_mul_f32 v93, v93, v64
 v_mul_f32 v94, v94, v64
 v_mul_f32 v95, v95, v64
 v_cvt_pk_bf16_f32 v88, v88, v89
 v_cvt_pk_bf16_f32 v89, v90, v91
 v_cvt_pk_bf16_f32 v90, v92, v93
 v_cvt_pk_bf16_f32 v91, v94, v95
 s_add_u32 s58, s48, 226304
 buffer_store_dwordx4 v[88:91], v1, s[12:15], s58 offen sc1
 v_mul_f32 v100, v100, v65
 v_mul_f32 v101, v101, v65
 v_mul_f32 v102, v102, v65
 v_mul_f32 v103, v103, v65
 v_cvt_pk_bf16_f32 v96, v96, v97
 v_cvt_pk_bf16_f32 v97, v98, v99
 v_cvt_pk_bf16_f32 v98, v100, v101
 v_cvt_pk_bf16_f32 v99, v102, v103
 s_add_u32 s58, s48, 1201152
 buffer_store_dwordx4 v[96:99], v1, s[12:15], s58 offen sc1
 s_cmp_eq_u32 s62, 0
 s_cbranch_scc1 L_nossm
 v_and_b32 v22, 15, v0
 v_lshrrev_b32 v23, 4, v0
 v_lshl_add_u32 v18, v22, 3, s33
 v_lshl_add_u32 v16, v23, 4, v18
 v_lshl_add_u32 v18, v23, 1, v18
 v_and_b32 v17, 3, v0
 v_bfe_u32 v24, v0, 2, 2
 v_sub_u32 v17, v17, v24
 v_lshlrev_b32 v24, 3, v23
 v_sub_u32 v17, v17, v24
 v_add_u32 v17, 32, v17
 v_lshl_add_u32 v17, v17, 3, s33
 v_lshlrev_b32 v20, 5, v22
 v_lshl_add_u32 v20, v23, 3, v20
 v_add_u32 v24, -1, v0
 v_and_b32 v24, 15, v24
 v_add_u32 v24, 48, v24
 v_add_u32 v19, -16, v0
 v_cmp_gt_u32 vcc, 16, v0
 v_accvgpr_read_b32 v21, a245
 s_add_u32 s34, s35, 4194304
 v_cndmask_b32 v19, v19, v24, vcc
 v_lshlrev_b32 v19, 2, v19
 v_cmp_eq_u32 vcc, 63, v0
 s_lshl_b32 s30, s31, 16
 s_and_b32 s31, s31, 0xffff0000
 s_bitcmp1_b32 s3, 0
 s_cselect_b32 s31, s31, s30
 v_mov_b64 v[224:225], 0
 v_mov_b64 v[226:227], 0
 v_mov_b64 v[228:229], 0
 v_mov_b64 v[230:231], 0
 v_mov_b64 v[232:233], 0
 v_mov_b64 v[234:235], 0
 v_mov_b64 v[236:237], 0
 v_mov_b64 v[238:239], 0
 v_mov_b64 v[240:241], 0
 v_mov_b64 v[242:243], 0
 v_mov_b64 v[244:245], 0
 v_mov_b64 v[246:247], 0
 v_mov_b64 v[248:249], 0
 v_mov_b64 v[250:251], 0
 v_mov_b64 v[252:253], 0
 v_mov_b64 v[254:255], 0
 s_waitcnt vmcnt(8) lgkmcnt(0)
 ds_read_b64_tr_b16 v[160:161], v17 offset:4608
 ds_read_b64_tr_b16 v[162:163], v17 offset:4576
 ds_read_b64_tr_b16 v[164:165], v17 offset:4864
 ds_read_b64_tr_b16 v[166:167], v17 offset:4832
 ds_read_b64 a[4:5], v16 offset:72
 ds_read_b64 a[6:7], v16 offset:80
 ds_read_b64 a[0:1], v16 offset:8
 ds_read_b64 a[2:3], v16 offset:16
 s_waitcnt lgkmcnt(6)
 ds_read_b64 a[68:69], v16 offset:1224
 ds_read_b64 a[70:71], v16 offset:1232
 ds_read_b64 a[64:65], v16 offset:1160
 ds_read_b64 a[66:67], v16 offset:1168
 ds_read_b64 a[132:133], v16 offset:2376
 ds_read_b64 a[134:135], v16 offset:2384
 ds_read_b64 a[128:129], v16 offset:2312
 ds_read_b64 a[130:131], v16 offset:2320
 s_waitcnt lgkmcnt(6)
 ds_read_b64 a[196:197], v16 offset:3528
 ds_read_b64 a[198:199], v16 offset:3536
 ds_read_b64 a[192:193], v16 offset:3464
 ds_read_b64 a[194:195], v16 offset:3472
 ds_read_b64_tr_b16 v[168:169], v17 offset:5120
 ds_read_b64_tr_b16 v[170:171], v17 offset:5088
 ds_read_b64_tr_b16 v[172:173], v17 offset:5376
 ds_read_b64_tr_b16 v[174:175], v17 offset:5344
 s_waitcnt lgkmcnt(6)
 ds_read_b64 a[12:13], v16 offset:200
 ds_read_b64 a[14:15], v16 offset:208
 ds_read_b64 a[8:9], v16 offset:136
 ds_read_b64 a[10:11], v16 offset:144
 ds_read_b64 a[76:77], v16 offset:1352
 ds_read_b64 a[78:79], v16 offset:1360
 ds_read_b64 a[72:73], v16 offset:1288
 ds_read_b64 a[74:75], v16 offset:1296
 s_waitcnt lgkmcnt(6)
 ds_read_b64 a[140:141], v16 offset:2504
 ds_read_b64 a[142:143], v16 offset:2512
 ds_read_b64 a[136:137], v16 offset:2440
 ds_read_b64 a[138:139], v16 offset:2448
 ds_read_b64 a[204:205], v16 offset:3656
 ds_read_b64 a[206:207], v16 offset:3664
 ds_read_b64 a[200:201], v16 offset:3592
 ds_read_b64 a[202:203], v16 offset:3600
 s_waitcnt lgkmcnt(6)
 ds_read_b64_tr_b16 v[176:177], v17 offset:5632
 ds_read_b64_tr_b16 v[178:179], v17 offset:5600
 ds_read_b64_tr_b16 v[180:181], v17 offset:5888
 ds_read_b64_tr_b16 v[182:183], v17 offset:5856
 s_waitcnt lgkmcnt(0)
 v_mfma_f32_16x16x32_bf16 v[32:35], v[160:163], a[4:7], 0
 ds_read_b64 a[20:21], v16 offset:328
 v_mfma_f32_16x16x32_bf16 v[32:35], v[164:167], a[0:3], v[32:35]
 ds_read_b64 a[22:23], v16 offset:336
 v_mfma_f32_16x16x32_bf16 v[36:39], v[160:163], a[68:71], 0
 ds_read_b64 a[16:17], v16 offset:264
 v_mfma_f32_16x16x32_bf16 v[36:39], v[164:167], a[64:67], v[36:39]
 ds_read_b64 a[18:19], v16 offset:272
 v_mfma_f32_16x16x32_bf16 v[40:43], v[160:163], a[132:135], 0
 ds_read_b64 a[84:85], v16 offset:1480
 v_mfma_f32_16x16x32_bf16 v[40:43], v[164:167], a[128:131], v[40:43]
 s_waitcnt vmcnt(0)
 ds_read_b64 a[86:87], v16 offset:1488
 v_mfma_f32_16x16x32_bf16 v[44:47], v[160:163], a[196:199], 0
 s_barrier
 ds_read_b64 a[80:81], v16 offset:1416
 v_mfma_f32_16x16x32_bf16 v[44:47], v[164:167], a[192:195], v[44:47]
 ds_read_b64 a[82:83], v16 offset:1424
 buffer_store_dword v21, v21, s[12:15], s93 offen sc1
 v_mfma_f32_16x16x32_bf16 v[48:51], v[160:163], a[12:15], 0
 ds_read_b64 a[148:149], v16 offset:2632
 v_mfma_f32_16x16x32_bf16 v[48:51], v[164:167], a[8:11], v[48:51]
 ds_read_b64 a[150:151], v16 offset:2640
 v_mfma_f32_16x16x32_bf16 v[48:51], v[168:171], a[4:7], v[48:51]
 ds_read_b64 a[144:145], v16 offset:2568
 v_and_b32 v2, 15, v0
 v_mfma_f32_16x16x32_bf16 v[48:51], v[172:175], a[0:3], v[48:51]
 ds_read_b64 a[146:147], v16 offset:2576
 v_lshlrev_b32 v11, 2, v2
 v_mfma_f32_16x16x32_bf16 v[52:55], v[160:163], a[76:79], 0
 ds_read_b64 a[212:213], v16 offset:3784
 v_mul_u32_u24 v7, 896, v2
 v_mfma_f32_16x16x32_bf16 v[52:55], v[164:167], a[72:75], v[52:55]
 ds_read_b64 a[214:215], v16 offset:3792
 v_lshrrev_b32 v3, 4, v0
 v_mfma_f32_16x16x32_bf16 v[52:55], v[168:171], a[68:71], v[52:55]
 ds_read_b64 a[208:209], v16 offset:3720
 v_lshlrev_b32 v8, 4, v3
 v_mfma_f32_16x16x32_bf16 v[52:55], v[172:175], a[64:67], v[52:55]
 ds_read_b64 a[210:211], v16 offset:3728
 v_lshl_add_u32 v2, v7, 1, v8
 v_mfma_f32_16x16x32_bf16 v[56:59], v[160:163], a[140:143], 0
 ds_read_b64_tr_b16 v[184:185], v17 offset:6144
 v_add_u32 v7, v7, v8
 v_mfma_f32_16x16x32_bf16 v[56:59], v[164:167], a[136:139], v[56:59]
 ds_read_b64_tr_b16 v[186:187], v17 offset:6112
 v_and_b32 v4, 1, v0
 v_mfma_f32_16x16x32_bf16 v[56:59], v[168:171], a[132:135], v[56:59]
 ds_read_b64_tr_b16 v[188:189], v17 offset:6400
 v_lshlrev_b32 v4, 4, v4
 v_mfma_f32_16x16x32_bf16 v[56:59], v[172:175], a[128:131], v[56:59]
 ds_read_b64_tr_b16 v[190:191], v17 offset:6368
 v_mov_b32 v5, 0x3f80
 v_mfma_f32_16x16x32_bf16 v[60:63], v[160:163], a[204:207], 0
 ds_read_b64 a[28:29], v16 offset:456
 v_lshlrev_b32 v4, v4, v5
 v_mfma_f32_16x16x32_bf16 v[60:63], v[164:167], a[200:203], v[60:63]
 ds_read_b64 a[30:31], v16 offset:464
 v_bfe_u32 v5, v0, 3, 1
 v_mfma_f32_16x16x32_bf16 v[60:63], v[168:171], a[196:199], v[60:63]
 ds_read_b64 a[24:25], v16 offset:392
 v_bfe_u32 v6, v0, 1, 1
 v_mfma_f32_16x16x32_bf16 v[60:63], v[172:175], a[192:195], v[60:63]
 s_waitcnt lgkmcnt(15)
 ds_read_b64 a[26:27], v16 offset:400
 v_lshl_add_u32 v5, v5, 1, v6
 v_mfma_f32_16x16x32_bf16 v[64:67], v[160:163], a[20:23], 0
 ds_read_b64 a[92:93], v16 offset:1608
 v_bfe_u32 v6, v0, 2, 1
 v_mfma_f32_16x16x32_bf16 v[64:67], v[164:167], a[16:19], v[64:67]
 ds_read_b64 a[94:95], v16 offset:1616
 v_lshlrev_b32 v6, 1, v6
 v_mfma_f32_16x16x32_bf16 v[64:67], v[168:171], a[12:15], v[64:67]
 ds_read_b64 a[88:89], v16 offset:1544
 v_sub_u32 v6, v3, v6
 v_mfma_f32_16x16x32_bf16 v[64:67], v[172:175], a[8:11], v[64:67]
 ds_read_b64 a[90:91], v16 offset:1552
 v_lshl_add_u32 v5, v6, 2, v5
 v_mfma_f32_16x16x32_bf16 v[64:67], v[176:179], a[4:7], v[64:67]
 ds_read_b64 a[156:157], v16 offset:2760
 v_cmp_eq_u32 s[16:17], 0, v5
 v_mfma_f32_16x16x32_bf16 v[64:67], v[180:183], a[0:3], v[64:67]
 ds_read_b64 a[158:159], v16 offset:2768
 v_cmp_eq_u32 s[18:19], 1, v5
 v_mfma_f32_16x16x32_bf16 v[68:71], v[160:163], a[84:87], 0
 ds_read_b64 a[152:153], v16 offset:2696
 v_cmp_eq_u32 s[20:21], 2, v5
 v_mfma_f32_16x16x32_bf16 v[68:71], v[164:167], a[80:83], v[68:71]
 ds_read_b64 a[154:155], v16 offset:2704
 v_cmp_eq_u32 s[22:23], 3, v5
 v_mfma_f32_16x16x32_bf16 v[68:71], v[168:171], a[76:79], v[68:71]
 ds_read_b64 a[220:221], v16 offset:3912
 v_cndmask_b32 v24, 0, v4, s[16:17]
 v_mfma_f32_16x16x32_bf16 v[68:71], v[172:175], a[72:75], v[68:71]
 ds_read_b64 a[222:223], v16 offset:3920
 v_cndmask_b32 v25, 0, v4, s[18:19]
 v_mfma_f32_16x16x32_bf16 v[68:71], v[176:179], a[68:71], v[68:71]
 ds_read_b64 a[216:217], v16 offset:3848
 v_cndmask_b32 v26, 0, v4, s[20:21]
 v_mfma_f32_16x16x32_bf16 v[68:71], v[180:183], a[64:67], v[68:71]
 s_waitcnt lgkmcnt(15)
 ds_read_b64 a[218:219], v16 offset:3856
 v_cndmask_b32 v27, 0, v4, s[22:23]
 v_mfma_f32_16x16x32_bf16 v[72:75], v[160:163], a[148:151], 0
 ds_read_b64_tr_b16 v[192:193], v17 offset:6656
 v_cmp_eq_u32 s[16:17], 4, v5
 v_mfma_f32_16x16x32_bf16 v[72:75], v[164:167], a[144:147], v[72:75]
 ds_read_b64_tr_b16 v[194:195], v17 offset:6624
 v_cmp_eq_u32 s[18:19], 5, v5
 v_mfma_f32_16x16x32_bf16 v[72:75], v[168:171], a[140:143], v[72:75]
 ds_read_b64_tr_b16 v[196:197], v17 offset:6912
 v_cmp_eq_u32 s[20:21], 6, v5
 v_mfma_f32_16x16x32_bf16 v[72:75], v[172:175], a[136:139], v[72:75]
 ds_read_b64_tr_b16 v[198:199], v17 offset:6880
 v_cmp_eq_u32 s[22:23], 7, v5
 v_mfma_f32_16x16x32_bf16 v[72:75], v[176:179], a[132:135], v[72:75]
 ds_read_b64 a[36:37], v16 offset:584
 v_cndmask_b32 v28, 0, v4, s[16:17]
 v_mfma_f32_16x16x32_bf16 v[72:75], v[180:183], a[128:131], v[72:75]
 ds_read_b64 a[38:39], v16 offset:592
 v_cndmask_b32 v29, 0, v4, s[18:19]
 v_mfma_f32_16x16x32_bf16 v[76:79], v[160:163], a[212:215], 0
 ds_read_b64 a[32:33], v16 offset:520
 v_cndmask_b32 v30, 0, v4, s[20:21]
 v_mfma_f32_16x16x32_bf16 v[76:79], v[164:167], a[208:211], v[76:79]
 ds_read_b64 a[34:35], v16 offset:528
 v_cndmask_b32 v31, 0, v4, s[22:23]
 v_mfma_f32_16x16x32_bf16 v[76:79], v[168:171], a[204:207], v[76:79]
 s_mov_b32 s8, s88
 ds_read_b64 a[100:101], v16 offset:1736
 v_mfma_f32_16x16x32_bf16 v[76:79], v[172:175], a[200:203], v[76:79]
 s_mov_b32 s9, s89
 ds_read_b64 a[102:103], v16 offset:1744
 v_mfma_f32_16x16x32_bf16 v[76:79], v[176:179], a[196:199], v[76:79]
 s_mov_b32 s10, 3670016
 ds_read_b64 a[96:97], v16 offset:1672
 v_mfma_f32_16x16x32_bf16 v[76:79], v[180:183], a[192:195], v[76:79]
 s_waitcnt lgkmcnt(15)
 ds_read_b64 a[98:99], v16 offset:1680
 v_mfma_f32_16x16x32_bf16 v[80:83], v[160:163], a[28:31], 0
 s_mov_b32 s11, 0x20000
 ds_read_b64 a[164:165], v16 offset:2888
 v_mfma_f32_16x16x32_bf16 v[80:83], v[164:167], a[24:27], v[80:83]
 s_mov_b32 s16, s64
 ds_read_b64 a[166:167], v16 offset:2896
 v_mfma_f32_16x16x32_bf16 v[80:83], v[168:171], a[20:23], v[80:83]
 s_mov_b32 s17, s65
 ds_read_b64 a[160:161], v16 offset:2824
 v_mfma_f32_16x16x32_bf16 v[80:83], v[172:175], a[16:19], v[80:83]
 s_mov_b32 s18, 1835008
 ds_read_b64 a[162:163], v16 offset:2832
 v_mfma_f32_16x16x32_bf16 v[80:83], v[176:179], a[12:15], v[80:83]
 s_mov_b32 s19, 0x20000
 ds_read_b64 a[228:229], v16 offset:4040
 v_mfma_f32_16x16x32_bf16 v[80:83], v[180:183], a[8:11], v[80:83]
 s_lshl_b32 s58, s3, 12
 ds_read_b64 a[230:231], v16 offset:4048
 v_mfma_f32_16x16x32_bf16 v[80:83], v[184:187], a[4:7], v[80:83]
 s_add_u32 s58, s58, 0x20000
 ds_read_b64 a[224:225], v16 offset:3976
 v_mfma_f32_16x16x32_bf16 v[80:83], v[188:191], a[0:3], v[80:83]
 s_mov_b32 s59, 0xffff0000
 ds_read_b64 a[226:227], v16 offset:3984
 v_lshrrev_b32 v8, 1, v0
 v_mfma_f32_16x16x32_bf16 v[84:87], v[160:163], a[92:95], 0
 ds_read_b64_tr_b16 v[200:201], v17 offset:7168
 v_mul_u32_u24 v8, 4096, v8
 v_mfma_f32_16x16x32_bf16 v[84:87], v[164:167], a[88:91], v[84:87]
 ds_read_b64_tr_b16 v[202:203], v17 offset:7136
 v_and_b32 v6, 1, v0
 v_mfma_f32_16x16x32_bf16 v[84:87], v[168:171], a[84:87], v[84:87]
 ds_read_b64_tr_b16 v[204:205], v17 offset:7424
 v_lshl_add_u32 v8, v6, 4, v8
 v_mfma_f32_16x16x32_bf16 v[84:87], v[172:175], a[80:83], v[84:87]
 ds_read_b64_tr_b16 v[206:207], v17 offset:7392
 v_lshlrev_b32 v10, 3, v3
 v_mfma_f32_16x16x32_bf16 v[84:87], v[176:179], a[76:79], v[84:87]
 ds_read_b64 a[44:45], v16 offset:712
 v_bfe_u32 v6, v0, 2, 2
 v_mfma_f32_16x16x32_bf16 v[84:87], v[180:183], a[72:75], v[84:87]
 ds_read_b64 a[46:47], v16 offset:720
 v_add_u32 v10, v10, v6
 v_mfma_f32_16x16x32_bf16 v[84:87], v[184:187], a[68:71], v[84:87]
 ds_read_b64 a[40:41], v16 offset:648
 v_lshlrev_b32 v10, 5, v10
 v_mfma_f32_16x16x32_bf16 v[84:87], v[188:191], a[64:67], v[84:87]
 ds_read_b64 a[42:43], v16 offset:656
 v_and_b32 v6, 3, v0
 v_mfma_f32_16x16x32_bf16 v[88:91], v[160:163], a[156:159], 0
 ds_read_b64 a[108:109], v16 offset:1864
 v_lshl_add_u32 v10, v6, 3, v10
 v_mfma_f32_16x16x32_bf16 v[88:91], v[164:167], a[152:155], v[88:91]
 ds_read_b64 a[110:111], v16 offset:1872
 v_add_u32 v10, s58, v10
 v_mfma_f32_16x16x32_bf16 v[88:91], v[168:171], a[148:151], v[88:91]
 ds_read_b64 a[104:105], v16 offset:1800
 v_mov_b32 v5, 0x24000
 v_mfma_f32_16x16x32_bf16 v[88:91], v[172:175], a[144:147], v[88:91]
 ds_read_b64 a[106:107], v16 offset:1808
 v_lshrrev_b32 v4, 2, v0
 v_mfma_f32_16x16x32_bf16 v[88:91], v[176:179], a[140:143], v[88:91]
 ds_read_b64 a[172:173], v16 offset:3016
 v_lshl_add_u32 v11, v6, 4, v4
 v_mfma_f32_16x16x32_bf16 v[88:91], v[180:183], a[136:139], v[88:91]
 ds_read_b64 a[174:175], v16 offset:3024
 v_lshlrev_b32 v11, 2, v11
 v_mfma_f32_16x16x32_bf16 v[88:91], v[184:187], a[132:135], v[88:91]
 ds_read_b64 a[168:169], v16 offset:2952
 v_mul_u32_u24 v7, 896, v4
 v_mfma_f32_16x16x32_bf16 v[88:91], v[188:191], a[128:131], v[88:91]
 s_waitcnt lgkmcnt(15)
 ds_read_b64 a[170:171], v16 offset:2960
 v_lshlrev_b32 v6, 4, v6
 v_mfma_f32_16x16x32_bf16 v[92:95], v[160:163], a[220:223], 0
 ds_read_b64 a[236:237], v16 offset:4168
 v_lshl_add_u32 v3, v7, 1, v6
 v_mfma_f32_16x16x32_bf16 v[92:95], v[164:167], a[216:219], v[92:95]
 ds_read_b64 a[238:239], v16 offset:4176
 v_add_u32 v7, v7, v6
 v_mfma_f32_16x16x32_bf16 v[92:95], v[168:171], a[212:215], v[92:95]
 s_bfe_u32 s40, s2, 0x20003
 ds_read_b64 a[232:233], v16 offset:4104
 v_mfma_f32_16x16x32_bf16 v[92:95], v[172:175], a[208:211], v[92:95]
 s_lshl_b32 s38, s40, 12
 ds_read_b64 a[234:235], v16 offset:4112
 v_mfma_f32_16x16x32_bf16 v[92:95], v[176:179], a[204:207], v[92:95]
 s_add_u32 s38, s38, 84967424
 ds_read_b64_tr_b16 v[208:209], v17 offset:7680
 v_mfma_f32_16x16x32_bf16 v[92:95], v[180:183], a[200:203], v[92:95]
 s_lshl_b32 s93, s95, 2
 ds_read_b64_tr_b16 v[210:211], v17 offset:7648
 v_mfma_f32_16x16x32_bf16 v[92:95], v[184:187], a[196:199], v[92:95]
 s_add_u32 s93, s93, 84963328
 ds_read_b64_tr_b16 v[212:213], v17 offset:7936
 v_mfma_f32_16x16x32_bf16 v[92:95], v[188:191], a[192:195], v[92:95]
 ds_read_b64_tr_b16 v[214:215], v17 offset:7904
 v_mfma_f32_16x16x32_bf16 v[96:99], v[160:163], a[36:39], 0
 ds_read_b64 a[52:53], v16 offset:840
 v_mfma_f32_16x16x32_bf16 v[96:99], v[164:167], a[32:35], v[96:99]
 ds_read_b64 a[54:55], v16 offset:848
 v_mfma_f32_16x16x32_bf16 v[96:99], v[168:171], a[28:31], v[96:99]
 ds_read_b64 a[48:49], v16 offset:776
 v_mfma_f32_16x16x32_bf16 v[96:99], v[172:175], a[24:27], v[96:99]
 ds_read_b64 a[50:51], v16 offset:784
 v_mfma_f32_16x16x32_bf16 v[96:99], v[176:179], a[20:23], v[96:99]
 ds_read_b64 a[116:117], v16 offset:1992
 v_mfma_f32_16x16x32_bf16 v[96:99], v[180:183], a[16:19], v[96:99]
 ds_read_b64 a[118:119], v16 offset:2000
 v_mfma_f32_16x16x32_bf16 v[96:99], v[184:187], a[12:15], v[96:99]
 ds_read_b64 a[112:113], v16 offset:1928
 v_add_f32 v39, v39, v42
 v_mfma_f32_16x16x32_bf16 v[96:99], v[188:191], a[8:11], v[96:99]
 ds_read_b64 a[114:115], v16 offset:1936
 v_add_f32 v43, v43, v46
 v_mfma_f32_16x16x32_bf16 v[96:99], v[192:195], a[4:7], v[96:99]
 ds_read_b64 a[180:181], v16 offset:3144
 v_add_f32 v39, v39, v45
 v_mfma_f32_16x16x32_bf16 v[96:99], v[196:199], a[0:3], v[96:99]
 ds_read_b64 a[182:183], v16 offset:3152
 v_cndmask_b32_e64 v224, v39, 0, vcc
 v_mfma_f32_16x16x32_bf16 v[100:103], v[160:163], a[100:103], 0
 ds_read_b64 a[176:177], v16 offset:3080
 v_cndmask_b32_e64 v225, v43, 0, vcc
 v_mfma_f32_16x16x32_bf16 v[100:103], v[164:167], a[96:99], v[100:103]
 ds_read_b64 a[178:179], v16 offset:3088
 v_cndmask_b32_e64 v226, v47, 0, vcc
 v_mfma_f32_16x16x32_bf16 v[100:103], v[168:171], a[92:95], v[100:103]
 ds_read_b64 a[244:245], v16 offset:4296
 v_add_f32 v33, v33, v36
 v_mfma_f32_16x16x32_bf16 v[100:103], v[172:175], a[88:91], v[100:103]
 ds_read_b64 a[246:247], v16 offset:4304
 v_add_f32 v34, v34, v37
 v_mfma_f32_16x16x32_bf16 v[100:103], v[176:179], a[84:87], v[100:103]
 ds_read_b64 a[240:241], v16 offset:4232
 v_add_f32 v35, v35, v38
 v_mfma_f32_16x16x32_bf16 v[100:103], v[180:183], a[80:83], v[100:103]
 ds_read_b64 a[242:243], v16 offset:4240
 v_add_f32 v34, v34, v40
 v_mfma_f32_16x16x32_bf16 v[100:103], v[184:187], a[76:79], v[100:103]
 ds_read_b64_tr_b16 v[216:217], v17 offset:8192
 v_add_f32 v35, v35, v41
 v_mfma_f32_16x16x32_bf16 v[100:103], v[188:191], a[72:75], v[100:103]
 ds_read_b64_tr_b16 v[218:219], v17 offset:8160
 v_add_f32 v35, v35, v44
 v_mfma_f32_16x16x32_bf16 v[100:103], v[192:195], a[68:71], v[100:103]
 ds_read_b64_tr_b16 v[220:221], v17 offset:8448
 v_add_f32 v55, v55, v58
 v_mfma_f32_16x16x32_bf16 v[100:103], v[196:199], a[64:67], v[100:103]
 ds_read_b64_tr_b16 v[222:223], v17 offset:8416
 v_add_f32 v59, v59, v62
 v_mfma_f32_16x16x32_bf16 v[104:107], v[160:163], a[164:167], 0
 ds_read_b64 a[60:61], v16 offset:968
 v_add_f32 v55, v55, v61
 v_mfma_f32_16x16x32_bf16 v[104:107], v[164:167], a[160:163], v[104:107]
 ds_read_b64 a[62:63], v16 offset:976
 v_cndmask_b32_e64 v232, v55, v39, vcc
 v_mfma_f32_16x16x32_bf16 v[104:107], v[168:171], a[156:159], v[104:107]
 ds_read_b64 a[56:57], v16 offset:904
 v_cndmask_b32_e64 v233, v59, v43, vcc
 v_mfma_f32_16x16x32_bf16 v[104:107], v[172:175], a[152:155], v[104:107]
 ds_read_b64 a[58:59], v16 offset:912
 v_cndmask_b32_e64 v234, v63, v47, vcc
 v_mfma_f32_16x16x32_bf16 v[104:107], v[176:179], a[148:151], v[104:107]
 ds_read_b64 a[124:125], v16 offset:2120
 v_add_f32 v49, v49, v52
 v_mfma_f32_16x16x32_bf16 v[104:107], v[180:183], a[144:147], v[104:107]
 ds_read_b64 a[126:127], v16 offset:2128
 v_add_f32 v50, v50, v53
 v_mfma_f32_16x16x32_bf16 v[104:107], v[184:187], a[140:143], v[104:107]
 ds_read_b64 a[120:121], v16 offset:2056
 v_add_f32 v51, v51, v54
 v_mfma_f32_16x16x32_bf16 v[104:107], v[188:191], a[136:139], v[104:107]
 ds_read_b64 a[122:123], v16 offset:2064
 v_add_f32 v50, v50, v56
 v_mfma_f32_16x16x32_bf16 v[104:107], v[192:195], a[132:135], v[104:107]
 ds_read_b64 a[188:189], v16 offset:3272
 v_add_f32 v51, v51, v57
 v_mfma_f32_16x16x32_bf16 v[104:107], v[196:199], a[128:131], v[104:107]
 ds_read_b64 a[190:191], v16 offset:3280
 v_add_f32 v51, v51, v60
 v_mfma_f32_16x16x32_bf16 v[108:111], v[160:163], a[228:231], 0
 ds_read_b64 a[184:185], v16 offset:3208
 v_add_f32 v71, v71, v74
 v_mfma_f32_16x16x32_bf16 v[108:111], v[164:167], a[224:227], v[108:111]
 ds_read_b64 a[186:187], v16 offset:3216
 v_add_f32 v75, v75, v78
 v_mfma_f32_16x16x32_bf16 v[108:111], v[168:171], a[220:223], v[108:111]
 ds_read_b64 v[12:13], v16 offset:4424
 v_add_f32 v71, v71, v77
 v_mfma_f32_16x16x32_bf16 v[108:111], v[172:175], a[216:219], v[108:111]
 ds_read_b64 v[14:15], v16 offset:4432
 v_cndmask_b32_e64 v240, v71, v55, vcc
 v_mfma_f32_16x16x32_bf16 v[108:111], v[176:179], a[212:215], v[108:111]
 ds_read_b64 a[248:249], v16 offset:4360
 v_cndmask_b32_e64 v241, v75, v59, vcc
 v_mfma_f32_16x16x32_bf16 v[108:111], v[180:183], a[208:211], v[108:111]
 ds_read_b64 a[250:251], v16 offset:4368
 v_cndmask_b32_e64 v242, v79, v63, vcc
 v_mfma_f32_16x16x32_bf16 v[108:111], v[184:187], a[204:207], v[108:111]
 ds_bpermute_b32 v224, v19, v224
 v_add_f32 v65, v65, v68
 v_mfma_f32_16x16x32_bf16 v[108:111], v[188:191], a[200:203], v[108:111]
 ds_bpermute_b32 v225, v19, v225
 v_add_f32 v66, v66, v69
 v_mfma_f32_16x16x32_bf16 v[108:111], v[192:195], a[196:199], v[108:111]
 ds_bpermute_b32 v226, v19, v226
 v_add_f32 v67, v67, v70
 v_mfma_f32_16x16x32_bf16 v[108:111], v[196:199], a[192:195], v[108:111]
 s_waitcnt lgkmcnt(15)
 ds_read_u16_d16_hi v228, v18 offset:128
 v_add_f32 v66, v66, v72
 v_mfma_f32_16x16x32_bf16 v[112:115], v[160:163], a[44:47], 0
 ds_read_u16_d16_hi v229, v18 offset:1280
 v_add_f32 v67, v67, v73
 v_mfma_f32_16x16x32_bf16 v[112:115], v[164:167], a[40:43], v[112:115]
 ds_read_u16_d16_hi v230, v18 offset:2432
 v_add_f32 v67, v67, v76
 v_mfma_f32_16x16x32_bf16 v[112:115], v[168:171], a[36:39], v[112:115]
 ds_read_u16_d16_hi v231, v18 offset:3584
 v_add_f32 v87, v87, v90
 v_mfma_f32_16x16x32_bf16 v[112:115], v[172:175], a[32:35], v[112:115]
 ds_bpermute_b32 v232, v19, v232
 v_add_f32 v91, v91, v94
 v_mfma_f32_16x16x32_bf16 v[112:115], v[176:179], a[28:31], v[112:115]
 ds_bpermute_b32 v233, v19, v233
 v_add_f32 v87, v87, v93
 v_mfma_f32_16x16x32_bf16 v[112:115], v[180:183], a[24:27], v[112:115]
 ds_bpermute_b32 v234, v19, v234
 v_cndmask_b32_e64 v248, v87, v71, vcc
 v_mfma_f32_16x16x32_bf16 v[112:115], v[184:187], a[20:23], v[112:115]
 ds_read_u16_d16_hi v236, v18 offset:256
 v_cndmask_b32_e64 v249, v91, v75, vcc
 v_mfma_f32_16x16x32_bf16 v[112:115], v[188:191], a[16:19], v[112:115]
 ds_read_u16_d16_hi v237, v18 offset:1408
 v_cndmask_b32_e64 v250, v95, v79, vcc
 v_mfma_f32_16x16x32_bf16 v[112:115], v[192:195], a[12:15], v[112:115]
 s_waitcnt lgkmcnt(10)
 v_add_f32 v32, v32, v224
 v_add_f32 v33, v33, v225
 v_mfma_f32_16x16x32_bf16 v[112:115], v[196:199], a[8:11], v[112:115]
 s_waitcnt lgkmcnt(8)
 v_add_f32 v34, v34, v226
 v_fmac_f32 v32, s31, v228
 v_mfma_f32_16x16x32_bf16 v[112:115], v[200:203], a[4:7], v[112:115]
 s_waitcnt lgkmcnt(6)
 v_fmac_f32 v33, s31, v229
 v_fmac_f32 v34, s31, v230
 v_mfma_f32_16x16x32_bf16 v[112:115], v[204:207], a[0:3], v[112:115]
 s_waitcnt lgkmcnt(5)
 v_fmac_f32 v35, s31, v231
 v_cvt_pk_bf16_f32 v32, v32, v33
 v_mfma_f32_16x16x32_bf16 v[116:119], v[160:163], a[108:111], 0
 ds_read_u16_d16_hi v238, v18 offset:2560
 v_cvt_pk_bf16_f32 v33, v34, v35
 v_mfma_f32_16x16x32_bf16 v[116:119], v[164:167], a[104:107], v[116:119]
 buffer_store_dwordx2 v[32:33], v20, s[12:15], s34 offen offset:0 sc1
 v_mfma_f32_16x16x32_bf16 v[116:119], v[168:171], a[100:103], v[116:119]
 ds_read_u16_d16_hi v239, v18 offset:3712
 v_add_f32 v81, v81, v84
 v_mfma_f32_16x16x32_bf16 v[116:119], v[172:175], a[96:99], v[116:119]
 ds_bpermute_b32 v240, v19, v240
 v_add_f32 v82, v82, v85
 v_mfma_f32_16x16x32_bf16 v[116:119], v[176:179], a[92:95], v[116:119]
 ds_bpermute_b32 v241, v19, v241
 v_add_f32 v83, v83, v86
 v_mfma_f32_16x16x32_bf16 v[116:119], v[180:183], a[88:91], v[116:119]
 ds_bpermute_b32 v242, v19, v242
 v_add_f32 v82, v82, v88
 v_mfma_f32_16x16x32_bf16 v[116:119], v[184:187], a[84:87], v[116:119]
 ds_read_u16_d16_hi v244, v18 offset:384
 v_add_f32 v83, v83, v89
 v_mfma_f32_16x16x32_bf16 v[116:119], v[188:191], a[80:83], v[116:119]
 ds_read_u16_d16_hi v245, v18 offset:1536
 v_add_f32 v83, v83, v92
 v_mfma_f32_16x16x32_bf16 v[116:119], v[192:195], a[76:79], v[116:119]
 s_waitcnt lgkmcnt(10)
 v_add_f32 v48, v48, v232
 v_add_f32 v49, v49, v233
 v_mfma_f32_16x16x32_bf16 v[116:119], v[196:199], a[72:75], v[116:119]
 s_waitcnt lgkmcnt(8)
 v_add_f32 v50, v50, v234
 v_fmac_f32 v48, s31, v236
 v_mfma_f32_16x16x32_bf16 v[116:119], v[200:203], a[68:71], v[116:119]
 s_waitcnt lgkmcnt(6)
 v_fmac_f32 v49, s31, v237
 v_fmac_f32 v50, s31, v238
 v_mfma_f32_16x16x32_bf16 v[116:119], v[204:207], a[64:67], v[116:119]
 s_waitcnt lgkmcnt(5)
 v_fmac_f32 v51, s31, v239
 v_cvt_pk_bf16_f32 v48, v48, v49
 v_mfma_f32_16x16x32_bf16 v[120:123], v[160:163], a[172:175], 0
 ds_read_u16_d16_hi v246, v18 offset:2688
 v_cvt_pk_bf16_f32 v49, v50, v51
 v_mfma_f32_16x16x32_bf16 v[120:123], v[164:167], a[168:171], v[120:123]
 buffer_store_dwordx2 v[48:49], v20, s[12:15], s34 offen offset:512 sc1
 v_mfma_f32_16x16x32_bf16 v[120:123], v[168:171], a[164:167], v[120:123]
 ds_read_u16_d16_hi v247, v18 offset:3840
 v_add_f32 v103, v103, v106
 v_mfma_f32_16x16x32_bf16 v[120:123], v[172:175], a[160:163], v[120:123]
 ds_bpermute_b32 v248, v19, v248
 v_add_f32 v107, v107, v110
 v_mfma_f32_16x16x32_bf16 v[120:123], v[176:179], a[156:159], v[120:123]
 ds_bpermute_b32 v249, v19, v249
 v_add_f32 v103, v103, v109
 v_mfma_f32_16x16x32_bf16 v[120:123], v[180:183], a[152:155], v[120:123]
 ds_bpermute_b32 v250, v19, v250
 v_cndmask_b32_e64 v224, v103, v87, vcc
 v_mfma_f32_16x16x32_bf16 v[120:123], v[184:187], a[148:151], v[120:123]
 ds_read_u16_d16_hi v252, v18 offset:512
 v_cndmask_b32_e64 v225, v107, v91, vcc
 v_mfma_f32_16x16x32_bf16 v[120:123], v[188:191], a[144:147], v[120:123]
 ds_read_u16_d16_hi v253, v18 offset:1664
 v_cndmask_b32_e64 v226, v111, v95, vcc
 v_mfma_f32_16x16x32_bf16 v[120:123], v[192:195], a[140:143], v[120:123]
 s_waitcnt lgkmcnt(10)
 v_add_f32 v64, v64, v240
 v_add_f32 v65, v65, v241
 v_mfma_f32_16x16x32_bf16 v[120:123], v[196:199], a[136:139], v[120:123]
 s_waitcnt lgkmcnt(8)
 v_add_f32 v66, v66, v242
 v_fmac_f32 v64, s31, v244
 v_mfma_f32_16x16x32_bf16 v[120:123], v[200:203], a[132:135], v[120:123]
 s_waitcnt lgkmcnt(6)
 v_fmac_f32 v65, s31, v245
 v_fmac_f32 v66, s31, v246
 v_mfma_f32_16x16x32_bf16 v[120:123], v[204:207], a[128:131], v[120:123]
 s_waitcnt lgkmcnt(5)
 v_fmac_f32 v67, s31, v247
 v_cvt_pk_bf16_f32 v64, v64, v65
 v_mfma_f32_16x16x32_bf16 v[124:127], v[160:163], a[236:239], 0
 ds_read_u16_d16_hi v254, v18 offset:2816
 v_cvt_pk_bf16_f32 v65, v66, v67
 v_mfma_f32_16x16x32_bf16 v[124:127], v[164:167], a[232:235], v[124:127]
 buffer_store_dwordx2 v[64:65], v20, s[12:15], s34 offen offset:1024 sc1
 v_mfma_f32_16x16x32_bf16 v[124:127], v[168:171], a[228:231], v[124:127]
 ds_read_u16_d16_hi v255, v18 offset:3968
 v_add_f32 v97, v97, v100
 v_mfma_f32_16x16x32_bf16 v[124:127], v[172:175], a[224:227], v[124:127]
 ds_bpermute_b32 v224, v19, v224
 v_add_f32 v98, v98, v101
 v_mfma_f32_16x16x32_bf16 v[124:127], v[176:179], a[220:223], v[124:127]
 ds_bpermute_b32 v225, v19, v225
 v_add_f32 v99, v99, v102
 v_mfma_f32_16x16x32_bf16 v[124:127], v[180:183], a[216:219], v[124:127]
 ds_bpermute_b32 v226, v19, v226
 v_add_f32 v98, v98, v104
 v_mfma_f32_16x16x32_bf16 v[124:127], v[184:187], a[212:215], v[124:127]
 ds_read_u16_d16_hi v228, v18 offset:640
 v_add_f32 v99, v99, v105
 v_mfma_f32_16x16x32_bf16 v[124:127], v[188:191], a[208:211], v[124:127]
 ds_read_u16_d16_hi v229, v18 offset:1792
 v_add_f32 v99, v99, v108
 v_mfma_f32_16x16x32_bf16 v[124:127], v[192:195], a[204:207], v[124:127]
 s_waitcnt lgkmcnt(10)
 v_add_f32 v80, v80, v248
 v_add_f32 v81, v81, v249
 v_mfma_f32_16x16x32_bf16 v[124:127], v[196:199], a[200:203], v[124:127]
 s_waitcnt lgkmcnt(8)
 v_add_f32 v82, v82, v250
 v_fmac_f32 v80, s31, v252
 v_mfma_f32_16x16x32_bf16 v[124:127], v[200:203], a[196:199], v[124:127]
 s_waitcnt lgkmcnt(6)
 v_fmac_f32 v81, s31, v253
 v_fmac_f32 v82, s31, v254
 v_mfma_f32_16x16x32_bf16 v[124:127], v[204:207], a[192:195], v[124:127]
 s_waitcnt lgkmcnt(5)
 v_fmac_f32 v83, s31, v255
 v_cvt_pk_bf16_f32 v80, v80, v81
 v_mfma_f32_16x16x32_bf16 v[128:131], v[160:163], a[52:55], 0
 ds_read_u16_d16_hi v230, v18 offset:2944
 v_cvt_pk_bf16_f32 v81, v82, v83
 v_mfma_f32_16x16x32_bf16 v[128:131], v[164:167], a[48:51], v[128:131]
 buffer_store_dwordx2 v[80:81], v20, s[12:15], s34 offen offset:1536 sc1
 v_mfma_f32_16x16x32_bf16 v[128:131], v[168:171], a[44:47], v[128:131]
 ds_read_u16_d16_hi v231, v18 offset:4096
 v_mfma_f32_16x16x32_bf16 v[128:131], v[172:175], a[40:43], v[128:131]
 v_mfma_f32_16x16x32_bf16 v[128:131], v[176:179], a[36:39], v[128:131]
 v_mfma_f32_16x16x32_bf16 v[128:131], v[180:183], a[32:35], v[128:131]
 v_mfma_f32_16x16x32_bf16 v[128:131], v[184:187], a[28:31], v[128:131]
 v_mfma_f32_16x16x32_bf16 v[128:131], v[188:191], a[24:27], v[128:131]
 v_add_f32 v119, v119, v122
 v_add_f32 v123, v123, v126
 v_mfma_f32_16x16x32_bf16 v[128:131], v[192:195], a[20:23], v[128:131]
 s_waitcnt lgkmcnt(5)
 v_add_f32 v96, v96, v224
 v_add_f32 v97, v97, v225
 v_mfma_f32_16x16x32_bf16 v[128:131], v[196:199], a[16:19], v[128:131]
 s_waitcnt lgkmcnt(3)
 v_add_f32 v98, v98, v226
 v_fmac_f32 v96, s31, v228
 v_mfma_f32_16x16x32_bf16 v[128:131], v[200:203], a[12:15], v[128:131]
 s_waitcnt lgkmcnt(1)
 v_fmac_f32 v97, s31, v229
 v_fmac_f32 v98, s31, v230
 v_mfma_f32_16x16x32_bf16 v[128:131], v[204:207], a[8:11], v[128:131]
 s_waitcnt lgkmcnt(0)
 v_fmac_f32 v99, s31, v231
 v_cvt_pk_bf16_f32 v96, v96, v97
 v_mfma_f32_16x16x32_bf16 v[128:131], v[208:211], a[4:7], v[128:131]
 v_cvt_pk_bf16_f32 v97, v98, v99
 v_add_f32 v119, v119, v125
 v_mfma_f32_16x16x32_bf16 v[128:131], v[212:215], a[0:3], v[128:131]
 buffer_store_dwordx2 v[96:97], v20, s[12:15], s34 offen offset:2048 sc1
 v_mfma_f32_16x16x32_bf16 v[132:135], v[160:163], a[116:119], 0
 v_cndmask_b32_e64 v232, v119, v103, vcc
 v_cndmask_b32_e64 v233, v123, v107, vcc
 v_mfma_f32_16x16x32_bf16 v[132:135], v[164:167], a[112:115], v[132:135]
 v_cndmask_b32_e64 v234, v127, v111, vcc
 v_add_f32 v113, v113, v116
 v_mfma_f32_16x16x32_bf16 v[132:135], v[168:171], a[108:111], v[132:135]
 ds_bpermute_b32 v232, v19, v232
 v_add_f32 v114, v114, v117
 v_mfma_f32_16x16x32_bf16 v[132:135], v[172:175], a[104:107], v[132:135]
 ds_bpermute_b32 v233, v19, v233
 v_add_f32 v115, v115, v118
 v_mfma_f32_16x16x32_bf16 v[132:135], v[176:179], a[100:103], v[132:135]
 ds_bpermute_b32 v234, v19, v234
 v_add_f32 v114, v114, v120
 v_mfma_f32_16x16x32_bf16 v[132:135], v[180:183], a[96:99], v[132:135]
 ds_read_u16_d16_hi v236, v18 offset:768
 v_add_f32 v115, v115, v121
 v_mfma_f32_16x16x32_bf16 v[132:135], v[184:187], a[92:95], v[132:135]
 ds_read_u16_d16_hi v237, v18 offset:1920
 v_add_f32 v115, v115, v124
 v_mfma_f32_16x16x32_bf16 v[132:135], v[188:191], a[88:91], v[132:135]
 ds_read_u16_d16_hi v238, v18 offset:3072
 v_mfma_f32_16x16x32_bf16 v[132:135], v[192:195], a[84:87], v[132:135]
 ds_read_u16_d16_hi v239, v18 offset:4224
 v_mfma_f32_16x16x32_bf16 v[132:135], v[196:199], a[80:83], v[132:135]
 v_mfma_f32_16x16x32_bf16 v[132:135], v[200:203], a[76:79], v[132:135]
 v_mfma_f32_16x16x32_bf16 v[132:135], v[204:207], a[72:75], v[132:135]
 v_mfma_f32_16x16x32_bf16 v[132:135], v[208:211], a[68:71], v[132:135]
 v_mfma_f32_16x16x32_bf16 v[132:135], v[212:215], a[64:67], v[132:135]
 v_mfma_f32_16x16x32_bf16 v[136:139], v[160:163], a[180:183], 0
 s_waitcnt lgkmcnt(5)
 v_add_f32 v112, v112, v232
 v_add_f32 v113, v113, v233
 v_mfma_f32_16x16x32_bf16 v[136:139], v[164:167], a[176:179], v[136:139]
 s_waitcnt lgkmcnt(3)
 v_add_f32 v114, v114, v234
 v_fmac_f32 v112, s31, v236
 v_mfma_f32_16x16x32_bf16 v[136:139], v[168:171], a[172:175], v[136:139]
 s_waitcnt lgkmcnt(1)
 v_fmac_f32 v113, s31, v237
 v_fmac_f32 v114, s31, v238
 v_mfma_f32_16x16x32_bf16 v[136:139], v[172:175], a[168:171], v[136:139]
 s_waitcnt lgkmcnt(0)
 v_fmac_f32 v115, s31, v239
 v_cvt_pk_bf16_f32 v112, v112, v113
 v_mfma_f32_16x16x32_bf16 v[136:139], v[176:179], a[164:167], v[136:139]
 v_cvt_pk_bf16_f32 v113, v114, v115
 v_mfma_f32_16x16x32_bf16 v[136:139], v[180:183], a[160:163], v[136:139]
 buffer_store_dwordx2 v[112:113], v20, s[12:15], s34 offen offset:2560 sc1
 v_mfma_f32_16x16x32_bf16 v[136:139], v[184:187], a[156:159], v[136:139]
 v_mfma_f32_16x16x32_bf16 v[136:139], v[188:191], a[152:155], v[136:139]
 v_mfma_f32_16x16x32_bf16 v[136:139], v[192:195], a[148:151], v[136:139]
 v_mfma_f32_16x16x32_bf16 v[136:139], v[196:199], a[144:147], v[136:139]
 v_mfma_f32_16x16x32_bf16 v[136:139], v[200:203], a[140:143], v[136:139]
 v_mfma_f32_16x16x32_bf16 v[136:139], v[204:207], a[136:139], v[136:139]
 v_mfma_f32_16x16x32_bf16 v[136:139], v[208:211], a[132:135], v[136:139]
 v_mfma_f32_16x16x32_bf16 v[136:139], v[212:215], a[128:131], v[136:139]
 v_mfma_f32_16x16x32_bf16 v[140:143], v[160:163], a[244:247], 0
 v_mfma_f32_16x16x32_bf16 v[140:143], v[164:167], a[240:243], v[140:143]
 v_mfma_f32_16x16x32_bf16 v[140:143], v[168:171], a[236:239], v[140:143]
 v_mfma_f32_16x16x32_bf16 v[140:143], v[172:175], a[232:235], v[140:143]
 v_mfma_f32_16x16x32_bf16 v[140:143], v[176:179], a[228:231], v[140:143]
 v_mfma_f32_16x16x32_bf16 v[140:143], v[180:183], a[224:227], v[140:143]
 v_mfma_f32_16x16x32_bf16 v[140:143], v[184:187], a[220:223], v[140:143]
 v_mfma_f32_16x16x32_bf16 v[140:143], v[188:191], a[216:219], v[140:143]
 v_mfma_f32_16x16x32_bf16 v[140:143], v[192:195], a[212:215], v[140:143]
 v_mfma_f32_16x16x32_bf16 v[140:143], v[196:199], a[208:211], v[140:143]
 v_mfma_f32_16x16x32_bf16 v[140:143], v[200:203], a[204:207], v[140:143]
 v_mfma_f32_16x16x32_bf16 v[140:143], v[204:207], a[200:203], v[140:143]
 v_mfma_f32_16x16x32_bf16 v[140:143], v[208:211], a[196:199], v[140:143]
 v_mfma_f32_16x16x32_bf16 v[140:143], v[212:215], a[192:195], v[140:143]
 v_mfma_f32_16x16x32_bf16 v[144:147], v[160:163], a[60:63], 0
 v_mfma_f32_16x16x32_bf16 v[144:147], v[164:167], a[56:59], v[144:147]
 v_mfma_f32_16x16x32_bf16 v[144:147], v[168:171], a[52:55], v[144:147]
 v_mfma_f32_16x16x32_bf16 v[144:147], v[172:175], a[48:51], v[144:147]
 v_mfma_f32_16x16x32_bf16 v[144:147], v[176:179], a[44:47], v[144:147]
 v_mfma_f32_16x16x32_bf16 v[144:147], v[180:183], a[40:43], v[144:147]
 v_mfma_f32_16x16x32_bf16 v[144:147], v[184:187], a[36:39], v[144:147]
 v_mfma_f32_16x16x32_bf16 v[144:147], v[188:191], a[32:35], v[144:147]
 v_add_f32 v135, v135, v138
 v_add_f32 v139, v139, v142
 v_mfma_f32_16x16x32_bf16 v[144:147], v[192:195], a[28:31], v[144:147]
 v_add_f32 v135, v135, v141
 v_cndmask_b32_e64 v240, v135, v119, vcc
 v_mfma_f32_16x16x32_bf16 v[144:147], v[196:199], a[24:27], v[144:147]
 v_cndmask_b32_e64 v241, v139, v123, vcc
 v_cndmask_b32_e64 v242, v143, v127, vcc
 v_mfma_f32_16x16x32_bf16 v[144:147], v[200:203], a[20:23], v[144:147]
 ds_bpermute_b32 v240, v19, v240
 v_add_f32 v129, v129, v132
 v_mfma_f32_16x16x32_bf16 v[144:147], v[204:207], a[16:19], v[144:147]
 ds_bpermute_b32 v241, v19, v241
 v_add_f32 v130, v130, v133
 v_mfma_f32_16x16x32_bf16 v[144:147], v[208:211], a[12:15], v[144:147]
 ds_bpermute_b32 v242, v19, v242
 v_add_f32 v131, v131, v134
 v_mfma_f32_16x16x32_bf16 v[144:147], v[212:215], a[8:11], v[144:147]
 ds_read_u16_d16_hi v244, v18 offset:896
 v_add_f32 v130, v130, v136
 v_mfma_f32_16x16x32_bf16 v[144:147], v[216:219], a[4:7], v[144:147]
 ds_read_u16_d16_hi v245, v18 offset:2048
 v_add_f32 v131, v131, v137
 v_mfma_f32_16x16x32_bf16 v[144:147], v[220:223], a[0:3], v[144:147]
 ds_read_u16_d16_hi v246, v18 offset:3200
 v_add_f32 v131, v131, v140
 v_mfma_f32_16x16x32_bf16 v[148:151], v[160:163], a[124:127], 0
 ds_read_u16_d16_hi v247, v18 offset:4352
 v_mfma_f32_16x16x32_bf16 v[148:151], v[164:167], a[120:123], v[148:151]
 v_mfma_f32_16x16x32_bf16 v[148:151], v[168:171], a[116:119], v[148:151]
 v_mfma_f32_16x16x32_bf16 v[148:151], v[172:175], a[112:115], v[148:151]
 v_mfma_f32_16x16x32_bf16 v[148:151], v[176:179], a[108:111], v[148:151]
 v_mfma_f32_16x16x32_bf16 v[148:151], v[180:183], a[104:107], v[148:151]
 v_mfma_f32_16x16x32_bf16 v[148:151], v[184:187], a[100:103], v[148:151]
 s_waitcnt lgkmcnt(5)
 v_add_f32 v128, v128, v240
 v_add_f32 v129, v129, v241
 v_mfma_f32_16x16x32_bf16 v[148:151], v[188:191], a[96:99], v[148:151]
 s_waitcnt lgkmcnt(3)
 v_add_f32 v130, v130, v242
 v_fmac_f32 v128, s31, v244
 v_mfma_f32_16x16x32_bf16 v[148:151], v[192:195], a[92:95], v[148:151]
 s_waitcnt lgkmcnt(1)
 v_fmac_f32 v129, s31, v245
 v_fmac_f32 v130, s31, v246
 v_mfma_f32_16x16x32_bf16 v[148:151], v[196:199], a[88:91], v[148:151]
 s_waitcnt lgkmcnt(0)
 v_fmac_f32 v131, s31, v247
 v_cvt_pk_bf16_f32 v128, v128, v129
 v_mfma_f32_16x16x32_bf16 v[148:151], v[200:203], a[84:87], v[148:151]
 v_cvt_pk_bf16_f32 v129, v130, v131
 v_mfma_f32_16x16x32_bf16 v[148:151], v[204:207], a[80:83], v[148:151]
 buffer_store_dwordx2 v[128:129], v20, s[12:15], s34 offen offset:3072 sc1
 v_mfma_f32_16x16x32_bf16 v[148:151], v[208:211], a[76:79], v[148:151]
 v_mfma_f32_16x16x32_bf16 v[148:151], v[212:215], a[72:75], v[148:151]
 v_mfma_f32_16x16x32_bf16 v[148:151], v[216:219], a[68:71], v[148:151]
 v_mfma_f32_16x16x32_bf16 v[148:151], v[220:223], a[64:67], v[148:151]
 v_mfma_f32_16x16x32_bf16 v[152:155], v[160:163], a[188:191], 0
 v_mfma_f32_16x16x32_bf16 v[152:155], v[164:167], a[184:187], v[152:155]
 v_mfma_f32_16x16x32_bf16 v[152:155], v[168:171], a[180:183], v[152:155]
 v_mfma_f32_16x16x32_bf16 v[152:155], v[172:175], a[176:179], v[152:155]
 v_mfma_f32_16x16x32_bf16 v[152:155], v[176:179], a[172:175], v[152:155]
 v_mfma_f32_16x16x32_bf16 v[152:155], v[180:183], a[168:171], v[152:155]
 v_mfma_f32_16x16x32_bf16 v[152:155], v[184:187], a[164:167], v[152:155]
 v_mfma_f32_16x16x32_bf16 v[152:155], v[188:191], a[160:163], v[152:155]
 v_mfma_f32_16x16x32_bf16 v[152:155], v[192:195], a[156:159], v[152:155]
 v_mfma_f32_16x16x32_bf16 v[152:155], v[196:199], a[152:155], v[152:155]
 v_mfma_f32_16x16x32_bf16 v[152:155], v[200:203], a[148:151], v[152:155]
 v_mfma_f32_16x16x32_bf16 v[152:155], v[204:207], a[144:147], v[152:155]
 v_mfma_f32_16x16x32_bf16 v[152:155], v[208:211], a[140:143], v[152:155]
 v_mfma_f32_16x16x32_bf16 v[152:155], v[212:215], a[136:139], v[152:155]
 v_mfma_f32_16x16x32_bf16 v[152:155], v[216:219], a[132:135], v[152:155]
 v_mfma_f32_16x16x32_bf16 v[152:155], v[220:223], a[128:131], v[152:155]
 v_mfma_f32_16x16x32_bf16 v[156:159], v[160:163], v[12:15], 0
 v_mfma_f32_16x16x32_bf16 v[156:159], v[164:167], a[248:251], v[156:159]
 v_mfma_f32_16x16x32_bf16 v[156:159], v[168:171], a[244:247], v[156:159]
 v_mfma_f32_16x16x32_bf16 v[156:159], v[172:175], a[240:243], v[156:159]
 v_mfma_f32_16x16x32_bf16 v[156:159], v[176:179], a[236:239], v[156:159]
 v_mfma_f32_16x16x32_bf16 v[156:159], v[180:183], a[232:235], v[156:159]
 v_mfma_f32_16x16x32_bf16 v[156:159], v[184:187], a[228:231], v[156:159]
 v_mfma_f32_16x16x32_bf16 v[156:159], v[188:191], a[224:227], v[156:159]
 v_mfma_f32_16x16x32_bf16 v[156:159], v[192:195], a[220:223], v[156:159]
 v_mfma_f32_16x16x32_bf16 v[156:159], v[196:199], a[216:219], v[156:159]
 v_mfma_f32_16x16x32_bf16 v[156:159], v[200:203], a[212:215], v[156:159]
 v_mfma_f32_16x16x32_bf16 v[156:159], v[204:207], a[208:211], v[156:159]
 v_mfma_f32_16x16x32_bf16 v[156:159], v[208:211], a[204:207], v[156:159]
 v_mfma_f32_16x16x32_bf16 v[156:159], v[212:215], a[200:203], v[156:159]
 v_mfma_f32_16x16x32_bf16 v[156:159], v[216:219], a[196:199], v[156:159]
 v_mfma_f32_16x16x32_bf16 v[156:159], v[220:223], a[192:195], v[156:159]
 s_nop 7
 v_add_f32 v151, v151, v154
 v_add_f32 v155, v155, v158
 v_add_f32 v151, v151, v157
 v_cndmask_b32_e64 v248, v151, v135, vcc
 v_cndmask_b32_e64 v249, v155, v139, vcc
 v_cndmask_b32_e64 v250, v159, v143, vcc
 ds_bpermute_b32 v248, v19, v248
 ds_bpermute_b32 v249, v19, v249
 ds_bpermute_b32 v250, v19, v250
 ds_read_u16_d16_hi v252, v18 offset:1024
 ds_read_u16_d16_hi v253, v18 offset:2176
 ds_read_u16_d16_hi v254, v18 offset:3328
 ds_read_u16_d16_hi v255, v18 offset:4480
 v_add_f32 v145, v145, v148
 v_add_f32 v146, v146, v149
 v_add_f32 v147, v147, v150
 v_add_f32 v146, v146, v152
 v_add_f32 v147, v147, v153
 v_add_f32 v147, v147, v156
 s_waitcnt lgkmcnt(0)
 v_add_f32 v144, v144, v248
 v_add_f32 v145, v145, v249
 v_add_f32 v146, v146, v250
 v_fmac_f32 v144, s31, v252
 v_fmac_f32 v145, s31, v253
 v_fmac_f32 v146, s31, v254
 v_fmac_f32 v147, s31, v255
 v_cvt_pk_bf16_f32 v144, v144, v145
 v_cvt_pk_bf16_f32 v145, v146, v147
 buffer_store_dwordx2 v[144:145], v20, s[12:15], s34 offen offset:3584 sc1
 v_mov_b32 v12, 1
 buffer_atomic_add v12, v9, s[12:15], s38 offen sc0 sc1
L_pub:
 s_waitcnt vmcnt(1)
 s_barrier
 buffer_store_dword v9, v9, s[12:15], s93 offen sc1
 s_waitcnt vmcnt(1)
L_job:
 s_cmp_lg_u32 s3, 0
 s_cbranch_scc1 L_jobw
 s_mov_b64 exec, 1
 ds_write_b32 v5, v12
 s_mov_b64 exec, -1
 s_waitcnt lgkmcnt(0)
L_jobw:
 s_barrier
 ds_read_b32 v13, v5
 v_xor_b32 v5, 4, v5
 s_waitcnt lgkmcnt(0)
 v_readfirstlane_b32 s41, v13
 v_mov_b32 v12, 1
 s_nop 2
 s_add_u32 s41, s41, -1
 s_cmp_ge_u32 s41, 140
 s_cbranch_scc0 L_jobgo
 s_endpgm
L_jobgo:
 s_mul_i32 s42, s41, 2341
 s_lshr_b32 s42, s42, 16
 s_mul_i32 s43, s42, 28
 s_sub_u32 s41, s41, s43
 s_mul_i32 s43, s41, 37
 s_lshr_b32 s43, s43, 8
 s_mul_i32 s44, s43, 7
 s_sub_u32 s41, s41, s44
 s_lshl_b32 s43, s43, 2
 s_add_u32 s43, s43, s40
 s_cmp_eq_u32 s42, 3
 s_cbranch_scc1 L_gate
 s_cmp_ge_u32 s42, 2
 s_cselect_b32 s44, 16, 0
 s_add_u32 s43, s43, s44
 s_lshr_b32 s44, 18, s42
 s_and_b32 s44, s44, 1
 s_lshr_b32 s45, s43, 1
 s_lshl_b32 s45, s45, 1
 s_sub_u32 s45, s45, s44
 s_lshl_b32 s45, s45, 6
 s_add_u32 s45, s45, 84938816
 s_mul_i32 s44, s44, 7
 s_add_u32 s41, s41, s44
 s_lshl_b32 s43, s43, 2
 s_add_u32 s43, s43, s3
 s_mul_i32 s37, s43, 14
 s_add_u32 s37, s37, s41
 s_mul_i32 s37, s37, 17408
 s_add_u32 s37, s37, 117440512
 s_mul_i32 s36, s43, 28672
 s_lshl_b32 s41, s41, 6
 s_add_u32 s36, s36, s41
L_rn:
 s_cmp_lg_u32 s3, 0
 s_cbranch_scc1 L_rx
 v_and_b32 v16, 15, v0
 v_lshlrev_b32 v16, 2, v16
 s_mov_b32 s32, 0
L_poll5:
 buffer_load_dword v17, v16, s[12:15], s45 offen sc1
 s_waitcnt vmcnt(0)
 v_cmp_ne_u32 vcc, 0, v17
 s_cbranch_vccz L_poll5_ok
 s_sleep 6
 s_add_u32 s32, s32, 1
 s_cmp_lt_u32 s32, 0x80000
 s_cbranch_scc1 L_poll5
L_poll5_ok:
L_rx:
 s_barrier
 s_cmp_eq_u32 s42, 4
 s_cbranch_scc1 L_rf
 buffer_load_dwordx4 a[0:3], v1, s[12:15], s37 offen offset:0 sc1
 buffer_load_dwordx4 a[4:7], v1, s[12:15], s37 offen offset:1024 sc1
 buffer_load_dwordx4 a[8:11], v1, s[12:15], s37 offen offset:2048 sc1
 buffer_load_dwordx4 a[12:15], v1, s[12:15], s37 offen offset:3072 sc1
 s_add_u32 s37, s37, 4096
 buffer_load_dwordx4 a[16:19], v1, s[12:15], s37 offen offset:0 sc1
 s_waitcnt vmcnt(4)
 buffer_load_dwordx4 a[20:23], v1, s[12:15], s37 offen offset:1024 sc1
 s_waitcnt vmcnt(4)
 buffer_load_dwordx4 a[24:27], v1, s[12:15], s37 offen offset:2048 sc1
 s_waitcnt vmcnt(4)
 buffer_load_dwordx4 a[28:31], v1, s[12:15], s37 offen offset:3072 sc1
 s_add_u32 s37, s37, 4096
 s_waitcnt vmcnt(4)
 buffer_load_dwordx4 a[32:35], v1, s[12:15], s37 offen offset:0 sc1
 s_waitcnt vmcnt(4)
 buffer_load_dwordx4 a[36:39], v1, s[12:15], s37 offen offset:1024 sc1
 s_waitcnt vmcnt(4)
 buffer_load_dwordx4 a[40:43], v1, s[12:15], s37 offen offset:2048 sc1
 s_waitcnt vmcnt(4)
 buffer_load_dwordx4 a[44:47], v1, s[12:15], s37 offen offset:3072 sc1
 s_add_u32 s37, s37, 4096
 s_waitcnt vmcnt(4)
 buffer_load_dwordx4 a[48:51], v1, s[12:15], s37 offen offset:0 sc1
 s_waitcnt vmcnt(4)
 buffer_load_dwordx4 a[52:55], v1, s[12:15], s37 offen offset:1024 sc1
 s_waitcnt vmcnt(4)
 buffer_load_dwordx4 a[56:59], v1, s[12:15], s37 offen offset:2048 sc1
 s_waitcnt vmcnt(4)
 buffer_load_dwordx4 a[60:63], v1, s[12:15], s37 offen offset:3072 sc1
 s_add_u32 s37, s37, 4096
 s_branch L_rg
L_rf:
 buffer_load_dwordx4 a[0:3], v1, s[12:15], s37 offen offset:0 sc1
 buffer_load_dwordx4 a[4:7], v1, s[12:15], s37 offen offset:1024 sc1
 buffer_load_dwordx4 a[8:11], v1, s[12:15], s37 offen offset:2048 sc1
 buffer_load_dwordx4 a[12:15], v1, s[12:15], s37 offen offset:3072 sc1
 s_add_u32 s37, s37, 4096
 buffer_load_dwordx4 a[16:19], v1, s[12:15], s37 offen offset:0 sc1
 buffer_load_dwordx4 a[20:23], v1, s[12:15], s37 offen offset:1024 sc1
 buffer_load_dwordx4 a[24:27], v1, s[12:15], s37 offen offset:2048 sc1
 buffer_load_dwordx4 a[28:31], v1, s[12:15], s37 offen offset:3072 sc1
 s_add_u32 s37, s37, 4096
 buffer_load_dwordx4 a[32:35], v1, s[12:15], s37 offen offset:0 sc1
 buffer_load_dwordx4 a[36:39], v1, s[12:15], s37 offen offset:1024 sc1
 buffer_load_dwordx4 a[40:43], v1, s[12:15], s37 offen offset:2048 sc1
 buffer_load_dwordx4 a[44:47], v1, s[12:15], s37 offen offset:3072 sc1
 s_add_u32 s37, s37, 4096
 buffer_load_dwordx4 a[48:51], v1, s[12:15], s37 offen offset:0 sc1
 buffer_load_dwordx4 a[52:55], v1, s[12:15], s37 offen offset:1024 sc1
 buffer_load_dwordx4 a[56:59], v1, s[12:15], s37 offen offset:2048 sc1
 buffer_load_dwordx4 a[60:63], v1, s[12:15], s37 offen offset:3072 sc1
 s_add_u32 s37, s37, 4096
L_rg:
 buffer_atomic_add v12, v9, s[12:15], s38 offen sc0 sc1
 s_waitcnt vmcnt(16)
 v_mfma_f32_16x16x32_bf16 v[32:35], v[24:27], a[0:3], 0
 v_mfma_f32_16x16x32_bf16 v[36:39], v[28:31], a[0:3], 0
 s_waitcnt vmcnt(15)
 v_mfma_f32_16x16x32_bf16 v[32:35], v[24:27], a[4:7], v[32:35]
 v_mfma_f32_16x16x32_bf16 v[36:39], v[28:31], a[4:7], v[36:39]
 s_waitcnt vmcnt(14)
 v_mfma_f32_16x16x32_bf16 v[32:35], v[24:27], a[8:11], v[32:35]
 v_mfma_f32_16x16x32_bf16 v[36:39], v[28:31], a[8:11], v[36:39]
 s_waitcnt vmcnt(13)
 v_mfma_f32_16x16x32_bf16 v[32:35], v[24:27], a[12:15], v[32:35]
 v_mfma_f32_16x16x32_bf16 v[36:39], v[28:31], a[12:15], v[36:39]
 s_waitcnt vmcnt(12)
 v_mfma_f32_16x16x32_bf16 v[32:35], v[24:27], a[16:19], v[32:35]
 v_mfma_f32_16x16x32_bf16 v[36:39], v[28:31], a[16:19], v[36:39]
 s_waitcnt vmcnt(11)
 v_mfma_f32_16x16x32_bf16 v[32:35], v[24:27], a[20:23], v[32:35]
 v_mfma_f32_16x16x32_bf16 v[36:39], v[28:31], a[20:23], v[36:39]
 s_waitcnt vmcnt(10)
 v_mfma_f32_16x16x32_bf16 v[32:35], v[24:27], a[24:27], v[32:35]
 v_mfma_f32_16x16x32_bf16 v[36:39], v[28:31], a[24:27], v[36:39]
 s_waitcnt vmcnt(9)
 v_mfma_f32_16x16x32_bf16 v[32:35], v[24:27], a[28:31], v[32:35]
 v_mfma_f32_16x16x32_bf16 v[36:39], v[28:31], a[28:31], v[36:39]
 s_waitcnt vmcnt(8)
 v_mfma_f32_16x16x32_bf16 v[32:35], v[24:27], a[32:35], v[32:35]
 v_mfma_f32_16x16x32_bf16 v[36:39], v[28:31], a[32:35], v[36:39]
 s_waitcnt vmcnt(7)
 v_mfma_f32_16x16x32_bf16 v[32:35], v[24:27], a[36:39], v[32:35]
 v_mfma_f32_16x16x32_bf16 v[36:39], v[28:31], a[36:39], v[36:39]
 s_waitcnt vmcnt(6)
 v_mfma_f32_16x16x32_bf16 v[32:35], v[24:27], a[40:43], v[32:35]
 v_mfma_f32_16x16x32_bf16 v[36:39], v[28:31], a[40:43], v[36:39]
 s_waitcnt vmcnt(5)
 v_mfma_f32_16x16x32_bf16 v[32:35], v[24:27], a[44:47], v[32:35]
 v_mfma_f32_16x16x32_bf16 v[36:39], v[28:31], a[44:47], v[36:39]
 s_waitcnt vmcnt(4)
 v_mfma_f32_16x16x32_bf16 v[32:35], v[24:27], a[48:51], v[32:35]
 v_mfma_f32_16x16x32_bf16 v[36:39], v[28:31], a[48:51], v[36:39]
 s_waitcnt vmcnt(3)
 v_mfma_f32_16x16x32_bf16 v[32:35], v[24:27], a[52:55], v[32:35]
 v_mfma_f32_16x16x32_bf16 v[36:39], v[28:31], a[52:55], v[36:39]
 s_waitcnt vmcnt(2)
 v_mfma_f32_16x16x32_bf16 v[32:35], v[24:27], a[56:59], v[32:35]
 v_mfma_f32_16x16x32_bf16 v[36:39], v[28:31], a[56:59], v[36:39]
 s_waitcnt vmcnt(1)
 v_mfma_f32_16x16x32_bf16 v[32:35], v[24:27], a[60:63], v[32:35]
 v_mfma_f32_16x16x32_bf16 v[36:39], v[28:31], a[60:63], v[36:39]
 s_nop 7
 v_cvt_pk_bf16_f32 v32, v32, v33
 v_cvt_pk_bf16_f32 v33, v34, v35
 v_cvt_pk_bf16_f32 v34, v36, v37
 v_cvt_pk_bf16_f32 v35, v38, v39
 buffer_store_dwordx4 v[32:35], v2, s[8:11], s36 offen offset:896
L_rd:
 s_waitcnt vmcnt(1)
 s_branch L_job
L_gate:
 s_lshl_b32 s43, s43, 2
 s_add_u32 s43, s43, s3
 s_mul_i32 s46, s43, 14336
 s_lshl_b32 s44, s41, 7
 s_lshl_b32 s47, s46, 1
 s_add_u32 s46, s46, s44
 s_add_u32 s47, s47, s44
 s_add_u32 s54, s46, 917504
 s_add_u32 s55, s47, 1835008
 buffer_load_dwordx4 v[48:51], v7, s[16:19], s46 offen offset:0
 buffer_load_dwordx4 v[52:55], v7, s[16:19], s46 offen offset:64
 buffer_load_dwordx4 v[56:59], v7, s[16:19], s54 offen offset:0
 buffer_load_dwordx4 v[60:63], v7, s[16:19], s54 offen offset:64
 s_lshl_b32 s56, s43, 5
 s_mul_i32 s57, s41, 262144
 s_add_u32 s56, s56, s57
 s_add_u32 s56, s56, 90177536
 s_add_u32 s57, s56, 131072
 s_lshl_b32 s45, s41, 6
 s_add_u32 s45, s45, 84963328
 s_cmp_lg_u32 s3, 0
 s_cbranch_scc1 L_gw
 v_and_b32 v16, 15, v0
 v_lshlrev_b32 v16, 2, v16
 s_mov_b32 s32, 0
L_poll6:
 buffer_load_dword v17, v16, s[12:15], s45 offen sc1
 s_waitcnt vmcnt(0)
 v_cmp_ne_u32 vcc, 0, v17
 s_cbranch_vccz L_poll6_ok
 s_sleep 6
 s_add_u32 s32, s32, 1
 s_cmp_lt_u32 s32, 0x80000
 s_cbranch_scc1 L_poll6
L_poll6_ok:
L_gw:
 s_barrier
 s_add_u32 m0, s58, 0
 s_nop 0
 buffer_load_dwordx4 v8, s[12:15], s56 offen offset:0 sc1 lds
 s_add_u32 m0, s58, 1024
 s_nop 0
 buffer_load_dwordx4 v8, s[12:15], s57 offen offset:0 sc1 lds
 s_add_u32 m0, s58, 0
 s_nop 0
 buffer_load_dwordx4 v8, s[12:15], s56 offen offset:2048 sc1 lds
 s_add_u32 m0, s58, 1024
 s_nop 0
 buffer_load_dwordx4 v8, s[12:15], s57 offen offset:2048 sc1 lds
 buffer_atomic_add v12, v9, s[12:15], s38 offen sc0 sc1
 s_waitcnt vmcnt(1)
 ds_read_b64_tr_b16 v[64:65], v10 offset:0
 ds_read_b64_tr_b16 v[66:67], v10 offset:128
 ds_read_b64_tr_b16 v[68:69], v10 offset:1024
 ds_read_b64_tr_b16 v[70:71], v10 offset:1152
 ds_read_b64_tr_b16 v[72:73], v10 offset:2048
 ds_read_b64_tr_b16 v[74:75], v10 offset:2176
 ds_read_b64_tr_b16 v[76:77], v10 offset:3072
 ds_read_b64_tr_b16 v[78:79], v10 offset:3200
 s_waitcnt lgkmcnt(0)
 ds_bpermute_b32 v64, v11, v64
 ds_bpermute_b32 v65, v11, v65
 ds_bpermute_b32 v66, v11, v66
 ds_bpermute_b32 v67, v11, v67
 ds_bpermute_b32 v68, v11, v68
 ds_bpermute_b32 v69, v11, v69
 ds_bpermute_b32 v70, v11, v70
 ds_bpermute_b32 v71, v11, v71
 ds_bpermute_b32 v72, v11, v72
 ds_bpermute_b32 v73, v11, v73
 ds_bpermute_b32 v74, v11, v74
 ds_bpermute_b32 v75, v11, v75
 ds_bpermute_b32 v76, v11, v76
 ds_bpermute_b32 v77, v11, v77
 ds_bpermute_b32 v78, v11, v78
 ds_bpermute_b32 v79, v11, v79
 s_waitcnt lgkmcnt(12)
 v_lshlrev_b32 v16, 16, v48
 v_and_b32 v17, s59, v48
 v_lshlrev_b32 v18, 16, v64
 v_and_b32 v19, s59, v64
 v_pk_mul_f32 v[16:17], v[16:17], v[18:19]
 v_cvt_pk_bf16_f32 v48, v16, v17
 v_lshlrev_b32 v16, 16, v49
 v_and_b32 v17, s59, v49
 v_lshlrev_b32 v18, 16, v65
 v_and_b32 v19, s59, v65
 v_pk_mul_f32 v[16:17], v[16:17], v[18:19]
 v_cvt_pk_bf16_f32 v49, v16, v17
 v_lshlrev_b32 v16, 16, v50
 v_and_b32 v17, s59, v50
 v_lshlrev_b32 v18, 16, v66
 v_and_b32 v19, s59, v66
 v_pk_mul_f32 v[16:17], v[16:17], v[18:19]
 v_cvt_pk_bf16_f32 v50, v16, v17
 v_lshlrev_b32 v16, 16, v51
 v_and_b32 v17, s59, v51
 v_lshlrev_b32 v18, 16, v67
 v_and_b32 v19, s59, v67
 v_pk_mul_f32 v[16:17], v[16:17], v[18:19]
 v_cvt_pk_bf16_f32 v51, v16, v17
 buffer_store_dwordx4 v[48:51], v3, s[8:11], s47 offen offset:0
 s_waitcnt lgkmcnt(8)
 v_lshlrev_b32 v16, 16, v52
 v_and_b32 v17, s59, v52
 v_lshlrev_b32 v18, 16, v68
 v_and_b32 v19, s59, v68
 v_pk_mul_f32 v[16:17], v[16:17], v[18:19]
 v_cvt_pk_bf16_f32 v52, v16, v17
 v_lshlrev_b32 v16, 16, v53
 v_and_b32 v17, s59, v53
 v_lshlrev_b32 v18, 16, v69
 v_and_b32 v19, s59, v69
 v_pk_mul_f32 v[16:17], v[16:17], v[18:19]
 v_cvt_pk_bf16_f32 v53, v16, v17
 v_lshlrev_b32 v16, 16, v54
 v_and_b32 v17, s59, v54
 v_lshlrev_b32 v18, 16, v70
 v_and_b32 v19, s59, v70
 v_pk_mul_f32 v[16:17], v[16:17], v[18:19]
 v_cvt_pk_bf16_f32 v54, v16, v17
 v_lshlrev_b32 v16, 16, v55
 v_and_b32 v17, s59, v55
 v_lshlrev_b32 v18, 16, v71
 v_and_b32 v19, s59, v71
 v_pk_mul_f32 v[16:17], v[16:17], v[18:19]
 v_cvt_pk_bf16_f32 v55, v16, v17
 buffer_store_dwordx4 v[52:55], v3, s[8:11], s47 offen offset:64
 s_waitcnt lgkmcnt(4)
 v_lshlrev_b32 v16, 16, v56
 v_and_b32 v17, s59, v56
 v_lshlrev_b32 v18, 16, v72
 v_and_b32 v19, s59, v72
 v_pk_mul_f32 v[16:17], v[16:17], v[18:19]
 v_cvt_pk_bf16_f32 v56, v16, v17
 v_lshlrev_b32 v16, 16, v57
 v_and_b32 v17, s59, v57
 v_lshlrev_b32 v18, 16, v73
 v_and_b32 v19, s59, v73
 v_pk_mul_f32 v[16:17], v[16:17], v[18:19]
 v_cvt_pk_bf16_f32 v57, v16, v17
 v_lshlrev_b32 v16, 16, v58
 v_and_b32 v17, s59, v58
 v_lshlrev_b32 v18, 16, v74
 v_and_b32 v19, s59, v74
 v_pk_mul_f32 v[16:17], v[16:17], v[18:19]
 v_cvt_pk_bf16_f32 v58, v16, v17
 v_lshlrev_b32 v16, 16, v59
 v_and_b32 v17, s59, v59
 v_lshlrev_b32 v18, 16, v75
 v_and_b32 v19, s59, v75
 v_pk_mul_f32 v[16:17], v[16:17], v[18:19]
 v_cvt_pk_bf16_f32 v59, v16, v17
 buffer_store_dwordx4 v[56:59], v3, s[8:11], s55 offen offset:0
 s_waitcnt lgkmcnt(0)
 v_lshlrev_b32 v16, 16, v60
 v_and_b32 v17, s59, v60
 v_lshlrev_b32 v18, 16, v76
 v_and_b32 v19, s59, v76
 v_pk_mul_f32 v[16:17], v[16:17], v[18:19]
 v_cvt_pk_bf16_f32 v60, v16, v17
 v_lshlrev_b32 v16, 16, v61
 v_and_b32 v17, s59, v61
 v_lshlrev_b32 v18, 16, v77
 v_and_b32 v19, s59, v77
 v_pk_mul_f32 v[16:17], v[16:17], v[18:19]
 v_cvt_pk_bf16_f32 v61, v16, v17
 v_lshlrev_b32 v16, 16, v62
 v_and_b32 v17, s59, v62
 v_lshlrev_b32 v18, 16, v78
 v_and_b32 v19, s59, v78
 v_pk_mul_f32 v[16:17], v[16:17], v[18:19]
 v_cvt_pk_bf16_f32 v62, v16, v17
 v_lshlrev_b32 v16, 16, v63
 v_and_b32 v17, s59, v63
 v_lshlrev_b32 v18, 16, v79
 v_and_b32 v19, s59, v79
 v_pk_mul_f32 v[16:17], v[16:17], v[18:19]
 v_cvt_pk_bf16_f32 v63, v16, v17
 buffer_store_dwordx4 v[60:63], v3, s[8:11], s55 offen offset:64
 s_waitcnt vmcnt(4)
 s_branch L_job
L_t1park:
 v_accvgpr_write_b32 a128, v128
 v_accvgpr_write_b32 a129, v129
 v_accvgpr_write_b32 a130, v130
 v_accvgpr_write_b32 a131, v131
 v_accvgpr_write_b32 a160, v192
 v_accvgpr_write_b32 a161, v193
 v_accvgpr_write_b32 a162, v194
 v_accvgpr_write_b32 a163, v195
 v_accvgpr_write_b32 a132, v136
 v_accvgpr_write_b32 a133, v137
 v_accvgpr_write_b32 a134, v138
 v_accvgpr_write_b32 a135, v139
 v_accvgpr_write_b32 a164, v200
 v_accvgpr_write_b32 a165, v201
 v_accvgpr_write_b32 a166, v202
 v_accvgpr_write_b32 a167, v203
 v_accvgpr_write_b32 a136, v144
 v_accvgpr_write_b32 a137, v145
 v_accvgpr_write_b32 a138, v146
 v_accvgpr_write_b32 a139, v147
 v_accvgpr_write_b32 a168, v208
 v_accvgpr_write_b32 a169, v209
 v_accvgpr_write_b32 a170, v210
 v_accvgpr_write_b32 a171, v211
 v_accvgpr_write_b32 a140, v152
 v_accvgpr_write_b32 a141, v153
 v_accvgpr_write_b32 a142, v154
 v_accvgpr_write_b32 a143, v155
 v_accvgpr_write_b32 a172, v216
 v_accvgpr_write_b32 a173, v217
 v_accvgpr_write_b32 a174, v218
 v_accvgpr_write_b32 a175, v219
 v_accvgpr_write_b32 a144, v160
 v_accvgpr_write_b32 a145, v161
 v_accvgpr_write_b32 a146, v162
 v_accvgpr_write_b32 a147, v163
 v_accvgpr_write_b32 a176, v224
 v_accvgpr_write_b32 a177, v225
 v_accvgpr_write_b32 a178, v226
 v_accvgpr_write_b32 a179, v227
 v_accvgpr_write_b32 a148, v168
 v_accvgpr_write_b32 a149, v169
 v_accvgpr_write_b32 a150, v170
 v_accvgpr_write_b32 a151, v171
 v_accvgpr_write_b32 a180, v232
 v_accvgpr_write_b32 a181, v233
 v_accvgpr_write_b32 a182, v234
 v_accvgpr_write_b32 a183, v235
 v_accvgpr_write_b32 a152, v176
 v_accvgpr_write_b32 a153, v177
 v_accvgpr_write_b32 a154, v178
 v_accvgpr_write_b32 a155, v179
 v_accvgpr_write_b32 a184, v240
 v_accvgpr_write_b32 a185, v241
 v_accvgpr_write_b32 a186, v242
 v_accvgpr_write_b32 a187, v243
 v_accvgpr_write_b32 a156, v184
 v_accvgpr_write_b32 a157, v185
 v_accvgpr_write_b32 a158, v186
 v_accvgpr_write_b32 a159, v187
 v_accvgpr_write_b32 a188, v248
 v_accvgpr_write_b32 a189, v249
 v_accvgpr_write_b32 a190, v250
 v_accvgpr_write_b32 a191, v251
 v_accvgpr_read_b32 v44, a254
 ds_read_b64_tr_b16 a[0:1], v44 offset:0
 ds_read_b64_tr_b16 a[2:3], v44 offset:2048
 ds_read_b64_tr_b16 a[4:5], v44 offset:4096
 ds_read_b64_tr_b16 a[6:7], v44 offset:6144
 ds_read_b64_tr_b16 a[8:9], v44 offset:8192
 ds_read_b64_tr_b16 a[10:11], v44 offset:10240
 ds_read_b64_tr_b16 a[12:13], v44 offset:12288
 ds_read_b64_tr_b16 a[14:15], v44 offset:14336
 ds_read_b64_tr_b16 a[16:17], v44 offset:16384
 ds_read_b64_tr_b16 a[18:19], v44 offset:18432
 ds_read_b64_tr_b16 a[20:21], v44 offset:20480
 ds_read_b64_tr_b16 a[22:23], v44 offset:22528
 ds_read_b64_tr_b16 a[24:25], v44 offset:24576
 ds_read_b64_tr_b16 a[26:27], v44 offset:26624
 s_branch L_op0in
L_tail2:
 v_accvgpr_read_b32 v11, a246
 s_mov_b32 s52, s55
 s_mov_b32 s53, s57
 v_readfirstlane_b32 s58, v11
 s_mov_b32 s59, 2.0
 s_nop 1
 s_cmp_eq_u32 s58, 0
 s_cselect_b32 s55, s55, 2.0
 s_cselect_b32 s57, s57, 2.0
 s_add_u32 s56, s55, 0x2000
 buffer_load_dwordx4 v[68:71], v1, s[12:15], s57 offen sc1
 s_waitcnt lgkmcnt(0)
 v_mfma_f32_16x16x32_bf16 v[128:131], a[64:67], v[16:19], v[128:131]
 ds_read_b128 a[96:99], v3 offset:4096
 v_mfma_f32_16x16x32_bf16 v[128:131], a[68:71], v[24:27], v[128:131]
 buffer_load_dwordx4 v[32:35], v1, s[12:15], s55 offen offset:0 sc1
 v_mfma_f32_16x16x32_bf16 v[192:195], a[68:71], v[28:31], v[192:195]
 ds_read_b128 a[100:103], v3 offset:20480
 v_mfma_f32_16x16x32_bf16 v[192:195], a[64:67], v[20:23], v[192:195]
 v_mov_b32 v72, v7
 v_mov_b32 v73, v8
 v_mfma_f32_16x16x32_bf16 v[132:135], a[72:75], v[16:19], v[132:135]
 ds_read_b128 a[104:107], v3 offset:5120
 v_mfma_f32_16x16x32_bf16 v[132:135], a[76:79], v[24:27], v[132:135]
 buffer_load_dwordx4 v[96:99], v1, s[12:15], s56 offen offset:0 sc1
 v_mfma_f32_16x16x32_bf16 v[196:199], a[76:79], v[28:31], v[196:199]
 ds_read_b128 a[108:111], v3 offset:21504
 v_mfma_f32_16x16x32_bf16 v[196:199], a[72:75], v[20:23], v[196:199]
 v_permlane32_swap_b32 v7, v72
 v_permlane32_swap_b32 v8, v73
 v_mfma_f32_16x16x32_bf16 v[136:139], a[80:83], v[16:19], v[136:139]
 ds_read_b128 a[112:115], v3 offset:6144
 v_mfma_f32_16x16x32_bf16 v[136:139], a[84:87], v[24:27], v[136:139]
 buffer_load_dwordx4 v[36:39], v1, s[12:15], s55 offen offset:1024 sc1
 v_mfma_f32_16x16x32_bf16 v[200:203], a[84:87], v[28:31], v[200:203]
 ds_read_b128 a[116:119], v3 offset:22528
 v_mfma_f32_16x16x32_bf16 v[200:203], a[80:83], v[20:23], v[200:203]
 v_add_f32 v7, v7, v72
 v_add_f32 v8, v8, v73
 v_mfma_f32_16x16x32_bf16 v[140:143], a[88:91], v[16:19], v[140:143]
 ds_read_b128 a[120:123], v3 offset:7168
 v_mfma_f32_16x16x32_bf16 v[140:143], a[92:95], v[24:27], v[140:143]
 buffer_load_dwordx4 v[100:103], v1, s[12:15], s56 offen offset:1024 sc1
 v_mfma_f32_16x16x32_bf16 v[204:207], a[92:95], v[28:31], v[204:207]
 ds_read_b128 a[124:127], v3 offset:23552
 v_mfma_f32_16x16x32_bf16 v[204:207], a[88:91], v[20:23], v[204:207]
 s_waitcnt lgkmcnt(6)
 v_mov_b32 v72, v7
 v_mov_b32 v73, v8
 v_mfma_f32_16x16x32_bf16 v[144:147], a[96:99], v[16:19], v[144:147]
 ds_read_b128 a[64:67], v3 offset:8192
 v_mfma_f32_16x16x32_bf16 v[144:147], a[100:103], v[24:27], v[144:147]
 buffer_load_dwordx4 v[40:43], v1, s[12:15], s55 offen offset:2048 sc1
 v_mfma_f32_16x16x32_bf16 v[208:211], a[100:103], v[28:31], v[208:211]
 ds_read_b128 a[68:71], v3 offset:24576
 v_mfma_f32_16x16x32_bf16 v[208:211], a[96:99], v[20:23], v[208:211]
 s_waitcnt lgkmcnt(6)
 v_permlane16_swap_b32 v7, v72
 v_permlane16_swap_b32 v8, v73
 v_mfma_f32_16x16x32_bf16 v[148:151], a[104:107], v[16:19], v[148:151]
 ds_read_b128 a[72:75], v3 offset:9216
 v_mfma_f32_16x16x32_bf16 v[148:151], a[108:111], v[24:27], v[148:151]
 buffer_load_dwordx4 v[104:107], v1, s[12:15], s56 offen offset:2048 sc1
 v_mfma_f32_16x16x32_bf16 v[212:215], a[108:111], v[28:31], v[212:215]
 ds_read_b128 a[76:79], v3 offset:25600
 v_mfma_f32_16x16x32_bf16 v[212:215], a[104:107], v[20:23], v[212:215]
 s_waitcnt lgkmcnt(6)
 v_add_f32 v7, v7, v72
 v_add_f32 v8, v8, v73
 v_mfma_f32_16x16x32_bf16 v[152:155], a[112:115], v[16:19], v[152:155]
 ds_read_b128 a[80:83], v3 offset:10240
 v_mfma_f32_16x16x32_bf16 v[152:155], a[116:119], v[24:27], v[152:155]
 buffer_load_dwordx4 v[44:47], v1, s[12:15], s55 offen offset:3072 sc1
 v_mfma_f32_16x16x32_bf16 v[216:219], a[116:119], v[28:31], v[216:219]
 ds_read_b128 a[84:87], v3 offset:26624
 v_mfma_f32_16x16x32_bf16 v[216:219], a[112:115], v[20:23], v[216:219]
 s_waitcnt lgkmcnt(6)
 v_mfma_f32_16x16x32_bf16 v[156:159], a[120:123], v[16:19], v[156:159]
 ds_read_b128 a[88:91], v3 offset:11264
 v_mfma_f32_16x16x32_bf16 v[156:159], a[124:127], v[24:27], v[156:159]
 buffer_load_dwordx4 v[108:111], v1, s[12:15], s56 offen offset:3072 sc1
 v_mfma_f32_16x16x32_bf16 v[220:223], a[124:127], v[28:31], v[220:223]
 ds_read_b128 a[92:95], v3 offset:27648
 v_mfma_f32_16x16x32_bf16 v[220:223], a[120:123], v[20:23], v[220:223]
 s_waitcnt lgkmcnt(6)
 v_mfma_f32_16x16x32_bf16 v[160:163], a[64:67], v[16:19], v[160:163]
 ds_read_b128 a[96:99], v3 offset:12288
 v_mfma_f32_16x16x32_bf16 v[160:163], a[68:71], v[24:27], v[160:163]
 buffer_load_dwordx4 v[48:51], v4, s[12:15], s55 offen offset:0 sc1
 v_mfma_f32_16x16x32_bf16 v[224:227], a[68:71], v[28:31], v[224:227]
 ds_read_b128 a[100:103], v3 offset:28672
 v_mfma_f32_16x16x32_bf16 v[224:227], a[64:67], v[20:23], v[224:227]
 s_waitcnt lgkmcnt(6)
 v_mfma_f32_16x16x32_bf16 v[164:167], a[72:75], v[16:19], v[164:167]
 ds_read_b128 a[104:107], v3 offset:13312
 v_mfma_f32_16x16x32_bf16 v[164:167], a[76:79], v[24:27], v[164:167]
 buffer_load_dwordx4 v[112:115], v4, s[12:15], s56 offen offset:0 sc1
 v_mfma_f32_16x16x32_bf16 v[228:231], a[76:79], v[28:31], v[228:231]
 ds_read_b128 a[108:111], v3 offset:29696
 v_mfma_f32_16x16x32_bf16 v[228:231], a[72:75], v[20:23], v[228:231]
 s_waitcnt lgkmcnt(6)
 v_mfma_f32_16x16x32_bf16 v[168:171], a[80:83], v[16:19], v[168:171]
 ds_read_b128 a[112:115], v3 offset:14336
 v_mfma_f32_16x16x32_bf16 v[168:171], a[84:87], v[24:27], v[168:171]
 buffer_load_dwordx4 v[52:55], v4, s[12:15], s55 offen offset:1024 sc1
 v_mfma_f32_16x16x32_bf16 v[232:235], a[84:87], v[28:31], v[232:235]
 ds_read_b128 a[116:119], v3 offset:30720
 v_mfma_f32_16x16x32_bf16 v[232:235], a[80:83], v[20:23], v[232:235]
 s_waitcnt lgkmcnt(6)
 v_mfma_f32_16x16x32_bf16 v[172:175], a[88:91], v[16:19], v[172:175]
 ds_read_b128 a[120:123], v3 offset:15360
 v_mfma_f32_16x16x32_bf16 v[172:175], a[92:95], v[24:27], v[172:175]
 buffer_load_dwordx4 v[116:119], v4, s[12:15], s56 offen offset:1024 sc1
 v_mfma_f32_16x16x32_bf16 v[236:239], a[92:95], v[28:31], v[236:239]
 ds_read_b128 a[124:127], v3 offset:31744
 v_mfma_f32_16x16x32_bf16 v[236:239], a[88:91], v[20:23], v[236:239]
 s_waitcnt lgkmcnt(6)
 v_mfma_f32_16x16x32_bf16 v[176:179], a[96:99], v[16:19], v[176:179]
 v_mfma_f32_16x16x32_bf16 v[176:179], a[100:103], v[24:27], v[176:179]
 buffer_load_dwordx4 v[56:59], v4, s[12:15], s55 offen offset:2048 sc1
 v_mfma_f32_16x16x32_bf16 v[240:243], a[100:103], v[28:31], v[240:243]
 v_mfma_f32_16x16x32_bf16 v[240:243], a[96:99], v[20:23], v[240:243]
 s_waitcnt lgkmcnt(4)
 v_mfma_f32_16x16x32_bf16 v[180:183], a[104:107], v[16:19], v[180:183]
 v_mfma_f32_16x16x32_bf16 v[180:183], a[108:111], v[24:27], v[180:183]
 buffer_load_dwordx4 v[120:123], v4, s[12:15], s56 offen offset:2048 sc1
 v_mfma_f32_16x16x32_bf16 v[244:247], a[108:111], v[28:31], v[244:247]
 v_mfma_f32_16x16x32_bf16 v[244:247], a[104:107], v[20:23], v[244:247]
 s_waitcnt lgkmcnt(2)
 v_mfma_f32_16x16x32_bf16 v[184:187], a[112:115], v[16:19], v[184:187]
 v_mfma_f32_16x16x32_bf16 v[184:187], a[116:119], v[24:27], v[184:187]
 buffer_load_dwordx4 v[60:63], v4, s[12:15], s55 offen offset:3072 sc1
 v_mfma_f32_16x16x32_bf16 v[248:251], a[116:119], v[28:31], v[248:251]
 v_mfma_f32_16x16x32_bf16 v[248:251], a[112:115], v[20:23], v[248:251]
 s_waitcnt lgkmcnt(0)
 v_mfma_f32_16x16x32_bf16 v[188:191], a[120:123], v[16:19], v[188:191]
 v_mfma_f32_16x16x32_bf16 v[188:191], a[124:127], v[24:27], v[188:191]
 v_mfma_f32_16x16x32_bf16 v[252:255], a[124:127], v[28:31], v[252:255]
 v_mfma_f32_16x16x32_bf16 v[252:255], a[120:123], v[20:23], v[252:255]
 buffer_load_dwordx4 v[124:127], v4, s[12:15], s56 offen offset:3072 sc1
 s_cmp_eq_u32 s58, 0
 s_cbranch_scc1 L_merge2
 v_and_b32 v11, 0, v0
 v_lshlrev_b32 v11, 2, v11
 s_mov_b32 s32, 0
L_poll7:
 buffer_load_dword v12, v11, s[12:15], s94 offen sc1
 s_waitcnt vmcnt(0)
 v_cmp_ne_u32 vcc, 0, v12
 s_cbranch_vccz L_poll7_ok
 s_sleep 6
 s_add_u32 s32, s32, 1
 s_cmp_lt_u32 s32, 0x80000
 s_cbranch_scc1 L_poll7
L_poll7_ok:
 s_mov_b32 s55, s52
 s_mov_b32 s57, s53
 s_add_u32 s56, s55, 0x2000
 buffer_load_dwordx4 v[68:71], v1, s[12:15], s57 offen sc1
 buffer_load_dwordx4 v[32:35], v1, s[12:15], s55 offen offset:0 sc1
 buffer_load_dwordx4 v[96:99], v1, s[12:15], s56 offen offset:0 sc1
 buffer_load_dwordx4 v[36:39], v1, s[12:15], s55 offen offset:1024 sc1
 buffer_load_dwordx4 v[100:103], v1, s[12:15], s56 offen offset:1024 sc1
 buffer_load_dwordx4 v[40:43], v1, s[12:15], s55 offen offset:2048 sc1
 buffer_load_dwordx4 v[104:107], v1, s[12:15], s56 offen offset:2048 sc1
 buffer_load_dwordx4 v[44:47], v1, s[12:15], s55 offen offset:3072 sc1
 buffer_load_dwordx4 v[108:111], v1, s[12:15], s56 offen offset:3072 sc1
 buffer_load_dwordx4 v[48:51], v4, s[12:15], s55 offen offset:0 sc1
 buffer_load_dwordx4 v[112:115], v4, s[12:15], s56 offen offset:0 sc1
 buffer_load_dwordx4 v[52:55], v4, s[12:15], s55 offen offset:1024 sc1
 buffer_load_dwordx4 v[116:119], v4, s[12:15], s56 offen offset:1024 sc1
 buffer_load_dwordx4 v[56:59], v4, s[12:15], s55 offen offset:2048 sc1
 buffer_load_dwordx4 v[120:123], v4, s[12:15], s56 offen offset:2048 sc1
 buffer_load_dwordx4 v[60:63], v4, s[12:15], s55 offen offset:3072 sc1
 buffer_load_dwordx4 v[124:127], v4, s[12:15], s56 offen offset:3072 sc1
L_merge2:
 s_waitcnt vmcnt(14)
 v_cmp_neq_f32 vcc, v70, v9
 v_cmp_neq_f32 s[20:21], v71, v10
 s_or_b64 vcc, vcc, s[20:21]
 s_cbranch_vccnz L_mslow
 v_mfma_f32_16x16x32_bf16 v[128:131], a[250:253], v[32:35], v[128:131]
 s_add_u32 m0, s29, 0
 v_add_f32 v7, v7, v68
 v_add_f32 v8, v8, v69
 v_mfma_f32_16x16x32_bf16 v[132:135], a[248:251], v[32:35], v[132:135]
 buffer_load_dwordx4 v2, s[8:11], s78 offen lds
 v_mfma_f32_16x16x32_bf16 v[192:195], a[250:253], v[96:99], v[192:195]
 v_rcp_f32 v64, v7
 v_mfma_f32_16x16x32_bf16 v[196:199], a[248:251], v[96:99], v[196:199]
 s_waitcnt vmcnt(13)
 v_rcp_f32 v65, v8
 v_mfma_f32_16x16x32_bf16 v[136:139], a[250:253], v[36:39], v[136:139]
 s_add_u32 m0, s29, 4096
 v_mfma_f32_16x16x32_bf16 v[140:143], a[248:251], v[36:39], v[140:143]
 buffer_load_dwordx4 v2, s[8:11], s79 offen lds
 v_mfma_f32_16x16x32_bf16 v[200:203], a[250:253], v[100:103], v[200:203]
 v_cvt_pk_bf16_f32 v128, v128, v129
 v_cvt_pk_bf16_f32 v129, v130, v131
 v_mfma_f32_16x16x32_bf16 v[204:207], a[248:251], v[100:103], v[204:207]
 s_waitcnt vmcnt(12)
 v_cvt_pk_bf16_f32 v130, v132, v133
 v_cvt_pk_bf16_f32 v131, v134, v135
 v_mfma_f32_16x16x32_bf16 v[144:147], a[250:253], v[40:43], v[144:147]
 s_add_u32 m0, s29, 8192
 v_cvt_pk_bf16_f32 v192, v192, v193
 v_cvt_pk_bf16_f32 v193, v194, v195
 v_mfma_f32_16x16x32_bf16 v[148:151], a[248:251], v[40:43], v[148:151]
 buffer_load_dwordx4 v2, s[8:11], s80 offen lds
 v_mfma_f32_16x16x32_bf16 v[208:211], a[250:253], v[104:107], v[208:211]
 v_cvt_pk_bf16_f32 v194, v196, v197
 v_cvt_pk_bf16_f32 v195, v198, v199
 v_mfma_f32_16x16x32_bf16 v[212:215], a[248:251], v[104:107], v[212:215]
 s_waitcnt vmcnt(11)
 v_cvt_pk_bf16_f32 v136, v136, v137
 v_cvt_pk_bf16_f32 v137, v138, v139
 v_mfma_f32_16x16x32_bf16 v[152:155], a[250:253], v[44:47], v[152:155]
 s_add_u32 m0, s29, 12288
 v_cvt_pk_bf16_f32 v138, v140, v141
 v_cvt_pk_bf16_f32 v139, v142, v143
 v_mfma_f32_16x16x32_bf16 v[156:159], a[248:251], v[44:47], v[156:159]
 buffer_load_dwordx4 v2, s[8:11], s81 offen lds
 v_mfma_f32_16x16x32_bf16 v[216:219], a[250:253], v[108:111], v[216:219]
 v_cvt_pk_bf16_f32 v200, v200, v201
 v_cvt_pk_bf16_f32 v201, v202, v203
 v_mfma_f32_16x16x32_bf16 v[220:223], a[248:251], v[108:111], v[220:223]
 s_waitcnt vmcnt(10)
 v_cvt_pk_bf16_f32 v202, v204, v205
 v_cvt_pk_bf16_f32 v203, v206, v207
 v_mfma_f32_16x16x32_bf16 v[160:163], a[250:253], v[48:51], v[160:163]
 s_add_u32 m0, s29, 16384
 v_cvt_pk_bf16_f32 v144, v144, v145
 v_cvt_pk_bf16_f32 v145, v146, v147
 v_mfma_f32_16x16x32_bf16 v[164:167], a[248:251], v[48:51], v[164:167]
 buffer_load_dwordx4 v2, s[8:11], s82 offen lds
 v_mfma_f32_16x16x32_bf16 v[224:227], a[250:253], v[112:115], v[224:227]
 v_cvt_pk_bf16_f32 v146, v148, v149
 v_cvt_pk_bf16_f32 v147, v150, v151
 v_mfma_f32_16x16x32_bf16 v[228:231], a[248:251], v[112:115], v[228:231]
 s_waitcnt vmcnt(9)
 v_cvt_pk_bf16_f32 v208, v208, v209
 v_cvt_pk_bf16_f32 v209, v210, v211
 v_mfma_f32_16x16x32_bf16 v[168:171], a[250:253], v[52:55], v[168:171]
 s_add_u32 m0, s29, 20480
 v_cvt_pk_bf16_f32 v210, v212, v213
 v_cvt_pk_bf16_f32 v211, v214, v215
 v_mfma_f32_16x16x32_bf16 v[172:175], a[248:251], v[52:55], v[172:175]
 buffer_load_dwordx4 v2, s[8:11], s83 offen lds
 v_mfma_f32_16x16x32_bf16 v[232:235], a[250:253], v[116:119], v[232:235]
 v_cvt_pk_bf16_f32 v152, v152, v153
 v_cvt_pk_bf16_f32 v153, v154, v155
 v_mfma_f32_16x16x32_bf16 v[236:239], a[248:251], v[116:119], v[236:239]
 s_waitcnt vmcnt(8)
 v_cvt_pk_bf16_f32 v154, v156, v157
 v_cvt_pk_bf16_f32 v155, v158, v159
 v_mfma_f32_16x16x32_bf16 v[176:179], a[250:253], v[56:59], v[176:179]
 s_add_u32 m0, s29, 24576
 v_cvt_pk_bf16_f32 v216, v216, v217
 v_cvt_pk_bf16_f32 v217, v218, v219
 v_mfma_f32_16x16x32_bf16 v[180:183], a[248:251], v[56:59], v[180:183]
 buffer_load_dwordx4 v2, s[8:11], s84 offen lds
 v_mfma_f32_16x16x32_bf16 v[240:243], a[250:253], v[120:123], v[240:243]
 v_cvt_pk_bf16_f32 v218, v220, v221
 v_cvt_pk_bf16_f32 v219, v222, v223
 v_mfma_f32_16x16x32_bf16 v[244:247], a[248:251], v[120:123], v[244:247]
 s_waitcnt vmcnt(7)
 v_cvt_pk_bf16_f32 v160, v160, v161
 v_cvt_pk_bf16_f32 v161, v162, v163
 v_mfma_f32_16x16x32_bf16 v[184:187], a[250:253], v[60:63], v[184:187]
 s_add_u32 m0, s29, 28672
 v_cvt_pk_bf16_f32 v162, v164, v165
 v_cvt_pk_bf16_f32 v163, v166, v167
 v_mfma_f32_16x16x32_bf16 v[188:191], a[248:251], v[60:63], v[188:191]
 buffer_load_dwordx4 v2, s[8:11], s85 offen lds
 v_mfma_f32_16x16x32_bf16 v[248:251], a[250:253], v[124:127], v[248:251]
 v_cvt_pk_bf16_f32 v224, v224, v225
 v_cvt_pk_bf16_f32 v225, v226, v227
 v_mfma_f32_16x16x32_bf16 v[252:255], a[248:251], v[124:127], v[252:255]
 v_cvt_pk_bf16_f32 v226, v228, v229
 v_cvt_pk_bf16_f32 v227, v230, v231
 v_add_u32 v2, 128, v2
 v_cvt_pk_bf16_f32 v168, v168, v169
 v_cvt_pk_bf16_f32 v169, v170, v171
 v_cvt_pk_bf16_f32 v170, v172, v173
 v_cvt_pk_bf16_f32 v171, v174, v175
 v_cvt_pk_bf16_f32 v232, v232, v233
 v_cvt_pk_bf16_f32 v233, v234, v235
 v_cvt_pk_bf16_f32 v234, v236, v237
 v_cvt_pk_bf16_f32 v235, v238, v239
 v_cvt_pk_bf16_f32 v176, v176, v177
 v_cvt_pk_bf16_f32 v177, v178, v179
 v_cvt_pk_bf16_f32 v178, v180, v181
 v_cvt_pk_bf16_f32 v179, v182, v183
 v_cvt_pk_bf16_f32 v240, v240, v241
 v_cvt_pk_bf16_f32 v241, v242, v243
 v_cvt_pk_bf16_f32 v242, v244, v245
 v_cvt_pk_bf16_f32 v243, v246, v247
 v_cvt_pk_bf16_f32 v184, v184, v185
 v_cvt_pk_bf16_f32 v185, v186, v187
 v_cvt_pk_bf16_f32 v186, v188, v189
 v_cvt_pk_bf16_f32 v187, v190, v191
 v_cvt_pk_bf16_f32 v248, v248, v249
 v_cvt_pk_bf16_f32 v249, v250, v251
 v_cvt_pk_bf16_f32 v250, v252, v253
 v_cvt_pk_bf16_f32 v251, v254, v255
 s_waitcnt vmcnt(0)
 s_branch L_attdone
L_mslow:
 s_add_u32 m0, s29, 0
 s_nop 0
 buffer_load_dwordx4 v2, s[8:11], s78 offen lds
 s_add_u32 m0, s29, 4096
 s_nop 0
 buffer_load_dwordx4 v2, s[8:11], s79 offen lds
 s_add_u32 m0, s29, 8192
 s_nop 0
 buffer_load_dwordx4 v2, s[8:11], s80 offen lds
 s_add_u32 m0, s29, 12288
 s_nop 0
 buffer_load_dwordx4 v2, s[8:11], s81 offen lds
 s_add_u32 m0, s29, 16384
 s_nop 0
 buffer_load_dwordx4 v2, s[8:11], s82 offen lds
 s_add_u32 m0, s29, 20480
 s_nop 0
 buffer_load_dwordx4 v2, s[8:11], s83 offen lds
 s_add_u32 m0, s29, 24576
 s_nop 0
 buffer_load_dwordx4 v2, s[8:11], s84 offen lds
 s_add_u32 m0, s29, 28672
 s_nop 0
 buffer_load_dwordx4 v2, s[8:11], s85 offen lds
 v_add_u32 v2, 128, v2
 s_mov_b32 s58, 0xffff0000
 s_waitcnt vmcnt(0)
 v_min_f32 v20, v70, v9
 v_sub_f32 v21, v20, v9
 v_sub_f32 v22, v20, v70
 v_exp_f32 v16, v21
 v_exp_f32 v18, v22
 s_nop 0
 v_mul_f32 v7, v7, v16
 v_fmac_f32 v7, v68, v18
 v_rcp_f32 v64, v7
 v_min_f32 v20, v71, v10
 v_sub_f32 v21, v20, v10
 v_sub_f32 v22, v20, v71
 v_exp_f32 v17, v21
 v_exp_f32 v19, v22
 s_nop 0
 v_mul_f32 v8, v8, v17
 v_fmac_f32 v8, v69, v19
 v_rcp_f32 v65, v8
 v_lshlrev_b32 v24, 16, v32
 v_and_b32 v25, s58, v32
 v_pk_mul_f32 v[24:25], v[24:25], v[18:19] op_sel:[0,0] op_sel_hi:[1,0]
 v_pk_fma_f32 v[128:129], v[128:129], v[16:17], v[24:25] op_sel:[0,0,0] op_sel_hi:[1,0,1]
 v_lshlrev_b32 v26, 16, v33
 v_and_b32 v27, s58, v33
 v_pk_mul_f32 v[26:27], v[26:27], v[18:19] op_sel:[0,0] op_sel_hi:[1,0]
 v_pk_fma_f32 v[130:131], v[130:131], v[16:17], v[26:27] op_sel:[0,0,0] op_sel_hi:[1,0,1]
 v_lshlrev_b32 v28, 16, v34
 v_and_b32 v29, s58, v34
 v_pk_mul_f32 v[28:29], v[28:29], v[18:19] op_sel:[0,0] op_sel_hi:[1,0]
 v_pk_fma_f32 v[132:133], v[132:133], v[16:17], v[28:29] op_sel:[0,0,0] op_sel_hi:[1,0,1]
 v_lshlrev_b32 v30, 16, v35
 v_and_b32 v31, s58, v35
 v_pk_mul_f32 v[30:31], v[30:31], v[18:19] op_sel:[0,0] op_sel_hi:[1,0]
 v_pk_fma_f32 v[134:135], v[134:135], v[16:17], v[30:31] op_sel:[0,0,0] op_sel_hi:[1,0,1]
 v_cvt_pk_bf16_f32 v128, v128, v129
 v_cvt_pk_bf16_f32 v129, v130, v131
 v_cvt_pk_bf16_f32 v130, v132, v133
 v_cvt_pk_bf16_f32 v131, v134, v135
 v_lshlrev_b32 v24, 16, v36
 v_and_b32 v25, s58, v36
 v_pk_mul_f32 v[24:25], v[24:25], v[18:19] op_sel:[0,0] op_sel_hi:[1,0]
 v_pk_fma_f32 v[136:137], v[136:137], v[16:17], v[24:25] op_sel:[0,0,0] op_sel_hi:[1,0,1]
 v_lshlrev_b32 v26, 16, v37
 v_and_b32 v27, s58, v37
 v_pk_mul_f32 v[26:27], v[26:27], v[18:19] op_sel:[0,0] op_sel_hi:[1,0]
 v_pk_fma_f32 v[138:139], v[138:139], v[16:17], v[26:27] op_sel:[0,0,0] op_sel_hi:[1,0,1]
 v_lshlrev_b32 v28, 16, v38
 v_and_b32 v29, s58, v38
 v_pk_mul_f32 v[28:29], v[28:29], v[18:19] op_sel:[0,0] op_sel_hi:[1,0]
 v_pk_fma_f32 v[140:141], v[140:141], v[16:17], v[28:29] op_sel:[0,0,0] op_sel_hi:[1,0,1]
 v_lshlrev_b32 v30, 16, v39
 v_and_b32 v31, s58, v39
 v_pk_mul_f32 v[30:31], v[30:31], v[18:19] op_sel:[0,0] op_sel_hi:[1,0]
 v_pk_fma_f32 v[142:143], v[142:143], v[16:17], v[30:31] op_sel:[0,0,0] op_sel_hi:[1,0,1]
 v_cvt_pk_bf16_f32 v136, v136, v137
 v_cvt_pk_bf16_f32 v137, v138, v139
 v_cvt_pk_bf16_f32 v138, v140, v141
 v_cvt_pk_bf16_f32 v139, v142, v143
 v_lshlrev_b32 v24, 16, v40
 v_and_b32 v25, s58, v40
 v_pk_mul_f32 v[24:25], v[24:25], v[18:19] op_sel:[0,0] op_sel_hi:[1,0]
 v_pk_fma_f32 v[144:145], v[144:145], v[16:17], v[24:25] op_sel:[0,0,0] op_sel_hi:[1,0,1]
 v_lshlrev_b32 v26, 16, v41
 v_and_b32 v27, s58, v41
 v_pk_mul_f32 v[26:27], v[26:27], v[18:19] op_sel:[0,0] op_sel_hi:[1,0]
 v_pk_fma_f32 v[146:147], v[146:147], v[16:17], v[26:27] op_sel:[0,0,0] op_sel_hi:[1,0,1]
 v_lshlrev_b32 v28, 16, v42
 v_and_b32 v29, s58, v42
 v_pk_mul_f32 v[28:29], v[28:29], v[18:19] op_sel:[0,0] op_sel_hi:[1,0]
 v_pk_fma_f32 v[148:149], v[148:149], v[16:17], v[28:29] op_sel:[0,0,0] op_sel_hi:[1,0,1]
 v_lshlrev_b32 v30, 16, v43
 v_and_b32 v31, s58, v43
 v_pk_mul_f32 v[30:31], v[30:31], v[18:19] op_sel:[0,0] op_sel_hi:[1,0]
 v_pk_fma_f32 v[150:151], v[150:151], v[16:17], v[30:31] op_sel:[0,0,0] op_sel_hi:[1,0,1]
 v_cvt_pk_bf16_f32 v144, v144, v145
 v_cvt_pk_bf16_f32 v145, v146, v147
 v_cvt_pk_bf16_f32 v146, v148, v149
 v_cvt_pk_bf16_f32 v147, v150, v151
 v_lshlrev_b32 v24, 16, v44
 v_and_b32 v25, s58, v44
 v_pk_mul_f32 v[24:25], v[24:25], v[18:19] op_sel:[0,0] op_sel_hi:[1,0]
 v_pk_fma_f32 v[152:153], v[152:153], v[16:17], v[24:25] op_sel:[0,0,0] op_sel_hi:[1,0,1]
 v_lshlrev_b32 v26, 16, v45
 v_and_b32 v27, s58, v45
 v_pk_mul_f32 v[26:27], v[26:27], v[18:19] op_sel:[0,0] op_sel_hi:[1,0]
 v_pk_fma_f32 v[154:155], v[154:155], v[16:17], v[26:27] op_sel:[0,0,0] op_sel_hi:[1,0,1]
 v_lshlrev_b32 v28, 16, v46
 v_and_b32 v29, s58, v46
 v_pk_mul_f32 v[28:29], v[28:29], v[18:19] op_sel:[0,0] op_sel_hi:[1,0]
 v_pk_fma_f32 v[156:157], v[156:157], v[16:17], v[28:29] op_sel:[0,0,0] op_sel_hi:[1,0,1]
 v_lshlrev_b32 v30, 16, v47
 v_and_b32 v31, s58, v47
 v_pk_mul_f32 v[30:31], v[30:31], v[18:19] op_sel:[0,0] op_sel_hi:[1,0]
 v_pk_fma_f32 v[158:159], v[158:159], v[16:17], v[30:31] op_sel:[0,0,0] op_sel_hi:[1,0,1]
 v_cvt_pk_bf16_f32 v152, v152, v153
 v_cvt_pk_bf16_f32 v153, v154, v155
 v_cvt_pk_bf16_f32 v154, v156, v157
 v_cvt_pk_bf16_f32 v155, v158, v159
 v_lshlrev_b32 v24, 16, v48
 v_and_b32 v25, s58, v48
 v_pk_mul_f32 v[24:25], v[24:25], v[18:19] op_sel:[0,0] op_sel_hi:[1,0]
 v_pk_fma_f32 v[160:161], v[160:161], v[16:17], v[24:25] op_sel:[0,0,0] op_sel_hi:[1,0,1]
 v_lshlrev_b32 v26, 16, v49
 v_and_b32 v27, s58, v49
 v_pk_mul_f32 v[26:27], v[26:27], v[18:19] op_sel:[0,0] op_sel_hi:[1,0]
 v_pk_fma_f32 v[162:163], v[162:163], v[16:17], v[26:27] op_sel:[0,0,0] op_sel_hi:[1,0,1]
 v_lshlrev_b32 v28, 16, v50
 v_and_b32 v29, s58, v50
 v_pk_mul_f32 v[28:29], v[28:29], v[18:19] op_sel:[0,0] op_sel_hi:[1,0]
 v_pk_fma_f32 v[164:165], v[164:165], v[16:17], v[28:29] op_sel:[0,0,0] op_sel_hi:[1,0,1]
 v_lshlrev_b32 v30, 16, v51
 v_and_b32 v31, s58, v51
 v_pk_mul_f32 v[30:31], v[30:31], v[18:19] op_sel:[0,0] op_sel_hi:[1,0]
 v_pk_fma_f32 v[166:167], v[166:167], v[16:17], v[30:31] op_sel:[0,0,0] op_sel_hi:[1,0,1]
 v_cvt_pk_bf16_f32 v160, v160, v161
 v_cvt_pk_bf16_f32 v161, v162, v163
 v_cvt_pk_bf16_f32 v162, v164, v165
 v_cvt_pk_bf16_f32 v163, v166, v167
 v_lshlrev_b32 v24, 16, v52
 v_and_b32 v25, s58, v52
 v_pk_mul_f32 v[24:25], v[24:25], v[18:19] op_sel:[0,0] op_sel_hi:[1,0]
 v_pk_fma_f32 v[168:169], v[168:169], v[16:17], v[24:25] op_sel:[0,0,0] op_sel_hi:[1,0,1]
 v_lshlrev_b32 v26, 16, v53
 v_and_b32 v27, s58, v53
 v_pk_mul_f32 v[26:27], v[26:27], v[18:19] op_sel:[0,0] op_sel_hi:[1,0]
 v_pk_fma_f32 v[170:171], v[170:171], v[16:17], v[26:27] op_sel:[0,0,0] op_sel_hi:[1,0,1]
 v_lshlrev_b32 v28, 16, v54
 v_and_b32 v29, s58, v54
 v_pk_mul_f32 v[28:29], v[28:29], v[18:19] op_sel:[0,0] op_sel_hi:[1,0]
 v_pk_fma_f32 v[172:173], v[172:173], v[16:17], v[28:29] op_sel:[0,0,0] op_sel_hi:[1,0,1]
 v_lshlrev_b32 v30, 16, v55
 v_and_b32 v31, s58, v55
 v_pk_mul_f32 v[30:31], v[30:31], v[18:19] op_sel:[0,0] op_sel_hi:[1,0]
 v_pk_fma_f32 v[174:175], v[174:175], v[16:17], v[30:31] op_sel:[0,0,0] op_sel_hi:[1,0,1]
 v_cvt_pk_bf16_f32 v168, v168, v169
 v_cvt_pk_bf16_f32 v169, v170, v171
 v_cvt_pk_bf16_f32 v170, v172, v173
 v_cvt_pk_bf16_f32 v171, v174, v175
 v_lshlrev_b32 v24, 16, v56
 v_and_b32 v25, s58, v56
 v_pk_mul_f32 v[24:25], v[24:25], v[18:19] op_sel:[0,0] op_sel_hi:[1,0]
 v_pk_fma_f32 v[176:177], v[176:177], v[16:17], v[24:25] op_sel:[0,0,0] op_sel_hi:[1,0,1]
 v_lshlrev_b32 v26, 16, v57
 v_and_b32 v27, s58, v57
 v_pk_mul_f32 v[26:27], v[26:27], v[18:19] op_sel:[0,0] op_sel_hi:[1,0]
 v_pk_fma_f32 v[178:179], v[178:179], v[16:17], v[26:27] op_sel:[0,0,0] op_sel_hi:[1,0,1]
 v_lshlrev_b32 v28, 16, v58
 v_and_b32 v29, s58, v58
 v_pk_mul_f32 v[28:29], v[28:29], v[18:19] op_sel:[0,0] op_sel_hi:[1,0]
 v_pk_fma_f32 v[180:181], v[180:181], v[16:17], v[28:29] op_sel:[0,0,0] op_sel_hi:[1,0,1]
 v_lshlrev_b32 v30, 16, v59
 v_and_b32 v31, s58, v59
 v_pk_mul_f32 v[30:31], v[30:31], v[18:19] op_sel:[0,0] op_sel_hi:[1,0]
 v_pk_fma_f32 v[182:183], v[182:183], v[16:17], v[30:31] op_sel:[0,0,0] op_sel_hi:[1,0,1]
 v_cvt_pk_bf16_f32 v176, v176, v177
 v_cvt_pk_bf16_f32 v177, v178, v179
 v_cvt_pk_bf16_f32 v178, v180, v181
 v_cvt_pk_bf16_f32 v179, v182, v183
 v_lshlrev_b32 v24, 16, v60
 v_and_b32 v25, s58, v60
 v_pk_mul_f32 v[24:25], v[24:25], v[18:19] op_sel:[0,0] op_sel_hi:[1,0]
 v_pk_fma_f32 v[184:185], v[184:185], v[16:17], v[24:25] op_sel:[0,0,0] op_sel_hi:[1,0,1]
 v_lshlrev_b32 v26, 16, v61
 v_and_b32 v27, s58, v61
 v_pk_mul_f32 v[26:27], v[26:27], v[18:19] op_sel:[0,0] op_sel_hi:[1,0]
 v_pk_fma_f32 v[186:187], v[186:187], v[16:17], v[26:27] op_sel:[0,0,0] op_sel_hi:[1,0,1]
 v_lshlrev_b32 v28, 16, v62
 v_and_b32 v29, s58, v62
 v_pk_mul_f32 v[28:29], v[28:29], v[18:19] op_sel:[0,0] op_sel_hi:[1,0]
 v_pk_fma_f32 v[188:189], v[188:189], v[16:17], v[28:29] op_sel:[0,0,0] op_sel_hi:[1,0,1]
 v_lshlrev_b32 v30, 16, v63
 v_and_b32 v31, s58, v63
 v_pk_mul_f32 v[30:31], v[30:31], v[18:19] op_sel:[0,0] op_sel_hi:[1,0]
 v_pk_fma_f32 v[190:191], v[190:191], v[16:17], v[30:31] op_sel:[0,0,0] op_sel_hi:[1,0,1]
 v_cvt_pk_bf16_f32 v184, v184, v185
 v_cvt_pk_bf16_f32 v185, v186, v187
 v_cvt_pk_bf16_f32 v186, v188, v189
 v_cvt_pk_bf16_f32 v187, v190, v191
 v_lshlrev_b32 v24, 16, v96
 v_and_b32 v25, s58, v96
 v_pk_mul_f32 v[24:25], v[24:25], v[18:19] op_sel:[0,1] op_sel_hi:[1,1]
 v_pk_fma_f32 v[192:193], v[192:193], v[16:17], v[24:25] op_sel:[0,1,0] op_sel_hi:[1,1,1]
 v_lshlrev_b32 v26, 16, v97
 v_and_b32 v27, s58, v97
 v_pk_mul_f32 v[26:27], v[26:27], v[18:19] op_sel:[0,1] op_sel_hi:[1,1]
 v_pk_fma_f32 v[194:195], v[194:195], v[16:17], v[26:27] op_sel:[0,1,0] op_sel_hi:[1,1,1]
 v_lshlrev_b32 v28, 16, v98
 v_and_b32 v29, s58, v98
 v_pk_mul_f32 v[28:29], v[28:29], v[18:19] op_sel:[0,1] op_sel_hi:[1,1]
 v_pk_fma_f32 v[196:197], v[196:197], v[16:17], v[28:29] op_sel:[0,1,0] op_sel_hi:[1,1,1]
 v_lshlrev_b32 v30, 16, v99
 v_and_b32 v31, s58, v99
 v_pk_mul_f32 v[30:31], v[30:31], v[18:19] op_sel:[0,1] op_sel_hi:[1,1]
 v_pk_fma_f32 v[198:199], v[198:199], v[16:17], v[30:31] op_sel:[0,1,0] op_sel_hi:[1,1,1]
 v_cvt_pk_bf16_f32 v192, v192, v193
 v_cvt_pk_bf16_f32 v193, v194, v195
 v_cvt_pk_bf16_f32 v194, v196, v197
 v_cvt_pk_bf16_f32 v195, v198, v199
 v_lshlrev_b32 v24, 16, v100
 v_and_b32 v25, s58, v100
 v_pk_mul_f32 v[24:25], v[24:25], v[18:19] op_sel:[0,1] op_sel_hi:[1,1]
 v_pk_fma_f32 v[200:201], v[200:201], v[16:17], v[24:25] op_sel:[0,1,0] op_sel_hi:[1,1,1]
 v_lshlrev_b32 v26, 16, v101
 v_and_b32 v27, s58, v101
 v_pk_mul_f32 v[26:27], v[26:27], v[18:19] op_sel:[0,1] op_sel_hi:[1,1]
 v_pk_fma_f32 v[202:203], v[202:203], v[16:17], v[26:27] op_sel:[0,1,0] op_sel_hi:[1,1,1]
 v_lshlrev_b32 v28, 16, v102
 v_and_b32 v29, s58, v102
 v_pk_mul_f32 v[28:29], v[28:29], v[18:19] op_sel:[0,1] op_sel_hi:[1,1]
 v_pk_fma_f32 v[204:205], v[204:205], v[16:17], v[28:29] op_sel:[0,1,0] op_sel_hi:[1,1,1]
 v_lshlrev_b32 v30, 16, v103
 v_and_b32 v31, s58, v103
 v_pk_mul_f32 v[30:31], v[30:31], v[18:19] op_sel:[0,1] op_sel_hi:[1,1]
 v_pk_fma_f32 v[206:207], v[206:207], v[16:17], v[30:31] op_sel:[0,1,0] op_sel_hi:[1,1,1]
 v_cvt_pk_bf16_f32 v200, v200, v201
 v_cvt_pk_bf16_f32 v201, v202, v203
 v_cvt_pk_bf16_f32 v202, v204, v205
 v_cvt_pk_bf16_f32 v203, v206, v207
 v_lshlrev_b32 v24, 16, v104
 v_and_b32 v25, s58, v104
 v_pk_mul_f32 v[24:25], v[24:25], v[18:19] op_sel:[0,1] op_sel_hi:[1,1]
 v_pk_fma_f32 v[208:209], v[208:209], v[16:17], v[24:25] op_sel:[0,1,0] op_sel_hi:[1,1,1]
 v_lshlrev_b32 v26, 16, v105
 v_and_b32 v27, s58, v105
 v_pk_mul_f32 v[26:27], v[26:27], v[18:19] op_sel:[0,1] op_sel_hi:[1,1]
 v_pk_fma_f32 v[210:211], v[210:211], v[16:17], v[26:27] op_sel:[0,1,0] op_sel_hi:[1,1,1]
 v_lshlrev_b32 v28, 16, v106
 v_and_b32 v29, s58, v106
 v_pk_mul_f32 v[28:29], v[28:29], v[18:19] op_sel:[0,1] op_sel_hi:[1,1]
 v_pk_fma_f32 v[212:213], v[212:213], v[16:17], v[28:29] op_sel:[0,1,0] op_sel_hi:[1,1,1]
 v_lshlrev_b32 v30, 16, v107
 v_and_b32 v31, s58, v107
 v_pk_mul_f32 v[30:31], v[30:31], v[18:19] op_sel:[0,1] op_sel_hi:[1,1]
 v_pk_fma_f32 v[214:215], v[214:215], v[16:17], v[30:31] op_sel:[0,1,0] op_sel_hi:[1,1,1]
 v_cvt_pk_bf16_f32 v208, v208, v209
 v_cvt_pk_bf16_f32 v209, v210, v211
 v_cvt_pk_bf16_f32 v210, v212, v213
 v_cvt_pk_bf16_f32 v211, v214, v215
 v_lshlrev_b32 v24, 16, v108
 v_and_b32 v25, s58, v108
 v_pk_mul_f32 v[24:25], v[24:25], v[18:19] op_sel:[0,1] op_sel_hi:[1,1]
 v_pk_fma_f32 v[216:217], v[216:217], v[16:17], v[24:25] op_sel:[0,1,0] op_sel_hi:[1,1,1]
 v_lshlrev_b32 v26, 16, v109
 v_and_b32 v27, s58, v109
 v_pk_mul_f32 v[26:27], v[26:27], v[18:19] op_sel:[0,1] op_sel_hi:[1,1]
 v_pk_fma_f32 v[218:219], v[218:219], v[16:17], v[26:27] op_sel:[0,1,0] op_sel_hi:[1,1,1]
 v_lshlrev_b32 v28, 16, v110
 v_and_b32 v29, s58, v110
 v_pk_mul_f32 v[28:29], v[28:29], v[18:19] op_sel:[0,1] op_sel_hi:[1,1]
 v_pk_fma_f32 v[220:221], v[220:221], v[16:17], v[28:29] op_sel:[0,1,0] op_sel_hi:[1,1,1]
 v_lshlrev_b32 v30, 16, v111
 v_and_b32 v31, s58, v111
 v_pk_mul_f32 v[30:31], v[30:31], v[18:19] op_sel:[0,1] op_sel_hi:[1,1]
 v_pk_fma_f32 v[222:223], v[222:223], v[16:17], v[30:31] op_sel:[0,1,0] op_sel_hi:[1,1,1]
 v_cvt_pk_bf16_f32 v216, v216, v217
 v_cvt_pk_bf16_f32 v217, v218, v219
 v_cvt_pk_bf16_f32 v218, v220, v221
 v_cvt_pk_bf16_f32 v219, v222, v223
 v_lshlrev_b32 v24, 16, v112
 v_and_b32 v25, s58, v112
 v_pk_mul_f32 v[24:25], v[24:25], v[18:19] op_sel:[0,1] op_sel_hi:[1,1]
 v_pk_fma_f32 v[224:225], v[224:225], v[16:17], v[24:25] op_sel:[0,1,0] op_sel_hi:[1,1,1]
 v_lshlrev_b32 v26, 16, v113
 v_and_b32 v27, s58, v113
 v_pk_mul_f32 v[26:27], v[26:27], v[18:19] op_sel:[0,1] op_sel_hi:[1,1]
 v_pk_fma_f32 v[226:227], v[226:227], v[16:17], v[26:27] op_sel:[0,1,0] op_sel_hi:[1,1,1]
 v_lshlrev_b32 v28, 16, v114
 v_and_b32 v29, s58, v114
 v_pk_mul_f32 v[28:29], v[28:29], v[18:19] op_sel:[0,1] op_sel_hi:[1,1]
 v_pk_fma_f32 v[228:229], v[228:229], v[16:17], v[28:29] op_sel:[0,1,0] op_sel_hi:[1,1,1]
 v_lshlrev_b32 v30, 16, v115
 v_and_b32 v31, s58, v115
 v_pk_mul_f32 v[30:31], v[30:31], v[18:19] op_sel:[0,1] op_sel_hi:[1,1]
 v_pk_fma_f32 v[230:231], v[230:231], v[16:17], v[30:31] op_sel:[0,1,0] op_sel_hi:[1,1,1]
 v_cvt_pk_bf16_f32 v224, v224, v225
 v_cvt_pk_bf16_f32 v225, v226, v227
 v_cvt_pk_bf16_f32 v226, v228, v229
 v_cvt_pk_bf16_f32 v227, v230, v231
 v_lshlrev_b32 v24, 16, v116
 v_and_b32 v25, s58, v116
 v_pk_mul_f32 v[24:25], v[24:25], v[18:19] op_sel:[0,1] op_sel_hi:[1,1]
 v_pk_fma_f32 v[232:233], v[232:233], v[16:17], v[24:25] op_sel:[0,1,0] op_sel_hi:[1,1,1]
 v_lshlrev_b32 v26, 16, v117
 v_and_b32 v27, s58, v117
 v_pk_mul_f32 v[26:27], v[26:27], v[18:19] op_sel:[0,1] op_sel_hi:[1,1]
 v_pk_fma_f32 v[234:235], v[234:235], v[16:17], v[26:27] op_sel:[0,1,0] op_sel_hi:[1,1,1]
 v_lshlrev_b32 v28, 16, v118
 v_and_b32 v29, s58, v118
 v_pk_mul_f32 v[28:29], v[28:29], v[18:19] op_sel:[0,1] op_sel_hi:[1,1]
 v_pk_fma_f32 v[236:237], v[236:237], v[16:17], v[28:29] op_sel:[0,1,0] op_sel_hi:[1,1,1]
 v_lshlrev_b32 v30, 16, v119
 v_and_b32 v31, s58, v119
 v_pk_mul_f32 v[30:31], v[30:31], v[18:19] op_sel:[0,1] op_sel_hi:[1,1]
 v_pk_fma_f32 v[238:239], v[238:239], v[16:17], v[30:31] op_sel:[0,1,0] op_sel_hi:[1,1,1]
 v_cvt_pk_bf16_f32 v232, v232, v233
 v_cvt_pk_bf16_f32 v233, v234, v235
 v_cvt_pk_bf16_f32 v234, v236, v237
 v_cvt_pk_bf16_f32 v235, v238, v239
 v_lshlrev_b32 v24, 16, v120
 v_and_b32 v25, s58, v120
 v_pk_mul_f32 v[24:25], v[24:25], v[18:19] op_sel:[0,1] op_sel_hi:[1,1]
 v_pk_fma_f32 v[240:241], v[240:241], v[16:17], v[24:25] op_sel:[0,1,0] op_sel_hi:[1,1,1]
 v_lshlrev_b32 v26, 16, v121
 v_and_b32 v27, s58, v121
 v_pk_mul_f32 v[26:27], v[26:27], v[18:19] op_sel:[0,1] op_sel_hi:[1,1]
 v_pk_fma_f32 v[242:243], v[242:243], v[16:17], v[26:27] op_sel:[0,1,0] op_sel_hi:[1,1,1]
 v_lshlrev_b32 v28, 16, v122
 v_and_b32 v29, s58, v122
 v_pk_mul_f32 v[28:29], v[28:29], v[18:19] op_sel:[0,1] op_sel_hi:[1,1]
 v_pk_fma_f32 v[244:245], v[244:245], v[16:17], v[28:29] op_sel:[0,1,0] op_sel_hi:[1,1,1]
 v_lshlrev_b32 v30, 16, v123
 v_and_b32 v31, s58, v123
 v_pk_mul_f32 v[30:31], v[30:31], v[18:19] op_sel:[0,1] op_sel_hi:[1,1]
 v_pk_fma_f32 v[246:247], v[246:247], v[16:17], v[30:31] op_sel:[0,1,0] op_sel_hi:[1,1,1]
 v_cvt_pk_bf16_f32 v240, v240, v241
 v_cvt_pk_bf16_f32 v241, v242, v243
 v_cvt_pk_bf16_f32 v242, v244, v245
 v_cvt_pk_bf16_f32 v243, v246, v247
 v_lshlrev_b32 v24, 16, v124
 v_and_b32 v25, s58, v124
 v_pk_mul_f32 v[24:25], v[24:25], v[18:19] op_sel:[0,1] op_sel_hi:[1,1]
 v_pk_fma_f32 v[248:249], v[248:249], v[16:17], v[24:25] op_sel:[0,1,0] op_sel_hi:[1,1,1]
 v_lshlrev_b32 v26, 16, v125
 v_and_b32 v27, s58, v125
 v_pk_mul_f32 v[26:27], v[26:27], v[18:19] op_sel:[0,1] op_sel_hi:[1,1]
 v_pk_fma_f32 v[250:251], v[250:251], v[16:17], v[26:27] op_sel:[0,1,0] op_sel_hi:[1,1,1]
 v_lshlrev_b32 v28, 16, v126
 v_and_b32 v29, s58, v126
 v_pk_mul_f32 v[28:29], v[28:29], v[18:19] op_sel:[0,1] op_sel_hi:[1,1]
 v_pk_fma_f32 v[252:253], v[252:253], v[16:17], v[28:29] op_sel:[0,1,0] op_sel_hi:[1,1,1]
 v_lshlrev_b32 v30, 16, v127
 v_and_b32 v31, s58, v127
 v_pk_mul_f32 v[30:31], v[30:31], v[18:19] op_sel:[0,1] op_sel_hi:[1,1]
 v_pk_fma_f32 v[254:255], v[254:255], v[16:17], v[30:31] op_sel:[0,1,0] op_sel_hi:[1,1,1]
 v_cvt_pk_bf16_f32 v248, v248, v249
 v_cvt_pk_bf16_f32 v249, v250, v251
 v_cvt_pk_bf16_f32 v250, v252, v253
 v_cvt_pk_bf16_f32 v251, v254, v255
L_attdone:
 v_accvgpr_read_b32 v44, a254
 ds_read_b64_tr_b16 a[160:161], v44 offset:0
 ds_read_b64_tr_b16 a[162:163], v44 offset:2048
 ds_read_b64_tr_b16 a[164:165], v44 offset:4096
 ds_read_b64_tr_b16 a[166:167], v44 offset:6144
 ds_read_b64_tr_b16 a[168:169], v44 offset:8192
 ds_read_b64_tr_b16 a[170:171], v44 offset:10240
 ds_read_b64_tr_b16 a[172:173], v44 offset:12288
 ds_read_b64_tr_b16 a[174:175], v44 offset:14336
 ds_read_b64_tr_b16 a[176:177], v44 offset:16384
 ds_read_b64_tr_b16 a[178:179], v44 offset:18432
 ds_read_b64_tr_b16 a[180:181], v44 offset:20480
 ds_read_b64_tr_b16 a[182:183], v44 offset:22528
 ds_read_b64_tr_b16 a[184:185], v44 offset:24576
 ds_read_b64_tr_b16 a[186:187], v44 offset:26624
 s_branch L_op1in
 s_endpgm
L_codeend:
.section .rodata,"a"
.p2align 6
.amdhsa_kernel concat_heads__ssm_conv_h3__compressed_kv_cla__prompt_kernel
  .amdhsa_next_free_vgpr 512
  .amdhsa_next_free_sgpr 102
  .amdhsa_accum_offset 256
  .amdhsa_group_segment_fixed_size 0
  .amdhsa_kernarg_size 120
  .amdhsa_user_sgpr_count 2
  .amdhsa_user_sgpr_kernarg_segment_ptr 1
  .amdhsa_system_sgpr_workgroup_id_x 1
  .amdhsa_float_denorm_mode_32 3
.end_amdhsa_kernel
```
